```python
import torch

def _softmax(x, axis=-1):
    return torch.softmax(x, dim=axis)
def _gelu(x):
    return torch.nn.functional.gelu(x, approximate="tanh")
def _silu(x):
    return torch.nn.functional.silu(x)
def _sigmoid(x):
    return torch.sigmoid(x)
def _layernorm(x, axis=-1, eps=1e-5):
    m = x.mean(dim=axis, keepdim=True)
    v = x.var(dim=axis, keepdim=True, unbiased=False)
    return (x - m) / torch.sqrt(v + eps)
def _scatter_add(tgt, idx, src, axis=0):
    return tgt.clone().index_add_(axis, idx, src)
def _segment_sum(src, seg, n):
    out = torch.zeros((n,) + src.shape[1:], dtype=src.dtype)
    return out.index_add_(0, seg, src)
def _pad(x, pw):
    flat = tuple(v for pair in reversed(pw) for v in pair)
    return torch.nn.functional.pad(x, flat)

kernel_name = 'gated_mix__sliding_local_dilated__compressed_kv_cla__prompt'

def setup_inputs():

    _w = (lambda a: (lambda t: t.to(torch.bfloat16) if t.is_floating_point() else t)(torch.as_tensor(a)))
    def _A_setup():
        B, S, D = 1, 2048, 576
        return {
            "x": _w((lambda *s: torch.randn(*s, dtype=torch.bfloat16) * 0.05)(B, S, D)),
            "wqkv": _w((lambda *s: torch.randn(*s, dtype=torch.bfloat16) * 1.6)(D, 3 * D)),
            "wo": _w((lambda *s: torch.randn(*s, dtype=torch.bfloat16) * 0.05)(D, D)),
        }
    _A_in = _A_setup()

    def _B_setup():
        B, H, Sq, Sk, D, M = 1, 32, 2048, 2048, 128, 576
        Dc = 4 * D
        return {
            "x": _w((lambda *s: torch.randn(*s, dtype=torch.bfloat16) * 0.05)(B, Sq, M)),
            "c_kv": _w((lambda *s: torch.randn(*s, dtype=torch.bfloat16) * 1.6)(B, Sk, Dc)),
            "w_q": _w((lambda *s: torch.randn(*s, dtype=torch.bfloat16) * 6.4)(M, H, D) * (M ** -0.5)),
            "w_uk": _w((lambda *s: torch.randn(*s, dtype=torch.bfloat16) * 6.4)(Dc, H, D) * (Dc ** -0.5)),
            "w_uv": _w((lambda *s: torch.randn(*s, dtype=torch.bfloat16) * 1.6)(Dc, H, D) * (Dc ** -0.5)),
            "w_o": _w((lambda *s: torch.randn(*s, dtype=torch.bfloat16) * 1.6)(H, D, M) * ((H * D) ** -0.5)),
        }
    _B_in = _B_setup()

    return {
        "A_x": _A_in["x"],
        "A_wqkv": _A_in["wqkv"],
        "A_wo": _A_in["wo"],
        "B_x": _B_in["x"],
        "B_c_kv": _B_in["c_kv"],
        "B_w_q": _B_in["w_q"],
        "B_w_uk": _B_in["w_uk"],
        "B_w_uv": _B_in["w_uv"],
        "B_w_o": _B_in["w_o"],
        "gate_w": _w((lambda *s: torch.randn(*s, dtype=torch.bfloat16) * 0.05)(576) * 16.0),
    }

def reference(A_x, A_wqkv, A_wo, B_x, B_c_kv, B_w_q, B_w_uk, B_w_uv, B_w_o, gate_w):
    def _A_ref(x, wqkv, wo):
        B, S, D = x.shape
        H = 32; Dh = D // H
        W, dil = 8, 2
        qkv = (lambda x, *d: x.permute(*d))((x @ wqkv).reshape(B, S, 3, H, Dh), 2, 0, 3, 1, 4)
        q, k, v = qkv[0], qkv[1], qkv[2]
        scale = Dh ** -0.5
        pos = torch.arange(S)
        off = torch.arange(W) * dil
        idx = pos[:, None] - off[None, :]
        mask = idx >= 0
        idx_c = torch.where(mask, idx, 0).reshape(-1)
        kg = k[:, :, idx_c, :].reshape(B, H, S, W, Dh)
        vg = v[:, :, idx_c, :].reshape(B, H, S, W, Dh)
        logits = torch.einsum("bhsd,bhswd->bhsw", q, kg) * scale
        logits = torch.where(mask[None, None, :, :], logits, -1e9)
        attn = _softmax(logits, axis=-1)
        o = torch.einsum("bhsw,bhswd->bhsd", attn, vg)
        return (lambda x, *d: x.permute(*d))(o, 0, 2, 1, 3).reshape(B, S, D) @ wo

    def _B_ref(x, c_kv, w_q, w_uk, w_uv, w_o):
        B, Sq, M = x.shape[0], x.shape[1], x.shape[2]
        Sk = c_kv.shape[1]
        H, D = w_q.shape[1], w_q.shape[2]
        q = torch.einsum("bqm,mhd->bhqd", x, w_q)
        k = torch.einsum("bkc,chd->bhkd", c_kv, w_uk)
        v = torch.einsum("bkc,chd->bhkd", c_kv, w_uv)
        scores = torch.einsum("bhqd,bhkd->bhqk", q, k) * (D ** -0.5)
        off = Sk - Sq
        qi = torch.arange(Sq)[:, None]
        kj = torch.arange(Sk)[None, :]
        cmask = kj <= (qi + off)
        scores = torch.where(cmask[None, None], scores, -1e9)
        p = _softmax(scores, axis=-1)
        ctx = torch.einsum("bhqk,bhkd->bhqd", p, v)
        return torch.einsum("bhqd,hdm->bqm", ctx, w_o)

    x = A_x
    g = _sigmoid((x * gate_w).sum(-1, keepdims=True))
    a = _A_ref(x, A_wqkv, A_wo)
    b = _B_ref(x, B_c_kv, B_w_q, B_w_uk, B_w_uv, B_w_o)
    return g * a + (1 - g) * b
```

```asm
; @launch kernel=k0_kernel grid=(256,1,1) block=(256,1,1) lds=0
; @launch kernel=k1_kernel grid=(256,1,1) block=(256,1,1) lds=163840
; @launch kernel=k2_kernel grid=(256,1,1) block=(256,1,1) lds=163840
; @launch kernel=k3_kernel grid=(256,1,1) block=(256,1,1) lds=40960
; @launch kernel=k4_kernel grid=(256,1,1) block=(256,1,1) lds=81920
.amdgcn_target "amdgcn-amd-amdhsa--gfx950"
.text

.globl k0_kernel
.p2align 8
.type k0_kernel,@function
k0_kernel:
s_cmp_ge_u32 s2, 256
s_cbranch_scc1 K0_END
s_load_dwordx16 s[16:31], s[0:1], 0
s_load_dwordx8 s[32:39], s[0:1], 64
s_load_dwordx2 s[40:41], s[0:1], 96
v_lshrrev_b32 v5, 6, v0
v_and_b32 v1, 63, v0
v_readfirstlane_b32 s3, v5
v_and_b32 v2, 15, v0
v_lshrrev_b32 v3, 4, v1
v_lshlrev_b32 v4, 4, v1
s_and_b32 s7, s2, 7
s_lshr_b32 s6, s2, 3
s_and_b32 s4, s6, 3
s_lshl_b32 s8, s7, 2
s_add_u32 s4, s4, s8
s_lshr_b32 s5, s6, 2
s_waitcnt lgkmcnt(0)
s_mov_b32 s52, s40
s_mov_b32 s53, s41
s_mov_b32 s54, 268435456
s_mov_b32 s55, 0x20000
s_mov_b32 s44, s18
s_mov_b32 s45, s19
s_mov_b32 s46, 1990656
s_mov_b32 s47, 0x20000
s_mov_b32 s56, s34
s_mov_b32 s57, s35
s_mov_b32 s58, 1152
s_mov_b32 s59, 0x20000
v_lshrrev_b32 v5, 2, v2
v_and_b32 v6, 3, v2
s_mul_i32 s8, s4, 18
s_lshl_b32 s9, s3, 2
s_add_u32 s9, s9, s8
v_mul_u32_u24 v7, 576, v5
v_add3_u32 v7, v7, v6, s9
s_lshl_b32 s9, s3, 2
v_add_u32 v8, s9, v6
v_lshrrev_b32 v9, 1, v8
v_mul_u32_u24 v9, 576, v9
v_and_b32 v10, 1, v8
s_add_u32 s8, s8, 16
v_add3_u32 v9, v9, v10, s8
v_cmp_eq_u32 vcc, 3, v5
s_nop 1
v_cndmask_b32 v7, v7, v9, vcc
v_cmp_lt_u32 s[12:13], 5, v8
s_nop 1
s_and_b64 s[12:13], s[12:13], vcc
v_cmp_eq_u32 s[14:15], 6, v8
s_nop 1
s_and_b64 s[14:15], s[14:15], vcc
v_mul_u32_u24 v9, 27648, v3
v_lshl_add_u32 v7, v7, 1, v9
v_mov_b32 v9, 2147418112
v_cndmask_b32 v7, v7, v9, s[12:13]
v_lshlrev_b32 v8, 4, v3
v_cndmask_b32 v8, v9, v8, s[14:15]
s_add_u32 s8, s5, 0
s_mul_i32 s9, s8, 110592
s_add_u32 s10, s9, 0
buffer_load_ushort v12, v7, s[44:47], s10 offen
s_add_u32 s10, s9, 3456
buffer_load_ushort v20, v7, s[44:47], s10 offen
s_add_u32 s10, s9, 6912
buffer_load_ushort v13, v7, s[44:47], s10 offen
s_add_u32 s10, s9, 10368
buffer_load_ushort v21, v7, s[44:47], s10 offen
s_add_u32 s10, s9, 13824
buffer_load_ushort v14, v7, s[44:47], s10 offen
s_add_u32 s10, s9, 17280
buffer_load_ushort v22, v7, s[44:47], s10 offen
s_add_u32 s10, s9, 20736
buffer_load_ushort v15, v7, s[44:47], s10 offen
s_add_u32 s10, s9, 24192
buffer_load_ushort v23, v7, s[44:47], s10 offen
s_lshl_b32 s9, s8, 6
buffer_load_dwordx4 v[16:19], v8, s[56:59], s9 offen
s_mul_i32 s9, s4, 72
s_lshl_b32 s8, s8, 2
s_add_u32 s9, s9, s8
s_add_u32 s9, s9, s3
s_lshl_b32 s9, s9, 10
s_add_u32 s9, s9, 35651584
s_waitcnt vmcnt(0)
v_lshl_or_b32 v12, v20, 16, v12
v_lshl_or_b32 v13, v21, 16, v13
v_lshl_or_b32 v14, v22, 16, v14
v_lshl_or_b32 v15, v23, 16, v15
v_or_b32 v12, v12, v16
v_or_b32 v13, v13, v17
v_or_b32 v14, v14, v18
v_or_b32 v15, v15, v19
buffer_store_dwordx4 v[12:15], v4, s[52:55], s9 offen
s_nop 1
s_add_u32 s8, s5, 8
s_mul_i32 s9, s8, 110592
s_add_u32 s10, s9, 0
buffer_load_ushort v12, v7, s[44:47], s10 offen
s_add_u32 s10, s9, 3456
buffer_load_ushort v20, v7, s[44:47], s10 offen
s_add_u32 s10, s9, 6912
buffer_load_ushort v13, v7, s[44:47], s10 offen
s_add_u32 s10, s9, 10368
buffer_load_ushort v21, v7, s[44:47], s10 offen
s_add_u32 s10, s9, 13824
buffer_load_ushort v14, v7, s[44:47], s10 offen
s_add_u32 s10, s9, 17280
buffer_load_ushort v22, v7, s[44:47], s10 offen
s_add_u32 s10, s9, 20736
buffer_load_ushort v15, v7, s[44:47], s10 offen
s_add_u32 s10, s9, 24192
buffer_load_ushort v23, v7, s[44:47], s10 offen
s_lshl_b32 s9, s8, 6
buffer_load_dwordx4 v[16:19], v8, s[56:59], s9 offen
s_mul_i32 s9, s4, 72
s_lshl_b32 s8, s8, 2
s_add_u32 s9, s9, s8
s_add_u32 s9, s9, s3
s_lshl_b32 s9, s9, 10
s_add_u32 s9, s9, 35651584
s_waitcnt vmcnt(0)
v_lshl_or_b32 v12, v20, 16, v12
v_lshl_or_b32 v13, v21, 16, v13
v_lshl_or_b32 v14, v22, 16, v14
v_lshl_or_b32 v15, v23, 16, v15
v_or_b32 v12, v12, v16
v_or_b32 v13, v13, v17
v_or_b32 v14, v14, v18
v_or_b32 v15, v15, v19
buffer_store_dwordx4 v[12:15], v4, s[52:55], s9 offen
s_nop 1
s_add_u32 s8, s5, 16
s_cmp_ge_u32 s8, 18
s_cbranch_scc1 K0_WO
s_mul_i32 s9, s8, 110592
s_add_u32 s10, s9, 0
buffer_load_ushort v12, v7, s[44:47], s10 offen
s_add_u32 s10, s9, 3456
buffer_load_ushort v20, v7, s[44:47], s10 offen
s_add_u32 s10, s9, 6912
buffer_load_ushort v13, v7, s[44:47], s10 offen
s_add_u32 s10, s9, 10368
buffer_load_ushort v21, v7, s[44:47], s10 offen
s_add_u32 s10, s9, 13824
buffer_load_ushort v14, v7, s[44:47], s10 offen
s_add_u32 s10, s9, 17280
buffer_load_ushort v22, v7, s[44:47], s10 offen
s_add_u32 s10, s9, 20736
buffer_load_ushort v15, v7, s[44:47], s10 offen
s_add_u32 s10, s9, 24192
buffer_load_ushort v23, v7, s[44:47], s10 offen
s_lshl_b32 s9, s8, 6
buffer_load_dwordx4 v[16:19], v8, s[56:59], s9 offen
s_mul_i32 s9, s4, 72
s_lshl_b32 s8, s8, 2
s_add_u32 s9, s9, s8
s_add_u32 s9, s9, s3
s_lshl_b32 s9, s9, 10
s_add_u32 s9, s9, 35651584
s_waitcnt vmcnt(0)
v_lshl_or_b32 v12, v20, 16, v12
v_lshl_or_b32 v13, v21, 16, v13
v_lshl_or_b32 v14, v22, 16, v14
v_lshl_or_b32 v15, v23, 16, v15
v_or_b32 v12, v12, v16
v_or_b32 v13, v13, v17
v_or_b32 v14, v14, v18
v_or_b32 v15, v15, v19
buffer_store_dwordx4 v[12:15], v4, s[52:55], s9 offen
s_nop 1
K0_WO:
s_mov_b32 s44, s32
s_mov_b32 s45, s33
s_mov_b32 s46, 4718592
s_mov_b32 s47, 0x20000
s_mov_b32 s48, s20
s_mov_b32 s49, s21
s_mov_b32 s50, 663552
s_mov_b32 s51, 0x20000
s_add_u32 s8, s6, 0
s_lshl_b32 s9, s8, 1
s_mul_i32 s11, s7, 72
s_add_u32 s9, s9, 0
v_mov_b32 v5, s9
s_lshl_b32 s12, s3, 4
s_add_u32 s11, s11, s12
v_add_u32 v6, s11, v2
v_lshlrev_b32 v5, 5, v5
v_lshl_add_u32 v5, v3, 2, v5
v_mul_u32_u24 v5, 1152, v5
v_lshl_add_u32 v7, v6, 1, v5
s_add_u32 s10, 0, 0
buffer_load_ushort v12, v7, s[44:47], s10 offen
s_add_u32 s10, 0, 1152
buffer_load_ushort v20, v7, s[44:47], s10 offen
s_add_u32 s10, 0, 2304
buffer_load_ushort v13, v7, s[44:47], s10 offen
s_add_u32 s10, 0, 3456
buffer_load_ushort v21, v7, s[44:47], s10 offen
s_add_u32 s10, 0, 18432
buffer_load_ushort v14, v7, s[44:47], s10 offen
s_add_u32 s10, 0, 19584
buffer_load_ushort v22, v7, s[44:47], s10 offen
s_add_u32 s10, 0, 20736
buffer_load_ushort v15, v7, s[44:47], s10 offen
s_add_u32 s10, 0, 21888
buffer_load_ushort v23, v7, s[44:47], s10 offen
s_mul_i32 s9, s7, 73
s_add_u32 s9, s9, s8
s_mul_i32 s9, s9, 9
s_add_u32 s9, s9, s3
s_add_u32 s9, s9, 0
s_lshl_b32 s9, s9, 10
s_add_u32 s9, s9, 38797312
s_waitcnt vmcnt(0)
v_lshl_or_b32 v12, v20, 16, v12
v_lshl_or_b32 v13, v21, 16, v13
v_lshl_or_b32 v14, v22, 16, v14
v_lshl_or_b32 v15, v23, 16, v15
buffer_store_dwordx4 v[12:15], v4, s[52:55], s9 offen
s_nop 1
s_lshl_b32 s9, s8, 1
s_mul_i32 s11, s7, 72
s_add_u32 s9, s9, 1
v_mov_b32 v5, s9
s_lshl_b32 s12, s3, 4
s_add_u32 s11, s11, s12
v_add_u32 v6, s11, v2
v_lshlrev_b32 v5, 5, v5
v_lshl_add_u32 v5, v3, 2, v5
v_mul_u32_u24 v5, 1152, v5
v_lshl_add_u32 v7, v6, 1, v5
s_add_u32 s10, 0, 0
buffer_load_ushort v12, v7, s[44:47], s10 offen
s_add_u32 s10, 0, 1152
buffer_load_ushort v20, v7, s[44:47], s10 offen
s_add_u32 s10, 0, 2304
buffer_load_ushort v13, v7, s[44:47], s10 offen
s_add_u32 s10, 0, 3456
buffer_load_ushort v21, v7, s[44:47], s10 offen
s_add_u32 s10, 0, 18432
buffer_load_ushort v14, v7, s[44:47], s10 offen
s_add_u32 s10, 0, 19584
buffer_load_ushort v22, v7, s[44:47], s10 offen
s_add_u32 s10, 0, 20736
buffer_load_ushort v15, v7, s[44:47], s10 offen
s_add_u32 s10, 0, 21888
buffer_load_ushort v23, v7, s[44:47], s10 offen
s_mul_i32 s9, s7, 73
s_add_u32 s9, s9, s8
s_mul_i32 s9, s9, 9
s_add_u32 s9, s9, s3
s_add_u32 s9, s9, 4
s_lshl_b32 s9, s9, 10
s_add_u32 s9, s9, 38797312
s_waitcnt vmcnt(0)
v_lshl_or_b32 v12, v20, 16, v12
v_lshl_or_b32 v13, v21, 16, v13
v_lshl_or_b32 v14, v22, 16, v14
v_lshl_or_b32 v15, v23, 16, v15
buffer_store_dwordx4 v[12:15], v4, s[52:55], s9 offen
s_nop 1
s_cmp_lg_u32 s3, 0
s_cbranch_scc1 K0_S0
s_lshl_b32 s9, s8, 1
s_mul_i32 s11, s7, 72
v_lshrrev_b32 v5, 3, v2
v_add_u32 v5, s9, v5
v_and_b32 v6, 7, v2
s_add_u32 s11, s11, 64
v_add_u32 v6, s11, v6
v_lshlrev_b32 v5, 5, v5
v_lshl_add_u32 v5, v3, 2, v5
v_mul_u32_u24 v5, 1152, v5
v_lshl_add_u32 v7, v6, 1, v5
s_add_u32 s10, 0, 0
buffer_load_ushort v12, v7, s[44:47], s10 offen
s_add_u32 s10, 0, 1152
buffer_load_ushort v20, v7, s[44:47], s10 offen
s_add_u32 s10, 0, 2304
buffer_load_ushort v13, v7, s[44:47], s10 offen
s_add_u32 s10, 0, 3456
buffer_load_ushort v21, v7, s[44:47], s10 offen
s_add_u32 s10, 0, 18432
buffer_load_ushort v14, v7, s[44:47], s10 offen
s_add_u32 s10, 0, 19584
buffer_load_ushort v22, v7, s[44:47], s10 offen
s_add_u32 s10, 0, 20736
buffer_load_ushort v15, v7, s[44:47], s10 offen
s_add_u32 s10, 0, 21888
buffer_load_ushort v23, v7, s[44:47], s10 offen
s_mul_i32 s9, s7, 73
s_add_u32 s9, s9, s8
s_mul_i32 s9, s9, 9
s_add_u32 s9, s9, 8
s_lshl_b32 s9, s9, 10
s_add_u32 s9, s9, 38797312
s_waitcnt vmcnt(0)
v_lshl_or_b32 v12, v20, 16, v12
v_lshl_or_b32 v13, v21, 16, v13
v_lshl_or_b32 v14, v22, 16, v14
v_lshl_or_b32 v15, v23, 16, v15
buffer_store_dwordx4 v[12:15], v4, s[52:55], s9 offen
s_nop 1
K0_S0:
s_add_u32 s8, s6, 32
s_lshl_b32 s9, s8, 1
s_mul_i32 s11, s7, 72
s_add_u32 s9, s9, 0
v_mov_b32 v5, s9
s_lshl_b32 s12, s3, 4
s_add_u32 s11, s11, s12
v_add_u32 v6, s11, v2
v_lshlrev_b32 v5, 5, v5
v_lshl_add_u32 v5, v3, 2, v5
v_mul_u32_u24 v5, 1152, v5
v_lshl_add_u32 v7, v6, 1, v5
s_add_u32 s10, 0, 0
buffer_load_ushort v12, v7, s[44:47], s10 offen
s_add_u32 s10, 0, 1152
buffer_load_ushort v20, v7, s[44:47], s10 offen
s_add_u32 s10, 0, 2304
buffer_load_ushort v13, v7, s[44:47], s10 offen
s_add_u32 s10, 0, 3456
buffer_load_ushort v21, v7, s[44:47], s10 offen
s_add_u32 s10, 0, 18432
buffer_load_ushort v14, v7, s[44:47], s10 offen
s_add_u32 s10, 0, 19584
buffer_load_ushort v22, v7, s[44:47], s10 offen
s_add_u32 s10, 0, 20736
buffer_load_ushort v15, v7, s[44:47], s10 offen
s_add_u32 s10, 0, 21888
buffer_load_ushort v23, v7, s[44:47], s10 offen
s_mul_i32 s9, s7, 73
s_add_u32 s9, s9, s8
s_mul_i32 s9, s9, 9
s_add_u32 s9, s9, s3
s_add_u32 s9, s9, 0
s_lshl_b32 s9, s9, 10
s_add_u32 s9, s9, 38797312
s_waitcnt vmcnt(0)
v_lshl_or_b32 v12, v20, 16, v12
v_lshl_or_b32 v13, v21, 16, v13
v_lshl_or_b32 v14, v22, 16, v14
v_lshl_or_b32 v15, v23, 16, v15
buffer_store_dwordx4 v[12:15], v4, s[52:55], s9 offen
s_nop 1
s_lshl_b32 s9, s8, 1
s_mul_i32 s11, s7, 72
s_add_u32 s9, s9, 1
v_mov_b32 v5, s9
s_lshl_b32 s12, s3, 4
s_add_u32 s11, s11, s12
v_add_u32 v6, s11, v2
v_lshlrev_b32 v5, 5, v5
v_lshl_add_u32 v5, v3, 2, v5
v_mul_u32_u24 v5, 1152, v5
v_lshl_add_u32 v7, v6, 1, v5
s_add_u32 s10, 0, 0
buffer_load_ushort v12, v7, s[44:47], s10 offen
s_add_u32 s10, 0, 1152
buffer_load_ushort v20, v7, s[44:47], s10 offen
s_add_u32 s10, 0, 2304
buffer_load_ushort v13, v7, s[44:47], s10 offen
s_add_u32 s10, 0, 3456
buffer_load_ushort v21, v7, s[44:47], s10 offen
s_add_u32 s10, 0, 18432
buffer_load_ushort v14, v7, s[44:47], s10 offen
s_add_u32 s10, 0, 19584
buffer_load_ushort v22, v7, s[44:47], s10 offen
s_add_u32 s10, 0, 20736
buffer_load_ushort v15, v7, s[44:47], s10 offen
s_add_u32 s10, 0, 21888
buffer_load_ushort v23, v7, s[44:47], s10 offen
s_mul_i32 s9, s7, 73
s_add_u32 s9, s9, s8
s_mul_i32 s9, s9, 9
s_add_u32 s9, s9, s3
s_add_u32 s9, s9, 4
s_lshl_b32 s9, s9, 10
s_add_u32 s9, s9, 38797312
s_waitcnt vmcnt(0)
v_lshl_or_b32 v12, v20, 16, v12
v_lshl_or_b32 v13, v21, 16, v13
v_lshl_or_b32 v14, v22, 16, v14
v_lshl_or_b32 v15, v23, 16, v15
buffer_store_dwordx4 v[12:15], v4, s[52:55], s9 offen
s_nop 1
s_cmp_lg_u32 s3, 0
s_cbranch_scc1 K0_S1
s_lshl_b32 s9, s8, 1
s_mul_i32 s11, s7, 72
v_lshrrev_b32 v5, 3, v2
v_add_u32 v5, s9, v5
v_and_b32 v6, 7, v2
s_add_u32 s11, s11, 64
v_add_u32 v6, s11, v6
v_lshlrev_b32 v5, 5, v5
v_lshl_add_u32 v5, v3, 2, v5
v_mul_u32_u24 v5, 1152, v5
v_lshl_add_u32 v7, v6, 1, v5
s_add_u32 s10, 0, 0
buffer_load_ushort v12, v7, s[44:47], s10 offen
s_add_u32 s10, 0, 1152
buffer_load_ushort v20, v7, s[44:47], s10 offen
s_add_u32 s10, 0, 2304
buffer_load_ushort v13, v7, s[44:47], s10 offen
s_add_u32 s10, 0, 3456
buffer_load_ushort v21, v7, s[44:47], s10 offen
s_add_u32 s10, 0, 18432
buffer_load_ushort v14, v7, s[44:47], s10 offen
s_add_u32 s10, 0, 19584
buffer_load_ushort v22, v7, s[44:47], s10 offen
s_add_u32 s10, 0, 20736
buffer_load_ushort v15, v7, s[44:47], s10 offen
s_add_u32 s10, 0, 21888
buffer_load_ushort v23, v7, s[44:47], s10 offen
s_mul_i32 s9, s7, 73
s_add_u32 s9, s9, s8
s_mul_i32 s9, s9, 9
s_add_u32 s9, s9, 8
s_lshl_b32 s9, s9, 10
s_add_u32 s9, s9, 38797312
s_waitcnt vmcnt(0)
v_lshl_or_b32 v12, v20, 16, v12
v_lshl_or_b32 v13, v21, 16, v13
v_lshl_or_b32 v14, v22, 16, v14
v_lshl_or_b32 v15, v23, 16, v15
buffer_store_dwordx4 v[12:15], v4, s[52:55], s9 offen
s_nop 1
K0_S1:
s_cmp_ge_u32 s6, 8
s_cbranch_scc1 K0_P3
s_add_u32 s8, s6, 64
s_lshl_b32 s9, s8, 1
s_mul_i32 s11, s7, 72
s_add_u32 s9, s9, 0
v_mov_b32 v5, s9
s_lshl_b32 s12, s3, 4
s_add_u32 s11, s11, s12
v_add_u32 v6, s11, v2
v_subrev_u32 v5, 128, v5
v_lshlrev_b32 v5, 1, v5
v_lshrrev_b32 v7, 1, v3
v_add_u32 v5, v5, v7
v_mul_u32_u24 v5, 18, v5
v_and_b32 v7, 1, v3
v_lshl_add_u32 v5, v7, 3, v5
v_mul_u32_u24 v5, 1152, v5
v_lshl_add_u32 v7, v6, 1, v5
s_add_u32 s10, 0, 0
buffer_load_ushort v12, v7, s[48:51], s10 offen
s_add_u32 s10, 0, 1152
buffer_load_ushort v20, v7, s[48:51], s10 offen
s_add_u32 s10, 0, 2304
buffer_load_ushort v13, v7, s[48:51], s10 offen
s_add_u32 s10, 0, 3456
buffer_load_ushort v21, v7, s[48:51], s10 offen
s_add_u32 s10, 0, 4608
buffer_load_ushort v14, v7, s[48:51], s10 offen
s_add_u32 s10, 0, 5760
buffer_load_ushort v22, v7, s[48:51], s10 offen
s_add_u32 s10, 0, 6912
buffer_load_ushort v15, v7, s[48:51], s10 offen
s_add_u32 s10, 0, 8064
buffer_load_ushort v23, v7, s[48:51], s10 offen
s_mul_i32 s9, s7, 73
s_add_u32 s9, s9, s8
s_mul_i32 s9, s9, 9
s_add_u32 s9, s9, s3
s_add_u32 s9, s9, 0
s_lshl_b32 s9, s9, 10
s_add_u32 s9, s9, 38797312
s_waitcnt vmcnt(0)
v_lshl_or_b32 v12, v20, 16, v12
v_lshl_or_b32 v13, v21, 16, v13
v_lshl_or_b32 v14, v22, 16, v14
v_lshl_or_b32 v15, v23, 16, v15
buffer_store_dwordx4 v[12:15], v4, s[52:55], s9 offen
s_nop 1
s_lshl_b32 s9, s8, 1
s_mul_i32 s11, s7, 72
s_add_u32 s9, s9, 1
v_mov_b32 v5, s9
s_lshl_b32 s12, s3, 4
s_add_u32 s11, s11, s12
v_add_u32 v6, s11, v2
v_subrev_u32 v5, 128, v5
v_lshlrev_b32 v5, 1, v5
v_lshrrev_b32 v7, 1, v3
v_add_u32 v5, v5, v7
v_mul_u32_u24 v5, 18, v5
v_and_b32 v7, 1, v3
v_lshl_add_u32 v5, v7, 3, v5
v_mul_u32_u24 v5, 1152, v5
v_lshl_add_u32 v7, v6, 1, v5
s_add_u32 s10, 0, 0
buffer_load_ushort v12, v7, s[48:51], s10 offen
s_add_u32 s10, 0, 1152
buffer_load_ushort v20, v7, s[48:51], s10 offen
s_add_u32 s10, 0, 2304
buffer_load_ushort v13, v7, s[48:51], s10 offen
s_add_u32 s10, 0, 3456
buffer_load_ushort v21, v7, s[48:51], s10 offen
s_add_u32 s10, 0, 4608
buffer_load_ushort v14, v7, s[48:51], s10 offen
s_add_u32 s10, 0, 5760
buffer_load_ushort v22, v7, s[48:51], s10 offen
s_add_u32 s10, 0, 6912
buffer_load_ushort v15, v7, s[48:51], s10 offen
s_add_u32 s10, 0, 8064
buffer_load_ushort v23, v7, s[48:51], s10 offen
s_mul_i32 s9, s7, 73
s_add_u32 s9, s9, s8
s_mul_i32 s9, s9, 9
s_add_u32 s9, s9, s3
s_add_u32 s9, s9, 4
s_lshl_b32 s9, s9, 10
s_add_u32 s9, s9, 38797312
s_waitcnt vmcnt(0)
v_lshl_or_b32 v12, v20, 16, v12
v_lshl_or_b32 v13, v21, 16, v13
v_lshl_or_b32 v14, v22, 16, v14
v_lshl_or_b32 v15, v23, 16, v15
buffer_store_dwordx4 v[12:15], v4, s[52:55], s9 offen
s_nop 1
s_cmp_lg_u32 s3, 0
s_cbranch_scc1 K0_S2
s_lshl_b32 s9, s8, 1
s_mul_i32 s11, s7, 72
v_lshrrev_b32 v5, 3, v2
v_add_u32 v5, s9, v5
v_and_b32 v6, 7, v2
s_add_u32 s11, s11, 64
v_add_u32 v6, s11, v6
v_subrev_u32 v5, 128, v5
v_lshlrev_b32 v5, 1, v5
v_lshrrev_b32 v7, 1, v3
v_add_u32 v5, v5, v7
v_mul_u32_u24 v5, 18, v5
v_and_b32 v7, 1, v3
v_lshl_add_u32 v5, v7, 3, v5
v_mul_u32_u24 v5, 1152, v5
v_lshl_add_u32 v7, v6, 1, v5
s_add_u32 s10, 0, 0
buffer_load_ushort v12, v7, s[48:51], s10 offen
s_add_u32 s10, 0, 1152
buffer_load_ushort v20, v7, s[48:51], s10 offen
s_add_u32 s10, 0, 2304
buffer_load_ushort v13, v7, s[48:51], s10 offen
s_add_u32 s10, 0, 3456
buffer_load_ushort v21, v7, s[48:51], s10 offen
s_add_u32 s10, 0, 4608
buffer_load_ushort v14, v7, s[48:51], s10 offen
s_add_u32 s10, 0, 5760
buffer_load_ushort v22, v7, s[48:51], s10 offen
s_add_u32 s10, 0, 6912
buffer_load_ushort v15, v7, s[48:51], s10 offen
s_add_u32 s10, 0, 8064
buffer_load_ushort v23, v7, s[48:51], s10 offen
s_mul_i32 s9, s7, 73
s_add_u32 s9, s9, s8
s_mul_i32 s9, s9, 9
s_add_u32 s9, s9, 8
s_lshl_b32 s9, s9, 10
s_add_u32 s9, s9, 38797312
s_waitcnt vmcnt(0)
v_lshl_or_b32 v12, v20, 16, v12
v_lshl_or_b32 v13, v21, 16, v13
v_lshl_or_b32 v14, v22, 16, v14
v_lshl_or_b32 v15, v23, 16, v15
buffer_store_dwordx4 v[12:15], v4, s[52:55], s9 offen
s_nop 1
K0_S2:
s_branch K0_END
K0_P3:
s_cmp_lg_u32 s6, 8
s_cbranch_scc1 K0_END
s_add_u32 s8, s6, 64
s_lshl_b32 s9, s8, 1
s_mul_i32 s11, s7, 72
s_add_u32 s9, s9, 0
v_mov_b32 v5, s9
s_lshl_b32 s12, s3, 4
s_add_u32 s11, s11, s12
v_add_u32 v6, s11, v2
v_subrev_u32 v5, 144, v5
v_lshlrev_b32 v5, 4, v5
v_lshl_add_u32 v5, v3, 2, v5
v_mul_u32_u24 v5, 18, v5
v_add_u32 v5, 16, v5
v_mul_u32_u24 v5, 1152, v5
v_lshl_add_u32 v7, v6, 1, v5
s_add_u32 s10, 0, 0
buffer_load_ushort v12, v7, s[48:51], s10 offen
s_add_u32 s10, 0, 1152
buffer_load_ushort v20, v7, s[48:51], s10 offen
s_add_u32 s10, 0, 20736
buffer_load_ushort v13, v7, s[48:51], s10 offen
s_add_u32 s10, 0, 21888
buffer_load_ushort v21, v7, s[48:51], s10 offen
s_add_u32 s10, 0, 41472
buffer_load_ushort v14, v7, s[48:51], s10 offen
s_add_u32 s10, 0, 42624
buffer_load_ushort v22, v7, s[48:51], s10 offen
s_add_u32 s10, 0, 62208
buffer_load_ushort v15, v7, s[48:51], s10 offen
s_add_u32 s10, 0, 63360
buffer_load_ushort v23, v7, s[48:51], s10 offen
s_mul_i32 s9, s7, 73
s_add_u32 s9, s9, s8
s_mul_i32 s9, s9, 9
s_add_u32 s9, s9, s3
s_add_u32 s9, s9, 0
s_lshl_b32 s9, s9, 10
s_add_u32 s9, s9, 38797312
s_waitcnt vmcnt(0)
v_lshl_or_b32 v12, v20, 16, v12
v_lshl_or_b32 v13, v21, 16, v13
v_lshl_or_b32 v14, v22, 16, v14
v_lshl_or_b32 v15, v23, 16, v15
buffer_store_dwordx4 v[12:15], v4, s[52:55], s9 offen
s_nop 1
s_lshl_b32 s9, s8, 1
s_mul_i32 s11, s7, 72
s_add_u32 s9, s9, 1
v_mov_b32 v5, s9
s_lshl_b32 s12, s3, 4
s_add_u32 s11, s11, s12
v_add_u32 v6, s11, v2
v_subrev_u32 v5, 144, v5
v_lshlrev_b32 v5, 4, v5
v_lshl_add_u32 v5, v3, 2, v5
v_mul_u32_u24 v5, 18, v5
v_add_u32 v5, 16, v5
v_mul_u32_u24 v5, 1152, v5
v_lshl_add_u32 v7, v6, 1, v5
s_add_u32 s10, 0, 0
buffer_load_ushort v12, v7, s[48:51], s10 offen
s_add_u32 s10, 0, 1152
buffer_load_ushort v20, v7, s[48:51], s10 offen
s_add_u32 s10, 0, 20736
buffer_load_ushort v13, v7, s[48:51], s10 offen
s_add_u32 s10, 0, 21888
buffer_load_ushort v21, v7, s[48:51], s10 offen
s_add_u32 s10, 0, 41472
buffer_load_ushort v14, v7, s[48:51], s10 offen
s_add_u32 s10, 0, 42624
buffer_load_ushort v22, v7, s[48:51], s10 offen
s_add_u32 s10, 0, 62208
buffer_load_ushort v15, v7, s[48:51], s10 offen
s_add_u32 s10, 0, 63360
buffer_load_ushort v23, v7, s[48:51], s10 offen
s_mul_i32 s9, s7, 73
s_add_u32 s9, s9, s8
s_mul_i32 s9, s9, 9
s_add_u32 s9, s9, s3
s_add_u32 s9, s9, 4
s_lshl_b32 s9, s9, 10
s_add_u32 s9, s9, 38797312
s_waitcnt vmcnt(0)
v_lshl_or_b32 v12, v20, 16, v12
v_lshl_or_b32 v13, v21, 16, v13
v_lshl_or_b32 v14, v22, 16, v14
v_lshl_or_b32 v15, v23, 16, v15
buffer_store_dwordx4 v[12:15], v4, s[52:55], s9 offen
s_nop 1
s_cmp_lg_u32 s3, 0
s_cbranch_scc1 K0_S3
s_lshl_b32 s9, s8, 1
s_mul_i32 s11, s7, 72
v_lshrrev_b32 v5, 3, v2
v_add_u32 v5, s9, v5
v_and_b32 v6, 7, v2
s_add_u32 s11, s11, 64
v_add_u32 v6, s11, v6
v_subrev_u32 v5, 144, v5
v_lshlrev_b32 v5, 4, v5
v_lshl_add_u32 v5, v3, 2, v5
v_mul_u32_u24 v5, 18, v5
v_add_u32 v5, 16, v5
v_mul_u32_u24 v5, 1152, v5
v_lshl_add_u32 v7, v6, 1, v5
s_add_u32 s10, 0, 0
buffer_load_ushort v12, v7, s[48:51], s10 offen
s_add_u32 s10, 0, 1152
buffer_load_ushort v20, v7, s[48:51], s10 offen
s_add_u32 s10, 0, 20736
buffer_load_ushort v13, v7, s[48:51], s10 offen
s_add_u32 s10, 0, 21888
buffer_load_ushort v21, v7, s[48:51], s10 offen
s_add_u32 s10, 0, 41472
buffer_load_ushort v14, v7, s[48:51], s10 offen
s_add_u32 s10, 0, 42624
buffer_load_ushort v22, v7, s[48:51], s10 offen
s_add_u32 s10, 0, 62208
buffer_load_ushort v15, v7, s[48:51], s10 offen
s_add_u32 s10, 0, 63360
buffer_load_ushort v23, v7, s[48:51], s10 offen
s_mul_i32 s9, s7, 73
s_add_u32 s9, s9, s8
s_mul_i32 s9, s9, 9
s_add_u32 s9, s9, 8
s_lshl_b32 s9, s9, 10
s_add_u32 s9, s9, 38797312
s_waitcnt vmcnt(0)
v_lshl_or_b32 v12, v20, 16, v12
v_lshl_or_b32 v13, v21, 16, v13
v_lshl_or_b32 v14, v22, 16, v14
v_lshl_or_b32 v15, v23, 16, v15
buffer_store_dwordx4 v[12:15], v4, s[52:55], s9 offen
s_nop 1
K0_S3:
K0_END:
s_endpgm
.globl k1_kernel
.p2align 8
.type k1_kernel,@function
k1_kernel:
s_cmp_ge_u32 s2, 256
s_cbranch_scc1 K1_END
s_load_dwordx16 s[16:31], s[0:1], 0
s_load_dwordx8 s[32:39], s[0:1], 64
s_load_dwordx2 s[40:41], s[0:1], 96
v_lshrrev_b32 v5, 6, v0
v_and_b32 v1, 63, v0
v_readfirstlane_b32 s3, v5
v_and_b32 v2, 15, v0
v_lshrrev_b32 v3, 4, v1
v_lshlrev_b32 v4, 4, v1
s_and_b32 s7, s2, 7
s_lshr_b32 s6, s2, 3
s_and_b32 s4, s6, 3
s_lshl_b32 s8, s7, 2
s_add_u32 s4, s4, s8
s_lshr_b32 s5, s6, 2
s_waitcnt lgkmcnt(0)
s_mov_b32 s52, s40
s_mov_b32 s53, s41
s_mov_b32 s54, 268435456
s_mov_b32 s55, 0x20000
s_mov_b32 s44, s24
s_mov_b32 s45, s25
s_mov_b32 s46, 2097152
s_mov_b32 s47, 0x20000
s_cmp_lt_u32 s3, 2
s_cselect_b32 s48, s28, s30
s_cselect_b32 s49, s29, s31
s_mov_b32 s50, 4194304
s_mov_b32 s51, 0x20000
s_lshr_b32 s8, s3, 1
s_lshl_b32 s8, s8, 7
s_and_b32 s9, s3, 1
s_lshl_b32 s10, s9, 12
v_lshrrev_b32 v16, 3, v1
v_and_b32 v17, 7, v1
v_xor_b32 v18, v17, v3
v_mul_u32_u24 v19, 1024, v16
v_lshl_add_u32 v5, v18, 4, v19
v_xor_b32 v18, 4, v18
v_lshl_add_u32 v6, v18, 4, v19
v_add_u32 v6, 7168, v6
v_and_b32 v18, 1, v3
v_lshlrev_b32 v18, 1, v18
v_xor_b32 v18, v17, v18
v_lshlrev_b32 v19, 13, v16
v_lshl_add_u32 v7, v18, 4, v19
v_xor_b32 v18, 4, v18
v_lshl_add_u32 v8, v18, 4, v19
v_add_u32 v8, 64512, v8
v_lshrrev_b32 v16, 1, v2
v_xor_b32 v16, v16, v3
v_add_u32 v17, s8, v2
v_lshlrev_b32 v17, 7, v17
v_add_u32 v17, 65536, v17
v_lshl_add_u32 v9, v16, 4, v17
v_xor_b32 v10, 64, v9
v_bfe_u32 v16, v1, 2, 2
v_lshl_add_u32 v17, v3, 3, v16
v_lshlrev_b32 v17, 7, v17
v_and_b32 v18, 3, v1
v_lshl_add_u32 v17, v18, 3, v17
v_add_u32 v17, s10, v17
v_lshrrev_b32 v16, 1, v16
v_and_b32 v18, 1, v3
v_lshl_add_u32 v16, v18, 1, v16
v_xor_b32 v18, 0, v16
v_lshl_add_u32 v11, v18, 5, v17
v_xor_b32 v18, 1, v16
v_lshl_add_u32 v12, v18, 5, v17
v_xor_b32 v18, 2, v16
v_lshl_add_u32 v13, v18, 5, v17
v_xor_b32 v18, 3, v16
v_lshl_add_u32 v14, v18, 5, v17
v_mov_b32 v15, v4
s_mov_b32 s92, 0x8000
s_lshl_b32 s60, s5, 18
s_lshl_b32 s11, s3, 16
s_add_u32 s60, s60, s11
s_lshl_b32 s61, s3, 13
s_add_u32 s61, s61, 65536
s_lshl_b32 s62, s4, 8
s_lshl_b32 s11, s9, 7
s_add_u32 s62, s62, s11
s_lshl_b32 s63, s3, 12
s_add_u32 m0, s61, 0
s_add_u32 s64, s60, 0
buffer_load_dwordx4 v5, s[44:47], s64 offen lds
buffer_load_dwordx4 v6, s[44:47], s64 offen offset:1024 lds
s_add_u32 m0, s61, 2048
s_add_u32 s64, s60, 16384
buffer_load_dwordx4 v5, s[44:47], s64 offen lds
buffer_load_dwordx4 v6, s[44:47], s64 offen offset:1024 lds
s_add_u32 m0, s63, 0
s_add_u32 s64, s62, 0
buffer_load_dwordx4 v7, s[48:51], s64 offen lds
buffer_load_dwordx4 v8, s[48:51], s64 offen offset:1024 lds
s_add_u32 m0, s63, 2048
s_add_u32 s64, s62, 131072
buffer_load_dwordx4 v7, s[48:51], s64 offen lds
buffer_load_dwordx4 v8, s[48:51], s64 offen offset:1024 lds
s_add_u32 m0, s61, 4096
s_add_u32 s64, s60, 32768
buffer_load_dwordx4 v5, s[44:47], s64 offen lds
buffer_load_dwordx4 v6, s[44:47], s64 offen offset:1024 lds
s_add_u32 m0, s61, 6144
s_add_u32 s64, s60, 49152
buffer_load_dwordx4 v5, s[44:47], s64 offen lds
buffer_load_dwordx4 v6, s[44:47], s64 offen offset:1024 lds
s_add_u32 m0, s63, 16384
s_add_u32 s64, s62, 262144
buffer_load_dwordx4 v7, s[48:51], s64 offen lds
buffer_load_dwordx4 v8, s[48:51], s64 offen offset:1024 lds
s_add_u32 m0, s63, 18432
s_add_u32 s64, s62, 393216
buffer_load_dwordx4 v7, s[48:51], s64 offen lds
buffer_load_dwordx4 v8, s[48:51], s64 offen offset:1024 lds
s_add_u32 m0, s61, 32768
s_add_u32 s64, s60, 128
buffer_load_dwordx4 v5, s[44:47], s64 offen lds
buffer_load_dwordx4 v6, s[44:47], s64 offen offset:1024 lds
s_add_u32 m0, s61, 34816
s_add_u32 s64, s60, 16512
buffer_load_dwordx4 v5, s[44:47], s64 offen lds
buffer_load_dwordx4 v6, s[44:47], s64 offen offset:1024 lds
s_add_u32 m0, s63, 32768
s_add_u32 s64, s62, 524288
buffer_load_dwordx4 v7, s[48:51], s64 offen lds
buffer_load_dwordx4 v8, s[48:51], s64 offen offset:1024 lds
s_add_u32 m0, s63, 34816
s_add_u32 s64, s62, 655360
buffer_load_dwordx4 v7, s[48:51], s64 offen lds
buffer_load_dwordx4 v8, s[48:51], s64 offen offset:1024 lds
s_add_u32 m0, s61, 36864
s_add_u32 s64, s60, 32896
buffer_load_dwordx4 v5, s[44:47], s64 offen lds
buffer_load_dwordx4 v6, s[44:47], s64 offen offset:1024 lds
s_add_u32 m0, s61, 38912
s_add_u32 s64, s60, 49280
buffer_load_dwordx4 v5, s[44:47], s64 offen lds
buffer_load_dwordx4 v6, s[44:47], s64 offen offset:1024 lds
s_add_u32 m0, s63, 49152
s_add_u32 s64, s62, 786432
buffer_load_dwordx4 v7, s[48:51], s64 offen lds
buffer_load_dwordx4 v8, s[48:51], s64 offen offset:1024 lds
s_add_u32 m0, s63, 51200
s_add_u32 s64, s62, 917504
buffer_load_dwordx4 v7, s[48:51], s64 offen lds
buffer_load_dwordx4 v8, s[48:51], s64 offen offset:1024 lds
s_add_u32 m0, s61, 65536
s_add_u32 s64, s60, 256
buffer_load_dwordx4 v5, s[44:47], s64 offen lds
buffer_load_dwordx4 v6, s[44:47], s64 offen offset:1024 lds
s_add_u32 m0, s61, 67584
s_add_u32 s64, s60, 16640
buffer_load_dwordx4 v5, s[44:47], s64 offen lds
buffer_load_dwordx4 v6, s[44:47], s64 offen offset:1024 lds
s_add_u32 s60, s60, 256
s_add_u32 s61, s61, 65536
s_add_u32 s62, s62, 1048576
v_mov_b32 v32, 0
v_mov_b32 v33, 0
v_mov_b32 v34, 0
v_mov_b32 v35, 0
v_mov_b32 v36, 0
v_mov_b32 v37, 0
v_mov_b32 v38, 0
v_mov_b32 v39, 0
v_mov_b32 v40, 0
v_mov_b32 v41, 0
v_mov_b32 v42, 0
v_mov_b32 v43, 0
v_mov_b32 v44, 0
v_mov_b32 v45, 0
v_mov_b32 v46, 0
v_mov_b32 v47, 0
v_mov_b32 v48, 0
v_mov_b32 v49, 0
v_mov_b32 v50, 0
v_mov_b32 v51, 0
v_mov_b32 v52, 0
v_mov_b32 v53, 0
v_mov_b32 v54, 0
v_mov_b32 v55, 0
v_mov_b32 v56, 0
v_mov_b32 v57, 0
v_mov_b32 v58, 0
v_mov_b32 v59, 0
v_mov_b32 v60, 0
v_mov_b32 v61, 0
v_mov_b32 v62, 0
v_mov_b32 v63, 0
v_mov_b32 v64, 0
v_mov_b32 v65, 0
v_mov_b32 v66, 0
v_mov_b32 v67, 0
v_mov_b32 v68, 0
v_mov_b32 v69, 0
v_mov_b32 v70, 0
v_mov_b32 v71, 0
v_mov_b32 v72, 0
v_mov_b32 v73, 0
v_mov_b32 v74, 0
v_mov_b32 v75, 0
v_mov_b32 v76, 0
v_mov_b32 v77, 0
v_mov_b32 v78, 0
v_mov_b32 v79, 0
v_mov_b32 v80, 0
v_mov_b32 v81, 0
v_mov_b32 v82, 0
v_mov_b32 v83, 0
v_mov_b32 v84, 0
v_mov_b32 v85, 0
v_mov_b32 v86, 0
v_mov_b32 v87, 0
v_mov_b32 v88, 0
v_mov_b32 v89, 0
v_mov_b32 v90, 0
v_mov_b32 v91, 0
v_mov_b32 v92, 0
v_mov_b32 v93, 0
v_mov_b32 v94, 0
v_mov_b32 v95, 0
v_mov_b32 v96, 0
v_mov_b32 v97, 0
v_mov_b32 v98, 0
v_mov_b32 v99, 0
v_mov_b32 v100, 0
v_mov_b32 v101, 0
v_mov_b32 v102, 0
v_mov_b32 v103, 0
v_mov_b32 v104, 0
v_mov_b32 v105, 0
v_mov_b32 v106, 0
v_mov_b32 v107, 0
v_mov_b32 v108, 0
v_mov_b32 v109, 0
v_mov_b32 v110, 0
v_mov_b32 v111, 0
v_mov_b32 v112, 0
v_mov_b32 v113, 0
v_mov_b32 v114, 0
v_mov_b32 v115, 0
v_mov_b32 v116, 0
v_mov_b32 v117, 0
v_mov_b32 v118, 0
v_mov_b32 v119, 0
v_mov_b32 v120, 0
v_mov_b32 v121, 0
v_mov_b32 v122, 0
v_mov_b32 v123, 0
v_mov_b32 v124, 0
v_mov_b32 v125, 0
v_mov_b32 v126, 0
v_mov_b32 v127, 0
v_mov_b32 v128, 0
v_mov_b32 v129, 0
v_mov_b32 v130, 0
v_mov_b32 v131, 0
v_mov_b32 v132, 0
v_mov_b32 v133, 0
v_mov_b32 v134, 0
v_mov_b32 v135, 0
v_mov_b32 v136, 0
v_mov_b32 v137, 0
v_mov_b32 v138, 0
v_mov_b32 v139, 0
v_mov_b32 v140, 0
v_mov_b32 v141, 0
v_mov_b32 v142, 0
v_mov_b32 v143, 0
v_mov_b32 v144, 0
v_mov_b32 v145, 0
v_mov_b32 v146, 0
v_mov_b32 v147, 0
v_mov_b32 v148, 0
v_mov_b32 v149, 0
v_mov_b32 v150, 0
v_mov_b32 v151, 0
v_mov_b32 v152, 0
v_mov_b32 v153, 0
v_mov_b32 v154, 0
v_mov_b32 v155, 0
v_mov_b32 v156, 0
v_mov_b32 v157, 0
v_mov_b32 v158, 0
v_mov_b32 v159, 0
v_mov_b32 v160, 0
v_mov_b32 v161, 0
v_mov_b32 v162, 0
v_mov_b32 v163, 0
v_mov_b32 v164, 0
v_mov_b32 v165, 0
v_mov_b32 v166, 0
v_mov_b32 v167, 0
v_mov_b32 v168, 0
v_mov_b32 v169, 0
v_mov_b32 v170, 0
v_mov_b32 v171, 0
v_mov_b32 v172, 0
v_mov_b32 v173, 0
v_mov_b32 v174, 0
v_mov_b32 v175, 0
v_mov_b32 v176, 0
v_mov_b32 v177, 0
v_mov_b32 v178, 0
v_mov_b32 v179, 0
v_mov_b32 v180, 0
v_mov_b32 v181, 0
v_mov_b32 v182, 0
v_mov_b32 v183, 0
v_mov_b32 v184, 0
v_mov_b32 v185, 0
v_mov_b32 v186, 0
v_mov_b32 v187, 0
v_mov_b32 v188, 0
v_mov_b32 v189, 0
v_mov_b32 v190, 0
v_mov_b32 v191, 0
v_mov_b32 v192, 0
v_mov_b32 v193, 0
v_mov_b32 v194, 0
v_mov_b32 v195, 0
v_mov_b32 v196, 0
v_mov_b32 v197, 0
v_mov_b32 v198, 0
v_mov_b32 v199, 0
v_mov_b32 v200, 0
v_mov_b32 v201, 0
v_mov_b32 v202, 0
v_mov_b32 v203, 0
v_mov_b32 v204, 0
v_mov_b32 v205, 0
v_mov_b32 v206, 0
v_mov_b32 v207, 0
v_mov_b32 v208, 0
v_mov_b32 v209, 0
v_mov_b32 v210, 0
v_mov_b32 v211, 0
v_mov_b32 v212, 0
v_mov_b32 v213, 0
v_mov_b32 v214, 0
v_mov_b32 v215, 0
v_mov_b32 v216, 0
v_mov_b32 v217, 0
v_mov_b32 v218, 0
v_mov_b32 v219, 0
v_mov_b32 v220, 0
v_mov_b32 v221, 0
v_mov_b32 v222, 0
v_mov_b32 v223, 0
v_mov_b32 v224, 0
v_mov_b32 v225, 0
v_mov_b32 v226, 0
v_mov_b32 v227, 0
v_mov_b32 v228, 0
v_mov_b32 v229, 0
v_mov_b32 v230, 0
v_mov_b32 v231, 0
v_mov_b32 v232, 0
v_mov_b32 v233, 0
v_mov_b32 v234, 0
v_mov_b32 v235, 0
v_mov_b32 v236, 0
v_mov_b32 v237, 0
v_mov_b32 v238, 0
v_mov_b32 v239, 0
v_mov_b32 v240, 0
v_mov_b32 v241, 0
v_mov_b32 v242, 0
v_mov_b32 v243, 0
v_mov_b32 v244, 0
v_mov_b32 v245, 0
v_mov_b32 v246, 0
v_mov_b32 v247, 0
v_mov_b32 v248, 0
v_mov_b32 v249, 0
v_mov_b32 v250, 0
v_mov_b32 v251, 0
v_mov_b32 v252, 0
v_mov_b32 v253, 0
v_mov_b32 v254, 0
v_mov_b32 v255, 0
v_accvgpr_write_b32 a0, 0
v_accvgpr_write_b32 a1, 0
v_accvgpr_write_b32 a2, 0
v_accvgpr_write_b32 a3, 0
v_accvgpr_write_b32 a4, 0
v_accvgpr_write_b32 a5, 0
v_accvgpr_write_b32 a6, 0
v_accvgpr_write_b32 a7, 0
v_accvgpr_write_b32 a8, 0
v_accvgpr_write_b32 a9, 0
v_accvgpr_write_b32 a10, 0
v_accvgpr_write_b32 a11, 0
v_accvgpr_write_b32 a12, 0
v_accvgpr_write_b32 a13, 0
v_accvgpr_write_b32 a14, 0
v_accvgpr_write_b32 a15, 0
v_accvgpr_write_b32 a16, 0
v_accvgpr_write_b32 a17, 0
v_accvgpr_write_b32 a18, 0
v_accvgpr_write_b32 a19, 0
v_accvgpr_write_b32 a20, 0
v_accvgpr_write_b32 a21, 0
v_accvgpr_write_b32 a22, 0
v_accvgpr_write_b32 a23, 0
v_accvgpr_write_b32 a24, 0
v_accvgpr_write_b32 a25, 0
v_accvgpr_write_b32 a26, 0
v_accvgpr_write_b32 a27, 0
v_accvgpr_write_b32 a28, 0
v_accvgpr_write_b32 a29, 0
v_accvgpr_write_b32 a30, 0
v_accvgpr_write_b32 a31, 0
s_mov_b32 s65, 0
s_mov_b32 s70, 0
s_mov_b32 s71, 2
s_waitcnt vmcnt(24)
s_barrier
ds_read_b128 a[64:67], v9 offset:0
ds_read_b64_tr_b16 a[96:97], v11 offset:0
ds_read_b64_tr_b16 a[98:99], v11 offset:512
ds_read_b128 a[68:71], v9 offset:2048
ds_read_b64_tr_b16 a[100:101], v12 offset:0
ds_read_b64_tr_b16 a[102:103], v12 offset:512
ds_read_b128 a[72:75], v9 offset:4096
ds_read_b64_tr_b16 a[104:105], v13 offset:0
ds_read_b64_tr_b16 a[106:107], v13 offset:512
ds_read_b128 a[76:79], v9 offset:6144
ds_read_b64_tr_b16 a[108:109], v14 offset:0
ds_read_b64_tr_b16 a[110:111], v14 offset:512
ds_read_b128 a[80:83], v9 offset:8192
ds_read_b64_tr_b16 a[112:113], v11 offset:8192
ds_read_b64_tr_b16 a[114:115], v11 offset:8704
ds_read_b128 a[84:87], v9 offset:10240
ds_read_b64_tr_b16 a[116:117], v12 offset:8192
ds_read_b64_tr_b16 a[118:119], v12 offset:8704
ds_read_b128 a[88:91], v9 offset:12288
ds_read_b64_tr_b16 a[120:121], v13 offset:8192
ds_read_b64_tr_b16 a[122:123], v13 offset:8704
ds_read_b128 a[92:95], v9 offset:14336
ds_read_b64_tr_b16 a[124:125], v14 offset:8192
ds_read_b64_tr_b16 a[126:127], v14 offset:8704
s_waitcnt lgkmcnt(0)
K1_LOOP:
v_mfma_f32_16x16x32_bf16 v[32:35], a[96:99], a[64:67], v[32:35]
s_waitcnt vmcnt(16)
v_mfma_f32_16x16x32_bf16 v[36:39], a[100:103], a[64:67], v[36:39]
s_barrier
v_mfma_f32_16x16x32_bf16 v[40:43], a[104:107], a[64:67], v[40:43]
s_add_u32 m0, s63, 0
s_add_u32 s64, s62, 0
v_mfma_f32_16x16x32_bf16 v[44:47], a[108:111], a[64:67], v[44:47]
buffer_load_dwordx4 v7, s[48:51], s64 offen lds
v_mfma_f32_16x16x32_bf16 v[160:163], a[64:67], a[112:115], v[160:163]
ds_read_b128 a[128:131], v10 offset:0
v_mfma_f32_16x16x32_bf16 v[168:171], a[64:67], a[116:119], v[168:171]
v_mfma_f32_16x16x32_bf16 v[176:179], a[64:67], a[120:123], v[176:179]
ds_read_b64_tr_b16 a[160:161], v11 offset:16384
ds_read_b64_tr_b16 a[162:163], v11 offset:16896
v_mfma_f32_16x16x32_bf16 v[184:187], a[64:67], a[124:127], v[184:187]
v_mfma_f32_16x16x32_bf16 v[188:191], a[68:71], a[124:127], v[188:191]
ds_read_b128 a[132:135], v10 offset:2048
v_mfma_f32_16x16x32_bf16 v[180:183], a[68:71], a[120:123], v[180:183]
v_mfma_f32_16x16x32_bf16 v[172:175], a[68:71], a[116:119], v[172:175]
buffer_load_dwordx4 v8, s[48:51], s64 offen offset:1024 lds
v_mfma_f32_16x16x32_bf16 v[164:167], a[68:71], a[112:115], v[164:167]
ds_read_b64_tr_b16 a[164:165], v12 offset:16384
ds_read_b64_tr_b16 a[166:167], v12 offset:16896
v_mfma_f32_16x16x32_bf16 v[60:63], a[108:111], a[68:71], v[60:63]
v_mfma_f32_16x16x32_bf16 v[56:59], a[104:107], a[68:71], v[56:59]
ds_read_b128 a[136:139], v10 offset:4096
v_mfma_f32_16x16x32_bf16 v[52:55], a[100:103], a[68:71], v[52:55]
v_mfma_f32_16x16x32_bf16 v[48:51], a[96:99], a[68:71], v[48:51]
ds_read_b64_tr_b16 a[168:169], v13 offset:16384
ds_read_b64_tr_b16 a[170:171], v13 offset:16896
v_mfma_f32_16x16x32_bf16 v[64:67], a[96:99], a[72:75], v[64:67]
s_add_u32 m0, s63, 2048
s_add_u32 s64, s62, 131072
v_mfma_f32_16x16x32_bf16 v[68:71], a[100:103], a[72:75], v[68:71]
buffer_load_dwordx4 v7, s[48:51], s64 offen lds
v_mfma_f32_16x16x32_bf16 v[72:75], a[104:107], a[72:75], v[72:75]
ds_read_b128 a[140:143], v10 offset:6144
v_mfma_f32_16x16x32_bf16 v[76:79], a[108:111], a[72:75], v[76:79]
v_mfma_f32_16x16x32_bf16 v[192:195], a[72:75], a[112:115], v[192:195]
ds_read_b64_tr_b16 a[172:173], v14 offset:16384
ds_read_b64_tr_b16 a[174:175], v14 offset:16896
v_mfma_f32_16x16x32_bf16 v[200:203], a[72:75], a[116:119], v[200:203]
v_mfma_f32_16x16x32_bf16 v[208:211], a[72:75], a[120:123], v[208:211]
ds_read_b128 a[144:147], v10 offset:8192
v_mfma_f32_16x16x32_bf16 v[216:219], a[72:75], a[124:127], v[216:219]
v_mfma_f32_16x16x32_bf16 v[220:223], a[76:79], a[124:127], v[220:223]
buffer_load_dwordx4 v8, s[48:51], s64 offen offset:1024 lds
v_mfma_f32_16x16x32_bf16 v[212:215], a[76:79], a[120:123], v[212:215]
ds_read_b64_tr_b16 a[176:177], v11 offset:24576
ds_read_b64_tr_b16 a[178:179], v11 offset:25088
v_mfma_f32_16x16x32_bf16 v[204:207], a[76:79], a[116:119], v[204:207]
v_mfma_f32_16x16x32_bf16 v[196:199], a[76:79], a[112:115], v[196:199]
ds_read_b128 a[148:151], v10 offset:10240
v_mfma_f32_16x16x32_bf16 v[92:95], a[108:111], a[76:79], v[92:95]
v_mfma_f32_16x16x32_bf16 v[88:91], a[104:107], a[76:79], v[88:91]
ds_read_b64_tr_b16 a[180:181], v12 offset:24576
ds_read_b64_tr_b16 a[182:183], v12 offset:25088
v_mfma_f32_16x16x32_bf16 v[84:87], a[100:103], a[76:79], v[84:87]
s_add_u32 m0, s61, 4096
s_add_u32 s64, s60, 32768
v_mfma_f32_16x16x32_bf16 v[80:83], a[96:99], a[76:79], v[80:83]
buffer_load_dwordx4 v5, s[44:47], s64 offen lds
v_mfma_f32_16x16x32_bf16 v[96:99], a[96:99], a[80:83], v[96:99]
ds_read_b128 a[152:155], v10 offset:12288
v_mfma_f32_16x16x32_bf16 v[100:103], a[100:103], a[80:83], v[100:103]
v_mfma_f32_16x16x32_bf16 v[104:107], a[104:107], a[80:83], v[104:107]
ds_read_b64_tr_b16 a[184:185], v13 offset:24576
ds_read_b64_tr_b16 a[186:187], v13 offset:25088
v_mfma_f32_16x16x32_bf16 v[108:111], a[108:111], a[80:83], v[108:111]
v_mfma_f32_16x16x32_bf16 v[224:227], a[80:83], a[112:115], v[224:227]
ds_read_b128 a[156:159], v10 offset:14336
v_mfma_f32_16x16x32_bf16 v[232:235], a[80:83], a[116:119], v[232:235]
v_mfma_f32_16x16x32_bf16 v[240:243], a[80:83], a[120:123], v[240:243]
buffer_load_dwordx4 v6, s[44:47], s64 offen offset:1024 lds
v_mfma_f32_16x16x32_bf16 v[248:251], a[80:83], a[124:127], v[248:251]
ds_read_b64_tr_b16 a[188:189], v14 offset:24576
ds_read_b64_tr_b16 a[190:191], v14 offset:25088
v_mfma_f32_16x16x32_bf16 v[252:255], a[84:87], a[124:127], v[252:255]
v_mfma_f32_16x16x32_bf16 v[244:247], a[84:87], a[120:123], v[244:247]
v_xor_b32 v11, 0x8000, v11
v_xor_b32 v12, 0x8000, v12
v_mfma_f32_16x16x32_bf16 v[236:239], a[84:87], a[116:119], v[236:239]
v_xor_b32 v13, 0x8000, v13
v_xor_b32 v14, 0x8000, v14
v_mfma_f32_16x16x32_bf16 v[228:231], a[84:87], a[112:115], v[228:231]
s_add_u32 s70, s70, 1
s_cmp_eq_u32 s70, 3
s_cselect_b32 s66, -65536, s92
s_cselect_b32 s70, 0, s70
v_mfma_f32_16x16x32_bf16 v[124:127], a[108:111], a[84:87], v[124:127]
s_add_u32 m0, s61, 6144
s_add_u32 s64, s60, 49152
v_mfma_f32_16x16x32_bf16 v[120:123], a[104:107], a[84:87], v[120:123]
buffer_load_dwordx4 v5, s[44:47], s64 offen lds
v_mfma_f32_16x16x32_bf16 v[116:119], a[100:103], a[84:87], v[116:119]
v_add_u32 v9, s66, v9
v_add_u32 v10, s66, v10
v_mfma_f32_16x16x32_bf16 v[112:115], a[96:99], a[84:87], v[112:115]
v_mfma_f32_16x16x32_bf16 v[128:131], a[96:99], a[88:91], v[128:131]
v_mfma_f32_16x16x32_bf16 v[132:135], a[100:103], a[88:91], v[132:135]
v_mfma_f32_16x16x32_bf16 v[136:139], a[104:107], a[88:91], v[136:139]
v_mfma_f32_16x16x32_bf16 v[140:143], a[108:111], a[88:91], v[140:143]
v_mfma_f32_16x16x32_bf16 a[0:3], a[88:91], a[112:115], a[0:3]
buffer_load_dwordx4 v6, s[44:47], s64 offen offset:1024 lds
v_mfma_f32_16x16x32_bf16 a[8:11], a[88:91], a[116:119], a[8:11]
v_mfma_f32_16x16x32_bf16 a[16:19], a[88:91], a[120:123], a[16:19]
v_mfma_f32_16x16x32_bf16 a[24:27], a[88:91], a[124:127], a[24:27]
v_mfma_f32_16x16x32_bf16 a[28:31], a[92:95], a[124:127], a[28:31]
v_mfma_f32_16x16x32_bf16 a[20:23], a[92:95], a[120:123], a[20:23]
v_mfma_f32_16x16x32_bf16 a[12:15], a[92:95], a[116:119], a[12:15]
v_mfma_f32_16x16x32_bf16 a[4:7], a[92:95], a[112:115], a[4:7]
v_mfma_f32_16x16x32_bf16 v[156:159], a[108:111], a[92:95], v[156:159]
v_mfma_f32_16x16x32_bf16 v[152:155], a[104:107], a[92:95], v[152:155]
v_mfma_f32_16x16x32_bf16 v[148:151], a[100:103], a[92:95], v[148:151]
v_mfma_f32_16x16x32_bf16 v[144:147], a[96:99], a[92:95], v[144:147]
s_waitcnt lgkmcnt(0)
v_mfma_f32_16x16x32_bf16 v[32:35], a[160:163], a[128:131], v[32:35]
s_waitcnt vmcnt(16)
v_mfma_f32_16x16x32_bf16 v[36:39], a[164:167], a[128:131], v[36:39]
s_barrier
v_mfma_f32_16x16x32_bf16 v[40:43], a[168:171], a[128:131], v[40:43]
s_add_u32 m0, s63, 16384
s_add_u32 s64, s62, 262144
v_mfma_f32_16x16x32_bf16 v[44:47], a[172:175], a[128:131], v[44:47]
buffer_load_dwordx4 v7, s[48:51], s64 offen lds
v_mfma_f32_16x16x32_bf16 v[160:163], a[128:131], a[176:179], v[160:163]
ds_read_b128 a[64:67], v9 offset:0
v_mfma_f32_16x16x32_bf16 v[168:171], a[128:131], a[180:183], v[168:171]
s_add_u32 s71, s71, 1
v_mfma_f32_16x16x32_bf16 v[176:179], a[128:131], a[184:187], v[176:179]
ds_read_b64_tr_b16 a[96:97], v11 offset:0
ds_read_b64_tr_b16 a[98:99], v11 offset:512
v_mfma_f32_16x16x32_bf16 v[184:187], a[128:131], a[188:191], v[184:187]
s_cmp_eq_u32 s71, 3
s_cselect_b32 s67, -65536, s92
s_cselect_b32 s71, 0, s71
v_mfma_f32_16x16x32_bf16 v[188:191], a[132:135], a[188:191], v[188:191]
ds_read_b128 a[68:71], v9 offset:2048
v_mfma_f32_16x16x32_bf16 v[180:183], a[132:135], a[184:187], v[180:183]
s_add_u32 s61, s61, s67
v_mfma_f32_16x16x32_bf16 v[172:175], a[132:135], a[180:183], v[172:175]
buffer_load_dwordx4 v8, s[48:51], s64 offen offset:1024 lds
v_mfma_f32_16x16x32_bf16 v[164:167], a[132:135], a[176:179], v[164:167]
s_add_u32 s60, s60, 128
ds_read_b64_tr_b16 a[100:101], v12 offset:0
ds_read_b64_tr_b16 a[102:103], v12 offset:512
v_mfma_f32_16x16x32_bf16 v[60:63], a[172:175], a[132:135], v[60:63]
v_mfma_f32_16x16x32_bf16 v[56:59], a[168:171], a[132:135], v[56:59]
s_cmp_ge_u32 s65, 5
s_cselect_b32 s46, 0, s46
ds_read_b128 a[72:75], v9 offset:4096
v_mfma_f32_16x16x32_bf16 v[52:55], a[164:167], a[132:135], v[52:55]
v_mfma_f32_16x16x32_bf16 v[48:51], a[160:163], a[132:135], v[48:51]
ds_read_b64_tr_b16 a[104:105], v13 offset:0
ds_read_b64_tr_b16 a[106:107], v13 offset:512
v_mfma_f32_16x16x32_bf16 v[64:67], a[160:163], a[136:139], v[64:67]
s_add_u32 m0, s63, 18432
s_add_u32 s64, s62, 393216
v_mfma_f32_16x16x32_bf16 v[68:71], a[164:167], a[136:139], v[68:71]
buffer_load_dwordx4 v7, s[48:51], s64 offen lds
v_mfma_f32_16x16x32_bf16 v[72:75], a[168:171], a[136:139], v[72:75]
ds_read_b128 a[76:79], v9 offset:6144
v_mfma_f32_16x16x32_bf16 v[76:79], a[172:175], a[136:139], v[76:79]
v_mfma_f32_16x16x32_bf16 v[192:195], a[136:139], a[176:179], v[192:195]
ds_read_b64_tr_b16 a[108:109], v14 offset:0
ds_read_b64_tr_b16 a[110:111], v14 offset:512
v_mfma_f32_16x16x32_bf16 v[200:203], a[136:139], a[180:183], v[200:203]
v_mfma_f32_16x16x32_bf16 v[208:211], a[136:139], a[184:187], v[208:211]
ds_read_b128 a[80:83], v9 offset:8192
v_mfma_f32_16x16x32_bf16 v[216:219], a[136:139], a[188:191], v[216:219]
v_mfma_f32_16x16x32_bf16 v[220:223], a[140:143], a[188:191], v[220:223]
buffer_load_dwordx4 v8, s[48:51], s64 offen offset:1024 lds
v_mfma_f32_16x16x32_bf16 v[212:215], a[140:143], a[184:187], v[212:215]
ds_read_b64_tr_b16 a[112:113], v11 offset:8192
ds_read_b64_tr_b16 a[114:115], v11 offset:8704
v_mfma_f32_16x16x32_bf16 v[204:207], a[140:143], a[180:183], v[204:207]
v_mfma_f32_16x16x32_bf16 v[196:199], a[140:143], a[176:179], v[196:199]
ds_read_b128 a[84:87], v9 offset:10240
v_mfma_f32_16x16x32_bf16 v[92:95], a[172:175], a[140:143], v[92:95]
v_mfma_f32_16x16x32_bf16 v[88:91], a[168:171], a[140:143], v[88:91]
ds_read_b64_tr_b16 a[116:117], v12 offset:8192
ds_read_b64_tr_b16 a[118:119], v12 offset:8704
v_mfma_f32_16x16x32_bf16 v[84:87], a[164:167], a[140:143], v[84:87]
s_add_u32 m0, s61, 0
s_add_u32 s64, s60, 0
v_mfma_f32_16x16x32_bf16 v[80:83], a[160:163], a[140:143], v[80:83]
buffer_load_dwordx4 v5, s[44:47], s64 offen lds
v_mfma_f32_16x16x32_bf16 v[96:99], a[160:163], a[144:147], v[96:99]
ds_read_b128 a[88:91], v9 offset:12288
v_mfma_f32_16x16x32_bf16 v[100:103], a[164:167], a[144:147], v[100:103]
v_mfma_f32_16x16x32_bf16 v[104:107], a[168:171], a[144:147], v[104:107]
ds_read_b64_tr_b16 a[120:121], v13 offset:8192
ds_read_b64_tr_b16 a[122:123], v13 offset:8704
v_mfma_f32_16x16x32_bf16 v[108:111], a[172:175], a[144:147], v[108:111]
v_mfma_f32_16x16x32_bf16 v[224:227], a[144:147], a[176:179], v[224:227]
ds_read_b128 a[92:95], v9 offset:14336
v_mfma_f32_16x16x32_bf16 v[232:235], a[144:147], a[180:183], v[232:235]
v_mfma_f32_16x16x32_bf16 v[240:243], a[144:147], a[184:187], v[240:243]
buffer_load_dwordx4 v6, s[44:47], s64 offen offset:1024 lds
v_mfma_f32_16x16x32_bf16 v[248:251], a[144:147], a[188:191], v[248:251]
ds_read_b64_tr_b16 a[124:125], v14 offset:8192
ds_read_b64_tr_b16 a[126:127], v14 offset:8704
v_mfma_f32_16x16x32_bf16 v[252:255], a[148:151], a[188:191], v[252:255]
v_mfma_f32_16x16x32_bf16 v[244:247], a[148:151], a[184:187], v[244:247]
v_mfma_f32_16x16x32_bf16 v[236:239], a[148:151], a[180:183], v[236:239]
v_mfma_f32_16x16x32_bf16 v[228:231], a[148:151], a[176:179], v[228:231]
v_mfma_f32_16x16x32_bf16 v[124:127], a[172:175], a[148:151], v[124:127]
s_add_u32 m0, s61, 2048
s_add_u32 s64, s60, 16384
v_mfma_f32_16x16x32_bf16 v[120:123], a[168:171], a[148:151], v[120:123]
buffer_load_dwordx4 v5, s[44:47], s64 offen lds
v_mfma_f32_16x16x32_bf16 v[116:119], a[164:167], a[148:151], v[116:119]
v_mfma_f32_16x16x32_bf16 v[112:115], a[160:163], a[148:151], v[112:115]
v_mfma_f32_16x16x32_bf16 v[128:131], a[160:163], a[152:155], v[128:131]
v_mfma_f32_16x16x32_bf16 v[132:135], a[164:167], a[152:155], v[132:135]
v_mfma_f32_16x16x32_bf16 v[136:139], a[168:171], a[152:155], v[136:139]
v_mfma_f32_16x16x32_bf16 v[140:143], a[172:175], a[152:155], v[140:143]
v_mfma_f32_16x16x32_bf16 a[0:3], a[152:155], a[176:179], a[0:3]
buffer_load_dwordx4 v6, s[44:47], s64 offen offset:1024 lds
v_mfma_f32_16x16x32_bf16 a[8:11], a[152:155], a[180:183], a[8:11]
v_mfma_f32_16x16x32_bf16 a[16:19], a[152:155], a[184:187], a[16:19]
v_mfma_f32_16x16x32_bf16 a[24:27], a[152:155], a[188:191], a[24:27]
v_mfma_f32_16x16x32_bf16 a[28:31], a[156:159], a[188:191], a[28:31]
v_mfma_f32_16x16x32_bf16 a[20:23], a[156:159], a[184:187], a[20:23]
v_mfma_f32_16x16x32_bf16 a[12:15], a[156:159], a[180:183], a[12:15]
v_mfma_f32_16x16x32_bf16 a[4:7], a[156:159], a[176:179], a[4:7]
v_mfma_f32_16x16x32_bf16 v[156:159], a[172:175], a[156:159], v[156:159]
v_mfma_f32_16x16x32_bf16 v[152:155], a[168:171], a[156:159], v[152:155]
v_mfma_f32_16x16x32_bf16 v[148:151], a[164:167], a[156:159], v[148:151]
v_mfma_f32_16x16x32_bf16 v[144:147], a[160:163], a[156:159], v[144:147]
s_waitcnt lgkmcnt(0)
s_add_u32 s62, s62, 524288
s_xor_b32 s63, s63, 0x8000
s_add_u32 s65, s65, 1
s_cmp_lt_u32 s65, 8
s_cbranch_scc1 K1_LOOP
s_nop 7
s_mul_i32 s8, s4, 1064960
s_lshl_b32 s9, s5, 17
s_add_u32 s8, s8, s9
s_lshr_b32 s9, s3, 1
s_lshl_b32 s9, s9, 16
s_add_u32 s8, s8, s9
s_and_b32 s9, s3, 1
s_lshl_b32 s10, s9, 11
s_add_u32 s10, s10, s8
s_lshl_b32 s11, s9, 12
s_add_u32 s11, s11, s8
s_add_u32 s11, s11, 24576
v_cvt_pk_bf16_f32 v32, v32, v33
v_cvt_pk_bf16_f32 v33, v34, v35
v_cvt_pk_bf16_f32 v34, v36, v37
v_cvt_pk_bf16_f32 v35, v38, v39
s_add_u32 s12, s10, 0
buffer_store_dwordx4 v[32:35], v4, s[52:55], s12 offen offset:0
v_cvt_pk_bf16_f32 v40, v40, v41
v_cvt_pk_bf16_f32 v41, v42, v43
v_cvt_pk_bf16_f32 v42, v44, v45
v_cvt_pk_bf16_f32 v43, v46, v47
s_add_u32 s12, s10, 0
buffer_store_dwordx4 v[40:43], v4, s[52:55], s12 offen offset:1024
v_cvt_pk_bf16_f32 v48, v48, v49
v_cvt_pk_bf16_f32 v49, v50, v51
v_cvt_pk_bf16_f32 v50, v52, v53
v_cvt_pk_bf16_f32 v51, v54, v55
s_add_u32 s12, s10, 4096
buffer_store_dwordx4 v[48:51], v4, s[52:55], s12 offen offset:0
v_cvt_pk_bf16_f32 v56, v56, v57
v_cvt_pk_bf16_f32 v57, v58, v59
v_cvt_pk_bf16_f32 v58, v60, v61
v_cvt_pk_bf16_f32 v59, v62, v63
s_add_u32 s12, s10, 4096
buffer_store_dwordx4 v[56:59], v4, s[52:55], s12 offen offset:1024
v_cvt_pk_bf16_f32 v64, v64, v65
v_cvt_pk_bf16_f32 v65, v66, v67
v_cvt_pk_bf16_f32 v66, v68, v69
v_cvt_pk_bf16_f32 v67, v70, v71
s_add_u32 s12, s10, 16384
buffer_store_dwordx4 v[64:67], v4, s[52:55], s12 offen offset:0
v_cvt_pk_bf16_f32 v72, v72, v73
v_cvt_pk_bf16_f32 v73, v74, v75
v_cvt_pk_bf16_f32 v74, v76, v77
v_cvt_pk_bf16_f32 v75, v78, v79
s_add_u32 s12, s10, 16384
buffer_store_dwordx4 v[72:75], v4, s[52:55], s12 offen offset:1024
v_cvt_pk_bf16_f32 v80, v80, v81
v_cvt_pk_bf16_f32 v81, v82, v83
v_cvt_pk_bf16_f32 v82, v84, v85
v_cvt_pk_bf16_f32 v83, v86, v87
s_add_u32 s12, s10, 20480
buffer_store_dwordx4 v[80:83], v4, s[52:55], s12 offen offset:0
v_cvt_pk_bf16_f32 v88, v88, v89
v_cvt_pk_bf16_f32 v89, v90, v91
v_cvt_pk_bf16_f32 v90, v92, v93
v_cvt_pk_bf16_f32 v91, v94, v95
s_add_u32 s12, s10, 20480
buffer_store_dwordx4 v[88:91], v4, s[52:55], s12 offen offset:1024
v_cvt_pk_bf16_f32 v96, v96, v97
v_cvt_pk_bf16_f32 v97, v98, v99
v_cvt_pk_bf16_f32 v98, v100, v101
v_cvt_pk_bf16_f32 v99, v102, v103
s_add_u32 s12, s10, 32768
buffer_store_dwordx4 v[96:99], v4, s[52:55], s12 offen offset:0
v_cvt_pk_bf16_f32 v104, v104, v105
v_cvt_pk_bf16_f32 v105, v106, v107
v_cvt_pk_bf16_f32 v106, v108, v109
v_cvt_pk_bf16_f32 v107, v110, v111
s_add_u32 s12, s10, 32768
buffer_store_dwordx4 v[104:107], v4, s[52:55], s12 offen offset:1024
v_cvt_pk_bf16_f32 v112, v112, v113
v_cvt_pk_bf16_f32 v113, v114, v115
v_cvt_pk_bf16_f32 v114, v116, v117
v_cvt_pk_bf16_f32 v115, v118, v119
s_add_u32 s12, s10, 36864
buffer_store_dwordx4 v[112:115], v4, s[52:55], s12 offen offset:0
v_cvt_pk_bf16_f32 v120, v120, v121
v_cvt_pk_bf16_f32 v121, v122, v123
v_cvt_pk_bf16_f32 v122, v124, v125
v_cvt_pk_bf16_f32 v123, v126, v127
s_add_u32 s12, s10, 36864
buffer_store_dwordx4 v[120:123], v4, s[52:55], s12 offen offset:1024
v_cvt_pk_bf16_f32 v128, v128, v129
v_cvt_pk_bf16_f32 v129, v130, v131
v_cvt_pk_bf16_f32 v130, v132, v133
v_cvt_pk_bf16_f32 v131, v134, v135
s_add_u32 s12, s10, 49152
buffer_store_dwordx4 v[128:131], v4, s[52:55], s12 offen offset:0
v_cvt_pk_bf16_f32 v136, v136, v137
v_cvt_pk_bf16_f32 v137, v138, v139
v_cvt_pk_bf16_f32 v138, v140, v141
v_cvt_pk_bf16_f32 v139, v142, v143
s_add_u32 s12, s10, 49152
buffer_store_dwordx4 v[136:139], v4, s[52:55], s12 offen offset:1024
v_cvt_pk_bf16_f32 v144, v144, v145
v_cvt_pk_bf16_f32 v145, v146, v147
v_cvt_pk_bf16_f32 v146, v148, v149
v_cvt_pk_bf16_f32 v147, v150, v151
s_add_u32 s12, s10, 53248
buffer_store_dwordx4 v[144:147], v4, s[52:55], s12 offen offset:0
v_cvt_pk_bf16_f32 v152, v152, v153
v_cvt_pk_bf16_f32 v153, v154, v155
v_cvt_pk_bf16_f32 v154, v156, v157
v_cvt_pk_bf16_f32 v155, v158, v159
s_add_u32 s12, s10, 53248
buffer_store_dwordx4 v[152:155], v4, s[52:55], s12 offen offset:1024
v_cvt_pk_bf16_f32 v160, v160, v161
v_cvt_pk_bf16_f32 v161, v162, v163
v_cvt_pk_bf16_f32 v162, v164, v165
v_cvt_pk_bf16_f32 v163, v166, v167
s_add_u32 s12, s11, 0
buffer_store_dwordx4 v[160:163], v4, s[52:55], s12 offen offset:0
v_cvt_pk_bf16_f32 v168, v168, v169
v_cvt_pk_bf16_f32 v169, v170, v171
v_cvt_pk_bf16_f32 v170, v172, v173
v_cvt_pk_bf16_f32 v171, v174, v175
s_add_u32 s12, s11, 0
buffer_store_dwordx4 v[168:171], v4, s[52:55], s12 offen offset:1024
v_cvt_pk_bf16_f32 v176, v176, v177
v_cvt_pk_bf16_f32 v177, v178, v179
v_cvt_pk_bf16_f32 v178, v180, v181
v_cvt_pk_bf16_f32 v179, v182, v183
s_add_u32 s12, s11, 0
buffer_store_dwordx4 v[176:179], v4, s[52:55], s12 offen offset:2048
v_cvt_pk_bf16_f32 v184, v184, v185
v_cvt_pk_bf16_f32 v185, v186, v187
v_cvt_pk_bf16_f32 v186, v188, v189
v_cvt_pk_bf16_f32 v187, v190, v191
s_add_u32 s12, s11, 0
buffer_store_dwordx4 v[184:187], v4, s[52:55], s12 offen offset:3072
v_cvt_pk_bf16_f32 v192, v192, v193
v_cvt_pk_bf16_f32 v193, v194, v195
v_cvt_pk_bf16_f32 v194, v196, v197
v_cvt_pk_bf16_f32 v195, v198, v199
s_add_u32 s12, s11, 16384
buffer_store_dwordx4 v[192:195], v4, s[52:55], s12 offen offset:0
v_cvt_pk_bf16_f32 v200, v200, v201
v_cvt_pk_bf16_f32 v201, v202, v203
v_cvt_pk_bf16_f32 v202, v204, v205
v_cvt_pk_bf16_f32 v203, v206, v207
s_add_u32 s12, s11, 16384
buffer_store_dwordx4 v[200:203], v4, s[52:55], s12 offen offset:1024
v_cvt_pk_bf16_f32 v208, v208, v209
v_cvt_pk_bf16_f32 v209, v210, v211
v_cvt_pk_bf16_f32 v210, v212, v213
v_cvt_pk_bf16_f32 v211, v214, v215
s_add_u32 s12, s11, 16384
buffer_store_dwordx4 v[208:211], v4, s[52:55], s12 offen offset:2048
v_cvt_pk_bf16_f32 v216, v216, v217
v_cvt_pk_bf16_f32 v217, v218, v219
v_cvt_pk_bf16_f32 v218, v220, v221
v_cvt_pk_bf16_f32 v219, v222, v223
s_add_u32 s12, s11, 16384
buffer_store_dwordx4 v[216:219], v4, s[52:55], s12 offen offset:3072
v_cvt_pk_bf16_f32 v224, v224, v225
v_cvt_pk_bf16_f32 v225, v226, v227
v_cvt_pk_bf16_f32 v226, v228, v229
v_cvt_pk_bf16_f32 v227, v230, v231
s_add_u32 s12, s11, 32768
buffer_store_dwordx4 v[224:227], v4, s[52:55], s12 offen offset:0
v_cvt_pk_bf16_f32 v232, v232, v233
v_cvt_pk_bf16_f32 v233, v234, v235
v_cvt_pk_bf16_f32 v234, v236, v237
v_cvt_pk_bf16_f32 v235, v238, v239
s_add_u32 s12, s11, 32768
buffer_store_dwordx4 v[232:235], v4, s[52:55], s12 offen offset:1024
v_cvt_pk_bf16_f32 v240, v240, v241
v_cvt_pk_bf16_f32 v241, v242, v243
v_cvt_pk_bf16_f32 v242, v244, v245
v_cvt_pk_bf16_f32 v243, v246, v247
s_add_u32 s12, s11, 32768
buffer_store_dwordx4 v[240:243], v4, s[52:55], s12 offen offset:2048
v_cvt_pk_bf16_f32 v248, v248, v249
v_cvt_pk_bf16_f32 v249, v250, v251
v_cvt_pk_bf16_f32 v250, v252, v253
v_cvt_pk_bf16_f32 v251, v254, v255
s_add_u32 s12, s11, 32768
buffer_store_dwordx4 v[248:251], v4, s[52:55], s12 offen offset:3072
v_accvgpr_read_b32 v16, a0
v_accvgpr_read_b32 v17, a1
v_accvgpr_read_b32 v18, a2
v_accvgpr_read_b32 v19, a3
v_accvgpr_read_b32 v20, a4
v_accvgpr_read_b32 v21, a5
v_accvgpr_read_b32 v22, a6
v_accvgpr_read_b32 v23, a7
v_cvt_pk_bf16_f32 v16, v16, v17
v_cvt_pk_bf16_f32 v17, v18, v19
v_cvt_pk_bf16_f32 v18, v20, v21
v_cvt_pk_bf16_f32 v19, v22, v23
s_add_u32 s12, s11, 49152
buffer_store_dwordx4 v[16:19], v4, s[52:55], s12 offen offset:0
v_accvgpr_read_b32 v24, a8
v_accvgpr_read_b32 v25, a9
v_accvgpr_read_b32 v26, a10
v_accvgpr_read_b32 v27, a11
v_accvgpr_read_b32 v28, a12
v_accvgpr_read_b32 v29, a13
v_accvgpr_read_b32 v30, a14
v_accvgpr_read_b32 v31, a15
v_cvt_pk_bf16_f32 v24, v24, v25
v_cvt_pk_bf16_f32 v25, v26, v27
v_cvt_pk_bf16_f32 v26, v28, v29
v_cvt_pk_bf16_f32 v27, v30, v31
s_add_u32 s12, s11, 49152
buffer_store_dwordx4 v[24:27], v4, s[52:55], s12 offen offset:1024
v_accvgpr_read_b32 v16, a16
v_accvgpr_read_b32 v17, a17
v_accvgpr_read_b32 v18, a18
v_accvgpr_read_b32 v19, a19
v_accvgpr_read_b32 v20, a20
v_accvgpr_read_b32 v21, a21
v_accvgpr_read_b32 v22, a22
v_accvgpr_read_b32 v23, a23
v_cvt_pk_bf16_f32 v16, v16, v17
v_cvt_pk_bf16_f32 v17, v18, v19
v_cvt_pk_bf16_f32 v18, v20, v21
v_cvt_pk_bf16_f32 v19, v22, v23
s_add_u32 s12, s11, 49152
buffer_store_dwordx4 v[16:19], v4, s[52:55], s12 offen offset:2048
v_accvgpr_read_b32 v24, a24
v_accvgpr_read_b32 v25, a25
v_accvgpr_read_b32 v26, a26
v_accvgpr_read_b32 v27, a27
v_accvgpr_read_b32 v28, a28
v_accvgpr_read_b32 v29, a29
v_accvgpr_read_b32 v30, a30
v_accvgpr_read_b32 v31, a31
v_cvt_pk_bf16_f32 v24, v24, v25
v_cvt_pk_bf16_f32 v25, v26, v27
v_cvt_pk_bf16_f32 v26, v28, v29
v_cvt_pk_bf16_f32 v27, v30, v31
s_add_u32 s12, s11, 49152
buffer_store_dwordx4 v[24:27], v4, s[52:55], s12 offen offset:3072
K1_END:
s_endpgm
.globl k2_kernel
.p2align 8
.type k2_kernel,@function
k2_kernel:
s_cmp_ge_u32 s2, 256
s_cbranch_scc1 K2_END
s_load_dwordx16 s[16:31], s[0:1], 0
s_load_dwordx8 s[32:39], s[0:1], 64
s_load_dwordx2 s[40:41], s[0:1], 96
v_lshrrev_b32 v5, 6, v0
v_and_b32 v1, 63, v0
v_readfirstlane_b32 s3, v5
v_and_b32 v2, 15, v0
v_lshrrev_b32 v3, 4, v1
v_lshlrev_b32 v4, 4, v1
s_and_b32 s7, s2, 7
s_lshr_b32 s6, s2, 3
s_and_b32 s4, s6, 3
s_lshl_b32 s8, s7, 2
s_add_u32 s4, s4, s8
s_lshr_b32 s5, s6, 2
s_waitcnt lgkmcnt(0)
s_mov_b32 s52, s40
s_mov_b32 s53, s41
s_mov_b32 s54, 268435456
s_mov_b32 s55, 0x20000
s_mov_b32 s44, s16
s_mov_b32 s45, s17
s_mov_b32 s46, 2359296
s_mov_b32 s47, 0x20000
s_mov_b32 s48, s26
s_mov_b32 s49, s27
s_mov_b32 s50, 4718592
s_mov_b32 s51, 0x20000
s_lshl_b32 s72, s5, 2
s_add_u32 s72, s72, s3
s_sub_u32 s73, 63, s72
s_lshl_b32 s8, s3, 6
v_lshrrev_b32 v16, 3, v1
v_and_b32 v17, 7, v1
v_xor_b32 v18, v17, v3
v_mul_u32_u24 v19, 1152, v16
v_lshl_add_u32 v5, v18, 4, v19
v_xor_b32 v18, 4, v18
v_lshl_add_u32 v6, v18, 4, v19
v_add_u32 v6, 8192, v6
v_and_b32 v18, 1, v3
v_lshlrev_b32 v18, 1, v18
v_xor_b32 v18, v17, v18
v_lshlrev_b32 v19, 13, v16
v_lshl_add_u32 v7, v18, 4, v19
v_xor_b32 v18, 4, v18
v_lshl_add_u32 v8, v18, 4, v19
v_add_u32 v8, 64512, v8
v_lshrrev_b32 v16, 1, v2
v_xor_b32 v16, v16, v3
v_add_u32 v17, s8, v2
v_lshlrev_b32 v17, 7, v17
v_add_u32 v17, 65536, v17
v_lshl_add_u32 v9, v16, 4, v17
v_xor_b32 v10, 64, v9
v_bfe_u32 v16, v1, 2, 2
v_lshl_add_u32 v17, v3, 3, v16
v_lshlrev_b32 v17, 7, v17
v_and_b32 v18, 3, v1
v_lshl_add_u32 v17, v18, 3, v17
v_lshrrev_b32 v16, 1, v16
v_and_b32 v18, 1, v3
v_lshl_add_u32 v16, v18, 1, v16
v_xor_b32 v18, 0, v16
v_lshl_add_u32 v11, v18, 5, v17
v_xor_b32 v18, 1, v16
v_lshl_add_u32 v12, v18, 5, v17
v_xor_b32 v18, 2, v16
v_lshl_add_u32 v13, v18, 5, v17
v_xor_b32 v18, 3, v16
v_lshl_add_u32 v14, v18, 5, v17
v_mov_b32 v15, v4
s_mov_b32 s92, 0x8000
s_mul_i32 s60, s72, 36864
s_mul_i32 s68, s73, 36864
s_lshl_b32 s61, s3, 13
s_add_u32 s61, s61, 65536
s_and_b32 s9, s3, 1
s_lshr_b32 s10, s3, 1
s_lshl_b32 s62, s4, 8
s_lshl_b32 s11, s9, 7
s_add_u32 s62, s62, s11
s_lshl_b32 s11, s10, 17
s_add_u32 s62, s62, s11
s_lshl_b32 s63, s9, 12
s_lshl_b32 s11, s10, 11
s_add_u32 s63, s63, s11
s_lshl_b32 s74, s3, 10
s_mul_i32 s69, s4, 73728
s_add_u32 s69, s69, s74
s_add_u32 s69, s69, 35651584
s_add_u32 s74, s74, 8192
s_add_u32 m0, s61, 0
s_add_u32 s64, s60, 0
buffer_load_dwordx4 v5, s[44:47], s64 offen lds
buffer_load_dwordx4 v6, s[44:47], s64 offen offset:1024 lds
s_add_u32 m0, s61, 2048
s_add_u32 s64, s60, 18432
buffer_load_dwordx4 v5, s[44:47], s64 offen lds
buffer_load_dwordx4 v6, s[44:47], s64 offen offset:1024 lds
s_add_u32 m0, s63, 0
s_add_u32 s64, s62, 0
buffer_load_dwordx4 v7, s[48:51], s64 offen lds
buffer_load_dwordx4 v8, s[48:51], s64 offen offset:1024 lds
s_add_u32 m0, s74, 0
s_add_u32 s64, s69, 0
buffer_load_dwordx4 v4, s[52:55], s64 offen lds
s_add_u32 m0, s61, 4096
s_add_u32 s64, s68, 0
buffer_load_dwordx4 v5, s[44:47], s64 offen lds
buffer_load_dwordx4 v6, s[44:47], s64 offen offset:1024 lds
s_add_u32 m0, s61, 6144
s_add_u32 s64, s68, 18432
buffer_load_dwordx4 v5, s[44:47], s64 offen lds
buffer_load_dwordx4 v6, s[44:47], s64 offen offset:1024 lds
s_add_u32 m0, s63, 16384
s_add_u32 s64, s62, 262144
buffer_load_dwordx4 v7, s[48:51], s64 offen lds
buffer_load_dwordx4 v8, s[48:51], s64 offen offset:1024 lds
s_add_u32 m0, s74, 16384
s_add_u32 s64, s69, 4096
buffer_load_dwordx4 v4, s[52:55], s64 offen lds
s_add_u32 m0, s61, 32768
s_add_u32 s64, s60, 128
buffer_load_dwordx4 v5, s[44:47], s64 offen lds
buffer_load_dwordx4 v6, s[44:47], s64 offen offset:1024 lds
s_add_u32 m0, s61, 34816
s_add_u32 s64, s60, 18560
buffer_load_dwordx4 v5, s[44:47], s64 offen lds
buffer_load_dwordx4 v6, s[44:47], s64 offen offset:1024 lds
s_add_u32 m0, s63, 32768
s_add_u32 s64, s62, 524288
buffer_load_dwordx4 v7, s[48:51], s64 offen lds
buffer_load_dwordx4 v8, s[48:51], s64 offen offset:1024 lds
s_add_u32 m0, s74, 32768
s_add_u32 s64, s69, 8192
buffer_load_dwordx4 v4, s[52:55], s64 offen lds
s_add_u32 m0, s61, 36864
s_add_u32 s64, s68, 128
buffer_load_dwordx4 v5, s[44:47], s64 offen lds
buffer_load_dwordx4 v6, s[44:47], s64 offen offset:1024 lds
s_add_u32 m0, s61, 38912
s_add_u32 s64, s68, 18560
buffer_load_dwordx4 v5, s[44:47], s64 offen lds
buffer_load_dwordx4 v6, s[44:47], s64 offen offset:1024 lds
s_add_u32 m0, s63, 49152
s_add_u32 s64, s62, 786432
buffer_load_dwordx4 v7, s[48:51], s64 offen lds
buffer_load_dwordx4 v8, s[48:51], s64 offen offset:1024 lds
s_add_u32 m0, s74, 49152
s_add_u32 s64, s69, 12288
buffer_load_dwordx4 v4, s[52:55], s64 offen lds
s_add_u32 m0, s61, 65536
s_add_u32 s64, s60, 256
buffer_load_dwordx4 v5, s[44:47], s64 offen lds
buffer_load_dwordx4 v6, s[44:47], s64 offen offset:1024 lds
s_add_u32 m0, s61, 67584
s_add_u32 s64, s60, 18688
buffer_load_dwordx4 v5, s[44:47], s64 offen lds
buffer_load_dwordx4 v6, s[44:47], s64 offen offset:1024 lds
s_add_u32 s60, s60, 256
s_add_u32 s68, s68, 256
s_add_u32 s61, s61, 65536
s_add_u32 s62, s62, 1048576
s_add_u32 s69, s69, 16384
v_mov_b32 v32, 0
v_mov_b32 v33, 0
v_mov_b32 v34, 0
v_mov_b32 v35, 0
v_mov_b32 v36, 0
v_mov_b32 v37, 0
v_mov_b32 v38, 0
v_mov_b32 v39, 0
v_mov_b32 v40, 0
v_mov_b32 v41, 0
v_mov_b32 v42, 0
v_mov_b32 v43, 0
v_mov_b32 v44, 0
v_mov_b32 v45, 0
v_mov_b32 v46, 0
v_mov_b32 v47, 0
v_mov_b32 v48, 0
v_mov_b32 v49, 0
v_mov_b32 v50, 0
v_mov_b32 v51, 0
v_mov_b32 v52, 0
v_mov_b32 v53, 0
v_mov_b32 v54, 0
v_mov_b32 v55, 0
v_mov_b32 v56, 0
v_mov_b32 v57, 0
v_mov_b32 v58, 0
v_mov_b32 v59, 0
v_mov_b32 v60, 0
v_mov_b32 v61, 0
v_mov_b32 v62, 0
v_mov_b32 v63, 0
v_mov_b32 v64, 0
v_mov_b32 v65, 0
v_mov_b32 v66, 0
v_mov_b32 v67, 0
v_mov_b32 v68, 0
v_mov_b32 v69, 0
v_mov_b32 v70, 0
v_mov_b32 v71, 0
v_mov_b32 v72, 0
v_mov_b32 v73, 0
v_mov_b32 v74, 0
v_mov_b32 v75, 0
v_mov_b32 v76, 0
v_mov_b32 v77, 0
v_mov_b32 v78, 0
v_mov_b32 v79, 0
v_mov_b32 v80, 0
v_mov_b32 v81, 0
v_mov_b32 v82, 0
v_mov_b32 v83, 0
v_mov_b32 v84, 0
v_mov_b32 v85, 0
v_mov_b32 v86, 0
v_mov_b32 v87, 0
v_mov_b32 v88, 0
v_mov_b32 v89, 0
v_mov_b32 v90, 0
v_mov_b32 v91, 0
v_mov_b32 v92, 0
v_mov_b32 v93, 0
v_mov_b32 v94, 0
v_mov_b32 v95, 0
v_mov_b32 v96, 0
v_mov_b32 v97, 0
v_mov_b32 v98, 0
v_mov_b32 v99, 0
v_mov_b32 v100, 0
v_mov_b32 v101, 0
v_mov_b32 v102, 0
v_mov_b32 v103, 0
v_mov_b32 v104, 0
v_mov_b32 v105, 0
v_mov_b32 v106, 0
v_mov_b32 v107, 0
v_mov_b32 v108, 0
v_mov_b32 v109, 0
v_mov_b32 v110, 0
v_mov_b32 v111, 0
v_mov_b32 v112, 0
v_mov_b32 v113, 0
v_mov_b32 v114, 0
v_mov_b32 v115, 0
v_mov_b32 v116, 0
v_mov_b32 v117, 0
v_mov_b32 v118, 0
v_mov_b32 v119, 0
v_mov_b32 v120, 0
v_mov_b32 v121, 0
v_mov_b32 v122, 0
v_mov_b32 v123, 0
v_mov_b32 v124, 0
v_mov_b32 v125, 0
v_mov_b32 v126, 0
v_mov_b32 v127, 0
v_mov_b32 v128, 0
v_mov_b32 v129, 0
v_mov_b32 v130, 0
v_mov_b32 v131, 0
v_mov_b32 v132, 0
v_mov_b32 v133, 0
v_mov_b32 v134, 0
v_mov_b32 v135, 0
v_mov_b32 v136, 0
v_mov_b32 v137, 0
v_mov_b32 v138, 0
v_mov_b32 v139, 0
v_mov_b32 v140, 0
v_mov_b32 v141, 0
v_mov_b32 v142, 0
v_mov_b32 v143, 0
v_mov_b32 v144, 0
v_mov_b32 v145, 0
v_mov_b32 v146, 0
v_mov_b32 v147, 0
v_mov_b32 v148, 0
v_mov_b32 v149, 0
v_mov_b32 v150, 0
v_mov_b32 v151, 0
v_mov_b32 v152, 0
v_mov_b32 v153, 0
v_mov_b32 v154, 0
v_mov_b32 v155, 0
v_mov_b32 v156, 0
v_mov_b32 v157, 0
v_mov_b32 v158, 0
v_mov_b32 v159, 0
v_mov_b32 v160, 0
v_mov_b32 v161, 0
v_mov_b32 v162, 0
v_mov_b32 v163, 0
v_mov_b32 v164, 0
v_mov_b32 v165, 0
v_mov_b32 v166, 0
v_mov_b32 v167, 0
v_mov_b32 v168, 0
v_mov_b32 v169, 0
v_mov_b32 v170, 0
v_mov_b32 v171, 0
v_mov_b32 v172, 0
v_mov_b32 v173, 0
v_mov_b32 v174, 0
v_mov_b32 v175, 0
v_mov_b32 v176, 0
v_mov_b32 v177, 0
v_mov_b32 v178, 0
v_mov_b32 v179, 0
v_mov_b32 v180, 0
v_mov_b32 v181, 0
v_mov_b32 v182, 0
v_mov_b32 v183, 0
v_mov_b32 v184, 0
v_mov_b32 v185, 0
v_mov_b32 v186, 0
v_mov_b32 v187, 0
v_mov_b32 v188, 0
v_mov_b32 v189, 0
v_mov_b32 v190, 0
v_mov_b32 v191, 0
v_mov_b32 v192, 0
v_mov_b32 v193, 0
v_mov_b32 v194, 0
v_mov_b32 v195, 0
v_mov_b32 v196, 0
v_mov_b32 v197, 0
v_mov_b32 v198, 0
v_mov_b32 v199, 0
v_mov_b32 v200, 0
v_mov_b32 v201, 0
v_mov_b32 v202, 0
v_mov_b32 v203, 0
v_mov_b32 v204, 0
v_mov_b32 v205, 0
v_mov_b32 v206, 0
v_mov_b32 v207, 0
v_mov_b32 v208, 0
v_mov_b32 v209, 0
v_mov_b32 v210, 0
v_mov_b32 v211, 0
v_mov_b32 v212, 0
v_mov_b32 v213, 0
v_mov_b32 v214, 0
v_mov_b32 v215, 0
v_mov_b32 v216, 0
v_mov_b32 v217, 0
v_mov_b32 v218, 0
v_mov_b32 v219, 0
v_mov_b32 v220, 0
v_mov_b32 v221, 0
v_mov_b32 v222, 0
v_mov_b32 v223, 0
s_mov_b32 s65, 0
s_mov_b32 s70, 0
s_mov_b32 s71, 2
s_waitcnt vmcnt(21)
s_barrier
ds_read_b128 a[64:67], v9 offset:0
ds_read_b128 a[112:115], v15 offset:8192
ds_read_b64_tr_b16 a[80:81], v11 offset:0
ds_read_b64_tr_b16 a[82:83], v11 offset:512
ds_read_b128 a[68:71], v9 offset:2048
ds_read_b128 a[116:119], v15 offset:9216
ds_read_b64_tr_b16 a[84:85], v12 offset:0
ds_read_b64_tr_b16 a[86:87], v12 offset:512
ds_read_b128 a[72:75], v9 offset:4096
ds_read_b128 a[120:123], v15 offset:10240
ds_read_b64_tr_b16 a[88:89], v13 offset:0
ds_read_b64_tr_b16 a[90:91], v13 offset:512
ds_read_b128 a[76:79], v9 offset:6144
ds_read_b128 a[124:127], v15 offset:11264
ds_read_b64_tr_b16 a[92:93], v14 offset:0
ds_read_b64_tr_b16 a[94:95], v14 offset:512
ds_read_b64_tr_b16 a[96:97], v11 offset:4096
ds_read_b64_tr_b16 a[98:99], v11 offset:4608
ds_read_b64_tr_b16 a[100:101], v12 offset:4096
ds_read_b64_tr_b16 a[102:103], v12 offset:4608
ds_read_b64_tr_b16 a[104:105], v13 offset:4096
ds_read_b64_tr_b16 a[106:107], v13 offset:4608
ds_read_b64_tr_b16 a[108:109], v14 offset:4096
ds_read_b64_tr_b16 a[110:111], v14 offset:4608
s_waitcnt lgkmcnt(0)
K2_GLOOP:
v_mfma_f32_16x16x32_bf16 v[32:35], a[80:83], a[64:67], v[32:35]
s_waitcnt vmcnt(14)
v_mfma_f32_16x16x32_bf16 v[64:67], a[80:83], a[68:71], v[64:67]
s_barrier
v_mfma_f32_16x16x32_bf16 v[96:99], a[80:83], a[72:75], v[96:99]
s_add_u32 m0, s63, 0
s_add_u32 s64, s62, 0
v_mfma_f32_16x16x32_bf16 v[128:131], a[80:83], a[76:79], v[128:131]
buffer_load_dwordx4 v7, s[48:51], s64 offen lds
v_mfma_f32_16x16x32_bf16 v[132:135], a[84:87], a[76:79], v[132:135]
ds_read_b128 a[128:131], v10 offset:0
ds_read_b128 a[176:179], v15 offset:24576
v_mfma_f32_16x16x32_bf16 v[100:103], a[84:87], a[72:75], v[100:103]
v_mfma_f32_16x16x32_bf16 v[68:71], a[84:87], a[68:71], v[68:71]
ds_read_b64_tr_b16 a[144:145], v11 offset:16384
ds_read_b64_tr_b16 a[146:147], v11 offset:16896
v_mfma_f32_16x16x32_bf16 v[36:39], a[84:87], a[64:67], v[36:39]
v_mfma_f32_16x16x32_bf16 v[40:43], a[88:91], a[64:67], v[40:43]
ds_read_b128 a[132:135], v10 offset:2048
ds_read_b128 a[180:183], v15 offset:25600
v_mfma_f32_16x16x32_bf16 v[72:75], a[88:91], a[68:71], v[72:75]
buffer_load_dwordx4 v8, s[48:51], s64 offen offset:1024 lds
v_mfma_f32_16x16x32_bf16 v[104:107], a[88:91], a[72:75], v[104:107]
ds_read_b64_tr_b16 a[148:149], v12 offset:16384
ds_read_b64_tr_b16 a[150:151], v12 offset:16896
v_mfma_f32_16x16x32_bf16 v[136:139], a[88:91], a[76:79], v[136:139]
v_mfma_f32_16x16x32_bf16 v[140:143], a[92:95], a[76:79], v[140:143]
ds_read_b128 a[136:139], v10 offset:4096
ds_read_b128 a[184:187], v15 offset:26624
v_mfma_f32_16x16x32_bf16 v[108:111], a[92:95], a[72:75], v[108:111]
v_mfma_f32_16x16x32_bf16 v[76:79], a[92:95], a[68:71], v[76:79]
s_add_u32 m0, s74, 0
s_add_u32 s64, s69, 0
v_mfma_f32_16x16x32_bf16 v[44:47], a[92:95], a[64:67], v[44:47]
buffer_load_dwordx4 v4, s[52:55], s64 offen lds
v_mfma_f32_16x16x32_bf16 v[48:51], a[96:99], a[64:67], v[48:51]
ds_read_b64_tr_b16 a[152:153], v13 offset:16384
ds_read_b64_tr_b16 a[154:155], v13 offset:16896
v_mfma_f32_16x16x32_bf16 v[80:83], a[96:99], a[68:71], v[80:83]
v_mfma_f32_16x16x32_bf16 v[112:115], a[96:99], a[72:75], v[112:115]
ds_read_b128 a[140:143], v10 offset:6144
ds_read_b128 a[188:191], v15 offset:27648
v_mfma_f32_16x16x32_bf16 v[144:147], a[96:99], a[76:79], v[144:147]
v_mfma_f32_16x16x32_bf16 v[148:151], a[100:103], a[76:79], v[148:151]
s_add_u32 m0, s61, 4096
s_add_u32 s64, s68, 0
v_mfma_f32_16x16x32_bf16 v[116:119], a[100:103], a[72:75], v[116:119]
buffer_load_dwordx4 v5, s[44:47], s64 offen lds
v_mfma_f32_16x16x32_bf16 v[84:87], a[100:103], a[68:71], v[84:87]
ds_read_b64_tr_b16 a[156:157], v14 offset:16384
ds_read_b64_tr_b16 a[158:159], v14 offset:16896
v_mfma_f32_16x16x32_bf16 v[52:55], a[100:103], a[64:67], v[52:55]
v_mfma_f32_16x16x32_bf16 v[56:59], a[104:107], a[64:67], v[56:59]
ds_read_b64_tr_b16 a[160:161], v11 offset:20480
ds_read_b64_tr_b16 a[162:163], v11 offset:20992
v_mfma_f32_16x16x32_bf16 v[88:91], a[104:107], a[68:71], v[88:91]
v_mfma_f32_16x16x32_bf16 v[120:123], a[104:107], a[72:75], v[120:123]
ds_read_b64_tr_b16 a[164:165], v12 offset:20480
ds_read_b64_tr_b16 a[166:167], v12 offset:20992
v_mfma_f32_16x16x32_bf16 v[152:155], a[104:107], a[76:79], v[152:155]
buffer_load_dwordx4 v6, s[44:47], s64 offen offset:1024 lds
v_mfma_f32_16x16x32_bf16 v[156:159], a[108:111], a[76:79], v[156:159]
ds_read_b64_tr_b16 a[168:169], v13 offset:20480
ds_read_b64_tr_b16 a[170:171], v13 offset:20992
v_mfma_f32_16x16x32_bf16 v[124:127], a[108:111], a[72:75], v[124:127]
v_mfma_f32_16x16x32_bf16 v[92:95], a[108:111], a[68:71], v[92:95]
ds_read_b64_tr_b16 a[172:173], v14 offset:20480
ds_read_b64_tr_b16 a[174:175], v14 offset:20992
v_mfma_f32_16x16x32_bf16 v[60:63], a[108:111], a[64:67], v[60:63]
v_mfma_f32_16x16x32_bf16 v[160:163], a[112:115], a[64:67], v[160:163]
s_add_u32 m0, s61, 6144
s_add_u32 s64, s68, 18432
v_mfma_f32_16x16x32_bf16 v[176:179], a[112:115], a[68:71], v[176:179]
buffer_load_dwordx4 v5, s[44:47], s64 offen lds
v_mfma_f32_16x16x32_bf16 v[192:195], a[112:115], a[72:75], v[192:195]
v_xor_b32 v11, 0x8000, v11
v_xor_b32 v12, 0x8000, v12
v_mfma_f32_16x16x32_bf16 v[208:211], a[112:115], a[76:79], v[208:211]
v_xor_b32 v13, 0x8000, v13
v_xor_b32 v14, 0x8000, v14
v_mfma_f32_16x16x32_bf16 v[212:215], a[116:119], a[76:79], v[212:215]
v_xor_b32 v15, 0x8000, v15
v_mfma_f32_16x16x32_bf16 v[196:199], a[116:119], a[72:75], v[196:199]
s_add_u32 s70, s70, 1
s_cmp_eq_u32 s70, 3
s_cselect_b32 s66, -65536, s92
s_cselect_b32 s70, 0, s70
v_mfma_f32_16x16x32_bf16 v[180:183], a[116:119], a[68:71], v[180:183]
v_add_u32 v9, s66, v9
v_add_u32 v10, s66, v10
v_mfma_f32_16x16x32_bf16 v[164:167], a[116:119], a[64:67], v[164:167]
buffer_load_dwordx4 v6, s[44:47], s64 offen offset:1024 lds
v_mfma_f32_16x16x32_bf16 v[168:171], a[120:123], a[64:67], v[168:171]
v_mfma_f32_16x16x32_bf16 v[184:187], a[120:123], a[68:71], v[184:187]
v_mfma_f32_16x16x32_bf16 v[200:203], a[120:123], a[72:75], v[200:203]
v_mfma_f32_16x16x32_bf16 v[216:219], a[120:123], a[76:79], v[216:219]
v_mfma_f32_16x16x32_bf16 v[220:223], a[124:127], a[76:79], v[220:223]
v_mfma_f32_16x16x32_bf16 v[204:207], a[124:127], a[72:75], v[204:207]
v_mfma_f32_16x16x32_bf16 v[188:191], a[124:127], a[68:71], v[188:191]
v_mfma_f32_16x16x32_bf16 v[172:175], a[124:127], a[64:67], v[172:175]
s_waitcnt lgkmcnt(0)
v_mfma_f32_16x16x32_bf16 v[32:35], a[144:147], a[128:131], v[32:35]
s_waitcnt vmcnt(14)
v_mfma_f32_16x16x32_bf16 v[64:67], a[144:147], a[132:135], v[64:67]
s_barrier
v_mfma_f32_16x16x32_bf16 v[96:99], a[144:147], a[136:139], v[96:99]
s_add_u32 m0, s63, 16384
s_add_u32 s64, s62, 262144
v_mfma_f32_16x16x32_bf16 v[128:131], a[144:147], a[140:143], v[128:131]
buffer_load_dwordx4 v7, s[48:51], s64 offen lds
v_mfma_f32_16x16x32_bf16 v[132:135], a[148:151], a[140:143], v[132:135]
ds_read_b128 a[64:67], v9 offset:0
ds_read_b128 a[112:115], v15 offset:8192
v_mfma_f32_16x16x32_bf16 v[100:103], a[148:151], a[136:139], v[100:103]
s_add_u32 s71, s71, 1
s_cmp_eq_u32 s71, 3
s_cselect_b32 s67, -65536, s92
s_cselect_b32 s71, 0, s71
v_mfma_f32_16x16x32_bf16 v[68:71], a[148:151], a[132:135], v[68:71]
ds_read_b64_tr_b16 a[80:81], v11 offset:0
ds_read_b64_tr_b16 a[82:83], v11 offset:512
v_mfma_f32_16x16x32_bf16 v[36:39], a[148:151], a[128:131], v[36:39]
s_add_u32 s61, s61, s67
v_mfma_f32_16x16x32_bf16 v[40:43], a[152:155], a[128:131], v[40:43]
ds_read_b128 a[68:71], v9 offset:2048
ds_read_b128 a[116:119], v15 offset:9216
v_mfma_f32_16x16x32_bf16 v[72:75], a[152:155], a[132:135], v[72:75]
buffer_load_dwordx4 v8, s[48:51], s64 offen offset:1024 lds
v_mfma_f32_16x16x32_bf16 v[104:107], a[152:155], a[136:139], v[104:107]
ds_read_b64_tr_b16 a[84:85], v12 offset:0
ds_read_b64_tr_b16 a[86:87], v12 offset:512
v_mfma_f32_16x16x32_bf16 v[136:139], a[152:155], a[140:143], v[136:139]
s_add_u32 s60, s60, 128
v_mfma_f32_16x16x32_bf16 v[140:143], a[156:159], a[140:143], v[140:143]
ds_read_b128 a[72:75], v9 offset:4096
ds_read_b128 a[120:123], v15 offset:10240
v_mfma_f32_16x16x32_bf16 v[108:111], a[156:159], a[136:139], v[108:111]
s_add_u32 s68, s68, 128
v_mfma_f32_16x16x32_bf16 v[76:79], a[156:159], a[132:135], v[76:79]
s_add_u32 m0, s74, 16384
s_add_u32 s64, s69, 4096
v_mfma_f32_16x16x32_bf16 v[44:47], a[156:159], a[128:131], v[44:47]
buffer_load_dwordx4 v4, s[52:55], s64 offen lds
v_mfma_f32_16x16x32_bf16 v[48:51], a[160:163], a[128:131], v[48:51]
ds_read_b64_tr_b16 a[88:89], v13 offset:0
ds_read_b64_tr_b16 a[90:91], v13 offset:512
v_mfma_f32_16x16x32_bf16 v[80:83], a[160:163], a[132:135], v[80:83]
s_cmp_ge_u32 s65, 6
s_cselect_b32 s46, 0, s46
v_mfma_f32_16x16x32_bf16 v[112:115], a[160:163], a[136:139], v[112:115]
ds_read_b128 a[76:79], v9 offset:6144
ds_read_b128 a[124:127], v15 offset:11264
v_mfma_f32_16x16x32_bf16 v[144:147], a[160:163], a[140:143], v[144:147]
v_mfma_f32_16x16x32_bf16 v[148:151], a[164:167], a[140:143], v[148:151]
s_add_u32 m0, s61, 0
s_add_u32 s64, s60, 0
v_mfma_f32_16x16x32_bf16 v[116:119], a[164:167], a[136:139], v[116:119]
buffer_load_dwordx4 v5, s[44:47], s64 offen lds
v_mfma_f32_16x16x32_bf16 v[84:87], a[164:167], a[132:135], v[84:87]
ds_read_b64_tr_b16 a[92:93], v14 offset:0
ds_read_b64_tr_b16 a[94:95], v14 offset:512
v_mfma_f32_16x16x32_bf16 v[52:55], a[164:167], a[128:131], v[52:55]
v_mfma_f32_16x16x32_bf16 v[56:59], a[168:171], a[128:131], v[56:59]
ds_read_b64_tr_b16 a[96:97], v11 offset:4096
ds_read_b64_tr_b16 a[98:99], v11 offset:4608
v_mfma_f32_16x16x32_bf16 v[88:91], a[168:171], a[132:135], v[88:91]
v_mfma_f32_16x16x32_bf16 v[120:123], a[168:171], a[136:139], v[120:123]
ds_read_b64_tr_b16 a[100:101], v12 offset:4096
ds_read_b64_tr_b16 a[102:103], v12 offset:4608
v_mfma_f32_16x16x32_bf16 v[152:155], a[168:171], a[140:143], v[152:155]
buffer_load_dwordx4 v6, s[44:47], s64 offen offset:1024 lds
v_mfma_f32_16x16x32_bf16 v[156:159], a[172:175], a[140:143], v[156:159]
ds_read_b64_tr_b16 a[104:105], v13 offset:4096
ds_read_b64_tr_b16 a[106:107], v13 offset:4608
v_mfma_f32_16x16x32_bf16 v[124:127], a[172:175], a[136:139], v[124:127]
v_mfma_f32_16x16x32_bf16 v[92:95], a[172:175], a[132:135], v[92:95]
ds_read_b64_tr_b16 a[108:109], v14 offset:4096
ds_read_b64_tr_b16 a[110:111], v14 offset:4608
v_mfma_f32_16x16x32_bf16 v[60:63], a[172:175], a[128:131], v[60:63]
v_mfma_f32_16x16x32_bf16 v[160:163], a[176:179], a[128:131], v[160:163]
s_add_u32 m0, s61, 2048
s_add_u32 s64, s60, 18432
v_mfma_f32_16x16x32_bf16 v[176:179], a[176:179], a[132:135], v[176:179]
buffer_load_dwordx4 v5, s[44:47], s64 offen lds
v_mfma_f32_16x16x32_bf16 v[192:195], a[176:179], a[136:139], v[192:195]
v_mfma_f32_16x16x32_bf16 v[208:211], a[176:179], a[140:143], v[208:211]
v_mfma_f32_16x16x32_bf16 v[212:215], a[180:183], a[140:143], v[212:215]
v_mfma_f32_16x16x32_bf16 v[196:199], a[180:183], a[136:139], v[196:199]
v_mfma_f32_16x16x32_bf16 v[180:183], a[180:183], a[132:135], v[180:183]
v_mfma_f32_16x16x32_bf16 v[164:167], a[180:183], a[128:131], v[164:167]
buffer_load_dwordx4 v6, s[44:47], s64 offen offset:1024 lds
v_mfma_f32_16x16x32_bf16 v[168:171], a[184:187], a[128:131], v[168:171]
v_mfma_f32_16x16x32_bf16 v[184:187], a[184:187], a[132:135], v[184:187]
v_mfma_f32_16x16x32_bf16 v[200:203], a[184:187], a[136:139], v[200:203]
v_mfma_f32_16x16x32_bf16 v[216:219], a[184:187], a[140:143], v[216:219]
v_mfma_f32_16x16x32_bf16 v[220:223], a[188:191], a[140:143], v[220:223]
v_mfma_f32_16x16x32_bf16 v[204:207], a[188:191], a[136:139], v[204:207]
v_mfma_f32_16x16x32_bf16 v[188:191], a[188:191], a[132:135], v[188:191]
v_mfma_f32_16x16x32_bf16 v[172:175], a[188:191], a[128:131], v[172:175]
s_waitcnt lgkmcnt(0)
s_add_u32 s62, s62, 524288
s_add_u32 s69, s69, 8192
s_xor_b32 s63, s63, 0x8000
s_xor_b32 s74, s74, 0x8000
s_add_u32 s65, s65, 1
s_cmp_lt_u32 s65, 9
s_cbranch_scc1 K2_GLOOP
s_waitcnt vmcnt(0)
s_barrier
s_mul_i32 s75, s4, 1064960
s_lshl_b32 s8, s3, 12
s_add_u32 s75, s75, s8
s_add_u32 m0, s8, 114688
s_add_u32 s64, s75, 0
buffer_load_dwordx4 v4, s[52:55], s64 offen offset:0 lds
buffer_load_dwordx4 v4, s[52:55], s64 offen offset:1024 lds
buffer_load_dwordx4 v4, s[52:55], s64 offen offset:2048 lds
buffer_load_dwordx4 v4, s[52:55], s64 offen offset:3072 lds
s_add_u32 m0, s8, 0
s_add_u32 s64, s75, 16384
buffer_load_dwordx4 v4, s[52:55], s64 offen offset:0 lds
buffer_load_dwordx4 v4, s[52:55], s64 offen offset:1024 lds
buffer_load_dwordx4 v4, s[52:55], s64 offen offset:2048 lds
buffer_load_dwordx4 v4, s[52:55], s64 offen offset:3072 lds
s_add_u32 m0, s8, 16384
s_add_u32 s64, s75, 32768
buffer_load_dwordx4 v4, s[52:55], s64 offen offset:0 lds
buffer_load_dwordx4 v4, s[52:55], s64 offen offset:1024 lds
buffer_load_dwordx4 v4, s[52:55], s64 offen offset:2048 lds
buffer_load_dwordx4 v4, s[52:55], s64 offen offset:3072 lds
s_add_u32 m0, s8, 32768
s_add_u32 s64, s75, 49152
buffer_load_dwordx4 v4, s[52:55], s64 offen offset:0 lds
buffer_load_dwordx4 v4, s[52:55], s64 offen offset:1024 lds
buffer_load_dwordx4 v4, s[52:55], s64 offen offset:2048 lds
buffer_load_dwordx4 v4, s[52:55], s64 offen offset:3072 lds
s_add_u32 m0, s8, 49152
s_add_u32 s64, s75, 65536
buffer_load_dwordx4 v4, s[52:55], s64 offen offset:0 lds
buffer_load_dwordx4 v4, s[52:55], s64 offen offset:1024 lds
buffer_load_dwordx4 v4, s[52:55], s64 offen offset:2048 lds
buffer_load_dwordx4 v4, s[52:55], s64 offen offset:3072 lds
s_add_u32 m0, s8, 65536
s_add_u32 s64, s75, 81920
buffer_load_dwordx4 v4, s[52:55], s64 offen offset:0 lds
buffer_load_dwordx4 v4, s[52:55], s64 offen offset:1024 lds
buffer_load_dwordx4 v4, s[52:55], s64 offen offset:2048 lds
buffer_load_dwordx4 v4, s[52:55], s64 offen offset:3072 lds
s_add_u32 m0, s8, 81920
s_add_u32 s64, s75, 98304
buffer_load_dwordx4 v4, s[52:55], s64 offen offset:0 lds
buffer_load_dwordx4 v4, s[52:55], s64 offen offset:1024 lds
buffer_load_dwordx4 v4, s[52:55], s64 offen offset:2048 lds
buffer_load_dwordx4 v4, s[52:55], s64 offen offset:3072 lds
s_lshl_b32 s9, s5, 16
s_sub_u32 s9, 1048576, s9
s_add_u32 s77, s75, s9
s_add_u32 s75, s75, 114688
s_add_u32 s76, s8, 98304
v_add_u32 v20, 48, v2
v_lshlrev_b32 v20, 2, v20
ds_bpermute_b32 v16, v20, v166
ds_bpermute_b32 v17, v20, v182
ds_bpermute_b32 v18, v20, v198
ds_bpermute_b32 v19, v20, v214
v_lshlrev_b32 v21, 16, v3
v_lshl_add_u32 v21, v2, 4, v21
v_add_u32 v22, 0x8000, v21
s_lshl_b32 s9, s4, 18
s_add_u32 s9, s9, 45088768
s_lshl_b32 s10, s72, 9
s_add_u32 s10, s10, s9
s_lshl_b32 s11, s73, 9
s_add_u32 s11, s11, s9
s_waitcnt lgkmcnt(0)
v_cvt_pk_bf16_f32 v160, v160, v161
v_cvt_pk_bf16_f32 v161, v162, v163
v_cvt_pk_bf16_f32 v162, v164, v165
v_cvt_pk_bf16_f32 v163, v166, v167
buffer_store_dwordx4 v[160:163], v21, s[52:55], s10 offen offset:0
v_cvt_pk_bf16_f32 v168, v168, v169
v_cvt_pk_bf16_f32 v169, v170, v171
v_cvt_pk_bf16_f32 v170, v172, v173
v_cvt_pk_bf16_f32 v171, v174, v175
buffer_store_dwordx4 v[168:171], v22, s[52:55], s10 offen offset:0
v_cvt_pk_bf16_f32 v176, v176, v177
v_cvt_pk_bf16_f32 v177, v178, v179
v_cvt_pk_bf16_f32 v178, v180, v181
v_cvt_pk_bf16_f32 v179, v182, v183
buffer_store_dwordx4 v[176:179], v21, s[52:55], s10 offen offset:256
v_cvt_pk_bf16_f32 v184, v184, v185
v_cvt_pk_bf16_f32 v185, v186, v187
v_cvt_pk_bf16_f32 v186, v188, v189
v_cvt_pk_bf16_f32 v187, v190, v191
buffer_store_dwordx4 v[184:187], v22, s[52:55], s10 offen offset:256
v_cvt_pk_bf16_f32 v192, v192, v193
v_cvt_pk_bf16_f32 v193, v194, v195
v_cvt_pk_bf16_f32 v194, v196, v197
v_cvt_pk_bf16_f32 v195, v198, v199
buffer_store_dwordx4 v[192:195], v21, s[52:55], s11 offen offset:0
v_cvt_pk_bf16_f32 v200, v200, v201
v_cvt_pk_bf16_f32 v201, v202, v203
v_cvt_pk_bf16_f32 v202, v204, v205
v_cvt_pk_bf16_f32 v203, v206, v207
buffer_store_dwordx4 v[200:203], v22, s[52:55], s11 offen offset:0
v_cvt_pk_bf16_f32 v208, v208, v209
v_cvt_pk_bf16_f32 v209, v210, v211
v_cvt_pk_bf16_f32 v210, v212, v213
v_cvt_pk_bf16_f32 v211, v214, v215
buffer_store_dwordx4 v[208:211], v21, s[52:55], s11 offen offset:256
v_cvt_pk_bf16_f32 v216, v216, v217
v_cvt_pk_bf16_f32 v217, v218, v219
v_cvt_pk_bf16_f32 v218, v220, v221
v_cvt_pk_bf16_f32 v219, v222, v223
buffer_store_dwordx4 v[216:219], v22, s[52:55], s11 offen offset:256
v_mul_f32 v16, 0x3fb8aa3b, v16
v_mul_f32 v17, 0x3fb8aa3b, v17
v_mul_f32 v18, 0x3fb8aa3b, v18
v_mul_f32 v19, 0x3fb8aa3b, v19
v_exp_f32 v16, v16
v_exp_f32 v17, v17
v_exp_f32 v18, v18
v_exp_f32 v19, v19
v_add_f32 v16, 1.0, v16
v_add_f32 v17, 1.0, v17
v_add_f32 v18, 1.0, v18
v_add_f32 v19, 1.0, v19
s_mov_b32 s12, 0x3e0293ee
s_mov_b32 s13, s12
v_pk_mul_f32 v[32:33], v[32:33], s[12:13]
v_pk_mul_f32 v[34:35], v[34:35], s[12:13]
v_pk_mul_f32 v[36:37], v[36:37], s[12:13]
v_pk_mul_f32 v[38:39], v[38:39], s[12:13]
v_cvt_pk_bf16_f32 v32, v32, v33
v_cvt_pk_bf16_f32 v33, v34, v35
v_cvt_pk_bf16_f32 v34, v36, v37
v_cvt_pk_bf16_f32 v35, v38, v39
v_accvgpr_write_b32 a0, v32
v_accvgpr_write_b32 a1, v33
v_accvgpr_write_b32 a2, v34
v_accvgpr_write_b32 a3, v35
v_pk_mul_f32 v[40:41], v[40:41], s[12:13]
v_pk_mul_f32 v[42:43], v[42:43], s[12:13]
v_pk_mul_f32 v[44:45], v[44:45], s[12:13]
v_pk_mul_f32 v[46:47], v[46:47], s[12:13]
v_cvt_pk_bf16_f32 v40, v40, v41
v_cvt_pk_bf16_f32 v41, v42, v43
v_cvt_pk_bf16_f32 v42, v44, v45
v_cvt_pk_bf16_f32 v43, v46, v47
v_accvgpr_write_b32 a4, v40
v_accvgpr_write_b32 a5, v41
v_accvgpr_write_b32 a6, v42
v_accvgpr_write_b32 a7, v43
v_pk_mul_f32 v[48:49], v[48:49], s[12:13]
v_pk_mul_f32 v[50:51], v[50:51], s[12:13]
v_pk_mul_f32 v[52:53], v[52:53], s[12:13]
v_pk_mul_f32 v[54:55], v[54:55], s[12:13]
v_cvt_pk_bf16_f32 v48, v48, v49
v_cvt_pk_bf16_f32 v49, v50, v51
v_cvt_pk_bf16_f32 v50, v52, v53
v_cvt_pk_bf16_f32 v51, v54, v55
v_accvgpr_write_b32 a8, v48
v_accvgpr_write_b32 a9, v49
v_accvgpr_write_b32 a10, v50
v_accvgpr_write_b32 a11, v51
v_pk_mul_f32 v[56:57], v[56:57], s[12:13]
v_pk_mul_f32 v[58:59], v[58:59], s[12:13]
v_pk_mul_f32 v[60:61], v[60:61], s[12:13]
v_pk_mul_f32 v[62:63], v[62:63], s[12:13]
v_cvt_pk_bf16_f32 v56, v56, v57
v_cvt_pk_bf16_f32 v57, v58, v59
v_cvt_pk_bf16_f32 v58, v60, v61
v_cvt_pk_bf16_f32 v59, v62, v63
v_accvgpr_write_b32 a12, v56
v_accvgpr_write_b32 a13, v57
v_accvgpr_write_b32 a14, v58
v_accvgpr_write_b32 a15, v59
v_pk_mul_f32 v[64:65], v[64:65], s[12:13]
v_pk_mul_f32 v[66:67], v[66:67], s[12:13]
v_pk_mul_f32 v[68:69], v[68:69], s[12:13]
v_pk_mul_f32 v[70:71], v[70:71], s[12:13]
v_cvt_pk_bf16_f32 v64, v64, v65
v_cvt_pk_bf16_f32 v65, v66, v67
v_cvt_pk_bf16_f32 v66, v68, v69
v_cvt_pk_bf16_f32 v67, v70, v71
v_accvgpr_write_b32 a16, v64
v_accvgpr_write_b32 a17, v65
v_accvgpr_write_b32 a18, v66
v_accvgpr_write_b32 a19, v67
v_pk_mul_f32 v[72:73], v[72:73], s[12:13]
v_pk_mul_f32 v[74:75], v[74:75], s[12:13]
v_pk_mul_f32 v[76:77], v[76:77], s[12:13]
v_pk_mul_f32 v[78:79], v[78:79], s[12:13]
v_cvt_pk_bf16_f32 v72, v72, v73
v_cvt_pk_bf16_f32 v73, v74, v75
v_cvt_pk_bf16_f32 v74, v76, v77
v_cvt_pk_bf16_f32 v75, v78, v79
v_accvgpr_write_b32 a20, v72
v_accvgpr_write_b32 a21, v73
v_accvgpr_write_b32 a22, v74
v_accvgpr_write_b32 a23, v75
v_pk_mul_f32 v[80:81], v[80:81], s[12:13]
v_pk_mul_f32 v[82:83], v[82:83], s[12:13]
v_pk_mul_f32 v[84:85], v[84:85], s[12:13]
v_pk_mul_f32 v[86:87], v[86:87], s[12:13]
v_cvt_pk_bf16_f32 v80, v80, v81
v_cvt_pk_bf16_f32 v81, v82, v83
v_cvt_pk_bf16_f32 v82, v84, v85
v_cvt_pk_bf16_f32 v83, v86, v87
v_accvgpr_write_b32 a24, v80
v_accvgpr_write_b32 a25, v81
v_accvgpr_write_b32 a26, v82
v_accvgpr_write_b32 a27, v83
v_pk_mul_f32 v[88:89], v[88:89], s[12:13]
v_pk_mul_f32 v[90:91], v[90:91], s[12:13]
v_pk_mul_f32 v[92:93], v[92:93], s[12:13]
v_pk_mul_f32 v[94:95], v[94:95], s[12:13]
v_cvt_pk_bf16_f32 v88, v88, v89
v_cvt_pk_bf16_f32 v89, v90, v91
v_cvt_pk_bf16_f32 v90, v92, v93
v_cvt_pk_bf16_f32 v91, v94, v95
v_accvgpr_write_b32 a28, v88
v_accvgpr_write_b32 a29, v89
v_accvgpr_write_b32 a30, v90
v_accvgpr_write_b32 a31, v91
v_pk_mul_f32 v[96:97], v[96:97], s[12:13]
v_pk_mul_f32 v[98:99], v[98:99], s[12:13]
v_pk_mul_f32 v[100:101], v[100:101], s[12:13]
v_pk_mul_f32 v[102:103], v[102:103], s[12:13]
v_cvt_pk_bf16_f32 v96, v96, v97
v_cvt_pk_bf16_f32 v97, v98, v99
v_cvt_pk_bf16_f32 v98, v100, v101
v_cvt_pk_bf16_f32 v99, v102, v103
v_accvgpr_write_b32 a32, v96
v_accvgpr_write_b32 a33, v97
v_accvgpr_write_b32 a34, v98
v_accvgpr_write_b32 a35, v99
v_pk_mul_f32 v[104:105], v[104:105], s[12:13]
v_pk_mul_f32 v[106:107], v[106:107], s[12:13]
v_pk_mul_f32 v[108:109], v[108:109], s[12:13]
v_pk_mul_f32 v[110:111], v[110:111], s[12:13]
v_cvt_pk_bf16_f32 v104, v104, v105
v_cvt_pk_bf16_f32 v105, v106, v107
v_cvt_pk_bf16_f32 v106, v108, v109
v_cvt_pk_bf16_f32 v107, v110, v111
v_accvgpr_write_b32 a36, v104
v_accvgpr_write_b32 a37, v105
v_accvgpr_write_b32 a38, v106
v_accvgpr_write_b32 a39, v107
v_pk_mul_f32 v[112:113], v[112:113], s[12:13]
v_pk_mul_f32 v[114:115], v[114:115], s[12:13]
v_pk_mul_f32 v[116:117], v[116:117], s[12:13]
v_pk_mul_f32 v[118:119], v[118:119], s[12:13]
v_cvt_pk_bf16_f32 v112, v112, v113
v_cvt_pk_bf16_f32 v113, v114, v115
v_cvt_pk_bf16_f32 v114, v116, v117
v_cvt_pk_bf16_f32 v115, v118, v119
v_accvgpr_write_b32 a40, v112
v_accvgpr_write_b32 a41, v113
v_accvgpr_write_b32 a42, v114
v_accvgpr_write_b32 a43, v115
v_pk_mul_f32 v[120:121], v[120:121], s[12:13]
v_pk_mul_f32 v[122:123], v[122:123], s[12:13]
v_pk_mul_f32 v[124:125], v[124:125], s[12:13]
v_pk_mul_f32 v[126:127], v[126:127], s[12:13]
v_cvt_pk_bf16_f32 v120, v120, v121
v_cvt_pk_bf16_f32 v121, v122, v123
v_cvt_pk_bf16_f32 v122, v124, v125
v_cvt_pk_bf16_f32 v123, v126, v127
v_accvgpr_write_b32 a44, v120
v_accvgpr_write_b32 a45, v121
v_accvgpr_write_b32 a46, v122
v_accvgpr_write_b32 a47, v123
v_pk_mul_f32 v[128:129], v[128:129], s[12:13]
v_pk_mul_f32 v[130:131], v[130:131], s[12:13]
v_pk_mul_f32 v[132:133], v[132:133], s[12:13]
v_pk_mul_f32 v[134:135], v[134:135], s[12:13]
v_cvt_pk_bf16_f32 v128, v128, v129
v_cvt_pk_bf16_f32 v129, v130, v131
v_cvt_pk_bf16_f32 v130, v132, v133
v_cvt_pk_bf16_f32 v131, v134, v135
v_accvgpr_write_b32 a48, v128
v_accvgpr_write_b32 a49, v129
v_accvgpr_write_b32 a50, v130
v_accvgpr_write_b32 a51, v131
v_pk_mul_f32 v[136:137], v[136:137], s[12:13]
v_pk_mul_f32 v[138:139], v[138:139], s[12:13]
v_pk_mul_f32 v[140:141], v[140:141], s[12:13]
v_pk_mul_f32 v[142:143], v[142:143], s[12:13]
v_cvt_pk_bf16_f32 v136, v136, v137
v_cvt_pk_bf16_f32 v137, v138, v139
v_cvt_pk_bf16_f32 v138, v140, v141
v_cvt_pk_bf16_f32 v139, v142, v143
v_accvgpr_write_b32 a52, v136
v_accvgpr_write_b32 a53, v137
v_accvgpr_write_b32 a54, v138
v_accvgpr_write_b32 a55, v139
v_pk_mul_f32 v[144:145], v[144:145], s[12:13]
v_pk_mul_f32 v[146:147], v[146:147], s[12:13]
v_pk_mul_f32 v[148:149], v[148:149], s[12:13]
v_pk_mul_f32 v[150:151], v[150:151], s[12:13]
v_cvt_pk_bf16_f32 v144, v144, v145
v_cvt_pk_bf16_f32 v145, v146, v147
v_cvt_pk_bf16_f32 v146, v148, v149
v_cvt_pk_bf16_f32 v147, v150, v151
v_accvgpr_write_b32 a56, v144
v_accvgpr_write_b32 a57, v145
v_accvgpr_write_b32 a58, v146
v_accvgpr_write_b32 a59, v147
v_pk_mul_f32 v[152:153], v[152:153], s[12:13]
v_pk_mul_f32 v[154:155], v[154:155], s[12:13]
v_pk_mul_f32 v[156:157], v[156:157], s[12:13]
v_pk_mul_f32 v[158:159], v[158:159], s[12:13]
v_cvt_pk_bf16_f32 v152, v152, v153
v_cvt_pk_bf16_f32 v153, v154, v155
v_cvt_pk_bf16_f32 v154, v156, v157
v_cvt_pk_bf16_f32 v155, v158, v159
v_accvgpr_write_b32 a60, v152
v_accvgpr_write_b32 a61, v153
v_accvgpr_write_b32 a62, v154
v_accvgpr_write_b32 a63, v155
s_waitcnt vmcnt(32)
s_barrier
v_add_u32 v5, 114688, v4
ds_read_b128 a[64:67], v5 offset:0
ds_read_b128 a[68:71], v5 offset:1024
ds_read_b128 a[72:75], v5 offset:2048
ds_read_b128 a[76:79], v5 offset:3072
ds_read_b128 a[80:83], v5 offset:4096
ds_read_b128 a[84:87], v5 offset:5120
ds_read_b128 a[88:91], v5 offset:6144
ds_read_b128 a[92:95], v5 offset:7168
v_mov_b32 v32, 0
v_mov_b32 v33, 0
v_mov_b32 v34, 0
v_mov_b32 v35, 0
v_mov_b32 v36, 0
v_mov_b32 v37, 0
v_mov_b32 v38, 0
v_mov_b32 v39, 0
v_mov_b32 v40, 0
v_mov_b32 v41, 0
v_mov_b32 v42, 0
v_mov_b32 v43, 0
v_mov_b32 v44, 0
v_mov_b32 v45, 0
v_mov_b32 v46, 0
v_mov_b32 v47, 0
v_mov_b32 v48, 0
v_mov_b32 v49, 0
v_mov_b32 v50, 0
v_mov_b32 v51, 0
v_mov_b32 v52, 0
v_mov_b32 v53, 0
v_mov_b32 v54, 0
v_mov_b32 v55, 0
v_mov_b32 v56, 0
v_mov_b32 v57, 0
v_mov_b32 v58, 0
v_mov_b32 v59, 0
v_mov_b32 v60, 0
v_mov_b32 v61, 0
v_mov_b32 v62, 0
v_mov_b32 v63, 0
v_mov_b32 v64, 0
v_mov_b32 v65, 0
v_mov_b32 v66, 0
v_mov_b32 v67, 0
v_mov_b32 v68, 0
v_mov_b32 v69, 0
v_mov_b32 v70, 0
v_mov_b32 v71, 0
v_mov_b32 v72, 0
v_mov_b32 v73, 0
v_mov_b32 v74, 0
v_mov_b32 v75, 0
v_mov_b32 v76, 0
v_mov_b32 v77, 0
v_mov_b32 v78, 0
v_mov_b32 v79, 0
v_mov_b32 v80, 0
v_mov_b32 v81, 0
v_mov_b32 v82, 0
v_mov_b32 v83, 0
v_mov_b32 v84, 0
v_mov_b32 v85, 0
v_mov_b32 v86, 0
v_mov_b32 v87, 0
v_mov_b32 v88, 0
v_mov_b32 v89, 0
v_mov_b32 v90, 0
v_mov_b32 v91, 0
v_mov_b32 v92, 0
v_mov_b32 v93, 0
v_mov_b32 v94, 0
v_mov_b32 v95, 0
v_mov_b32 v96, 0
v_mov_b32 v97, 0
v_mov_b32 v98, 0
v_mov_b32 v99, 0
v_mov_b32 v100, 0
v_mov_b32 v101, 0
v_mov_b32 v102, 0
v_mov_b32 v103, 0
v_mov_b32 v104, 0
v_mov_b32 v105, 0
v_mov_b32 v106, 0
v_mov_b32 v107, 0
v_mov_b32 v108, 0
v_mov_b32 v109, 0
v_mov_b32 v110, 0
v_mov_b32 v111, 0
v_mov_b32 v112, 0
v_mov_b32 v113, 0
v_mov_b32 v114, 0
v_mov_b32 v115, 0
v_mov_b32 v116, 0
v_mov_b32 v117, 0
v_mov_b32 v118, 0
v_mov_b32 v119, 0
v_mov_b32 v120, 0
v_mov_b32 v121, 0
v_mov_b32 v122, 0
v_mov_b32 v123, 0
v_mov_b32 v124, 0
v_mov_b32 v125, 0
v_mov_b32 v126, 0
v_mov_b32 v127, 0
v_mov_b32 v128, 0
v_mov_b32 v129, 0
v_mov_b32 v130, 0
v_mov_b32 v131, 0
v_mov_b32 v132, 0
v_mov_b32 v133, 0
v_mov_b32 v134, 0
v_mov_b32 v135, 0
v_mov_b32 v136, 0
v_mov_b32 v137, 0
v_mov_b32 v138, 0
v_mov_b32 v139, 0
v_mov_b32 v140, 0
v_mov_b32 v141, 0
v_mov_b32 v142, 0
v_mov_b32 v143, 0
v_mov_b32 v144, 0
v_mov_b32 v145, 0
v_mov_b32 v146, 0
v_mov_b32 v147, 0
v_mov_b32 v148, 0
v_mov_b32 v149, 0
v_mov_b32 v150, 0
v_mov_b32 v151, 0
v_mov_b32 v152, 0
v_mov_b32 v153, 0
v_mov_b32 v154, 0
v_mov_b32 v155, 0
v_mov_b32 v156, 0
v_mov_b32 v157, 0
v_mov_b32 v158, 0
v_mov_b32 v159, 0
v_mov_b32 v232, 0
v_mov_b32 v233, 0
v_mov_b32 v234, 0
v_mov_b32 v235, 0
v_mov_b32 v236, 0
v_mov_b32 v237, 0
v_mov_b32 v238, 0
v_mov_b32 v239, 0
v_mov_b32 v240, 0
v_mov_b32 v241, 0
v_mov_b32 v242, 0
v_mov_b32 v243, 0
v_mov_b32 v244, 0
v_mov_b32 v245, 0
v_mov_b32 v246, 0
v_mov_b32 v247, 0
v_mov_b32 v248, 0
v_mov_b32 v249, 0
v_mov_b32 v250, 0
v_mov_b32 v251, 0
v_mov_b32 v252, 0
v_mov_b32 v253, 0
v_mov_b32 v254, 0
v_mov_b32 v255, 0
v_mov_b32 v20, 0x3f803f80
v_accvgpr_write_b32 a128, v20
v_accvgpr_write_b32 a129, v20
v_accvgpr_write_b32 a130, v20
v_accvgpr_write_b32 a131, v20
v_accvgpr_write_b32 a96, 0
v_accvgpr_write_b32 a97, 0
v_accvgpr_write_b32 a98, 0
v_accvgpr_write_b32 a99, 0
v_accvgpr_write_b32 a100, 0
v_accvgpr_write_b32 a101, 0
v_accvgpr_write_b32 a102, 0
v_accvgpr_write_b32 a103, 0
v_accvgpr_write_b32 a104, 0
v_accvgpr_write_b32 a105, 0
v_accvgpr_write_b32 a106, 0
v_accvgpr_write_b32 a107, 0
v_accvgpr_write_b32 a108, 0
v_accvgpr_write_b32 a109, 0
v_accvgpr_write_b32 a110, 0
v_accvgpr_write_b32 a111, 0
v_accvgpr_write_b32 a112, 0
v_accvgpr_write_b32 a113, 0
v_accvgpr_write_b32 a114, 0
v_accvgpr_write_b32 a115, 0
v_accvgpr_write_b32 a116, 0
v_accvgpr_write_b32 a117, 0
v_accvgpr_write_b32 a118, 0
v_accvgpr_write_b32 a119, 0
v_accvgpr_write_b32 a120, 0
v_accvgpr_write_b32 a121, 0
v_accvgpr_write_b32 a122, 0
v_accvgpr_write_b32 a123, 0
v_accvgpr_write_b32 a124, 0
v_accvgpr_write_b32 a125, 0
v_accvgpr_write_b32 a126, 0
v_accvgpr_write_b32 a127, 0
s_waitcnt lgkmcnt(0)
v_mfma_f32_16x16x32_bf16 v[192:195], a[64:67], a[0:3], 0
v_mfma_f32_16x16x32_bf16 v[192:195], a[68:71], a[4:7], v[192:195]
v_mfma_f32_16x16x32_bf16 v[192:195], a[72:75], a[8:11], v[192:195]
v_mfma_f32_16x16x32_bf16 v[192:195], a[76:79], a[12:15], v[192:195]
v_mfma_f32_16x16x32_bf16 v[196:199], a[64:67], a[16:19], 0
v_mfma_f32_16x16x32_bf16 v[196:199], a[68:71], a[20:23], v[196:199]
v_mfma_f32_16x16x32_bf16 v[196:199], a[72:75], a[24:27], v[196:199]
v_mfma_f32_16x16x32_bf16 v[196:199], a[76:79], a[28:31], v[196:199]
v_mfma_f32_16x16x32_bf16 v[200:203], a[64:67], a[32:35], 0
v_mfma_f32_16x16x32_bf16 v[200:203], a[68:71], a[36:39], v[200:203]
v_mfma_f32_16x16x32_bf16 v[200:203], a[72:75], a[40:43], v[200:203]
v_mfma_f32_16x16x32_bf16 v[200:203], a[76:79], a[44:47], v[200:203]
v_mfma_f32_16x16x32_bf16 v[204:207], a[64:67], a[48:51], 0
v_mfma_f32_16x16x32_bf16 v[204:207], a[68:71], a[52:55], v[204:207]
v_mfma_f32_16x16x32_bf16 v[204:207], a[72:75], a[56:59], v[204:207]
v_mfma_f32_16x16x32_bf16 v[204:207], a[76:79], a[60:63], v[204:207]
v_lshlrev_b32 v20, 2, v3
v_sub_u32 v20, v2, v20
v_cmp_gt_i32 s[84:85], 0, v20
v_cmp_gt_i32 s[86:87], 1, v20
v_cmp_gt_i32 s[88:89], 2, v20
v_cmp_gt_i32 s[90:91], 3, v20
v_mov_b32 v6, 0xf149f2ca
s_nop 3
v_max3_f32 v192, v192, v193, v194
v_max_f32 v192, v192, v195
v_max3_f32 v196, v196, v197, v198
v_max_f32 v196, v196, v199
v_max3_f32 v200, v200, v201, v202
v_max_f32 v200, v200, v203
v_max3_f32 v204, v204, v205, v206
v_max_f32 v204, v204, v207
v_mov_b32 v193, v192
v_mov_b32 v197, v196
v_mov_b32 v201, v200
v_mov_b32 v205, v204
s_nop 1
v_permlane32_swap_b32 v193, v192
v_permlane32_swap_b32 v197, v196
v_permlane32_swap_b32 v201, v200
v_permlane32_swap_b32 v205, v204
s_nop 1
v_max_f32 v192, v192, v193
v_max_f32 v196, v196, v197
v_max_f32 v200, v200, v201
v_max_f32 v204, v204, v205
v_mov_b32 v193, v192
v_mov_b32 v197, v196
v_mov_b32 v201, v200
v_mov_b32 v205, v204
s_nop 1
v_permlane16_swap_b32 v193, v192
v_permlane16_swap_b32 v197, v196
v_permlane16_swap_b32 v201, v200
v_permlane16_swap_b32 v205, v204
s_nop 1
v_max_f32 v192, v192, v193
v_max_f32 v196, v196, v197
v_max_f32 v200, v200, v201
v_max_f32 v204, v204, v205
v_sub_f32 v160, 0, v192
v_sub_f32 v161, 0, v192
v_sub_f32 v162, 0, v192
v_sub_f32 v163, 0, v192
v_sub_f32 v164, 0, v196
v_sub_f32 v165, 0, v196
v_sub_f32 v166, 0, v196
v_sub_f32 v167, 0, v196
v_sub_f32 v168, 0, v192
v_sub_f32 v169, 0, v192
v_sub_f32 v170, 0, v192
v_sub_f32 v171, 0, v192
v_sub_f32 v172, 0, v196
v_sub_f32 v173, 0, v196
v_sub_f32 v174, 0, v196
v_sub_f32 v175, 0, v196
v_sub_f32 v176, 0, v200
v_sub_f32 v177, 0, v200
v_sub_f32 v178, 0, v200
v_sub_f32 v179, 0, v200
v_sub_f32 v180, 0, v204
v_sub_f32 v181, 0, v204
v_sub_f32 v182, 0, v204
v_sub_f32 v183, 0, v204
v_sub_f32 v184, 0, v200
v_sub_f32 v185, 0, v200
v_sub_f32 v186, 0, v200
v_sub_f32 v187, 0, v200
v_sub_f32 v188, 0, v204
v_sub_f32 v189, 0, v204
v_sub_f32 v190, 0, v204
v_sub_f32 v191, 0, v204
v_mov_b32 v220, 0
v_mov_b32 v221, v6
v_mov_b32 v222, v6
v_mov_b32 v223, v6
s_mov_b32 s79, s72
s_mov_b32 s80, s73
s_cmp_lg_u32 s72, 0
s_cbranch_scc1 K2_NOD0
v_cndmask_b32 v160, v160, v6, s[84:85]
v_cndmask_b32 v172, v172, v6, s[84:85]
v_mov_b32 v168, v6
v_cndmask_b32 v161, v161, v6, s[86:87]
v_cndmask_b32 v173, v173, v6, s[86:87]
v_mov_b32 v169, v6
v_cndmask_b32 v162, v162, v6, s[88:89]
v_cndmask_b32 v174, v174, v6, s[88:89]
v_mov_b32 v170, v6
v_cndmask_b32 v163, v163, v6, s[90:91]
v_cndmask_b32 v175, v175, v6, s[90:91]
v_mov_b32 v171, v6
s_mov_b32 s79, 1
K2_NOD0:
s_mov_b32 s78, 1
s_mov_b32 s82, -16384
s_lshl_b32 s65, s5, 2
s_add_u32 s65, s65, 5
s_nop 1
K2_DUAL:
v_mfma_f32_16x16x32_bf16 v[192:195], a[64:67], a[0:3], v[160:163]
s_add_u32 s82, s82, 16384
v_mfma_f32_16x16x32_bf16 v[192:195], a[68:71], a[4:7], v[192:195]
s_and_b32 s82, s82, 131071
v_exp_f32 v221, v221
v_mfma_f32_16x16x32_bf16 v[192:195], a[72:75], a[8:11], v[192:195]
s_cmp_le_u32 s75, s77
v_cvt_pk_bf16_f32 v238, v220, v221
v_mfma_f32_16x16x32_bf16 v[192:195], a[76:79], a[12:15], v[192:195]
s_waitcnt vmcnt(20)
v_exp_f32 v222, v222
v_mfma_f32_16x16x32_bf16 v[196:199], a[64:67], a[16:19], v[164:167]
s_barrier
v_mfma_f32_16x16x32_bf16 v[196:199], a[68:71], a[20:23], v[196:199]
s_cselect_b32 s64, s75, 2147418112
v_exp_f32 v223, v223
v_mfma_f32_16x16x32_bf16 v[196:199], a[72:75], a[24:27], v[196:199]
v_cvt_pk_bf16_f32 v239, v222, v223
v_mfma_f32_16x16x32_bf16 v[196:199], a[76:79], a[28:31], v[196:199]
v_add_u32 v5, s82, v4
v_mfma_f32_16x16x32_bf16 v[200:203], a[80:83], a[0:3], v[168:171]
v_mfma_f32_16x16x32_bf16 v[200:203], a[84:87], a[4:7], v[200:203]
s_mov_b32 m0, s76
v_exp_f32 v192, v192
v_mfma_f32_16x16x32_bf16 v[200:203], a[88:91], a[8:11], v[200:203]
buffer_load_dwordx4 v4, s[52:55], s64 offen offset:0 lds
v_mfma_f32_16x16x32_bf16 v[200:203], a[92:95], a[12:15], v[200:203]
s_add_u32 s75, s75, 16384
v_exp_f32 v193, v193
v_mfma_f32_16x16x32_bf16 v[204:207], a[80:83], a[16:19], v[172:175]
v_cvt_pk_bf16_f32 v224, v192, v193
v_mfma_f32_16x16x32_bf16 v[204:207], a[84:87], a[20:23], v[204:207]
s_add_u32 s76, s76, 16384
v_exp_f32 v194, v194
v_mfma_f32_16x16x32_bf16 v[204:207], a[88:91], a[24:27], v[204:207]
v_mfma_f32_16x16x32_bf16 v[204:207], a[92:95], a[28:31], v[204:207]
v_exp_f32 v195, v195
v_mfma_f32_16x16x32_bf16 v[96:99], a[96:99], v[232:235], v[96:99]
v_cvt_pk_bf16_f32 v225, v194, v195
v_mfma_f32_16x16x32_bf16 v[128:131], a[96:99], v[236:239], v[128:131]
s_and_b32 s76, s76, 131071
v_exp_f32 v196, v196
v_mfma_f32_16x16x32_bf16 v[100:103], a[100:103], v[232:235], v[100:103]
buffer_load_dwordx4 v4, s[52:55], s64 offen offset:1024 lds
v_mfma_f32_16x16x32_bf16 v[132:135], a[100:103], v[236:239], v[132:135]
s_cmp_eq_u32 s78, s79
v_exp_f32 v197, v197
v_mfma_f32_16x16x32_bf16 v[104:107], a[104:107], v[232:235], v[104:107]
v_cvt_pk_bf16_f32 v228, v196, v197
v_mfma_f32_16x16x32_bf16 v[136:139], a[104:107], v[236:239], v[136:139]
s_cbranch_scc1 K2_MD0
K2_MD0_R:
v_exp_f32 v198, v198
v_mfma_f32_16x16x32_bf16 v[108:111], a[108:111], v[232:235], v[108:111]
ds_read_b128 a[96:99], v5 offset:8192
v_mfma_f32_16x16x32_bf16 v[140:143], a[108:111], v[236:239], v[140:143]
s_add_u32 s78, s78, 1
v_exp_f32 v199, v199
v_mfma_f32_16x16x32_bf16 v[112:115], a[112:115], v[232:235], v[112:115]
ds_read_b128 a[100:103], v5 offset:9216
v_cvt_pk_bf16_f32 v229, v198, v199
v_mfma_f32_16x16x32_bf16 v[144:147], a[112:115], v[236:239], v[144:147]
v_exp_f32 v200, v200
v_mfma_f32_16x16x32_bf16 v[116:119], a[116:119], v[232:235], v[116:119]
buffer_load_dwordx4 v4, s[52:55], s64 offen offset:2048 lds
v_mfma_f32_16x16x32_bf16 v[148:151], a[116:119], v[236:239], v[148:151]
v_exp_f32 v201, v201
v_mfma_f32_16x16x32_bf16 v[120:123], a[120:123], v[232:235], v[120:123]
ds_read_b128 a[104:107], v5 offset:10240
v_cvt_pk_bf16_f32 v226, v200, v201
v_mfma_f32_16x16x32_bf16 v[152:155], a[120:123], v[236:239], v[152:155]
v_exp_f32 v202, v202
v_mfma_f32_16x16x32_bf16 v[124:127], a[124:127], v[232:235], v[124:127]
buffer_load_dwordx4 v4, s[52:55], s64 offen offset:3072 lds
v_mfma_f32_16x16x32_bf16 v[156:159], a[124:127], v[236:239], v[156:159]
v_exp_f32 v203, v203
v_mfma_f32_16x16x32_bf16 v[248:251], a[128:131], v[232:235], v[248:251]
ds_read_b128 a[108:111], v5 offset:11264
v_cvt_pk_bf16_f32 v227, v202, v203
v_mfma_f32_16x16x32_bf16 v[252:255], a[128:131], v[236:239], v[252:255]
v_exp_f32 v204, v204
v_mfma_f32_16x16x32_bf16 v[208:211], a[64:67], a[32:35], v[176:179]
ds_read_b128 a[112:115], v5 offset:12288
ds_read_b128 a[116:119], v5 offset:13312
v_mfma_f32_16x16x32_bf16 v[208:211], a[68:71], a[36:39], v[208:211]
v_exp_f32 v205, v205
v_mfma_f32_16x16x32_bf16 v[208:211], a[72:75], a[40:43], v[208:211]
ds_read_b128 a[120:123], v5 offset:14336
v_cvt_pk_bf16_f32 v230, v204, v205
v_mfma_f32_16x16x32_bf16 v[208:211], a[76:79], a[44:47], v[208:211]
v_exp_f32 v206, v206
v_mfma_f32_16x16x32_bf16 v[212:215], a[64:67], a[48:51], v[180:183]
v_mfma_f32_16x16x32_bf16 v[212:215], a[68:71], a[52:55], v[212:215]
v_exp_f32 v207, v207
v_mfma_f32_16x16x32_bf16 v[212:215], a[72:75], a[56:59], v[212:215]
ds_read_b128 a[124:127], v5 offset:15360
v_cvt_pk_bf16_f32 v231, v206, v207
v_mfma_f32_16x16x32_bf16 v[212:215], a[76:79], a[60:63], v[212:215]
v_mfma_f32_16x16x32_bf16 v[216:219], a[80:83], a[32:35], v[184:187]
ds_read_b128 a[64:67], v5 offset:0
ds_read_b128 a[68:71], v5 offset:1024
v_mfma_f32_16x16x32_bf16 v[216:219], a[84:87], a[36:39], v[216:219]
v_exp_f32 v208, v208
v_mfma_f32_16x16x32_bf16 v[216:219], a[88:91], a[40:43], v[216:219]
v_mfma_f32_16x16x32_bf16 v[216:219], a[92:95], a[44:47], v[216:219]
v_exp_f32 v209, v209
v_mfma_f32_16x16x32_bf16 v[220:223], a[80:83], a[48:51], v[188:191]
ds_read_b128 a[72:75], v5 offset:2048
v_cvt_pk_bf16_f32 v232, v208, v209
v_mfma_f32_16x16x32_bf16 v[220:223], a[84:87], a[52:55], v[220:223]
v_exp_f32 v210, v210
v_mfma_f32_16x16x32_bf16 v[220:223], a[88:91], a[56:59], v[220:223]
ds_read_b128 a[76:79], v5 offset:3072
ds_read_b128 a[80:83], v5 offset:4096
v_mfma_f32_16x16x32_bf16 v[220:223], a[92:95], a[60:63], v[220:223]
s_waitcnt lgkmcnt(5)
v_exp_f32 v211, v211
v_mfma_f32_16x16x32_bf16 v[32:35], a[96:99], v[224:227], v[32:35]
ds_read_b128 a[84:87], v5 offset:5120
v_cvt_pk_bf16_f32 v233, v210, v211
v_mfma_f32_16x16x32_bf16 v[64:67], a[96:99], v[228:231], v[64:67]
v_exp_f32 v212, v212
v_mfma_f32_16x16x32_bf16 v[36:39], a[100:103], v[224:227], v[36:39]
v_mfma_f32_16x16x32_bf16 v[68:71], a[100:103], v[228:231], v[68:71]
v_exp_f32 v213, v213
v_mfma_f32_16x16x32_bf16 v[40:43], a[104:107], v[224:227], v[40:43]
ds_read_b128 a[88:91], v5 offset:6144
v_cvt_pk_bf16_f32 v236, v212, v213
v_mfma_f32_16x16x32_bf16 v[72:75], a[104:107], v[228:231], v[72:75]
v_exp_f32 v214, v214
v_mfma_f32_16x16x32_bf16 v[44:47], a[108:111], v[224:227], v[44:47]
ds_read_b128 a[92:95], v5 offset:7168
v_mfma_f32_16x16x32_bf16 v[76:79], a[108:111], v[228:231], v[76:79]
v_exp_f32 v215, v215
v_mfma_f32_16x16x32_bf16 v[48:51], a[112:115], v[224:227], v[48:51]
v_cvt_pk_bf16_f32 v237, v214, v215
v_mfma_f32_16x16x32_bf16 v[80:83], a[112:115], v[228:231], v[80:83]
v_exp_f32 v216, v216
v_mfma_f32_16x16x32_bf16 v[52:55], a[116:119], v[224:227], v[52:55]
v_mfma_f32_16x16x32_bf16 v[84:87], a[116:119], v[228:231], v[84:87]
v_exp_f32 v217, v217
v_mfma_f32_16x16x32_bf16 v[56:59], a[120:123], v[224:227], v[56:59]
v_cvt_pk_bf16_f32 v234, v216, v217
v_mfma_f32_16x16x32_bf16 v[88:91], a[120:123], v[228:231], v[88:91]
s_cmp_lg_u32 s78, s65
v_exp_f32 v218, v218
v_mfma_f32_16x16x32_bf16 v[60:63], a[124:127], v[224:227], v[60:63]
v_mfma_f32_16x16x32_bf16 v[92:95], a[124:127], v[228:231], v[92:95]
s_waitcnt lgkmcnt(0)
v_exp_f32 v219, v219
v_mfma_f32_16x16x32_bf16 v[240:243], a[128:131], v[224:227], v[240:243]
v_cvt_pk_bf16_f32 v235, v218, v219
v_mfma_f32_16x16x32_bf16 v[244:247], a[128:131], v[228:231], v[244:247]
v_exp_f32 v220, v220
s_cbranch_scc1 K2_DUAL
v_subrev_u32 v5, 16384, v5
s_sub_u32 s82, s82, 16384
s_sub_u32 s8, s78, 1
s_cmp_lg_u32 s8, s73
s_cbranch_scc1 K2_NOD1
v_cndmask_b32 v176, v176, v6, s[84:85]
v_cndmask_b32 v188, v188, v6, s[84:85]
v_mov_b32 v184, v6
v_cndmask_b32 v177, v177, v6, s[86:87]
v_cndmask_b32 v189, v189, v6, s[86:87]
v_mov_b32 v185, v6
v_cndmask_b32 v178, v178, v6, s[88:89]
v_cndmask_b32 v190, v190, v6, s[88:89]
v_mov_b32 v186, v6
v_cndmask_b32 v179, v179, v6, s[90:91]
v_cndmask_b32 v191, v191, v6, s[90:91]
v_mov_b32 v187, v6
s_add_u32 s80, s80, 1
K2_NOD1:
s_lshl_b32 s65, s5, 2
s_sub_u32 s65, 65, s65
K2_SINGLE:
v_mfma_f32_16x16x32_bf16 v[192:195], a[64:67], a[32:35], v[176:179]
s_add_u32 s82, s82, 32768
ds_read_b128 a[112:115], v5 offset:28672
ds_read_b128 a[116:119], v5 offset:29696
v_mfma_f32_16x16x32_bf16 v[192:195], a[68:71], a[36:39], v[192:195]
s_and_b32 s82, s82, 131071
v_exp_f32 v221, v221
v_mfma_f32_16x16x32_bf16 v[192:195], a[72:75], a[40:43], v[192:195]
s_cmp_le_u32 s75, s77
ds_read_b128 a[120:123], v5 offset:30720
v_cvt_pk_bf16_f32 v238, v220, v221
v_mfma_f32_16x16x32_bf16 v[192:195], a[76:79], a[44:47], v[192:195]
s_waitcnt vmcnt(20)
v_exp_f32 v222, v222
v_mfma_f32_16x16x32_bf16 v[196:199], a[64:67], a[48:51], v[180:183]
s_barrier
v_mfma_f32_16x16x32_bf16 v[196:199], a[68:71], a[52:55], v[196:199]
s_cselect_b32 s64, s75, 2147418112
v_exp_f32 v223, v223
v_mfma_f32_16x16x32_bf16 v[196:199], a[72:75], a[56:59], v[196:199]
ds_read_b128 a[124:127], v5 offset:31744
v_cvt_pk_bf16_f32 v239, v222, v223
v_mfma_f32_16x16x32_bf16 v[196:199], a[76:79], a[60:63], v[196:199]
v_add_u32 v5, s82, v4
v_mfma_f32_16x16x32_bf16 v[200:203], a[80:83], a[32:35], v[184:187]
ds_read_b128 a[64:67], v5 offset:0
ds_read_b128 a[68:71], v5 offset:1024
v_mfma_f32_16x16x32_bf16 v[200:203], a[84:87], a[36:39], v[200:203]
s_mov_b32 m0, s76
v_exp_f32 v192, v192
v_mfma_f32_16x16x32_bf16 v[200:203], a[88:91], a[40:43], v[200:203]
buffer_load_dwordx4 v4, s[52:55], s64 offen offset:0 lds
v_mfma_f32_16x16x32_bf16 v[200:203], a[92:95], a[44:47], v[200:203]
s_add_u32 s75, s75, 16384
v_exp_f32 v193, v193
v_mfma_f32_16x16x32_bf16 v[204:207], a[80:83], a[48:51], v[188:191]
ds_read_b128 a[72:75], v5 offset:2048
v_cvt_pk_bf16_f32 v224, v192, v193
v_mfma_f32_16x16x32_bf16 v[204:207], a[84:87], a[52:55], v[204:207]
s_add_u32 s76, s76, 16384
v_exp_f32 v194, v194
v_mfma_f32_16x16x32_bf16 v[204:207], a[88:91], a[56:59], v[204:207]
ds_read_b128 a[76:79], v5 offset:3072
ds_read_b128 a[80:83], v5 offset:4096
v_mfma_f32_16x16x32_bf16 v[204:207], a[92:95], a[60:63], v[204:207]
s_waitcnt lgkmcnt(5)
v_exp_f32 v195, v195
v_mfma_f32_16x16x32_bf16 v[96:99], a[96:99], v[232:235], v[96:99]
ds_read_b128 a[84:87], v5 offset:5120
v_cvt_pk_bf16_f32 v225, v194, v195
v_mfma_f32_16x16x32_bf16 v[128:131], a[96:99], v[236:239], v[128:131]
s_and_b32 s76, s76, 131071
v_exp_f32 v196, v196
v_mfma_f32_16x16x32_bf16 v[100:103], a[100:103], v[232:235], v[100:103]
buffer_load_dwordx4 v4, s[52:55], s64 offen offset:1024 lds
v_mfma_f32_16x16x32_bf16 v[132:135], a[100:103], v[236:239], v[132:135]
s_cmp_eq_u32 s78, s80
v_exp_f32 v197, v197
v_mfma_f32_16x16x32_bf16 v[104:107], a[104:107], v[232:235], v[104:107]
ds_read_b128 a[88:91], v5 offset:6144
v_cvt_pk_bf16_f32 v228, v196, v197
v_mfma_f32_16x16x32_bf16 v[136:139], a[104:107], v[236:239], v[136:139]
s_cbranch_scc1 K2_MS0
K2_MS0_R:
v_exp_f32 v198, v198
v_mfma_f32_16x16x32_bf16 v[108:111], a[108:111], v[232:235], v[108:111]
ds_read_b128 a[92:95], v5 offset:7168
ds_read_b128 a[96:99], v5 offset:8192
v_mfma_f32_16x16x32_bf16 v[140:143], a[108:111], v[236:239], v[140:143]
s_add_u32 s78, s78, 1
v_exp_f32 v199, v199
v_mfma_f32_16x16x32_bf16 v[112:115], a[112:115], v[232:235], v[112:115]
ds_read_b128 a[100:103], v5 offset:9216
v_cvt_pk_bf16_f32 v229, v198, v199
v_mfma_f32_16x16x32_bf16 v[144:147], a[112:115], v[236:239], v[144:147]
v_exp_f32 v200, v200
v_mfma_f32_16x16x32_bf16 v[116:119], a[116:119], v[232:235], v[116:119]
buffer_load_dwordx4 v4, s[52:55], s64 offen offset:2048 lds
v_mfma_f32_16x16x32_bf16 v[148:151], a[116:119], v[236:239], v[148:151]
v_exp_f32 v201, v201
v_mfma_f32_16x16x32_bf16 v[120:123], a[120:123], v[232:235], v[120:123]
ds_read_b128 a[104:107], v5 offset:10240
v_cvt_pk_bf16_f32 v226, v200, v201
v_mfma_f32_16x16x32_bf16 v[152:155], a[120:123], v[236:239], v[152:155]
v_exp_f32 v202, v202
v_mfma_f32_16x16x32_bf16 v[124:127], a[124:127], v[232:235], v[124:127]
buffer_load_dwordx4 v4, s[52:55], s64 offen offset:3072 lds
v_mfma_f32_16x16x32_bf16 v[156:159], a[124:127], v[236:239], v[156:159]
v_exp_f32 v203, v203
v_mfma_f32_16x16x32_bf16 v[248:251], a[128:131], v[232:235], v[248:251]
ds_read_b128 a[108:111], v5 offset:11264
v_cvt_pk_bf16_f32 v227, v202, v203
v_mfma_f32_16x16x32_bf16 v[252:255], a[128:131], v[236:239], v[252:255]
s_waitcnt lgkmcnt(4)
v_exp_f32 v204, v204
v_mfma_f32_16x16x32_bf16 v[208:211], a[64:67], a[32:35], v[176:179]
ds_read_b128 a[112:115], v5 offset:12288
ds_read_b128 a[116:119], v5 offset:13312
v_mfma_f32_16x16x32_bf16 v[208:211], a[68:71], a[36:39], v[208:211]
v_exp_f32 v205, v205
v_mfma_f32_16x16x32_bf16 v[208:211], a[72:75], a[40:43], v[208:211]
s_cmp_le_u32 s75, s77
ds_read_b128 a[120:123], v5 offset:14336
v_cvt_pk_bf16_f32 v230, v204, v205
v_mfma_f32_16x16x32_bf16 v[208:211], a[76:79], a[44:47], v[208:211]
s_waitcnt vmcnt(20)
v_exp_f32 v206, v206
v_mfma_f32_16x16x32_bf16 v[212:215], a[64:67], a[48:51], v[180:183]
s_barrier
v_mfma_f32_16x16x32_bf16 v[212:215], a[68:71], a[52:55], v[212:215]
s_cselect_b32 s64, s75, 2147418112
v_exp_f32 v207, v207
v_mfma_f32_16x16x32_bf16 v[212:215], a[72:75], a[56:59], v[212:215]
ds_read_b128 a[124:127], v5 offset:15360
v_cvt_pk_bf16_f32 v231, v206, v207
v_mfma_f32_16x16x32_bf16 v[212:215], a[76:79], a[60:63], v[212:215]
v_mfma_f32_16x16x32_bf16 v[216:219], a[80:83], a[32:35], v[184:187]
ds_read_b128 a[64:67], v5 offset:16384
ds_read_b128 a[68:71], v5 offset:17408
v_mfma_f32_16x16x32_bf16 v[216:219], a[84:87], a[36:39], v[216:219]
s_mov_b32 m0, s76
v_exp_f32 v208, v208
v_mfma_f32_16x16x32_bf16 v[216:219], a[88:91], a[40:43], v[216:219]
buffer_load_dwordx4 v4, s[52:55], s64 offen offset:0 lds
v_mfma_f32_16x16x32_bf16 v[216:219], a[92:95], a[44:47], v[216:219]
s_add_u32 s75, s75, 16384
v_exp_f32 v209, v209
v_mfma_f32_16x16x32_bf16 v[220:223], a[80:83], a[48:51], v[188:191]
ds_read_b128 a[72:75], v5 offset:18432
v_cvt_pk_bf16_f32 v232, v208, v209
v_mfma_f32_16x16x32_bf16 v[220:223], a[84:87], a[52:55], v[220:223]
s_add_u32 s76, s76, 16384
v_exp_f32 v210, v210
v_mfma_f32_16x16x32_bf16 v[220:223], a[88:91], a[56:59], v[220:223]
ds_read_b128 a[76:79], v5 offset:19456
ds_read_b128 a[80:83], v5 offset:20480
v_mfma_f32_16x16x32_bf16 v[220:223], a[92:95], a[60:63], v[220:223]
s_waitcnt lgkmcnt(5)
v_exp_f32 v211, v211
v_mfma_f32_16x16x32_bf16 v[96:99], a[96:99], v[224:227], v[96:99]
ds_read_b128 a[84:87], v5 offset:21504
v_cvt_pk_bf16_f32 v233, v210, v211
v_mfma_f32_16x16x32_bf16 v[128:131], a[96:99], v[228:231], v[128:131]
s_and_b32 s76, s76, 131071
v_exp_f32 v212, v212
v_mfma_f32_16x16x32_bf16 v[100:103], a[100:103], v[224:227], v[100:103]
buffer_load_dwordx4 v4, s[52:55], s64 offen offset:1024 lds
v_mfma_f32_16x16x32_bf16 v[132:135], a[100:103], v[228:231], v[132:135]
s_cmp_eq_u32 s78, s80
v_exp_f32 v213, v213
v_mfma_f32_16x16x32_bf16 v[104:107], a[104:107], v[224:227], v[104:107]
ds_read_b128 a[88:91], v5 offset:22528
v_cvt_pk_bf16_f32 v236, v212, v213
v_mfma_f32_16x16x32_bf16 v[136:139], a[104:107], v[228:231], v[136:139]
s_cbranch_scc1 K2_MS1
K2_MS1_R:
v_exp_f32 v214, v214
v_mfma_f32_16x16x32_bf16 v[108:111], a[108:111], v[224:227], v[108:111]
ds_read_b128 a[92:95], v5 offset:23552
ds_read_b128 a[96:99], v5 offset:24576
v_mfma_f32_16x16x32_bf16 v[140:143], a[108:111], v[228:231], v[140:143]
s_add_u32 s78, s78, 1
v_exp_f32 v215, v215
v_mfma_f32_16x16x32_bf16 v[112:115], a[112:115], v[224:227], v[112:115]
ds_read_b128 a[100:103], v5 offset:25600
v_cvt_pk_bf16_f32 v237, v214, v215
v_mfma_f32_16x16x32_bf16 v[144:147], a[112:115], v[228:231], v[144:147]
v_exp_f32 v216, v216
v_mfma_f32_16x16x32_bf16 v[116:119], a[116:119], v[224:227], v[116:119]
buffer_load_dwordx4 v4, s[52:55], s64 offen offset:2048 lds
v_mfma_f32_16x16x32_bf16 v[148:151], a[116:119], v[228:231], v[148:151]
v_exp_f32 v217, v217
v_mfma_f32_16x16x32_bf16 v[120:123], a[120:123], v[224:227], v[120:123]
ds_read_b128 a[104:107], v5 offset:26624
v_cvt_pk_bf16_f32 v234, v216, v217
v_mfma_f32_16x16x32_bf16 v[152:155], a[120:123], v[228:231], v[152:155]
s_cmp_lg_u32 s78, s65
v_exp_f32 v218, v218
v_mfma_f32_16x16x32_bf16 v[124:127], a[124:127], v[224:227], v[124:127]
buffer_load_dwordx4 v4, s[52:55], s64 offen offset:3072 lds
v_mfma_f32_16x16x32_bf16 v[156:159], a[124:127], v[228:231], v[156:159]
s_waitcnt lgkmcnt(3)
v_exp_f32 v219, v219
v_mfma_f32_16x16x32_bf16 v[248:251], a[128:131], v[224:227], v[248:251]
ds_read_b128 a[108:111], v5 offset:27648
v_cvt_pk_bf16_f32 v235, v218, v219
v_mfma_f32_16x16x32_bf16 v[252:255], a[128:131], v[228:231], v[252:255]
v_exp_f32 v220, v220
s_cbranch_scc1 K2_SINGLE
ds_read_b128 a[112:115], v5 offset:28672
ds_read_b128 a[116:119], v5 offset:29696
ds_read_b128 a[120:123], v5 offset:30720
ds_read_b128 a[124:127], v5 offset:31744
v_exp_f32 v221, v221
v_exp_f32 v222, v222
v_exp_f32 v223, v223
s_nop 0
v_cvt_pk_bf16_f32 v238, v220, v221
v_cvt_pk_bf16_f32 v239, v222, v223
s_waitcnt lgkmcnt(0)
s_nop 0
v_mfma_f32_16x16x32_bf16 v[96:99], a[96:99], v[232:235], v[96:99]
v_mfma_f32_16x16x32_bf16 v[128:131], a[96:99], v[236:239], v[128:131]
v_mfma_f32_16x16x32_bf16 v[100:103], a[100:103], v[232:235], v[100:103]
v_mfma_f32_16x16x32_bf16 v[132:135], a[100:103], v[236:239], v[132:135]
v_mfma_f32_16x16x32_bf16 v[104:107], a[104:107], v[232:235], v[104:107]
v_mfma_f32_16x16x32_bf16 v[136:139], a[104:107], v[236:239], v[136:139]
v_mfma_f32_16x16x32_bf16 v[108:111], a[108:111], v[232:235], v[108:111]
v_mfma_f32_16x16x32_bf16 v[140:143], a[108:111], v[236:239], v[140:143]
v_mfma_f32_16x16x32_bf16 v[112:115], a[112:115], v[232:235], v[112:115]
v_mfma_f32_16x16x32_bf16 v[144:147], a[112:115], v[236:239], v[144:147]
v_mfma_f32_16x16x32_bf16 v[116:119], a[116:119], v[232:235], v[116:119]
v_mfma_f32_16x16x32_bf16 v[148:151], a[116:119], v[236:239], v[148:151]
v_mfma_f32_16x16x32_bf16 v[120:123], a[120:123], v[232:235], v[120:123]
v_mfma_f32_16x16x32_bf16 v[152:155], a[120:123], v[236:239], v[152:155]
v_mfma_f32_16x16x32_bf16 v[124:127], a[124:127], v[232:235], v[124:127]
v_mfma_f32_16x16x32_bf16 v[156:159], a[124:127], v[236:239], v[156:159]
v_mfma_f32_16x16x32_bf16 v[248:251], a[128:131], v[232:235], v[248:251]
v_mfma_f32_16x16x32_bf16 v[252:255], a[128:131], v[236:239], v[252:255]
s_lshl_b32 s8, s5, 2
s_add_u32 s8, s8, s3
s_mul_i32 s8, s8, 598016
s_lshl_b32 s9, s4, 14
s_add_u32 s8, s8, s9
s_add_u32 s8, s8, 54525952
s_nop 3
v_mul_f32 v16, v16, v240
v_mul_f32 v17, v17, v244
v_mul_f32 v18, v18, v248
v_mul_f32 v19, v19, v252
v_rcp_f32 v20, v16
v_rcp_f32 v22, v17
v_rcp_f32 v24, v18
v_rcp_f32 v26, v19
s_nop 0
v_mov_b32 v21, v20
v_mov_b32 v23, v22
v_mov_b32 v25, v24
v_mov_b32 v27, v26
v_pk_mul_f32 v[32:33], v[32:33], v[20:21]
v_pk_mul_f32 v[34:35], v[34:35], v[20:21]
v_pk_mul_f32 v[36:37], v[36:37], v[20:21]
v_pk_mul_f32 v[38:39], v[38:39], v[20:21]
v_cvt_pk_bf16_f32 v32, v32, v33
v_cvt_pk_bf16_f32 v33, v34, v35
v_cvt_pk_bf16_f32 v34, v36, v37
v_cvt_pk_bf16_f32 v35, v38, v39
buffer_store_dwordx4 v[32:35], v4, s[52:55], s8 offen offset:0
v_pk_mul_f32 v[64:65], v[64:65], v[22:23]
v_pk_mul_f32 v[66:67], v[66:67], v[22:23]
v_pk_mul_f32 v[68:69], v[68:69], v[22:23]
v_pk_mul_f32 v[70:71], v[70:71], v[22:23]
v_cvt_pk_bf16_f32 v64, v64, v65
v_cvt_pk_bf16_f32 v65, v66, v67
v_cvt_pk_bf16_f32 v66, v68, v69
v_cvt_pk_bf16_f32 v67, v70, v71
buffer_store_dwordx4 v[64:67], v4, s[52:55], s8 offen offset:1024
v_pk_mul_f32 v[96:97], v[96:97], v[24:25]
v_pk_mul_f32 v[98:99], v[98:99], v[24:25]
v_pk_mul_f32 v[100:101], v[100:101], v[24:25]
v_pk_mul_f32 v[102:103], v[102:103], v[24:25]
v_cvt_pk_bf16_f32 v96, v96, v97
v_cvt_pk_bf16_f32 v97, v98, v99
v_cvt_pk_bf16_f32 v98, v100, v101
v_cvt_pk_bf16_f32 v99, v102, v103
buffer_store_dwordx4 v[96:99], v4, s[52:55], s8 offen offset:2048
v_pk_mul_f32 v[128:129], v[128:129], v[26:27]
v_pk_mul_f32 v[130:131], v[130:131], v[26:27]
v_pk_mul_f32 v[132:133], v[132:133], v[26:27]
v_pk_mul_f32 v[134:135], v[134:135], v[26:27]
v_cvt_pk_bf16_f32 v128, v128, v129
v_cvt_pk_bf16_f32 v129, v130, v131
v_cvt_pk_bf16_f32 v130, v132, v133
v_cvt_pk_bf16_f32 v131, v134, v135
buffer_store_dwordx4 v[128:131], v4, s[52:55], s8 offen offset:3072
s_add_u32 s8, s8, 4096
v_pk_mul_f32 v[40:41], v[40:41], v[20:21]
v_pk_mul_f32 v[42:43], v[42:43], v[20:21]
v_pk_mul_f32 v[44:45], v[44:45], v[20:21]
v_pk_mul_f32 v[46:47], v[46:47], v[20:21]
v_cvt_pk_bf16_f32 v40, v40, v41
v_cvt_pk_bf16_f32 v41, v42, v43
v_cvt_pk_bf16_f32 v42, v44, v45
v_cvt_pk_bf16_f32 v43, v46, v47
buffer_store_dwordx4 v[40:43], v4, s[52:55], s8 offen offset:0
v_pk_mul_f32 v[72:73], v[72:73], v[22:23]
v_pk_mul_f32 v[74:75], v[74:75], v[22:23]
v_pk_mul_f32 v[76:77], v[76:77], v[22:23]
v_pk_mul_f32 v[78:79], v[78:79], v[22:23]
v_cvt_pk_bf16_f32 v72, v72, v73
v_cvt_pk_bf16_f32 v73, v74, v75
v_cvt_pk_bf16_f32 v74, v76, v77
v_cvt_pk_bf16_f32 v75, v78, v79
buffer_store_dwordx4 v[72:75], v4, s[52:55], s8 offen offset:1024
v_pk_mul_f32 v[104:105], v[104:105], v[24:25]
v_pk_mul_f32 v[106:107], v[106:107], v[24:25]
v_pk_mul_f32 v[108:109], v[108:109], v[24:25]
v_pk_mul_f32 v[110:111], v[110:111], v[24:25]
v_cvt_pk_bf16_f32 v104, v104, v105
v_cvt_pk_bf16_f32 v105, v106, v107
v_cvt_pk_bf16_f32 v106, v108, v109
v_cvt_pk_bf16_f32 v107, v110, v111
buffer_store_dwordx4 v[104:107], v4, s[52:55], s8 offen offset:2048
v_pk_mul_f32 v[136:137], v[136:137], v[26:27]
v_pk_mul_f32 v[138:139], v[138:139], v[26:27]
v_pk_mul_f32 v[140:141], v[140:141], v[26:27]
v_pk_mul_f32 v[142:143], v[142:143], v[26:27]
v_cvt_pk_bf16_f32 v136, v136, v137
v_cvt_pk_bf16_f32 v137, v138, v139
v_cvt_pk_bf16_f32 v138, v140, v141
v_cvt_pk_bf16_f32 v139, v142, v143
buffer_store_dwordx4 v[136:139], v4, s[52:55], s8 offen offset:3072
s_add_u32 s8, s8, 4096
v_pk_mul_f32 v[48:49], v[48:49], v[20:21]
v_pk_mul_f32 v[50:51], v[50:51], v[20:21]
v_pk_mul_f32 v[52:53], v[52:53], v[20:21]
v_pk_mul_f32 v[54:55], v[54:55], v[20:21]
v_cvt_pk_bf16_f32 v48, v48, v49
v_cvt_pk_bf16_f32 v49, v50, v51
v_cvt_pk_bf16_f32 v50, v52, v53
v_cvt_pk_bf16_f32 v51, v54, v55
buffer_store_dwordx4 v[48:51], v4, s[52:55], s8 offen offset:0
v_pk_mul_f32 v[80:81], v[80:81], v[22:23]
v_pk_mul_f32 v[82:83], v[82:83], v[22:23]
v_pk_mul_f32 v[84:85], v[84:85], v[22:23]
v_pk_mul_f32 v[86:87], v[86:87], v[22:23]
v_cvt_pk_bf16_f32 v80, v80, v81
v_cvt_pk_bf16_f32 v81, v82, v83
v_cvt_pk_bf16_f32 v82, v84, v85
v_cvt_pk_bf16_f32 v83, v86, v87
buffer_store_dwordx4 v[80:83], v4, s[52:55], s8 offen offset:1024
v_pk_mul_f32 v[112:113], v[112:113], v[24:25]
v_pk_mul_f32 v[114:115], v[114:115], v[24:25]
v_pk_mul_f32 v[116:117], v[116:117], v[24:25]
v_pk_mul_f32 v[118:119], v[118:119], v[24:25]
v_cvt_pk_bf16_f32 v112, v112, v113
v_cvt_pk_bf16_f32 v113, v114, v115
v_cvt_pk_bf16_f32 v114, v116, v117
v_cvt_pk_bf16_f32 v115, v118, v119
buffer_store_dwordx4 v[112:115], v4, s[52:55], s8 offen offset:2048
v_pk_mul_f32 v[144:145], v[144:145], v[26:27]
v_pk_mul_f32 v[146:147], v[146:147], v[26:27]
v_pk_mul_f32 v[148:149], v[148:149], v[26:27]
v_pk_mul_f32 v[150:151], v[150:151], v[26:27]
v_cvt_pk_bf16_f32 v144, v144, v145
v_cvt_pk_bf16_f32 v145, v146, v147
v_cvt_pk_bf16_f32 v146, v148, v149
v_cvt_pk_bf16_f32 v147, v150, v151
buffer_store_dwordx4 v[144:147], v4, s[52:55], s8 offen offset:3072
s_add_u32 s8, s8, 4096
v_pk_mul_f32 v[56:57], v[56:57], v[20:21]
v_pk_mul_f32 v[58:59], v[58:59], v[20:21]
v_pk_mul_f32 v[60:61], v[60:61], v[20:21]
v_pk_mul_f32 v[62:63], v[62:63], v[20:21]
v_cvt_pk_bf16_f32 v56, v56, v57
v_cvt_pk_bf16_f32 v57, v58, v59
v_cvt_pk_bf16_f32 v58, v60, v61
v_cvt_pk_bf16_f32 v59, v62, v63
buffer_store_dwordx4 v[56:59], v4, s[52:55], s8 offen offset:0
v_pk_mul_f32 v[88:89], v[88:89], v[22:23]
v_pk_mul_f32 v[90:91], v[90:91], v[22:23]
v_pk_mul_f32 v[92:93], v[92:93], v[22:23]
v_pk_mul_f32 v[94:95], v[94:95], v[22:23]
v_cvt_pk_bf16_f32 v88, v88, v89
v_cvt_pk_bf16_f32 v89, v90, v91
v_cvt_pk_bf16_f32 v90, v92, v93
v_cvt_pk_bf16_f32 v91, v94, v95
buffer_store_dwordx4 v[88:91], v4, s[52:55], s8 offen offset:1024
v_pk_mul_f32 v[120:121], v[120:121], v[24:25]
v_pk_mul_f32 v[122:123], v[122:123], v[24:25]
v_pk_mul_f32 v[124:125], v[124:125], v[24:25]
v_pk_mul_f32 v[126:127], v[126:127], v[24:25]
v_cvt_pk_bf16_f32 v120, v120, v121
v_cvt_pk_bf16_f32 v121, v122, v123
v_cvt_pk_bf16_f32 v122, v124, v125
v_cvt_pk_bf16_f32 v123, v126, v127
buffer_store_dwordx4 v[120:123], v4, s[52:55], s8 offen offset:2048
v_pk_mul_f32 v[152:153], v[152:153], v[26:27]
v_pk_mul_f32 v[154:155], v[154:155], v[26:27]
v_pk_mul_f32 v[156:157], v[156:157], v[26:27]
v_pk_mul_f32 v[158:159], v[158:159], v[26:27]
v_cvt_pk_bf16_f32 v152, v152, v153
v_cvt_pk_bf16_f32 v153, v154, v155
v_cvt_pk_bf16_f32 v154, v156, v157
v_cvt_pk_bf16_f32 v155, v158, v159
buffer_store_dwordx4 v[152:155], v4, s[52:55], s8 offen offset:3072
s_add_u32 s8, s8, 4096
K2_END:
s_endpgm
K2_MD0:
s_cmp_eq_u32 s79, s72
s_cbranch_scc0 K2_MD0_F
v_cndmask_b32 v160, v160, v6, s[84:85]
v_cndmask_b32 v172, v172, v6, s[84:85]
v_mov_b32 v168, v6
v_cndmask_b32 v161, v161, v6, s[86:87]
v_cndmask_b32 v173, v173, v6, s[86:87]
v_mov_b32 v169, v6
v_cndmask_b32 v162, v162, v6, s[88:89]
v_cndmask_b32 v174, v174, v6, s[88:89]
v_mov_b32 v170, v6
v_cndmask_b32 v163, v163, v6, s[90:91]
v_cndmask_b32 v175, v175, v6, s[90:91]
v_mov_b32 v171, v6
s_add_u32 s79, s79, 1
s_branch K2_MD0_R
K2_MD0_F:
v_mov_b32 v160, v6
v_mov_b32 v161, v6
v_mov_b32 v162, v6
v_mov_b32 v163, v6
v_mov_b32 v164, v6
v_mov_b32 v165, v6
v_mov_b32 v166, v6
v_mov_b32 v167, v6
v_mov_b32 v172, v6
v_mov_b32 v173, v6
v_mov_b32 v174, v6
v_mov_b32 v175, v6
s_mov_b32 s79, -1
s_branch K2_MD0_R
K2_MS0:
s_cmp_eq_u32 s80, s73
s_cbranch_scc0 K2_MS0_F
v_cndmask_b32 v176, v176, v6, s[84:85]
v_cndmask_b32 v188, v188, v6, s[84:85]
v_mov_b32 v184, v6
v_cndmask_b32 v177, v177, v6, s[86:87]
v_cndmask_b32 v189, v189, v6, s[86:87]
v_mov_b32 v185, v6
v_cndmask_b32 v178, v178, v6, s[88:89]
v_cndmask_b32 v190, v190, v6, s[88:89]
v_mov_b32 v186, v6
v_cndmask_b32 v179, v179, v6, s[90:91]
v_cndmask_b32 v191, v191, v6, s[90:91]
v_mov_b32 v187, v6
s_add_u32 s80, s80, 1
s_branch K2_MS0_R
K2_MS0_F:
v_mov_b32 v176, v6
v_mov_b32 v177, v6
v_mov_b32 v178, v6
v_mov_b32 v179, v6
v_mov_b32 v180, v6
v_mov_b32 v181, v6
v_mov_b32 v182, v6
v_mov_b32 v183, v6
v_mov_b32 v188, v6
v_mov_b32 v189, v6
v_mov_b32 v190, v6
v_mov_b32 v191, v6
s_mov_b32 s80, -1
s_branch K2_MS0_R
K2_MS1:
s_cmp_eq_u32 s80, s73
s_cbranch_scc0 K2_MS1_F
v_cndmask_b32 v176, v176, v6, s[84:85]
v_cndmask_b32 v188, v188, v6, s[84:85]
v_mov_b32 v184, v6
v_cndmask_b32 v177, v177, v6, s[86:87]
v_cndmask_b32 v189, v189, v6, s[86:87]
v_mov_b32 v185, v6
v_cndmask_b32 v178, v178, v6, s[88:89]
v_cndmask_b32 v190, v190, v6, s[88:89]
v_mov_b32 v186, v6
v_cndmask_b32 v179, v179, v6, s[90:91]
v_cndmask_b32 v191, v191, v6, s[90:91]
v_mov_b32 v187, v6
s_add_u32 s80, s80, 1
s_branch K2_MS1_R
K2_MS1_F:
v_mov_b32 v176, v6
v_mov_b32 v177, v6
v_mov_b32 v178, v6
v_mov_b32 v179, v6
v_mov_b32 v180, v6
v_mov_b32 v181, v6
v_mov_b32 v182, v6
v_mov_b32 v183, v6
v_mov_b32 v188, v6
v_mov_b32 v189, v6
v_mov_b32 v190, v6
v_mov_b32 v191, v6
s_mov_b32 s80, -1
s_branch K2_MS1_R
.globl k3_kernel
.p2align 8
.type k3_kernel,@function
k3_kernel:
s_cmp_ge_u32 s2, 256
s_cbranch_scc1 K3_END
s_load_dwordx16 s[16:31], s[0:1], 0
s_load_dwordx8 s[32:39], s[0:1], 64
s_load_dwordx2 s[40:41], s[0:1], 96
v_lshrrev_b32 v5, 6, v0
v_and_b32 v1, 63, v0
v_readfirstlane_b32 s3, v5
v_and_b32 v2, 15, v0
v_lshrrev_b32 v3, 4, v1
v_lshlrev_b32 v4, 4, v1
s_and_b32 s7, s2, 7
s_lshr_b32 s6, s2, 3
s_and_b32 s4, s6, 3
s_lshl_b32 s8, s7, 2
s_add_u32 s4, s4, s8
s_lshr_b32 s5, s6, 2
s_waitcnt lgkmcnt(0)
s_mov_b32 s52, s40
s_mov_b32 s53, s41
s_mov_b32 s54, 268435456
s_mov_b32 s55, 0x20000
s_lshl_b32 s72, s5, 2
s_add_u32 s72, s72, s3
s_sub_u32 s73, 63, s72
s_lshl_b32 s9, s4, 18
s_add_u32 s9, s9, 45088768
s_lshl_b32 s10, s72, 9
s_add_u32 s10, s10, s9
s_lshl_b32 s11, s73, 9
s_add_u32 s11, s11, s9
s_mul_i32 s8, s3, 10240
s_add_u32 m0, s8, 0
s_add_u32 s64, s10, 65024
buffer_load_dwordx4 v4, s[52:55], s64 offen lds
s_add_u32 m0, s8, 1024
s_add_u32 s64, s10, 97792
buffer_load_dwordx4 v4, s[52:55], s64 offen lds
s_add_u32 m0, s8, 2048
s_add_u32 s64, s10, 130560
buffer_load_dwordx4 v4, s[52:55], s64 offen lds
s_add_u32 m0, s8, 3072
s_add_u32 s64, s10, 163328
buffer_load_dwordx4 v4, s[52:55], s64 offen lds
s_add_u32 m0, s8, 4096
s_add_u32 s64, s10, 196096
buffer_load_dwordx4 v4, s[52:55], s64 offen lds
s_add_u32 m0, s8, 5120
s_add_u32 s64, s11, 65024
buffer_load_dwordx4 v4, s[52:55], s64 offen lds
s_add_u32 m0, s8, 6144
s_add_u32 s64, s11, 97792
buffer_load_dwordx4 v4, s[52:55], s64 offen lds
s_add_u32 m0, s8, 7168
s_add_u32 s64, s11, 130560
buffer_load_dwordx4 v4, s[52:55], s64 offen lds
s_add_u32 m0, s8, 8192
s_add_u32 s64, s11, 163328
buffer_load_dwordx4 v4, s[52:55], s64 offen lds
s_add_u32 m0, s8, 9216
s_add_u32 s64, s11, 196096
buffer_load_dwordx4 v4, s[52:55], s64 offen lds
v_and_b32 v6, 31, v1
v_cmp_lt_u32 vcc, 31, v1
v_mov_b32 v7, s72
v_mov_b32 v8, s73
v_cndmask_b32 v7, v7, v8, vcc
v_lshl_add_u32 v5, v7, 5, v6
v_lshlrev_b32 v7, 4, v5
buffer_load_dwordx4 v[16:19], v7, s[52:55], s9 offen
s_add_u32 s9, s9, 32768
buffer_load_dwordx4 v[20:23], v7, s[52:55], s9 offen
v_lshrrev_b32 v8, 5, v1
v_mul_u32_u24 v8, 5120, v8
v_lshl_add_u32 v8, v6, 4, v8
v_add_u32 v8, s8, v8
s_waitcnt vmcnt(0)
ds_read_b128 v[96:99], v8 offset:4608
ds_read_b128 v[32:35], v8 offset:512
ds_read_b128 v[36:39], v8 offset:1536
ds_read_b128 v[100:103], v8 offset:4576
ds_read_b128 v[40:43], v8 offset:480
ds_read_b128 v[44:47], v8 offset:1504
ds_read_b128 v[104:107], v8 offset:4544
ds_read_b128 v[48:51], v8 offset:448
ds_read_b128 v[52:55], v8 offset:1472
ds_read_b128 v[108:111], v8 offset:4512
ds_read_b128 v[56:59], v8 offset:416
ds_read_b128 v[60:63], v8 offset:1440
s_waitcnt lgkmcnt(0)
ds_read_b128 v[112:115], v8 offset:4480
ds_read_b128 v[64:67], v8 offset:384
ds_read_b128 v[68:71], v8 offset:1408
ds_read_b128 v[116:119], v8 offset:4448
ds_read_b128 v[72:75], v8 offset:352
ds_read_b128 v[76:79], v8 offset:1376
ds_read_b128 v[120:123], v8 offset:4416
ds_read_b128 v[80:83], v8 offset:320
ds_read_b128 v[84:87], v8 offset:1344
ds_read_b128 v[124:127], v8 offset:4384
ds_read_b128 v[88:91], v8 offset:288
ds_read_b128 v[92:95], v8 offset:1312
s_waitcnt lgkmcnt(0)
ds_read_b128 v[128:131], v8 offset:2560
ds_read_b128 v[132:135], v8 offset:3584
ds_read_b128 v[136:139], v8 offset:2528
ds_read_b128 v[140:143], v8 offset:3552
ds_read_b128 v[144:147], v8 offset:2496
ds_read_b128 v[148:151], v8 offset:3520
ds_read_b128 v[152:155], v8 offset:2464
ds_read_b128 v[156:159], v8 offset:3488
s_waitcnt lgkmcnt(0)
ds_read_b128 v[160:163], v8 offset:2432
ds_read_b128 v[164:167], v8 offset:3456
ds_read_b128 v[168:171], v8 offset:2400
ds_read_b128 v[172:175], v8 offset:3424
ds_read_b128 v[176:179], v8 offset:2368
ds_read_b128 v[180:183], v8 offset:3392
ds_read_b128 v[184:187], v8 offset:2336
ds_read_b128 v[188:191], v8 offset:3360
v_dot2_f32_bf16 v24, v96, v97, 0
v_dot2_f32_bf16 v25, v96, v101, 0
v_dot2_f32_bf16 v26, v96, v105, 0
v_dot2_f32_bf16 v27, v96, v109, 0
v_dot2_f32_bf16 v28, v96, v113, 0
v_dot2_f32_bf16 v29, v96, v117, 0
v_dot2_f32_bf16 v30, v96, v121, 0
v_dot2_f32_bf16 v31, v96, v125, 0
v_dot2_f32_bf16 v24, v16, v32, v24
v_dot2_f32_bf16 v25, v16, v40, v25
v_dot2_f32_bf16 v26, v16, v48, v26
v_dot2_f32_bf16 v27, v16, v56, v27
v_dot2_f32_bf16 v28, v16, v64, v28
v_dot2_f32_bf16 v29, v16, v72, v29
v_dot2_f32_bf16 v30, v16, v80, v30
v_dot2_f32_bf16 v31, v16, v88, v31
v_dot2_f32_bf16 v24, v17, v33, v24
v_dot2_f32_bf16 v25, v17, v41, v25
v_dot2_f32_bf16 v26, v17, v49, v26
v_dot2_f32_bf16 v27, v17, v57, v27
v_dot2_f32_bf16 v28, v17, v65, v28
v_dot2_f32_bf16 v29, v17, v73, v29
v_dot2_f32_bf16 v30, v17, v81, v30
v_dot2_f32_bf16 v31, v17, v89, v31
v_dot2_f32_bf16 v24, v18, v34, v24
v_dot2_f32_bf16 v25, v18, v42, v25
v_dot2_f32_bf16 v26, v18, v50, v26
v_dot2_f32_bf16 v27, v18, v58, v27
v_dot2_f32_bf16 v28, v18, v66, v28
v_dot2_f32_bf16 v29, v18, v74, v29
v_dot2_f32_bf16 v30, v18, v82, v30
v_dot2_f32_bf16 v31, v18, v90, v31
v_dot2_f32_bf16 v24, v19, v35, v24
v_dot2_f32_bf16 v25, v19, v43, v25
v_dot2_f32_bf16 v26, v19, v51, v26
v_dot2_f32_bf16 v27, v19, v59, v27
v_dot2_f32_bf16 v28, v19, v67, v28
v_dot2_f32_bf16 v29, v19, v75, v29
v_dot2_f32_bf16 v30, v19, v83, v30
v_dot2_f32_bf16 v31, v19, v91, v31
v_dot2_f32_bf16 v24, v20, v36, v24
v_dot2_f32_bf16 v25, v20, v44, v25
v_dot2_f32_bf16 v26, v20, v52, v26
v_dot2_f32_bf16 v27, v20, v60, v27
v_dot2_f32_bf16 v28, v20, v68, v28
v_dot2_f32_bf16 v29, v20, v76, v29
v_dot2_f32_bf16 v30, v20, v84, v30
v_dot2_f32_bf16 v31, v20, v92, v31
v_dot2_f32_bf16 v24, v21, v37, v24
v_dot2_f32_bf16 v25, v21, v45, v25
v_dot2_f32_bf16 v26, v21, v53, v26
v_dot2_f32_bf16 v27, v21, v61, v27
v_dot2_f32_bf16 v28, v21, v69, v28
v_dot2_f32_bf16 v29, v21, v77, v29
v_dot2_f32_bf16 v30, v21, v85, v30
v_dot2_f32_bf16 v31, v21, v93, v31
v_dot2_f32_bf16 v24, v22, v38, v24
v_dot2_f32_bf16 v25, v22, v46, v25
v_dot2_f32_bf16 v26, v22, v54, v26
v_dot2_f32_bf16 v27, v22, v62, v27
v_dot2_f32_bf16 v28, v22, v70, v28
v_dot2_f32_bf16 v29, v22, v78, v29
v_dot2_f32_bf16 v30, v22, v86, v30
v_dot2_f32_bf16 v31, v22, v94, v31
v_dot2_f32_bf16 v24, v23, v39, v24
v_dot2_f32_bf16 v25, v23, v47, v25
v_dot2_f32_bf16 v26, v23, v55, v26
v_dot2_f32_bf16 v27, v23, v63, v27
v_dot2_f32_bf16 v28, v23, v71, v28
v_dot2_f32_bf16 v29, v23, v79, v29
v_dot2_f32_bf16 v30, v23, v87, v30
v_dot2_f32_bf16 v31, v23, v95, v31
v_mov_b32 v9, 0xf149f2ca
s_nop 2
v_cmp_gt_u32 vcc, 2, v5
s_nop 1
v_cndmask_b32 v25, v25, v9, vcc
v_cmp_gt_u32 vcc, 4, v5
s_nop 1
v_cndmask_b32 v26, v26, v9, vcc
v_cmp_gt_u32 vcc, 6, v5
s_nop 1
v_cndmask_b32 v27, v27, v9, vcc
v_cmp_gt_u32 vcc, 8, v5
s_nop 1
v_cndmask_b32 v28, v28, v9, vcc
v_cmp_gt_u32 vcc, 10, v5
s_nop 1
v_cndmask_b32 v29, v29, v9, vcc
v_cmp_gt_u32 vcc, 12, v5
s_nop 1
v_cndmask_b32 v30, v30, v9, vcc
v_cmp_gt_u32 vcc, 14, v5
s_nop 1
v_cndmask_b32 v31, v31, v9, vcc
v_max3_f32 v10, v24, v25, v26
v_max3_f32 v10, v10, v27, v28
v_max3_f32 v10, v10, v29, v30
v_max_f32 v10, v10, v31
s_mov_b32 s12, 0x3eae1a93
v_sub_f32 v24, v24, v10
v_sub_f32 v25, v25, v10
v_sub_f32 v26, v26, v10
v_sub_f32 v27, v27, v10
v_sub_f32 v28, v28, v10
v_sub_f32 v29, v29, v10
v_sub_f32 v30, v30, v10
v_sub_f32 v31, v31, v10
v_mul_f32 v24, s12, v24
v_mul_f32 v25, s12, v25
v_mul_f32 v26, s12, v26
v_mul_f32 v27, s12, v27
v_mul_f32 v28, s12, v28
v_mul_f32 v29, s12, v29
v_mul_f32 v30, s12, v30
v_mul_f32 v31, s12, v31
v_exp_f32 v24, v24
v_exp_f32 v25, v25
v_exp_f32 v26, v26
v_exp_f32 v27, v27
v_exp_f32 v28, v28
v_exp_f32 v29, v29
v_exp_f32 v30, v30
v_exp_f32 v31, v31
v_lshlrev_b32 v11, 16, v99
v_mul_f32 v11, 0xbfb8aa3b, v11
v_exp_f32 v11, v11
v_cvt_pk_bf16_f32 v32, v24, 0
v_cvt_pk_bf16_f32 v40, v25, 0
v_cvt_pk_bf16_f32 v48, v26, 0
v_cvt_pk_bf16_f32 v56, v27, 0
v_cvt_pk_bf16_f32 v64, v28, 0
v_cvt_pk_bf16_f32 v72, v29, 0
v_cvt_pk_bf16_f32 v80, v30, 0
v_cvt_pk_bf16_f32 v88, v31, 0
v_lshlrev_b32 v33, 16, v32
v_lshlrev_b32 v41, 16, v40
v_lshlrev_b32 v49, 16, v48
v_lshlrev_b32 v57, 16, v56
v_lshlrev_b32 v65, 16, v64
v_lshlrev_b32 v73, 16, v72
v_lshlrev_b32 v81, 16, v80
v_lshlrev_b32 v89, 16, v88
v_add_f32 v11, 1.0, v11
v_add_f32 v10, v33, v41
v_add_f32 v10, v10, v49
v_add_f32 v10, v10, v57
v_add_f32 v10, v10, v65
v_add_f32 v10, v10, v73
v_add_f32 v10, v10, v81
v_add_f32 v10, v10, v89
v_mul_f32 v10, v10, v11
v_rcp_f32 v10, v10
s_waitcnt lgkmcnt(0)
v_dot2_f32_bf16 v192, v128, v32, 0
v_dot2_f32_bf16 v193, v128, v33, 0
v_dot2_f32_bf16 v194, v129, v32, 0
v_dot2_f32_bf16 v195, v129, v33, 0
v_dot2_f32_bf16 v196, v130, v32, 0
v_dot2_f32_bf16 v197, v130, v33, 0
v_dot2_f32_bf16 v198, v131, v32, 0
v_dot2_f32_bf16 v199, v131, v33, 0
v_dot2_f32_bf16 v200, v132, v32, 0
v_dot2_f32_bf16 v201, v132, v33, 0
v_dot2_f32_bf16 v202, v133, v32, 0
v_dot2_f32_bf16 v203, v133, v33, 0
v_dot2_f32_bf16 v204, v134, v32, 0
v_dot2_f32_bf16 v205, v134, v33, 0
v_dot2_f32_bf16 v206, v135, v32, 0
v_dot2_f32_bf16 v207, v135, v33, 0
v_dot2_f32_bf16 v208, v98, v32, 0
v_dot2_f32_bf16 v209, v98, v33, 0
v_dot2_f32_bf16 v192, v136, v40, v192
v_dot2_f32_bf16 v193, v136, v41, v193
v_dot2_f32_bf16 v194, v137, v40, v194
v_dot2_f32_bf16 v195, v137, v41, v195
v_dot2_f32_bf16 v196, v138, v40, v196
v_dot2_f32_bf16 v197, v138, v41, v197
v_dot2_f32_bf16 v198, v139, v40, v198
v_dot2_f32_bf16 v199, v139, v41, v199
v_dot2_f32_bf16 v200, v140, v40, v200
v_dot2_f32_bf16 v201, v140, v41, v201
v_dot2_f32_bf16 v202, v141, v40, v202
v_dot2_f32_bf16 v203, v141, v41, v203
v_dot2_f32_bf16 v204, v142, v40, v204
v_dot2_f32_bf16 v205, v142, v41, v205
v_dot2_f32_bf16 v206, v143, v40, v206
v_dot2_f32_bf16 v207, v143, v41, v207
v_dot2_f32_bf16 v208, v102, v40, v208
v_dot2_f32_bf16 v209, v102, v41, v209
v_dot2_f32_bf16 v192, v144, v48, v192
v_dot2_f32_bf16 v193, v144, v49, v193
v_dot2_f32_bf16 v194, v145, v48, v194
v_dot2_f32_bf16 v195, v145, v49, v195
v_dot2_f32_bf16 v196, v146, v48, v196
v_dot2_f32_bf16 v197, v146, v49, v197
v_dot2_f32_bf16 v198, v147, v48, v198
v_dot2_f32_bf16 v199, v147, v49, v199
v_dot2_f32_bf16 v200, v148, v48, v200
v_dot2_f32_bf16 v201, v148, v49, v201
v_dot2_f32_bf16 v202, v149, v48, v202
v_dot2_f32_bf16 v203, v149, v49, v203
v_dot2_f32_bf16 v204, v150, v48, v204
v_dot2_f32_bf16 v205, v150, v49, v205
v_dot2_f32_bf16 v206, v151, v48, v206
v_dot2_f32_bf16 v207, v151, v49, v207
v_dot2_f32_bf16 v208, v106, v48, v208
v_dot2_f32_bf16 v209, v106, v49, v209
v_dot2_f32_bf16 v192, v152, v56, v192
v_dot2_f32_bf16 v193, v152, v57, v193
v_dot2_f32_bf16 v194, v153, v56, v194
v_dot2_f32_bf16 v195, v153, v57, v195
v_dot2_f32_bf16 v196, v154, v56, v196
v_dot2_f32_bf16 v197, v154, v57, v197
v_dot2_f32_bf16 v198, v155, v56, v198
v_dot2_f32_bf16 v199, v155, v57, v199
v_dot2_f32_bf16 v200, v156, v56, v200
v_dot2_f32_bf16 v201, v156, v57, v201
v_dot2_f32_bf16 v202, v157, v56, v202
v_dot2_f32_bf16 v203, v157, v57, v203
v_dot2_f32_bf16 v204, v158, v56, v204
v_dot2_f32_bf16 v205, v158, v57, v205
v_dot2_f32_bf16 v206, v159, v56, v206
v_dot2_f32_bf16 v207, v159, v57, v207
v_dot2_f32_bf16 v208, v110, v56, v208
v_dot2_f32_bf16 v209, v110, v57, v209
v_dot2_f32_bf16 v192, v160, v64, v192
v_dot2_f32_bf16 v193, v160, v65, v193
v_dot2_f32_bf16 v194, v161, v64, v194
v_dot2_f32_bf16 v195, v161, v65, v195
v_dot2_f32_bf16 v196, v162, v64, v196
v_dot2_f32_bf16 v197, v162, v65, v197
v_dot2_f32_bf16 v198, v163, v64, v198
v_dot2_f32_bf16 v199, v163, v65, v199
v_dot2_f32_bf16 v200, v164, v64, v200
v_dot2_f32_bf16 v201, v164, v65, v201
v_dot2_f32_bf16 v202, v165, v64, v202
v_dot2_f32_bf16 v203, v165, v65, v203
v_dot2_f32_bf16 v204, v166, v64, v204
v_dot2_f32_bf16 v205, v166, v65, v205
v_dot2_f32_bf16 v206, v167, v64, v206
v_dot2_f32_bf16 v207, v167, v65, v207
v_dot2_f32_bf16 v208, v114, v64, v208
v_dot2_f32_bf16 v209, v114, v65, v209
v_dot2_f32_bf16 v192, v168, v72, v192
v_dot2_f32_bf16 v193, v168, v73, v193
v_dot2_f32_bf16 v194, v169, v72, v194
v_dot2_f32_bf16 v195, v169, v73, v195
v_dot2_f32_bf16 v196, v170, v72, v196
v_dot2_f32_bf16 v197, v170, v73, v197
v_dot2_f32_bf16 v198, v171, v72, v198
v_dot2_f32_bf16 v199, v171, v73, v199
v_dot2_f32_bf16 v200, v172, v72, v200
v_dot2_f32_bf16 v201, v172, v73, v201
v_dot2_f32_bf16 v202, v173, v72, v202
v_dot2_f32_bf16 v203, v173, v73, v203
v_dot2_f32_bf16 v204, v174, v72, v204
v_dot2_f32_bf16 v205, v174, v73, v205
v_dot2_f32_bf16 v206, v175, v72, v206
v_dot2_f32_bf16 v207, v175, v73, v207
v_dot2_f32_bf16 v208, v118, v72, v208
v_dot2_f32_bf16 v209, v118, v73, v209
v_dot2_f32_bf16 v192, v176, v80, v192
v_dot2_f32_bf16 v193, v176, v81, v193
v_dot2_f32_bf16 v194, v177, v80, v194
v_dot2_f32_bf16 v195, v177, v81, v195
v_dot2_f32_bf16 v196, v178, v80, v196
v_dot2_f32_bf16 v197, v178, v81, v197
v_dot2_f32_bf16 v198, v179, v80, v198
v_dot2_f32_bf16 v199, v179, v81, v199
v_dot2_f32_bf16 v200, v180, v80, v200
v_dot2_f32_bf16 v201, v180, v81, v201
v_dot2_f32_bf16 v202, v181, v80, v202
v_dot2_f32_bf16 v203, v181, v81, v203
v_dot2_f32_bf16 v204, v182, v80, v204
v_dot2_f32_bf16 v205, v182, v81, v205
v_dot2_f32_bf16 v206, v183, v80, v206
v_dot2_f32_bf16 v207, v183, v81, v207
v_dot2_f32_bf16 v208, v122, v80, v208
v_dot2_f32_bf16 v209, v122, v81, v209
v_dot2_f32_bf16 v192, v184, v88, v192
v_dot2_f32_bf16 v193, v184, v89, v193
v_dot2_f32_bf16 v194, v185, v88, v194
v_dot2_f32_bf16 v195, v185, v89, v195
v_dot2_f32_bf16 v196, v186, v88, v196
v_dot2_f32_bf16 v197, v186, v89, v197
v_dot2_f32_bf16 v198, v187, v88, v198
v_dot2_f32_bf16 v199, v187, v89, v199
v_dot2_f32_bf16 v200, v188, v88, v200
v_dot2_f32_bf16 v201, v188, v89, v201
v_dot2_f32_bf16 v202, v189, v88, v202
v_dot2_f32_bf16 v203, v189, v89, v203
v_dot2_f32_bf16 v204, v190, v88, v204
v_dot2_f32_bf16 v205, v190, v89, v205
v_dot2_f32_bf16 v206, v191, v88, v206
v_dot2_f32_bf16 v207, v191, v89, v207
v_dot2_f32_bf16 v208, v126, v88, v208
v_dot2_f32_bf16 v209, v126, v89, v209
s_nop 2
v_mul_f32 v192, v10, v192
v_mul_f32 v193, v10, v193
v_mul_f32 v194, v10, v194
v_mul_f32 v195, v10, v195
v_mul_f32 v196, v10, v196
v_mul_f32 v197, v10, v197
v_mul_f32 v198, v10, v198
v_mul_f32 v199, v10, v199
v_mul_f32 v200, v10, v200
v_mul_f32 v201, v10, v201
v_mul_f32 v202, v10, v202
v_mul_f32 v203, v10, v203
v_mul_f32 v204, v10, v204
v_mul_f32 v205, v10, v205
v_mul_f32 v206, v10, v206
v_mul_f32 v207, v10, v207
v_mul_f32 v208, v10, v208
v_mul_f32 v209, v10, v209
v_cvt_pk_bf16_f32 v192, v192, v193
v_cvt_pk_bf16_f32 v193, v194, v195
v_cvt_pk_bf16_f32 v194, v196, v197
v_cvt_pk_bf16_f32 v195, v198, v199
v_cvt_pk_bf16_f32 v196, v200, v201
v_cvt_pk_bf16_f32 v197, v202, v203
v_cvt_pk_bf16_f32 v198, v204, v205
v_cvt_pk_bf16_f32 v199, v206, v207
v_cvt_pk_bf16_f32 v200, v208, v209
s_mul_i32 s8, s72, 598016
s_add_u32 s8, s8, 54525952
s_lshr_b32 s9, s4, 1
s_add_u32 s9, s9, 128
s_lshl_b32 s9, s9, 12
s_add_u32 s9, s9, s8
s_and_b32 s10, s4, 1
s_lshl_b32 s10, s10, 9
s_add_u32 s9, s9, s10
v_lshlrev_b32 v7, 10, v3
v_lshl_add_u32 v7, v2, 4, v7
buffer_store_dwordx4 v[192:195], v7, s[52:55], s9 offen
buffer_store_dwordx4 v[196:199], v7, s[52:55], s9 offen offset:256
s_lshr_b32 s9, s4, 4
s_add_u32 s9, s9, 144
s_lshl_b32 s9, s9, 12
s_add_u32 s9, s9, s8
s_bfe_u32 s10, s4, 131074
s_lshl_b32 s10, s10, 8
s_add_u32 s9, s9, s10
s_and_b32 s10, s4, 3
s_lshl_b32 s10, s10, 2
s_add_u32 s9, s9, s10
buffer_store_dword v200, v7, s[52:55], s9 offen
K3_END:
s_endpgm
.globl k4_kernel
.p2align 8
.type k4_kernel,@function
k4_kernel:
s_cmp_ge_u32 s2, 256
s_cbranch_scc1 K4_END
s_load_dwordx16 s[16:31], s[0:1], 0
s_load_dwordx8 s[32:39], s[0:1], 64
s_load_dwordx2 s[40:41], s[0:1], 96
v_lshrrev_b32 v5, 6, v0
v_and_b32 v1, 63, v0
v_readfirstlane_b32 s3, v5
v_and_b32 v2, 15, v0
v_lshrrev_b32 v3, 4, v1
v_lshlrev_b32 v4, 4, v1
s_and_b32 s7, s2, 7
s_lshr_b32 s6, s2, 3
s_and_b32 s4, s6, 3
s_lshl_b32 s8, s7, 2
s_add_u32 s4, s4, s8
s_lshr_b32 s5, s6, 2
s_waitcnt lgkmcnt(0)
s_mov_b32 s52, s40
s_mov_b32 s53, s41
s_mov_b32 s54, 268435456
s_mov_b32 s55, 0x20000
s_mov_b32 s56, s36
s_mov_b32 s57, s37
s_mov_b32 s58, 2359296
s_mov_b32 s59, 0x20000
s_and_b32 s72, s6, 3
s_lshl_b32 s8, s7, 2
s_add_u32 s72, s72, s8
s_lshr_b32 s73, s6, 2
s_mul_i32 s76, s72, 598016
s_add_u32 s76, s76, 54525952
s_mul_i32 s77, s73, 672768
s_add_u32 s77, s77, 38797312
v_add_u32 v5, 4096, v4
v_add_u32 v6, 8192, v4
s_mov_b32 s78, 0
s_lshl_b32 s8, s3, 4
s_add_u32 s8, s8, s78
s_lshl_b32 s9, s78, 2
s_add_u32 s9, s9, s3
s_cmp_lt_u32 s78, 16
s_cselect_b32 s8, s8, s9
s_lshl_b32 s9, s8, 13
s_add_u32 s74, s76, s9
s_mul_i32 s9, s8, 9216
s_add_u32 s75, s77, s9
s_cmp_gt_u32 s8, 72
s_cselect_b32 s74, 2147418112, s74
s_cselect_b32 s75, 2147418112, s75
s_add_u32 s78, s78, 1
buffer_load_dwordx4 a[32:35], v4, s[52:55], s75 offen offset:0
buffer_load_dwordx4 a[0:3], v4, s[52:55], s74 offen offset:0
buffer_load_dwordx4 a[4:7], v4, s[52:55], s74 offen offset:1024
buffer_load_dwordx4 a[8:11], v4, s[52:55], s74 offen offset:2048
buffer_load_dwordx4 a[12:15], v4, s[52:55], s74 offen offset:3072
buffer_load_dwordx4 a[36:39], v4, s[52:55], s75 offen offset:1024
buffer_load_dwordx4 a[40:43], v4, s[52:55], s75 offen offset:2048
buffer_load_dwordx4 a[44:47], v4, s[52:55], s75 offen offset:3072
buffer_load_dwordx4 a[64:67], v6, s[52:55], s75 offen offset:0
buffer_load_dwordx4 a[48:51], v5, s[52:55], s75 offen offset:0
buffer_load_dwordx4 a[16:19], v5, s[52:55], s74 offen offset:0
buffer_load_dwordx4 a[20:23], v5, s[52:55], s74 offen offset:1024
buffer_load_dwordx4 a[24:27], v5, s[52:55], s74 offen offset:2048
buffer_load_dwordx4 a[28:31], v5, s[52:55], s74 offen offset:3072
buffer_load_dwordx4 a[52:55], v5, s[52:55], s75 offen offset:1024
buffer_load_dwordx4 a[56:59], v5, s[52:55], s75 offen offset:2048
buffer_load_dwordx4 a[60:63], v5, s[52:55], s75 offen offset:3072
s_lshl_b32 s8, s3, 4
s_add_u32 s8, s8, s78
s_lshl_b32 s9, s78, 2
s_add_u32 s9, s9, s3
s_cmp_lt_u32 s78, 16
s_cselect_b32 s8, s8, s9
s_lshl_b32 s9, s8, 13
s_add_u32 s74, s76, s9
s_mul_i32 s9, s8, 9216
s_add_u32 s75, s77, s9
s_cmp_gt_u32 s8, 72
s_cselect_b32 s74, 2147418112, s74
s_cselect_b32 s75, 2147418112, s75
s_add_u32 s78, s78, 1
buffer_load_dwordx4 a[100:103], v4, s[52:55], s75 offen offset:0
buffer_load_dwordx4 a[68:71], v4, s[52:55], s74 offen offset:0
buffer_load_dwordx4 a[72:75], v4, s[52:55], s74 offen offset:1024
buffer_load_dwordx4 a[76:79], v4, s[52:55], s74 offen offset:2048
buffer_load_dwordx4 a[80:83], v4, s[52:55], s74 offen offset:3072
buffer_load_dwordx4 a[104:107], v4, s[52:55], s75 offen offset:1024
buffer_load_dwordx4 a[108:111], v4, s[52:55], s75 offen offset:2048
buffer_load_dwordx4 a[112:115], v4, s[52:55], s75 offen offset:3072
buffer_load_dwordx4 a[132:135], v6, s[52:55], s75 offen offset:0
buffer_load_dwordx4 a[116:119], v5, s[52:55], s75 offen offset:0
buffer_load_dwordx4 a[84:87], v5, s[52:55], s74 offen offset:0
buffer_load_dwordx4 a[88:91], v5, s[52:55], s74 offen offset:1024
buffer_load_dwordx4 a[92:95], v5, s[52:55], s74 offen offset:2048
buffer_load_dwordx4 a[96:99], v5, s[52:55], s74 offen offset:3072
buffer_load_dwordx4 a[120:123], v5, s[52:55], s75 offen offset:1024
buffer_load_dwordx4 a[124:127], v5, s[52:55], s75 offen offset:2048
buffer_load_dwordx4 a[128:131], v5, s[52:55], s75 offen offset:3072
v_mov_b32 v32, 0
v_mov_b32 v33, 0
v_mov_b32 v34, 0
v_mov_b32 v35, 0
v_mov_b32 v36, 0
v_mov_b32 v37, 0
v_mov_b32 v38, 0
v_mov_b32 v39, 0
v_mov_b32 v40, 0
v_mov_b32 v41, 0
v_mov_b32 v42, 0
v_mov_b32 v43, 0
v_mov_b32 v44, 0
v_mov_b32 v45, 0
v_mov_b32 v46, 0
v_mov_b32 v47, 0
v_mov_b32 v48, 0
v_mov_b32 v49, 0
v_mov_b32 v50, 0
v_mov_b32 v51, 0
v_mov_b32 v52, 0
v_mov_b32 v53, 0
v_mov_b32 v54, 0
v_mov_b32 v55, 0
v_mov_b32 v56, 0
v_mov_b32 v57, 0
v_mov_b32 v58, 0
v_mov_b32 v59, 0
v_mov_b32 v60, 0
v_mov_b32 v61, 0
v_mov_b32 v62, 0
v_mov_b32 v63, 0
v_mov_b32 v64, 0
v_mov_b32 v65, 0
v_mov_b32 v66, 0
v_mov_b32 v67, 0
v_mov_b32 v68, 0
v_mov_b32 v69, 0
v_mov_b32 v70, 0
v_mov_b32 v71, 0
v_mov_b32 v72, 0
v_mov_b32 v73, 0
v_mov_b32 v74, 0
v_mov_b32 v75, 0
v_mov_b32 v76, 0
v_mov_b32 v77, 0
v_mov_b32 v78, 0
v_mov_b32 v79, 0
v_mov_b32 v80, 0
v_mov_b32 v81, 0
v_mov_b32 v82, 0
v_mov_b32 v83, 0
v_mov_b32 v84, 0
v_mov_b32 v85, 0
v_mov_b32 v86, 0
v_mov_b32 v87, 0
v_mov_b32 v88, 0
v_mov_b32 v89, 0
v_mov_b32 v90, 0
v_mov_b32 v91, 0
v_mov_b32 v92, 0
v_mov_b32 v93, 0
v_mov_b32 v94, 0
v_mov_b32 v95, 0
v_mov_b32 v96, 0
v_mov_b32 v97, 0
v_mov_b32 v98, 0
v_mov_b32 v99, 0
v_mov_b32 v100, 0
v_mov_b32 v101, 0
v_mov_b32 v102, 0
v_mov_b32 v103, 0
v_mov_b32 v104, 0
v_mov_b32 v105, 0
v_mov_b32 v106, 0
v_mov_b32 v107, 0
v_mov_b32 v108, 0
v_mov_b32 v109, 0
v_mov_b32 v110, 0
v_mov_b32 v111, 0
v_mov_b32 v112, 0
v_mov_b32 v113, 0
v_mov_b32 v114, 0
v_mov_b32 v115, 0
v_mov_b32 v116, 0
v_mov_b32 v117, 0
v_mov_b32 v118, 0
v_mov_b32 v119, 0
v_mov_b32 v120, 0
v_mov_b32 v121, 0
v_mov_b32 v122, 0
v_mov_b32 v123, 0
v_mov_b32 v124, 0
v_mov_b32 v125, 0
v_mov_b32 v126, 0
v_mov_b32 v127, 0
s_lshl_b32 s8, s3, 4
s_add_u32 s8, s8, s78
s_lshl_b32 s9, s78, 2
s_add_u32 s9, s9, s3
s_cmp_lt_u32 s78, 16
s_cselect_b32 s8, s8, s9
s_lshl_b32 s9, s8, 13
s_add_u32 s74, s76, s9
s_mul_i32 s9, s8, 9216
s_add_u32 s75, s77, s9
s_cmp_gt_u32 s8, 72
s_cselect_b32 s74, 2147418112, s74
s_cselect_b32 s75, 2147418112, s75
s_add_u32 s78, s78, 1
K4_LOOP:
s_waitcnt vmcnt(17)
v_mfma_f32_16x16x32_bf16 v[32:35], a[32:35], a[0:3], v[32:35]
buffer_load_dwordx4 a[168:171], v4, s[52:55], s75 offen offset:0
v_mfma_f32_16x16x32_bf16 v[56:59], a[32:35], a[4:7], v[56:59]
v_mfma_f32_16x16x32_bf16 v[80:83], a[32:35], a[8:11], v[80:83]
buffer_load_dwordx4 a[136:139], v4, s[52:55], s74 offen offset:0
v_mfma_f32_16x16x32_bf16 v[104:107], a[32:35], a[12:15], v[104:107]
v_mfma_f32_16x16x32_bf16 v[36:39], a[36:39], a[0:3], v[36:39]
buffer_load_dwordx4 a[140:143], v4, s[52:55], s74 offen offset:1024
v_mfma_f32_16x16x32_bf16 v[60:63], a[36:39], a[4:7], v[60:63]
v_mfma_f32_16x16x32_bf16 v[84:87], a[36:39], a[8:11], v[84:87]
buffer_load_dwordx4 a[144:147], v4, s[52:55], s74 offen offset:2048
v_mfma_f32_16x16x32_bf16 v[108:111], a[36:39], a[12:15], v[108:111]
v_mfma_f32_16x16x32_bf16 v[40:43], a[40:43], a[0:3], v[40:43]
buffer_load_dwordx4 a[148:151], v4, s[52:55], s74 offen offset:3072
v_mfma_f32_16x16x32_bf16 v[64:67], a[40:43], a[4:7], v[64:67]
v_mfma_f32_16x16x32_bf16 v[88:91], a[40:43], a[8:11], v[88:91]
buffer_load_dwordx4 a[172:175], v4, s[52:55], s75 offen offset:1024
v_mfma_f32_16x16x32_bf16 v[112:115], a[40:43], a[12:15], v[112:115]
v_mfma_f32_16x16x32_bf16 v[44:47], a[44:47], a[0:3], v[44:47]
buffer_load_dwordx4 a[176:179], v4, s[52:55], s75 offen offset:2048
v_mfma_f32_16x16x32_bf16 v[68:71], a[44:47], a[4:7], v[68:71]
v_mfma_f32_16x16x32_bf16 v[92:95], a[44:47], a[8:11], v[92:95]
buffer_load_dwordx4 a[180:183], v4, s[52:55], s75 offen offset:3072
v_mfma_f32_16x16x32_bf16 v[116:119], a[44:47], a[12:15], v[116:119]
v_mfma_f32_16x16x32_bf16 v[48:51], a[64:67], a[0:3], v[48:51]
buffer_load_dwordx4 a[200:203], v6, s[52:55], s75 offen offset:0
v_mfma_f32_16x16x32_bf16 v[72:75], a[64:67], a[4:7], v[72:75]
v_mfma_f32_16x16x32_bf16 v[96:99], a[64:67], a[8:11], v[96:99]
buffer_load_dwordx4 a[184:187], v5, s[52:55], s75 offen offset:0
v_mfma_f32_16x16x32_bf16 v[120:123], a[64:67], a[12:15], v[120:123]
v_mfma_f32_16x16x32_bf16 v[32:35], a[48:51], a[16:19], v[32:35]
buffer_load_dwordx4 a[152:155], v5, s[52:55], s74 offen offset:0
v_mfma_f32_16x16x32_bf16 v[56:59], a[48:51], a[20:23], v[56:59]
v_mfma_f32_16x16x32_bf16 v[80:83], a[48:51], a[24:27], v[80:83]
buffer_load_dwordx4 a[156:159], v5, s[52:55], s74 offen offset:1024
v_mfma_f32_16x16x32_bf16 v[104:107], a[48:51], a[28:31], v[104:107]
v_mfma_f32_16x16x32_bf16 v[36:39], a[52:55], a[16:19], v[36:39]
buffer_load_dwordx4 a[160:163], v5, s[52:55], s74 offen offset:2048
v_mfma_f32_16x16x32_bf16 v[60:63], a[52:55], a[20:23], v[60:63]
v_mfma_f32_16x16x32_bf16 v[84:87], a[52:55], a[24:27], v[84:87]
buffer_load_dwordx4 a[164:167], v5, s[52:55], s74 offen offset:3072
v_mfma_f32_16x16x32_bf16 v[108:111], a[52:55], a[28:31], v[108:111]
v_mfma_f32_16x16x32_bf16 v[40:43], a[56:59], a[16:19], v[40:43]
buffer_load_dwordx4 a[188:191], v5, s[52:55], s75 offen offset:1024
v_mfma_f32_16x16x32_bf16 v[64:67], a[56:59], a[20:23], v[64:67]
v_mfma_f32_16x16x32_bf16 v[88:91], a[56:59], a[24:27], v[88:91]
buffer_load_dwordx4 a[192:195], v5, s[52:55], s75 offen offset:2048
v_mfma_f32_16x16x32_bf16 v[112:115], a[56:59], a[28:31], v[112:115]
v_mfma_f32_16x16x32_bf16 v[44:47], a[60:63], a[16:19], v[44:47]
buffer_load_dwordx4 a[196:199], v5, s[52:55], s75 offen offset:3072
v_mfma_f32_16x16x32_bf16 v[68:71], a[60:63], a[20:23], v[68:71]
s_lshl_b32 s8, s3, 4
s_add_u32 s8, s8, s78
v_mfma_f32_16x16x32_bf16 v[92:95], a[60:63], a[24:27], v[92:95]
s_lshl_b32 s9, s78, 2
s_add_u32 s9, s9, s3
v_mfma_f32_16x16x32_bf16 v[116:119], a[60:63], a[28:31], v[116:119]
s_cmp_lt_u32 s78, 16
s_cselect_b32 s8, s8, s9
v_mfma_f32_16x16x32_bf16 v[52:55], a[64:67], a[16:19], v[52:55]
s_lshl_b32 s9, s8, 13
s_add_u32 s74, s76, s9
v_mfma_f32_16x16x32_bf16 v[76:79], a[64:67], a[20:23], v[76:79]
s_mul_i32 s9, s8, 9216
s_add_u32 s75, s77, s9
v_mfma_f32_16x16x32_bf16 v[100:103], a[64:67], a[24:27], v[100:103]
s_cmp_gt_u32 s8, 72
s_cselect_b32 s74, 2147418112, s74
v_mfma_f32_16x16x32_bf16 v[124:127], a[64:67], a[28:31], v[124:127]
s_cselect_b32 s75, 2147418112, s75
s_add_u32 s78, s78, 1
s_waitcnt vmcnt(17)
v_mfma_f32_16x16x32_bf16 v[32:35], a[100:103], a[68:71], v[32:35]
buffer_load_dwordx4 a[32:35], v4, s[52:55], s75 offen offset:0
v_mfma_f32_16x16x32_bf16 v[56:59], a[100:103], a[72:75], v[56:59]
v_mfma_f32_16x16x32_bf16 v[80:83], a[100:103], a[76:79], v[80:83]
buffer_load_dwordx4 a[0:3], v4, s[52:55], s74 offen offset:0
v_mfma_f32_16x16x32_bf16 v[104:107], a[100:103], a[80:83], v[104:107]
v_mfma_f32_16x16x32_bf16 v[36:39], a[104:107], a[68:71], v[36:39]
buffer_load_dwordx4 a[4:7], v4, s[52:55], s74 offen offset:1024
v_mfma_f32_16x16x32_bf16 v[60:63], a[104:107], a[72:75], v[60:63]
v_mfma_f32_16x16x32_bf16 v[84:87], a[104:107], a[76:79], v[84:87]
buffer_load_dwordx4 a[8:11], v4, s[52:55], s74 offen offset:2048
v_mfma_f32_16x16x32_bf16 v[108:111], a[104:107], a[80:83], v[108:111]
v_mfma_f32_16x16x32_bf16 v[40:43], a[108:111], a[68:71], v[40:43]
buffer_load_dwordx4 a[12:15], v4, s[52:55], s74 offen offset:3072
v_mfma_f32_16x16x32_bf16 v[64:67], a[108:111], a[72:75], v[64:67]
v_mfma_f32_16x16x32_bf16 v[88:91], a[108:111], a[76:79], v[88:91]
buffer_load_dwordx4 a[36:39], v4, s[52:55], s75 offen offset:1024
v_mfma_f32_16x16x32_bf16 v[112:115], a[108:111], a[80:83], v[112:115]
v_mfma_f32_16x16x32_bf16 v[44:47], a[112:115], a[68:71], v[44:47]
buffer_load_dwordx4 a[40:43], v4, s[52:55], s75 offen offset:2048
v_mfma_f32_16x16x32_bf16 v[68:71], a[112:115], a[72:75], v[68:71]
v_mfma_f32_16x16x32_bf16 v[92:95], a[112:115], a[76:79], v[92:95]
buffer_load_dwordx4 a[44:47], v4, s[52:55], s75 offen offset:3072
v_mfma_f32_16x16x32_bf16 v[116:119], a[112:115], a[80:83], v[116:119]
v_mfma_f32_16x16x32_bf16 v[48:51], a[132:135], a[68:71], v[48:51]
buffer_load_dwordx4 a[64:67], v6, s[52:55], s75 offen offset:0
v_mfma_f32_16x16x32_bf16 v[72:75], a[132:135], a[72:75], v[72:75]
v_mfma_f32_16x16x32_bf16 v[96:99], a[132:135], a[76:79], v[96:99]
buffer_load_dwordx4 a[48:51], v5, s[52:55], s75 offen offset:0
v_mfma_f32_16x16x32_bf16 v[120:123], a[132:135], a[80:83], v[120:123]
v_mfma_f32_16x16x32_bf16 v[32:35], a[116:119], a[84:87], v[32:35]
buffer_load_dwordx4 a[16:19], v5, s[52:55], s74 offen offset:0
v_mfma_f32_16x16x32_bf16 v[56:59], a[116:119], a[88:91], v[56:59]
v_mfma_f32_16x16x32_bf16 v[80:83], a[116:119], a[92:95], v[80:83]
buffer_load_dwordx4 a[20:23], v5, s[52:55], s74 offen offset:1024
v_mfma_f32_16x16x32_bf16 v[104:107], a[116:119], a[96:99], v[104:107]
v_mfma_f32_16x16x32_bf16 v[36:39], a[120:123], a[84:87], v[36:39]
buffer_load_dwordx4 a[24:27], v5, s[52:55], s74 offen offset:2048
v_mfma_f32_16x16x32_bf16 v[60:63], a[120:123], a[88:91], v[60:63]
v_mfma_f32_16x16x32_bf16 v[84:87], a[120:123], a[92:95], v[84:87]
buffer_load_dwordx4 a[28:31], v5, s[52:55], s74 offen offset:3072
v_mfma_f32_16x16x32_bf16 v[108:111], a[120:123], a[96:99], v[108:111]
v_mfma_f32_16x16x32_bf16 v[40:43], a[124:127], a[84:87], v[40:43]
buffer_load_dwordx4 a[52:55], v5, s[52:55], s75 offen offset:1024
v_mfma_f32_16x16x32_bf16 v[64:67], a[124:127], a[88:91], v[64:67]
v_mfma_f32_16x16x32_bf16 v[88:91], a[124:127], a[92:95], v[88:91]
buffer_load_dwordx4 a[56:59], v5, s[52:55], s75 offen offset:2048
v_mfma_f32_16x16x32_bf16 v[112:115], a[124:127], a[96:99], v[112:115]
v_mfma_f32_16x16x32_bf16 v[44:47], a[128:131], a[84:87], v[44:47]
buffer_load_dwordx4 a[60:63], v5, s[52:55], s75 offen offset:3072
v_mfma_f32_16x16x32_bf16 v[68:71], a[128:131], a[88:91], v[68:71]
s_lshl_b32 s8, s3, 4
s_add_u32 s8, s8, s78
v_mfma_f32_16x16x32_bf16 v[92:95], a[128:131], a[92:95], v[92:95]
s_lshl_b32 s9, s78, 2
s_add_u32 s9, s9, s3
v_mfma_f32_16x16x32_bf16 v[116:119], a[128:131], a[96:99], v[116:119]
s_cmp_lt_u32 s78, 16
s_cselect_b32 s8, s8, s9
v_mfma_f32_16x16x32_bf16 v[52:55], a[132:135], a[84:87], v[52:55]
s_lshl_b32 s9, s8, 13
s_add_u32 s74, s76, s9
v_mfma_f32_16x16x32_bf16 v[76:79], a[132:135], a[88:91], v[76:79]
s_mul_i32 s9, s8, 9216
s_add_u32 s75, s77, s9
v_mfma_f32_16x16x32_bf16 v[100:103], a[132:135], a[92:95], v[100:103]
s_cmp_gt_u32 s8, 72
s_cselect_b32 s74, 2147418112, s74
v_mfma_f32_16x16x32_bf16 v[124:127], a[132:135], a[96:99], v[124:127]
s_cselect_b32 s75, 2147418112, s75
s_add_u32 s78, s78, 1
s_waitcnt vmcnt(17)
v_mfma_f32_16x16x32_bf16 v[32:35], a[168:171], a[136:139], v[32:35]
buffer_load_dwordx4 a[100:103], v4, s[52:55], s75 offen offset:0
v_mfma_f32_16x16x32_bf16 v[56:59], a[168:171], a[140:143], v[56:59]
v_mfma_f32_16x16x32_bf16 v[80:83], a[168:171], a[144:147], v[80:83]
buffer_load_dwordx4 a[68:71], v4, s[52:55], s74 offen offset:0
v_mfma_f32_16x16x32_bf16 v[104:107], a[168:171], a[148:151], v[104:107]
v_mfma_f32_16x16x32_bf16 v[36:39], a[172:175], a[136:139], v[36:39]
buffer_load_dwordx4 a[72:75], v4, s[52:55], s74 offen offset:1024
v_mfma_f32_16x16x32_bf16 v[60:63], a[172:175], a[140:143], v[60:63]
v_mfma_f32_16x16x32_bf16 v[84:87], a[172:175], a[144:147], v[84:87]
buffer_load_dwordx4 a[76:79], v4, s[52:55], s74 offen offset:2048
v_mfma_f32_16x16x32_bf16 v[108:111], a[172:175], a[148:151], v[108:111]
v_mfma_f32_16x16x32_bf16 v[40:43], a[176:179], a[136:139], v[40:43]
buffer_load_dwordx4 a[80:83], v4, s[52:55], s74 offen offset:3072
v_mfma_f32_16x16x32_bf16 v[64:67], a[176:179], a[140:143], v[64:67]
v_mfma_f32_16x16x32_bf16 v[88:91], a[176:179], a[144:147], v[88:91]
buffer_load_dwordx4 a[104:107], v4, s[52:55], s75 offen offset:1024
v_mfma_f32_16x16x32_bf16 v[112:115], a[176:179], a[148:151], v[112:115]
v_mfma_f32_16x16x32_bf16 v[44:47], a[180:183], a[136:139], v[44:47]
buffer_load_dwordx4 a[108:111], v4, s[52:55], s75 offen offset:2048
v_mfma_f32_16x16x32_bf16 v[68:71], a[180:183], a[140:143], v[68:71]
v_mfma_f32_16x16x32_bf16 v[92:95], a[180:183], a[144:147], v[92:95]
buffer_load_dwordx4 a[112:115], v4, s[52:55], s75 offen offset:3072
v_mfma_f32_16x16x32_bf16 v[116:119], a[180:183], a[148:151], v[116:119]
v_mfma_f32_16x16x32_bf16 v[48:51], a[200:203], a[136:139], v[48:51]
buffer_load_dwordx4 a[132:135], v6, s[52:55], s75 offen offset:0
v_mfma_f32_16x16x32_bf16 v[72:75], a[200:203], a[140:143], v[72:75]
v_mfma_f32_16x16x32_bf16 v[96:99], a[200:203], a[144:147], v[96:99]
buffer_load_dwordx4 a[116:119], v5, s[52:55], s75 offen offset:0
v_mfma_f32_16x16x32_bf16 v[120:123], a[200:203], a[148:151], v[120:123]
v_mfma_f32_16x16x32_bf16 v[32:35], a[184:187], a[152:155], v[32:35]
buffer_load_dwordx4 a[84:87], v5, s[52:55], s74 offen offset:0
v_mfma_f32_16x16x32_bf16 v[56:59], a[184:187], a[156:159], v[56:59]
v_mfma_f32_16x16x32_bf16 v[80:83], a[184:187], a[160:163], v[80:83]
buffer_load_dwordx4 a[88:91], v5, s[52:55], s74 offen offset:1024
v_mfma_f32_16x16x32_bf16 v[104:107], a[184:187], a[164:167], v[104:107]
v_mfma_f32_16x16x32_bf16 v[36:39], a[188:191], a[152:155], v[36:39]
buffer_load_dwordx4 a[92:95], v5, s[52:55], s74 offen offset:2048
v_mfma_f32_16x16x32_bf16 v[60:63], a[188:191], a[156:159], v[60:63]
v_mfma_f32_16x16x32_bf16 v[84:87], a[188:191], a[160:163], v[84:87]
buffer_load_dwordx4 a[96:99], v5, s[52:55], s74 offen offset:3072
v_mfma_f32_16x16x32_bf16 v[108:111], a[188:191], a[164:167], v[108:111]
v_mfma_f32_16x16x32_bf16 v[40:43], a[192:195], a[152:155], v[40:43]
buffer_load_dwordx4 a[120:123], v5, s[52:55], s75 offen offset:1024
v_mfma_f32_16x16x32_bf16 v[64:67], a[192:195], a[156:159], v[64:67]
v_mfma_f32_16x16x32_bf16 v[88:91], a[192:195], a[160:163], v[88:91]
buffer_load_dwordx4 a[124:127], v5, s[52:55], s75 offen offset:2048
v_mfma_f32_16x16x32_bf16 v[112:115], a[192:195], a[164:167], v[112:115]
v_mfma_f32_16x16x32_bf16 v[44:47], a[196:199], a[152:155], v[44:47]
buffer_load_dwordx4 a[128:131], v5, s[52:55], s75 offen offset:3072
v_mfma_f32_16x16x32_bf16 v[68:71], a[196:199], a[156:159], v[68:71]
s_lshl_b32 s8, s3, 4
s_add_u32 s8, s8, s78
v_mfma_f32_16x16x32_bf16 v[92:95], a[196:199], a[160:163], v[92:95]
s_lshl_b32 s9, s78, 2
s_add_u32 s9, s9, s3
v_mfma_f32_16x16x32_bf16 v[116:119], a[196:199], a[164:167], v[116:119]
s_cmp_lt_u32 s78, 16
s_cselect_b32 s8, s8, s9
v_mfma_f32_16x16x32_bf16 v[52:55], a[200:203], a[152:155], v[52:55]
s_lshl_b32 s9, s8, 13
s_add_u32 s74, s76, s9
v_mfma_f32_16x16x32_bf16 v[76:79], a[200:203], a[156:159], v[76:79]
s_mul_i32 s9, s8, 9216
s_add_u32 s75, s77, s9
v_mfma_f32_16x16x32_bf16 v[100:103], a[200:203], a[160:163], v[100:103]
s_cmp_gt_u32 s8, 72
s_cselect_b32 s74, 2147418112, s74
v_mfma_f32_16x16x32_bf16 v[124:127], a[200:203], a[164:167], v[124:127]
s_cselect_b32 s75, 2147418112, s75
s_add_u32 s78, s78, 1
s_cmp_lt_u32 s78, 21
s_cbranch_scc1 K4_LOOP
s_cmp_lg_u32 s3, 0
s_cbranch_scc1 K4_RED
s_waitcnt vmcnt(17)
v_mfma_f32_16x16x32_bf16 v[32:35], a[32:35], a[0:3], v[32:35]
v_mfma_f32_16x16x32_bf16 v[56:59], a[32:35], a[4:7], v[56:59]
v_mfma_f32_16x16x32_bf16 v[80:83], a[32:35], a[8:11], v[80:83]
v_mfma_f32_16x16x32_bf16 v[104:107], a[32:35], a[12:15], v[104:107]
v_mfma_f32_16x16x32_bf16 v[36:39], a[36:39], a[0:3], v[36:39]
v_mfma_f32_16x16x32_bf16 v[60:63], a[36:39], a[4:7], v[60:63]
v_mfma_f32_16x16x32_bf16 v[84:87], a[36:39], a[8:11], v[84:87]
v_mfma_f32_16x16x32_bf16 v[108:111], a[36:39], a[12:15], v[108:111]
v_mfma_f32_16x16x32_bf16 v[40:43], a[40:43], a[0:3], v[40:43]
v_mfma_f32_16x16x32_bf16 v[64:67], a[40:43], a[4:7], v[64:67]
v_mfma_f32_16x16x32_bf16 v[88:91], a[40:43], a[8:11], v[88:91]
v_mfma_f32_16x16x32_bf16 v[112:115], a[40:43], a[12:15], v[112:115]
v_mfma_f32_16x16x32_bf16 v[44:47], a[44:47], a[0:3], v[44:47]
v_mfma_f32_16x16x32_bf16 v[68:71], a[44:47], a[4:7], v[68:71]
v_mfma_f32_16x16x32_bf16 v[92:95], a[44:47], a[8:11], v[92:95]
v_mfma_f32_16x16x32_bf16 v[116:119], a[44:47], a[12:15], v[116:119]
v_mfma_f32_16x16x32_bf16 v[48:51], a[64:67], a[0:3], v[48:51]
v_mfma_f32_16x16x32_bf16 v[72:75], a[64:67], a[4:7], v[72:75]
v_mfma_f32_16x16x32_bf16 v[96:99], a[64:67], a[8:11], v[96:99]
v_mfma_f32_16x16x32_bf16 v[120:123], a[64:67], a[12:15], v[120:123]
v_mfma_f32_16x16x32_bf16 v[32:35], a[48:51], a[16:19], v[32:35]
v_mfma_f32_16x16x32_bf16 v[56:59], a[48:51], a[20:23], v[56:59]
v_mfma_f32_16x16x32_bf16 v[80:83], a[48:51], a[24:27], v[80:83]
v_mfma_f32_16x16x32_bf16 v[104:107], a[48:51], a[28:31], v[104:107]
v_mfma_f32_16x16x32_bf16 v[36:39], a[52:55], a[16:19], v[36:39]
v_mfma_f32_16x16x32_bf16 v[60:63], a[52:55], a[20:23], v[60:63]
v_mfma_f32_16x16x32_bf16 v[84:87], a[52:55], a[24:27], v[84:87]
v_mfma_f32_16x16x32_bf16 v[108:111], a[52:55], a[28:31], v[108:111]
v_mfma_f32_16x16x32_bf16 v[40:43], a[56:59], a[16:19], v[40:43]
v_mfma_f32_16x16x32_bf16 v[64:67], a[56:59], a[20:23], v[64:67]
v_mfma_f32_16x16x32_bf16 v[88:91], a[56:59], a[24:27], v[88:91]
v_mfma_f32_16x16x32_bf16 v[112:115], a[56:59], a[28:31], v[112:115]
v_mfma_f32_16x16x32_bf16 v[44:47], a[60:63], a[16:19], v[44:47]
v_mfma_f32_16x16x32_bf16 v[68:71], a[60:63], a[20:23], v[68:71]
v_mfma_f32_16x16x32_bf16 v[92:95], a[60:63], a[24:27], v[92:95]
v_mfma_f32_16x16x32_bf16 v[116:119], a[60:63], a[28:31], v[116:119]
v_mfma_f32_16x16x32_bf16 v[52:55], a[64:67], a[16:19], v[52:55]
v_mfma_f32_16x16x32_bf16 v[76:79], a[64:67], a[20:23], v[76:79]
v_mfma_f32_16x16x32_bf16 v[100:103], a[64:67], a[24:27], v[100:103]
v_mfma_f32_16x16x32_bf16 v[124:127], a[64:67], a[28:31], v[124:127]
K4_RED:
s_waitcnt vmcnt(0)
v_cmp_lt_u32 vcc, 31, v1
s_mul_i32 s8, s3, 20480
v_add_u32 v5, s8, v4
s_mul_i32 s8, s3, 5120
v_add_u32 v6, s8, v4
s_nop 3
v_cndmask_b32 v48, v48, v52, vcc
v_cndmask_b32 v49, v49, v53, vcc
v_cndmask_b32 v50, v50, v54, vcc
v_cndmask_b32 v51, v51, v55, vcc
v_cndmask_b32 v72, v72, v76, vcc
v_cndmask_b32 v73, v73, v77, vcc
v_cndmask_b32 v74, v74, v78, vcc
v_cndmask_b32 v75, v75, v79, vcc
v_cndmask_b32 v96, v96, v100, vcc
v_cndmask_b32 v97, v97, v101, vcc
v_cndmask_b32 v98, v98, v102, vcc
v_cndmask_b32 v99, v99, v103, vcc
v_cndmask_b32 v120, v120, v124, vcc
v_cndmask_b32 v121, v121, v125, vcc
v_cndmask_b32 v122, v122, v126, vcc
v_cndmask_b32 v123, v123, v127, vcc
ds_write_b128 v5, v[32:35] offset:0
ds_write_b128 v5, v[36:39] offset:1024
ds_write_b128 v5, v[40:43] offset:2048
ds_write_b128 v5, v[44:47] offset:3072
ds_write_b128 v5, v[48:51] offset:4096
ds_write_b128 v5, v[56:59] offset:5120
ds_write_b128 v5, v[60:63] offset:6144
ds_write_b128 v5, v[64:67] offset:7168
ds_write_b128 v5, v[68:71] offset:8192
ds_write_b128 v5, v[72:75] offset:9216
ds_write_b128 v5, v[80:83] offset:10240
ds_write_b128 v5, v[84:87] offset:11264
ds_write_b128 v5, v[88:91] offset:12288
ds_write_b128 v5, v[92:95] offset:13312
ds_write_b128 v5, v[96:99] offset:14336
ds_write_b128 v5, v[104:107] offset:15360
ds_write_b128 v5, v[108:111] offset:16384
ds_write_b128 v5, v[112:115] offset:17408
ds_write_b128 v5, v[116:119] offset:18432
ds_write_b128 v5, v[120:123] offset:19456
s_waitcnt lgkmcnt(0)
s_barrier
v_add_u32 v7, 40960, v6
ds_read_b128 v[32:35], v6 offset:0
ds_read_b128 v[36:39], v6 offset:1024
ds_read_b128 v[40:43], v6 offset:2048
ds_read_b128 v[44:47], v6 offset:3072
ds_read_b128 v[48:51], v6 offset:4096
ds_read_b128 v[52:55], v6 offset:20480
ds_read_b128 v[56:59], v6 offset:21504
ds_read_b128 v[60:63], v6 offset:22528
ds_read_b128 v[64:67], v6 offset:23552
ds_read_b128 v[68:71], v6 offset:24576
s_waitcnt lgkmcnt(0)
ds_read_b128 v[72:75], v7 offset:0
ds_read_b128 v[76:79], v7 offset:1024
ds_read_b128 v[80:83], v7 offset:2048
ds_read_b128 v[84:87], v7 offset:3072
ds_read_b128 v[88:91], v7 offset:4096
ds_read_b128 v[92:95], v7 offset:20480
ds_read_b128 v[96:99], v7 offset:21504
ds_read_b128 v[100:103], v7 offset:22528
ds_read_b128 v[104:107], v7 offset:23552
ds_read_b128 v[108:111], v7 offset:24576
s_sub_u32 s8, 63, s72
s_cmp_lt_u32 s3, 2
s_cselect_b32 s8, s72, s8
s_lshl_b32 s8, s8, 5
s_and_b32 s9, s3, 1
s_lshl_b32 s9, s9, 4
s_add_u32 s8, s8, s9
s_mul_i32 s8, s8, 1152
s_mul_i32 s9, s73, 144
s_add_u32 s8, s8, s9
v_mul_u32_u24 v8, 1152, v2
v_lshl_add_u32 v8, v3, 3, v8
v_mov_b32 v9, 2147418112
v_cndmask_b32 v9, v8, v9, vcc
s_waitcnt lgkmcnt(0)
v_add_f32 v32, v32, v52
v_add_f32 v33, v33, v53
v_add_f32 v34, v34, v54
v_add_f32 v35, v35, v55
v_add_f32 v36, v36, v56
v_add_f32 v37, v37, v57
v_add_f32 v38, v38, v58
v_add_f32 v39, v39, v59
v_add_f32 v40, v40, v60
v_add_f32 v41, v41, v61
v_add_f32 v42, v42, v62
v_add_f32 v43, v43, v63
v_add_f32 v44, v44, v64
v_add_f32 v45, v45, v65
v_add_f32 v46, v46, v66
v_add_f32 v47, v47, v67
v_add_f32 v48, v48, v68
v_add_f32 v49, v49, v69
v_add_f32 v50, v50, v70
v_add_f32 v51, v51, v71
v_add_f32 v32, v32, v72
v_add_f32 v33, v33, v73
v_add_f32 v34, v34, v74
v_add_f32 v35, v35, v75
v_add_f32 v36, v36, v76
v_add_f32 v37, v37, v77
v_add_f32 v38, v38, v78
v_add_f32 v39, v39, v79
v_add_f32 v40, v40, v80
v_add_f32 v41, v41, v81
v_add_f32 v42, v42, v82
v_add_f32 v43, v43, v83
v_add_f32 v44, v44, v84
v_add_f32 v45, v45, v85
v_add_f32 v46, v46, v86
v_add_f32 v47, v47, v87
v_add_f32 v48, v48, v88
v_add_f32 v49, v49, v89
v_add_f32 v50, v50, v90
v_add_f32 v51, v51, v91
v_add_f32 v32, v32, v92
v_add_f32 v33, v33, v93
v_add_f32 v34, v34, v94
v_add_f32 v35, v35, v95
v_add_f32 v36, v36, v96
v_add_f32 v37, v37, v97
v_add_f32 v38, v38, v98
v_add_f32 v39, v39, v99
v_add_f32 v40, v40, v100
v_add_f32 v41, v41, v101
v_add_f32 v42, v42, v102
v_add_f32 v43, v43, v103
v_add_f32 v44, v44, v104
v_add_f32 v45, v45, v105
v_add_f32 v46, v46, v106
v_add_f32 v47, v47, v107
v_add_f32 v48, v48, v108
v_add_f32 v49, v49, v109
v_add_f32 v50, v50, v110
v_add_f32 v51, v51, v111
v_mov_b32 v52, v48
v_mov_b32 v53, v49
v_mov_b32 v54, v50
v_mov_b32 v55, v51
s_nop 1
v_permlane32_swap_b32 v52, v48
v_permlane32_swap_b32 v53, v49
v_permlane32_swap_b32 v54, v50
v_permlane32_swap_b32 v55, v51
s_nop 1
v_add_f32 v48, v48, v52
v_add_f32 v49, v49, v53
v_add_f32 v50, v50, v54
v_add_f32 v51, v51, v55
v_cvt_pk_bf16_f32 v32, v32, v33
v_cvt_pk_bf16_f32 v33, v34, v35
buffer_store_dwordx2 v[32:33], v8, s[56:59], s8 offen offset:0
v_cvt_pk_bf16_f32 v36, v36, v37
v_cvt_pk_bf16_f32 v37, v38, v39
buffer_store_dwordx2 v[36:37], v8, s[56:59], s8 offen offset:32
v_cvt_pk_bf16_f32 v40, v40, v41
v_cvt_pk_bf16_f32 v41, v42, v43
buffer_store_dwordx2 v[40:41], v8, s[56:59], s8 offen offset:64
v_cvt_pk_bf16_f32 v44, v44, v45
v_cvt_pk_bf16_f32 v45, v46, v47
buffer_store_dwordx2 v[44:45], v8, s[56:59], s8 offen offset:96
v_cvt_pk_bf16_f32 v48, v48, v49
v_cvt_pk_bf16_f32 v49, v50, v51
buffer_store_dwordx2 v[48:49], v9, s[56:59], s8 offen offset:128
K4_END:
s_endpgm
.section .rodata,"a"
.p2align 6
.amdhsa_kernel k0_kernel
  .amdhsa_next_free_vgpr 512
  .amdhsa_next_free_sgpr 102
  .amdhsa_accum_offset 256
  .amdhsa_group_segment_fixed_size 0
  .amdhsa_kernarg_size 104
  .amdhsa_user_sgpr_count 2
  .amdhsa_user_sgpr_kernarg_segment_ptr 1
  .amdhsa_system_sgpr_workgroup_id_x 1
.end_amdhsa_kernel

.p2align 6
.amdhsa_kernel k1_kernel
  .amdhsa_next_free_vgpr 512
  .amdhsa_next_free_sgpr 102
  .amdhsa_accum_offset 256
  .amdhsa_group_segment_fixed_size 0
  .amdhsa_kernarg_size 104
  .amdhsa_user_sgpr_count 2
  .amdhsa_user_sgpr_kernarg_segment_ptr 1
  .amdhsa_system_sgpr_workgroup_id_x 1
.end_amdhsa_kernel

.p2align 6
.amdhsa_kernel k2_kernel
  .amdhsa_next_free_vgpr 512
  .amdhsa_next_free_sgpr 102
  .amdhsa_accum_offset 256
  .amdhsa_group_segment_fixed_size 0
  .amdhsa_kernarg_size 104
  .amdhsa_user_sgpr_count 2
  .amdhsa_user_sgpr_kernarg_segment_ptr 1
  .amdhsa_system_sgpr_workgroup_id_x 1
.end_amdhsa_kernel

.p2align 6
.amdhsa_kernel k3_kernel
  .amdhsa_next_free_vgpr 512
  .amdhsa_next_free_sgpr 102
  .amdhsa_accum_offset 256
  .amdhsa_group_segment_fixed_size 0
  .amdhsa_kernarg_size 104
  .amdhsa_user_sgpr_count 2
  .amdhsa_user_sgpr_kernarg_segment_ptr 1
  .amdhsa_system_sgpr_workgroup_id_x 1
.end_amdhsa_kernel

.p2align 6
.amdhsa_kernel k4_kernel
  .amdhsa_next_free_vgpr 512
  .amdhsa_next_free_sgpr 102
  .amdhsa_accum_offset 256
  .amdhsa_group_segment_fixed_size 0
  .amdhsa_kernarg_size 104
  .amdhsa_user_sgpr_count 2
  .amdhsa_user_sgpr_kernarg_segment_ptr 1
  .amdhsa_system_sgpr_workgroup_id_x 1
.end_amdhsa_kernel
```

```asm
; @launch grid=(256,1,1) block=(256,1,1) lds=163840
.amdgcn_target "amdgcn-amd-amdhsa--gfx950"
.text

.globl gated_mix__sliding_local_dilated__compressed_kv_cla__prompt_kernel
.p2align 8
.type gated_mix__sliding_local_dilated__compressed_kv_cla__prompt_kernel,@function
gated_mix__sliding_local_dilated__compressed_kv_cla__prompt_kernel:
s_cmp_ge_u32 s2, 256
s_cbranch_scc1 L_END
s_load_dwordx2 s[8:9], s[0:1], 32
s_load_dwordx2 s[16:17], s[0:1], 48
s_load_dwordx2 s[48:49], s[0:1], 56
s_load_dwordx2 s[24:25], s[0:1], 96
s_load_dwordx2 s[12:13], s[0:1], 0
s_load_dwordx2 s[20:21], s[0:1], 40
s_load_dwordx2 s[28:29], s[0:1], 8
s_load_dwordx2 s[50:51], s[0:1], 16
s_load_dwordx2 s[32:33], s[0:1], 64
s_load_dwordx2 s[36:37], s[0:1], 72
s_load_dwordx2 s[40:41], s[0:1], 88
s_load_dwordx2 s[44:45], s[0:1], 80
s_getpc_b64 s[96:97]
s_lshr_b32 s6, s2, 3
s_lshl_b32 s98, s6, 11
s_add_u32 s96, s96, s98
s_addc_u32 s97, s97, 0
v_lshlrev_b32 v16, 3, v0
v_mov_b32 v17, s97
v_add_co_u32 v16, vcc, s96, v16
s_nop 1
v_addc_co_u32 v17, vcc, 0, v17, vcc
global_load_dwordx2 a[250:251], v[16:17], off
v_lshrrev_b32 v5, 6, v0
v_and_b32 v1, 63, v0
v_readfirstlane_b32 s3, v5
v_and_b32 v2, 15, v0
v_lshrrev_b32 v3, 4, v1
v_lshlrev_b32 v4, 4, v1
s_and_b32 s7, s2, 7
s_and_b32 s53, s6, 3
s_lshl_b32 s4, s7, 2
s_add_u32 s4, s4, s53
s_lshr_b32 s5, s6, 2
s_lshl_b32 s54, s5, 2
s_add_u32 s54, s54, s3
s_sub_u32 s55, 63, s54
v_lshrrev_b32 v16, 3, v1
v_and_b32 v17, 7, v1
v_xor_b32 v18, v17, v3
v_lshlrev_b32 v19, 10, v16
v_lshl_add_u32 v5, v18, 4, v19
v_xor_b32 v18, 4, v18
v_lshl_add_u32 v6, v18, 4, v19
v_add_u32 v6, 7168, v6
v_and_b32 v18, 1, v3
v_lshlrev_b32 v18, 1, v18
v_xor_b32 v18, v17, v18
v_lshlrev_b32 v19, 13, v16
v_lshl_add_u32 v7, v18, 4, v19
v_xor_b32 v18, 4, v18
v_lshl_add_u32 v8, v18, 4, v19
v_add_u32 v8, 64512, v8
s_lshl_b32 s52, s53, 1
s_add_u32 s52, s52, s5
s_and_b32 s53, s7, 1
s_add_u32 s52, s52, s53
s_mov_b32 s66, s52
s_and_b32 s52, s52, 7
s_lshl_b32 s57, s52, 7
s_lshl_b32 s62, s52, 19
s_lshl_b32 s56, s54, 16
s_lshl_b32 s60, s3, 13
s_add_u32 s60, s60, 65536
s_and_b32 s53, s3, 1
s_lshl_b32 s61, s4, 8
s_lshl_b32 s52, s53, 7
s_add_u32 s61, s61, s52
s_lshl_b32 s64, s3, 12
s_add_u32 s58, s56, s57
s_add_u32 s63, s61, s62
s_mov_b32 s10, 2097152
s_mov_b32 s11, 0x20000
s_mov_b32 s18, 4194304
s_mov_b32 s19, 0x20000
s_mov_b32 s26, 268435456
s_mov_b32 s27, 0x20000
s_mov_b32 s14, 2359296
s_mov_b32 s15, 0x20000
s_mov_b32 s22, 4718592
s_mov_b32 s23, 0x20000
s_mov_b32 s30, 1990656
s_mov_b32 s31, 0x20000
s_mov_b32 s34, 4718592
s_mov_b32 s35, 0x20000
s_mov_b32 s38, 1152
s_mov_b32 s39, 0x20000
s_mov_b32 s42, 256
s_mov_b32 s43, 0x20000
s_mov_b32 s46, 2359296
s_mov_b32 s47, 0x20000
s_cmp_lt_u32 s3, 2
s_waitcnt lgkmcnt(0)
s_cselect_b32 s16, s16, s48
s_cselect_b32 s17, s17, s49
s_add_u32 m0, s60, 0
s_add_u32 s52, s58, 0
buffer_load_dwordx4 v5, s[8:11], s52 offen lds
buffer_load_dwordx4 v6, s[8:11], s52 offen offset:1024 lds
s_add_u32 m0, s60, 2048
s_add_u32 s52, s58, 16384
buffer_load_dwordx4 v5, s[8:11], s52 offen lds
buffer_load_dwordx4 v6, s[8:11], s52 offen offset:1024 lds
s_add_u32 m0, s64, 0
s_add_u32 s52, s63, 0
buffer_load_dwordx4 v7, s[16:19], s52 offen lds
buffer_load_dwordx4 v8, s[16:19], s52 offen offset:1024 lds
s_add_u32 m0, s64, 2048
s_add_u32 s52, s63, 131072
buffer_load_dwordx4 v7, s[16:19], s52 offen lds
buffer_load_dwordx4 v8, s[16:19], s52 offen offset:1024 lds
s_add_u32 m0, s60, 4096
s_add_u32 s52, s58, 32768
buffer_load_dwordx4 v5, s[8:11], s52 offen lds
buffer_load_dwordx4 v6, s[8:11], s52 offen offset:1024 lds
s_add_u32 m0, s60, 6144
s_add_u32 s52, s58, 49152
buffer_load_dwordx4 v5, s[8:11], s52 offen lds
buffer_load_dwordx4 v6, s[8:11], s52 offen offset:1024 lds
s_lshl_b32 s78, s4, 10
s_add_u32 s78, s78, 75497472
s_cmp_eq_u32 s54, 0
s_cselect_b32 s48, s78, 2147418112
v_mov_b32 v16, 0
v_mov_b32 v17, 0
v_mov_b32 v18, 0
v_mov_b32 v19, 0
buffer_store_dwordx4 v[16:19], v4, s[24:27], s48 offen sc1
s_add_u32 m0, s64, 16384
s_add_u32 s52, s63, 262144
buffer_load_dwordx4 v7, s[16:19], s52 offen lds
buffer_load_dwordx4 v8, s[16:19], s52 offen offset:1024 lds
s_add_u32 m0, s64, 18432
s_add_u32 s52, s63, 393216
buffer_load_dwordx4 v7, s[16:19], s52 offen lds
buffer_load_dwordx4 v8, s[16:19], s52 offen offset:1024 lds
s_add_u32 s78, s78, 512
s_cmp_eq_u32 s3, 0
s_cselect_b32 s79, s78, 2147418112
v_mov_b32 v15, 1
v_mov_b32 v16, 2147418112
v_cmp_eq_u32 vcc, 0, v1
s_nop 1
v_cndmask_b32 v0, v16, 0, vcc
s_lshr_b32 s48, s3, 1
s_lshl_b32 s48, s48, 7
s_and_b32 s49, s64, 4096
v_lshrrev_b32 v16, 1, v2
v_xor_b32 v16, v16, v3
v_add_u32 v17, s48, v2
v_lshlrev_b32 v17, 7, v17
v_add_u32 v17, 65536, v17
v_lshl_add_u32 v9, v16, 4, v17
v_xor_b32 v10, 64, v9
v_bfe_u32 v16, v1, 2, 2
v_lshl_add_u32 v17, v3, 3, v16
v_lshlrev_b32 v17, 7, v17
v_and_b32 v18, 3, v1
v_lshl_add_u32 v17, v18, 3, v17
v_add_u32 v17, s49, v17
v_lshrrev_b32 v16, 1, v16
v_and_b32 v18, 1, v3
v_lshl_add_u32 v16, v18, 1, v16
v_xor_b32 v18, 0, v16
v_lshl_add_u32 v11, v18, 5, v17
v_xor_b32 v18, 1, v16
v_lshl_add_u32 v12, v18, 5, v17
v_xor_b32 v18, 2, v16
v_lshl_add_u32 v13, v18, 5, v17
v_xor_b32 v18, 3, v16
v_lshl_add_u32 v14, v18, 5, v17
s_mul_i32 s76, s4, 1064960
s_lshl_b32 s52, s5, 17
s_add_u32 s76, s76, s52
s_lshl_b32 s52, s48, 9
s_add_u32 s76, s76, s52
s_add_u32 s77, s76, s49
s_add_u32 s77, s77, 24576
s_lshr_b32 s49, s49, 1
s_add_u32 s76, s76, s49
s_lshl_b32 s67, s3, 10
s_mul_i32 s65, s4, 73728
s_add_u32 s65, s65, s67
s_add_u32 s65, s65, 35651584
s_add_u32 s67, s67, 8192
s_mov_b32 s80, 0x3e0293ee
s_add_u32 s57, s57, 128
s_and_b32 s57, s57, 1023
s_add_u32 s58, s56, s57
s_add_u32 m0, s60, 32768
s_add_u32 s52, s58, 0
buffer_load_dwordx4 v5, s[8:11], s52 offen lds
buffer_load_dwordx4 v6, s[8:11], s52 offen offset:1024 lds
s_add_u32 m0, s60, 34816
s_add_u32 s52, s58, 16384
buffer_load_dwordx4 v5, s[8:11], s52 offen lds
buffer_load_dwordx4 v6, s[8:11], s52 offen offset:1024 lds
s_mov_b32 s81, 0x05040100
s_mov_b32 s82, 0x07060302
v_mov_b32 v24, 2147418112
v_and_b32 v16, 1, v3
v_lshrrev_b32 v17, 1, v3
v_cmp_gt_u32 vcc, 8, v2
s_lshr_b32 s48, s3, 1
s_and_b32 s49, s3, 1
s_and_b32 s52, s2, 3
s_lshl_b32 s52, s52, 1
s_add_u32 s49, s49, s52
s_lshr_b32 s52, s2, 2
s_lshl_b32 s52, s52, 1
s_add_u32 s52, s52, s48
s_lshl_b32 s68, s52, 5
s_mul_i32 s74, s68, 1152
s_mul_i32 s53, s49, 144
s_add_u32 s74, s74, s53
s_mul_i32 s75, s49, 73
s_lshr_b32 s53, s52, 1
s_add_u32 s75, s75, s53
s_mul_i32 s75, s75, 9216
s_add_u32 s75, s75, 38797312
s_lshl_b32 s53, s48, 12
s_add_u32 s75, s75, s53
v_mul_u32_u24 v18, 4, v16
v_mul_u32_u24 v19, 8, v17
v_add_u32 v18, v18, v19
v_mul_u32_u24 v18, 1152, v18
v_lshl_add_u32 v19, v2, 3, v18
v_accvgpr_write_b32 a223, v19
v_lshl_add_u32 v19, v2, 1, v18
v_add_u32 v19, 128, v19
v_cndmask_b32 v19, v24, v19, vcc
v_accvgpr_write_b32 a224, v19
s_mul_i32 s53, s48, 3968
s_sub_u32 s53, 8192, s53
v_add_u32 v19, s53, v4
v_cndmask_b32 v19, v24, v19, vcc
v_accvgpr_write_b32 a225, v19
v_accvgpr_write_b32 a226, v24
s_mov_b32 s73, 0
s_cmp_lt_u32 s54, 18
s_cbranch_scc1 U_WA
s_mov_b32 s28, s50
s_mov_b32 s29, s51
s_mov_b32 s30, 663552
s_mul_i32 s48, s4, 14
s_add_u32 s48, s48, s54
s_sub_u32 s48, s48, 18
s_and_b32 s49, s48, 7
s_lshr_b32 s48, s48, 3
s_add_u32 s52, s48, 128
s_and_b32 s50, s48, 1
s_cmp_lt_u32 s48, 16
s_cbranch_scc0 U_X
s_mul_i32 s51, s48, 36
s_mov_b32 s69, 4608
s_mov_b32 s70, 9216
s_mov_b32 s71, 1152
s_mul_i32 s68, s51, 1152
s_mul_i32 s53, s49, 144
s_add_u32 s68, s68, s53
s_mul_i32 s72, s49, 73
s_lshr_b32 s53, s52, 1
s_add_u32 s72, s72, s53
s_mul_i32 s72, s72, 9216
s_add_u32 s72, s72, 38797312
s_lshl_b32 s53, s50, 12
s_add_u32 s72, s72, s53
v_mul_u32_u24 v18, 2, v16
v_mul_u32_u24 v19, 18, v17
v_add_u32 v18, v18, v19
v_mul_u32_u24 v18, 1152, v18
v_lshl_add_u32 v19, v2, 3, v18
v_accvgpr_write_b32 a220, v19
v_lshl_add_u32 v19, v2, 1, v18
v_add_u32 v19, 128, v19
v_cndmask_b32 v19, v24, v19, vcc
v_accvgpr_write_b32 a221, v19
s_mul_i32 s53, s50, 3968
s_sub_u32 s53, 8192, s53
v_add_u32 v19, s53, v4
v_cndmask_b32 v19, v24, v19, vcc
v_accvgpr_write_b32 a222, v19
s_branch U_DONE
U_X:
s_mul_i32 s51, s50, 288
s_add_u32 s51, s51, 16
s_mov_b32 s69, 1152
s_mov_b32 s70, 20736
s_mov_b32 s71, 41472
s_mul_i32 s68, s51, 1152
s_mul_i32 s53, s49, 144
s_add_u32 s68, s68, s53
s_mul_i32 s72, s49, 73
s_lshr_b32 s53, s52, 1
s_add_u32 s72, s72, s53
s_mul_i32 s72, s72, 9216
s_add_u32 s72, s72, 38797312
s_lshl_b32 s53, s50, 12
s_add_u32 s72, s72, s53
v_mul_u32_u24 v18, 72, v16
v_mul_u32_u24 v19, 144, v17
v_add_u32 v18, v18, v19
v_mul_u32_u24 v18, 1152, v18
v_lshl_add_u32 v19, v2, 3, v18
v_accvgpr_write_b32 a220, v19
v_lshl_add_u32 v19, v2, 1, v18
v_add_u32 v19, 128, v19
v_cndmask_b32 v19, v24, v19, vcc
v_accvgpr_write_b32 a221, v19
s_mul_i32 s53, s50, 3968
s_sub_u32 s53, 8192, s53
v_add_u32 v19, s53, v4
v_cndmask_b32 v19, v24, v19, vcc
v_accvgpr_write_b32 a222, v19
s_cmp_lt_u32 s48, 18
s_cselect_b32 s68, s68, 2147418112
s_cselect_b32 s72, s72, 2147418112
s_branch U_DONE
U_WA:
s_mul_i32 s68, s54, 110592
s_mul_i32 s53, s4, 36
s_add_u32 s68, s68, s53
s_mov_b32 s69, 3456
s_mov_b32 s70, 6912
s_mov_b32 s71, 13824
s_mul_i32 s72, s4, 18
s_add_u32 s72, s72, s54
s_lshl_b32 s72, s72, 12
s_add_u32 s72, s72, 35651584
s_lshl_b32 s73, s54, 6
v_lshrrev_b32 v18, 2, v2
v_and_b32 v19, 3, v2
v_mul_u32_u24 v20, 1152, v18
v_lshl_add_u32 v20, v19, 3, v20
v_add_u32 v21, 1, v19
v_cmp_eq_u32 vcc, 2, v19
s_nop 1
v_cndmask_b32 v21, v21, 0, vcc
v_mul_u32_u24 v21, 1152, v21
v_add_u32 v21, 32, v21
v_cmp_eq_u32 vcc, 3, v18
s_nop 1
v_cndmask_b32 v20, v20, v21, vcc
v_mul_u32_u24 v21, 27648, v3
v_add_u32 v20, v20, v21
v_cmp_eq_u32 vcc, 15, v2
v_lshlrev_b32 v21, 4, v3
s_nop 0
v_cndmask_b32 v20, v20, v24, vcc
v_cndmask_b32 v21, v24, v21, vcc
v_accvgpr_write_b32 a220, v20
v_accvgpr_write_b32 a226, v21
v_accvgpr_write_b32 a221, v24
v_accvgpr_write_b32 a222, v24
U_DONE:
s_waitcnt vmcnt(8)
s_barrier
ds_read_b128 a[64:67], v9 offset:0
ds_read_b128 a[68:71], v9 offset:2048
ds_read_b128 a[72:75], v9 offset:4096
ds_read_b128 a[76:79], v9 offset:6144
ds_read_b128 a[80:83], v9 offset:8192
ds_read_b128 a[84:87], v9 offset:10240
ds_read_b128 a[88:91], v9 offset:12288
ds_read_b128 a[92:95], v9 offset:14336
ds_read_b64_tr_b16 a[112:113], v11 offset:8192
ds_read_b64_tr_b16 a[114:115], v11 offset:8704
ds_read_b64_tr_b16 a[116:117], v12 offset:8192
ds_read_b64_tr_b16 a[118:119], v12 offset:8704
ds_read_b64_tr_b16 a[120:121], v13 offset:8192
ds_read_b64_tr_b16 a[122:123], v13 offset:8704
ds_read_b64_tr_b16 a[124:125], v14 offset:8192
ds_read_b64_tr_b16 a[126:127], v14 offset:8704
ds_read_b64_tr_b16 a[96:97], v11 offset:0
ds_read_b64_tr_b16 a[98:99], v11 offset:512
ds_read_b64_tr_b16 a[100:101], v12 offset:0
ds_read_b64_tr_b16 a[102:103], v12 offset:512
ds_read_b64_tr_b16 a[104:105], v13 offset:0
ds_read_b64_tr_b16 a[106:107], v13 offset:512
ds_read_b64_tr_b16 a[108:109], v14 offset:0
ds_read_b64_tr_b16 a[110:111], v14 offset:512
s_lshl_b32 s48, s4, 2
s_cmp_eq_u32 s54, 0
s_cselect_b32 s48, s48, 2147418112
buffer_store_dword v15, v0, s[40:43], s48 offen sc1
s_waitcnt lgkmcnt(0)
v_mfma_f32_16x16x32_bf16 v[160:163], a[96:99], a[64:67], 0
s_waitcnt vmcnt(5)
v_mfma_f32_16x16x32_bf16 v[164:167], a[100:103], a[64:67], 0
s_barrier
v_mfma_f32_16x16x32_bf16 v[168:171], a[104:107], a[64:67], 0
ds_read_b128 a[128:131], v10 offset:0
ds_read_b128 a[132:135], v10 offset:2048
v_mfma_f32_16x16x32_bf16 v[172:175], a[108:111], a[64:67], 0
s_add_u32 m0, s60, 36864
s_add_u32 s52, s58, 32768
v_mfma_f32_16x16x32_bf16 v[32:35], a[64:67], a[112:115], 0
buffer_load_dwordx4 v5, s[8:11], s52 offen lds
v_mfma_f32_16x16x32_bf16 v[40:43], a[64:67], a[116:119], 0
ds_read_b128 a[136:139], v10 offset:4096
ds_read_b128 a[140:143], v10 offset:6144
v_mfma_f32_16x16x32_bf16 v[48:51], a[64:67], a[120:123], 0
v_mfma_f32_16x16x32_bf16 v[56:59], a[64:67], a[124:127], 0
ds_read_b128 a[144:147], v10 offset:8192
ds_read_b128 a[148:151], v10 offset:10240
v_mfma_f32_16x16x32_bf16 v[60:63], a[68:71], a[124:127], 0
buffer_load_dwordx4 v6, s[8:11], s52 offen offset:1024 lds
v_mfma_f32_16x16x32_bf16 v[52:55], a[68:71], a[120:123], 0
ds_read_b128 a[152:155], v10 offset:12288
ds_read_b128 a[156:159], v10 offset:14336
v_mfma_f32_16x16x32_bf16 v[44:47], a[68:71], a[116:119], 0
v_mfma_f32_16x16x32_bf16 v[36:39], a[68:71], a[112:115], 0
s_add_u32 m0, s60, 38912
s_add_u32 s52, s58, 49152
v_mfma_f32_16x16x32_bf16 v[188:191], a[108:111], a[68:71], 0
ds_read_b64_tr_b16 a[176:177], v11 offset:24576
ds_read_b64_tr_b16 a[178:179], v11 offset:25088
v_mfma_f32_16x16x32_bf16 v[184:187], a[104:107], a[68:71], 0
buffer_load_dwordx4 v5, s[8:11], s52 offen lds
v_mfma_f32_16x16x32_bf16 v[180:183], a[100:103], a[68:71], 0
ds_read_b64_tr_b16 a[180:181], v12 offset:24576
ds_read_b64_tr_b16 a[182:183], v12 offset:25088
v_mfma_f32_16x16x32_bf16 v[176:179], a[96:99], a[68:71], 0
v_mfma_f32_16x16x32_bf16 v[192:195], a[96:99], a[72:75], 0
ds_read_b64_tr_b16 a[184:185], v13 offset:24576
ds_read_b64_tr_b16 a[186:187], v13 offset:25088
v_mfma_f32_16x16x32_bf16 v[196:199], a[100:103], a[72:75], 0
v_mfma_f32_16x16x32_bf16 v[200:203], a[104:107], a[72:75], 0
buffer_load_dwordx4 v6, s[8:11], s52 offen offset:1024 lds
v_mfma_f32_16x16x32_bf16 v[204:207], a[108:111], a[72:75], 0
s_add_u32 s62, s62, 524288
s_and_b32 s62, s62, 4194303
s_add_u32 s63, s61, s62
v_mfma_f32_16x16x32_bf16 v[64:67], a[72:75], a[112:115], 0
ds_read_b64_tr_b16 a[188:189], v14 offset:24576
ds_read_b64_tr_b16 a[190:191], v14 offset:25088
v_mfma_f32_16x16x32_bf16 v[72:75], a[72:75], a[116:119], 0
s_add_u32 m0, s64, 32768
s_add_u32 s52, s63, 0
v_mfma_f32_16x16x32_bf16 v[80:83], a[72:75], a[120:123], 0
ds_read_b64_tr_b16 a[160:161], v11 offset:16384
ds_read_b64_tr_b16 a[162:163], v11 offset:16896
v_mfma_f32_16x16x32_bf16 v[88:91], a[72:75], a[124:127], 0
buffer_load_dwordx4 v7, s[16:19], s52 offen lds
v_mfma_f32_16x16x32_bf16 v[92:95], a[76:79], a[124:127], 0
ds_read_b64_tr_b16 a[164:165], v12 offset:16384
ds_read_b64_tr_b16 a[166:167], v12 offset:16896
v_mfma_f32_16x16x32_bf16 v[84:87], a[76:79], a[120:123], 0
v_mfma_f32_16x16x32_bf16 v[76:79], a[76:79], a[116:119], 0
ds_read_b64_tr_b16 a[168:169], v13 offset:16384
ds_read_b64_tr_b16 a[170:171], v13 offset:16896
v_mfma_f32_16x16x32_bf16 v[68:71], a[76:79], a[112:115], 0
v_mfma_f32_16x16x32_bf16 v[220:223], a[108:111], a[76:79], 0
buffer_load_dwordx4 v8, s[16:19], s52 offen offset:1024 lds
v_mfma_f32_16x16x32_bf16 v[216:219], a[104:107], a[76:79], 0
ds_read_b64_tr_b16 a[172:173], v14 offset:16384
ds_read_b64_tr_b16 a[174:175], v14 offset:16896
v_mfma_f32_16x16x32_bf16 v[212:215], a[100:103], a[76:79], 0
v_mfma_f32_16x16x32_bf16 v[208:211], a[96:99], a[76:79], 0
s_add_u32 m0, s64, 34816
s_add_u32 s52, s63, 131072
v_mfma_f32_16x16x32_bf16 v[224:227], a[96:99], a[80:83], 0
v_mfma_f32_16x16x32_bf16 v[228:231], a[100:103], a[80:83], 0
buffer_load_dwordx4 v7, s[16:19], s52 offen lds
v_mfma_f32_16x16x32_bf16 v[232:235], a[104:107], a[80:83], 0
v_mfma_f32_16x16x32_bf16 v[236:239], a[108:111], a[80:83], 0
v_mfma_f32_16x16x32_bf16 v[96:99], a[80:83], a[112:115], 0
v_mfma_f32_16x16x32_bf16 v[104:107], a[80:83], a[116:119], 0
buffer_load_dwordx4 v8, s[16:19], s52 offen offset:1024 lds
v_mfma_f32_16x16x32_bf16 v[112:115], a[80:83], a[120:123], 0
v_mfma_f32_16x16x32_bf16 v[120:123], a[80:83], a[124:127], 0
v_mfma_f32_16x16x32_bf16 v[124:127], a[84:87], a[124:127], 0
s_add_u32 m0, s64, 49152
s_add_u32 s52, s63, 262144
v_mfma_f32_16x16x32_bf16 v[116:119], a[84:87], a[120:123], 0
v_mfma_f32_16x16x32_bf16 v[108:111], a[84:87], a[116:119], 0
buffer_load_dwordx4 v7, s[16:19], s52 offen lds
v_mfma_f32_16x16x32_bf16 v[100:103], a[84:87], a[112:115], 0
v_mfma_f32_16x16x32_bf16 v[252:255], a[108:111], a[84:87], 0
v_mfma_f32_16x16x32_bf16 v[248:251], a[104:107], a[84:87], 0
v_mfma_f32_16x16x32_bf16 v[244:247], a[100:103], a[84:87], 0
v_mfma_f32_16x16x32_bf16 v[240:243], a[96:99], a[84:87], 0
buffer_load_dwordx4 v8, s[16:19], s52 offen offset:1024 lds
v_mfma_f32_16x16x32_bf16 a[0:3], a[96:99], a[88:91], 0
v_mfma_f32_16x16x32_bf16 a[4:7], a[100:103], a[88:91], 0
v_mfma_f32_16x16x32_bf16 a[8:11], a[104:107], a[88:91], 0
s_add_u32 m0, s64, 51200
s_add_u32 s52, s63, 393216
v_mfma_f32_16x16x32_bf16 a[12:15], a[108:111], a[88:91], 0
v_mfma_f32_16x16x32_bf16 v[128:131], a[88:91], a[112:115], 0
buffer_load_dwordx4 v7, s[16:19], s52 offen lds
v_mfma_f32_16x16x32_bf16 v[136:139], a[88:91], a[116:119], 0
v_mfma_f32_16x16x32_bf16 v[144:147], a[88:91], a[120:123], 0
v_mfma_f32_16x16x32_bf16 v[152:155], a[88:91], a[124:127], 0
v_mfma_f32_16x16x32_bf16 v[156:159], a[92:95], a[124:127], 0
v_add_u32 v9, 32768, v9
v_add_u32 v10, 32768, v10
v_mfma_f32_16x16x32_bf16 v[148:151], a[92:95], a[120:123], 0
buffer_load_dwordx4 v8, s[16:19], s52 offen offset:1024 lds
v_mfma_f32_16x16x32_bf16 v[140:143], a[92:95], a[116:119], 0
v_mfma_f32_16x16x32_bf16 v[132:135], a[92:95], a[112:115], 0
v_mfma_f32_16x16x32_bf16 a[28:31], a[108:111], a[92:95], 0
v_mfma_f32_16x16x32_bf16 a[24:27], a[104:107], a[92:95], 0
v_mfma_f32_16x16x32_bf16 a[20:23], a[100:103], a[92:95], 0
v_mfma_f32_16x16x32_bf16 a[16:19], a[96:99], a[92:95], 0
s_waitcnt lgkmcnt(0)
v_mfma_f32_16x16x32_bf16 v[160:163], a[160:163], a[128:131], v[160:163]
s_waitcnt vmcnt(4)
v_mfma_f32_16x16x32_bf16 v[164:167], a[164:167], a[128:131], v[164:167]
s_barrier
v_mfma_f32_16x16x32_bf16 v[168:171], a[168:171], a[128:131], v[168:171]
ds_read_b128 a[64:67], v9 offset:0
ds_read_b128 a[68:71], v9 offset:2048
v_mfma_f32_16x16x32_bf16 v[172:175], a[172:175], a[128:131], v[172:175]
s_add_u32 s57, s57, 128
s_and_b32 s57, s57, 1023
s_add_u32 s58, s56, s57
v_mfma_f32_16x16x32_bf16 v[32:35], a[128:131], a[176:179], v[32:35]
s_add_u32 m0, s60, 65536
s_add_u32 s52, s58, 0
v_mfma_f32_16x16x32_bf16 v[40:43], a[128:131], a[180:183], v[40:43]
buffer_load_dwordx4 v5, s[8:11], s52 offen lds
v_mfma_f32_16x16x32_bf16 v[48:51], a[128:131], a[184:187], v[48:51]
ds_read_b128 a[72:75], v9 offset:4096
ds_read_b128 a[76:79], v9 offset:6144
v_mfma_f32_16x16x32_bf16 v[56:59], a[128:131], a[188:191], v[56:59]
v_mfma_f32_16x16x32_bf16 v[60:63], a[132:135], a[188:191], v[60:63]
buffer_load_dwordx4 v6, s[8:11], s52 offen offset:1024 lds
v_mfma_f32_16x16x32_bf16 v[52:55], a[132:135], a[184:187], v[52:55]
ds_read_b128 a[80:83], v9 offset:8192
ds_read_b128 a[84:87], v9 offset:10240
v_mfma_f32_16x16x32_bf16 v[44:47], a[132:135], a[180:183], v[44:47]
v_mfma_f32_16x16x32_bf16 v[36:39], a[132:135], a[176:179], v[36:39]
s_add_u32 m0, s60, 67584
s_add_u32 s52, s58, 16384
v_mfma_f32_16x16x32_bf16 v[188:191], a[172:175], a[132:135], v[188:191]
ds_read_b128 a[88:91], v9 offset:12288
ds_read_b128 a[92:95], v9 offset:14336
v_mfma_f32_16x16x32_bf16 v[184:187], a[168:171], a[132:135], v[184:187]
buffer_load_dwordx4 v5, s[8:11], s52 offen lds
v_mfma_f32_16x16x32_bf16 v[180:183], a[164:167], a[132:135], v[180:183]
ds_read_b64_tr_b16 a[112:113], v11 offset:40960
ds_read_b64_tr_b16 a[114:115], v11 offset:41472
v_mfma_f32_16x16x32_bf16 v[176:179], a[160:163], a[132:135], v[176:179]
v_mfma_f32_16x16x32_bf16 v[192:195], a[160:163], a[136:139], v[192:195]
ds_read_b64_tr_b16 a[116:117], v12 offset:40960
ds_read_b64_tr_b16 a[118:119], v12 offset:41472
v_mfma_f32_16x16x32_bf16 v[196:199], a[164:167], a[136:139], v[196:199]
v_mfma_f32_16x16x32_bf16 v[200:203], a[168:171], a[136:139], v[200:203]
buffer_load_dwordx4 v6, s[8:11], s52 offen offset:1024 lds
v_mfma_f32_16x16x32_bf16 v[204:207], a[172:175], a[136:139], v[204:207]
s_add_u32 s62, s62, 524288
s_and_b32 s62, s62, 4194303
s_add_u32 s63, s61, s62
v_mfma_f32_16x16x32_bf16 v[64:67], a[136:139], a[176:179], v[64:67]
ds_read_b64_tr_b16 a[120:121], v13 offset:40960
ds_read_b64_tr_b16 a[122:123], v13 offset:41472
v_mfma_f32_16x16x32_bf16 v[72:75], a[136:139], a[180:183], v[72:75]
s_add_u32 m0, s64, 0
s_add_u32 s52, s63, 0
v_mfma_f32_16x16x32_bf16 v[80:83], a[136:139], a[184:187], v[80:83]
ds_read_b64_tr_b16 a[124:125], v14 offset:40960
ds_read_b64_tr_b16 a[126:127], v14 offset:41472
v_mfma_f32_16x16x32_bf16 v[88:91], a[136:139], a[188:191], v[88:91]
buffer_load_dwordx4 v7, s[16:19], s52 offen lds
v_mfma_f32_16x16x32_bf16 v[92:95], a[140:143], a[188:191], v[92:95]
ds_read_b64_tr_b16 a[96:97], v11 offset:32768
ds_read_b64_tr_b16 a[98:99], v11 offset:33280
v_mfma_f32_16x16x32_bf16 v[84:87], a[140:143], a[184:187], v[84:87]
v_mfma_f32_16x16x32_bf16 v[76:79], a[140:143], a[180:183], v[76:79]
ds_read_b64_tr_b16 a[100:101], v12 offset:32768
ds_read_b64_tr_b16 a[102:103], v12 offset:33280
v_mfma_f32_16x16x32_bf16 v[68:71], a[140:143], a[176:179], v[68:71]
v_mfma_f32_16x16x32_bf16 v[220:223], a[172:175], a[140:143], v[220:223]
buffer_load_dwordx4 v8, s[16:19], s52 offen offset:1024 lds
v_mfma_f32_16x16x32_bf16 v[216:219], a[168:171], a[140:143], v[216:219]
ds_read_b64_tr_b16 a[104:105], v13 offset:32768
ds_read_b64_tr_b16 a[106:107], v13 offset:33280
v_mfma_f32_16x16x32_bf16 v[212:215], a[164:167], a[140:143], v[212:215]
v_mfma_f32_16x16x32_bf16 v[208:211], a[160:163], a[140:143], v[208:211]
s_add_u32 m0, s64, 2048
s_add_u32 s52, s63, 131072
v_mfma_f32_16x16x32_bf16 v[224:227], a[160:163], a[144:147], v[224:227]
ds_read_b64_tr_b16 a[108:109], v14 offset:32768
ds_read_b64_tr_b16 a[110:111], v14 offset:33280
v_mfma_f32_16x16x32_bf16 v[228:231], a[164:167], a[144:147], v[228:231]
buffer_load_dwordx4 v7, s[16:19], s52 offen lds
v_mfma_f32_16x16x32_bf16 v[232:235], a[168:171], a[144:147], v[232:235]
v_mfma_f32_16x16x32_bf16 v[236:239], a[172:175], a[144:147], v[236:239]
v_mfma_f32_16x16x32_bf16 v[96:99], a[144:147], a[176:179], v[96:99]
v_mfma_f32_16x16x32_bf16 v[104:107], a[144:147], a[180:183], v[104:107]
buffer_load_dwordx4 v8, s[16:19], s52 offen offset:1024 lds
v_mfma_f32_16x16x32_bf16 v[112:115], a[144:147], a[184:187], v[112:115]
v_mfma_f32_16x16x32_bf16 v[120:123], a[144:147], a[188:191], v[120:123]
v_mfma_f32_16x16x32_bf16 v[124:127], a[148:151], a[188:191], v[124:127]
s_add_u32 m0, s60, 69632
s_add_u32 s52, s58, 32768
v_mfma_f32_16x16x32_bf16 v[116:119], a[148:151], a[184:187], v[116:119]
v_mfma_f32_16x16x32_bf16 v[108:111], a[148:151], a[180:183], v[108:111]
buffer_load_dwordx4 v5, s[8:11], s52 offen lds
v_mfma_f32_16x16x32_bf16 v[100:103], a[148:151], a[176:179], v[100:103]
v_mfma_f32_16x16x32_bf16 v[252:255], a[172:175], a[148:151], v[252:255]
v_mfma_f32_16x16x32_bf16 v[248:251], a[168:171], a[148:151], v[248:251]
v_mfma_f32_16x16x32_bf16 v[244:247], a[164:167], a[148:151], v[244:247]
v_mfma_f32_16x16x32_bf16 v[240:243], a[160:163], a[148:151], v[240:243]
buffer_load_dwordx4 v6, s[8:11], s52 offen offset:1024 lds
v_mfma_f32_16x16x32_bf16 a[0:3], a[160:163], a[152:155], a[0:3]
v_mfma_f32_16x16x32_bf16 a[4:7], a[164:167], a[152:155], a[4:7]
v_mfma_f32_16x16x32_bf16 a[8:11], a[168:171], a[152:155], a[8:11]
s_add_u32 m0, s60, 71680
s_add_u32 s52, s58, 49152
v_mfma_f32_16x16x32_bf16 a[12:15], a[172:175], a[152:155], a[12:15]
v_mfma_f32_16x16x32_bf16 v[128:131], a[152:155], a[176:179], v[128:131]
buffer_load_dwordx4 v5, s[8:11], s52 offen lds
v_mfma_f32_16x16x32_bf16 v[136:139], a[152:155], a[180:183], v[136:139]
v_mfma_f32_16x16x32_bf16 v[144:147], a[152:155], a[184:187], v[144:147]
v_mfma_f32_16x16x32_bf16 v[152:155], a[152:155], a[188:191], v[152:155]
v_mfma_f32_16x16x32_bf16 v[156:159], a[156:159], a[188:191], v[156:159]
v_mfma_f32_16x16x32_bf16 v[148:151], a[156:159], a[184:187], v[148:151]
buffer_load_dwordx4 v6, s[8:11], s52 offen offset:1024 lds
v_mfma_f32_16x16x32_bf16 v[140:143], a[156:159], a[180:183], v[140:143]
v_mfma_f32_16x16x32_bf16 v[132:135], a[156:159], a[176:179], v[132:135]
v_mfma_f32_16x16x32_bf16 a[28:31], a[172:175], a[156:159], a[28:31]
v_mfma_f32_16x16x32_bf16 a[24:27], a[168:171], a[156:159], a[24:27]
v_mfma_f32_16x16x32_bf16 a[20:23], a[164:167], a[156:159], a[20:23]
v_mfma_f32_16x16x32_bf16 a[16:19], a[160:163], a[156:159], a[16:19]
s_waitcnt lgkmcnt(0)
v_mfma_f32_16x16x32_bf16 v[160:163], a[96:99], a[64:67], v[160:163]
s_waitcnt vmcnt(12)
v_mfma_f32_16x16x32_bf16 v[164:167], a[100:103], a[64:67], v[164:167]
s_barrier
v_mfma_f32_16x16x32_bf16 v[168:171], a[104:107], a[64:67], v[168:171]
ds_read_b128 a[128:131], v10 offset:0
ds_read_b128 a[132:135], v10 offset:2048
v_mfma_f32_16x16x32_bf16 v[172:175], a[108:111], a[64:67], v[172:175]
s_add_u32 m0, s64, 16384
s_add_u32 s52, s63, 262144
v_accvgpr_read_b32 v16, a220
v_mfma_f32_16x16x32_bf16 v[32:35], a[64:67], a[112:115], v[32:35]
buffer_load_dwordx4 v7, s[16:19], s52 offen lds
v_mfma_f32_16x16x32_bf16 v[40:43], a[64:67], a[116:119], v[40:43]
ds_read_b128 a[136:139], v10 offset:4096
ds_read_b128 a[140:143], v10 offset:6144
v_mfma_f32_16x16x32_bf16 v[48:51], a[64:67], a[120:123], v[48:51]
v_accvgpr_read_b32 v17, a221
v_accvgpr_read_b32 v18, a226
v_mfma_f32_16x16x32_bf16 v[56:59], a[64:67], a[124:127], v[56:59]
s_mov_b32 s48, s68
ds_read_b128 a[144:147], v10 offset:8192
ds_read_b128 a[148:151], v10 offset:10240
v_mfma_f32_16x16x32_bf16 v[60:63], a[68:71], a[124:127], v[60:63]
buffer_load_dwordx4 v8, s[16:19], s52 offen offset:1024 lds
v_mfma_f32_16x16x32_bf16 v[52:55], a[68:71], a[120:123], v[52:55]
ds_read_b128 a[152:155], v10 offset:12288
ds_read_b128 a[156:159], v10 offset:14336
v_mfma_f32_16x16x32_bf16 v[44:47], a[68:71], a[116:119], v[44:47]
buffer_load_dwordx2 a[192:193], v16, s[28:31], s48 offen
v_mfma_f32_16x16x32_bf16 v[36:39], a[68:71], a[112:115], v[36:39]
s_add_u32 m0, s64, 18432
s_add_u32 s52, s63, 393216
v_mfma_f32_16x16x32_bf16 v[188:191], a[108:111], a[68:71], v[188:191]
ds_read_b64_tr_b16 a[176:177], v11 offset:57344
ds_read_b64_tr_b16 a[178:179], v11 offset:57856
v_mfma_f32_16x16x32_bf16 v[184:187], a[104:107], a[68:71], v[184:187]
buffer_load_dwordx4 v7, s[16:19], s52 offen lds
v_mfma_f32_16x16x32_bf16 v[180:183], a[100:103], a[68:71], v[180:183]
ds_read_b64_tr_b16 a[180:181], v12 offset:57344
ds_read_b64_tr_b16 a[182:183], v12 offset:57856
v_mfma_f32_16x16x32_bf16 v[176:179], a[96:99], a[68:71], v[176:179]
buffer_load_ushort a208, v17, s[28:31], s48 offen
v_mfma_f32_16x16x32_bf16 v[192:195], a[96:99], a[72:75], v[192:195]
ds_read_b64_tr_b16 a[184:185], v13 offset:57344
ds_read_b64_tr_b16 a[186:187], v13 offset:57856
v_mfma_f32_16x16x32_bf16 v[196:199], a[100:103], a[72:75], v[196:199]
s_add_u32 s48, s68, s69
v_mfma_f32_16x16x32_bf16 v[200:203], a[104:107], a[72:75], v[200:203]
buffer_load_dwordx4 v8, s[16:19], s52 offen offset:1024 lds
v_mfma_f32_16x16x32_bf16 v[204:207], a[108:111], a[72:75], v[204:207]
s_add_u32 s57, s57, 128
s_and_b32 s57, s57, 1023
s_add_u32 s58, s56, s57
v_mfma_f32_16x16x32_bf16 v[64:67], a[72:75], a[112:115], v[64:67]
ds_read_b64_tr_b16 a[188:189], v14 offset:57344
ds_read_b64_tr_b16 a[190:191], v14 offset:57856
v_mfma_f32_16x16x32_bf16 v[72:75], a[72:75], a[116:119], v[72:75]
s_add_u32 m0, s60, 0
s_add_u32 s52, s58, 0
v_mfma_f32_16x16x32_bf16 v[80:83], a[72:75], a[120:123], v[80:83]
ds_read_b64_tr_b16 a[160:161], v11 offset:49152
ds_read_b64_tr_b16 a[162:163], v11 offset:49664
v_mfma_f32_16x16x32_bf16 v[88:91], a[72:75], a[124:127], v[88:91]
buffer_load_dwordx4 v5, s[8:11], s52 offen lds
v_mfma_f32_16x16x32_bf16 v[92:95], a[76:79], a[124:127], v[92:95]
ds_read_b64_tr_b16 a[164:165], v12 offset:49152
ds_read_b64_tr_b16 a[166:167], v12 offset:49664
v_mfma_f32_16x16x32_bf16 v[84:87], a[76:79], a[120:123], v[84:87]
buffer_load_dwordx2 a[194:195], v16, s[28:31], s48 offen
v_mfma_f32_16x16x32_bf16 v[76:79], a[76:79], a[116:119], v[76:79]
ds_read_b64_tr_b16 a[168:169], v13 offset:49152
ds_read_b64_tr_b16 a[170:171], v13 offset:49664
v_mfma_f32_16x16x32_bf16 v[68:71], a[76:79], a[112:115], v[68:71]
v_mfma_f32_16x16x32_bf16 v[220:223], a[108:111], a[76:79], v[220:223]
buffer_load_dwordx4 v6, s[8:11], s52 offen offset:1024 lds
v_mfma_f32_16x16x32_bf16 v[216:219], a[104:107], a[76:79], v[216:219]
ds_read_b64_tr_b16 a[172:173], v14 offset:49152
ds_read_b64_tr_b16 a[174:175], v14 offset:49664
v_mfma_f32_16x16x32_bf16 v[212:215], a[100:103], a[76:79], v[212:215]
buffer_load_ushort a209, v17, s[28:31], s48 offen
v_mfma_f32_16x16x32_bf16 v[208:211], a[96:99], a[76:79], v[208:211]
s_add_u32 m0, s60, 2048
s_add_u32 s52, s58, 16384
v_mfma_f32_16x16x32_bf16 v[224:227], a[96:99], a[80:83], v[224:227]
s_add_u32 s48, s68, s70
v_mfma_f32_16x16x32_bf16 v[228:231], a[100:103], a[80:83], v[228:231]
buffer_load_dwordx4 v5, s[8:11], s52 offen lds
v_mfma_f32_16x16x32_bf16 v[232:235], a[104:107], a[80:83], v[232:235]
buffer_load_dwordx2 a[196:197], v16, s[28:31], s48 offen
v_mfma_f32_16x16x32_bf16 v[236:239], a[108:111], a[80:83], v[236:239]
v_mfma_f32_16x16x32_bf16 v[96:99], a[80:83], a[112:115], v[96:99]
v_mfma_f32_16x16x32_bf16 v[104:107], a[80:83], a[116:119], v[104:107]
buffer_load_dwordx4 v6, s[8:11], s52 offen offset:1024 lds
v_mfma_f32_16x16x32_bf16 v[112:115], a[80:83], a[120:123], v[112:115]
s_add_u32 s62, s62, 524288
s_and_b32 s62, s62, 4194303
s_add_u32 s63, s61, s62
v_mfma_f32_16x16x32_bf16 v[120:123], a[80:83], a[124:127], v[120:123]
buffer_load_ushort a210, v17, s[28:31], s48 offen
v_mfma_f32_16x16x32_bf16 v[124:127], a[84:87], a[124:127], v[124:127]
s_add_u32 m0, s64, 32768
s_add_u32 s52, s63, 0
v_mfma_f32_16x16x32_bf16 v[116:119], a[84:87], a[120:123], v[116:119]
s_add_u32 s48, s68, s69
s_add_u32 s48, s48, s70
v_mfma_f32_16x16x32_bf16 v[108:111], a[84:87], a[116:119], v[108:111]
buffer_load_dwordx4 v7, s[16:19], s52 offen lds
v_mfma_f32_16x16x32_bf16 v[100:103], a[84:87], a[112:115], v[100:103]
buffer_load_dwordx2 a[198:199], v16, s[28:31], s48 offen
v_mfma_f32_16x16x32_bf16 v[252:255], a[108:111], a[84:87], v[252:255]
v_mfma_f32_16x16x32_bf16 v[248:251], a[104:107], a[84:87], v[248:251]
v_mfma_f32_16x16x32_bf16 v[244:247], a[100:103], a[84:87], v[244:247]
buffer_load_ushort a211, v17, s[28:31], s48 offen
v_mfma_f32_16x16x32_bf16 v[240:243], a[96:99], a[84:87], v[240:243]
buffer_load_dwordx4 v8, s[16:19], s52 offen offset:1024 lds
v_mfma_f32_16x16x32_bf16 a[0:3], a[96:99], a[88:91], a[0:3]
s_add_u32 s48, s68, s71
v_mfma_f32_16x16x32_bf16 a[4:7], a[100:103], a[88:91], a[4:7]
buffer_load_dwordx2 a[200:201], v16, s[28:31], s48 offen
v_mfma_f32_16x16x32_bf16 a[8:11], a[104:107], a[88:91], a[8:11]
s_add_u32 m0, s64, 34816
s_add_u32 s52, s63, 131072
v_mfma_f32_16x16x32_bf16 a[12:15], a[108:111], a[88:91], a[12:15]
v_mfma_f32_16x16x32_bf16 v[128:131], a[88:91], a[112:115], v[128:131]
buffer_load_dwordx4 v7, s[16:19], s52 offen lds
v_mfma_f32_16x16x32_bf16 v[136:139], a[88:91], a[116:119], v[136:139]
buffer_load_ushort a212, v17, s[28:31], s48 offen
v_mfma_f32_16x16x32_bf16 v[144:147], a[88:91], a[120:123], v[144:147]
v_mfma_f32_16x16x32_bf16 v[152:155], a[88:91], a[124:127], v[152:155]
s_add_u32 s48, s68, s69
s_add_u32 s48, s48, s71
v_mfma_f32_16x16x32_bf16 v[156:159], a[92:95], a[124:127], v[156:159]
v_add_u32 v9, 32768, v9
v_add_u32 v10, 32768, v10
v_mfma_f32_16x16x32_bf16 v[148:151], a[92:95], a[120:123], v[148:151]
buffer_load_dwordx4 v8, s[16:19], s52 offen offset:1024 lds
v_mfma_f32_16x16x32_bf16 v[140:143], a[92:95], a[116:119], v[140:143]
buffer_load_dwordx2 a[202:203], v16, s[28:31], s48 offen
v_mfma_f32_16x16x32_bf16 v[132:135], a[92:95], a[112:115], v[132:135]
v_mfma_f32_16x16x32_bf16 a[28:31], a[108:111], a[92:95], a[28:31]
v_mfma_f32_16x16x32_bf16 a[24:27], a[104:107], a[92:95], a[24:27]
buffer_load_ushort a213, v17, s[28:31], s48 offen
v_mfma_f32_16x16x32_bf16 a[20:23], a[100:103], a[92:95], a[20:23]
v_mfma_f32_16x16x32_bf16 a[16:19], a[96:99], a[92:95], a[16:19]
s_waitcnt lgkmcnt(0)
s_add_u32 s48, s68, s70
s_add_u32 s48, s48, s71
v_mfma_f32_16x16x32_bf16 v[160:163], a[160:163], a[128:131], v[160:163]
s_waitcnt vmcnt(24)
v_mfma_f32_16x16x32_bf16 v[164:167], a[164:167], a[128:131], v[164:167]
s_barrier
v_mfma_f32_16x16x32_bf16 v[168:171], a[168:171], a[128:131], v[168:171]
ds_read_b128 a[64:67], v9 offset:0
ds_read_b128 a[68:71], v9 offset:2048
v_mfma_f32_16x16x32_bf16 v[172:175], a[172:175], a[128:131], v[172:175]
s_add_u32 m0, s60, 4096
s_add_u32 s52, s58, 32768
v_mfma_f32_16x16x32_bf16 v[32:35], a[128:131], a[176:179], v[32:35]
buffer_load_dwordx4 v5, s[8:11], s52 offen lds
v_mfma_f32_16x16x32_bf16 v[40:43], a[128:131], a[180:183], v[40:43]
ds_read_b128 a[72:75], v9 offset:4096
ds_read_b128 a[76:79], v9 offset:6144
v_mfma_f32_16x16x32_bf16 v[48:51], a[128:131], a[184:187], v[48:51]
buffer_load_dwordx2 a[204:205], v16, s[28:31], s48 offen
v_mfma_f32_16x16x32_bf16 v[56:59], a[128:131], a[188:191], v[56:59]
ds_read_b128 a[80:83], v9 offset:8192
ds_read_b128 a[84:87], v9 offset:10240
v_mfma_f32_16x16x32_bf16 v[60:63], a[132:135], a[188:191], v[60:63]
buffer_load_dwordx4 v6, s[8:11], s52 offen offset:1024 lds
v_mfma_f32_16x16x32_bf16 v[52:55], a[132:135], a[184:187], v[52:55]
ds_read_b128 a[88:91], v9 offset:12288
ds_read_b128 a[92:95], v9 offset:14336
v_mfma_f32_16x16x32_bf16 v[44:47], a[132:135], a[180:183], v[44:47]
buffer_load_ushort a214, v17, s[28:31], s48 offen
v_mfma_f32_16x16x32_bf16 v[36:39], a[132:135], a[176:179], v[36:39]
s_add_u32 m0, s60, 6144
s_add_u32 s52, s58, 49152
v_mfma_f32_16x16x32_bf16 v[188:191], a[172:175], a[132:135], v[188:191]
ds_read_b64_tr_b16 a[112:113], v11 offset:8192
ds_read_b64_tr_b16 a[114:115], v11 offset:8704
v_mfma_f32_16x16x32_bf16 v[184:187], a[168:171], a[132:135], v[184:187]
buffer_load_dwordx4 v5, s[8:11], s52 offen lds
v_mfma_f32_16x16x32_bf16 v[180:183], a[164:167], a[132:135], v[180:183]
ds_read_b64_tr_b16 a[116:117], v12 offset:8192
ds_read_b64_tr_b16 a[118:119], v12 offset:8704
v_mfma_f32_16x16x32_bf16 v[176:179], a[160:163], a[132:135], v[176:179]
s_add_u32 s48, s68, s69
s_add_u32 s48, s48, s70
s_add_u32 s48, s48, s71
v_mfma_f32_16x16x32_bf16 v[192:195], a[160:163], a[136:139], v[192:195]
ds_read_b64_tr_b16 a[120:121], v13 offset:8192
ds_read_b64_tr_b16 a[122:123], v13 offset:8704
v_mfma_f32_16x16x32_bf16 v[196:199], a[164:167], a[136:139], v[196:199]
buffer_load_dwordx2 a[206:207], v16, s[28:31], s48 offen
v_mfma_f32_16x16x32_bf16 v[200:203], a[168:171], a[136:139], v[200:203]
buffer_load_dwordx4 v6, s[8:11], s52 offen offset:1024 lds
v_mfma_f32_16x16x32_bf16 v[204:207], a[172:175], a[136:139], v[204:207]
ds_read_b64_tr_b16 a[124:125], v14 offset:8192
ds_read_b64_tr_b16 a[126:127], v14 offset:8704
v_mfma_f32_16x16x32_bf16 v[64:67], a[136:139], a[176:179], v[64:67]
buffer_load_ushort a215, v17, s[28:31], s48 offen
v_mfma_f32_16x16x32_bf16 v[72:75], a[136:139], a[180:183], v[72:75]
s_add_u32 m0, s64, 49152
s_add_u32 s52, s63, 262144
v_mfma_f32_16x16x32_bf16 v[80:83], a[136:139], a[184:187], v[80:83]
ds_read_b64_tr_b16 a[96:97], v11 offset:0
ds_read_b64_tr_b16 a[98:99], v11 offset:512
v_mfma_f32_16x16x32_bf16 v[88:91], a[136:139], a[188:191], v[88:91]
buffer_load_dwordx4 v7, s[16:19], s52 offen lds
v_mfma_f32_16x16x32_bf16 v[92:95], a[140:143], a[188:191], v[92:95]
ds_read_b64_tr_b16 a[100:101], v12 offset:0
ds_read_b64_tr_b16 a[102:103], v12 offset:512
v_mfma_f32_16x16x32_bf16 v[84:87], a[140:143], a[184:187], v[84:87]
buffer_load_dwordx4 a[216:219], v18, s[36:39], s73 offen
v_mfma_f32_16x16x32_bf16 v[76:79], a[140:143], a[180:183], v[76:79]
ds_read_b64_tr_b16 a[104:105], v13 offset:0
ds_read_b64_tr_b16 a[106:107], v13 offset:512
v_mfma_f32_16x16x32_bf16 v[68:71], a[140:143], a[176:179], v[68:71]
v_mfma_f32_16x16x32_bf16 v[220:223], a[172:175], a[140:143], v[220:223]
buffer_load_dwordx4 v8, s[16:19], s52 offen offset:1024 lds
v_mfma_f32_16x16x32_bf16 v[216:219], a[168:171], a[140:143], v[216:219]
ds_read_b64_tr_b16 a[108:109], v14 offset:0
ds_read_b64_tr_b16 a[110:111], v14 offset:512
v_mfma_f32_16x16x32_bf16 v[212:215], a[164:167], a[140:143], v[212:215]
v_mfma_f32_16x16x32_bf16 v[208:211], a[160:163], a[140:143], v[208:211]
s_add_u32 m0, s64, 51200
s_add_u32 s52, s63, 393216
v_mfma_f32_16x16x32_bf16 v[224:227], a[160:163], a[144:147], v[224:227]
v_mfma_f32_16x16x32_bf16 v[228:231], a[164:167], a[144:147], v[228:231]
buffer_load_dwordx4 v7, s[16:19], s52 offen lds
v_mfma_f32_16x16x32_bf16 v[232:235], a[168:171], a[144:147], v[232:235]
v_mfma_f32_16x16x32_bf16 v[236:239], a[172:175], a[144:147], v[236:239]
v_mfma_f32_16x16x32_bf16 v[96:99], a[144:147], a[176:179], v[96:99]
v_mfma_f32_16x16x32_bf16 v[104:107], a[144:147], a[180:183], v[104:107]
buffer_load_dwordx4 v8, s[16:19], s52 offen offset:1024 lds
v_mfma_f32_16x16x32_bf16 v[112:115], a[144:147], a[184:187], v[112:115]
s_add_u32 s57, s57, 128
s_and_b32 s57, s57, 1023
s_add_u32 s58, s56, s57
v_mfma_f32_16x16x32_bf16 v[120:123], a[144:147], a[188:191], v[120:123]
v_mfma_f32_16x16x32_bf16 v[124:127], a[148:151], a[188:191], v[124:127]
s_add_u32 m0, s60, 32768
s_add_u32 s52, s58, 0
v_mfma_f32_16x16x32_bf16 v[116:119], a[148:151], a[184:187], v[116:119]
v_mfma_f32_16x16x32_bf16 v[108:111], a[148:151], a[180:183], v[108:111]
buffer_load_dwordx4 v5, s[8:11], s52 offen lds
v_mfma_f32_16x16x32_bf16 v[100:103], a[148:151], a[176:179], v[100:103]
v_mfma_f32_16x16x32_bf16 v[252:255], a[172:175], a[148:151], v[252:255]
v_mfma_f32_16x16x32_bf16 v[248:251], a[168:171], a[148:151], v[248:251]
v_mfma_f32_16x16x32_bf16 v[244:247], a[164:167], a[148:151], v[244:247]
v_mfma_f32_16x16x32_bf16 v[240:243], a[160:163], a[148:151], v[240:243]
buffer_load_dwordx4 v6, s[8:11], s52 offen offset:1024 lds
v_mfma_f32_16x16x32_bf16 a[0:3], a[160:163], a[152:155], a[0:3]
v_mfma_f32_16x16x32_bf16 a[4:7], a[164:167], a[152:155], a[4:7]
v_mfma_f32_16x16x32_bf16 a[8:11], a[168:171], a[152:155], a[8:11]
s_add_u32 m0, s60, 34816
s_add_u32 s52, s58, 16384
v_mfma_f32_16x16x32_bf16 a[12:15], a[172:175], a[152:155], a[12:15]
v_mfma_f32_16x16x32_bf16 v[128:131], a[152:155], a[176:179], v[128:131]
buffer_load_dwordx4 v5, s[8:11], s52 offen lds
v_mfma_f32_16x16x32_bf16 v[136:139], a[152:155], a[180:183], v[136:139]
v_mfma_f32_16x16x32_bf16 v[144:147], a[152:155], a[184:187], v[144:147]
v_mfma_f32_16x16x32_bf16 v[152:155], a[152:155], a[188:191], v[152:155]
v_mfma_f32_16x16x32_bf16 v[156:159], a[156:159], a[188:191], v[156:159]
v_mfma_f32_16x16x32_bf16 v[148:151], a[156:159], a[184:187], v[148:151]
buffer_load_dwordx4 v6, s[8:11], s52 offen offset:1024 lds
v_mfma_f32_16x16x32_bf16 v[140:143], a[156:159], a[180:183], v[140:143]
v_mfma_f32_16x16x32_bf16 v[132:135], a[156:159], a[176:179], v[132:135]
v_mfma_f32_16x16x32_bf16 a[28:31], a[172:175], a[156:159], a[28:31]
v_mfma_f32_16x16x32_bf16 a[24:27], a[168:171], a[156:159], a[24:27]
v_mfma_f32_16x16x32_bf16 a[20:23], a[164:167], a[156:159], a[20:23]
v_mfma_f32_16x16x32_bf16 a[16:19], a[160:163], a[156:159], a[16:19]
s_waitcnt lgkmcnt(0)
v_mfma_f32_16x16x32_bf16 v[160:163], a[96:99], a[64:67], v[160:163]
s_waitcnt vmcnt(35)
v_mfma_f32_16x16x32_bf16 v[164:167], a[100:103], a[64:67], v[164:167]
s_barrier
v_mfma_f32_16x16x32_bf16 v[168:171], a[104:107], a[64:67], v[168:171]
ds_read_b128 a[128:131], v10 offset:0
ds_read_b128 a[132:135], v10 offset:2048
v_mfma_f32_16x16x32_bf16 v[172:175], a[108:111], a[64:67], v[172:175]
s_add_u32 s62, s62, 524288
s_and_b32 s62, s62, 4194303
s_add_u32 s63, s61, s62
v_mfma_f32_16x16x32_bf16 v[32:35], a[64:67], a[112:115], v[32:35]
s_add_u32 m0, s64, 0
s_add_u32 s52, s63, 0
v_mfma_f32_16x16x32_bf16 v[40:43], a[64:67], a[116:119], v[40:43]
buffer_load_dwordx4 v7, s[16:19], s52 offen lds
v_mfma_f32_16x16x32_bf16 v[48:51], a[64:67], a[120:123], v[48:51]
ds_read_b128 a[136:139], v10 offset:4096
ds_read_b128 a[140:143], v10 offset:6144
v_mfma_f32_16x16x32_bf16 v[56:59], a[64:67], a[124:127], v[56:59]
v_mfma_f32_16x16x32_bf16 v[60:63], a[68:71], a[124:127], v[60:63]
ds_read_b128 a[144:147], v10 offset:8192
ds_read_b128 a[148:151], v10 offset:10240
v_mfma_f32_16x16x32_bf16 v[52:55], a[68:71], a[120:123], v[52:55]
v_mfma_f32_16x16x32_bf16 v[44:47], a[68:71], a[116:119], v[44:47]
ds_read_b128 a[152:155], v10 offset:12288
ds_read_b128 a[156:159], v10 offset:14336
v_mfma_f32_16x16x32_bf16 v[36:39], a[68:71], a[112:115], v[36:39]
buffer_load_dwordx4 v8, s[16:19], s52 offen offset:1024 lds
v_mfma_f32_16x16x32_bf16 v[188:191], a[108:111], a[68:71], v[188:191]
ds_read_b64_tr_b16 a[176:177], v11 offset:24576
ds_read_b64_tr_b16 a[178:179], v11 offset:25088
v_mfma_f32_16x16x32_bf16 v[184:187], a[104:107], a[68:71], v[184:187]
v_mfma_f32_16x16x32_bf16 v[180:183], a[100:103], a[68:71], v[180:183]
ds_read_b64_tr_b16 a[180:181], v12 offset:24576
ds_read_b64_tr_b16 a[182:183], v12 offset:25088
v_mfma_f32_16x16x32_bf16 v[176:179], a[96:99], a[68:71], v[176:179]
v_mfma_f32_16x16x32_bf16 v[192:195], a[96:99], a[72:75], v[192:195]
s_add_u32 m0, s64, 2048
s_add_u32 s52, s63, 131072
v_mfma_f32_16x16x32_bf16 v[196:199], a[100:103], a[72:75], v[196:199]
ds_read_b64_tr_b16 a[184:185], v13 offset:24576
ds_read_b64_tr_b16 a[186:187], v13 offset:25088
v_mfma_f32_16x16x32_bf16 v[200:203], a[104:107], a[72:75], v[200:203]
buffer_load_dwordx4 v7, s[16:19], s52 offen lds
v_mfma_f32_16x16x32_bf16 v[204:207], a[108:111], a[72:75], v[204:207]
ds_read_b64_tr_b16 a[188:189], v14 offset:24576
ds_read_b64_tr_b16 a[190:191], v14 offset:25088
v_mfma_f32_16x16x32_bf16 v[64:67], a[72:75], a[112:115], v[64:67]
s_waitcnt vmcnt(10)
v_mfma_f32_16x16x32_bf16 v[72:75], a[72:75], a[116:119], v[72:75]
ds_read_b64_tr_b16 a[160:161], v11 offset:16384
ds_read_b64_tr_b16 a[162:163], v11 offset:16896
v_mfma_f32_16x16x32_bf16 v[80:83], a[72:75], a[120:123], v[80:83]
v_accvgpr_read_b32 v16, a192
v_accvgpr_read_b32 v17, a194
v_mfma_f32_16x16x32_bf16 v[88:91], a[72:75], a[124:127], v[88:91]
ds_read_b64_tr_b16 a[164:165], v12 offset:16384
ds_read_b64_tr_b16 a[166:167], v12 offset:16896
v_mfma_f32_16x16x32_bf16 v[92:95], a[76:79], a[124:127], v[92:95]
v_accvgpr_read_b32 v18, a196
v_accvgpr_read_b32 v19, a198
v_mfma_f32_16x16x32_bf16 v[84:87], a[76:79], a[120:123], v[84:87]
buffer_load_dwordx4 v8, s[16:19], s52 offen offset:1024 lds
v_mfma_f32_16x16x32_bf16 v[76:79], a[76:79], a[116:119], v[76:79]
ds_read_b64_tr_b16 a[168:169], v13 offset:16384
ds_read_b64_tr_b16 a[170:171], v13 offset:16896
v_mfma_f32_16x16x32_bf16 v[68:71], a[76:79], a[112:115], v[68:71]
v_accvgpr_read_b32 v20, a200
v_accvgpr_read_b32 v21, a202
v_mfma_f32_16x16x32_bf16 v[220:223], a[108:111], a[76:79], v[220:223]
ds_read_b64_tr_b16 a[172:173], v14 offset:16384
ds_read_b64_tr_b16 a[174:175], v14 offset:16896
v_mfma_f32_16x16x32_bf16 v[216:219], a[104:107], a[76:79], v[216:219]
v_accvgpr_read_b32 v22, a204
v_accvgpr_read_b32 v23, a206
v_mfma_f32_16x16x32_bf16 v[212:215], a[100:103], a[76:79], v[212:215]
v_mfma_f32_16x16x32_bf16 v[208:211], a[96:99], a[76:79], v[208:211]
s_add_u32 m0, s60, 36864
s_add_u32 s52, s58, 32768
v_perm_b32 v24, v17, v16, s81
v_mfma_f32_16x16x32_bf16 v[224:227], a[96:99], a[80:83], v[224:227]
v_perm_b32 v25, v19, v18, s81
v_perm_b32 v26, v21, v20, s81
v_mfma_f32_16x16x32_bf16 v[228:231], a[100:103], a[80:83], v[228:231]
buffer_load_dwordx4 v5, s[8:11], s52 offen lds
v_mfma_f32_16x16x32_bf16 v[232:235], a[104:107], a[80:83], v[232:235]
v_perm_b32 v27, v23, v22, s81
v_perm_b32 v28, v17, v16, s82
v_mfma_f32_16x16x32_bf16 v[236:239], a[108:111], a[80:83], v[236:239]
v_perm_b32 v29, v19, v18, s82
v_perm_b32 v30, v21, v20, s82
v_mfma_f32_16x16x32_bf16 v[96:99], a[80:83], a[112:115], v[96:99]
v_perm_b32 v31, v23, v22, s82
v_accvgpr_read_b32 v16, a216
v_mfma_f32_16x16x32_bf16 v[104:107], a[80:83], a[116:119], v[104:107]
v_accvgpr_read_b32 v17, a217
v_accvgpr_read_b32 v18, a218
v_mfma_f32_16x16x32_bf16 v[112:115], a[80:83], a[120:123], v[112:115]
v_accvgpr_read_b32 v19, a219
v_or_b32 v24, v24, v16
v_mfma_f32_16x16x32_bf16 v[120:123], a[80:83], a[124:127], v[120:123]
v_or_b32 v25, v25, v17
v_or_b32 v26, v26, v18
v_mfma_f32_16x16x32_bf16 v[124:127], a[84:87], a[124:127], v[124:127]
buffer_load_dwordx4 v6, s[8:11], s52 offen offset:1024 lds
v_mfma_f32_16x16x32_bf16 v[116:119], a[84:87], a[120:123], v[116:119]
v_or_b32 v27, v27, v19
v_mfma_f32_16x16x32_bf16 v[108:111], a[84:87], a[116:119], v[108:111]
buffer_store_dwordx4 v[24:27], v4, s[24:27], s72 offen offset:0 sc1
v_mfma_f32_16x16x32_bf16 v[100:103], a[84:87], a[112:115], v[100:103]
v_mfma_f32_16x16x32_bf16 v[252:255], a[108:111], a[84:87], v[252:255]
v_mfma_f32_16x16x32_bf16 v[248:251], a[104:107], a[84:87], v[248:251]
s_add_u32 m0, s60, 38912
s_add_u32 s52, s58, 49152
v_mfma_f32_16x16x32_bf16 v[244:247], a[100:103], a[84:87], v[244:247]
buffer_store_dwordx4 v[28:31], v4, s[24:27], s72 offen offset:1024 sc1
v_mfma_f32_16x16x32_bf16 v[240:243], a[96:99], a[84:87], v[240:243]
buffer_load_dwordx4 v5, s[8:11], s52 offen lds
v_mfma_f32_16x16x32_bf16 a[0:3], a[96:99], a[88:91], a[0:3]
v_accvgpr_read_b32 v16, a193
v_accvgpr_read_b32 v17, a195
v_mfma_f32_16x16x32_bf16 a[4:7], a[100:103], a[88:91], a[4:7]
v_accvgpr_read_b32 v18, a197
v_accvgpr_read_b32 v19, a199
v_mfma_f32_16x16x32_bf16 a[8:11], a[104:107], a[88:91], a[8:11]
v_accvgpr_read_b32 v20, a201
v_accvgpr_read_b32 v21, a203
v_mfma_f32_16x16x32_bf16 a[12:15], a[108:111], a[88:91], a[12:15]
v_accvgpr_read_b32 v22, a205
v_accvgpr_read_b32 v23, a207
v_mfma_f32_16x16x32_bf16 v[128:131], a[88:91], a[112:115], v[128:131]
v_mfma_f32_16x16x32_bf16 v[136:139], a[88:91], a[116:119], v[136:139]
v_perm_b32 v24, v17, v16, s81
v_perm_b32 v25, v19, v18, s81
v_mfma_f32_16x16x32_bf16 v[144:147], a[88:91], a[120:123], v[144:147]
buffer_load_dwordx4 v6, s[8:11], s52 offen offset:1024 lds
v_mfma_f32_16x16x32_bf16 v[152:155], a[88:91], a[124:127], v[152:155]
v_perm_b32 v26, v21, v20, s81
v_perm_b32 v27, v23, v22, s81
v_mfma_f32_16x16x32_bf16 v[156:159], a[92:95], a[124:127], v[156:159]
v_add_u32 v9, -65536, v9
v_add_u32 v10, -65536, v10
v_mfma_f32_16x16x32_bf16 v[148:151], a[92:95], a[120:123], v[148:151]
v_perm_b32 v28, v17, v16, s82
v_perm_b32 v29, v19, v18, s82
v_mfma_f32_16x16x32_bf16 v[140:143], a[92:95], a[116:119], v[140:143]
v_perm_b32 v30, v21, v20, s82
v_perm_b32 v31, v23, v22, s82
v_mfma_f32_16x16x32_bf16 v[132:135], a[92:95], a[112:115], v[132:135]
buffer_store_dwordx4 v[24:27], v4, s[24:27], s72 offen offset:2048 sc1
v_mfma_f32_16x16x32_bf16 a[28:31], a[108:111], a[92:95], a[28:31]
v_mfma_f32_16x16x32_bf16 a[24:27], a[104:107], a[92:95], a[24:27]
v_mfma_f32_16x16x32_bf16 a[20:23], a[100:103], a[92:95], a[20:23]
v_mfma_f32_16x16x32_bf16 a[16:19], a[96:99], a[92:95], a[16:19]
s_waitcnt lgkmcnt(0)
v_mfma_f32_16x16x32_bf16 v[160:163], a[160:163], a[128:131], v[160:163]
s_waitcnt vmcnt(21)
v_mfma_f32_16x16x32_bf16 v[164:167], a[164:167], a[128:131], v[164:167]
s_barrier
v_mfma_f32_16x16x32_bf16 v[168:171], a[168:171], a[128:131], v[168:171]
ds_read_b128 a[64:67], v9 offset:0
ds_read_b128 a[68:71], v9 offset:2048
v_mfma_f32_16x16x32_bf16 v[172:175], a[172:175], a[128:131], v[172:175]
s_add_u32 m0, s64, 16384
s_add_u32 s52, s63, 262144
v_mfma_f32_16x16x32_bf16 v[32:35], a[128:131], a[176:179], v[32:35]
buffer_load_dwordx4 v7, s[16:19], s52 offen lds
v_mfma_f32_16x16x32_bf16 v[40:43], a[128:131], a[180:183], v[40:43]
ds_read_b128 a[72:75], v9 offset:4096
ds_read_b128 a[76:79], v9 offset:6144
v_mfma_f32_16x16x32_bf16 v[48:51], a[128:131], a[184:187], v[48:51]
buffer_store_dwordx4 v[28:31], v4, s[24:27], s72 offen offset:3072 sc1
v_mfma_f32_16x16x32_bf16 v[56:59], a[128:131], a[188:191], v[56:59]
ds_read_b128 a[80:83], v9 offset:8192
ds_read_b128 a[84:87], v9 offset:10240
v_mfma_f32_16x16x32_bf16 v[60:63], a[132:135], a[188:191], v[60:63]
v_accvgpr_read_b32 v16, a208
v_accvgpr_read_b32 v17, a209
v_mfma_f32_16x16x32_bf16 v[52:55], a[132:135], a[184:187], v[52:55]
ds_read_b128 a[88:91], v9 offset:12288
ds_read_b128 a[92:95], v9 offset:14336
v_mfma_f32_16x16x32_bf16 v[44:47], a[132:135], a[180:183], v[44:47]
v_accvgpr_read_b32 v18, a210
v_accvgpr_read_b32 v19, a211
v_mfma_f32_16x16x32_bf16 v[36:39], a[132:135], a[176:179], v[36:39]
buffer_load_dwordx4 v8, s[16:19], s52 offen offset:1024 lds
v_mfma_f32_16x16x32_bf16 v[188:191], a[172:175], a[132:135], v[188:191]
ds_read_b64_tr_b16 a[112:113], v11 offset:40960
ds_read_b64_tr_b16 a[114:115], v11 offset:41472
v_mfma_f32_16x16x32_bf16 v[184:187], a[168:171], a[132:135], v[184:187]
v_accvgpr_read_b32 v20, a212
v_accvgpr_read_b32 v21, a213
v_mfma_f32_16x16x32_bf16 v[180:183], a[164:167], a[132:135], v[180:183]
ds_read_b64_tr_b16 a[116:117], v12 offset:40960
ds_read_b64_tr_b16 a[118:119], v12 offset:41472
v_mfma_f32_16x16x32_bf16 v[176:179], a[160:163], a[132:135], v[176:179]
v_accvgpr_read_b32 v22, a214
v_accvgpr_read_b32 v23, a215
v_mfma_f32_16x16x32_bf16 v[192:195], a[160:163], a[136:139], v[192:195]
s_add_u32 m0, s64, 18432
s_add_u32 s52, s63, 393216
v_mfma_f32_16x16x32_bf16 v[196:199], a[164:167], a[136:139], v[196:199]
ds_read_b64_tr_b16 a[120:121], v13 offset:40960
ds_read_b64_tr_b16 a[122:123], v13 offset:41472
v_mfma_f32_16x16x32_bf16 v[200:203], a[168:171], a[136:139], v[200:203]
buffer_load_dwordx4 v7, s[16:19], s52 offen lds
v_mfma_f32_16x16x32_bf16 v[204:207], a[172:175], a[136:139], v[204:207]
ds_read_b64_tr_b16 a[124:125], v14 offset:40960
ds_read_b64_tr_b16 a[126:127], v14 offset:41472
v_mfma_f32_16x16x32_bf16 v[64:67], a[136:139], a[176:179], v[64:67]
v_lshl_or_b32 v24, v17, 16, v16
v_lshl_or_b32 v25, v19, 16, v18
v_mfma_f32_16x16x32_bf16 v[72:75], a[136:139], a[180:183], v[72:75]
ds_read_b64_tr_b16 a[96:97], v11 offset:32768
ds_read_b64_tr_b16 a[98:99], v11 offset:33280
v_mfma_f32_16x16x32_bf16 v[80:83], a[136:139], a[184:187], v[80:83]
v_lshl_or_b32 v26, v21, 16, v20
v_lshl_or_b32 v27, v23, 16, v22
v_mfma_f32_16x16x32_bf16 v[88:91], a[136:139], a[188:191], v[88:91]
ds_read_b64_tr_b16 a[100:101], v12 offset:32768
ds_read_b64_tr_b16 a[102:103], v12 offset:33280
v_mfma_f32_16x16x32_bf16 v[92:95], a[140:143], a[188:191], v[92:95]
v_accvgpr_read_b32 v16, a222
v_mfma_f32_16x16x32_bf16 v[84:87], a[140:143], a[184:187], v[84:87]
buffer_load_dwordx4 v8, s[16:19], s52 offen offset:1024 lds
v_mfma_f32_16x16x32_bf16 v[76:79], a[140:143], a[180:183], v[76:79]
s_add_u32 s57, s57, 128
s_and_b32 s57, s57, 1023
s_add_u32 s58, s56, s57
v_mfma_f32_16x16x32_bf16 v[68:71], a[140:143], a[176:179], v[68:71]
ds_read_b64_tr_b16 a[104:105], v13 offset:32768
ds_read_b64_tr_b16 a[106:107], v13 offset:33280
v_mfma_f32_16x16x32_bf16 v[220:223], a[172:175], a[140:143], v[220:223]
buffer_store_dwordx4 v[24:27], v16, s[24:27], s72 offen sc1
v_mfma_f32_16x16x32_bf16 v[216:219], a[168:171], a[140:143], v[216:219]
ds_read_b64_tr_b16 a[108:109], v14 offset:32768
ds_read_b64_tr_b16 a[110:111], v14 offset:33280
v_mfma_f32_16x16x32_bf16 v[212:215], a[164:167], a[140:143], v[212:215]
s_lshl_b32 s48, s4, 2
v_mov_b32 v30, s48
v_mfma_f32_16x16x32_bf16 v[208:211], a[160:163], a[140:143], v[208:211]
s_add_u32 m0, s60, 65536
s_add_u32 s52, s58, 0
v_mfma_f32_16x16x32_bf16 v[224:227], a[160:163], a[144:147], v[224:227]
buffer_load_dword v31, v30, s[40:43], 0 offen sc1
v_mfma_f32_16x16x32_bf16 v[228:231], a[164:167], a[144:147], v[228:231]
buffer_load_dwordx4 v5, s[8:11], s52 offen lds
v_mfma_f32_16x16x32_bf16 v[232:235], a[168:171], a[144:147], v[232:235]
v_mfma_f32_16x16x32_bf16 v[236:239], a[172:175], a[144:147], v[236:239]
v_mfma_f32_16x16x32_bf16 v[96:99], a[144:147], a[176:179], v[96:99]
v_mfma_f32_16x16x32_bf16 v[104:107], a[144:147], a[180:183], v[104:107]
v_mfma_f32_16x16x32_bf16 v[112:115], a[144:147], a[184:187], v[112:115]
v_mfma_f32_16x16x32_bf16 v[120:123], a[144:147], a[188:191], v[120:123]
v_mfma_f32_16x16x32_bf16 v[124:127], a[148:151], a[188:191], v[124:127]
buffer_load_dwordx4 v6, s[8:11], s52 offen offset:1024 lds
v_mfma_f32_16x16x32_bf16 v[116:119], a[148:151], a[184:187], v[116:119]
v_mfma_f32_16x16x32_bf16 v[108:111], a[148:151], a[180:183], v[108:111]
v_mfma_f32_16x16x32_bf16 v[100:103], a[148:151], a[176:179], v[100:103]
v_mfma_f32_16x16x32_bf16 v[252:255], a[172:175], a[148:151], v[252:255]
v_mfma_f32_16x16x32_bf16 v[248:251], a[168:171], a[148:151], v[248:251]
s_add_u32 m0, s60, 67584
s_add_u32 s52, s58, 16384
v_mfma_f32_16x16x32_bf16 v[244:247], a[164:167], a[148:151], v[244:247]
v_mfma_f32_16x16x32_bf16 v[240:243], a[160:163], a[148:151], v[240:243]
buffer_load_dwordx4 v5, s[8:11], s52 offen lds
v_mfma_f32_16x16x32_bf16 a[0:3], a[160:163], a[152:155], a[0:3]
v_mfma_f32_16x16x32_bf16 a[4:7], a[164:167], a[152:155], a[4:7]
v_mfma_f32_16x16x32_bf16 a[8:11], a[168:171], a[152:155], a[8:11]
v_mfma_f32_16x16x32_bf16 a[12:15], a[172:175], a[152:155], a[12:15]
v_mfma_f32_16x16x32_bf16 v[128:131], a[152:155], a[176:179], v[128:131]
v_mfma_f32_16x16x32_bf16 v[136:139], a[152:155], a[180:183], v[136:139]
v_mfma_f32_16x16x32_bf16 v[144:147], a[152:155], a[184:187], v[144:147]
buffer_load_dwordx4 v6, s[8:11], s52 offen offset:1024 lds
v_mfma_f32_16x16x32_bf16 v[152:155], a[152:155], a[188:191], v[152:155]
v_mfma_f32_16x16x32_bf16 v[156:159], a[156:159], a[188:191], v[156:159]
v_mfma_f32_16x16x32_bf16 v[148:151], a[156:159], a[184:187], v[148:151]
v_mfma_f32_16x16x32_bf16 v[140:143], a[156:159], a[180:183], v[140:143]
v_mfma_f32_16x16x32_bf16 v[132:135], a[156:159], a[176:179], v[132:135]
v_mfma_f32_16x16x32_bf16 a[28:31], a[172:175], a[156:159], a[28:31]
v_mfma_f32_16x16x32_bf16 a[24:27], a[168:171], a[156:159], a[24:27]
v_mfma_f32_16x16x32_bf16 a[20:23], a[164:167], a[156:159], a[20:23]
v_mfma_f32_16x16x32_bf16 a[16:19], a[160:163], a[156:159], a[16:19]
s_waitcnt lgkmcnt(0)
v_mfma_f32_16x16x32_bf16 v[160:163], a[96:99], a[64:67], v[160:163]
s_waitcnt vmcnt(26)
v_mfma_f32_16x16x32_bf16 v[164:167], a[100:103], a[64:67], v[164:167]
s_barrier
v_mfma_f32_16x16x32_bf16 v[168:171], a[104:107], a[64:67], v[168:171]
ds_read_b128 a[128:131], v10 offset:0
ds_read_b128 a[132:135], v10 offset:2048
v_mfma_f32_16x16x32_bf16 v[172:175], a[108:111], a[64:67], v[172:175]
s_add_u32 s62, s62, 524288
s_and_b32 s62, s62, 4194303
s_add_u32 s63, s61, s62
v_mfma_f32_16x16x32_bf16 v[32:35], a[64:67], a[112:115], v[32:35]
s_add_u32 m0, s64, 32768
s_add_u32 s52, s63, 0
v_mfma_f32_16x16x32_bf16 v[40:43], a[64:67], a[116:119], v[40:43]
buffer_load_dwordx4 v7, s[16:19], s52 offen lds
v_mfma_f32_16x16x32_bf16 v[48:51], a[64:67], a[120:123], v[48:51]
s_waitcnt vmcnt(5)
ds_read_b128 a[136:139], v10 offset:4096
ds_read_b128 a[140:143], v10 offset:6144
v_mfma_f32_16x16x32_bf16 v[56:59], a[64:67], a[124:127], v[56:59]
v_cmp_gt_u32 vcc, 1, v31
v_mfma_f32_16x16x32_bf16 v[60:63], a[68:71], a[124:127], v[60:63]
ds_read_b128 a[144:147], v10 offset:8192
ds_read_b128 a[148:151], v10 offset:10240
v_mfma_f32_16x16x32_bf16 v[52:55], a[68:71], a[120:123], v[52:55]
v_mfma_f32_16x16x32_bf16 v[44:47], a[68:71], a[116:119], v[44:47]
ds_read_b128 a[152:155], v10 offset:12288
ds_read_b128 a[156:159], v10 offset:14336
v_mfma_f32_16x16x32_bf16 v[36:39], a[68:71], a[112:115], v[36:39]
buffer_load_dwordx4 v8, s[16:19], s52 offen offset:1024 lds
v_mfma_f32_16x16x32_bf16 v[188:191], a[108:111], a[68:71], v[188:191]
ds_read_b64_tr_b16 a[176:177], v11 offset:57344
ds_read_b64_tr_b16 a[178:179], v11 offset:57856
v_mfma_f32_16x16x32_bf16 v[184:187], a[104:107], a[68:71], v[184:187]
s_cbranch_vccnz CK_Z
CK_Z_R:
v_mfma_f32_16x16x32_bf16 v[180:183], a[100:103], a[68:71], v[180:183]
ds_read_b64_tr_b16 a[180:181], v12 offset:57344
ds_read_b64_tr_b16 a[182:183], v12 offset:57856
v_mfma_f32_16x16x32_bf16 v[176:179], a[96:99], a[68:71], v[176:179]
v_mfma_f32_16x16x32_bf16 v[192:195], a[96:99], a[72:75], v[192:195]
s_add_u32 m0, s64, 34816
s_add_u32 s52, s63, 131072
v_mfma_f32_16x16x32_bf16 v[196:199], a[100:103], a[72:75], v[196:199]
ds_read_b64_tr_b16 a[184:185], v13 offset:57344
ds_read_b64_tr_b16 a[186:187], v13 offset:57856
v_mfma_f32_16x16x32_bf16 v[200:203], a[104:107], a[72:75], v[200:203]
buffer_load_dwordx4 v7, s[16:19], s52 offen lds
v_mfma_f32_16x16x32_bf16 v[204:207], a[108:111], a[72:75], v[204:207]
ds_read_b64_tr_b16 a[188:189], v14 offset:57344
ds_read_b64_tr_b16 a[190:191], v14 offset:57856
v_mfma_f32_16x16x32_bf16 v[64:67], a[72:75], a[112:115], v[64:67]
v_mfma_f32_16x16x32_bf16 v[72:75], a[72:75], a[116:119], v[72:75]
ds_read_b64_tr_b16 a[160:161], v11 offset:49152
ds_read_b64_tr_b16 a[162:163], v11 offset:49664
v_mfma_f32_16x16x32_bf16 v[80:83], a[72:75], a[120:123], v[80:83]
v_mfma_f32_16x16x32_bf16 v[88:91], a[72:75], a[124:127], v[88:91]
ds_read_b64_tr_b16 a[164:165], v12 offset:49152
ds_read_b64_tr_b16 a[166:167], v12 offset:49664
v_mfma_f32_16x16x32_bf16 v[92:95], a[76:79], a[124:127], v[92:95]
v_mfma_f32_16x16x32_bf16 v[84:87], a[76:79], a[120:123], v[84:87]
buffer_load_dwordx4 v8, s[16:19], s52 offen offset:1024 lds
v_mfma_f32_16x16x32_bf16 v[76:79], a[76:79], a[116:119], v[76:79]
ds_read_b64_tr_b16 a[168:169], v13 offset:49152
ds_read_b64_tr_b16 a[170:171], v13 offset:49664
v_mfma_f32_16x16x32_bf16 v[68:71], a[76:79], a[112:115], v[68:71]
v_mfma_f32_16x16x32_bf16 v[220:223], a[108:111], a[76:79], v[220:223]
ds_read_b64_tr_b16 a[172:173], v14 offset:49152
ds_read_b64_tr_b16 a[174:175], v14 offset:49664
v_mfma_f32_16x16x32_bf16 v[216:219], a[104:107], a[76:79], v[216:219]
v_mfma_f32_16x16x32_bf16 v[212:215], a[100:103], a[76:79], v[212:215]
v_mfma_f32_16x16x32_bf16 v[208:211], a[96:99], a[76:79], v[208:211]
s_add_u32 m0, s60, 69632
s_add_u32 s52, s58, 32768
v_mfma_f32_16x16x32_bf16 v[224:227], a[96:99], a[80:83], v[224:227]
v_mfma_f32_16x16x32_bf16 v[228:231], a[100:103], a[80:83], v[228:231]
buffer_load_dwordx4 v5, s[8:11], s52 offen lds
v_mfma_f32_16x16x32_bf16 v[232:235], a[104:107], a[80:83], v[232:235]
v_mfma_f32_16x16x32_bf16 v[236:239], a[108:111], a[80:83], v[236:239]
v_mfma_f32_16x16x32_bf16 v[96:99], a[80:83], a[112:115], v[96:99]
v_mfma_f32_16x16x32_bf16 v[104:107], a[80:83], a[116:119], v[104:107]
v_mfma_f32_16x16x32_bf16 v[112:115], a[80:83], a[120:123], v[112:115]
v_mfma_f32_16x16x32_bf16 v[120:123], a[80:83], a[124:127], v[120:123]
v_mfma_f32_16x16x32_bf16 v[124:127], a[84:87], a[124:127], v[124:127]
buffer_load_dwordx4 v6, s[8:11], s52 offen offset:1024 lds
v_mfma_f32_16x16x32_bf16 v[116:119], a[84:87], a[120:123], v[116:119]
v_mfma_f32_16x16x32_bf16 v[108:111], a[84:87], a[116:119], v[108:111]
v_mfma_f32_16x16x32_bf16 v[100:103], a[84:87], a[112:115], v[100:103]
v_mfma_f32_16x16x32_bf16 v[252:255], a[108:111], a[84:87], v[252:255]
v_mfma_f32_16x16x32_bf16 v[248:251], a[104:107], a[84:87], v[248:251]
s_add_u32 m0, s60, 71680
s_add_u32 s52, s58, 49152
v_mfma_f32_16x16x32_bf16 v[244:247], a[100:103], a[84:87], v[244:247]
v_mfma_f32_16x16x32_bf16 v[240:243], a[96:99], a[84:87], v[240:243]
buffer_load_dwordx4 v5, s[8:11], s52 offen lds
v_mfma_f32_16x16x32_bf16 a[0:3], a[96:99], a[88:91], a[0:3]
v_mfma_f32_16x16x32_bf16 a[4:7], a[100:103], a[88:91], a[4:7]
v_mfma_f32_16x16x32_bf16 a[8:11], a[104:107], a[88:91], a[8:11]
v_mfma_f32_16x16x32_bf16 a[12:15], a[108:111], a[88:91], a[12:15]
v_mfma_f32_16x16x32_bf16 v[128:131], a[88:91], a[112:115], v[128:131]
v_mfma_f32_16x16x32_bf16 v[136:139], a[88:91], a[116:119], v[136:139]
v_mfma_f32_16x16x32_bf16 v[144:147], a[88:91], a[120:123], v[144:147]
buffer_load_dwordx4 v6, s[8:11], s52 offen offset:1024 lds
v_mfma_f32_16x16x32_bf16 v[152:155], a[88:91], a[124:127], v[152:155]
v_mfma_f32_16x16x32_bf16 v[156:159], a[92:95], a[124:127], v[156:159]
v_add_u32 v9, 32768, v9
v_add_u32 v10, 32768, v10
v_mfma_f32_16x16x32_bf16 v[148:151], a[92:95], a[120:123], v[148:151]
v_mfma_f32_16x16x32_bf16 v[140:143], a[92:95], a[116:119], v[140:143]
v_mfma_f32_16x16x32_bf16 v[132:135], a[92:95], a[112:115], v[132:135]
v_mfma_f32_16x16x32_bf16 a[28:31], a[108:111], a[92:95], a[28:31]
v_mfma_f32_16x16x32_bf16 a[24:27], a[104:107], a[92:95], a[24:27]
v_mfma_f32_16x16x32_bf16 a[20:23], a[100:103], a[92:95], a[20:23]
v_mfma_f32_16x16x32_bf16 a[16:19], a[96:99], a[92:95], a[16:19]
s_waitcnt lgkmcnt(0)
v_mfma_f32_16x16x32_bf16 v[160:163], a[160:163], a[128:131], v[160:163]
s_waitcnt vmcnt(20)
v_mfma_f32_16x16x32_bf16 v[164:167], a[164:167], a[128:131], v[164:167]
s_barrier
v_mfma_f32_16x16x32_bf16 v[168:171], a[168:171], a[128:131], v[168:171]
ds_read_b128 a[64:67], v9 offset:0
ds_read_b128 a[68:71], v9 offset:2048
v_mfma_f32_16x16x32_bf16 v[172:175], a[172:175], a[128:131], v[172:175]
s_add_u32 m0, s64, 49152
s_add_u32 s52, s63, 262144
v_accvgpr_read_b32 v16, a223
v_mfma_f32_16x16x32_bf16 v[32:35], a[128:131], a[176:179], v[32:35]
buffer_load_dwordx4 v7, s[16:19], s52 offen lds
v_mfma_f32_16x16x32_bf16 v[40:43], a[128:131], a[180:183], v[40:43]
ds_read_b128 a[72:75], v9 offset:4096
ds_read_b128 a[76:79], v9 offset:6144
v_mfma_f32_16x16x32_bf16 v[48:51], a[128:131], a[184:187], v[48:51]
v_accvgpr_read_b32 v17, a224
v_mfma_f32_16x16x32_bf16 v[56:59], a[128:131], a[188:191], v[56:59]
s_add_u32 s48, s74, 0
ds_read_b128 a[80:83], v9 offset:8192
ds_read_b128 a[84:87], v9 offset:10240
v_mfma_f32_16x16x32_bf16 v[60:63], a[132:135], a[188:191], v[60:63]
buffer_load_dwordx2 a[192:193], v16, s[32:35], s48 offen
v_mfma_f32_16x16x32_bf16 v[52:55], a[132:135], a[184:187], v[52:55]
ds_read_b128 a[88:91], v9 offset:12288
ds_read_b128 a[92:95], v9 offset:14336
v_mfma_f32_16x16x32_bf16 v[44:47], a[132:135], a[180:183], v[44:47]
v_mfma_f32_16x16x32_bf16 v[36:39], a[132:135], a[176:179], v[36:39]
buffer_load_dwordx4 v8, s[16:19], s52 offen offset:1024 lds
v_mfma_f32_16x16x32_bf16 v[188:191], a[172:175], a[132:135], v[188:191]
ds_read_b64_tr_b16 a[112:113], v11 offset:8192
ds_read_b64_tr_b16 a[114:115], v11 offset:8704
v_mfma_f32_16x16x32_bf16 v[184:187], a[168:171], a[132:135], v[184:187]
buffer_load_ushort a208, v17, s[32:35], s48 offen
v_mfma_f32_16x16x32_bf16 v[180:183], a[164:167], a[132:135], v[180:183]
ds_read_b64_tr_b16 a[116:117], v12 offset:8192
ds_read_b64_tr_b16 a[118:119], v12 offset:8704
v_mfma_f32_16x16x32_bf16 v[176:179], a[160:163], a[132:135], v[176:179]
s_add_u32 s48, s74, 1152
v_mfma_f32_16x16x32_bf16 v[192:195], a[160:163], a[136:139], v[192:195]
s_add_u32 m0, s64, 51200
s_add_u32 s52, s63, 393216
v_mfma_f32_16x16x32_bf16 v[196:199], a[164:167], a[136:139], v[196:199]
ds_read_b64_tr_b16 a[120:121], v13 offset:8192
ds_read_b64_tr_b16 a[122:123], v13 offset:8704
v_mfma_f32_16x16x32_bf16 v[200:203], a[168:171], a[136:139], v[200:203]
buffer_load_dwordx4 v7, s[16:19], s52 offen lds
v_mfma_f32_16x16x32_bf16 v[204:207], a[172:175], a[136:139], v[204:207]
ds_read_b64_tr_b16 a[124:125], v14 offset:8192
ds_read_b64_tr_b16 a[126:127], v14 offset:8704
v_mfma_f32_16x16x32_bf16 v[64:67], a[136:139], a[176:179], v[64:67]
buffer_load_dwordx2 a[194:195], v16, s[32:35], s48 offen
v_mfma_f32_16x16x32_bf16 v[72:75], a[136:139], a[180:183], v[72:75]
ds_read_b64_tr_b16 a[96:97], v11 offset:0
ds_read_b64_tr_b16 a[98:99], v11 offset:512
v_mfma_f32_16x16x32_bf16 v[80:83], a[136:139], a[184:187], v[80:83]
v_mfma_f32_16x16x32_bf16 v[88:91], a[136:139], a[188:191], v[88:91]
ds_read_b64_tr_b16 a[100:101], v12 offset:0
ds_read_b64_tr_b16 a[102:103], v12 offset:512
v_mfma_f32_16x16x32_bf16 v[92:95], a[140:143], a[188:191], v[92:95]
buffer_load_ushort a209, v17, s[32:35], s48 offen
v_mfma_f32_16x16x32_bf16 v[84:87], a[140:143], a[184:187], v[84:87]
buffer_load_dwordx4 v8, s[16:19], s52 offen offset:1024 lds
v_mfma_f32_16x16x32_bf16 v[76:79], a[140:143], a[180:183], v[76:79]
s_add_u32 s57, s57, 128
s_and_b32 s57, s57, 1023
s_add_u32 s58, s56, s57
v_mfma_f32_16x16x32_bf16 v[68:71], a[140:143], a[176:179], v[68:71]
s_add_u32 s48, s74, 2304
ds_read_b64_tr_b16 a[104:105], v13 offset:0
ds_read_b64_tr_b16 a[106:107], v13 offset:512
v_mfma_f32_16x16x32_bf16 v[220:223], a[172:175], a[140:143], v[220:223]
buffer_load_dwordx2 a[196:197], v16, s[32:35], s48 offen
v_mfma_f32_16x16x32_bf16 v[216:219], a[168:171], a[140:143], v[216:219]
ds_read_b64_tr_b16 a[108:109], v14 offset:0
ds_read_b64_tr_b16 a[110:111], v14 offset:512
v_mfma_f32_16x16x32_bf16 v[212:215], a[164:167], a[140:143], v[212:215]
v_mfma_f32_16x16x32_bf16 v[208:211], a[160:163], a[140:143], v[208:211]
s_add_u32 m0, s60, 0
s_add_u32 s52, s58, 0
v_mfma_f32_16x16x32_bf16 v[224:227], a[160:163], a[144:147], v[224:227]
buffer_load_ushort a210, v17, s[32:35], s48 offen
v_mfma_f32_16x16x32_bf16 v[228:231], a[164:167], a[144:147], v[228:231]
buffer_load_dwordx4 v5, s[8:11], s52 offen lds
v_mfma_f32_16x16x32_bf16 v[232:235], a[168:171], a[144:147], v[232:235]
s_add_u32 s48, s74, 3456
v_mfma_f32_16x16x32_bf16 v[236:239], a[172:175], a[144:147], v[236:239]
buffer_load_dwordx2 a[198:199], v16, s[32:35], s48 offen
v_mfma_f32_16x16x32_bf16 v[96:99], a[144:147], a[176:179], v[96:99]
v_mfma_f32_16x16x32_bf16 v[104:107], a[144:147], a[180:183], v[104:107]
v_mfma_f32_16x16x32_bf16 v[112:115], a[144:147], a[184:187], v[112:115]
buffer_load_ushort a211, v17, s[32:35], s48 offen
v_mfma_f32_16x16x32_bf16 v[120:123], a[144:147], a[188:191], v[120:123]
v_mfma_f32_16x16x32_bf16 v[124:127], a[148:151], a[188:191], v[124:127]
buffer_load_dwordx4 v6, s[8:11], s52 offen offset:1024 lds
v_mfma_f32_16x16x32_bf16 v[116:119], a[148:151], a[184:187], v[116:119]
s_add_u32 s48, s74, 18432
v_mfma_f32_16x16x32_bf16 v[108:111], a[148:151], a[180:183], v[108:111]
buffer_load_dwordx2 a[200:201], v16, s[32:35], s48 offen
v_mfma_f32_16x16x32_bf16 v[100:103], a[148:151], a[176:179], v[100:103]
v_mfma_f32_16x16x32_bf16 v[252:255], a[172:175], a[148:151], v[252:255]
v_mfma_f32_16x16x32_bf16 v[248:251], a[168:171], a[148:151], v[248:251]
s_add_u32 m0, s60, 2048
s_add_u32 s52, s58, 16384
v_mfma_f32_16x16x32_bf16 v[244:247], a[164:167], a[148:151], v[244:247]
buffer_load_ushort a212, v17, s[32:35], s48 offen
v_mfma_f32_16x16x32_bf16 v[240:243], a[160:163], a[148:151], v[240:243]
buffer_load_dwordx4 v5, s[8:11], s52 offen lds
v_mfma_f32_16x16x32_bf16 a[0:3], a[160:163], a[152:155], a[0:3]
s_add_u32 s48, s74, 19584
v_mfma_f32_16x16x32_bf16 a[4:7], a[164:167], a[152:155], a[4:7]
buffer_load_dwordx2 a[202:203], v16, s[32:35], s48 offen
v_mfma_f32_16x16x32_bf16 a[8:11], a[168:171], a[152:155], a[8:11]
v_mfma_f32_16x16x32_bf16 a[12:15], a[172:175], a[152:155], a[12:15]
v_mfma_f32_16x16x32_bf16 v[128:131], a[152:155], a[176:179], v[128:131]
buffer_load_ushort a213, v17, s[32:35], s48 offen
v_mfma_f32_16x16x32_bf16 v[136:139], a[152:155], a[180:183], v[136:139]
v_mfma_f32_16x16x32_bf16 v[144:147], a[152:155], a[184:187], v[144:147]
buffer_load_dwordx4 v6, s[8:11], s52 offen offset:1024 lds
v_mfma_f32_16x16x32_bf16 v[152:155], a[152:155], a[188:191], v[152:155]
s_add_u32 s48, s74, 20736
v_mfma_f32_16x16x32_bf16 v[156:159], a[156:159], a[188:191], v[156:159]
buffer_load_dwordx2 a[204:205], v16, s[32:35], s48 offen
v_mfma_f32_16x16x32_bf16 v[148:151], a[156:159], a[184:187], v[148:151]
v_mfma_f32_16x16x32_bf16 v[140:143], a[156:159], a[180:183], v[140:143]
v_mfma_f32_16x16x32_bf16 v[132:135], a[156:159], a[176:179], v[132:135]
buffer_load_ushort a214, v17, s[32:35], s48 offen
v_mfma_f32_16x16x32_bf16 a[28:31], a[172:175], a[156:159], a[28:31]
v_mfma_f32_16x16x32_bf16 a[24:27], a[168:171], a[156:159], a[24:27]
s_add_u32 s48, s74, 21888
v_mfma_f32_16x16x32_bf16 a[20:23], a[164:167], a[156:159], a[20:23]
buffer_load_dwordx2 a[206:207], v16, s[32:35], s48 offen
v_mfma_f32_16x16x32_bf16 a[16:19], a[160:163], a[156:159], a[16:19]
s_waitcnt lgkmcnt(0)
v_mfma_f32_16x16x32_bf16 v[160:163], a[96:99], a[64:67], v[160:163]
s_waitcnt vmcnt(36)
v_mfma_f32_16x16x32_bf16 v[164:167], a[100:103], a[64:67], v[164:167]
s_barrier
v_mfma_f32_16x16x32_bf16 v[168:171], a[104:107], a[64:67], v[168:171]
ds_read_b128 a[128:131], v10 offset:0
ds_read_b128 a[132:135], v10 offset:2048
v_mfma_f32_16x16x32_bf16 v[172:175], a[108:111], a[64:67], v[172:175]
s_add_u32 s62, s62, 524288
s_and_b32 s62, s62, 4194303
s_add_u32 s63, s61, s62
v_mfma_f32_16x16x32_bf16 v[32:35], a[64:67], a[112:115], v[32:35]
s_add_u32 m0, s64, 0
s_add_u32 s52, s63, 0
v_mfma_f32_16x16x32_bf16 v[40:43], a[64:67], a[116:119], v[40:43]
buffer_load_dwordx4 v7, s[16:19], s52 offen lds
v_mfma_f32_16x16x32_bf16 v[48:51], a[64:67], a[120:123], v[48:51]
ds_read_b128 a[136:139], v10 offset:4096
ds_read_b128 a[140:143], v10 offset:6144
v_mfma_f32_16x16x32_bf16 v[56:59], a[64:67], a[124:127], v[56:59]
buffer_atomic_add v15, v0, s[24:27], s79 offen sc1
v_mfma_f32_16x16x32_bf16 v[60:63], a[68:71], a[124:127], v[60:63]
ds_read_b128 a[144:147], v10 offset:8192
ds_read_b128 a[148:151], v10 offset:10240
v_mfma_f32_16x16x32_bf16 v[52:55], a[68:71], a[120:123], v[52:55]
buffer_load_ushort a215, v17, s[32:35], s48 offen
v_mfma_f32_16x16x32_bf16 v[44:47], a[68:71], a[116:119], v[44:47]
ds_read_b128 a[152:155], v10 offset:12288
ds_read_b128 a[156:159], v10 offset:14336
v_mfma_f32_16x16x32_bf16 v[36:39], a[68:71], a[112:115], v[36:39]
buffer_load_dwordx4 v8, s[16:19], s52 offen offset:1024 lds
v_mfma_f32_16x16x32_bf16 v[188:191], a[108:111], a[68:71], v[188:191]
ds_read_b64_tr_b16 a[176:177], v11 offset:24576
ds_read_b64_tr_b16 a[178:179], v11 offset:25088
v_mfma_f32_16x16x32_bf16 v[184:187], a[104:107], a[68:71], v[184:187]
v_mfma_f32_16x16x32_bf16 v[180:183], a[100:103], a[68:71], v[180:183]
ds_read_b64_tr_b16 a[180:181], v12 offset:24576
ds_read_b64_tr_b16 a[182:183], v12 offset:25088
v_mfma_f32_16x16x32_bf16 v[176:179], a[96:99], a[68:71], v[176:179]
v_mfma_f32_16x16x32_bf16 v[192:195], a[96:99], a[72:75], v[192:195]
s_add_u32 m0, s64, 2048
s_add_u32 s52, s63, 131072
v_mfma_f32_16x16x32_bf16 v[196:199], a[100:103], a[72:75], v[196:199]
ds_read_b64_tr_b16 a[184:185], v13 offset:24576
ds_read_b64_tr_b16 a[186:187], v13 offset:25088
v_mfma_f32_16x16x32_bf16 v[200:203], a[104:107], a[72:75], v[200:203]
buffer_load_dwordx4 v7, s[16:19], s52 offen lds
v_mfma_f32_16x16x32_bf16 v[204:207], a[108:111], a[72:75], v[204:207]
ds_read_b64_tr_b16 a[188:189], v14 offset:24576
ds_read_b64_tr_b16 a[190:191], v14 offset:25088
v_mfma_f32_16x16x32_bf16 v[64:67], a[72:75], a[112:115], v[64:67]
v_mfma_f32_16x16x32_bf16 v[72:75], a[72:75], a[116:119], v[72:75]
ds_read_b64_tr_b16 a[160:161], v11 offset:16384
ds_read_b64_tr_b16 a[162:163], v11 offset:16896
v_mfma_f32_16x16x32_bf16 v[80:83], a[72:75], a[120:123], v[80:83]
v_mfma_f32_16x16x32_bf16 v[88:91], a[72:75], a[124:127], v[88:91]
ds_read_b64_tr_b16 a[164:165], v12 offset:16384
ds_read_b64_tr_b16 a[166:167], v12 offset:16896
v_mfma_f32_16x16x32_bf16 v[92:95], a[76:79], a[124:127], v[92:95]
v_mfma_f32_16x16x32_bf16 v[84:87], a[76:79], a[120:123], v[84:87]
buffer_load_dwordx4 v8, s[16:19], s52 offen offset:1024 lds
v_mfma_f32_16x16x32_bf16 v[76:79], a[76:79], a[116:119], v[76:79]
ds_read_b64_tr_b16 a[168:169], v13 offset:16384
ds_read_b64_tr_b16 a[170:171], v13 offset:16896
v_mfma_f32_16x16x32_bf16 v[68:71], a[76:79], a[112:115], v[68:71]
v_mfma_f32_16x16x32_bf16 v[220:223], a[108:111], a[76:79], v[220:223]
ds_read_b64_tr_b16 a[172:173], v14 offset:16384
ds_read_b64_tr_b16 a[174:175], v14 offset:16896
v_mfma_f32_16x16x32_bf16 v[216:219], a[104:107], a[76:79], v[216:219]
v_mfma_f32_16x16x32_bf16 v[212:215], a[100:103], a[76:79], v[212:215]
v_mfma_f32_16x16x32_bf16 v[208:211], a[96:99], a[76:79], v[208:211]
s_add_u32 m0, s60, 4096
s_add_u32 s52, s58, 32768
v_mfma_f32_16x16x32_bf16 v[224:227], a[96:99], a[80:83], v[224:227]
v_mfma_f32_16x16x32_bf16 v[228:231], a[100:103], a[80:83], v[228:231]
buffer_load_dwordx4 v5, s[8:11], s52 offen lds
v_mfma_f32_16x16x32_bf16 v[232:235], a[104:107], a[80:83], v[232:235]
v_mfma_f32_16x16x32_bf16 v[236:239], a[108:111], a[80:83], v[236:239]
v_mfma_f32_16x16x32_bf16 v[96:99], a[80:83], a[112:115], v[96:99]
v_mfma_f32_16x16x32_bf16 v[104:107], a[80:83], a[116:119], v[104:107]
v_mfma_f32_16x16x32_bf16 v[112:115], a[80:83], a[120:123], v[112:115]
v_mfma_f32_16x16x32_bf16 v[120:123], a[80:83], a[124:127], v[120:123]
v_mfma_f32_16x16x32_bf16 v[124:127], a[84:87], a[124:127], v[124:127]
buffer_load_dwordx4 v6, s[8:11], s52 offen offset:1024 lds
v_mfma_f32_16x16x32_bf16 v[116:119], a[84:87], a[120:123], v[116:119]
v_mfma_f32_16x16x32_bf16 v[108:111], a[84:87], a[116:119], v[108:111]
v_mfma_f32_16x16x32_bf16 v[100:103], a[84:87], a[112:115], v[100:103]
v_mfma_f32_16x16x32_bf16 v[252:255], a[108:111], a[84:87], v[252:255]
v_mfma_f32_16x16x32_bf16 v[248:251], a[104:107], a[84:87], v[248:251]
s_add_u32 m0, s60, 6144
s_add_u32 s52, s58, 49152
v_mfma_f32_16x16x32_bf16 v[244:247], a[100:103], a[84:87], v[244:247]
v_mfma_f32_16x16x32_bf16 v[240:243], a[96:99], a[84:87], v[240:243]
buffer_load_dwordx4 v5, s[8:11], s52 offen lds
v_mfma_f32_16x16x32_bf16 a[0:3], a[96:99], a[88:91], a[0:3]
v_mfma_f32_16x16x32_bf16 a[4:7], a[100:103], a[88:91], a[4:7]
v_mfma_f32_16x16x32_bf16 a[8:11], a[104:107], a[88:91], a[8:11]
v_mfma_f32_16x16x32_bf16 a[12:15], a[108:111], a[88:91], a[12:15]
v_mfma_f32_16x16x32_bf16 v[128:131], a[88:91], a[112:115], v[128:131]
v_mfma_f32_16x16x32_bf16 v[136:139], a[88:91], a[116:119], v[136:139]
v_mfma_f32_16x16x32_bf16 v[144:147], a[88:91], a[120:123], v[144:147]
buffer_load_dwordx4 v6, s[8:11], s52 offen offset:1024 lds
v_mfma_f32_16x16x32_bf16 v[152:155], a[88:91], a[124:127], v[152:155]
v_mfma_f32_16x16x32_bf16 v[156:159], a[92:95], a[124:127], v[156:159]
v_add_u32 v9, 32768, v9
v_add_u32 v10, 32768, v10
v_mfma_f32_16x16x32_bf16 v[148:151], a[92:95], a[120:123], v[148:151]
v_mfma_f32_16x16x32_bf16 v[140:143], a[92:95], a[116:119], v[140:143]
v_mfma_f32_16x16x32_bf16 v[132:135], a[92:95], a[112:115], v[132:135]
v_mfma_f32_16x16x32_bf16 a[28:31], a[108:111], a[92:95], a[28:31]
v_mfma_f32_16x16x32_bf16 a[24:27], a[104:107], a[92:95], a[24:27]
v_mfma_f32_16x16x32_bf16 a[20:23], a[100:103], a[92:95], a[20:23]
v_mfma_f32_16x16x32_bf16 a[16:19], a[96:99], a[92:95], a[16:19]
s_waitcnt lgkmcnt(0)
v_mfma_f32_16x16x32_bf16 v[160:163], a[160:163], a[128:131], v[160:163]
s_waitcnt vmcnt(33)
v_mfma_f32_16x16x32_bf16 v[164:167], a[164:167], a[128:131], v[164:167]
s_barrier
v_mfma_f32_16x16x32_bf16 v[168:171], a[168:171], a[128:131], v[168:171]
ds_read_b128 a[64:67], v9 offset:0
ds_read_b128 a[68:71], v9 offset:2048
v_mfma_f32_16x16x32_bf16 v[172:175], a[172:175], a[128:131], v[172:175]
s_add_u32 m0, s64, 16384
s_add_u32 s52, s63, 262144
v_mfma_f32_16x16x32_bf16 v[32:35], a[128:131], a[176:179], v[32:35]
buffer_load_dwordx4 v7, s[16:19], s52 offen lds
v_mfma_f32_16x16x32_bf16 v[40:43], a[128:131], a[180:183], v[40:43]
ds_read_b128 a[72:75], v9 offset:4096
ds_read_b128 a[76:79], v9 offset:6144
v_mfma_f32_16x16x32_bf16 v[48:51], a[128:131], a[184:187], v[48:51]
v_mfma_f32_16x16x32_bf16 v[56:59], a[128:131], a[188:191], v[56:59]
ds_read_b128 a[80:83], v9 offset:8192
ds_read_b128 a[84:87], v9 offset:10240
v_mfma_f32_16x16x32_bf16 v[60:63], a[132:135], a[188:191], v[60:63]
v_mfma_f32_16x16x32_bf16 v[52:55], a[132:135], a[184:187], v[52:55]
ds_read_b128 a[88:91], v9 offset:12288
ds_read_b128 a[92:95], v9 offset:14336
v_mfma_f32_16x16x32_bf16 v[44:47], a[132:135], a[180:183], v[44:47]
v_mfma_f32_16x16x32_bf16 v[36:39], a[132:135], a[176:179], v[36:39]
buffer_load_dwordx4 v8, s[16:19], s52 offen offset:1024 lds
v_mfma_f32_16x16x32_bf16 v[188:191], a[172:175], a[132:135], v[188:191]
ds_read_b64_tr_b16 a[112:113], v11 offset:40960
ds_read_b64_tr_b16 a[114:115], v11 offset:41472
v_mfma_f32_16x16x32_bf16 v[184:187], a[168:171], a[132:135], v[184:187]
v_mfma_f32_16x16x32_bf16 v[180:183], a[164:167], a[132:135], v[180:183]
ds_read_b64_tr_b16 a[116:117], v12 offset:40960
ds_read_b64_tr_b16 a[118:119], v12 offset:41472
v_mfma_f32_16x16x32_bf16 v[176:179], a[160:163], a[132:135], v[176:179]
v_mfma_f32_16x16x32_bf16 v[192:195], a[160:163], a[136:139], v[192:195]
s_add_u32 m0, s64, 18432
s_add_u32 s52, s63, 393216
v_mfma_f32_16x16x32_bf16 v[196:199], a[164:167], a[136:139], v[196:199]
ds_read_b64_tr_b16 a[120:121], v13 offset:40960
ds_read_b64_tr_b16 a[122:123], v13 offset:41472
v_mfma_f32_16x16x32_bf16 v[200:203], a[168:171], a[136:139], v[200:203]
buffer_load_dwordx4 v7, s[16:19], s52 offen lds
v_mfma_f32_16x16x32_bf16 v[204:207], a[172:175], a[136:139], v[204:207]
ds_read_b64_tr_b16 a[124:125], v14 offset:40960
ds_read_b64_tr_b16 a[126:127], v14 offset:41472
v_mfma_f32_16x16x32_bf16 v[64:67], a[136:139], a[176:179], v[64:67]
s_waitcnt vmcnt(10)
v_mfma_f32_16x16x32_bf16 v[72:75], a[136:139], a[180:183], v[72:75]
ds_read_b64_tr_b16 a[96:97], v11 offset:32768
ds_read_b64_tr_b16 a[98:99], v11 offset:33280
v_mfma_f32_16x16x32_bf16 v[80:83], a[136:139], a[184:187], v[80:83]
v_accvgpr_read_b32 v16, a192
v_accvgpr_read_b32 v17, a194
v_mfma_f32_16x16x32_bf16 v[88:91], a[136:139], a[188:191], v[88:91]
ds_read_b64_tr_b16 a[100:101], v12 offset:32768
ds_read_b64_tr_b16 a[102:103], v12 offset:33280
v_mfma_f32_16x16x32_bf16 v[92:95], a[140:143], a[188:191], v[92:95]
v_accvgpr_read_b32 v18, a196
v_accvgpr_read_b32 v19, a198
v_mfma_f32_16x16x32_bf16 v[84:87], a[140:143], a[184:187], v[84:87]
buffer_load_dwordx4 v8, s[16:19], s52 offen offset:1024 lds
v_mfma_f32_16x16x32_bf16 v[76:79], a[140:143], a[180:183], v[76:79]
s_add_u32 s57, s57, 128
s_and_b32 s57, s57, 1023
s_add_u32 s58, s56, s57
v_mfma_f32_16x16x32_bf16 v[68:71], a[140:143], a[176:179], v[68:71]
ds_read_b64_tr_b16 a[104:105], v13 offset:32768
ds_read_b64_tr_b16 a[106:107], v13 offset:33280
v_mfma_f32_16x16x32_bf16 v[220:223], a[172:175], a[140:143], v[220:223]
v_accvgpr_read_b32 v20, a200
v_accvgpr_read_b32 v21, a202
v_mfma_f32_16x16x32_bf16 v[216:219], a[168:171], a[140:143], v[216:219]
ds_read_b64_tr_b16 a[108:109], v14 offset:32768
ds_read_b64_tr_b16 a[110:111], v14 offset:33280
v_mfma_f32_16x16x32_bf16 v[212:215], a[164:167], a[140:143], v[212:215]
v_accvgpr_read_b32 v22, a204
v_accvgpr_read_b32 v23, a206
v_mfma_f32_16x16x32_bf16 v[208:211], a[160:163], a[140:143], v[208:211]
s_add_u32 m0, s60, 32768
s_add_u32 s52, s58, 0
v_mfma_f32_16x16x32_bf16 v[224:227], a[160:163], a[144:147], v[224:227]
v_perm_b32 v24, v17, v16, s81
v_perm_b32 v25, v19, v18, s81
v_mfma_f32_16x16x32_bf16 v[228:231], a[164:167], a[144:147], v[228:231]
buffer_load_dwordx4 v5, s[8:11], s52 offen lds
v_mfma_f32_16x16x32_bf16 v[232:235], a[168:171], a[144:147], v[232:235]
v_perm_b32 v26, v21, v20, s81
v_perm_b32 v27, v23, v22, s81
v_mfma_f32_16x16x32_bf16 v[236:239], a[172:175], a[144:147], v[236:239]
v_perm_b32 v28, v17, v16, s82
v_perm_b32 v29, v19, v18, s82
v_mfma_f32_16x16x32_bf16 v[96:99], a[144:147], a[176:179], v[96:99]
v_perm_b32 v30, v21, v20, s82
v_perm_b32 v31, v23, v22, s82
v_mfma_f32_16x16x32_bf16 v[104:107], a[144:147], a[180:183], v[104:107]
buffer_store_dwordx4 v[24:27], v4, s[24:27], s75 offen offset:0 sc1
v_mfma_f32_16x16x32_bf16 v[112:115], a[144:147], a[184:187], v[112:115]
v_mfma_f32_16x16x32_bf16 v[120:123], a[144:147], a[188:191], v[120:123]
v_mfma_f32_16x16x32_bf16 v[124:127], a[148:151], a[188:191], v[124:127]
buffer_load_dwordx4 v6, s[8:11], s52 offen offset:1024 lds
v_mfma_f32_16x16x32_bf16 v[116:119], a[148:151], a[184:187], v[116:119]
buffer_store_dwordx4 v[28:31], v4, s[24:27], s75 offen offset:1024 sc1
v_mfma_f32_16x16x32_bf16 v[108:111], a[148:151], a[180:183], v[108:111]
v_accvgpr_read_b32 v16, a193
v_accvgpr_read_b32 v17, a195
v_mfma_f32_16x16x32_bf16 v[100:103], a[148:151], a[176:179], v[100:103]
v_accvgpr_read_b32 v18, a197
v_accvgpr_read_b32 v19, a199
v_mfma_f32_16x16x32_bf16 v[252:255], a[172:175], a[148:151], v[252:255]
v_accvgpr_read_b32 v20, a201
v_accvgpr_read_b32 v21, a203
v_mfma_f32_16x16x32_bf16 v[248:251], a[168:171], a[148:151], v[248:251]
s_add_u32 m0, s60, 34816
s_add_u32 s52, s58, 16384
v_accvgpr_read_b32 v22, a205
v_mfma_f32_16x16x32_bf16 v[244:247], a[164:167], a[148:151], v[244:247]
v_accvgpr_read_b32 v23, a207
v_mfma_f32_16x16x32_bf16 v[240:243], a[160:163], a[148:151], v[240:243]
buffer_load_dwordx4 v5, s[8:11], s52 offen lds
v_mfma_f32_16x16x32_bf16 a[0:3], a[160:163], a[152:155], a[0:3]
v_perm_b32 v24, v17, v16, s81
v_perm_b32 v25, v19, v18, s81
v_mfma_f32_16x16x32_bf16 a[4:7], a[164:167], a[152:155], a[4:7]
v_perm_b32 v26, v21, v20, s81
v_perm_b32 v27, v23, v22, s81
v_mfma_f32_16x16x32_bf16 a[8:11], a[168:171], a[152:155], a[8:11]
v_perm_b32 v28, v17, v16, s82
v_perm_b32 v29, v19, v18, s82
v_mfma_f32_16x16x32_bf16 a[12:15], a[172:175], a[152:155], a[12:15]
v_perm_b32 v30, v21, v20, s82
v_perm_b32 v31, v23, v22, s82
v_mfma_f32_16x16x32_bf16 v[128:131], a[152:155], a[176:179], v[128:131]
buffer_store_dwordx4 v[24:27], v4, s[24:27], s75 offen offset:2048 sc1
v_mfma_f32_16x16x32_bf16 v[136:139], a[152:155], a[180:183], v[136:139]
v_mfma_f32_16x16x32_bf16 v[144:147], a[152:155], a[184:187], v[144:147]
buffer_load_dwordx4 v6, s[8:11], s52 offen offset:1024 lds
v_mfma_f32_16x16x32_bf16 v[152:155], a[152:155], a[188:191], v[152:155]
v_mfma_f32_16x16x32_bf16 v[156:159], a[156:159], a[188:191], v[156:159]
buffer_store_dwordx4 v[28:31], v4, s[24:27], s75 offen offset:3072 sc1
v_mfma_f32_16x16x32_bf16 v[148:151], a[156:159], a[184:187], v[148:151]
v_accvgpr_read_b32 v16, a208
v_accvgpr_read_b32 v17, a209
v_mfma_f32_16x16x32_bf16 v[140:143], a[156:159], a[180:183], v[140:143]
v_accvgpr_read_b32 v18, a210
v_accvgpr_read_b32 v19, a211
v_mfma_f32_16x16x32_bf16 v[132:135], a[156:159], a[176:179], v[132:135]
v_accvgpr_read_b32 v20, a212
v_accvgpr_read_b32 v21, a213
v_mfma_f32_16x16x32_bf16 a[28:31], a[172:175], a[156:159], a[28:31]
v_accvgpr_read_b32 v22, a214
v_accvgpr_read_b32 v23, a215
v_mfma_f32_16x16x32_bf16 a[24:27], a[168:171], a[156:159], a[24:27]
v_mfma_f32_16x16x32_bf16 a[20:23], a[164:167], a[156:159], a[20:23]
v_lshl_or_b32 v24, v17, 16, v16
v_lshl_or_b32 v25, v19, 16, v18
v_mfma_f32_16x16x32_bf16 a[16:19], a[160:163], a[156:159], a[16:19]
s_waitcnt lgkmcnt(0)
v_lshl_or_b32 v26, v21, 16, v20
v_lshl_or_b32 v27, v23, 16, v22
v_mfma_f32_16x16x32_bf16 v[160:163], a[96:99], a[64:67], v[160:163]
s_waitcnt vmcnt(37)
v_accvgpr_read_b32 v16, a225
v_mfma_f32_16x16x32_bf16 v[164:167], a[100:103], a[64:67], v[164:167]
s_barrier
v_mfma_f32_16x16x32_bf16 v[168:171], a[104:107], a[64:67], v[168:171]
ds_read_b128 a[128:131], v10 offset:0
ds_read_b128 a[132:135], v10 offset:2048
v_mfma_f32_16x16x32_bf16 v[172:175], a[108:111], a[64:67], v[172:175]
s_add_u32 s62, s62, 524288
s_and_b32 s62, s62, 4194303
s_add_u32 s63, s61, s62
v_mfma_f32_16x16x32_bf16 v[32:35], a[64:67], a[112:115], v[32:35]
s_add_u32 m0, s64, 32768
s_add_u32 s52, s63, 0
v_mfma_f32_16x16x32_bf16 v[40:43], a[64:67], a[116:119], v[40:43]
buffer_load_dwordx4 v7, s[16:19], s52 offen lds
v_mfma_f32_16x16x32_bf16 v[48:51], a[64:67], a[120:123], v[48:51]
ds_read_b128 a[136:139], v10 offset:4096
ds_read_b128 a[140:143], v10 offset:6144
v_mfma_f32_16x16x32_bf16 v[56:59], a[64:67], a[124:127], v[56:59]
buffer_store_dwordx4 v[24:27], v16, s[24:27], s75 offen sc1
v_mfma_f32_16x16x32_bf16 v[60:63], a[68:71], a[124:127], v[60:63]
ds_read_b128 a[144:147], v10 offset:8192
ds_read_b128 a[148:151], v10 offset:10240
v_mfma_f32_16x16x32_bf16 v[52:55], a[68:71], a[120:123], v[52:55]
v_mov_b32 v29, 0
v_mfma_f32_16x16x32_bf16 v[44:47], a[68:71], a[116:119], v[44:47]
ds_read_b128 a[152:155], v10 offset:12288
ds_read_b128 a[156:159], v10 offset:14336
v_mfma_f32_16x16x32_bf16 v[36:39], a[68:71], a[112:115], v[36:39]
buffer_load_dwordx4 v8, s[16:19], s52 offen offset:1024 lds
v_mfma_f32_16x16x32_bf16 v[188:191], a[108:111], a[68:71], v[188:191]
ds_read_b64_tr_b16 a[176:177], v11 offset:57344
ds_read_b64_tr_b16 a[178:179], v11 offset:57856
v_mfma_f32_16x16x32_bf16 v[184:187], a[104:107], a[68:71], v[184:187]
v_mfma_f32_16x16x32_bf16 v[180:183], a[100:103], a[68:71], v[180:183]
ds_read_b64_tr_b16 a[180:181], v12 offset:57344
ds_read_b64_tr_b16 a[182:183], v12 offset:57856
v_mfma_f32_16x16x32_bf16 v[176:179], a[96:99], a[68:71], v[176:179]
v_mfma_f32_16x16x32_bf16 v[192:195], a[96:99], a[72:75], v[192:195]
s_add_u32 m0, s64, 34816
s_add_u32 s52, s63, 131072
v_mfma_f32_16x16x32_bf16 v[196:199], a[100:103], a[72:75], v[196:199]
ds_read_b64_tr_b16 a[184:185], v13 offset:57344
ds_read_b64_tr_b16 a[186:187], v13 offset:57856
v_mfma_f32_16x16x32_bf16 v[200:203], a[104:107], a[72:75], v[200:203]
buffer_load_dwordx4 v7, s[16:19], s52 offen lds
v_mfma_f32_16x16x32_bf16 v[204:207], a[108:111], a[72:75], v[204:207]
ds_read_b64_tr_b16 a[188:189], v14 offset:57344
ds_read_b64_tr_b16 a[190:191], v14 offset:57856
v_mfma_f32_16x16x32_bf16 v[64:67], a[72:75], a[112:115], v[64:67]
v_mfma_f32_16x16x32_bf16 v[72:75], a[72:75], a[116:119], v[72:75]
ds_read_b64_tr_b16 a[160:161], v11 offset:49152
ds_read_b64_tr_b16 a[162:163], v11 offset:49664
v_mfma_f32_16x16x32_bf16 v[80:83], a[72:75], a[120:123], v[80:83]
v_mfma_f32_16x16x32_bf16 v[88:91], a[72:75], a[124:127], v[88:91]
ds_read_b64_tr_b16 a[164:165], v12 offset:49152
ds_read_b64_tr_b16 a[166:167], v12 offset:49664
v_mfma_f32_16x16x32_bf16 v[92:95], a[76:79], a[124:127], v[92:95]
v_mfma_f32_16x16x32_bf16 v[84:87], a[76:79], a[120:123], v[84:87]
buffer_load_dwordx4 v8, s[16:19], s52 offen offset:1024 lds
v_mfma_f32_16x16x32_bf16 v[76:79], a[76:79], a[116:119], v[76:79]
ds_read_b64_tr_b16 a[168:169], v13 offset:49152
ds_read_b64_tr_b16 a[170:171], v13 offset:49664
v_mfma_f32_16x16x32_bf16 v[68:71], a[76:79], a[112:115], v[68:71]
v_mfma_f32_16x16x32_bf16 v[220:223], a[108:111], a[76:79], v[220:223]
ds_read_b64_tr_b16 a[172:173], v14 offset:49152
ds_read_b64_tr_b16 a[174:175], v14 offset:49664
v_mfma_f32_16x16x32_bf16 v[216:219], a[104:107], a[76:79], v[216:219]
v_mfma_f32_16x16x32_bf16 v[212:215], a[100:103], a[76:79], v[212:215]
v_mfma_f32_16x16x32_bf16 v[208:211], a[96:99], a[76:79], v[208:211]
s_add_u32 m0, s60, 36864
s_add_u32 s52, s58, 32768
v_mfma_f32_16x16x32_bf16 v[224:227], a[96:99], a[80:83], v[224:227]
v_mfma_f32_16x16x32_bf16 v[228:231], a[100:103], a[80:83], v[228:231]
buffer_load_dwordx4 v5, s[8:11], s52 offen lds
v_mfma_f32_16x16x32_bf16 v[232:235], a[104:107], a[80:83], v[232:235]
v_mfma_f32_16x16x32_bf16 v[236:239], a[108:111], a[80:83], v[236:239]
v_mfma_f32_16x16x32_bf16 v[96:99], a[80:83], a[112:115], v[96:99]
v_mfma_f32_16x16x32_bf16 v[104:107], a[80:83], a[116:119], v[104:107]
v_mfma_f32_16x16x32_bf16 v[112:115], a[80:83], a[120:123], v[112:115]
v_mfma_f32_16x16x32_bf16 v[120:123], a[80:83], a[124:127], v[120:123]
v_mfma_f32_16x16x32_bf16 v[124:127], a[84:87], a[124:127], v[124:127]
buffer_load_dwordx4 v6, s[8:11], s52 offen offset:1024 lds
v_mfma_f32_16x16x32_bf16 v[116:119], a[84:87], a[120:123], v[116:119]
v_mfma_f32_16x16x32_bf16 v[108:111], a[84:87], a[116:119], v[108:111]
v_mfma_f32_16x16x32_bf16 v[100:103], a[84:87], a[112:115], v[100:103]
v_mfma_f32_16x16x32_bf16 v[252:255], a[108:111], a[84:87], v[252:255]
v_mfma_f32_16x16x32_bf16 v[248:251], a[104:107], a[84:87], v[248:251]
s_add_u32 m0, s60, 38912
s_add_u32 s52, s58, 49152
v_mfma_f32_16x16x32_bf16 v[244:247], a[100:103], a[84:87], v[244:247]
v_mfma_f32_16x16x32_bf16 v[240:243], a[96:99], a[84:87], v[240:243]
buffer_load_dwordx4 v5, s[8:11], s52 offen lds
v_mfma_f32_16x16x32_bf16 a[0:3], a[96:99], a[88:91], a[0:3]
v_mfma_f32_16x16x32_bf16 a[4:7], a[100:103], a[88:91], a[4:7]
v_mfma_f32_16x16x32_bf16 a[8:11], a[104:107], a[88:91], a[8:11]
v_mfma_f32_16x16x32_bf16 a[12:15], a[108:111], a[88:91], a[12:15]
v_mfma_f32_16x16x32_bf16 v[128:131], a[88:91], a[112:115], v[128:131]
v_mfma_f32_16x16x32_bf16 v[136:139], a[88:91], a[116:119], v[136:139]
v_mfma_f32_16x16x32_bf16 v[144:147], a[88:91], a[120:123], v[144:147]
buffer_load_dwordx4 v6, s[8:11], s52 offen offset:1024 lds
v_mfma_f32_16x16x32_bf16 v[152:155], a[88:91], a[124:127], v[152:155]
v_mfma_f32_16x16x32_bf16 v[156:159], a[92:95], a[124:127], v[156:159]
v_add_u32 v9, -65536, v9
v_add_u32 v10, -65536, v10
v_mfma_f32_16x16x32_bf16 v[148:151], a[92:95], a[120:123], v[148:151]
v_mfma_f32_16x16x32_bf16 v[140:143], a[92:95], a[116:119], v[140:143]
v_mfma_f32_16x16x32_bf16 v[132:135], a[92:95], a[112:115], v[132:135]
v_mfma_f32_16x16x32_bf16 a[28:31], a[108:111], a[92:95], a[28:31]
v_mfma_f32_16x16x32_bf16 a[24:27], a[104:107], a[92:95], a[24:27]
v_mfma_f32_16x16x32_bf16 a[20:23], a[100:103], a[92:95], a[20:23]
v_mfma_f32_16x16x32_bf16 a[16:19], a[96:99], a[92:95], a[16:19]
s_waitcnt lgkmcnt(0)
v_mfma_f32_16x16x32_bf16 v[160:163], a[160:163], a[128:131], v[160:163]
s_waitcnt vmcnt(21)
v_mfma_f32_16x16x32_bf16 v[164:167], a[164:167], a[128:131], v[164:167]
s_barrier
v_mfma_f32_16x16x32_bf16 v[168:171], a[168:171], a[128:131], v[168:171]
ds_read_b128 a[64:67], v9 offset:0
ds_read_b128 a[68:71], v9 offset:2048
v_mfma_f32_16x16x32_bf16 v[172:175], a[172:175], a[128:131], v[172:175]
s_add_u32 m0, s64, 49152
s_add_u32 s52, s63, 262144
v_mfma_f32_16x16x32_bf16 v[32:35], a[128:131], a[176:179], v[32:35]
buffer_load_dwordx4 v7, s[16:19], s52 offen lds
v_mfma_f32_16x16x32_bf16 v[40:43], a[128:131], a[180:183], v[40:43]
ds_read_b128 a[72:75], v9 offset:4096
ds_read_b128 a[76:79], v9 offset:6144
v_mfma_f32_16x16x32_bf16 v[48:51], a[128:131], a[184:187], v[48:51]
v_mfma_f32_16x16x32_bf16 v[56:59], a[128:131], a[188:191], v[56:59]
ds_read_b128 a[80:83], v9 offset:8192
ds_read_b128 a[84:87], v9 offset:10240
v_mfma_f32_16x16x32_bf16 v[60:63], a[132:135], a[188:191], v[60:63]
buffer_load_dword v30, v29, s[24:27], s78 offen sc1
v_mfma_f32_16x16x32_bf16 v[52:55], a[132:135], a[184:187], v[52:55]
ds_read_b128 a[88:91], v9 offset:12288
ds_read_b128 a[92:95], v9 offset:14336
v_mfma_f32_16x16x32_bf16 v[44:47], a[132:135], a[180:183], v[44:47]
v_mfma_f32_16x16x32_bf16 v[36:39], a[132:135], a[176:179], v[36:39]
buffer_load_dwordx4 v8, s[16:19], s52 offen offset:1024 lds
v_mfma_f32_16x16x32_bf16 v[188:191], a[172:175], a[132:135], v[188:191]
ds_read_b64_tr_b16 a[112:113], v11 offset:8192
ds_read_b64_tr_b16 a[114:115], v11 offset:8704
v_mfma_f32_16x16x32_bf16 v[184:187], a[168:171], a[132:135], v[184:187]
v_mfma_f32_16x16x32_bf16 v[180:183], a[164:167], a[132:135], v[180:183]
ds_read_b64_tr_b16 a[116:117], v12 offset:8192
ds_read_b64_tr_b16 a[118:119], v12 offset:8704
v_mfma_f32_16x16x32_bf16 v[176:179], a[160:163], a[132:135], v[176:179]
v_mfma_f32_16x16x32_bf16 v[192:195], a[160:163], a[136:139], v[192:195]
s_add_u32 m0, s64, 51200
s_add_u32 s52, s63, 393216
v_mfma_f32_16x16x32_bf16 v[196:199], a[164:167], a[136:139], v[196:199]
ds_read_b64_tr_b16 a[120:121], v13 offset:8192
ds_read_b64_tr_b16 a[122:123], v13 offset:8704
v_mfma_f32_16x16x32_bf16 v[200:203], a[168:171], a[136:139], v[200:203]
buffer_load_dwordx4 v7, s[16:19], s52 offen lds
v_mfma_f32_16x16x32_bf16 v[204:207], a[172:175], a[136:139], v[204:207]
ds_read_b64_tr_b16 a[124:125], v14 offset:8192
ds_read_b64_tr_b16 a[126:127], v14 offset:8704
v_mfma_f32_16x16x32_bf16 v[64:67], a[136:139], a[176:179], v[64:67]
v_mfma_f32_16x16x32_bf16 v[72:75], a[136:139], a[180:183], v[72:75]
ds_read_b64_tr_b16 a[96:97], v11 offset:0
ds_read_b64_tr_b16 a[98:99], v11 offset:512
v_mfma_f32_16x16x32_bf16 v[80:83], a[136:139], a[184:187], v[80:83]
v_mfma_f32_16x16x32_bf16 v[88:91], a[136:139], a[188:191], v[88:91]
ds_read_b64_tr_b16 a[100:101], v12 offset:0
ds_read_b64_tr_b16 a[102:103], v12 offset:512
v_mfma_f32_16x16x32_bf16 v[92:95], a[140:143], a[188:191], v[92:95]
v_mfma_f32_16x16x32_bf16 v[84:87], a[140:143], a[184:187], v[84:87]
buffer_load_dwordx4 v8, s[16:19], s52 offen offset:1024 lds
v_mfma_f32_16x16x32_bf16 v[76:79], a[140:143], a[180:183], v[76:79]
s_cmp_ge_u32 s66, 9
s_cselect_b32 s57, 9, 0
s_sub_u32 s66, s66, s57
v_mfma_f32_16x16x32_bf16 v[68:71], a[140:143], a[176:179], v[68:71]
s_lshl_b32 s57, s66, 7
s_mul_i32 s58, s54, 36864
s_add_u32 s58, s58, s57
v_mfma_f32_16x16x32_bf16 v[220:223], a[172:175], a[140:143], v[220:223]
s_mul_i32 s59, s55, 36864
s_add_u32 s59, s59, s57
v_mfma_f32_16x16x32_bf16 v[216:219], a[168:171], a[140:143], v[216:219]
v_lshrrev_b32 v31, 3, v1
v_lshl_add_u32 v5, v31, 7, v5
v_mfma_f32_16x16x32_bf16 v[212:215], a[164:167], a[140:143], v[212:215]
v_lshl_add_u32 v6, v31, 7, v6
v_add_u32 v6, 1024, v6
v_mfma_f32_16x16x32_bf16 v[208:211], a[160:163], a[140:143], v[208:211]
s_add_u32 m0, s60, 65536
s_add_u32 s52, s58, 0
v_mfma_f32_16x16x32_bf16 v[224:227], a[160:163], a[144:147], v[224:227]
ds_read_b64_tr_b16 a[104:105], v13 offset:0
ds_read_b64_tr_b16 a[106:107], v13 offset:512
v_mfma_f32_16x16x32_bf16 v[228:231], a[164:167], a[144:147], v[228:231]
buffer_load_dwordx4 v5, s[12:15], s52 offen lds
v_mfma_f32_16x16x32_bf16 v[232:235], a[168:171], a[144:147], v[232:235]
ds_read_b64_tr_b16 a[108:109], v14 offset:0
ds_read_b64_tr_b16 a[110:111], v14 offset:512
v_mfma_f32_16x16x32_bf16 v[236:239], a[172:175], a[144:147], v[236:239]
v_mfma_f32_16x16x32_bf16 v[96:99], a[144:147], a[176:179], v[96:99]
v_mfma_f32_16x16x32_bf16 v[104:107], a[144:147], a[180:183], v[104:107]
v_mfma_f32_16x16x32_bf16 v[112:115], a[144:147], a[184:187], v[112:115]
v_mfma_f32_16x16x32_bf16 v[120:123], a[144:147], a[188:191], v[120:123]
v_mfma_f32_16x16x32_bf16 v[124:127], a[148:151], a[188:191], v[124:127]
buffer_load_dwordx4 v6, s[12:15], s52 offen offset:1024 lds
v_mfma_f32_16x16x32_bf16 v[116:119], a[148:151], a[184:187], v[116:119]
v_mfma_f32_16x16x32_bf16 v[108:111], a[148:151], a[180:183], v[108:111]
v_mfma_f32_16x16x32_bf16 v[100:103], a[148:151], a[176:179], v[100:103]
v_mfma_f32_16x16x32_bf16 v[252:255], a[172:175], a[148:151], v[252:255]
v_mfma_f32_16x16x32_bf16 v[248:251], a[168:171], a[148:151], v[248:251]
s_add_u32 m0, s60, 67584
s_add_u32 s52, s58, 18432
v_mfma_f32_16x16x32_bf16 v[244:247], a[164:167], a[148:151], v[244:247]
v_mfma_f32_16x16x32_bf16 v[240:243], a[160:163], a[148:151], v[240:243]
buffer_load_dwordx4 v5, s[12:15], s52 offen lds
v_mfma_f32_16x16x32_bf16 a[0:3], a[160:163], a[152:155], a[0:3]
v_mfma_f32_16x16x32_bf16 a[4:7], a[164:167], a[152:155], a[4:7]
v_mfma_f32_16x16x32_bf16 a[8:11], a[168:171], a[152:155], a[8:11]
s_waitcnt vmcnt(6)
v_mfma_f32_16x16x32_bf16 a[12:15], a[172:175], a[152:155], a[12:15]
v_cmp_gt_u32 vcc, 8, v30
v_mfma_f32_16x16x32_bf16 v[128:131], a[152:155], a[176:179], v[128:131]
v_mfma_f32_16x16x32_bf16 v[136:139], a[152:155], a[180:183], v[136:139]
v_mfma_f32_16x16x32_bf16 v[144:147], a[152:155], a[184:187], v[144:147]
buffer_load_dwordx4 v6, s[12:15], s52 offen offset:1024 lds
v_mfma_f32_16x16x32_bf16 v[152:155], a[152:155], a[188:191], v[152:155]
v_mfma_f32_16x16x32_bf16 v[156:159], a[156:159], a[188:191], v[156:159]
s_cbranch_vccnz CK_WA
CK_WA_R:
v_mfma_f32_16x16x32_bf16 v[148:151], a[156:159], a[184:187], v[148:151]
v_mfma_f32_16x16x32_bf16 v[140:143], a[156:159], a[180:183], v[140:143]
v_mfma_f32_16x16x32_bf16 v[132:135], a[156:159], a[176:179], v[132:135]
v_mfma_f32_16x16x32_bf16 a[28:31], a[172:175], a[156:159], a[28:31]
v_mfma_f32_16x16x32_bf16 a[24:27], a[168:171], a[156:159], a[24:27]
v_mfma_f32_16x16x32_bf16 a[20:23], a[164:167], a[156:159], a[20:23]
v_mfma_f32_16x16x32_bf16 a[16:19], a[160:163], a[156:159], a[16:19]
s_waitcnt lgkmcnt(0)
v_mfma_f32_16x16x32_bf16 v[160:163], a[96:99], a[64:67], v[160:163]
s_waitcnt vmcnt(26)
v_mfma_f32_16x16x32_bf16 v[164:167], a[100:103], a[64:67], v[164:167]
s_barrier
v_mfma_f32_16x16x32_bf16 v[168:171], a[104:107], a[64:67], v[168:171]
ds_read_b128 a[128:131], v10 offset:0
ds_read_b128 a[132:135], v10 offset:2048
v_mfma_f32_16x16x32_bf16 v[172:175], a[108:111], a[64:67], v[172:175]
s_lshr_b32 s53, s3, 1
s_lshl_b32 s62, s53, 17
s_add_u32 s61, s61, s62
v_mfma_f32_16x16x32_bf16 v[32:35], a[64:67], a[112:115], v[32:35]
s_lshl_b32 s53, s53, 11
s_and_b32 s64, s64, 4096
s_add_u32 s64, s64, s53
v_mfma_f32_16x16x32_bf16 v[40:43], a[64:67], a[116:119], v[40:43]
s_mov_b32 s62, s66
s_lshl_b32 s63, s62, 19
s_add_u32 s63, s63, s61
v_mfma_f32_16x16x32_bf16 v[48:51], a[64:67], a[120:123], v[48:51]
s_lshl_b32 s66, s62, 13
s_add_u32 s66, s66, s65
v_mfma_f32_16x16x32_bf16 v[56:59], a[64:67], a[124:127], v[56:59]
s_add_u32 m0, s64, 0
s_add_u32 s52, s63, 0
v_mfma_f32_16x16x32_bf16 v[60:63], a[68:71], a[124:127], v[60:63]
buffer_load_dwordx4 v7, s[20:23], s52 offen lds
v_mfma_f32_16x16x32_bf16 v[52:55], a[68:71], a[120:123], v[52:55]
ds_read_b128 a[136:139], v10 offset:4096
ds_read_b128 a[140:143], v10 offset:6144
v_mfma_f32_16x16x32_bf16 v[44:47], a[68:71], a[116:119], v[44:47]
v_mfma_f32_16x16x32_bf16 v[36:39], a[68:71], a[112:115], v[36:39]
ds_read_b128 a[144:147], v10 offset:8192
ds_read_b128 a[148:151], v10 offset:10240
v_mfma_f32_16x16x32_bf16 v[188:191], a[108:111], a[68:71], v[188:191]
buffer_load_dwordx4 v8, s[20:23], s52 offen offset:1024 lds
v_mfma_f32_16x16x32_bf16 v[184:187], a[104:107], a[68:71], v[184:187]
ds_read_b128 a[152:155], v10 offset:12288
ds_read_b128 a[156:159], v10 offset:14336
v_mfma_f32_16x16x32_bf16 v[180:183], a[100:103], a[68:71], v[180:183]
v_mfma_f32_16x16x32_bf16 v[176:179], a[96:99], a[68:71], v[176:179]
ds_read_b64_tr_b16 a[176:177], v11 offset:24576
ds_read_b64_tr_b16 a[178:179], v11 offset:25088
v_mfma_f32_16x16x32_bf16 v[192:195], a[96:99], a[72:75], v[192:195]
v_mfma_f32_16x16x32_bf16 v[196:199], a[100:103], a[72:75], v[196:199]
ds_read_b64_tr_b16 a[180:181], v12 offset:24576
ds_read_b64_tr_b16 a[182:183], v12 offset:25088
v_mfma_f32_16x16x32_bf16 v[200:203], a[104:107], a[72:75], v[200:203]
s_add_u32 m0, s67, 0
s_add_u32 s52, s66, 0
v_mfma_f32_16x16x32_bf16 v[204:207], a[108:111], a[72:75], v[204:207]
ds_read_b64_tr_b16 a[184:185], v13 offset:24576
ds_read_b64_tr_b16 a[186:187], v13 offset:25088
v_mfma_f32_16x16x32_bf16 v[64:67], a[72:75], a[112:115], v[64:67]
buffer_load_dwordx4 v4, s[24:27], s52 offen sc1 lds
v_mfma_f32_16x16x32_bf16 v[72:75], a[72:75], a[116:119], v[72:75]
ds_read_b64_tr_b16 a[188:189], v14 offset:24576
ds_read_b64_tr_b16 a[190:191], v14 offset:25088
v_mfma_f32_16x16x32_bf16 v[80:83], a[72:75], a[120:123], v[80:83]
v_mfma_f32_16x16x32_bf16 v[88:91], a[72:75], a[124:127], v[88:91]
ds_read_b64_tr_b16 a[160:161], v11 offset:16384
ds_read_b64_tr_b16 a[162:163], v11 offset:16896
v_mfma_f32_16x16x32_bf16 v[92:95], a[76:79], a[124:127], v[92:95]
v_mfma_f32_16x16x32_bf16 v[84:87], a[76:79], a[120:123], v[84:87]
ds_read_b64_tr_b16 a[164:165], v12 offset:16384
ds_read_b64_tr_b16 a[166:167], v12 offset:16896
v_mfma_f32_16x16x32_bf16 v[76:79], a[76:79], a[116:119], v[76:79]
s_add_u32 m0, s60, 69632
s_add_u32 s52, s59, 0
v_mfma_f32_16x16x32_bf16 v[68:71], a[76:79], a[112:115], v[68:71]
ds_read_b64_tr_b16 a[168:169], v13 offset:16384
ds_read_b64_tr_b16 a[170:171], v13 offset:16896
v_mfma_f32_16x16x32_bf16 v[220:223], a[108:111], a[76:79], v[220:223]
buffer_load_dwordx4 v5, s[12:15], s52 offen lds
v_mfma_f32_16x16x32_bf16 v[216:219], a[104:107], a[76:79], v[216:219]
ds_read_b64_tr_b16 a[172:173], v14 offset:16384
ds_read_b64_tr_b16 a[174:175], v14 offset:16896
v_mfma_f32_16x16x32_bf16 v[212:215], a[100:103], a[76:79], v[212:215]
v_mfma_f32_16x16x32_bf16 v[208:211], a[96:99], a[76:79], v[208:211]
v_mfma_f32_16x16x32_bf16 v[224:227], a[96:99], a[80:83], v[224:227]
v_mfma_f32_16x16x32_bf16 v[228:231], a[100:103], a[80:83], v[228:231]
v_mfma_f32_16x16x32_bf16 v[232:235], a[104:107], a[80:83], v[232:235]
v_mfma_f32_16x16x32_bf16 v[236:239], a[108:111], a[80:83], v[236:239]
v_mfma_f32_16x16x32_bf16 v[96:99], a[80:83], a[112:115], v[96:99]
v_mfma_f32_16x16x32_bf16 v[104:107], a[80:83], a[116:119], v[104:107]
buffer_load_dwordx4 v6, s[12:15], s52 offen offset:1024 lds
v_mfma_f32_16x16x32_bf16 v[112:115], a[80:83], a[120:123], v[112:115]
v_mfma_f32_16x16x32_bf16 v[120:123], a[80:83], a[124:127], v[120:123]
v_mfma_f32_16x16x32_bf16 v[124:127], a[84:87], a[124:127], v[124:127]
v_mfma_f32_16x16x32_bf16 v[116:119], a[84:87], a[120:123], v[116:119]
v_mfma_f32_16x16x32_bf16 v[108:111], a[84:87], a[116:119], v[108:111]
v_mfma_f32_16x16x32_bf16 v[100:103], a[84:87], a[112:115], v[100:103]
s_add_u32 m0, s60, 71680
s_add_u32 s52, s59, 18432
v_mfma_f32_16x16x32_bf16 v[252:255], a[108:111], a[84:87], v[252:255]
v_mfma_f32_16x16x32_bf16 v[248:251], a[104:107], a[84:87], v[248:251]
buffer_load_dwordx4 v5, s[12:15], s52 offen lds
v_mfma_f32_16x16x32_bf16 v[244:247], a[100:103], a[84:87], v[244:247]
v_mfma_f32_16x16x32_bf16 v[240:243], a[96:99], a[84:87], v[240:243]
v_mfma_f32_16x16x32_bf16 a[0:3], a[96:99], a[88:91], a[0:3]
v_mfma_f32_16x16x32_bf16 a[4:7], a[100:103], a[88:91], a[4:7]
v_mfma_f32_16x16x32_bf16 a[8:11], a[104:107], a[88:91], a[8:11]
v_mfma_f32_16x16x32_bf16 a[12:15], a[108:111], a[88:91], a[12:15]
v_mfma_f32_16x16x32_bf16 v[128:131], a[88:91], a[112:115], v[128:131]
v_mfma_f32_16x16x32_bf16 v[136:139], a[88:91], a[116:119], v[136:139]
buffer_load_dwordx4 v6, s[12:15], s52 offen offset:1024 lds
v_mfma_f32_16x16x32_bf16 v[144:147], a[88:91], a[120:123], v[144:147]
v_mfma_f32_16x16x32_bf16 v[152:155], a[88:91], a[124:127], v[152:155]
v_mfma_f32_16x16x32_bf16 v[156:159], a[92:95], a[124:127], v[156:159]
v_add_u32 v9, 32768, v9
v_add_u32 v10, 32768, v10
v_mfma_f32_16x16x32_bf16 v[148:151], a[92:95], a[120:123], v[148:151]
v_mfma_f32_16x16x32_bf16 v[140:143], a[92:95], a[116:119], v[140:143]
v_mfma_f32_16x16x32_bf16 v[132:135], a[92:95], a[112:115], v[132:135]
v_mfma_f32_16x16x32_bf16 a[28:31], a[108:111], a[92:95], a[28:31]
v_mfma_f32_16x16x32_bf16 a[24:27], a[104:107], a[92:95], a[24:27]
v_mfma_f32_16x16x32_bf16 a[20:23], a[100:103], a[92:95], a[20:23]
v_mfma_f32_16x16x32_bf16 a[16:19], a[96:99], a[92:95], a[16:19]
s_waitcnt lgkmcnt(0)
v_mfma_f32_16x16x32_bf16 v[160:163], a[160:163], a[128:131], v[160:163]
s_waitcnt vmcnt(16)
v_mfma_f32_16x16x32_bf16 v[164:167], a[164:167], a[128:131], v[164:167]
s_barrier
v_mfma_f32_16x16x32_bf16 v[168:171], a[168:171], a[128:131], v[168:171]
ds_read_b128 a[64:67], v9 offset:0
ds_read_b128 a[68:71], v9 offset:2048
v_mfma_f32_16x16x32_bf16 v[172:175], a[172:175], a[128:131], v[172:175]
s_add_u32 m0, s64, 16384
s_add_u32 s52, s63, 262144
v_mfma_f32_16x16x32_bf16 v[32:35], a[128:131], a[176:179], v[32:35]
buffer_load_dwordx4 v7, s[20:23], s52 offen lds
v_mfma_f32_16x16x32_bf16 v[40:43], a[128:131], a[180:183], v[40:43]
ds_read_b128 a[72:75], v9 offset:4096
ds_read_b128 a[76:79], v9 offset:6144
v_mfma_f32_16x16x32_bf16 v[48:51], a[128:131], a[184:187], v[48:51]
v_mfma_f32_16x16x32_bf16 v[56:59], a[128:131], a[188:191], v[56:59]
ds_read_b128 a[80:83], v9 offset:8192
ds_read_b128 a[84:87], v9 offset:10240
v_mfma_f32_16x16x32_bf16 v[60:63], a[132:135], a[188:191], v[60:63]
v_mfma_f32_16x16x32_bf16 v[52:55], a[132:135], a[184:187], v[52:55]
ds_read_b128 a[88:91], v9 offset:12288
ds_read_b128 a[92:95], v9 offset:14336
v_mfma_f32_16x16x32_bf16 v[44:47], a[132:135], a[180:183], v[44:47]
v_mfma_f32_16x16x32_bf16 v[36:39], a[132:135], a[176:179], v[36:39]
ds_read_b64_tr_b16 a[112:113], v11 offset:40960
ds_read_b64_tr_b16 a[114:115], v11 offset:41472
v_mfma_f32_16x16x32_bf16 v[188:191], a[172:175], a[132:135], v[188:191]
buffer_load_dwordx4 v8, s[20:23], s52 offen offset:1024 lds
v_mfma_f32_16x16x32_bf16 v[184:187], a[168:171], a[132:135], v[184:187]
ds_read_b64_tr_b16 a[116:117], v12 offset:40960
ds_read_b64_tr_b16 a[118:119], v12 offset:41472
v_mfma_f32_16x16x32_bf16 v[180:183], a[164:167], a[132:135], v[180:183]
v_mfma_f32_16x16x32_bf16 v[176:179], a[160:163], a[132:135], v[176:179]
ds_read_b64_tr_b16 a[120:121], v13 offset:40960
ds_read_b64_tr_b16 a[122:123], v13 offset:41472
v_mfma_f32_16x16x32_bf16 v[192:195], a[160:163], a[136:139], v[192:195]
v_mfma_f32_16x16x32_bf16 v[196:199], a[164:167], a[136:139], v[196:199]
ds_read_b64_tr_b16 a[124:125], v14 offset:40960
ds_read_b64_tr_b16 a[126:127], v14 offset:41472
v_mfma_f32_16x16x32_bf16 v[200:203], a[168:171], a[136:139], v[200:203]
s_add_u32 m0, s67, 16384
s_add_u32 s52, s66, 4096
v_mfma_f32_16x16x32_bf16 v[204:207], a[172:175], a[136:139], v[204:207]
ds_read_b64_tr_b16 a[96:97], v11 offset:32768
ds_read_b64_tr_b16 a[98:99], v11 offset:33280
v_mfma_f32_16x16x32_bf16 v[64:67], a[136:139], a[176:179], v[64:67]
buffer_load_dwordx4 v4, s[24:27], s52 offen sc1 lds
v_mfma_f32_16x16x32_bf16 v[72:75], a[136:139], a[180:183], v[72:75]
s_cmp_eq_u32 s57, 1024
s_cselect_b32 s53, -1024, 64
s_cselect_b32 s56, 0, 64
v_mfma_f32_16x16x32_bf16 v[80:83], a[136:139], a[184:187], v[80:83]
s_add_u32 s53, s53, s56
s_add_u32 s57, s57, s53
s_add_u32 s58, s58, s53
v_mfma_f32_16x16x32_bf16 v[88:91], a[136:139], a[188:191], v[88:91]
s_add_u32 s59, s59, s53
ds_read_b64_tr_b16 a[100:101], v12 offset:32768
ds_read_b64_tr_b16 a[102:103], v12 offset:33280
v_mfma_f32_16x16x32_bf16 v[92:95], a[140:143], a[188:191], v[92:95]
v_mfma_f32_16x16x32_bf16 v[84:87], a[140:143], a[184:187], v[84:87]
ds_read_b64_tr_b16 a[104:105], v13 offset:32768
ds_read_b64_tr_b16 a[106:107], v13 offset:33280
v_mfma_f32_16x16x32_bf16 v[76:79], a[140:143], a[180:183], v[76:79]
s_add_u32 m0, s60, 0
s_add_u32 s52, s58, 0
v_mfma_f32_16x16x32_bf16 v[68:71], a[140:143], a[176:179], v[68:71]
ds_read_b64_tr_b16 a[108:109], v14 offset:32768
ds_read_b64_tr_b16 a[110:111], v14 offset:33280
v_mfma_f32_16x16x32_bf16 v[220:223], a[172:175], a[140:143], v[220:223]
buffer_load_dwordx4 v5, s[12:15], s52 offen lds
v_mfma_f32_16x16x32_bf16 v[216:219], a[168:171], a[140:143], v[216:219]
v_mfma_f32_16x16x32_bf16 v[212:215], a[164:167], a[140:143], v[212:215]
v_mfma_f32_16x16x32_bf16 v[208:211], a[160:163], a[140:143], v[208:211]
v_mfma_f32_16x16x32_bf16 v[224:227], a[160:163], a[144:147], v[224:227]
v_mfma_f32_16x16x32_bf16 v[228:231], a[164:167], a[144:147], v[228:231]
v_mfma_f32_16x16x32_bf16 v[232:235], a[168:171], a[144:147], v[232:235]
v_mfma_f32_16x16x32_bf16 v[236:239], a[172:175], a[144:147], v[236:239]
v_mfma_f32_16x16x32_bf16 v[96:99], a[144:147], a[176:179], v[96:99]
v_mfma_f32_16x16x32_bf16 v[104:107], a[144:147], a[180:183], v[104:107]
buffer_load_dwordx4 v6, s[12:15], s52 offen offset:1024 lds
v_mfma_f32_16x16x32_bf16 v[112:115], a[144:147], a[184:187], v[112:115]
v_mfma_f32_16x16x32_bf16 v[120:123], a[144:147], a[188:191], v[120:123]
v_mfma_f32_16x16x32_bf16 v[124:127], a[148:151], a[188:191], v[124:127]
v_mfma_f32_16x16x32_bf16 v[116:119], a[148:151], a[184:187], v[116:119]
v_mfma_f32_16x16x32_bf16 v[108:111], a[148:151], a[180:183], v[108:111]
v_mfma_f32_16x16x32_bf16 v[100:103], a[148:151], a[176:179], v[100:103]
s_add_u32 m0, s60, 2048
s_add_u32 s52, s58, 18432
v_mfma_f32_16x16x32_bf16 v[252:255], a[172:175], a[148:151], v[252:255]
v_mfma_f32_16x16x32_bf16 v[248:251], a[168:171], a[148:151], v[248:251]
buffer_load_dwordx4 v5, s[12:15], s52 offen lds
v_mfma_f32_16x16x32_bf16 v[244:247], a[164:167], a[148:151], v[244:247]
v_mfma_f32_16x16x32_bf16 v[240:243], a[160:163], a[148:151], v[240:243]
v_mfma_f32_16x16x32_bf16 a[0:3], a[160:163], a[152:155], a[0:3]
v_mfma_f32_16x16x32_bf16 a[4:7], a[164:167], a[152:155], a[4:7]
v_mfma_f32_16x16x32_bf16 a[8:11], a[168:171], a[152:155], a[8:11]
v_mfma_f32_16x16x32_bf16 a[12:15], a[172:175], a[152:155], a[12:15]
v_mfma_f32_16x16x32_bf16 v[128:131], a[152:155], a[176:179], v[128:131]
v_mfma_f32_16x16x32_bf16 v[136:139], a[152:155], a[180:183], v[136:139]
buffer_load_dwordx4 v6, s[12:15], s52 offen offset:1024 lds
v_mfma_f32_16x16x32_bf16 v[144:147], a[152:155], a[184:187], v[144:147]
v_mfma_f32_16x16x32_bf16 v[152:155], a[152:155], a[188:191], v[152:155]
v_mfma_f32_16x16x32_bf16 v[156:159], a[156:159], a[188:191], v[156:159]
v_mfma_f32_16x16x32_bf16 v[148:151], a[156:159], a[184:187], v[148:151]
v_mfma_f32_16x16x32_bf16 v[140:143], a[156:159], a[180:183], v[140:143]
v_mfma_f32_16x16x32_bf16 v[132:135], a[156:159], a[176:179], v[132:135]
v_mfma_f32_16x16x32_bf16 a[28:31], a[172:175], a[156:159], a[28:31]
v_mfma_f32_16x16x32_bf16 a[24:27], a[168:171], a[156:159], a[24:27]
v_mfma_f32_16x16x32_bf16 a[20:23], a[164:167], a[156:159], a[20:23]
v_mfma_f32_16x16x32_bf16 a[16:19], a[160:163], a[156:159], a[16:19]
s_waitcnt lgkmcnt(0)
v_mfma_f32_16x16x32_bf16 v[32:35], a[64:67], a[112:115], v[32:35]
s_waitcnt vmcnt(18)
v_mfma_f32_16x16x32_bf16 v[36:39], a[68:71], a[112:115], v[36:39]
s_barrier
v_mfma_f32_16x16x32_bf16 v[40:43], a[64:67], a[116:119], v[40:43]
ds_read_b128 a[128:131], v10 offset:0
ds_read_b128 a[132:135], v10 offset:2048
v_mfma_f32_16x16x32_bf16 v[44:47], a[68:71], a[116:119], v[44:47]
ds_read_b128 a[136:139], v10 offset:4096
ds_read_b128 a[140:143], v10 offset:6144
v_mfma_f32_16x16x32_bf16 v[48:51], a[64:67], a[120:123], v[48:51]
ds_read_b128 a[144:147], v10 offset:8192
ds_read_b128 a[148:151], v10 offset:10240
v_mfma_f32_16x16x32_bf16 v[52:55], a[68:71], a[120:123], v[52:55]
ds_read_b128 a[152:155], v10 offset:12288
ds_read_b128 a[156:159], v10 offset:14336
v_mfma_f32_16x16x32_bf16 v[56:59], a[64:67], a[124:127], v[56:59]
ds_read_b64_tr_b16 a[176:177], v11 offset:57344
ds_read_b64_tr_b16 a[178:179], v11 offset:57856
v_mfma_f32_16x16x32_bf16 v[60:63], a[68:71], a[124:127], v[60:63]
ds_read_b64_tr_b16 a[180:181], v12 offset:57344
ds_read_b64_tr_b16 a[182:183], v12 offset:57856
v_mfma_f32_16x16x32_bf16 v[64:67], a[72:75], a[112:115], v[64:67]
ds_read_b64_tr_b16 a[184:185], v13 offset:57344
ds_read_b64_tr_b16 a[186:187], v13 offset:57856
v_mfma_f32_16x16x32_bf16 v[68:71], a[76:79], a[112:115], v[68:71]
ds_read_b64_tr_b16 a[188:189], v14 offset:57344
ds_read_b64_tr_b16 a[190:191], v14 offset:57856
v_mfma_f32_16x16x32_bf16 v[72:75], a[72:75], a[116:119], v[72:75]
ds_read_b64_tr_b16 a[160:161], v11 offset:49152
ds_read_b64_tr_b16 a[162:163], v11 offset:49664
v_mfma_f32_16x16x32_bf16 v[76:79], a[76:79], a[116:119], v[76:79]
ds_read_b64_tr_b16 a[164:165], v12 offset:49152
ds_read_b64_tr_b16 a[166:167], v12 offset:49664
v_mfma_f32_16x16x32_bf16 v[80:83], a[72:75], a[120:123], v[80:83]
ds_read_b64_tr_b16 a[168:169], v13 offset:49152
ds_read_b64_tr_b16 a[170:171], v13 offset:49664
v_mfma_f32_16x16x32_bf16 v[84:87], a[76:79], a[120:123], v[84:87]
ds_read_b64_tr_b16 a[172:173], v14 offset:49152
ds_read_b64_tr_b16 a[174:175], v14 offset:49664
v_mfma_f32_16x16x32_bf16 v[88:91], a[72:75], a[124:127], v[88:91]
v_mfma_f32_16x16x32_bf16 v[92:95], a[76:79], a[124:127], v[92:95]
s_add_u32 s62, s62, 1
s_cmp_eq_u32 s62, 9
s_cselect_b32 s62, 0, s62
v_mfma_f32_16x16x32_bf16 v[96:99], a[80:83], a[112:115], v[96:99]
s_lshl_b32 s63, s62, 19
s_add_u32 s63, s63, s61
v_mfma_f32_16x16x32_bf16 v[100:103], a[84:87], a[112:115], v[100:103]
s_lshl_b32 s66, s62, 13
s_add_u32 s66, s66, s65
v_mfma_f32_16x16x32_bf16 v[104:107], a[80:83], a[116:119], v[104:107]
s_add_u32 m0, s64, 32768
s_add_u32 s52, s63, 0
v_mfma_f32_16x16x32_bf16 v[108:111], a[84:87], a[116:119], v[108:111]
buffer_load_dwordx4 v7, s[20:23], s52 offen lds
v_mfma_f32_16x16x32_bf16 v[112:115], a[80:83], a[120:123], v[112:115]
v_mfma_f32_16x16x32_bf16 v[116:119], a[84:87], a[120:123], v[116:119]
v_mfma_f32_16x16x32_bf16 v[120:123], a[80:83], a[124:127], v[120:123]
buffer_load_dwordx4 v8, s[20:23], s52 offen offset:1024 lds
v_mfma_f32_16x16x32_bf16 v[124:127], a[84:87], a[124:127], v[124:127]
v_mfma_f32_16x16x32_bf16 v[128:131], a[88:91], a[112:115], v[128:131]
v_mfma_f32_16x16x32_bf16 v[132:135], a[92:95], a[112:115], v[132:135]
v_add_u32 v9, 32768, v9
v_add_u32 v10, 32768, v10
v_mfma_f32_16x16x32_bf16 v[136:139], a[88:91], a[116:119], v[136:139]
v_mfma_f32_16x16x32_bf16 v[140:143], a[92:95], a[116:119], v[140:143]
s_add_u32 m0, s67, 32768
s_add_u32 s52, s66, 0
v_mfma_f32_16x16x32_bf16 v[144:147], a[88:91], a[120:123], v[144:147]
v_mfma_f32_16x16x32_bf16 v[148:151], a[92:95], a[120:123], v[148:151]
buffer_load_dwordx4 v4, s[24:27], s52 offen sc1 lds
v_mfma_f32_16x16x32_bf16 v[152:155], a[88:91], a[124:127], v[152:155]
v_mfma_f32_16x16x32_bf16 v[156:159], a[92:95], a[124:127], v[156:159]
s_waitcnt lgkmcnt(0)
v_mfma_f32_16x16x32_bf16 v[32:35], a[128:131], a[176:179], v[32:35]
v_mfma_f32_16x16x32_bf16 v[36:39], a[132:135], a[176:179], v[36:39]
s_add_u32 m0, s60, 4096
s_add_u32 s52, s59, 0
v_mfma_f32_16x16x32_bf16 v[40:43], a[128:131], a[180:183], v[40:43]
s_lshr_b32 s51, s3, 1
s_lshl_b32 s51, s51, 14
s_lshl_b32 s50, s3, 13
v_mfma_f32_16x16x32_bf16 v[44:47], a[132:135], a[180:183], v[44:47]
buffer_load_dwordx4 v5, s[12:15], s52 offen lds
v_mfma_f32_16x16x32_bf16 v[48:51], a[128:131], a[184:187], v[48:51]
s_sub_u32 s51, s50, s51
s_and_b32 s50, s3, 1
s_lshl_b32 s50, s50, 12
v_mfma_f32_16x16x32_bf16 v[52:55], a[132:135], a[184:187], v[52:55]
v_add_u32 v9, s51, v9
v_add_u32 v10, s51, v10
v_mfma_f32_16x16x32_bf16 v[56:59], a[128:131], a[188:191], v[56:59]
v_subrev_u32 v11, s50, v11
v_subrev_u32 v12, s50, v12
v_mfma_f32_16x16x32_bf16 v[60:63], a[132:135], a[188:191], v[60:63]
v_subrev_u32 v13, s50, v13
v_subrev_u32 v14, s50, v14
v_mfma_f32_16x16x32_bf16 v[64:67], a[136:139], a[176:179], v[64:67]
v_cvt_pk_bf16_f32 v32, v32, v33
v_cvt_pk_bf16_f32 v33, v34, v35
v_mfma_f32_16x16x32_bf16 v[68:71], a[140:143], a[176:179], v[68:71]
v_cvt_pk_bf16_f32 v34, v36, v37
v_cvt_pk_bf16_f32 v35, v38, v39
v_mfma_f32_16x16x32_bf16 v[72:75], a[136:139], a[180:183], v[72:75]
buffer_load_dwordx4 v6, s[12:15], s52 offen offset:1024 lds
v_mfma_f32_16x16x32_bf16 v[76:79], a[140:143], a[180:183], v[76:79]
v_cvt_pk_bf16_f32 v40, v40, v41
v_cvt_pk_bf16_f32 v41, v42, v43
v_mfma_f32_16x16x32_bf16 v[80:83], a[136:139], a[184:187], v[80:83]
s_add_u32 s49, s77, 0
v_cvt_pk_bf16_f32 v42, v44, v45
v_cvt_pk_bf16_f32 v43, v46, v47
v_mfma_f32_16x16x32_bf16 v[84:87], a[140:143], a[184:187], v[84:87]
buffer_store_dwordx4 v[32:35], v4, s[24:27], s49 offen offset:0 sc1
v_mfma_f32_16x16x32_bf16 v[88:91], a[136:139], a[188:191], v[88:91]
s_add_u32 m0, s60, 6144
s_add_u32 s52, s59, 18432
v_cvt_pk_bf16_f32 v48, v48, v49
v_mfma_f32_16x16x32_bf16 v[92:95], a[140:143], a[188:191], v[92:95]
v_cvt_pk_bf16_f32 v49, v50, v51
v_cvt_pk_bf16_f32 v50, v52, v53
v_mfma_f32_16x16x32_bf16 v[96:99], a[144:147], a[176:179], v[96:99]
buffer_load_dwordx4 v5, s[12:15], s52 offen lds
v_mfma_f32_16x16x32_bf16 v[100:103], a[148:151], a[176:179], v[100:103]
v_cvt_pk_bf16_f32 v51, v54, v55
v_cvt_pk_bf16_f32 v56, v56, v57
v_mfma_f32_16x16x32_bf16 v[104:107], a[144:147], a[180:183], v[104:107]
v_cvt_pk_bf16_f32 v57, v58, v59
v_cvt_pk_bf16_f32 v58, v60, v61
v_mfma_f32_16x16x32_bf16 v[108:111], a[148:151], a[180:183], v[108:111]
v_cvt_pk_bf16_f32 v59, v62, v63
v_cvt_pk_bf16_f32 v64, v64, v65
v_mfma_f32_16x16x32_bf16 v[112:115], a[144:147], a[184:187], v[112:115]
v_cvt_pk_bf16_f32 v65, v66, v67
v_cvt_pk_bf16_f32 v66, v68, v69
v_mfma_f32_16x16x32_bf16 v[116:119], a[148:151], a[184:187], v[116:119]
s_add_u32 s49, s77, 0
v_cvt_pk_bf16_f32 v67, v70, v71
v_cvt_pk_bf16_f32 v72, v72, v73
v_mfma_f32_16x16x32_bf16 v[120:123], a[144:147], a[188:191], v[120:123]
buffer_store_dwordx4 v[40:43], v4, s[24:27], s49 offen offset:1024 sc1
v_mfma_f32_16x16x32_bf16 v[124:127], a[148:151], a[188:191], v[124:127]
buffer_load_dwordx4 v6, s[12:15], s52 offen offset:1024 lds
v_mfma_f32_16x16x32_bf16 v[128:131], a[152:155], a[176:179], v[128:131]
v_cvt_pk_bf16_f32 v73, v74, v75
v_cvt_pk_bf16_f32 v74, v76, v77
v_mfma_f32_16x16x32_bf16 v[132:135], a[156:159], a[176:179], v[132:135]
v_cvt_pk_bf16_f32 v75, v78, v79
v_cvt_pk_bf16_f32 v80, v80, v81
v_mfma_f32_16x16x32_bf16 v[136:139], a[152:155], a[180:183], v[136:139]
v_cvt_pk_bf16_f32 v81, v82, v83
v_cvt_pk_bf16_f32 v82, v84, v85
v_mfma_f32_16x16x32_bf16 v[140:143], a[156:159], a[180:183], v[140:143]
v_cvt_pk_bf16_f32 v83, v86, v87
v_cvt_pk_bf16_f32 v88, v88, v89
v_mfma_f32_16x16x32_bf16 v[144:147], a[152:155], a[184:187], v[144:147]
v_cvt_pk_bf16_f32 v89, v90, v91
v_cvt_pk_bf16_f32 v90, v92, v93
v_mfma_f32_16x16x32_bf16 v[148:151], a[156:159], a[184:187], v[148:151]
v_cvt_pk_bf16_f32 v91, v94, v95
v_cvt_pk_bf16_f32 v96, v96, v97
v_mfma_f32_16x16x32_bf16 v[152:155], a[152:155], a[188:191], v[152:155]
s_add_u32 s49, s77, 0
v_cvt_pk_bf16_f32 v97, v98, v99
v_cvt_pk_bf16_f32 v98, v100, v101
v_mfma_f32_16x16x32_bf16 v[156:159], a[156:159], a[188:191], v[156:159]
buffer_store_dwordx4 v[48:51], v4, s[24:27], s49 offen offset:2048 sc1
v_mfma_f32_16x16x32_bf16 v[160:163], a[96:99], a[64:67], v[160:163]
s_waitcnt vmcnt(17)
v_cvt_pk_bf16_f32 v99, v102, v103
v_cvt_pk_bf16_f32 v104, v104, v105
v_mfma_f32_16x16x32_bf16 v[160:163], a[160:163], a[128:131], v[160:163]
s_barrier
v_mfma_f32_16x16x32_bf16 v[164:167], a[100:103], a[64:67], v[164:167]
ds_read_b128 a[112:115], v9 offset:0
ds_read_b128 a[116:119], v9 offset:2048
v_mfma_f32_16x16x32_bf16 v[164:167], a[164:167], a[128:131], v[164:167]
s_add_u32 m0, s64, 49152
s_add_u32 s52, s63, 262144
v_cvt_pk_bf16_f32 v105, v106, v107
v_mfma_f32_16x16x32_bf16 v[168:171], a[104:107], a[64:67], v[168:171]
buffer_load_dwordx4 v7, s[20:23], s52 offen lds
v_mfma_f32_16x16x32_bf16 v[168:171], a[168:171], a[128:131], v[168:171]
ds_read_b128 a[120:123], v9 offset:4096
ds_read_b128 a[124:127], v9 offset:6144
v_mfma_f32_16x16x32_bf16 v[172:175], a[108:111], a[64:67], v[172:175]
v_cvt_pk_bf16_f32 v106, v108, v109
v_cvt_pk_bf16_f32 v107, v110, v111
v_mfma_f32_16x16x32_bf16 v[172:175], a[172:175], a[128:131], v[172:175]
s_add_u32 s49, s77, 0
ds_read_b64_tr_b16 a[176:177], v11 offset:0
ds_read_b64_tr_b16 a[178:179], v11 offset:512
v_mfma_f32_16x16x32_bf16 v[176:179], a[96:99], a[68:71], v[176:179]
buffer_store_dwordx4 v[56:59], v4, s[24:27], s49 offen offset:3072 sc1
v_mfma_f32_16x16x32_bf16 v[176:179], a[160:163], a[132:135], v[176:179]
ds_read_b64_tr_b16 a[180:181], v12 offset:0
ds_read_b64_tr_b16 a[182:183], v12 offset:512
v_mfma_f32_16x16x32_bf16 v[180:183], a[100:103], a[68:71], v[180:183]
v_cvt_pk_bf16_f32 v112, v112, v113
v_cvt_pk_bf16_f32 v113, v114, v115
v_mfma_f32_16x16x32_bf16 v[180:183], a[164:167], a[132:135], v[180:183]
ds_read_b64_tr_b16 a[184:185], v13 offset:0
ds_read_b64_tr_b16 a[186:187], v13 offset:512
v_mfma_f32_16x16x32_bf16 v[184:187], a[104:107], a[68:71], v[184:187]
buffer_load_dwordx4 v8, s[20:23], s52 offen offset:1024 lds
v_mfma_f32_16x16x32_bf16 v[184:187], a[168:171], a[132:135], v[184:187]
ds_read_b64_tr_b16 a[188:189], v14 offset:0
ds_read_b64_tr_b16 a[190:191], v14 offset:512
v_mfma_f32_16x16x32_bf16 v[188:191], a[108:111], a[68:71], v[188:191]
ds_read_b64_tr_b16 a[64:65], v11 offset:4096
ds_read_b64_tr_b16 a[66:67], v11 offset:4608
v_mfma_f32_16x16x32_bf16 v[188:191], a[172:175], a[132:135], v[188:191]
ds_read_b64_tr_b16 a[128:129], v12 offset:4096
ds_read_b64_tr_b16 a[130:131], v12 offset:4608
v_mfma_f32_16x16x32_bf16 v[192:195], a[96:99], a[72:75], v[192:195]
s_add_u32 s49, s77, 16384
ds_read_b64_tr_b16 a[68:69], v13 offset:4096
ds_read_b64_tr_b16 a[70:71], v13 offset:4608
v_mfma_f32_16x16x32_bf16 v[192:195], a[160:163], a[136:139], v[192:195]
ds_read_b64_tr_b16 a[132:133], v14 offset:4096
ds_read_b64_tr_b16 a[134:135], v14 offset:4608
v_mfma_f32_16x16x32_bf16 v[196:199], a[100:103], a[72:75], v[196:199]
s_add_u32 m0, s67, 49152
s_add_u32 s52, s66, 4096
v_cvt_pk_bf16_f32 v114, v116, v117
v_mfma_f32_16x16x32_bf16 v[196:199], a[164:167], a[136:139], v[196:199]
buffer_store_dwordx4 v[64:67], v4, s[24:27], s49 offen offset:0 sc1
v_mfma_f32_16x16x32_bf16 v[200:203], a[104:107], a[72:75], v[200:203]
buffer_load_dwordx4 v4, s[24:27], s52 offen sc1 lds
v_mfma_f32_16x16x32_bf16 v[200:203], a[168:171], a[136:139], v[200:203]
s_cmp_eq_u32 s57, 1024
s_cselect_b32 s53, -1024, 64
s_cselect_b32 s56, 0, 64
v_mfma_f32_16x16x32_bf16 v[204:207], a[108:111], a[72:75], v[204:207]
s_add_u32 s53, s53, s56
s_add_u32 s57, s57, s53
s_add_u32 s58, s58, s53
v_mfma_f32_16x16x32_bf16 v[204:207], a[172:175], a[136:139], v[204:207]
s_add_u32 s59, s59, s53
v_cvt_pk_bf16_f32 v115, v118, v119
v_cvt_pk_bf16_f32 v120, v120, v121
v_mfma_f32_16x16x32_bf16 v[208:211], a[96:99], a[76:79], v[208:211]
ds_read_b128 a[72:75], v4 offset:8192
ds_read_b128 a[136:139], v4 offset:9216
v_mfma_f32_16x16x32_bf16 v[208:211], a[160:163], a[140:143], v[208:211]
v_cvt_pk_bf16_f32 v121, v122, v123
v_cvt_pk_bf16_f32 v122, v124, v125
v_mfma_f32_16x16x32_bf16 v[212:215], a[100:103], a[76:79], v[212:215]
s_add_u32 m0, s60, 32768
s_add_u32 s52, s58, 0
v_cvt_pk_bf16_f32 v123, v126, v127
v_mfma_f32_16x16x32_bf16 v[212:215], a[164:167], a[140:143], v[212:215]
s_add_u32 s49, s77, 16384
v_cvt_pk_bf16_f32 v128, v128, v129
v_cvt_pk_bf16_f32 v129, v130, v131
v_mfma_f32_16x16x32_bf16 v[216:219], a[104:107], a[76:79], v[216:219]
buffer_load_dwordx4 v5, s[12:15], s52 offen lds
v_mfma_f32_16x16x32_bf16 v[216:219], a[168:171], a[140:143], v[216:219]
buffer_store_dwordx4 v[72:75], v4, s[24:27], s49 offen offset:1024 sc1
v_mfma_f32_16x16x32_bf16 v[220:223], a[108:111], a[76:79], v[220:223]
v_cvt_pk_bf16_f32 v130, v132, v133
v_cvt_pk_bf16_f32 v131, v134, v135
v_mfma_f32_16x16x32_bf16 v[220:223], a[172:175], a[140:143], v[220:223]
v_cvt_pk_bf16_f32 v136, v136, v137
v_cvt_pk_bf16_f32 v137, v138, v139
v_mfma_f32_16x16x32_bf16 v[224:227], a[96:99], a[80:83], v[224:227]
ds_read_b128 a[76:79], v4 offset:10240
ds_read_b128 a[140:143], v4 offset:11264
v_mfma_f32_16x16x32_bf16 v[224:227], a[160:163], a[144:147], v[224:227]
v_cvt_pk_bf16_f32 v138, v140, v141
v_cvt_pk_bf16_f32 v139, v142, v143
v_mfma_f32_16x16x32_bf16 v[228:231], a[100:103], a[80:83], v[228:231]
v_cvt_pk_bf16_f32 v144, v144, v145
v_cvt_pk_bf16_f32 v145, v146, v147
v_mfma_f32_16x16x32_bf16 v[228:231], a[164:167], a[144:147], v[228:231]
v_cvt_pk_bf16_f32 v146, v148, v149
v_cvt_pk_bf16_f32 v147, v150, v151
v_mfma_f32_16x16x32_bf16 v[232:235], a[104:107], a[80:83], v[232:235]
v_cvt_pk_bf16_f32 v152, v152, v153
v_cvt_pk_bf16_f32 v153, v154, v155
v_mfma_f32_16x16x32_bf16 v[232:235], a[168:171], a[144:147], v[232:235]
buffer_load_dwordx4 v6, s[12:15], s52 offen offset:1024 lds
v_mfma_f32_16x16x32_bf16 v[236:239], a[108:111], a[80:83], v[236:239]
s_add_u32 s49, s77, 16384
v_cvt_pk_bf16_f32 v154, v156, v157
v_cvt_pk_bf16_f32 v155, v158, v159
v_mfma_f32_16x16x32_bf16 v[236:239], a[172:175], a[144:147], v[236:239]
buffer_store_dwordx4 v[80:83], v4, s[24:27], s49 offen offset:2048 sc1
v_mfma_f32_16x16x32_bf16 v[240:243], a[96:99], a[84:87], v[240:243]
v_mul_f32 v160, s80, v160
v_mul_f32 v161, s80, v161
v_mfma_f32_16x16x32_bf16 v[240:243], a[160:163], a[148:151], v[240:243]
v_mul_f32 v162, s80, v162
v_mul_f32 v163, s80, v163
v_mfma_f32_16x16x32_bf16 v[244:247], a[100:103], a[84:87], v[244:247]
v_mul_f32 v164, s80, v164
v_mul_f32 v165, s80, v165
v_mfma_f32_16x16x32_bf16 v[244:247], a[164:167], a[148:151], v[244:247]
s_add_u32 m0, s60, 34816
s_add_u32 s52, s58, 18432
v_mul_f32 v166, s80, v166
v_mfma_f32_16x16x32_bf16 v[248:251], a[104:107], a[84:87], v[248:251]
v_mul_f32 v167, s80, v167
v_cvt_pk_bf16_f32 v160, v160, v161
v_mfma_f32_16x16x32_bf16 v[248:251], a[168:171], a[148:151], v[248:251]
buffer_load_dwordx4 v5, s[12:15], s52 offen lds
v_mfma_f32_16x16x32_bf16 v[252:255], a[108:111], a[84:87], v[252:255]
v_cvt_pk_bf16_f32 v161, v162, v163
v_cvt_pk_bf16_f32 v162, v164, v165
v_mfma_f32_16x16x32_bf16 v[252:255], a[172:175], a[148:151], v[252:255]
s_add_u32 s49, s77, 16384
v_cvt_pk_bf16_f32 v163, v166, v167
v_mul_f32 v168, s80, v168
v_mfma_f32_16x16x32_bf16 a[0:3], a[96:99], a[88:91], a[0:3]
buffer_store_dwordx4 v[88:91], v4, s[24:27], s49 offen offset:3072 sc1
v_mfma_f32_16x16x32_bf16 a[0:3], a[160:163], a[152:155], a[0:3]
v_mul_f32 v169, s80, v169
v_mul_f32 v170, s80, v170
v_mfma_f32_16x16x32_bf16 a[4:7], a[100:103], a[88:91], a[4:7]
v_mul_f32 v171, s80, v171
v_mul_f32 v172, s80, v172
v_mfma_f32_16x16x32_bf16 a[4:7], a[164:167], a[152:155], a[4:7]
v_mul_f32 v173, s80, v173
v_mul_f32 v174, s80, v174
v_mfma_f32_16x16x32_bf16 a[8:11], a[104:107], a[88:91], a[8:11]
v_mul_f32 v175, s80, v175
v_cvt_pk_bf16_f32 v168, v168, v169
v_mfma_f32_16x16x32_bf16 a[8:11], a[168:171], a[152:155], a[8:11]
buffer_load_dwordx4 v6, s[12:15], s52 offen offset:1024 lds
v_mfma_f32_16x16x32_bf16 a[12:15], a[108:111], a[88:91], a[12:15]
v_cvt_pk_bf16_f32 v169, v170, v171
v_cvt_pk_bf16_f32 v170, v172, v173
v_mfma_f32_16x16x32_bf16 a[12:15], a[172:175], a[152:155], a[12:15]
v_cvt_pk_bf16_f32 v171, v174, v175
v_mul_f32 v176, s80, v176
v_mfma_f32_16x16x32_bf16 a[16:19], a[96:99], a[92:95], a[16:19]
s_add_u32 s49, s77, 32768
v_mul_f32 v177, s80, v177
v_mul_f32 v178, s80, v178
v_mfma_f32_16x16x32_bf16 a[16:19], a[160:163], a[156:159], a[16:19]
buffer_store_dwordx4 v[96:99], v4, s[24:27], s49 offen offset:0 sc1
v_mfma_f32_16x16x32_bf16 a[20:23], a[100:103], a[92:95], a[20:23]
v_mul_f32 v179, s80, v179
v_mul_f32 v180, s80, v180
v_mfma_f32_16x16x32_bf16 a[20:23], a[164:167], a[156:159], a[20:23]
v_mul_f32 v181, s80, v181
v_mul_f32 v182, s80, v182
v_mfma_f32_16x16x32_bf16 a[24:27], a[104:107], a[92:95], a[24:27]
v_mul_f32 v183, s80, v183
v_cvt_pk_bf16_f32 v176, v176, v177
v_mfma_f32_16x16x32_bf16 a[24:27], a[168:171], a[156:159], a[24:27]
v_cvt_pk_bf16_f32 v177, v178, v179
v_cvt_pk_bf16_f32 v178, v180, v181
v_mfma_f32_16x16x32_bf16 a[28:31], a[108:111], a[92:95], a[28:31]
v_cvt_pk_bf16_f32 v179, v182, v183
v_mul_f32 v184, s80, v184
v_mfma_f32_16x16x32_bf16 a[28:31], a[172:175], a[156:159], a[28:31]
s_waitcnt lgkmcnt(0)
v_mul_f32 v185, s80, v185
v_mul_f32 v186, s80, v186
v_mfma_f32_16x16x32_bf16 a[32:35], a[176:179], a[112:115], 0
s_waitcnt vmcnt(27)
v_mul_f32 v187, s80, v187
v_mul_f32 v188, s80, v188
v_mfma_f32_16x16x32_bf16 a[36:39], a[176:179], a[116:119], 0
s_barrier
v_mfma_f32_16x16x32_bf16 a[40:43], a[176:179], a[120:123], 0
s_add_u32 s49, s77, 32768
ds_read_b128 a[96:99], v10 offset:0
ds_read_b128 a[100:103], v10 offset:2048
v_mfma_f32_16x16x32_bf16 a[44:47], a[176:179], a[124:127], 0
s_add_u32 s62, s62, 1
s_cmp_eq_u32 s62, 9
s_cselect_b32 s62, 0, s62
v_mfma_f32_16x16x32_bf16 a[48:51], a[180:183], a[124:127], 0
s_lshl_b32 s63, s62, 19
s_add_u32 s63, s63, s61
v_mul_f32 v189, s80, v189
v_mfma_f32_16x16x32_bf16 a[52:55], a[180:183], a[120:123], 0
s_lshl_b32 s66, s62, 13
s_add_u32 s66, s66, s65
v_mul_f32 v190, s80, v190
v_mfma_f32_16x16x32_bf16 a[56:59], a[180:183], a[116:119], 0
s_add_u32 m0, s64, 0
s_add_u32 s52, s63, 0
v_mul_f32 v191, s80, v191
v_mfma_f32_16x16x32_bf16 a[60:63], a[180:183], a[112:115], 0
buffer_load_dwordx4 v7, s[20:23], s52 offen lds
v_mfma_f32_16x16x32_bf16 a[192:195], a[184:187], a[112:115], 0
ds_read_b128 a[104:107], v10 offset:4096
ds_read_b128 a[108:111], v10 offset:6144
v_mfma_f32_16x16x32_bf16 a[196:199], a[184:187], a[116:119], 0
buffer_store_dwordx4 v[104:107], v4, s[24:27], s49 offen offset:1024 sc1
v_mfma_f32_16x16x32_bf16 a[200:203], a[184:187], a[120:123], 0
buffer_load_dwordx4 v8, s[20:23], s52 offen offset:1024 lds
v_mfma_f32_16x16x32_bf16 a[204:207], a[184:187], a[124:127], 0
ds_read_b64_tr_b16 a[160:161], v11 offset:16384
ds_read_b64_tr_b16 a[162:163], v11 offset:16896
v_mfma_f32_16x16x32_bf16 a[208:211], a[188:191], a[124:127], 0
v_cvt_pk_bf16_f32 v184, v184, v185
v_cvt_pk_bf16_f32 v185, v186, v187
v_mfma_f32_16x16x32_bf16 a[212:215], a[188:191], a[120:123], 0
ds_read_b64_tr_b16 a[164:165], v12 offset:16384
ds_read_b64_tr_b16 a[166:167], v12 offset:16896
v_mfma_f32_16x16x32_bf16 a[216:219], a[188:191], a[116:119], 0
s_add_u32 m0, s67, 0
s_add_u32 s52, s66, 0
v_cvt_pk_bf16_f32 v186, v188, v189
v_mfma_f32_16x16x32_bf16 a[220:223], a[188:191], a[112:115], 0
ds_read_b64_tr_b16 a[168:169], v13 offset:16384
ds_read_b64_tr_b16 a[170:171], v13 offset:16896
v_mfma_f32_16x16x32_bf16 a[224:227], a[64:67], a[112:115], 0
buffer_load_dwordx4 v4, s[24:27], s52 offen sc1 lds
v_mfma_f32_16x16x32_bf16 a[228:231], a[64:67], a[116:119], 0
s_add_u32 s49, s77, 32768
ds_read_b64_tr_b16 a[172:173], v14 offset:16384
ds_read_b64_tr_b16 a[174:175], v14 offset:16896
v_mfma_f32_16x16x32_bf16 a[232:235], a[64:67], a[120:123], 0
buffer_store_dwordx4 v[112:115], v4, s[24:27], s49 offen offset:2048 sc1
v_mfma_f32_16x16x32_bf16 a[236:239], a[64:67], a[124:127], 0
ds_read_b64_tr_b16 a[80:81], v11 offset:20480
ds_read_b64_tr_b16 a[82:83], v11 offset:20992
v_mfma_f32_16x16x32_bf16 a[240:243], a[128:131], a[124:127], 0
s_add_u32 m0, s60, 36864
s_add_u32 s52, s59, 0
v_cvt_pk_bf16_f32 v187, v190, v191
v_mfma_f32_16x16x32_bf16 a[244:247], a[128:131], a[120:123], 0
ds_read_b64_tr_b16 a[144:145], v12 offset:20480
ds_read_b64_tr_b16 a[146:147], v12 offset:20992
v_mfma_f32_16x16x32_bf16 v[36:39], a[128:131], a[116:119], 0
buffer_load_dwordx4 v5, s[12:15], s52 offen lds
v_mfma_f32_16x16x32_bf16 v[44:47], a[128:131], a[112:115], 0
ds_read_b64_tr_b16 a[84:85], v13 offset:20480
ds_read_b64_tr_b16 a[86:87], v13 offset:20992
v_mfma_f32_16x16x32_bf16 v[52:55], a[68:71], a[112:115], 0
v_mul_f32 v192, s80, v192
v_mul_f32 v193, s80, v193
v_mfma_f32_16x16x32_bf16 v[60:63], a[68:71], a[116:119], 0
ds_read_b64_tr_b16 a[148:149], v14 offset:20480
ds_read_b64_tr_b16 a[150:151], v14 offset:20992
v_mfma_f32_16x16x32_bf16 v[68:71], a[68:71], a[120:123], 0
v_mul_f32 v194, s80, v194
v_mul_f32 v195, s80, v195
v_mfma_f32_16x16x32_bf16 v[76:79], a[68:71], a[124:127], 0
ds_read_b128 a[88:91], v4 offset:24576
ds_read_b128 a[152:155], v4 offset:25600
v_mfma_f32_16x16x32_bf16 v[84:87], a[132:135], a[124:127], 0
buffer_load_dwordx4 v6, s[12:15], s52 offen offset:1024 lds
v_mfma_f32_16x16x32_bf16 v[92:95], a[132:135], a[120:123], 0
ds_read_b128 a[92:95], v4 offset:26624
ds_read_b128 a[156:159], v4 offset:27648
v_mfma_f32_16x16x32_bf16 v[100:103], a[132:135], a[116:119], 0
v_mul_f32 v196, s80, v196
v_mul_f32 v197, s80, v197
v_mfma_f32_16x16x32_bf16 v[108:111], a[132:135], a[112:115], 0
v_mul_f32 v198, s80, v198
v_mul_f32 v199, s80, v199
v_mfma_f32_16x16x32_bf16 v[116:119], a[72:75], a[112:115], 0
s_add_u32 m0, s60, 38912
s_add_u32 s52, s59, 18432
v_cvt_pk_bf16_f32 v192, v192, v193
v_mfma_f32_16x16x32_bf16 v[124:127], a[72:75], a[116:119], 0
s_add_u32 s49, s77, 32768
v_cvt_pk_bf16_f32 v193, v194, v195
v_cvt_pk_bf16_f32 v194, v196, v197
v_mfma_f32_16x16x32_bf16 v[132:135], a[72:75], a[120:123], 0
buffer_load_dwordx4 v5, s[12:15], s52 offen lds
v_mfma_f32_16x16x32_bf16 v[140:143], a[72:75], a[124:127], 0
buffer_store_dwordx4 v[120:123], v4, s[24:27], s49 offen offset:3072 sc1
v_mfma_f32_16x16x32_bf16 v[148:151], a[136:139], a[124:127], 0
v_cvt_pk_bf16_f32 v195, v198, v199
v_mul_f32 v200, s80, v200
v_mfma_f32_16x16x32_bf16 v[156:159], a[136:139], a[120:123], 0
v_mul_f32 v201, s80, v201
v_mul_f32 v202, s80, v202
v_mfma_f32_16x16x32_bf16 v[32:35], a[136:139], a[116:119], 0
v_mul_f32 v203, s80, v203
v_mul_f32 v204, s80, v204
v_mfma_f32_16x16x32_bf16 v[40:43], a[136:139], a[112:115], 0
v_mul_f32 v205, s80, v205
v_mul_f32 v206, s80, v206
v_mfma_f32_16x16x32_bf16 v[48:51], a[76:79], a[112:115], 0
buffer_load_dwordx4 v6, s[12:15], s52 offen offset:1024 lds
v_mfma_f32_16x16x32_bf16 v[56:59], a[76:79], a[116:119], 0
v_add_u32 v9, -65536, v9
v_add_u32 v10, -65536, v10
v_mfma_f32_16x16x32_bf16 v[64:67], a[76:79], a[120:123], 0
v_mul_f32 v207, s80, v207
v_cvt_pk_bf16_f32 v200, v200, v201
v_mfma_f32_16x16x32_bf16 v[72:75], a[76:79], a[124:127], 0
v_cvt_pk_bf16_f32 v201, v202, v203
v_cvt_pk_bf16_f32 v202, v204, v205
v_mfma_f32_16x16x32_bf16 v[80:83], a[140:143], a[124:127], 0
v_cvt_pk_bf16_f32 v203, v206, v207
v_mul_f32 v208, s80, v208
v_mfma_f32_16x16x32_bf16 v[88:91], a[140:143], a[120:123], 0
v_mul_f32 v209, s80, v209
v_mul_f32 v210, s80, v210
v_mfma_f32_16x16x32_bf16 v[96:99], a[140:143], a[116:119], 0
v_mul_f32 v211, s80, v211
v_mul_f32 v212, s80, v212
v_mfma_f32_16x16x32_bf16 v[104:107], a[140:143], a[112:115], 0
s_waitcnt lgkmcnt(0)
v_mul_f32 v213, s80, v213
v_mul_f32 v214, s80, v214
v_mfma_f32_16x16x32_bf16 a[32:35], a[160:163], a[96:99], a[32:35]
s_waitcnt vmcnt(24)
v_mul_f32 v215, s80, v215
v_cvt_pk_bf16_f32 v208, v208, v209
v_mfma_f32_16x16x32_bf16 a[36:39], a[160:163], a[100:103], a[36:39]
s_barrier
v_mfma_f32_16x16x32_bf16 a[40:43], a[160:163], a[104:107], a[40:43]
s_add_u32 s49, s77, 49152
ds_read_b128 a[112:115], v9 offset:0
ds_read_b128 a[116:119], v9 offset:2048
v_mfma_f32_16x16x32_bf16 a[44:47], a[160:163], a[108:111], a[44:47]
s_add_u32 m0, s64, 16384
s_add_u32 s52, s63, 262144
v_cvt_pk_bf16_f32 v209, v210, v211
v_mfma_f32_16x16x32_bf16 a[48:51], a[164:167], a[108:111], a[48:51]
buffer_load_dwordx4 v7, s[20:23], s52 offen lds
v_mfma_f32_16x16x32_bf16 a[52:55], a[164:167], a[104:107], a[52:55]
ds_read_b128 a[120:123], v9 offset:4096
ds_read_b128 a[124:127], v9 offset:6144
v_mfma_f32_16x16x32_bf16 a[56:59], a[164:167], a[100:103], a[56:59]
buffer_store_dwordx4 v[128:131], v4, s[24:27], s49 offen offset:0 sc1
v_mfma_f32_16x16x32_bf16 a[60:63], a[164:167], a[96:99], a[60:63]
ds_read_b64_tr_b16 a[176:177], v11 offset:32768
ds_read_b64_tr_b16 a[178:179], v11 offset:33280
v_mfma_f32_16x16x32_bf16 a[192:195], a[168:171], a[96:99], a[192:195]
v_cvt_pk_bf16_f32 v210, v212, v213
v_cvt_pk_bf16_f32 v211, v214, v215
v_mfma_f32_16x16x32_bf16 a[196:199], a[168:171], a[100:103], a[196:199]
ds_read_b64_tr_b16 a[180:181], v12 offset:32768
ds_read_b64_tr_b16 a[182:183], v12 offset:33280
v_mfma_f32_16x16x32_bf16 a[200:203], a[168:171], a[104:107], a[200:203]
buffer_load_dwordx4 v8, s[20:23], s52 offen offset:1024 lds
v_mfma_f32_16x16x32_bf16 a[204:207], a[168:171], a[108:111], a[204:207]
ds_read_b64_tr_b16 a[184:185], v13 offset:32768
ds_read_b64_tr_b16 a[186:187], v13 offset:33280
v_mfma_f32_16x16x32_bf16 a[208:211], a[172:175], a[108:111], a[208:211]
v_mul_f32 v216, s80, v216
v_mul_f32 v217, s80, v217
v_mfma_f32_16x16x32_bf16 a[212:215], a[172:175], a[104:107], a[212:215]
ds_read_b64_tr_b16 a[188:189], v14 offset:32768
ds_read_b64_tr_b16 a[190:191], v14 offset:33280
v_mfma_f32_16x16x32_bf16 a[216:219], a[172:175], a[100:103], a[216:219]
s_add_u32 m0, s67, 16384
s_add_u32 s52, s66, 4096
v_mul_f32 v218, s80, v218
v_mfma_f32_16x16x32_bf16 a[220:223], a[172:175], a[96:99], a[220:223]
ds_read_b64_tr_b16 a[64:65], v11 offset:36864
ds_read_b64_tr_b16 a[66:67], v11 offset:37376
v_mfma_f32_16x16x32_bf16 a[224:227], a[80:83], a[96:99], a[224:227]
buffer_load_dwordx4 v4, s[24:27], s52 offen sc1 lds
v_mfma_f32_16x16x32_bf16 a[228:231], a[80:83], a[100:103], a[228:231]
s_cmp_eq_u32 s57, 1024
s_cselect_b32 s53, -1024, 64
s_cselect_b32 s56, 0, 64
v_mfma_f32_16x16x32_bf16 a[232:235], a[80:83], a[104:107], a[232:235]
s_add_u32 s53, s53, s56
s_add_u32 s57, s57, s53
s_add_u32 s58, s58, s53
v_mfma_f32_16x16x32_bf16 a[236:239], a[80:83], a[108:111], a[236:239]
s_add_u32 s59, s59, s53
ds_read_b64_tr_b16 a[128:129], v12 offset:36864
ds_read_b64_tr_b16 a[130:131], v12 offset:37376
v_mfma_f32_16x16x32_bf16 a[240:243], a[144:147], a[108:111], a[240:243]
s_add_u32 m0, s60, 65536
s_add_u32 s52, s58, 0
v_mul_f32 v219, s80, v219
v_mfma_f32_16x16x32_bf16 a[244:247], a[144:147], a[104:107], a[244:247]
s_add_u32 s49, s77, 49152
ds_read_b64_tr_b16 a[68:69], v13 offset:36864
ds_read_b64_tr_b16 a[70:71], v13 offset:37376
v_mfma_f32_16x16x32_bf16 v[36:39], a[144:147], a[100:103], v[36:39]
buffer_load_dwordx4 v5, s[12:15], s52 offen lds
v_mfma_f32_16x16x32_bf16 v[44:47], a[144:147], a[96:99], v[44:47]
ds_read_b64_tr_b16 a[132:133], v14 offset:36864
ds_read_b64_tr_b16 a[134:135], v14 offset:37376
v_mfma_f32_16x16x32_bf16 v[52:55], a[84:87], a[96:99], v[52:55]
buffer_store_dwordx4 v[136:139], v4, s[24:27], s49 offen offset:1024 sc1
v_mfma_f32_16x16x32_bf16 v[60:63], a[84:87], a[100:103], v[60:63]
ds_read_b128 a[72:75], v4 offset:40960
ds_read_b128 a[136:139], v4 offset:41984
v_mfma_f32_16x16x32_bf16 v[68:71], a[84:87], a[104:107], v[68:71]
v_mul_f32 v220, s80, v220
v_mul_f32 v221, s80, v221
v_mfma_f32_16x16x32_bf16 v[76:79], a[84:87], a[108:111], v[76:79]
ds_read_b128 a[76:79], v4 offset:43008
ds_read_b128 a[140:143], v4 offset:44032
v_mfma_f32_16x16x32_bf16 v[84:87], a[148:151], a[108:111], v[84:87]
buffer_load_dwordx4 v6, s[12:15], s52 offen offset:1024 lds
v_mfma_f32_16x16x32_bf16 v[92:95], a[148:151], a[104:107], v[92:95]
v_mul_f32 v222, s80, v222
v_mul_f32 v223, s80, v223
v_mfma_f32_16x16x32_bf16 v[100:103], a[148:151], a[100:103], v[100:103]
v_cvt_pk_bf16_f32 v216, v216, v217
v_cvt_pk_bf16_f32 v217, v218, v219
v_mfma_f32_16x16x32_bf16 v[108:111], a[148:151], a[96:99], v[108:111]
v_cvt_pk_bf16_f32 v218, v220, v221
v_cvt_pk_bf16_f32 v219, v222, v223
v_mfma_f32_16x16x32_bf16 v[116:119], a[88:91], a[96:99], v[116:119]
s_add_u32 m0, s60, 67584
s_add_u32 s52, s58, 18432
v_mul_f32 v224, s80, v224
v_mfma_f32_16x16x32_bf16 v[124:127], a[88:91], a[100:103], v[124:127]
v_mul_f32 v225, s80, v225
v_mul_f32 v226, s80, v226
v_mfma_f32_16x16x32_bf16 v[132:135], a[88:91], a[104:107], v[132:135]
buffer_load_dwordx4 v5, s[12:15], s52 offen lds
v_mfma_f32_16x16x32_bf16 v[140:143], a[88:91], a[108:111], v[140:143]
v_mul_f32 v227, s80, v227
v_mul_f32 v228, s80, v228
v_mfma_f32_16x16x32_bf16 v[148:151], a[152:155], a[108:111], v[148:151]
v_mul_f32 v229, s80, v229
v_mul_f32 v230, s80, v230
v_mfma_f32_16x16x32_bf16 v[156:159], a[152:155], a[104:107], v[156:159]
v_mul_f32 v231, s80, v231
v_cvt_pk_bf16_f32 v224, v224, v225
v_mfma_f32_16x16x32_bf16 v[32:35], a[152:155], a[100:103], v[32:35]
v_cvt_pk_bf16_f32 v225, v226, v227
v_cvt_pk_bf16_f32 v226, v228, v229
v_mfma_f32_16x16x32_bf16 v[40:43], a[152:155], a[96:99], v[40:43]
s_add_u32 s49, s77, 49152
v_cvt_pk_bf16_f32 v227, v230, v231
v_mul_f32 v232, s80, v232
v_mfma_f32_16x16x32_bf16 v[48:51], a[92:95], a[96:99], v[48:51]
buffer_load_dwordx4 v6, s[12:15], s52 offen offset:1024 lds
v_mfma_f32_16x16x32_bf16 v[56:59], a[92:95], a[100:103], v[56:59]
buffer_store_dwordx4 v[144:147], v4, s[24:27], s49 offen offset:2048 sc1
v_mfma_f32_16x16x32_bf16 v[64:67], a[92:95], a[104:107], v[64:67]
v_mul_f32 v233, s80, v233
v_mul_f32 v234, s80, v234
v_mfma_f32_16x16x32_bf16 v[72:75], a[92:95], a[108:111], v[72:75]
v_mul_f32 v235, s80, v235
v_mul_f32 v236, s80, v236
v_mfma_f32_16x16x32_bf16 v[80:83], a[156:159], a[108:111], v[80:83]
v_mul_f32 v237, s80, v237
v_mul_f32 v238, s80, v238
v_mfma_f32_16x16x32_bf16 v[88:91], a[156:159], a[104:107], v[88:91]
v_mul_f32 v239, s80, v239
v_cvt_pk_bf16_f32 v232, v232, v233
v_mfma_f32_16x16x32_bf16 v[96:99], a[156:159], a[100:103], v[96:99]
v_cvt_pk_bf16_f32 v233, v234, v235
v_cvt_pk_bf16_f32 v234, v236, v237
v_mfma_f32_16x16x32_bf16 v[104:107], a[156:159], a[96:99], v[104:107]
s_waitcnt lgkmcnt(0)
v_cvt_pk_bf16_f32 v235, v238, v239
v_mul_f32 v240, s80, v240
v_mfma_f32_16x16x32_bf16 a[32:35], a[176:179], a[112:115], a[32:35]
s_waitcnt vmcnt(28)
v_mul_f32 v241, s80, v241
v_mul_f32 v242, s80, v242
v_mfma_f32_16x16x32_bf16 a[36:39], a[176:179], a[116:119], a[36:39]
s_barrier
v_mfma_f32_16x16x32_bf16 a[40:43], a[176:179], a[120:123], a[40:43]
ds_read_b128 a[96:99], v10 offset:0
ds_read_b128 a[100:103], v10 offset:2048
v_mfma_f32_16x16x32_bf16 a[44:47], a[176:179], a[124:127], a[44:47]
s_add_u32 s62, s62, 1
s_cmp_eq_u32 s62, 9
s_cselect_b32 s62, 0, s62
v_mfma_f32_16x16x32_bf16 a[48:51], a[180:183], a[124:127], a[48:51]
s_lshl_b32 s63, s62, 19
s_add_u32 s63, s63, s61
v_mul_f32 v243, s80, v243
v_mfma_f32_16x16x32_bf16 a[52:55], a[180:183], a[120:123], a[52:55]
s_lshl_b32 s66, s62, 13
s_add_u32 s66, s66, s65
v_mul_f32 v244, s80, v244
v_mfma_f32_16x16x32_bf16 a[56:59], a[180:183], a[116:119], a[56:59]
s_add_u32 m0, s64, 32768
s_add_u32 s52, s63, 0
v_mul_f32 v245, s80, v245
v_mfma_f32_16x16x32_bf16 a[60:63], a[180:183], a[112:115], a[60:63]
buffer_load_dwordx4 v7, s[20:23], s52 offen lds
v_mfma_f32_16x16x32_bf16 a[192:195], a[184:187], a[112:115], a[192:195]
s_add_u32 s49, s77, 49152
ds_read_b128 a[104:107], v10 offset:4096
ds_read_b128 a[108:111], v10 offset:6144
v_mfma_f32_16x16x32_bf16 a[196:199], a[184:187], a[116:119], a[196:199]
buffer_store_dwordx4 v[152:155], v4, s[24:27], s49 offen offset:3072 sc1
v_mfma_f32_16x16x32_bf16 a[200:203], a[184:187], a[120:123], a[200:203]
buffer_load_dwordx4 v8, s[20:23], s52 offen offset:1024 lds
v_mfma_f32_16x16x32_bf16 a[204:207], a[184:187], a[124:127], a[204:207]
ds_read_b64_tr_b16 a[160:161], v11 offset:49152
ds_read_b64_tr_b16 a[162:163], v11 offset:49664
v_mfma_f32_16x16x32_bf16 a[208:211], a[188:191], a[124:127], a[208:211]
v_mul_f32 v246, s80, v246
v_mul_f32 v247, s80, v247
v_mfma_f32_16x16x32_bf16 a[212:215], a[188:191], a[120:123], a[212:215]
ds_read_b64_tr_b16 a[164:165], v12 offset:49152
ds_read_b64_tr_b16 a[166:167], v12 offset:49664
v_mfma_f32_16x16x32_bf16 a[216:219], a[188:191], a[116:119], a[216:219]
s_add_u32 m0, s67, 32768
s_add_u32 s52, s66, 0
v_cvt_pk_bf16_f32 v240, v240, v241
v_mfma_f32_16x16x32_bf16 a[220:223], a[188:191], a[112:115], a[220:223]
ds_read_b64_tr_b16 a[168:169], v13 offset:49152
ds_read_b64_tr_b16 a[170:171], v13 offset:49664
v_mfma_f32_16x16x32_bf16 a[224:227], a[64:67], a[112:115], a[224:227]
buffer_load_dwordx4 v4, s[24:27], s52 offen sc1 lds
v_mfma_f32_16x16x32_bf16 a[228:231], a[64:67], a[116:119], a[228:231]
ds_read_b64_tr_b16 a[172:173], v14 offset:49152
ds_read_b64_tr_b16 a[174:175], v14 offset:49664
v_mfma_f32_16x16x32_bf16 a[232:235], a[64:67], a[120:123], a[232:235]
v_cvt_pk_bf16_f32 v241, v242, v243
v_cvt_pk_bf16_f32 v242, v244, v245
v_mfma_f32_16x16x32_bf16 a[236:239], a[64:67], a[124:127], a[236:239]
ds_read_b64_tr_b16 a[80:81], v11 offset:53248
ds_read_b64_tr_b16 a[82:83], v11 offset:53760
v_mfma_f32_16x16x32_bf16 a[240:243], a[128:131], a[124:127], a[240:243]
s_add_u32 m0, s60, 69632
s_add_u32 s52, s59, 0
v_cvt_pk_bf16_f32 v243, v246, v247
v_mfma_f32_16x16x32_bf16 a[244:247], a[128:131], a[120:123], a[244:247]
ds_read_b64_tr_b16 a[144:145], v12 offset:53248
ds_read_b64_tr_b16 a[146:147], v12 offset:53760
v_mfma_f32_16x16x32_bf16 v[36:39], a[128:131], a[116:119], v[36:39]
buffer_load_dwordx4 v5, s[12:15], s52 offen lds
v_mfma_f32_16x16x32_bf16 v[44:47], a[128:131], a[112:115], v[44:47]
ds_read_b64_tr_b16 a[84:85], v13 offset:53248
ds_read_b64_tr_b16 a[86:87], v13 offset:53760
v_mfma_f32_16x16x32_bf16 v[52:55], a[68:71], a[112:115], v[52:55]
s_add_u32 s49, s76, 0
v_mul_f32 v248, s80, v248
v_mul_f32 v249, s80, v249
v_mfma_f32_16x16x32_bf16 v[60:63], a[68:71], a[116:119], v[60:63]
ds_read_b64_tr_b16 a[148:149], v14 offset:53248
ds_read_b64_tr_b16 a[150:151], v14 offset:53760
v_mfma_f32_16x16x32_bf16 v[68:71], a[68:71], a[120:123], v[68:71]
buffer_store_dwordx4 v[160:163], v4, s[24:27], s49 offen offset:0 sc1
v_mfma_f32_16x16x32_bf16 v[76:79], a[68:71], a[124:127], v[76:79]
ds_read_b128 a[88:91], v4 offset:57344
ds_read_b128 a[152:155], v4 offset:58368
v_mfma_f32_16x16x32_bf16 v[84:87], a[132:135], a[124:127], v[84:87]
buffer_load_dwordx4 v6, s[12:15], s52 offen offset:1024 lds
v_mfma_f32_16x16x32_bf16 v[92:95], a[132:135], a[120:123], v[92:95]
ds_read_b128 a[92:95], v4 offset:59392
ds_read_b128 a[156:159], v4 offset:60416
v_mfma_f32_16x16x32_bf16 v[100:103], a[132:135], a[116:119], v[100:103]
v_mul_f32 v250, s80, v250
v_mul_f32 v251, s80, v251
v_mfma_f32_16x16x32_bf16 v[108:111], a[132:135], a[112:115], v[108:111]
v_mul_f32 v252, s80, v252
v_mul_f32 v253, s80, v253
v_mfma_f32_16x16x32_bf16 v[116:119], a[72:75], a[112:115], v[116:119]
s_add_u32 m0, s60, 71680
s_add_u32 s52, s59, 18432
v_mul_f32 v254, s80, v254
v_mfma_f32_16x16x32_bf16 v[124:127], a[72:75], a[116:119], v[124:127]
v_mul_f32 v255, s80, v255
v_cvt_pk_bf16_f32 v248, v248, v249
v_mfma_f32_16x16x32_bf16 v[132:135], a[72:75], a[120:123], v[132:135]
buffer_load_dwordx4 v5, s[12:15], s52 offen lds
v_mfma_f32_16x16x32_bf16 v[140:143], a[72:75], a[124:127], v[140:143]
v_cvt_pk_bf16_f32 v249, v250, v251
v_cvt_pk_bf16_f32 v250, v252, v253
v_mfma_f32_16x16x32_bf16 v[148:151], a[136:139], a[124:127], v[148:151]
v_cvt_pk_bf16_f32 v251, v254, v255
v_mfma_f32_16x16x32_bf16 v[156:159], a[136:139], a[120:123], v[156:159]
v_mfma_f32_16x16x32_bf16 v[32:35], a[136:139], a[116:119], v[32:35]
v_mfma_f32_16x16x32_bf16 v[40:43], a[136:139], a[112:115], v[40:43]
v_mfma_f32_16x16x32_bf16 v[48:51], a[76:79], a[112:115], v[48:51]
buffer_load_dwordx4 v6, s[12:15], s52 offen offset:1024 lds
v_mfma_f32_16x16x32_bf16 v[56:59], a[76:79], a[116:119], v[56:59]
s_add_u32 s49, s76, 0
v_add_u32 v9, 32768, v9
v_add_u32 v10, 32768, v10
v_mfma_f32_16x16x32_bf16 v[64:67], a[76:79], a[120:123], v[64:67]
buffer_store_dwordx4 v[168:171], v4, s[24:27], s49 offen offset:1024 sc1
v_mfma_f32_16x16x32_bf16 v[72:75], a[76:79], a[124:127], v[72:75]
v_mfma_f32_16x16x32_bf16 v[80:83], a[140:143], a[124:127], v[80:83]
v_mfma_f32_16x16x32_bf16 v[88:91], a[140:143], a[120:123], v[88:91]
v_mfma_f32_16x16x32_bf16 v[96:99], a[140:143], a[116:119], v[96:99]
v_mfma_f32_16x16x32_bf16 v[104:107], a[140:143], a[112:115], v[104:107]
s_waitcnt lgkmcnt(0)
v_mfma_f32_16x16x32_bf16 a[32:35], a[160:163], a[96:99], a[32:35]
s_waitcnt vmcnt(20)
v_mfma_f32_16x16x32_bf16 a[36:39], a[160:163], a[100:103], a[36:39]
s_barrier
v_mfma_f32_16x16x32_bf16 a[40:43], a[160:163], a[104:107], a[40:43]
ds_read_b128 a[112:115], v9 offset:0
ds_read_b128 a[116:119], v9 offset:2048
v_mfma_f32_16x16x32_bf16 a[44:47], a[160:163], a[108:111], a[44:47]
s_add_u32 m0, s64, 49152
s_add_u32 s52, s63, 262144
v_mfma_f32_16x16x32_bf16 a[48:51], a[164:167], a[108:111], a[48:51]
buffer_load_dwordx4 v7, s[20:23], s52 offen lds
v_mfma_f32_16x16x32_bf16 a[52:55], a[164:167], a[104:107], a[52:55]
ds_read_b128 a[120:123], v9 offset:4096
ds_read_b128 a[124:127], v9 offset:6144
v_mfma_f32_16x16x32_bf16 a[56:59], a[164:167], a[100:103], a[56:59]
v_mfma_f32_16x16x32_bf16 a[60:63], a[164:167], a[96:99], a[60:63]
ds_read_b64_tr_b16 a[176:177], v11 offset:0
ds_read_b64_tr_b16 a[178:179], v11 offset:512
v_mfma_f32_16x16x32_bf16 a[192:195], a[168:171], a[96:99], a[192:195]
v_mfma_f32_16x16x32_bf16 a[196:199], a[168:171], a[100:103], a[196:199]
s_add_u32 s49, s76, 4096
ds_read_b64_tr_b16 a[180:181], v12 offset:0
ds_read_b64_tr_b16 a[182:183], v12 offset:512
v_mfma_f32_16x16x32_bf16 a[200:203], a[168:171], a[104:107], a[200:203]
buffer_load_dwordx4 v8, s[20:23], s52 offen offset:1024 lds
v_mfma_f32_16x16x32_bf16 a[204:207], a[168:171], a[108:111], a[204:207]
ds_read_b64_tr_b16 a[184:185], v13 offset:0
ds_read_b64_tr_b16 a[186:187], v13 offset:512
v_mfma_f32_16x16x32_bf16 a[208:211], a[172:175], a[108:111], a[208:211]
buffer_store_dwordx4 v[176:179], v4, s[24:27], s49 offen offset:0 sc1
v_mfma_f32_16x16x32_bf16 a[212:215], a[172:175], a[104:107], a[212:215]
ds_read_b64_tr_b16 a[188:189], v14 offset:0
ds_read_b64_tr_b16 a[190:191], v14 offset:512
v_mfma_f32_16x16x32_bf16 a[216:219], a[172:175], a[100:103], a[216:219]
s_add_u32 m0, s67, 49152
s_add_u32 s52, s66, 4096
v_mfma_f32_16x16x32_bf16 a[220:223], a[172:175], a[96:99], a[220:223]
ds_read_b64_tr_b16 a[64:65], v11 offset:4096
ds_read_b64_tr_b16 a[66:67], v11 offset:4608
v_mfma_f32_16x16x32_bf16 a[224:227], a[80:83], a[96:99], a[224:227]
buffer_load_dwordx4 v4, s[24:27], s52 offen sc1 lds
v_mfma_f32_16x16x32_bf16 a[228:231], a[80:83], a[100:103], a[228:231]
s_cmp_eq_u32 s57, 1024
s_cselect_b32 s53, -1024, 64
s_cselect_b32 s56, 0, 64
v_mfma_f32_16x16x32_bf16 a[232:235], a[80:83], a[104:107], a[232:235]
s_add_u32 s53, s53, s56
s_add_u32 s57, s57, s53
s_add_u32 s58, s58, s53
v_mfma_f32_16x16x32_bf16 a[236:239], a[80:83], a[108:111], a[236:239]
s_add_u32 s59, s59, s53
ds_read_b64_tr_b16 a[128:129], v12 offset:4096
ds_read_b64_tr_b16 a[130:131], v12 offset:4608
v_mfma_f32_16x16x32_bf16 a[240:243], a[144:147], a[108:111], a[240:243]
s_add_u32 m0, s60, 0
s_add_u32 s52, s58, 0
v_mfma_f32_16x16x32_bf16 a[244:247], a[144:147], a[104:107], a[244:247]
ds_read_b64_tr_b16 a[68:69], v13 offset:4096
ds_read_b64_tr_b16 a[70:71], v13 offset:4608
v_mfma_f32_16x16x32_bf16 v[36:39], a[144:147], a[100:103], v[36:39]
buffer_load_dwordx4 v5, s[12:15], s52 offen lds
v_mfma_f32_16x16x32_bf16 v[44:47], a[144:147], a[96:99], v[44:47]
ds_read_b64_tr_b16 a[132:133], v14 offset:4096
ds_read_b64_tr_b16 a[134:135], v14 offset:4608
v_mfma_f32_16x16x32_bf16 v[52:55], a[84:87], a[96:99], v[52:55]
v_mfma_f32_16x16x32_bf16 v[60:63], a[84:87], a[100:103], v[60:63]
ds_read_b128 a[72:75], v4 offset:8192
ds_read_b128 a[136:139], v4 offset:9216
v_mfma_f32_16x16x32_bf16 v[68:71], a[84:87], a[104:107], v[68:71]
v_mfma_f32_16x16x32_bf16 v[76:79], a[84:87], a[108:111], v[76:79]
s_add_u32 s49, s76, 4096
ds_read_b128 a[76:79], v4 offset:10240
ds_read_b128 a[140:143], v4 offset:11264
v_mfma_f32_16x16x32_bf16 v[84:87], a[148:151], a[108:111], v[84:87]
buffer_load_dwordx4 v6, s[12:15], s52 offen offset:1024 lds
v_mfma_f32_16x16x32_bf16 v[92:95], a[148:151], a[104:107], v[92:95]
buffer_store_dwordx4 v[184:187], v4, s[24:27], s49 offen offset:1024 sc1
v_mfma_f32_16x16x32_bf16 v[100:103], a[148:151], a[100:103], v[100:103]
v_mfma_f32_16x16x32_bf16 v[108:111], a[148:151], a[96:99], v[108:111]
v_mfma_f32_16x16x32_bf16 v[116:119], a[88:91], a[96:99], v[116:119]
s_add_u32 m0, s60, 2048
s_add_u32 s52, s58, 18432
v_mfma_f32_16x16x32_bf16 v[124:127], a[88:91], a[100:103], v[124:127]
v_mfma_f32_16x16x32_bf16 v[132:135], a[88:91], a[104:107], v[132:135]
buffer_load_dwordx4 v5, s[12:15], s52 offen lds
v_mfma_f32_16x16x32_bf16 v[140:143], a[88:91], a[108:111], v[140:143]
v_mfma_f32_16x16x32_bf16 v[148:151], a[152:155], a[108:111], v[148:151]
v_mfma_f32_16x16x32_bf16 v[156:159], a[152:155], a[104:107], v[156:159]
v_mfma_f32_16x16x32_bf16 v[32:35], a[152:155], a[100:103], v[32:35]
v_mfma_f32_16x16x32_bf16 v[40:43], a[152:155], a[96:99], v[40:43]
v_mfma_f32_16x16x32_bf16 v[48:51], a[92:95], a[96:99], v[48:51]
buffer_load_dwordx4 v6, s[12:15], s52 offen offset:1024 lds
v_mfma_f32_16x16x32_bf16 v[56:59], a[92:95], a[100:103], v[56:59]
v_mfma_f32_16x16x32_bf16 v[64:67], a[92:95], a[104:107], v[64:67]
v_mfma_f32_16x16x32_bf16 v[72:75], a[92:95], a[108:111], v[72:75]
v_mfma_f32_16x16x32_bf16 v[80:83], a[156:159], a[108:111], v[80:83]
s_add_u32 s49, s76, 16384
v_mfma_f32_16x16x32_bf16 v[88:91], a[156:159], a[104:107], v[88:91]
buffer_store_dwordx4 v[192:195], v4, s[24:27], s49 offen offset:0 sc1
v_mfma_f32_16x16x32_bf16 v[96:99], a[156:159], a[100:103], v[96:99]
v_mfma_f32_16x16x32_bf16 v[104:107], a[156:159], a[96:99], v[104:107]
s_waitcnt lgkmcnt(0)
v_mfma_f32_16x16x32_bf16 a[32:35], a[176:179], a[112:115], a[32:35]
s_waitcnt vmcnt(26)
v_mfma_f32_16x16x32_bf16 a[36:39], a[176:179], a[116:119], a[36:39]
s_barrier
v_mfma_f32_16x16x32_bf16 a[40:43], a[176:179], a[120:123], a[40:43]
ds_read_b128 a[96:99], v10 offset:0
ds_read_b128 a[100:103], v10 offset:2048
v_mfma_f32_16x16x32_bf16 a[44:47], a[176:179], a[124:127], a[44:47]
s_add_u32 s62, s62, 1
s_cmp_eq_u32 s62, 9
s_cselect_b32 s62, 0, s62
v_mfma_f32_16x16x32_bf16 a[48:51], a[180:183], a[124:127], a[48:51]
s_lshl_b32 s63, s62, 19
s_add_u32 s63, s63, s61
v_mfma_f32_16x16x32_bf16 a[52:55], a[180:183], a[120:123], a[52:55]
s_lshl_b32 s66, s62, 13
s_add_u32 s66, s66, s65
v_mfma_f32_16x16x32_bf16 a[56:59], a[180:183], a[116:119], a[56:59]
s_add_u32 m0, s64, 0
s_add_u32 s52, s63, 0
v_mfma_f32_16x16x32_bf16 a[60:63], a[180:183], a[112:115], a[60:63]
buffer_load_dwordx4 v7, s[20:23], s52 offen lds
v_mfma_f32_16x16x32_bf16 a[192:195], a[184:187], a[112:115], a[192:195]
ds_read_b128 a[104:107], v10 offset:4096
ds_read_b128 a[108:111], v10 offset:6144
v_mfma_f32_16x16x32_bf16 a[196:199], a[184:187], a[116:119], a[196:199]
v_mfma_f32_16x16x32_bf16 a[200:203], a[184:187], a[120:123], a[200:203]
buffer_load_dwordx4 v8, s[20:23], s52 offen offset:1024 lds
v_mfma_f32_16x16x32_bf16 a[204:207], a[184:187], a[124:127], a[204:207]
ds_read_b64_tr_b16 a[160:161], v11 offset:16384
ds_read_b64_tr_b16 a[162:163], v11 offset:16896
v_mfma_f32_16x16x32_bf16 a[208:211], a[188:191], a[124:127], a[208:211]
s_add_u32 s49, s76, 16384
v_mfma_f32_16x16x32_bf16 a[212:215], a[188:191], a[120:123], a[212:215]
ds_read_b64_tr_b16 a[164:165], v12 offset:16384
ds_read_b64_tr_b16 a[166:167], v12 offset:16896
v_mfma_f32_16x16x32_bf16 a[216:219], a[188:191], a[116:119], a[216:219]
s_add_u32 m0, s67, 0
s_add_u32 s52, s66, 0
v_mfma_f32_16x16x32_bf16 a[220:223], a[188:191], a[112:115], a[220:223]
ds_read_b64_tr_b16 a[168:169], v13 offset:16384
ds_read_b64_tr_b16 a[170:171], v13 offset:16896
v_mfma_f32_16x16x32_bf16 a[224:227], a[64:67], a[112:115], a[224:227]
buffer_load_dwordx4 v4, s[24:27], s52 offen sc1 lds
v_mfma_f32_16x16x32_bf16 a[228:231], a[64:67], a[116:119], a[228:231]
ds_read_b64_tr_b16 a[172:173], v14 offset:16384
ds_read_b64_tr_b16 a[174:175], v14 offset:16896
v_mfma_f32_16x16x32_bf16 a[232:235], a[64:67], a[120:123], a[232:235]
buffer_store_dwordx4 v[200:203], v4, s[24:27], s49 offen offset:1024 sc1
v_mfma_f32_16x16x32_bf16 a[236:239], a[64:67], a[124:127], a[236:239]
ds_read_b64_tr_b16 a[80:81], v11 offset:20480
ds_read_b64_tr_b16 a[82:83], v11 offset:20992
v_mfma_f32_16x16x32_bf16 a[240:243], a[128:131], a[124:127], a[240:243]
s_add_u32 m0, s60, 4096
s_add_u32 s52, s59, 0
v_mfma_f32_16x16x32_bf16 a[244:247], a[128:131], a[120:123], a[244:247]
ds_read_b64_tr_b16 a[144:145], v12 offset:20480
ds_read_b64_tr_b16 a[146:147], v12 offset:20992
v_mfma_f32_16x16x32_bf16 v[36:39], a[128:131], a[116:119], v[36:39]
buffer_load_dwordx4 v5, s[12:15], s52 offen lds
v_mfma_f32_16x16x32_bf16 v[44:47], a[128:131], a[112:115], v[44:47]
ds_read_b64_tr_b16 a[84:85], v13 offset:20480
ds_read_b64_tr_b16 a[86:87], v13 offset:20992
v_mfma_f32_16x16x32_bf16 v[52:55], a[68:71], a[112:115], v[52:55]
v_mfma_f32_16x16x32_bf16 v[60:63], a[68:71], a[116:119], v[60:63]
ds_read_b64_tr_b16 a[148:149], v14 offset:20480
ds_read_b64_tr_b16 a[150:151], v14 offset:20992
v_mfma_f32_16x16x32_bf16 v[68:71], a[68:71], a[120:123], v[68:71]
v_mfma_f32_16x16x32_bf16 v[76:79], a[68:71], a[124:127], v[76:79]
ds_read_b128 a[88:91], v4 offset:24576
ds_read_b128 a[152:155], v4 offset:25600
v_mfma_f32_16x16x32_bf16 v[84:87], a[132:135], a[124:127], v[84:87]
buffer_load_dwordx4 v6, s[12:15], s52 offen offset:1024 lds
v_mfma_f32_16x16x32_bf16 v[92:95], a[132:135], a[120:123], v[92:95]
ds_read_b128 a[92:95], v4 offset:26624
ds_read_b128 a[156:159], v4 offset:27648
v_mfma_f32_16x16x32_bf16 v[100:103], a[132:135], a[116:119], v[100:103]
v_mfma_f32_16x16x32_bf16 v[108:111], a[132:135], a[112:115], v[108:111]
v_mfma_f32_16x16x32_bf16 v[116:119], a[72:75], a[112:115], v[116:119]
s_add_u32 m0, s60, 6144
s_add_u32 s52, s59, 18432
v_mfma_f32_16x16x32_bf16 v[124:127], a[72:75], a[116:119], v[124:127]
s_add_u32 s49, s76, 20480
v_mfma_f32_16x16x32_bf16 v[132:135], a[72:75], a[120:123], v[132:135]
buffer_load_dwordx4 v5, s[12:15], s52 offen lds
v_mfma_f32_16x16x32_bf16 v[140:143], a[72:75], a[124:127], v[140:143]
buffer_store_dwordx4 v[208:211], v4, s[24:27], s49 offen offset:0 sc1
v_mfma_f32_16x16x32_bf16 v[148:151], a[136:139], a[124:127], v[148:151]
v_mfma_f32_16x16x32_bf16 v[156:159], a[136:139], a[120:123], v[156:159]
v_mfma_f32_16x16x32_bf16 v[32:35], a[136:139], a[116:119], v[32:35]
v_mfma_f32_16x16x32_bf16 v[40:43], a[136:139], a[112:115], v[40:43]
v_mfma_f32_16x16x32_bf16 v[48:51], a[76:79], a[112:115], v[48:51]
buffer_load_dwordx4 v6, s[12:15], s52 offen offset:1024 lds
v_mfma_f32_16x16x32_bf16 v[56:59], a[76:79], a[116:119], v[56:59]
v_add_u32 v9, 32768, v9
v_add_u32 v10, 32768, v10
v_mfma_f32_16x16x32_bf16 v[64:67], a[76:79], a[120:123], v[64:67]
v_mfma_f32_16x16x32_bf16 v[72:75], a[76:79], a[124:127], v[72:75]
v_mfma_f32_16x16x32_bf16 v[80:83], a[140:143], a[124:127], v[80:83]
v_mfma_f32_16x16x32_bf16 v[88:91], a[140:143], a[120:123], v[88:91]
v_mfma_f32_16x16x32_bf16 v[96:99], a[140:143], a[116:119], v[96:99]
v_mfma_f32_16x16x32_bf16 v[104:107], a[140:143], a[112:115], v[104:107]
s_waitcnt lgkmcnt(0)
v_mfma_f32_16x16x32_bf16 a[32:35], a[160:163], a[96:99], a[32:35]
s_waitcnt vmcnt(20)
v_mfma_f32_16x16x32_bf16 a[36:39], a[160:163], a[100:103], a[36:39]
s_barrier
v_mfma_f32_16x16x32_bf16 a[40:43], a[160:163], a[104:107], a[40:43]
s_add_u32 s49, s76, 20480
ds_read_b128 a[112:115], v9 offset:0
ds_read_b128 a[116:119], v9 offset:2048
v_mfma_f32_16x16x32_bf16 a[44:47], a[160:163], a[108:111], a[44:47]
s_add_u32 m0, s64, 16384
s_add_u32 s52, s63, 262144
v_mfma_f32_16x16x32_bf16 a[48:51], a[164:167], a[108:111], a[48:51]
buffer_load_dwordx4 v7, s[20:23], s52 offen lds
v_mfma_f32_16x16x32_bf16 a[52:55], a[164:167], a[104:107], a[52:55]
ds_read_b128 a[120:123], v9 offset:4096
ds_read_b128 a[124:127], v9 offset:6144
v_mfma_f32_16x16x32_bf16 a[56:59], a[164:167], a[100:103], a[56:59]
buffer_store_dwordx4 v[216:219], v4, s[24:27], s49 offen offset:1024 sc1
v_mfma_f32_16x16x32_bf16 a[60:63], a[164:167], a[96:99], a[60:63]
ds_read_b64_tr_b16 a[176:177], v11 offset:32768
ds_read_b64_tr_b16 a[178:179], v11 offset:33280
v_mfma_f32_16x16x32_bf16 a[192:195], a[168:171], a[96:99], a[192:195]
v_mfma_f32_16x16x32_bf16 a[196:199], a[168:171], a[100:103], a[196:199]
ds_read_b64_tr_b16 a[180:181], v12 offset:32768
ds_read_b64_tr_b16 a[182:183], v12 offset:33280
v_mfma_f32_16x16x32_bf16 a[200:203], a[168:171], a[104:107], a[200:203]
buffer_load_dwordx4 v8, s[20:23], s52 offen offset:1024 lds
v_mfma_f32_16x16x32_bf16 a[204:207], a[168:171], a[108:111], a[204:207]
ds_read_b64_tr_b16 a[184:185], v13 offset:32768
ds_read_b64_tr_b16 a[186:187], v13 offset:33280
v_mfma_f32_16x16x32_bf16 a[208:211], a[172:175], a[108:111], a[208:211]
v_mfma_f32_16x16x32_bf16 a[212:215], a[172:175], a[104:107], a[212:215]
ds_read_b64_tr_b16 a[188:189], v14 offset:32768
ds_read_b64_tr_b16 a[190:191], v14 offset:33280
v_mfma_f32_16x16x32_bf16 a[216:219], a[172:175], a[100:103], a[216:219]
s_add_u32 m0, s67, 16384
s_add_u32 s52, s66, 4096
v_mfma_f32_16x16x32_bf16 a[220:223], a[172:175], a[96:99], a[220:223]
ds_read_b64_tr_b16 a[64:65], v11 offset:36864
ds_read_b64_tr_b16 a[66:67], v11 offset:37376
v_mfma_f32_16x16x32_bf16 a[224:227], a[80:83], a[96:99], a[224:227]
buffer_load_dwordx4 v4, s[24:27], s52 offen sc1 lds
v_mfma_f32_16x16x32_bf16 a[228:231], a[80:83], a[100:103], a[228:231]
s_cmp_eq_u32 s57, 1024
s_cselect_b32 s53, -1024, 64
s_cselect_b32 s56, 0, 64
v_mfma_f32_16x16x32_bf16 a[232:235], a[80:83], a[104:107], a[232:235]
s_add_u32 s53, s53, s56
s_add_u32 s57, s57, s53
s_add_u32 s58, s58, s53
v_mfma_f32_16x16x32_bf16 a[236:239], a[80:83], a[108:111], a[236:239]
s_add_u32 s59, s59, s53
ds_read_b64_tr_b16 a[128:129], v12 offset:36864
ds_read_b64_tr_b16 a[130:131], v12 offset:37376
v_mfma_f32_16x16x32_bf16 a[240:243], a[144:147], a[108:111], a[240:243]
s_add_u32 m0, s60, 32768
s_add_u32 s52, s58, 0
v_mfma_f32_16x16x32_bf16 a[244:247], a[144:147], a[104:107], a[244:247]
s_add_u32 s49, s76, 32768
ds_read_b64_tr_b16 a[68:69], v13 offset:36864
ds_read_b64_tr_b16 a[70:71], v13 offset:37376
v_mfma_f32_16x16x32_bf16 v[36:39], a[144:147], a[100:103], v[36:39]
buffer_load_dwordx4 v5, s[12:15], s52 offen lds
v_mfma_f32_16x16x32_bf16 v[44:47], a[144:147], a[96:99], v[44:47]
ds_read_b64_tr_b16 a[132:133], v14 offset:36864
ds_read_b64_tr_b16 a[134:135], v14 offset:37376
v_mfma_f32_16x16x32_bf16 v[52:55], a[84:87], a[96:99], v[52:55]
buffer_store_dwordx4 v[224:227], v4, s[24:27], s49 offen offset:0 sc1
v_mfma_f32_16x16x32_bf16 v[60:63], a[84:87], a[100:103], v[60:63]
ds_read_b128 a[72:75], v4 offset:40960
ds_read_b128 a[136:139], v4 offset:41984
v_mfma_f32_16x16x32_bf16 v[68:71], a[84:87], a[104:107], v[68:71]
v_mfma_f32_16x16x32_bf16 v[76:79], a[84:87], a[108:111], v[76:79]
ds_read_b128 a[76:79], v4 offset:43008
ds_read_b128 a[140:143], v4 offset:44032
v_mfma_f32_16x16x32_bf16 v[84:87], a[148:151], a[108:111], v[84:87]
buffer_load_dwordx4 v6, s[12:15], s52 offen offset:1024 lds
v_mfma_f32_16x16x32_bf16 v[92:95], a[148:151], a[104:107], v[92:95]
v_mfma_f32_16x16x32_bf16 v[100:103], a[148:151], a[100:103], v[100:103]
v_mfma_f32_16x16x32_bf16 v[108:111], a[148:151], a[96:99], v[108:111]
v_mfma_f32_16x16x32_bf16 v[116:119], a[88:91], a[96:99], v[116:119]
s_add_u32 m0, s60, 34816
s_add_u32 s52, s58, 18432
v_mfma_f32_16x16x32_bf16 v[124:127], a[88:91], a[100:103], v[124:127]
v_mfma_f32_16x16x32_bf16 v[132:135], a[88:91], a[104:107], v[132:135]
buffer_load_dwordx4 v5, s[12:15], s52 offen lds
v_mfma_f32_16x16x32_bf16 v[140:143], a[88:91], a[108:111], v[140:143]
v_mfma_f32_16x16x32_bf16 v[148:151], a[152:155], a[108:111], v[148:151]
v_mfma_f32_16x16x32_bf16 v[156:159], a[152:155], a[104:107], v[156:159]
v_mfma_f32_16x16x32_bf16 v[32:35], a[152:155], a[100:103], v[32:35]
v_mfma_f32_16x16x32_bf16 v[40:43], a[152:155], a[96:99], v[40:43]
s_add_u32 s49, s76, 32768
v_mfma_f32_16x16x32_bf16 v[48:51], a[92:95], a[96:99], v[48:51]
buffer_load_dwordx4 v6, s[12:15], s52 offen offset:1024 lds
v_mfma_f32_16x16x32_bf16 v[56:59], a[92:95], a[100:103], v[56:59]
buffer_store_dwordx4 v[232:235], v4, s[24:27], s49 offen offset:1024 sc1
v_mfma_f32_16x16x32_bf16 v[64:67], a[92:95], a[104:107], v[64:67]
v_mfma_f32_16x16x32_bf16 v[72:75], a[92:95], a[108:111], v[72:75]
v_mfma_f32_16x16x32_bf16 v[80:83], a[156:159], a[108:111], v[80:83]
v_mfma_f32_16x16x32_bf16 v[88:91], a[156:159], a[104:107], v[88:91]
v_mfma_f32_16x16x32_bf16 v[96:99], a[156:159], a[100:103], v[96:99]
v_mfma_f32_16x16x32_bf16 v[104:107], a[156:159], a[96:99], v[104:107]
s_waitcnt lgkmcnt(0)
v_mfma_f32_16x16x32_bf16 a[32:35], a[176:179], a[112:115], a[32:35]
s_waitcnt vmcnt(25)
v_mfma_f32_16x16x32_bf16 a[36:39], a[176:179], a[116:119], a[36:39]
s_barrier
v_mfma_f32_16x16x32_bf16 a[40:43], a[176:179], a[120:123], a[40:43]
ds_read_b128 a[96:99], v10 offset:0
ds_read_b128 a[100:103], v10 offset:2048
v_mfma_f32_16x16x32_bf16 a[44:47], a[176:179], a[124:127], a[44:47]
s_add_u32 s62, s62, 1
s_cmp_eq_u32 s62, 9
s_cselect_b32 s62, 0, s62
v_mfma_f32_16x16x32_bf16 a[48:51], a[180:183], a[124:127], a[48:51]
s_lshl_b32 s63, s62, 19
s_add_u32 s63, s63, s61
v_mfma_f32_16x16x32_bf16 a[52:55], a[180:183], a[120:123], a[52:55]
s_lshl_b32 s66, s62, 13
s_add_u32 s66, s66, s65
v_mfma_f32_16x16x32_bf16 a[56:59], a[180:183], a[116:119], a[56:59]
s_add_u32 m0, s64, 32768
s_add_u32 s52, s63, 0
v_mfma_f32_16x16x32_bf16 a[60:63], a[180:183], a[112:115], a[60:63]
buffer_load_dwordx4 v7, s[20:23], s52 offen lds
v_mfma_f32_16x16x32_bf16 a[192:195], a[184:187], a[112:115], a[192:195]
s_add_u32 s49, s76, 36864
ds_read_b128 a[104:107], v10 offset:4096
ds_read_b128 a[108:111], v10 offset:6144
v_mfma_f32_16x16x32_bf16 a[196:199], a[184:187], a[116:119], a[196:199]
buffer_store_dwordx4 v[240:243], v4, s[24:27], s49 offen offset:0 sc1
v_mfma_f32_16x16x32_bf16 a[200:203], a[184:187], a[120:123], a[200:203]
buffer_load_dwordx4 v8, s[20:23], s52 offen offset:1024 lds
v_mfma_f32_16x16x32_bf16 a[204:207], a[184:187], a[124:127], a[204:207]
ds_read_b64_tr_b16 a[160:161], v11 offset:49152
ds_read_b64_tr_b16 a[162:163], v11 offset:49664
v_mfma_f32_16x16x32_bf16 a[208:211], a[188:191], a[124:127], a[208:211]
v_mfma_f32_16x16x32_bf16 a[212:215], a[188:191], a[120:123], a[212:215]
ds_read_b64_tr_b16 a[164:165], v12 offset:49152
ds_read_b64_tr_b16 a[166:167], v12 offset:49664
v_mfma_f32_16x16x32_bf16 a[216:219], a[188:191], a[116:119], a[216:219]
s_add_u32 m0, s67, 32768
s_add_u32 s52, s66, 0
v_mfma_f32_16x16x32_bf16 a[220:223], a[188:191], a[112:115], a[220:223]
ds_read_b64_tr_b16 a[168:169], v13 offset:49152
ds_read_b64_tr_b16 a[170:171], v13 offset:49664
v_mfma_f32_16x16x32_bf16 a[224:227], a[64:67], a[112:115], a[224:227]
buffer_load_dwordx4 v4, s[24:27], s52 offen sc1 lds
v_mfma_f32_16x16x32_bf16 a[228:231], a[64:67], a[116:119], a[228:231]
ds_read_b64_tr_b16 a[172:173], v14 offset:49152
ds_read_b64_tr_b16 a[174:175], v14 offset:49664
v_mfma_f32_16x16x32_bf16 a[232:235], a[64:67], a[120:123], a[232:235]
v_mfma_f32_16x16x32_bf16 a[236:239], a[64:67], a[124:127], a[236:239]
ds_read_b64_tr_b16 a[80:81], v11 offset:53248
ds_read_b64_tr_b16 a[82:83], v11 offset:53760
v_mfma_f32_16x16x32_bf16 a[240:243], a[128:131], a[124:127], a[240:243]
s_add_u32 m0, s60, 36864
s_add_u32 s52, s59, 0
v_mfma_f32_16x16x32_bf16 a[244:247], a[128:131], a[120:123], a[244:247]
ds_read_b64_tr_b16 a[144:145], v12 offset:53248
ds_read_b64_tr_b16 a[146:147], v12 offset:53760
v_mfma_f32_16x16x32_bf16 v[36:39], a[128:131], a[116:119], v[36:39]
buffer_load_dwordx4 v5, s[12:15], s52 offen lds
v_mfma_f32_16x16x32_bf16 v[44:47], a[128:131], a[112:115], v[44:47]
ds_read_b64_tr_b16 a[84:85], v13 offset:53248
ds_read_b64_tr_b16 a[86:87], v13 offset:53760
v_mfma_f32_16x16x32_bf16 v[52:55], a[68:71], a[112:115], v[52:55]
s_add_u32 s49, s76, 36864
v_mfma_f32_16x16x32_bf16 v[60:63], a[68:71], a[116:119], v[60:63]
ds_read_b64_tr_b16 a[148:149], v14 offset:53248
ds_read_b64_tr_b16 a[150:151], v14 offset:53760
v_mfma_f32_16x16x32_bf16 v[68:71], a[68:71], a[120:123], v[68:71]
buffer_store_dwordx4 v[248:251], v4, s[24:27], s49 offen offset:1024 sc1
v_mfma_f32_16x16x32_bf16 v[76:79], a[68:71], a[124:127], v[76:79]
ds_read_b128 a[88:91], v4 offset:57344
ds_read_b128 a[152:155], v4 offset:58368
v_mfma_f32_16x16x32_bf16 v[84:87], a[132:135], a[124:127], v[84:87]
buffer_load_dwordx4 v6, s[12:15], s52 offen offset:1024 lds
v_mfma_f32_16x16x32_bf16 v[92:95], a[132:135], a[120:123], v[92:95]
ds_read_b128 a[92:95], v4 offset:59392
ds_read_b128 a[156:159], v4 offset:60416
v_mfma_f32_16x16x32_bf16 v[100:103], a[132:135], a[116:119], v[100:103]
v_accvgpr_read_b32 v16, a0
v_accvgpr_read_b32 v17, a1
v_mfma_f32_16x16x32_bf16 v[108:111], a[132:135], a[112:115], v[108:111]
v_accvgpr_read_b32 v18, a2
v_accvgpr_read_b32 v19, a3
v_mfma_f32_16x16x32_bf16 v[116:119], a[72:75], a[112:115], v[116:119]
s_add_u32 m0, s60, 38912
s_add_u32 s52, s59, 18432
v_accvgpr_read_b32 v20, a4
v_mfma_f32_16x16x32_bf16 v[124:127], a[72:75], a[116:119], v[124:127]
v_accvgpr_read_b32 v21, a5
v_accvgpr_read_b32 v22, a6
v_mfma_f32_16x16x32_bf16 v[132:135], a[72:75], a[120:123], v[132:135]
buffer_load_dwordx4 v5, s[12:15], s52 offen lds
v_mfma_f32_16x16x32_bf16 v[140:143], a[72:75], a[124:127], v[140:143]
v_accvgpr_read_b32 v23, a7
v_mul_f32 v16, s80, v16
v_mfma_f32_16x16x32_bf16 v[148:151], a[136:139], a[124:127], v[148:151]
v_mul_f32 v17, s80, v17
v_mul_f32 v18, s80, v18
v_mfma_f32_16x16x32_bf16 v[156:159], a[136:139], a[120:123], v[156:159]
v_mul_f32 v19, s80, v19
v_mul_f32 v20, s80, v20
v_mfma_f32_16x16x32_bf16 v[32:35], a[136:139], a[116:119], v[32:35]
v_mul_f32 v21, s80, v21
v_mul_f32 v22, s80, v22
v_mfma_f32_16x16x32_bf16 v[40:43], a[136:139], a[112:115], v[40:43]
v_mul_f32 v23, s80, v23
v_cvt_pk_bf16_f32 v16, v16, v17
v_mfma_f32_16x16x32_bf16 v[48:51], a[76:79], a[112:115], v[48:51]
buffer_load_dwordx4 v6, s[12:15], s52 offen offset:1024 lds
v_mfma_f32_16x16x32_bf16 v[56:59], a[76:79], a[116:119], v[56:59]
v_add_u32 v9, -65536, v9
v_add_u32 v10, -65536, v10
v_mfma_f32_16x16x32_bf16 v[64:67], a[76:79], a[120:123], v[64:67]
v_cvt_pk_bf16_f32 v17, v18, v19
v_cvt_pk_bf16_f32 v18, v20, v21
v_mfma_f32_16x16x32_bf16 v[72:75], a[76:79], a[124:127], v[72:75]
v_cvt_pk_bf16_f32 v19, v22, v23
v_mfma_f32_16x16x32_bf16 v[80:83], a[140:143], a[124:127], v[80:83]
s_add_u32 s49, s76, 49152
v_mfma_f32_16x16x32_bf16 v[88:91], a[140:143], a[120:123], v[88:91]
buffer_store_dwordx4 v[16:19], v4, s[24:27], s49 offen offset:0 sc1
v_mfma_f32_16x16x32_bf16 v[96:99], a[140:143], a[116:119], v[96:99]
v_accvgpr_read_b32 v24, a8
v_accvgpr_read_b32 v25, a9
v_mfma_f32_16x16x32_bf16 v[104:107], a[140:143], a[112:115], v[104:107]
s_waitcnt lgkmcnt(0)
v_accvgpr_read_b32 v26, a10
v_accvgpr_read_b32 v27, a11
v_mfma_f32_16x16x32_bf16 a[32:35], a[160:163], a[96:99], a[32:35]
s_waitcnt vmcnt(20)
v_accvgpr_read_b32 v28, a12
v_accvgpr_read_b32 v29, a13
v_mfma_f32_16x16x32_bf16 a[36:39], a[160:163], a[100:103], a[36:39]
s_barrier
v_mfma_f32_16x16x32_bf16 a[40:43], a[160:163], a[104:107], a[40:43]
ds_read_b128 a[112:115], v9 offset:0
ds_read_b128 a[116:119], v9 offset:2048
v_mfma_f32_16x16x32_bf16 a[44:47], a[160:163], a[108:111], a[44:47]
s_add_u32 m0, s64, 49152
s_add_u32 s52, s63, 262144
v_accvgpr_read_b32 v30, a14
v_mfma_f32_16x16x32_bf16 a[48:51], a[164:167], a[108:111], a[48:51]
buffer_load_dwordx4 v7, s[20:23], s52 offen lds
v_mfma_f32_16x16x32_bf16 a[52:55], a[164:167], a[104:107], a[52:55]
ds_read_b128 a[120:123], v9 offset:4096
ds_read_b128 a[124:127], v9 offset:6144
v_mfma_f32_16x16x32_bf16 a[56:59], a[164:167], a[100:103], a[56:59]
v_accvgpr_read_b32 v31, a15
v_mul_f32 v24, s80, v24
v_mfma_f32_16x16x32_bf16 a[60:63], a[164:167], a[96:99], a[60:63]
ds_read_b64_tr_b16 a[176:177], v11 offset:0
ds_read_b64_tr_b16 a[178:179], v11 offset:512
v_mfma_f32_16x16x32_bf16 a[192:195], a[168:171], a[96:99], a[192:195]
v_mul_f32 v25, s80, v25
v_mul_f32 v26, s80, v26
v_mfma_f32_16x16x32_bf16 a[196:199], a[168:171], a[100:103], a[196:199]
ds_read_b64_tr_b16 a[180:181], v12 offset:0
ds_read_b64_tr_b16 a[182:183], v12 offset:512
v_mfma_f32_16x16x32_bf16 a[200:203], a[168:171], a[104:107], a[200:203]
buffer_load_dwordx4 v8, s[20:23], s52 offen offset:1024 lds
v_mfma_f32_16x16x32_bf16 a[204:207], a[168:171], a[108:111], a[204:207]
ds_read_b64_tr_b16 a[184:185], v13 offset:0
ds_read_b64_tr_b16 a[186:187], v13 offset:512
v_mfma_f32_16x16x32_bf16 a[208:211], a[172:175], a[108:111], a[208:211]
v_mul_f32 v27, s80, v27
v_mul_f32 v28, s80, v28
v_mfma_f32_16x16x32_bf16 a[212:215], a[172:175], a[104:107], a[212:215]
ds_read_b64_tr_b16 a[188:189], v14 offset:0
ds_read_b64_tr_b16 a[190:191], v14 offset:512
v_mfma_f32_16x16x32_bf16 a[216:219], a[172:175], a[100:103], a[216:219]
s_add_u32 m0, s67, 49152
s_add_u32 s52, s66, 4096
v_mul_f32 v29, s80, v29
v_mfma_f32_16x16x32_bf16 a[220:223], a[172:175], a[96:99], a[220:223]
ds_read_b64_tr_b16 a[64:65], v11 offset:4096
ds_read_b64_tr_b16 a[66:67], v11 offset:4608
v_mfma_f32_16x16x32_bf16 a[224:227], a[80:83], a[96:99], a[224:227]
buffer_load_dwordx4 v4, s[24:27], s52 offen sc1 lds
v_mfma_f32_16x16x32_bf16 a[228:231], a[80:83], a[100:103], a[228:231]
s_cmp_eq_u32 s57, 1024
s_cselect_b32 s53, -1024, 64
s_cselect_b32 s56, 0, 64
v_mfma_f32_16x16x32_bf16 a[232:235], a[80:83], a[104:107], a[232:235]
s_add_u32 s53, s53, s56
s_add_u32 s57, s57, s53
s_add_u32 s58, s58, s53
v_mfma_f32_16x16x32_bf16 a[236:239], a[80:83], a[108:111], a[236:239]
s_add_u32 s59, s59, s53
ds_read_b64_tr_b16 a[128:129], v12 offset:4096
ds_read_b64_tr_b16 a[130:131], v12 offset:4608
v_mfma_f32_16x16x32_bf16 a[240:243], a[144:147], a[108:111], a[240:243]
s_add_u32 m0, s60, 65536
s_add_u32 s52, s58, 0
v_mul_f32 v30, s80, v30
v_mfma_f32_16x16x32_bf16 a[244:247], a[144:147], a[104:107], a[244:247]
ds_read_b64_tr_b16 a[68:69], v13 offset:4096
ds_read_b64_tr_b16 a[70:71], v13 offset:4608
v_mfma_f32_16x16x32_bf16 v[36:39], a[144:147], a[100:103], v[36:39]
buffer_load_dwordx4 v5, s[12:15], s52 offen lds
v_mfma_f32_16x16x32_bf16 v[44:47], a[144:147], a[96:99], v[44:47]
ds_read_b64_tr_b16 a[132:133], v14 offset:4096
ds_read_b64_tr_b16 a[134:135], v14 offset:4608
v_mfma_f32_16x16x32_bf16 v[52:55], a[84:87], a[96:99], v[52:55]
v_mul_f32 v31, s80, v31
v_cvt_pk_bf16_f32 v24, v24, v25
v_mfma_f32_16x16x32_bf16 v[60:63], a[84:87], a[100:103], v[60:63]
ds_read_b128 a[72:75], v4 offset:8192
ds_read_b128 a[136:139], v4 offset:9216
v_mfma_f32_16x16x32_bf16 v[68:71], a[84:87], a[104:107], v[68:71]
v_cvt_pk_bf16_f32 v25, v26, v27
v_cvt_pk_bf16_f32 v26, v28, v29
v_mfma_f32_16x16x32_bf16 v[76:79], a[84:87], a[108:111], v[76:79]
ds_read_b128 a[76:79], v4 offset:10240
ds_read_b128 a[140:143], v4 offset:11264
v_mfma_f32_16x16x32_bf16 v[84:87], a[148:151], a[108:111], v[84:87]
buffer_load_dwordx4 v6, s[12:15], s52 offen offset:1024 lds
v_mfma_f32_16x16x32_bf16 v[92:95], a[148:151], a[104:107], v[92:95]
v_cvt_pk_bf16_f32 v27, v30, v31
v_mfma_f32_16x16x32_bf16 v[100:103], a[148:151], a[100:103], v[100:103]
s_add_u32 s49, s76, 49152
v_mfma_f32_16x16x32_bf16 v[108:111], a[148:151], a[96:99], v[108:111]
buffer_store_dwordx4 v[24:27], v4, s[24:27], s49 offen offset:1024 sc1
v_mfma_f32_16x16x32_bf16 v[116:119], a[88:91], a[96:99], v[116:119]
s_add_u32 m0, s60, 67584
s_add_u32 s52, s58, 18432
v_accvgpr_read_b32 v16, a16
v_mfma_f32_16x16x32_bf16 v[124:127], a[88:91], a[100:103], v[124:127]
v_accvgpr_read_b32 v17, a17
v_accvgpr_read_b32 v18, a18
v_mfma_f32_16x16x32_bf16 v[132:135], a[88:91], a[104:107], v[132:135]
buffer_load_dwordx4 v5, s[12:15], s52 offen lds
v_mfma_f32_16x16x32_bf16 v[140:143], a[88:91], a[108:111], v[140:143]
v_accvgpr_read_b32 v19, a19
v_accvgpr_read_b32 v20, a20
v_mfma_f32_16x16x32_bf16 v[148:151], a[152:155], a[108:111], v[148:151]
v_accvgpr_read_b32 v21, a21
v_accvgpr_read_b32 v22, a22
v_mfma_f32_16x16x32_bf16 v[156:159], a[152:155], a[104:107], v[156:159]
v_accvgpr_read_b32 v23, a23
v_mul_f32 v16, s80, v16
v_mfma_f32_16x16x32_bf16 v[32:35], a[152:155], a[100:103], v[32:35]
v_mul_f32 v17, s80, v17
v_mul_f32 v18, s80, v18
v_mfma_f32_16x16x32_bf16 v[40:43], a[152:155], a[96:99], v[40:43]
v_mul_f32 v19, s80, v19
v_mul_f32 v20, s80, v20
v_mfma_f32_16x16x32_bf16 v[48:51], a[92:95], a[96:99], v[48:51]
buffer_load_dwordx4 v6, s[12:15], s52 offen offset:1024 lds
v_mfma_f32_16x16x32_bf16 v[56:59], a[92:95], a[100:103], v[56:59]
v_mul_f32 v21, s80, v21
v_mul_f32 v22, s80, v22
v_mfma_f32_16x16x32_bf16 v[64:67], a[92:95], a[104:107], v[64:67]
v_mul_f32 v23, s80, v23
v_cvt_pk_bf16_f32 v16, v16, v17
v_mfma_f32_16x16x32_bf16 v[72:75], a[92:95], a[108:111], v[72:75]
v_cvt_pk_bf16_f32 v17, v18, v19
v_cvt_pk_bf16_f32 v18, v20, v21
v_mfma_f32_16x16x32_bf16 v[80:83], a[156:159], a[108:111], v[80:83]
v_cvt_pk_bf16_f32 v19, v22, v23
v_mfma_f32_16x16x32_bf16 v[88:91], a[156:159], a[104:107], v[88:91]
v_mfma_f32_16x16x32_bf16 v[96:99], a[156:159], a[100:103], v[96:99]
s_add_u32 s49, s76, 53248
v_mfma_f32_16x16x32_bf16 v[104:107], a[156:159], a[96:99], v[104:107]
s_waitcnt lgkmcnt(0)
v_mfma_f32_16x16x32_bf16 a[32:35], a[176:179], a[112:115], a[32:35]
s_waitcnt vmcnt(24)
v_mfma_f32_16x16x32_bf16 a[36:39], a[176:179], a[116:119], a[36:39]
s_barrier
v_mfma_f32_16x16x32_bf16 a[40:43], a[176:179], a[120:123], a[40:43]
ds_read_b128 a[96:99], v10 offset:0
ds_read_b128 a[100:103], v10 offset:2048
v_mfma_f32_16x16x32_bf16 a[44:47], a[176:179], a[124:127], a[44:47]
s_add_u32 s62, s62, 1
s_cmp_eq_u32 s62, 9
s_cselect_b32 s62, 0, s62
v_mfma_f32_16x16x32_bf16 a[48:51], a[180:183], a[124:127], a[48:51]
s_lshl_b32 s63, s62, 19
s_add_u32 s63, s63, s61
v_mfma_f32_16x16x32_bf16 a[52:55], a[180:183], a[120:123], a[52:55]
s_lshl_b32 s66, s62, 13
s_add_u32 s66, s66, s65
v_mfma_f32_16x16x32_bf16 a[56:59], a[180:183], a[116:119], a[56:59]
s_add_u32 m0, s64, 0
s_add_u32 s52, s63, 0
v_mfma_f32_16x16x32_bf16 a[60:63], a[180:183], a[112:115], a[60:63]
buffer_load_dwordx4 v7, s[20:23], s52 offen lds
v_mfma_f32_16x16x32_bf16 a[192:195], a[184:187], a[112:115], a[192:195]
ds_read_b128 a[104:107], v10 offset:4096
ds_read_b128 a[108:111], v10 offset:6144
v_mfma_f32_16x16x32_bf16 a[196:199], a[184:187], a[116:119], a[196:199]
buffer_store_dwordx4 v[16:19], v4, s[24:27], s49 offen offset:0 sc1
v_mfma_f32_16x16x32_bf16 a[200:203], a[184:187], a[120:123], a[200:203]
buffer_load_dwordx4 v8, s[20:23], s52 offen offset:1024 lds
v_mfma_f32_16x16x32_bf16 a[204:207], a[184:187], a[124:127], a[204:207]
ds_read_b64_tr_b16 a[160:161], v11 offset:16384
ds_read_b64_tr_b16 a[162:163], v11 offset:16896
v_mfma_f32_16x16x32_bf16 a[208:211], a[188:191], a[124:127], a[208:211]
v_accvgpr_read_b32 v24, a24
v_accvgpr_read_b32 v25, a25
v_mfma_f32_16x16x32_bf16 a[212:215], a[188:191], a[120:123], a[212:215]
ds_read_b64_tr_b16 a[164:165], v12 offset:16384
ds_read_b64_tr_b16 a[166:167], v12 offset:16896
v_mfma_f32_16x16x32_bf16 a[216:219], a[188:191], a[116:119], a[216:219]
s_add_u32 m0, s67, 0
s_add_u32 s52, s66, 0
v_accvgpr_read_b32 v26, a26
v_mfma_f32_16x16x32_bf16 a[220:223], a[188:191], a[112:115], a[220:223]
ds_read_b64_tr_b16 a[168:169], v13 offset:16384
ds_read_b64_tr_b16 a[170:171], v13 offset:16896
v_mfma_f32_16x16x32_bf16 a[224:227], a[64:67], a[112:115], a[224:227]
buffer_load_dwordx4 v4, s[24:27], s52 offen sc1 lds
v_mfma_f32_16x16x32_bf16 a[228:231], a[64:67], a[116:119], a[228:231]
ds_read_b64_tr_b16 a[172:173], v14 offset:16384
ds_read_b64_tr_b16 a[174:175], v14 offset:16896
v_mfma_f32_16x16x32_bf16 a[232:235], a[64:67], a[120:123], a[232:235]
v_accvgpr_read_b32 v27, a27
v_accvgpr_read_b32 v28, a28
v_mfma_f32_16x16x32_bf16 a[236:239], a[64:67], a[124:127], a[236:239]
ds_read_b64_tr_b16 a[80:81], v11 offset:20480
ds_read_b64_tr_b16 a[82:83], v11 offset:20992
v_mfma_f32_16x16x32_bf16 a[240:243], a[128:131], a[124:127], a[240:243]
s_add_u32 m0, s60, 69632
s_add_u32 s52, s59, 0
v_accvgpr_read_b32 v29, a29
v_mfma_f32_16x16x32_bf16 a[244:247], a[128:131], a[120:123], a[244:247]
ds_read_b64_tr_b16 a[144:145], v12 offset:20480
ds_read_b64_tr_b16 a[146:147], v12 offset:20992
v_mfma_f32_16x16x32_bf16 v[36:39], a[128:131], a[116:119], v[36:39]
buffer_load_dwordx4 v5, s[12:15], s52 offen lds
v_mfma_f32_16x16x32_bf16 v[44:47], a[128:131], a[112:115], v[44:47]
ds_read_b64_tr_b16 a[84:85], v13 offset:20480
ds_read_b64_tr_b16 a[86:87], v13 offset:20992
v_mfma_f32_16x16x32_bf16 v[52:55], a[68:71], a[112:115], v[52:55]
v_accvgpr_read_b32 v30, a30
v_accvgpr_read_b32 v31, a31
v_mfma_f32_16x16x32_bf16 v[60:63], a[68:71], a[116:119], v[60:63]
ds_read_b64_tr_b16 a[148:149], v14 offset:20480
ds_read_b64_tr_b16 a[150:151], v14 offset:20992
v_mfma_f32_16x16x32_bf16 v[68:71], a[68:71], a[120:123], v[68:71]
v_mul_f32 v24, s80, v24
v_mul_f32 v25, s80, v25
v_mfma_f32_16x16x32_bf16 v[76:79], a[68:71], a[124:127], v[76:79]
ds_read_b128 a[88:91], v4 offset:24576
ds_read_b128 a[152:155], v4 offset:25600
v_mfma_f32_16x16x32_bf16 v[84:87], a[132:135], a[124:127], v[84:87]
buffer_load_dwordx4 v6, s[12:15], s52 offen offset:1024 lds
v_mfma_f32_16x16x32_bf16 v[92:95], a[132:135], a[120:123], v[92:95]
ds_read_b128 a[92:95], v4 offset:26624
ds_read_b128 a[156:159], v4 offset:27648
v_mfma_f32_16x16x32_bf16 v[100:103], a[132:135], a[116:119], v[100:103]
v_mul_f32 v26, s80, v26
v_mul_f32 v27, s80, v27
v_mfma_f32_16x16x32_bf16 v[108:111], a[132:135], a[112:115], v[108:111]
v_mul_f32 v28, s80, v28
v_mul_f32 v29, s80, v29
v_mfma_f32_16x16x32_bf16 v[116:119], a[72:75], a[112:115], v[116:119]
s_add_u32 m0, s60, 71680
s_add_u32 s52, s59, 18432
v_mul_f32 v30, s80, v30
v_mfma_f32_16x16x32_bf16 v[124:127], a[72:75], a[116:119], v[124:127]
v_mul_f32 v31, s80, v31
v_cvt_pk_bf16_f32 v24, v24, v25
v_mfma_f32_16x16x32_bf16 v[132:135], a[72:75], a[120:123], v[132:135]
buffer_load_dwordx4 v5, s[12:15], s52 offen lds
v_mfma_f32_16x16x32_bf16 v[140:143], a[72:75], a[124:127], v[140:143]
v_cvt_pk_bf16_f32 v25, v26, v27
v_cvt_pk_bf16_f32 v26, v28, v29
v_mfma_f32_16x16x32_bf16 v[148:151], a[136:139], a[124:127], v[148:151]
v_cvt_pk_bf16_f32 v27, v30, v31
v_mfma_f32_16x16x32_bf16 v[156:159], a[136:139], a[120:123], v[156:159]
s_add_u32 s49, s76, 53248
v_mfma_f32_16x16x32_bf16 v[32:35], a[136:139], a[116:119], v[32:35]
buffer_store_dwordx4 v[24:27], v4, s[24:27], s49 offen offset:1024 sc1
v_mfma_f32_16x16x32_bf16 v[40:43], a[136:139], a[112:115], v[40:43]
v_mfma_f32_16x16x32_bf16 v[48:51], a[76:79], a[112:115], v[48:51]
buffer_load_dwordx4 v6, s[12:15], s52 offen offset:1024 lds
v_mfma_f32_16x16x32_bf16 v[56:59], a[76:79], a[116:119], v[56:59]
v_add_u32 v9, 32768, v9
v_add_u32 v10, 32768, v10
v_mfma_f32_16x16x32_bf16 v[64:67], a[76:79], a[120:123], v[64:67]
v_mov_b32 v29, 0
v_and_b32 v28, 31, v1
v_mfma_f32_16x16x32_bf16 v[72:75], a[76:79], a[124:127], v[72:75]
v_lshlrev_b32 v28, 2, v28
v_mfma_f32_16x16x32_bf16 v[80:83], a[140:143], a[124:127], v[80:83]
buffer_load_dword v30, v28, s[40:43], 0 offen sc1
v_mfma_f32_16x16x32_bf16 v[88:91], a[140:143], a[120:123], v[88:91]
v_mfma_f32_16x16x32_bf16 v[96:99], a[140:143], a[116:119], v[96:99]
v_mfma_f32_16x16x32_bf16 v[104:107], a[140:143], a[112:115], v[104:107]
s_waitcnt lgkmcnt(0)
v_mfma_f32_16x16x32_bf16 a[32:35], a[160:163], a[96:99], a[32:35]
s_waitcnt vmcnt(19)
v_mfma_f32_16x16x32_bf16 a[36:39], a[160:163], a[100:103], a[36:39]
s_barrier
v_mfma_f32_16x16x32_bf16 a[40:43], a[160:163], a[104:107], a[40:43]
ds_read_b128 a[112:115], v9 offset:0
ds_read_b128 a[116:119], v9 offset:2048
v_mfma_f32_16x16x32_bf16 a[44:47], a[160:163], a[108:111], a[44:47]
s_add_u32 m0, s64, 16384
s_add_u32 s52, s63, 262144
v_mfma_f32_16x16x32_bf16 a[48:51], a[164:167], a[108:111], a[48:51]
buffer_load_dwordx4 v7, s[20:23], s52 offen lds
v_mfma_f32_16x16x32_bf16 a[52:55], a[164:167], a[104:107], a[52:55]
ds_read_b128 a[120:123], v9 offset:4096
ds_read_b128 a[124:127], v9 offset:6144
v_mfma_f32_16x16x32_bf16 a[56:59], a[164:167], a[100:103], a[56:59]
v_mfma_f32_16x16x32_bf16 a[60:63], a[164:167], a[96:99], a[60:63]
ds_read_b64_tr_b16 a[176:177], v11 offset:32768
ds_read_b64_tr_b16 a[178:179], v11 offset:33280
v_mfma_f32_16x16x32_bf16 a[192:195], a[168:171], a[96:99], a[192:195]
v_mfma_f32_16x16x32_bf16 a[196:199], a[168:171], a[100:103], a[196:199]
ds_read_b64_tr_b16 a[180:181], v12 offset:32768
ds_read_b64_tr_b16 a[182:183], v12 offset:33280
v_mfma_f32_16x16x32_bf16 a[200:203], a[168:171], a[104:107], a[200:203]
buffer_load_dwordx4 v8, s[20:23], s52 offen offset:1024 lds
v_mfma_f32_16x16x32_bf16 a[204:207], a[168:171], a[108:111], a[204:207]
ds_read_b64_tr_b16 a[184:185], v13 offset:32768
ds_read_b64_tr_b16 a[186:187], v13 offset:33280
v_mfma_f32_16x16x32_bf16 a[208:211], a[172:175], a[108:111], a[208:211]
v_mfma_f32_16x16x32_bf16 a[212:215], a[172:175], a[104:107], a[212:215]
ds_read_b64_tr_b16 a[188:189], v14 offset:32768
ds_read_b64_tr_b16 a[190:191], v14 offset:33280
v_mfma_f32_16x16x32_bf16 a[216:219], a[172:175], a[100:103], a[216:219]
s_add_u32 m0, s67, 16384
s_add_u32 s52, s66, 4096
v_mfma_f32_16x16x32_bf16 a[220:223], a[172:175], a[96:99], a[220:223]
ds_read_b64_tr_b16 a[64:65], v11 offset:36864
ds_read_b64_tr_b16 a[66:67], v11 offset:37376
v_mfma_f32_16x16x32_bf16 a[224:227], a[80:83], a[96:99], a[224:227]
buffer_load_dwordx4 v4, s[24:27], s52 offen sc1 lds
v_mfma_f32_16x16x32_bf16 a[228:231], a[80:83], a[100:103], a[228:231]
s_cmp_eq_u32 s57, 1024
s_cselect_b32 s53, -1024, 64
s_cselect_b32 s56, 0, 64
v_mfma_f32_16x16x32_bf16 a[232:235], a[80:83], a[104:107], a[232:235]
s_add_u32 s53, s53, s56
s_add_u32 s57, s57, s53
s_add_u32 s58, s58, s53
v_mfma_f32_16x16x32_bf16 a[236:239], a[80:83], a[108:111], a[236:239]
s_add_u32 s59, s59, s53
ds_read_b64_tr_b16 a[128:129], v12 offset:36864
ds_read_b64_tr_b16 a[130:131], v12 offset:37376
v_mfma_f32_16x16x32_bf16 a[240:243], a[144:147], a[108:111], a[240:243]
s_add_u32 m0, s60, 0
s_add_u32 s52, s58, 0
v_mfma_f32_16x16x32_bf16 a[244:247], a[144:147], a[104:107], a[244:247]
ds_read_b64_tr_b16 a[68:69], v13 offset:36864
ds_read_b64_tr_b16 a[70:71], v13 offset:37376
v_mfma_f32_16x16x32_bf16 v[36:39], a[144:147], a[100:103], v[36:39]
buffer_load_dwordx4 v5, s[12:15], s52 offen lds
v_mfma_f32_16x16x32_bf16 v[44:47], a[144:147], a[96:99], v[44:47]
ds_read_b64_tr_b16 a[132:133], v14 offset:36864
ds_read_b64_tr_b16 a[134:135], v14 offset:37376
v_mfma_f32_16x16x32_bf16 v[52:55], a[84:87], a[96:99], v[52:55]
v_mfma_f32_16x16x32_bf16 v[60:63], a[84:87], a[100:103], v[60:63]
ds_read_b128 a[72:75], v4 offset:40960
ds_read_b128 a[136:139], v4 offset:41984
v_mfma_f32_16x16x32_bf16 v[68:71], a[84:87], a[104:107], v[68:71]
v_mfma_f32_16x16x32_bf16 v[76:79], a[84:87], a[108:111], v[76:79]
ds_read_b128 a[76:79], v4 offset:43008
ds_read_b128 a[140:143], v4 offset:44032
v_mfma_f32_16x16x32_bf16 v[84:87], a[148:151], a[108:111], v[84:87]
buffer_load_dwordx4 v6, s[12:15], s52 offen offset:1024 lds
v_mfma_f32_16x16x32_bf16 v[92:95], a[148:151], a[104:107], v[92:95]
v_mfma_f32_16x16x32_bf16 v[100:103], a[148:151], a[100:103], v[100:103]
v_mfma_f32_16x16x32_bf16 v[108:111], a[148:151], a[96:99], v[108:111]
v_mfma_f32_16x16x32_bf16 v[116:119], a[88:91], a[96:99], v[116:119]
s_add_u32 m0, s60, 2048
s_add_u32 s52, s58, 18432
v_mfma_f32_16x16x32_bf16 v[124:127], a[88:91], a[100:103], v[124:127]
v_mfma_f32_16x16x32_bf16 v[132:135], a[88:91], a[104:107], v[132:135]
buffer_load_dwordx4 v5, s[12:15], s52 offen lds
v_mfma_f32_16x16x32_bf16 v[140:143], a[88:91], a[108:111], v[140:143]
s_waitcnt vmcnt(6)
v_mfma_f32_16x16x32_bf16 v[148:151], a[152:155], a[108:111], v[148:151]
v_cmp_gt_u32 vcc, 1, v30
v_mfma_f32_16x16x32_bf16 v[156:159], a[152:155], a[104:107], v[156:159]
v_mfma_f32_16x16x32_bf16 v[32:35], a[152:155], a[100:103], v[32:35]
v_mfma_f32_16x16x32_bf16 v[40:43], a[152:155], a[96:99], v[40:43]
v_mfma_f32_16x16x32_bf16 v[48:51], a[92:95], a[96:99], v[48:51]
buffer_load_dwordx4 v6, s[12:15], s52 offen offset:1024 lds
v_mfma_f32_16x16x32_bf16 v[56:59], a[92:95], a[100:103], v[56:59]
s_cbranch_vccnz CK_ZA
CK_ZA_R:
v_mfma_f32_16x16x32_bf16 v[64:67], a[92:95], a[104:107], v[64:67]
v_mfma_f32_16x16x32_bf16 v[72:75], a[92:95], a[108:111], v[72:75]
v_mfma_f32_16x16x32_bf16 v[80:83], a[156:159], a[108:111], v[80:83]
v_mfma_f32_16x16x32_bf16 v[88:91], a[156:159], a[104:107], v[88:91]
v_mfma_f32_16x16x32_bf16 v[96:99], a[156:159], a[100:103], v[96:99]
v_mfma_f32_16x16x32_bf16 v[104:107], a[156:159], a[96:99], v[104:107]
s_waitcnt lgkmcnt(0)
v_mfma_f32_16x16x32_bf16 a[32:35], a[176:179], a[112:115], a[32:35]
s_waitcnt vmcnt(22)
v_mfma_f32_16x16x32_bf16 a[36:39], a[176:179], a[116:119], a[36:39]
s_barrier
v_mfma_f32_16x16x32_bf16 a[40:43], a[176:179], a[120:123], a[40:43]
ds_read_b128 a[96:99], v10 offset:0
ds_read_b128 a[100:103], v10 offset:2048
v_mfma_f32_16x16x32_bf16 a[44:47], a[176:179], a[124:127], a[44:47]
s_add_u32 s62, s62, 1
s_cmp_eq_u32 s62, 9
s_cselect_b32 s62, 0, s62
v_mfma_f32_16x16x32_bf16 a[48:51], a[180:183], a[124:127], a[48:51]
s_lshl_b32 s63, s62, 19
s_add_u32 s63, s63, s61
v_mfma_f32_16x16x32_bf16 a[52:55], a[180:183], a[120:123], a[52:55]
s_lshl_b32 s66, s62, 13
s_add_u32 s66, s66, s65
v_mfma_f32_16x16x32_bf16 a[56:59], a[180:183], a[116:119], a[56:59]
s_add_u32 m0, s64, 32768
s_add_u32 s52, s63, 0
v_mfma_f32_16x16x32_bf16 a[60:63], a[180:183], a[112:115], a[60:63]
buffer_load_dwordx4 v7, s[20:23], s52 offen lds
v_mfma_f32_16x16x32_bf16 a[192:195], a[184:187], a[112:115], a[192:195]
ds_read_b128 a[104:107], v10 offset:4096
ds_read_b128 a[108:111], v10 offset:6144
v_mfma_f32_16x16x32_bf16 a[196:199], a[184:187], a[116:119], a[196:199]
v_accvgpr_read_b32 v112, a32
v_accvgpr_read_b32 v113, a33
v_mfma_f32_16x16x32_bf16 a[200:203], a[184:187], a[120:123], a[200:203]
buffer_load_dwordx4 v8, s[20:23], s52 offen offset:1024 lds
v_mfma_f32_16x16x32_bf16 a[204:207], a[184:187], a[124:127], a[204:207]
ds_read_b64_tr_b16 a[160:161], v11 offset:49152
ds_read_b64_tr_b16 a[162:163], v11 offset:49664
v_mfma_f32_16x16x32_bf16 a[208:211], a[188:191], a[124:127], a[208:211]
v_accvgpr_read_b32 v114, a34
v_accvgpr_read_b32 v115, a35
v_mfma_f32_16x16x32_bf16 a[212:215], a[188:191], a[120:123], a[212:215]
ds_read_b64_tr_b16 a[164:165], v12 offset:49152
ds_read_b64_tr_b16 a[166:167], v12 offset:49664
v_mfma_f32_16x16x32_bf16 a[216:219], a[188:191], a[116:119], a[216:219]
s_add_u32 m0, s67, 32768
s_add_u32 s52, s66, 0
v_accvgpr_read_b32 v120, a36
v_mfma_f32_16x16x32_bf16 a[220:223], a[188:191], a[112:115], a[220:223]
ds_read_b64_tr_b16 a[168:169], v13 offset:49152
ds_read_b64_tr_b16 a[170:171], v13 offset:49664
v_mfma_f32_16x16x32_bf16 a[224:227], a[64:67], a[112:115], a[224:227]
buffer_load_dwordx4 v4, s[24:27], s52 offen sc1 lds
v_mfma_f32_16x16x32_bf16 a[228:231], a[64:67], a[116:119], a[228:231]
ds_read_b64_tr_b16 a[172:173], v14 offset:49152
ds_read_b64_tr_b16 a[174:175], v14 offset:49664
v_mfma_f32_16x16x32_bf16 a[232:235], a[64:67], a[120:123], a[232:235]
v_accvgpr_read_b32 v121, a37
v_accvgpr_read_b32 v122, a38
v_mfma_f32_16x16x32_bf16 a[236:239], a[64:67], a[124:127], a[236:239]
ds_read_b64_tr_b16 a[80:81], v11 offset:53248
ds_read_b64_tr_b16 a[82:83], v11 offset:53760
v_mfma_f32_16x16x32_bf16 a[240:243], a[128:131], a[124:127], a[240:243]
s_add_u32 m0, s60, 4096
s_add_u32 s52, s59, 0
v_accvgpr_read_b32 v123, a39
v_mfma_f32_16x16x32_bf16 a[244:247], a[128:131], a[120:123], a[244:247]
ds_read_b64_tr_b16 a[144:145], v12 offset:53248
ds_read_b64_tr_b16 a[146:147], v12 offset:53760
v_mfma_f32_16x16x32_bf16 v[36:39], a[128:131], a[116:119], v[36:39]
buffer_load_dwordx4 v5, s[12:15], s52 offen lds
v_mfma_f32_16x16x32_bf16 v[44:47], a[128:131], a[112:115], v[44:47]
ds_read_b64_tr_b16 a[84:85], v13 offset:53248
ds_read_b64_tr_b16 a[86:87], v13 offset:53760
v_mfma_f32_16x16x32_bf16 v[52:55], a[68:71], a[112:115], v[52:55]
v_accvgpr_read_b32 v128, a40
v_accvgpr_read_b32 v129, a41
v_mfma_f32_16x16x32_bf16 v[60:63], a[68:71], a[116:119], v[60:63]
ds_read_b64_tr_b16 a[148:149], v14 offset:53248
ds_read_b64_tr_b16 a[150:151], v14 offset:53760
v_mfma_f32_16x16x32_bf16 v[68:71], a[68:71], a[120:123], v[68:71]
v_accvgpr_read_b32 v130, a42
v_accvgpr_read_b32 v131, a43
v_mfma_f32_16x16x32_bf16 v[76:79], a[68:71], a[124:127], v[76:79]
ds_read_b128 a[88:91], v4 offset:57344
ds_read_b128 a[152:155], v4 offset:58368
v_mfma_f32_16x16x32_bf16 v[84:87], a[132:135], a[124:127], v[84:87]
buffer_load_dwordx4 v6, s[12:15], s52 offen offset:1024 lds
v_mfma_f32_16x16x32_bf16 v[92:95], a[132:135], a[120:123], v[92:95]
ds_read_b128 a[92:95], v4 offset:59392
ds_read_b128 a[156:159], v4 offset:60416
v_mfma_f32_16x16x32_bf16 v[100:103], a[132:135], a[116:119], v[100:103]
v_accvgpr_read_b32 v136, a44
v_accvgpr_read_b32 v137, a45
v_mfma_f32_16x16x32_bf16 v[108:111], a[132:135], a[112:115], v[108:111]
v_accvgpr_read_b32 v138, a46
v_accvgpr_read_b32 v139, a47
v_mfma_f32_16x16x32_bf16 v[116:119], a[72:75], a[112:115], v[116:119]
s_add_u32 m0, s60, 6144
s_add_u32 s52, s59, 18432
v_accvgpr_read_b32 v144, a48
v_mfma_f32_16x16x32_bf16 v[124:127], a[72:75], a[116:119], v[124:127]
v_accvgpr_read_b32 v145, a49
v_accvgpr_read_b32 v146, a50
v_mfma_f32_16x16x32_bf16 v[132:135], a[72:75], a[120:123], v[132:135]
buffer_load_dwordx4 v5, s[12:15], s52 offen lds
v_mfma_f32_16x16x32_bf16 v[140:143], a[72:75], a[124:127], v[140:143]
v_accvgpr_read_b32 v147, a51
v_accvgpr_read_b32 v152, a52
v_mfma_f32_16x16x32_bf16 v[148:151], a[136:139], a[124:127], v[148:151]
v_accvgpr_read_b32 v153, a53
v_accvgpr_read_b32 v154, a54
v_mfma_f32_16x16x32_bf16 v[156:159], a[136:139], a[120:123], v[156:159]
v_accvgpr_read_b32 v155, a55
v_mfma_f32_16x16x32_bf16 v[32:35], a[136:139], a[116:119], v[32:35]
v_mfma_f32_16x16x32_bf16 v[40:43], a[136:139], a[112:115], v[40:43]
v_mfma_f32_16x16x32_bf16 v[48:51], a[76:79], a[112:115], v[48:51]
buffer_load_dwordx4 v6, s[12:15], s52 offen offset:1024 lds
v_mfma_f32_16x16x32_bf16 v[56:59], a[76:79], a[116:119], v[56:59]
v_add_u32 v9, 32768, v9
v_add_u32 v10, 32768, v10
v_mfma_f32_16x16x32_bf16 v[64:67], a[76:79], a[120:123], v[64:67]
v_mfma_f32_16x16x32_bf16 v[72:75], a[76:79], a[124:127], v[72:75]
v_mfma_f32_16x16x32_bf16 v[80:83], a[140:143], a[124:127], v[80:83]
v_mfma_f32_16x16x32_bf16 v[88:91], a[140:143], a[120:123], v[88:91]
v_mfma_f32_16x16x32_bf16 v[96:99], a[140:143], a[116:119], v[96:99]
v_mfma_f32_16x16x32_bf16 v[104:107], a[140:143], a[112:115], v[104:107]
s_waitcnt lgkmcnt(0)
v_mfma_f32_16x16x32_bf16 v[112:115], a[160:163], a[96:99], v[112:115]
s_waitcnt vmcnt(15)
v_mfma_f32_16x16x32_bf16 v[120:123], a[160:163], a[100:103], v[120:123]
s_barrier
v_mfma_f32_16x16x32_bf16 v[128:131], a[160:163], a[104:107], v[128:131]
ds_read_b128 a[112:115], v9 offset:0
ds_read_b128 a[116:119], v9 offset:2048
v_mfma_f32_16x16x32_bf16 v[136:139], a[160:163], a[108:111], v[136:139]
s_add_u32 m0, s64, 49152
s_add_u32 s52, s63, 262144
v_mfma_f32_16x16x32_bf16 v[144:147], a[164:167], a[108:111], v[144:147]
buffer_load_dwordx4 v7, s[20:23], s52 offen lds
v_mfma_f32_16x16x32_bf16 v[152:155], a[164:167], a[104:107], v[152:155]
ds_read_b128 a[120:123], v9 offset:4096
ds_read_b128 a[124:127], v9 offset:6144
v_mfma_f32_16x16x32_bf16 a[56:59], a[164:167], a[100:103], a[56:59]
v_mfma_f32_16x16x32_bf16 a[60:63], a[164:167], a[96:99], a[60:63]
ds_read_b64_tr_b16 a[176:177], v11 offset:0
ds_read_b64_tr_b16 a[178:179], v11 offset:512
v_mfma_f32_16x16x32_bf16 a[192:195], a[168:171], a[96:99], a[192:195]
v_mfma_f32_16x16x32_bf16 a[196:199], a[168:171], a[100:103], a[196:199]
ds_read_b64_tr_b16 a[180:181], v12 offset:0
ds_read_b64_tr_b16 a[182:183], v12 offset:512
v_mfma_f32_16x16x32_bf16 a[200:203], a[168:171], a[104:107], a[200:203]
buffer_load_dwordx4 v8, s[20:23], s52 offen offset:1024 lds
v_mfma_f32_16x16x32_bf16 a[204:207], a[168:171], a[108:111], a[204:207]
ds_read_b64_tr_b16 a[184:185], v13 offset:0
ds_read_b64_tr_b16 a[186:187], v13 offset:512
v_mfma_f32_16x16x32_bf16 a[208:211], a[172:175], a[108:111], a[208:211]
v_mfma_f32_16x16x32_bf16 a[212:215], a[172:175], a[104:107], a[212:215]
ds_read_b64_tr_b16 a[188:189], v14 offset:0
ds_read_b64_tr_b16 a[190:191], v14 offset:512
v_mfma_f32_16x16x32_bf16 a[216:219], a[172:175], a[100:103], a[216:219]
s_add_u32 m0, s67, 49152
s_add_u32 s52, s66, 4096
v_accvgpr_read_b32 v160, a56
v_mfma_f32_16x16x32_bf16 a[220:223], a[172:175], a[96:99], a[220:223]
ds_read_b64_tr_b16 a[64:65], v11 offset:4096
ds_read_b64_tr_b16 a[66:67], v11 offset:4608
v_mfma_f32_16x16x32_bf16 a[224:227], a[80:83], a[96:99], a[224:227]
buffer_load_dwordx4 v4, s[24:27], s52 offen sc1 lds
v_mfma_f32_16x16x32_bf16 a[228:231], a[80:83], a[100:103], a[228:231]
s_cmp_eq_u32 s57, 1024
s_cselect_b32 s53, -1024, 64
s_cselect_b32 s56, 0, 64
v_mfma_f32_16x16x32_bf16 a[232:235], a[80:83], a[104:107], a[232:235]
s_add_u32 s53, s53, s56
s_add_u32 s57, s57, s53
s_add_u32 s58, s58, s53
v_mfma_f32_16x16x32_bf16 a[236:239], a[80:83], a[108:111], a[236:239]
s_add_u32 s59, s59, s53
ds_read_b64_tr_b16 a[128:129], v12 offset:4096
ds_read_b64_tr_b16 a[130:131], v12 offset:4608
v_mfma_f32_16x16x32_bf16 a[240:243], a[144:147], a[108:111], a[240:243]
s_add_u32 m0, s60, 32768
s_add_u32 s52, s58, 0
v_accvgpr_read_b32 v161, a57
v_mfma_f32_16x16x32_bf16 a[244:247], a[144:147], a[104:107], a[244:247]
ds_read_b64_tr_b16 a[68:69], v13 offset:4096
ds_read_b64_tr_b16 a[70:71], v13 offset:4608
v_mfma_f32_16x16x32_bf16 v[36:39], a[144:147], a[100:103], v[36:39]
buffer_load_dwordx4 v5, s[12:15], s52 offen lds
v_mfma_f32_16x16x32_bf16 v[44:47], a[144:147], a[96:99], v[44:47]
ds_read_b64_tr_b16 a[132:133], v14 offset:4096
ds_read_b64_tr_b16 a[134:135], v14 offset:4608
v_mfma_f32_16x16x32_bf16 v[52:55], a[84:87], a[96:99], v[52:55]
v_accvgpr_read_b32 v162, a58
v_accvgpr_read_b32 v163, a59
v_mfma_f32_16x16x32_bf16 v[60:63], a[84:87], a[100:103], v[60:63]
ds_read_b128 a[72:75], v4 offset:8192
ds_read_b128 a[136:139], v4 offset:9216
v_mfma_f32_16x16x32_bf16 v[68:71], a[84:87], a[104:107], v[68:71]
v_accvgpr_read_b32 v164, a60
v_accvgpr_read_b32 v165, a61
v_mfma_f32_16x16x32_bf16 v[76:79], a[84:87], a[108:111], v[76:79]
ds_read_b128 a[76:79], v4 offset:10240
ds_read_b128 a[140:143], v4 offset:11264
v_mfma_f32_16x16x32_bf16 v[84:87], a[148:151], a[108:111], v[84:87]
buffer_load_dwordx4 v6, s[12:15], s52 offen offset:1024 lds
v_mfma_f32_16x16x32_bf16 v[92:95], a[148:151], a[104:107], v[92:95]
v_accvgpr_read_b32 v166, a62
v_accvgpr_read_b32 v167, a63
v_mfma_f32_16x16x32_bf16 v[100:103], a[148:151], a[100:103], v[100:103]
v_accvgpr_read_b32 v168, a192
v_accvgpr_read_b32 v169, a193
v_mfma_f32_16x16x32_bf16 v[108:111], a[148:151], a[96:99], v[108:111]
v_accvgpr_read_b32 v170, a194
v_accvgpr_read_b32 v171, a195
v_mfma_f32_16x16x32_bf16 v[116:119], a[88:91], a[96:99], v[116:119]
s_add_u32 m0, s60, 34816
s_add_u32 s52, s58, 18432
v_accvgpr_read_b32 v172, a196
v_mfma_f32_16x16x32_bf16 v[124:127], a[88:91], a[100:103], v[124:127]
v_accvgpr_read_b32 v173, a197
v_accvgpr_read_b32 v174, a198
v_mfma_f32_16x16x32_bf16 v[132:135], a[88:91], a[104:107], v[132:135]
buffer_load_dwordx4 v5, s[12:15], s52 offen lds
v_mfma_f32_16x16x32_bf16 v[140:143], a[88:91], a[108:111], v[140:143]
v_accvgpr_read_b32 v175, a199
v_accvgpr_read_b32 v176, a200
v_mfma_f32_16x16x32_bf16 v[148:151], a[152:155], a[108:111], v[148:151]
v_accvgpr_read_b32 v177, a201
v_accvgpr_read_b32 v178, a202
v_mfma_f32_16x16x32_bf16 v[156:159], a[152:155], a[104:107], v[156:159]
v_accvgpr_read_b32 v179, a203
v_accvgpr_read_b32 v180, a204
v_mfma_f32_16x16x32_bf16 v[32:35], a[152:155], a[100:103], v[32:35]
v_accvgpr_read_b32 v181, a205
v_accvgpr_read_b32 v182, a206
v_mfma_f32_16x16x32_bf16 v[40:43], a[152:155], a[96:99], v[40:43]
v_accvgpr_read_b32 v183, a207
v_mfma_f32_16x16x32_bf16 v[48:51], a[92:95], a[96:99], v[48:51]
buffer_load_dwordx4 v6, s[12:15], s52 offen offset:1024 lds
v_mfma_f32_16x16x32_bf16 v[56:59], a[92:95], a[100:103], v[56:59]
v_mfma_f32_16x16x32_bf16 v[64:67], a[92:95], a[104:107], v[64:67]
v_mfma_f32_16x16x32_bf16 v[72:75], a[92:95], a[108:111], v[72:75]
v_mfma_f32_16x16x32_bf16 v[80:83], a[156:159], a[108:111], v[80:83]
v_mfma_f32_16x16x32_bf16 v[88:91], a[156:159], a[104:107], v[88:91]
v_mfma_f32_16x16x32_bf16 v[96:99], a[156:159], a[100:103], v[96:99]
v_mfma_f32_16x16x32_bf16 v[104:107], a[156:159], a[96:99], v[104:107]
s_waitcnt lgkmcnt(0)
v_mfma_f32_16x16x32_bf16 v[112:115], a[176:179], a[112:115], v[112:115]
s_waitcnt vmcnt(18)
v_mfma_f32_16x16x32_bf16 v[120:123], a[176:179], a[116:119], v[120:123]
s_barrier
v_mfma_f32_16x16x32_bf16 v[128:131], a[176:179], a[120:123], v[128:131]
ds_read_b128 a[96:99], v10 offset:0
ds_read_b128 a[100:103], v10 offset:2048
v_mfma_f32_16x16x32_bf16 v[136:139], a[176:179], a[124:127], v[136:139]
s_add_u32 s62, s62, 1
s_cmp_eq_u32 s62, 9
s_cselect_b32 s62, 0, s62
v_mfma_f32_16x16x32_bf16 v[144:147], a[180:183], a[124:127], v[144:147]
s_lshl_b32 s63, s62, 19
s_add_u32 s63, s63, s61
v_mfma_f32_16x16x32_bf16 v[152:155], a[180:183], a[120:123], v[152:155]
s_lshl_b32 s66, s62, 13
s_add_u32 s66, s66, s65
v_mfma_f32_16x16x32_bf16 v[160:163], a[180:183], a[116:119], v[160:163]
s_add_u32 m0, s64, 0
s_add_u32 s52, s63, 0
v_mfma_f32_16x16x32_bf16 v[164:167], a[180:183], a[112:115], v[164:167]
buffer_load_dwordx4 v7, s[20:23], s52 offen lds
v_mfma_f32_16x16x32_bf16 v[168:171], a[184:187], a[112:115], v[168:171]
ds_read_b128 a[104:107], v10 offset:4096
ds_read_b128 a[108:111], v10 offset:6144
v_mfma_f32_16x16x32_bf16 v[172:175], a[184:187], a[116:119], v[172:175]
buffer_atomic_add v15, v0, s[24:27], s79 offen offset:4 sc1
v_mfma_f32_16x16x32_bf16 v[176:179], a[184:187], a[120:123], v[176:179]
buffer_load_dwordx4 v8, s[20:23], s52 offen offset:1024 lds
v_mfma_f32_16x16x32_bf16 v[180:183], a[184:187], a[124:127], v[180:183]
ds_read_b64_tr_b16 a[160:161], v11 offset:16384
ds_read_b64_tr_b16 a[162:163], v11 offset:16896
v_mfma_f32_16x16x32_bf16 a[208:211], a[188:191], a[124:127], a[208:211]
v_mfma_f32_16x16x32_bf16 a[212:215], a[188:191], a[120:123], a[212:215]
ds_read_b64_tr_b16 a[164:165], v12 offset:16384
ds_read_b64_tr_b16 a[166:167], v12 offset:16896
v_mfma_f32_16x16x32_bf16 a[216:219], a[188:191], a[116:119], a[216:219]
s_add_u32 m0, s67, 0
s_add_u32 s52, s66, 0
v_mfma_f32_16x16x32_bf16 a[220:223], a[188:191], a[112:115], a[220:223]
ds_read_b64_tr_b16 a[168:169], v13 offset:16384
ds_read_b64_tr_b16 a[170:171], v13 offset:16896
v_mfma_f32_16x16x32_bf16 a[224:227], a[64:67], a[112:115], a[224:227]
buffer_load_dwordx4 v4, s[24:27], s52 offen sc1 lds
v_mfma_f32_16x16x32_bf16 a[228:231], a[64:67], a[116:119], a[228:231]
ds_read_b64_tr_b16 a[172:173], v14 offset:16384
ds_read_b64_tr_b16 a[174:175], v14 offset:16896
v_mfma_f32_16x16x32_bf16 a[232:235], a[64:67], a[120:123], a[232:235]
v_mfma_f32_16x16x32_bf16 a[236:239], a[64:67], a[124:127], a[236:239]
ds_read_b64_tr_b16 a[80:81], v11 offset:20480
ds_read_b64_tr_b16 a[82:83], v11 offset:20992
v_mfma_f32_16x16x32_bf16 a[240:243], a[128:131], a[124:127], a[240:243]
s_add_u32 m0, s60, 36864
s_add_u32 s52, s59, 0
v_accvgpr_read_b32 v184, a208
v_mfma_f32_16x16x32_bf16 a[244:247], a[128:131], a[120:123], a[244:247]
ds_read_b64_tr_b16 a[144:145], v12 offset:20480
ds_read_b64_tr_b16 a[146:147], v12 offset:20992
v_mfma_f32_16x16x32_bf16 v[36:39], a[128:131], a[116:119], v[36:39]
buffer_load_dwordx4 v5, s[12:15], s52 offen lds
v_mfma_f32_16x16x32_bf16 v[44:47], a[128:131], a[112:115], v[44:47]
ds_read_b64_tr_b16 a[84:85], v13 offset:20480
ds_read_b64_tr_b16 a[86:87], v13 offset:20992
v_mfma_f32_16x16x32_bf16 v[52:55], a[68:71], a[112:115], v[52:55]
v_accvgpr_read_b32 v185, a209
v_accvgpr_read_b32 v186, a210
v_mfma_f32_16x16x32_bf16 v[60:63], a[68:71], a[116:119], v[60:63]
ds_read_b64_tr_b16 a[148:149], v14 offset:20480
ds_read_b64_tr_b16 a[150:151], v14 offset:20992
v_mfma_f32_16x16x32_bf16 v[68:71], a[68:71], a[120:123], v[68:71]
v_accvgpr_read_b32 v187, a211
v_accvgpr_read_b32 v188, a212
v_mfma_f32_16x16x32_bf16 v[76:79], a[68:71], a[124:127], v[76:79]
ds_read_b128 a[88:91], v4 offset:24576
ds_read_b128 a[152:155], v4 offset:25600
v_mfma_f32_16x16x32_bf16 v[84:87], a[132:135], a[124:127], v[84:87]
buffer_load_dwordx4 v6, s[12:15], s52 offen offset:1024 lds
v_mfma_f32_16x16x32_bf16 v[92:95], a[132:135], a[120:123], v[92:95]
ds_read_b128 a[92:95], v4 offset:26624
ds_read_b128 a[156:159], v4 offset:27648
v_mfma_f32_16x16x32_bf16 v[100:103], a[132:135], a[116:119], v[100:103]
v_accvgpr_read_b32 v189, a213
v_accvgpr_read_b32 v190, a214
v_mfma_f32_16x16x32_bf16 v[108:111], a[132:135], a[112:115], v[108:111]
v_accvgpr_read_b32 v191, a215
v_accvgpr_read_b32 v192, a216
v_mfma_f32_16x16x32_bf16 v[116:119], a[72:75], a[112:115], v[116:119]
s_add_u32 m0, s60, 38912
s_add_u32 s52, s59, 18432
v_accvgpr_read_b32 v193, a217
v_mfma_f32_16x16x32_bf16 v[124:127], a[72:75], a[116:119], v[124:127]
v_accvgpr_read_b32 v194, a218
v_accvgpr_read_b32 v195, a219
v_mfma_f32_16x16x32_bf16 v[132:135], a[72:75], a[120:123], v[132:135]
buffer_load_dwordx4 v5, s[12:15], s52 offen lds
v_mfma_f32_16x16x32_bf16 v[140:143], a[72:75], a[124:127], v[140:143]
v_accvgpr_read_b32 v196, a220
v_accvgpr_read_b32 v197, a221
v_mfma_f32_16x16x32_bf16 v[148:151], a[136:139], a[124:127], v[148:151]
v_accvgpr_read_b32 v198, a222
v_accvgpr_read_b32 v199, a223
v_mfma_f32_16x16x32_bf16 v[156:159], a[136:139], a[120:123], v[156:159]
v_accvgpr_read_b32 v200, a224
v_accvgpr_read_b32 v201, a225
v_mfma_f32_16x16x32_bf16 v[32:35], a[136:139], a[116:119], v[32:35]
v_accvgpr_read_b32 v202, a226
v_accvgpr_read_b32 v203, a227
v_mfma_f32_16x16x32_bf16 v[40:43], a[136:139], a[112:115], v[40:43]
v_accvgpr_read_b32 v204, a228
v_accvgpr_read_b32 v205, a229
v_mfma_f32_16x16x32_bf16 v[48:51], a[76:79], a[112:115], v[48:51]
buffer_load_dwordx4 v6, s[12:15], s52 offen offset:1024 lds
v_mfma_f32_16x16x32_bf16 v[56:59], a[76:79], a[116:119], v[56:59]
v_add_u32 v9, -65536, v9
v_add_u32 v10, -65536, v10
v_mfma_f32_16x16x32_bf16 v[64:67], a[76:79], a[120:123], v[64:67]
v_accvgpr_read_b32 v206, a230
v_accvgpr_read_b32 v207, a231
v_mfma_f32_16x16x32_bf16 v[72:75], a[76:79], a[124:127], v[72:75]
v_mfma_f32_16x16x32_bf16 v[80:83], a[140:143], a[124:127], v[80:83]
v_mfma_f32_16x16x32_bf16 v[88:91], a[140:143], a[120:123], v[88:91]
v_mfma_f32_16x16x32_bf16 v[96:99], a[140:143], a[116:119], v[96:99]
v_mfma_f32_16x16x32_bf16 v[104:107], a[140:143], a[112:115], v[104:107]
s_waitcnt lgkmcnt(0)
v_mfma_f32_16x16x32_bf16 v[112:115], a[160:163], a[96:99], v[112:115]
s_waitcnt vmcnt(15)
v_mfma_f32_16x16x32_bf16 v[120:123], a[160:163], a[100:103], v[120:123]
s_barrier
v_mfma_f32_16x16x32_bf16 v[128:131], a[160:163], a[104:107], v[128:131]
ds_read_b128 a[112:115], v9 offset:0
ds_read_b128 a[116:119], v9 offset:2048
v_mfma_f32_16x16x32_bf16 v[136:139], a[160:163], a[108:111], v[136:139]
s_add_u32 m0, s64, 16384
s_add_u32 s52, s63, 262144
v_mfma_f32_16x16x32_bf16 v[144:147], a[164:167], a[108:111], v[144:147]
buffer_load_dwordx4 v7, s[20:23], s52 offen lds
v_mfma_f32_16x16x32_bf16 v[152:155], a[164:167], a[104:107], v[152:155]
ds_read_b128 a[120:123], v9 offset:4096
ds_read_b128 a[124:127], v9 offset:6144
v_mfma_f32_16x16x32_bf16 v[160:163], a[164:167], a[100:103], v[160:163]
v_mfma_f32_16x16x32_bf16 v[164:167], a[164:167], a[96:99], v[164:167]
ds_read_b64_tr_b16 a[176:177], v11 offset:32768
ds_read_b64_tr_b16 a[178:179], v11 offset:33280
v_mfma_f32_16x16x32_bf16 v[168:171], a[168:171], a[96:99], v[168:171]
v_mfma_f32_16x16x32_bf16 v[172:175], a[168:171], a[100:103], v[172:175]
ds_read_b64_tr_b16 a[180:181], v12 offset:32768
ds_read_b64_tr_b16 a[182:183], v12 offset:33280
v_mfma_f32_16x16x32_bf16 v[176:179], a[168:171], a[104:107], v[176:179]
v_mfma_f32_16x16x32_bf16 v[180:183], a[168:171], a[108:111], v[180:183]
ds_read_b64_tr_b16 a[184:185], v13 offset:32768
ds_read_b64_tr_b16 a[186:187], v13 offset:33280
v_mfma_f32_16x16x32_bf16 v[184:187], a[172:175], a[108:111], v[184:187]
v_mfma_f32_16x16x32_bf16 v[188:191], a[172:175], a[104:107], v[188:191]
ds_read_b64_tr_b16 a[188:189], v14 offset:32768
ds_read_b64_tr_b16 a[190:191], v14 offset:33280
v_mfma_f32_16x16x32_bf16 v[192:195], a[172:175], a[100:103], v[192:195]
v_mfma_f32_16x16x32_bf16 v[196:199], a[172:175], a[96:99], v[196:199]
ds_read_b64_tr_b16 a[64:65], v11 offset:36864
ds_read_b64_tr_b16 a[66:67], v11 offset:37376
v_mfma_f32_16x16x32_bf16 v[200:203], a[80:83], a[96:99], v[200:203]
v_mfma_f32_16x16x32_bf16 v[204:207], a[80:83], a[100:103], v[204:207]
ds_read_b64_tr_b16 a[128:129], v12 offset:36864
ds_read_b64_tr_b16 a[130:131], v12 offset:37376
v_mfma_f32_16x16x32_bf16 a[232:235], a[80:83], a[104:107], a[232:235]
buffer_load_dwordx4 v8, s[20:23], s52 offen offset:1024 lds
v_mfma_f32_16x16x32_bf16 a[236:239], a[80:83], a[108:111], a[236:239]
ds_read_b64_tr_b16 a[68:69], v13 offset:36864
ds_read_b64_tr_b16 a[70:71], v13 offset:37376
v_mfma_f32_16x16x32_bf16 a[240:243], a[144:147], a[108:111], a[240:243]
v_mfma_f32_16x16x32_bf16 a[244:247], a[144:147], a[104:107], a[244:247]
ds_read_b64_tr_b16 a[132:133], v14 offset:36864
ds_read_b64_tr_b16 a[134:135], v14 offset:37376
v_mfma_f32_16x16x32_bf16 v[36:39], a[144:147], a[100:103], v[36:39]
v_mfma_f32_16x16x32_bf16 v[44:47], a[144:147], a[96:99], v[44:47]
ds_read_b128 a[72:75], v4 offset:40960
ds_read_b128 a[136:139], v4 offset:41984
v_mfma_f32_16x16x32_bf16 v[52:55], a[84:87], a[96:99], v[52:55]
v_mfma_f32_16x16x32_bf16 v[60:63], a[84:87], a[100:103], v[60:63]
ds_read_b128 a[76:79], v4 offset:43008
ds_read_b128 a[140:143], v4 offset:44032
v_mfma_f32_16x16x32_bf16 v[68:71], a[84:87], a[104:107], v[68:71]
v_accvgpr_read_b32 v208, a232
v_accvgpr_read_b32 v209, a233
v_mfma_f32_16x16x32_bf16 v[76:79], a[84:87], a[108:111], v[76:79]
v_accvgpr_read_b32 v210, a234
v_accvgpr_read_b32 v211, a235
v_mfma_f32_16x16x32_bf16 v[84:87], a[148:151], a[108:111], v[84:87]
v_accvgpr_read_b32 v212, a236
v_accvgpr_read_b32 v213, a237
v_mfma_f32_16x16x32_bf16 v[92:95], a[148:151], a[104:107], v[92:95]
v_accvgpr_read_b32 v214, a238
v_accvgpr_read_b32 v215, a239
v_mfma_f32_16x16x32_bf16 v[100:103], a[148:151], a[100:103], v[100:103]
s_add_u32 m0, s67, 16384
s_add_u32 s52, s66, 4096
v_accvgpr_read_b32 v216, a240
v_mfma_f32_16x16x32_bf16 v[108:111], a[148:151], a[96:99], v[108:111]
v_accvgpr_read_b32 v217, a241
v_accvgpr_read_b32 v218, a242
v_mfma_f32_16x16x32_bf16 v[116:119], a[88:91], a[96:99], v[116:119]
buffer_load_dwordx4 v4, s[24:27], s52 offen sc1 lds
v_mfma_f32_16x16x32_bf16 v[124:127], a[88:91], a[100:103], v[124:127]
v_accvgpr_read_b32 v219, a243
v_accvgpr_read_b32 v220, a244
v_mfma_f32_16x16x32_bf16 v[132:135], a[88:91], a[104:107], v[132:135]
v_accvgpr_read_b32 v221, a245
v_accvgpr_read_b32 v222, a246
v_mfma_f32_16x16x32_bf16 v[140:143], a[88:91], a[108:111], v[140:143]
v_accvgpr_read_b32 v223, a247
v_mfma_f32_16x16x32_bf16 v[148:151], a[152:155], a[108:111], v[148:151]
v_mov_b32 v16, 0x3f803f80
v_accvgpr_write_b32 a240, v16
v_mfma_f32_16x16x32_bf16 v[156:159], a[152:155], a[104:107], v[156:159]
v_accvgpr_write_b32 a241, v16
v_accvgpr_write_b32 a242, v16
v_mfma_f32_16x16x32_bf16 v[32:35], a[152:155], a[100:103], v[32:35]
v_accvgpr_write_b32 a243, v16
v_accvgpr_write_b32 a232, 0
v_mfma_f32_16x16x32_bf16 v[40:43], a[152:155], a[96:99], v[40:43]
v_accvgpr_write_b32 a233, 0
v_accvgpr_write_b32 a234, 0
v_mfma_f32_16x16x32_bf16 v[48:51], a[92:95], a[96:99], v[48:51]
v_accvgpr_write_b32 a235, 0
v_accvgpr_write_b32 a236, 0
v_mfma_f32_16x16x32_bf16 v[56:59], a[92:95], a[100:103], v[56:59]
v_accvgpr_write_b32 a237, 0
v_accvgpr_write_b32 a238, 0
v_mfma_f32_16x16x32_bf16 v[64:67], a[92:95], a[104:107], v[64:67]
v_accvgpr_write_b32 a239, 0
v_mov_b32 v224, 0
v_mfma_f32_16x16x32_bf16 v[72:75], a[92:95], a[108:111], v[72:75]
v_mov_b32 v225, 0
v_mov_b32 v226, 0
v_mfma_f32_16x16x32_bf16 v[80:83], a[156:159], a[108:111], v[80:83]
v_mov_b32 v227, 0
v_mov_b32 v228, 0
v_mfma_f32_16x16x32_bf16 v[88:91], a[156:159], a[104:107], v[88:91]
v_mov_b32 v229, 0
v_mov_b32 v230, 0
v_mfma_f32_16x16x32_bf16 v[96:99], a[156:159], a[100:103], v[96:99]
v_mov_b32 v231, 0
v_mov_b32 v232, 0
v_mfma_f32_16x16x32_bf16 v[104:107], a[156:159], a[96:99], v[104:107]
s_waitcnt lgkmcnt(0)
v_mov_b32 v233, 0
v_mov_b32 v234, 0
v_mfma_f32_16x16x32_bf16 v[112:115], a[176:179], a[112:115], v[112:115]
s_waitcnt vmcnt(15)
v_mov_b32 v235, 0
v_mov_b32 v236, 0
v_mfma_f32_16x16x32_bf16 v[120:123], a[176:179], a[116:119], v[120:123]
s_barrier
v_mfma_f32_16x16x32_bf16 v[128:131], a[176:179], a[120:123], v[128:131]
ds_read_b128 a[96:99], v10 offset:0
ds_read_b128 a[100:103], v10 offset:2048
v_mfma_f32_16x16x32_bf16 v[136:139], a[176:179], a[124:127], v[136:139]
v_mov_b32 v237, 0
v_mov_b32 v238, 0
v_mfma_f32_16x16x32_bf16 v[144:147], a[180:183], a[124:127], v[144:147]
ds_read_b128 a[104:107], v10 offset:4096
ds_read_b128 a[108:111], v10 offset:6144
v_mfma_f32_16x16x32_bf16 v[152:155], a[180:183], a[120:123], v[152:155]
buffer_load_dword v30, v29, s[24:27], s78 offen offset:4 sc1
v_mfma_f32_16x16x32_bf16 v[160:163], a[180:183], a[116:119], v[160:163]
ds_read_b64_tr_b16 a[160:161], v11 offset:49152
ds_read_b64_tr_b16 a[162:163], v11 offset:49664
v_mfma_f32_16x16x32_bf16 v[164:167], a[180:183], a[112:115], v[164:167]
v_mov_b32 v239, 0
v_mov_b32 v240, 0
v_mfma_f32_16x16x32_bf16 v[168:171], a[184:187], a[112:115], v[168:171]
ds_read_b64_tr_b16 a[164:165], v12 offset:49152
ds_read_b64_tr_b16 a[166:167], v12 offset:49664
v_mfma_f32_16x16x32_bf16 v[172:175], a[184:187], a[116:119], v[172:175]
v_mov_b32 v241, 0
v_mov_b32 v242, 0
v_mfma_f32_16x16x32_bf16 v[176:179], a[184:187], a[120:123], v[176:179]
ds_read_b64_tr_b16 a[168:169], v13 offset:49152
ds_read_b64_tr_b16 a[170:171], v13 offset:49664
v_mfma_f32_16x16x32_bf16 v[180:183], a[184:187], a[124:127], v[180:183]
v_mov_b32 v243, 0
v_mov_b32 v244, 0
v_mfma_f32_16x16x32_bf16 v[184:187], a[188:191], a[124:127], v[184:187]
ds_read_b64_tr_b16 a[172:173], v14 offset:49152
ds_read_b64_tr_b16 a[174:175], v14 offset:49664
v_mfma_f32_16x16x32_bf16 v[188:191], a[188:191], a[120:123], v[188:191]
v_mov_b32 v245, 0
v_mov_b32 v246, 0
v_mfma_f32_16x16x32_bf16 v[192:195], a[188:191], a[116:119], v[192:195]
ds_read_b64_tr_b16 a[80:81], v11 offset:53248
ds_read_b64_tr_b16 a[82:83], v11 offset:53760
v_mfma_f32_16x16x32_bf16 v[196:199], a[188:191], a[112:115], v[196:199]
v_mov_b32 v247, 0
v_mov_b32 v248, 0
v_mfma_f32_16x16x32_bf16 v[200:203], a[64:67], a[112:115], v[200:203]
ds_read_b64_tr_b16 a[144:145], v12 offset:53248
ds_read_b64_tr_b16 a[146:147], v12 offset:53760
v_mfma_f32_16x16x32_bf16 v[204:207], a[64:67], a[116:119], v[204:207]
v_mov_b32 v249, 0
v_mov_b32 v250, 0
v_mfma_f32_16x16x32_bf16 v[208:211], a[64:67], a[120:123], v[208:211]
ds_read_b64_tr_b16 a[84:85], v13 offset:53248
ds_read_b64_tr_b16 a[86:87], v13 offset:53760
v_mfma_f32_16x16x32_bf16 v[212:215], a[64:67], a[124:127], v[212:215]
v_mov_b32 v251, 0
v_mov_b32 v252, 0
v_mfma_f32_16x16x32_bf16 v[216:219], a[128:131], a[124:127], v[216:219]
ds_read_b64_tr_b16 a[148:149], v14 offset:53248
ds_read_b64_tr_b16 a[150:151], v14 offset:53760
v_mfma_f32_16x16x32_bf16 v[220:223], a[128:131], a[120:123], v[220:223]
v_mov_b32 v253, 0
v_mov_b32 v254, 0
v_mfma_f32_16x16x32_bf16 v[36:39], a[128:131], a[116:119], v[36:39]
ds_read_b128 a[88:91], v4 offset:57344
ds_read_b128 a[152:155], v4 offset:58368
v_mfma_f32_16x16x32_bf16 v[44:47], a[128:131], a[112:115], v[44:47]
v_mov_b32 v255, 0
v_lshlrev_b32 v16, 2, v3
v_mfma_f32_16x16x32_bf16 v[52:55], a[68:71], a[112:115], v[52:55]
ds_read_b128 a[92:95], v4 offset:59392
ds_read_b128 a[156:159], v4 offset:60416
v_mfma_f32_16x16x32_bf16 v[60:63], a[68:71], a[116:119], v[60:63]
v_sub_u32 v16, v2, v16
v_cmp_gt_i32 s[84:85], 0, v16
v_mfma_f32_16x16x32_bf16 v[68:71], a[68:71], a[120:123], v[68:71]
v_cmp_gt_i32 s[86:87], 1, v16
v_cmp_gt_i32 s[88:89], 2, v16
v_mfma_f32_16x16x32_bf16 v[76:79], a[68:71], a[124:127], v[76:79]
v_cmp_gt_i32 s[90:91], 3, v16
v_add_u32 v17, 48, v2
v_mfma_f32_16x16x32_bf16 v[84:87], a[132:135], a[124:127], v[84:87]
v_lshlrev_b32 v17, 2, v17
v_lshlrev_b32 v18, 16, v3
v_mfma_f32_16x16x32_bf16 v[92:95], a[132:135], a[120:123], v[92:95]
v_lshl_add_u32 v18, v2, 4, v18
v_add_u32 v19, 0x8000, v18
v_mfma_f32_16x16x32_bf16 v[100:103], a[132:135], a[116:119], v[100:103]
v_mov_b32 v20, 2147418112
v_cmp_eq_u32 s[96:97], 3, v3
v_mfma_f32_16x16x32_bf16 v[108:111], a[132:135], a[112:115], v[108:111]
v_mfma_f32_16x16x32_bf16 v[116:119], a[72:75], a[112:115], v[116:119]
v_cndmask_b32 v19, v19, v20, s[96:97]
v_mfma_f32_16x16x32_bf16 v[124:127], a[72:75], a[116:119], v[124:127]
v_mfma_f32_16x16x32_bf16 v[132:135], a[72:75], a[120:123], v[132:135]
v_mfma_f32_16x16x32_bf16 v[140:143], a[72:75], a[124:127], v[140:143]
v_mfma_f32_16x16x32_bf16 v[148:151], a[136:139], a[124:127], v[148:151]
s_waitcnt vmcnt(0)
v_mfma_f32_16x16x32_bf16 v[156:159], a[136:139], a[120:123], v[156:159]
v_cmp_gt_u32 vcc, 8, v30
v_mfma_f32_16x16x32_bf16 v[32:35], a[136:139], a[116:119], v[32:35]
v_mfma_f32_16x16x32_bf16 v[40:43], a[136:139], a[112:115], v[40:43]
v_mfma_f32_16x16x32_bf16 v[48:51], a[76:79], a[112:115], v[48:51]
v_add_u32 v9, 32768, v9
v_add_u32 v10, 32768, v10
v_mfma_f32_16x16x32_bf16 v[56:59], a[76:79], a[116:119], v[56:59]
v_mfma_f32_16x16x32_bf16 v[64:67], a[76:79], a[120:123], v[64:67]
s_cbranch_vccnz CK_KV
CK_KV_R:
v_mfma_f32_16x16x32_bf16 v[72:75], a[76:79], a[124:127], v[72:75]
v_mfma_f32_16x16x32_bf16 v[80:83], a[140:143], a[124:127], v[80:83]
v_mfma_f32_16x16x32_bf16 v[88:91], a[140:143], a[120:123], v[88:91]
v_mfma_f32_16x16x32_bf16 v[96:99], a[140:143], a[116:119], v[96:99]
v_mfma_f32_16x16x32_bf16 v[104:107], a[140:143], a[112:115], v[104:107]
s_waitcnt lgkmcnt(0)
v_mfma_f32_16x16x32_bf16 v[112:115], a[160:163], a[96:99], v[112:115]
s_waitcnt vmcnt(4)
v_mov_b32 v6, 0xf149f2ca
v_mfma_f32_16x16x32_bf16 v[120:123], a[160:163], a[100:103], v[120:123]
s_barrier
v_mfma_f32_16x16x32_bf16 v[128:131], a[160:163], a[104:107], v[128:131]
ds_read_b128 a[112:115], v9 offset:0
ds_read_b128 a[116:119], v9 offset:2048
v_mfma_f32_16x16x32_bf16 v[136:139], a[160:163], a[108:111], v[136:139]
s_lshl_b32 s76, s3, 12
s_mul_i32 s77, s4, 1064960
s_add_u32 s77, s77, s76
v_mfma_f32_16x16x32_bf16 v[144:147], a[164:167], a[108:111], v[144:147]
s_add_u32 m0, s76, 32768
s_add_u32 s52, s77, 0
v_mfma_f32_16x16x32_bf16 v[152:155], a[164:167], a[104:107], v[152:155]
buffer_load_dwordx4 v4, s[24:27], s52 offen offset:0 sc1 lds
v_mfma_f32_16x16x32_bf16 v[160:163], a[164:167], a[100:103], v[160:163]
ds_read_b128 a[120:123], v9 offset:4096
ds_read_b128 a[124:127], v9 offset:6144
v_mfma_f32_16x16x32_bf16 v[164:167], a[164:167], a[96:99], v[164:167]
s_cmp_eq_u32 s54, 0
s_cbranch_scc1 D0
D0_R:
v_mfma_f32_16x16x32_bf16 v[168:171], a[168:171], a[96:99], v[168:171]
s_lshl_b32 s49, s4, 18
ds_read_b64_tr_b16 a[176:177], v11 offset:0
ds_read_b64_tr_b16 a[178:179], v11 offset:512
v_mfma_f32_16x16x32_bf16 v[172:175], a[168:171], a[100:103], v[172:175]
s_add_u32 s49, s49, 45088768
s_lshl_b32 s50, s54, 9
s_add_u32 s50, s50, s49
v_mfma_f32_16x16x32_bf16 v[176:179], a[168:171], a[104:107], v[176:179]
s_lshl_b32 s51, s55, 9
ds_read_b64_tr_b16 a[180:181], v12 offset:0
ds_read_b64_tr_b16 a[182:183], v12 offset:512
v_mfma_f32_16x16x32_bf16 v[180:183], a[168:171], a[108:111], v[180:183]
s_add_u32 s51, s51, s49
v_mfma_f32_16x16x32_bf16 v[184:187], a[172:175], a[108:111], v[184:187]
ds_read_b64_tr_b16 a[184:185], v13 offset:0
ds_read_b64_tr_b16 a[186:187], v13 offset:512
v_mfma_f32_16x16x32_bf16 v[188:191], a[172:175], a[104:107], v[188:191]
v_mfma_f32_16x16x32_bf16 v[192:195], a[172:175], a[100:103], v[192:195]
buffer_load_dwordx4 v4, s[24:27], s52 offen offset:1024 sc1 lds
v_mfma_f32_16x16x32_bf16 v[196:199], a[172:175], a[96:99], v[196:199]
ds_read_b64_tr_b16 a[188:189], v14 offset:0
ds_read_b64_tr_b16 a[190:191], v14 offset:512
v_mfma_f32_16x16x32_bf16 v[200:203], a[80:83], a[96:99], v[200:203]
v_mfma_f32_16x16x32_bf16 v[204:207], a[80:83], a[100:103], v[204:207]
ds_read_b64_tr_b16 a[64:65], v11 offset:4096
ds_read_b64_tr_b16 a[66:67], v11 offset:4608
v_mfma_f32_16x16x32_bf16 v[208:211], a[80:83], a[104:107], v[208:211]
v_mfma_f32_16x16x32_bf16 v[212:215], a[80:83], a[108:111], v[212:215]
ds_read_b64_tr_b16 a[128:129], v12 offset:4096
ds_read_b64_tr_b16 a[130:131], v12 offset:4608
v_mfma_f32_16x16x32_bf16 v[216:219], a[144:147], a[108:111], v[216:219]
v_mfma_f32_16x16x32_bf16 v[220:223], a[144:147], a[104:107], v[220:223]
ds_read_b64_tr_b16 a[68:69], v13 offset:4096
ds_read_b64_tr_b16 a[70:71], v13 offset:4608
v_mfma_f32_16x16x32_bf16 v[36:39], a[144:147], a[100:103], v[36:39]
v_mfma_f32_16x16x32_bf16 v[44:47], a[144:147], a[96:99], v[44:47]
ds_read_b64_tr_b16 a[132:133], v14 offset:4096
ds_read_b64_tr_b16 a[134:135], v14 offset:4608
v_mfma_f32_16x16x32_bf16 v[52:55], a[84:87], a[96:99], v[52:55]
v_mfma_f32_16x16x32_bf16 v[60:63], a[84:87], a[100:103], v[60:63]
buffer_load_dwordx4 v4, s[24:27], s52 offen offset:2048 sc1 lds
v_mfma_f32_16x16x32_bf16 v[68:71], a[84:87], a[104:107], v[68:71]
ds_read_b128 a[72:75], v4 offset:8192
ds_read_b128 a[136:139], v4 offset:9216
v_mfma_f32_16x16x32_bf16 v[76:79], a[84:87], a[108:111], v[76:79]
v_mfma_f32_16x16x32_bf16 v[84:87], a[148:151], a[108:111], v[84:87]
ds_read_b128 a[76:79], v4 offset:10240
ds_read_b128 a[140:143], v4 offset:11264
v_mfma_f32_16x16x32_bf16 v[92:95], a[148:151], a[104:107], v[92:95]
v_mfma_f32_16x16x32_bf16 v[100:103], a[148:151], a[100:103], v[100:103]
v_mfma_f32_16x16x32_bf16 v[108:111], a[148:151], a[96:99], v[108:111]
v_mfma_f32_16x16x32_bf16 v[116:119], a[88:91], a[96:99], v[116:119]
v_mfma_f32_16x16x32_bf16 v[124:127], a[88:91], a[100:103], v[124:127]
v_mfma_f32_16x16x32_bf16 v[132:135], a[88:91], a[104:107], v[132:135]
v_mfma_f32_16x16x32_bf16 v[140:143], a[88:91], a[108:111], v[140:143]
buffer_load_dwordx4 v4, s[24:27], s52 offen offset:3072 sc1 lds
v_mfma_f32_16x16x32_bf16 v[148:151], a[152:155], a[108:111], v[148:151]
v_mfma_f32_16x16x32_bf16 v[156:159], a[152:155], a[104:107], v[156:159]
v_mfma_f32_16x16x32_bf16 v[32:35], a[152:155], a[100:103], v[32:35]
v_mfma_f32_16x16x32_bf16 v[40:43], a[152:155], a[96:99], v[40:43]
v_mfma_f32_16x16x32_bf16 v[48:51], a[92:95], a[96:99], v[48:51]
v_mfma_f32_16x16x32_bf16 v[56:59], a[92:95], a[100:103], v[56:59]
v_mfma_f32_16x16x32_bf16 v[64:67], a[92:95], a[104:107], v[64:67]
v_mfma_f32_16x16x32_bf16 v[72:75], a[92:95], a[108:111], v[72:75]
v_mfma_f32_16x16x32_bf16 v[80:83], a[156:159], a[108:111], v[80:83]
v_mfma_f32_16x16x32_bf16 v[88:91], a[156:159], a[104:107], v[88:91]
v_mfma_f32_16x16x32_bf16 v[96:99], a[156:159], a[100:103], v[96:99]
v_mfma_f32_16x16x32_bf16 v[104:107], a[156:159], a[96:99], v[104:107]
s_waitcnt lgkmcnt(0)
v_mfma_f32_16x16x32_bf16 v[112:115], a[176:179], a[112:115], v[112:115]
s_waitcnt vmcnt(5)
v_mfma_f32_16x16x32_bf16 v[164:167], a[180:183], a[112:115], v[164:167]
s_barrier
v_mfma_f32_16x16x32_bf16 v[168:171], a[184:187], a[112:115], v[168:171]
ds_read_b128 a[96:99], v10 offset:0
ds_read_b128 a[100:103], v10 offset:2048
v_mfma_f32_16x16x32_bf16 v[196:199], a[188:191], a[112:115], v[196:199]
ds_read_b128 a[104:107], v10 offset:4096
ds_read_b128 a[108:111], v10 offset:6144
v_mfma_f32_16x16x32_bf16 v[200:203], a[64:67], a[112:115], v[200:203]
ds_read_b64_tr_b16 a[160:161], v11 offset:16384
ds_read_b64_tr_b16 a[162:163], v11 offset:16896
v_mfma_f32_16x16x32_bf16 v[44:47], a[128:131], a[112:115], v[44:47]
ds_read_b64_tr_b16 a[164:165], v12 offset:16384
ds_read_b64_tr_b16 a[166:167], v12 offset:16896
v_mfma_f32_16x16x32_bf16 v[52:55], a[68:71], a[112:115], v[52:55]
ds_read_b64_tr_b16 a[168:169], v13 offset:16384
ds_read_b64_tr_b16 a[170:171], v13 offset:16896
v_mfma_f32_16x16x32_bf16 v[108:111], a[132:135], a[112:115], v[108:111]
ds_read_b64_tr_b16 a[172:173], v14 offset:16384
ds_read_b64_tr_b16 a[174:175], v14 offset:16896
v_mfma_f32_16x16x32_bf16 v[120:123], a[176:179], a[116:119], v[120:123]
ds_read_b64_tr_b16 a[80:81], v11 offset:20480
ds_read_b64_tr_b16 a[82:83], v11 offset:20992
v_mfma_f32_16x16x32_bf16 v[160:163], a[180:183], a[116:119], v[160:163]
ds_read_b64_tr_b16 a[144:145], v12 offset:20480
ds_read_b64_tr_b16 a[146:147], v12 offset:20992
v_mfma_f32_16x16x32_bf16 v[172:175], a[184:187], a[116:119], v[172:175]
ds_read_b64_tr_b16 a[84:85], v13 offset:20480
ds_read_b64_tr_b16 a[86:87], v13 offset:20992
v_mfma_f32_16x16x32_bf16 v[192:195], a[188:191], a[116:119], v[192:195]
ds_read_b64_tr_b16 a[148:149], v14 offset:20480
ds_read_b64_tr_b16 a[150:151], v14 offset:20992
v_mfma_f32_16x16x32_bf16 v[204:207], a[64:67], a[116:119], v[204:207]
ds_read_b128 a[88:91], v4 offset:24576
ds_read_b128 a[152:155], v4 offset:25600
v_mfma_f32_16x16x32_bf16 v[36:39], a[128:131], a[116:119], v[36:39]
ds_read_b128 a[92:95], v4 offset:26624
ds_read_b128 a[156:159], v4 offset:27648
v_mfma_f32_16x16x32_bf16 v[60:63], a[68:71], a[116:119], v[60:63]
v_mfma_f32_16x16x32_bf16 v[100:103], a[132:135], a[116:119], v[100:103]
s_add_u32 m0, s76, 49152
s_add_u32 s52, s77, 16384
v_mfma_f32_16x16x32_bf16 v[128:131], a[176:179], a[120:123], v[128:131]
buffer_load_dwordx4 v4, s[24:27], s52 offen offset:0 sc1 lds
v_mfma_f32_16x16x32_bf16 v[152:155], a[180:183], a[120:123], v[152:155]
v_mfma_f32_16x16x32_bf16 v[176:179], a[184:187], a[120:123], v[176:179]
v_mfma_f32_16x16x32_bf16 v[188:191], a[188:191], a[120:123], v[188:191]
v_mfma_f32_16x16x32_bf16 v[208:211], a[64:67], a[120:123], v[208:211]
v_mfma_f32_16x16x32_bf16 v[220:223], a[128:131], a[120:123], v[220:223]
v_mfma_f32_16x16x32_bf16 v[68:71], a[68:71], a[120:123], v[68:71]
v_mfma_f32_16x16x32_bf16 v[92:95], a[132:135], a[120:123], v[92:95]
s_waitcnt lgkmcnt(0)
v_mfma_f32_16x16x32_bf16 v[112:115], a[160:163], a[96:99], v[112:115]
buffer_load_dwordx4 v4, s[24:27], s52 offen offset:1024 sc1 lds
v_mfma_f32_16x16x32_bf16 v[164:167], a[164:167], a[96:99], v[164:167]
v_mfma_f32_16x16x32_bf16 v[168:171], a[168:171], a[96:99], v[168:171]
v_mfma_f32_16x16x32_bf16 v[196:199], a[172:175], a[96:99], v[196:199]
v_mfma_f32_16x16x32_bf16 v[200:203], a[80:83], a[96:99], v[200:203]
v_mfma_f32_16x16x32_bf16 v[44:47], a[144:147], a[96:99], v[44:47]
v_mfma_f32_16x16x32_bf16 v[52:55], a[84:87], a[96:99], v[52:55]
v_mfma_f32_16x16x32_bf16 v[108:111], a[148:151], a[96:99], v[108:111]
buffer_load_dwordx4 v4, s[24:27], s52 offen offset:2048 sc1 lds
v_mfma_f32_16x16x32_bf16 v[120:123], a[160:163], a[100:103], v[120:123]
v_cvt_pk_bf16_f32 v112, v112, v113
v_cvt_pk_bf16_f32 v113, v114, v115
v_mfma_f32_16x16x32_bf16 v[160:163], a[164:167], a[100:103], v[160:163]
v_cvt_pk_bf16_f32 v114, v164, v165
v_cvt_pk_bf16_f32 v115, v166, v167
v_mfma_f32_16x16x32_bf16 v[172:175], a[168:171], a[100:103], v[172:175]
v_cvt_pk_bf16_f32 v168, v168, v169
v_cvt_pk_bf16_f32 v169, v170, v171
v_mfma_f32_16x16x32_bf16 v[192:195], a[172:175], a[100:103], v[192:195]
v_cvt_pk_bf16_f32 v170, v196, v197
v_cvt_pk_bf16_f32 v171, v198, v199
v_mfma_f32_16x16x32_bf16 v[204:207], a[80:83], a[100:103], v[204:207]
v_cvt_pk_bf16_f32 v200, v200, v201
v_cvt_pk_bf16_f32 v201, v202, v203
v_mfma_f32_16x16x32_bf16 v[36:39], a[144:147], a[100:103], v[36:39]
v_cvt_pk_bf16_f32 v202, v44, v45
v_cvt_pk_bf16_f32 v203, v46, v47
v_mfma_f32_16x16x32_bf16 v[60:63], a[84:87], a[100:103], v[60:63]
buffer_load_dwordx4 v4, s[24:27], s52 offen offset:3072 sc1 lds
v_mfma_f32_16x16x32_bf16 v[100:103], a[148:151], a[100:103], v[100:103]
v_cvt_pk_bf16_f32 v52, v52, v53
v_cvt_pk_bf16_f32 v53, v54, v55
v_mfma_f32_16x16x32_bf16 v[128:131], a[160:163], a[104:107], v[128:131]
v_cvt_pk_bf16_f32 v54, v108, v109
v_cvt_pk_bf16_f32 v55, v110, v111
v_mfma_f32_16x16x32_bf16 v[152:155], a[164:167], a[104:107], v[152:155]
v_cvt_pk_bf16_f32 v120, v120, v121
v_cvt_pk_bf16_f32 v121, v122, v123
v_mfma_f32_16x16x32_bf16 v[176:179], a[168:171], a[104:107], v[176:179]
v_cvt_pk_bf16_f32 v122, v160, v161
v_cvt_pk_bf16_f32 v123, v162, v163
v_mfma_f32_16x16x32_bf16 v[188:191], a[172:175], a[104:107], v[188:191]
v_cvt_pk_bf16_f32 v172, v172, v173
v_cvt_pk_bf16_f32 v173, v174, v175
v_mfma_f32_16x16x32_bf16 v[208:211], a[80:83], a[104:107], v[208:211]
v_cvt_pk_bf16_f32 v174, v192, v193
v_cvt_pk_bf16_f32 v175, v194, v195
v_mfma_f32_16x16x32_bf16 v[220:223], a[144:147], a[104:107], v[220:223]
v_cvt_pk_bf16_f32 v204, v204, v205
v_cvt_pk_bf16_f32 v205, v206, v207
v_mfma_f32_16x16x32_bf16 v[68:71], a[84:87], a[104:107], v[68:71]
v_cvt_pk_bf16_f32 v206, v36, v37
v_cvt_pk_bf16_f32 v207, v38, v39
v_mfma_f32_16x16x32_bf16 v[92:95], a[148:151], a[104:107], v[92:95]
v_cvt_pk_bf16_f32 v60, v60, v61
v_cvt_pk_bf16_f32 v61, v62, v63
v_mfma_f32_16x16x32_bf16 v[136:139], a[176:179], a[124:127], v[136:139]
s_waitcnt vmcnt(4)
v_cvt_pk_bf16_f32 v62, v100, v101
v_cvt_pk_bf16_f32 v63, v102, v103
v_mfma_f32_16x16x32_bf16 v[136:139], a[160:163], a[108:111], v[136:139]
s_barrier
v_mfma_f32_16x16x32_bf16 v[144:147], a[180:183], a[124:127], v[144:147]
v_cvt_pk_bf16_f32 v128, v128, v129
v_cvt_pk_bf16_f32 v129, v130, v131
v_mfma_f32_16x16x32_bf16 v[144:147], a[164:167], a[108:111], v[144:147]
s_add_u32 m0, s76, 65536
s_add_u32 s52, s77, 32768
v_cvt_pk_bf16_f32 v130, v152, v153
v_mfma_f32_16x16x32_bf16 v[180:183], a[184:187], a[124:127], v[180:183]
buffer_load_dwordx4 v4, s[24:27], s52 offen offset:0 sc1 lds
v_mfma_f32_16x16x32_bf16 v[180:183], a[168:171], a[108:111], v[180:183]
v_cvt_pk_bf16_f32 v131, v154, v155
v_cvt_pk_bf16_f32 v176, v176, v177
v_mfma_f32_16x16x32_bf16 v[184:187], a[188:191], a[124:127], v[184:187]
v_cvt_pk_bf16_f32 v177, v178, v179
v_cvt_pk_bf16_f32 v178, v188, v189
v_mfma_f32_16x16x32_bf16 v[184:187], a[172:175], a[108:111], v[184:187]
v_cvt_pk_bf16_f32 v179, v190, v191
v_cvt_pk_bf16_f32 v208, v208, v209
v_mfma_f32_16x16x32_bf16 v[212:215], a[64:67], a[124:127], v[212:215]
v_cvt_pk_bf16_f32 v209, v210, v211
v_cvt_pk_bf16_f32 v210, v220, v221
v_mfma_f32_16x16x32_bf16 v[212:215], a[80:83], a[108:111], v[212:215]
v_cvt_pk_bf16_f32 v211, v222, v223
v_cvt_pk_bf16_f32 v68, v68, v69
v_mfma_f32_16x16x32_bf16 v[216:219], a[128:131], a[124:127], v[216:219]
v_cvt_pk_bf16_f32 v69, v70, v71
v_cvt_pk_bf16_f32 v70, v92, v93
v_mfma_f32_16x16x32_bf16 v[216:219], a[144:147], a[108:111], v[216:219]
v_cvt_pk_bf16_f32 v71, v94, v95
v_cvt_pk_bf16_f32 v136, v136, v137
v_mfma_f32_16x16x32_bf16 v[76:79], a[68:71], a[124:127], v[76:79]
v_cvt_pk_bf16_f32 v137, v138, v139
v_cvt_pk_bf16_f32 v138, v144, v145
v_mfma_f32_16x16x32_bf16 v[76:79], a[84:87], a[108:111], v[76:79]
ds_read_b128 a[192:195], v4 offset:32768
v_cvt_pk_bf16_f32 v139, v146, v147
v_mfma_f32_16x16x32_bf16 v[84:87], a[132:135], a[124:127], v[84:87]
buffer_load_dwordx4 v4, s[24:27], s52 offen offset:1024 sc1 lds
v_mfma_f32_16x16x32_bf16 v[84:87], a[148:151], a[108:111], v[84:87]
v_cvt_pk_bf16_f32 v180, v180, v181
v_cvt_pk_bf16_f32 v181, v182, v183
v_mfma_f32_16x16x32_bf16 v[116:119], a[72:75], a[112:115], v[116:119]
v_cvt_pk_bf16_f32 v182, v184, v185
v_cvt_pk_bf16_f32 v183, v186, v187
v_mfma_f32_16x16x32_bf16 v[116:119], a[88:91], a[96:99], v[116:119]
ds_read_b128 a[196:199], v4 offset:33792
ds_read_b128 a[200:203], v4 offset:34816
v_mfma_f32_16x16x32_bf16 v[40:43], a[136:139], a[112:115], v[40:43]
v_cvt_pk_bf16_f32 v212, v212, v213
v_cvt_pk_bf16_f32 v213, v214, v215
v_mfma_f32_16x16x32_bf16 v[40:43], a[152:155], a[96:99], v[40:43]
v_cvt_pk_bf16_f32 v214, v216, v217
v_cvt_pk_bf16_f32 v215, v218, v219
v_mfma_f32_16x16x32_bf16 v[48:51], a[76:79], a[112:115], v[48:51]
ds_read_b128 a[204:207], v4 offset:35840
ds_read_b128 a[208:211], v4 offset:36864
v_mfma_f32_16x16x32_bf16 v[48:51], a[92:95], a[96:99], v[48:51]
ds_read_b128 a[212:215], v4 offset:37888
ds_read_b128 a[216:219], v4 offset:38912
v_mfma_f32_16x16x32_bf16 v[104:107], a[140:143], a[112:115], v[104:107]
v_cvt_pk_bf16_f32 v76, v76, v77
v_cvt_pk_bf16_f32 v77, v78, v79
v_mfma_f32_16x16x32_bf16 v[104:107], a[156:159], a[96:99], v[104:107]
v_cvt_pk_bf16_f32 v78, v84, v85
v_cvt_pk_bf16_f32 v79, v86, v87
v_mfma_f32_16x16x32_bf16 v[124:127], a[72:75], a[116:119], v[124:127]
ds_read_b128 a[220:223], v4 offset:39936
v_mfma_f32_16x16x32_bf16 v[124:127], a[88:91], a[100:103], v[124:127]
buffer_load_dwordx4 v4, s[24:27], s52 offen offset:2048 sc1 lds
v_mfma_f32_16x16x32_bf16 v[32:35], a[136:139], a[116:119], v[32:35]
v_mfma_f32_16x16x32_bf16 v[32:35], a[152:155], a[100:103], v[32:35]
v_mfma_f32_16x16x32_bf16 v[56:59], a[76:79], a[116:119], v[56:59]
v_mfma_f32_16x16x32_bf16 v[56:59], a[92:95], a[100:103], v[56:59]
v_mfma_f32_16x16x32_bf16 v[96:99], a[140:143], a[116:119], v[96:99]
ds_bpermute_b32 v8, v17, v119
v_cvt_pk_bf16_f32 v116, v116, v117
v_mfma_f32_16x16x32_bf16 v[96:99], a[156:159], a[100:103], v[96:99]
v_cvt_pk_bf16_f32 v117, v118, v119
v_cvt_pk_bf16_f32 v118, v40, v41
v_mfma_f32_16x16x32_bf16 v[132:135], a[72:75], a[120:123], v[132:135]
v_cvt_pk_bf16_f32 v119, v42, v43
v_mfma_f32_16x16x32_bf16 v[132:135], a[88:91], a[104:107], v[132:135]
buffer_store_dwordx4 v[116:119], v18, s[24:27], s50 offen offset:0 sc1
v_mfma_f32_16x16x32_bf16 v[156:159], a[136:139], a[120:123], v[156:159]
v_cvt_pk_bf16_f32 v48, v48, v49
v_cvt_pk_bf16_f32 v49, v50, v51
v_mfma_f32_16x16x32_bf16 v[156:159], a[152:155], a[104:107], v[156:159]
buffer_load_dwordx4 v4, s[24:27], s52 offen offset:3072 sc1 lds
v_mfma_f32_16x16x32_bf16 v[64:67], a[76:79], a[120:123], v[64:67]
v_cvt_pk_bf16_f32 v50, v104, v105
v_cvt_pk_bf16_f32 v51, v106, v107
v_mfma_f32_16x16x32_bf16 v[64:67], a[92:95], a[104:107], v[64:67]
buffer_store_dwordx4 v[48:51], v19, s[24:27], s50 offen offset:0 sc1
v_mfma_f32_16x16x32_bf16 v[88:91], a[140:143], a[120:123], v[88:91]
ds_bpermute_b32 v9, v17, v127
v_cvt_pk_bf16_f32 v124, v124, v125
v_mfma_f32_16x16x32_bf16 v[88:91], a[156:159], a[104:107], v[88:91]
v_cvt_pk_bf16_f32 v125, v126, v127
v_cvt_pk_bf16_f32 v126, v32, v33
v_mfma_f32_16x16x32_bf16 v[140:143], a[72:75], a[124:127], v[140:143]
v_cvt_pk_bf16_f32 v127, v34, v35
v_mfma_f32_16x16x32_bf16 v[140:143], a[88:91], a[108:111], v[140:143]
buffer_store_dwordx4 v[124:127], v18, s[24:27], s50 offen offset:256 sc1
v_mfma_f32_16x16x32_bf16 v[148:151], a[136:139], a[124:127], v[148:151]
v_cvt_pk_bf16_f32 v56, v56, v57
v_cvt_pk_bf16_f32 v57, v58, v59
v_mfma_f32_16x16x32_bf16 v[148:151], a[152:155], a[108:111], v[148:151]
v_cvt_pk_bf16_f32 v58, v96, v97
v_cvt_pk_bf16_f32 v59, v98, v99
v_mfma_f32_16x16x32_bf16 v[72:75], a[76:79], a[124:127], v[72:75]
buffer_store_dwordx4 v[56:59], v19, s[24:27], s50 offen offset:256 sc1
v_mfma_f32_16x16x32_bf16 v[72:75], a[92:95], a[108:111], v[72:75]
v_mfma_f32_16x16x32_bf16 v[80:83], a[140:143], a[124:127], v[80:83]
ds_bpermute_b32 v10, v17, v135
v_cvt_pk_bf16_f32 v132, v132, v133
v_mfma_f32_16x16x32_bf16 v[80:83], a[156:159], a[108:111], v[80:83]
s_waitcnt lgkmcnt(0)
v_cvt_pk_bf16_f32 v133, v134, v135
v_cvt_pk_bf16_f32 v134, v156, v157
v_mfma_f32_16x16x32_bf16 v[164:167], a[192:195], v[112:115], v[224:227]
v_cvt_pk_bf16_f32 v135, v158, v159
v_mfma_f32_16x16x32_bf16 v[164:167], a[196:199], v[168:171], v[164:167]
buffer_store_dwordx4 v[132:135], v18, s[24:27], s51 offen offset:0 sc1
v_mfma_f32_16x16x32_bf16 v[164:167], a[200:203], v[200:203], v[164:167]
v_cvt_pk_bf16_f32 v64, v64, v65
v_cvt_pk_bf16_f32 v65, v66, v67
v_mfma_f32_16x16x32_bf16 v[164:167], a[204:207], v[52:55], v[164:167]
v_cvt_pk_bf16_f32 v66, v88, v89
v_cvt_pk_bf16_f32 v67, v90, v91
v_mfma_f32_16x16x32_bf16 v[196:199], a[192:195], v[120:123], v[228:231]
buffer_store_dwordx4 v[64:67], v19, s[24:27], s51 offen offset:0 sc1
v_mfma_f32_16x16x32_bf16 v[196:199], a[196:199], v[172:175], v[196:199]
v_mfma_f32_16x16x32_bf16 v[196:199], a[200:203], v[204:207], v[196:199]
ds_bpermute_b32 v11, v17, v143
v_cvt_pk_bf16_f32 v140, v140, v141
v_mfma_f32_16x16x32_bf16 v[196:199], a[204:207], v[60:63], v[196:199]
v_cvt_pk_bf16_f32 v141, v142, v143
v_cvt_pk_bf16_f32 v142, v148, v149
v_mfma_f32_16x16x32_bf16 v[44:47], a[208:211], v[112:115], v[232:235]
v_cvt_pk_bf16_f32 v143, v150, v151
v_mfma_f32_16x16x32_bf16 v[44:47], a[212:215], v[168:171], v[44:47]
buffer_store_dwordx4 v[140:143], v18, s[24:27], s51 offen offset:256 sc1
v_mfma_f32_16x16x32_bf16 v[44:47], a[216:219], v[200:203], v[44:47]
v_cvt_pk_bf16_f32 v72, v72, v73
v_cvt_pk_bf16_f32 v73, v74, v75
v_mfma_f32_16x16x32_bf16 v[44:47], a[220:223], v[52:55], v[44:47]
v_cvt_pk_bf16_f32 v74, v80, v81
v_cvt_pk_bf16_f32 v75, v82, v83
v_mfma_f32_16x16x32_bf16 v[108:111], a[208:211], v[120:123], v[236:239]
buffer_store_dwordx4 v[72:75], v19, s[24:27], s51 offen offset:256 sc1
v_mfma_f32_16x16x32_bf16 v[108:111], a[212:215], v[172:175], v[108:111]
v_mfma_f32_16x16x32_bf16 v[108:111], a[216:219], v[204:207], v[108:111]
v_mfma_f32_16x16x32_bf16 v[108:111], a[220:223], v[60:63], v[108:111]
s_waitcnt vmcnt(12)
v_mfma_f32_16x16x32_bf16 v[160:163], a[192:195], v[128:131], v[240:243]
s_barrier
v_mfma_f32_16x16x32_bf16 v[160:163], a[196:199], v[176:179], v[160:163]
v_mfma_f32_16x16x32_bf16 v[160:163], a[200:203], v[208:211], v[160:163]
v_mfma_f32_16x16x32_bf16 v[160:163], a[204:207], v[68:71], v[160:163]
v_mfma_f32_16x16x32_bf16 v[192:195], a[192:195], v[136:139], v[244:247]
v_mfma_f32_16x16x32_bf16 v[192:195], a[196:199], v[180:183], v[192:195]
v_mfma_f32_16x16x32_bf16 v[192:195], a[200:203], v[212:215], v[192:195]
v_mfma_f32_16x16x32_bf16 v[192:195], a[204:207], v[76:79], v[192:195]
v_mfma_f32_16x16x32_bf16 v[36:39], a[208:211], v[128:131], v[248:251]
v_mfma_f32_16x16x32_bf16 v[36:39], a[212:215], v[176:179], v[36:39]
v_mfma_f32_16x16x32_bf16 v[36:39], a[216:219], v[208:211], v[36:39]
v_mfma_f32_16x16x32_bf16 v[36:39], a[220:223], v[68:71], v[36:39]
v_mfma_f32_16x16x32_bf16 v[100:103], a[208:211], v[136:139], v[252:255]
v_mfma_f32_16x16x32_bf16 v[100:103], a[212:215], v[180:183], v[100:103]
v_mfma_f32_16x16x32_bf16 v[100:103], a[216:219], v[212:215], v[100:103]
v_mfma_f32_16x16x32_bf16 v[100:103], a[220:223], v[76:79], v[100:103]
ds_read_b128 a[64:67], v4 offset:57344
ds_read_b128 a[68:71], v4 offset:58368
ds_read_b128 a[72:75], v4 offset:59392
ds_read_b128 a[76:79], v4 offset:60416
ds_read_b128 a[80:83], v4 offset:61440
ds_read_b128 a[84:87], v4 offset:62464
ds_read_b128 a[88:91], v4 offset:63488
ds_read_b128 a[92:95], v4 offset:64512
s_add_u32 m0, s76, 81920
s_add_u32 s52, s77, 49152
buffer_load_dwordx4 v4, s[24:27], s52 offen offset:0 sc1 lds
v_max3_f32 v24, v164, v165, v166
v_max3_f32 v25, v167, v44, v45
v_max3_f32 v26, v196, v197, v198
v_max3_f32 v27, v199, v108, v109
v_max3_f32 v24, v24, v46, v47
buffer_load_dwordx4 v4, s[24:27], s52 offen offset:1024 sc1 lds
v_max_f32 v24, v24, v25
v_max3_f32 v26, v26, v110, v111
v_max_f32 v26, v26, v27
v_mov_b32 v25, v24
v_mov_b32 v27, v26
buffer_load_dwordx4 v4, s[24:27], s52 offen offset:2048 sc1 lds
s_nop 1
v_permlane32_swap_b32 v25, v24
v_permlane32_swap_b32 v27, v26
s_nop 0
v_max_f32 v24, v24, v25
buffer_load_dwordx4 v4, s[24:27], s52 offen offset:3072 sc1 lds
v_max_f32 v26, v26, v27
v_mov_b32 v25, v24
v_mov_b32 v27, v26
s_nop 1
v_permlane16_swap_b32 v25, v24
s_add_u32 m0, s76, 98304
s_add_u32 s52, s77, 65536
buffer_load_dwordx4 v4, s[24:27], s52 offen offset:0 sc1 lds
v_permlane16_swap_b32 v27, v26
s_nop 0
v_max_f32 v24, v24, v25
v_max_f32 v26, v26, v27
v_sub_f32 v164, v164, v24
buffer_load_dwordx4 v4, s[24:27], s52 offen offset:1024 sc1 lds
v_sub_f32 v165, v165, v24
v_sub_f32 v166, v166, v24
v_sub_f32 v167, v167, v24
v_sub_f32 v196, v196, v26
v_sub_f32 v197, v197, v26
buffer_load_dwordx4 v4, s[24:27], s52 offen offset:2048 sc1 lds
v_sub_f32 v198, v198, v26
v_sub_f32 v199, v199, v26
v_sub_f32 v44, v44, v24
v_sub_f32 v45, v45, v24
v_sub_f32 v46, v46, v24
buffer_load_dwordx4 v4, s[24:27], s52 offen offset:3072 sc1 lds
v_sub_f32 v47, v47, v24
v_sub_f32 v108, v108, v26
v_sub_f32 v109, v109, v26
v_sub_f32 v110, v110, v26
v_sub_f32 v111, v111, v26
s_add_u32 m0, s76, 114688
s_add_u32 s52, s77, 81920
buffer_load_dwordx4 v4, s[24:27], s52 offen offset:0 sc1 lds
v_sub_f32 v224, v224, v24
v_sub_f32 v225, v225, v24
v_sub_f32 v226, v226, v24
v_sub_f32 v227, v227, v24
v_sub_f32 v228, v228, v26
buffer_load_dwordx4 v4, s[24:27], s52 offen offset:1024 sc1 lds
v_sub_f32 v229, v229, v26
v_sub_f32 v230, v230, v26
v_sub_f32 v231, v231, v26
v_sub_f32 v232, v232, v24
v_sub_f32 v233, v233, v24
buffer_load_dwordx4 v4, s[24:27], s52 offen offset:2048 sc1 lds
v_sub_f32 v234, v234, v24
v_sub_f32 v235, v235, v24
v_sub_f32 v236, v236, v26
v_sub_f32 v237, v237, v26
v_sub_f32 v238, v238, v26
buffer_load_dwordx4 v4, s[24:27], s52 offen offset:3072 sc1 lds
v_sub_f32 v239, v239, v26
v_exp_f32 v164, v164
v_exp_f32 v165, v165
v_exp_f32 v166, v166
v_exp_f32 v167, v167
s_add_u32 m0, s76, 0
s_add_u32 s52, s77, 98304
buffer_load_dwordx4 v4, s[24:27], s52 offen offset:0 sc1 lds
v_cvt_pk_bf16_f32 v152, v164, v165
v_exp_f32 v196, v196
v_exp_f32 v197, v197
v_cvt_pk_bf16_f32 v153, v166, v167
v_exp_f32 v198, v198
buffer_load_dwordx4 v4, s[24:27], s52 offen offset:1024 sc1 lds
v_exp_f32 v199, v199
v_cvt_pk_bf16_f32 v188, v196, v197
v_exp_f32 v44, v44
v_exp_f32 v45, v45
v_cvt_pk_bf16_f32 v189, v198, v199
buffer_load_dwordx4 v4, s[24:27], s52 offen offset:2048 sc1 lds
v_exp_f32 v46, v46
v_exp_f32 v47, v47
v_cvt_pk_bf16_f32 v154, v44, v45
v_exp_f32 v108, v108
v_exp_f32 v109, v109
buffer_load_dwordx4 v4, s[24:27], s52 offen offset:3072 sc1 lds
v_cvt_pk_bf16_f32 v155, v46, v47
v_exp_f32 v110, v110
v_exp_f32 v111, v111
v_cvt_pk_bf16_f32 v190, v108, v109
v_max3_f32 v24, v160, v161, v162
s_add_u32 m0, s76, 16384
s_add_u32 s52, s77, 114688
buffer_load_dwordx4 v4, s[24:27], s52 offen offset:0 sc1 lds
v_cvt_pk_bf16_f32 v191, v110, v111
v_max3_f32 v25, v163, v36, v37
v_max3_f32 v26, v192, v193, v194
v_max3_f32 v27, v195, v100, v101
v_max3_f32 v24, v24, v38, v39
buffer_load_dwordx4 v4, s[24:27], s52 offen offset:1024 sc1 lds
v_max_f32 v24, v24, v25
v_max3_f32 v26, v26, v102, v103
v_max_f32 v26, v26, v27
v_mov_b32 v25, v24
v_mov_b32 v27, v26
buffer_load_dwordx4 v4, s[24:27], s52 offen offset:2048 sc1 lds
s_nop 1
v_permlane32_swap_b32 v25, v24
v_permlane32_swap_b32 v27, v26
s_nop 0
v_max_f32 v24, v24, v25
buffer_load_dwordx4 v4, s[24:27], s52 offen offset:3072 sc1 lds
v_max_f32 v26, v26, v27
v_mov_b32 v25, v24
v_mov_b32 v27, v26
s_nop 1
v_permlane16_swap_b32 v25, v24
v_permlane16_swap_b32 v27, v26
s_nop 0
v_max_f32 v24, v24, v25
v_max_f32 v26, v26, v27
v_sub_f32 v160, v160, v24
v_sub_f32 v161, v161, v24
v_sub_f32 v162, v162, v24
v_sub_f32 v163, v163, v24
v_sub_f32 v192, v192, v26
v_sub_f32 v193, v193, v26
v_sub_f32 v194, v194, v26
v_sub_f32 v195, v195, v26
v_sub_f32 v36, v36, v24
v_sub_f32 v37, v37, v24
v_sub_f32 v38, v38, v24
v_sub_f32 v39, v39, v24
v_sub_f32 v100, v100, v26
v_sub_f32 v101, v101, v26
v_sub_f32 v102, v102, v26
v_sub_f32 v103, v103, v26
v_sub_f32 v240, v240, v24
v_sub_f32 v241, v241, v24
v_sub_f32 v242, v242, v24
v_sub_f32 v243, v243, v24
v_sub_f32 v244, v244, v26
v_sub_f32 v245, v245, v26
v_sub_f32 v246, v246, v26
v_sub_f32 v247, v247, v26
v_sub_f32 v248, v248, v24
v_sub_f32 v249, v249, v24
v_sub_f32 v250, v250, v24
v_sub_f32 v251, v251, v24
v_sub_f32 v252, v252, v26
v_sub_f32 v253, v253, v26
v_sub_f32 v254, v254, v26
v_sub_f32 v255, v255, v26
v_mov_b32 v116, 0
v_mov_b32 v117, 0
v_mov_b32 v118, 0
v_mov_b32 v119, 0
v_mov_b32 v40, 0
v_mov_b32 v41, 0
v_mov_b32 v42, 0
v_mov_b32 v43, 0
v_mov_b32 v48, 0
v_mov_b32 v49, 0
v_mov_b32 v50, 0
v_mov_b32 v51, 0
v_mov_b32 v104, 0
v_mov_b32 v105, 0
v_mov_b32 v106, 0
v_mov_b32 v107, 0
v_mov_b32 v124, 0
v_mov_b32 v125, 0
v_mov_b32 v126, 0
v_mov_b32 v127, 0
v_mov_b32 v32, 0
v_mov_b32 v33, 0
v_mov_b32 v34, 0
v_mov_b32 v35, 0
v_mov_b32 v56, 0
v_mov_b32 v57, 0
v_mov_b32 v58, 0
v_mov_b32 v59, 0
v_mov_b32 v96, 0
v_mov_b32 v97, 0
v_mov_b32 v98, 0
v_mov_b32 v99, 0
v_mov_b32 v132, 0
v_mov_b32 v133, 0
v_mov_b32 v134, 0
v_mov_b32 v135, 0
v_mov_b32 v156, 0
v_mov_b32 v157, 0
v_mov_b32 v158, 0
v_mov_b32 v159, 0
v_mov_b32 v64, 0
v_mov_b32 v65, 0
v_mov_b32 v66, 0
v_mov_b32 v67, 0
v_mov_b32 v88, 0
v_mov_b32 v89, 0
v_mov_b32 v90, 0
v_mov_b32 v91, 0
v_mov_b32 v140, 0
v_mov_b32 v141, 0
v_mov_b32 v142, 0
v_mov_b32 v143, 0
v_mov_b32 v148, 0
v_mov_b32 v149, 0
v_mov_b32 v150, 0
v_mov_b32 v151, 0
v_mov_b32 v72, 0
v_mov_b32 v73, 0
v_mov_b32 v74, 0
v_mov_b32 v75, 0
v_mov_b32 v80, 0
v_mov_b32 v81, 0
v_mov_b32 v82, 0
v_mov_b32 v83, 0
ds_read_b128 a[192:195], v4 offset:49152
ds_read_b128 a[196:199], v4 offset:50176
ds_read_b128 a[200:203], v4 offset:51200
ds_read_b128 a[204:207], v4 offset:52224
ds_read_b128 a[208:211], v4 offset:53248
ds_read_b128 a[212:215], v4 offset:54272
ds_read_b128 a[216:219], v4 offset:55296
ds_read_b128 a[220:223], v4 offset:56320
s_waitcnt lgkmcnt(8)
v_mfma_f32_16x16x32_bf16 a[0:3], a[64:67], v[152:155], 0
s_add_u32 s56, s77, 131072
v_exp_f32 v160, v160
v_mfma_f32_16x16x32_bf16 a[32:35], a[64:67], v[188:191], 0
s_add_u32 s57, s76, 32768
v_exp_f32 v161, v161
v_mfma_f32_16x16x32_bf16 a[4:7], a[68:71], v[152:155], 0
s_lshl_b32 s48, s5, 16
v_exp_f32 v162, v162
v_mfma_f32_16x16x32_bf16 a[36:39], a[68:71], v[188:191], 0
s_sub_u32 s48, 1048576, s48
v_exp_f32 v163, v163
v_mfma_f32_16x16x32_bf16 a[8:11], a[72:75], v[152:155], 0
s_add_u32 s58, s77, s48
v_cvt_pk_bf16_f32 v220, v160, v161
v_cvt_pk_bf16_f32 v221, v162, v163
v_mfma_f32_16x16x32_bf16 a[40:43], a[72:75], v[188:191], 0
s_mov_b32 s62, 49152
v_exp_f32 v192, v192
v_mfma_f32_16x16x32_bf16 a[12:15], a[76:79], v[152:155], 0
s_mov_b32 s59, 1
v_exp_f32 v193, v193
v_mfma_f32_16x16x32_bf16 a[44:47], a[76:79], v[188:191], 0
s_mov_b32 s61, s54
v_exp_f32 v194, v194
v_mfma_f32_16x16x32_bf16 a[16:19], a[80:83], v[152:155], 0
s_mov_b32 s63, 0
v_exp_f32 v195, v195
v_mfma_f32_16x16x32_bf16 a[48:51], a[80:83], v[188:191], 0
v_cvt_pk_bf16_f32 v92, v192, v193
v_cvt_pk_bf16_f32 v93, v194, v195
v_mfma_f32_16x16x32_bf16 a[20:23], a[84:87], v[152:155], 0
v_exp_f32 v36, v36
v_mfma_f32_16x16x32_bf16 a[52:55], a[84:87], v[188:191], 0
v_exp_f32 v37, v37
v_mfma_f32_16x16x32_bf16 a[24:27], a[88:91], v[152:155], 0
v_exp_f32 v38, v38
v_mfma_f32_16x16x32_bf16 a[56:59], a[88:91], v[188:191], 0
v_exp_f32 v39, v39
v_mfma_f32_16x16x32_bf16 a[28:31], a[92:95], v[152:155], 0
v_cvt_pk_bf16_f32 v222, v36, v37
v_cvt_pk_bf16_f32 v223, v38, v39
v_mfma_f32_16x16x32_bf16 a[60:63], a[92:95], v[188:191], 0
v_exp_f32 v100, v100
v_mfma_f32_16x16x32_bf16 a[224:227], a[240:243], v[152:155], 0
s_waitcnt vmcnt(20) lgkmcnt(0)
v_add_u32 v5, 49152, v4
v_mfma_f32_16x16x32_bf16 a[228:231], a[240:243], v[188:191], 0
s_barrier
buffer_atomic_add v15, v0, s[24:27], s79 offen offset:8 sc1
s_cmp_eq_u32 s54, 0
s_cbranch_scc1 L_TRANS
s_cmp_eq_u32 s54, 1
s_cbranch_scc1 L_DX
L_DUAL:
v_mfma_f32_16x16x32_bf16 v[164:167], a[192:195], v[112:115], v[224:227]
s_add_u32 s62, s62, 16384
v_mfma_f32_16x16x32_bf16 v[164:167], a[196:199], v[168:171], v[164:167]
s_and_b32 s62, s62, 131071
v_exp_f32 v101, v101
v_mfma_f32_16x16x32_bf16 v[164:167], a[200:203], v[200:203], v[164:167]
s_cmp_le_u32 s56, s58
v_cvt_pk_bf16_f32 v94, v100, v101
v_mfma_f32_16x16x32_bf16 v[164:167], a[204:207], v[52:55], v[164:167]
s_waitcnt vmcnt(20)
v_exp_f32 v102, v102
v_mfma_f32_16x16x32_bf16 v[196:199], a[192:195], v[120:123], v[228:231]
s_barrier
v_mfma_f32_16x16x32_bf16 v[196:199], a[196:199], v[172:175], v[196:199]
s_cselect_b32 s52, s56, 2147418112
v_exp_f32 v103, v103
v_mfma_f32_16x16x32_bf16 v[196:199], a[200:203], v[204:207], v[196:199]
v_cvt_pk_bf16_f32 v95, v102, v103
v_mfma_f32_16x16x32_bf16 v[196:199], a[204:207], v[60:63], v[196:199]
v_add_u32 v5, s62, v4
v_mfma_f32_16x16x32_bf16 v[44:47], a[208:211], v[112:115], v[232:235]
v_mfma_f32_16x16x32_bf16 v[44:47], a[212:215], v[168:171], v[44:47]
s_mov_b32 m0, s57
v_exp_f32 v164, v164
v_mfma_f32_16x16x32_bf16 v[44:47], a[216:219], v[200:203], v[44:47]
buffer_load_dwordx4 v4, s[24:27], s52 offen offset:0 sc1 lds
v_mfma_f32_16x16x32_bf16 v[44:47], a[220:223], v[52:55], v[44:47]
s_add_u32 s56, s56, 16384
v_exp_f32 v165, v165
v_mfma_f32_16x16x32_bf16 v[108:111], a[208:211], v[120:123], v[236:239]
v_cvt_pk_bf16_f32 v152, v164, v165
v_mfma_f32_16x16x32_bf16 v[108:111], a[212:215], v[172:175], v[108:111]
s_add_u32 s57, s57, 16384
v_exp_f32 v166, v166
v_mfma_f32_16x16x32_bf16 v[108:111], a[216:219], v[204:207], v[108:111]
v_mfma_f32_16x16x32_bf16 v[108:111], a[220:223], v[60:63], v[108:111]
v_exp_f32 v167, v167
v_mfma_f32_16x16x32_bf16 v[116:119], a[64:67], v[220:223], v[116:119]
v_cvt_pk_bf16_f32 v153, v166, v167
v_mfma_f32_16x16x32_bf16 v[132:135], a[64:67], v[92:95], v[132:135]
s_and_b32 s57, s57, 131071
v_exp_f32 v196, v196
v_mfma_f32_16x16x32_bf16 v[40:43], a[68:71], v[220:223], v[40:43]
buffer_load_dwordx4 v4, s[24:27], s52 offen offset:1024 sc1 lds
v_mfma_f32_16x16x32_bf16 v[156:159], a[68:71], v[92:95], v[156:159]
s_add_u32 s59, s59, 1
v_exp_f32 v197, v197
v_mfma_f32_16x16x32_bf16 v[48:51], a[72:75], v[220:223], v[48:51]
v_cvt_pk_bf16_f32 v188, v196, v197
v_mfma_f32_16x16x32_bf16 v[64:67], a[72:75], v[92:95], v[64:67]
v_exp_f32 v198, v198
v_mfma_f32_16x16x32_bf16 v[104:107], a[76:79], v[220:223], v[104:107]
ds_read_b128 a[64:67], v5 offset:8192
v_mfma_f32_16x16x32_bf16 v[88:91], a[76:79], v[92:95], v[88:91]
v_exp_f32 v199, v199
v_mfma_f32_16x16x32_bf16 v[124:127], a[80:83], v[220:223], v[124:127]
ds_read_b128 a[68:71], v5 offset:9216
v_cvt_pk_bf16_f32 v189, v198, v199
v_mfma_f32_16x16x32_bf16 v[140:143], a[80:83], v[92:95], v[140:143]
v_exp_f32 v44, v44
v_mfma_f32_16x16x32_bf16 v[32:35], a[84:87], v[220:223], v[32:35]
buffer_load_dwordx4 v4, s[24:27], s52 offen offset:2048 sc1 lds
v_mfma_f32_16x16x32_bf16 v[148:151], a[84:87], v[92:95], v[148:151]
v_exp_f32 v45, v45
v_mfma_f32_16x16x32_bf16 v[56:59], a[88:91], v[220:223], v[56:59]
ds_read_b128 a[72:75], v5 offset:10240
v_cvt_pk_bf16_f32 v154, v44, v45
v_mfma_f32_16x16x32_bf16 v[72:75], a[88:91], v[92:95], v[72:75]
v_exp_f32 v46, v46
v_mfma_f32_16x16x32_bf16 v[96:99], a[92:95], v[220:223], v[96:99]
buffer_load_dwordx4 v4, s[24:27], s52 offen offset:3072 sc1 lds
v_mfma_f32_16x16x32_bf16 v[80:83], a[92:95], v[92:95], v[80:83]
v_exp_f32 v47, v47
v_mfma_f32_16x16x32_bf16 a[232:235], a[240:243], v[220:223], a[232:235]
ds_read_b128 a[76:79], v5 offset:11264
v_cvt_pk_bf16_f32 v155, v46, v47
v_mfma_f32_16x16x32_bf16 a[236:239], a[240:243], v[92:95], a[236:239]
v_exp_f32 v108, v108
v_mfma_f32_16x16x32_bf16 v[160:163], a[192:195], v[128:131], v[240:243]
ds_read_b128 a[80:83], v5 offset:12288
ds_read_b128 a[84:87], v5 offset:13312
v_mfma_f32_16x16x32_bf16 v[160:163], a[196:199], v[176:179], v[160:163]
v_exp_f32 v109, v109
v_mfma_f32_16x16x32_bf16 v[160:163], a[200:203], v[208:211], v[160:163]
ds_read_b128 a[88:91], v5 offset:14336
v_cvt_pk_bf16_f32 v190, v108, v109
v_mfma_f32_16x16x32_bf16 v[160:163], a[204:207], v[68:71], v[160:163]
v_exp_f32 v110, v110
v_mfma_f32_16x16x32_bf16 v[192:195], a[192:195], v[136:139], v[244:247]
v_mfma_f32_16x16x32_bf16 v[192:195], a[196:199], v[180:183], v[192:195]
v_exp_f32 v111, v111
v_mfma_f32_16x16x32_bf16 v[192:195], a[200:203], v[212:215], v[192:195]
ds_read_b128 a[92:95], v5 offset:15360
v_cvt_pk_bf16_f32 v191, v110, v111
v_mfma_f32_16x16x32_bf16 v[192:195], a[204:207], v[76:79], v[192:195]
v_mfma_f32_16x16x32_bf16 v[36:39], a[208:211], v[128:131], v[248:251]
ds_read_b128 a[192:195], v5 offset:0
ds_read_b128 a[196:199], v5 offset:1024
v_mfma_f32_16x16x32_bf16 v[36:39], a[212:215], v[176:179], v[36:39]
v_exp_f32 v160, v160
v_mfma_f32_16x16x32_bf16 v[36:39], a[216:219], v[208:211], v[36:39]
v_mfma_f32_16x16x32_bf16 v[36:39], a[220:223], v[68:71], v[36:39]
v_exp_f32 v161, v161
v_mfma_f32_16x16x32_bf16 v[100:103], a[208:211], v[136:139], v[252:255]
ds_read_b128 a[200:203], v5 offset:2048
v_cvt_pk_bf16_f32 v220, v160, v161
v_mfma_f32_16x16x32_bf16 v[100:103], a[212:215], v[180:183], v[100:103]
v_exp_f32 v162, v162
v_mfma_f32_16x16x32_bf16 v[100:103], a[216:219], v[212:215], v[100:103]
ds_read_b128 a[204:207], v5 offset:3072
ds_read_b128 a[208:211], v5 offset:4096
v_mfma_f32_16x16x32_bf16 v[100:103], a[220:223], v[76:79], v[100:103]
s_waitcnt lgkmcnt(5)
v_exp_f32 v163, v163
v_mfma_f32_16x16x32_bf16 a[0:3], a[64:67], v[152:155], a[0:3]
ds_read_b128 a[212:215], v5 offset:5120
v_cvt_pk_bf16_f32 v221, v162, v163
v_mfma_f32_16x16x32_bf16 a[32:35], a[64:67], v[188:191], a[32:35]
v_exp_f32 v192, v192
v_mfma_f32_16x16x32_bf16 a[4:7], a[68:71], v[152:155], a[4:7]
v_mfma_f32_16x16x32_bf16 a[36:39], a[68:71], v[188:191], a[36:39]
v_exp_f32 v193, v193
v_mfma_f32_16x16x32_bf16 a[8:11], a[72:75], v[152:155], a[8:11]
ds_read_b128 a[216:219], v5 offset:6144
v_cvt_pk_bf16_f32 v92, v192, v193
v_mfma_f32_16x16x32_bf16 a[40:43], a[72:75], v[188:191], a[40:43]
v_exp_f32 v194, v194
v_mfma_f32_16x16x32_bf16 a[12:15], a[76:79], v[152:155], a[12:15]
ds_read_b128 a[220:223], v5 offset:7168
v_mfma_f32_16x16x32_bf16 a[44:47], a[76:79], v[188:191], a[44:47]
v_exp_f32 v195, v195
v_mfma_f32_16x16x32_bf16 a[16:19], a[80:83], v[152:155], a[16:19]
v_cvt_pk_bf16_f32 v93, v194, v195
v_mfma_f32_16x16x32_bf16 a[48:51], a[80:83], v[188:191], a[48:51]
v_exp_f32 v36, v36
v_mfma_f32_16x16x32_bf16 a[20:23], a[84:87], v[152:155], a[20:23]
v_mfma_f32_16x16x32_bf16 a[52:55], a[84:87], v[188:191], a[52:55]
v_exp_f32 v37, v37
v_mfma_f32_16x16x32_bf16 a[24:27], a[88:91], v[152:155], a[24:27]
v_cvt_pk_bf16_f32 v222, v36, v37
v_mfma_f32_16x16x32_bf16 a[56:59], a[88:91], v[188:191], a[56:59]
s_cmp_lt_u32 s59, s61
v_exp_f32 v38, v38
v_mfma_f32_16x16x32_bf16 a[28:31], a[92:95], v[152:155], a[28:31]
v_mfma_f32_16x16x32_bf16 a[60:63], a[92:95], v[188:191], a[60:63]
s_waitcnt lgkmcnt(0)
v_exp_f32 v39, v39
v_mfma_f32_16x16x32_bf16 a[224:227], a[240:243], v[152:155], a[224:227]
v_cvt_pk_bf16_f32 v223, v38, v39
v_mfma_f32_16x16x32_bf16 a[228:231], a[240:243], v[188:191], a[228:231]
v_exp_f32 v100, v100
s_cbranch_scc1 L_DUAL
s_cmp_lg_u32 s63, 0
s_cbranch_scc1 L_TRANS
L_DX:
v_cndmask_b32 v224, v224, v6, s[84:85]
v_cndmask_b32 v236, v236, v6, s[84:85]
v_mov_b32 v232, v6
v_cndmask_b32 v225, v225, v6, s[86:87]
v_cndmask_b32 v237, v237, v6, s[86:87]
v_mov_b32 v233, v6
v_cndmask_b32 v226, v226, v6, s[88:89]
v_cndmask_b32 v238, v238, v6, s[88:89]
v_mov_b32 v234, v6
v_cndmask_b32 v227, v227, v6, s[90:91]
v_cndmask_b32 v239, v239, v6, s[90:91]
v_mov_b32 v235, v6
s_mov_b32 s63, 1
s_branch L_DUAL
L_TRANS:
s_mul_i32 s65, s54, 598016
s_lshl_b32 s48, s4, 14
s_add_u32 s65, s65, s48
s_add_u32 s65, s65, 54525952
s_mov_b32 s61, s55
s_cmp_ge_u32 s3, 2
s_cbranch_scc1 L_NOSE
s_nop 1
v_mul_f32 v8, 0x3fb8aa3b, v8
v_accvgpr_read_b32 v144, a224
v_exp_f32 v8, v8
v_mul_f32 v9, 0x3fb8aa3b, v9
v_accvgpr_read_b32 v146, a228
v_exp_f32 v9, v9
s_nop 0
v_fma_f32 v144, v144, v8, v144
v_fma_f32 v146, v146, v9, v146
v_rcp_f32 v144, v144
v_rcp_f32 v146, v146
s_nop 0
v_mov_b32 v145, v144
v_mov_b32 v147, v146
s_add_u32 s48, s65, 0
v_accvgpr_read_b32 v16, a0
v_accvgpr_read_b32 v17, a1
v_accvgpr_read_b32 v18, a2
v_accvgpr_read_b32 v19, a3
v_accvgpr_read_b32 v20, a4
v_accvgpr_read_b32 v21, a5
v_accvgpr_read_b32 v22, a6
v_accvgpr_read_b32 v23, a7
v_pk_mul_f32 v[16:17], v[16:17], v[144:145]
v_pk_mul_f32 v[18:19], v[18:19], v[144:145]
v_pk_mul_f32 v[20:21], v[20:21], v[144:145]
v_pk_mul_f32 v[22:23], v[22:23], v[144:145]
v_cvt_pk_bf16_f32 v16, v16, v17
v_cvt_pk_bf16_f32 v17, v18, v19
v_cvt_pk_bf16_f32 v18, v20, v21
v_cvt_pk_bf16_f32 v19, v22, v23
buffer_store_dwordx4 v[16:19], v4, s[24:27], s48 offen offset:0 sc1
v_accvgpr_read_b32 v24, a32
v_accvgpr_read_b32 v25, a33
v_accvgpr_read_b32 v26, a34
v_accvgpr_read_b32 v27, a35
v_accvgpr_read_b32 v28, a36
v_accvgpr_read_b32 v29, a37
v_accvgpr_read_b32 v30, a38
v_accvgpr_read_b32 v31, a39
v_pk_mul_f32 v[24:25], v[24:25], v[146:147]
v_pk_mul_f32 v[26:27], v[26:27], v[146:147]
v_pk_mul_f32 v[28:29], v[28:29], v[146:147]
v_pk_mul_f32 v[30:31], v[30:31], v[146:147]
v_cvt_pk_bf16_f32 v24, v24, v25
v_cvt_pk_bf16_f32 v25, v26, v27
v_cvt_pk_bf16_f32 v26, v28, v29
v_cvt_pk_bf16_f32 v27, v30, v31
buffer_store_dwordx4 v[24:27], v4, s[24:27], s48 offen offset:1024 sc1
s_add_u32 s48, s65, 4096
v_accvgpr_read_b32 v16, a8
v_accvgpr_read_b32 v17, a9
v_accvgpr_read_b32 v18, a10
v_accvgpr_read_b32 v19, a11
v_accvgpr_read_b32 v20, a12
v_accvgpr_read_b32 v21, a13
v_accvgpr_read_b32 v22, a14
v_accvgpr_read_b32 v23, a15
v_pk_mul_f32 v[16:17], v[16:17], v[144:145]
v_pk_mul_f32 v[18:19], v[18:19], v[144:145]
v_pk_mul_f32 v[20:21], v[20:21], v[144:145]
v_pk_mul_f32 v[22:23], v[22:23], v[144:145]
v_cvt_pk_bf16_f32 v16, v16, v17
v_cvt_pk_bf16_f32 v17, v18, v19
v_cvt_pk_bf16_f32 v18, v20, v21
v_cvt_pk_bf16_f32 v19, v22, v23
buffer_store_dwordx4 v[16:19], v4, s[24:27], s48 offen offset:0 sc1
v_accvgpr_read_b32 v24, a40
v_accvgpr_read_b32 v25, a41
v_accvgpr_read_b32 v26, a42
v_accvgpr_read_b32 v27, a43
v_accvgpr_read_b32 v28, a44
v_accvgpr_read_b32 v29, a45
v_accvgpr_read_b32 v30, a46
v_accvgpr_read_b32 v31, a47
v_pk_mul_f32 v[24:25], v[24:25], v[146:147]
v_pk_mul_f32 v[26:27], v[26:27], v[146:147]
v_pk_mul_f32 v[28:29], v[28:29], v[146:147]
v_pk_mul_f32 v[30:31], v[30:31], v[146:147]
v_cvt_pk_bf16_f32 v24, v24, v25
v_cvt_pk_bf16_f32 v25, v26, v27
v_cvt_pk_bf16_f32 v26, v28, v29
v_cvt_pk_bf16_f32 v27, v30, v31
buffer_store_dwordx4 v[24:27], v4, s[24:27], s48 offen offset:1024 sc1
s_add_u32 s48, s65, 8192
v_accvgpr_read_b32 v16, a16
v_accvgpr_read_b32 v17, a17
v_accvgpr_read_b32 v18, a18
v_accvgpr_read_b32 v19, a19
v_accvgpr_read_b32 v20, a20
v_accvgpr_read_b32 v21, a21
v_accvgpr_read_b32 v22, a22
v_accvgpr_read_b32 v23, a23
v_pk_mul_f32 v[16:17], v[16:17], v[144:145]
v_pk_mul_f32 v[18:19], v[18:19], v[144:145]
v_pk_mul_f32 v[20:21], v[20:21], v[144:145]
v_pk_mul_f32 v[22:23], v[22:23], v[144:145]
v_cvt_pk_bf16_f32 v16, v16, v17
v_cvt_pk_bf16_f32 v17, v18, v19
v_cvt_pk_bf16_f32 v18, v20, v21
v_cvt_pk_bf16_f32 v19, v22, v23
buffer_store_dwordx4 v[16:19], v4, s[24:27], s48 offen offset:0 sc1
v_accvgpr_read_b32 v24, a48
v_accvgpr_read_b32 v25, a49
v_accvgpr_read_b32 v26, a50
v_accvgpr_read_b32 v27, a51
v_accvgpr_read_b32 v28, a52
v_accvgpr_read_b32 v29, a53
v_accvgpr_read_b32 v30, a54
v_accvgpr_read_b32 v31, a55
v_pk_mul_f32 v[24:25], v[24:25], v[146:147]
v_pk_mul_f32 v[26:27], v[26:27], v[146:147]
v_pk_mul_f32 v[28:29], v[28:29], v[146:147]
v_pk_mul_f32 v[30:31], v[30:31], v[146:147]
v_cvt_pk_bf16_f32 v24, v24, v25
v_cvt_pk_bf16_f32 v25, v26, v27
v_cvt_pk_bf16_f32 v26, v28, v29
v_cvt_pk_bf16_f32 v27, v30, v31
buffer_store_dwordx4 v[24:27], v4, s[24:27], s48 offen offset:1024 sc1
s_add_u32 s48, s65, 12288
v_accvgpr_read_b32 v16, a24
v_accvgpr_read_b32 v17, a25
v_accvgpr_read_b32 v18, a26
v_accvgpr_read_b32 v19, a27
v_accvgpr_read_b32 v20, a28
v_accvgpr_read_b32 v21, a29
v_accvgpr_read_b32 v22, a30
v_accvgpr_read_b32 v23, a31
v_pk_mul_f32 v[16:17], v[16:17], v[144:145]
v_pk_mul_f32 v[18:19], v[18:19], v[144:145]
v_pk_mul_f32 v[20:21], v[20:21], v[144:145]
v_pk_mul_f32 v[22:23], v[22:23], v[144:145]
v_cvt_pk_bf16_f32 v16, v16, v17
v_cvt_pk_bf16_f32 v17, v18, v19
v_cvt_pk_bf16_f32 v18, v20, v21
v_cvt_pk_bf16_f32 v19, v22, v23
buffer_store_dwordx4 v[16:19], v4, s[24:27], s48 offen offset:0 sc1
v_accvgpr_read_b32 v24, a56
v_accvgpr_read_b32 v25, a57
v_accvgpr_read_b32 v26, a58
v_accvgpr_read_b32 v27, a59
v_accvgpr_read_b32 v28, a60
v_accvgpr_read_b32 v29, a61
v_accvgpr_read_b32 v30, a62
v_accvgpr_read_b32 v31, a63
v_pk_mul_f32 v[24:25], v[24:25], v[146:147]
v_pk_mul_f32 v[26:27], v[26:27], v[146:147]
v_pk_mul_f32 v[28:29], v[28:29], v[146:147]
v_pk_mul_f32 v[30:31], v[30:31], v[146:147]
v_cvt_pk_bf16_f32 v24, v24, v25
v_cvt_pk_bf16_f32 v25, v26, v27
v_cvt_pk_bf16_f32 v26, v28, v29
v_cvt_pk_bf16_f32 v27, v30, v31
buffer_store_dwordx4 v[24:27], v4, s[24:27], s48 offen offset:1024 sc1
L_NOSE:
s_cmp_ge_u32 s59, s61
s_cbranch_scc1 L_FIN
L_SINGLE:
v_mfma_f32_16x16x32_bf16 v[164:167], a[192:195], v[128:131], v[240:243]
s_add_u32 s62, s62, 16384
ds_read_b128 a[80:83], v5 offset:12288
ds_read_b128 a[84:87], v5 offset:13312
v_mfma_f32_16x16x32_bf16 v[164:167], a[196:199], v[176:179], v[164:167]
s_and_b32 s62, s62, 131071
v_exp_f32 v101, v101
v_mfma_f32_16x16x32_bf16 v[164:167], a[200:203], v[208:211], v[164:167]
s_cmp_le_u32 s56, s58
ds_read_b128 a[88:91], v5 offset:14336
v_cvt_pk_bf16_f32 v94, v100, v101
v_mfma_f32_16x16x32_bf16 v[164:167], a[204:207], v[68:71], v[164:167]
s_waitcnt vmcnt(20)
v_exp_f32 v102, v102
v_mfma_f32_16x16x32_bf16 v[196:199], a[192:195], v[136:139], v[244:247]
s_barrier
v_mfma_f32_16x16x32_bf16 v[196:199], a[196:199], v[180:183], v[196:199]
s_cselect_b32 s52, s56, 2147418112
v_exp_f32 v103, v103
v_mfma_f32_16x16x32_bf16 v[196:199], a[200:203], v[212:215], v[196:199]
ds_read_b128 a[92:95], v5 offset:15360
v_cvt_pk_bf16_f32 v95, v102, v103
v_mfma_f32_16x16x32_bf16 v[196:199], a[204:207], v[76:79], v[196:199]
v_add_u32 v5, s62, v4
v_mfma_f32_16x16x32_bf16 v[44:47], a[208:211], v[128:131], v[248:251]
ds_read_b128 a[192:195], v5 offset:0
ds_read_b128 a[196:199], v5 offset:1024
v_mfma_f32_16x16x32_bf16 v[44:47], a[212:215], v[176:179], v[44:47]
s_mov_b32 m0, s57
v_exp_f32 v164, v164
v_mfma_f32_16x16x32_bf16 v[44:47], a[216:219], v[208:211], v[44:47]
buffer_load_dwordx4 v4, s[24:27], s52 offen offset:0 sc1 lds
v_mfma_f32_16x16x32_bf16 v[44:47], a[220:223], v[68:71], v[44:47]
s_add_u32 s56, s56, 16384
v_exp_f32 v165, v165
v_mfma_f32_16x16x32_bf16 v[108:111], a[208:211], v[136:139], v[252:255]
ds_read_b128 a[200:203], v5 offset:2048
v_cvt_pk_bf16_f32 v152, v164, v165
v_mfma_f32_16x16x32_bf16 v[108:111], a[212:215], v[180:183], v[108:111]
s_add_u32 s57, s57, 16384
v_exp_f32 v166, v166
v_mfma_f32_16x16x32_bf16 v[108:111], a[216:219], v[212:215], v[108:111]
ds_read_b128 a[204:207], v5 offset:3072
ds_read_b128 a[208:211], v5 offset:4096
v_mfma_f32_16x16x32_bf16 v[108:111], a[220:223], v[76:79], v[108:111]
s_waitcnt lgkmcnt(5)
v_exp_f32 v167, v167
v_mfma_f32_16x16x32_bf16 v[116:119], a[64:67], v[220:223], v[116:119]
ds_read_b128 a[212:215], v5 offset:5120
v_cvt_pk_bf16_f32 v153, v166, v167
v_mfma_f32_16x16x32_bf16 v[132:135], a[64:67], v[92:95], v[132:135]
s_and_b32 s57, s57, 131071
v_exp_f32 v196, v196
v_mfma_f32_16x16x32_bf16 v[40:43], a[68:71], v[220:223], v[40:43]
buffer_load_dwordx4 v4, s[24:27], s52 offen offset:1024 sc1 lds
v_mfma_f32_16x16x32_bf16 v[156:159], a[68:71], v[92:95], v[156:159]
s_add_u32 s59, s59, 1
v_exp_f32 v197, v197
v_mfma_f32_16x16x32_bf16 v[48:51], a[72:75], v[220:223], v[48:51]
ds_read_b128 a[216:219], v5 offset:6144
v_cvt_pk_bf16_f32 v188, v196, v197
v_mfma_f32_16x16x32_bf16 v[64:67], a[72:75], v[92:95], v[64:67]
v_exp_f32 v198, v198
v_mfma_f32_16x16x32_bf16 v[104:107], a[76:79], v[220:223], v[104:107]
ds_read_b128 a[220:223], v5 offset:7168
ds_read_b128 a[64:67], v5 offset:8192
v_mfma_f32_16x16x32_bf16 v[88:91], a[76:79], v[92:95], v[88:91]
v_exp_f32 v199, v199
v_mfma_f32_16x16x32_bf16 v[124:127], a[80:83], v[220:223], v[124:127]
ds_read_b128 a[68:71], v5 offset:9216
v_cvt_pk_bf16_f32 v189, v198, v199
v_mfma_f32_16x16x32_bf16 v[140:143], a[80:83], v[92:95], v[140:143]
v_exp_f32 v44, v44
v_mfma_f32_16x16x32_bf16 v[32:35], a[84:87], v[220:223], v[32:35]
buffer_load_dwordx4 v4, s[24:27], s52 offen offset:2048 sc1 lds
v_mfma_f32_16x16x32_bf16 v[148:151], a[84:87], v[92:95], v[148:151]
v_exp_f32 v45, v45
v_mfma_f32_16x16x32_bf16 v[56:59], a[88:91], v[220:223], v[56:59]
ds_read_b128 a[72:75], v5 offset:10240
v_cvt_pk_bf16_f32 v154, v44, v45
v_mfma_f32_16x16x32_bf16 v[72:75], a[88:91], v[92:95], v[72:75]
v_exp_f32 v46, v46
v_mfma_f32_16x16x32_bf16 v[96:99], a[92:95], v[220:223], v[96:99]
buffer_load_dwordx4 v4, s[24:27], s52 offen offset:3072 sc1 lds
v_mfma_f32_16x16x32_bf16 v[80:83], a[92:95], v[92:95], v[80:83]
s_waitcnt lgkmcnt(3)
v_exp_f32 v47, v47
v_mfma_f32_16x16x32_bf16 a[232:235], a[240:243], v[220:223], a[232:235]
ds_read_b128 a[76:79], v5 offset:11264
v_cvt_pk_bf16_f32 v155, v46, v47
v_mfma_f32_16x16x32_bf16 a[236:239], a[240:243], v[92:95], a[236:239]
v_exp_f32 v108, v108
v_mfma_f32_16x16x32_bf16 v[160:163], a[192:195], v[128:131], v[240:243]
s_add_u32 s62, s62, 16384
ds_read_b128 a[80:83], v5 offset:12288
ds_read_b128 a[84:87], v5 offset:13312
v_mfma_f32_16x16x32_bf16 v[160:163], a[196:199], v[176:179], v[160:163]
s_and_b32 s62, s62, 131071
v_exp_f32 v109, v109
v_mfma_f32_16x16x32_bf16 v[160:163], a[200:203], v[208:211], v[160:163]
s_cmp_le_u32 s56, s58
ds_read_b128 a[88:91], v5 offset:14336
v_cvt_pk_bf16_f32 v190, v108, v109
v_mfma_f32_16x16x32_bf16 v[160:163], a[204:207], v[68:71], v[160:163]
s_waitcnt vmcnt(20)
v_exp_f32 v110, v110
v_mfma_f32_16x16x32_bf16 v[192:195], a[192:195], v[136:139], v[244:247]
s_barrier
v_mfma_f32_16x16x32_bf16 v[192:195], a[196:199], v[180:183], v[192:195]
s_cselect_b32 s52, s56, 2147418112
v_exp_f32 v111, v111
v_mfma_f32_16x16x32_bf16 v[192:195], a[200:203], v[212:215], v[192:195]
ds_read_b128 a[92:95], v5 offset:15360
v_cvt_pk_bf16_f32 v191, v110, v111
v_mfma_f32_16x16x32_bf16 v[192:195], a[204:207], v[76:79], v[192:195]
v_add_u32 v5, s62, v4
v_mfma_f32_16x16x32_bf16 v[36:39], a[208:211], v[128:131], v[248:251]
ds_read_b128 a[192:195], v5 offset:0
ds_read_b128 a[196:199], v5 offset:1024
v_mfma_f32_16x16x32_bf16 v[36:39], a[212:215], v[176:179], v[36:39]
s_mov_b32 m0, s57
v_exp_f32 v160, v160
v_mfma_f32_16x16x32_bf16 v[36:39], a[216:219], v[208:211], v[36:39]
buffer_load_dwordx4 v4, s[24:27], s52 offen offset:0 sc1 lds
v_mfma_f32_16x16x32_bf16 v[36:39], a[220:223], v[68:71], v[36:39]
s_add_u32 s56, s56, 16384
v_exp_f32 v161, v161
v_mfma_f32_16x16x32_bf16 v[100:103], a[208:211], v[136:139], v[252:255]
ds_read_b128 a[200:203], v5 offset:2048
v_cvt_pk_bf16_f32 v220, v160, v161
v_mfma_f32_16x16x32_bf16 v[100:103], a[212:215], v[180:183], v[100:103]
s_add_u32 s57, s57, 16384
v_exp_f32 v162, v162
v_mfma_f32_16x16x32_bf16 v[100:103], a[216:219], v[212:215], v[100:103]
ds_read_b128 a[204:207], v5 offset:3072
ds_read_b128 a[208:211], v5 offset:4096
v_mfma_f32_16x16x32_bf16 v[100:103], a[220:223], v[76:79], v[100:103]
s_waitcnt lgkmcnt(5)
v_exp_f32 v163, v163
v_mfma_f32_16x16x32_bf16 v[116:119], a[64:67], v[152:155], v[116:119]
ds_read_b128 a[212:215], v5 offset:5120
v_cvt_pk_bf16_f32 v221, v162, v163
v_mfma_f32_16x16x32_bf16 v[132:135], a[64:67], v[188:191], v[132:135]
s_and_b32 s57, s57, 131071
v_exp_f32 v192, v192
v_mfma_f32_16x16x32_bf16 v[40:43], a[68:71], v[152:155], v[40:43]
buffer_load_dwordx4 v4, s[24:27], s52 offen offset:1024 sc1 lds
v_mfma_f32_16x16x32_bf16 v[156:159], a[68:71], v[188:191], v[156:159]
s_add_u32 s59, s59, 1
v_exp_f32 v193, v193
v_mfma_f32_16x16x32_bf16 v[48:51], a[72:75], v[152:155], v[48:51]
ds_read_b128 a[216:219], v5 offset:6144
v_cvt_pk_bf16_f32 v92, v192, v193
v_mfma_f32_16x16x32_bf16 v[64:67], a[72:75], v[188:191], v[64:67]
v_exp_f32 v194, v194
v_mfma_f32_16x16x32_bf16 v[104:107], a[76:79], v[152:155], v[104:107]
ds_read_b128 a[220:223], v5 offset:7168
ds_read_b128 a[64:67], v5 offset:8192
v_mfma_f32_16x16x32_bf16 v[88:91], a[76:79], v[188:191], v[88:91]
v_exp_f32 v195, v195
v_mfma_f32_16x16x32_bf16 v[124:127], a[80:83], v[152:155], v[124:127]
ds_read_b128 a[68:71], v5 offset:9216
v_cvt_pk_bf16_f32 v93, v194, v195
v_mfma_f32_16x16x32_bf16 v[140:143], a[80:83], v[188:191], v[140:143]
v_exp_f32 v36, v36
v_mfma_f32_16x16x32_bf16 v[32:35], a[84:87], v[152:155], v[32:35]
buffer_load_dwordx4 v4, s[24:27], s52 offen offset:2048 sc1 lds
v_mfma_f32_16x16x32_bf16 v[148:151], a[84:87], v[188:191], v[148:151]
v_exp_f32 v37, v37
v_mfma_f32_16x16x32_bf16 v[56:59], a[88:91], v[152:155], v[56:59]
ds_read_b128 a[72:75], v5 offset:10240
v_cvt_pk_bf16_f32 v222, v36, v37
v_mfma_f32_16x16x32_bf16 v[72:75], a[88:91], v[188:191], v[72:75]
s_cmp_lt_u32 s59, s61
v_exp_f32 v38, v38
v_mfma_f32_16x16x32_bf16 v[96:99], a[92:95], v[152:155], v[96:99]
buffer_load_dwordx4 v4, s[24:27], s52 offen offset:3072 sc1 lds
v_mfma_f32_16x16x32_bf16 v[80:83], a[92:95], v[188:191], v[80:83]
s_waitcnt lgkmcnt(3)
v_exp_f32 v39, v39
v_mfma_f32_16x16x32_bf16 a[232:235], a[240:243], v[152:155], a[232:235]
ds_read_b128 a[76:79], v5 offset:11264
v_cvt_pk_bf16_f32 v223, v38, v39
v_mfma_f32_16x16x32_bf16 a[236:239], a[240:243], v[188:191], a[236:239]
v_exp_f32 v100, v100
s_cbranch_scc1 L_SINGLE
L_FIN:
v_cndmask_b32 v240, v240, v6, s[84:85]
v_cndmask_b32 v252, v252, v6, s[84:85]
v_mov_b32 v248, v6
v_cndmask_b32 v241, v241, v6, s[86:87]
v_cndmask_b32 v253, v253, v6, s[86:87]
v_mov_b32 v249, v6
v_cndmask_b32 v242, v242, v6, s[88:89]
v_cndmask_b32 v254, v254, v6, s[88:89]
v_mov_b32 v250, v6
v_cndmask_b32 v243, v243, v6, s[90:91]
v_cndmask_b32 v255, v255, v6, s[90:91]
v_mov_b32 v251, v6
v_and_b32 v186, 31, v1
v_lshlrev_b32 v186, 10, v186
s_mov_b32 s51, 75497984
v_mfma_f32_16x16x32_bf16 v[164:167], a[192:195], v[128:131], v[240:243]
s_add_u32 s62, s62, 16384
ds_read_b128 a[80:83], v5 offset:12288
ds_read_b128 a[84:87], v5 offset:13312
v_mfma_f32_16x16x32_bf16 v[164:167], a[196:199], v[176:179], v[164:167]
s_and_b32 s62, s62, 131071
v_exp_f32 v101, v101
v_mfma_f32_16x16x32_bf16 v[164:167], a[200:203], v[208:211], v[164:167]
ds_read_b128 a[88:91], v5 offset:14336
v_cvt_pk_bf16_f32 v94, v100, v101
v_mfma_f32_16x16x32_bf16 v[164:167], a[204:207], v[68:71], v[164:167]
s_waitcnt vmcnt(0)
v_exp_f32 v102, v102
v_mfma_f32_16x16x32_bf16 v[196:199], a[192:195], v[136:139], v[244:247]
s_barrier
v_mfma_f32_16x16x32_bf16 v[196:199], a[196:199], v[180:183], v[196:199]
v_exp_f32 v103, v103
v_mfma_f32_16x16x32_bf16 v[196:199], a[200:203], v[212:215], v[196:199]
ds_read_b128 a[92:95], v5 offset:15360
v_cvt_pk_bf16_f32 v95, v102, v103
v_mfma_f32_16x16x32_bf16 v[196:199], a[204:207], v[76:79], v[196:199]
v_add_u32 v5, s62, v4
v_mfma_f32_16x16x32_bf16 v[44:47], a[208:211], v[128:131], v[248:251]
v_mfma_f32_16x16x32_bf16 v[44:47], a[212:215], v[176:179], v[44:47]
v_exp_f32 v164, v164
v_mfma_f32_16x16x32_bf16 v[44:47], a[216:219], v[208:211], v[44:47]
buffer_load_dword v185, v186, s[24:27], s51 offen offset:8 sc1
v_mfma_f32_16x16x32_bf16 v[44:47], a[220:223], v[68:71], v[44:47]
v_exp_f32 v165, v165
v_mfma_f32_16x16x32_bf16 v[108:111], a[208:211], v[136:139], v[252:255]
v_cvt_pk_bf16_f32 v152, v164, v165
v_mfma_f32_16x16x32_bf16 v[108:111], a[212:215], v[180:183], v[108:111]
v_exp_f32 v166, v166
v_mfma_f32_16x16x32_bf16 v[108:111], a[216:219], v[212:215], v[108:111]
v_mfma_f32_16x16x32_bf16 v[108:111], a[220:223], v[76:79], v[108:111]
s_waitcnt lgkmcnt(0)
v_exp_f32 v167, v167
v_mfma_f32_16x16x32_bf16 v[116:119], a[64:67], v[220:223], v[116:119]
v_cvt_pk_bf16_f32 v153, v166, v167
v_mfma_f32_16x16x32_bf16 v[132:135], a[64:67], v[92:95], v[132:135]
v_exp_f32 v196, v196
v_mfma_f32_16x16x32_bf16 v[40:43], a[68:71], v[220:223], v[40:43]
v_mfma_f32_16x16x32_bf16 v[156:159], a[68:71], v[92:95], v[156:159]
v_exp_f32 v197, v197
v_mfma_f32_16x16x32_bf16 v[48:51], a[72:75], v[220:223], v[48:51]
v_cvt_pk_bf16_f32 v188, v196, v197
v_mfma_f32_16x16x32_bf16 v[64:67], a[72:75], v[92:95], v[64:67]
v_exp_f32 v198, v198
v_mfma_f32_16x16x32_bf16 v[104:107], a[76:79], v[220:223], v[104:107]
ds_read_b128 a[64:67], v5 offset:8192
v_mfma_f32_16x16x32_bf16 v[88:91], a[76:79], v[92:95], v[88:91]
v_exp_f32 v199, v199
v_mfma_f32_16x16x32_bf16 v[124:127], a[80:83], v[220:223], v[124:127]
ds_read_b128 a[68:71], v5 offset:9216
v_cvt_pk_bf16_f32 v189, v198, v199
v_mfma_f32_16x16x32_bf16 v[140:143], a[80:83], v[92:95], v[140:143]
v_exp_f32 v44, v44
v_mfma_f32_16x16x32_bf16 v[32:35], a[84:87], v[220:223], v[32:35]
v_mfma_f32_16x16x32_bf16 v[148:151], a[84:87], v[92:95], v[148:151]
v_exp_f32 v45, v45
v_mfma_f32_16x16x32_bf16 v[56:59], a[88:91], v[220:223], v[56:59]
ds_read_b128 a[72:75], v5 offset:10240
v_cvt_pk_bf16_f32 v154, v44, v45
v_mfma_f32_16x16x32_bf16 v[72:75], a[88:91], v[92:95], v[72:75]
v_exp_f32 v46, v46
v_mfma_f32_16x16x32_bf16 v[96:99], a[92:95], v[220:223], v[96:99]
v_mfma_f32_16x16x32_bf16 v[80:83], a[92:95], v[92:95], v[80:83]
v_exp_f32 v47, v47
v_mfma_f32_16x16x32_bf16 a[232:235], a[240:243], v[220:223], a[232:235]
ds_read_b128 a[76:79], v5 offset:11264
v_cvt_pk_bf16_f32 v155, v46, v47
v_mfma_f32_16x16x32_bf16 a[236:239], a[240:243], v[92:95], a[236:239]
v_exp_f32 v108, v108
ds_read_b128 a[80:83], v5 offset:12288
ds_read_b128 a[84:87], v5 offset:13312
ds_read_b128 a[88:91], v5 offset:14336
ds_read_b128 a[92:95], v5 offset:15360
v_exp_f32 v109, v109
v_exp_f32 v110, v110
v_exp_f32 v111, v111
s_cmp_lt_u32 s3, 1
s_cbranch_scc1 L_XB1
s_barrier
L_XB1:
v_cvt_pk_bf16_f32 v190, v108, v109
v_cvt_pk_bf16_f32 v191, v110, v111
s_waitcnt vmcnt(0)
v_cmp_gt_u32 vcc, 8, v185
s_nop 4
s_cbranch_vccnz CK_QA
CK_QA_R:
s_waitcnt lgkmcnt(0)
v_mfma_f32_16x16x32_bf16 v[116:119], a[64:67], v[152:155], v[116:119]
s_lshl_b32 s49, s4, 18
s_add_u32 s49, s49, 45088768
s_lshl_b32 s50, s54, 9
v_mfma_f32_16x16x32_bf16 v[132:135], a[64:67], v[188:191], v[132:135]
s_add_u32 s50, s50, s49
s_lshl_b32 s51, s55, 9
s_add_u32 s51, s51, s49
v_mfma_f32_16x16x32_bf16 v[40:43], a[68:71], v[152:155], v[40:43]
s_lshl_b32 s67, s3, 13
s_add_u32 s67, s67, 131072
v_mfma_f32_16x16x32_bf16 v[156:159], a[68:71], v[188:191], v[156:159]
v_mfma_f32_16x16x32_bf16 v[48:51], a[72:75], v[152:155], v[48:51]
v_mfma_f32_16x16x32_bf16 v[64:67], a[72:75], v[188:191], v[64:67]
v_mfma_f32_16x16x32_bf16 v[104:107], a[76:79], v[152:155], v[104:107]
v_mfma_f32_16x16x32_bf16 v[88:91], a[76:79], v[188:191], v[88:91]
v_mfma_f32_16x16x32_bf16 v[124:127], a[80:83], v[152:155], v[124:127]
v_mfma_f32_16x16x32_bf16 v[140:143], a[80:83], v[188:191], v[140:143]
v_mfma_f32_16x16x32_bf16 v[32:35], a[84:87], v[152:155], v[32:35]
v_mfma_f32_16x16x32_bf16 v[148:151], a[84:87], v[188:191], v[148:151]
v_mfma_f32_16x16x32_bf16 v[56:59], a[88:91], v[152:155], v[56:59]
v_mfma_f32_16x16x32_bf16 v[72:75], a[88:91], v[188:191], v[72:75]
v_mfma_f32_16x16x32_bf16 v[96:99], a[92:95], v[152:155], v[96:99]
v_mfma_f32_16x16x32_bf16 v[80:83], a[92:95], v[188:191], v[80:83]
v_mfma_f32_16x16x32_bf16 a[232:235], a[240:243], v[152:155], a[232:235]
v_mfma_f32_16x16x32_bf16 a[236:239], a[240:243], v[188:191], a[236:239]
s_mov_b32 exec_hi, 0xffff
s_add_u32 m0, s67, 0
s_add_u32 s52, s50, 65280
buffer_load_dwordx4 v4, s[24:27], s52 offen sc1 lds
s_add_u32 m0, s67, 768
s_add_u32 s52, s50, 98048
buffer_load_dwordx4 v4, s[24:27], s52 offen sc1 lds
s_add_u32 m0, s67, 1536
s_add_u32 s52, s50, 130816
buffer_load_dwordx4 v4, s[24:27], s52 offen sc1 lds
s_add_u32 m0, s67, 2304
s_add_u32 s52, s50, 163584
buffer_load_dwordx4 v4, s[24:27], s52 offen sc1 lds
s_add_u32 m0, s67, 3072
s_add_u32 s52, s50, 196352
buffer_load_dwordx4 v4, s[24:27], s52 offen sc1 lds
s_add_u32 m0, s67, 3840
s_add_u32 s52, s51, 65280
buffer_load_dwordx4 v4, s[24:27], s52 offen sc1 lds
s_add_u32 m0, s67, 4608
s_add_u32 s52, s51, 98048
buffer_load_dwordx4 v4, s[24:27], s52 offen sc1 lds
s_add_u32 m0, s67, 5376
s_add_u32 s52, s51, 130816
buffer_load_dwordx4 v4, s[24:27], s52 offen sc1 lds
s_add_u32 m0, s67, 6144
s_add_u32 s52, s51, 163584
buffer_load_dwordx4 v4, s[24:27], s52 offen sc1 lds
s_add_u32 m0, s67, 6912
s_add_u32 s52, s51, 196352
buffer_load_dwordx4 v4, s[24:27], s52 offen sc1 lds
s_mov_b32 exec_hi, -1
v_and_b32 v218, 31, v1
v_cmp_lt_u32 vcc, 31, v1
v_mov_b32 v216, s54
v_mov_b32 v219, s55
v_cndmask_b32 v216, v216, v219, vcc
v_lshl_add_u32 v216, v216, 5, v218
v_lshlrev_b32 v219, 4, v216
buffer_load_dwordx4 v[224:227], v219, s[24:27], s49 offen sc1
s_add_u32 s49, s49, 32768
buffer_load_dwordx4 v[228:231], v219, s[24:27], s49 offen sc1
v_lshrrev_b32 v217, 5, v1
v_mul_u32_u24 v217, 3840, v217
v_lshl_add_u32 v217, v218, 4, v217
v_add_u32 v217, s67, v217
s_cmp_lt_u32 s3, 2
s_cbranch_scc1 L_XB2
s_barrier
L_XB2:
v_mul_f32 v10, 0x3fb8aa3b, v10
v_accvgpr_read_b32 v144, a232
v_exp_f32 v10, v10
v_mul_f32 v11, 0x3fb8aa3b, v11
v_accvgpr_read_b32 v146, a236
v_exp_f32 v11, v11
s_nop 0
v_fma_f32 v144, v144, v10, v144
v_fma_f32 v146, v146, v11, v146
v_rcp_f32 v144, v144
v_rcp_f32 v146, v146
s_nop 0
v_mov_b32 v145, v144
v_mov_b32 v147, v146
s_add_u32 s48, s65, 0
v_pk_mul_f32 v[116:117], v[116:117], v[144:145]
v_pk_mul_f32 v[118:119], v[118:119], v[144:145]
v_pk_mul_f32 v[40:41], v[40:41], v[144:145]
v_pk_mul_f32 v[42:43], v[42:43], v[144:145]
v_cvt_pk_bf16_f32 v116, v116, v117
v_cvt_pk_bf16_f32 v117, v118, v119
v_cvt_pk_bf16_f32 v118, v40, v41
v_cvt_pk_bf16_f32 v119, v42, v43
buffer_store_dwordx4 v[116:119], v4, s[24:27], s48 offen offset:2048 sc1
v_pk_mul_f32 v[132:133], v[132:133], v[146:147]
v_pk_mul_f32 v[134:135], v[134:135], v[146:147]
v_pk_mul_f32 v[156:157], v[156:157], v[146:147]
v_pk_mul_f32 v[158:159], v[158:159], v[146:147]
v_cvt_pk_bf16_f32 v132, v132, v133
v_cvt_pk_bf16_f32 v133, v134, v135
v_cvt_pk_bf16_f32 v134, v156, v157
v_cvt_pk_bf16_f32 v135, v158, v159
buffer_store_dwordx4 v[132:135], v4, s[24:27], s48 offen offset:3072 sc1
s_add_u32 s48, s65, 4096
v_pk_mul_f32 v[48:49], v[48:49], v[144:145]
v_pk_mul_f32 v[50:51], v[50:51], v[144:145]
v_pk_mul_f32 v[104:105], v[104:105], v[144:145]
v_pk_mul_f32 v[106:107], v[106:107], v[144:145]
v_cvt_pk_bf16_f32 v48, v48, v49
v_cvt_pk_bf16_f32 v49, v50, v51
v_cvt_pk_bf16_f32 v50, v104, v105
v_cvt_pk_bf16_f32 v51, v106, v107
buffer_store_dwordx4 v[48:51], v4, s[24:27], s48 offen offset:2048 sc1
v_pk_mul_f32 v[64:65], v[64:65], v[146:147]
v_pk_mul_f32 v[66:67], v[66:67], v[146:147]
v_pk_mul_f32 v[88:89], v[88:89], v[146:147]
v_pk_mul_f32 v[90:91], v[90:91], v[146:147]
v_cvt_pk_bf16_f32 v64, v64, v65
v_cvt_pk_bf16_f32 v65, v66, v67
v_cvt_pk_bf16_f32 v66, v88, v89
v_cvt_pk_bf16_f32 v67, v90, v91
buffer_store_dwordx4 v[64:67], v4, s[24:27], s48 offen offset:3072 sc1
s_add_u32 s48, s65, 8192
v_pk_mul_f32 v[124:125], v[124:125], v[144:145]
v_pk_mul_f32 v[126:127], v[126:127], v[144:145]
v_pk_mul_f32 v[32:33], v[32:33], v[144:145]
v_pk_mul_f32 v[34:35], v[34:35], v[144:145]
v_cvt_pk_bf16_f32 v124, v124, v125
v_cvt_pk_bf16_f32 v125, v126, v127
v_cvt_pk_bf16_f32 v126, v32, v33
v_cvt_pk_bf16_f32 v127, v34, v35
buffer_store_dwordx4 v[124:127], v4, s[24:27], s48 offen offset:2048 sc1
v_pk_mul_f32 v[140:141], v[140:141], v[146:147]
v_pk_mul_f32 v[142:143], v[142:143], v[146:147]
v_pk_mul_f32 v[148:149], v[148:149], v[146:147]
v_pk_mul_f32 v[150:151], v[150:151], v[146:147]
v_cvt_pk_bf16_f32 v140, v140, v141
v_cvt_pk_bf16_f32 v141, v142, v143
v_cvt_pk_bf16_f32 v142, v148, v149
v_cvt_pk_bf16_f32 v143, v150, v151
buffer_store_dwordx4 v[140:143], v4, s[24:27], s48 offen offset:3072 sc1
s_add_u32 s48, s65, 12288
v_pk_mul_f32 v[56:57], v[56:57], v[144:145]
v_pk_mul_f32 v[58:59], v[58:59], v[144:145]
v_pk_mul_f32 v[96:97], v[96:97], v[144:145]
v_pk_mul_f32 v[98:99], v[98:99], v[144:145]
v_cvt_pk_bf16_f32 v56, v56, v57
v_cvt_pk_bf16_f32 v57, v58, v59
v_cvt_pk_bf16_f32 v58, v96, v97
v_cvt_pk_bf16_f32 v59, v98, v99
buffer_store_dwordx4 v[56:59], v4, s[24:27], s48 offen offset:2048 sc1
v_pk_mul_f32 v[72:73], v[72:73], v[146:147]
v_pk_mul_f32 v[74:75], v[74:75], v[146:147]
v_pk_mul_f32 v[80:81], v[80:81], v[146:147]
v_pk_mul_f32 v[82:83], v[82:83], v[146:147]
v_cvt_pk_bf16_f32 v72, v72, v73
v_cvt_pk_bf16_f32 v73, v74, v75
v_cvt_pk_bf16_f32 v74, v80, v81
v_cvt_pk_bf16_f32 v75, v82, v83
buffer_store_dwordx4 v[72:75], v4, s[24:27], s48 offen offset:3072 sc1
s_cmp_lt_u32 s3, 3
s_cbranch_scc1 L_XB3
s_barrier
L_XB3:
s_cmp_lt_u32 s3, 2
s_cbranch_scc1 L_NOSE2
v_mul_f32 v8, 0x3fb8aa3b, v8
v_accvgpr_read_b32 v144, a224
v_exp_f32 v8, v8
v_mul_f32 v9, 0x3fb8aa3b, v9
v_accvgpr_read_b32 v146, a228
v_exp_f32 v9, v9
s_nop 0
v_fma_f32 v144, v144, v8, v144
v_fma_f32 v146, v146, v9, v146
v_rcp_f32 v144, v144
v_rcp_f32 v146, v146
s_nop 0
v_mov_b32 v145, v144
v_mov_b32 v147, v146
s_add_u32 s48, s65, 0
v_accvgpr_read_b32 v16, a0
v_accvgpr_read_b32 v17, a1
v_accvgpr_read_b32 v18, a2
v_accvgpr_read_b32 v19, a3
v_accvgpr_read_b32 v20, a4
v_accvgpr_read_b32 v21, a5
v_accvgpr_read_b32 v22, a6
v_accvgpr_read_b32 v23, a7
v_pk_mul_f32 v[16:17], v[16:17], v[144:145]
v_pk_mul_f32 v[18:19], v[18:19], v[144:145]
v_pk_mul_f32 v[20:21], v[20:21], v[144:145]
v_pk_mul_f32 v[22:23], v[22:23], v[144:145]
v_cvt_pk_bf16_f32 v16, v16, v17
v_cvt_pk_bf16_f32 v17, v18, v19
v_cvt_pk_bf16_f32 v18, v20, v21
v_cvt_pk_bf16_f32 v19, v22, v23
buffer_store_dwordx4 v[16:19], v4, s[24:27], s48 offen offset:0 sc1
v_accvgpr_read_b32 v24, a32
v_accvgpr_read_b32 v25, a33
v_accvgpr_read_b32 v26, a34
v_accvgpr_read_b32 v27, a35
v_accvgpr_read_b32 v28, a36
v_accvgpr_read_b32 v29, a37
v_accvgpr_read_b32 v30, a38
v_accvgpr_read_b32 v31, a39
v_pk_mul_f32 v[24:25], v[24:25], v[146:147]
v_pk_mul_f32 v[26:27], v[26:27], v[146:147]
v_pk_mul_f32 v[28:29], v[28:29], v[146:147]
v_pk_mul_f32 v[30:31], v[30:31], v[146:147]
v_cvt_pk_bf16_f32 v24, v24, v25
v_cvt_pk_bf16_f32 v25, v26, v27
v_cvt_pk_bf16_f32 v26, v28, v29
v_cvt_pk_bf16_f32 v27, v30, v31
buffer_store_dwordx4 v[24:27], v4, s[24:27], s48 offen offset:1024 sc1
s_add_u32 s48, s65, 4096
v_accvgpr_read_b32 v16, a8
v_accvgpr_read_b32 v17, a9
v_accvgpr_read_b32 v18, a10
v_accvgpr_read_b32 v19, a11
v_accvgpr_read_b32 v20, a12
v_accvgpr_read_b32 v21, a13
v_accvgpr_read_b32 v22, a14
v_accvgpr_read_b32 v23, a15
v_pk_mul_f32 v[16:17], v[16:17], v[144:145]
v_pk_mul_f32 v[18:19], v[18:19], v[144:145]
v_pk_mul_f32 v[20:21], v[20:21], v[144:145]
v_pk_mul_f32 v[22:23], v[22:23], v[144:145]
v_cvt_pk_bf16_f32 v16, v16, v17
v_cvt_pk_bf16_f32 v17, v18, v19
v_cvt_pk_bf16_f32 v18, v20, v21
v_cvt_pk_bf16_f32 v19, v22, v23
buffer_store_dwordx4 v[16:19], v4, s[24:27], s48 offen offset:0 sc1
v_accvgpr_read_b32 v24, a40
v_accvgpr_read_b32 v25, a41
v_accvgpr_read_b32 v26, a42
v_accvgpr_read_b32 v27, a43
v_accvgpr_read_b32 v28, a44
v_accvgpr_read_b32 v29, a45
v_accvgpr_read_b32 v30, a46
v_accvgpr_read_b32 v31, a47
v_pk_mul_f32 v[24:25], v[24:25], v[146:147]
v_pk_mul_f32 v[26:27], v[26:27], v[146:147]
v_pk_mul_f32 v[28:29], v[28:29], v[146:147]
v_pk_mul_f32 v[30:31], v[30:31], v[146:147]
v_cvt_pk_bf16_f32 v24, v24, v25
v_cvt_pk_bf16_f32 v25, v26, v27
v_cvt_pk_bf16_f32 v26, v28, v29
v_cvt_pk_bf16_f32 v27, v30, v31
buffer_store_dwordx4 v[24:27], v4, s[24:27], s48 offen offset:1024 sc1
s_add_u32 s48, s65, 8192
v_accvgpr_read_b32 v16, a16
v_accvgpr_read_b32 v17, a17
v_accvgpr_read_b32 v18, a18
v_accvgpr_read_b32 v19, a19
v_accvgpr_read_b32 v20, a20
v_accvgpr_read_b32 v21, a21
v_accvgpr_read_b32 v22, a22
v_accvgpr_read_b32 v23, a23
v_pk_mul_f32 v[16:17], v[16:17], v[144:145]
v_pk_mul_f32 v[18:19], v[18:19], v[144:145]
v_pk_mul_f32 v[20:21], v[20:21], v[144:145]
v_pk_mul_f32 v[22:23], v[22:23], v[144:145]
v_cvt_pk_bf16_f32 v16, v16, v17
v_cvt_pk_bf16_f32 v17, v18, v19
v_cvt_pk_bf16_f32 v18, v20, v21
v_cvt_pk_bf16_f32 v19, v22, v23
buffer_store_dwordx4 v[16:19], v4, s[24:27], s48 offen offset:0 sc1
v_accvgpr_read_b32 v24, a48
v_accvgpr_read_b32 v25, a49
v_accvgpr_read_b32 v26, a50
v_accvgpr_read_b32 v27, a51
v_accvgpr_read_b32 v28, a52
v_accvgpr_read_b32 v29, a53
v_accvgpr_read_b32 v30, a54
v_accvgpr_read_b32 v31, a55
v_pk_mul_f32 v[24:25], v[24:25], v[146:147]
v_pk_mul_f32 v[26:27], v[26:27], v[146:147]
v_pk_mul_f32 v[28:29], v[28:29], v[146:147]
v_pk_mul_f32 v[30:31], v[30:31], v[146:147]
v_cvt_pk_bf16_f32 v24, v24, v25
v_cvt_pk_bf16_f32 v25, v26, v27
v_cvt_pk_bf16_f32 v26, v28, v29
v_cvt_pk_bf16_f32 v27, v30, v31
buffer_store_dwordx4 v[24:27], v4, s[24:27], s48 offen offset:1024 sc1
s_add_u32 s48, s65, 12288
v_accvgpr_read_b32 v16, a24
v_accvgpr_read_b32 v17, a25
v_accvgpr_read_b32 v18, a26
v_accvgpr_read_b32 v19, a27
v_accvgpr_read_b32 v20, a28
v_accvgpr_read_b32 v21, a29
v_accvgpr_read_b32 v22, a30
v_accvgpr_read_b32 v23, a31
v_pk_mul_f32 v[16:17], v[16:17], v[144:145]
v_pk_mul_f32 v[18:19], v[18:19], v[144:145]
v_pk_mul_f32 v[20:21], v[20:21], v[144:145]
v_pk_mul_f32 v[22:23], v[22:23], v[144:145]
v_cvt_pk_bf16_f32 v16, v16, v17
v_cvt_pk_bf16_f32 v17, v18, v19
v_cvt_pk_bf16_f32 v18, v20, v21
v_cvt_pk_bf16_f32 v19, v22, v23
buffer_store_dwordx4 v[16:19], v4, s[24:27], s48 offen offset:0 sc1
v_accvgpr_read_b32 v24, a56
v_accvgpr_read_b32 v25, a57
v_accvgpr_read_b32 v26, a58
v_accvgpr_read_b32 v27, a59
v_accvgpr_read_b32 v28, a60
v_accvgpr_read_b32 v29, a61
v_accvgpr_read_b32 v30, a62
v_accvgpr_read_b32 v31, a63
v_pk_mul_f32 v[24:25], v[24:25], v[146:147]
v_pk_mul_f32 v[26:27], v[26:27], v[146:147]
v_pk_mul_f32 v[28:29], v[28:29], v[146:147]
v_pk_mul_f32 v[30:31], v[30:31], v[146:147]
v_cvt_pk_bf16_f32 v24, v24, v25
v_cvt_pk_bf16_f32 v25, v26, v27
v_cvt_pk_bf16_f32 v26, v28, v29
v_cvt_pk_bf16_f32 v27, v30, v31
buffer_store_dwordx4 v[24:27], v4, s[24:27], s48 offen offset:1024 sc1
L_NOSE2:
v_mov_b32 v5, v216
v_mov_b32 v6, v217
v_add_u32 v7, 4096, v4
v_add_u32 v8, 8192, v4
s_and_b32 s63, s6, 3
s_lshl_b32 s56, s7, 2
s_add_u32 s56, s56, s63
s_lshr_b32 s57, s6, 2
s_add_u32 s63, s63, s57
s_mul_i32 s58, s56, 598016
s_add_u32 s58, s58, 54525952
s_mul_i32 s59, s57, 672768
s_add_u32 s59, s59, 38797312
s_lshl_b32 s66, s54, 10
s_lshr_b32 s48, s4, 3
s_lshl_b32 s48, s48, 7
s_add_u32 s66, s66, s48
s_add_u32 s66, s66, 75497472
s_add_u32 s48, s63, 0
s_and_b32 s48, s48, 3
s_lshl4_add_u32 s48, s3, s48
s_add_u32 s48, s48, 0
s_mul_i32 s48, s48, 9216
s_add_u32 s62, s59, s48
buffer_load_dwordx4 a[0:3], v4, s[24:27], s62 offen offset:0 sc1
buffer_load_dwordx4 a[4:7], v4, s[24:27], s62 offen offset:1024 sc1
buffer_load_dwordx4 a[8:11], v4, s[24:27], s62 offen offset:2048 sc1
buffer_load_dwordx4 a[12:15], v4, s[24:27], s62 offen offset:3072 sc1
buffer_load_dwordx4 a[16:19], v7, s[24:27], s62 offen offset:0 sc1
buffer_load_dwordx4 a[20:23], v7, s[24:27], s62 offen offset:1024 sc1
buffer_load_dwordx4 a[24:27], v7, s[24:27], s62 offen offset:2048 sc1
buffer_load_dwordx4 a[28:31], v7, s[24:27], s62 offen offset:3072 sc1
buffer_load_dwordx4 a[32:35], v8, s[24:27], s62 offen offset:0 sc1
s_waitcnt vmcnt(9)
buffer_atomic_add v15, v0, s[24:27], s66 offen sc1
v_mov_b32 v16, v224
v_mov_b32 v17, v225
v_mov_b32 v18, v226
v_mov_b32 v19, v227
v_mov_b32 v20, v228
v_mov_b32 v21, v229
v_mov_b32 v22, v230
v_mov_b32 v23, v231
s_add_u32 s48, s63, 1
s_and_b32 s48, s48, 3
s_lshl4_add_u32 s48, s3, s48
s_add_u32 s48, s48, 0
s_mul_i32 s48, s48, 9216
s_add_u32 s62, s59, s48
buffer_load_dwordx4 a[36:39], v4, s[24:27], s62 offen offset:0 sc1
ds_read_b128 v[96:99], v6 offset:3328
ds_read_b128 v[32:35], v6 offset:256
ds_read_b128 v[36:39], v6 offset:1024
ds_read_b128 v[100:103], v6 offset:3296
ds_read_b128 v[40:43], v6 offset:224
ds_read_b128 v[44:47], v6 offset:992
buffer_load_dwordx4 a[40:43], v4, s[24:27], s62 offen offset:1024 sc1
ds_read_b128 v[104:107], v6 offset:3264
ds_read_b128 v[48:51], v6 offset:192
ds_read_b128 v[52:55], v6 offset:960
ds_read_b128 v[108:111], v6 offset:3232
ds_read_b128 v[56:59], v6 offset:160
ds_read_b128 v[60:63], v6 offset:928
buffer_load_dwordx4 a[44:47], v4, s[24:27], s62 offen offset:2048 sc1
ds_read_b128 v[112:115], v6 offset:3200
ds_read_b128 v[64:67], v6 offset:128
ds_read_b128 v[68:71], v6 offset:896
ds_read_b128 v[116:119], v6 offset:3168
ds_read_b128 v[72:75], v6 offset:96
ds_read_b128 v[76:79], v6 offset:864
buffer_load_dwordx4 a[48:51], v4, s[24:27], s62 offen offset:3072 sc1
ds_read_b128 v[120:123], v6 offset:3136
ds_read_b128 v[80:83], v6 offset:64
ds_read_b128 v[84:87], v6 offset:832
ds_read_b128 v[124:127], v6 offset:3104
ds_read_b128 v[88:91], v6 offset:32
ds_read_b128 v[92:95], v6 offset:800
buffer_load_dwordx4 a[52:55], v7, s[24:27], s62 offen offset:0 sc1
s_waitcnt lgkmcnt(0)
ds_read_b128 v[128:131], v6 offset:1792
ds_read_b128 v[132:135], v6 offset:2560
ds_read_b128 v[136:139], v6 offset:1760
ds_read_b128 v[140:143], v6 offset:2528
ds_read_b128 v[144:147], v6 offset:1728
buffer_load_dwordx4 a[56:59], v7, s[24:27], s62 offen offset:1024 sc1
ds_read_b128 v[148:151], v6 offset:2496
ds_read_b128 v[152:155], v6 offset:1696
ds_read_b128 v[156:159], v6 offset:2464
ds_read_b128 v[160:163], v6 offset:1664
ds_read_b128 v[164:167], v6 offset:2432
ds_read_b128 v[168:171], v6 offset:1632
buffer_load_dwordx4 a[60:63], v7, s[24:27], s62 offen offset:2048 sc1
ds_read_b128 v[172:175], v6 offset:2400
ds_read_b128 v[176:179], v6 offset:1600
ds_read_b128 v[180:183], v6 offset:2368
ds_read_b128 v[184:187], v6 offset:1568
ds_read_b128 v[188:191], v6 offset:2336
v_and_b32 v9, 0xffff, v97
buffer_load_dwordx4 a[64:67], v7, s[24:27], s62 offen offset:3072 sc1
v_and_b32 v11, 0xffff0000, v97
v_dot2_f32_bf16 v24, v98, v99, 0
v_dot2_f32_bf16 v25, v102, v99, 0
v_dot2_f32_bf16 v26, v106, v99, 0
v_dot2_f32_bf16 v27, v110, v99, 0
v_dot2_f32_bf16 v28, v114, v99, 0
buffer_load_dwordx4 a[68:71], v8, s[24:27], s62 offen offset:0 sc1
v_dot2_f32_bf16 v29, v118, v99, 0
v_dot2_f32_bf16 v30, v122, v99, 0
v_dot2_f32_bf16 v31, v126, v99, 0
v_dot2_f32_bf16 v24, v96, v9, v24
v_dot2_f32_bf16 v25, v100, v9, v25
v_dot2_f32_bf16 v26, v104, v9, v26
s_add_u32 s48, s63, 2
s_and_b32 s48, s48, 3
s_lshl4_add_u32 s48, s3, s48
s_add_u32 s48, s48, 0
s_mul_i32 s48, s48, 9216
s_add_u32 s62, s59, s48
buffer_load_dwordx4 a[72:75], v4, s[24:27], s62 offen offset:0 sc1
v_dot2_f32_bf16 v27, v108, v9, v27
v_dot2_f32_bf16 v28, v112, v9, v28
v_dot2_f32_bf16 v29, v116, v9, v29
v_dot2_f32_bf16 v30, v120, v9, v30
v_dot2_f32_bf16 v31, v124, v9, v31
v_dot2_f32_bf16 v24, v16, v32, v24
buffer_load_dwordx4 a[76:79], v4, s[24:27], s62 offen offset:1024 sc1
v_dot2_f32_bf16 v25, v16, v40, v25
v_dot2_f32_bf16 v26, v16, v48, v26
v_dot2_f32_bf16 v27, v16, v56, v27
v_dot2_f32_bf16 v28, v16, v64, v28
v_dot2_f32_bf16 v29, v16, v72, v29
v_dot2_f32_bf16 v30, v16, v80, v30
buffer_load_dwordx4 a[80:83], v4, s[24:27], s62 offen offset:2048 sc1
v_dot2_f32_bf16 v31, v16, v88, v31
v_dot2_f32_bf16 v24, v17, v33, v24
v_dot2_f32_bf16 v25, v17, v41, v25
v_dot2_f32_bf16 v26, v17, v49, v26
v_dot2_f32_bf16 v27, v17, v57, v27
v_dot2_f32_bf16 v28, v17, v65, v28
buffer_load_dwordx4 a[84:87], v4, s[24:27], s62 offen offset:3072 sc1
v_dot2_f32_bf16 v29, v17, v73, v29
v_dot2_f32_bf16 v30, v17, v81, v30
v_dot2_f32_bf16 v31, v17, v89, v31
v_dot2_f32_bf16 v24, v18, v34, v24
v_dot2_f32_bf16 v25, v18, v42, v25
v_dot2_f32_bf16 v26, v18, v50, v26
buffer_load_dwordx4 a[88:91], v7, s[24:27], s62 offen offset:0 sc1
v_dot2_f32_bf16 v27, v18, v58, v27
v_dot2_f32_bf16 v28, v18, v66, v28
v_dot2_f32_bf16 v29, v18, v74, v29
v_dot2_f32_bf16 v30, v18, v82, v30
v_dot2_f32_bf16 v31, v18, v90, v31
v_dot2_f32_bf16 v24, v19, v35, v24
buffer_load_dwordx4 a[92:95], v7, s[24:27], s62 offen offset:1024 sc1
v_dot2_f32_bf16 v25, v19, v43, v25
v_dot2_f32_bf16 v26, v19, v51, v26
v_dot2_f32_bf16 v27, v19, v59, v27
v_dot2_f32_bf16 v28, v19, v67, v28
v_dot2_f32_bf16 v29, v19, v75, v29
v_dot2_f32_bf16 v30, v19, v83, v30
buffer_load_dwordx4 a[96:99], v7, s[24:27], s62 offen offset:2048 sc1
v_dot2_f32_bf16 v31, v19, v91, v31
v_dot2_f32_bf16 v24, v20, v36, v24
v_dot2_f32_bf16 v25, v20, v44, v25
v_dot2_f32_bf16 v26, v20, v52, v26
v_dot2_f32_bf16 v27, v20, v60, v27
v_dot2_f32_bf16 v28, v20, v68, v28
buffer_load_dwordx4 a[100:103], v7, s[24:27], s62 offen offset:3072 sc1
v_dot2_f32_bf16 v29, v20, v76, v29
v_dot2_f32_bf16 v30, v20, v84, v30
v_dot2_f32_bf16 v31, v20, v92, v31
v_dot2_f32_bf16 v24, v21, v37, v24
v_dot2_f32_bf16 v25, v21, v45, v25
v_dot2_f32_bf16 v26, v21, v53, v26
buffer_load_dwordx4 a[104:107], v8, s[24:27], s62 offen offset:0 sc1
v_dot2_f32_bf16 v27, v21, v61, v27
v_dot2_f32_bf16 v28, v21, v69, v28
v_dot2_f32_bf16 v29, v21, v77, v29
v_dot2_f32_bf16 v30, v21, v85, v30
v_dot2_f32_bf16 v31, v21, v93, v31
v_dot2_f32_bf16 v24, v22, v38, v24
s_add_u32 s48, s63, 3
s_and_b32 s48, s48, 3
s_lshl4_add_u32 s48, s3, s48
s_add_u32 s48, s48, 0
s_mul_i32 s48, s48, 9216
s_add_u32 s62, s59, s48
buffer_load_dwordx4 a[108:111], v4, s[24:27], s62 offen offset:0 sc1
v_dot2_f32_bf16 v25, v22, v46, v25
v_dot2_f32_bf16 v26, v22, v54, v26
v_dot2_f32_bf16 v27, v22, v62, v27
v_dot2_f32_bf16 v28, v22, v70, v28
v_dot2_f32_bf16 v29, v22, v78, v29
v_dot2_f32_bf16 v30, v22, v86, v30
buffer_load_dwordx4 a[112:115], v4, s[24:27], s62 offen offset:1024 sc1
v_dot2_f32_bf16 v31, v22, v94, v31
v_dot2_f32_bf16 v24, v23, v39, v24
v_dot2_f32_bf16 v25, v23, v47, v25
v_dot2_f32_bf16 v26, v23, v55, v26
v_dot2_f32_bf16 v27, v23, v63, v27
v_dot2_f32_bf16 v28, v23, v71, v28
buffer_load_dwordx4 a[116:119], v4, s[24:27], s62 offen offset:2048 sc1
v_dot2_f32_bf16 v29, v23, v79, v29
v_dot2_f32_bf16 v30, v23, v87, v30
v_dot2_f32_bf16 v31, v23, v95, v31
v_mov_b32 v9, 0xf149f2ca
v_mul_f32 v11, 0xbfb8aa3b, v11
v_exp_f32 v11, v11
buffer_load_dwordx4 a[120:123], v4, s[24:27], s62 offen offset:3072 sc1
v_cmp_gt_u32 vcc, 2, v5
v_cmp_gt_u32 s[84:85], 4, v5
s_nop 0
v_cndmask_b32 v25, v25, v9, vcc
v_cndmask_b32 v26, v26, v9, s[84:85]
v_cmp_gt_u32 vcc, 6, v5
buffer_load_dwordx4 a[124:127], v7, s[24:27], s62 offen offset:0 sc1
v_cmp_gt_u32 s[84:85], 8, v5
s_nop 0
v_cndmask_b32 v27, v27, v9, vcc
v_cndmask_b32 v28, v28, v9, s[84:85]
v_cmp_gt_u32 vcc, 10, v5
v_cmp_gt_u32 s[84:85], 12, v5
buffer_load_dwordx4 a[128:131], v7, s[24:27], s62 offen offset:1024 sc1
s_nop 0
v_cndmask_b32 v29, v29, v9, vcc
v_cndmask_b32 v30, v30, v9, s[84:85]
v_cmp_gt_u32 vcc, 14, v5
s_nop 0
s_nop 0
buffer_load_dwordx4 a[132:135], v7, s[24:27], s62 offen offset:2048 sc1
v_cndmask_b32 v31, v31, v9, vcc
v_max3_f32 v10, v24, v25, v26
v_max3_f32 v10, v10, v27, v28
v_max3_f32 v10, v10, v29, v30
v_max_f32 v10, v10, v31
v_sub_f32 v24, v24, v10
buffer_load_dwordx4 a[136:139], v7, s[24:27], s62 offen offset:3072 sc1
v_sub_f32 v25, v25, v10
v_sub_f32 v26, v26, v10
v_sub_f32 v27, v27, v10
v_sub_f32 v28, v28, v10
v_sub_f32 v29, v29, v10
v_sub_f32 v30, v30, v10
buffer_load_dwordx4 a[140:143], v8, s[24:27], s62 offen offset:0 sc1
v_sub_f32 v31, v31, v10
v_mul_f32 v24, 0x3eae1a93, v24
v_mul_f32 v25, 0x3eae1a93, v25
v_mul_f32 v26, 0x3eae1a93, v26
v_mul_f32 v27, 0x3eae1a93, v27
v_mul_f32 v28, 0x3eae1a93, v28
s_add_u32 s48, s63, 4
s_and_b32 s48, s48, 3
s_lshl4_add_u32 s48, s3, s48
s_add_u32 s48, s48, 4
s_mul_i32 s48, s48, 9216
s_add_u32 s62, s59, s48
buffer_load_dwordx4 a[144:147], v4, s[24:27], s62 offen offset:0 sc1
v_mul_f32 v29, 0x3eae1a93, v29
v_mul_f32 v30, 0x3eae1a93, v30
v_mul_f32 v31, 0x3eae1a93, v31
v_exp_f32 v24, v24
v_exp_f32 v25, v25
v_exp_f32 v26, v26
buffer_load_dwordx4 a[148:151], v4, s[24:27], s62 offen offset:1024 sc1
v_exp_f32 v27, v27
v_exp_f32 v28, v28
v_exp_f32 v29, v29
v_exp_f32 v30, v30
v_exp_f32 v31, v31
v_cvt_pk_bf16_f32 v32, v24, 0
buffer_load_dwordx4 a[152:155], v4, s[24:27], s62 offen offset:2048 sc1
v_cvt_pk_bf16_f32 v40, v25, 0
v_cvt_pk_bf16_f32 v48, v26, 0
v_cvt_pk_bf16_f32 v56, v27, 0
v_cvt_pk_bf16_f32 v64, v28, 0
v_cvt_pk_bf16_f32 v72, v29, 0
v_cvt_pk_bf16_f32 v80, v30, 0
buffer_load_dwordx4 a[156:159], v4, s[24:27], s62 offen offset:3072 sc1
v_cvt_pk_bf16_f32 v88, v31, 0
v_lshlrev_b32 v33, 16, v32
v_lshlrev_b32 v41, 16, v40
v_lshlrev_b32 v49, 16, v48
v_lshlrev_b32 v57, 16, v56
v_lshlrev_b32 v65, 16, v64
buffer_load_dwordx4 a[160:163], v7, s[24:27], s62 offen offset:0 sc1
v_lshlrev_b32 v73, 16, v72
v_lshlrev_b32 v81, 16, v80
v_lshlrev_b32 v89, 16, v88
v_add_f32 v10, v33, v41
v_add_f32 v10, v10, v49
v_add_f32 v10, v10, v57
buffer_load_dwordx4 a[164:167], v7, s[24:27], s62 offen offset:1024 sc1
v_add_f32 v10, v10, v65
v_add_f32 v10, v10, v73
v_add_f32 v10, v10, v81
v_add_f32 v10, v10, v89
v_fma_f32 v10, v10, v11, v10
v_rcp_f32 v10, v10
buffer_load_dwordx4 a[168:171], v7, s[24:27], s62 offen offset:2048 sc1
s_waitcnt lgkmcnt(0)
v_dot2_f32_bf16 v192, v128, v32, 0
v_dot2_f32_bf16 v193, v128, v33, 0
v_dot2_f32_bf16 v194, v129, v32, 0
v_dot2_f32_bf16 v195, v129, v33, 0
v_dot2_f32_bf16 v196, v130, v32, 0
buffer_load_dwordx4 a[172:175], v7, s[24:27], s62 offen offset:3072 sc1
v_dot2_f32_bf16 v197, v130, v33, 0
v_dot2_f32_bf16 v198, v131, v32, 0
v_dot2_f32_bf16 v199, v131, v33, 0
v_dot2_f32_bf16 v200, v132, v32, 0
v_dot2_f32_bf16 v201, v132, v33, 0
v_dot2_f32_bf16 v202, v133, v32, 0
buffer_load_dwordx4 a[176:179], v8, s[24:27], s62 offen offset:0 sc1
v_dot2_f32_bf16 v203, v133, v33, 0
v_dot2_f32_bf16 v204, v134, v32, 0
v_dot2_f32_bf16 v205, v134, v33, 0
v_dot2_f32_bf16 v206, v135, v32, 0
v_dot2_f32_bf16 v207, v135, v33, 0
v_dot2_f32_bf16 v208, v96, v33, 0
s_add_u32 s48, s63, 5
s_and_b32 s48, s48, 3
s_lshl4_add_u32 s48, s3, s48
s_add_u32 s48, s48, 4
s_mul_i32 s48, s48, 9216
s_add_u32 s62, s59, s48
buffer_load_dwordx4 a[180:183], v4, s[24:27], s62 offen offset:0 sc1
v_dot2_f32_bf16 v209, v98, v33, 0
v_dot2_f32_bf16 v192, v136, v40, v192
v_dot2_f32_bf16 v193, v136, v41, v193
v_dot2_f32_bf16 v194, v137, v40, v194
v_dot2_f32_bf16 v195, v137, v41, v195
v_dot2_f32_bf16 v196, v138, v40, v196
buffer_load_dwordx4 a[184:187], v4, s[24:27], s62 offen offset:1024 sc1
v_dot2_f32_bf16 v197, v138, v41, v197
v_dot2_f32_bf16 v198, v139, v40, v198
v_dot2_f32_bf16 v199, v139, v41, v199
v_dot2_f32_bf16 v200, v140, v40, v200
v_dot2_f32_bf16 v201, v140, v41, v201
v_dot2_f32_bf16 v202, v141, v40, v202
buffer_load_dwordx4 a[188:191], v4, s[24:27], s62 offen offset:2048 sc1
v_dot2_f32_bf16 v203, v141, v41, v203
v_dot2_f32_bf16 v204, v142, v40, v204
v_dot2_f32_bf16 v205, v142, v41, v205
v_dot2_f32_bf16 v206, v143, v40, v206
v_dot2_f32_bf16 v207, v143, v41, v207
v_dot2_f32_bf16 v208, v100, v41, v208
buffer_load_dwordx4 a[192:195], v4, s[24:27], s62 offen offset:3072 sc1
v_dot2_f32_bf16 v209, v102, v41, v209
v_dot2_f32_bf16 v192, v144, v48, v192
v_dot2_f32_bf16 v193, v144, v49, v193
v_dot2_f32_bf16 v194, v145, v48, v194
v_dot2_f32_bf16 v195, v145, v49, v195
v_dot2_f32_bf16 v196, v146, v48, v196
buffer_load_dwordx4 a[196:199], v7, s[24:27], s62 offen offset:0 sc1
v_dot2_f32_bf16 v197, v146, v49, v197
v_dot2_f32_bf16 v198, v147, v48, v198
v_dot2_f32_bf16 v199, v147, v49, v199
v_dot2_f32_bf16 v200, v148, v48, v200
v_dot2_f32_bf16 v201, v148, v49, v201
v_dot2_f32_bf16 v202, v149, v48, v202
buffer_load_dwordx4 a[200:203], v7, s[24:27], s62 offen offset:1024 sc1
v_dot2_f32_bf16 v203, v149, v49, v203
v_dot2_f32_bf16 v204, v150, v48, v204
v_dot2_f32_bf16 v205, v150, v49, v205
v_dot2_f32_bf16 v206, v151, v48, v206
v_dot2_f32_bf16 v207, v151, v49, v207
v_dot2_f32_bf16 v208, v104, v49, v208
buffer_load_dwordx4 a[204:207], v7, s[24:27], s62 offen offset:2048 sc1
v_dot2_f32_bf16 v209, v106, v49, v209
v_dot2_f32_bf16 v192, v152, v56, v192
v_dot2_f32_bf16 v193, v152, v57, v193
v_dot2_f32_bf16 v194, v153, v56, v194
v_dot2_f32_bf16 v195, v153, v57, v195
v_dot2_f32_bf16 v196, v154, v56, v196
buffer_load_dwordx4 a[208:211], v7, s[24:27], s62 offen offset:3072 sc1
v_dot2_f32_bf16 v197, v154, v57, v197
v_dot2_f32_bf16 v198, v155, v56, v198
v_dot2_f32_bf16 v199, v155, v57, v199
v_dot2_f32_bf16 v200, v156, v56, v200
v_dot2_f32_bf16 v201, v156, v57, v201
v_dot2_f32_bf16 v202, v157, v56, v202
buffer_load_dwordx4 a[212:215], v8, s[24:27], s62 offen offset:0 sc1
v_dot2_f32_bf16 v203, v157, v57, v203
v_dot2_f32_bf16 v204, v158, v56, v204
v_dot2_f32_bf16 v205, v158, v57, v205
v_dot2_f32_bf16 v206, v159, v56, v206
v_dot2_f32_bf16 v207, v159, v57, v207
v_dot2_f32_bf16 v208, v108, v57, v208
s_add_u32 s48, s63, 6
s_and_b32 s48, s48, 3
s_lshl4_add_u32 s48, s3, s48
s_add_u32 s48, s48, 4
s_mul_i32 s48, s48, 9216
s_add_u32 s62, s59, s48
buffer_load_dwordx4 a[216:219], v4, s[24:27], s62 offen offset:0 sc1
v_dot2_f32_bf16 v209, v110, v57, v209
v_dot2_f32_bf16 v192, v160, v64, v192
v_dot2_f32_bf16 v193, v160, v65, v193
v_dot2_f32_bf16 v194, v161, v64, v194
v_dot2_f32_bf16 v195, v161, v65, v195
v_dot2_f32_bf16 v196, v162, v64, v196
buffer_load_dwordx4 a[220:223], v4, s[24:27], s62 offen offset:1024 sc1
v_dot2_f32_bf16 v197, v162, v65, v197
v_dot2_f32_bf16 v198, v163, v64, v198
v_dot2_f32_bf16 v199, v163, v65, v199
v_dot2_f32_bf16 v200, v164, v64, v200
v_dot2_f32_bf16 v201, v164, v65, v201
v_dot2_f32_bf16 v202, v165, v64, v202
buffer_load_dwordx4 a[224:227], v4, s[24:27], s62 offen offset:2048 sc1
v_dot2_f32_bf16 v203, v165, v65, v203
v_dot2_f32_bf16 v204, v166, v64, v204
v_dot2_f32_bf16 v205, v166, v65, v205
v_dot2_f32_bf16 v206, v167, v64, v206
v_dot2_f32_bf16 v207, v167, v65, v207
v_dot2_f32_bf16 v208, v112, v65, v208
buffer_load_dwordx4 a[228:231], v4, s[24:27], s62 offen offset:3072 sc1
v_dot2_f32_bf16 v209, v114, v65, v209
v_dot2_f32_bf16 v192, v168, v72, v192
v_dot2_f32_bf16 v193, v168, v73, v193
v_dot2_f32_bf16 v194, v169, v72, v194
v_dot2_f32_bf16 v195, v169, v73, v195
v_dot2_f32_bf16 v196, v170, v72, v196
buffer_load_dwordx4 a[232:235], v7, s[24:27], s62 offen offset:0 sc1
v_dot2_f32_bf16 v197, v170, v73, v197
v_dot2_f32_bf16 v198, v171, v72, v198
v_dot2_f32_bf16 v199, v171, v73, v199
v_dot2_f32_bf16 v200, v172, v72, v200
v_dot2_f32_bf16 v201, v172, v73, v201
v_dot2_f32_bf16 v202, v173, v72, v202
buffer_load_dwordx4 a[236:239], v7, s[24:27], s62 offen offset:1024 sc1
v_dot2_f32_bf16 v203, v173, v73, v203
v_dot2_f32_bf16 v204, v174, v72, v204
v_dot2_f32_bf16 v205, v174, v73, v205
v_dot2_f32_bf16 v206, v175, v72, v206
v_dot2_f32_bf16 v207, v175, v73, v207
v_dot2_f32_bf16 v208, v116, v73, v208
buffer_load_dwordx4 a[240:243], v7, s[24:27], s62 offen offset:2048 sc1
v_dot2_f32_bf16 v209, v118, v73, v209
v_dot2_f32_bf16 v192, v176, v80, v192
v_dot2_f32_bf16 v193, v176, v81, v193
v_dot2_f32_bf16 v194, v177, v80, v194
v_dot2_f32_bf16 v195, v177, v81, v195
v_dot2_f32_bf16 v196, v178, v80, v196
buffer_load_dwordx4 a[244:247], v7, s[24:27], s62 offen offset:3072 sc1
v_dot2_f32_bf16 v197, v178, v81, v197
v_dot2_f32_bf16 v198, v179, v80, v198
v_dot2_f32_bf16 v199, v179, v81, v199
v_dot2_f32_bf16 v200, v180, v80, v200
v_dot2_f32_bf16 v201, v180, v81, v201
v_dot2_f32_bf16 v202, v181, v80, v202
buffer_load_dwordx4 a[248:251], v8, s[24:27], s62 offen offset:0 sc1
v_dot2_f32_bf16 v203, v181, v81, v203
v_dot2_f32_bf16 v204, v182, v80, v204
v_dot2_f32_bf16 v205, v182, v81, v205
v_dot2_f32_bf16 v206, v183, v80, v206
v_dot2_f32_bf16 v207, v183, v81, v207
v_dot2_f32_bf16 v208, v120, v81, v208
v_dot2_f32_bf16 v209, v122, v81, v209
v_dot2_f32_bf16 v192, v184, v88, v192
v_dot2_f32_bf16 v193, v184, v89, v193
v_dot2_f32_bf16 v194, v185, v88, v194
v_dot2_f32_bf16 v195, v185, v89, v195
v_dot2_f32_bf16 v196, v186, v88, v196
v_dot2_f32_bf16 v197, v186, v89, v197
v_dot2_f32_bf16 v198, v187, v88, v198
v_dot2_f32_bf16 v199, v187, v89, v199
v_dot2_f32_bf16 v200, v188, v88, v200
v_dot2_f32_bf16 v201, v188, v89, v201
v_dot2_f32_bf16 v202, v189, v88, v202
v_dot2_f32_bf16 v203, v189, v89, v203
v_dot2_f32_bf16 v204, v190, v88, v204
v_dot2_f32_bf16 v205, v190, v89, v205
v_dot2_f32_bf16 v206, v191, v88, v206
v_dot2_f32_bf16 v207, v191, v89, v207
v_dot2_f32_bf16 v208, v124, v89, v208
v_dot2_f32_bf16 v209, v126, v89, v209
v_lshlrev_b32 v9, 10, v3
v_lshl_add_u32 v9, v2, 4, v9
s_nop 0
v_mul_f32 v192, v10, v192
v_mul_f32 v193, v10, v193
v_mul_f32 v194, v10, v194
v_mul_f32 v195, v10, v195
v_mul_f32 v196, v10, v196
v_mul_f32 v197, v10, v197
v_mul_f32 v198, v10, v198
v_mul_f32 v199, v10, v199
v_mul_f32 v200, v10, v200
v_mul_f32 v201, v10, v201
v_mul_f32 v202, v10, v202
v_mul_f32 v203, v10, v203
v_mul_f32 v204, v10, v204
v_mul_f32 v205, v10, v205
v_mul_f32 v206, v10, v206
v_mul_f32 v207, v10, v207
v_mul_f32 v208, v10, v208
v_mul_f32 v209, v10, v209
v_cvt_pk_bf16_f32 v192, v192, v193
v_cvt_pk_bf16_f32 v193, v194, v195
v_cvt_pk_bf16_f32 v194, v196, v197
v_cvt_pk_bf16_f32 v195, v198, v199
v_cvt_pk_bf16_f32 v196, v200, v201
v_cvt_pk_bf16_f32 v197, v202, v203
v_cvt_pk_bf16_f32 v198, v204, v205
v_cvt_pk_bf16_f32 v199, v206, v207
v_cvt_pk_bf16_f32 v200, v208, v209
s_mul_i32 s49, s54, 598016
s_add_u32 s49, s49, 54525952
s_lshr_b32 s50, s4, 1
s_add_u32 s50, s50, 128
s_lshl_b32 s50, s50, 12
s_add_u32 s50, s50, s49
s_and_b32 s51, s4, 1
s_lshl_b32 s51, s51, 9
s_add_u32 s50, s50, s51
buffer_store_dwordx4 v[192:195], v9, s[24:27], s50 offen sc1
buffer_store_dwordx4 v[196:199], v9, s[24:27], s50 offen offset:256 sc1
s_lshr_b32 s50, s4, 4
s_add_u32 s50, s50, 144
s_lshl_b32 s50, s50, 12
s_add_u32 s50, s50, s49
s_bfe_u32 s51, s4, 131074
s_lshl_b32 s51, s51, 8
s_add_u32 s50, s50, s51
s_and_b32 s51, s4, 3
s_lshl_b32 s51, s51, 2
s_add_u32 s50, s50, s51
buffer_store_dword v200, v9, s[24:27], s50 offen sc1
s_lshl_b32 s51, s56, 10
s_add_u32 s51, s51, 75497472
s_lshl_b32 s50, s3, 7
v_mov_b32 v10, s50
v_and_b32 v11, 3, v1
v_lshlrev_b32 v11, 7, v11
buffer_load_dword v12, v10, s[24:27], s51 offen sc1
s_waitcnt vmcnt(0)
buffer_atomic_add v15, v0, s[24:27], s66 offen offset:4 sc1
v_cmp_gt_u32 vcc, 8, v12
s_nop 4
s_cbranch_vccnz CK_ZB
CK_ZB_R:
s_add_u32 s48, s63, 0
s_and_b32 s48, s48, 3
s_lshl4_add_u32 s48, s3, s48
s_add_u32 s48, s48, 0
s_mul_i32 s48, s48, 8192
s_add_u32 s61, s58, s48
buffer_load_dwordx4 v[128:131], v4, s[24:27], s61 offen offset:0 sc1
buffer_load_dwordx4 v[132:135], v4, s[24:27], s61 offen offset:1024 sc1
buffer_load_dwordx4 v[136:139], v4, s[24:27], s61 offen offset:2048 sc1
buffer_load_dwordx4 v[140:143], v4, s[24:27], s61 offen offset:3072 sc1
buffer_load_dwordx4 v[144:147], v7, s[24:27], s61 offen offset:0 sc1
buffer_load_dwordx4 v[148:151], v7, s[24:27], s61 offen offset:1024 sc1
buffer_load_dwordx4 v[152:155], v7, s[24:27], s61 offen offset:2048 sc1
buffer_load_dwordx4 v[156:159], v7, s[24:27], s61 offen offset:3072 sc1
s_add_u32 s48, s63, 1
s_and_b32 s48, s48, 3
s_lshl4_add_u32 s48, s3, s48
s_add_u32 s48, s48, 0
s_mul_i32 s48, s48, 8192
s_add_u32 s61, s58, s48
buffer_load_dwordx4 v[160:163], v4, s[24:27], s61 offen offset:0 sc1
buffer_load_dwordx4 v[164:167], v4, s[24:27], s61 offen offset:1024 sc1
buffer_load_dwordx4 v[168:171], v4, s[24:27], s61 offen offset:2048 sc1
buffer_load_dwordx4 v[172:175], v4, s[24:27], s61 offen offset:3072 sc1
buffer_load_dwordx4 v[176:179], v7, s[24:27], s61 offen offset:0 sc1
buffer_load_dwordx4 v[180:183], v7, s[24:27], s61 offen offset:1024 sc1
buffer_load_dwordx4 v[184:187], v7, s[24:27], s61 offen offset:2048 sc1
buffer_load_dwordx4 v[188:191], v7, s[24:27], s61 offen offset:3072 sc1
s_waitcnt vmcnt(8)
v_mfma_f32_16x16x32_bf16 v[32:35], a[0:3], v[128:131], 0
s_add_u32 s48, s63, 2
s_and_b32 s48, s48, 3
v_mfma_f32_16x16x32_bf16 v[56:59], a[0:3], v[132:135], 0
s_lshl4_add_u32 s48, s3, s48
s_add_u32 s48, s48, 0
v_mfma_f32_16x16x32_bf16 v[80:83], a[0:3], v[136:139], 0
s_mul_i32 s48, s48, 8192
s_add_u32 s61, s58, s48
v_mfma_f32_16x16x32_bf16 v[104:107], a[0:3], v[140:143], 0
buffer_load_dwordx4 v[192:195], v4, s[24:27], s61 offen offset:0 sc1
v_mfma_f32_16x16x32_bf16 v[36:39], a[4:7], v[128:131], 0
v_mfma_f32_16x16x32_bf16 v[60:63], a[4:7], v[132:135], 0
buffer_load_dwordx4 v[196:199], v4, s[24:27], s61 offen offset:1024 sc1
v_mfma_f32_16x16x32_bf16 v[84:87], a[4:7], v[136:139], 0
v_mfma_f32_16x16x32_bf16 v[108:111], a[4:7], v[140:143], 0
buffer_load_dwordx4 v[200:203], v4, s[24:27], s61 offen offset:2048 sc1
v_mfma_f32_16x16x32_bf16 v[40:43], a[8:11], v[128:131], 0
v_mfma_f32_16x16x32_bf16 v[64:67], a[8:11], v[132:135], 0
buffer_load_dwordx4 v[204:207], v4, s[24:27], s61 offen offset:3072 sc1
v_mfma_f32_16x16x32_bf16 v[88:91], a[8:11], v[136:139], 0
v_mfma_f32_16x16x32_bf16 v[112:115], a[8:11], v[140:143], 0
buffer_load_dwordx4 v[208:211], v7, s[24:27], s61 offen offset:0 sc1
v_mfma_f32_16x16x32_bf16 v[44:47], a[12:15], v[128:131], 0
v_mfma_f32_16x16x32_bf16 v[68:71], a[12:15], v[132:135], 0
buffer_load_dwordx4 v[212:215], v7, s[24:27], s61 offen offset:1024 sc1
v_mfma_f32_16x16x32_bf16 v[92:95], a[12:15], v[136:139], 0
v_mfma_f32_16x16x32_bf16 v[116:119], a[12:15], v[140:143], 0
buffer_load_dwordx4 v[216:219], v7, s[24:27], s61 offen offset:2048 sc1
v_mfma_f32_16x16x32_bf16 v[48:51], a[32:35], v[128:131], 0
v_mfma_f32_16x16x32_bf16 v[72:75], a[32:35], v[132:135], 0
buffer_load_dwordx4 v[220:223], v7, s[24:27], s61 offen offset:3072 sc1
v_mfma_f32_16x16x32_bf16 v[96:99], a[32:35], v[136:139], 0
v_mfma_f32_16x16x32_bf16 v[120:123], a[32:35], v[140:143], 0
v_mfma_f32_16x16x32_bf16 v[32:35], a[16:19], v[144:147], v[32:35]
v_mfma_f32_16x16x32_bf16 v[56:59], a[16:19], v[148:151], v[56:59]
v_mfma_f32_16x16x32_bf16 v[80:83], a[16:19], v[152:155], v[80:83]
v_mfma_f32_16x16x32_bf16 v[104:107], a[16:19], v[156:159], v[104:107]
v_mfma_f32_16x16x32_bf16 v[36:39], a[20:23], v[144:147], v[36:39]
v_mfma_f32_16x16x32_bf16 v[60:63], a[20:23], v[148:151], v[60:63]
v_mfma_f32_16x16x32_bf16 v[84:87], a[20:23], v[152:155], v[84:87]
v_mfma_f32_16x16x32_bf16 v[108:111], a[20:23], v[156:159], v[108:111]
v_mfma_f32_16x16x32_bf16 v[40:43], a[24:27], v[144:147], v[40:43]
v_mfma_f32_16x16x32_bf16 v[64:67], a[24:27], v[148:151], v[64:67]
v_mfma_f32_16x16x32_bf16 v[88:91], a[24:27], v[152:155], v[88:91]
v_mfma_f32_16x16x32_bf16 v[112:115], a[24:27], v[156:159], v[112:115]
v_mfma_f32_16x16x32_bf16 v[44:47], a[28:31], v[144:147], v[44:47]
v_mfma_f32_16x16x32_bf16 v[68:71], a[28:31], v[148:151], v[68:71]
v_mfma_f32_16x16x32_bf16 v[92:95], a[28:31], v[152:155], v[92:95]
v_mfma_f32_16x16x32_bf16 v[116:119], a[28:31], v[156:159], v[116:119]
v_mfma_f32_16x16x32_bf16 v[52:55], a[32:35], v[144:147], 0
v_mfma_f32_16x16x32_bf16 v[76:79], a[32:35], v[148:151], 0
v_mfma_f32_16x16x32_bf16 v[100:103], a[32:35], v[152:155], 0
v_mfma_f32_16x16x32_bf16 v[124:127], a[32:35], v[156:159], 0
s_waitcnt vmcnt(8)
v_mfma_f32_16x16x32_bf16 v[32:35], a[36:39], v[160:163], v[32:35]
s_add_u32 s48, s63, 3
s_and_b32 s48, s48, 3
v_mfma_f32_16x16x32_bf16 v[56:59], a[36:39], v[164:167], v[56:59]
s_lshl4_add_u32 s48, s3, s48
s_add_u32 s48, s48, 0
v_mfma_f32_16x16x32_bf16 v[80:83], a[36:39], v[168:171], v[80:83]
s_mul_i32 s48, s48, 8192
s_add_u32 s61, s58, s48
v_mfma_f32_16x16x32_bf16 v[104:107], a[36:39], v[172:175], v[104:107]
buffer_load_dwordx4 v[128:131], v4, s[24:27], s61 offen offset:0 sc1
v_mfma_f32_16x16x32_bf16 v[36:39], a[40:43], v[160:163], v[36:39]
v_mfma_f32_16x16x32_bf16 v[60:63], a[40:43], v[164:167], v[60:63]
buffer_load_dwordx4 v[132:135], v4, s[24:27], s61 offen offset:1024 sc1
v_mfma_f32_16x16x32_bf16 v[84:87], a[40:43], v[168:171], v[84:87]
v_mfma_f32_16x16x32_bf16 v[108:111], a[40:43], v[172:175], v[108:111]
buffer_load_dwordx4 v[136:139], v4, s[24:27], s61 offen offset:2048 sc1
v_mfma_f32_16x16x32_bf16 v[40:43], a[44:47], v[160:163], v[40:43]
v_mfma_f32_16x16x32_bf16 v[64:67], a[44:47], v[164:167], v[64:67]
buffer_load_dwordx4 v[140:143], v4, s[24:27], s61 offen offset:3072 sc1
v_mfma_f32_16x16x32_bf16 v[88:91], a[44:47], v[168:171], v[88:91]
v_mfma_f32_16x16x32_bf16 v[112:115], a[44:47], v[172:175], v[112:115]
buffer_load_dwordx4 v[144:147], v7, s[24:27], s61 offen offset:0 sc1
v_mfma_f32_16x16x32_bf16 v[44:47], a[48:51], v[160:163], v[44:47]
v_mfma_f32_16x16x32_bf16 v[68:71], a[48:51], v[164:167], v[68:71]
buffer_load_dwordx4 v[148:151], v7, s[24:27], s61 offen offset:1024 sc1
v_mfma_f32_16x16x32_bf16 v[92:95], a[48:51], v[168:171], v[92:95]
v_mfma_f32_16x16x32_bf16 v[116:119], a[48:51], v[172:175], v[116:119]
buffer_load_dwordx4 v[152:155], v7, s[24:27], s61 offen offset:2048 sc1
v_mfma_f32_16x16x32_bf16 v[48:51], a[68:71], v[160:163], v[48:51]
v_mfma_f32_16x16x32_bf16 v[72:75], a[68:71], v[164:167], v[72:75]
buffer_load_dwordx4 v[156:159], v7, s[24:27], s61 offen offset:3072 sc1
v_mfma_f32_16x16x32_bf16 v[96:99], a[68:71], v[168:171], v[96:99]
v_mfma_f32_16x16x32_bf16 v[120:123], a[68:71], v[172:175], v[120:123]
s_add_u32 s48, s63, 7
s_and_b32 s48, s48, 3
v_mfma_f32_16x16x32_bf16 v[32:35], a[52:55], v[176:179], v[32:35]
s_lshl4_add_u32 s48, s3, s48
s_add_u32 s48, s48, 4
v_mfma_f32_16x16x32_bf16 v[56:59], a[52:55], v[180:183], v[56:59]
s_mul_i32 s48, s48, 9216
s_add_u32 s62, s59, s48
v_mfma_f32_16x16x32_bf16 v[80:83], a[52:55], v[184:187], v[80:83]
buffer_load_dwordx4 a[0:3], v4, s[24:27], s62 offen offset:0 sc1
v_mfma_f32_16x16x32_bf16 v[104:107], a[52:55], v[188:191], v[104:107]
v_mfma_f32_16x16x32_bf16 v[36:39], a[56:59], v[176:179], v[36:39]
buffer_load_dwordx4 a[4:7], v4, s[24:27], s62 offen offset:1024 sc1
v_mfma_f32_16x16x32_bf16 v[60:63], a[56:59], v[180:183], v[60:63]
v_mfma_f32_16x16x32_bf16 v[84:87], a[56:59], v[184:187], v[84:87]
buffer_load_dwordx4 a[8:11], v4, s[24:27], s62 offen offset:2048 sc1
v_mfma_f32_16x16x32_bf16 v[108:111], a[56:59], v[188:191], v[108:111]
v_mfma_f32_16x16x32_bf16 v[40:43], a[60:63], v[176:179], v[40:43]
buffer_load_dwordx4 a[12:15], v4, s[24:27], s62 offen offset:3072 sc1
v_mfma_f32_16x16x32_bf16 v[64:67], a[60:63], v[180:183], v[64:67]
v_mfma_f32_16x16x32_bf16 v[88:91], a[60:63], v[184:187], v[88:91]
buffer_load_dwordx4 a[16:19], v7, s[24:27], s62 offen offset:0 sc1
v_mfma_f32_16x16x32_bf16 v[112:115], a[60:63], v[188:191], v[112:115]
v_mfma_f32_16x16x32_bf16 v[44:47], a[64:67], v[176:179], v[44:47]
buffer_load_dwordx4 a[20:23], v7, s[24:27], s62 offen offset:1024 sc1
v_mfma_f32_16x16x32_bf16 v[68:71], a[64:67], v[180:183], v[68:71]
v_mfma_f32_16x16x32_bf16 v[92:95], a[64:67], v[184:187], v[92:95]
buffer_load_dwordx4 a[24:27], v7, s[24:27], s62 offen offset:2048 sc1
v_mfma_f32_16x16x32_bf16 v[116:119], a[64:67], v[188:191], v[116:119]
v_mfma_f32_16x16x32_bf16 v[52:55], a[68:71], v[176:179], v[52:55]
v_mfma_f32_16x16x32_bf16 v[76:79], a[68:71], v[180:183], v[76:79]
v_mfma_f32_16x16x32_bf16 v[100:103], a[68:71], v[184:187], v[100:103]
v_mfma_f32_16x16x32_bf16 v[124:127], a[68:71], v[188:191], v[124:127]
s_waitcnt vmcnt(15)
v_mfma_f32_16x16x32_bf16 v[32:35], a[72:75], v[192:195], v[32:35]
s_add_u32 s48, s63, 4
s_and_b32 s48, s48, 3
v_mfma_f32_16x16x32_bf16 v[56:59], a[72:75], v[196:199], v[56:59]
s_lshl4_add_u32 s48, s3, s48
s_add_u32 s48, s48, 4
v_mfma_f32_16x16x32_bf16 v[80:83], a[72:75], v[200:203], v[80:83]
s_mul_i32 s48, s48, 8192
s_add_u32 s61, s58, s48
v_mfma_f32_16x16x32_bf16 v[104:107], a[72:75], v[204:207], v[104:107]
buffer_load_dwordx4 v[160:163], v4, s[24:27], s61 offen offset:0 sc1
v_mfma_f32_16x16x32_bf16 v[36:39], a[76:79], v[192:195], v[36:39]
v_mfma_f32_16x16x32_bf16 v[60:63], a[76:79], v[196:199], v[60:63]
buffer_load_dwordx4 v[164:167], v4, s[24:27], s61 offen offset:1024 sc1
v_mfma_f32_16x16x32_bf16 v[84:87], a[76:79], v[200:203], v[84:87]
v_mfma_f32_16x16x32_bf16 v[108:111], a[76:79], v[204:207], v[108:111]
buffer_load_dwordx4 v[168:171], v4, s[24:27], s61 offen offset:2048 sc1
v_mfma_f32_16x16x32_bf16 v[40:43], a[80:83], v[192:195], v[40:43]
v_mfma_f32_16x16x32_bf16 v[64:67], a[80:83], v[196:199], v[64:67]
buffer_load_dwordx4 v[172:175], v4, s[24:27], s61 offen offset:3072 sc1
v_mfma_f32_16x16x32_bf16 v[88:91], a[80:83], v[200:203], v[88:91]
v_mfma_f32_16x16x32_bf16 v[112:115], a[80:83], v[204:207], v[112:115]
buffer_load_dwordx4 v[176:179], v7, s[24:27], s61 offen offset:0 sc1
v_mfma_f32_16x16x32_bf16 v[44:47], a[84:87], v[192:195], v[44:47]
v_mfma_f32_16x16x32_bf16 v[68:71], a[84:87], v[196:199], v[68:71]
buffer_load_dwordx4 v[180:183], v7, s[24:27], s61 offen offset:1024 sc1
v_mfma_f32_16x16x32_bf16 v[92:95], a[84:87], v[200:203], v[92:95]
v_mfma_f32_16x16x32_bf16 v[116:119], a[84:87], v[204:207], v[116:119]
buffer_load_dwordx4 v[184:187], v7, s[24:27], s61 offen offset:2048 sc1
v_mfma_f32_16x16x32_bf16 v[48:51], a[104:107], v[192:195], v[48:51]
v_mfma_f32_16x16x32_bf16 v[72:75], a[104:107], v[196:199], v[72:75]
buffer_load_dwordx4 v[188:191], v7, s[24:27], s61 offen offset:3072 sc1
v_mfma_f32_16x16x32_bf16 v[96:99], a[104:107], v[200:203], v[96:99]
v_mfma_f32_16x16x32_bf16 v[120:123], a[104:107], v[204:207], v[120:123]
buffer_load_dwordx4 a[28:31], v7, s[24:27], s62 offen offset:3072 sc1
v_mfma_f32_16x16x32_bf16 v[32:35], a[88:91], v[208:211], v[32:35]
v_mfma_f32_16x16x32_bf16 v[56:59], a[88:91], v[212:215], v[56:59]
buffer_load_dwordx4 a[32:35], v8, s[24:27], s62 offen offset:0 sc1
v_mfma_f32_16x16x32_bf16 v[80:83], a[88:91], v[216:219], v[80:83]
v_mfma_f32_16x16x32_bf16 v[104:107], a[88:91], v[220:223], v[104:107]
s_add_u32 s48, s63, 8
s_and_b32 s48, s48, 3
v_mfma_f32_16x16x32_bf16 v[36:39], a[92:95], v[208:211], v[36:39]
s_lshl4_add_u32 s48, s3, s48
s_add_u32 s48, s48, 8
v_mfma_f32_16x16x32_bf16 v[60:63], a[92:95], v[212:215], v[60:63]
s_mul_i32 s48, s48, 9216
s_add_u32 s62, s59, s48
v_mfma_f32_16x16x32_bf16 v[84:87], a[92:95], v[216:219], v[84:87]
buffer_load_dwordx4 a[36:39], v4, s[24:27], s62 offen offset:0 sc1
v_mfma_f32_16x16x32_bf16 v[108:111], a[92:95], v[220:223], v[108:111]
v_mfma_f32_16x16x32_bf16 v[40:43], a[96:99], v[208:211], v[40:43]
buffer_load_dwordx4 a[40:43], v4, s[24:27], s62 offen offset:1024 sc1
v_mfma_f32_16x16x32_bf16 v[64:67], a[96:99], v[212:215], v[64:67]
v_mfma_f32_16x16x32_bf16 v[88:91], a[96:99], v[216:219], v[88:91]
buffer_load_dwordx4 a[44:47], v4, s[24:27], s62 offen offset:2048 sc1
v_mfma_f32_16x16x32_bf16 v[112:115], a[96:99], v[220:223], v[112:115]
v_mfma_f32_16x16x32_bf16 v[44:47], a[100:103], v[208:211], v[44:47]
buffer_load_dwordx4 a[48:51], v4, s[24:27], s62 offen offset:3072 sc1
v_mfma_f32_16x16x32_bf16 v[68:71], a[100:103], v[212:215], v[68:71]
v_mfma_f32_16x16x32_bf16 v[92:95], a[100:103], v[216:219], v[92:95]
buffer_load_dwordx4 a[52:55], v7, s[24:27], s62 offen offset:0 sc1
v_mfma_f32_16x16x32_bf16 v[116:119], a[100:103], v[220:223], v[116:119]
v_mfma_f32_16x16x32_bf16 v[52:55], a[104:107], v[208:211], v[52:55]
v_mfma_f32_16x16x32_bf16 v[76:79], a[104:107], v[212:215], v[76:79]
v_mfma_f32_16x16x32_bf16 v[100:103], a[104:107], v[216:219], v[100:103]
v_mfma_f32_16x16x32_bf16 v[124:127], a[104:107], v[220:223], v[124:127]
s_waitcnt vmcnt(22)
v_mfma_f32_16x16x32_bf16 v[32:35], a[108:111], v[128:131], v[32:35]
s_add_u32 s48, s63, 5
s_and_b32 s48, s48, 3
v_mfma_f32_16x16x32_bf16 v[56:59], a[108:111], v[132:135], v[56:59]
s_lshl4_add_u32 s48, s3, s48
s_add_u32 s48, s48, 4
v_mfma_f32_16x16x32_bf16 v[80:83], a[108:111], v[136:139], v[80:83]
s_mul_i32 s48, s48, 8192
s_add_u32 s61, s58, s48
v_mfma_f32_16x16x32_bf16 v[104:107], a[108:111], v[140:143], v[104:107]
buffer_load_dwordx4 v[192:195], v4, s[24:27], s61 offen offset:0 sc1
v_mfma_f32_16x16x32_bf16 v[36:39], a[112:115], v[128:131], v[36:39]
v_mfma_f32_16x16x32_bf16 v[60:63], a[112:115], v[132:135], v[60:63]
buffer_load_dwordx4 v[196:199], v4, s[24:27], s61 offen offset:1024 sc1
v_mfma_f32_16x16x32_bf16 v[84:87], a[112:115], v[136:139], v[84:87]
v_mfma_f32_16x16x32_bf16 v[108:111], a[112:115], v[140:143], v[108:111]
buffer_load_dwordx4 v[200:203], v4, s[24:27], s61 offen offset:2048 sc1
v_mfma_f32_16x16x32_bf16 v[40:43], a[116:119], v[128:131], v[40:43]
v_mfma_f32_16x16x32_bf16 v[64:67], a[116:119], v[132:135], v[64:67]
buffer_load_dwordx4 v[204:207], v4, s[24:27], s61 offen offset:3072 sc1
v_mfma_f32_16x16x32_bf16 v[88:91], a[116:119], v[136:139], v[88:91]
v_mfma_f32_16x16x32_bf16 v[112:115], a[116:119], v[140:143], v[112:115]
buffer_load_dwordx4 v[208:211], v7, s[24:27], s61 offen offset:0 sc1
v_mfma_f32_16x16x32_bf16 v[44:47], a[120:123], v[128:131], v[44:47]
v_mfma_f32_16x16x32_bf16 v[68:71], a[120:123], v[132:135], v[68:71]
buffer_load_dwordx4 v[212:215], v7, s[24:27], s61 offen offset:1024 sc1
v_mfma_f32_16x16x32_bf16 v[92:95], a[120:123], v[136:139], v[92:95]
v_mfma_f32_16x16x32_bf16 v[116:119], a[120:123], v[140:143], v[116:119]
buffer_load_dwordx4 v[216:219], v7, s[24:27], s61 offen offset:2048 sc1
v_mfma_f32_16x16x32_bf16 v[48:51], a[140:143], v[128:131], v[48:51]
v_mfma_f32_16x16x32_bf16 v[72:75], a[140:143], v[132:135], v[72:75]
buffer_load_dwordx4 v[220:223], v7, s[24:27], s61 offen offset:3072 sc1
v_mfma_f32_16x16x32_bf16 v[96:99], a[140:143], v[136:139], v[96:99]
v_mfma_f32_16x16x32_bf16 v[120:123], a[140:143], v[140:143], v[120:123]
buffer_load_dwordx4 a[56:59], v7, s[24:27], s62 offen offset:1024 sc1
v_mfma_f32_16x16x32_bf16 v[32:35], a[124:127], v[144:147], v[32:35]
v_mfma_f32_16x16x32_bf16 v[56:59], a[124:127], v[148:151], v[56:59]
buffer_load_dwordx4 a[60:63], v7, s[24:27], s62 offen offset:2048 sc1
v_mfma_f32_16x16x32_bf16 v[80:83], a[124:127], v[152:155], v[80:83]
v_mfma_f32_16x16x32_bf16 v[104:107], a[124:127], v[156:159], v[104:107]
buffer_load_dwordx4 a[64:67], v7, s[24:27], s62 offen offset:3072 sc1
v_mfma_f32_16x16x32_bf16 v[36:39], a[128:131], v[144:147], v[36:39]
v_mfma_f32_16x16x32_bf16 v[60:63], a[128:131], v[148:151], v[60:63]
buffer_load_dwordx4 a[68:71], v8, s[24:27], s62 offen offset:0 sc1
v_mfma_f32_16x16x32_bf16 v[84:87], a[128:131], v[152:155], v[84:87]
v_mfma_f32_16x16x32_bf16 v[108:111], a[128:131], v[156:159], v[108:111]
s_add_u32 s48, s63, 9
s_and_b32 s48, s48, 3
v_mfma_f32_16x16x32_bf16 v[40:43], a[132:135], v[144:147], v[40:43]
s_lshl4_add_u32 s48, s3, s48
s_add_u32 s48, s48, 8
v_mfma_f32_16x16x32_bf16 v[64:67], a[132:135], v[148:151], v[64:67]
s_mul_i32 s48, s48, 9216
s_add_u32 s62, s59, s48
v_mfma_f32_16x16x32_bf16 v[88:91], a[132:135], v[152:155], v[88:91]
buffer_load_dwordx4 a[72:75], v4, s[24:27], s62 offen offset:0 sc1
v_mfma_f32_16x16x32_bf16 v[112:115], a[132:135], v[156:159], v[112:115]
v_mfma_f32_16x16x32_bf16 v[44:47], a[136:139], v[144:147], v[44:47]
buffer_load_dwordx4 a[76:79], v4, s[24:27], s62 offen offset:1024 sc1
v_mfma_f32_16x16x32_bf16 v[68:71], a[136:139], v[148:151], v[68:71]
v_mfma_f32_16x16x32_bf16 v[92:95], a[136:139], v[152:155], v[92:95]
buffer_load_dwordx4 a[80:83], v4, s[24:27], s62 offen offset:2048 sc1
v_mfma_f32_16x16x32_bf16 v[116:119], a[136:139], v[156:159], v[116:119]
v_mfma_f32_16x16x32_bf16 v[52:55], a[140:143], v[144:147], v[52:55]
v_mfma_f32_16x16x32_bf16 v[76:79], a[140:143], v[148:151], v[76:79]
v_mfma_f32_16x16x32_bf16 v[100:103], a[140:143], v[152:155], v[100:103]
v_mfma_f32_16x16x32_bf16 v[124:127], a[140:143], v[156:159], v[124:127]
s_waitcnt vmcnt(22)
v_mfma_f32_16x16x32_bf16 v[32:35], a[144:147], v[160:163], v[32:35]
s_add_u32 s48, s63, 6
s_and_b32 s48, s48, 3
v_mfma_f32_16x16x32_bf16 v[56:59], a[144:147], v[164:167], v[56:59]
s_lshl4_add_u32 s48, s3, s48
s_add_u32 s48, s48, 4
v_mfma_f32_16x16x32_bf16 v[80:83], a[144:147], v[168:171], v[80:83]
s_mul_i32 s48, s48, 8192
s_add_u32 s61, s58, s48
v_mfma_f32_16x16x32_bf16 v[104:107], a[144:147], v[172:175], v[104:107]
buffer_load_dwordx4 v[128:131], v4, s[24:27], s61 offen offset:0 sc1
v_mfma_f32_16x16x32_bf16 v[36:39], a[148:151], v[160:163], v[36:39]
v_mfma_f32_16x16x32_bf16 v[60:63], a[148:151], v[164:167], v[60:63]
buffer_load_dwordx4 v[132:135], v4, s[24:27], s61 offen offset:1024 sc1
v_mfma_f32_16x16x32_bf16 v[84:87], a[148:151], v[168:171], v[84:87]
v_mfma_f32_16x16x32_bf16 v[108:111], a[148:151], v[172:175], v[108:111]
buffer_load_dwordx4 v[136:139], v4, s[24:27], s61 offen offset:2048 sc1
v_mfma_f32_16x16x32_bf16 v[40:43], a[152:155], v[160:163], v[40:43]
v_mfma_f32_16x16x32_bf16 v[64:67], a[152:155], v[164:167], v[64:67]
buffer_load_dwordx4 v[140:143], v4, s[24:27], s61 offen offset:3072 sc1
v_mfma_f32_16x16x32_bf16 v[88:91], a[152:155], v[168:171], v[88:91]
v_mfma_f32_16x16x32_bf16 v[112:115], a[152:155], v[172:175], v[112:115]
buffer_load_dwordx4 v[144:147], v7, s[24:27], s61 offen offset:0 sc1
v_mfma_f32_16x16x32_bf16 v[44:47], a[156:159], v[160:163], v[44:47]
v_mfma_f32_16x16x32_bf16 v[68:71], a[156:159], v[164:167], v[68:71]
buffer_load_dwordx4 v[148:151], v7, s[24:27], s61 offen offset:1024 sc1
v_mfma_f32_16x16x32_bf16 v[92:95], a[156:159], v[168:171], v[92:95]
v_mfma_f32_16x16x32_bf16 v[116:119], a[156:159], v[172:175], v[116:119]
buffer_load_dwordx4 v[152:155], v7, s[24:27], s61 offen offset:2048 sc1
v_mfma_f32_16x16x32_bf16 v[48:51], a[176:179], v[160:163], v[48:51]
v_mfma_f32_16x16x32_bf16 v[72:75], a[176:179], v[164:167], v[72:75]
buffer_load_dwordx4 v[156:159], v7, s[24:27], s61 offen offset:3072 sc1
v_mfma_f32_16x16x32_bf16 v[96:99], a[176:179], v[168:171], v[96:99]
v_mfma_f32_16x16x32_bf16 v[120:123], a[176:179], v[172:175], v[120:123]
buffer_load_dwordx4 a[84:87], v4, s[24:27], s62 offen offset:3072 sc1
v_mfma_f32_16x16x32_bf16 v[32:35], a[160:163], v[176:179], v[32:35]
v_mfma_f32_16x16x32_bf16 v[56:59], a[160:163], v[180:183], v[56:59]
buffer_load_dwordx4 a[88:91], v7, s[24:27], s62 offen offset:0 sc1
v_mfma_f32_16x16x32_bf16 v[80:83], a[160:163], v[184:187], v[80:83]
v_mfma_f32_16x16x32_bf16 v[104:107], a[160:163], v[188:191], v[104:107]
buffer_load_dwordx4 a[92:95], v7, s[24:27], s62 offen offset:1024 sc1
v_mfma_f32_16x16x32_bf16 v[36:39], a[164:167], v[176:179], v[36:39]
v_mfma_f32_16x16x32_bf16 v[60:63], a[164:167], v[180:183], v[60:63]
buffer_load_dwordx4 a[96:99], v7, s[24:27], s62 offen offset:2048 sc1
v_mfma_f32_16x16x32_bf16 v[84:87], a[164:167], v[184:187], v[84:87]
v_mfma_f32_16x16x32_bf16 v[108:111], a[164:167], v[188:191], v[108:111]
buffer_load_dwordx4 a[100:103], v7, s[24:27], s62 offen offset:3072 sc1
v_mfma_f32_16x16x32_bf16 v[40:43], a[168:171], v[176:179], v[40:43]
v_mfma_f32_16x16x32_bf16 v[64:67], a[168:171], v[180:183], v[64:67]
buffer_load_dwordx4 a[104:107], v8, s[24:27], s62 offen offset:0 sc1
v_mfma_f32_16x16x32_bf16 v[88:91], a[168:171], v[184:187], v[88:91]
v_mfma_f32_16x16x32_bf16 v[112:115], a[168:171], v[188:191], v[112:115]
s_add_u32 s48, s63, 10
s_and_b32 s48, s48, 3
v_mfma_f32_16x16x32_bf16 v[44:47], a[172:175], v[176:179], v[44:47]
s_lshl4_add_u32 s48, s3, s48
s_add_u32 s48, s48, 8
v_mfma_f32_16x16x32_bf16 v[68:71], a[172:175], v[180:183], v[68:71]
s_mul_i32 s48, s48, 9216
s_add_u32 s62, s59, s48
v_mfma_f32_16x16x32_bf16 v[92:95], a[172:175], v[184:187], v[92:95]
buffer_load_dwordx4 a[108:111], v4, s[24:27], s62 offen offset:0 sc1
v_mfma_f32_16x16x32_bf16 v[116:119], a[172:175], v[188:191], v[116:119]
v_mfma_f32_16x16x32_bf16 v[52:55], a[176:179], v[176:179], v[52:55]
v_mfma_f32_16x16x32_bf16 v[76:79], a[176:179], v[180:183], v[76:79]
v_mfma_f32_16x16x32_bf16 v[100:103], a[176:179], v[184:187], v[100:103]
v_mfma_f32_16x16x32_bf16 v[124:127], a[176:179], v[188:191], v[124:127]
s_waitcnt vmcnt(22)
v_mfma_f32_16x16x32_bf16 v[32:35], a[180:183], v[192:195], v[32:35]
s_add_u32 s48, s63, 7
s_and_b32 s48, s48, 3
v_mfma_f32_16x16x32_bf16 v[56:59], a[180:183], v[196:199], v[56:59]
s_lshl4_add_u32 s48, s3, s48
s_add_u32 s48, s48, 4
v_mfma_f32_16x16x32_bf16 v[80:83], a[180:183], v[200:203], v[80:83]
s_mul_i32 s48, s48, 8192
s_add_u32 s61, s58, s48
v_mfma_f32_16x16x32_bf16 v[104:107], a[180:183], v[204:207], v[104:107]
buffer_load_dwordx4 v[160:163], v4, s[24:27], s61 offen offset:0 sc1
v_mfma_f32_16x16x32_bf16 v[36:39], a[184:187], v[192:195], v[36:39]
v_mfma_f32_16x16x32_bf16 v[60:63], a[184:187], v[196:199], v[60:63]
buffer_load_dwordx4 v[164:167], v4, s[24:27], s61 offen offset:1024 sc1
v_mfma_f32_16x16x32_bf16 v[84:87], a[184:187], v[200:203], v[84:87]
v_mfma_f32_16x16x32_bf16 v[108:111], a[184:187], v[204:207], v[108:111]
buffer_load_dwordx4 v[168:171], v4, s[24:27], s61 offen offset:2048 sc1
v_mfma_f32_16x16x32_bf16 v[40:43], a[188:191], v[192:195], v[40:43]
v_mfma_f32_16x16x32_bf16 v[64:67], a[188:191], v[196:199], v[64:67]
buffer_load_dwordx4 v[172:175], v4, s[24:27], s61 offen offset:3072 sc1
v_mfma_f32_16x16x32_bf16 v[88:91], a[188:191], v[200:203], v[88:91]
v_mfma_f32_16x16x32_bf16 v[112:115], a[188:191], v[204:207], v[112:115]
buffer_load_dwordx4 v[176:179], v7, s[24:27], s61 offen offset:0 sc1
v_mfma_f32_16x16x32_bf16 v[44:47], a[192:195], v[192:195], v[44:47]
v_mfma_f32_16x16x32_bf16 v[68:71], a[192:195], v[196:199], v[68:71]
buffer_load_dwordx4 v[180:183], v7, s[24:27], s61 offen offset:1024 sc1
v_mfma_f32_16x16x32_bf16 v[92:95], a[192:195], v[200:203], v[92:95]
v_mfma_f32_16x16x32_bf16 v[116:119], a[192:195], v[204:207], v[116:119]
buffer_load_dwordx4 v[184:187], v7, s[24:27], s61 offen offset:2048 sc1
v_mfma_f32_16x16x32_bf16 v[48:51], a[212:215], v[192:195], v[48:51]
v_mfma_f32_16x16x32_bf16 v[72:75], a[212:215], v[196:199], v[72:75]
buffer_load_dwordx4 v[188:191], v7, s[24:27], s61 offen offset:3072 sc1
v_mfma_f32_16x16x32_bf16 v[96:99], a[212:215], v[200:203], v[96:99]
v_mfma_f32_16x16x32_bf16 v[120:123], a[212:215], v[204:207], v[120:123]
buffer_load_dwordx4 a[112:115], v4, s[24:27], s62 offen offset:1024 sc1
v_mfma_f32_16x16x32_bf16 v[32:35], a[196:199], v[208:211], v[32:35]
v_mfma_f32_16x16x32_bf16 v[56:59], a[196:199], v[212:215], v[56:59]
buffer_load_dwordx4 a[116:119], v4, s[24:27], s62 offen offset:2048 sc1
v_mfma_f32_16x16x32_bf16 v[80:83], a[196:199], v[216:219], v[80:83]
v_mfma_f32_16x16x32_bf16 v[104:107], a[196:199], v[220:223], v[104:107]
buffer_load_dwordx4 a[120:123], v4, s[24:27], s62 offen offset:3072 sc1
v_mfma_f32_16x16x32_bf16 v[36:39], a[200:203], v[208:211], v[36:39]
v_mfma_f32_16x16x32_bf16 v[60:63], a[200:203], v[212:215], v[60:63]
buffer_load_dwordx4 a[124:127], v7, s[24:27], s62 offen offset:0 sc1
v_mfma_f32_16x16x32_bf16 v[84:87], a[200:203], v[216:219], v[84:87]
v_mfma_f32_16x16x32_bf16 v[108:111], a[200:203], v[220:223], v[108:111]
buffer_load_dwordx4 a[128:131], v7, s[24:27], s62 offen offset:1024 sc1
v_mfma_f32_16x16x32_bf16 v[40:43], a[204:207], v[208:211], v[40:43]
v_mfma_f32_16x16x32_bf16 v[64:67], a[204:207], v[212:215], v[64:67]
buffer_load_dwordx4 a[132:135], v7, s[24:27], s62 offen offset:2048 sc1
v_mfma_f32_16x16x32_bf16 v[88:91], a[204:207], v[216:219], v[88:91]
v_mfma_f32_16x16x32_bf16 v[112:115], a[204:207], v[220:223], v[112:115]
buffer_load_dwordx4 a[136:139], v7, s[24:27], s62 offen offset:3072 sc1
v_mfma_f32_16x16x32_bf16 v[44:47], a[208:211], v[208:211], v[44:47]
v_mfma_f32_16x16x32_bf16 v[68:71], a[208:211], v[212:215], v[68:71]
v_mfma_f32_16x16x32_bf16 v[92:95], a[208:211], v[216:219], v[92:95]
v_mfma_f32_16x16x32_bf16 v[116:119], a[208:211], v[220:223], v[116:119]
v_mfma_f32_16x16x32_bf16 v[52:55], a[212:215], v[208:211], v[52:55]
v_mfma_f32_16x16x32_bf16 v[76:79], a[212:215], v[212:215], v[76:79]
v_mfma_f32_16x16x32_bf16 v[100:103], a[212:215], v[216:219], v[100:103]
v_mfma_f32_16x16x32_bf16 v[124:127], a[212:215], v[220:223], v[124:127]
s_waitcnt vmcnt(22)
v_mfma_f32_16x16x32_bf16 v[32:35], a[216:219], v[128:131], v[32:35]
s_add_u32 s48, s63, 8
s_and_b32 s48, s48, 3
v_mfma_f32_16x16x32_bf16 v[56:59], a[216:219], v[132:135], v[56:59]
s_lshl4_add_u32 s48, s3, s48
s_add_u32 s48, s48, 8
v_mfma_f32_16x16x32_bf16 v[80:83], a[216:219], v[136:139], v[80:83]
s_mul_i32 s48, s48, 8192
s_add_u32 s61, s58, s48
v_mfma_f32_16x16x32_bf16 v[104:107], a[216:219], v[140:143], v[104:107]
buffer_load_dwordx4 v[192:195], v4, s[24:27], s61 offen offset:0 sc1
v_mfma_f32_16x16x32_bf16 v[36:39], a[220:223], v[128:131], v[36:39]
v_mfma_f32_16x16x32_bf16 v[60:63], a[220:223], v[132:135], v[60:63]
buffer_load_dwordx4 v[196:199], v4, s[24:27], s61 offen offset:1024 sc1
v_mfma_f32_16x16x32_bf16 v[84:87], a[220:223], v[136:139], v[84:87]
v_mfma_f32_16x16x32_bf16 v[108:111], a[220:223], v[140:143], v[108:111]
buffer_load_dwordx4 v[200:203], v4, s[24:27], s61 offen offset:2048 sc1
v_mfma_f32_16x16x32_bf16 v[40:43], a[224:227], v[128:131], v[40:43]
v_mfma_f32_16x16x32_bf16 v[64:67], a[224:227], v[132:135], v[64:67]
buffer_load_dwordx4 v[204:207], v4, s[24:27], s61 offen offset:3072 sc1
v_mfma_f32_16x16x32_bf16 v[88:91], a[224:227], v[136:139], v[88:91]
v_mfma_f32_16x16x32_bf16 v[112:115], a[224:227], v[140:143], v[112:115]
buffer_load_dwordx4 v[208:211], v7, s[24:27], s61 offen offset:0 sc1
v_mfma_f32_16x16x32_bf16 v[44:47], a[228:231], v[128:131], v[44:47]
v_mfma_f32_16x16x32_bf16 v[68:71], a[228:231], v[132:135], v[68:71]
buffer_load_dwordx4 v[212:215], v7, s[24:27], s61 offen offset:1024 sc1
v_mfma_f32_16x16x32_bf16 v[92:95], a[228:231], v[136:139], v[92:95]
v_mfma_f32_16x16x32_bf16 v[116:119], a[228:231], v[140:143], v[116:119]
buffer_load_dwordx4 v[216:219], v7, s[24:27], s61 offen offset:2048 sc1
v_mfma_f32_16x16x32_bf16 v[48:51], a[248:251], v[128:131], v[48:51]
v_mfma_f32_16x16x32_bf16 v[72:75], a[248:251], v[132:135], v[72:75]
buffer_load_dwordx4 v[220:223], v7, s[24:27], s61 offen offset:3072 sc1
v_mfma_f32_16x16x32_bf16 v[96:99], a[248:251], v[136:139], v[96:99]
v_mfma_f32_16x16x32_bf16 v[120:123], a[248:251], v[140:143], v[120:123]
buffer_load_dwordx4 a[140:143], v8, s[24:27], s62 offen offset:0 sc1
v_mfma_f32_16x16x32_bf16 v[32:35], a[232:235], v[144:147], v[32:35]
v_mfma_f32_16x16x32_bf16 v[56:59], a[232:235], v[148:151], v[56:59]
s_add_u32 s48, s63, 11
s_and_b32 s48, s48, 3
v_mfma_f32_16x16x32_bf16 v[80:83], a[232:235], v[152:155], v[80:83]
s_lshl4_add_u32 s48, s3, s48
s_add_u32 s48, s48, 8
v_mfma_f32_16x16x32_bf16 v[104:107], a[232:235], v[156:159], v[104:107]
s_mul_i32 s48, s48, 9216
s_add_u32 s62, s59, s48
v_mfma_f32_16x16x32_bf16 v[36:39], a[236:239], v[144:147], v[36:39]
buffer_load_dwordx4 a[144:147], v4, s[24:27], s62 offen offset:0 sc1
v_mfma_f32_16x16x32_bf16 v[60:63], a[236:239], v[148:151], v[60:63]
v_mfma_f32_16x16x32_bf16 v[84:87], a[236:239], v[152:155], v[84:87]
buffer_load_dwordx4 a[148:151], v4, s[24:27], s62 offen offset:1024 sc1
v_mfma_f32_16x16x32_bf16 v[108:111], a[236:239], v[156:159], v[108:111]
v_mfma_f32_16x16x32_bf16 v[40:43], a[240:243], v[144:147], v[40:43]
buffer_load_dwordx4 a[152:155], v4, s[24:27], s62 offen offset:2048 sc1
v_mfma_f32_16x16x32_bf16 v[64:67], a[240:243], v[148:151], v[64:67]
v_mfma_f32_16x16x32_bf16 v[88:91], a[240:243], v[152:155], v[88:91]
buffer_load_dwordx4 a[156:159], v4, s[24:27], s62 offen offset:3072 sc1
v_mfma_f32_16x16x32_bf16 v[112:115], a[240:243], v[156:159], v[112:115]
v_mfma_f32_16x16x32_bf16 v[44:47], a[244:247], v[144:147], v[44:47]
buffer_load_dwordx4 a[160:163], v7, s[24:27], s62 offen offset:0 sc1
v_mfma_f32_16x16x32_bf16 v[68:71], a[244:247], v[148:151], v[68:71]
v_mfma_f32_16x16x32_bf16 v[92:95], a[244:247], v[152:155], v[92:95]
buffer_load_dwordx4 a[164:167], v7, s[24:27], s62 offen offset:1024 sc1
v_mfma_f32_16x16x32_bf16 v[116:119], a[244:247], v[156:159], v[116:119]
v_mfma_f32_16x16x32_bf16 v[52:55], a[248:251], v[144:147], v[52:55]
v_mfma_f32_16x16x32_bf16 v[76:79], a[248:251], v[148:151], v[76:79]
v_mfma_f32_16x16x32_bf16 v[100:103], a[248:251], v[152:155], v[100:103]
v_mfma_f32_16x16x32_bf16 v[124:127], a[248:251], v[156:159], v[124:127]
s_waitcnt vmcnt(22)
v_mfma_f32_16x16x32_bf16 v[32:35], a[0:3], v[160:163], v[32:35]
s_add_u32 s48, s63, 9
s_and_b32 s48, s48, 3
v_mfma_f32_16x16x32_bf16 v[56:59], a[0:3], v[164:167], v[56:59]
s_lshl4_add_u32 s48, s3, s48
s_add_u32 s48, s48, 8
v_mfma_f32_16x16x32_bf16 v[80:83], a[0:3], v[168:171], v[80:83]
s_mul_i32 s48, s48, 8192
s_add_u32 s61, s58, s48
v_mfma_f32_16x16x32_bf16 v[104:107], a[0:3], v[172:175], v[104:107]
buffer_load_dwordx4 v[128:131], v4, s[24:27], s61 offen offset:0 sc1
v_mfma_f32_16x16x32_bf16 v[36:39], a[4:7], v[160:163], v[36:39]
v_mfma_f32_16x16x32_bf16 v[60:63], a[4:7], v[164:167], v[60:63]
buffer_load_dwordx4 v[132:135], v4, s[24:27], s61 offen offset:1024 sc1
v_mfma_f32_16x16x32_bf16 v[84:87], a[4:7], v[168:171], v[84:87]
v_mfma_f32_16x16x32_bf16 v[108:111], a[4:7], v[172:175], v[108:111]
buffer_load_dwordx4 v[136:139], v4, s[24:27], s61 offen offset:2048 sc1
v_mfma_f32_16x16x32_bf16 v[40:43], a[8:11], v[160:163], v[40:43]
v_mfma_f32_16x16x32_bf16 v[64:67], a[8:11], v[164:167], v[64:67]
buffer_load_dwordx4 v[140:143], v4, s[24:27], s61 offen offset:3072 sc1
v_mfma_f32_16x16x32_bf16 v[88:91], a[8:11], v[168:171], v[88:91]
v_mfma_f32_16x16x32_bf16 v[112:115], a[8:11], v[172:175], v[112:115]
buffer_load_dwordx4 v[144:147], v7, s[24:27], s61 offen offset:0 sc1
v_mfma_f32_16x16x32_bf16 v[44:47], a[12:15], v[160:163], v[44:47]
v_mfma_f32_16x16x32_bf16 v[68:71], a[12:15], v[164:167], v[68:71]
buffer_load_dwordx4 v[148:151], v7, s[24:27], s61 offen offset:1024 sc1
v_mfma_f32_16x16x32_bf16 v[92:95], a[12:15], v[168:171], v[92:95]
v_mfma_f32_16x16x32_bf16 v[116:119], a[12:15], v[172:175], v[116:119]
buffer_load_dwordx4 v[152:155], v7, s[24:27], s61 offen offset:2048 sc1
v_mfma_f32_16x16x32_bf16 v[48:51], a[32:35], v[160:163], v[48:51]
v_mfma_f32_16x16x32_bf16 v[72:75], a[32:35], v[164:167], v[72:75]
buffer_load_dwordx4 v[156:159], v7, s[24:27], s61 offen offset:3072 sc1
v_mfma_f32_16x16x32_bf16 v[96:99], a[32:35], v[168:171], v[96:99]
v_mfma_f32_16x16x32_bf16 v[120:123], a[32:35], v[172:175], v[120:123]
buffer_load_dwordx4 a[168:171], v7, s[24:27], s62 offen offset:2048 sc1
v_mfma_f32_16x16x32_bf16 v[32:35], a[16:19], v[176:179], v[32:35]
v_mfma_f32_16x16x32_bf16 v[56:59], a[16:19], v[180:183], v[56:59]
buffer_load_dwordx4 a[172:175], v7, s[24:27], s62 offen offset:3072 sc1
v_mfma_f32_16x16x32_bf16 v[80:83], a[16:19], v[184:187], v[80:83]
v_mfma_f32_16x16x32_bf16 v[104:107], a[16:19], v[188:191], v[104:107]
buffer_load_dwordx4 a[176:179], v8, s[24:27], s62 offen offset:0 sc1
v_mfma_f32_16x16x32_bf16 v[36:39], a[20:23], v[176:179], v[36:39]
v_mfma_f32_16x16x32_bf16 v[60:63], a[20:23], v[180:183], v[60:63]
s_add_u32 s48, s63, 12
s_and_b32 s48, s48, 3
v_mfma_f32_16x16x32_bf16 v[84:87], a[20:23], v[184:187], v[84:87]
s_lshl4_add_u32 s48, s3, s48
s_add_u32 s48, s48, 12
v_mfma_f32_16x16x32_bf16 v[108:111], a[20:23], v[188:191], v[108:111]
s_mul_i32 s48, s48, 9216
s_add_u32 s62, s59, s48
v_mfma_f32_16x16x32_bf16 v[40:43], a[24:27], v[176:179], v[40:43]
buffer_load_dwordx4 a[180:183], v4, s[24:27], s62 offen offset:0 sc1
v_mfma_f32_16x16x32_bf16 v[64:67], a[24:27], v[180:183], v[64:67]
v_mfma_f32_16x16x32_bf16 v[88:91], a[24:27], v[184:187], v[88:91]
buffer_load_dwordx4 a[184:187], v4, s[24:27], s62 offen offset:1024 sc1
v_mfma_f32_16x16x32_bf16 v[112:115], a[24:27], v[188:191], v[112:115]
v_mfma_f32_16x16x32_bf16 v[44:47], a[28:31], v[176:179], v[44:47]
buffer_load_dwordx4 a[188:191], v4, s[24:27], s62 offen offset:2048 sc1
v_mfma_f32_16x16x32_bf16 v[68:71], a[28:31], v[180:183], v[68:71]
v_mfma_f32_16x16x32_bf16 v[92:95], a[28:31], v[184:187], v[92:95]
buffer_load_dwordx4 a[192:195], v4, s[24:27], s62 offen offset:3072 sc1
v_mfma_f32_16x16x32_bf16 v[116:119], a[28:31], v[188:191], v[116:119]
v_mfma_f32_16x16x32_bf16 v[52:55], a[32:35], v[176:179], v[52:55]
v_mfma_f32_16x16x32_bf16 v[76:79], a[32:35], v[180:183], v[76:79]
v_mfma_f32_16x16x32_bf16 v[100:103], a[32:35], v[184:187], v[100:103]
v_mfma_f32_16x16x32_bf16 v[124:127], a[32:35], v[188:191], v[124:127]
s_waitcnt vmcnt(22)
v_mfma_f32_16x16x32_bf16 v[32:35], a[36:39], v[192:195], v[32:35]
s_add_u32 s48, s63, 10
s_and_b32 s48, s48, 3
v_mfma_f32_16x16x32_bf16 v[56:59], a[36:39], v[196:199], v[56:59]
s_lshl4_add_u32 s48, s3, s48
s_add_u32 s48, s48, 8
v_mfma_f32_16x16x32_bf16 v[80:83], a[36:39], v[200:203], v[80:83]
s_mul_i32 s48, s48, 8192
s_add_u32 s61, s58, s48
v_mfma_f32_16x16x32_bf16 v[104:107], a[36:39], v[204:207], v[104:107]
buffer_load_dwordx4 v[160:163], v4, s[24:27], s61 offen offset:0 sc1
v_mfma_f32_16x16x32_bf16 v[36:39], a[40:43], v[192:195], v[36:39]
v_mfma_f32_16x16x32_bf16 v[60:63], a[40:43], v[196:199], v[60:63]
buffer_load_dwordx4 v[164:167], v4, s[24:27], s61 offen offset:1024 sc1
v_mfma_f32_16x16x32_bf16 v[84:87], a[40:43], v[200:203], v[84:87]
v_mfma_f32_16x16x32_bf16 v[108:111], a[40:43], v[204:207], v[108:111]
buffer_load_dwordx4 v[168:171], v4, s[24:27], s61 offen offset:2048 sc1
v_mfma_f32_16x16x32_bf16 v[40:43], a[44:47], v[192:195], v[40:43]
v_mfma_f32_16x16x32_bf16 v[64:67], a[44:47], v[196:199], v[64:67]
buffer_load_dwordx4 v[172:175], v4, s[24:27], s61 offen offset:3072 sc1
v_mfma_f32_16x16x32_bf16 v[88:91], a[44:47], v[200:203], v[88:91]
v_mfma_f32_16x16x32_bf16 v[112:115], a[44:47], v[204:207], v[112:115]
buffer_load_dwordx4 v[176:179], v7, s[24:27], s61 offen offset:0 sc1
v_mfma_f32_16x16x32_bf16 v[44:47], a[48:51], v[192:195], v[44:47]
v_mfma_f32_16x16x32_bf16 v[68:71], a[48:51], v[196:199], v[68:71]
buffer_load_dwordx4 v[180:183], v7, s[24:27], s61 offen offset:1024 sc1
v_mfma_f32_16x16x32_bf16 v[92:95], a[48:51], v[200:203], v[92:95]
v_mfma_f32_16x16x32_bf16 v[116:119], a[48:51], v[204:207], v[116:119]
buffer_load_dwordx4 v[184:187], v7, s[24:27], s61 offen offset:2048 sc1
v_mfma_f32_16x16x32_bf16 v[48:51], a[68:71], v[192:195], v[48:51]
v_mfma_f32_16x16x32_bf16 v[72:75], a[68:71], v[196:199], v[72:75]
buffer_load_dwordx4 v[188:191], v7, s[24:27], s61 offen offset:3072 sc1
v_mfma_f32_16x16x32_bf16 v[96:99], a[68:71], v[200:203], v[96:99]
v_mfma_f32_16x16x32_bf16 v[120:123], a[68:71], v[204:207], v[120:123]
buffer_load_dwordx4 a[196:199], v7, s[24:27], s62 offen offset:0 sc1
v_mfma_f32_16x16x32_bf16 v[32:35], a[52:55], v[208:211], v[32:35]
v_mfma_f32_16x16x32_bf16 v[56:59], a[52:55], v[212:215], v[56:59]
buffer_load_dwordx4 a[200:203], v7, s[24:27], s62 offen offset:1024 sc1
v_mfma_f32_16x16x32_bf16 v[80:83], a[52:55], v[216:219], v[80:83]
v_mfma_f32_16x16x32_bf16 v[104:107], a[52:55], v[220:223], v[104:107]
buffer_load_dwordx4 a[204:207], v7, s[24:27], s62 offen offset:2048 sc1
v_mfma_f32_16x16x32_bf16 v[36:39], a[56:59], v[208:211], v[36:39]
v_mfma_f32_16x16x32_bf16 v[60:63], a[56:59], v[212:215], v[60:63]
buffer_load_dwordx4 a[208:211], v7, s[24:27], s62 offen offset:3072 sc1
v_mfma_f32_16x16x32_bf16 v[84:87], a[56:59], v[216:219], v[84:87]
v_mfma_f32_16x16x32_bf16 v[108:111], a[56:59], v[220:223], v[108:111]
buffer_load_dwordx4 a[212:215], v8, s[24:27], s62 offen offset:0 sc1
v_mfma_f32_16x16x32_bf16 v[40:43], a[60:63], v[208:211], v[40:43]
v_mfma_f32_16x16x32_bf16 v[64:67], a[60:63], v[212:215], v[64:67]
s_add_u32 s48, s63, 13
s_and_b32 s48, s48, 3
v_mfma_f32_16x16x32_bf16 v[88:91], a[60:63], v[216:219], v[88:91]
s_lshl4_add_u32 s48, s3, s48
s_add_u32 s48, s48, 12
v_mfma_f32_16x16x32_bf16 v[112:115], a[60:63], v[220:223], v[112:115]
s_mul_i32 s48, s48, 9216
s_add_u32 s62, s59, s48
v_mfma_f32_16x16x32_bf16 v[44:47], a[64:67], v[208:211], v[44:47]
buffer_load_dwordx4 a[216:219], v4, s[24:27], s62 offen offset:0 sc1
v_mfma_f32_16x16x32_bf16 v[68:71], a[64:67], v[212:215], v[68:71]
v_mfma_f32_16x16x32_bf16 v[92:95], a[64:67], v[216:219], v[92:95]
buffer_load_dwordx4 a[220:223], v4, s[24:27], s62 offen offset:1024 sc1
v_mfma_f32_16x16x32_bf16 v[116:119], a[64:67], v[220:223], v[116:119]
v_mfma_f32_16x16x32_bf16 v[52:55], a[68:71], v[208:211], v[52:55]
v_mfma_f32_16x16x32_bf16 v[76:79], a[68:71], v[212:215], v[76:79]
v_mfma_f32_16x16x32_bf16 v[100:103], a[68:71], v[216:219], v[100:103]
v_mfma_f32_16x16x32_bf16 v[124:127], a[68:71], v[220:223], v[124:127]
s_waitcnt vmcnt(22)
v_mfma_f32_16x16x32_bf16 v[32:35], a[72:75], v[128:131], v[32:35]
s_add_u32 s48, s63, 11
s_and_b32 s48, s48, 3
v_mfma_f32_16x16x32_bf16 v[56:59], a[72:75], v[132:135], v[56:59]
s_lshl4_add_u32 s48, s3, s48
s_add_u32 s48, s48, 8
v_mfma_f32_16x16x32_bf16 v[80:83], a[72:75], v[136:139], v[80:83]
s_mul_i32 s48, s48, 8192
s_add_u32 s61, s58, s48
v_mfma_f32_16x16x32_bf16 v[104:107], a[72:75], v[140:143], v[104:107]
buffer_load_dwordx4 v[192:195], v4, s[24:27], s61 offen offset:0 sc1
v_mfma_f32_16x16x32_bf16 v[36:39], a[76:79], v[128:131], v[36:39]
v_mfma_f32_16x16x32_bf16 v[60:63], a[76:79], v[132:135], v[60:63]
buffer_load_dwordx4 v[196:199], v4, s[24:27], s61 offen offset:1024 sc1
v_mfma_f32_16x16x32_bf16 v[84:87], a[76:79], v[136:139], v[84:87]
v_mfma_f32_16x16x32_bf16 v[108:111], a[76:79], v[140:143], v[108:111]
buffer_load_dwordx4 v[200:203], v4, s[24:27], s61 offen offset:2048 sc1
v_mfma_f32_16x16x32_bf16 v[40:43], a[80:83], v[128:131], v[40:43]
v_mfma_f32_16x16x32_bf16 v[64:67], a[80:83], v[132:135], v[64:67]
buffer_load_dwordx4 v[204:207], v4, s[24:27], s61 offen offset:3072 sc1
v_mfma_f32_16x16x32_bf16 v[88:91], a[80:83], v[136:139], v[88:91]
v_mfma_f32_16x16x32_bf16 v[112:115], a[80:83], v[140:143], v[112:115]
buffer_load_dwordx4 v[208:211], v7, s[24:27], s61 offen offset:0 sc1
v_mfma_f32_16x16x32_bf16 v[44:47], a[84:87], v[128:131], v[44:47]
v_mfma_f32_16x16x32_bf16 v[68:71], a[84:87], v[132:135], v[68:71]
buffer_load_dwordx4 v[212:215], v7, s[24:27], s61 offen offset:1024 sc1
v_mfma_f32_16x16x32_bf16 v[92:95], a[84:87], v[136:139], v[92:95]
v_mfma_f32_16x16x32_bf16 v[116:119], a[84:87], v[140:143], v[116:119]
buffer_load_dwordx4 v[216:219], v7, s[24:27], s61 offen offset:2048 sc1
v_mfma_f32_16x16x32_bf16 v[48:51], a[104:107], v[128:131], v[48:51]
v_mfma_f32_16x16x32_bf16 v[72:75], a[104:107], v[132:135], v[72:75]
buffer_load_dwordx4 v[220:223], v7, s[24:27], s61 offen offset:3072 sc1
v_mfma_f32_16x16x32_bf16 v[96:99], a[104:107], v[136:139], v[96:99]
v_mfma_f32_16x16x32_bf16 v[120:123], a[104:107], v[140:143], v[120:123]
buffer_load_dwordx4 a[224:227], v4, s[24:27], s62 offen offset:2048 sc1
v_mfma_f32_16x16x32_bf16 v[32:35], a[88:91], v[144:147], v[32:35]
v_mfma_f32_16x16x32_bf16 v[56:59], a[88:91], v[148:151], v[56:59]
buffer_load_dwordx4 a[228:231], v4, s[24:27], s62 offen offset:3072 sc1
v_mfma_f32_16x16x32_bf16 v[80:83], a[88:91], v[152:155], v[80:83]
v_mfma_f32_16x16x32_bf16 v[104:107], a[88:91], v[156:159], v[104:107]
buffer_load_dwordx4 a[232:235], v7, s[24:27], s62 offen offset:0 sc1
v_mfma_f32_16x16x32_bf16 v[36:39], a[92:95], v[144:147], v[36:39]
v_mfma_f32_16x16x32_bf16 v[60:63], a[92:95], v[148:151], v[60:63]
buffer_load_dwordx4 a[236:239], v7, s[24:27], s62 offen offset:1024 sc1
v_mfma_f32_16x16x32_bf16 v[84:87], a[92:95], v[152:155], v[84:87]
v_mfma_f32_16x16x32_bf16 v[108:111], a[92:95], v[156:159], v[108:111]
buffer_load_dwordx4 a[240:243], v7, s[24:27], s62 offen offset:2048 sc1
v_mfma_f32_16x16x32_bf16 v[40:43], a[96:99], v[144:147], v[40:43]
v_mfma_f32_16x16x32_bf16 v[64:67], a[96:99], v[148:151], v[64:67]
buffer_load_dwordx4 a[244:247], v7, s[24:27], s62 offen offset:3072 sc1
v_mfma_f32_16x16x32_bf16 v[88:91], a[96:99], v[152:155], v[88:91]
v_mfma_f32_16x16x32_bf16 v[112:115], a[96:99], v[156:159], v[112:115]
buffer_load_dwordx4 a[248:251], v8, s[24:27], s62 offen offset:0 sc1
v_mfma_f32_16x16x32_bf16 v[44:47], a[100:103], v[144:147], v[44:47]
v_mfma_f32_16x16x32_bf16 v[68:71], a[100:103], v[148:151], v[68:71]
v_mfma_f32_16x16x32_bf16 v[92:95], a[100:103], v[152:155], v[92:95]
v_mfma_f32_16x16x32_bf16 v[116:119], a[100:103], v[156:159], v[116:119]
v_mfma_f32_16x16x32_bf16 v[52:55], a[104:107], v[144:147], v[52:55]
v_mfma_f32_16x16x32_bf16 v[76:79], a[104:107], v[148:151], v[76:79]
v_mfma_f32_16x16x32_bf16 v[100:103], a[104:107], v[152:155], v[100:103]
v_mfma_f32_16x16x32_bf16 v[124:127], a[104:107], v[156:159], v[124:127]
s_waitcnt vmcnt(22)
v_mfma_f32_16x16x32_bf16 v[32:35], a[108:111], v[160:163], v[32:35]
s_add_u32 s48, s63, 12
s_and_b32 s48, s48, 3
v_mfma_f32_16x16x32_bf16 v[56:59], a[108:111], v[164:167], v[56:59]
s_lshl4_add_u32 s48, s3, s48
s_add_u32 s48, s48, 12
v_mfma_f32_16x16x32_bf16 v[80:83], a[108:111], v[168:171], v[80:83]
s_mul_i32 s48, s48, 8192
s_add_u32 s61, s58, s48
v_mfma_f32_16x16x32_bf16 v[104:107], a[108:111], v[172:175], v[104:107]
buffer_load_dwordx4 v[128:131], v4, s[24:27], s61 offen offset:0 sc1
v_mfma_f32_16x16x32_bf16 v[36:39], a[112:115], v[160:163], v[36:39]
v_mfma_f32_16x16x32_bf16 v[60:63], a[112:115], v[164:167], v[60:63]
buffer_load_dwordx4 v[132:135], v4, s[24:27], s61 offen offset:1024 sc1
v_mfma_f32_16x16x32_bf16 v[84:87], a[112:115], v[168:171], v[84:87]
v_mfma_f32_16x16x32_bf16 v[108:111], a[112:115], v[172:175], v[108:111]
buffer_load_dwordx4 v[136:139], v4, s[24:27], s61 offen offset:2048 sc1
v_mfma_f32_16x16x32_bf16 v[40:43], a[116:119], v[160:163], v[40:43]
v_mfma_f32_16x16x32_bf16 v[64:67], a[116:119], v[164:167], v[64:67]
buffer_load_dwordx4 v[140:143], v4, s[24:27], s61 offen offset:3072 sc1
v_mfma_f32_16x16x32_bf16 v[88:91], a[116:119], v[168:171], v[88:91]
v_mfma_f32_16x16x32_bf16 v[112:115], a[116:119], v[172:175], v[112:115]
buffer_load_dwordx4 v[144:147], v7, s[24:27], s61 offen offset:0 sc1
v_mfma_f32_16x16x32_bf16 v[44:47], a[120:123], v[160:163], v[44:47]
v_mfma_f32_16x16x32_bf16 v[68:71], a[120:123], v[164:167], v[68:71]
buffer_load_dwordx4 v[148:151], v7, s[24:27], s61 offen offset:1024 sc1
v_mfma_f32_16x16x32_bf16 v[92:95], a[120:123], v[168:171], v[92:95]
v_mfma_f32_16x16x32_bf16 v[116:119], a[120:123], v[172:175], v[116:119]
buffer_load_dwordx4 v[152:155], v7, s[24:27], s61 offen offset:2048 sc1
v_mfma_f32_16x16x32_bf16 v[48:51], a[140:143], v[160:163], v[48:51]
v_mfma_f32_16x16x32_bf16 v[72:75], a[140:143], v[164:167], v[72:75]
buffer_load_dwordx4 v[156:159], v7, s[24:27], s61 offen offset:3072 sc1
v_mfma_f32_16x16x32_bf16 v[96:99], a[140:143], v[168:171], v[96:99]
v_mfma_f32_16x16x32_bf16 v[120:123], a[140:143], v[172:175], v[120:123]
s_add_u32 s48, s63, 14
s_and_b32 s48, s48, 3
v_mfma_f32_16x16x32_bf16 v[32:35], a[124:127], v[176:179], v[32:35]
s_lshl4_add_u32 s48, s3, s48
s_add_u32 s48, s48, 12
v_mfma_f32_16x16x32_bf16 v[56:59], a[124:127], v[180:183], v[56:59]
s_mul_i32 s48, s48, 9216
s_add_u32 s62, s59, s48
v_mfma_f32_16x16x32_bf16 v[80:83], a[124:127], v[184:187], v[80:83]
buffer_load_dwordx4 a[0:3], v4, s[24:27], s62 offen offset:0 sc1
v_mfma_f32_16x16x32_bf16 v[104:107], a[124:127], v[188:191], v[104:107]
v_mfma_f32_16x16x32_bf16 v[36:39], a[128:131], v[176:179], v[36:39]
buffer_load_dwordx4 a[4:7], v4, s[24:27], s62 offen offset:1024 sc1
v_mfma_f32_16x16x32_bf16 v[60:63], a[128:131], v[180:183], v[60:63]
v_mfma_f32_16x16x32_bf16 v[84:87], a[128:131], v[184:187], v[84:87]
buffer_load_dwordx4 a[8:11], v4, s[24:27], s62 offen offset:2048 sc1
v_mfma_f32_16x16x32_bf16 v[108:111], a[128:131], v[188:191], v[108:111]
v_mfma_f32_16x16x32_bf16 v[40:43], a[132:135], v[176:179], v[40:43]
buffer_load_dwordx4 a[12:15], v4, s[24:27], s62 offen offset:3072 sc1
v_mfma_f32_16x16x32_bf16 v[64:67], a[132:135], v[180:183], v[64:67]
v_mfma_f32_16x16x32_bf16 v[88:91], a[132:135], v[184:187], v[88:91]
buffer_load_dwordx4 a[16:19], v7, s[24:27], s62 offen offset:0 sc1
v_mfma_f32_16x16x32_bf16 v[112:115], a[132:135], v[188:191], v[112:115]
v_mfma_f32_16x16x32_bf16 v[44:47], a[136:139], v[176:179], v[44:47]
buffer_load_dwordx4 a[20:23], v7, s[24:27], s62 offen offset:1024 sc1
v_mfma_f32_16x16x32_bf16 v[68:71], a[136:139], v[180:183], v[68:71]
v_mfma_f32_16x16x32_bf16 v[92:95], a[136:139], v[184:187], v[92:95]
buffer_load_dwordx4 a[24:27], v7, s[24:27], s62 offen offset:2048 sc1
v_mfma_f32_16x16x32_bf16 v[116:119], a[136:139], v[188:191], v[116:119]
v_mfma_f32_16x16x32_bf16 v[52:55], a[140:143], v[176:179], v[52:55]
v_mfma_f32_16x16x32_bf16 v[76:79], a[140:143], v[180:183], v[76:79]
v_mfma_f32_16x16x32_bf16 v[100:103], a[140:143], v[184:187], v[100:103]
v_mfma_f32_16x16x32_bf16 v[124:127], a[140:143], v[188:191], v[124:127]
s_waitcnt vmcnt(22)
v_mfma_f32_16x16x32_bf16 v[32:35], a[144:147], v[192:195], v[32:35]
s_add_u32 s48, s63, 13
s_and_b32 s48, s48, 3
v_mfma_f32_16x16x32_bf16 v[56:59], a[144:147], v[196:199], v[56:59]
s_lshl4_add_u32 s48, s3, s48
s_add_u32 s48, s48, 12
v_mfma_f32_16x16x32_bf16 v[80:83], a[144:147], v[200:203], v[80:83]
s_mul_i32 s48, s48, 8192
s_add_u32 s61, s58, s48
v_mfma_f32_16x16x32_bf16 v[104:107], a[144:147], v[204:207], v[104:107]
buffer_load_dwordx4 v[160:163], v4, s[24:27], s61 offen offset:0 sc1
v_mfma_f32_16x16x32_bf16 v[36:39], a[148:151], v[192:195], v[36:39]
v_mfma_f32_16x16x32_bf16 v[60:63], a[148:151], v[196:199], v[60:63]
buffer_load_dwordx4 v[164:167], v4, s[24:27], s61 offen offset:1024 sc1
v_mfma_f32_16x16x32_bf16 v[84:87], a[148:151], v[200:203], v[84:87]
v_mfma_f32_16x16x32_bf16 v[108:111], a[148:151], v[204:207], v[108:111]
buffer_load_dwordx4 v[168:171], v4, s[24:27], s61 offen offset:2048 sc1
v_mfma_f32_16x16x32_bf16 v[40:43], a[152:155], v[192:195], v[40:43]
v_mfma_f32_16x16x32_bf16 v[64:67], a[152:155], v[196:199], v[64:67]
buffer_load_dwordx4 v[172:175], v4, s[24:27], s61 offen offset:3072 sc1
v_mfma_f32_16x16x32_bf16 v[88:91], a[152:155], v[200:203], v[88:91]
v_mfma_f32_16x16x32_bf16 v[112:115], a[152:155], v[204:207], v[112:115]
buffer_load_dwordx4 v[176:179], v7, s[24:27], s61 offen offset:0 sc1
v_mfma_f32_16x16x32_bf16 v[44:47], a[156:159], v[192:195], v[44:47]
v_mfma_f32_16x16x32_bf16 v[68:71], a[156:159], v[196:199], v[68:71]
buffer_load_dwordx4 v[180:183], v7, s[24:27], s61 offen offset:1024 sc1
v_mfma_f32_16x16x32_bf16 v[92:95], a[156:159], v[200:203], v[92:95]
v_mfma_f32_16x16x32_bf16 v[116:119], a[156:159], v[204:207], v[116:119]
buffer_load_dwordx4 v[184:187], v7, s[24:27], s61 offen offset:2048 sc1
v_mfma_f32_16x16x32_bf16 v[48:51], a[176:179], v[192:195], v[48:51]
v_mfma_f32_16x16x32_bf16 v[72:75], a[176:179], v[196:199], v[72:75]
buffer_load_dwordx4 v[188:191], v7, s[24:27], s61 offen offset:3072 sc1
v_mfma_f32_16x16x32_bf16 v[96:99], a[176:179], v[200:203], v[96:99]
v_mfma_f32_16x16x32_bf16 v[120:123], a[176:179], v[204:207], v[120:123]
buffer_load_dwordx4 a[28:31], v7, s[24:27], s62 offen offset:3072 sc1
v_mfma_f32_16x16x32_bf16 v[32:35], a[160:163], v[208:211], v[32:35]
v_mfma_f32_16x16x32_bf16 v[56:59], a[160:163], v[212:215], v[56:59]
buffer_load_dwordx4 a[32:35], v8, s[24:27], s62 offen offset:0 sc1
v_mfma_f32_16x16x32_bf16 v[80:83], a[160:163], v[216:219], v[80:83]
v_mfma_f32_16x16x32_bf16 v[104:107], a[160:163], v[220:223], v[104:107]
s_add_u32 s48, s63, 15
s_and_b32 s48, s48, 3
v_mfma_f32_16x16x32_bf16 v[36:39], a[164:167], v[208:211], v[36:39]
s_lshl4_add_u32 s48, s3, s48
s_add_u32 s48, s48, 12
v_mfma_f32_16x16x32_bf16 v[60:63], a[164:167], v[212:215], v[60:63]
s_mul_i32 s48, s48, 9216
s_add_u32 s62, s59, s48
v_mfma_f32_16x16x32_bf16 v[84:87], a[164:167], v[216:219], v[84:87]
buffer_load_dwordx4 a[36:39], v4, s[24:27], s62 offen offset:0 sc1
v_mfma_f32_16x16x32_bf16 v[108:111], a[164:167], v[220:223], v[108:111]
v_mfma_f32_16x16x32_bf16 v[40:43], a[168:171], v[208:211], v[40:43]
buffer_load_dwordx4 a[40:43], v4, s[24:27], s62 offen offset:1024 sc1
v_mfma_f32_16x16x32_bf16 v[64:67], a[168:171], v[212:215], v[64:67]
v_mfma_f32_16x16x32_bf16 v[88:91], a[168:171], v[216:219], v[88:91]
buffer_load_dwordx4 a[44:47], v4, s[24:27], s62 offen offset:2048 sc1
v_mfma_f32_16x16x32_bf16 v[112:115], a[168:171], v[220:223], v[112:115]
v_mfma_f32_16x16x32_bf16 v[44:47], a[172:175], v[208:211], v[44:47]
buffer_load_dwordx4 a[48:51], v4, s[24:27], s62 offen offset:3072 sc1
v_mfma_f32_16x16x32_bf16 v[68:71], a[172:175], v[212:215], v[68:71]
v_mfma_f32_16x16x32_bf16 v[92:95], a[172:175], v[216:219], v[92:95]
buffer_load_dwordx4 a[52:55], v7, s[24:27], s62 offen offset:0 sc1
v_mfma_f32_16x16x32_bf16 v[116:119], a[172:175], v[220:223], v[116:119]
v_mfma_f32_16x16x32_bf16 v[52:55], a[176:179], v[208:211], v[52:55]
v_mfma_f32_16x16x32_bf16 v[76:79], a[176:179], v[212:215], v[76:79]
v_mfma_f32_16x16x32_bf16 v[100:103], a[176:179], v[216:219], v[100:103]
v_mfma_f32_16x16x32_bf16 v[124:127], a[176:179], v[220:223], v[124:127]
s_waitcnt vmcnt(22)
v_mfma_f32_16x16x32_bf16 v[32:35], a[180:183], v[128:131], v[32:35]
s_add_u32 s48, s63, 14
s_and_b32 s48, s48, 3
v_mfma_f32_16x16x32_bf16 v[56:59], a[180:183], v[132:135], v[56:59]
s_lshl4_add_u32 s48, s3, s48
s_add_u32 s48, s48, 12
v_mfma_f32_16x16x32_bf16 v[80:83], a[180:183], v[136:139], v[80:83]
s_mul_i32 s48, s48, 8192
s_add_u32 s61, s58, s48
v_mfma_f32_16x16x32_bf16 v[104:107], a[180:183], v[140:143], v[104:107]
buffer_load_dwordx4 v[192:195], v4, s[24:27], s61 offen offset:0 sc1
v_mfma_f32_16x16x32_bf16 v[36:39], a[184:187], v[128:131], v[36:39]
v_mfma_f32_16x16x32_bf16 v[60:63], a[184:187], v[132:135], v[60:63]
buffer_load_dwordx4 v[196:199], v4, s[24:27], s61 offen offset:1024 sc1
v_mfma_f32_16x16x32_bf16 v[84:87], a[184:187], v[136:139], v[84:87]
v_mfma_f32_16x16x32_bf16 v[108:111], a[184:187], v[140:143], v[108:111]
buffer_load_dwordx4 v[200:203], v4, s[24:27], s61 offen offset:2048 sc1
v_mfma_f32_16x16x32_bf16 v[40:43], a[188:191], v[128:131], v[40:43]
v_mfma_f32_16x16x32_bf16 v[64:67], a[188:191], v[132:135], v[64:67]
buffer_load_dwordx4 v[204:207], v4, s[24:27], s61 offen offset:3072 sc1
v_mfma_f32_16x16x32_bf16 v[88:91], a[188:191], v[136:139], v[88:91]
v_mfma_f32_16x16x32_bf16 v[112:115], a[188:191], v[140:143], v[112:115]
buffer_load_dwordx4 v[208:211], v7, s[24:27], s61 offen offset:0 sc1
v_mfma_f32_16x16x32_bf16 v[44:47], a[192:195], v[128:131], v[44:47]
v_mfma_f32_16x16x32_bf16 v[68:71], a[192:195], v[132:135], v[68:71]
buffer_load_dwordx4 v[212:215], v7, s[24:27], s61 offen offset:1024 sc1
v_mfma_f32_16x16x32_bf16 v[92:95], a[192:195], v[136:139], v[92:95]
v_mfma_f32_16x16x32_bf16 v[116:119], a[192:195], v[140:143], v[116:119]
buffer_load_dwordx4 v[216:219], v7, s[24:27], s61 offen offset:2048 sc1
v_mfma_f32_16x16x32_bf16 v[48:51], a[212:215], v[128:131], v[48:51]
v_mfma_f32_16x16x32_bf16 v[72:75], a[212:215], v[132:135], v[72:75]
buffer_load_dwordx4 v[220:223], v7, s[24:27], s61 offen offset:3072 sc1
v_mfma_f32_16x16x32_bf16 v[96:99], a[212:215], v[136:139], v[96:99]
v_mfma_f32_16x16x32_bf16 v[120:123], a[212:215], v[140:143], v[120:123]
buffer_load_dwordx4 a[56:59], v7, s[24:27], s62 offen offset:1024 sc1
v_mfma_f32_16x16x32_bf16 v[32:35], a[196:199], v[144:147], v[32:35]
v_mfma_f32_16x16x32_bf16 v[56:59], a[196:199], v[148:151], v[56:59]
buffer_load_dwordx4 a[60:63], v7, s[24:27], s62 offen offset:2048 sc1
v_mfma_f32_16x16x32_bf16 v[80:83], a[196:199], v[152:155], v[80:83]
v_mfma_f32_16x16x32_bf16 v[104:107], a[196:199], v[156:159], v[104:107]
buffer_load_dwordx4 a[64:67], v7, s[24:27], s62 offen offset:3072 sc1
v_mfma_f32_16x16x32_bf16 v[36:39], a[200:203], v[144:147], v[36:39]
v_mfma_f32_16x16x32_bf16 v[60:63], a[200:203], v[148:151], v[60:63]
buffer_load_dwordx4 a[68:71], v8, s[24:27], s62 offen offset:0 sc1
v_mfma_f32_16x16x32_bf16 v[84:87], a[200:203], v[152:155], v[84:87]
v_mfma_f32_16x16x32_bf16 v[108:111], a[200:203], v[156:159], v[108:111]
s_add_u32 s48, s3, 64
s_mul_i32 s48, s48, 9216
v_mfma_f32_16x16x32_bf16 v[40:43], a[204:207], v[144:147], v[40:43]
s_add_u32 s62, s59, s48
v_mfma_f32_16x16x32_bf16 v[64:67], a[204:207], v[148:151], v[64:67]
buffer_load_dwordx4 a[72:75], v4, s[24:27], s62 offen offset:0 sc1
v_mfma_f32_16x16x32_bf16 v[88:91], a[204:207], v[152:155], v[88:91]
v_mfma_f32_16x16x32_bf16 v[112:115], a[204:207], v[156:159], v[112:115]
buffer_load_dwordx4 a[76:79], v4, s[24:27], s62 offen offset:1024 sc1
v_mfma_f32_16x16x32_bf16 v[44:47], a[208:211], v[144:147], v[44:47]
v_mfma_f32_16x16x32_bf16 v[68:71], a[208:211], v[148:151], v[68:71]
buffer_load_dwordx4 a[80:83], v4, s[24:27], s62 offen offset:2048 sc1
v_mfma_f32_16x16x32_bf16 v[92:95], a[208:211], v[152:155], v[92:95]
v_mfma_f32_16x16x32_bf16 v[116:119], a[208:211], v[156:159], v[116:119]
v_mfma_f32_16x16x32_bf16 v[52:55], a[212:215], v[144:147], v[52:55]
v_mfma_f32_16x16x32_bf16 v[76:79], a[212:215], v[148:151], v[76:79]
v_mfma_f32_16x16x32_bf16 v[100:103], a[212:215], v[152:155], v[100:103]
v_mfma_f32_16x16x32_bf16 v[124:127], a[212:215], v[156:159], v[124:127]
s_waitcnt vmcnt(22)
v_mfma_f32_16x16x32_bf16 v[32:35], a[216:219], v[160:163], v[32:35]
buffer_load_dword v12, v11, s[24:27], s51 offen offset:4 sc1
v_mfma_f32_16x16x32_bf16 v[56:59], a[216:219], v[164:167], v[56:59]
v_mfma_f32_16x16x32_bf16 v[80:83], a[216:219], v[168:171], v[80:83]
s_add_u32 s48, s63, 15
s_and_b32 s48, s48, 3
v_mfma_f32_16x16x32_bf16 v[104:107], a[216:219], v[172:175], v[104:107]
s_lshl4_add_u32 s48, s3, s48
s_add_u32 s48, s48, 12
v_mfma_f32_16x16x32_bf16 v[36:39], a[220:223], v[160:163], v[36:39]
s_mul_i32 s48, s48, 8192
s_add_u32 s61, s58, s48
v_mfma_f32_16x16x32_bf16 v[60:63], a[220:223], v[164:167], v[60:63]
buffer_load_dwordx4 v[128:131], v4, s[24:27], s61 offen offset:0 sc1
v_mfma_f32_16x16x32_bf16 v[84:87], a[220:223], v[168:171], v[84:87]
v_mfma_f32_16x16x32_bf16 v[108:111], a[220:223], v[172:175], v[108:111]
buffer_load_dwordx4 v[132:135], v4, s[24:27], s61 offen offset:1024 sc1
v_mfma_f32_16x16x32_bf16 v[40:43], a[224:227], v[160:163], v[40:43]
v_mfma_f32_16x16x32_bf16 v[64:67], a[224:227], v[164:167], v[64:67]
buffer_load_dwordx4 v[136:139], v4, s[24:27], s61 offen offset:2048 sc1
v_mfma_f32_16x16x32_bf16 v[88:91], a[224:227], v[168:171], v[88:91]
v_mfma_f32_16x16x32_bf16 v[112:115], a[224:227], v[172:175], v[112:115]
buffer_load_dwordx4 v[140:143], v4, s[24:27], s61 offen offset:3072 sc1
v_mfma_f32_16x16x32_bf16 v[44:47], a[228:231], v[160:163], v[44:47]
v_mfma_f32_16x16x32_bf16 v[68:71], a[228:231], v[164:167], v[68:71]
buffer_load_dwordx4 v[144:147], v7, s[24:27], s61 offen offset:0 sc1
v_mfma_f32_16x16x32_bf16 v[92:95], a[228:231], v[168:171], v[92:95]
v_mfma_f32_16x16x32_bf16 v[116:119], a[228:231], v[172:175], v[116:119]
buffer_load_dwordx4 v[148:151], v7, s[24:27], s61 offen offset:1024 sc1
v_mfma_f32_16x16x32_bf16 v[48:51], a[248:251], v[160:163], v[48:51]
v_mfma_f32_16x16x32_bf16 v[72:75], a[248:251], v[164:167], v[72:75]
buffer_load_dwordx4 v[152:155], v7, s[24:27], s61 offen offset:2048 sc1
v_mfma_f32_16x16x32_bf16 v[96:99], a[248:251], v[168:171], v[96:99]
v_mfma_f32_16x16x32_bf16 v[120:123], a[248:251], v[172:175], v[120:123]
buffer_load_dwordx4 v[156:159], v7, s[24:27], s61 offen offset:3072 sc1
v_mfma_f32_16x16x32_bf16 v[32:35], a[232:235], v[176:179], v[32:35]
v_mfma_f32_16x16x32_bf16 v[56:59], a[232:235], v[180:183], v[56:59]
buffer_load_dwordx4 a[84:87], v4, s[24:27], s62 offen offset:3072 sc1
v_mfma_f32_16x16x32_bf16 v[80:83], a[232:235], v[184:187], v[80:83]
v_mfma_f32_16x16x32_bf16 v[104:107], a[232:235], v[188:191], v[104:107]
buffer_load_dwordx4 a[88:91], v7, s[24:27], s62 offen offset:0 sc1
v_mfma_f32_16x16x32_bf16 v[36:39], a[236:239], v[176:179], v[36:39]
v_mfma_f32_16x16x32_bf16 v[60:63], a[236:239], v[180:183], v[60:63]
buffer_load_dwordx4 a[92:95], v7, s[24:27], s62 offen offset:1024 sc1
v_mfma_f32_16x16x32_bf16 v[84:87], a[236:239], v[184:187], v[84:87]
v_mfma_f32_16x16x32_bf16 v[108:111], a[236:239], v[188:191], v[108:111]
buffer_load_dwordx4 a[96:99], v7, s[24:27], s62 offen offset:2048 sc1
v_mfma_f32_16x16x32_bf16 v[40:43], a[240:243], v[176:179], v[40:43]
v_mfma_f32_16x16x32_bf16 v[64:67], a[240:243], v[180:183], v[64:67]
buffer_load_dwordx4 a[100:103], v7, s[24:27], s62 offen offset:3072 sc1
v_mfma_f32_16x16x32_bf16 v[88:91], a[240:243], v[184:187], v[88:91]
v_mfma_f32_16x16x32_bf16 v[112:115], a[240:243], v[188:191], v[112:115]
buffer_load_dwordx4 a[104:107], v8, s[24:27], s62 offen offset:0 sc1
v_mfma_f32_16x16x32_bf16 v[44:47], a[244:247], v[176:179], v[44:47]
v_mfma_f32_16x16x32_bf16 v[68:71], a[244:247], v[180:183], v[68:71]
s_add_u32 s48, s3, 68
s_mul_i32 s48, s48, 9216
v_mfma_f32_16x16x32_bf16 v[92:95], a[244:247], v[184:187], v[92:95]
s_add_u32 s62, s59, s48
v_mfma_f32_16x16x32_bf16 v[116:119], a[244:247], v[188:191], v[116:119]
buffer_load_dwordx4 a[108:111], v4, s[24:27], s62 offen offset:0 sc1
v_mfma_f32_16x16x32_bf16 v[52:55], a[248:251], v[176:179], v[52:55]
v_mfma_f32_16x16x32_bf16 v[76:79], a[248:251], v[180:183], v[76:79]
v_mfma_f32_16x16x32_bf16 v[100:103], a[248:251], v[184:187], v[100:103]
v_mfma_f32_16x16x32_bf16 v[124:127], a[248:251], v[188:191], v[124:127]
s_waitcnt vmcnt(23)
s_waitcnt vmcnt(15)
v_cmp_gt_u32 vcc, 8, v12
s_nop 4
s_cbranch_vccnz CK_ZAA
CK_ZAA_R:
v_mfma_f32_16x16x32_bf16 v[32:35], a[0:3], v[192:195], v[32:35]
s_add_u32 s48, s3, 64
s_mul_i32 s48, s48, 8192
v_mfma_f32_16x16x32_bf16 v[56:59], a[0:3], v[196:199], v[56:59]
s_add_u32 s61, s58, s48
v_mfma_f32_16x16x32_bf16 v[80:83], a[0:3], v[200:203], v[80:83]
buffer_load_dwordx4 v[160:163], v4, s[24:27], s61 offen offset:0 sc1
v_mfma_f32_16x16x32_bf16 v[104:107], a[0:3], v[204:207], v[104:107]
v_mfma_f32_16x16x32_bf16 v[36:39], a[4:7], v[192:195], v[36:39]
buffer_load_dwordx4 v[164:167], v4, s[24:27], s61 offen offset:1024 sc1
v_mfma_f32_16x16x32_bf16 v[60:63], a[4:7], v[196:199], v[60:63]
v_mfma_f32_16x16x32_bf16 v[84:87], a[4:7], v[200:203], v[84:87]
buffer_load_dwordx4 v[168:171], v4, s[24:27], s61 offen offset:2048 sc1
v_mfma_f32_16x16x32_bf16 v[108:111], a[4:7], v[204:207], v[108:111]
v_mfma_f32_16x16x32_bf16 v[40:43], a[8:11], v[192:195], v[40:43]
buffer_load_dwordx4 v[172:175], v4, s[24:27], s61 offen offset:3072 sc1
v_mfma_f32_16x16x32_bf16 v[64:67], a[8:11], v[196:199], v[64:67]
v_mfma_f32_16x16x32_bf16 v[88:91], a[8:11], v[200:203], v[88:91]
buffer_load_dwordx4 v[176:179], v7, s[24:27], s61 offen offset:0 sc1
v_mfma_f32_16x16x32_bf16 v[112:115], a[8:11], v[204:207], v[112:115]
v_mfma_f32_16x16x32_bf16 v[44:47], a[12:15], v[192:195], v[44:47]
buffer_load_dwordx4 v[180:183], v7, s[24:27], s61 offen offset:1024 sc1
v_mfma_f32_16x16x32_bf16 v[68:71], a[12:15], v[196:199], v[68:71]
v_mfma_f32_16x16x32_bf16 v[92:95], a[12:15], v[200:203], v[92:95]
buffer_load_dwordx4 v[184:187], v7, s[24:27], s61 offen offset:2048 sc1
v_mfma_f32_16x16x32_bf16 v[116:119], a[12:15], v[204:207], v[116:119]
v_mfma_f32_16x16x32_bf16 v[48:51], a[32:35], v[192:195], v[48:51]
buffer_load_dwordx4 v[188:191], v7, s[24:27], s61 offen offset:3072 sc1
v_mfma_f32_16x16x32_bf16 v[72:75], a[32:35], v[196:199], v[72:75]
v_mfma_f32_16x16x32_bf16 v[96:99], a[32:35], v[200:203], v[96:99]
buffer_load_dwordx4 a[112:115], v4, s[24:27], s62 offen offset:1024 sc1
v_mfma_f32_16x16x32_bf16 v[120:123], a[32:35], v[204:207], v[120:123]
v_mfma_f32_16x16x32_bf16 v[32:35], a[16:19], v[208:211], v[32:35]
buffer_load_dwordx4 a[116:119], v4, s[24:27], s62 offen offset:2048 sc1
v_mfma_f32_16x16x32_bf16 v[56:59], a[16:19], v[212:215], v[56:59]
v_mfma_f32_16x16x32_bf16 v[80:83], a[16:19], v[216:219], v[80:83]
buffer_load_dwordx4 a[120:123], v4, s[24:27], s62 offen offset:3072 sc1
v_mfma_f32_16x16x32_bf16 v[104:107], a[16:19], v[220:223], v[104:107]
v_mfma_f32_16x16x32_bf16 v[36:39], a[20:23], v[208:211], v[36:39]
buffer_load_dwordx4 a[124:127], v7, s[24:27], s62 offen offset:0 sc1
v_mfma_f32_16x16x32_bf16 v[60:63], a[20:23], v[212:215], v[60:63]
v_mfma_f32_16x16x32_bf16 v[84:87], a[20:23], v[216:219], v[84:87]
buffer_load_dwordx4 a[128:131], v7, s[24:27], s62 offen offset:1024 sc1
v_mfma_f32_16x16x32_bf16 v[108:111], a[20:23], v[220:223], v[108:111]
v_mfma_f32_16x16x32_bf16 v[40:43], a[24:27], v[208:211], v[40:43]
buffer_load_dwordx4 a[132:135], v7, s[24:27], s62 offen offset:2048 sc1
v_mfma_f32_16x16x32_bf16 v[64:67], a[24:27], v[212:215], v[64:67]
v_mfma_f32_16x16x32_bf16 v[88:91], a[24:27], v[216:219], v[88:91]
buffer_load_dwordx4 a[136:139], v7, s[24:27], s62 offen offset:3072 sc1
v_mfma_f32_16x16x32_bf16 v[112:115], a[24:27], v[220:223], v[112:115]
v_mfma_f32_16x16x32_bf16 v[44:47], a[28:31], v[208:211], v[44:47]
v_mfma_f32_16x16x32_bf16 v[68:71], a[28:31], v[212:215], v[68:71]
v_mfma_f32_16x16x32_bf16 v[92:95], a[28:31], v[216:219], v[92:95]
v_mfma_f32_16x16x32_bf16 v[116:119], a[28:31], v[220:223], v[116:119]
v_mfma_f32_16x16x32_bf16 v[52:55], a[32:35], v[208:211], v[52:55]
v_mfma_f32_16x16x32_bf16 v[76:79], a[32:35], v[212:215], v[76:79]
v_mfma_f32_16x16x32_bf16 v[100:103], a[32:35], v[216:219], v[100:103]
v_mfma_f32_16x16x32_bf16 v[124:127], a[32:35], v[220:223], v[124:127]
s_waitcnt vmcnt(22)
v_mfma_f32_16x16x32_bf16 v[32:35], a[36:39], v[128:131], v[32:35]
s_add_u32 s48, s3, 68
s_mul_i32 s48, s48, 8192
v_mfma_f32_16x16x32_bf16 v[56:59], a[36:39], v[132:135], v[56:59]
s_add_u32 s61, s58, s48
v_mfma_f32_16x16x32_bf16 v[80:83], a[36:39], v[136:139], v[80:83]
buffer_load_dwordx4 v[192:195], v4, s[24:27], s61 offen offset:0 sc1
v_mfma_f32_16x16x32_bf16 v[104:107], a[36:39], v[140:143], v[104:107]
v_mfma_f32_16x16x32_bf16 v[36:39], a[40:43], v[128:131], v[36:39]
buffer_load_dwordx4 v[196:199], v4, s[24:27], s61 offen offset:1024 sc1
v_mfma_f32_16x16x32_bf16 v[60:63], a[40:43], v[132:135], v[60:63]
v_mfma_f32_16x16x32_bf16 v[84:87], a[40:43], v[136:139], v[84:87]
buffer_load_dwordx4 v[200:203], v4, s[24:27], s61 offen offset:2048 sc1
v_mfma_f32_16x16x32_bf16 v[108:111], a[40:43], v[140:143], v[108:111]
v_mfma_f32_16x16x32_bf16 v[40:43], a[44:47], v[128:131], v[40:43]
buffer_load_dwordx4 v[204:207], v4, s[24:27], s61 offen offset:3072 sc1
v_mfma_f32_16x16x32_bf16 v[64:67], a[44:47], v[132:135], v[64:67]
v_mfma_f32_16x16x32_bf16 v[88:91], a[44:47], v[136:139], v[88:91]
buffer_load_dwordx4 v[208:211], v7, s[24:27], s61 offen offset:0 sc1
v_mfma_f32_16x16x32_bf16 v[112:115], a[44:47], v[140:143], v[112:115]
v_mfma_f32_16x16x32_bf16 v[44:47], a[48:51], v[128:131], v[44:47]
buffer_load_dwordx4 v[212:215], v7, s[24:27], s61 offen offset:1024 sc1
v_mfma_f32_16x16x32_bf16 v[68:71], a[48:51], v[132:135], v[68:71]
v_mfma_f32_16x16x32_bf16 v[92:95], a[48:51], v[136:139], v[92:95]
buffer_load_dwordx4 v[216:219], v7, s[24:27], s61 offen offset:2048 sc1
v_mfma_f32_16x16x32_bf16 v[116:119], a[48:51], v[140:143], v[116:119]
v_mfma_f32_16x16x32_bf16 v[48:51], a[68:71], v[128:131], v[48:51]
buffer_load_dwordx4 v[220:223], v7, s[24:27], s61 offen offset:3072 sc1
v_mfma_f32_16x16x32_bf16 v[72:75], a[68:71], v[132:135], v[72:75]
v_mfma_f32_16x16x32_bf16 v[96:99], a[68:71], v[136:139], v[96:99]
buffer_load_dwordx4 a[140:143], v8, s[24:27], s62 offen offset:0 sc1
v_mfma_f32_16x16x32_bf16 v[120:123], a[68:71], v[140:143], v[120:123]
v_mfma_f32_16x16x32_bf16 v[32:35], a[52:55], v[144:147], v[32:35]
s_add_u32 s48, s3, 72
s_mul_i32 s48, s48, 9216
v_mfma_f32_16x16x32_bf16 v[56:59], a[52:55], v[148:151], v[56:59]
s_add_u32 s62, s59, s48
s_cmp_eq_u32 s3, 0
v_mfma_f32_16x16x32_bf16 v[80:83], a[52:55], v[152:155], v[80:83]
s_cselect_b32 s62, s62, 2147418112
v_mfma_f32_16x16x32_bf16 v[104:107], a[52:55], v[156:159], v[104:107]
buffer_load_dwordx4 a[144:147], v4, s[24:27], s62 offen offset:0 sc1
v_mfma_f32_16x16x32_bf16 v[36:39], a[56:59], v[144:147], v[36:39]
v_mfma_f32_16x16x32_bf16 v[60:63], a[56:59], v[148:151], v[60:63]
buffer_load_dwordx4 a[148:151], v4, s[24:27], s62 offen offset:1024 sc1
v_mfma_f32_16x16x32_bf16 v[84:87], a[56:59], v[152:155], v[84:87]
v_mfma_f32_16x16x32_bf16 v[108:111], a[56:59], v[156:159], v[108:111]
buffer_load_dwordx4 a[152:155], v4, s[24:27], s62 offen offset:2048 sc1
v_mfma_f32_16x16x32_bf16 v[40:43], a[60:63], v[144:147], v[40:43]
v_mfma_f32_16x16x32_bf16 v[64:67], a[60:63], v[148:151], v[64:67]
buffer_load_dwordx4 a[156:159], v4, s[24:27], s62 offen offset:3072 sc1
v_mfma_f32_16x16x32_bf16 v[88:91], a[60:63], v[152:155], v[88:91]
v_mfma_f32_16x16x32_bf16 v[112:115], a[60:63], v[156:159], v[112:115]
buffer_load_dwordx4 a[160:163], v7, s[24:27], s62 offen offset:0 sc1
v_mfma_f32_16x16x32_bf16 v[44:47], a[64:67], v[144:147], v[44:47]
v_mfma_f32_16x16x32_bf16 v[68:71], a[64:67], v[148:151], v[68:71]
buffer_load_dwordx4 a[164:167], v7, s[24:27], s62 offen offset:1024 sc1
v_mfma_f32_16x16x32_bf16 v[92:95], a[64:67], v[152:155], v[92:95]
v_mfma_f32_16x16x32_bf16 v[116:119], a[64:67], v[156:159], v[116:119]
v_mfma_f32_16x16x32_bf16 v[52:55], a[68:71], v[144:147], v[52:55]
v_mfma_f32_16x16x32_bf16 v[76:79], a[68:71], v[148:151], v[76:79]
v_mfma_f32_16x16x32_bf16 v[100:103], a[68:71], v[152:155], v[100:103]
v_mfma_f32_16x16x32_bf16 v[124:127], a[68:71], v[156:159], v[124:127]
s_waitcnt vmcnt(22)
v_mfma_f32_16x16x32_bf16 v[32:35], a[72:75], v[160:163], v[32:35]
s_add_u32 s48, s3, 72
s_mul_i32 s48, s48, 8192
v_mfma_f32_16x16x32_bf16 v[56:59], a[72:75], v[164:167], v[56:59]
s_add_u32 s61, s58, s48
s_cmp_eq_u32 s3, 0
v_mfma_f32_16x16x32_bf16 v[80:83], a[72:75], v[168:171], v[80:83]
s_cselect_b32 s61, s61, 2147418112
v_mfma_f32_16x16x32_bf16 v[104:107], a[72:75], v[172:175], v[104:107]
buffer_load_dwordx4 v[128:131], v4, s[24:27], s61 offen offset:0 sc1
v_mfma_f32_16x16x32_bf16 v[36:39], a[76:79], v[160:163], v[36:39]
v_mfma_f32_16x16x32_bf16 v[60:63], a[76:79], v[164:167], v[60:63]
buffer_load_dwordx4 v[132:135], v4, s[24:27], s61 offen offset:1024 sc1
v_mfma_f32_16x16x32_bf16 v[84:87], a[76:79], v[168:171], v[84:87]
v_mfma_f32_16x16x32_bf16 v[108:111], a[76:79], v[172:175], v[108:111]
buffer_load_dwordx4 v[136:139], v4, s[24:27], s61 offen offset:2048 sc1
v_mfma_f32_16x16x32_bf16 v[40:43], a[80:83], v[160:163], v[40:43]
v_mfma_f32_16x16x32_bf16 v[64:67], a[80:83], v[164:167], v[64:67]
buffer_load_dwordx4 v[140:143], v4, s[24:27], s61 offen offset:3072 sc1
v_mfma_f32_16x16x32_bf16 v[88:91], a[80:83], v[168:171], v[88:91]
v_mfma_f32_16x16x32_bf16 v[112:115], a[80:83], v[172:175], v[112:115]
buffer_load_dwordx4 v[144:147], v7, s[24:27], s61 offen offset:0 sc1
v_mfma_f32_16x16x32_bf16 v[44:47], a[84:87], v[160:163], v[44:47]
v_mfma_f32_16x16x32_bf16 v[68:71], a[84:87], v[164:167], v[68:71]
buffer_load_dwordx4 v[148:151], v7, s[24:27], s61 offen offset:1024 sc1
v_mfma_f32_16x16x32_bf16 v[92:95], a[84:87], v[168:171], v[92:95]
v_mfma_f32_16x16x32_bf16 v[116:119], a[84:87], v[172:175], v[116:119]
buffer_load_dwordx4 v[152:155], v7, s[24:27], s61 offen offset:2048 sc1
v_mfma_f32_16x16x32_bf16 v[48:51], a[104:107], v[160:163], v[48:51]
v_mfma_f32_16x16x32_bf16 v[72:75], a[104:107], v[164:167], v[72:75]
buffer_load_dwordx4 v[156:159], v7, s[24:27], s61 offen offset:3072 sc1
v_mfma_f32_16x16x32_bf16 v[96:99], a[104:107], v[168:171], v[96:99]
v_mfma_f32_16x16x32_bf16 v[120:123], a[104:107], v[172:175], v[120:123]
buffer_load_dwordx4 a[168:171], v7, s[24:27], s62 offen offset:2048 sc1
v_mfma_f32_16x16x32_bf16 v[32:35], a[88:91], v[176:179], v[32:35]
v_mfma_f32_16x16x32_bf16 v[56:59], a[88:91], v[180:183], v[56:59]
buffer_load_dwordx4 a[172:175], v7, s[24:27], s62 offen offset:3072 sc1
v_mfma_f32_16x16x32_bf16 v[80:83], a[88:91], v[184:187], v[80:83]
v_mfma_f32_16x16x32_bf16 v[104:107], a[88:91], v[188:191], v[104:107]
buffer_load_dwordx4 a[176:179], v8, s[24:27], s62 offen offset:0 sc1
v_mfma_f32_16x16x32_bf16 v[36:39], a[92:95], v[176:179], v[36:39]
v_mfma_f32_16x16x32_bf16 v[60:63], a[92:95], v[180:183], v[60:63]
v_mfma_f32_16x16x32_bf16 v[84:87], a[92:95], v[184:187], v[84:87]
v_mfma_f32_16x16x32_bf16 v[108:111], a[92:95], v[188:191], v[108:111]
v_mfma_f32_16x16x32_bf16 v[40:43], a[96:99], v[176:179], v[40:43]
v_mfma_f32_16x16x32_bf16 v[64:67], a[96:99], v[180:183], v[64:67]
v_mfma_f32_16x16x32_bf16 v[88:91], a[96:99], v[184:187], v[88:91]
v_mfma_f32_16x16x32_bf16 v[112:115], a[96:99], v[188:191], v[112:115]
v_mfma_f32_16x16x32_bf16 v[44:47], a[100:103], v[176:179], v[44:47]
v_mfma_f32_16x16x32_bf16 v[68:71], a[100:103], v[180:183], v[68:71]
v_mfma_f32_16x16x32_bf16 v[92:95], a[100:103], v[184:187], v[92:95]
v_mfma_f32_16x16x32_bf16 v[116:119], a[100:103], v[188:191], v[116:119]
v_mfma_f32_16x16x32_bf16 v[52:55], a[104:107], v[176:179], v[52:55]
v_mfma_f32_16x16x32_bf16 v[76:79], a[104:107], v[180:183], v[76:79]
v_mfma_f32_16x16x32_bf16 v[100:103], a[104:107], v[184:187], v[100:103]
v_mfma_f32_16x16x32_bf16 v[124:127], a[104:107], v[188:191], v[124:127]
s_waitcnt vmcnt(17)
v_mfma_f32_16x16x32_bf16 v[32:35], a[108:111], v[192:195], v[32:35]
v_mfma_f32_16x16x32_bf16 v[56:59], a[108:111], v[196:199], v[56:59]
v_mfma_f32_16x16x32_bf16 v[80:83], a[108:111], v[200:203], v[80:83]
v_mfma_f32_16x16x32_bf16 v[104:107], a[108:111], v[204:207], v[104:107]
v_mfma_f32_16x16x32_bf16 v[36:39], a[112:115], v[192:195], v[36:39]
v_mfma_f32_16x16x32_bf16 v[60:63], a[112:115], v[196:199], v[60:63]
v_mfma_f32_16x16x32_bf16 v[84:87], a[112:115], v[200:203], v[84:87]
v_mfma_f32_16x16x32_bf16 v[108:111], a[112:115], v[204:207], v[108:111]
v_mfma_f32_16x16x32_bf16 v[40:43], a[116:119], v[192:195], v[40:43]
v_mfma_f32_16x16x32_bf16 v[64:67], a[116:119], v[196:199], v[64:67]
v_mfma_f32_16x16x32_bf16 v[88:91], a[116:119], v[200:203], v[88:91]
v_mfma_f32_16x16x32_bf16 v[112:115], a[116:119], v[204:207], v[112:115]
v_mfma_f32_16x16x32_bf16 v[44:47], a[120:123], v[192:195], v[44:47]
v_mfma_f32_16x16x32_bf16 v[68:71], a[120:123], v[196:199], v[68:71]
v_mfma_f32_16x16x32_bf16 v[92:95], a[120:123], v[200:203], v[92:95]
v_mfma_f32_16x16x32_bf16 v[116:119], a[120:123], v[204:207], v[116:119]
v_mfma_f32_16x16x32_bf16 v[48:51], a[140:143], v[192:195], v[48:51]
v_mfma_f32_16x16x32_bf16 v[72:75], a[140:143], v[196:199], v[72:75]
v_mfma_f32_16x16x32_bf16 v[96:99], a[140:143], v[200:203], v[96:99]
v_mfma_f32_16x16x32_bf16 v[120:123], a[140:143], v[204:207], v[120:123]
v_mfma_f32_16x16x32_bf16 v[32:35], a[124:127], v[208:211], v[32:35]
v_mfma_f32_16x16x32_bf16 v[56:59], a[124:127], v[212:215], v[56:59]
v_mfma_f32_16x16x32_bf16 v[80:83], a[124:127], v[216:219], v[80:83]
v_mfma_f32_16x16x32_bf16 v[104:107], a[124:127], v[220:223], v[104:107]
v_mfma_f32_16x16x32_bf16 v[36:39], a[128:131], v[208:211], v[36:39]
v_mfma_f32_16x16x32_bf16 v[60:63], a[128:131], v[212:215], v[60:63]
v_mfma_f32_16x16x32_bf16 v[84:87], a[128:131], v[216:219], v[84:87]
v_mfma_f32_16x16x32_bf16 v[108:111], a[128:131], v[220:223], v[108:111]
v_mfma_f32_16x16x32_bf16 v[40:43], a[132:135], v[208:211], v[40:43]
v_mfma_f32_16x16x32_bf16 v[64:67], a[132:135], v[212:215], v[64:67]
v_mfma_f32_16x16x32_bf16 v[88:91], a[132:135], v[216:219], v[88:91]
v_mfma_f32_16x16x32_bf16 v[112:115], a[132:135], v[220:223], v[112:115]
v_mfma_f32_16x16x32_bf16 v[44:47], a[136:139], v[208:211], v[44:47]
v_mfma_f32_16x16x32_bf16 v[68:71], a[136:139], v[212:215], v[68:71]
v_mfma_f32_16x16x32_bf16 v[92:95], a[136:139], v[216:219], v[92:95]
v_mfma_f32_16x16x32_bf16 v[116:119], a[136:139], v[220:223], v[116:119]
v_mfma_f32_16x16x32_bf16 v[52:55], a[140:143], v[208:211], v[52:55]
v_mfma_f32_16x16x32_bf16 v[76:79], a[140:143], v[212:215], v[76:79]
v_mfma_f32_16x16x32_bf16 v[100:103], a[140:143], v[216:219], v[100:103]
v_mfma_f32_16x16x32_bf16 v[124:127], a[140:143], v[220:223], v[124:127]
s_cmp_lg_u32 s3, 0
s_cbranch_scc1 L_RED
s_waitcnt vmcnt(0)
v_mfma_f32_16x16x32_bf16 v[32:35], a[144:147], v[128:131], v[32:35]
v_mfma_f32_16x16x32_bf16 v[56:59], a[144:147], v[132:135], v[56:59]
v_mfma_f32_16x16x32_bf16 v[80:83], a[144:147], v[136:139], v[80:83]
v_mfma_f32_16x16x32_bf16 v[104:107], a[144:147], v[140:143], v[104:107]
v_mfma_f32_16x16x32_bf16 v[36:39], a[148:151], v[128:131], v[36:39]
v_mfma_f32_16x16x32_bf16 v[60:63], a[148:151], v[132:135], v[60:63]
v_mfma_f32_16x16x32_bf16 v[84:87], a[148:151], v[136:139], v[84:87]
v_mfma_f32_16x16x32_bf16 v[108:111], a[148:151], v[140:143], v[108:111]
v_mfma_f32_16x16x32_bf16 v[40:43], a[152:155], v[128:131], v[40:43]
v_mfma_f32_16x16x32_bf16 v[64:67], a[152:155], v[132:135], v[64:67]
v_mfma_f32_16x16x32_bf16 v[88:91], a[152:155], v[136:139], v[88:91]
v_mfma_f32_16x16x32_bf16 v[112:115], a[152:155], v[140:143], v[112:115]
v_mfma_f32_16x16x32_bf16 v[44:47], a[156:159], v[128:131], v[44:47]
v_mfma_f32_16x16x32_bf16 v[68:71], a[156:159], v[132:135], v[68:71]
v_mfma_f32_16x16x32_bf16 v[92:95], a[156:159], v[136:139], v[92:95]
v_mfma_f32_16x16x32_bf16 v[116:119], a[156:159], v[140:143], v[116:119]
v_mfma_f32_16x16x32_bf16 v[48:51], a[176:179], v[128:131], v[48:51]
v_mfma_f32_16x16x32_bf16 v[72:75], a[176:179], v[132:135], v[72:75]
v_mfma_f32_16x16x32_bf16 v[96:99], a[176:179], v[136:139], v[96:99]
v_mfma_f32_16x16x32_bf16 v[120:123], a[176:179], v[140:143], v[120:123]
v_mfma_f32_16x16x32_bf16 v[32:35], a[160:163], v[144:147], v[32:35]
v_mfma_f32_16x16x32_bf16 v[56:59], a[160:163], v[148:151], v[56:59]
v_mfma_f32_16x16x32_bf16 v[80:83], a[160:163], v[152:155], v[80:83]
v_mfma_f32_16x16x32_bf16 v[104:107], a[160:163], v[156:159], v[104:107]
v_mfma_f32_16x16x32_bf16 v[36:39], a[164:167], v[144:147], v[36:39]
v_mfma_f32_16x16x32_bf16 v[60:63], a[164:167], v[148:151], v[60:63]
v_mfma_f32_16x16x32_bf16 v[84:87], a[164:167], v[152:155], v[84:87]
v_mfma_f32_16x16x32_bf16 v[108:111], a[164:167], v[156:159], v[108:111]
v_mfma_f32_16x16x32_bf16 v[40:43], a[168:171], v[144:147], v[40:43]
v_mfma_f32_16x16x32_bf16 v[64:67], a[168:171], v[148:151], v[64:67]
v_mfma_f32_16x16x32_bf16 v[88:91], a[168:171], v[152:155], v[88:91]
v_mfma_f32_16x16x32_bf16 v[112:115], a[168:171], v[156:159], v[112:115]
v_mfma_f32_16x16x32_bf16 v[44:47], a[172:175], v[144:147], v[44:47]
v_mfma_f32_16x16x32_bf16 v[68:71], a[172:175], v[148:151], v[68:71]
v_mfma_f32_16x16x32_bf16 v[92:95], a[172:175], v[152:155], v[92:95]
v_mfma_f32_16x16x32_bf16 v[116:119], a[172:175], v[156:159], v[116:119]
v_mfma_f32_16x16x32_bf16 v[52:55], a[176:179], v[144:147], v[52:55]
v_mfma_f32_16x16x32_bf16 v[76:79], a[176:179], v[148:151], v[76:79]
v_mfma_f32_16x16x32_bf16 v[100:103], a[176:179], v[152:155], v[100:103]
v_mfma_f32_16x16x32_bf16 v[124:127], a[176:179], v[156:159], v[124:127]
L_RED:
v_cmp_lt_u32 vcc, 31, v1
s_mul_i32 s48, s3, 20480
v_add_u32 v5, s48, v4
s_mul_i32 s48, s3, 5120
v_add_u32 v6, s48, v4
s_waitcnt vmcnt(0)
s_barrier
s_nop 1
v_cndmask_b32 v48, v48, v52, vcc
v_cndmask_b32 v49, v49, v53, vcc
v_cndmask_b32 v50, v50, v54, vcc
v_cndmask_b32 v51, v51, v55, vcc
v_cndmask_b32 v72, v72, v76, vcc
v_cndmask_b32 v73, v73, v77, vcc
v_cndmask_b32 v74, v74, v78, vcc
v_cndmask_b32 v75, v75, v79, vcc
v_cndmask_b32 v96, v96, v100, vcc
v_cndmask_b32 v97, v97, v101, vcc
v_cndmask_b32 v98, v98, v102, vcc
v_cndmask_b32 v99, v99, v103, vcc
v_cndmask_b32 v120, v120, v124, vcc
v_cndmask_b32 v121, v121, v125, vcc
v_cndmask_b32 v122, v122, v126, vcc
v_cndmask_b32 v123, v123, v127, vcc
ds_write_b128 v5, v[32:35] offset:0
ds_write_b128 v5, v[36:39] offset:1024
ds_write_b128 v5, v[40:43] offset:2048
ds_write_b128 v5, v[44:47] offset:3072
ds_write_b128 v5, v[48:51] offset:4096
ds_write_b128 v5, v[56:59] offset:5120
ds_write_b128 v5, v[60:63] offset:6144
ds_write_b128 v5, v[64:67] offset:7168
ds_write_b128 v5, v[68:71] offset:8192
ds_write_b128 v5, v[72:75] offset:9216
ds_write_b128 v5, v[80:83] offset:10240
ds_write_b128 v5, v[84:87] offset:11264
ds_write_b128 v5, v[88:91] offset:12288
ds_write_b128 v5, v[92:95] offset:13312
ds_write_b128 v5, v[96:99] offset:14336
ds_write_b128 v5, v[104:107] offset:15360
ds_write_b128 v5, v[108:111] offset:16384
ds_write_b128 v5, v[112:115] offset:17408
ds_write_b128 v5, v[116:119] offset:18432
ds_write_b128 v5, v[120:123] offset:19456
v_add_u32 v7, 40960, v6
s_sub_u32 s48, 63, s56
s_cmp_lt_u32 s3, 2
s_cselect_b32 s48, s56, s48
s_lshl_b32 s48, s48, 5
s_and_b32 s49, s3, 1
s_lshl_b32 s49, s49, 4
s_add_u32 s48, s48, s49
s_mul_i32 s48, s48, 1152
s_mul_i32 s49, s57, 144
s_add_u32 s48, s48, s49
v_mul_u32_u24 v10, 1152, v2
v_lshl_add_u32 v8, v3, 5, v10
v_lshl_add_u32 v10, v3, 3, v10
v_mov_b32 v9, 2147418112
v_cndmask_b32 v9, v10, v9, vcc
s_waitcnt lgkmcnt(0)
s_barrier
ds_read_b128 v[128:131], v6 offset:0
ds_read_b128 v[132:135], v6 offset:1024
ds_read_b128 v[136:139], v6 offset:2048
ds_read_b128 v[140:143], v6 offset:3072
ds_read_b128 v[144:147], v6 offset:4096
ds_read_b128 v[148:151], v6 offset:20480
ds_read_b128 v[152:155], v6 offset:21504
ds_read_b128 v[156:159], v6 offset:22528
ds_read_b128 v[160:163], v6 offset:23552
ds_read_b128 v[164:167], v6 offset:24576
ds_read_b128 v[168:171], v7 offset:0
ds_read_b128 v[172:175], v7 offset:1024
ds_read_b128 v[176:179], v7 offset:2048
ds_read_b128 v[180:183], v7 offset:3072
ds_read_b128 v[184:187], v7 offset:4096
s_waitcnt lgkmcnt(5)
ds_read_b128 v[188:191], v7 offset:20480
ds_read_b128 v[192:195], v7 offset:21504
ds_read_b128 v[196:199], v7 offset:22528
ds_read_b128 v[200:203], v7 offset:23552
ds_read_b128 v[204:207], v7 offset:24576
v_pk_add_f32 v[128:129], v[128:129], v[148:149]
v_pk_add_f32 v[130:131], v[130:131], v[150:151]
v_pk_add_f32 v[132:133], v[132:133], v[152:153]
v_pk_add_f32 v[134:135], v[134:135], v[154:155]
v_pk_add_f32 v[136:137], v[136:137], v[156:157]
v_pk_add_f32 v[138:139], v[138:139], v[158:159]
v_pk_add_f32 v[140:141], v[140:141], v[160:161]
v_pk_add_f32 v[142:143], v[142:143], v[162:163]
v_pk_add_f32 v[144:145], v[144:145], v[164:165]
v_pk_add_f32 v[146:147], v[146:147], v[166:167]
s_waitcnt lgkmcnt(5)
v_pk_add_f32 v[128:129], v[128:129], v[168:169]
v_pk_add_f32 v[130:131], v[130:131], v[170:171]
v_pk_add_f32 v[132:133], v[132:133], v[172:173]
v_pk_add_f32 v[134:135], v[134:135], v[174:175]
v_pk_add_f32 v[136:137], v[136:137], v[176:177]
v_pk_add_f32 v[138:139], v[138:139], v[178:179]
v_pk_add_f32 v[140:141], v[140:141], v[180:181]
v_pk_add_f32 v[142:143], v[142:143], v[182:183]
v_pk_add_f32 v[144:145], v[144:145], v[184:185]
v_pk_add_f32 v[146:147], v[146:147], v[186:187]
s_waitcnt lgkmcnt(0)
v_pk_add_f32 v[128:129], v[128:129], v[188:189]
v_pk_add_f32 v[130:131], v[130:131], v[190:191]
v_pk_add_f32 v[132:133], v[132:133], v[192:193]
v_pk_add_f32 v[134:135], v[134:135], v[194:195]
v_pk_add_f32 v[136:137], v[136:137], v[196:197]
v_pk_add_f32 v[138:139], v[138:139], v[198:199]
v_pk_add_f32 v[140:141], v[140:141], v[200:201]
v_pk_add_f32 v[142:143], v[142:143], v[202:203]
v_pk_add_f32 v[144:145], v[144:145], v[204:205]
v_pk_add_f32 v[146:147], v[146:147], v[206:207]
v_mov_b32 v148, v144
v_mov_b32 v149, v145
v_mov_b32 v150, v146
v_mov_b32 v151, v147
v_cvt_pk_bf16_f32 v32, v128, v132
v_cvt_pk_bf16_f32 v33, v136, v140
v_cvt_pk_bf16_f32 v34, v129, v133
v_cvt_pk_bf16_f32 v35, v137, v141
v_cvt_pk_bf16_f32 v36, v130, v134
v_cvt_pk_bf16_f32 v37, v138, v142
v_cvt_pk_bf16_f32 v38, v131, v135
v_cvt_pk_bf16_f32 v39, v139, v143
v_permlane32_swap_b32 v148, v144
v_permlane32_swap_b32 v149, v145
v_permlane32_swap_b32 v150, v146
v_permlane32_swap_b32 v151, v147
buffer_store_dwordx4 v[32:35], v8, s[44:47], s48 offen
buffer_store_dwordx4 v[36:39], v8, s[44:47], s48 offen offset:16
v_add_f32 v144, v144, v148
v_add_f32 v145, v145, v149
v_add_f32 v146, v146, v150
v_add_f32 v147, v147, v151
v_cvt_pk_bf16_f32 v40, v144, v145
v_cvt_pk_bf16_f32 v41, v146, v147
buffer_store_dwordx2 v[40:41], v9, s[44:47], s48 offen offset:128
L_END:
s_endpgm
CK_Z:
s_mov_b32 s83, 0
CK_Z_L:
s_sleep 2
buffer_load_dword v31, v30, s[40:43], 0 offen sc1
s_add_u32 s83, s83, 1
s_waitcnt vmcnt(0)
v_cmp_gt_u32 vcc, 1, v31
s_cmp_gt_u32 s83, 0x20000
s_cbranch_scc1 CK_Z_R
s_nop 3
s_cbranch_vccnz CK_Z_L
s_branch CK_Z_R
CK_WA:
s_mov_b32 s83, 0
CK_WA_L:
s_sleep 2
buffer_load_dword v30, v29, s[24:27], s78 offen sc1
s_add_u32 s83, s83, 1
s_waitcnt vmcnt(0)
v_cmp_gt_u32 vcc, 8, v30
s_cmp_gt_u32 s83, 0x20000
s_cbranch_scc1 CK_WA_R
s_nop 3
s_cbranch_vccnz CK_WA_L
s_branch CK_WA_R
CK_ZA:
s_mov_b32 s83, 0
CK_ZA_L:
s_sleep 2
buffer_load_dword v30, v28, s[40:43], 0 offen sc1
s_add_u32 s83, s83, 1
s_waitcnt vmcnt(0)
v_cmp_gt_u32 vcc, 1, v30
s_cmp_gt_u32 s83, 0x20000
s_cbranch_scc1 CK_ZA_R
s_nop 3
s_cbranch_vccnz CK_ZA_L
s_branch CK_ZA_R
CK_KV:
s_mov_b32 s83, 0
CK_KV_L:
s_sleep 2
buffer_load_dword v30, v29, s[24:27], s78 offen offset:4 sc1
s_add_u32 s83, s83, 1
s_waitcnt vmcnt(0)
v_cmp_gt_u32 vcc, 8, v30
s_cmp_gt_u32 s83, 0x20000
s_cbranch_scc1 CK_KV_R
s_nop 3
s_cbranch_vccnz CK_KV_L
s_branch CK_KV_R
D0:
v_cndmask_b32 v224, v224, v6, s[84:85]
v_cndmask_b32 v236, v236, v6, s[84:85]
v_mov_b32 v232, v6
v_cndmask_b32 v225, v225, v6, s[86:87]
v_cndmask_b32 v237, v237, v6, s[86:87]
v_mov_b32 v233, v6
v_cndmask_b32 v226, v226, v6, s[88:89]
v_cndmask_b32 v238, v238, v6, s[88:89]
v_mov_b32 v234, v6
v_cndmask_b32 v227, v227, v6, s[90:91]
v_cndmask_b32 v239, v239, v6, s[90:91]
v_mov_b32 v235, v6
s_branch D0_R
CK_QA:
s_mov_b32 s83, 0
CK_QA_L:
s_sleep 2
buffer_load_dword v185, v186, s[24:27], s51 offen offset:8 sc1
s_add_u32 s83, s83, 1
s_waitcnt vmcnt(0)
v_cmp_gt_u32 vcc, 8, v185
s_cmp_gt_u32 s83, 0x20000
s_cbranch_scc1 CK_QA_R
s_nop 3
s_cbranch_vccnz CK_QA_L
s_branch CK_QA_R
CK_ZB:
s_mov_b32 s83, 0
CK_ZB_L:
s_sleep 2
buffer_load_dword v12, v10, s[24:27], s51 offen sc1
s_add_u32 s83, s83, 1
s_waitcnt vmcnt(0)
v_cmp_gt_u32 vcc, 8, v12
s_cmp_gt_u32 s83, 0x20000
s_cbranch_scc1 CK_ZB_R
s_nop 3
s_cbranch_vccnz CK_ZB_L
s_branch CK_ZB_R
CK_ZAA:
s_mov_b32 s83, 0
CK_ZAA_L:
s_sleep 2
buffer_load_dword v12, v11, s[24:27], s51 offen offset:4 sc1
s_add_u32 s83, s83, 1
s_waitcnt vmcnt(0)
v_cmp_gt_u32 vcc, 8, v12
s_cmp_gt_u32 s83, 0x20000
s_cbranch_scc1 CK_ZAA_R
s_nop 3
s_cbranch_vccnz CK_ZAA_L
s_branch CK_ZAA_R
.section .rodata,"a"
.p2align 6
.amdhsa_kernel gated_mix__sliding_local_dilated__compressed_kv_cla__prompt_kernel
  .amdhsa_next_free_vgpr 512
  .amdhsa_next_free_sgpr 102
  .amdhsa_accum_offset 256
  .amdhsa_group_segment_fixed_size 0
  .amdhsa_kernarg_size 104
  .amdhsa_user_sgpr_count 2
  .amdhsa_user_sgpr_kernarg_segment_ptr 1
  .amdhsa_system_sgpr_workgroup_id_x 1
.end_amdhsa_kernel
```

```asm
; @launch grid=(256,1,1) block=(256,1,1) lds=163840
.amdgcn_target "amdgcn-amd-amdhsa--gfx950"
.text

.globl gated_mix__sliding_local_dilated__compressed_kv_cla__prompt_kernel
.p2align 8
.type gated_mix__sliding_local_dilated__compressed_kv_cla__prompt_kernel,@function
gated_mix__sliding_local_dilated__compressed_kv_cla__prompt_kernel:
s_cmp_ge_u32 s2, 256
s_cbranch_scc1 L_END
s_load_dwordx2 s[8:9], s[0:1], 32
s_load_dwordx2 s[16:17], s[0:1], 48
s_load_dwordx2 s[52:53], s[0:1], 56
s_load_dwordx2 s[24:25], s[0:1], 96
s_load_dwordx2 s[12:13], s[0:1], 0
s_load_dwordx2 s[20:21], s[0:1], 40
s_load_dwordx2 s[28:29], s[0:1], 8
s_load_dwordx2 s[48:49], s[0:1], 16
s_load_dwordx2 s[32:33], s[0:1], 64
s_load_dwordx2 s[36:37], s[0:1], 72
s_load_dwordx2 s[40:41], s[0:1], 88
s_load_dwordx2 s[44:45], s[0:1], 80
s_getpc_b64 s[96:97]
s_lshr_b32 s6, s2, 3
s_lshl_b32 s98, s6, 11
s_add_u32 s96, s96, s98
s_addc_u32 s97, s97, 0
v_lshlrev_b32 v16, 3, v0
v_mov_b32 v17, s97
v_add_co_u32 v16, vcc, s96, v16
v_lshrrev_b32 v5, 6, v0
v_and_b32 v1, 63, v0
v_addc_co_u32 v17, vcc, 0, v17, vcc
v_readfirstlane_b32 s3, v5
global_load_dwordx2 a[252:253], v[16:17], off
v_and_b32 v2, 15, v0
v_lshrrev_b32 v3, 4, v1
v_lshlrev_b32 v4, 4, v1
s_and_b32 s7, s2, 7
s_and_b32 s65, s6, 3
s_lshl2_add_u32 s4, s7, s65
s_lshr_b32 s5, s6, 2
s_lshl2_add_u32 s66, s5, s3
s_sub_u32 s67, 63, s66
v_lshrrev_b32 v16, 3, v1
v_and_b32 v17, 7, v1
v_xor_b32 v18, v17, v3
v_lshlrev_b32 v19, 10, v16
v_lshl_add_u32 v5, v18, 4, v19
v_xor_b32 v18, 4, v18
v_lshl_add_u32 v6, v18, 4, v19
v_add_u32 v6, 7168, v6
v_and_b32 v18, 1, v3
v_lshlrev_b32 v18, 1, v18
v_xor_b32 v18, v17, v18
v_lshlrev_b32 v19, 13, v16
v_lshl_add_u32 v7, v18, 4, v19
v_xor_b32 v18, 4, v18
v_lshl_add_u32 v8, v18, 4, v19
v_add_u32 v8, 64512, v8
s_add_u32 s69, s65, s5
s_and_b32 s69, s69, 1
s_mul_i32 s64, s7, 2
s_and_b32 s64, s64, 7
s_or_b32 s69, s69, s64
s_add_u32 s93, s65, s5
s_and_b32 s93, s93, 1
s_mul_i32 s64, s7, 2
s_and_b32 s64, s64, 7
s_or_b32 s93, s93, s64
s_lshl_b32 s70, s69, 7
s_lshl_b32 s75, s69, 19
s_lshr_b32 s54, s3, 1
s_and_b32 s55, s3, 1
s_lshl3_add_u32 s87, s54, s5
s_lshl_b32 s64, s55, 5
s_add_u32 s68, s87, s64
s_lshl_b32 s68, s68, 15
s_lshl_b32 s73, s3, 13
s_add_u32 s73, s73, 65536
s_lshl1_add_u32 s74, s4, s55
s_lshl_b32 s74, s74, 7
s_lshl_b32 s77, s3, 12
s_add_u32 s71, s68, s70
s_add_u32 s76, s74, s75
s_mov_b32 s10, 2097152
s_mov_b32 s11, 0x20000
s_mov_b32 s18, 4194304
s_mov_b32 s19, 0x20000
s_cmp_lt_u32 s3, 2
s_waitcnt lgkmcnt(0)
s_cselect_b32 s16, s16, s52
s_cselect_b32 s17, s17, s53
s_add_u32 m0, s73, 0
s_add_u32 s64, s71, 0
buffer_load_dwordx4 v5, s[8:11], s64 offen lds
buffer_load_dwordx4 v6, s[8:11], s64 offen offset:1024 lds
s_add_u32 m0, s73, 2048
s_add_u32 s64, s71, 16384
buffer_load_dwordx4 v5, s[8:11], s64 offen lds
buffer_load_dwordx4 v6, s[8:11], s64 offen offset:1024 lds
s_add_u32 m0, s77, 0
s_add_u32 s64, s76, 0
buffer_load_dwordx4 v7, s[16:19], s64 offen lds
buffer_load_dwordx4 v8, s[16:19], s64 offen offset:1024 lds
s_add_u32 m0, s77, 2048
s_add_u32 s64, s76, 131072
buffer_load_dwordx4 v7, s[16:19], s64 offen lds
buffer_load_dwordx4 v8, s[16:19], s64 offen offset:1024 lds
s_add_u32 m0, s73, 4096
s_add_u32 s64, s71, 524288
buffer_load_dwordx4 v5, s[8:11], s64 offen lds
buffer_load_dwordx4 v6, s[8:11], s64 offen offset:1024 lds
s_add_u32 m0, s73, 6144
s_add_u32 s64, s71, 540672
buffer_load_dwordx4 v5, s[8:11], s64 offen lds
buffer_load_dwordx4 v6, s[8:11], s64 offen offset:1024 lds
s_mov_b32 s26, 268435456
s_mov_b32 s27, 0x20000
s_mov_b32 s14, 2359296
s_mov_b32 s15, 0x20000
s_mov_b32 s22, 4718592
s_mov_b32 s23, 0x20000
s_mov_b32 s30, 1990656
s_mov_b32 s31, 0x20000
s_mov_b32 s34, 4718592
s_mov_b32 s35, 0x20000
s_mov_b32 s38, 1152
s_mov_b32 s39, 0x20000
s_mov_b32 s42, 256
s_mov_b32 s43, 0x20000
s_mov_b32 s46, 2359296
s_mov_b32 s47, 0x20000
s_mov_b32 s50, 663552
s_mov_b32 s51, 0x20000
s_lshl_b32 s89, s4, 10
s_add_u32 s89, s89, 75497472
s_cmp_eq_u32 s66, 0
s_cselect_b32 s52, s89, 2147418112
v_mov_b32 v16, 0
v_mov_b32 v17, 0
v_mov_b32 v18, 0
v_mov_b32 v19, 0
buffer_store_dwordx4 v[16:19], v4, s[24:27], s52 offen sc1
s_add_u32 s89, s89, 512
s_cmp_eq_u32 s3, 0
s_cselect_b32 s90, s89, 2147418112
v_mov_b32 v24, 2147418112
v_cmp_eq_u32 vcc, 1, v1
s_lshl_b32 s52, s54, 7
s_lshl_b32 s53, s55, 12
v_cndmask_b32 v0, v24, 0, vcc
v_lshrrev_b32 v16, 1, v2
v_xor_b32 v16, v16, v3
v_add_u32 v17, s52, v2
v_lshlrev_b32 v17, 7, v17
v_add_u32 v17, 65536, v17
v_lshl_add_u32 v9, v16, 4, v17
v_xor_b32 v10, 64, v9
v_bfe_u32 v16, v1, 2, 2
v_lshl_add_u32 v17, v3, 3, v16
v_lshlrev_b32 v17, 7, v17
v_and_b32 v18, 3, v1
v_lshl_add_u32 v17, v18, 3, v17
v_add_u32 v17, s53, v17
v_lshrrev_b32 v16, 1, v16
v_and_b32 v18, 1, v3
v_lshl_add_u32 v16, v18, 1, v16
v_xor_b32 v18, 0, v16
v_lshl_add_u32 v11, v18, 5, v17
v_xor_b32 v18, 1, v16
v_lshl_add_u32 v12, v18, 5, v17
v_xor_b32 v18, 2, v16
v_lshl_add_u32 v13, v18, 5, v17
v_xor_b32 v18, 3, v16
v_lshl_add_u32 v14, v18, 5, v17
s_lshl_b32 s87, s87, 14
s_mul_i32 s64, s4, 1064960
s_add_u32 s87, s87, s64
s_add_u32 s88, s87, s53
s_add_u32 s88, s88, 24576
s_lshr_b32 s53, s53, 1
s_add_u32 s87, s87, s53
s_lshl_b32 s80, s3, 10
s_mul_i32 s78, s4, 73728
s_add_u32 s78, s78, s80
s_add_u32 s78, s78, 35651584
s_add_u32 s80, s80, 8192
s_mov_b32 s91, 0x3e0293ee
s_mov_b32 s85, 0x05040100
s_mov_b32 s86, 0x07060302
s_lshl2_add_u32 s52, s7, s3
s_mul_i32 s81, s6, 110592
s_mul_i32 s65, s52, 36
s_add_u32 s81, s81, s65
s_mul_i32 s82, s52, 18
s_add_u32 s82, s82, s6
s_lshl_b32 s82, s82, 12
s_add_u32 s82, s82, 35651584
s_lshl_b32 s83, s6, 6
s_lshl_b32 s84, s52, 10
s_add_u32 s84, s84, 75497984
s_cmp_lt_u32 s6, 18
s_cselect_b32 s82, s82, 2147418112
s_cselect_b32 s84, s84, 2147418112
v_lshrrev_b32 v18, 2, v2
v_and_b32 v19, 3, v2
v_mul_u32_u24 v20, 1152, v18
v_cmp_eq_u32 vcc, 2, v19
v_lshl_add_u32 v20, v19, 3, v20
v_add_u32 v21, 1, v19
v_cndmask_b32 v21, v21, 0, vcc
v_cmp_eq_u32 vcc, 3, v18
v_mul_u32_u24 v21, 1152, v21
v_add_u32 v21, 32, v21
v_cndmask_b32 v20, v20, v21, vcc
v_cmp_eq_u32 vcc, 15, v2
v_mul_u32_u24 v21, 27648, v3
v_add_u32 v20, v20, v21
v_lshlrev_b32 v21, 4, v3
v_cndmask_b32 v26, v20, v24, vcc
v_cndmask_b32 v27, v24, v21, vcc
v_and_b32 v18, 7, v1
v_cmp_gt_u32 vcc, 48, v1
v_mul_u32_u24 v18, 3456, v18
v_mul_u32_u24 v19, 1152, v3
v_bfe_u32 v20, v1, 3, 1
v_mul_u32_u24 v20, 140, v20
v_add3_u32 v18, v18, v19, v20
v_cndmask_b32 v28, v24, v18, vcc
s_add_u32 m0, s77, 16384
s_add_u32 s64, s76, 262144
buffer_load_dwordx4 v7, s[16:19], s64 offen lds
buffer_load_dwordx4 v8, s[16:19], s64 offen offset:1024 lds
s_add_u32 m0, s77, 18432
s_add_u32 s64, s76, 393216
buffer_load_dwordx4 v7, s[16:19], s64 offen lds
buffer_load_dwordx4 v8, s[16:19], s64 offen offset:1024 lds
s_xor_b32 s71, s70, 128
s_add_u32 s71, s68, s71
s_add_u32 m0, s73, 32768
s_add_u32 s64, s71, 0
buffer_load_dwordx4 v5, s[8:11], s64 offen lds
buffer_load_dwordx4 v6, s[8:11], s64 offen offset:1024 lds
s_add_u32 m0, s73, 34816
s_add_u32 s64, s71, 16384
buffer_load_dwordx4 v5, s[8:11], s64 offen lds
buffer_load_dwordx4 v6, s[8:11], s64 offen offset:1024 lds
s_waitcnt vmcnt(8)
s_barrier
ds_read_b128 a[64:67], v9 offset:0
ds_read_b128 a[68:71], v9 offset:2048
ds_read_b128 a[72:75], v9 offset:4096
ds_read_b128 a[76:79], v9 offset:6144
ds_read_b128 a[80:83], v9 offset:8192
ds_read_b128 a[84:87], v9 offset:10240
ds_read_b128 a[88:91], v9 offset:12288
ds_read_b128 a[92:95], v9 offset:14336
ds_read_b64_tr_b16 a[112:113], v11 offset:8192
ds_read_b64_tr_b16 a[114:115], v11 offset:8704
ds_read_b64_tr_b16 a[116:117], v12 offset:8192
ds_read_b64_tr_b16 a[118:119], v12 offset:8704
ds_read_b64_tr_b16 a[120:121], v13 offset:8192
ds_read_b64_tr_b16 a[122:123], v13 offset:8704
ds_read_b64_tr_b16 a[124:125], v14 offset:8192
ds_read_b64_tr_b16 a[126:127], v14 offset:8704
ds_read_b64_tr_b16 a[96:97], v11 offset:0
ds_read_b64_tr_b16 a[98:99], v11 offset:512
ds_read_b64_tr_b16 a[100:101], v12 offset:0
ds_read_b64_tr_b16 a[102:103], v12 offset:512
ds_read_b64_tr_b16 a[104:105], v13 offset:0
ds_read_b64_tr_b16 a[106:107], v13 offset:512
ds_read_b64_tr_b16 a[108:109], v14 offset:0
ds_read_b64_tr_b16 a[110:111], v14 offset:512
s_lshl_b32 s52, s4, 2
s_cmp_eq_u32 s66, 0
s_cselect_b32 s52, s52, 2147418112
buffer_store_dword v1, v0, s[40:43], s52 offen sc1
s_waitcnt lgkmcnt(0)
v_mfma_f32_16x16x32_bf16 v[160:163], a[96:99], a[64:67], 0
s_waitcnt vmcnt(5)
v_mfma_f32_16x16x32_bf16 v[164:167], a[100:103], a[64:67], 0
s_barrier
v_mfma_f32_16x16x32_bf16 v[168:171], a[104:107], a[64:67], 0
ds_read_b128 a[128:131], v10 offset:0
ds_read_b128 a[132:135], v10 offset:2048
v_mfma_f32_16x16x32_bf16 v[172:175], a[108:111], a[64:67], 0
s_add_u32 m0, s73, 36864
s_add_u32 s64, s71, 524288
v_mfma_f32_16x16x32_bf16 v[32:35], a[64:67], a[112:115], 0
buffer_load_dwordx4 v5, s[8:11], s64 offen lds
v_mfma_f32_16x16x32_bf16 v[40:43], a[64:67], a[116:119], 0
ds_read_b128 a[136:139], v10 offset:4096
ds_read_b128 a[140:143], v10 offset:6144
v_mfma_f32_16x16x32_bf16 v[48:51], a[64:67], a[120:123], 0
v_mfma_f32_16x16x32_bf16 v[56:59], a[64:67], a[124:127], 0
ds_read_b128 a[144:147], v10 offset:8192
ds_read_b128 a[148:151], v10 offset:10240
v_mfma_f32_16x16x32_bf16 v[60:63], a[68:71], a[124:127], 0
buffer_load_dwordx4 v6, s[8:11], s64 offen offset:1024 lds
v_mfma_f32_16x16x32_bf16 v[52:55], a[68:71], a[120:123], 0
ds_read_b128 a[152:155], v10 offset:12288
ds_read_b128 a[156:159], v10 offset:14336
v_mfma_f32_16x16x32_bf16 v[44:47], a[68:71], a[116:119], 0
v_mfma_f32_16x16x32_bf16 v[36:39], a[68:71], a[112:115], 0
s_add_u32 m0, s73, 38912
s_add_u32 s64, s71, 540672
v_mfma_f32_16x16x32_bf16 v[188:191], a[108:111], a[68:71], 0
ds_read_b64_tr_b16 a[176:177], v11 offset:24576
ds_read_b64_tr_b16 a[178:179], v11 offset:25088
v_mfma_f32_16x16x32_bf16 v[184:187], a[104:107], a[68:71], 0
buffer_load_dwordx4 v5, s[8:11], s64 offen lds
v_mfma_f32_16x16x32_bf16 v[180:183], a[100:103], a[68:71], 0
ds_read_b64_tr_b16 a[180:181], v12 offset:24576
ds_read_b64_tr_b16 a[182:183], v12 offset:25088
v_mfma_f32_16x16x32_bf16 v[176:179], a[96:99], a[68:71], 0
v_mfma_f32_16x16x32_bf16 v[192:195], a[96:99], a[72:75], 0
ds_read_b64_tr_b16 a[184:185], v13 offset:24576
ds_read_b64_tr_b16 a[186:187], v13 offset:25088
v_mfma_f32_16x16x32_bf16 v[196:199], a[100:103], a[72:75], 0
v_mfma_f32_16x16x32_bf16 v[200:203], a[104:107], a[72:75], 0
buffer_load_dwordx4 v6, s[8:11], s64 offen offset:1024 lds
v_mfma_f32_16x16x32_bf16 v[204:207], a[108:111], a[72:75], 0
s_xor_b32 s76, s75, 524288
s_add_u32 s76, s74, s76
v_mfma_f32_16x16x32_bf16 v[64:67], a[72:75], a[112:115], 0
ds_read_b64_tr_b16 a[188:189], v14 offset:24576
ds_read_b64_tr_b16 a[190:191], v14 offset:25088
v_mfma_f32_16x16x32_bf16 v[72:75], a[72:75], a[116:119], 0
s_add_u32 m0, s77, 32768
s_add_u32 s64, s76, 0
v_mfma_f32_16x16x32_bf16 v[80:83], a[72:75], a[120:123], 0
ds_read_b64_tr_b16 a[160:161], v11 offset:16384
ds_read_b64_tr_b16 a[162:163], v11 offset:16896
v_mfma_f32_16x16x32_bf16 v[88:91], a[72:75], a[124:127], 0
buffer_load_dwordx4 v7, s[16:19], s64 offen lds
v_mfma_f32_16x16x32_bf16 v[92:95], a[76:79], a[124:127], 0
ds_read_b64_tr_b16 a[164:165], v12 offset:16384
ds_read_b64_tr_b16 a[166:167], v12 offset:16896
v_mfma_f32_16x16x32_bf16 v[84:87], a[76:79], a[120:123], 0
v_mfma_f32_16x16x32_bf16 v[76:79], a[76:79], a[116:119], 0
ds_read_b64_tr_b16 a[168:169], v13 offset:16384
ds_read_b64_tr_b16 a[170:171], v13 offset:16896
v_mfma_f32_16x16x32_bf16 v[68:71], a[76:79], a[112:115], 0
v_mfma_f32_16x16x32_bf16 v[220:223], a[108:111], a[76:79], 0
buffer_load_dwordx4 v8, s[16:19], s64 offen offset:1024 lds
v_mfma_f32_16x16x32_bf16 v[216:219], a[104:107], a[76:79], 0
ds_read_b64_tr_b16 a[172:173], v14 offset:16384
ds_read_b64_tr_b16 a[174:175], v14 offset:16896
v_mfma_f32_16x16x32_bf16 v[212:215], a[100:103], a[76:79], 0
v_mfma_f32_16x16x32_bf16 v[208:211], a[96:99], a[76:79], 0
s_add_u32 m0, s77, 34816
s_add_u32 s64, s76, 131072
v_mfma_f32_16x16x32_bf16 v[224:227], a[96:99], a[80:83], 0
v_mfma_f32_16x16x32_bf16 v[228:231], a[100:103], a[80:83], 0
buffer_load_dwordx4 v7, s[16:19], s64 offen lds
v_mfma_f32_16x16x32_bf16 v[232:235], a[104:107], a[80:83], 0
v_mfma_f32_16x16x32_bf16 v[236:239], a[108:111], a[80:83], 0
v_mfma_f32_16x16x32_bf16 v[96:99], a[80:83], a[112:115], 0
v_mfma_f32_16x16x32_bf16 v[104:107], a[80:83], a[116:119], 0
buffer_load_dwordx4 v8, s[16:19], s64 offen offset:1024 lds
v_mfma_f32_16x16x32_bf16 v[112:115], a[80:83], a[120:123], 0
v_mfma_f32_16x16x32_bf16 v[120:123], a[80:83], a[124:127], 0
v_mfma_f32_16x16x32_bf16 v[124:127], a[84:87], a[124:127], 0
s_add_u32 m0, s77, 49152
s_add_u32 s64, s76, 262144
v_mfma_f32_16x16x32_bf16 v[116:119], a[84:87], a[120:123], 0
v_mfma_f32_16x16x32_bf16 v[108:111], a[84:87], a[116:119], 0
buffer_load_dwordx4 v7, s[16:19], s64 offen lds
v_mfma_f32_16x16x32_bf16 v[100:103], a[84:87], a[112:115], 0
v_mfma_f32_16x16x32_bf16 v[252:255], a[108:111], a[84:87], 0
v_mfma_f32_16x16x32_bf16 v[248:251], a[104:107], a[84:87], 0
v_mfma_f32_16x16x32_bf16 v[244:247], a[100:103], a[84:87], 0
v_mfma_f32_16x16x32_bf16 v[240:243], a[96:99], a[84:87], 0
buffer_load_dwordx4 v8, s[16:19], s64 offen offset:1024 lds
v_mfma_f32_16x16x32_bf16 a[0:3], a[96:99], a[88:91], 0
v_mfma_f32_16x16x32_bf16 a[4:7], a[100:103], a[88:91], 0
v_mfma_f32_16x16x32_bf16 a[8:11], a[104:107], a[88:91], 0
s_add_u32 m0, s77, 51200
s_add_u32 s64, s76, 393216
v_mfma_f32_16x16x32_bf16 a[12:15], a[108:111], a[88:91], 0
v_mfma_f32_16x16x32_bf16 v[128:131], a[88:91], a[112:115], 0
buffer_load_dwordx4 v7, s[16:19], s64 offen lds
v_mfma_f32_16x16x32_bf16 v[136:139], a[88:91], a[116:119], 0
v_mfma_f32_16x16x32_bf16 v[144:147], a[88:91], a[120:123], 0
v_mfma_f32_16x16x32_bf16 v[152:155], a[88:91], a[124:127], 0
v_mfma_f32_16x16x32_bf16 v[156:159], a[92:95], a[124:127], 0
v_add_u32 v9, 32768, v9
v_add_u32 v10, 32768, v10
v_mfma_f32_16x16x32_bf16 v[148:151], a[92:95], a[120:123], 0
buffer_load_dwordx4 v8, s[16:19], s64 offen offset:1024 lds
v_mfma_f32_16x16x32_bf16 v[140:143], a[92:95], a[116:119], 0
v_mfma_f32_16x16x32_bf16 v[132:135], a[92:95], a[112:115], 0
v_mfma_f32_16x16x32_bf16 a[28:31], a[108:111], a[92:95], 0
v_mfma_f32_16x16x32_bf16 a[24:27], a[104:107], a[92:95], 0
v_mfma_f32_16x16x32_bf16 a[20:23], a[100:103], a[92:95], 0
v_mfma_f32_16x16x32_bf16 a[16:19], a[96:99], a[92:95], 0
s_waitcnt lgkmcnt(0)
v_mfma_f32_16x16x32_bf16 v[160:163], a[160:163], a[128:131], v[160:163]
s_waitcnt vmcnt(4)
v_mfma_f32_16x16x32_bf16 v[164:167], a[164:167], a[128:131], v[164:167]
s_barrier
v_mfma_f32_16x16x32_bf16 v[168:171], a[168:171], a[128:131], v[168:171]
s_mul_i32 s52, s6, 110592
ds_read_b128 a[64:67], v9 offset:0
ds_read_b128 a[68:71], v9 offset:2048
v_mfma_f32_16x16x32_bf16 v[172:175], a[172:175], a[128:131], v[172:175]
s_xor_b32 s71, s70, 256
s_add_u32 s71, s68, s71
s_mul_i32 s53, s3, 27648
v_mfma_f32_16x16x32_bf16 v[32:35], a[128:131], a[176:179], v[32:35]
s_add_u32 m0, s73, 65536
s_add_u32 s64, s71, 0
s_add_u32 s52, s52, s53
v_mfma_f32_16x16x32_bf16 v[40:43], a[128:131], a[180:183], v[40:43]
buffer_load_dwordx4 v5, s[8:11], s64 offen lds
v_mfma_f32_16x16x32_bf16 v[48:51], a[128:131], a[184:187], v[48:51]
s_mul_i32 s53, s7, 144
ds_read_b128 a[72:75], v9 offset:4096
ds_read_b128 a[76:79], v9 offset:6144
v_mfma_f32_16x16x32_bf16 v[56:59], a[128:131], a[188:191], v[56:59]
s_add_u32 s52, s52, s53
v_mfma_f32_16x16x32_bf16 v[60:63], a[132:135], a[188:191], v[60:63]
buffer_load_dwordx4 v6, s[8:11], s64 offen offset:1024 lds
v_mfma_f32_16x16x32_bf16 v[52:55], a[132:135], a[184:187], v[52:55]
ds_read_b128 a[80:83], v9 offset:8192
ds_read_b128 a[84:87], v9 offset:10240
v_mfma_f32_16x16x32_bf16 v[44:47], a[132:135], a[180:183], v[44:47]
buffer_load_dword a252, v28, s[28:31], s52 offen
v_mfma_f32_16x16x32_bf16 v[36:39], a[132:135], a[176:179], v[36:39]
s_add_u32 m0, s73, 67584
s_add_u32 s64, s71, 16384
v_mfma_f32_16x16x32_bf16 v[188:191], a[172:175], a[132:135], v[188:191]
ds_read_b128 a[88:91], v9 offset:12288
ds_read_b128 a[92:95], v9 offset:14336
v_mfma_f32_16x16x32_bf16 v[184:187], a[168:171], a[132:135], v[184:187]
buffer_load_dwordx4 v5, s[8:11], s64 offen lds
v_mfma_f32_16x16x32_bf16 v[180:183], a[164:167], a[132:135], v[180:183]
ds_read_b64_tr_b16 a[112:113], v11 offset:40960
ds_read_b64_tr_b16 a[114:115], v11 offset:41472
v_mfma_f32_16x16x32_bf16 v[176:179], a[160:163], a[132:135], v[176:179]
v_mfma_f32_16x16x32_bf16 v[192:195], a[160:163], a[136:139], v[192:195]
ds_read_b64_tr_b16 a[116:117], v12 offset:40960
ds_read_b64_tr_b16 a[118:119], v12 offset:41472
v_mfma_f32_16x16x32_bf16 v[196:199], a[164:167], a[136:139], v[196:199]
v_mfma_f32_16x16x32_bf16 v[200:203], a[168:171], a[136:139], v[200:203]
buffer_load_dwordx4 v6, s[8:11], s64 offen offset:1024 lds
v_mfma_f32_16x16x32_bf16 v[204:207], a[172:175], a[136:139], v[204:207]
s_xor_b32 s76, s75, 1048576
s_add_u32 s76, s74, s76
v_mfma_f32_16x16x32_bf16 v[64:67], a[136:139], a[176:179], v[64:67]
ds_read_b64_tr_b16 a[120:121], v13 offset:40960
ds_read_b64_tr_b16 a[122:123], v13 offset:41472
v_mfma_f32_16x16x32_bf16 v[72:75], a[136:139], a[180:183], v[72:75]
s_add_u32 m0, s77, 0
s_add_u32 s64, s76, 0
v_mfma_f32_16x16x32_bf16 v[80:83], a[136:139], a[184:187], v[80:83]
ds_read_b64_tr_b16 a[124:125], v14 offset:40960
ds_read_b64_tr_b16 a[126:127], v14 offset:41472
v_mfma_f32_16x16x32_bf16 v[88:91], a[136:139], a[188:191], v[88:91]
buffer_load_dwordx4 v7, s[16:19], s64 offen lds
v_mfma_f32_16x16x32_bf16 v[92:95], a[140:143], a[188:191], v[92:95]
ds_read_b64_tr_b16 a[96:97], v11 offset:32768
ds_read_b64_tr_b16 a[98:99], v11 offset:33280
v_mfma_f32_16x16x32_bf16 v[84:87], a[140:143], a[184:187], v[84:87]
v_mfma_f32_16x16x32_bf16 v[76:79], a[140:143], a[180:183], v[76:79]
ds_read_b64_tr_b16 a[100:101], v12 offset:32768
ds_read_b64_tr_b16 a[102:103], v12 offset:33280
v_mfma_f32_16x16x32_bf16 v[68:71], a[140:143], a[176:179], v[68:71]
v_mfma_f32_16x16x32_bf16 v[220:223], a[172:175], a[140:143], v[220:223]
buffer_load_dwordx4 v8, s[16:19], s64 offen offset:1024 lds
v_mfma_f32_16x16x32_bf16 v[216:219], a[168:171], a[140:143], v[216:219]
ds_read_b64_tr_b16 a[104:105], v13 offset:32768
ds_read_b64_tr_b16 a[106:107], v13 offset:33280
v_mfma_f32_16x16x32_bf16 v[212:215], a[164:167], a[140:143], v[212:215]
v_mfma_f32_16x16x32_bf16 v[208:211], a[160:163], a[140:143], v[208:211]
s_add_u32 m0, s77, 2048
s_add_u32 s64, s76, 131072
v_mfma_f32_16x16x32_bf16 v[224:227], a[160:163], a[144:147], v[224:227]
ds_read_b64_tr_b16 a[108:109], v14 offset:32768
ds_read_b64_tr_b16 a[110:111], v14 offset:33280
v_mfma_f32_16x16x32_bf16 v[228:231], a[164:167], a[144:147], v[228:231]
buffer_load_dwordx4 v7, s[16:19], s64 offen lds
v_mfma_f32_16x16x32_bf16 v[232:235], a[168:171], a[144:147], v[232:235]
v_mfma_f32_16x16x32_bf16 v[236:239], a[172:175], a[144:147], v[236:239]
v_mfma_f32_16x16x32_bf16 v[96:99], a[144:147], a[176:179], v[96:99]
v_mfma_f32_16x16x32_bf16 v[104:107], a[144:147], a[180:183], v[104:107]
buffer_load_dwordx4 v8, s[16:19], s64 offen offset:1024 lds
v_mfma_f32_16x16x32_bf16 v[112:115], a[144:147], a[184:187], v[112:115]
v_mfma_f32_16x16x32_bf16 v[120:123], a[144:147], a[188:191], v[120:123]
v_mfma_f32_16x16x32_bf16 v[124:127], a[148:151], a[188:191], v[124:127]
s_add_u32 m0, s73, 69632
s_add_u32 s64, s71, 524288
v_mfma_f32_16x16x32_bf16 v[116:119], a[148:151], a[184:187], v[116:119]
v_mfma_f32_16x16x32_bf16 v[108:111], a[148:151], a[180:183], v[108:111]
buffer_load_dwordx4 v5, s[8:11], s64 offen lds
v_mfma_f32_16x16x32_bf16 v[100:103], a[148:151], a[176:179], v[100:103]
v_mfma_f32_16x16x32_bf16 v[252:255], a[172:175], a[148:151], v[252:255]
v_mfma_f32_16x16x32_bf16 v[248:251], a[168:171], a[148:151], v[248:251]
v_mfma_f32_16x16x32_bf16 v[244:247], a[164:167], a[148:151], v[244:247]
v_mfma_f32_16x16x32_bf16 v[240:243], a[160:163], a[148:151], v[240:243]
buffer_load_dwordx4 v6, s[8:11], s64 offen offset:1024 lds
v_mfma_f32_16x16x32_bf16 a[0:3], a[160:163], a[152:155], a[0:3]
v_mfma_f32_16x16x32_bf16 a[4:7], a[164:167], a[152:155], a[4:7]
v_mfma_f32_16x16x32_bf16 a[8:11], a[168:171], a[152:155], a[8:11]
s_add_u32 m0, s73, 71680
s_add_u32 s64, s71, 540672
v_mfma_f32_16x16x32_bf16 a[12:15], a[172:175], a[152:155], a[12:15]
v_mfma_f32_16x16x32_bf16 v[128:131], a[152:155], a[176:179], v[128:131]
buffer_load_dwordx4 v5, s[8:11], s64 offen lds
v_mfma_f32_16x16x32_bf16 v[136:139], a[152:155], a[180:183], v[136:139]
v_mfma_f32_16x16x32_bf16 v[144:147], a[152:155], a[184:187], v[144:147]
v_mfma_f32_16x16x32_bf16 v[152:155], a[152:155], a[188:191], v[152:155]
v_mfma_f32_16x16x32_bf16 v[156:159], a[156:159], a[188:191], v[156:159]
v_mfma_f32_16x16x32_bf16 v[148:151], a[156:159], a[184:187], v[148:151]
buffer_load_dwordx4 v6, s[8:11], s64 offen offset:1024 lds
v_mfma_f32_16x16x32_bf16 v[140:143], a[156:159], a[180:183], v[140:143]
v_mfma_f32_16x16x32_bf16 v[132:135], a[156:159], a[176:179], v[132:135]
v_mfma_f32_16x16x32_bf16 a[28:31], a[172:175], a[156:159], a[28:31]
v_mfma_f32_16x16x32_bf16 a[24:27], a[168:171], a[156:159], a[24:27]
v_mfma_f32_16x16x32_bf16 a[20:23], a[164:167], a[156:159], a[20:23]
v_mfma_f32_16x16x32_bf16 a[16:19], a[160:163], a[156:159], a[16:19]
s_waitcnt lgkmcnt(0)
v_mfma_f32_16x16x32_bf16 v[160:163], a[96:99], a[64:67], v[160:163]
s_waitcnt vmcnt(13)
v_mfma_f32_16x16x32_bf16 v[164:167], a[100:103], a[64:67], v[164:167]
s_barrier
v_mfma_f32_16x16x32_bf16 v[168:171], a[104:107], a[64:67], v[168:171]
ds_read_b128 a[128:131], v10 offset:0
ds_read_b128 a[132:135], v10 offset:2048
v_mfma_f32_16x16x32_bf16 v[172:175], a[108:111], a[64:67], v[172:175]
s_add_u32 m0, s77, 16384
s_add_u32 s64, s76, 262144
v_mfma_f32_16x16x32_bf16 v[32:35], a[64:67], a[112:115], v[32:35]
buffer_load_dwordx4 v7, s[16:19], s64 offen lds
v_mfma_f32_16x16x32_bf16 v[40:43], a[64:67], a[116:119], v[40:43]
ds_read_b128 a[136:139], v10 offset:4096
ds_read_b128 a[140:143], v10 offset:6144
v_mfma_f32_16x16x32_bf16 v[48:51], a[64:67], a[120:123], v[48:51]
v_mfma_f32_16x16x32_bf16 v[56:59], a[64:67], a[124:127], v[56:59]
ds_read_b128 a[144:147], v10 offset:8192
ds_read_b128 a[148:151], v10 offset:10240
v_mfma_f32_16x16x32_bf16 v[60:63], a[68:71], a[124:127], v[60:63]
buffer_load_dwordx4 v8, s[16:19], s64 offen offset:1024 lds
v_mfma_f32_16x16x32_bf16 v[52:55], a[68:71], a[120:123], v[52:55]
ds_read_b128 a[152:155], v10 offset:12288
ds_read_b128 a[156:159], v10 offset:14336
v_mfma_f32_16x16x32_bf16 v[44:47], a[68:71], a[116:119], v[44:47]
v_mfma_f32_16x16x32_bf16 v[36:39], a[68:71], a[112:115], v[36:39]
s_add_u32 m0, s77, 18432
s_add_u32 s64, s76, 393216
v_mfma_f32_16x16x32_bf16 v[188:191], a[108:111], a[68:71], v[188:191]
ds_read_b64_tr_b16 a[176:177], v11 offset:57344
ds_read_b64_tr_b16 a[178:179], v11 offset:57856
v_mfma_f32_16x16x32_bf16 v[184:187], a[104:107], a[68:71], v[184:187]
buffer_load_dwordx4 v7, s[16:19], s64 offen lds
v_mfma_f32_16x16x32_bf16 v[180:183], a[100:103], a[68:71], v[180:183]
ds_read_b64_tr_b16 a[180:181], v12 offset:57344
ds_read_b64_tr_b16 a[182:183], v12 offset:57856
v_mfma_f32_16x16x32_bf16 v[176:179], a[96:99], a[68:71], v[176:179]
v_mfma_f32_16x16x32_bf16 v[192:195], a[96:99], a[72:75], v[192:195]
ds_read_b64_tr_b16 a[184:185], v13 offset:57344
ds_read_b64_tr_b16 a[186:187], v13 offset:57856
v_mfma_f32_16x16x32_bf16 v[196:199], a[100:103], a[72:75], v[196:199]
v_mfma_f32_16x16x32_bf16 v[200:203], a[104:107], a[72:75], v[200:203]
buffer_load_dwordx4 v8, s[16:19], s64 offen offset:1024 lds
v_mfma_f32_16x16x32_bf16 v[204:207], a[108:111], a[72:75], v[204:207]
s_xor_b32 s71, s70, 384
s_add_u32 s71, s68, s71
v_mfma_f32_16x16x32_bf16 v[64:67], a[72:75], a[112:115], v[64:67]
ds_read_b64_tr_b16 a[188:189], v14 offset:57344
ds_read_b64_tr_b16 a[190:191], v14 offset:57856
v_mfma_f32_16x16x32_bf16 v[72:75], a[72:75], a[116:119], v[72:75]
s_add_u32 m0, s73, 0
s_add_u32 s64, s71, 0
v_mfma_f32_16x16x32_bf16 v[80:83], a[72:75], a[120:123], v[80:83]
ds_read_b64_tr_b16 a[160:161], v11 offset:49152
ds_read_b64_tr_b16 a[162:163], v11 offset:49664
v_mfma_f32_16x16x32_bf16 v[88:91], a[72:75], a[124:127], v[88:91]
buffer_load_dwordx4 v5, s[8:11], s64 offen lds
v_mfma_f32_16x16x32_bf16 v[92:95], a[76:79], a[124:127], v[92:95]
ds_read_b64_tr_b16 a[164:165], v12 offset:49152
ds_read_b64_tr_b16 a[166:167], v12 offset:49664
v_mfma_f32_16x16x32_bf16 v[84:87], a[76:79], a[120:123], v[84:87]
v_mfma_f32_16x16x32_bf16 v[76:79], a[76:79], a[116:119], v[76:79]
ds_read_b64_tr_b16 a[168:169], v13 offset:49152
ds_read_b64_tr_b16 a[170:171], v13 offset:49664
v_mfma_f32_16x16x32_bf16 v[68:71], a[76:79], a[112:115], v[68:71]
v_mfma_f32_16x16x32_bf16 v[220:223], a[108:111], a[76:79], v[220:223]
buffer_load_dwordx4 v6, s[8:11], s64 offen offset:1024 lds
v_mfma_f32_16x16x32_bf16 v[216:219], a[104:107], a[76:79], v[216:219]
ds_read_b64_tr_b16 a[172:173], v14 offset:49152
ds_read_b64_tr_b16 a[174:175], v14 offset:49664
v_mfma_f32_16x16x32_bf16 v[212:215], a[100:103], a[76:79], v[212:215]
v_mfma_f32_16x16x32_bf16 v[208:211], a[96:99], a[76:79], v[208:211]
s_add_u32 m0, s73, 2048
s_add_u32 s64, s71, 16384
v_mfma_f32_16x16x32_bf16 v[224:227], a[96:99], a[80:83], v[224:227]
v_mfma_f32_16x16x32_bf16 v[228:231], a[100:103], a[80:83], v[228:231]
buffer_load_dwordx4 v5, s[8:11], s64 offen lds
v_mfma_f32_16x16x32_bf16 v[232:235], a[104:107], a[80:83], v[232:235]
v_mfma_f32_16x16x32_bf16 v[236:239], a[108:111], a[80:83], v[236:239]
v_mfma_f32_16x16x32_bf16 v[96:99], a[80:83], a[112:115], v[96:99]
v_mfma_f32_16x16x32_bf16 v[104:107], a[80:83], a[116:119], v[104:107]
buffer_load_dwordx4 v6, s[8:11], s64 offen offset:1024 lds
v_mfma_f32_16x16x32_bf16 v[112:115], a[80:83], a[120:123], v[112:115]
s_xor_b32 s76, s75, 1572864
s_add_u32 s76, s74, s76
v_mfma_f32_16x16x32_bf16 v[120:123], a[80:83], a[124:127], v[120:123]
v_mfma_f32_16x16x32_bf16 v[124:127], a[84:87], a[124:127], v[124:127]
s_add_u32 m0, s77, 32768
s_add_u32 s64, s76, 0
v_mfma_f32_16x16x32_bf16 v[116:119], a[84:87], a[120:123], v[116:119]
v_mfma_f32_16x16x32_bf16 v[108:111], a[84:87], a[116:119], v[108:111]
buffer_load_dwordx4 v7, s[16:19], s64 offen lds
v_mfma_f32_16x16x32_bf16 v[100:103], a[84:87], a[112:115], v[100:103]
v_mfma_f32_16x16x32_bf16 v[252:255], a[108:111], a[84:87], v[252:255]
v_mfma_f32_16x16x32_bf16 v[248:251], a[104:107], a[84:87], v[248:251]
v_mfma_f32_16x16x32_bf16 v[244:247], a[100:103], a[84:87], v[244:247]
v_mfma_f32_16x16x32_bf16 v[240:243], a[96:99], a[84:87], v[240:243]
buffer_load_dwordx4 v8, s[16:19], s64 offen offset:1024 lds
v_mfma_f32_16x16x32_bf16 a[0:3], a[96:99], a[88:91], a[0:3]
v_mfma_f32_16x16x32_bf16 a[4:7], a[100:103], a[88:91], a[4:7]
v_mfma_f32_16x16x32_bf16 a[8:11], a[104:107], a[88:91], a[8:11]
s_add_u32 m0, s77, 34816
s_add_u32 s64, s76, 131072
v_mfma_f32_16x16x32_bf16 a[12:15], a[108:111], a[88:91], a[12:15]
v_mfma_f32_16x16x32_bf16 v[128:131], a[88:91], a[112:115], v[128:131]
buffer_load_dwordx4 v7, s[16:19], s64 offen lds
v_mfma_f32_16x16x32_bf16 v[136:139], a[88:91], a[116:119], v[136:139]
v_mfma_f32_16x16x32_bf16 v[144:147], a[88:91], a[120:123], v[144:147]
v_mfma_f32_16x16x32_bf16 v[152:155], a[88:91], a[124:127], v[152:155]
v_mfma_f32_16x16x32_bf16 v[156:159], a[92:95], a[124:127], v[156:159]
v_add_u32 v9, 32768, v9
v_add_u32 v10, 32768, v10
v_mfma_f32_16x16x32_bf16 v[148:151], a[92:95], a[120:123], v[148:151]
buffer_load_dwordx4 v8, s[16:19], s64 offen offset:1024 lds
v_mfma_f32_16x16x32_bf16 v[140:143], a[92:95], a[116:119], v[140:143]
v_mfma_f32_16x16x32_bf16 v[132:135], a[92:95], a[112:115], v[132:135]
v_mfma_f32_16x16x32_bf16 a[28:31], a[108:111], a[92:95], a[28:31]
v_mfma_f32_16x16x32_bf16 a[24:27], a[104:107], a[92:95], a[24:27]
v_mfma_f32_16x16x32_bf16 a[20:23], a[100:103], a[92:95], a[20:23]
v_mfma_f32_16x16x32_bf16 a[16:19], a[96:99], a[92:95], a[16:19]
s_waitcnt lgkmcnt(0)
v_mfma_f32_16x16x32_bf16 v[160:163], a[160:163], a[128:131], v[160:163]
s_waitcnt vmcnt(12)
v_mfma_f32_16x16x32_bf16 v[164:167], a[164:167], a[128:131], v[164:167]
s_barrier
v_mfma_f32_16x16x32_bf16 v[168:171], a[168:171], a[128:131], v[168:171]
ds_read_b128 a[64:67], v9 offset:0
ds_read_b128 a[68:71], v9 offset:2048
v_mfma_f32_16x16x32_bf16 v[172:175], a[172:175], a[128:131], v[172:175]
s_add_u32 m0, s73, 4096
s_add_u32 s64, s71, 524288
v_mfma_f32_16x16x32_bf16 v[32:35], a[128:131], a[176:179], v[32:35]
buffer_load_dwordx4 v5, s[8:11], s64 offen lds
v_mfma_f32_16x16x32_bf16 v[40:43], a[128:131], a[180:183], v[40:43]
ds_read_b128 a[72:75], v9 offset:4096
ds_read_b128 a[76:79], v9 offset:6144
v_mfma_f32_16x16x32_bf16 v[48:51], a[128:131], a[184:187], v[48:51]
v_mfma_f32_16x16x32_bf16 v[56:59], a[128:131], a[188:191], v[56:59]
ds_read_b128 a[80:83], v9 offset:8192
ds_read_b128 a[84:87], v9 offset:10240
v_mfma_f32_16x16x32_bf16 v[60:63], a[132:135], a[188:191], v[60:63]
buffer_load_dwordx4 v6, s[8:11], s64 offen offset:1024 lds
v_mfma_f32_16x16x32_bf16 v[52:55], a[132:135], a[184:187], v[52:55]
ds_read_b128 a[88:91], v9 offset:12288
ds_read_b128 a[92:95], v9 offset:14336
v_mfma_f32_16x16x32_bf16 v[44:47], a[132:135], a[180:183], v[44:47]
v_mfma_f32_16x16x32_bf16 v[36:39], a[132:135], a[176:179], v[36:39]
s_add_u32 m0, s73, 6144
s_add_u32 s64, s71, 540672
v_mfma_f32_16x16x32_bf16 v[188:191], a[172:175], a[132:135], v[188:191]
ds_read_b64_tr_b16 a[112:113], v11 offset:8192
ds_read_b64_tr_b16 a[114:115], v11 offset:8704
v_mfma_f32_16x16x32_bf16 v[184:187], a[168:171], a[132:135], v[184:187]
buffer_load_dwordx4 v5, s[8:11], s64 offen lds
v_mfma_f32_16x16x32_bf16 v[180:183], a[164:167], a[132:135], v[180:183]
ds_read_b64_tr_b16 a[116:117], v12 offset:8192
ds_read_b64_tr_b16 a[118:119], v12 offset:8704
v_mfma_f32_16x16x32_bf16 v[176:179], a[160:163], a[132:135], v[176:179]
v_mfma_f32_16x16x32_bf16 v[192:195], a[160:163], a[136:139], v[192:195]
ds_read_b64_tr_b16 a[120:121], v13 offset:8192
ds_read_b64_tr_b16 a[122:123], v13 offset:8704
v_mfma_f32_16x16x32_bf16 v[196:199], a[164:167], a[136:139], v[196:199]
v_mfma_f32_16x16x32_bf16 v[200:203], a[168:171], a[136:139], v[200:203]
buffer_load_dwordx4 v6, s[8:11], s64 offen offset:1024 lds
v_mfma_f32_16x16x32_bf16 v[204:207], a[172:175], a[136:139], v[204:207]
ds_read_b64_tr_b16 a[124:125], v14 offset:8192
ds_read_b64_tr_b16 a[126:127], v14 offset:8704
v_mfma_f32_16x16x32_bf16 v[64:67], a[136:139], a[176:179], v[64:67]
v_mfma_f32_16x16x32_bf16 v[72:75], a[136:139], a[180:183], v[72:75]
s_add_u32 m0, s77, 49152
s_add_u32 s64, s76, 262144
v_mfma_f32_16x16x32_bf16 v[80:83], a[136:139], a[184:187], v[80:83]
ds_read_b64_tr_b16 a[96:97], v11 offset:0
ds_read_b64_tr_b16 a[98:99], v11 offset:512
v_mfma_f32_16x16x32_bf16 v[88:91], a[136:139], a[188:191], v[88:91]
buffer_load_dwordx4 v7, s[16:19], s64 offen lds
v_mfma_f32_16x16x32_bf16 v[92:95], a[140:143], a[188:191], v[92:95]
ds_read_b64_tr_b16 a[100:101], v12 offset:0
ds_read_b64_tr_b16 a[102:103], v12 offset:512
v_mfma_f32_16x16x32_bf16 v[84:87], a[140:143], a[184:187], v[84:87]
v_mfma_f32_16x16x32_bf16 v[76:79], a[140:143], a[180:183], v[76:79]
ds_read_b64_tr_b16 a[104:105], v13 offset:0
ds_read_b64_tr_b16 a[106:107], v13 offset:512
v_mfma_f32_16x16x32_bf16 v[68:71], a[140:143], a[176:179], v[68:71]
v_mfma_f32_16x16x32_bf16 v[220:223], a[172:175], a[140:143], v[220:223]
buffer_load_dwordx4 v8, s[16:19], s64 offen offset:1024 lds
v_mfma_f32_16x16x32_bf16 v[216:219], a[168:171], a[140:143], v[216:219]
ds_read_b64_tr_b16 a[108:109], v14 offset:0
ds_read_b64_tr_b16 a[110:111], v14 offset:512
v_mfma_f32_16x16x32_bf16 v[212:215], a[164:167], a[140:143], v[212:215]
v_mfma_f32_16x16x32_bf16 v[208:211], a[160:163], a[140:143], v[208:211]
s_add_u32 m0, s77, 51200
s_add_u32 s64, s76, 393216
v_mfma_f32_16x16x32_bf16 v[224:227], a[160:163], a[144:147], v[224:227]
v_mfma_f32_16x16x32_bf16 v[228:231], a[164:167], a[144:147], v[228:231]
buffer_load_dwordx4 v7, s[16:19], s64 offen lds
v_mfma_f32_16x16x32_bf16 v[232:235], a[168:171], a[144:147], v[232:235]
v_mfma_f32_16x16x32_bf16 v[236:239], a[172:175], a[144:147], v[236:239]
v_mfma_f32_16x16x32_bf16 v[96:99], a[144:147], a[176:179], v[96:99]
v_mfma_f32_16x16x32_bf16 v[104:107], a[144:147], a[180:183], v[104:107]
buffer_load_dwordx4 v8, s[16:19], s64 offen offset:1024 lds
v_mfma_f32_16x16x32_bf16 v[112:115], a[144:147], a[184:187], v[112:115]
s_xor_b32 s71, s70, 512
s_add_u32 s71, s68, s71
v_mfma_f32_16x16x32_bf16 v[120:123], a[144:147], a[188:191], v[120:123]
v_mfma_f32_16x16x32_bf16 v[124:127], a[148:151], a[188:191], v[124:127]
s_add_u32 m0, s73, 32768
s_add_u32 s64, s71, 0
v_mfma_f32_16x16x32_bf16 v[116:119], a[148:151], a[184:187], v[116:119]
v_mfma_f32_16x16x32_bf16 v[108:111], a[148:151], a[180:183], v[108:111]
buffer_load_dwordx4 v5, s[8:11], s64 offen lds
v_mfma_f32_16x16x32_bf16 v[100:103], a[148:151], a[176:179], v[100:103]
v_mfma_f32_16x16x32_bf16 v[252:255], a[172:175], a[148:151], v[252:255]
v_mfma_f32_16x16x32_bf16 v[248:251], a[168:171], a[148:151], v[248:251]
v_mfma_f32_16x16x32_bf16 v[244:247], a[164:167], a[148:151], v[244:247]
v_mfma_f32_16x16x32_bf16 v[240:243], a[160:163], a[148:151], v[240:243]
buffer_load_dwordx4 v6, s[8:11], s64 offen offset:1024 lds
v_mfma_f32_16x16x32_bf16 a[0:3], a[160:163], a[152:155], a[0:3]
v_mfma_f32_16x16x32_bf16 a[4:7], a[164:167], a[152:155], a[4:7]
v_mfma_f32_16x16x32_bf16 a[8:11], a[168:171], a[152:155], a[8:11]
s_add_u32 m0, s73, 34816
s_add_u32 s64, s71, 16384
v_mfma_f32_16x16x32_bf16 a[12:15], a[172:175], a[152:155], a[12:15]
v_mfma_f32_16x16x32_bf16 v[128:131], a[152:155], a[176:179], v[128:131]
buffer_load_dwordx4 v5, s[8:11], s64 offen lds
v_mfma_f32_16x16x32_bf16 v[136:139], a[152:155], a[180:183], v[136:139]
v_mfma_f32_16x16x32_bf16 v[144:147], a[152:155], a[184:187], v[144:147]
v_mfma_f32_16x16x32_bf16 v[152:155], a[152:155], a[188:191], v[152:155]
v_mfma_f32_16x16x32_bf16 v[156:159], a[156:159], a[188:191], v[156:159]
v_mfma_f32_16x16x32_bf16 v[148:151], a[156:159], a[184:187], v[148:151]
buffer_load_dwordx4 v6, s[8:11], s64 offen offset:1024 lds
v_mfma_f32_16x16x32_bf16 v[140:143], a[156:159], a[180:183], v[140:143]
v_mfma_f32_16x16x32_bf16 v[132:135], a[156:159], a[176:179], v[132:135]
v_mfma_f32_16x16x32_bf16 a[28:31], a[172:175], a[156:159], a[28:31]
v_mfma_f32_16x16x32_bf16 a[24:27], a[168:171], a[156:159], a[24:27]
v_mfma_f32_16x16x32_bf16 a[20:23], a[164:167], a[156:159], a[20:23]
v_mfma_f32_16x16x32_bf16 a[16:19], a[160:163], a[156:159], a[16:19]
s_waitcnt lgkmcnt(0)
v_mfma_f32_16x16x32_bf16 v[160:163], a[96:99], a[64:67], v[160:163]
s_waitcnt vmcnt(20)
v_mfma_f32_16x16x32_bf16 v[164:167], a[100:103], a[64:67], v[164:167]
s_barrier
v_mfma_f32_16x16x32_bf16 v[168:171], a[104:107], a[64:67], v[168:171]
s_add_u32 s52, s81, 0
ds_read_b128 a[128:131], v10 offset:0
ds_read_b128 a[132:135], v10 offset:2048
v_mfma_f32_16x16x32_bf16 v[172:175], a[108:111], a[64:67], v[172:175]
s_xor_b32 s76, s75, 2097152
s_add_u32 s76, s74, s76
v_mfma_f32_16x16x32_bf16 v[32:35], a[64:67], a[112:115], v[32:35]
s_add_u32 m0, s77, 0
s_add_u32 s64, s76, 0
v_mfma_f32_16x16x32_bf16 v[40:43], a[64:67], a[116:119], v[40:43]
buffer_load_dwordx4 v7, s[16:19], s64 offen lds
v_mfma_f32_16x16x32_bf16 v[48:51], a[64:67], a[120:123], v[48:51]
ds_read_b128 a[136:139], v10 offset:4096
ds_read_b128 a[140:143], v10 offset:6144
v_mfma_f32_16x16x32_bf16 v[56:59], a[64:67], a[124:127], v[56:59]
buffer_load_dwordx2 a[192:193], v26, s[28:31], s52 offen
v_mfma_f32_16x16x32_bf16 v[60:63], a[68:71], a[124:127], v[60:63]
ds_read_b128 a[144:147], v10 offset:8192
ds_read_b128 a[148:151], v10 offset:10240
v_mfma_f32_16x16x32_bf16 v[52:55], a[68:71], a[120:123], v[52:55]
s_add_u32 s52, s81, 3456
v_mfma_f32_16x16x32_bf16 v[44:47], a[68:71], a[116:119], v[44:47]
ds_read_b128 a[152:155], v10 offset:12288
ds_read_b128 a[156:159], v10 offset:14336
v_mfma_f32_16x16x32_bf16 v[36:39], a[68:71], a[112:115], v[36:39]
buffer_load_dwordx4 v8, s[16:19], s64 offen offset:1024 lds
v_mfma_f32_16x16x32_bf16 v[188:191], a[108:111], a[68:71], v[188:191]
ds_read_b64_tr_b16 a[176:177], v11 offset:24576
ds_read_b64_tr_b16 a[178:179], v11 offset:25088
v_mfma_f32_16x16x32_bf16 v[184:187], a[104:107], a[68:71], v[184:187]
buffer_load_dwordx2 a[194:195], v26, s[28:31], s52 offen
v_mfma_f32_16x16x32_bf16 v[180:183], a[100:103], a[68:71], v[180:183]
ds_read_b64_tr_b16 a[180:181], v12 offset:24576
ds_read_b64_tr_b16 a[182:183], v12 offset:25088
v_mfma_f32_16x16x32_bf16 v[176:179], a[96:99], a[68:71], v[176:179]
s_add_u32 s52, s81, 6912
v_mfma_f32_16x16x32_bf16 v[192:195], a[96:99], a[72:75], v[192:195]
s_add_u32 m0, s77, 2048
s_add_u32 s64, s76, 131072
v_mfma_f32_16x16x32_bf16 v[196:199], a[100:103], a[72:75], v[196:199]
ds_read_b64_tr_b16 a[184:185], v13 offset:24576
ds_read_b64_tr_b16 a[186:187], v13 offset:25088
v_mfma_f32_16x16x32_bf16 v[200:203], a[104:107], a[72:75], v[200:203]
buffer_load_dwordx4 v7, s[16:19], s64 offen lds
v_mfma_f32_16x16x32_bf16 v[204:207], a[108:111], a[72:75], v[204:207]
ds_read_b64_tr_b16 a[188:189], v14 offset:24576
ds_read_b64_tr_b16 a[190:191], v14 offset:25088
v_mfma_f32_16x16x32_bf16 v[64:67], a[72:75], a[112:115], v[64:67]
buffer_load_dwordx2 a[196:197], v26, s[28:31], s52 offen
v_mfma_f32_16x16x32_bf16 v[72:75], a[72:75], a[116:119], v[72:75]
ds_read_b64_tr_b16 a[160:161], v11 offset:16384
ds_read_b64_tr_b16 a[162:163], v11 offset:16896
v_mfma_f32_16x16x32_bf16 v[80:83], a[72:75], a[120:123], v[80:83]
s_add_u32 s52, s81, 10368
v_mfma_f32_16x16x32_bf16 v[88:91], a[72:75], a[124:127], v[88:91]
ds_read_b64_tr_b16 a[164:165], v12 offset:16384
ds_read_b64_tr_b16 a[166:167], v12 offset:16896
v_mfma_f32_16x16x32_bf16 v[92:95], a[76:79], a[124:127], v[92:95]
buffer_load_dwordx2 a[198:199], v26, s[28:31], s52 offen
v_mfma_f32_16x16x32_bf16 v[84:87], a[76:79], a[120:123], v[84:87]
buffer_load_dwordx4 v8, s[16:19], s64 offen offset:1024 lds
v_mfma_f32_16x16x32_bf16 v[76:79], a[76:79], a[116:119], v[76:79]
s_add_u32 s52, s81, 13824
ds_read_b64_tr_b16 a[168:169], v13 offset:16384
ds_read_b64_tr_b16 a[170:171], v13 offset:16896
v_mfma_f32_16x16x32_bf16 v[68:71], a[76:79], a[112:115], v[68:71]
buffer_load_dwordx2 a[200:201], v26, s[28:31], s52 offen
v_mfma_f32_16x16x32_bf16 v[220:223], a[108:111], a[76:79], v[220:223]
ds_read_b64_tr_b16 a[172:173], v14 offset:16384
ds_read_b64_tr_b16 a[174:175], v14 offset:16896
v_mfma_f32_16x16x32_bf16 v[216:219], a[104:107], a[76:79], v[216:219]
s_add_u32 s52, s81, 17280
v_mfma_f32_16x16x32_bf16 v[212:215], a[100:103], a[76:79], v[212:215]
buffer_load_dwordx2 a[202:203], v26, s[28:31], s52 offen
v_mfma_f32_16x16x32_bf16 v[208:211], a[96:99], a[76:79], v[208:211]
s_add_u32 m0, s73, 36864
s_add_u32 s64, s71, 524288
v_mfma_f32_16x16x32_bf16 v[224:227], a[96:99], a[80:83], v[224:227]
s_add_u32 s52, s81, 20736
v_mfma_f32_16x16x32_bf16 v[228:231], a[100:103], a[80:83], v[228:231]
buffer_load_dwordx4 v5, s[8:11], s64 offen lds
v_mfma_f32_16x16x32_bf16 v[232:235], a[104:107], a[80:83], v[232:235]
buffer_load_dwordx2 a[204:205], v26, s[28:31], s52 offen
v_mfma_f32_16x16x32_bf16 v[236:239], a[108:111], a[80:83], v[236:239]
v_mfma_f32_16x16x32_bf16 v[96:99], a[80:83], a[112:115], v[96:99]
s_add_u32 s52, s81, 24192
v_mfma_f32_16x16x32_bf16 v[104:107], a[80:83], a[116:119], v[104:107]
buffer_load_dwordx2 a[206:207], v26, s[28:31], s52 offen
v_mfma_f32_16x16x32_bf16 v[112:115], a[80:83], a[120:123], v[112:115]
v_mfma_f32_16x16x32_bf16 v[120:123], a[80:83], a[124:127], v[120:123]
buffer_load_dwordx4 a[208:211], v27, s[36:39], s83 offen
v_mfma_f32_16x16x32_bf16 v[124:127], a[84:87], a[124:127], v[124:127]
buffer_load_dwordx4 v6, s[8:11], s64 offen offset:1024 lds
v_mfma_f32_16x16x32_bf16 v[116:119], a[84:87], a[120:123], v[116:119]
v_mfma_f32_16x16x32_bf16 v[108:111], a[84:87], a[116:119], v[108:111]
v_mfma_f32_16x16x32_bf16 v[100:103], a[84:87], a[112:115], v[100:103]
v_mfma_f32_16x16x32_bf16 v[252:255], a[108:111], a[84:87], v[252:255]
v_mfma_f32_16x16x32_bf16 v[248:251], a[104:107], a[84:87], v[248:251]
s_add_u32 m0, s73, 38912
s_add_u32 s64, s71, 540672
v_mfma_f32_16x16x32_bf16 v[244:247], a[100:103], a[84:87], v[244:247]
v_mfma_f32_16x16x32_bf16 v[240:243], a[96:99], a[84:87], v[240:243]
buffer_load_dwordx4 v5, s[8:11], s64 offen lds
v_mfma_f32_16x16x32_bf16 a[0:3], a[96:99], a[88:91], a[0:3]
v_mfma_f32_16x16x32_bf16 a[4:7], a[100:103], a[88:91], a[4:7]
v_mfma_f32_16x16x32_bf16 a[8:11], a[104:107], a[88:91], a[8:11]
v_mfma_f32_16x16x32_bf16 a[12:15], a[108:111], a[88:91], a[12:15]
v_mfma_f32_16x16x32_bf16 v[128:131], a[88:91], a[112:115], v[128:131]
v_mfma_f32_16x16x32_bf16 v[136:139], a[88:91], a[116:119], v[136:139]
v_mfma_f32_16x16x32_bf16 v[144:147], a[88:91], a[120:123], v[144:147]
buffer_load_dwordx4 v6, s[8:11], s64 offen offset:1024 lds
v_mfma_f32_16x16x32_bf16 v[152:155], a[88:91], a[124:127], v[152:155]
v_mfma_f32_16x16x32_bf16 v[156:159], a[92:95], a[124:127], v[156:159]
v_add_u32 v9, -65536, v9
v_add_u32 v10, -65536, v10
v_mfma_f32_16x16x32_bf16 v[148:151], a[92:95], a[120:123], v[148:151]
v_mfma_f32_16x16x32_bf16 v[140:143], a[92:95], a[116:119], v[140:143]
v_mfma_f32_16x16x32_bf16 v[132:135], a[92:95], a[112:115], v[132:135]
v_mfma_f32_16x16x32_bf16 a[28:31], a[108:111], a[92:95], a[28:31]
v_mfma_f32_16x16x32_bf16 a[24:27], a[104:107], a[92:95], a[24:27]
v_mfma_f32_16x16x32_bf16 a[20:23], a[100:103], a[92:95], a[20:23]
v_mfma_f32_16x16x32_bf16 a[16:19], a[96:99], a[92:95], a[16:19]
s_waitcnt lgkmcnt(0)
v_mfma_f32_16x16x32_bf16 v[160:163], a[160:163], a[128:131], v[160:163]
s_waitcnt vmcnt(25)
v_mfma_f32_16x16x32_bf16 v[164:167], a[164:167], a[128:131], v[164:167]
s_barrier
v_mfma_f32_16x16x32_bf16 v[168:171], a[168:171], a[128:131], v[168:171]
ds_read_b128 a[64:67], v9 offset:0
ds_read_b128 a[68:71], v9 offset:2048
v_mfma_f32_16x16x32_bf16 v[172:175], a[172:175], a[128:131], v[172:175]
s_add_u32 m0, s77, 16384
s_add_u32 s64, s76, 262144
v_mfma_f32_16x16x32_bf16 v[32:35], a[128:131], a[176:179], v[32:35]
buffer_load_dwordx4 v7, s[16:19], s64 offen lds
v_mfma_f32_16x16x32_bf16 v[40:43], a[128:131], a[180:183], v[40:43]
ds_read_b128 a[72:75], v9 offset:4096
ds_read_b128 a[76:79], v9 offset:6144
v_mfma_f32_16x16x32_bf16 v[48:51], a[128:131], a[184:187], v[48:51]
v_mfma_f32_16x16x32_bf16 v[56:59], a[128:131], a[188:191], v[56:59]
ds_read_b128 a[80:83], v9 offset:8192
ds_read_b128 a[84:87], v9 offset:10240
v_mfma_f32_16x16x32_bf16 v[60:63], a[132:135], a[188:191], v[60:63]
v_mfma_f32_16x16x32_bf16 v[52:55], a[132:135], a[184:187], v[52:55]
ds_read_b128 a[88:91], v9 offset:12288
ds_read_b128 a[92:95], v9 offset:14336
v_mfma_f32_16x16x32_bf16 v[44:47], a[132:135], a[180:183], v[44:47]
v_mfma_f32_16x16x32_bf16 v[36:39], a[132:135], a[176:179], v[36:39]
buffer_load_dwordx4 v8, s[16:19], s64 offen offset:1024 lds
v_mfma_f32_16x16x32_bf16 v[188:191], a[172:175], a[132:135], v[188:191]
ds_read_b64_tr_b16 a[112:113], v11 offset:40960
ds_read_b64_tr_b16 a[114:115], v11 offset:41472
v_mfma_f32_16x16x32_bf16 v[184:187], a[168:171], a[132:135], v[184:187]
v_mfma_f32_16x16x32_bf16 v[180:183], a[164:167], a[132:135], v[180:183]
ds_read_b64_tr_b16 a[116:117], v12 offset:40960
ds_read_b64_tr_b16 a[118:119], v12 offset:41472
v_mfma_f32_16x16x32_bf16 v[176:179], a[160:163], a[132:135], v[176:179]
s_waitcnt vmcnt(5)
v_mfma_f32_16x16x32_bf16 v[192:195], a[160:163], a[136:139], v[192:195]
s_add_u32 m0, s77, 18432
s_add_u32 s64, s76, 393216
v_accvgpr_read_b32 v16, a192
v_mfma_f32_16x16x32_bf16 v[196:199], a[164:167], a[136:139], v[196:199]
ds_read_b64_tr_b16 a[120:121], v13 offset:40960
ds_read_b64_tr_b16 a[122:123], v13 offset:41472
v_mfma_f32_16x16x32_bf16 v[200:203], a[168:171], a[136:139], v[200:203]
buffer_load_dwordx4 v7, s[16:19], s64 offen lds
v_mfma_f32_16x16x32_bf16 v[204:207], a[172:175], a[136:139], v[204:207]
ds_read_b64_tr_b16 a[124:125], v14 offset:40960
ds_read_b64_tr_b16 a[126:127], v14 offset:41472
v_mfma_f32_16x16x32_bf16 v[64:67], a[136:139], a[176:179], v[64:67]
v_accvgpr_read_b32 v17, a194
v_accvgpr_read_b32 v18, a196
v_mfma_f32_16x16x32_bf16 v[72:75], a[136:139], a[180:183], v[72:75]
ds_read_b64_tr_b16 a[96:97], v11 offset:32768
ds_read_b64_tr_b16 a[98:99], v11 offset:33280
v_mfma_f32_16x16x32_bf16 v[80:83], a[136:139], a[184:187], v[80:83]
v_accvgpr_read_b32 v19, a198
v_accvgpr_read_b32 v20, a200
v_mfma_f32_16x16x32_bf16 v[88:91], a[136:139], a[188:191], v[88:91]
ds_read_b64_tr_b16 a[100:101], v12 offset:32768
ds_read_b64_tr_b16 a[102:103], v12 offset:33280
v_mfma_f32_16x16x32_bf16 v[92:95], a[140:143], a[188:191], v[92:95]
v_accvgpr_read_b32 v21, a202
v_accvgpr_read_b32 v22, a204
v_mfma_f32_16x16x32_bf16 v[84:87], a[140:143], a[184:187], v[84:87]
buffer_load_dwordx4 v8, s[16:19], s64 offen offset:1024 lds
v_mfma_f32_16x16x32_bf16 v[76:79], a[140:143], a[180:183], v[76:79]
s_xor_b32 s71, s70, 640
s_add_u32 s71, s68, s71
v_accvgpr_read_b32 v23, a206
v_mfma_f32_16x16x32_bf16 v[68:71], a[140:143], a[176:179], v[68:71]
ds_read_b64_tr_b16 a[104:105], v13 offset:32768
ds_read_b64_tr_b16 a[106:107], v13 offset:33280
v_mfma_f32_16x16x32_bf16 v[220:223], a[172:175], a[140:143], v[220:223]
v_perm_b32 v24, v17, v16, s85
v_perm_b32 v25, v19, v18, s85
v_mfma_f32_16x16x32_bf16 v[216:219], a[168:171], a[140:143], v[216:219]
ds_read_b64_tr_b16 a[108:109], v14 offset:32768
ds_read_b64_tr_b16 a[110:111], v14 offset:33280
v_mfma_f32_16x16x32_bf16 v[212:215], a[164:167], a[140:143], v[212:215]
v_perm_b32 v26, v21, v20, s85
v_perm_b32 v27, v23, v22, s85
v_mfma_f32_16x16x32_bf16 v[208:211], a[160:163], a[140:143], v[208:211]
s_add_u32 m0, s73, 65536
s_add_u32 s64, s71, 0
v_perm_b32 v28, v17, v16, s86
v_mfma_f32_16x16x32_bf16 v[224:227], a[160:163], a[144:147], v[224:227]
v_perm_b32 v29, v19, v18, s86
v_perm_b32 v30, v21, v20, s86
v_mfma_f32_16x16x32_bf16 v[228:231], a[164:167], a[144:147], v[228:231]
buffer_load_dwordx4 v5, s[8:11], s64 offen lds
v_mfma_f32_16x16x32_bf16 v[232:235], a[168:171], a[144:147], v[232:235]
v_perm_b32 v31, v23, v22, s86
v_accvgpr_read_b32 v16, a208
v_mfma_f32_16x16x32_bf16 v[236:239], a[172:175], a[144:147], v[236:239]
v_accvgpr_read_b32 v17, a209
v_accvgpr_read_b32 v18, a210
v_mfma_f32_16x16x32_bf16 v[96:99], a[144:147], a[176:179], v[96:99]
v_accvgpr_read_b32 v19, a211
v_or_b32 v24, v24, v16
v_mfma_f32_16x16x32_bf16 v[104:107], a[144:147], a[180:183], v[104:107]
v_or_b32 v25, v25, v17
v_or_b32 v26, v26, v18
v_mfma_f32_16x16x32_bf16 v[112:115], a[144:147], a[184:187], v[112:115]
v_or_b32 v27, v27, v19
v_mfma_f32_16x16x32_bf16 v[120:123], a[144:147], a[188:191], v[120:123]
buffer_store_dwordx4 v[24:27], v4, s[24:27], s82 offen offset:0 sc1
v_mfma_f32_16x16x32_bf16 v[124:127], a[148:151], a[188:191], v[124:127]
buffer_load_dwordx4 v6, s[8:11], s64 offen offset:1024 lds
v_mfma_f32_16x16x32_bf16 v[116:119], a[148:151], a[184:187], v[116:119]
v_mfma_f32_16x16x32_bf16 v[108:111], a[148:151], a[180:183], v[108:111]
buffer_store_dwordx4 v[28:31], v4, s[24:27], s82 offen offset:1024 sc1
v_mfma_f32_16x16x32_bf16 v[100:103], a[148:151], a[176:179], v[100:103]
v_accvgpr_read_b32 v16, a193
v_accvgpr_read_b32 v17, a195
v_mfma_f32_16x16x32_bf16 v[252:255], a[172:175], a[148:151], v[252:255]
v_accvgpr_read_b32 v18, a197
v_accvgpr_read_b32 v19, a199
v_mfma_f32_16x16x32_bf16 v[248:251], a[168:171], a[148:151], v[248:251]
s_add_u32 m0, s73, 67584
s_add_u32 s64, s71, 16384
v_accvgpr_read_b32 v20, a201
v_mfma_f32_16x16x32_bf16 v[244:247], a[164:167], a[148:151], v[244:247]
v_accvgpr_read_b32 v21, a203
v_accvgpr_read_b32 v22, a205
v_mfma_f32_16x16x32_bf16 v[240:243], a[160:163], a[148:151], v[240:243]
buffer_load_dwordx4 v5, s[8:11], s64 offen lds
v_mfma_f32_16x16x32_bf16 a[0:3], a[160:163], a[152:155], a[0:3]
v_accvgpr_read_b32 v23, a207
v_mfma_f32_16x16x32_bf16 a[4:7], a[164:167], a[152:155], a[4:7]
v_mfma_f32_16x16x32_bf16 a[8:11], a[168:171], a[152:155], a[8:11]
v_perm_b32 v24, v17, v16, s85
v_perm_b32 v25, v19, v18, s85
v_mfma_f32_16x16x32_bf16 a[12:15], a[172:175], a[152:155], a[12:15]
v_perm_b32 v26, v21, v20, s85
v_perm_b32 v27, v23, v22, s85
v_mfma_f32_16x16x32_bf16 v[128:131], a[152:155], a[176:179], v[128:131]
v_perm_b32 v28, v17, v16, s86
v_perm_b32 v29, v19, v18, s86
v_mfma_f32_16x16x32_bf16 v[136:139], a[152:155], a[180:183], v[136:139]
v_perm_b32 v30, v21, v20, s86
v_perm_b32 v31, v23, v22, s86
v_mfma_f32_16x16x32_bf16 v[144:147], a[152:155], a[184:187], v[144:147]
buffer_load_dwordx4 v6, s[8:11], s64 offen offset:1024 lds
v_mfma_f32_16x16x32_bf16 v[152:155], a[152:155], a[188:191], v[152:155]
buffer_store_dwordx4 v[24:27], v4, s[24:27], s82 offen offset:2048 sc1
v_mfma_f32_16x16x32_bf16 v[156:159], a[156:159], a[188:191], v[156:159]
v_mfma_f32_16x16x32_bf16 v[148:151], a[156:159], a[184:187], v[148:151]
v_mfma_f32_16x16x32_bf16 v[140:143], a[156:159], a[180:183], v[140:143]
buffer_store_dwordx4 v[28:31], v4, s[24:27], s82 offen offset:3072 sc1
v_mfma_f32_16x16x32_bf16 v[132:135], a[156:159], a[176:179], v[132:135]
s_lshl_b32 s52, s7, 4
v_and_b32 v22, 3, v1
v_lshl_add_u32 v22, v22, 2, s52
v_mfma_f32_16x16x32_bf16 a[28:31], a[172:175], a[156:159], a[28:31]
buffer_load_dword v23, v22, s[40:43], 0 offen sc1
v_mfma_f32_16x16x32_bf16 a[24:27], a[168:171], a[156:159], a[24:27]
v_mfma_f32_16x16x32_bf16 a[20:23], a[164:167], a[156:159], a[20:23]
v_mfma_f32_16x16x32_bf16 a[16:19], a[160:163], a[156:159], a[16:19]
s_waitcnt lgkmcnt(0)
v_mfma_f32_16x16x32_bf16 v[160:163], a[96:99], a[64:67], v[160:163]
s_waitcnt vmcnt(34)
v_mfma_f32_16x16x32_bf16 v[164:167], a[100:103], a[64:67], v[164:167]
s_barrier
v_mfma_f32_16x16x32_bf16 v[168:171], a[104:107], a[64:67], v[168:171]
ds_read_b128 a[128:131], v10 offset:0
ds_read_b128 a[132:135], v10 offset:2048
v_mfma_f32_16x16x32_bf16 v[172:175], a[108:111], a[64:67], v[172:175]
s_xor_b32 s76, s75, 2621440
s_add_u32 s76, s74, s76
v_mfma_f32_16x16x32_bf16 v[32:35], a[64:67], a[112:115], v[32:35]
s_add_u32 m0, s77, 32768
s_add_u32 s64, s76, 0
v_mfma_f32_16x16x32_bf16 v[40:43], a[64:67], a[116:119], v[40:43]
buffer_load_dwordx4 v7, s[16:19], s64 offen lds
v_mfma_f32_16x16x32_bf16 v[48:51], a[64:67], a[120:123], v[48:51]
ds_read_b128 a[136:139], v10 offset:4096
ds_read_b128 a[140:143], v10 offset:6144
v_mfma_f32_16x16x32_bf16 v[56:59], a[64:67], a[124:127], v[56:59]
v_mfma_f32_16x16x32_bf16 v[60:63], a[68:71], a[124:127], v[60:63]
ds_read_b128 a[144:147], v10 offset:8192
ds_read_b128 a[148:151], v10 offset:10240
v_mfma_f32_16x16x32_bf16 v[52:55], a[68:71], a[120:123], v[52:55]
v_mfma_f32_16x16x32_bf16 v[44:47], a[68:71], a[116:119], v[44:47]
ds_read_b128 a[152:155], v10 offset:12288
ds_read_b128 a[156:159], v10 offset:14336
v_mfma_f32_16x16x32_bf16 v[36:39], a[68:71], a[112:115], v[36:39]
buffer_load_dwordx4 v8, s[16:19], s64 offen offset:1024 lds
v_mfma_f32_16x16x32_bf16 v[188:191], a[108:111], a[68:71], v[188:191]
ds_read_b64_tr_b16 a[176:177], v11 offset:57344
ds_read_b64_tr_b16 a[178:179], v11 offset:57856
v_mfma_f32_16x16x32_bf16 v[184:187], a[104:107], a[68:71], v[184:187]
v_mfma_f32_16x16x32_bf16 v[180:183], a[100:103], a[68:71], v[180:183]
ds_read_b64_tr_b16 a[180:181], v12 offset:57344
ds_read_b64_tr_b16 a[182:183], v12 offset:57856
v_mfma_f32_16x16x32_bf16 v[176:179], a[96:99], a[68:71], v[176:179]
v_mfma_f32_16x16x32_bf16 v[192:195], a[96:99], a[72:75], v[192:195]
s_add_u32 m0, s77, 34816
s_add_u32 s64, s76, 131072
v_mfma_f32_16x16x32_bf16 v[196:199], a[100:103], a[72:75], v[196:199]
ds_read_b64_tr_b16 a[184:185], v13 offset:57344
ds_read_b64_tr_b16 a[186:187], v13 offset:57856
v_mfma_f32_16x16x32_bf16 v[200:203], a[104:107], a[72:75], v[200:203]
buffer_load_dwordx4 v7, s[16:19], s64 offen lds
v_mfma_f32_16x16x32_bf16 v[204:207], a[108:111], a[72:75], v[204:207]
ds_read_b64_tr_b16 a[188:189], v14 offset:57344
ds_read_b64_tr_b16 a[190:191], v14 offset:57856
v_mfma_f32_16x16x32_bf16 v[64:67], a[72:75], a[112:115], v[64:67]
v_mfma_f32_16x16x32_bf16 v[72:75], a[72:75], a[116:119], v[72:75]
ds_read_b64_tr_b16 a[160:161], v11 offset:49152
ds_read_b64_tr_b16 a[162:163], v11 offset:49664
v_mfma_f32_16x16x32_bf16 v[80:83], a[72:75], a[120:123], v[80:83]
v_mfma_f32_16x16x32_bf16 v[88:91], a[72:75], a[124:127], v[88:91]
ds_read_b64_tr_b16 a[164:165], v12 offset:49152
ds_read_b64_tr_b16 a[166:167], v12 offset:49664
v_mfma_f32_16x16x32_bf16 v[92:95], a[76:79], a[124:127], v[92:95]
v_mfma_f32_16x16x32_bf16 v[84:87], a[76:79], a[120:123], v[84:87]
buffer_load_dwordx4 v8, s[16:19], s64 offen offset:1024 lds
v_mfma_f32_16x16x32_bf16 v[76:79], a[76:79], a[116:119], v[76:79]
ds_read_b64_tr_b16 a[168:169], v13 offset:49152
ds_read_b64_tr_b16 a[170:171], v13 offset:49664
v_mfma_f32_16x16x32_bf16 v[68:71], a[76:79], a[112:115], v[68:71]
v_mfma_f32_16x16x32_bf16 v[220:223], a[108:111], a[76:79], v[220:223]
ds_read_b64_tr_b16 a[172:173], v14 offset:49152
ds_read_b64_tr_b16 a[174:175], v14 offset:49664
v_mfma_f32_16x16x32_bf16 v[216:219], a[104:107], a[76:79], v[216:219]
v_mfma_f32_16x16x32_bf16 v[212:215], a[100:103], a[76:79], v[212:215]
v_mfma_f32_16x16x32_bf16 v[208:211], a[96:99], a[76:79], v[208:211]
s_add_u32 m0, s73, 69632
s_add_u32 s64, s71, 524288
v_mfma_f32_16x16x32_bf16 v[224:227], a[96:99], a[80:83], v[224:227]
v_mfma_f32_16x16x32_bf16 v[228:231], a[100:103], a[80:83], v[228:231]
buffer_load_dwordx4 v5, s[8:11], s64 offen lds
v_mfma_f32_16x16x32_bf16 v[232:235], a[104:107], a[80:83], v[232:235]
v_mfma_f32_16x16x32_bf16 v[236:239], a[108:111], a[80:83], v[236:239]
v_mfma_f32_16x16x32_bf16 v[96:99], a[80:83], a[112:115], v[96:99]
v_mfma_f32_16x16x32_bf16 v[104:107], a[80:83], a[116:119], v[104:107]
v_mfma_f32_16x16x32_bf16 v[112:115], a[80:83], a[120:123], v[112:115]
v_mfma_f32_16x16x32_bf16 v[120:123], a[80:83], a[124:127], v[120:123]
v_mfma_f32_16x16x32_bf16 v[124:127], a[84:87], a[124:127], v[124:127]
buffer_load_dwordx4 v6, s[8:11], s64 offen offset:1024 lds
v_mfma_f32_16x16x32_bf16 v[116:119], a[84:87], a[120:123], v[116:119]
v_mfma_f32_16x16x32_bf16 v[108:111], a[84:87], a[116:119], v[108:111]
v_mfma_f32_16x16x32_bf16 v[100:103], a[84:87], a[112:115], v[100:103]
v_mfma_f32_16x16x32_bf16 v[252:255], a[108:111], a[84:87], v[252:255]
v_mfma_f32_16x16x32_bf16 v[248:251], a[104:107], a[84:87], v[248:251]
s_add_u32 m0, s73, 71680
s_add_u32 s64, s71, 540672
s_waitcnt vmcnt(6)
v_mfma_f32_16x16x32_bf16 v[244:247], a[100:103], a[84:87], v[244:247]
v_cmp_gt_u32 vcc, 1, v23
v_mfma_f32_16x16x32_bf16 v[240:243], a[96:99], a[84:87], v[240:243]
buffer_load_dwordx4 v5, s[8:11], s64 offen lds
v_mfma_f32_16x16x32_bf16 a[0:3], a[96:99], a[88:91], a[0:3]
v_mfma_f32_16x16x32_bf16 a[4:7], a[100:103], a[88:91], a[4:7]
v_mfma_f32_16x16x32_bf16 a[8:11], a[104:107], a[88:91], a[8:11]
v_mfma_f32_16x16x32_bf16 a[12:15], a[108:111], a[88:91], a[12:15]
s_cbranch_vccnz CK_Z
CK_Z_R:
v_mfma_f32_16x16x32_bf16 v[128:131], a[88:91], a[112:115], v[128:131]
buffer_atomic_add v1, v0, s[24:27], s84 offen offset:0 sc1
v_mfma_f32_16x16x32_bf16 v[136:139], a[88:91], a[116:119], v[136:139]
s_mul_i32 s52, s66, 147456
s_lshl_b32 s53, s4, 8
s_add_u32 s52, s52, s53
v_mfma_f32_16x16x32_bf16 v[144:147], a[88:91], a[120:123], v[144:147]
buffer_load_dwordx4 v6, s[8:11], s64 offen offset:1024 lds
v_mfma_f32_16x16x32_bf16 v[152:155], a[88:91], a[124:127], v[152:155]
s_lshl2_add_u32 s53, s2, s3
s_mul_i32 s53, s53, 2304
v_lshrrev_b32 v16, 1, v1
v_mfma_f32_16x16x32_bf16 v[156:159], a[92:95], a[124:127], v[156:159]
v_add_u32 v9, 32768, v9
v_add_u32 v10, 32768, v10
v_mfma_f32_16x16x32_bf16 v[148:151], a[92:95], a[120:123], v[148:151]
v_and_b32 v17, 1, v1
v_lshlrev_b32 v16, 13, v16
v_mfma_f32_16x16x32_bf16 v[140:143], a[92:95], a[116:119], v[140:143]
v_lshl_add_u32 v16, v17, 7, v16
v_mov_b32 v17, 2147418112
v_mfma_f32_16x16x32_bf16 v[132:135], a[92:95], a[112:115], v[132:135]
v_cmp_gt_u32 s[96:97], 18, v1
v_lshlrev_b32 v18, 7, v1
v_mfma_f32_16x16x32_bf16 a[28:31], a[108:111], a[92:95], a[28:31]
v_mov_b32 v29, 0
v_mfma_f32_16x16x32_bf16 a[24:27], a[104:107], a[92:95], a[24:27]
v_mfma_f32_16x16x32_bf16 a[20:23], a[100:103], a[92:95], a[20:23]
v_cndmask_b32 v16, v17, v16, s[96:97]
v_cndmask_b32 v18, v17, v18, s[96:97]
v_mfma_f32_16x16x32_bf16 a[16:19], a[96:99], a[92:95], a[16:19]
s_waitcnt lgkmcnt(0)
v_mfma_f32_16x16x32_bf16 v[160:163], a[160:163], a[128:131], v[160:163]
s_waitcnt vmcnt(22)
v_mfma_f32_16x16x32_bf16 v[164:167], a[164:167], a[128:131], v[164:167]
s_barrier
v_mfma_f32_16x16x32_bf16 v[168:171], a[168:171], a[128:131], v[168:171]
ds_read_b128 a[64:67], v9 offset:0
ds_read_b128 a[68:71], v9 offset:2048
v_mfma_f32_16x16x32_bf16 v[172:175], a[172:175], a[128:131], v[172:175]
s_add_u32 m0, s77, 49152
s_add_u32 s64, s76, 262144
v_mfma_f32_16x16x32_bf16 v[32:35], a[128:131], a[176:179], v[32:35]
buffer_load_dwordx4 v7, s[16:19], s64 offen lds
v_mfma_f32_16x16x32_bf16 v[40:43], a[128:131], a[180:183], v[40:43]
ds_read_b128 a[72:75], v9 offset:4096
ds_read_b128 a[76:79], v9 offset:6144
v_mfma_f32_16x16x32_bf16 v[48:51], a[128:131], a[184:187], v[48:51]
buffer_load_dword a253, v18, s[12:15], s53 offen
v_mfma_f32_16x16x32_bf16 v[56:59], a[128:131], a[188:191], v[56:59]
ds_read_b128 a[80:83], v9 offset:8192
ds_read_b128 a[84:87], v9 offset:10240
v_mfma_f32_16x16x32_bf16 v[60:63], a[132:135], a[188:191], v[60:63]
v_mfma_f32_16x16x32_bf16 v[52:55], a[132:135], a[184:187], v[52:55]
ds_read_b128 a[88:91], v9 offset:12288
ds_read_b128 a[92:95], v9 offset:14336
v_mfma_f32_16x16x32_bf16 v[44:47], a[132:135], a[180:183], v[44:47]
v_mfma_f32_16x16x32_bf16 v[36:39], a[132:135], a[176:179], v[36:39]
buffer_load_dwordx4 v8, s[16:19], s64 offen offset:1024 lds
v_mfma_f32_16x16x32_bf16 v[188:191], a[172:175], a[132:135], v[188:191]
ds_read_b64_tr_b16 a[112:113], v11 offset:8192
ds_read_b64_tr_b16 a[114:115], v11 offset:8704
v_mfma_f32_16x16x32_bf16 v[184:187], a[168:171], a[132:135], v[184:187]
v_mfma_f32_16x16x32_bf16 v[180:183], a[164:167], a[132:135], v[180:183]
ds_read_b64_tr_b16 a[116:117], v12 offset:8192
ds_read_b64_tr_b16 a[118:119], v12 offset:8704
v_mfma_f32_16x16x32_bf16 v[176:179], a[160:163], a[132:135], v[176:179]
v_mfma_f32_16x16x32_bf16 v[192:195], a[160:163], a[136:139], v[192:195]
s_add_u32 m0, s77, 51200
s_add_u32 s64, s76, 393216
v_mfma_f32_16x16x32_bf16 v[196:199], a[164:167], a[136:139], v[196:199]
ds_read_b64_tr_b16 a[120:121], v13 offset:8192
ds_read_b64_tr_b16 a[122:123], v13 offset:8704
v_mfma_f32_16x16x32_bf16 v[200:203], a[168:171], a[136:139], v[200:203]
buffer_load_dwordx4 v7, s[16:19], s64 offen lds
v_mfma_f32_16x16x32_bf16 v[204:207], a[172:175], a[136:139], v[204:207]
ds_read_b64_tr_b16 a[124:125], v14 offset:8192
ds_read_b64_tr_b16 a[126:127], v14 offset:8704
v_mfma_f32_16x16x32_bf16 v[64:67], a[136:139], a[176:179], v[64:67]
v_mfma_f32_16x16x32_bf16 v[72:75], a[136:139], a[180:183], v[72:75]
ds_read_b64_tr_b16 a[96:97], v11 offset:0
ds_read_b64_tr_b16 a[98:99], v11 offset:512
v_mfma_f32_16x16x32_bf16 v[80:83], a[136:139], a[184:187], v[80:83]
v_mfma_f32_16x16x32_bf16 v[88:91], a[136:139], a[188:191], v[88:91]
ds_read_b64_tr_b16 a[100:101], v12 offset:0
ds_read_b64_tr_b16 a[102:103], v12 offset:512
v_mfma_f32_16x16x32_bf16 v[92:95], a[140:143], a[188:191], v[92:95]
v_mfma_f32_16x16x32_bf16 v[84:87], a[140:143], a[184:187], v[84:87]
buffer_load_dwordx4 v8, s[16:19], s64 offen offset:1024 lds
v_mfma_f32_16x16x32_bf16 v[76:79], a[140:143], a[180:183], v[76:79]
s_xor_b32 s71, s70, 768
s_add_u32 s71, s68, s71
v_mfma_f32_16x16x32_bf16 v[68:71], a[140:143], a[176:179], v[68:71]
ds_read_b64_tr_b16 a[104:105], v13 offset:0
ds_read_b64_tr_b16 a[106:107], v13 offset:512
v_mfma_f32_16x16x32_bf16 v[220:223], a[172:175], a[140:143], v[220:223]
v_mfma_f32_16x16x32_bf16 v[216:219], a[168:171], a[140:143], v[216:219]
ds_read_b64_tr_b16 a[108:109], v14 offset:0
ds_read_b64_tr_b16 a[110:111], v14 offset:512
v_mfma_f32_16x16x32_bf16 v[212:215], a[164:167], a[140:143], v[212:215]
v_mfma_f32_16x16x32_bf16 v[208:211], a[160:163], a[140:143], v[208:211]
s_add_u32 m0, s73, 0
s_add_u32 s64, s71, 0
v_mfma_f32_16x16x32_bf16 v[224:227], a[160:163], a[144:147], v[224:227]
v_mfma_f32_16x16x32_bf16 v[228:231], a[164:167], a[144:147], v[228:231]
buffer_load_dwordx4 v5, s[8:11], s64 offen lds
v_mfma_f32_16x16x32_bf16 v[232:235], a[168:171], a[144:147], v[232:235]
v_mfma_f32_16x16x32_bf16 v[236:239], a[172:175], a[144:147], v[236:239]
v_mfma_f32_16x16x32_bf16 v[96:99], a[144:147], a[176:179], v[96:99]
v_mfma_f32_16x16x32_bf16 v[104:107], a[144:147], a[180:183], v[104:107]
v_mfma_f32_16x16x32_bf16 v[112:115], a[144:147], a[184:187], v[112:115]
v_mfma_f32_16x16x32_bf16 v[120:123], a[144:147], a[188:191], v[120:123]
v_mfma_f32_16x16x32_bf16 v[124:127], a[148:151], a[188:191], v[124:127]
buffer_load_dwordx4 v6, s[8:11], s64 offen offset:1024 lds
v_mfma_f32_16x16x32_bf16 v[116:119], a[148:151], a[184:187], v[116:119]
v_mfma_f32_16x16x32_bf16 v[108:111], a[148:151], a[180:183], v[108:111]
v_mfma_f32_16x16x32_bf16 v[100:103], a[148:151], a[176:179], v[100:103]
v_mfma_f32_16x16x32_bf16 v[252:255], a[172:175], a[148:151], v[252:255]
v_mfma_f32_16x16x32_bf16 v[248:251], a[168:171], a[148:151], v[248:251]
s_add_u32 m0, s73, 2048
s_add_u32 s64, s71, 16384
v_mfma_f32_16x16x32_bf16 v[244:247], a[164:167], a[148:151], v[244:247]
v_mfma_f32_16x16x32_bf16 v[240:243], a[160:163], a[148:151], v[240:243]
buffer_load_dwordx4 v5, s[8:11], s64 offen lds
v_mfma_f32_16x16x32_bf16 a[0:3], a[160:163], a[152:155], a[0:3]
v_mfma_f32_16x16x32_bf16 a[4:7], a[164:167], a[152:155], a[4:7]
v_mfma_f32_16x16x32_bf16 a[8:11], a[168:171], a[152:155], a[8:11]
v_mfma_f32_16x16x32_bf16 a[12:15], a[172:175], a[152:155], a[12:15]
v_mfma_f32_16x16x32_bf16 v[128:131], a[152:155], a[176:179], v[128:131]
v_mfma_f32_16x16x32_bf16 v[136:139], a[152:155], a[180:183], v[136:139]
v_mfma_f32_16x16x32_bf16 v[144:147], a[152:155], a[184:187], v[144:147]
buffer_load_dwordx4 v6, s[8:11], s64 offen offset:1024 lds
v_mfma_f32_16x16x32_bf16 v[152:155], a[152:155], a[188:191], v[152:155]
v_mfma_f32_16x16x32_bf16 v[156:159], a[156:159], a[188:191], v[156:159]
v_mfma_f32_16x16x32_bf16 v[148:151], a[156:159], a[184:187], v[148:151]
v_mfma_f32_16x16x32_bf16 v[140:143], a[156:159], a[180:183], v[140:143]
v_mfma_f32_16x16x32_bf16 v[132:135], a[156:159], a[176:179], v[132:135]
v_mfma_f32_16x16x32_bf16 a[28:31], a[172:175], a[156:159], a[28:31]
v_mfma_f32_16x16x32_bf16 a[24:27], a[168:171], a[156:159], a[24:27]
v_mfma_f32_16x16x32_bf16 a[20:23], a[164:167], a[156:159], a[20:23]
v_mfma_f32_16x16x32_bf16 a[16:19], a[160:163], a[156:159], a[16:19]
s_waitcnt lgkmcnt(0)
v_mfma_f32_16x16x32_bf16 v[160:163], a[96:99], a[64:67], v[160:163]
s_waitcnt vmcnt(27)
v_mfma_f32_16x16x32_bf16 v[164:167], a[100:103], a[64:67], v[164:167]
s_barrier
v_mfma_f32_16x16x32_bf16 v[168:171], a[104:107], a[64:67], v[168:171]
ds_read_b128 a[128:131], v10 offset:0
ds_read_b128 a[132:135], v10 offset:2048
v_mfma_f32_16x16x32_bf16 v[172:175], a[108:111], a[64:67], v[172:175]
s_xor_b32 s76, s75, 3145728
s_add_u32 s76, s74, s76
v_mfma_f32_16x16x32_bf16 v[32:35], a[64:67], a[112:115], v[32:35]
s_add_u32 m0, s77, 0
s_add_u32 s64, s76, 0
v_mfma_f32_16x16x32_bf16 v[40:43], a[64:67], a[116:119], v[40:43]
buffer_load_dwordx4 v7, s[16:19], s64 offen lds
v_mfma_f32_16x16x32_bf16 v[48:51], a[64:67], a[120:123], v[48:51]
ds_read_b128 a[136:139], v10 offset:4096
ds_read_b128 a[140:143], v10 offset:6144
v_mfma_f32_16x16x32_bf16 v[56:59], a[64:67], a[124:127], v[56:59]
buffer_load_dword a252, v16, s[20:23], s52 offen
v_mfma_f32_16x16x32_bf16 v[60:63], a[68:71], a[124:127], v[60:63]
s_add_u32 s52, s52, 73728
ds_read_b128 a[144:147], v10 offset:8192
ds_read_b128 a[148:151], v10 offset:10240
v_mfma_f32_16x16x32_bf16 v[52:55], a[68:71], a[120:123], v[52:55]
v_mfma_f32_16x16x32_bf16 v[44:47], a[68:71], a[116:119], v[44:47]
ds_read_b128 a[152:155], v10 offset:12288
ds_read_b128 a[156:159], v10 offset:14336
v_mfma_f32_16x16x32_bf16 v[36:39], a[68:71], a[112:115], v[36:39]
buffer_load_dwordx4 v8, s[16:19], s64 offen offset:1024 lds
v_mfma_f32_16x16x32_bf16 v[188:191], a[108:111], a[68:71], v[188:191]
ds_read_b64_tr_b16 a[176:177], v11 offset:24576
ds_read_b64_tr_b16 a[178:179], v11 offset:25088
v_mfma_f32_16x16x32_bf16 v[184:187], a[104:107], a[68:71], v[184:187]
v_mfma_f32_16x16x32_bf16 v[180:183], a[100:103], a[68:71], v[180:183]
ds_read_b64_tr_b16 a[180:181], v12 offset:24576
ds_read_b64_tr_b16 a[182:183], v12 offset:25088
v_mfma_f32_16x16x32_bf16 v[176:179], a[96:99], a[68:71], v[176:179]
v_mfma_f32_16x16x32_bf16 v[192:195], a[96:99], a[72:75], v[192:195]
s_add_u32 m0, s77, 2048
s_add_u32 s64, s76, 131072
v_mfma_f32_16x16x32_bf16 v[196:199], a[100:103], a[72:75], v[196:199]
ds_read_b64_tr_b16 a[184:185], v13 offset:24576
ds_read_b64_tr_b16 a[186:187], v13 offset:25088
v_mfma_f32_16x16x32_bf16 v[200:203], a[104:107], a[72:75], v[200:203]
buffer_load_dwordx4 v7, s[16:19], s64 offen lds
v_mfma_f32_16x16x32_bf16 v[204:207], a[108:111], a[72:75], v[204:207]
ds_read_b64_tr_b16 a[188:189], v14 offset:24576
ds_read_b64_tr_b16 a[190:191], v14 offset:25088
v_mfma_f32_16x16x32_bf16 v[64:67], a[72:75], a[112:115], v[64:67]
v_mfma_f32_16x16x32_bf16 v[72:75], a[72:75], a[116:119], v[72:75]
ds_read_b64_tr_b16 a[160:161], v11 offset:16384
ds_read_b64_tr_b16 a[162:163], v11 offset:16896
v_mfma_f32_16x16x32_bf16 v[80:83], a[72:75], a[120:123], v[80:83]
v_mfma_f32_16x16x32_bf16 v[88:91], a[72:75], a[124:127], v[88:91]
ds_read_b64_tr_b16 a[164:165], v12 offset:16384
ds_read_b64_tr_b16 a[166:167], v12 offset:16896
v_mfma_f32_16x16x32_bf16 v[92:95], a[76:79], a[124:127], v[92:95]
v_mfma_f32_16x16x32_bf16 v[84:87], a[76:79], a[120:123], v[84:87]
buffer_load_dwordx4 v8, s[16:19], s64 offen offset:1024 lds
v_mfma_f32_16x16x32_bf16 v[76:79], a[76:79], a[116:119], v[76:79]
ds_read_b64_tr_b16 a[168:169], v13 offset:16384
ds_read_b64_tr_b16 a[170:171], v13 offset:16896
v_mfma_f32_16x16x32_bf16 v[68:71], a[76:79], a[112:115], v[68:71]
v_mfma_f32_16x16x32_bf16 v[220:223], a[108:111], a[76:79], v[220:223]
ds_read_b64_tr_b16 a[172:173], v14 offset:16384
ds_read_b64_tr_b16 a[174:175], v14 offset:16896
v_mfma_f32_16x16x32_bf16 v[216:219], a[104:107], a[76:79], v[216:219]
v_mfma_f32_16x16x32_bf16 v[212:215], a[100:103], a[76:79], v[212:215]
v_mfma_f32_16x16x32_bf16 v[208:211], a[96:99], a[76:79], v[208:211]
s_add_u32 m0, s73, 4096
s_add_u32 s64, s71, 524288
v_mfma_f32_16x16x32_bf16 v[224:227], a[96:99], a[80:83], v[224:227]
v_mfma_f32_16x16x32_bf16 v[228:231], a[100:103], a[80:83], v[228:231]
buffer_load_dwordx4 v5, s[8:11], s64 offen lds
v_mfma_f32_16x16x32_bf16 v[232:235], a[104:107], a[80:83], v[232:235]
v_mfma_f32_16x16x32_bf16 v[236:239], a[108:111], a[80:83], v[236:239]
v_mfma_f32_16x16x32_bf16 v[96:99], a[80:83], a[112:115], v[96:99]
v_mfma_f32_16x16x32_bf16 v[104:107], a[80:83], a[116:119], v[104:107]
v_mfma_f32_16x16x32_bf16 v[112:115], a[80:83], a[120:123], v[112:115]
v_mfma_f32_16x16x32_bf16 v[120:123], a[80:83], a[124:127], v[120:123]
v_mfma_f32_16x16x32_bf16 v[124:127], a[84:87], a[124:127], v[124:127]
buffer_load_dwordx4 v6, s[8:11], s64 offen offset:1024 lds
v_mfma_f32_16x16x32_bf16 v[116:119], a[84:87], a[120:123], v[116:119]
v_mfma_f32_16x16x32_bf16 v[108:111], a[84:87], a[116:119], v[108:111]
v_mfma_f32_16x16x32_bf16 v[100:103], a[84:87], a[112:115], v[100:103]
v_mfma_f32_16x16x32_bf16 v[252:255], a[108:111], a[84:87], v[252:255]
v_mfma_f32_16x16x32_bf16 v[248:251], a[104:107], a[84:87], v[248:251]
s_add_u32 m0, s73, 6144
s_add_u32 s64, s71, 540672
v_mfma_f32_16x16x32_bf16 v[244:247], a[100:103], a[84:87], v[244:247]
v_mfma_f32_16x16x32_bf16 v[240:243], a[96:99], a[84:87], v[240:243]
buffer_load_dwordx4 v5, s[8:11], s64 offen lds
v_mfma_f32_16x16x32_bf16 a[0:3], a[96:99], a[88:91], a[0:3]
v_mfma_f32_16x16x32_bf16 a[4:7], a[100:103], a[88:91], a[4:7]
v_mfma_f32_16x16x32_bf16 a[8:11], a[104:107], a[88:91], a[8:11]
v_mfma_f32_16x16x32_bf16 a[12:15], a[108:111], a[88:91], a[12:15]
v_mfma_f32_16x16x32_bf16 v[128:131], a[88:91], a[112:115], v[128:131]
v_mfma_f32_16x16x32_bf16 v[136:139], a[88:91], a[116:119], v[136:139]
v_mfma_f32_16x16x32_bf16 v[144:147], a[88:91], a[120:123], v[144:147]
buffer_load_dwordx4 v6, s[8:11], s64 offen offset:1024 lds
v_mfma_f32_16x16x32_bf16 v[152:155], a[88:91], a[124:127], v[152:155]
v_mfma_f32_16x16x32_bf16 v[156:159], a[92:95], a[124:127], v[156:159]
v_add_u32 v9, 32768, v9
v_add_u32 v10, 32768, v10
v_mfma_f32_16x16x32_bf16 v[148:151], a[92:95], a[120:123], v[148:151]
v_mfma_f32_16x16x32_bf16 v[140:143], a[92:95], a[116:119], v[140:143]
v_mfma_f32_16x16x32_bf16 v[132:135], a[92:95], a[112:115], v[132:135]
v_mfma_f32_16x16x32_bf16 a[28:31], a[108:111], a[92:95], a[28:31]
v_mfma_f32_16x16x32_bf16 a[24:27], a[104:107], a[92:95], a[24:27]
v_mfma_f32_16x16x32_bf16 a[20:23], a[100:103], a[92:95], a[20:23]
v_mfma_f32_16x16x32_bf16 a[16:19], a[96:99], a[92:95], a[16:19]
s_waitcnt lgkmcnt(0)
v_mfma_f32_16x16x32_bf16 v[160:163], a[160:163], a[128:131], v[160:163]
s_waitcnt vmcnt(18)
v_mfma_f32_16x16x32_bf16 v[164:167], a[164:167], a[128:131], v[164:167]
s_barrier
v_mfma_f32_16x16x32_bf16 v[168:171], a[168:171], a[128:131], v[168:171]
ds_read_b128 a[64:67], v9 offset:0
ds_read_b128 a[68:71], v9 offset:2048
v_mfma_f32_16x16x32_bf16 v[172:175], a[172:175], a[128:131], v[172:175]
s_add_u32 m0, s77, 16384
s_add_u32 s64, s76, 262144
v_mfma_f32_16x16x32_bf16 v[32:35], a[128:131], a[176:179], v[32:35]
buffer_load_dwordx4 v7, s[16:19], s64 offen lds
v_mfma_f32_16x16x32_bf16 v[40:43], a[128:131], a[180:183], v[40:43]
ds_read_b128 a[72:75], v9 offset:4096
ds_read_b128 a[76:79], v9 offset:6144
v_mfma_f32_16x16x32_bf16 v[48:51], a[128:131], a[184:187], v[48:51]
buffer_load_dword a252, v16, s[20:23], s52 offen
v_mfma_f32_16x16x32_bf16 v[56:59], a[128:131], a[188:191], v[56:59]
s_lshr_b32 s52, s2, 1
ds_read_b128 a[80:83], v9 offset:8192
ds_read_b128 a[84:87], v9 offset:10240
v_mfma_f32_16x16x32_bf16 v[60:63], a[132:135], a[188:191], v[60:63]
s_lshl2_add_u32 s52, s52, s3
s_mul_i32 s52, s52, 9216
s_and_b32 s53, s2, 1
v_mfma_f32_16x16x32_bf16 v[52:55], a[132:135], a[184:187], v[52:55]
s_lshl_b32 s53, s53, 9
ds_read_b128 a[88:91], v9 offset:12288
ds_read_b128 a[92:95], v9 offset:14336
v_mfma_f32_16x16x32_bf16 v[44:47], a[132:135], a[180:183], v[44:47]
s_add_u32 s52, s52, s53
s_lshl2_add_u32 s53, s2, s3
s_mul_i32 s53, s53, 768
v_mfma_f32_16x16x32_bf16 v[36:39], a[132:135], a[176:179], v[36:39]
buffer_load_dwordx4 v8, s[16:19], s64 offen offset:1024 lds
v_mfma_f32_16x16x32_bf16 v[188:191], a[172:175], a[132:135], v[188:191]
ds_read_b64_tr_b16 a[112:113], v11 offset:40960
ds_read_b64_tr_b16 a[114:115], v11 offset:41472
v_mfma_f32_16x16x32_bf16 v[184:187], a[168:171], a[132:135], v[184:187]
v_cmp_gt_u32 s[96:97], 40, v1
v_and_b32 v16, 7, v1
v_mfma_f32_16x16x32_bf16 v[180:183], a[164:167], a[132:135], v[180:183]
ds_read_b64_tr_b16 a[116:117], v12 offset:40960
ds_read_b64_tr_b16 a[118:119], v12 offset:41472
v_mfma_f32_16x16x32_bf16 v[176:179], a[160:163], a[132:135], v[176:179]
v_mul_u32_u24 v16, 1152, v16
v_lshrrev_b32 v19, 3, v1
v_mfma_f32_16x16x32_bf16 v[192:195], a[160:163], a[136:139], v[192:195]
s_add_u32 m0, s77, 18432
s_add_u32 s64, s76, 393216
v_lshl_add_u32 v16, v19, 7, v16
v_mfma_f32_16x16x32_bf16 v[196:199], a[164:167], a[136:139], v[196:199]
ds_read_b64_tr_b16 a[120:121], v13 offset:40960
ds_read_b64_tr_b16 a[122:123], v13 offset:41472
v_mfma_f32_16x16x32_bf16 v[200:203], a[168:171], a[136:139], v[200:203]
buffer_load_dwordx4 v7, s[16:19], s64 offen lds
v_mfma_f32_16x16x32_bf16 v[204:207], a[172:175], a[136:139], v[204:207]
ds_read_b64_tr_b16 a[124:125], v14 offset:40960
ds_read_b64_tr_b16 a[126:127], v14 offset:41472
v_mfma_f32_16x16x32_bf16 v[64:67], a[136:139], a[176:179], v[64:67]
v_cndmask_b32 v16, v17, v16, s[96:97]
v_cmp_gt_u32 s[96:97], 6, v1
v_mfma_f32_16x16x32_bf16 v[72:75], a[136:139], a[180:183], v[72:75]
ds_read_b64_tr_b16 a[96:97], v11 offset:32768
ds_read_b64_tr_b16 a[98:99], v11 offset:33280
v_mfma_f32_16x16x32_bf16 v[80:83], a[136:139], a[184:187], v[80:83]
v_cndmask_b32 v18, v17, v18, s[96:97]
v_mfma_f32_16x16x32_bf16 v[88:91], a[136:139], a[188:191], v[88:91]
ds_read_b64_tr_b16 a[100:101], v12 offset:32768
ds_read_b64_tr_b16 a[102:103], v12 offset:33280
v_mfma_f32_16x16x32_bf16 v[92:95], a[140:143], a[188:191], v[92:95]
v_mfma_f32_16x16x32_bf16 v[84:87], a[140:143], a[184:187], v[84:87]
buffer_load_dwordx4 v8, s[16:19], s64 offen offset:1024 lds
v_mfma_f32_16x16x32_bf16 v[76:79], a[140:143], a[180:183], v[76:79]
s_xor_b32 s71, s70, 896
s_add_u32 s71, s68, s71
v_mfma_f32_16x16x32_bf16 v[68:71], a[140:143], a[176:179], v[68:71]
ds_read_b64_tr_b16 a[104:105], v13 offset:32768
ds_read_b64_tr_b16 a[106:107], v13 offset:33280
v_mfma_f32_16x16x32_bf16 v[220:223], a[172:175], a[140:143], v[220:223]
v_mfma_f32_16x16x32_bf16 v[216:219], a[168:171], a[140:143], v[216:219]
ds_read_b64_tr_b16 a[108:109], v14 offset:32768
ds_read_b64_tr_b16 a[110:111], v14 offset:33280
v_mfma_f32_16x16x32_bf16 v[212:215], a[164:167], a[140:143], v[212:215]
v_mfma_f32_16x16x32_bf16 v[208:211], a[160:163], a[140:143], v[208:211]
s_add_u32 m0, s73, 32768
s_add_u32 s64, s71, 0
v_mfma_f32_16x16x32_bf16 v[224:227], a[160:163], a[144:147], v[224:227]
v_mfma_f32_16x16x32_bf16 v[228:231], a[164:167], a[144:147], v[228:231]
buffer_load_dwordx4 v5, s[8:11], s64 offen lds
v_mfma_f32_16x16x32_bf16 v[232:235], a[168:171], a[144:147], v[232:235]
v_mfma_f32_16x16x32_bf16 v[236:239], a[172:175], a[144:147], v[236:239]
v_mfma_f32_16x16x32_bf16 v[96:99], a[144:147], a[176:179], v[96:99]
v_mfma_f32_16x16x32_bf16 v[104:107], a[144:147], a[180:183], v[104:107]
v_mfma_f32_16x16x32_bf16 v[112:115], a[144:147], a[184:187], v[112:115]
v_mfma_f32_16x16x32_bf16 v[120:123], a[144:147], a[188:191], v[120:123]
v_mfma_f32_16x16x32_bf16 v[124:127], a[148:151], a[188:191], v[124:127]
buffer_load_dwordx4 v6, s[8:11], s64 offen offset:1024 lds
v_mfma_f32_16x16x32_bf16 v[116:119], a[148:151], a[184:187], v[116:119]
v_mfma_f32_16x16x32_bf16 v[108:111], a[148:151], a[180:183], v[108:111]
v_mfma_f32_16x16x32_bf16 v[100:103], a[148:151], a[176:179], v[100:103]
v_mfma_f32_16x16x32_bf16 v[252:255], a[172:175], a[148:151], v[252:255]
v_mfma_f32_16x16x32_bf16 v[248:251], a[168:171], a[148:151], v[248:251]
s_add_u32 m0, s73, 34816
s_add_u32 s64, s71, 16384
v_mfma_f32_16x16x32_bf16 v[244:247], a[164:167], a[148:151], v[244:247]
v_mfma_f32_16x16x32_bf16 v[240:243], a[160:163], a[148:151], v[240:243]
buffer_load_dwordx4 v5, s[8:11], s64 offen lds
v_mfma_f32_16x16x32_bf16 a[0:3], a[160:163], a[152:155], a[0:3]
v_mfma_f32_16x16x32_bf16 a[4:7], a[164:167], a[152:155], a[4:7]
v_mfma_f32_16x16x32_bf16 a[8:11], a[168:171], a[152:155], a[8:11]
v_mfma_f32_16x16x32_bf16 a[12:15], a[172:175], a[152:155], a[12:15]
v_mfma_f32_16x16x32_bf16 v[128:131], a[152:155], a[176:179], v[128:131]
v_mfma_f32_16x16x32_bf16 v[136:139], a[152:155], a[180:183], v[136:139]
v_mfma_f32_16x16x32_bf16 v[144:147], a[152:155], a[184:187], v[144:147]
buffer_load_dwordx4 v6, s[8:11], s64 offen offset:1024 lds
v_mfma_f32_16x16x32_bf16 v[152:155], a[152:155], a[188:191], v[152:155]
v_mfma_f32_16x16x32_bf16 v[156:159], a[156:159], a[188:191], v[156:159]
v_mfma_f32_16x16x32_bf16 v[148:151], a[156:159], a[184:187], v[148:151]
v_mfma_f32_16x16x32_bf16 v[140:143], a[156:159], a[180:183], v[140:143]
v_mfma_f32_16x16x32_bf16 v[132:135], a[156:159], a[176:179], v[132:135]
v_mfma_f32_16x16x32_bf16 a[28:31], a[172:175], a[156:159], a[28:31]
v_mfma_f32_16x16x32_bf16 a[24:27], a[168:171], a[156:159], a[24:27]
v_mfma_f32_16x16x32_bf16 a[20:23], a[164:167], a[156:159], a[20:23]
v_mfma_f32_16x16x32_bf16 a[16:19], a[160:163], a[156:159], a[16:19]
s_waitcnt lgkmcnt(0)
v_mfma_f32_16x16x32_bf16 v[160:163], a[96:99], a[64:67], v[160:163]
s_waitcnt vmcnt(22)
v_mfma_f32_16x16x32_bf16 v[164:167], a[100:103], a[64:67], v[164:167]
s_barrier
v_mfma_f32_16x16x32_bf16 v[168:171], a[104:107], a[64:67], v[168:171]
ds_read_b128 a[128:131], v10 offset:0
ds_read_b128 a[132:135], v10 offset:2048
v_mfma_f32_16x16x32_bf16 v[172:175], a[108:111], a[64:67], v[172:175]
s_xor_b32 s76, s75, 3670016
s_add_u32 s76, s74, s76
v_mfma_f32_16x16x32_bf16 v[32:35], a[64:67], a[112:115], v[32:35]
s_add_u32 m0, s77, 32768
s_add_u32 s64, s76, 0
v_mfma_f32_16x16x32_bf16 v[40:43], a[64:67], a[116:119], v[40:43]
buffer_load_dwordx4 v7, s[16:19], s64 offen lds
v_mfma_f32_16x16x32_bf16 v[48:51], a[64:67], a[120:123], v[48:51]
ds_read_b128 a[136:139], v10 offset:4096
ds_read_b128 a[140:143], v10 offset:6144
v_mfma_f32_16x16x32_bf16 v[56:59], a[64:67], a[124:127], v[56:59]
v_mfma_f32_16x16x32_bf16 v[60:63], a[68:71], a[124:127], v[60:63]
ds_read_b128 a[144:147], v10 offset:8192
ds_read_b128 a[148:151], v10 offset:10240
v_mfma_f32_16x16x32_bf16 v[52:55], a[68:71], a[120:123], v[52:55]
v_mfma_f32_16x16x32_bf16 v[44:47], a[68:71], a[116:119], v[44:47]
ds_read_b128 a[152:155], v10 offset:12288
ds_read_b128 a[156:159], v10 offset:14336
v_mfma_f32_16x16x32_bf16 v[36:39], a[68:71], a[112:115], v[36:39]
buffer_load_dwordx4 v8, s[16:19], s64 offen offset:1024 lds
v_mfma_f32_16x16x32_bf16 v[188:191], a[108:111], a[68:71], v[188:191]
ds_read_b64_tr_b16 a[176:177], v11 offset:57344
ds_read_b64_tr_b16 a[178:179], v11 offset:57856
v_mfma_f32_16x16x32_bf16 v[184:187], a[104:107], a[68:71], v[184:187]
v_mfma_f32_16x16x32_bf16 v[180:183], a[100:103], a[68:71], v[180:183]
ds_read_b64_tr_b16 a[180:181], v12 offset:57344
ds_read_b64_tr_b16 a[182:183], v12 offset:57856
v_mfma_f32_16x16x32_bf16 v[176:179], a[96:99], a[68:71], v[176:179]
v_mfma_f32_16x16x32_bf16 v[192:195], a[96:99], a[72:75], v[192:195]
s_add_u32 m0, s77, 34816
s_add_u32 s64, s76, 131072
v_mfma_f32_16x16x32_bf16 v[196:199], a[100:103], a[72:75], v[196:199]
ds_read_b64_tr_b16 a[184:185], v13 offset:57344
ds_read_b64_tr_b16 a[186:187], v13 offset:57856
v_mfma_f32_16x16x32_bf16 v[200:203], a[104:107], a[72:75], v[200:203]
buffer_load_dwordx4 v7, s[16:19], s64 offen lds
v_mfma_f32_16x16x32_bf16 v[204:207], a[108:111], a[72:75], v[204:207]
ds_read_b64_tr_b16 a[188:189], v14 offset:57344
ds_read_b64_tr_b16 a[190:191], v14 offset:57856
v_mfma_f32_16x16x32_bf16 v[64:67], a[72:75], a[112:115], v[64:67]
v_mfma_f32_16x16x32_bf16 v[72:75], a[72:75], a[116:119], v[72:75]
ds_read_b64_tr_b16 a[160:161], v11 offset:49152
ds_read_b64_tr_b16 a[162:163], v11 offset:49664
v_mfma_f32_16x16x32_bf16 v[80:83], a[72:75], a[120:123], v[80:83]
v_mfma_f32_16x16x32_bf16 v[88:91], a[72:75], a[124:127], v[88:91]
ds_read_b64_tr_b16 a[164:165], v12 offset:49152
ds_read_b64_tr_b16 a[166:167], v12 offset:49664
v_mfma_f32_16x16x32_bf16 v[92:95], a[76:79], a[124:127], v[92:95]
v_mfma_f32_16x16x32_bf16 v[84:87], a[76:79], a[120:123], v[84:87]
buffer_load_dwordx4 v8, s[16:19], s64 offen offset:1024 lds
v_mfma_f32_16x16x32_bf16 v[76:79], a[76:79], a[116:119], v[76:79]
ds_read_b64_tr_b16 a[168:169], v13 offset:49152
ds_read_b64_tr_b16 a[170:171], v13 offset:49664
v_mfma_f32_16x16x32_bf16 v[68:71], a[76:79], a[112:115], v[68:71]
v_mfma_f32_16x16x32_bf16 v[220:223], a[108:111], a[76:79], v[220:223]
ds_read_b64_tr_b16 a[172:173], v14 offset:49152
ds_read_b64_tr_b16 a[174:175], v14 offset:49664
v_mfma_f32_16x16x32_bf16 v[216:219], a[104:107], a[76:79], v[216:219]
v_mfma_f32_16x16x32_bf16 v[212:215], a[100:103], a[76:79], v[212:215]
v_mfma_f32_16x16x32_bf16 v[208:211], a[96:99], a[76:79], v[208:211]
s_add_u32 m0, s73, 36864
s_add_u32 s64, s71, 524288
v_mfma_f32_16x16x32_bf16 v[224:227], a[96:99], a[80:83], v[224:227]
v_mfma_f32_16x16x32_bf16 v[228:231], a[100:103], a[80:83], v[228:231]
buffer_load_dwordx4 v5, s[8:11], s64 offen lds
v_mfma_f32_16x16x32_bf16 v[232:235], a[104:107], a[80:83], v[232:235]
v_mfma_f32_16x16x32_bf16 v[236:239], a[108:111], a[80:83], v[236:239]
v_mfma_f32_16x16x32_bf16 v[96:99], a[80:83], a[112:115], v[96:99]
v_mfma_f32_16x16x32_bf16 v[104:107], a[80:83], a[116:119], v[104:107]
v_mfma_f32_16x16x32_bf16 v[112:115], a[80:83], a[120:123], v[112:115]
v_mfma_f32_16x16x32_bf16 v[120:123], a[80:83], a[124:127], v[120:123]
v_mfma_f32_16x16x32_bf16 v[124:127], a[84:87], a[124:127], v[124:127]
buffer_load_dwordx4 v6, s[8:11], s64 offen offset:1024 lds
v_mfma_f32_16x16x32_bf16 v[116:119], a[84:87], a[120:123], v[116:119]
buffer_load_dword v30, v29, s[24:27], s89 offen sc1
v_mfma_f32_16x16x32_bf16 v[108:111], a[84:87], a[116:119], v[108:111]
v_mfma_f32_16x16x32_bf16 v[100:103], a[84:87], a[112:115], v[100:103]
v_mfma_f32_16x16x32_bf16 v[252:255], a[108:111], a[84:87], v[252:255]
v_mfma_f32_16x16x32_bf16 v[248:251], a[104:107], a[84:87], v[248:251]
s_add_u32 m0, s73, 38912
s_add_u32 s64, s71, 540672
v_mfma_f32_16x16x32_bf16 v[244:247], a[100:103], a[84:87], v[244:247]
v_mfma_f32_16x16x32_bf16 v[240:243], a[96:99], a[84:87], v[240:243]
buffer_load_dwordx4 v5, s[8:11], s64 offen lds
v_mfma_f32_16x16x32_bf16 a[0:3], a[96:99], a[88:91], a[0:3]
v_mfma_f32_16x16x32_bf16 a[4:7], a[100:103], a[88:91], a[4:7]
v_mfma_f32_16x16x32_bf16 a[8:11], a[104:107], a[88:91], a[8:11]
v_mfma_f32_16x16x32_bf16 a[12:15], a[108:111], a[88:91], a[12:15]
v_mfma_f32_16x16x32_bf16 v[128:131], a[88:91], a[112:115], v[128:131]
v_mfma_f32_16x16x32_bf16 v[136:139], a[88:91], a[116:119], v[136:139]
v_mfma_f32_16x16x32_bf16 v[144:147], a[88:91], a[120:123], v[144:147]
buffer_load_dwordx4 v6, s[8:11], s64 offen offset:1024 lds
v_mfma_f32_16x16x32_bf16 v[152:155], a[88:91], a[124:127], v[152:155]
v_mfma_f32_16x16x32_bf16 v[156:159], a[92:95], a[124:127], v[156:159]
v_add_u32 v9, -65536, v9
v_add_u32 v10, -65536, v10
v_mfma_f32_16x16x32_bf16 v[148:151], a[92:95], a[120:123], v[148:151]
v_mfma_f32_16x16x32_bf16 v[140:143], a[92:95], a[116:119], v[140:143]
v_mfma_f32_16x16x32_bf16 v[132:135], a[92:95], a[112:115], v[132:135]
v_mfma_f32_16x16x32_bf16 a[28:31], a[108:111], a[92:95], a[28:31]
v_mfma_f32_16x16x32_bf16 a[24:27], a[104:107], a[92:95], a[24:27]
v_mfma_f32_16x16x32_bf16 a[20:23], a[100:103], a[92:95], a[20:23]
v_mfma_f32_16x16x32_bf16 a[16:19], a[96:99], a[92:95], a[16:19]
s_waitcnt lgkmcnt(0)
v_mfma_f32_16x16x32_bf16 v[160:163], a[160:163], a[128:131], v[160:163]
s_waitcnt vmcnt(18)
v_mfma_f32_16x16x32_bf16 v[164:167], a[164:167], a[128:131], v[164:167]
s_barrier
v_mfma_f32_16x16x32_bf16 v[168:171], a[168:171], a[128:131], v[168:171]
ds_read_b128 a[64:67], v9 offset:0
ds_read_b128 a[68:71], v9 offset:2048
v_mfma_f32_16x16x32_bf16 v[172:175], a[172:175], a[128:131], v[172:175]
s_add_u32 m0, s77, 49152
s_add_u32 s64, s76, 262144
v_mfma_f32_16x16x32_bf16 v[32:35], a[128:131], a[176:179], v[32:35]
buffer_load_dwordx4 v7, s[16:19], s64 offen lds
v_mfma_f32_16x16x32_bf16 v[40:43], a[128:131], a[180:183], v[40:43]
ds_read_b128 a[72:75], v9 offset:4096
ds_read_b128 a[76:79], v9 offset:6144
v_mfma_f32_16x16x32_bf16 v[48:51], a[128:131], a[184:187], v[48:51]
v_mfma_f32_16x16x32_bf16 v[56:59], a[128:131], a[188:191], v[56:59]
ds_read_b128 a[80:83], v9 offset:8192
ds_read_b128 a[84:87], v9 offset:10240
v_mfma_f32_16x16x32_bf16 v[60:63], a[132:135], a[188:191], v[60:63]
v_mfma_f32_16x16x32_bf16 v[52:55], a[132:135], a[184:187], v[52:55]
ds_read_b128 a[88:91], v9 offset:12288
ds_read_b128 a[92:95], v9 offset:14336
v_mfma_f32_16x16x32_bf16 v[44:47], a[132:135], a[180:183], v[44:47]
v_mfma_f32_16x16x32_bf16 v[36:39], a[132:135], a[176:179], v[36:39]
buffer_load_dwordx4 v8, s[16:19], s64 offen offset:1024 lds
v_mfma_f32_16x16x32_bf16 v[188:191], a[172:175], a[132:135], v[188:191]
ds_read_b64_tr_b16 a[112:113], v11 offset:8192
ds_read_b64_tr_b16 a[114:115], v11 offset:8704
v_mfma_f32_16x16x32_bf16 v[184:187], a[168:171], a[132:135], v[184:187]
v_mfma_f32_16x16x32_bf16 v[180:183], a[164:167], a[132:135], v[180:183]
ds_read_b64_tr_b16 a[116:117], v12 offset:8192
ds_read_b64_tr_b16 a[118:119], v12 offset:8704
v_mfma_f32_16x16x32_bf16 v[176:179], a[160:163], a[132:135], v[176:179]
v_mfma_f32_16x16x32_bf16 v[192:195], a[160:163], a[136:139], v[192:195]
s_add_u32 m0, s77, 51200
s_add_u32 s64, s76, 393216
v_mfma_f32_16x16x32_bf16 v[196:199], a[164:167], a[136:139], v[196:199]
ds_read_b64_tr_b16 a[120:121], v13 offset:8192
ds_read_b64_tr_b16 a[122:123], v13 offset:8704
v_mfma_f32_16x16x32_bf16 v[200:203], a[168:171], a[136:139], v[200:203]
buffer_load_dwordx4 v7, s[16:19], s64 offen lds
v_mfma_f32_16x16x32_bf16 v[204:207], a[172:175], a[136:139], v[204:207]
ds_read_b64_tr_b16 a[124:125], v14 offset:8192
ds_read_b64_tr_b16 a[126:127], v14 offset:8704
v_mfma_f32_16x16x32_bf16 v[64:67], a[136:139], a[176:179], v[64:67]
v_mfma_f32_16x16x32_bf16 v[72:75], a[136:139], a[180:183], v[72:75]
ds_read_b64_tr_b16 a[96:97], v11 offset:0
ds_read_b64_tr_b16 a[98:99], v11 offset:512
v_mfma_f32_16x16x32_bf16 v[80:83], a[136:139], a[184:187], v[80:83]
v_mfma_f32_16x16x32_bf16 v[88:91], a[136:139], a[188:191], v[88:91]
ds_read_b64_tr_b16 a[100:101], v12 offset:0
ds_read_b64_tr_b16 a[102:103], v12 offset:512
v_mfma_f32_16x16x32_bf16 v[92:95], a[140:143], a[188:191], v[92:95]
v_mfma_f32_16x16x32_bf16 v[84:87], a[140:143], a[184:187], v[84:87]
buffer_load_dwordx4 v8, s[16:19], s64 offen offset:1024 lds
v_mfma_f32_16x16x32_bf16 v[76:79], a[140:143], a[180:183], v[76:79]
s_lshl_b32 s70, s93, 7
s_mul_i32 s68, s66, 36864
s_mul_i32 s69, s67, 36864
v_mfma_f32_16x16x32_bf16 v[68:71], a[140:143], a[176:179], v[68:71]
v_lshrrev_b32 v31, 3, v1
v_lshl_add_u32 v5, v31, 7, v5
v_mfma_f32_16x16x32_bf16 v[220:223], a[172:175], a[140:143], v[220:223]
v_lshl_add_u32 v6, v31, 7, v6
v_add_u32 v6, 1024, v6
v_mfma_f32_16x16x32_bf16 v[216:219], a[168:171], a[140:143], v[216:219]
s_xor_b32 s65, s70, 0
s_add_u32 s71, s68, s65
s_add_u32 s72, s69, s65
v_mfma_f32_16x16x32_bf16 v[212:215], a[164:167], a[140:143], v[212:215]
ds_read_b64_tr_b16 a[104:105], v13 offset:0
ds_read_b64_tr_b16 a[106:107], v13 offset:512
v_mfma_f32_16x16x32_bf16 v[208:211], a[160:163], a[140:143], v[208:211]
s_add_u32 m0, s73, 65536
s_add_u32 s64, s71, 0
v_mfma_f32_16x16x32_bf16 v[224:227], a[160:163], a[144:147], v[224:227]
ds_read_b64_tr_b16 a[108:109], v14 offset:0
ds_read_b64_tr_b16 a[110:111], v14 offset:512
v_mfma_f32_16x16x32_bf16 v[228:231], a[164:167], a[144:147], v[228:231]
buffer_load_dwordx4 v5, s[12:15], s64 offen lds
v_mfma_f32_16x16x32_bf16 v[232:235], a[168:171], a[144:147], v[232:235]
v_mfma_f32_16x16x32_bf16 v[236:239], a[172:175], a[144:147], v[236:239]
v_mfma_f32_16x16x32_bf16 v[96:99], a[144:147], a[176:179], v[96:99]
v_mfma_f32_16x16x32_bf16 v[104:107], a[144:147], a[180:183], v[104:107]
v_mfma_f32_16x16x32_bf16 v[112:115], a[144:147], a[184:187], v[112:115]
v_mfma_f32_16x16x32_bf16 v[120:123], a[144:147], a[188:191], v[120:123]
v_mfma_f32_16x16x32_bf16 v[124:127], a[148:151], a[188:191], v[124:127]
buffer_load_dwordx4 v6, s[12:15], s64 offen offset:1024 lds
v_mfma_f32_16x16x32_bf16 v[116:119], a[148:151], a[184:187], v[116:119]
v_mfma_f32_16x16x32_bf16 v[108:111], a[148:151], a[180:183], v[108:111]
v_mfma_f32_16x16x32_bf16 v[100:103], a[148:151], a[176:179], v[100:103]
v_mfma_f32_16x16x32_bf16 v[252:255], a[172:175], a[148:151], v[252:255]
v_mfma_f32_16x16x32_bf16 v[248:251], a[168:171], a[148:151], v[248:251]
s_add_u32 m0, s73, 67584
s_add_u32 s64, s71, 18432
v_mfma_f32_16x16x32_bf16 v[244:247], a[164:167], a[148:151], v[244:247]
v_mfma_f32_16x16x32_bf16 v[240:243], a[160:163], a[148:151], v[240:243]
buffer_load_dwordx4 v5, s[12:15], s64 offen lds
v_mfma_f32_16x16x32_bf16 a[0:3], a[160:163], a[152:155], a[0:3]
v_mfma_f32_16x16x32_bf16 a[4:7], a[164:167], a[152:155], a[4:7]
v_mfma_f32_16x16x32_bf16 a[8:11], a[168:171], a[152:155], a[8:11]
s_waitcnt vmcnt(9)
v_mfma_f32_16x16x32_bf16 a[12:15], a[172:175], a[152:155], a[12:15]
v_cmp_gt_u32 vcc, 18, v30
v_mfma_f32_16x16x32_bf16 v[128:131], a[152:155], a[176:179], v[128:131]
v_mfma_f32_16x16x32_bf16 v[136:139], a[152:155], a[180:183], v[136:139]
v_mfma_f32_16x16x32_bf16 v[144:147], a[152:155], a[184:187], v[144:147]
buffer_load_dwordx4 v6, s[12:15], s64 offen offset:1024 lds
v_mfma_f32_16x16x32_bf16 v[152:155], a[152:155], a[188:191], v[152:155]
v_mfma_f32_16x16x32_bf16 v[156:159], a[156:159], a[188:191], v[156:159]
s_cbranch_vccnz CK_WA
CK_WA_R:
v_mfma_f32_16x16x32_bf16 v[148:151], a[156:159], a[184:187], v[148:151]
v_mfma_f32_16x16x32_bf16 v[140:143], a[156:159], a[180:183], v[140:143]
v_mfma_f32_16x16x32_bf16 v[132:135], a[156:159], a[176:179], v[132:135]
v_mfma_f32_16x16x32_bf16 a[28:31], a[172:175], a[156:159], a[28:31]
v_mfma_f32_16x16x32_bf16 a[24:27], a[168:171], a[156:159], a[24:27]
v_mfma_f32_16x16x32_bf16 a[20:23], a[164:167], a[156:159], a[20:23]
v_mfma_f32_16x16x32_bf16 a[16:19], a[160:163], a[156:159], a[16:19]
s_waitcnt lgkmcnt(0)
v_mfma_f32_16x16x32_bf16 v[160:163], a[96:99], a[64:67], v[160:163]
s_waitcnt vmcnt(21)
v_mfma_f32_16x16x32_bf16 v[164:167], a[100:103], a[64:67], v[164:167]
s_barrier
v_mfma_f32_16x16x32_bf16 v[168:171], a[104:107], a[64:67], v[168:171]
ds_read_b128 a[128:131], v10 offset:0
ds_read_b128 a[132:135], v10 offset:2048
v_mfma_f32_16x16x32_bf16 v[172:175], a[108:111], a[64:67], v[172:175]
s_lshr_b32 s65, s3, 1
s_lshl_b32 s75, s65, 17
s_add_u32 s74, s74, s75
v_mfma_f32_16x16x32_bf16 v[32:35], a[64:67], a[112:115], v[32:35]
s_lshl_b32 s65, s65, 11
s_and_b32 s77, s77, 4096
s_add_u32 s77, s77, s65
v_mfma_f32_16x16x32_bf16 v[40:43], a[64:67], a[116:119], v[40:43]
s_xor_b32 s75, s93, 0
s_lshl_b32 s76, s75, 19
s_add_u32 s76, s76, s74
v_mfma_f32_16x16x32_bf16 v[48:51], a[64:67], a[120:123], v[48:51]
s_lshl_b32 s79, s75, 13
s_add_u32 s79, s79, s78
v_mfma_f32_16x16x32_bf16 v[56:59], a[64:67], a[124:127], v[56:59]
s_add_u32 m0, s77, 0
s_add_u32 s64, s76, 0
v_mfma_f32_16x16x32_bf16 v[60:63], a[68:71], a[124:127], v[60:63]
buffer_load_dwordx4 v7, s[20:23], s64 offen lds
v_mfma_f32_16x16x32_bf16 v[52:55], a[68:71], a[120:123], v[52:55]
ds_read_b128 a[136:139], v10 offset:4096
ds_read_b128 a[140:143], v10 offset:6144
v_mfma_f32_16x16x32_bf16 v[44:47], a[68:71], a[116:119], v[44:47]
buffer_load_dword a252, v16, s[32:35], s52 offen
v_mfma_f32_16x16x32_bf16 v[36:39], a[68:71], a[112:115], v[36:39]
ds_read_b128 a[144:147], v10 offset:8192
ds_read_b128 a[148:151], v10 offset:10240
v_mfma_f32_16x16x32_bf16 v[188:191], a[108:111], a[68:71], v[188:191]
buffer_load_dwordx4 v8, s[20:23], s64 offen offset:1024 lds
v_mfma_f32_16x16x32_bf16 v[184:187], a[104:107], a[68:71], v[184:187]
ds_read_b128 a[152:155], v10 offset:12288
ds_read_b128 a[156:159], v10 offset:14336
v_mfma_f32_16x16x32_bf16 v[180:183], a[100:103], a[68:71], v[180:183]
buffer_load_dword a253, v18, s[48:51], s53 offen
v_mfma_f32_16x16x32_bf16 v[176:179], a[96:99], a[68:71], v[176:179]
ds_read_b64_tr_b16 a[176:177], v11 offset:24576
ds_read_b64_tr_b16 a[178:179], v11 offset:25088
v_mfma_f32_16x16x32_bf16 v[192:195], a[96:99], a[72:75], v[192:195]
v_mfma_f32_16x16x32_bf16 v[196:199], a[100:103], a[72:75], v[196:199]
ds_read_b64_tr_b16 a[180:181], v12 offset:24576
ds_read_b64_tr_b16 a[182:183], v12 offset:25088
v_mfma_f32_16x16x32_bf16 v[200:203], a[104:107], a[72:75], v[200:203]
s_add_u32 m0, s80, 0
s_add_u32 s64, s79, 0
v_mfma_f32_16x16x32_bf16 v[204:207], a[108:111], a[72:75], v[204:207]
ds_read_b64_tr_b16 a[184:185], v13 offset:24576
ds_read_b64_tr_b16 a[186:187], v13 offset:25088
v_mfma_f32_16x16x32_bf16 v[64:67], a[72:75], a[112:115], v[64:67]
buffer_load_dwordx4 v4, s[24:27], s64 offen sc1 lds
v_mfma_f32_16x16x32_bf16 v[72:75], a[72:75], a[116:119], v[72:75]
ds_read_b64_tr_b16 a[188:189], v14 offset:24576
ds_read_b64_tr_b16 a[190:191], v14 offset:25088
v_mfma_f32_16x16x32_bf16 v[80:83], a[72:75], a[120:123], v[80:83]
v_mfma_f32_16x16x32_bf16 v[88:91], a[72:75], a[124:127], v[88:91]
ds_read_b64_tr_b16 a[160:161], v11 offset:16384
ds_read_b64_tr_b16 a[162:163], v11 offset:16896
v_mfma_f32_16x16x32_bf16 v[92:95], a[76:79], a[124:127], v[92:95]
v_mfma_f32_16x16x32_bf16 v[84:87], a[76:79], a[120:123], v[84:87]
ds_read_b64_tr_b16 a[164:165], v12 offset:16384
ds_read_b64_tr_b16 a[166:167], v12 offset:16896
v_mfma_f32_16x16x32_bf16 v[76:79], a[76:79], a[116:119], v[76:79]
s_add_u32 m0, s73, 69632
s_add_u32 s64, s72, 0
v_mfma_f32_16x16x32_bf16 v[68:71], a[76:79], a[112:115], v[68:71]
ds_read_b64_tr_b16 a[168:169], v13 offset:16384
ds_read_b64_tr_b16 a[170:171], v13 offset:16896
v_mfma_f32_16x16x32_bf16 v[220:223], a[108:111], a[76:79], v[220:223]
buffer_load_dwordx4 v5, s[12:15], s64 offen lds
v_mfma_f32_16x16x32_bf16 v[216:219], a[104:107], a[76:79], v[216:219]
ds_read_b64_tr_b16 a[172:173], v14 offset:16384
ds_read_b64_tr_b16 a[174:175], v14 offset:16896
v_mfma_f32_16x16x32_bf16 v[212:215], a[100:103], a[76:79], v[212:215]
v_mfma_f32_16x16x32_bf16 v[208:211], a[96:99], a[76:79], v[208:211]
v_mfma_f32_16x16x32_bf16 v[224:227], a[96:99], a[80:83], v[224:227]
v_mfma_f32_16x16x32_bf16 v[228:231], a[100:103], a[80:83], v[228:231]
v_mfma_f32_16x16x32_bf16 v[232:235], a[104:107], a[80:83], v[232:235]
v_mfma_f32_16x16x32_bf16 v[236:239], a[108:111], a[80:83], v[236:239]
v_mfma_f32_16x16x32_bf16 v[96:99], a[80:83], a[112:115], v[96:99]
v_mfma_f32_16x16x32_bf16 v[104:107], a[80:83], a[116:119], v[104:107]
buffer_load_dwordx4 v6, s[12:15], s64 offen offset:1024 lds
v_mfma_f32_16x16x32_bf16 v[112:115], a[80:83], a[120:123], v[112:115]
v_mfma_f32_16x16x32_bf16 v[120:123], a[80:83], a[124:127], v[120:123]
v_mfma_f32_16x16x32_bf16 v[124:127], a[84:87], a[124:127], v[124:127]
v_mfma_f32_16x16x32_bf16 v[116:119], a[84:87], a[120:123], v[116:119]
v_mfma_f32_16x16x32_bf16 v[108:111], a[84:87], a[116:119], v[108:111]
v_mfma_f32_16x16x32_bf16 v[100:103], a[84:87], a[112:115], v[100:103]
s_add_u32 m0, s73, 71680
s_add_u32 s64, s72, 18432
v_mfma_f32_16x16x32_bf16 v[252:255], a[108:111], a[84:87], v[252:255]
v_mfma_f32_16x16x32_bf16 v[248:251], a[104:107], a[84:87], v[248:251]
buffer_load_dwordx4 v5, s[12:15], s64 offen lds
v_mfma_f32_16x16x32_bf16 v[244:247], a[100:103], a[84:87], v[244:247]
v_mfma_f32_16x16x32_bf16 v[240:243], a[96:99], a[84:87], v[240:243]
v_mfma_f32_16x16x32_bf16 a[0:3], a[96:99], a[88:91], a[0:3]
v_mfma_f32_16x16x32_bf16 a[4:7], a[100:103], a[88:91], a[4:7]
v_mfma_f32_16x16x32_bf16 a[8:11], a[104:107], a[88:91], a[8:11]
v_mfma_f32_16x16x32_bf16 a[12:15], a[108:111], a[88:91], a[12:15]
v_mfma_f32_16x16x32_bf16 v[128:131], a[88:91], a[112:115], v[128:131]
v_mfma_f32_16x16x32_bf16 v[136:139], a[88:91], a[116:119], v[136:139]
buffer_load_dwordx4 v6, s[12:15], s64 offen offset:1024 lds
v_mfma_f32_16x16x32_bf16 v[144:147], a[88:91], a[120:123], v[144:147]
v_mfma_f32_16x16x32_bf16 v[152:155], a[88:91], a[124:127], v[152:155]
v_mfma_f32_16x16x32_bf16 v[156:159], a[92:95], a[124:127], v[156:159]
v_add_u32 v9, 32768, v9
v_add_u32 v10, 32768, v10
v_mfma_f32_16x16x32_bf16 v[148:151], a[92:95], a[120:123], v[148:151]
v_mfma_f32_16x16x32_bf16 v[140:143], a[92:95], a[116:119], v[140:143]
v_mfma_f32_16x16x32_bf16 v[132:135], a[92:95], a[112:115], v[132:135]
v_mfma_f32_16x16x32_bf16 a[28:31], a[108:111], a[92:95], a[28:31]
v_mfma_f32_16x16x32_bf16 a[24:27], a[104:107], a[92:95], a[24:27]
v_mfma_f32_16x16x32_bf16 a[20:23], a[100:103], a[92:95], a[20:23]
v_mfma_f32_16x16x32_bf16 a[16:19], a[96:99], a[92:95], a[16:19]
s_waitcnt lgkmcnt(0)
v_mfma_f32_16x16x32_bf16 v[160:163], a[160:163], a[128:131], v[160:163]
s_waitcnt vmcnt(17)
v_mfma_f32_16x16x32_bf16 v[164:167], a[164:167], a[128:131], v[164:167]
s_barrier
v_mfma_f32_16x16x32_bf16 v[168:171], a[168:171], a[128:131], v[168:171]
ds_read_b128 a[64:67], v9 offset:0
ds_read_b128 a[68:71], v9 offset:2048
v_mfma_f32_16x16x32_bf16 v[172:175], a[172:175], a[128:131], v[172:175]
s_add_u32 m0, s77, 16384
s_add_u32 s64, s76, 262144
v_mfma_f32_16x16x32_bf16 v[32:35], a[128:131], a[176:179], v[32:35]
buffer_load_dwordx4 v7, s[20:23], s64 offen lds
v_mfma_f32_16x16x32_bf16 v[40:43], a[128:131], a[180:183], v[40:43]
ds_read_b128 a[72:75], v9 offset:4096
ds_read_b128 a[76:79], v9 offset:6144
v_mfma_f32_16x16x32_bf16 v[48:51], a[128:131], a[184:187], v[48:51]
v_mfma_f32_16x16x32_bf16 v[56:59], a[128:131], a[188:191], v[56:59]
ds_read_b128 a[80:83], v9 offset:8192
ds_read_b128 a[84:87], v9 offset:10240
v_mfma_f32_16x16x32_bf16 v[60:63], a[132:135], a[188:191], v[60:63]
v_mfma_f32_16x16x32_bf16 v[52:55], a[132:135], a[184:187], v[52:55]
ds_read_b128 a[88:91], v9 offset:12288
ds_read_b128 a[92:95], v9 offset:14336
v_mfma_f32_16x16x32_bf16 v[44:47], a[132:135], a[180:183], v[44:47]
v_mfma_f32_16x16x32_bf16 v[36:39], a[132:135], a[176:179], v[36:39]
ds_read_b64_tr_b16 a[112:113], v11 offset:40960
ds_read_b64_tr_b16 a[114:115], v11 offset:41472
v_mfma_f32_16x16x32_bf16 v[188:191], a[172:175], a[132:135], v[188:191]
buffer_load_dwordx4 v8, s[20:23], s64 offen offset:1024 lds
v_mfma_f32_16x16x32_bf16 v[184:187], a[168:171], a[132:135], v[184:187]
ds_read_b64_tr_b16 a[116:117], v12 offset:40960
ds_read_b64_tr_b16 a[118:119], v12 offset:41472
v_mfma_f32_16x16x32_bf16 v[180:183], a[164:167], a[132:135], v[180:183]
v_mfma_f32_16x16x32_bf16 v[176:179], a[160:163], a[132:135], v[176:179]
ds_read_b64_tr_b16 a[120:121], v13 offset:40960
ds_read_b64_tr_b16 a[122:123], v13 offset:41472
v_mfma_f32_16x16x32_bf16 v[192:195], a[160:163], a[136:139], v[192:195]
v_mfma_f32_16x16x32_bf16 v[196:199], a[164:167], a[136:139], v[196:199]
ds_read_b64_tr_b16 a[124:125], v14 offset:40960
ds_read_b64_tr_b16 a[126:127], v14 offset:41472
v_mfma_f32_16x16x32_bf16 v[200:203], a[168:171], a[136:139], v[200:203]
s_add_u32 m0, s80, 16384
s_add_u32 s64, s79, 4096
v_mfma_f32_16x16x32_bf16 v[204:207], a[172:175], a[136:139], v[204:207]
ds_read_b64_tr_b16 a[96:97], v11 offset:32768
ds_read_b64_tr_b16 a[98:99], v11 offset:33280
v_mfma_f32_16x16x32_bf16 v[64:67], a[136:139], a[176:179], v[64:67]
buffer_load_dwordx4 v4, s[24:27], s64 offen sc1 lds
v_mfma_f32_16x16x32_bf16 v[72:75], a[136:139], a[180:183], v[72:75]
s_xor_b32 s65, s70, 128
s_add_u32 s71, s68, s65
s_add_u32 s72, s69, s65
v_mfma_f32_16x16x32_bf16 v[80:83], a[136:139], a[184:187], v[80:83]
ds_read_b64_tr_b16 a[100:101], v12 offset:32768
ds_read_b64_tr_b16 a[102:103], v12 offset:33280
v_mfma_f32_16x16x32_bf16 v[88:91], a[136:139], a[188:191], v[88:91]
v_mfma_f32_16x16x32_bf16 v[92:95], a[140:143], a[188:191], v[92:95]
ds_read_b64_tr_b16 a[104:105], v13 offset:32768
ds_read_b64_tr_b16 a[106:107], v13 offset:33280
v_mfma_f32_16x16x32_bf16 v[84:87], a[140:143], a[184:187], v[84:87]
v_mfma_f32_16x16x32_bf16 v[76:79], a[140:143], a[180:183], v[76:79]
s_add_u32 m0, s73, 0
s_add_u32 s64, s71, 0
v_mfma_f32_16x16x32_bf16 v[68:71], a[140:143], a[176:179], v[68:71]
ds_read_b64_tr_b16 a[108:109], v14 offset:32768
ds_read_b64_tr_b16 a[110:111], v14 offset:33280
v_mfma_f32_16x16x32_bf16 v[220:223], a[172:175], a[140:143], v[220:223]
buffer_load_dwordx4 v5, s[12:15], s64 offen lds
v_mfma_f32_16x16x32_bf16 v[216:219], a[168:171], a[140:143], v[216:219]
v_mfma_f32_16x16x32_bf16 v[212:215], a[164:167], a[140:143], v[212:215]
v_mfma_f32_16x16x32_bf16 v[208:211], a[160:163], a[140:143], v[208:211]
v_mfma_f32_16x16x32_bf16 v[224:227], a[160:163], a[144:147], v[224:227]
v_mfma_f32_16x16x32_bf16 v[228:231], a[164:167], a[144:147], v[228:231]
v_mfma_f32_16x16x32_bf16 v[232:235], a[168:171], a[144:147], v[232:235]
v_mfma_f32_16x16x32_bf16 v[236:239], a[172:175], a[144:147], v[236:239]
v_mfma_f32_16x16x32_bf16 v[96:99], a[144:147], a[176:179], v[96:99]
v_mfma_f32_16x16x32_bf16 v[104:107], a[144:147], a[180:183], v[104:107]
buffer_load_dwordx4 v6, s[12:15], s64 offen offset:1024 lds
v_mfma_f32_16x16x32_bf16 v[112:115], a[144:147], a[184:187], v[112:115]
v_mfma_f32_16x16x32_bf16 v[120:123], a[144:147], a[188:191], v[120:123]
v_mfma_f32_16x16x32_bf16 v[124:127], a[148:151], a[188:191], v[124:127]
v_mfma_f32_16x16x32_bf16 v[116:119], a[148:151], a[184:187], v[116:119]
v_mfma_f32_16x16x32_bf16 v[108:111], a[148:151], a[180:183], v[108:111]
v_mfma_f32_16x16x32_bf16 v[100:103], a[148:151], a[176:179], v[100:103]
s_add_u32 m0, s73, 2048
s_add_u32 s64, s71, 18432
v_mfma_f32_16x16x32_bf16 v[252:255], a[172:175], a[148:151], v[252:255]
v_mfma_f32_16x16x32_bf16 v[248:251], a[168:171], a[148:151], v[248:251]
buffer_load_dwordx4 v5, s[12:15], s64 offen lds
v_mfma_f32_16x16x32_bf16 v[244:247], a[164:167], a[148:151], v[244:247]
v_mfma_f32_16x16x32_bf16 v[240:243], a[160:163], a[148:151], v[240:243]
v_mfma_f32_16x16x32_bf16 a[0:3], a[160:163], a[152:155], a[0:3]
v_mfma_f32_16x16x32_bf16 a[4:7], a[164:167], a[152:155], a[4:7]
v_mfma_f32_16x16x32_bf16 a[8:11], a[168:171], a[152:155], a[8:11]
v_mfma_f32_16x16x32_bf16 a[12:15], a[172:175], a[152:155], a[12:15]
v_mfma_f32_16x16x32_bf16 v[128:131], a[152:155], a[176:179], v[128:131]
v_mfma_f32_16x16x32_bf16 v[136:139], a[152:155], a[180:183], v[136:139]
buffer_load_dwordx4 v6, s[12:15], s64 offen offset:1024 lds
v_mfma_f32_16x16x32_bf16 v[144:147], a[152:155], a[184:187], v[144:147]
v_mfma_f32_16x16x32_bf16 v[152:155], a[152:155], a[188:191], v[152:155]
v_mfma_f32_16x16x32_bf16 v[156:159], a[156:159], a[188:191], v[156:159]
v_mfma_f32_16x16x32_bf16 v[148:151], a[156:159], a[184:187], v[148:151]
v_mfma_f32_16x16x32_bf16 v[140:143], a[156:159], a[180:183], v[140:143]
v_mfma_f32_16x16x32_bf16 v[132:135], a[156:159], a[176:179], v[132:135]
v_mfma_f32_16x16x32_bf16 a[28:31], a[172:175], a[156:159], a[28:31]
v_mfma_f32_16x16x32_bf16 a[24:27], a[168:171], a[156:159], a[24:27]
v_mfma_f32_16x16x32_bf16 a[20:23], a[164:167], a[156:159], a[20:23]
v_mfma_f32_16x16x32_bf16 a[16:19], a[160:163], a[156:159], a[16:19]
s_waitcnt lgkmcnt(0)
v_mfma_f32_16x16x32_bf16 v[32:35], a[64:67], a[112:115], v[32:35]
s_waitcnt vmcnt(20)
v_mfma_f32_16x16x32_bf16 v[36:39], a[68:71], a[112:115], v[36:39]
s_barrier
v_mfma_f32_16x16x32_bf16 v[40:43], a[64:67], a[116:119], v[40:43]
ds_read_b128 a[128:131], v10 offset:0
ds_read_b128 a[132:135], v10 offset:2048
v_mfma_f32_16x16x32_bf16 v[44:47], a[68:71], a[116:119], v[44:47]
ds_read_b128 a[136:139], v10 offset:4096
ds_read_b128 a[140:143], v10 offset:6144
v_mfma_f32_16x16x32_bf16 v[48:51], a[64:67], a[120:123], v[48:51]
ds_read_b128 a[144:147], v10 offset:8192
ds_read_b128 a[148:151], v10 offset:10240
v_mfma_f32_16x16x32_bf16 v[52:55], a[68:71], a[120:123], v[52:55]
ds_read_b128 a[152:155], v10 offset:12288
ds_read_b128 a[156:159], v10 offset:14336
v_mfma_f32_16x16x32_bf16 v[56:59], a[64:67], a[124:127], v[56:59]
ds_read_b64_tr_b16 a[176:177], v11 offset:57344
ds_read_b64_tr_b16 a[178:179], v11 offset:57856
v_mfma_f32_16x16x32_bf16 v[60:63], a[68:71], a[124:127], v[60:63]
ds_read_b64_tr_b16 a[180:181], v12 offset:57344
ds_read_b64_tr_b16 a[182:183], v12 offset:57856
v_mfma_f32_16x16x32_bf16 v[64:67], a[72:75], a[112:115], v[64:67]
ds_read_b64_tr_b16 a[184:185], v13 offset:57344
ds_read_b64_tr_b16 a[186:187], v13 offset:57856
v_mfma_f32_16x16x32_bf16 v[68:71], a[76:79], a[112:115], v[68:71]
ds_read_b64_tr_b16 a[188:189], v14 offset:57344
ds_read_b64_tr_b16 a[190:191], v14 offset:57856
v_mfma_f32_16x16x32_bf16 v[72:75], a[72:75], a[116:119], v[72:75]
ds_read_b64_tr_b16 a[160:161], v11 offset:49152
ds_read_b64_tr_b16 a[162:163], v11 offset:49664
v_mfma_f32_16x16x32_bf16 v[76:79], a[76:79], a[116:119], v[76:79]
ds_read_b64_tr_b16 a[164:165], v12 offset:49152
ds_read_b64_tr_b16 a[166:167], v12 offset:49664
v_mfma_f32_16x16x32_bf16 v[80:83], a[72:75], a[120:123], v[80:83]
ds_read_b64_tr_b16 a[168:169], v13 offset:49152
ds_read_b64_tr_b16 a[170:171], v13 offset:49664
v_mfma_f32_16x16x32_bf16 v[84:87], a[76:79], a[120:123], v[84:87]
ds_read_b64_tr_b16 a[172:173], v14 offset:49152
ds_read_b64_tr_b16 a[174:175], v14 offset:49664
v_mfma_f32_16x16x32_bf16 v[88:91], a[72:75], a[124:127], v[88:91]
v_mfma_f32_16x16x32_bf16 v[92:95], a[76:79], a[124:127], v[92:95]
s_xor_b32 s75, s93, 1
s_lshl_b32 s76, s75, 19
s_add_u32 s76, s76, s74
v_mfma_f32_16x16x32_bf16 v[96:99], a[80:83], a[112:115], v[96:99]
s_lshl_b32 s79, s75, 13
s_add_u32 s79, s79, s78
v_mfma_f32_16x16x32_bf16 v[100:103], a[84:87], a[112:115], v[100:103]
s_add_u32 m0, s77, 32768
s_add_u32 s64, s76, 0
v_mfma_f32_16x16x32_bf16 v[104:107], a[80:83], a[116:119], v[104:107]
buffer_load_dwordx4 v7, s[20:23], s64 offen lds
v_mfma_f32_16x16x32_bf16 v[108:111], a[84:87], a[116:119], v[108:111]
v_mfma_f32_16x16x32_bf16 v[112:115], a[80:83], a[120:123], v[112:115]
v_mfma_f32_16x16x32_bf16 v[116:119], a[84:87], a[120:123], v[116:119]
v_mfma_f32_16x16x32_bf16 v[120:123], a[80:83], a[124:127], v[120:123]
buffer_load_dwordx4 v8, s[20:23], s64 offen offset:1024 lds
v_mfma_f32_16x16x32_bf16 v[124:127], a[84:87], a[124:127], v[124:127]
v_mfma_f32_16x16x32_bf16 v[128:131], a[88:91], a[112:115], v[128:131]
v_mfma_f32_16x16x32_bf16 v[132:135], a[92:95], a[112:115], v[132:135]
v_add_u32 v9, 32768, v9
v_add_u32 v10, 32768, v10
v_mfma_f32_16x16x32_bf16 v[136:139], a[88:91], a[116:119], v[136:139]
s_lshr_b32 s55, s3, 1
s_lshl_b32 s55, s55, 14
s_lshl_b32 s54, s3, 13
v_mfma_f32_16x16x32_bf16 v[140:143], a[92:95], a[116:119], v[140:143]
s_add_u32 m0, s80, 32768
s_add_u32 s64, s79, 0
s_sub_u32 s55, s54, s55
v_mfma_f32_16x16x32_bf16 v[144:147], a[88:91], a[120:123], v[144:147]
s_and_b32 s54, s3, 1
s_lshl_b32 s54, s54, 12
v_mfma_f32_16x16x32_bf16 v[148:151], a[92:95], a[120:123], v[148:151]
buffer_load_dwordx4 v4, s[24:27], s64 offen sc1 lds
v_mfma_f32_16x16x32_bf16 v[152:155], a[88:91], a[124:127], v[152:155]
v_add_u32 v9, s55, v9
v_add_u32 v10, s55, v10
v_mfma_f32_16x16x32_bf16 v[156:159], a[92:95], a[124:127], v[156:159]
s_waitcnt lgkmcnt(0)
v_subrev_u32 v11, s54, v11
v_subrev_u32 v12, s54, v12
v_mfma_f32_16x16x32_bf16 v[32:35], a[128:131], a[176:179], v[32:35]
v_subrev_u32 v13, s54, v13
v_subrev_u32 v14, s54, v14
v_mfma_f32_16x16x32_bf16 v[36:39], a[132:135], a[176:179], v[36:39]
s_add_u32 m0, s73, 4096
s_add_u32 s64, s72, 0
v_mfma_f32_16x16x32_bf16 v[40:43], a[128:131], a[180:183], v[40:43]
v_mfma_f32_16x16x32_bf16 v[44:47], a[132:135], a[180:183], v[44:47]
buffer_load_dwordx4 v5, s[12:15], s64 offen lds
v_mfma_f32_16x16x32_bf16 v[48:51], a[128:131], a[184:187], v[48:51]
v_mfma_f32_16x16x32_bf16 v[52:55], a[132:135], a[184:187], v[52:55]
v_mfma_f32_16x16x32_bf16 v[56:59], a[128:131], a[188:191], v[56:59]
v_mfma_f32_16x16x32_bf16 v[60:63], a[132:135], a[188:191], v[60:63]
v_mfma_f32_16x16x32_bf16 v[64:67], a[136:139], a[176:179], v[64:67]
v_cvt_pk_bf16_f32 v32, v32, v33
v_cvt_pk_bf16_f32 v33, v34, v35
v_mfma_f32_16x16x32_bf16 v[68:71], a[140:143], a[176:179], v[68:71]
v_cvt_pk_bf16_f32 v34, v36, v37
v_cvt_pk_bf16_f32 v35, v38, v39
v_mfma_f32_16x16x32_bf16 v[72:75], a[136:139], a[180:183], v[72:75]
buffer_load_dwordx4 v6, s[12:15], s64 offen offset:1024 lds
v_mfma_f32_16x16x32_bf16 v[76:79], a[140:143], a[180:183], v[76:79]
v_cvt_pk_bf16_f32 v40, v40, v41
v_cvt_pk_bf16_f32 v41, v42, v43
v_mfma_f32_16x16x32_bf16 v[80:83], a[136:139], a[184:187], v[80:83]
v_cvt_pk_bf16_f32 v42, v44, v45
v_cvt_pk_bf16_f32 v43, v46, v47
v_mfma_f32_16x16x32_bf16 v[84:87], a[140:143], a[184:187], v[84:87]
v_cvt_pk_bf16_f32 v48, v48, v49
v_cvt_pk_bf16_f32 v49, v50, v51
v_mfma_f32_16x16x32_bf16 v[88:91], a[136:139], a[188:191], v[88:91]
s_add_u32 m0, s73, 6144
s_add_u32 s64, s72, 18432
s_add_u32 s53, s88, 0
v_mfma_f32_16x16x32_bf16 v[92:95], a[140:143], a[188:191], v[92:95]
buffer_store_dwordx4 v[32:35], v4, s[24:27], s53 offen offset:0 sc1
v_mfma_f32_16x16x32_bf16 v[96:99], a[144:147], a[176:179], v[96:99]
buffer_load_dwordx4 v5, s[12:15], s64 offen lds
v_mfma_f32_16x16x32_bf16 v[100:103], a[148:151], a[176:179], v[100:103]
v_cvt_pk_bf16_f32 v50, v52, v53
v_cvt_pk_bf16_f32 v51, v54, v55
v_mfma_f32_16x16x32_bf16 v[104:107], a[144:147], a[180:183], v[104:107]
v_cvt_pk_bf16_f32 v56, v56, v57
v_cvt_pk_bf16_f32 v57, v58, v59
v_mfma_f32_16x16x32_bf16 v[108:111], a[148:151], a[180:183], v[108:111]
v_cvt_pk_bf16_f32 v58, v60, v61
v_cvt_pk_bf16_f32 v59, v62, v63
v_mfma_f32_16x16x32_bf16 v[112:115], a[144:147], a[184:187], v[112:115]
v_cvt_pk_bf16_f32 v64, v64, v65
v_cvt_pk_bf16_f32 v65, v66, v67
v_mfma_f32_16x16x32_bf16 v[116:119], a[148:151], a[184:187], v[116:119]
v_cvt_pk_bf16_f32 v66, v68, v69
v_cvt_pk_bf16_f32 v67, v70, v71
v_mfma_f32_16x16x32_bf16 v[120:123], a[144:147], a[188:191], v[120:123]
v_cvt_pk_bf16_f32 v72, v72, v73
v_cvt_pk_bf16_f32 v73, v74, v75
v_mfma_f32_16x16x32_bf16 v[124:127], a[148:151], a[188:191], v[124:127]
buffer_load_dwordx4 v6, s[12:15], s64 offen offset:1024 lds
v_mfma_f32_16x16x32_bf16 v[128:131], a[152:155], a[176:179], v[128:131]
v_cvt_pk_bf16_f32 v74, v76, v77
v_cvt_pk_bf16_f32 v75, v78, v79
v_mfma_f32_16x16x32_bf16 v[132:135], a[156:159], a[176:179], v[132:135]
v_cvt_pk_bf16_f32 v80, v80, v81
v_cvt_pk_bf16_f32 v81, v82, v83
v_mfma_f32_16x16x32_bf16 v[136:139], a[152:155], a[180:183], v[136:139]
v_cvt_pk_bf16_f32 v82, v84, v85
v_cvt_pk_bf16_f32 v83, v86, v87
v_mfma_f32_16x16x32_bf16 v[140:143], a[156:159], a[180:183], v[140:143]
v_cvt_pk_bf16_f32 v88, v88, v89
v_cvt_pk_bf16_f32 v89, v90, v91
v_mfma_f32_16x16x32_bf16 v[144:147], a[152:155], a[184:187], v[144:147]
v_cvt_pk_bf16_f32 v90, v92, v93
v_cvt_pk_bf16_f32 v91, v94, v95
v_mfma_f32_16x16x32_bf16 v[148:151], a[156:159], a[184:187], v[148:151]
v_cvt_pk_bf16_f32 v96, v96, v97
v_cvt_pk_bf16_f32 v97, v98, v99
v_mfma_f32_16x16x32_bf16 v[152:155], a[152:155], a[188:191], v[152:155]
v_cvt_pk_bf16_f32 v98, v100, v101
v_cvt_pk_bf16_f32 v99, v102, v103
v_mfma_f32_16x16x32_bf16 v[156:159], a[156:159], a[188:191], v[156:159]
v_cvt_pk_bf16_f32 v104, v104, v105
v_cvt_pk_bf16_f32 v105, v106, v107
v_mfma_f32_16x16x32_bf16 v[160:163], a[96:99], a[64:67], v[160:163]
s_waitcnt vmcnt(15)
v_cvt_pk_bf16_f32 v106, v108, v109
v_cvt_pk_bf16_f32 v107, v110, v111
v_mfma_f32_16x16x32_bf16 v[160:163], a[160:163], a[128:131], v[160:163]
s_barrier
v_mfma_f32_16x16x32_bf16 v[164:167], a[100:103], a[64:67], v[164:167]
ds_read_b128 a[112:115], v9 offset:0
ds_read_b128 a[116:119], v9 offset:2048
v_mfma_f32_16x16x32_bf16 v[164:167], a[164:167], a[128:131], v[164:167]
s_add_u32 m0, s77, 49152
s_add_u32 s64, s76, 262144
v_cvt_pk_bf16_f32 v112, v112, v113
v_mfma_f32_16x16x32_bf16 v[168:171], a[104:107], a[64:67], v[168:171]
buffer_load_dwordx4 v7, s[20:23], s64 offen lds
v_mfma_f32_16x16x32_bf16 v[168:171], a[168:171], a[128:131], v[168:171]
ds_read_b128 a[120:123], v9 offset:4096
ds_read_b128 a[124:127], v9 offset:6144
v_mfma_f32_16x16x32_bf16 v[172:175], a[108:111], a[64:67], v[172:175]
v_cvt_pk_bf16_f32 v113, v114, v115
v_cvt_pk_bf16_f32 v114, v116, v117
v_mfma_f32_16x16x32_bf16 v[172:175], a[172:175], a[128:131], v[172:175]
ds_read_b64_tr_b16 a[176:177], v11 offset:0
ds_read_b64_tr_b16 a[178:179], v11 offset:512
v_mfma_f32_16x16x32_bf16 v[176:179], a[96:99], a[68:71], v[176:179]
v_cvt_pk_bf16_f32 v115, v118, v119
v_cvt_pk_bf16_f32 v120, v120, v121
v_mfma_f32_16x16x32_bf16 v[176:179], a[160:163], a[132:135], v[176:179]
s_add_u32 s53, s88, 0
ds_read_b64_tr_b16 a[180:181], v12 offset:0
ds_read_b64_tr_b16 a[182:183], v12 offset:512
v_mfma_f32_16x16x32_bf16 v[180:183], a[100:103], a[68:71], v[180:183]
buffer_store_dwordx4 v[40:43], v4, s[24:27], s53 offen offset:1024 sc1
v_mfma_f32_16x16x32_bf16 v[180:183], a[164:167], a[132:135], v[180:183]
ds_read_b64_tr_b16 a[184:185], v13 offset:0
ds_read_b64_tr_b16 a[186:187], v13 offset:512
v_mfma_f32_16x16x32_bf16 v[184:187], a[104:107], a[68:71], v[184:187]
buffer_load_dwordx4 v8, s[20:23], s64 offen offset:1024 lds
v_mfma_f32_16x16x32_bf16 v[184:187], a[168:171], a[132:135], v[184:187]
ds_read_b64_tr_b16 a[188:189], v14 offset:0
ds_read_b64_tr_b16 a[190:191], v14 offset:512
v_mfma_f32_16x16x32_bf16 v[188:191], a[108:111], a[68:71], v[188:191]
ds_read_b64_tr_b16 a[64:65], v11 offset:4096
ds_read_b64_tr_b16 a[66:67], v11 offset:4608
v_mfma_f32_16x16x32_bf16 v[188:191], a[172:175], a[132:135], v[188:191]
ds_read_b64_tr_b16 a[128:129], v12 offset:4096
ds_read_b64_tr_b16 a[130:131], v12 offset:4608
v_mfma_f32_16x16x32_bf16 v[192:195], a[96:99], a[72:75], v[192:195]
ds_read_b64_tr_b16 a[68:69], v13 offset:4096
ds_read_b64_tr_b16 a[70:71], v13 offset:4608
v_mfma_f32_16x16x32_bf16 v[192:195], a[160:163], a[136:139], v[192:195]
ds_read_b64_tr_b16 a[132:133], v14 offset:4096
ds_read_b64_tr_b16 a[134:135], v14 offset:4608
v_mfma_f32_16x16x32_bf16 v[196:199], a[100:103], a[72:75], v[196:199]
s_add_u32 m0, s80, 49152
s_add_u32 s64, s79, 4096
v_cvt_pk_bf16_f32 v121, v122, v123
v_mfma_f32_16x16x32_bf16 v[196:199], a[164:167], a[136:139], v[196:199]
v_cvt_pk_bf16_f32 v122, v124, v125
v_cvt_pk_bf16_f32 v123, v126, v127
v_mfma_f32_16x16x32_bf16 v[200:203], a[104:107], a[72:75], v[200:203]
buffer_load_dwordx4 v4, s[24:27], s64 offen sc1 lds
v_mfma_f32_16x16x32_bf16 v[200:203], a[168:171], a[136:139], v[200:203]
s_xor_b32 s65, s70, 256
s_add_u32 s71, s68, s65
s_add_u32 s72, s69, s65
v_mfma_f32_16x16x32_bf16 v[204:207], a[108:111], a[72:75], v[204:207]
v_cvt_pk_bf16_f32 v128, v128, v129
v_cvt_pk_bf16_f32 v129, v130, v131
v_mfma_f32_16x16x32_bf16 v[204:207], a[172:175], a[136:139], v[204:207]
v_cvt_pk_bf16_f32 v130, v132, v133
v_cvt_pk_bf16_f32 v131, v134, v135
v_mfma_f32_16x16x32_bf16 v[208:211], a[96:99], a[76:79], v[208:211]
ds_read_b128 a[72:75], v4 offset:8192
ds_read_b128 a[136:139], v4 offset:9216
v_mfma_f32_16x16x32_bf16 v[208:211], a[160:163], a[140:143], v[208:211]
v_cvt_pk_bf16_f32 v136, v136, v137
v_cvt_pk_bf16_f32 v137, v138, v139
v_mfma_f32_16x16x32_bf16 v[212:215], a[100:103], a[76:79], v[212:215]
s_add_u32 m0, s73, 32768
s_add_u32 s64, s71, 0
v_cvt_pk_bf16_f32 v138, v140, v141
v_mfma_f32_16x16x32_bf16 v[212:215], a[164:167], a[140:143], v[212:215]
v_cvt_pk_bf16_f32 v139, v142, v143
v_cvt_pk_bf16_f32 v144, v144, v145
v_mfma_f32_16x16x32_bf16 v[216:219], a[104:107], a[76:79], v[216:219]
buffer_load_dwordx4 v5, s[12:15], s64 offen lds
v_mfma_f32_16x16x32_bf16 v[216:219], a[168:171], a[140:143], v[216:219]
v_cvt_pk_bf16_f32 v145, v146, v147
v_cvt_pk_bf16_f32 v146, v148, v149
v_mfma_f32_16x16x32_bf16 v[220:223], a[108:111], a[76:79], v[220:223]
v_cvt_pk_bf16_f32 v147, v150, v151
v_cvt_pk_bf16_f32 v152, v152, v153
v_mfma_f32_16x16x32_bf16 v[220:223], a[172:175], a[140:143], v[220:223]
v_cvt_pk_bf16_f32 v153, v154, v155
v_cvt_pk_bf16_f32 v154, v156, v157
v_mfma_f32_16x16x32_bf16 v[224:227], a[96:99], a[80:83], v[224:227]
ds_read_b128 a[76:79], v4 offset:10240
ds_read_b128 a[140:143], v4 offset:11264
v_mfma_f32_16x16x32_bf16 v[224:227], a[160:163], a[144:147], v[224:227]
v_cvt_pk_bf16_f32 v155, v158, v159
v_mul_f32 v160, s91, v160
v_mfma_f32_16x16x32_bf16 v[228:231], a[100:103], a[80:83], v[228:231]
v_mul_f32 v161, s91, v161
v_mul_f32 v162, s91, v162
v_mfma_f32_16x16x32_bf16 v[228:231], a[164:167], a[144:147], v[228:231]
v_mul_f32 v163, s91, v163
v_mul_f32 v164, s91, v164
v_mfma_f32_16x16x32_bf16 v[232:235], a[104:107], a[80:83], v[232:235]
s_add_u32 s53, s88, 0
v_mul_f32 v165, s91, v165
v_mul_f32 v166, s91, v166
v_mfma_f32_16x16x32_bf16 v[232:235], a[168:171], a[144:147], v[232:235]
buffer_load_dwordx4 v6, s[12:15], s64 offen offset:1024 lds
v_mfma_f32_16x16x32_bf16 v[236:239], a[108:111], a[80:83], v[236:239]
buffer_store_dwordx4 v[48:51], v4, s[24:27], s53 offen offset:2048 sc1
v_mfma_f32_16x16x32_bf16 v[236:239], a[172:175], a[144:147], v[236:239]
v_mul_f32 v167, s91, v167
v_cvt_pk_bf16_f32 v160, v160, v161
v_mfma_f32_16x16x32_bf16 v[240:243], a[96:99], a[84:87], v[240:243]
v_cvt_pk_bf16_f32 v161, v162, v163
v_cvt_pk_bf16_f32 v162, v164, v165
v_mfma_f32_16x16x32_bf16 v[240:243], a[160:163], a[148:151], v[240:243]
v_cvt_pk_bf16_f32 v163, v166, v167
v_mul_f32 v168, s91, v168
v_mfma_f32_16x16x32_bf16 v[244:247], a[100:103], a[84:87], v[244:247]
v_mul_f32 v169, s91, v169
v_mul_f32 v170, s91, v170
v_mfma_f32_16x16x32_bf16 v[244:247], a[164:167], a[148:151], v[244:247]
s_add_u32 m0, s73, 34816
s_add_u32 s64, s71, 18432
v_mul_f32 v171, s91, v171
v_mfma_f32_16x16x32_bf16 v[248:251], a[104:107], a[84:87], v[248:251]
v_mul_f32 v172, s91, v172
v_mul_f32 v173, s91, v173
v_mfma_f32_16x16x32_bf16 v[248:251], a[168:171], a[148:151], v[248:251]
buffer_load_dwordx4 v5, s[12:15], s64 offen lds
v_mfma_f32_16x16x32_bf16 v[252:255], a[108:111], a[84:87], v[252:255]
v_mul_f32 v174, s91, v174
v_mul_f32 v175, s91, v175
v_mfma_f32_16x16x32_bf16 v[252:255], a[172:175], a[148:151], v[252:255]
v_cvt_pk_bf16_f32 v168, v168, v169
v_cvt_pk_bf16_f32 v169, v170, v171
v_mfma_f32_16x16x32_bf16 a[0:3], a[96:99], a[88:91], a[0:3]
v_cvt_pk_bf16_f32 v170, v172, v173
v_cvt_pk_bf16_f32 v171, v174, v175
v_mfma_f32_16x16x32_bf16 a[0:3], a[160:163], a[152:155], a[0:3]
v_mul_f32 v176, s91, v176
v_mul_f32 v177, s91, v177
v_mfma_f32_16x16x32_bf16 a[4:7], a[100:103], a[88:91], a[4:7]
v_mul_f32 v178, s91, v178
v_mul_f32 v179, s91, v179
v_mfma_f32_16x16x32_bf16 a[4:7], a[164:167], a[152:155], a[4:7]
v_mul_f32 v180, s91, v180
v_mul_f32 v181, s91, v181
v_mfma_f32_16x16x32_bf16 a[8:11], a[104:107], a[88:91], a[8:11]
v_mul_f32 v182, s91, v182
v_mul_f32 v183, s91, v183
v_mfma_f32_16x16x32_bf16 a[8:11], a[168:171], a[152:155], a[8:11]
buffer_load_dwordx4 v6, s[12:15], s64 offen offset:1024 lds
v_mfma_f32_16x16x32_bf16 a[12:15], a[108:111], a[88:91], a[12:15]
v_cvt_pk_bf16_f32 v176, v176, v177
v_cvt_pk_bf16_f32 v177, v178, v179
v_mfma_f32_16x16x32_bf16 a[12:15], a[172:175], a[152:155], a[12:15]
v_cvt_pk_bf16_f32 v178, v180, v181
v_cvt_pk_bf16_f32 v179, v182, v183
v_mfma_f32_16x16x32_bf16 a[16:19], a[96:99], a[92:95], a[16:19]
v_mul_f32 v184, s91, v184
v_mul_f32 v185, s91, v185
v_mfma_f32_16x16x32_bf16 a[16:19], a[160:163], a[156:159], a[16:19]
v_mul_f32 v186, s91, v186
v_mul_f32 v187, s91, v187
v_mfma_f32_16x16x32_bf16 a[20:23], a[100:103], a[92:95], a[20:23]
v_mul_f32 v188, s91, v188
v_mul_f32 v189, s91, v189
v_mfma_f32_16x16x32_bf16 a[20:23], a[164:167], a[156:159], a[20:23]
v_mul_f32 v190, s91, v190
v_mul_f32 v191, s91, v191
v_mfma_f32_16x16x32_bf16 a[24:27], a[104:107], a[92:95], a[24:27]
v_cvt_pk_bf16_f32 v184, v184, v185
v_cvt_pk_bf16_f32 v185, v186, v187
v_mfma_f32_16x16x32_bf16 a[24:27], a[168:171], a[156:159], a[24:27]
v_cvt_pk_bf16_f32 v186, v188, v189
v_cvt_pk_bf16_f32 v187, v190, v191
v_mfma_f32_16x16x32_bf16 a[28:31], a[108:111], a[92:95], a[28:31]
v_mul_f32 v192, s91, v192
v_mul_f32 v193, s91, v193
v_mfma_f32_16x16x32_bf16 a[28:31], a[172:175], a[156:159], a[28:31]
s_waitcnt lgkmcnt(0)
s_add_u32 s53, s88, 0
v_mul_f32 v194, s91, v194
v_mfma_f32_16x16x32_bf16 a[32:35], a[176:179], a[112:115], 0
s_waitcnt vmcnt(21)
v_mul_f32 v195, s91, v195
v_mul_f32 v196, s91, v196
v_mfma_f32_16x16x32_bf16 a[36:39], a[176:179], a[116:119], 0
s_barrier
v_mfma_f32_16x16x32_bf16 a[40:43], a[176:179], a[120:123], 0
ds_read_b128 a[96:99], v10 offset:0
ds_read_b128 a[100:103], v10 offset:2048
v_mfma_f32_16x16x32_bf16 a[44:47], a[176:179], a[124:127], 0
s_xor_b32 s75, s93, 2
s_lshl_b32 s76, s75, 19
s_add_u32 s76, s76, s74
v_mfma_f32_16x16x32_bf16 a[48:51], a[180:183], a[124:127], 0
s_lshl_b32 s79, s75, 13
s_add_u32 s79, s79, s78
v_mul_f32 v197, s91, v197
v_mfma_f32_16x16x32_bf16 a[52:55], a[180:183], a[120:123], 0
s_add_u32 m0, s77, 0
s_add_u32 s64, s76, 0
v_mul_f32 v198, s91, v198
v_mfma_f32_16x16x32_bf16 a[56:59], a[180:183], a[116:119], 0
buffer_load_dwordx4 v7, s[20:23], s64 offen lds
v_mfma_f32_16x16x32_bf16 a[60:63], a[180:183], a[112:115], 0
ds_read_b128 a[104:107], v10 offset:4096
ds_read_b128 a[108:111], v10 offset:6144
v_mfma_f32_16x16x32_bf16 a[192:195], a[184:187], a[112:115], 0
buffer_store_dwordx4 v[56:59], v4, s[24:27], s53 offen offset:3072 sc1
v_mfma_f32_16x16x32_bf16 a[196:199], a[184:187], a[116:119], 0
ds_read_b64_tr_b16 a[160:161], v11 offset:16384
ds_read_b64_tr_b16 a[162:163], v11 offset:16896
v_mfma_f32_16x16x32_bf16 a[200:203], a[184:187], a[120:123], 0
buffer_load_dwordx4 v8, s[20:23], s64 offen offset:1024 lds
v_mfma_f32_16x16x32_bf16 a[204:207], a[184:187], a[124:127], 0
ds_read_b64_tr_b16 a[164:165], v12 offset:16384
ds_read_b64_tr_b16 a[166:167], v12 offset:16896
v_mfma_f32_16x16x32_bf16 a[208:211], a[188:191], a[124:127], 0
v_mul_f32 v199, s91, v199
v_cvt_pk_bf16_f32 v192, v192, v193
v_mfma_f32_16x16x32_bf16 a[212:215], a[188:191], a[120:123], 0
ds_read_b64_tr_b16 a[168:169], v13 offset:16384
ds_read_b64_tr_b16 a[170:171], v13 offset:16896
v_mfma_f32_16x16x32_bf16 a[216:219], a[188:191], a[116:119], 0
s_add_u32 m0, s80, 0
s_add_u32 s64, s79, 0
v_cvt_pk_bf16_f32 v193, v194, v195
v_mfma_f32_16x16x32_bf16 a[220:223], a[188:191], a[112:115], 0
ds_read_b64_tr_b16 a[172:173], v14 offset:16384
ds_read_b64_tr_b16 a[174:175], v14 offset:16896
v_mfma_f32_16x16x32_bf16 a[224:227], a[64:67], a[112:115], 0
buffer_load_dwordx4 v4, s[24:27], s64 offen sc1 lds
v_mfma_f32_16x16x32_bf16 a[228:231], a[64:67], a[116:119], 0
ds_read_b64_tr_b16 a[80:81], v11 offset:20480
ds_read_b64_tr_b16 a[82:83], v11 offset:20992
v_mfma_f32_16x16x32_bf16 a[232:235], a[64:67], a[120:123], 0
v_cvt_pk_bf16_f32 v194, v196, v197
v_cvt_pk_bf16_f32 v195, v198, v199
v_mfma_f32_16x16x32_bf16 a[236:239], a[64:67], a[124:127], 0
ds_read_b64_tr_b16 a[144:145], v12 offset:20480
ds_read_b64_tr_b16 a[146:147], v12 offset:20992
v_mfma_f32_16x16x32_bf16 a[240:243], a[128:131], a[124:127], 0
s_add_u32 m0, s73, 36864
s_add_u32 s64, s72, 0
v_mul_f32 v200, s91, v200
v_mfma_f32_16x16x32_bf16 a[244:247], a[128:131], a[120:123], 0
ds_read_b64_tr_b16 a[84:85], v13 offset:20480
ds_read_b64_tr_b16 a[86:87], v13 offset:20992
v_mfma_f32_16x16x32_bf16 a[248:251], a[128:131], a[116:119], 0
buffer_load_dwordx4 v5, s[12:15], s64 offen lds
v_mfma_f32_16x16x32_bf16 v[36:39], a[128:131], a[112:115], 0
ds_read_b64_tr_b16 a[148:149], v14 offset:20480
ds_read_b64_tr_b16 a[150:151], v14 offset:20992
v_mfma_f32_16x16x32_bf16 v[44:47], a[68:71], a[112:115], 0
v_mul_f32 v201, s91, v201
v_mul_f32 v202, s91, v202
v_mfma_f32_16x16x32_bf16 v[32:35], a[68:71], a[116:119], 0
ds_read_b128 a[88:91], v4 offset:24576
ds_read_b128 a[152:155], v4 offset:25600
v_mfma_f32_16x16x32_bf16 v[52:55], a[68:71], a[120:123], 0
s_add_u32 s53, s88, 262144
v_mul_f32 v203, s91, v203
v_mul_f32 v204, s91, v204
v_mfma_f32_16x16x32_bf16 v[60:63], a[68:71], a[124:127], 0
ds_read_b128 a[92:95], v4 offset:26624
ds_read_b128 a[156:159], v4 offset:27648
v_mfma_f32_16x16x32_bf16 v[68:71], a[132:135], a[124:127], 0
buffer_load_dwordx4 v6, s[12:15], s64 offen offset:1024 lds
v_mfma_f32_16x16x32_bf16 v[76:79], a[132:135], a[120:123], 0
buffer_store_dwordx4 v[64:67], v4, s[24:27], s53 offen offset:0 sc1
v_mfma_f32_16x16x32_bf16 v[84:87], a[132:135], a[116:119], 0
v_mul_f32 v205, s91, v205
v_mul_f32 v206, s91, v206
v_mfma_f32_16x16x32_bf16 v[92:95], a[132:135], a[112:115], 0
v_mul_f32 v207, s91, v207
v_cvt_pk_bf16_f32 v200, v200, v201
v_mfma_f32_16x16x32_bf16 v[100:103], a[72:75], a[112:115], 0
s_add_u32 m0, s73, 38912
s_add_u32 s64, s72, 18432
v_cvt_pk_bf16_f32 v201, v202, v203
v_mfma_f32_16x16x32_bf16 v[108:111], a[72:75], a[116:119], 0
v_cvt_pk_bf16_f32 v202, v204, v205
v_cvt_pk_bf16_f32 v203, v206, v207
v_mfma_f32_16x16x32_bf16 v[116:119], a[72:75], a[120:123], 0
buffer_load_dwordx4 v5, s[12:15], s64 offen lds
v_mfma_f32_16x16x32_bf16 v[40:43], a[72:75], a[124:127], 0
v_mul_f32 v208, s91, v208
v_mul_f32 v209, s91, v209
v_mfma_f32_16x16x32_bf16 v[124:127], a[136:139], a[124:127], 0
v_mul_f32 v210, s91, v210
v_mul_f32 v211, s91, v211
v_mfma_f32_16x16x32_bf16 v[132:135], a[136:139], a[120:123], 0
v_mul_f32 v212, s91, v212
v_mul_f32 v213, s91, v213
v_mfma_f32_16x16x32_bf16 v[140:143], a[136:139], a[116:119], 0
v_mul_f32 v214, s91, v214
v_mul_f32 v215, s91, v215
v_mfma_f32_16x16x32_bf16 v[148:151], a[136:139], a[112:115], 0
v_cvt_pk_bf16_f32 v208, v208, v209
v_cvt_pk_bf16_f32 v209, v210, v211
v_mfma_f32_16x16x32_bf16 v[156:159], a[76:79], a[112:115], 0
buffer_load_dwordx4 v6, s[12:15], s64 offen offset:1024 lds
v_mfma_f32_16x16x32_bf16 v[48:51], a[76:79], a[116:119], 0
v_add_u32 v9, -65536, v9
v_add_u32 v10, -65536, v10
v_mfma_f32_16x16x32_bf16 v[164:167], a[76:79], a[120:123], 0
v_cvt_pk_bf16_f32 v210, v212, v213
v_cvt_pk_bf16_f32 v211, v214, v215
v_mfma_f32_16x16x32_bf16 v[172:175], a[76:79], a[124:127], 0
v_mul_f32 v216, s91, v216
v_mul_f32 v217, s91, v217
v_mfma_f32_16x16x32_bf16 v[180:183], a[140:143], a[124:127], 0
v_mul_f32 v218, s91, v218
v_mul_f32 v219, s91, v219
v_mfma_f32_16x16x32_bf16 v[188:191], a[140:143], a[120:123], 0
v_mul_f32 v220, s91, v220
v_mul_f32 v221, s91, v221
v_mfma_f32_16x16x32_bf16 v[56:59], a[140:143], a[116:119], 0
v_mul_f32 v222, s91, v222
v_mul_f32 v223, s91, v223
v_mfma_f32_16x16x32_bf16 v[196:199], a[140:143], a[112:115], 0
s_waitcnt lgkmcnt(0)
v_cvt_pk_bf16_f32 v216, v216, v217
v_cvt_pk_bf16_f32 v217, v218, v219
v_mfma_f32_16x16x32_bf16 a[32:35], a[160:163], a[96:99], a[32:35]
s_waitcnt vmcnt(18)
v_cvt_pk_bf16_f32 v218, v220, v221
v_cvt_pk_bf16_f32 v219, v222, v223
v_mfma_f32_16x16x32_bf16 a[36:39], a[160:163], a[100:103], a[36:39]
s_barrier
v_mfma_f32_16x16x32_bf16 a[40:43], a[160:163], a[104:107], a[40:43]
ds_read_b128 a[112:115], v9 offset:0
ds_read_b128 a[116:119], v9 offset:2048
v_mfma_f32_16x16x32_bf16 a[44:47], a[160:163], a[108:111], a[44:47]
s_add_u32 m0, s77, 16384
s_add_u32 s64, s76, 262144
v_mul_f32 v224, s91, v224
v_mfma_f32_16x16x32_bf16 a[48:51], a[164:167], a[108:111], a[48:51]
buffer_load_dwordx4 v7, s[20:23], s64 offen lds
v_mfma_f32_16x16x32_bf16 a[52:55], a[164:167], a[104:107], a[52:55]
s_add_u32 s53, s88, 262144
ds_read_b128 a[120:123], v9 offset:4096
ds_read_b128 a[124:127], v9 offset:6144
v_mfma_f32_16x16x32_bf16 a[56:59], a[164:167], a[100:103], a[56:59]
buffer_store_dwordx4 v[72:75], v4, s[24:27], s53 offen offset:1024 sc1
v_mfma_f32_16x16x32_bf16 a[60:63], a[164:167], a[96:99], a[60:63]
ds_read_b64_tr_b16 a[176:177], v11 offset:32768
ds_read_b64_tr_b16 a[178:179], v11 offset:33280
v_mfma_f32_16x16x32_bf16 a[192:195], a[168:171], a[96:99], a[192:195]
v_mul_f32 v225, s91, v225
v_mul_f32 v226, s91, v226
v_mfma_f32_16x16x32_bf16 a[196:199], a[168:171], a[100:103], a[196:199]
ds_read_b64_tr_b16 a[180:181], v12 offset:32768
ds_read_b64_tr_b16 a[182:183], v12 offset:33280
v_mfma_f32_16x16x32_bf16 a[200:203], a[168:171], a[104:107], a[200:203]
buffer_load_dwordx4 v8, s[20:23], s64 offen offset:1024 lds
v_mfma_f32_16x16x32_bf16 a[204:207], a[168:171], a[108:111], a[204:207]
ds_read_b64_tr_b16 a[184:185], v13 offset:32768
ds_read_b64_tr_b16 a[186:187], v13 offset:33280
v_mfma_f32_16x16x32_bf16 a[208:211], a[172:175], a[108:111], a[208:211]
v_mul_f32 v227, s91, v227
v_mul_f32 v228, s91, v228
v_mfma_f32_16x16x32_bf16 a[212:215], a[172:175], a[104:107], a[212:215]
ds_read_b64_tr_b16 a[188:189], v14 offset:32768
ds_read_b64_tr_b16 a[190:191], v14 offset:33280
v_mfma_f32_16x16x32_bf16 a[216:219], a[172:175], a[100:103], a[216:219]
s_add_u32 m0, s80, 16384
s_add_u32 s64, s79, 4096
v_mul_f32 v229, s91, v229
v_mfma_f32_16x16x32_bf16 a[220:223], a[172:175], a[96:99], a[220:223]
ds_read_b64_tr_b16 a[64:65], v11 offset:36864
ds_read_b64_tr_b16 a[66:67], v11 offset:37376
v_mfma_f32_16x16x32_bf16 a[224:227], a[80:83], a[96:99], a[224:227]
buffer_load_dwordx4 v4, s[24:27], s64 offen sc1 lds
v_mfma_f32_16x16x32_bf16 a[228:231], a[80:83], a[100:103], a[228:231]
s_xor_b32 s65, s70, 384
s_add_u32 s71, s68, s65
s_add_u32 s72, s69, s65
v_mfma_f32_16x16x32_bf16 a[232:235], a[80:83], a[104:107], a[232:235]
ds_read_b64_tr_b16 a[128:129], v12 offset:36864
ds_read_b64_tr_b16 a[130:131], v12 offset:37376
v_mfma_f32_16x16x32_bf16 a[236:239], a[80:83], a[108:111], a[236:239]
v_mul_f32 v230, s91, v230
v_mul_f32 v231, s91, v231
v_mfma_f32_16x16x32_bf16 a[240:243], a[144:147], a[108:111], a[240:243]
s_add_u32 m0, s73, 65536
s_add_u32 s64, s71, 0
v_cvt_pk_bf16_f32 v224, v224, v225
v_mfma_f32_16x16x32_bf16 a[244:247], a[144:147], a[104:107], a[244:247]
ds_read_b64_tr_b16 a[68:69], v13 offset:36864
ds_read_b64_tr_b16 a[70:71], v13 offset:37376
v_mfma_f32_16x16x32_bf16 a[248:251], a[144:147], a[100:103], a[248:251]
buffer_load_dwordx4 v5, s[12:15], s64 offen lds
v_mfma_f32_16x16x32_bf16 v[36:39], a[144:147], a[96:99], v[36:39]
ds_read_b64_tr_b16 a[132:133], v14 offset:36864
ds_read_b64_tr_b16 a[134:135], v14 offset:37376
v_mfma_f32_16x16x32_bf16 v[44:47], a[84:87], a[96:99], v[44:47]
v_cvt_pk_bf16_f32 v225, v226, v227
v_cvt_pk_bf16_f32 v226, v228, v229
v_mfma_f32_16x16x32_bf16 v[32:35], a[84:87], a[100:103], v[32:35]
ds_read_b128 a[72:75], v4 offset:40960
ds_read_b128 a[136:139], v4 offset:41984
v_mfma_f32_16x16x32_bf16 v[52:55], a[84:87], a[104:107], v[52:55]
v_cvt_pk_bf16_f32 v227, v230, v231
v_mul_f32 v232, s91, v232
v_mfma_f32_16x16x32_bf16 v[60:63], a[84:87], a[108:111], v[60:63]
ds_read_b128 a[76:79], v4 offset:43008
ds_read_b128 a[140:143], v4 offset:44032
v_mfma_f32_16x16x32_bf16 v[68:71], a[148:151], a[108:111], v[68:71]
buffer_load_dwordx4 v6, s[12:15], s64 offen offset:1024 lds
v_mfma_f32_16x16x32_bf16 v[76:79], a[148:151], a[104:107], v[76:79]
v_mul_f32 v233, s91, v233
v_mul_f32 v234, s91, v234
v_mfma_f32_16x16x32_bf16 v[84:87], a[148:151], a[100:103], v[84:87]
v_mul_f32 v235, s91, v235
v_mul_f32 v236, s91, v236
v_mfma_f32_16x16x32_bf16 v[92:95], a[148:151], a[96:99], v[92:95]
v_mul_f32 v237, s91, v237
v_mul_f32 v238, s91, v238
v_mfma_f32_16x16x32_bf16 v[100:103], a[88:91], a[96:99], v[100:103]
s_add_u32 m0, s73, 67584
s_add_u32 s64, s71, 18432
s_add_u32 s53, s88, 262144
v_mfma_f32_16x16x32_bf16 v[108:111], a[88:91], a[100:103], v[108:111]
buffer_store_dwordx4 v[80:83], v4, s[24:27], s53 offen offset:2048 sc1
v_mfma_f32_16x16x32_bf16 v[116:119], a[88:91], a[104:107], v[116:119]
buffer_load_dwordx4 v5, s[12:15], s64 offen lds
v_mfma_f32_16x16x32_bf16 v[40:43], a[88:91], a[108:111], v[40:43]
v_mul_f32 v239, s91, v239
v_cvt_pk_bf16_f32 v232, v232, v233
v_mfma_f32_16x16x32_bf16 v[124:127], a[152:155], a[108:111], v[124:127]
v_cvt_pk_bf16_f32 v233, v234, v235
v_cvt_pk_bf16_f32 v234, v236, v237
v_mfma_f32_16x16x32_bf16 v[132:135], a[152:155], a[104:107], v[132:135]
v_cvt_pk_bf16_f32 v235, v238, v239
v_mul_f32 v240, s91, v240
v_mfma_f32_16x16x32_bf16 v[140:143], a[152:155], a[100:103], v[140:143]
v_mul_f32 v241, s91, v241
v_mul_f32 v242, s91, v242
v_mfma_f32_16x16x32_bf16 v[148:151], a[152:155], a[96:99], v[148:151]
v_mul_f32 v243, s91, v243
v_mul_f32 v244, s91, v244
v_mfma_f32_16x16x32_bf16 v[156:159], a[92:95], a[96:99], v[156:159]
buffer_load_dwordx4 v6, s[12:15], s64 offen offset:1024 lds
v_mfma_f32_16x16x32_bf16 v[48:51], a[92:95], a[100:103], v[48:51]
v_mul_f32 v245, s91, v245
v_mul_f32 v246, s91, v246
v_mfma_f32_16x16x32_bf16 v[164:167], a[92:95], a[104:107], v[164:167]
v_mul_f32 v247, s91, v247
v_cvt_pk_bf16_f32 v240, v240, v241
v_mfma_f32_16x16x32_bf16 v[172:175], a[92:95], a[108:111], v[172:175]
v_cvt_pk_bf16_f32 v241, v242, v243
v_cvt_pk_bf16_f32 v242, v244, v245
v_mfma_f32_16x16x32_bf16 v[180:183], a[156:159], a[108:111], v[180:183]
v_cvt_pk_bf16_f32 v243, v246, v247
v_mul_f32 v248, s91, v248
v_mfma_f32_16x16x32_bf16 v[188:191], a[156:159], a[104:107], v[188:191]
v_mul_f32 v249, s91, v249
v_mul_f32 v250, s91, v250
v_mfma_f32_16x16x32_bf16 v[56:59], a[156:159], a[100:103], v[56:59]
v_mul_f32 v251, s91, v251
v_mul_f32 v252, s91, v252
v_mfma_f32_16x16x32_bf16 v[196:199], a[156:159], a[96:99], v[196:199]
s_waitcnt lgkmcnt(0)
v_mul_f32 v253, s91, v253
v_mul_f32 v254, s91, v254
v_mfma_f32_16x16x32_bf16 a[32:35], a[176:179], a[112:115], a[32:35]
s_waitcnt vmcnt(23)
v_mul_f32 v255, s91, v255
v_cvt_pk_bf16_f32 v248, v248, v249
v_mfma_f32_16x16x32_bf16 a[36:39], a[176:179], a[116:119], a[36:39]
s_barrier
v_mfma_f32_16x16x32_bf16 a[40:43], a[176:179], a[120:123], a[40:43]
ds_read_b128 a[96:99], v10 offset:0
ds_read_b128 a[100:103], v10 offset:2048
v_mfma_f32_16x16x32_bf16 a[44:47], a[176:179], a[124:127], a[44:47]
s_xor_b32 s75, s93, 3
s_lshl_b32 s76, s75, 19
s_add_u32 s76, s76, s74
v_mfma_f32_16x16x32_bf16 a[48:51], a[180:183], a[124:127], a[48:51]
s_lshl_b32 s79, s75, 13
s_add_u32 s79, s79, s78
v_cvt_pk_bf16_f32 v249, v250, v251
v_mfma_f32_16x16x32_bf16 a[52:55], a[180:183], a[120:123], a[52:55]
s_add_u32 m0, s77, 32768
s_add_u32 s64, s76, 0
v_cvt_pk_bf16_f32 v250, v252, v253
v_mfma_f32_16x16x32_bf16 a[56:59], a[180:183], a[116:119], a[56:59]
buffer_load_dwordx4 v7, s[20:23], s64 offen lds
v_mfma_f32_16x16x32_bf16 a[60:63], a[180:183], a[112:115], a[60:63]
ds_read_b128 a[104:107], v10 offset:4096
ds_read_b128 a[108:111], v10 offset:6144
v_mfma_f32_16x16x32_bf16 a[192:195], a[184:187], a[112:115], a[192:195]
v_cvt_pk_bf16_f32 v251, v254, v255
v_accvgpr_read_b32 v16, a0
v_mfma_f32_16x16x32_bf16 a[196:199], a[184:187], a[116:119], a[196:199]
ds_read_b64_tr_b16 a[160:161], v11 offset:49152
ds_read_b64_tr_b16 a[162:163], v11 offset:49664
v_mfma_f32_16x16x32_bf16 a[200:203], a[184:187], a[120:123], a[200:203]
buffer_load_dwordx4 v8, s[20:23], s64 offen offset:1024 lds
v_mfma_f32_16x16x32_bf16 a[204:207], a[184:187], a[124:127], a[204:207]
s_add_u32 s53, s88, 262144
ds_read_b64_tr_b16 a[164:165], v12 offset:49152
ds_read_b64_tr_b16 a[166:167], v12 offset:49664
v_mfma_f32_16x16x32_bf16 a[208:211], a[188:191], a[124:127], a[208:211]
buffer_store_dwordx4 v[88:91], v4, s[24:27], s53 offen offset:3072 sc1
v_mfma_f32_16x16x32_bf16 a[212:215], a[188:191], a[120:123], a[212:215]
ds_read_b64_tr_b16 a[168:169], v13 offset:49152
ds_read_b64_tr_b16 a[170:171], v13 offset:49664
v_mfma_f32_16x16x32_bf16 a[216:219], a[188:191], a[116:119], a[216:219]
s_add_u32 m0, s80, 32768
s_add_u32 s64, s79, 0
v_accvgpr_read_b32 v17, a1
v_mfma_f32_16x16x32_bf16 a[220:223], a[188:191], a[112:115], a[220:223]
ds_read_b64_tr_b16 a[172:173], v14 offset:49152
ds_read_b64_tr_b16 a[174:175], v14 offset:49664
v_mfma_f32_16x16x32_bf16 a[224:227], a[64:67], a[112:115], a[224:227]
buffer_load_dwordx4 v4, s[24:27], s64 offen sc1 lds
v_mfma_f32_16x16x32_bf16 a[228:231], a[64:67], a[116:119], a[228:231]
ds_read_b64_tr_b16 a[80:81], v11 offset:53248
ds_read_b64_tr_b16 a[82:83], v11 offset:53760
v_mfma_f32_16x16x32_bf16 a[232:235], a[64:67], a[120:123], a[232:235]
v_accvgpr_read_b32 v18, a2
v_accvgpr_read_b32 v19, a3
v_mfma_f32_16x16x32_bf16 a[236:239], a[64:67], a[124:127], a[236:239]
ds_read_b64_tr_b16 a[144:145], v12 offset:53248
ds_read_b64_tr_b16 a[146:147], v12 offset:53760
v_mfma_f32_16x16x32_bf16 a[240:243], a[128:131], a[124:127], a[240:243]
s_add_u32 m0, s73, 69632
s_add_u32 s64, s72, 0
v_accvgpr_read_b32 v20, a4
v_mfma_f32_16x16x32_bf16 a[244:247], a[128:131], a[120:123], a[244:247]
ds_read_b64_tr_b16 a[84:85], v13 offset:53248
ds_read_b64_tr_b16 a[86:87], v13 offset:53760
v_mfma_f32_16x16x32_bf16 a[248:251], a[128:131], a[116:119], a[248:251]
buffer_load_dwordx4 v5, s[12:15], s64 offen lds
v_mfma_f32_16x16x32_bf16 v[36:39], a[128:131], a[112:115], v[36:39]
ds_read_b64_tr_b16 a[148:149], v14 offset:53248
ds_read_b64_tr_b16 a[150:151], v14 offset:53760
v_mfma_f32_16x16x32_bf16 v[44:47], a[68:71], a[112:115], v[44:47]
v_accvgpr_read_b32 v21, a5
v_accvgpr_read_b32 v22, a6
v_mfma_f32_16x16x32_bf16 v[32:35], a[68:71], a[116:119], v[32:35]
ds_read_b128 a[88:91], v4 offset:57344
ds_read_b128 a[152:155], v4 offset:58368
v_mfma_f32_16x16x32_bf16 v[52:55], a[68:71], a[120:123], v[52:55]
v_accvgpr_read_b32 v23, a7
v_mul_f32 v16, s91, v16
v_mfma_f32_16x16x32_bf16 v[60:63], a[68:71], a[124:127], v[60:63]
ds_read_b128 a[92:95], v4 offset:59392
ds_read_b128 a[156:159], v4 offset:60416
v_mfma_f32_16x16x32_bf16 v[68:71], a[132:135], a[124:127], v[68:71]
buffer_load_dwordx4 v6, s[12:15], s64 offen offset:1024 lds
v_mfma_f32_16x16x32_bf16 v[76:79], a[132:135], a[120:123], v[76:79]
v_mul_f32 v17, s91, v17
v_mul_f32 v18, s91, v18
v_mfma_f32_16x16x32_bf16 v[84:87], a[132:135], a[116:119], v[84:87]
v_mul_f32 v19, s91, v19
v_mul_f32 v20, s91, v20
v_mfma_f32_16x16x32_bf16 v[92:95], a[132:135], a[112:115], v[92:95]
v_mul_f32 v21, s91, v21
v_mul_f32 v22, s91, v22
v_mfma_f32_16x16x32_bf16 v[100:103], a[72:75], a[112:115], v[100:103]
s_add_u32 m0, s73, 71680
s_add_u32 s64, s72, 18432
v_mul_f32 v23, s91, v23
v_mfma_f32_16x16x32_bf16 v[108:111], a[72:75], a[116:119], v[108:111]
v_cvt_pk_bf16_f32 v16, v16, v17
v_cvt_pk_bf16_f32 v17, v18, v19
v_mfma_f32_16x16x32_bf16 v[116:119], a[72:75], a[120:123], v[116:119]
buffer_load_dwordx4 v5, s[12:15], s64 offen lds
v_mfma_f32_16x16x32_bf16 v[40:43], a[72:75], a[124:127], v[40:43]
v_cvt_pk_bf16_f32 v18, v20, v21
v_cvt_pk_bf16_f32 v19, v22, v23
v_mfma_f32_16x16x32_bf16 v[124:127], a[136:139], a[124:127], v[124:127]
v_accvgpr_write_b32 a0, v16
v_accvgpr_write_b32 a1, v17
v_mfma_f32_16x16x32_bf16 v[132:135], a[136:139], a[120:123], v[132:135]
v_accvgpr_write_b32 a2, v18
v_accvgpr_write_b32 a3, v19
v_mfma_f32_16x16x32_bf16 v[140:143], a[136:139], a[116:119], v[140:143]
s_add_u32 s53, s87, 0
v_accvgpr_read_b32 v16, a8
v_accvgpr_read_b32 v17, a9
v_mfma_f32_16x16x32_bf16 v[148:151], a[136:139], a[112:115], v[148:151]
buffer_store_dwordx4 v[160:163], v4, s[24:27], s53 offen offset:0 sc1
v_mfma_f32_16x16x32_bf16 v[156:159], a[76:79], a[112:115], v[156:159]
buffer_load_dwordx4 v6, s[12:15], s64 offen offset:1024 lds
v_mfma_f32_16x16x32_bf16 v[48:51], a[76:79], a[116:119], v[48:51]
v_add_u32 v9, 32768, v9
v_add_u32 v10, 32768, v10
v_mfma_f32_16x16x32_bf16 v[164:167], a[76:79], a[120:123], v[164:167]
v_accvgpr_read_b32 v18, a10
v_accvgpr_read_b32 v19, a11
v_mfma_f32_16x16x32_bf16 v[172:175], a[76:79], a[124:127], v[172:175]
v_accvgpr_read_b32 v20, a12
v_accvgpr_read_b32 v21, a13
v_mfma_f32_16x16x32_bf16 v[180:183], a[140:143], a[124:127], v[180:183]
v_accvgpr_read_b32 v22, a14
v_accvgpr_read_b32 v23, a15
v_mfma_f32_16x16x32_bf16 v[188:191], a[140:143], a[120:123], v[188:191]
v_mul_f32 v16, s91, v16
v_mul_f32 v17, s91, v17
v_mfma_f32_16x16x32_bf16 v[56:59], a[140:143], a[116:119], v[56:59]
v_mul_f32 v18, s91, v18
v_mul_f32 v19, s91, v19
v_mfma_f32_16x16x32_bf16 v[196:199], a[140:143], a[112:115], v[196:199]
s_waitcnt lgkmcnt(0)
v_mul_f32 v20, s91, v20
v_mul_f32 v21, s91, v21
v_mfma_f32_16x16x32_bf16 a[32:35], a[160:163], a[96:99], a[32:35]
s_waitcnt vmcnt(18)
v_mul_f32 v22, s91, v22
v_mul_f32 v23, s91, v23
v_mfma_f32_16x16x32_bf16 a[36:39], a[160:163], a[100:103], a[36:39]
s_barrier
v_mfma_f32_16x16x32_bf16 a[40:43], a[160:163], a[104:107], a[40:43]
ds_read_b128 a[112:115], v9 offset:0
ds_read_b128 a[116:119], v9 offset:2048
v_mfma_f32_16x16x32_bf16 a[44:47], a[160:163], a[108:111], a[44:47]
s_add_u32 m0, s77, 49152
s_add_u32 s64, s76, 262144
v_cvt_pk_bf16_f32 v16, v16, v17
v_mfma_f32_16x16x32_bf16 a[48:51], a[164:167], a[108:111], a[48:51]
buffer_load_dwordx4 v7, s[20:23], s64 offen lds
v_mfma_f32_16x16x32_bf16 a[52:55], a[164:167], a[104:107], a[52:55]
ds_read_b128 a[120:123], v9 offset:4096
ds_read_b128 a[124:127], v9 offset:6144
v_mfma_f32_16x16x32_bf16 a[56:59], a[164:167], a[100:103], a[56:59]
v_cvt_pk_bf16_f32 v17, v18, v19
v_cvt_pk_bf16_f32 v18, v20, v21
v_mfma_f32_16x16x32_bf16 a[60:63], a[164:167], a[96:99], a[60:63]
ds_read_b64_tr_b16 a[176:177], v11 offset:0
ds_read_b64_tr_b16 a[178:179], v11 offset:512
v_mfma_f32_16x16x32_bf16 a[192:195], a[168:171], a[96:99], a[192:195]
v_cvt_pk_bf16_f32 v19, v22, v23
v_accvgpr_write_b32 a8, v16
v_mfma_f32_16x16x32_bf16 a[196:199], a[168:171], a[100:103], a[196:199]
ds_read_b64_tr_b16 a[180:181], v12 offset:0
ds_read_b64_tr_b16 a[182:183], v12 offset:512
v_mfma_f32_16x16x32_bf16 a[200:203], a[168:171], a[104:107], a[200:203]
buffer_load_dwordx4 v8, s[20:23], s64 offen offset:1024 lds
v_mfma_f32_16x16x32_bf16 a[204:207], a[168:171], a[108:111], a[204:207]
ds_read_b64_tr_b16 a[184:185], v13 offset:0
ds_read_b64_tr_b16 a[186:187], v13 offset:512
v_mfma_f32_16x16x32_bf16 a[208:211], a[172:175], a[108:111], a[208:211]
v_accvgpr_write_b32 a9, v17
v_accvgpr_write_b32 a10, v18
v_mfma_f32_16x16x32_bf16 a[212:215], a[172:175], a[104:107], a[212:215]
ds_read_b64_tr_b16 a[188:189], v14 offset:0
ds_read_b64_tr_b16 a[190:191], v14 offset:512
v_mfma_f32_16x16x32_bf16 a[216:219], a[172:175], a[100:103], a[216:219]
s_add_u32 m0, s80, 49152
s_add_u32 s64, s79, 4096
v_accvgpr_write_b32 a11, v19
v_mfma_f32_16x16x32_bf16 a[220:223], a[172:175], a[96:99], a[220:223]
ds_read_b64_tr_b16 a[64:65], v11 offset:4096
ds_read_b64_tr_b16 a[66:67], v11 offset:4608
v_mfma_f32_16x16x32_bf16 a[224:227], a[80:83], a[96:99], a[224:227]
buffer_load_dwordx4 v4, s[24:27], s64 offen sc1 lds
v_mfma_f32_16x16x32_bf16 a[228:231], a[80:83], a[100:103], a[228:231]
s_xor_b32 s65, s70, 512
s_add_u32 s71, s68, s65
s_add_u32 s72, s69, s65
v_mfma_f32_16x16x32_bf16 a[232:235], a[80:83], a[104:107], a[232:235]
s_add_u32 s53, s87, 0
ds_read_b64_tr_b16 a[128:129], v12 offset:4096
ds_read_b64_tr_b16 a[130:131], v12 offset:4608
v_mfma_f32_16x16x32_bf16 a[236:239], a[80:83], a[108:111], a[236:239]
buffer_store_dwordx4 v[168:171], v4, s[24:27], s53 offen offset:1024 sc1
v_mfma_f32_16x16x32_bf16 a[240:243], a[144:147], a[108:111], a[240:243]
s_add_u32 m0, s73, 0
s_add_u32 s64, s71, 0
v_accvgpr_read_b32 v16, a16
v_mfma_f32_16x16x32_bf16 a[244:247], a[144:147], a[104:107], a[244:247]
ds_read_b64_tr_b16 a[68:69], v13 offset:4096
ds_read_b64_tr_b16 a[70:71], v13 offset:4608
v_mfma_f32_16x16x32_bf16 a[248:251], a[144:147], a[100:103], a[248:251]
buffer_load_dwordx4 v5, s[12:15], s64 offen lds
v_mfma_f32_16x16x32_bf16 v[36:39], a[144:147], a[96:99], v[36:39]
ds_read_b64_tr_b16 a[132:133], v14 offset:4096
ds_read_b64_tr_b16 a[134:135], v14 offset:4608
v_mfma_f32_16x16x32_bf16 v[44:47], a[84:87], a[96:99], v[44:47]
v_accvgpr_read_b32 v17, a17
v_accvgpr_read_b32 v18, a18
v_mfma_f32_16x16x32_bf16 v[32:35], a[84:87], a[100:103], v[32:35]
ds_read_b128 a[72:75], v4 offset:8192
ds_read_b128 a[136:139], v4 offset:9216
v_mfma_f32_16x16x32_bf16 v[52:55], a[84:87], a[104:107], v[52:55]
v_accvgpr_read_b32 v19, a19
v_accvgpr_read_b32 v20, a20
v_mfma_f32_16x16x32_bf16 v[60:63], a[84:87], a[108:111], v[60:63]
ds_read_b128 a[76:79], v4 offset:10240
ds_read_b128 a[140:143], v4 offset:11264
v_mfma_f32_16x16x32_bf16 v[68:71], a[148:151], a[108:111], v[68:71]
buffer_load_dwordx4 v6, s[12:15], s64 offen offset:1024 lds
v_mfma_f32_16x16x32_bf16 v[76:79], a[148:151], a[104:107], v[76:79]
v_accvgpr_read_b32 v21, a21
v_accvgpr_read_b32 v22, a22
v_mfma_f32_16x16x32_bf16 v[84:87], a[148:151], a[100:103], v[84:87]
v_accvgpr_read_b32 v23, a23
v_mul_f32 v16, s91, v16
v_mfma_f32_16x16x32_bf16 v[92:95], a[148:151], a[96:99], v[92:95]
v_mul_f32 v17, s91, v17
v_mul_f32 v18, s91, v18
v_mfma_f32_16x16x32_bf16 v[100:103], a[88:91], a[96:99], v[100:103]
s_add_u32 m0, s73, 2048
s_add_u32 s64, s71, 18432
v_mul_f32 v19, s91, v19
v_mfma_f32_16x16x32_bf16 v[108:111], a[88:91], a[100:103], v[108:111]
v_mul_f32 v20, s91, v20
v_mul_f32 v21, s91, v21
v_mfma_f32_16x16x32_bf16 v[116:119], a[88:91], a[104:107], v[116:119]
buffer_load_dwordx4 v5, s[12:15], s64 offen lds
v_mfma_f32_16x16x32_bf16 v[40:43], a[88:91], a[108:111], v[40:43]
v_mul_f32 v22, s91, v22
v_mul_f32 v23, s91, v23
v_mfma_f32_16x16x32_bf16 v[124:127], a[152:155], a[108:111], v[124:127]
v_cvt_pk_bf16_f32 v16, v16, v17
v_cvt_pk_bf16_f32 v17, v18, v19
v_mfma_f32_16x16x32_bf16 v[132:135], a[152:155], a[104:107], v[132:135]
v_cvt_pk_bf16_f32 v18, v20, v21
v_cvt_pk_bf16_f32 v19, v22, v23
v_mfma_f32_16x16x32_bf16 v[140:143], a[152:155], a[100:103], v[140:143]
v_accvgpr_write_b32 a16, v16
v_accvgpr_write_b32 a17, v17
v_mfma_f32_16x16x32_bf16 v[148:151], a[152:155], a[96:99], v[148:151]
v_accvgpr_write_b32 a18, v18
v_accvgpr_write_b32 a19, v19
v_mfma_f32_16x16x32_bf16 v[156:159], a[92:95], a[96:99], v[156:159]
buffer_load_dwordx4 v6, s[12:15], s64 offen offset:1024 lds
v_mfma_f32_16x16x32_bf16 v[48:51], a[92:95], a[100:103], v[48:51]
v_accvgpr_read_b32 v16, a24
v_accvgpr_read_b32 v17, a25
v_mfma_f32_16x16x32_bf16 v[164:167], a[92:95], a[104:107], v[164:167]
v_accvgpr_read_b32 v18, a26
v_accvgpr_read_b32 v19, a27
v_mfma_f32_16x16x32_bf16 v[172:175], a[92:95], a[108:111], v[172:175]
v_accvgpr_read_b32 v20, a28
v_accvgpr_read_b32 v21, a29
v_mfma_f32_16x16x32_bf16 v[180:183], a[156:159], a[108:111], v[180:183]
s_add_u32 s53, s87, 4096
v_accvgpr_read_b32 v22, a30
v_accvgpr_read_b32 v23, a31
v_mfma_f32_16x16x32_bf16 v[188:191], a[156:159], a[104:107], v[188:191]
buffer_store_dwordx4 v[176:179], v4, s[24:27], s53 offen offset:0 sc1
v_mfma_f32_16x16x32_bf16 v[56:59], a[156:159], a[100:103], v[56:59]
v_mul_f32 v16, s91, v16
v_mul_f32 v17, s91, v17
v_mfma_f32_16x16x32_bf16 v[196:199], a[156:159], a[96:99], v[196:199]
s_waitcnt lgkmcnt(0)
v_mul_f32 v18, s91, v18
v_mul_f32 v19, s91, v19
v_mfma_f32_16x16x32_bf16 a[32:35], a[176:179], a[112:115], a[32:35]
s_waitcnt vmcnt(23)
v_mul_f32 v20, s91, v20
v_mul_f32 v21, s91, v21
v_mfma_f32_16x16x32_bf16 a[36:39], a[176:179], a[116:119], a[36:39]
s_barrier
v_mfma_f32_16x16x32_bf16 a[40:43], a[176:179], a[120:123], a[40:43]
ds_read_b128 a[96:99], v10 offset:0
ds_read_b128 a[100:103], v10 offset:2048
v_mfma_f32_16x16x32_bf16 a[44:47], a[176:179], a[124:127], a[44:47]
s_xor_b32 s75, s93, 4
s_lshl_b32 s76, s75, 19
s_add_u32 s76, s76, s74
v_mfma_f32_16x16x32_bf16 a[48:51], a[180:183], a[124:127], a[48:51]
s_lshl_b32 s79, s75, 13
s_add_u32 s79, s79, s78
v_mul_f32 v22, s91, v22
v_mfma_f32_16x16x32_bf16 a[52:55], a[180:183], a[120:123], a[52:55]
s_add_u32 m0, s77, 0
s_add_u32 s64, s76, 0
v_mul_f32 v23, s91, v23
v_mfma_f32_16x16x32_bf16 a[56:59], a[180:183], a[116:119], a[56:59]
buffer_load_dwordx4 v7, s[20:23], s64 offen lds
v_mfma_f32_16x16x32_bf16 a[60:63], a[180:183], a[112:115], a[60:63]
ds_read_b128 a[104:107], v10 offset:4096
ds_read_b128 a[108:111], v10 offset:6144
v_mfma_f32_16x16x32_bf16 a[192:195], a[184:187], a[112:115], a[192:195]
v_cvt_pk_bf16_f32 v16, v16, v17
v_cvt_pk_bf16_f32 v17, v18, v19
v_mfma_f32_16x16x32_bf16 a[196:199], a[184:187], a[116:119], a[196:199]
ds_read_b64_tr_b16 a[160:161], v11 offset:16384
ds_read_b64_tr_b16 a[162:163], v11 offset:16896
v_mfma_f32_16x16x32_bf16 a[200:203], a[184:187], a[120:123], a[200:203]
buffer_load_dwordx4 v8, s[20:23], s64 offen offset:1024 lds
v_mfma_f32_16x16x32_bf16 a[204:207], a[184:187], a[124:127], a[204:207]
ds_read_b64_tr_b16 a[164:165], v12 offset:16384
ds_read_b64_tr_b16 a[166:167], v12 offset:16896
v_mfma_f32_16x16x32_bf16 a[208:211], a[188:191], a[124:127], a[208:211]
v_cvt_pk_bf16_f32 v18, v20, v21
v_cvt_pk_bf16_f32 v19, v22, v23
v_mfma_f32_16x16x32_bf16 a[212:215], a[188:191], a[120:123], a[212:215]
ds_read_b64_tr_b16 a[168:169], v13 offset:16384
ds_read_b64_tr_b16 a[170:171], v13 offset:16896
v_mfma_f32_16x16x32_bf16 a[216:219], a[188:191], a[116:119], a[216:219]
s_add_u32 m0, s80, 0
s_add_u32 s64, s79, 0
v_accvgpr_write_b32 a24, v16
v_mfma_f32_16x16x32_bf16 a[220:223], a[188:191], a[112:115], a[220:223]
ds_read_b64_tr_b16 a[172:173], v14 offset:16384
ds_read_b64_tr_b16 a[174:175], v14 offset:16896
v_mfma_f32_16x16x32_bf16 a[224:227], a[64:67], a[112:115], a[224:227]
buffer_load_dwordx4 v4, s[24:27], s64 offen sc1 lds
v_mfma_f32_16x16x32_bf16 a[228:231], a[64:67], a[116:119], a[228:231]
ds_read_b64_tr_b16 a[80:81], v11 offset:20480
ds_read_b64_tr_b16 a[82:83], v11 offset:20992
v_mfma_f32_16x16x32_bf16 a[232:235], a[64:67], a[120:123], a[232:235]
v_accvgpr_write_b32 a25, v17
v_accvgpr_write_b32 a26, v18
v_mfma_f32_16x16x32_bf16 a[236:239], a[64:67], a[124:127], a[236:239]
ds_read_b64_tr_b16 a[144:145], v12 offset:20480
ds_read_b64_tr_b16 a[146:147], v12 offset:20992
v_mfma_f32_16x16x32_bf16 a[240:243], a[128:131], a[124:127], a[240:243]
s_add_u32 m0, s73, 4096
s_add_u32 s64, s72, 0
v_accvgpr_write_b32 a27, v19
v_mfma_f32_16x16x32_bf16 a[244:247], a[128:131], a[120:123], a[244:247]
ds_read_b64_tr_b16 a[84:85], v13 offset:20480
ds_read_b64_tr_b16 a[86:87], v13 offset:20992
v_mfma_f32_16x16x32_bf16 a[248:251], a[128:131], a[116:119], a[248:251]
buffer_load_dwordx4 v5, s[12:15], s64 offen lds
v_mfma_f32_16x16x32_bf16 v[36:39], a[128:131], a[112:115], v[36:39]
s_add_u32 s53, s87, 4096
ds_read_b64_tr_b16 a[148:149], v14 offset:20480
ds_read_b64_tr_b16 a[150:151], v14 offset:20992
v_mfma_f32_16x16x32_bf16 v[44:47], a[68:71], a[112:115], v[44:47]
buffer_store_dwordx4 v[184:187], v4, s[24:27], s53 offen offset:1024 sc1
v_mfma_f32_16x16x32_bf16 v[32:35], a[68:71], a[116:119], v[32:35]
ds_read_b128 a[88:91], v4 offset:24576
ds_read_b128 a[152:155], v4 offset:25600
v_mfma_f32_16x16x32_bf16 v[52:55], a[68:71], a[120:123], v[52:55]
v_accvgpr_write_b32 a4, v248
v_accvgpr_write_b32 a5, v249
v_mfma_f32_16x16x32_bf16 v[60:63], a[68:71], a[124:127], v[60:63]
ds_read_b128 a[92:95], v4 offset:26624
ds_read_b128 a[156:159], v4 offset:27648
v_mfma_f32_16x16x32_bf16 v[68:71], a[132:135], a[124:127], v[68:71]
buffer_load_dwordx4 v6, s[12:15], s64 offen offset:1024 lds
v_mfma_f32_16x16x32_bf16 v[76:79], a[132:135], a[120:123], v[76:79]
v_accvgpr_write_b32 a6, v250
v_accvgpr_write_b32 a7, v251
v_mfma_f32_16x16x32_bf16 v[84:87], a[132:135], a[116:119], v[84:87]
v_accvgpr_write_b32 a12, v240
v_accvgpr_write_b32 a13, v241
v_mfma_f32_16x16x32_bf16 v[92:95], a[132:135], a[112:115], v[92:95]
v_accvgpr_write_b32 a14, v242
v_accvgpr_write_b32 a15, v243
v_mfma_f32_16x16x32_bf16 v[100:103], a[72:75], a[112:115], v[100:103]
s_add_u32 m0, s73, 6144
s_add_u32 s64, s72, 18432
v_accvgpr_write_b32 a20, v232
v_mfma_f32_16x16x32_bf16 v[108:111], a[72:75], a[116:119], v[108:111]
v_accvgpr_write_b32 a21, v233
v_accvgpr_write_b32 a22, v234
v_mfma_f32_16x16x32_bf16 v[116:119], a[72:75], a[120:123], v[116:119]
buffer_load_dwordx4 v5, s[12:15], s64 offen lds
v_mfma_f32_16x16x32_bf16 v[40:43], a[72:75], a[124:127], v[40:43]
v_accvgpr_write_b32 a23, v235
v_accvgpr_write_b32 a28, v224
v_mfma_f32_16x16x32_bf16 v[124:127], a[136:139], a[124:127], v[124:127]
v_accvgpr_write_b32 a29, v225
v_accvgpr_write_b32 a30, v226
v_mfma_f32_16x16x32_bf16 v[132:135], a[136:139], a[120:123], v[132:135]
v_accvgpr_write_b32 a31, v227
v_and_b32 v28, 31, v1
v_mfma_f32_16x16x32_bf16 v[140:143], a[136:139], a[116:119], v[140:143]
v_lshlrev_b32 v28, 2, v28
v_mfma_f32_16x16x32_bf16 v[148:151], a[136:139], a[112:115], v[148:151]
buffer_load_dword v30, v28, s[40:43], 0 offen sc1
v_mfma_f32_16x16x32_bf16 v[156:159], a[76:79], a[112:115], v[156:159]
buffer_load_dwordx4 v6, s[12:15], s64 offen offset:1024 lds
v_mfma_f32_16x16x32_bf16 v[48:51], a[76:79], a[116:119], v[48:51]
v_add_u32 v9, 32768, v9
v_add_u32 v10, 32768, v10
v_mfma_f32_16x16x32_bf16 v[164:167], a[76:79], a[120:123], v[164:167]
v_mfma_f32_16x16x32_bf16 v[172:175], a[76:79], a[124:127], v[172:175]
v_mfma_f32_16x16x32_bf16 v[180:183], a[140:143], a[124:127], v[180:183]
v_mfma_f32_16x16x32_bf16 v[188:191], a[140:143], a[120:123], v[188:191]
v_mfma_f32_16x16x32_bf16 v[56:59], a[140:143], a[116:119], v[56:59]
v_mfma_f32_16x16x32_bf16 v[196:199], a[140:143], a[112:115], v[196:199]
s_waitcnt lgkmcnt(0)
v_mfma_f32_16x16x32_bf16 a[32:35], a[160:163], a[96:99], a[32:35]
s_waitcnt vmcnt(18)
v_mfma_f32_16x16x32_bf16 a[36:39], a[160:163], a[100:103], a[36:39]
s_barrier
v_mfma_f32_16x16x32_bf16 a[40:43], a[160:163], a[104:107], a[40:43]
s_add_u32 s53, s87, 262144
ds_read_b128 a[112:115], v9 offset:0
ds_read_b128 a[116:119], v9 offset:2048
v_mfma_f32_16x16x32_bf16 a[44:47], a[160:163], a[108:111], a[44:47]
s_add_u32 m0, s77, 16384
s_add_u32 s64, s76, 262144
v_mfma_f32_16x16x32_bf16 a[48:51], a[164:167], a[108:111], a[48:51]
buffer_load_dwordx4 v7, s[20:23], s64 offen lds
v_mfma_f32_16x16x32_bf16 a[52:55], a[164:167], a[104:107], a[52:55]
ds_read_b128 a[120:123], v9 offset:4096
ds_read_b128 a[124:127], v9 offset:6144
v_mfma_f32_16x16x32_bf16 a[56:59], a[164:167], a[100:103], a[56:59]
buffer_store_dwordx4 v[192:195], v4, s[24:27], s53 offen offset:0 sc1
v_mfma_f32_16x16x32_bf16 a[60:63], a[164:167], a[96:99], a[60:63]
ds_read_b64_tr_b16 a[176:177], v11 offset:32768
ds_read_b64_tr_b16 a[178:179], v11 offset:33280
v_mfma_f32_16x16x32_bf16 a[192:195], a[168:171], a[96:99], a[192:195]
v_accvgpr_read_b32 v64, a32
v_accvgpr_read_b32 v65, a33
v_mfma_f32_16x16x32_bf16 a[196:199], a[168:171], a[100:103], a[196:199]
ds_read_b64_tr_b16 a[180:181], v12 offset:32768
ds_read_b64_tr_b16 a[182:183], v12 offset:33280
v_mfma_f32_16x16x32_bf16 a[200:203], a[168:171], a[104:107], a[200:203]
buffer_load_dwordx4 v8, s[20:23], s64 offen offset:1024 lds
v_mfma_f32_16x16x32_bf16 a[204:207], a[168:171], a[108:111], a[204:207]
ds_read_b64_tr_b16 a[184:185], v13 offset:32768
ds_read_b64_tr_b16 a[186:187], v13 offset:33280
v_mfma_f32_16x16x32_bf16 a[208:211], a[172:175], a[108:111], a[208:211]
v_accvgpr_read_b32 v66, a34
v_accvgpr_read_b32 v67, a35
v_mfma_f32_16x16x32_bf16 a[212:215], a[172:175], a[104:107], a[212:215]
ds_read_b64_tr_b16 a[188:189], v14 offset:32768
ds_read_b64_tr_b16 a[190:191], v14 offset:33280
v_mfma_f32_16x16x32_bf16 a[216:219], a[172:175], a[100:103], a[216:219]
s_add_u32 m0, s80, 16384
s_add_u32 s64, s79, 4096
v_accvgpr_write_b32 a32, v152
v_mfma_f32_16x16x32_bf16 a[220:223], a[172:175], a[96:99], a[220:223]
ds_read_b64_tr_b16 a[64:65], v11 offset:36864
ds_read_b64_tr_b16 a[66:67], v11 offset:37376
v_mfma_f32_16x16x32_bf16 a[224:227], a[80:83], a[96:99], a[224:227]
buffer_load_dwordx4 v4, s[24:27], s64 offen sc1 lds
v_mfma_f32_16x16x32_bf16 a[228:231], a[80:83], a[100:103], a[228:231]
s_xor_b32 s65, s70, 640
s_add_u32 s71, s68, s65
s_add_u32 s72, s69, s65
v_mfma_f32_16x16x32_bf16 a[232:235], a[80:83], a[104:107], a[232:235]
ds_read_b64_tr_b16 a[128:129], v12 offset:36864
ds_read_b64_tr_b16 a[130:131], v12 offset:37376
v_mfma_f32_16x16x32_bf16 a[236:239], a[80:83], a[108:111], a[236:239]
v_accvgpr_write_b32 a33, v153
v_accvgpr_write_b32 a34, v154
v_mfma_f32_16x16x32_bf16 a[240:243], a[144:147], a[108:111], a[240:243]
s_add_u32 m0, s73, 32768
s_add_u32 s64, s71, 0
v_accvgpr_write_b32 a35, v155
v_mfma_f32_16x16x32_bf16 a[244:247], a[144:147], a[104:107], a[244:247]
ds_read_b64_tr_b16 a[68:69], v13 offset:36864
ds_read_b64_tr_b16 a[70:71], v13 offset:37376
v_mfma_f32_16x16x32_bf16 a[248:251], a[144:147], a[100:103], a[248:251]
buffer_load_dwordx4 v5, s[12:15], s64 offen lds
v_mfma_f32_16x16x32_bf16 v[36:39], a[144:147], a[96:99], v[36:39]
ds_read_b64_tr_b16 a[132:133], v14 offset:36864
ds_read_b64_tr_b16 a[134:135], v14 offset:37376
v_mfma_f32_16x16x32_bf16 v[44:47], a[84:87], a[96:99], v[44:47]
v_accvgpr_read_b32 v204, a36
v_accvgpr_read_b32 v205, a37
v_mfma_f32_16x16x32_bf16 v[32:35], a[84:87], a[100:103], v[32:35]
ds_read_b128 a[72:75], v4 offset:40960
ds_read_b128 a[136:139], v4 offset:41984
v_mfma_f32_16x16x32_bf16 v[52:55], a[84:87], a[104:107], v[52:55]
v_accvgpr_read_b32 v206, a38
v_accvgpr_read_b32 v207, a39
v_mfma_f32_16x16x32_bf16 v[60:63], a[84:87], a[108:111], v[60:63]
ds_read_b128 a[76:79], v4 offset:43008
ds_read_b128 a[140:143], v4 offset:44032
v_mfma_f32_16x16x32_bf16 v[68:71], a[148:151], a[108:111], v[68:71]
buffer_load_dwordx4 v6, s[12:15], s64 offen offset:1024 lds
v_mfma_f32_16x16x32_bf16 v[76:79], a[148:151], a[104:107], v[76:79]
s_add_u32 s53, s87, 262144
v_accvgpr_read_b32 v212, a40
v_accvgpr_read_b32 v213, a41
v_mfma_f32_16x16x32_bf16 v[84:87], a[148:151], a[100:103], v[84:87]
buffer_store_dwordx4 v[200:203], v4, s[24:27], s53 offen offset:1024 sc1
v_mfma_f32_16x16x32_bf16 v[92:95], a[148:151], a[96:99], v[92:95]
s_waitcnt vmcnt(8)
v_accvgpr_read_b32 v214, a42
v_accvgpr_read_b32 v215, a43
v_mfma_f32_16x16x32_bf16 v[100:103], a[88:91], a[96:99], v[100:103]
s_add_u32 m0, s73, 34816
s_add_u32 s64, s71, 18432
v_accvgpr_read_b32 v220, a44
v_mfma_f32_16x16x32_bf16 v[108:111], a[88:91], a[100:103], v[108:111]
v_accvgpr_read_b32 v221, a45
v_accvgpr_read_b32 v222, a46
v_mfma_f32_16x16x32_bf16 v[116:119], a[88:91], a[104:107], v[116:119]
buffer_load_dwordx4 v5, s[12:15], s64 offen lds
v_mfma_f32_16x16x32_bf16 v[40:43], a[88:91], a[108:111], v[40:43]
v_accvgpr_read_b32 v223, a47
v_cmp_gt_u32 vcc, 1, v30
v_mfma_f32_16x16x32_bf16 v[124:127], a[152:155], a[108:111], v[124:127]
v_mfma_f32_16x16x32_bf16 v[132:135], a[152:155], a[104:107], v[132:135]
v_mfma_f32_16x16x32_bf16 v[140:143], a[152:155], a[100:103], v[140:143]
v_mfma_f32_16x16x32_bf16 v[148:151], a[152:155], a[96:99], v[148:151]
v_mfma_f32_16x16x32_bf16 v[156:159], a[92:95], a[96:99], v[156:159]
buffer_load_dwordx4 v6, s[12:15], s64 offen offset:1024 lds
v_mfma_f32_16x16x32_bf16 v[48:51], a[92:95], a[100:103], v[48:51]
s_cbranch_vccnz CK_ZA
CK_ZA_R:
v_mfma_f32_16x16x32_bf16 v[164:167], a[92:95], a[104:107], v[164:167]
v_mfma_f32_16x16x32_bf16 v[172:175], a[92:95], a[108:111], v[172:175]
v_mfma_f32_16x16x32_bf16 v[180:183], a[156:159], a[108:111], v[180:183]
v_mfma_f32_16x16x32_bf16 v[188:191], a[156:159], a[104:107], v[188:191]
v_mfma_f32_16x16x32_bf16 v[56:59], a[156:159], a[100:103], v[56:59]
v_mfma_f32_16x16x32_bf16 v[196:199], a[156:159], a[96:99], v[196:199]
s_waitcnt lgkmcnt(0)
v_mfma_f32_16x16x32_bf16 v[64:67], a[176:179], a[112:115], v[64:67]
s_waitcnt vmcnt(24)
v_mfma_f32_16x16x32_bf16 v[204:207], a[176:179], a[116:119], v[204:207]
s_barrier
v_mfma_f32_16x16x32_bf16 v[212:215], a[176:179], a[120:123], v[212:215]
ds_read_b128 a[96:99], v10 offset:0
ds_read_b128 a[100:103], v10 offset:2048
v_mfma_f32_16x16x32_bf16 v[220:223], a[176:179], a[124:127], v[220:223]
s_xor_b32 s75, s93, 5
s_lshl_b32 s76, s75, 19
s_add_u32 s76, s76, s74
v_mfma_f32_16x16x32_bf16 a[48:51], a[180:183], a[124:127], a[48:51]
s_lshl_b32 s79, s75, 13
s_add_u32 s79, s79, s78
v_mfma_f32_16x16x32_bf16 a[52:55], a[180:183], a[120:123], a[52:55]
s_add_u32 m0, s77, 32768
s_add_u32 s64, s76, 0
v_mfma_f32_16x16x32_bf16 a[56:59], a[180:183], a[116:119], a[56:59]
buffer_load_dwordx4 v7, s[20:23], s64 offen lds
v_mfma_f32_16x16x32_bf16 a[60:63], a[180:183], a[112:115], a[60:63]
ds_read_b128 a[104:107], v10 offset:4096
ds_read_b128 a[108:111], v10 offset:6144
v_mfma_f32_16x16x32_bf16 a[192:195], a[184:187], a[112:115], a[192:195]
s_add_u32 s53, s87, 266240
v_mfma_f32_16x16x32_bf16 a[196:199], a[184:187], a[116:119], a[196:199]
ds_read_b64_tr_b16 a[160:161], v11 offset:49152
ds_read_b64_tr_b16 a[162:163], v11 offset:49664
v_mfma_f32_16x16x32_bf16 a[200:203], a[184:187], a[120:123], a[200:203]
buffer_load_dwordx4 v8, s[20:23], s64 offen offset:1024 lds
v_mfma_f32_16x16x32_bf16 a[204:207], a[184:187], a[124:127], a[204:207]
ds_read_b64_tr_b16 a[164:165], v12 offset:49152
ds_read_b64_tr_b16 a[166:167], v12 offset:49664
v_mfma_f32_16x16x32_bf16 a[208:211], a[188:191], a[124:127], a[208:211]
buffer_store_dwordx4 v[208:211], v4, s[24:27], s53 offen offset:0 sc1
v_mfma_f32_16x16x32_bf16 a[212:215], a[188:191], a[120:123], a[212:215]
ds_read_b64_tr_b16 a[168:169], v13 offset:49152
ds_read_b64_tr_b16 a[170:171], v13 offset:49664
v_mfma_f32_16x16x32_bf16 a[216:219], a[188:191], a[116:119], a[216:219]
s_add_u32 m0, s80, 32768
s_add_u32 s64, s79, 0
v_accvgpr_read_b32 v72, a48
v_mfma_f32_16x16x32_bf16 a[220:223], a[188:191], a[112:115], a[220:223]
ds_read_b64_tr_b16 a[172:173], v14 offset:49152
ds_read_b64_tr_b16 a[174:175], v14 offset:49664
v_mfma_f32_16x16x32_bf16 a[224:227], a[64:67], a[112:115], a[224:227]
buffer_load_dwordx4 v4, s[24:27], s64 offen sc1 lds
v_mfma_f32_16x16x32_bf16 a[228:231], a[64:67], a[116:119], a[228:231]
ds_read_b64_tr_b16 a[80:81], v11 offset:53248
ds_read_b64_tr_b16 a[82:83], v11 offset:53760
v_mfma_f32_16x16x32_bf16 a[232:235], a[64:67], a[120:123], a[232:235]
v_accvgpr_read_b32 v73, a49
v_accvgpr_read_b32 v74, a50
v_mfma_f32_16x16x32_bf16 a[236:239], a[64:67], a[124:127], a[236:239]
ds_read_b64_tr_b16 a[144:145], v12 offset:53248
ds_read_b64_tr_b16 a[146:147], v12 offset:53760
v_mfma_f32_16x16x32_bf16 a[240:243], a[128:131], a[124:127], a[240:243]
s_add_u32 m0, s73, 36864
s_add_u32 s64, s72, 0
v_accvgpr_read_b32 v75, a51
v_mfma_f32_16x16x32_bf16 a[244:247], a[128:131], a[120:123], a[244:247]
ds_read_b64_tr_b16 a[84:85], v13 offset:53248
ds_read_b64_tr_b16 a[86:87], v13 offset:53760
v_mfma_f32_16x16x32_bf16 a[248:251], a[128:131], a[116:119], a[248:251]
buffer_load_dwordx4 v5, s[12:15], s64 offen lds
v_mfma_f32_16x16x32_bf16 v[36:39], a[128:131], a[112:115], v[36:39]
ds_read_b64_tr_b16 a[148:149], v14 offset:53248
ds_read_b64_tr_b16 a[150:151], v14 offset:53760
v_mfma_f32_16x16x32_bf16 v[44:47], a[68:71], a[112:115], v[44:47]
v_accvgpr_read_b32 v228, a52
v_accvgpr_read_b32 v229, a53
v_mfma_f32_16x16x32_bf16 v[32:35], a[68:71], a[116:119], v[32:35]
ds_read_b128 a[88:91], v4 offset:57344
ds_read_b128 a[152:155], v4 offset:58368
v_mfma_f32_16x16x32_bf16 v[52:55], a[68:71], a[120:123], v[52:55]
v_accvgpr_read_b32 v230, a54
v_accvgpr_read_b32 v231, a55
v_mfma_f32_16x16x32_bf16 v[60:63], a[68:71], a[124:127], v[60:63]
ds_read_b128 a[92:95], v4 offset:59392
ds_read_b128 a[156:159], v4 offset:60416
v_mfma_f32_16x16x32_bf16 v[68:71], a[132:135], a[124:127], v[68:71]
buffer_load_dwordx4 v6, s[12:15], s64 offen offset:1024 lds
v_mfma_f32_16x16x32_bf16 v[76:79], a[132:135], a[120:123], v[76:79]
v_accvgpr_read_b32 v80, a56
v_accvgpr_read_b32 v81, a57
v_mfma_f32_16x16x32_bf16 v[84:87], a[132:135], a[116:119], v[84:87]
v_accvgpr_read_b32 v82, a58
v_accvgpr_read_b32 v83, a59
v_mfma_f32_16x16x32_bf16 v[92:95], a[132:135], a[112:115], v[92:95]
v_accvgpr_read_b32 v236, a60
v_accvgpr_read_b32 v237, a61
v_mfma_f32_16x16x32_bf16 v[100:103], a[72:75], a[112:115], v[100:103]
s_add_u32 m0, s73, 38912
s_add_u32 s64, s72, 18432
v_accvgpr_read_b32 v238, a62
v_mfma_f32_16x16x32_bf16 v[108:111], a[72:75], a[116:119], v[108:111]
v_accvgpr_read_b32 v239, a63
v_accvgpr_read_b32 v244, a192
v_mfma_f32_16x16x32_bf16 v[116:119], a[72:75], a[120:123], v[116:119]
buffer_load_dwordx4 v5, s[12:15], s64 offen lds
v_mfma_f32_16x16x32_bf16 v[40:43], a[72:75], a[124:127], v[40:43]
s_add_u32 s53, s87, 266240
v_accvgpr_read_b32 v245, a193
v_accvgpr_read_b32 v246, a194
v_mfma_f32_16x16x32_bf16 v[124:127], a[136:139], a[124:127], v[124:127]
buffer_store_dwordx4 v[216:219], v4, s[24:27], s53 offen offset:1024 sc1
v_mfma_f32_16x16x32_bf16 v[132:135], a[136:139], a[120:123], v[132:135]
v_accvgpr_read_b32 v247, a195
v_accvgpr_read_b32 v252, a196
v_mfma_f32_16x16x32_bf16 v[140:143], a[136:139], a[116:119], v[140:143]
v_accvgpr_read_b32 v253, a197
v_accvgpr_read_b32 v254, a198
v_mfma_f32_16x16x32_bf16 v[148:151], a[136:139], a[112:115], v[148:151]
v_accvgpr_read_b32 v255, a199
v_accvgpr_read_b32 v88, a200
v_mfma_f32_16x16x32_bf16 v[156:159], a[76:79], a[112:115], v[156:159]
buffer_load_dwordx4 v6, s[12:15], s64 offen offset:1024 lds
v_mfma_f32_16x16x32_bf16 v[48:51], a[76:79], a[116:119], v[48:51]
v_add_u32 v9, -65536, v9
v_add_u32 v10, -65536, v10
v_mfma_f32_16x16x32_bf16 v[164:167], a[76:79], a[120:123], v[164:167]
v_accvgpr_read_b32 v89, a201
v_accvgpr_read_b32 v90, a202
v_mfma_f32_16x16x32_bf16 v[172:175], a[76:79], a[124:127], v[172:175]
v_accvgpr_read_b32 v91, a203
v_mfma_f32_16x16x32_bf16 v[180:183], a[140:143], a[124:127], v[180:183]
v_mfma_f32_16x16x32_bf16 v[188:191], a[140:143], a[120:123], v[188:191]
v_mfma_f32_16x16x32_bf16 v[56:59], a[140:143], a[116:119], v[56:59]
v_mfma_f32_16x16x32_bf16 v[196:199], a[140:143], a[112:115], v[196:199]
s_waitcnt lgkmcnt(0)
v_mfma_f32_16x16x32_bf16 v[64:67], a[160:163], a[96:99], v[64:67]
s_waitcnt vmcnt(18)
v_mfma_f32_16x16x32_bf16 v[204:207], a[160:163], a[100:103], v[204:207]
s_barrier
v_mfma_f32_16x16x32_bf16 v[212:215], a[160:163], a[104:107], v[212:215]
ds_read_b128 a[112:115], v9 offset:0
ds_read_b128 a[116:119], v9 offset:2048
v_mfma_f32_16x16x32_bf16 v[220:223], a[160:163], a[108:111], v[220:223]
s_add_u32 m0, s77, 49152
s_add_u32 s64, s76, 262144
v_mfma_f32_16x16x32_bf16 v[72:75], a[164:167], a[108:111], v[72:75]
buffer_load_dwordx4 v7, s[20:23], s64 offen lds
v_mfma_f32_16x16x32_bf16 v[228:231], a[164:167], a[104:107], v[228:231]
ds_read_b128 a[120:123], v9 offset:4096
ds_read_b128 a[124:127], v9 offset:6144
v_mfma_f32_16x16x32_bf16 v[80:83], a[164:167], a[100:103], v[80:83]
v_mfma_f32_16x16x32_bf16 v[236:239], a[164:167], a[96:99], v[236:239]
ds_read_b64_tr_b16 a[176:177], v11 offset:0
ds_read_b64_tr_b16 a[178:179], v11 offset:512
v_mfma_f32_16x16x32_bf16 v[244:247], a[168:171], a[96:99], v[244:247]
v_mfma_f32_16x16x32_bf16 v[252:255], a[168:171], a[100:103], v[252:255]
ds_read_b64_tr_b16 a[180:181], v12 offset:0
ds_read_b64_tr_b16 a[182:183], v12 offset:512
v_mfma_f32_16x16x32_bf16 v[88:91], a[168:171], a[104:107], v[88:91]
buffer_load_dwordx4 v8, s[20:23], s64 offen offset:1024 lds
v_mfma_f32_16x16x32_bf16 a[204:207], a[168:171], a[108:111], a[204:207]
ds_read_b64_tr_b16 a[184:185], v13 offset:0
ds_read_b64_tr_b16 a[186:187], v13 offset:512
v_mfma_f32_16x16x32_bf16 a[208:211], a[172:175], a[108:111], a[208:211]
v_mfma_f32_16x16x32_bf16 a[212:215], a[172:175], a[104:107], a[212:215]
ds_read_b64_tr_b16 a[188:189], v14 offset:0
ds_read_b64_tr_b16 a[190:191], v14 offset:512
v_mfma_f32_16x16x32_bf16 a[216:219], a[172:175], a[100:103], a[216:219]
s_add_u32 m0, s80, 49152
s_add_u32 s64, s79, 4096
s_add_u32 s53, s88, 524288
v_mfma_f32_16x16x32_bf16 a[220:223], a[172:175], a[96:99], a[220:223]
ds_read_b64_tr_b16 a[64:65], v11 offset:4096
ds_read_b64_tr_b16 a[66:67], v11 offset:4608
v_mfma_f32_16x16x32_bf16 a[224:227], a[80:83], a[96:99], a[224:227]
buffer_load_dwordx4 v4, s[24:27], s64 offen sc1 lds
v_mfma_f32_16x16x32_bf16 a[228:231], a[80:83], a[100:103], a[228:231]
s_xor_b32 s65, s70, 768
s_add_u32 s71, s68, s65
s_add_u32 s72, s69, s65
v_mfma_f32_16x16x32_bf16 a[232:235], a[80:83], a[104:107], a[232:235]
ds_read_b64_tr_b16 a[128:129], v12 offset:4096
ds_read_b64_tr_b16 a[130:131], v12 offset:4608
v_mfma_f32_16x16x32_bf16 a[236:239], a[80:83], a[108:111], a[236:239]
buffer_store_dwordx4 v[96:99], v4, s[24:27], s53 offen offset:0 sc1
v_mfma_f32_16x16x32_bf16 a[240:243], a[144:147], a[108:111], a[240:243]
s_add_u32 m0, s73, 65536
s_add_u32 s64, s71, 0
v_accvgpr_read_b32 v160, a204
v_mfma_f32_16x16x32_bf16 a[244:247], a[144:147], a[104:107], a[244:247]
ds_read_b64_tr_b16 a[68:69], v13 offset:4096
ds_read_b64_tr_b16 a[70:71], v13 offset:4608
v_mfma_f32_16x16x32_bf16 a[248:251], a[144:147], a[100:103], a[248:251]
buffer_load_dwordx4 v5, s[12:15], s64 offen lds
v_mfma_f32_16x16x32_bf16 v[36:39], a[144:147], a[96:99], v[36:39]
ds_read_b64_tr_b16 a[132:133], v14 offset:4096
ds_read_b64_tr_b16 a[134:135], v14 offset:4608
v_mfma_f32_16x16x32_bf16 v[44:47], a[84:87], a[96:99], v[44:47]
v_accvgpr_read_b32 v161, a205
v_accvgpr_read_b32 v162, a206
v_mfma_f32_16x16x32_bf16 v[32:35], a[84:87], a[100:103], v[32:35]
ds_read_b128 a[72:75], v4 offset:8192
ds_read_b128 a[136:139], v4 offset:9216
v_mfma_f32_16x16x32_bf16 v[52:55], a[84:87], a[104:107], v[52:55]
v_accvgpr_read_b32 v163, a207
v_accvgpr_read_b32 v168, a208
v_mfma_f32_16x16x32_bf16 v[60:63], a[84:87], a[108:111], v[60:63]
ds_read_b128 a[76:79], v4 offset:10240
ds_read_b128 a[140:143], v4 offset:11264
v_mfma_f32_16x16x32_bf16 v[68:71], a[148:151], a[108:111], v[68:71]
buffer_load_dwordx4 v6, s[12:15], s64 offen offset:1024 lds
v_mfma_f32_16x16x32_bf16 v[76:79], a[148:151], a[104:107], v[76:79]
v_accvgpr_read_b32 v169, a209
v_accvgpr_read_b32 v170, a210
v_mfma_f32_16x16x32_bf16 v[84:87], a[148:151], a[100:103], v[84:87]
v_accvgpr_read_b32 v171, a211
v_accvgpr_read_b32 v176, a212
v_mfma_f32_16x16x32_bf16 v[92:95], a[148:151], a[96:99], v[92:95]
v_accvgpr_read_b32 v177, a213
v_accvgpr_read_b32 v178, a214
v_mfma_f32_16x16x32_bf16 v[100:103], a[88:91], a[96:99], v[100:103]
s_add_u32 m0, s73, 67584
s_add_u32 s64, s71, 18432
v_accvgpr_read_b32 v179, a215
v_mfma_f32_16x16x32_bf16 v[108:111], a[88:91], a[100:103], v[108:111]
v_accvgpr_read_b32 v184, a216
v_accvgpr_read_b32 v185, a217
v_mfma_f32_16x16x32_bf16 v[116:119], a[88:91], a[104:107], v[116:119]
buffer_load_dwordx4 v5, s[12:15], s64 offen lds
v_mfma_f32_16x16x32_bf16 v[40:43], a[88:91], a[108:111], v[40:43]
v_accvgpr_read_b32 v186, a218
v_accvgpr_read_b32 v187, a219
v_mfma_f32_16x16x32_bf16 v[124:127], a[152:155], a[108:111], v[124:127]
v_accvgpr_read_b32 v248, a220
v_accvgpr_read_b32 v249, a221
v_mfma_f32_16x16x32_bf16 v[132:135], a[152:155], a[104:107], v[132:135]
v_accvgpr_read_b32 v250, a222
v_accvgpr_read_b32 v251, a223
v_mfma_f32_16x16x32_bf16 v[140:143], a[152:155], a[100:103], v[140:143]
v_accvgpr_read_b32 v240, a224
v_accvgpr_read_b32 v241, a225
v_mfma_f32_16x16x32_bf16 v[148:151], a[152:155], a[96:99], v[148:151]
v_accvgpr_read_b32 v242, a226
v_accvgpr_read_b32 v243, a227
v_mfma_f32_16x16x32_bf16 v[156:159], a[92:95], a[96:99], v[156:159]
buffer_load_dwordx4 v6, s[12:15], s64 offen offset:1024 lds
v_mfma_f32_16x16x32_bf16 v[48:51], a[92:95], a[100:103], v[48:51]
s_add_u32 s53, s88, 524288
v_accvgpr_read_b32 v232, a228
v_accvgpr_read_b32 v233, a229
v_mfma_f32_16x16x32_bf16 v[164:167], a[92:95], a[104:107], v[164:167]
buffer_store_dwordx4 v[104:107], v4, s[24:27], s53 offen offset:1024 sc1
v_mfma_f32_16x16x32_bf16 v[172:175], a[92:95], a[108:111], v[172:175]
v_accvgpr_read_b32 v234, a230
v_accvgpr_read_b32 v235, a231
v_mfma_f32_16x16x32_bf16 v[180:183], a[156:159], a[108:111], v[180:183]
v_accvgpr_read_b32 v224, a232
v_accvgpr_read_b32 v225, a233
v_mfma_f32_16x16x32_bf16 v[188:191], a[156:159], a[104:107], v[188:191]
v_accvgpr_read_b32 v226, a234
v_accvgpr_read_b32 v227, a235
v_mfma_f32_16x16x32_bf16 v[56:59], a[156:159], a[100:103], v[56:59]
v_accvgpr_read_b32 v192, a236
v_accvgpr_read_b32 v193, a237
v_mfma_f32_16x16x32_bf16 v[196:199], a[156:159], a[96:99], v[196:199]
s_waitcnt lgkmcnt(0)
v_accvgpr_read_b32 v194, a238
v_accvgpr_read_b32 v195, a239
v_mfma_f32_16x16x32_bf16 v[64:67], a[176:179], a[112:115], v[64:67]
s_waitcnt vmcnt(23)
v_accvgpr_read_b32 v152, a240
v_accvgpr_read_b32 v153, a241
v_mfma_f32_16x16x32_bf16 v[204:207], a[176:179], a[116:119], v[204:207]
s_barrier
v_mfma_f32_16x16x32_bf16 v[212:215], a[176:179], a[120:123], v[212:215]
ds_read_b128 a[96:99], v10 offset:0
ds_read_b128 a[100:103], v10 offset:2048
v_mfma_f32_16x16x32_bf16 v[220:223], a[176:179], a[124:127], v[220:223]
s_xor_b32 s75, s93, 6
s_lshl_b32 s76, s75, 19
s_add_u32 s76, s76, s74
v_mfma_f32_16x16x32_bf16 v[72:75], a[180:183], a[124:127], v[72:75]
s_lshl_b32 s79, s75, 13
s_add_u32 s79, s79, s78
v_accvgpr_read_b32 v154, a242
v_mfma_f32_16x16x32_bf16 v[228:231], a[180:183], a[120:123], v[228:231]
s_add_u32 m0, s77, 0
s_add_u32 s64, s76, 0
v_accvgpr_read_b32 v155, a243
v_mfma_f32_16x16x32_bf16 v[80:83], a[180:183], a[116:119], v[80:83]
buffer_load_dwordx4 v7, s[20:23], s64 offen lds
v_mfma_f32_16x16x32_bf16 v[236:239], a[180:183], a[112:115], v[236:239]
ds_read_b128 a[104:107], v10 offset:4096
ds_read_b128 a[108:111], v10 offset:6144
v_mfma_f32_16x16x32_bf16 v[244:247], a[184:187], a[112:115], v[244:247]
v_mfma_f32_16x16x32_bf16 v[252:255], a[184:187], a[116:119], v[252:255]
ds_read_b64_tr_b16 a[160:161], v11 offset:16384
ds_read_b64_tr_b16 a[162:163], v11 offset:16896
v_mfma_f32_16x16x32_bf16 v[88:91], a[184:187], a[120:123], v[88:91]
buffer_load_dwordx4 v8, s[20:23], s64 offen offset:1024 lds
v_mfma_f32_16x16x32_bf16 v[160:163], a[184:187], a[124:127], v[160:163]
ds_read_b64_tr_b16 a[164:165], v12 offset:16384
ds_read_b64_tr_b16 a[166:167], v12 offset:16896
v_mfma_f32_16x16x32_bf16 v[168:171], a[188:191], a[124:127], v[168:171]
v_mfma_f32_16x16x32_bf16 v[176:179], a[188:191], a[120:123], v[176:179]
ds_read_b64_tr_b16 a[168:169], v13 offset:16384
ds_read_b64_tr_b16 a[170:171], v13 offset:16896
v_mfma_f32_16x16x32_bf16 v[184:187], a[188:191], a[116:119], v[184:187]
s_add_u32 m0, s80, 0
s_add_u32 s64, s79, 0
v_mfma_f32_16x16x32_bf16 v[248:251], a[188:191], a[112:115], v[248:251]
ds_read_b64_tr_b16 a[172:173], v14 offset:16384
ds_read_b64_tr_b16 a[174:175], v14 offset:16896
v_mfma_f32_16x16x32_bf16 v[240:243], a[64:67], a[112:115], v[240:243]
buffer_load_dwordx4 v4, s[24:27], s64 offen sc1 lds
v_mfma_f32_16x16x32_bf16 v[232:235], a[64:67], a[116:119], v[232:235]
ds_read_b64_tr_b16 a[80:81], v11 offset:20480
ds_read_b64_tr_b16 a[82:83], v11 offset:20992
v_mfma_f32_16x16x32_bf16 v[224:227], a[64:67], a[120:123], v[224:227]
v_mfma_f32_16x16x32_bf16 v[192:195], a[64:67], a[124:127], v[192:195]
ds_read_b64_tr_b16 a[144:145], v12 offset:20480
ds_read_b64_tr_b16 a[146:147], v12 offset:20992
v_mfma_f32_16x16x32_bf16 v[152:155], a[128:131], a[124:127], v[152:155]
s_add_u32 m0, s73, 69632
s_add_u32 s64, s72, 0
s_add_u32 s53, s88, 524288
v_mfma_f32_16x16x32_bf16 a[244:247], a[128:131], a[120:123], a[244:247]
ds_read_b64_tr_b16 a[84:85], v13 offset:20480
ds_read_b64_tr_b16 a[86:87], v13 offset:20992
v_mfma_f32_16x16x32_bf16 a[248:251], a[128:131], a[116:119], a[248:251]
buffer_load_dwordx4 v5, s[12:15], s64 offen lds
v_mfma_f32_16x16x32_bf16 v[36:39], a[128:131], a[112:115], v[36:39]
ds_read_b64_tr_b16 a[148:149], v14 offset:20480
ds_read_b64_tr_b16 a[150:151], v14 offset:20992
v_mfma_f32_16x16x32_bf16 v[44:47], a[68:71], a[112:115], v[44:47]
buffer_store_dwordx4 v[112:115], v4, s[24:27], s53 offen offset:2048 sc1
v_mfma_f32_16x16x32_bf16 v[32:35], a[68:71], a[116:119], v[32:35]
ds_read_b128 a[88:91], v4 offset:24576
ds_read_b128 a[152:155], v4 offset:25600
v_mfma_f32_16x16x32_bf16 v[52:55], a[68:71], a[120:123], v[52:55]
v_mfma_f32_16x16x32_bf16 v[60:63], a[68:71], a[124:127], v[60:63]
ds_read_b128 a[92:95], v4 offset:26624
ds_read_b128 a[156:159], v4 offset:27648
v_mfma_f32_16x16x32_bf16 v[68:71], a[132:135], a[124:127], v[68:71]
buffer_load_dwordx4 v6, s[12:15], s64 offen offset:1024 lds
v_mfma_f32_16x16x32_bf16 v[76:79], a[132:135], a[120:123], v[76:79]
v_accvgpr_read_b32 v200, a244
v_accvgpr_read_b32 v201, a245
v_mfma_f32_16x16x32_bf16 v[84:87], a[132:135], a[116:119], v[84:87]
v_accvgpr_read_b32 v202, a246
v_accvgpr_read_b32 v203, a247
v_mfma_f32_16x16x32_bf16 v[92:95], a[132:135], a[112:115], v[92:95]
v_accvgpr_read_b32 v208, a248
v_accvgpr_read_b32 v209, a249
v_mfma_f32_16x16x32_bf16 v[100:103], a[72:75], a[112:115], v[100:103]
s_add_u32 m0, s73, 71680
s_add_u32 s64, s72, 18432
v_accvgpr_read_b32 v210, a250
v_mfma_f32_16x16x32_bf16 v[108:111], a[72:75], a[116:119], v[108:111]
v_accvgpr_read_b32 v211, a251
v_mfma_f32_16x16x32_bf16 v[116:119], a[72:75], a[120:123], v[116:119]
buffer_load_dwordx4 v5, s[12:15], s64 offen lds
v_mfma_f32_16x16x32_bf16 v[40:43], a[72:75], a[124:127], v[40:43]
s_lshr_b32 s84, s7, 1
s_and_b32 s85, s7, 1
s_and_b32 s52, s6, 7
v_mfma_f32_16x16x32_bf16 v[124:127], a[136:139], a[124:127], v[124:127]
s_lshl3_add_u32 s85, s85, s52
s_lshr_b32 s86, s6, 3
s_lshl_b32 s83, s3, 13
v_mfma_f32_16x16x32_bf16 v[132:135], a[136:139], a[120:123], v[132:135]
s_add_u32 s83, s83, 131072
s_mul_i32 s52, s2, 5462
s_lshr_b32 s52, s52, 16
v_mfma_f32_16x16x32_bf16 v[140:143], a[136:139], a[116:119], v[140:143]
s_mul_i32 s54, s52, 12
s_sub_u32 s54, s2, s54
s_mul_i32 s54, s54, 3
v_mfma_f32_16x16x32_bf16 v[148:151], a[136:139], a[112:115], v[148:151]
s_add_u32 s54, s54, s3
s_mul_i32 s55, s52, 13108
s_lshr_b32 s55, s55, 16
v_mfma_f32_16x16x32_bf16 v[156:159], a[76:79], a[112:115], v[156:159]
buffer_load_dwordx4 v6, s[12:15], s64 offen offset:1024 lds
v_mfma_f32_16x16x32_bf16 v[48:51], a[76:79], a[116:119], v[48:51]
s_mul_i32 s82, s55, 5
v_add_u32 v9, 32768, v9
v_add_u32 v10, 32768, v10
v_mfma_f32_16x16x32_bf16 v[164:167], a[76:79], a[120:123], v[164:167]
s_sub_u32 s52, s52, s82
v_mfma_f32_16x16x32_bf16 v[172:175], a[76:79], a[124:127], v[172:175]
v_lshrrev_b32 v16, 1, v1
v_and_b32 v17, 1, v1
v_mfma_f32_16x16x32_bf16 v[180:183], a[140:143], a[124:127], v[180:183]
v_mul_u32_u24 v18, 1152, v16
v_lshl_add_u32 v18, v17, 4, v18
v_mfma_f32_16x16x32_bf16 v[188:191], a[140:143], a[120:123], v[188:191]
v_mov_b32 v24, v18
v_lshrrev_b32 v18, 4, v16
v_mfma_f32_16x16x32_bf16 v[56:59], a[140:143], a[116:119], v[56:59]
v_bfe_u32 v19, v16, 2, 2
v_and_b32 v16, 3, v16
v_mfma_f32_16x16x32_bf16 v[196:199], a[140:143], a[112:115], v[196:199]
s_waitcnt lgkmcnt(0)
s_add_u32 s53, s88, 524288
v_lshrrev_b32 v20, 1, v19
v_mfma_f32_16x16x32_bf16 v[64:67], a[160:163], a[96:99], v[64:67]
s_waitcnt vmcnt(17)
v_mul_u32_u24 v20, 18, v20
v_and_b32 v21, 1, v19
v_mfma_f32_16x16x32_bf16 v[204:207], a[160:163], a[100:103], v[204:207]
s_barrier
v_mfma_f32_16x16x32_bf16 v[212:215], a[160:163], a[104:107], v[212:215]
ds_read_b128 a[112:115], v9 offset:0
ds_read_b128 a[116:119], v9 offset:2048
v_mfma_f32_16x16x32_bf16 v[220:223], a[160:163], a[108:111], v[220:223]
s_add_u32 m0, s77, 16384
s_add_u32 s64, s76, 262144
v_lshl_add_u32 v20, v21, 1, v20
v_mfma_f32_16x16x32_bf16 v[72:75], a[164:167], a[108:111], v[72:75]
buffer_load_dwordx4 v7, s[20:23], s64 offen lds
v_mfma_f32_16x16x32_bf16 v[228:231], a[164:167], a[104:107], v[228:231]
ds_read_b128 a[120:123], v9 offset:4096
ds_read_b128 a[124:127], v9 offset:6144
v_mfma_f32_16x16x32_bf16 v[80:83], a[164:167], a[100:103], v[80:83]
buffer_store_dwordx4 v[120:123], v4, s[24:27], s53 offen offset:3072 sc1
v_mfma_f32_16x16x32_bf16 v[236:239], a[164:167], a[96:99], v[236:239]
ds_read_b64_tr_b16 a[176:177], v11 offset:32768
ds_read_b64_tr_b16 a[178:179], v11 offset:33280
v_mfma_f32_16x16x32_bf16 v[244:247], a[168:171], a[96:99], v[244:247]
buffer_atomic_add v1, v0, s[24:27], s90 offen offset:4 sc1
v_mfma_f32_16x16x32_bf16 v[252:255], a[168:171], a[100:103], v[252:255]
ds_read_b64_tr_b16 a[180:181], v12 offset:32768
ds_read_b64_tr_b16 a[182:183], v12 offset:33280
v_mfma_f32_16x16x32_bf16 v[88:91], a[168:171], a[104:107], v[88:91]
buffer_load_dwordx4 v8, s[20:23], s64 offen offset:1024 lds
v_mfma_f32_16x16x32_bf16 v[160:163], a[168:171], a[108:111], v[160:163]
ds_read_b64_tr_b16 a[184:185], v13 offset:32768
ds_read_b64_tr_b16 a[186:187], v13 offset:33280
v_mfma_f32_16x16x32_bf16 v[168:171], a[172:175], a[108:111], v[168:171]
v_lshl_add_u32 v20, v16, 2, v20
v_add_u32 v20, v20, v18
v_mfma_f32_16x16x32_bf16 v[176:179], a[172:175], a[104:107], v[176:179]
ds_read_b64_tr_b16 a[188:189], v14 offset:32768
ds_read_b64_tr_b16 a[190:191], v14 offset:33280
v_mfma_f32_16x16x32_bf16 v[184:187], a[172:175], a[100:103], v[184:187]
s_add_u32 m0, s80, 16384
s_add_u32 s64, s79, 4096
v_mad_u32_u24 v20, s52, 36, v20
v_mfma_f32_16x16x32_bf16 v[248:251], a[172:175], a[96:99], v[248:251]
ds_read_b64_tr_b16 a[64:65], v11 offset:36864
ds_read_b64_tr_b16 a[66:67], v11 offset:37376
v_mfma_f32_16x16x32_bf16 v[240:243], a[80:83], a[96:99], v[240:243]
buffer_load_dwordx4 v4, s[24:27], s64 offen sc1 lds
v_mfma_f32_16x16x32_bf16 v[232:235], a[80:83], a[100:103], v[232:235]
s_xor_b32 s65, s70, 896
s_add_u32 s71, s68, s65
s_add_u32 s72, s69, s65
v_mfma_f32_16x16x32_bf16 v[224:227], a[80:83], a[104:107], v[224:227]
ds_read_b64_tr_b16 a[128:129], v12 offset:36864
ds_read_b64_tr_b16 a[130:131], v12 offset:37376
v_mfma_f32_16x16x32_bf16 v[192:195], a[80:83], a[108:111], v[192:195]
v_lshlrev_b32 v21, 1, v18
v_lshl_add_u32 v21, v19, 2, v21
v_mfma_f32_16x16x32_bf16 v[152:155], a[144:147], a[108:111], v[152:155]
s_add_u32 m0, s73, 0
s_add_u32 s64, s71, 0
v_lshrrev_b32 v22, 1, v16
v_mfma_f32_16x16x32_bf16 v[200:203], a[144:147], a[104:107], v[200:203]
ds_read_b64_tr_b16 a[68:69], v13 offset:36864
ds_read_b64_tr_b16 a[70:71], v13 offset:37376
v_mfma_f32_16x16x32_bf16 v[208:211], a[144:147], a[100:103], v[208:211]
buffer_load_dwordx4 v5, s[12:15], s64 offen lds
v_mfma_f32_16x16x32_bf16 v[36:39], a[144:147], a[96:99], v[36:39]
ds_read_b64_tr_b16 a[132:133], v14 offset:36864
ds_read_b64_tr_b16 a[134:135], v14 offset:37376
v_mfma_f32_16x16x32_bf16 v[44:47], a[84:87], a[96:99], v[44:47]
v_add_u32 v21, v21, v22
v_mul_u32_u24 v21, 18, v21
v_mfma_f32_16x16x32_bf16 v[32:35], a[84:87], a[100:103], v[32:35]
ds_read_b128 a[72:75], v4 offset:40960
ds_read_b128 a[136:139], v4 offset:41984
v_mfma_f32_16x16x32_bf16 v[52:55], a[84:87], a[104:107], v[52:55]
s_add_u32 s53, s88, 786432
v_and_b32 v22, 1, v16
v_add3_u32 v21, v21, v22, 16
v_mfma_f32_16x16x32_bf16 v[60:63], a[84:87], a[108:111], v[60:63]
ds_read_b128 a[76:79], v4 offset:43008
ds_read_b128 a[140:143], v4 offset:44032
v_mfma_f32_16x16x32_bf16 v[68:71], a[148:151], a[108:111], v[68:71]
buffer_load_dwordx4 v6, s[12:15], s64 offen offset:1024 lds
v_mfma_f32_16x16x32_bf16 v[76:79], a[148:151], a[104:107], v[76:79]
buffer_store_dwordx4 v[128:131], v4, s[24:27], s53 offen offset:0 sc1
v_mfma_f32_16x16x32_bf16 v[84:87], a[148:151], a[100:103], v[84:87]
v_cmp_lt_u32 s[96:97], 1, v19
v_mov_b32 v22, 0x100000
v_mfma_f32_16x16x32_bf16 v[92:95], a[148:151], a[96:99], v[92:95]
v_mul_u32_u24 v23, 1, v23
v_mfma_f32_16x16x32_bf16 v[100:103], a[88:91], a[96:99], v[100:103]
s_add_u32 m0, s73, 2048
s_add_u32 s64, s71, 18432
v_cndmask_b32 v21, v21, v22, s[96:97]
v_mfma_f32_16x16x32_bf16 v[108:111], a[88:91], a[100:103], v[108:111]
v_mov_b32 v22, s52
v_cmp_eq_u32 s[96:97], 4, v22
v_mfma_f32_16x16x32_bf16 v[116:119], a[88:91], a[104:107], v[116:119]
buffer_load_dwordx4 v5, s[12:15], s64 offen lds
v_mfma_f32_16x16x32_bf16 v[40:43], a[88:91], a[108:111], v[40:43]
v_cndmask_b32 v20, v20, v21, s[96:97]
v_mul_u32_u24 v20, 1152, v20
v_mfma_f32_16x16x32_bf16 v[124:127], a[152:155], a[108:111], v[124:127]
v_lshl_add_u32 v20, v17, 4, v20
v_mov_b32 v25, v20
v_mfma_f32_16x16x32_bf16 v[132:135], a[152:155], a[104:107], v[132:135]
v_mov_b32 v16, s54
v_mov_b32 v17, s55
v_mfma_f32_16x16x32_bf16 v[140:143], a[152:155], a[100:103], v[140:143]
v_add_u32 v18, 32, v22
v_mfma_f32_16x16x32_bf16 v[148:151], a[152:155], a[96:99], v[148:151]
s_mul_i32 s82, s55, 165888
s_lshl_b32 s54, s54, 5
s_add_u32 s82, s82, s54
v_mfma_f32_16x16x32_bf16 v[156:159], a[92:95], a[96:99], v[156:159]
buffer_load_dwordx4 v6, s[12:15], s64 offen offset:1024 lds
v_mfma_f32_16x16x32_bf16 v[48:51], a[92:95], a[100:103], v[48:51]
s_and_b32 s52, s2, 1
s_lshr_b32 s54, s3, 1
s_lshl1_add_u32 s52, s52, s54
v_mfma_f32_16x16x32_bf16 v[164:167], a[92:95], a[104:107], v[164:167]
s_mul_i32 s52, s52, 9
s_and_b32 s54, s3, 1
s_mul_i32 s55, s54, 5
v_mfma_f32_16x16x32_bf16 v[172:175], a[92:95], a[108:111], v[172:175]
s_add_u32 s52, s52, s55
s_lshr_b32 s55, s2, 1
s_mul_i32 s81, s55, 1152
v_mfma_f32_16x16x32_bf16 v[180:183], a[156:159], a[108:111], v[180:183]
s_add_u32 s81, s81, s52
s_lshl_b32 s81, s81, 5
v_mfma_f32_16x16x32_bf16 v[188:191], a[156:159], a[104:107], v[188:191]
v_cmp_gt_u32 s[96:97], 5, v1
v_add_u32 v19, s52, v1
v_mfma_f32_16x16x32_bf16 v[56:59], a[156:159], a[100:103], v[56:59]
v_lshrrev_b32 v20, 5, s55
v_and_b32 v21, 31, s55
v_mfma_f32_16x16x32_bf16 v[196:199], a[156:159], a[96:99], v[196:199]
s_waitcnt lgkmcnt(0)
v_cndmask_b32 v16, v16, v19, s[96:97]
v_cndmask_b32 v17, v17, v20, s[96:97]
v_mfma_f32_16x16x32_bf16 v[64:67], a[176:179], a[112:115], v[64:67]
s_waitcnt vmcnt(24)
v_cndmask_b32 v18, v18, v21, s[96:97]
v_mul_u32_u24 v19, 7282, v16
v_mfma_f32_16x16x32_bf16 v[204:207], a[176:179], a[116:119], v[204:207]
s_barrier
v_mfma_f32_16x16x32_bf16 v[212:215], a[176:179], a[120:123], v[212:215]
ds_read_b128 a[96:99], v10 offset:0
ds_read_b128 a[100:103], v10 offset:2048
v_mfma_f32_16x16x32_bf16 v[220:223], a[176:179], a[124:127], v[220:223]
s_xor_b32 s75, s93, 7
s_lshl_b32 s76, s75, 19
s_add_u32 s76, s76, s74
v_mfma_f32_16x16x32_bf16 v[72:75], a[180:183], a[124:127], v[72:75]
s_lshl_b32 s79, s75, 13
s_add_u32 s79, s79, s78
v_lshrrev_b32 v19, 16, v19
v_mfma_f32_16x16x32_bf16 v[228:231], a[180:183], a[120:123], v[228:231]
s_add_u32 m0, s77, 32768
s_add_u32 s64, s76, 0
s_add_u32 s53, s88, 786432
v_mfma_f32_16x16x32_bf16 v[80:83], a[180:183], a[116:119], v[80:83]
buffer_load_dwordx4 v7, s[20:23], s64 offen lds
v_mfma_f32_16x16x32_bf16 v[236:239], a[180:183], a[112:115], v[236:239]
ds_read_b128 a[104:107], v10 offset:4096
ds_read_b128 a[108:111], v10 offset:6144
v_mfma_f32_16x16x32_bf16 v[244:247], a[184:187], a[112:115], v[244:247]
buffer_store_dwordx4 v[136:139], v4, s[24:27], s53 offen offset:1024 sc1
v_mfma_f32_16x16x32_bf16 v[252:255], a[184:187], a[116:119], v[252:255]
ds_read_b64_tr_b16 a[160:161], v11 offset:49152
ds_read_b64_tr_b16 a[162:163], v11 offset:49664
v_mfma_f32_16x16x32_bf16 v[88:91], a[184:187], a[120:123], v[88:91]
buffer_load_dwordx4 v8, s[20:23], s64 offen offset:1024 lds
v_mfma_f32_16x16x32_bf16 v[160:163], a[184:187], a[124:127], v[160:163]
ds_read_b64_tr_b16 a[164:165], v12 offset:49152
ds_read_b64_tr_b16 a[166:167], v12 offset:49664
v_mfma_f32_16x16x32_bf16 v[168:171], a[188:191], a[124:127], v[168:171]
v_mul_u32_u24 v20, 9, v19
v_sub_u32 v16, v16, v20
v_mfma_f32_16x16x32_bf16 v[176:179], a[188:191], a[120:123], v[176:179]
ds_read_b64_tr_b16 a[168:169], v13 offset:49152
ds_read_b64_tr_b16 a[170:171], v13 offset:49664
v_mfma_f32_16x16x32_bf16 v[184:187], a[188:191], a[116:119], v[184:187]
s_add_u32 m0, s80, 32768
s_add_u32 s64, s79, 0
v_lshl_add_u32 v19, v19, 2, v17
v_mfma_f32_16x16x32_bf16 v[248:251], a[188:191], a[112:115], v[248:251]
ds_read_b64_tr_b16 a[172:173], v14 offset:49152
ds_read_b64_tr_b16 a[174:175], v14 offset:49664
v_mfma_f32_16x16x32_bf16 v[240:243], a[64:67], a[112:115], v[240:243]
buffer_load_dwordx4 v4, s[24:27], s64 offen sc1 lds
v_mfma_f32_16x16x32_bf16 v[232:235], a[64:67], a[116:119], v[232:235]
ds_read_b64_tr_b16 a[80:81], v11 offset:53248
ds_read_b64_tr_b16 a[82:83], v11 offset:53760
v_mfma_f32_16x16x32_bf16 v[224:227], a[64:67], a[120:123], v[224:227]
v_mul_u32_u24 v19, 336, v19
v_lshrrev_b32 v20, 1, v16
v_mfma_f32_16x16x32_bf16 v[192:195], a[64:67], a[124:127], v[192:195]
ds_read_b64_tr_b16 a[144:145], v12 offset:53248
ds_read_b64_tr_b16 a[146:147], v12 offset:53760
v_mfma_f32_16x16x32_bf16 v[152:155], a[128:131], a[124:127], v[152:155]
s_add_u32 m0, s73, 4096
s_add_u32 s64, s72, 0
v_sub_u32 v20, v20, v17
v_mfma_f32_16x16x32_bf16 v[200:203], a[128:131], a[120:123], v[200:203]
ds_read_b64_tr_b16 a[84:85], v13 offset:53248
ds_read_b64_tr_b16 a[86:87], v13 offset:53760
v_mfma_f32_16x16x32_bf16 v[208:211], a[128:131], a[116:119], v[208:211]
buffer_load_dwordx4 v5, s[12:15], s64 offen lds
v_mfma_f32_16x16x32_bf16 v[36:39], a[128:131], a[112:115], v[36:39]
ds_read_b64_tr_b16 a[148:149], v14 offset:53248
ds_read_b64_tr_b16 a[150:151], v14 offset:53760
v_mfma_f32_16x16x32_bf16 v[44:47], a[68:71], a[112:115], v[44:47]
v_add_u32 v20, 3, v20
v_and_b32 v20, 3, v20
v_mfma_f32_16x16x32_bf16 v[32:35], a[68:71], a[116:119], v[32:35]
ds_read_b128 a[88:91], v4 offset:57344
ds_read_b128 a[152:155], v4 offset:58368
v_mfma_f32_16x16x32_bf16 v[52:55], a[68:71], a[120:123], v[52:55]
v_cmp_eq_u32 s[96:97], 8, v16
v_and_b32 v16, 1, v16
v_mfma_f32_16x16x32_bf16 v[60:63], a[68:71], a[124:127], v[60:63]
ds_read_b128 a[92:95], v4 offset:59392
ds_read_b128 a[156:159], v4 offset:60416
v_mfma_f32_16x16x32_bf16 v[68:71], a[132:135], a[124:127], v[68:71]
buffer_load_dwordx4 v6, s[12:15], s64 offen offset:1024 lds
v_mfma_f32_16x16x32_bf16 v[76:79], a[132:135], a[120:123], v[76:79]
v_lshlrev_b32 v21, 1, v20
v_mul_u32_u24 v22, 74, v20
v_mfma_f32_16x16x32_bf16 v[84:87], a[132:135], a[116:119], v[84:87]
v_cndmask_b32 v21, v21, 4, s[96:97]
v_cndmask_b32 v20, v20, 0, s[96:97]
v_mfma_f32_16x16x32_bf16 v[92:95], a[132:135], a[112:115], v[92:95]
v_mad_u32_u24 v21, v18, 5, v21
v_lshl_add_u32 v22, v18, 1, v22
v_mfma_f32_16x16x32_bf16 v[100:103], a[72:75], a[112:115], v[100:103]
s_add_u32 m0, s73, 6144
s_add_u32 s64, s72, 18432
s_add_u32 s53, s88, 786432
v_mfma_f32_16x16x32_bf16 v[108:111], a[72:75], a[116:119], v[108:111]
buffer_store_dwordx4 v[144:147], v4, s[24:27], s53 offen offset:2048 sc1
v_mfma_f32_16x16x32_bf16 v[116:119], a[72:75], a[120:123], v[116:119]
buffer_load_dwordx4 v5, s[12:15], s64 offen lds
v_mfma_f32_16x16x32_bf16 v[40:43], a[72:75], a[124:127], v[40:43]
v_cmp_gt_u32 s[96:97], 2, v20
v_add_u32 v22, 37, v22
v_mfma_f32_16x16x32_bf16 v[124:127], a[136:139], a[124:127], v[124:127]
v_add_u32 v19, v19, v16
v_mfma_f32_16x16x32_bf16 v[132:135], a[136:139], a[120:123], v[132:135]
v_cndmask_b32 v21, v22, v21, s[96:97]
v_add_lshl_u32 v19, v19, v21, 10
v_mfma_f32_16x16x32_bf16 v[140:143], a[136:139], a[116:119], v[140:143]
v_add_u32 v19, 38797312, v19
v_mfma_f32_16x16x32_bf16 v[148:151], a[136:139], a[112:115], v[148:151]
s_cmp_eq_u32 s54, 1
s_cselect_b32 s96, 16, 0
v_mfma_f32_16x16x32_bf16 v[156:159], a[76:79], a[112:115], v[156:159]
buffer_load_dwordx4 v6, s[12:15], s64 offen offset:1024 lds
v_mfma_f32_16x16x32_bf16 v[48:51], a[76:79], a[116:119], v[48:51]
v_add_u32 v9, 32768, v9
v_add_u32 v10, 32768, v10
v_mfma_f32_16x16x32_bf16 v[164:167], a[76:79], a[120:123], v[164:167]
s_cmp_eq_u32 s3, 3
s_cselect_b32 s52, 32, 0
s_or_b32 s96, s96, s52
v_mfma_f32_16x16x32_bf16 v[172:175], a[76:79], a[124:127], v[172:175]
s_cmp_ge_u32 s2, 240
s_cselect_b32 s52, 32, 0
s_or_b32 s96, s96, s52
v_mfma_f32_16x16x32_bf16 v[180:183], a[140:143], a[124:127], v[180:183]
s_mov_b32 s97, 0
v_mfma_f32_16x16x32_bf16 v[188:191], a[140:143], a[120:123], v[188:191]
v_mov_b32 v20, 2147418112
v_cndmask_b32 v26, v19, v20, s[96:97]
v_mfma_f32_16x16x32_bf16 v[56:59], a[140:143], a[116:119], v[56:59]
v_lshlrev_b32 v27, 3, v1
v_add_u32 v27, s83, v27
v_mfma_f32_16x16x32_bf16 v[196:199], a[140:143], a[112:115], v[196:199]
s_waitcnt lgkmcnt(0)
v_mov_b32 v16, 0x3f803f80
v_accvgpr_write_b32 a240, v16
v_mfma_f32_16x16x32_bf16 v[64:67], a[160:163], a[96:99], v[64:67]
s_waitcnt vmcnt(19)
v_accvgpr_write_b32 a241, v16
v_accvgpr_write_b32 a242, v16
v_mfma_f32_16x16x32_bf16 v[204:207], a[160:163], a[100:103], v[204:207]
s_barrier
v_mfma_f32_16x16x32_bf16 v[212:215], a[160:163], a[104:107], v[212:215]
ds_read_b128 a[112:115], v9 offset:0
ds_read_b128 a[116:119], v9 offset:2048
v_mfma_f32_16x16x32_bf16 v[220:223], a[160:163], a[108:111], v[220:223]
s_add_u32 m0, s77, 49152
s_add_u32 s64, s76, 262144
v_accvgpr_write_b32 a243, v16
v_mfma_f32_16x16x32_bf16 v[72:75], a[164:167], a[108:111], v[72:75]
buffer_load_dwordx4 v7, s[20:23], s64 offen lds
v_mfma_f32_16x16x32_bf16 v[228:231], a[164:167], a[104:107], v[228:231]
ds_read_b128 a[120:123], v9 offset:4096
ds_read_b128 a[124:127], v9 offset:6144
v_mfma_f32_16x16x32_bf16 v[80:83], a[164:167], a[100:103], v[80:83]
buffer_load_dword v30, v29, s[24:27], s89 offen offset:4 sc1
v_mfma_f32_16x16x32_bf16 v[236:239], a[164:167], a[96:99], v[236:239]
ds_read_b64_tr_b16 a[176:177], v11 offset:0
ds_read_b64_tr_b16 a[178:179], v11 offset:512
v_mfma_f32_16x16x32_bf16 v[244:247], a[168:171], a[96:99], v[244:247]
v_accvgpr_write_b32 a232, 0
v_accvgpr_write_b32 a233, 0
v_mfma_f32_16x16x32_bf16 v[252:255], a[168:171], a[100:103], v[252:255]
ds_read_b64_tr_b16 a[180:181], v12 offset:0
ds_read_b64_tr_b16 a[182:183], v12 offset:512
v_mfma_f32_16x16x32_bf16 v[88:91], a[168:171], a[104:107], v[88:91]
buffer_load_dwordx4 v8, s[20:23], s64 offen offset:1024 lds
v_mfma_f32_16x16x32_bf16 v[160:163], a[168:171], a[108:111], v[160:163]
s_add_u32 s53, s88, 786432
ds_read_b64_tr_b16 a[184:185], v13 offset:0
ds_read_b64_tr_b16 a[186:187], v13 offset:512
v_mfma_f32_16x16x32_bf16 v[168:171], a[172:175], a[108:111], v[168:171]
buffer_store_dwordx4 a[32:35], v4, s[24:27], s53 offen offset:3072 sc1
v_mfma_f32_16x16x32_bf16 v[176:179], a[172:175], a[104:107], v[176:179]
ds_read_b64_tr_b16 a[188:189], v14 offset:0
ds_read_b64_tr_b16 a[190:191], v14 offset:512
v_mfma_f32_16x16x32_bf16 v[184:187], a[172:175], a[100:103], v[184:187]
s_add_u32 m0, s80, 49152
s_add_u32 s64, s79, 4096
v_accvgpr_write_b32 a234, 0
v_mfma_f32_16x16x32_bf16 v[248:251], a[172:175], a[96:99], v[248:251]
ds_read_b64_tr_b16 a[64:65], v11 offset:4096
ds_read_b64_tr_b16 a[66:67], v11 offset:4608
v_mfma_f32_16x16x32_bf16 v[240:243], a[80:83], a[96:99], v[240:243]
buffer_load_dwordx4 v4, s[24:27], s64 offen sc1 lds
v_mfma_f32_16x16x32_bf16 v[232:235], a[80:83], a[100:103], v[232:235]
s_mov_b32 s65, 1024
s_add_u32 s71, s68, s65
s_add_u32 s72, s69, s65
v_mfma_f32_16x16x32_bf16 v[224:227], a[80:83], a[104:107], v[224:227]
ds_read_b64_tr_b16 a[128:129], v12 offset:4096
ds_read_b64_tr_b16 a[130:131], v12 offset:4608
v_mfma_f32_16x16x32_bf16 v[192:195], a[80:83], a[108:111], v[192:195]
v_accvgpr_write_b32 a235, 0
v_accvgpr_write_b32 a236, 0
v_mfma_f32_16x16x32_bf16 v[152:155], a[144:147], a[108:111], v[152:155]
s_add_u32 m0, s73, 32768
s_add_u32 s64, s71, 0
v_accvgpr_write_b32 a237, 0
v_mfma_f32_16x16x32_bf16 v[200:203], a[144:147], a[104:107], v[200:203]
ds_read_b64_tr_b16 a[68:69], v13 offset:4096
ds_read_b64_tr_b16 a[70:71], v13 offset:4608
v_mfma_f32_16x16x32_bf16 v[208:211], a[144:147], a[100:103], v[208:211]
buffer_load_dwordx4 v5, s[12:15], s64 offen lds
v_mfma_f32_16x16x32_bf16 v[36:39], a[144:147], a[96:99], v[36:39]
ds_read_b64_tr_b16 a[132:133], v14 offset:4096
ds_read_b64_tr_b16 a[134:135], v14 offset:4608
v_mfma_f32_16x16x32_bf16 v[44:47], a[84:87], a[96:99], v[44:47]
v_accvgpr_write_b32 a238, 0
v_accvgpr_write_b32 a239, 0
v_mfma_f32_16x16x32_bf16 v[32:35], a[84:87], a[100:103], v[32:35]
ds_read_b128 a[72:75], v4 offset:8192
ds_read_b128 a[136:139], v4 offset:9216
v_mfma_f32_16x16x32_bf16 v[52:55], a[84:87], a[104:107], v[52:55]
v_lshlrev_b32 v16, 2, v3
v_sub_u32 v16, v2, v16
v_mfma_f32_16x16x32_bf16 v[60:63], a[84:87], a[108:111], v[60:63]
ds_read_b128 a[76:79], v4 offset:10240
ds_read_b128 a[140:143], v4 offset:11264
v_mfma_f32_16x16x32_bf16 v[68:71], a[148:151], a[108:111], v[68:71]
buffer_load_dwordx4 v6, s[12:15], s64 offen offset:1024 lds
v_mfma_f32_16x16x32_bf16 v[76:79], a[148:151], a[104:107], v[76:79]
v_cmp_gt_i32 s[56:57], 0, v16
v_cmp_gt_i32 s[58:59], 1, v16
v_mfma_f32_16x16x32_bf16 v[84:87], a[148:151], a[100:103], v[84:87]
v_cmp_gt_i32 s[60:61], 2, v16
v_cmp_gt_i32 s[62:63], 3, v16
v_mfma_f32_16x16x32_bf16 v[92:95], a[148:151], a[96:99], v[92:95]
v_cmp_eq_u32 s[96:97], 3, v3
v_add_u32 v17, 48, v2
v_mfma_f32_16x16x32_bf16 v[100:103], a[88:91], a[96:99], v[100:103]
s_add_u32 m0, s73, 34816
s_add_u32 s64, s71, 18432
v_lshlrev_b32 v17, 2, v17
v_mfma_f32_16x16x32_bf16 v[108:111], a[88:91], a[100:103], v[108:111]
v_lshlrev_b32 v18, 16, v3
v_lshl_add_u32 v18, v2, 4, v18
v_mfma_f32_16x16x32_bf16 v[116:119], a[88:91], a[104:107], v[116:119]
buffer_load_dwordx4 v5, s[12:15], s64 offen lds
v_mfma_f32_16x16x32_bf16 v[40:43], a[88:91], a[108:111], v[40:43]
v_add_u32 v19, 0x8000, v18
v_cndmask_b32 v19, v19, v20, s[96:97]
v_mfma_f32_16x16x32_bf16 v[124:127], a[152:155], a[108:111], v[124:127]
v_mov_b32 v216, 0
v_mov_b32 v217, 0
v_mfma_f32_16x16x32_bf16 v[132:135], a[152:155], a[104:107], v[132:135]
v_mov_b32 v218, 0
v_mov_b32 v219, 0
v_mfma_f32_16x16x32_bf16 v[140:143], a[152:155], a[100:103], v[140:143]
s_add_u32 s53, s87, 524288
v_mov_b32 v96, 0
v_mov_b32 v97, 0
v_mfma_f32_16x16x32_bf16 v[148:151], a[152:155], a[96:99], v[148:151]
buffer_store_dwordx4 a[28:31], v4, s[24:27], s53 offen offset:0 sc1
v_mfma_f32_16x16x32_bf16 v[156:159], a[92:95], a[96:99], v[156:159]
buffer_load_dwordx4 v6, s[12:15], s64 offen offset:1024 lds
v_mfma_f32_16x16x32_bf16 v[48:51], a[92:95], a[100:103], v[48:51]
v_mov_b32 v98, 0
v_mov_b32 v99, 0
v_mfma_f32_16x16x32_bf16 v[164:167], a[92:95], a[104:107], v[164:167]
v_mov_b32 v104, 0
v_mov_b32 v105, 0
v_mfma_f32_16x16x32_bf16 v[172:175], a[92:95], a[108:111], v[172:175]
v_mov_b32 v106, 0
v_mov_b32 v107, 0
v_mfma_f32_16x16x32_bf16 v[180:183], a[156:159], a[108:111], v[180:183]
v_mov_b32 v112, 0
v_mov_b32 v113, 0
v_mfma_f32_16x16x32_bf16 v[188:191], a[156:159], a[104:107], v[188:191]
v_mov_b32 v114, 0
v_mov_b32 v115, 0
v_mfma_f32_16x16x32_bf16 v[56:59], a[156:159], a[100:103], v[56:59]
v_mov_b32 v120, 0
v_mov_b32 v121, 0
v_mfma_f32_16x16x32_bf16 v[196:199], a[156:159], a[96:99], v[196:199]
s_waitcnt lgkmcnt(0)
v_mov_b32 v122, 0
v_mov_b32 v123, 0
v_mfma_f32_16x16x32_bf16 v[64:67], a[176:179], a[112:115], v[64:67]
s_waitcnt vmcnt(24)
v_mov_b32 v128, 0
v_mov_b32 v129, 0
v_mfma_f32_16x16x32_bf16 v[204:207], a[176:179], a[116:119], v[204:207]
s_barrier
v_mfma_f32_16x16x32_bf16 v[212:215], a[176:179], a[120:123], v[212:215]
ds_read_b128 a[96:99], v10 offset:0
ds_read_b128 a[100:103], v10 offset:2048
v_mfma_f32_16x16x32_bf16 v[220:223], a[176:179], a[124:127], v[220:223]
s_mov_b32 s75, 8
s_lshl_b32 s76, s75, 19
s_add_u32 s76, s76, s74
v_mfma_f32_16x16x32_bf16 v[72:75], a[180:183], a[124:127], v[72:75]
s_lshl_b32 s79, s75, 13
s_add_u32 s79, s79, s78
v_mov_b32 v130, 0
v_mfma_f32_16x16x32_bf16 v[228:231], a[180:183], a[120:123], v[228:231]
s_add_u32 m0, s77, 0
s_add_u32 s64, s76, 0
v_mov_b32 v131, 0
v_mfma_f32_16x16x32_bf16 v[80:83], a[180:183], a[116:119], v[80:83]
buffer_load_dwordx4 v7, s[20:23], s64 offen lds
v_mfma_f32_16x16x32_bf16 v[236:239], a[180:183], a[112:115], v[236:239]
ds_read_b128 a[104:107], v10 offset:4096
ds_read_b128 a[108:111], v10 offset:6144
v_mfma_f32_16x16x32_bf16 v[244:247], a[184:187], a[112:115], v[244:247]
v_mov_b32 v136, 0
v_mov_b32 v137, 0
v_mfma_f32_16x16x32_bf16 v[252:255], a[184:187], a[116:119], v[252:255]
ds_read_b64_tr_b16 a[160:161], v11 offset:16384
ds_read_b64_tr_b16 a[162:163], v11 offset:16896
v_mfma_f32_16x16x32_bf16 v[88:91], a[184:187], a[120:123], v[88:91]
buffer_load_dwordx4 v8, s[20:23], s64 offen offset:1024 lds
v_mfma_f32_16x16x32_bf16 v[160:163], a[184:187], a[124:127], v[160:163]
ds_read_b64_tr_b16 a[164:165], v12 offset:16384
ds_read_b64_tr_b16 a[166:167], v12 offset:16896
v_mfma_f32_16x16x32_bf16 v[168:171], a[188:191], a[124:127], v[168:171]
v_mov_b32 v138, 0
v_mov_b32 v139, 0
v_mfma_f32_16x16x32_bf16 v[176:179], a[188:191], a[120:123], v[176:179]
ds_read_b64_tr_b16 a[168:169], v13 offset:16384
ds_read_b64_tr_b16 a[170:171], v13 offset:16896
v_mfma_f32_16x16x32_bf16 v[184:187], a[188:191], a[116:119], v[184:187]
s_add_u32 m0, s80, 0
s_add_u32 s64, s79, 0
v_mov_b32 v144, 0
v_mfma_f32_16x16x32_bf16 v[248:251], a[188:191], a[112:115], v[248:251]
ds_read_b64_tr_b16 a[172:173], v14 offset:16384
ds_read_b64_tr_b16 a[174:175], v14 offset:16896
v_mfma_f32_16x16x32_bf16 v[240:243], a[64:67], a[112:115], v[240:243]
buffer_load_dwordx4 v4, s[24:27], s64 offen sc1 lds
v_mfma_f32_16x16x32_bf16 v[232:235], a[64:67], a[116:119], v[232:235]
s_add_u32 s53, s87, 524288
ds_read_b64_tr_b16 a[80:81], v11 offset:20480
ds_read_b64_tr_b16 a[82:83], v11 offset:20992
v_mfma_f32_16x16x32_bf16 v[224:227], a[64:67], a[120:123], v[224:227]
buffer_store_dwordx4 a[20:23], v4, s[24:27], s53 offen offset:1024 sc1
v_mfma_f32_16x16x32_bf16 v[192:195], a[64:67], a[124:127], v[192:195]
ds_read_b64_tr_b16 a[144:145], v12 offset:20480
ds_read_b64_tr_b16 a[146:147], v12 offset:20992
v_mfma_f32_16x16x32_bf16 v[152:155], a[128:131], a[124:127], v[152:155]
s_add_u32 m0, s73, 36864
s_add_u32 s64, s72, 0
v_mov_b32 v145, 0
v_mfma_f32_16x16x32_bf16 v[200:203], a[128:131], a[120:123], v[200:203]
ds_read_b64_tr_b16 a[84:85], v13 offset:20480
ds_read_b64_tr_b16 a[86:87], v13 offset:20992
v_mfma_f32_16x16x32_bf16 v[208:211], a[128:131], a[116:119], v[208:211]
buffer_load_dwordx4 v5, s[12:15], s64 offen lds
v_mfma_f32_16x16x32_bf16 v[36:39], a[128:131], a[112:115], v[36:39]
ds_read_b64_tr_b16 a[148:149], v14 offset:20480
ds_read_b64_tr_b16 a[150:151], v14 offset:20992
v_mfma_f32_16x16x32_bf16 v[44:47], a[68:71], a[112:115], v[44:47]
v_mov_b32 v146, 0
v_mov_b32 v147, 0
v_mfma_f32_16x16x32_bf16 v[32:35], a[68:71], a[116:119], v[32:35]
ds_read_b128 a[88:91], v4 offset:24576
ds_read_b128 a[152:155], v4 offset:25600
v_mfma_f32_16x16x32_bf16 v[52:55], a[68:71], a[120:123], v[52:55]
v_mfma_f32_16x16x32_bf16 v[60:63], a[68:71], a[124:127], v[60:63]
ds_read_b128 a[92:95], v4 offset:26624
ds_read_b128 a[156:159], v4 offset:27648
v_mfma_f32_16x16x32_bf16 v[68:71], a[132:135], a[124:127], v[68:71]
buffer_load_dwordx4 v6, s[12:15], s64 offen offset:1024 lds
v_mfma_f32_16x16x32_bf16 v[76:79], a[132:135], a[120:123], v[76:79]
v_mfma_f32_16x16x32_bf16 v[84:87], a[132:135], a[116:119], v[84:87]
v_mfma_f32_16x16x32_bf16 v[92:95], a[132:135], a[112:115], v[92:95]
v_mfma_f32_16x16x32_bf16 v[100:103], a[72:75], a[112:115], v[100:103]
s_add_u32 m0, s73, 38912
s_add_u32 s64, s72, 18432
v_mfma_f32_16x16x32_bf16 v[108:111], a[72:75], a[116:119], v[108:111]
v_mfma_f32_16x16x32_bf16 v[116:119], a[72:75], a[120:123], v[116:119]
buffer_load_dwordx4 v5, s[12:15], s64 offen lds
v_mfma_f32_16x16x32_bf16 v[40:43], a[72:75], a[124:127], v[40:43]
v_mfma_f32_16x16x32_bf16 v[124:127], a[136:139], a[124:127], v[124:127]
v_mfma_f32_16x16x32_bf16 v[132:135], a[136:139], a[120:123], v[132:135]
v_mfma_f32_16x16x32_bf16 v[140:143], a[136:139], a[116:119], v[140:143]
v_mfma_f32_16x16x32_bf16 v[148:151], a[136:139], a[112:115], v[148:151]
v_mfma_f32_16x16x32_bf16 v[156:159], a[76:79], a[112:115], v[156:159]
buffer_load_dwordx4 v6, s[12:15], s64 offen offset:1024 lds
v_mfma_f32_16x16x32_bf16 v[48:51], a[76:79], a[116:119], v[48:51]
v_add_u32 v9, -65536, v9
v_add_u32 v10, -65536, v10
v_mfma_f32_16x16x32_bf16 v[164:167], a[76:79], a[120:123], v[164:167]
v_mfma_f32_16x16x32_bf16 v[172:175], a[76:79], a[124:127], v[172:175]
v_mfma_f32_16x16x32_bf16 v[180:183], a[140:143], a[124:127], v[180:183]
s_add_u32 s53, s87, 528384
v_mfma_f32_16x16x32_bf16 v[188:191], a[140:143], a[120:123], v[188:191]
buffer_store_dwordx4 a[12:15], v4, s[24:27], s53 offen offset:0 sc1
v_mfma_f32_16x16x32_bf16 v[56:59], a[140:143], a[116:119], v[56:59]
v_mfma_f32_16x16x32_bf16 v[196:199], a[140:143], a[112:115], v[196:199]
s_waitcnt lgkmcnt(0)
v_mfma_f32_16x16x32_bf16 v[64:67], a[160:163], a[96:99], v[64:67]
s_waitcnt vmcnt(19)
v_mfma_f32_16x16x32_bf16 v[204:207], a[160:163], a[100:103], v[204:207]
s_barrier
v_mfma_f32_16x16x32_bf16 v[212:215], a[160:163], a[104:107], v[212:215]
ds_read_b128 a[112:115], v9 offset:0
ds_read_b128 a[116:119], v9 offset:2048
v_mfma_f32_16x16x32_bf16 v[220:223], a[160:163], a[108:111], v[220:223]
s_add_u32 m0, s77, 16384
s_add_u32 s64, s76, 262144
v_mfma_f32_16x16x32_bf16 v[72:75], a[164:167], a[108:111], v[72:75]
buffer_load_dwordx4 v7, s[20:23], s64 offen lds
v_mfma_f32_16x16x32_bf16 v[228:231], a[164:167], a[104:107], v[228:231]
ds_read_b128 a[120:123], v9 offset:4096
ds_read_b128 a[124:127], v9 offset:6144
v_mfma_f32_16x16x32_bf16 v[80:83], a[164:167], a[100:103], v[80:83]
v_mfma_f32_16x16x32_bf16 v[236:239], a[164:167], a[96:99], v[236:239]
ds_read_b64_tr_b16 a[176:177], v11 offset:32768
ds_read_b64_tr_b16 a[178:179], v11 offset:33280
v_mfma_f32_16x16x32_bf16 v[244:247], a[168:171], a[96:99], v[244:247]
buffer_load_dwordx4 v8, s[20:23], s64 offen offset:1024 lds
v_mfma_f32_16x16x32_bf16 v[252:255], a[168:171], a[100:103], v[252:255]
ds_read_b64_tr_b16 a[180:181], v12 offset:32768
ds_read_b64_tr_b16 a[182:183], v12 offset:33280
v_mfma_f32_16x16x32_bf16 v[88:91], a[168:171], a[104:107], v[88:91]
v_mfma_f32_16x16x32_bf16 v[160:163], a[168:171], a[108:111], v[160:163]
s_add_u32 m0, s80, 16384
s_add_u32 s64, s79, 4096
v_mfma_f32_16x16x32_bf16 v[168:171], a[172:175], a[108:111], v[168:171]
ds_read_b64_tr_b16 a[184:185], v13 offset:32768
ds_read_b64_tr_b16 a[186:187], v13 offset:33280
v_mfma_f32_16x16x32_bf16 v[176:179], a[172:175], a[104:107], v[176:179]
buffer_load_dwordx4 v4, s[24:27], s64 offen sc1 lds
v_mfma_f32_16x16x32_bf16 v[184:187], a[172:175], a[100:103], v[184:187]
ds_read_b64_tr_b16 a[188:189], v14 offset:32768
ds_read_b64_tr_b16 a[190:191], v14 offset:33280
v_mfma_f32_16x16x32_bf16 v[248:251], a[172:175], a[96:99], v[248:251]
v_mfma_f32_16x16x32_bf16 v[240:243], a[80:83], a[96:99], v[240:243]
s_add_u32 m0, s83, 0
s_add_u32 s64, s81, 0
v_mfma_f32_16x16x32_bf16 v[232:235], a[80:83], a[100:103], v[232:235]
ds_read_b64_tr_b16 a[64:65], v11 offset:36864
ds_read_b64_tr_b16 a[66:67], v11 offset:37376
v_mfma_f32_16x16x32_bf16 v[224:227], a[80:83], a[104:107], v[224:227]
buffer_load_dwordx4 v24, s[32:35], s64 offen lds
v_mfma_f32_16x16x32_bf16 v[192:195], a[80:83], a[108:111], v[192:195]
ds_read_b64_tr_b16 a[128:129], v12 offset:36864
ds_read_b64_tr_b16 a[130:131], v12 offset:37376
v_mfma_f32_16x16x32_bf16 v[152:155], a[144:147], a[108:111], v[152:155]
s_add_u32 m0, s83, 1024
s_add_u32 s64, s81, 32
v_mfma_f32_16x16x32_bf16 v[200:203], a[144:147], a[104:107], v[200:203]
ds_read_b64_tr_b16 a[68:69], v13 offset:36864
ds_read_b64_tr_b16 a[70:71], v13 offset:37376
v_mfma_f32_16x16x32_bf16 v[208:211], a[144:147], a[100:103], v[208:211]
buffer_load_dwordx4 v24, s[32:35], s64 offen lds
v_mfma_f32_16x16x32_bf16 v[36:39], a[144:147], a[96:99], v[36:39]
s_add_u32 s53, s87, 528384
ds_read_b64_tr_b16 a[132:133], v14 offset:36864
ds_read_b64_tr_b16 a[134:135], v14 offset:37376
v_mfma_f32_16x16x32_bf16 v[44:47], a[84:87], a[96:99], v[44:47]
buffer_store_dwordx4 a[4:7], v4, s[24:27], s53 offen offset:1024 sc1
v_mfma_f32_16x16x32_bf16 v[32:35], a[84:87], a[100:103], v[32:35]
s_add_u32 m0, s83, 2048
s_add_u32 s64, s81, 64
v_mfma_f32_16x16x32_bf16 v[52:55], a[84:87], a[104:107], v[52:55]
ds_read_b128 a[72:75], v4 offset:40960
ds_read_b128 a[136:139], v4 offset:41984
v_mfma_f32_16x16x32_bf16 v[60:63], a[84:87], a[108:111], v[60:63]
buffer_load_dwordx4 v24, s[32:35], s64 offen lds
v_mfma_f32_16x16x32_bf16 v[68:71], a[148:151], a[108:111], v[68:71]
ds_read_b128 a[76:79], v4 offset:43008
ds_read_b128 a[140:143], v4 offset:44032
v_mfma_f32_16x16x32_bf16 v[76:79], a[148:151], a[104:107], v[76:79]
v_mfma_f32_16x16x32_bf16 v[84:87], a[148:151], a[100:103], v[84:87]
s_add_u32 m0, s83, 3072
s_add_u32 s64, s81, 96
v_mfma_f32_16x16x32_bf16 v[92:95], a[148:151], a[96:99], v[92:95]
v_mfma_f32_16x16x32_bf16 v[100:103], a[88:91], a[96:99], v[100:103]
buffer_load_dwordx4 v24, s[32:35], s64 offen lds
v_mfma_f32_16x16x32_bf16 v[108:111], a[88:91], a[100:103], v[108:111]
v_mfma_f32_16x16x32_bf16 v[116:119], a[88:91], a[104:107], v[116:119]
s_add_u32 m0, s83, 4096
s_add_u32 s64, s81, 128
s_waitcnt vmcnt(25)
v_mfma_f32_16x16x32_bf16 v[40:43], a[88:91], a[108:111], v[40:43]
v_cmp_gt_u32 vcc, 8, v30
v_mfma_f32_16x16x32_bf16 v[124:127], a[152:155], a[108:111], v[124:127]
buffer_load_dwordx4 v24, s[32:35], s64 offen lds
v_mfma_f32_16x16x32_bf16 v[132:135], a[152:155], a[104:107], v[132:135]
v_mfma_f32_16x16x32_bf16 v[140:143], a[152:155], a[100:103], v[140:143]
v_mfma_f32_16x16x32_bf16 v[148:151], a[152:155], a[96:99], v[148:151]
s_add_u32 m0, s83, 5120
s_add_u32 s64, s82, 0
v_mfma_f32_16x16x32_bf16 v[156:159], a[92:95], a[96:99], v[156:159]
s_cbranch_vccnz CK_KV
CK_KV_R:
v_mfma_f32_16x16x32_bf16 v[48:51], a[92:95], a[100:103], v[48:51]
buffer_load_dwordx4 v25, s[48:51], s64 offen lds
v_mfma_f32_16x16x32_bf16 v[164:167], a[92:95], a[104:107], v[164:167]
v_mfma_f32_16x16x32_bf16 v[172:175], a[92:95], a[108:111], v[172:175]
v_mfma_f32_16x16x32_bf16 v[180:183], a[156:159], a[108:111], v[180:183]
v_mfma_f32_16x16x32_bf16 v[188:191], a[156:159], a[104:107], v[188:191]
v_mfma_f32_16x16x32_bf16 v[56:59], a[156:159], a[100:103], v[56:59]
v_mfma_f32_16x16x32_bf16 v[196:199], a[156:159], a[96:99], v[196:199]
s_waitcnt lgkmcnt(0)
v_mfma_f32_16x16x32_bf16 v[64:67], a[176:179], a[112:115], v[64:67]
s_waitcnt vmcnt(24)
v_mov_b32 v6, 0xf149f2ca
v_mfma_f32_16x16x32_bf16 v[204:207], a[176:179], a[116:119], v[204:207]
s_barrier
v_mfma_f32_16x16x32_bf16 v[212:215], a[176:179], a[120:123], v[212:215]
s_add_u32 s53, s87, 786432
ds_read_b128 a[96:99], v10 offset:0
ds_read_b128 a[100:103], v10 offset:2048
v_mfma_f32_16x16x32_bf16 v[220:223], a[176:179], a[124:127], v[220:223]
s_lshl_b32 s70, s3, 12
s_mul_i32 s68, s4, 1064960
s_add_u32 s68, s68, s70
v_mfma_f32_16x16x32_bf16 v[72:75], a[180:183], a[124:127], v[72:75]
s_add_u32 m0, s70, 32768
s_add_u32 s64, s68, 0
v_mfma_f32_16x16x32_bf16 v[228:231], a[180:183], a[120:123], v[228:231]
buffer_load_dwordx4 v4, s[24:27], s64 offen offset:0 sc1 lds
v_mfma_f32_16x16x32_bf16 v[80:83], a[180:183], a[116:119], v[80:83]
ds_read_b128 a[104:107], v10 offset:4096
ds_read_b128 a[108:111], v10 offset:6144
v_mfma_f32_16x16x32_bf16 v[236:239], a[180:183], a[112:115], v[236:239]
buffer_store_dwordx4 a[0:3], v4, s[24:27], s53 offen offset:0 sc1
v_mfma_f32_16x16x32_bf16 v[244:247], a[184:187], a[112:115], v[244:247]
ds_read_b64_tr_b16 a[160:161], v11 offset:49152
ds_read_b64_tr_b16 a[162:163], v11 offset:49664
v_mfma_f32_16x16x32_bf16 v[252:255], a[184:187], a[116:119], v[252:255]
s_cmp_eq_u32 s66, 0
s_cbranch_scc1 D0
D0_R:
v_mfma_f32_16x16x32_bf16 v[88:91], a[184:187], a[120:123], v[88:91]
s_lshl_b32 s52, s4, 18
ds_read_b64_tr_b16 a[164:165], v12 offset:49152
ds_read_b64_tr_b16 a[166:167], v12 offset:49664
v_mfma_f32_16x16x32_bf16 v[160:163], a[184:187], a[124:127], v[160:163]
s_add_u32 s52, s52, 45088768
s_lshl_b32 s54, s66, 9
s_add_u32 s54, s54, s52
v_mfma_f32_16x16x32_bf16 v[168:171], a[188:191], a[124:127], v[168:171]
s_lshl_b32 s55, s67, 9
ds_read_b64_tr_b16 a[168:169], v13 offset:49152
ds_read_b64_tr_b16 a[170:171], v13 offset:49664
v_mfma_f32_16x16x32_bf16 v[176:179], a[188:191], a[120:123], v[176:179]
s_add_u32 s55, s55, s52
v_mfma_f32_16x16x32_bf16 v[184:187], a[188:191], a[116:119], v[184:187]
buffer_load_dwordx4 v4, s[24:27], s64 offen offset:1024 sc1 lds
v_mfma_f32_16x16x32_bf16 v[248:251], a[188:191], a[112:115], v[248:251]
ds_read_b64_tr_b16 a[172:173], v14 offset:49152
ds_read_b64_tr_b16 a[174:175], v14 offset:49664
v_mfma_f32_16x16x32_bf16 v[240:243], a[64:67], a[112:115], v[240:243]
v_mfma_f32_16x16x32_bf16 v[232:235], a[64:67], a[116:119], v[232:235]
ds_read_b64_tr_b16 a[80:81], v11 offset:53248
ds_read_b64_tr_b16 a[82:83], v11 offset:53760
v_mfma_f32_16x16x32_bf16 v[224:227], a[64:67], a[120:123], v[224:227]
v_mfma_f32_16x16x32_bf16 v[192:195], a[64:67], a[124:127], v[192:195]
ds_read_b64_tr_b16 a[144:145], v12 offset:53248
ds_read_b64_tr_b16 a[146:147], v12 offset:53760
v_mfma_f32_16x16x32_bf16 v[152:155], a[128:131], a[124:127], v[152:155]
v_mfma_f32_16x16x32_bf16 v[200:203], a[128:131], a[120:123], v[200:203]
ds_read_b64_tr_b16 a[84:85], v13 offset:53248
ds_read_b64_tr_b16 a[86:87], v13 offset:53760
v_mfma_f32_16x16x32_bf16 v[208:211], a[128:131], a[116:119], v[208:211]
v_mfma_f32_16x16x32_bf16 v[36:39], a[128:131], a[112:115], v[36:39]
ds_read_b64_tr_b16 a[148:149], v14 offset:53248
ds_read_b64_tr_b16 a[150:151], v14 offset:53760
v_mfma_f32_16x16x32_bf16 v[44:47], a[68:71], a[112:115], v[44:47]
v_mfma_f32_16x16x32_bf16 v[32:35], a[68:71], a[116:119], v[32:35]
buffer_load_dwordx4 v4, s[24:27], s64 offen offset:2048 sc1 lds
v_mfma_f32_16x16x32_bf16 v[52:55], a[68:71], a[120:123], v[52:55]
ds_read_b128 a[88:91], v4 offset:57344
ds_read_b128 a[152:155], v4 offset:58368
v_mfma_f32_16x16x32_bf16 v[60:63], a[68:71], a[124:127], v[60:63]
v_mfma_f32_16x16x32_bf16 v[68:71], a[132:135], a[124:127], v[68:71]
ds_read_b128 a[92:95], v4 offset:59392
ds_read_b128 a[156:159], v4 offset:60416
v_mfma_f32_16x16x32_bf16 v[76:79], a[132:135], a[120:123], v[76:79]
s_add_u32 s53, s87, 786432
v_mfma_f32_16x16x32_bf16 v[84:87], a[132:135], a[116:119], v[84:87]
buffer_store_dwordx4 a[8:11], v4, s[24:27], s53 offen offset:1024 sc1
v_mfma_f32_16x16x32_bf16 v[92:95], a[132:135], a[112:115], v[92:95]
v_mfma_f32_16x16x32_bf16 v[100:103], a[72:75], a[112:115], v[100:103]
v_mfma_f32_16x16x32_bf16 v[108:111], a[72:75], a[116:119], v[108:111]
v_mfma_f32_16x16x32_bf16 v[116:119], a[72:75], a[120:123], v[116:119]
v_mfma_f32_16x16x32_bf16 v[40:43], a[72:75], a[124:127], v[40:43]
buffer_load_dwordx4 v4, s[24:27], s64 offen offset:3072 sc1 lds
v_mfma_f32_16x16x32_bf16 v[124:127], a[136:139], a[124:127], v[124:127]
v_mfma_f32_16x16x32_bf16 v[132:135], a[136:139], a[120:123], v[132:135]
v_mfma_f32_16x16x32_bf16 v[140:143], a[136:139], a[116:119], v[140:143]
v_mfma_f32_16x16x32_bf16 v[148:151], a[136:139], a[112:115], v[148:151]
v_mfma_f32_16x16x32_bf16 v[156:159], a[76:79], a[112:115], v[156:159]
v_add_u32 v9, 32768, v9
v_add_u32 v10, 32768, v10
v_mfma_f32_16x16x32_bf16 v[48:51], a[76:79], a[116:119], v[48:51]
v_mfma_f32_16x16x32_bf16 v[164:167], a[76:79], a[120:123], v[164:167]
v_mfma_f32_16x16x32_bf16 v[172:175], a[76:79], a[124:127], v[172:175]
v_mfma_f32_16x16x32_bf16 v[180:183], a[140:143], a[124:127], v[180:183]
v_mfma_f32_16x16x32_bf16 v[188:191], a[140:143], a[120:123], v[188:191]
v_mfma_f32_16x16x32_bf16 v[56:59], a[140:143], a[116:119], v[56:59]
v_mfma_f32_16x16x32_bf16 v[196:199], a[140:143], a[112:115], v[196:199]
s_waitcnt lgkmcnt(0)
v_mfma_f32_16x16x32_bf16 v[64:67], a[160:163], a[96:99], v[64:67]
s_waitcnt vmcnt(17)
v_mfma_f32_16x16x32_bf16 v[204:207], a[160:163], a[100:103], v[204:207]
s_barrier
v_mfma_f32_16x16x32_bf16 v[212:215], a[160:163], a[104:107], v[212:215]
ds_read_b128 a[112:115], v9 offset:0
ds_read_b128 a[116:119], v9 offset:2048
v_mfma_f32_16x16x32_bf16 v[220:223], a[160:163], a[108:111], v[220:223]
s_add_u32 m0, s70, 49152
s_add_u32 s64, s68, 16384
s_waitcnt vmcnt(6)
v_mfma_f32_16x16x32_bf16 v[72:75], a[164:167], a[108:111], v[72:75]
buffer_load_dwordx4 v4, s[24:27], s64 offen offset:0 sc1 lds
v_mfma_f32_16x16x32_bf16 v[228:231], a[164:167], a[104:107], v[228:231]
ds_read_b128 a[120:123], v9 offset:4096
ds_read_b128 a[124:127], v9 offset:6144
v_mfma_f32_16x16x32_bf16 v[80:83], a[164:167], a[100:103], v[80:83]
ds_read_b64_tr_b16 a[192:193], v27 offset:0
ds_read_b64_tr_b16 a[194:195], v27 offset:512
v_mfma_f32_16x16x32_bf16 v[236:239], a[164:167], a[96:99], v[236:239]
ds_read_b64_tr_b16 a[176:177], v11 offset:0
ds_read_b64_tr_b16 a[178:179], v11 offset:512
v_mfma_f32_16x16x32_bf16 v[244:247], a[168:171], a[96:99], v[244:247]
s_add_u32 s53, s87, 790528
ds_read_b64_tr_b16 a[196:197], v27 offset:1024
ds_read_b64_tr_b16 a[198:199], v27 offset:1536
v_mfma_f32_16x16x32_bf16 v[252:255], a[168:171], a[100:103], v[252:255]
ds_read_b64_tr_b16 a[180:181], v12 offset:0
ds_read_b64_tr_b16 a[182:183], v12 offset:512
v_mfma_f32_16x16x32_bf16 v[88:91], a[168:171], a[104:107], v[88:91]
buffer_store_dwordx4 a[16:19], v4, s[24:27], s53 offen offset:0 sc1
v_mfma_f32_16x16x32_bf16 v[160:163], a[168:171], a[108:111], v[160:163]
ds_read_b64_tr_b16 a[184:185], v13 offset:0
ds_read_b64_tr_b16 a[186:187], v13 offset:512
v_mfma_f32_16x16x32_bf16 v[168:171], a[172:175], a[108:111], v[168:171]
ds_read_b64_tr_b16 a[200:201], v27 offset:2048
ds_read_b64_tr_b16 a[202:203], v27 offset:2560
v_mfma_f32_16x16x32_bf16 v[176:179], a[172:175], a[104:107], v[176:179]
ds_read_b64_tr_b16 a[188:189], v14 offset:0
ds_read_b64_tr_b16 a[190:191], v14 offset:512
v_mfma_f32_16x16x32_bf16 v[184:187], a[172:175], a[100:103], v[184:187]
buffer_load_dwordx4 v4, s[24:27], s64 offen offset:1024 sc1 lds
v_mfma_f32_16x16x32_bf16 v[248:251], a[172:175], a[96:99], v[248:251]
ds_read_b64_tr_b16 a[64:65], v11 offset:4096
ds_read_b64_tr_b16 a[66:67], v11 offset:4608
v_mfma_f32_16x16x32_bf16 v[240:243], a[80:83], a[96:99], v[240:243]
ds_read_b64_tr_b16 a[204:205], v27 offset:3072
ds_read_b64_tr_b16 a[206:207], v27 offset:3584
v_mfma_f32_16x16x32_bf16 v[232:235], a[80:83], a[100:103], v[232:235]
ds_read_b64_tr_b16 a[128:129], v12 offset:4096
ds_read_b64_tr_b16 a[130:131], v12 offset:4608
v_mfma_f32_16x16x32_bf16 v[224:227], a[80:83], a[104:107], v[224:227]
ds_read_b64_tr_b16 a[208:209], v27 offset:4096
ds_read_b64_tr_b16 a[210:211], v27 offset:4608
v_mfma_f32_16x16x32_bf16 v[192:195], a[80:83], a[108:111], v[192:195]
ds_read_b64_tr_b16 a[68:69], v13 offset:4096
ds_read_b64_tr_b16 a[70:71], v13 offset:4608
v_mfma_f32_16x16x32_bf16 v[152:155], a[144:147], a[108:111], v[152:155]
ds_read_b64_tr_b16 a[212:213], v27 offset:5120
ds_read_b64_tr_b16 a[214:215], v27 offset:5632
v_mfma_f32_16x16x32_bf16 v[200:203], a[144:147], a[104:107], v[200:203]
ds_read_b64_tr_b16 a[132:133], v14 offset:4096
ds_read_b64_tr_b16 a[134:135], v14 offset:4608
v_mfma_f32_16x16x32_bf16 v[208:211], a[144:147], a[100:103], v[208:211]
v_readlane_b32 s81, v26, 0
v_readlane_b32 s82, v26, 1
v_mfma_f32_16x16x32_bf16 v[36:39], a[144:147], a[96:99], v[36:39]
ds_read_b128 a[72:75], v4 offset:8192
ds_read_b128 a[136:139], v4 offset:9216
v_mfma_f32_16x16x32_bf16 v[44:47], a[84:87], a[96:99], v[44:47]
v_readlane_b32 s71, v26, 2
v_readlane_b32 s72, v26, 3
v_mfma_f32_16x16x32_bf16 v[32:35], a[84:87], a[100:103], v[32:35]
buffer_load_dwordx4 v4, s[24:27], s64 offen offset:2048 sc1 lds
v_mfma_f32_16x16x32_bf16 v[52:55], a[84:87], a[104:107], v[52:55]
ds_read_b128 a[76:79], v4 offset:10240
ds_read_b128 a[140:143], v4 offset:11264
v_mfma_f32_16x16x32_bf16 v[60:63], a[84:87], a[108:111], v[60:63]
v_readlane_b32 s74, v26, 4
v_readlane_b32 s75, v26, 5
v_mfma_f32_16x16x32_bf16 v[68:71], a[148:151], a[108:111], v[68:71]
v_mfma_f32_16x16x32_bf16 v[76:79], a[148:151], a[104:107], v[76:79]
v_mfma_f32_16x16x32_bf16 v[84:87], a[148:151], a[100:103], v[84:87]
v_mfma_f32_16x16x32_bf16 v[92:95], a[148:151], a[96:99], v[92:95]
v_mfma_f32_16x16x32_bf16 v[100:103], a[88:91], a[96:99], v[100:103]
v_mfma_f32_16x16x32_bf16 v[108:111], a[88:91], a[100:103], v[108:111]
v_mfma_f32_16x16x32_bf16 v[116:119], a[88:91], a[104:107], v[116:119]
v_mfma_f32_16x16x32_bf16 v[40:43], a[88:91], a[108:111], v[40:43]
buffer_load_dwordx4 v4, s[24:27], s64 offen offset:3072 sc1 lds
v_mfma_f32_16x16x32_bf16 v[124:127], a[152:155], a[108:111], v[124:127]
s_add_u32 s53, s87, 790528
v_mfma_f32_16x16x32_bf16 v[132:135], a[152:155], a[104:107], v[132:135]
buffer_store_dwordx4 a[24:27], v4, s[24:27], s53 offen offset:1024 sc1
v_mfma_f32_16x16x32_bf16 v[140:143], a[152:155], a[100:103], v[140:143]
v_mfma_f32_16x16x32_bf16 v[148:151], a[152:155], a[96:99], v[148:151]
v_mfma_f32_16x16x32_bf16 v[156:159], a[92:95], a[96:99], v[156:159]
v_mfma_f32_16x16x32_bf16 v[48:51], a[92:95], a[100:103], v[48:51]
v_mfma_f32_16x16x32_bf16 v[164:167], a[92:95], a[104:107], v[164:167]
v_mfma_f32_16x16x32_bf16 v[172:175], a[92:95], a[108:111], v[172:175]
v_mfma_f32_16x16x32_bf16 v[180:183], a[156:159], a[108:111], v[180:183]
v_mfma_f32_16x16x32_bf16 v[188:191], a[156:159], a[104:107], v[188:191]
v_mfma_f32_16x16x32_bf16 v[56:59], a[156:159], a[100:103], v[56:59]
v_mfma_f32_16x16x32_bf16 v[196:199], a[156:159], a[96:99], v[196:199]
s_waitcnt lgkmcnt(0)
v_mfma_f32_16x16x32_bf16 v[64:67], a[176:179], a[112:115], v[64:67]
s_waitcnt vmcnt(19)
v_mfma_f32_16x16x32_bf16 v[236:239], a[180:183], a[112:115], v[236:239]
s_barrier
v_mfma_f32_16x16x32_bf16 v[244:247], a[184:187], a[112:115], v[244:247]
ds_read_b128 a[96:99], v10 offset:0
ds_read_b128 a[100:103], v10 offset:2048
v_mfma_f32_16x16x32_bf16 v[248:251], a[188:191], a[112:115], v[248:251]
ds_read_b128 a[104:107], v10 offset:4096
ds_read_b128 a[108:111], v10 offset:6144
v_mfma_f32_16x16x32_bf16 v[240:243], a[64:67], a[112:115], v[240:243]
ds_read_b64_tr_b16 a[160:161], v11 offset:16384
ds_read_b64_tr_b16 a[162:163], v11 offset:16896
v_mfma_f32_16x16x32_bf16 v[36:39], a[128:131], a[112:115], v[36:39]
ds_read_b64_tr_b16 a[164:165], v12 offset:16384
ds_read_b64_tr_b16 a[166:167], v12 offset:16896
v_mfma_f32_16x16x32_bf16 v[44:47], a[68:71], a[112:115], v[44:47]
ds_read_b64_tr_b16 a[168:169], v13 offset:16384
ds_read_b64_tr_b16 a[170:171], v13 offset:16896
v_mfma_f32_16x16x32_bf16 v[92:95], a[132:135], a[112:115], v[92:95]
ds_read_b64_tr_b16 a[172:173], v14 offset:16384
ds_read_b64_tr_b16 a[174:175], v14 offset:16896
v_mfma_f32_16x16x32_bf16 v[204:207], a[176:179], a[116:119], v[204:207]
ds_read_b64_tr_b16 a[80:81], v11 offset:20480
ds_read_b64_tr_b16 a[82:83], v11 offset:20992
v_mfma_f32_16x16x32_bf16 v[80:83], a[180:183], a[116:119], v[80:83]
ds_read_b64_tr_b16 a[144:145], v12 offset:20480
ds_read_b64_tr_b16 a[146:147], v12 offset:20992
v_mfma_f32_16x16x32_bf16 v[252:255], a[184:187], a[116:119], v[252:255]
ds_read_b64_tr_b16 a[84:85], v13 offset:20480
ds_read_b64_tr_b16 a[86:87], v13 offset:20992
v_mfma_f32_16x16x32_bf16 v[184:187], a[188:191], a[116:119], v[184:187]
ds_read_b64_tr_b16 a[148:149], v14 offset:20480
ds_read_b64_tr_b16 a[150:151], v14 offset:20992
v_mfma_f32_16x16x32_bf16 v[232:235], a[64:67], a[116:119], v[232:235]
ds_read_b128 a[88:91], v4 offset:24576
ds_read_b128 a[152:155], v4 offset:25600
v_mfma_f32_16x16x32_bf16 v[208:211], a[128:131], a[116:119], v[208:211]
ds_read_b128 a[92:95], v4 offset:26624
ds_read_b128 a[156:159], v4 offset:27648
v_mfma_f32_16x16x32_bf16 v[32:35], a[68:71], a[116:119], v[32:35]
buffer_store_dwordx4 a[192:195], v4, s[24:27], s81 offen sc1
v_mfma_f32_16x16x32_bf16 v[84:87], a[132:135], a[116:119], v[84:87]
s_add_u32 m0, s70, 65536
s_add_u32 s64, s68, 32768
v_mfma_f32_16x16x32_bf16 v[212:215], a[176:179], a[120:123], v[212:215]
buffer_load_dwordx4 v4, s[24:27], s64 offen offset:0 sc1 lds
v_mfma_f32_16x16x32_bf16 v[228:231], a[180:183], a[120:123], v[228:231]
v_mfma_f32_16x16x32_bf16 v[88:91], a[184:187], a[120:123], v[88:91]
v_mfma_f32_16x16x32_bf16 v[176:179], a[188:191], a[120:123], v[176:179]
buffer_store_dwordx4 a[196:199], v4, s[24:27], s82 offen sc1
v_mfma_f32_16x16x32_bf16 v[224:227], a[64:67], a[120:123], v[224:227]
v_mfma_f32_16x16x32_bf16 v[200:203], a[128:131], a[120:123], v[200:203]
v_mfma_f32_16x16x32_bf16 v[52:55], a[68:71], a[120:123], v[52:55]
v_mfma_f32_16x16x32_bf16 v[76:79], a[132:135], a[120:123], v[76:79]
s_waitcnt lgkmcnt(0)
v_mfma_f32_16x16x32_bf16 v[64:67], a[160:163], a[96:99], v[64:67]
buffer_load_dwordx4 v4, s[24:27], s64 offen offset:1024 sc1 lds
v_mfma_f32_16x16x32_bf16 v[236:239], a[164:167], a[96:99], v[236:239]
buffer_store_dwordx4 a[200:203], v4, s[24:27], s71 offen sc1
v_mfma_f32_16x16x32_bf16 v[244:247], a[168:171], a[96:99], v[244:247]
v_mfma_f32_16x16x32_bf16 v[248:251], a[172:175], a[96:99], v[248:251]
v_mfma_f32_16x16x32_bf16 v[240:243], a[80:83], a[96:99], v[240:243]
v_mfma_f32_16x16x32_bf16 v[36:39], a[144:147], a[96:99], v[36:39]
v_mfma_f32_16x16x32_bf16 v[44:47], a[84:87], a[96:99], v[44:47]
buffer_store_dwordx4 a[204:207], v4, s[24:27], s72 offen sc1
v_mfma_f32_16x16x32_bf16 v[92:95], a[148:151], a[96:99], v[92:95]
buffer_load_dwordx4 v4, s[24:27], s64 offen offset:2048 sc1 lds
v_mfma_f32_16x16x32_bf16 v[204:207], a[160:163], a[100:103], v[204:207]
v_cvt_pk_bf16_f32 v64, v64, v65
v_cvt_pk_bf16_f32 v65, v66, v67
v_mfma_f32_16x16x32_bf16 v[80:83], a[164:167], a[100:103], v[80:83]
v_cvt_pk_bf16_f32 v66, v236, v237
v_cvt_pk_bf16_f32 v67, v238, v239
v_mfma_f32_16x16x32_bf16 v[252:255], a[168:171], a[100:103], v[252:255]
v_cvt_pk_bf16_f32 v244, v244, v245
v_cvt_pk_bf16_f32 v245, v246, v247
v_mfma_f32_16x16x32_bf16 v[184:187], a[172:175], a[100:103], v[184:187]
buffer_store_dwordx4 a[208:211], v4, s[24:27], s74 offen sc1
v_mfma_f32_16x16x32_bf16 v[232:235], a[80:83], a[100:103], v[232:235]
v_cvt_pk_bf16_f32 v246, v248, v249
v_cvt_pk_bf16_f32 v247, v250, v251
v_mfma_f32_16x16x32_bf16 v[208:211], a[144:147], a[100:103], v[208:211]
v_cvt_pk_bf16_f32 v240, v240, v241
v_cvt_pk_bf16_f32 v241, v242, v243
v_mfma_f32_16x16x32_bf16 v[32:35], a[84:87], a[100:103], v[32:35]
buffer_load_dwordx4 v4, s[24:27], s64 offen offset:3072 sc1 lds
v_mfma_f32_16x16x32_bf16 v[84:87], a[148:151], a[100:103], v[84:87]
v_cvt_pk_bf16_f32 v242, v36, v37
v_cvt_pk_bf16_f32 v243, v38, v39
v_mfma_f32_16x16x32_bf16 v[212:215], a[160:163], a[104:107], v[212:215]
buffer_store_dwordx4 a[212:215], v4, s[24:27], s75 offen sc1
v_mfma_f32_16x16x32_bf16 v[228:231], a[164:167], a[104:107], v[228:231]
v_cvt_pk_bf16_f32 v44, v44, v45
v_cvt_pk_bf16_f32 v45, v46, v47
v_mfma_f32_16x16x32_bf16 v[88:91], a[168:171], a[104:107], v[88:91]
v_cvt_pk_bf16_f32 v46, v92, v93
v_cvt_pk_bf16_f32 v47, v94, v95
v_mfma_f32_16x16x32_bf16 v[176:179], a[172:175], a[104:107], v[176:179]
v_cvt_pk_bf16_f32 v204, v204, v205
v_cvt_pk_bf16_f32 v205, v206, v207
v_mfma_f32_16x16x32_bf16 v[224:227], a[80:83], a[104:107], v[224:227]
v_cvt_pk_bf16_f32 v206, v80, v81
v_cvt_pk_bf16_f32 v207, v82, v83
v_mfma_f32_16x16x32_bf16 v[200:203], a[144:147], a[104:107], v[200:203]
v_cvt_pk_bf16_f32 v252, v252, v253
v_cvt_pk_bf16_f32 v253, v254, v255
v_mfma_f32_16x16x32_bf16 v[52:55], a[84:87], a[104:107], v[52:55]
v_cvt_pk_bf16_f32 v254, v184, v185
v_cvt_pk_bf16_f32 v255, v186, v187
v_mfma_f32_16x16x32_bf16 v[76:79], a[148:151], a[104:107], v[76:79]
v_cvt_pk_bf16_f32 v232, v232, v233
v_cvt_pk_bf16_f32 v233, v234, v235
v_mfma_f32_16x16x32_bf16 v[220:223], a[176:179], a[124:127], v[220:223]
s_waitcnt vmcnt(16)
v_cvt_pk_bf16_f32 v234, v208, v209
v_cvt_pk_bf16_f32 v235, v210, v211
v_mfma_f32_16x16x32_bf16 v[220:223], a[160:163], a[108:111], v[220:223]
s_barrier
v_mfma_f32_16x16x32_bf16 v[72:75], a[180:183], a[124:127], v[72:75]
v_cvt_pk_bf16_f32 v32, v32, v33
v_cvt_pk_bf16_f32 v33, v34, v35
v_mfma_f32_16x16x32_bf16 v[72:75], a[164:167], a[108:111], v[72:75]
s_add_u32 m0, s70, 81920
s_add_u32 s64, s68, 49152
v_cvt_pk_bf16_f32 v34, v84, v85
v_mfma_f32_16x16x32_bf16 v[160:163], a[184:187], a[124:127], v[160:163]
buffer_load_dwordx4 v4, s[24:27], s64 offen offset:0 sc1 lds
v_mfma_f32_16x16x32_bf16 v[160:163], a[168:171], a[108:111], v[160:163]
v_cvt_pk_bf16_f32 v35, v86, v87
v_cvt_pk_bf16_f32 v212, v212, v213
v_mfma_f32_16x16x32_bf16 v[168:171], a[188:191], a[124:127], v[168:171]
v_cvt_pk_bf16_f32 v213, v214, v215
v_cvt_pk_bf16_f32 v214, v228, v229
v_mfma_f32_16x16x32_bf16 v[168:171], a[172:175], a[108:111], v[168:171]
v_cvt_pk_bf16_f32 v215, v230, v231
v_cvt_pk_bf16_f32 v88, v88, v89
v_mfma_f32_16x16x32_bf16 v[192:195], a[64:67], a[124:127], v[192:195]
v_cvt_pk_bf16_f32 v89, v90, v91
v_cvt_pk_bf16_f32 v90, v176, v177
v_mfma_f32_16x16x32_bf16 v[192:195], a[80:83], a[108:111], v[192:195]
v_cvt_pk_bf16_f32 v91, v178, v179
v_cvt_pk_bf16_f32 v224, v224, v225
v_mfma_f32_16x16x32_bf16 v[152:155], a[128:131], a[124:127], v[152:155]
v_cvt_pk_bf16_f32 v225, v226, v227
v_cvt_pk_bf16_f32 v226, v200, v201
v_mfma_f32_16x16x32_bf16 v[152:155], a[144:147], a[108:111], v[152:155]
v_cvt_pk_bf16_f32 v227, v202, v203
v_cvt_pk_bf16_f32 v52, v52, v53
v_mfma_f32_16x16x32_bf16 v[60:63], a[68:71], a[124:127], v[60:63]
v_cvt_pk_bf16_f32 v53, v54, v55
v_cvt_pk_bf16_f32 v54, v76, v77
v_mfma_f32_16x16x32_bf16 v[60:63], a[84:87], a[108:111], v[60:63]
v_cvt_pk_bf16_f32 v55, v78, v79
v_cvt_pk_bf16_f32 v220, v220, v221
v_mfma_f32_16x16x32_bf16 v[68:71], a[132:135], a[124:127], v[68:71]
buffer_load_dwordx4 v4, s[24:27], s64 offen offset:1024 sc1 lds
v_mfma_f32_16x16x32_bf16 v[68:71], a[148:151], a[108:111], v[68:71]
v_cvt_pk_bf16_f32 v221, v222, v223
v_cvt_pk_bf16_f32 v222, v72, v73
v_mfma_f32_16x16x32_bf16 v[100:103], a[72:75], a[112:115], v[100:103]
v_cvt_pk_bf16_f32 v223, v74, v75
v_cvt_pk_bf16_f32 v160, v160, v161
v_mfma_f32_16x16x32_bf16 v[100:103], a[88:91], a[96:99], v[100:103]
v_cvt_pk_bf16_f32 v161, v162, v163
v_cvt_pk_bf16_f32 v162, v168, v169
v_mfma_f32_16x16x32_bf16 v[148:151], a[136:139], a[112:115], v[148:151]
v_cvt_pk_bf16_f32 v163, v170, v171
v_cvt_pk_bf16_f32 v192, v192, v193
v_mfma_f32_16x16x32_bf16 v[148:151], a[152:155], a[96:99], v[148:151]
v_cvt_pk_bf16_f32 v193, v194, v195
v_cvt_pk_bf16_f32 v194, v152, v153
v_mfma_f32_16x16x32_bf16 v[156:159], a[76:79], a[112:115], v[156:159]
ds_read_b128 a[192:195], v4 offset:32768
v_cvt_pk_bf16_f32 v195, v154, v155
v_mfma_f32_16x16x32_bf16 v[156:159], a[92:95], a[96:99], v[156:159]
ds_read_b128 a[196:199], v4 offset:33792
ds_read_b128 a[200:203], v4 offset:34816
v_mfma_f32_16x16x32_bf16 v[196:199], a[140:143], a[112:115], v[196:199]
v_cvt_pk_bf16_f32 v60, v60, v61
v_cvt_pk_bf16_f32 v61, v62, v63
v_mfma_f32_16x16x32_bf16 v[196:199], a[156:159], a[96:99], v[196:199]
v_cvt_pk_bf16_f32 v62, v68, v69
v_cvt_pk_bf16_f32 v63, v70, v71
v_mfma_f32_16x16x32_bf16 v[108:111], a[72:75], a[116:119], v[108:111]
ds_read_b128 a[204:207], v4 offset:35840
ds_read_b128 a[208:211], v4 offset:36864
v_mfma_f32_16x16x32_bf16 v[108:111], a[88:91], a[100:103], v[108:111]
buffer_load_dwordx4 v4, s[24:27], s64 offen offset:2048 sc1 lds
v_mfma_f32_16x16x32_bf16 v[140:143], a[136:139], a[116:119], v[140:143]
ds_read_b128 a[212:215], v4 offset:37888
ds_read_b128 a[216:219], v4 offset:38912
v_mfma_f32_16x16x32_bf16 v[140:143], a[152:155], a[100:103], v[140:143]
ds_read_b128 a[220:223], v4 offset:39936
v_mfma_f32_16x16x32_bf16 v[48:51], a[76:79], a[116:119], v[48:51]
v_mfma_f32_16x16x32_bf16 v[48:51], a[92:95], a[100:103], v[48:51]
v_mfma_f32_16x16x32_bf16 v[56:59], a[140:143], a[116:119], v[56:59]
ds_bpermute_b32 v8, v17, v103
v_cvt_pk_bf16_f32 v100, v100, v101
v_mfma_f32_16x16x32_bf16 v[56:59], a[156:159], a[100:103], v[56:59]
v_cvt_pk_bf16_f32 v101, v102, v103
v_cvt_pk_bf16_f32 v102, v148, v149
v_mfma_f32_16x16x32_bf16 v[116:119], a[72:75], a[120:123], v[116:119]
v_cvt_pk_bf16_f32 v103, v150, v151
v_mfma_f32_16x16x32_bf16 v[116:119], a[88:91], a[104:107], v[116:119]
buffer_store_dwordx4 v[100:103], v18, s[24:27], s54 offen offset:0 sc1
v_mfma_f32_16x16x32_bf16 v[132:135], a[136:139], a[120:123], v[132:135]
v_cvt_pk_bf16_f32 v156, v156, v157
v_cvt_pk_bf16_f32 v157, v158, v159
v_mfma_f32_16x16x32_bf16 v[132:135], a[152:155], a[104:107], v[132:135]
buffer_load_dwordx4 v4, s[24:27], s64 offen offset:3072 sc1 lds
v_mfma_f32_16x16x32_bf16 v[164:167], a[76:79], a[120:123], v[164:167]
v_cvt_pk_bf16_f32 v158, v196, v197
v_cvt_pk_bf16_f32 v159, v198, v199
v_mfma_f32_16x16x32_bf16 v[164:167], a[92:95], a[104:107], v[164:167]
buffer_store_dwordx4 v[156:159], v19, s[24:27], s54 offen offset:0 sc1
v_mfma_f32_16x16x32_bf16 v[188:191], a[140:143], a[120:123], v[188:191]
ds_bpermute_b32 v9, v17, v111
v_cvt_pk_bf16_f32 v108, v108, v109
v_mfma_f32_16x16x32_bf16 v[188:191], a[156:159], a[104:107], v[188:191]
v_cvt_pk_bf16_f32 v109, v110, v111
v_cvt_pk_bf16_f32 v110, v140, v141
v_mfma_f32_16x16x32_bf16 v[40:43], a[72:75], a[124:127], v[40:43]
v_cvt_pk_bf16_f32 v111, v142, v143
v_mfma_f32_16x16x32_bf16 v[40:43], a[88:91], a[108:111], v[40:43]
buffer_store_dwordx4 v[108:111], v18, s[24:27], s54 offen offset:256 sc1
v_mfma_f32_16x16x32_bf16 v[124:127], a[136:139], a[124:127], v[124:127]
v_cvt_pk_bf16_f32 v48, v48, v49
v_cvt_pk_bf16_f32 v49, v50, v51
v_mfma_f32_16x16x32_bf16 v[124:127], a[152:155], a[108:111], v[124:127]
v_cvt_pk_bf16_f32 v50, v56, v57
v_cvt_pk_bf16_f32 v51, v58, v59
v_mfma_f32_16x16x32_bf16 v[172:175], a[76:79], a[124:127], v[172:175]
buffer_store_dwordx4 v[48:51], v19, s[24:27], s54 offen offset:256 sc1
v_mfma_f32_16x16x32_bf16 v[172:175], a[92:95], a[108:111], v[172:175]
v_mfma_f32_16x16x32_bf16 v[180:183], a[140:143], a[124:127], v[180:183]
ds_bpermute_b32 v10, v17, v119
v_cvt_pk_bf16_f32 v116, v116, v117
v_mfma_f32_16x16x32_bf16 v[180:183], a[156:159], a[108:111], v[180:183]
s_waitcnt lgkmcnt(0)
v_cvt_pk_bf16_f32 v117, v118, v119
v_cvt_pk_bf16_f32 v118, v132, v133
v_mfma_f32_16x16x32_bf16 v[236:239], a[192:195], v[64:67], v[216:219]
v_cvt_pk_bf16_f32 v119, v134, v135
v_mfma_f32_16x16x32_bf16 v[236:239], a[196:199], v[244:247], v[236:239]
buffer_store_dwordx4 v[116:119], v18, s[24:27], s55 offen offset:0 sc1
v_mfma_f32_16x16x32_bf16 v[236:239], a[200:203], v[240:243], v[236:239]
v_cvt_pk_bf16_f32 v164, v164, v165
v_cvt_pk_bf16_f32 v165, v166, v167
v_mfma_f32_16x16x32_bf16 v[236:239], a[204:207], v[44:47], v[236:239]
v_cvt_pk_bf16_f32 v166, v188, v189
v_cvt_pk_bf16_f32 v167, v190, v191
v_mfma_f32_16x16x32_bf16 v[248:251], a[192:195], v[204:207], v[96:99]
buffer_store_dwordx4 v[164:167], v19, s[24:27], s55 offen offset:0 sc1
v_mfma_f32_16x16x32_bf16 v[248:251], a[196:199], v[252:255], v[248:251]
v_mfma_f32_16x16x32_bf16 v[248:251], a[200:203], v[232:235], v[248:251]
ds_bpermute_b32 v11, v17, v43
v_cvt_pk_bf16_f32 v40, v40, v41
v_mfma_f32_16x16x32_bf16 v[248:251], a[204:207], v[32:35], v[248:251]
v_cvt_pk_bf16_f32 v41, v42, v43
v_cvt_pk_bf16_f32 v42, v124, v125
v_mfma_f32_16x16x32_bf16 v[36:39], a[208:211], v[64:67], v[104:107]
v_cvt_pk_bf16_f32 v43, v126, v127
v_mfma_f32_16x16x32_bf16 v[36:39], a[212:215], v[244:247], v[36:39]
buffer_store_dwordx4 v[40:43], v18, s[24:27], s55 offen offset:256 sc1
v_mfma_f32_16x16x32_bf16 v[36:39], a[216:219], v[240:243], v[36:39]
v_cvt_pk_bf16_f32 v172, v172, v173
v_cvt_pk_bf16_f32 v173, v174, v175
v_mfma_f32_16x16x32_bf16 v[36:39], a[220:223], v[44:47], v[36:39]
v_cvt_pk_bf16_f32 v174, v180, v181
v_cvt_pk_bf16_f32 v175, v182, v183
v_mfma_f32_16x16x32_bf16 v[92:95], a[208:211], v[204:207], v[112:115]
buffer_store_dwordx4 v[172:175], v19, s[24:27], s55 offen offset:256 sc1
v_mfma_f32_16x16x32_bf16 v[92:95], a[212:215], v[252:255], v[92:95]
v_mfma_f32_16x16x32_bf16 v[92:95], a[216:219], v[232:235], v[92:95]
v_mfma_f32_16x16x32_bf16 v[92:95], a[220:223], v[32:35], v[92:95]
s_waitcnt vmcnt(23)
v_mfma_f32_16x16x32_bf16 v[80:83], a[192:195], v[212:215], v[120:123]
s_barrier
v_mfma_f32_16x16x32_bf16 v[80:83], a[196:199], v[88:91], v[80:83]
v_mfma_f32_16x16x32_bf16 v[80:83], a[200:203], v[224:227], v[80:83]
v_mfma_f32_16x16x32_bf16 v[80:83], a[204:207], v[52:55], v[80:83]
v_mfma_f32_16x16x32_bf16 v[184:187], a[192:195], v[220:223], v[128:131]
v_mfma_f32_16x16x32_bf16 v[184:187], a[196:199], v[160:163], v[184:187]
v_mfma_f32_16x16x32_bf16 v[184:187], a[200:203], v[192:195], v[184:187]
v_mfma_f32_16x16x32_bf16 v[184:187], a[204:207], v[60:63], v[184:187]
v_mfma_f32_16x16x32_bf16 v[208:211], a[208:211], v[212:215], v[136:139]
v_mfma_f32_16x16x32_bf16 v[208:211], a[212:215], v[88:91], v[208:211]
v_mfma_f32_16x16x32_bf16 v[208:211], a[216:219], v[224:227], v[208:211]
v_mfma_f32_16x16x32_bf16 v[208:211], a[220:223], v[52:55], v[208:211]
v_mfma_f32_16x16x32_bf16 v[84:87], a[208:211], v[220:223], v[144:147]
v_mfma_f32_16x16x32_bf16 v[84:87], a[212:215], v[160:163], v[84:87]
v_mfma_f32_16x16x32_bf16 v[84:87], a[216:219], v[192:195], v[84:87]
v_mfma_f32_16x16x32_bf16 v[84:87], a[220:223], v[60:63], v[84:87]
ds_read_b128 a[64:67], v4 offset:57344
ds_read_b128 a[68:71], v4 offset:58368
ds_read_b128 a[72:75], v4 offset:59392
ds_read_b128 a[76:79], v4 offset:60416
ds_read_b128 a[80:83], v4 offset:61440
ds_read_b128 a[84:87], v4 offset:62464
ds_read_b128 a[88:91], v4 offset:63488
ds_read_b128 a[92:95], v4 offset:64512
s_add_u32 m0, s70, 98304
s_add_u32 s64, s68, 65536
buffer_load_dwordx4 v4, s[24:27], s64 offen offset:0 sc1 lds
v_max3_f32 v24, v236, v237, v238
v_max3_f32 v25, v239, v36, v37
v_max3_f32 v26, v248, v249, v250
v_max3_f32 v27, v251, v92, v93
v_max3_f32 v24, v24, v38, v39
v_max_f32 v24, v24, v25
v_max3_f32 v26, v26, v94, v95
v_max_f32 v26, v26, v27
v_mov_b32 v25, v24
buffer_load_dwordx4 v4, s[24:27], s64 offen offset:1024 sc1 lds
v_mov_b32 v27, v26
s_nop 1
v_permlane32_swap_b32 v25, v24
v_permlane32_swap_b32 v27, v26
s_nop 0
v_max_f32 v24, v24, v25
v_max_f32 v26, v26, v27
v_mov_b32 v25, v24
v_mov_b32 v27, v26
buffer_load_dwordx4 v4, s[24:27], s64 offen offset:2048 sc1 lds
s_nop 1
v_permlane16_swap_b32 v25, v24
v_permlane16_swap_b32 v27, v26
s_nop 0
v_max_f32 v24, v24, v25
v_max_f32 v26, v26, v27
v_sub_f32 v236, v236, v24
v_sub_f32 v237, v237, v24
v_sub_f32 v238, v238, v24
buffer_load_dwordx4 v4, s[24:27], s64 offen offset:3072 sc1 lds
v_sub_f32 v239, v239, v24
v_sub_f32 v248, v248, v26
v_sub_f32 v249, v249, v26
v_sub_f32 v250, v250, v26
v_sub_f32 v251, v251, v26
v_sub_f32 v36, v36, v24
v_sub_f32 v37, v37, v24
v_sub_f32 v38, v38, v24
v_sub_f32 v39, v39, v24
s_add_u32 m0, s70, 114688
s_add_u32 s64, s68, 81920
buffer_load_dwordx4 v4, s[24:27], s64 offen offset:0 sc1 lds
v_sub_f32 v92, v92, v26
v_sub_f32 v93, v93, v26
v_sub_f32 v94, v94, v26
v_sub_f32 v95, v95, v26
v_sub_f32 v216, v216, v24
v_sub_f32 v217, v217, v24
v_sub_f32 v218, v218, v24
v_sub_f32 v219, v219, v24
v_sub_f32 v96, v96, v26
buffer_load_dwordx4 v4, s[24:27], s64 offen offset:1024 sc1 lds
v_sub_f32 v97, v97, v26
v_sub_f32 v98, v98, v26
v_sub_f32 v99, v99, v26
v_sub_f32 v104, v104, v24
v_sub_f32 v105, v105, v24
v_sub_f32 v106, v106, v24
v_sub_f32 v107, v107, v24
v_sub_f32 v112, v112, v26
v_sub_f32 v113, v113, v26
buffer_load_dwordx4 v4, s[24:27], s64 offen offset:2048 sc1 lds
v_sub_f32 v114, v114, v26
v_sub_f32 v115, v115, v26
v_exp_f32 v236, v236
v_exp_f32 v237, v237
v_exp_f32 v238, v238
v_exp_f32 v239, v239
v_cvt_pk_bf16_f32 v228, v236, v237
v_exp_f32 v248, v248
v_exp_f32 v249, v249
buffer_load_dwordx4 v4, s[24:27], s64 offen offset:3072 sc1 lds
v_cvt_pk_bf16_f32 v229, v238, v239
v_exp_f32 v250, v250
v_exp_f32 v251, v251
v_cvt_pk_bf16_f32 v176, v248, v249
v_exp_f32 v36, v36
v_exp_f32 v37, v37
v_cvt_pk_bf16_f32 v177, v250, v251
v_exp_f32 v38, v38
v_exp_f32 v39, v39
s_add_u32 m0, s70, 0
s_add_u32 s64, s68, 98304
buffer_load_dwordx4 v4, s[24:27], s64 offen offset:0 sc1 lds
v_cvt_pk_bf16_f32 v230, v36, v37
v_exp_f32 v92, v92
v_exp_f32 v93, v93
v_cvt_pk_bf16_f32 v231, v38, v39
v_exp_f32 v94, v94
v_exp_f32 v95, v95
v_cvt_pk_bf16_f32 v178, v92, v93
v_max3_f32 v24, v80, v81, v82
v_cvt_pk_bf16_f32 v179, v94, v95
buffer_load_dwordx4 v4, s[24:27], s64 offen offset:1024 sc1 lds
v_max3_f32 v25, v83, v208, v209
v_max3_f32 v26, v184, v185, v186
v_max3_f32 v27, v187, v84, v85
v_max3_f32 v24, v24, v210, v211
v_max_f32 v24, v24, v25
v_max3_f32 v26, v26, v86, v87
v_max_f32 v26, v26, v27
v_mov_b32 v25, v24
v_mov_b32 v27, v26
buffer_load_dwordx4 v4, s[24:27], s64 offen offset:2048 sc1 lds
s_nop 1
v_permlane32_swap_b32 v25, v24
v_permlane32_swap_b32 v27, v26
s_nop 0
v_max_f32 v24, v24, v25
v_max_f32 v26, v26, v27
v_mov_b32 v25, v24
v_mov_b32 v27, v26
s_nop 1
buffer_load_dwordx4 v4, s[24:27], s64 offen offset:3072 sc1 lds
v_permlane16_swap_b32 v25, v24
v_permlane16_swap_b32 v27, v26
s_nop 0
v_max_f32 v24, v24, v25
v_max_f32 v26, v26, v27
v_sub_f32 v80, v80, v24
v_sub_f32 v81, v81, v24
v_sub_f32 v82, v82, v24
v_sub_f32 v83, v83, v24
s_add_u32 m0, s70, 16384
s_add_u32 s64, s68, 114688
buffer_load_dwordx4 v4, s[24:27], s64 offen offset:0 sc1 lds
v_sub_f32 v184, v184, v26
v_sub_f32 v185, v185, v26
v_sub_f32 v186, v186, v26
v_sub_f32 v187, v187, v26
v_sub_f32 v208, v208, v24
v_sub_f32 v209, v209, v24
v_sub_f32 v210, v210, v24
v_sub_f32 v211, v211, v24
v_sub_f32 v84, v84, v26
buffer_load_dwordx4 v4, s[24:27], s64 offen offset:1024 sc1 lds
v_sub_f32 v85, v85, v26
v_sub_f32 v86, v86, v26
v_sub_f32 v87, v87, v26
v_sub_f32 v120, v120, v24
v_sub_f32 v121, v121, v24
v_sub_f32 v122, v122, v24
v_sub_f32 v123, v123, v24
v_sub_f32 v128, v128, v26
v_sub_f32 v129, v129, v26
buffer_load_dwordx4 v4, s[24:27], s64 offen offset:2048 sc1 lds
v_sub_f32 v130, v130, v26
v_sub_f32 v131, v131, v26
v_sub_f32 v136, v136, v24
v_sub_f32 v137, v137, v24
v_sub_f32 v138, v138, v24
v_sub_f32 v139, v139, v24
v_sub_f32 v144, v144, v26
v_sub_f32 v145, v145, v26
v_sub_f32 v146, v146, v26
buffer_load_dwordx4 v4, s[24:27], s64 offen offset:3072 sc1 lds
v_sub_f32 v147, v147, v26
v_mov_b32 v100, 0
v_mov_b32 v101, 0
v_mov_b32 v102, 0
v_mov_b32 v103, 0
v_mov_b32 v148, 0
v_mov_b32 v149, 0
v_mov_b32 v150, 0
v_mov_b32 v151, 0
v_mov_b32 v156, 0
v_mov_b32 v157, 0
v_mov_b32 v158, 0
v_mov_b32 v159, 0
v_mov_b32 v196, 0
v_mov_b32 v197, 0
v_mov_b32 v198, 0
v_mov_b32 v199, 0
v_mov_b32 v108, 0
v_mov_b32 v109, 0
v_mov_b32 v110, 0
v_mov_b32 v111, 0
v_mov_b32 v140, 0
v_mov_b32 v141, 0
v_mov_b32 v142, 0
v_mov_b32 v143, 0
v_mov_b32 v48, 0
v_mov_b32 v49, 0
v_mov_b32 v50, 0
v_mov_b32 v51, 0
v_mov_b32 v56, 0
v_mov_b32 v57, 0
v_mov_b32 v58, 0
v_mov_b32 v59, 0
v_mov_b32 v116, 0
v_mov_b32 v117, 0
v_mov_b32 v118, 0
v_mov_b32 v119, 0
v_mov_b32 v132, 0
v_mov_b32 v133, 0
v_mov_b32 v134, 0
v_mov_b32 v135, 0
v_mov_b32 v164, 0
v_mov_b32 v165, 0
v_mov_b32 v166, 0
v_mov_b32 v167, 0
v_mov_b32 v188, 0
v_mov_b32 v189, 0
v_mov_b32 v190, 0
v_mov_b32 v191, 0
v_mov_b32 v40, 0
v_mov_b32 v41, 0
v_mov_b32 v42, 0
v_mov_b32 v43, 0
v_mov_b32 v124, 0
v_mov_b32 v125, 0
v_mov_b32 v126, 0
v_mov_b32 v127, 0
v_mov_b32 v172, 0
v_mov_b32 v173, 0
v_mov_b32 v174, 0
v_mov_b32 v175, 0
v_mov_b32 v180, 0
v_mov_b32 v181, 0
v_mov_b32 v182, 0
v_mov_b32 v183, 0
ds_read_b128 a[192:195], v4 offset:49152
ds_read_b128 a[196:199], v4 offset:50176
ds_read_b128 a[200:203], v4 offset:51200
ds_read_b128 a[204:207], v4 offset:52224
ds_read_b128 a[208:211], v4 offset:53248
ds_read_b128 a[212:215], v4 offset:54272
ds_read_b128 a[216:219], v4 offset:55296
ds_read_b128 a[220:223], v4 offset:56320
s_waitcnt lgkmcnt(8)
v_mfma_f32_16x16x32_bf16 a[0:3], a[64:67], v[228:231], 0
s_lshl_b32 s52, s5, 16
v_exp_f32 v80, v80
v_mfma_f32_16x16x32_bf16 a[32:35], a[64:67], v[176:179], 0
s_sub_u32 s52, 1064960, s52
v_exp_f32 v81, v81
v_mfma_f32_16x16x32_bf16 a[4:7], a[68:71], v[228:231], 0
s_add_u32 s71, s68, s52
v_exp_f32 v82, v82
v_mfma_f32_16x16x32_bf16 a[36:39], a[68:71], v[176:179], 0
s_add_u32 s68, s68, 131072
v_exp_f32 v83, v83
v_mfma_f32_16x16x32_bf16 a[8:11], a[72:75], v[228:231], 0
s_lshl2_add_u32 s77, s86, s84
v_cvt_pk_bf16_f32 v200, v80, v81
v_cvt_pk_bf16_f32 v201, v82, v83
v_mfma_f32_16x16x32_bf16 a[40:43], a[72:75], v[176:179], 0
s_mul_i32 s77, s77, 344064
v_exp_f32 v184, v184
v_mfma_f32_16x16x32_bf16 a[12:15], a[76:79], v[228:231], 0
s_add_u32 s77, s77, s70
v_exp_f32 v185, v185
v_mfma_f32_16x16x32_bf16 a[44:47], a[76:79], v[176:179], 0
s_add_u32 s77, s77, 38797312
v_exp_f32 v186, v186
v_mfma_f32_16x16x32_bf16 a[16:19], a[80:83], v[228:231], 0
s_add_u32 s70, s70, 32768
v_exp_f32 v187, v187
v_mfma_f32_16x16x32_bf16 a[48:51], a[80:83], v[176:179], 0
s_mov_b32 s75, 49152
v_cvt_pk_bf16_f32 v76, v184, v185
v_cvt_pk_bf16_f32 v77, v186, v187
v_mfma_f32_16x16x32_bf16 a[20:23], a[84:87], v[228:231], 0
s_mov_b32 s72, 1
v_exp_f32 v208, v208
v_mfma_f32_16x16x32_bf16 a[52:55], a[84:87], v[176:179], 0
s_mov_b32 s73, 16
v_exp_f32 v209, v209
v_mfma_f32_16x16x32_bf16 a[24:27], a[88:91], v[228:231], 0
s_min_u32 s74, s73, s66
v_exp_f32 v210, v210
v_mfma_f32_16x16x32_bf16 a[56:59], a[88:91], v[176:179], 0
v_exp_f32 v211, v211
v_mfma_f32_16x16x32_bf16 a[28:31], a[92:95], v[228:231], 0
v_cvt_pk_bf16_f32 v202, v208, v209
v_cvt_pk_bf16_f32 v203, v210, v211
v_mfma_f32_16x16x32_bf16 a[60:63], a[92:95], v[176:179], 0
v_exp_f32 v84, v84
v_mfma_f32_16x16x32_bf16 a[224:227], a[240:243], v[228:231], 0
s_waitcnt vmcnt(16) lgkmcnt(0)
v_add_u32 v5, 49152, v4
v_mfma_f32_16x16x32_bf16 a[228:231], a[240:243], v[176:179], 0
s_barrier
buffer_atomic_add v1, v0, s[24:27], s90 offen offset:8 sc1
s_cmp_lt_u32 s66, 2
s_cbranch_scc1 L_DN
L_DUAL:
v_mfma_f32_16x16x32_bf16 v[236:239], a[192:195], v[64:67], v[216:219]
s_add_u32 s75, s75, 16384
v_mfma_f32_16x16x32_bf16 v[236:239], a[196:199], v[244:247], v[236:239]
s_and_b32 s75, s75, 131071
v_exp_f32 v85, v85
v_mfma_f32_16x16x32_bf16 v[236:239], a[200:203], v[240:243], v[236:239]
s_cmp_eq_u32 s68, s71
v_cvt_pk_bf16_f32 v78, v84, v85
v_mfma_f32_16x16x32_bf16 v[236:239], a[204:207], v[44:47], v[236:239]
s_waitcnt vmcnt(20)
v_exp_f32 v86, v86
v_mfma_f32_16x16x32_bf16 v[248:251], a[192:195], v[204:207], v[96:99]
s_barrier
v_mfma_f32_16x16x32_bf16 v[248:251], a[196:199], v[252:255], v[248:251]
s_cselect_b32 s64, s77, s68
v_exp_f32 v87, v87
v_mfma_f32_16x16x32_bf16 v[248:251], a[200:203], v[232:235], v[248:251]
v_cvt_pk_bf16_f32 v79, v86, v87
v_mfma_f32_16x16x32_bf16 v[248:251], a[204:207], v[32:35], v[248:251]
v_add_u32 v5, s75, v4
v_mfma_f32_16x16x32_bf16 v[36:39], a[208:211], v[64:67], v[104:107]
v_mfma_f32_16x16x32_bf16 v[36:39], a[212:215], v[244:247], v[36:39]
s_mov_b32 m0, s70
v_exp_f32 v236, v236
v_mfma_f32_16x16x32_bf16 v[36:39], a[216:219], v[240:243], v[36:39]
buffer_load_dwordx4 v4, s[24:27], s64 offen offset:0 sc1 lds
v_mfma_f32_16x16x32_bf16 v[36:39], a[220:223], v[44:47], v[36:39]
s_add_u32 s68, s64, 16384
v_exp_f32 v237, v237
v_mfma_f32_16x16x32_bf16 v[92:95], a[208:211], v[204:207], v[112:115]
v_cvt_pk_bf16_f32 v228, v236, v237
v_mfma_f32_16x16x32_bf16 v[92:95], a[212:215], v[252:255], v[92:95]
s_add_u32 s70, s70, 16384
v_exp_f32 v238, v238
v_mfma_f32_16x16x32_bf16 v[92:95], a[216:219], v[232:235], v[92:95]
v_mfma_f32_16x16x32_bf16 v[92:95], a[220:223], v[32:35], v[92:95]
v_exp_f32 v239, v239
v_mfma_f32_16x16x32_bf16 v[100:103], a[64:67], v[200:203], v[100:103]
v_cvt_pk_bf16_f32 v229, v238, v239
v_mfma_f32_16x16x32_bf16 v[116:119], a[64:67], v[76:79], v[116:119]
s_and_b32 s70, s70, 131071
v_exp_f32 v248, v248
v_mfma_f32_16x16x32_bf16 v[148:151], a[68:71], v[200:203], v[148:151]
buffer_load_dwordx4 v4, s[24:27], s64 offen offset:1024 sc1 lds
v_mfma_f32_16x16x32_bf16 v[132:135], a[68:71], v[76:79], v[132:135]
s_add_u32 s72, s72, 1
v_exp_f32 v249, v249
v_mfma_f32_16x16x32_bf16 v[156:159], a[72:75], v[200:203], v[156:159]
v_cvt_pk_bf16_f32 v176, v248, v249
v_mfma_f32_16x16x32_bf16 v[164:167], a[72:75], v[76:79], v[164:167]
v_exp_f32 v250, v250
v_mfma_f32_16x16x32_bf16 v[196:199], a[76:79], v[200:203], v[196:199]
ds_read_b128 a[64:67], v5 offset:8192
v_mfma_f32_16x16x32_bf16 v[188:191], a[76:79], v[76:79], v[188:191]
v_exp_f32 v251, v251
v_mfma_f32_16x16x32_bf16 v[108:111], a[80:83], v[200:203], v[108:111]
ds_read_b128 a[68:71], v5 offset:9216
v_cvt_pk_bf16_f32 v177, v250, v251
v_mfma_f32_16x16x32_bf16 v[40:43], a[80:83], v[76:79], v[40:43]
v_exp_f32 v36, v36
v_mfma_f32_16x16x32_bf16 v[140:143], a[84:87], v[200:203], v[140:143]
buffer_load_dwordx4 v4, s[24:27], s64 offen offset:2048 sc1 lds
v_mfma_f32_16x16x32_bf16 v[124:127], a[84:87], v[76:79], v[124:127]
v_exp_f32 v37, v37
v_mfma_f32_16x16x32_bf16 v[48:51], a[88:91], v[200:203], v[48:51]
ds_read_b128 a[72:75], v5 offset:10240
v_cvt_pk_bf16_f32 v230, v36, v37
v_mfma_f32_16x16x32_bf16 v[172:175], a[88:91], v[76:79], v[172:175]
v_exp_f32 v38, v38
v_mfma_f32_16x16x32_bf16 v[56:59], a[92:95], v[200:203], v[56:59]
buffer_load_dwordx4 v4, s[24:27], s64 offen offset:3072 sc1 lds
v_mfma_f32_16x16x32_bf16 v[180:183], a[92:95], v[76:79], v[180:183]
v_exp_f32 v39, v39
v_mfma_f32_16x16x32_bf16 a[232:235], a[240:243], v[200:203], a[232:235]
ds_read_b128 a[76:79], v5 offset:11264
v_cvt_pk_bf16_f32 v231, v38, v39
v_mfma_f32_16x16x32_bf16 a[236:239], a[240:243], v[76:79], a[236:239]
v_exp_f32 v92, v92
v_mfma_f32_16x16x32_bf16 v[80:83], a[192:195], v[212:215], v[120:123]
ds_read_b128 a[80:83], v5 offset:12288
ds_read_b128 a[84:87], v5 offset:13312
v_mfma_f32_16x16x32_bf16 v[80:83], a[196:199], v[88:91], v[80:83]
v_exp_f32 v93, v93
v_mfma_f32_16x16x32_bf16 v[80:83], a[200:203], v[224:227], v[80:83]
ds_read_b128 a[88:91], v5 offset:14336
v_cvt_pk_bf16_f32 v178, v92, v93
v_mfma_f32_16x16x32_bf16 v[80:83], a[204:207], v[52:55], v[80:83]
v_exp_f32 v94, v94
v_mfma_f32_16x16x32_bf16 v[184:187], a[192:195], v[220:223], v[128:131]
v_mfma_f32_16x16x32_bf16 v[184:187], a[196:199], v[160:163], v[184:187]
v_exp_f32 v95, v95
v_mfma_f32_16x16x32_bf16 v[184:187], a[200:203], v[192:195], v[184:187]
ds_read_b128 a[92:95], v5 offset:15360
v_cvt_pk_bf16_f32 v179, v94, v95
v_mfma_f32_16x16x32_bf16 v[184:187], a[204:207], v[60:63], v[184:187]
v_mfma_f32_16x16x32_bf16 v[208:211], a[208:211], v[212:215], v[136:139]
ds_read_b128 a[192:195], v5 offset:0
ds_read_b128 a[196:199], v5 offset:1024
v_mfma_f32_16x16x32_bf16 v[208:211], a[212:215], v[88:91], v[208:211]
v_exp_f32 v80, v80
v_mfma_f32_16x16x32_bf16 v[208:211], a[216:219], v[224:227], v[208:211]
v_mfma_f32_16x16x32_bf16 v[208:211], a[220:223], v[52:55], v[208:211]
v_exp_f32 v81, v81
v_mfma_f32_16x16x32_bf16 v[84:87], a[208:211], v[220:223], v[144:147]
ds_read_b128 a[200:203], v5 offset:2048
v_cvt_pk_bf16_f32 v200, v80, v81
v_mfma_f32_16x16x32_bf16 v[84:87], a[212:215], v[160:163], v[84:87]
v_exp_f32 v82, v82
v_mfma_f32_16x16x32_bf16 v[84:87], a[216:219], v[192:195], v[84:87]
ds_read_b128 a[204:207], v5 offset:3072
ds_read_b128 a[208:211], v5 offset:4096
v_mfma_f32_16x16x32_bf16 v[84:87], a[220:223], v[60:63], v[84:87]
s_waitcnt lgkmcnt(5)
v_exp_f32 v83, v83
v_mfma_f32_16x16x32_bf16 a[0:3], a[64:67], v[228:231], a[0:3]
ds_read_b128 a[212:215], v5 offset:5120
v_cvt_pk_bf16_f32 v201, v82, v83
v_mfma_f32_16x16x32_bf16 a[32:35], a[64:67], v[176:179], a[32:35]
v_exp_f32 v184, v184
v_mfma_f32_16x16x32_bf16 a[4:7], a[68:71], v[228:231], a[4:7]
v_mfma_f32_16x16x32_bf16 a[36:39], a[68:71], v[176:179], a[36:39]
v_exp_f32 v185, v185
v_mfma_f32_16x16x32_bf16 a[8:11], a[72:75], v[228:231], a[8:11]
ds_read_b128 a[216:219], v5 offset:6144
v_cvt_pk_bf16_f32 v76, v184, v185
v_mfma_f32_16x16x32_bf16 a[40:43], a[72:75], v[176:179], a[40:43]
v_exp_f32 v186, v186
v_mfma_f32_16x16x32_bf16 a[12:15], a[76:79], v[228:231], a[12:15]
ds_read_b128 a[220:223], v5 offset:7168
v_mfma_f32_16x16x32_bf16 a[44:47], a[76:79], v[176:179], a[44:47]
v_exp_f32 v187, v187
v_mfma_f32_16x16x32_bf16 a[16:19], a[80:83], v[228:231], a[16:19]
v_cvt_pk_bf16_f32 v77, v186, v187
v_mfma_f32_16x16x32_bf16 a[48:51], a[80:83], v[176:179], a[48:51]
v_exp_f32 v208, v208
v_mfma_f32_16x16x32_bf16 a[20:23], a[84:87], v[228:231], a[20:23]
v_mfma_f32_16x16x32_bf16 a[52:55], a[84:87], v[176:179], a[52:55]
v_exp_f32 v209, v209
v_mfma_f32_16x16x32_bf16 a[24:27], a[88:91], v[228:231], a[24:27]
v_cvt_pk_bf16_f32 v202, v208, v209
v_mfma_f32_16x16x32_bf16 a[56:59], a[88:91], v[176:179], a[56:59]
s_cmp_lt_u32 s72, s74
v_exp_f32 v210, v210
v_mfma_f32_16x16x32_bf16 a[28:31], a[92:95], v[228:231], a[28:31]
v_mfma_f32_16x16x32_bf16 a[60:63], a[92:95], v[176:179], a[60:63]
s_waitcnt lgkmcnt(0)
v_exp_f32 v211, v211
v_mfma_f32_16x16x32_bf16 a[224:227], a[240:243], v[228:231], a[224:227]
v_cvt_pk_bf16_f32 v203, v210, v211
v_mfma_f32_16x16x32_bf16 a[228:231], a[240:243], v[176:179], a[228:231]
v_exp_f32 v84, v84
s_cbranch_scc1 L_DUAL
s_cmp_lt_u32 s72, s73
s_cbranch_scc1 L_DN
s_cmp_lg_u32 s73, 16
s_cbranch_scc1 L_DC
v_and_b32 v169, 31, v1
v_lshlrev_b32 v169, 10, v169
v_add_u32 v169, 75497992, v169
buffer_load_dword v168, v169, s[24:27], 0 offen sc1
s_mov_b32 s73, 20
s_branch L_DN
L_DC:
s_waitcnt vmcnt(12)
v_cmp_gt_u32 vcc, 8, v168
s_mov_b32 s73, 64
s_nop 3
s_cbranch_vccnz CK_D
CK_D_R:
L_DN:
s_min_u32 s74, s73, s66
s_cmp_lt_u32 s72, s66
s_cbranch_scc1 L_DUAL
s_cmp_gt_u32 s72, s66
s_cbranch_scc1 L_POST
v_cndmask_b32 v216, v216, v6, s[56:57]
v_cndmask_b32 v112, v112, v6, s[56:57]
v_mov_b32 v104, v6
v_cndmask_b32 v217, v217, v6, s[58:59]
v_cndmask_b32 v113, v113, v6, s[58:59]
v_mov_b32 v105, v6
v_cndmask_b32 v218, v218, v6, s[60:61]
v_cndmask_b32 v114, v114, v6, s[60:61]
v_mov_b32 v106, v6
v_cndmask_b32 v219, v219, v6, s[62:63]
v_cndmask_b32 v115, v115, v6, s[62:63]
v_mov_b32 v107, v6
s_nop 0
s_branch L_DUAL
L_POST:
s_lshr_b32 s52, s4, 3
s_mul_i32 s52, s52, 75776
s_and_b32 s53, s4, 7
s_lshl_b32 s53, s53, 13
s_add_u32 s52, s52, s53
s_add_u32 s52, s52, 54525952
s_mul_i32 s78, s66, 303104
s_add_u32 s78, s78, s52
s_mul_i32 s79, s67, 303104
s_add_u32 s79, s79, s52
s_mov_b32 s76, 0
v_mov_b32 v7, 0x5d800000
s_cmp_ge_u32 s3, 2
s_cbranch_scc1 L_SN
v_accvgpr_read_b32 v72, a224
v_accvgpr_read_b32 v74, a228
v_cmp_nle_f32 vcc, v72, v7
v_cmp_nle_f32 s[96:97], v74, v7
s_nop 3
s_or_b64 vcc, vcc, s[96:97]
s_cbranch_vccnz L_SN
v_mul_f32 v8, 0x3fb8aa3b, v8
v_mul_f32 v9, 0x3fb8aa3b, v9
v_exp_f32 v8, v8
v_exp_f32 v9, v9
s_nop 0
v_fma_f32 v72, v72, v8, v72
v_fma_f32 v74, v74, v9, v74
v_rcp_f32 v72, v72
v_rcp_f32 v74, v74
s_add_u32 s52, s78, 4096
v_mov_b32 v73, v72
v_mov_b32 v75, v74
v_accvgpr_read_b32 v16, a0
v_accvgpr_read_b32 v17, a1
v_accvgpr_read_b32 v18, a2
v_accvgpr_read_b32 v19, a3
v_accvgpr_read_b32 v20, a4
v_accvgpr_read_b32 v21, a5
v_accvgpr_read_b32 v22, a6
v_accvgpr_read_b32 v23, a7
v_pk_mul_f32 v[16:17], v[16:17], v[72:73]
v_pk_mul_f32 v[18:19], v[18:19], v[72:73]
v_pk_mul_f32 v[20:21], v[20:21], v[72:73]
v_pk_mul_f32 v[22:23], v[22:23], v[72:73]
v_cvt_pk_bf16_f32 v16, v16, v17
v_cvt_pk_bf16_f32 v17, v18, v19
v_cvt_pk_bf16_f32 v18, v20, v21
v_cvt_pk_bf16_f32 v19, v22, v23
buffer_store_dwordx4 v[16:19], v4, s[24:27], s78 offen offset:0 sc1
v_accvgpr_read_b32 v24, a32
v_accvgpr_read_b32 v25, a33
v_accvgpr_read_b32 v26, a34
v_accvgpr_read_b32 v27, a35
v_accvgpr_read_b32 v28, a36
v_accvgpr_read_b32 v29, a37
v_accvgpr_read_b32 v30, a38
v_accvgpr_read_b32 v31, a39
v_pk_mul_f32 v[24:25], v[24:25], v[74:75]
v_pk_mul_f32 v[26:27], v[26:27], v[74:75]
v_pk_mul_f32 v[28:29], v[28:29], v[74:75]
v_pk_mul_f32 v[30:31], v[30:31], v[74:75]
v_cvt_pk_bf16_f32 v24, v24, v25
v_cvt_pk_bf16_f32 v25, v26, v27
v_cvt_pk_bf16_f32 v26, v28, v29
v_cvt_pk_bf16_f32 v27, v30, v31
buffer_store_dwordx4 v[24:27], v4, s[24:27], s78 offen offset:1024 sc1
v_accvgpr_read_b32 v16, a8
v_accvgpr_read_b32 v17, a9
v_accvgpr_read_b32 v18, a10
v_accvgpr_read_b32 v19, a11
v_accvgpr_read_b32 v20, a12
v_accvgpr_read_b32 v21, a13
v_accvgpr_read_b32 v22, a14
v_accvgpr_read_b32 v23, a15
v_pk_mul_f32 v[16:17], v[16:17], v[72:73]
v_pk_mul_f32 v[18:19], v[18:19], v[72:73]
v_pk_mul_f32 v[20:21], v[20:21], v[72:73]
v_pk_mul_f32 v[22:23], v[22:23], v[72:73]
v_cvt_pk_bf16_f32 v16, v16, v17
v_cvt_pk_bf16_f32 v17, v18, v19
v_cvt_pk_bf16_f32 v18, v20, v21
v_cvt_pk_bf16_f32 v19, v22, v23
buffer_store_dwordx4 v[16:19], v4, s[24:27], s78 offen offset:2048 sc1
v_accvgpr_read_b32 v24, a40
v_accvgpr_read_b32 v25, a41
v_accvgpr_read_b32 v26, a42
v_accvgpr_read_b32 v27, a43
v_accvgpr_read_b32 v28, a44
v_accvgpr_read_b32 v29, a45
v_accvgpr_read_b32 v30, a46
v_accvgpr_read_b32 v31, a47
v_pk_mul_f32 v[24:25], v[24:25], v[74:75]
v_pk_mul_f32 v[26:27], v[26:27], v[74:75]
v_pk_mul_f32 v[28:29], v[28:29], v[74:75]
v_pk_mul_f32 v[30:31], v[30:31], v[74:75]
v_cvt_pk_bf16_f32 v24, v24, v25
v_cvt_pk_bf16_f32 v25, v26, v27
v_cvt_pk_bf16_f32 v26, v28, v29
v_cvt_pk_bf16_f32 v27, v30, v31
buffer_store_dwordx4 v[24:27], v4, s[24:27], s78 offen offset:3072 sc1
v_accvgpr_read_b32 v16, a16
v_accvgpr_read_b32 v17, a17
v_accvgpr_read_b32 v18, a18
v_accvgpr_read_b32 v19, a19
v_accvgpr_read_b32 v20, a20
v_accvgpr_read_b32 v21, a21
v_accvgpr_read_b32 v22, a22
v_accvgpr_read_b32 v23, a23
v_pk_mul_f32 v[16:17], v[16:17], v[72:73]
v_pk_mul_f32 v[18:19], v[18:19], v[72:73]
v_pk_mul_f32 v[20:21], v[20:21], v[72:73]
v_pk_mul_f32 v[22:23], v[22:23], v[72:73]
v_cvt_pk_bf16_f32 v16, v16, v17
v_cvt_pk_bf16_f32 v17, v18, v19
v_cvt_pk_bf16_f32 v18, v20, v21
v_cvt_pk_bf16_f32 v19, v22, v23
buffer_store_dwordx4 v[16:19], v4, s[24:27], s52 offen offset:0 sc1
v_accvgpr_read_b32 v24, a48
v_accvgpr_read_b32 v25, a49
v_accvgpr_read_b32 v26, a50
v_accvgpr_read_b32 v27, a51
v_accvgpr_read_b32 v28, a52
v_accvgpr_read_b32 v29, a53
v_accvgpr_read_b32 v30, a54
v_accvgpr_read_b32 v31, a55
v_pk_mul_f32 v[24:25], v[24:25], v[74:75]
v_pk_mul_f32 v[26:27], v[26:27], v[74:75]
v_pk_mul_f32 v[28:29], v[28:29], v[74:75]
v_pk_mul_f32 v[30:31], v[30:31], v[74:75]
v_cvt_pk_bf16_f32 v24, v24, v25
v_cvt_pk_bf16_f32 v25, v26, v27
v_cvt_pk_bf16_f32 v26, v28, v29
v_cvt_pk_bf16_f32 v27, v30, v31
buffer_store_dwordx4 v[24:27], v4, s[24:27], s52 offen offset:1024 sc1
v_accvgpr_read_b32 v16, a24
v_accvgpr_read_b32 v17, a25
v_accvgpr_read_b32 v18, a26
v_accvgpr_read_b32 v19, a27
v_accvgpr_read_b32 v20, a28
v_accvgpr_read_b32 v21, a29
v_accvgpr_read_b32 v22, a30
v_accvgpr_read_b32 v23, a31
v_pk_mul_f32 v[16:17], v[16:17], v[72:73]
v_pk_mul_f32 v[18:19], v[18:19], v[72:73]
v_pk_mul_f32 v[20:21], v[20:21], v[72:73]
v_pk_mul_f32 v[22:23], v[22:23], v[72:73]
v_cvt_pk_bf16_f32 v16, v16, v17
v_cvt_pk_bf16_f32 v17, v18, v19
v_cvt_pk_bf16_f32 v18, v20, v21
v_cvt_pk_bf16_f32 v19, v22, v23
buffer_store_dwordx4 v[16:19], v4, s[24:27], s52 offen offset:2048 sc1
v_accvgpr_read_b32 v24, a56
v_accvgpr_read_b32 v25, a57
v_accvgpr_read_b32 v26, a58
v_accvgpr_read_b32 v27, a59
v_accvgpr_read_b32 v28, a60
v_accvgpr_read_b32 v29, a61
v_accvgpr_read_b32 v30, a62
v_accvgpr_read_b32 v31, a63
v_pk_mul_f32 v[24:25], v[24:25], v[74:75]
v_pk_mul_f32 v[26:27], v[26:27], v[74:75]
v_pk_mul_f32 v[28:29], v[28:29], v[74:75]
v_pk_mul_f32 v[30:31], v[30:31], v[74:75]
v_cvt_pk_bf16_f32 v24, v24, v25
v_cvt_pk_bf16_f32 v25, v26, v27
v_cvt_pk_bf16_f32 v26, v28, v29
v_cvt_pk_bf16_f32 v27, v30, v31
buffer_store_dwordx4 v[24:27], v4, s[24:27], s52 offen offset:3072 sc1
s_mov_b32 s76, 1
s_min_u32 s74, s73, s67
L_SINGLE:
v_mfma_f32_16x16x32_bf16 v[236:239], a[192:195], v[212:215], v[120:123]
s_add_u32 s75, s75, 16384
ds_read_b128 a[80:83], v5 offset:12288
ds_read_b128 a[84:87], v5 offset:13312
v_mfma_f32_16x16x32_bf16 v[236:239], a[196:199], v[88:91], v[236:239]
s_and_b32 s75, s75, 131071
v_exp_f32 v85, v85
v_mfma_f32_16x16x32_bf16 v[236:239], a[200:203], v[224:227], v[236:239]
s_cmp_eq_u32 s68, s71
ds_read_b128 a[88:91], v5 offset:14336
v_cvt_pk_bf16_f32 v78, v84, v85
v_mfma_f32_16x16x32_bf16 v[236:239], a[204:207], v[52:55], v[236:239]
s_waitcnt vmcnt(20)
v_exp_f32 v86, v86
v_mfma_f32_16x16x32_bf16 v[248:251], a[192:195], v[220:223], v[128:131]
s_barrier
v_mfma_f32_16x16x32_bf16 v[248:251], a[196:199], v[160:163], v[248:251]
s_cselect_b32 s64, s77, s68
v_exp_f32 v87, v87
v_mfma_f32_16x16x32_bf16 v[248:251], a[200:203], v[192:195], v[248:251]
ds_read_b128 a[92:95], v5 offset:15360
v_cvt_pk_bf16_f32 v79, v86, v87
v_mfma_f32_16x16x32_bf16 v[248:251], a[204:207], v[60:63], v[248:251]
v_add_u32 v5, s75, v4
v_mfma_f32_16x16x32_bf16 v[36:39], a[208:211], v[212:215], v[136:139]
ds_read_b128 a[192:195], v5 offset:0
ds_read_b128 a[196:199], v5 offset:1024
v_mfma_f32_16x16x32_bf16 v[36:39], a[212:215], v[88:91], v[36:39]
s_mov_b32 m0, s70
v_exp_f32 v236, v236
v_mfma_f32_16x16x32_bf16 v[36:39], a[216:219], v[224:227], v[36:39]
buffer_load_dwordx4 v4, s[24:27], s64 offen offset:0 sc1 lds
v_mfma_f32_16x16x32_bf16 v[36:39], a[220:223], v[52:55], v[36:39]
s_add_u32 s68, s64, 16384
v_exp_f32 v237, v237
v_mfma_f32_16x16x32_bf16 v[92:95], a[208:211], v[220:223], v[144:147]
ds_read_b128 a[200:203], v5 offset:2048
v_cvt_pk_bf16_f32 v228, v236, v237
v_mfma_f32_16x16x32_bf16 v[92:95], a[212:215], v[160:163], v[92:95]
s_add_u32 s70, s70, 16384
v_exp_f32 v238, v238
v_mfma_f32_16x16x32_bf16 v[92:95], a[216:219], v[192:195], v[92:95]
ds_read_b128 a[204:207], v5 offset:3072
ds_read_b128 a[208:211], v5 offset:4096
v_mfma_f32_16x16x32_bf16 v[92:95], a[220:223], v[60:63], v[92:95]
s_waitcnt lgkmcnt(5)
v_exp_f32 v239, v239
v_mfma_f32_16x16x32_bf16 v[100:103], a[64:67], v[200:203], v[100:103]
ds_read_b128 a[212:215], v5 offset:5120
v_cvt_pk_bf16_f32 v229, v238, v239
v_mfma_f32_16x16x32_bf16 v[116:119], a[64:67], v[76:79], v[116:119]
s_and_b32 s70, s70, 131071
v_exp_f32 v248, v248
v_mfma_f32_16x16x32_bf16 v[148:151], a[68:71], v[200:203], v[148:151]
buffer_load_dwordx4 v4, s[24:27], s64 offen offset:1024 sc1 lds
v_mfma_f32_16x16x32_bf16 v[132:135], a[68:71], v[76:79], v[132:135]
s_add_u32 s72, s72, 1
v_exp_f32 v249, v249
v_mfma_f32_16x16x32_bf16 v[156:159], a[72:75], v[200:203], v[156:159]
ds_read_b128 a[216:219], v5 offset:6144
v_cvt_pk_bf16_f32 v176, v248, v249
v_mfma_f32_16x16x32_bf16 v[164:167], a[72:75], v[76:79], v[164:167]
v_exp_f32 v250, v250
v_mfma_f32_16x16x32_bf16 v[196:199], a[76:79], v[200:203], v[196:199]
ds_read_b128 a[220:223], v5 offset:7168
ds_read_b128 a[64:67], v5 offset:8192
v_mfma_f32_16x16x32_bf16 v[188:191], a[76:79], v[76:79], v[188:191]
v_exp_f32 v251, v251
v_mfma_f32_16x16x32_bf16 v[108:111], a[80:83], v[200:203], v[108:111]
ds_read_b128 a[68:71], v5 offset:9216
v_cvt_pk_bf16_f32 v177, v250, v251
v_mfma_f32_16x16x32_bf16 v[40:43], a[80:83], v[76:79], v[40:43]
v_exp_f32 v36, v36
v_mfma_f32_16x16x32_bf16 v[140:143], a[84:87], v[200:203], v[140:143]
buffer_load_dwordx4 v4, s[24:27], s64 offen offset:2048 sc1 lds
v_mfma_f32_16x16x32_bf16 v[124:127], a[84:87], v[76:79], v[124:127]
v_exp_f32 v37, v37
v_mfma_f32_16x16x32_bf16 v[48:51], a[88:91], v[200:203], v[48:51]
ds_read_b128 a[72:75], v5 offset:10240
v_cvt_pk_bf16_f32 v230, v36, v37
v_mfma_f32_16x16x32_bf16 v[172:175], a[88:91], v[76:79], v[172:175]
v_exp_f32 v38, v38
v_mfma_f32_16x16x32_bf16 v[56:59], a[92:95], v[200:203], v[56:59]
buffer_load_dwordx4 v4, s[24:27], s64 offen offset:3072 sc1 lds
v_mfma_f32_16x16x32_bf16 v[180:183], a[92:95], v[76:79], v[180:183]
s_waitcnt lgkmcnt(3)
v_exp_f32 v39, v39
v_mfma_f32_16x16x32_bf16 a[232:235], a[240:243], v[200:203], a[232:235]
ds_read_b128 a[76:79], v5 offset:11264
v_cvt_pk_bf16_f32 v231, v38, v39
v_mfma_f32_16x16x32_bf16 a[236:239], a[240:243], v[76:79], a[236:239]
v_exp_f32 v92, v92
v_mfma_f32_16x16x32_bf16 v[80:83], a[192:195], v[212:215], v[120:123]
s_add_u32 s75, s75, 16384
ds_read_b128 a[80:83], v5 offset:12288
ds_read_b128 a[84:87], v5 offset:13312
v_mfma_f32_16x16x32_bf16 v[80:83], a[196:199], v[88:91], v[80:83]
s_and_b32 s75, s75, 131071
v_exp_f32 v93, v93
v_mfma_f32_16x16x32_bf16 v[80:83], a[200:203], v[224:227], v[80:83]
s_cmp_eq_u32 s68, s71
ds_read_b128 a[88:91], v5 offset:14336
v_cvt_pk_bf16_f32 v178, v92, v93
v_mfma_f32_16x16x32_bf16 v[80:83], a[204:207], v[52:55], v[80:83]
s_waitcnt vmcnt(20)
v_exp_f32 v94, v94
v_mfma_f32_16x16x32_bf16 v[184:187], a[192:195], v[220:223], v[128:131]
s_barrier
v_mfma_f32_16x16x32_bf16 v[184:187], a[196:199], v[160:163], v[184:187]
s_cselect_b32 s64, s77, s68
v_exp_f32 v95, v95
v_mfma_f32_16x16x32_bf16 v[184:187], a[200:203], v[192:195], v[184:187]
ds_read_b128 a[92:95], v5 offset:15360
v_cvt_pk_bf16_f32 v179, v94, v95
v_mfma_f32_16x16x32_bf16 v[184:187], a[204:207], v[60:63], v[184:187]
v_add_u32 v5, s75, v4
v_mfma_f32_16x16x32_bf16 v[208:211], a[208:211], v[212:215], v[136:139]
ds_read_b128 a[192:195], v5 offset:0
ds_read_b128 a[196:199], v5 offset:1024
v_mfma_f32_16x16x32_bf16 v[208:211], a[212:215], v[88:91], v[208:211]
s_mov_b32 m0, s70
v_exp_f32 v80, v80
v_mfma_f32_16x16x32_bf16 v[208:211], a[216:219], v[224:227], v[208:211]
buffer_load_dwordx4 v4, s[24:27], s64 offen offset:0 sc1 lds
v_mfma_f32_16x16x32_bf16 v[208:211], a[220:223], v[52:55], v[208:211]
s_add_u32 s68, s64, 16384
v_exp_f32 v81, v81
v_mfma_f32_16x16x32_bf16 v[84:87], a[208:211], v[220:223], v[144:147]
ds_read_b128 a[200:203], v5 offset:2048
v_cvt_pk_bf16_f32 v200, v80, v81
v_mfma_f32_16x16x32_bf16 v[84:87], a[212:215], v[160:163], v[84:87]
s_add_u32 s70, s70, 16384
v_exp_f32 v82, v82
v_mfma_f32_16x16x32_bf16 v[84:87], a[216:219], v[192:195], v[84:87]
ds_read_b128 a[204:207], v5 offset:3072
ds_read_b128 a[208:211], v5 offset:4096
v_mfma_f32_16x16x32_bf16 v[84:87], a[220:223], v[60:63], v[84:87]
s_waitcnt lgkmcnt(5)
v_exp_f32 v83, v83
v_mfma_f32_16x16x32_bf16 v[100:103], a[64:67], v[228:231], v[100:103]
ds_read_b128 a[212:215], v5 offset:5120
v_cvt_pk_bf16_f32 v201, v82, v83
v_mfma_f32_16x16x32_bf16 v[116:119], a[64:67], v[176:179], v[116:119]
s_and_b32 s70, s70, 131071
v_exp_f32 v184, v184
v_mfma_f32_16x16x32_bf16 v[148:151], a[68:71], v[228:231], v[148:151]
buffer_load_dwordx4 v4, s[24:27], s64 offen offset:1024 sc1 lds
v_mfma_f32_16x16x32_bf16 v[132:135], a[68:71], v[176:179], v[132:135]
s_add_u32 s72, s72, 1
v_exp_f32 v185, v185
v_mfma_f32_16x16x32_bf16 v[156:159], a[72:75], v[228:231], v[156:159]
ds_read_b128 a[216:219], v5 offset:6144
v_cvt_pk_bf16_f32 v76, v184, v185
v_mfma_f32_16x16x32_bf16 v[164:167], a[72:75], v[176:179], v[164:167]
v_exp_f32 v186, v186
v_mfma_f32_16x16x32_bf16 v[196:199], a[76:79], v[228:231], v[196:199]
ds_read_b128 a[220:223], v5 offset:7168
ds_read_b128 a[64:67], v5 offset:8192
v_mfma_f32_16x16x32_bf16 v[188:191], a[76:79], v[176:179], v[188:191]
v_exp_f32 v187, v187
v_mfma_f32_16x16x32_bf16 v[108:111], a[80:83], v[228:231], v[108:111]
ds_read_b128 a[68:71], v5 offset:9216
v_cvt_pk_bf16_f32 v77, v186, v187
v_mfma_f32_16x16x32_bf16 v[40:43], a[80:83], v[176:179], v[40:43]
v_exp_f32 v208, v208
v_mfma_f32_16x16x32_bf16 v[140:143], a[84:87], v[228:231], v[140:143]
buffer_load_dwordx4 v4, s[24:27], s64 offen offset:2048 sc1 lds
v_mfma_f32_16x16x32_bf16 v[124:127], a[84:87], v[176:179], v[124:127]
v_exp_f32 v209, v209
v_mfma_f32_16x16x32_bf16 v[48:51], a[88:91], v[228:231], v[48:51]
ds_read_b128 a[72:75], v5 offset:10240
v_cvt_pk_bf16_f32 v202, v208, v209
v_mfma_f32_16x16x32_bf16 v[172:175], a[88:91], v[176:179], v[172:175]
s_cmp_lt_u32 s72, s74
v_exp_f32 v210, v210
v_mfma_f32_16x16x32_bf16 v[56:59], a[92:95], v[228:231], v[56:59]
buffer_load_dwordx4 v4, s[24:27], s64 offen offset:3072 sc1 lds
v_mfma_f32_16x16x32_bf16 v[180:183], a[92:95], v[176:179], v[180:183]
s_waitcnt lgkmcnt(3)
v_exp_f32 v211, v211
v_mfma_f32_16x16x32_bf16 a[232:235], a[240:243], v[228:231], a[232:235]
ds_read_b128 a[76:79], v5 offset:11264
v_cvt_pk_bf16_f32 v203, v210, v211
v_mfma_f32_16x16x32_bf16 a[236:239], a[240:243], v[176:179], a[236:239]
v_exp_f32 v84, v84
s_cbranch_scc1 L_SINGLE
s_cmp_lt_u32 s72, s73
s_cbranch_scc1 L_SN
s_cmp_lg_u32 s73, 16
s_cbranch_scc1 L_SC
v_and_b32 v169, 31, v1
v_lshlrev_b32 v169, 10, v169
v_add_u32 v169, 75497992, v169
buffer_load_dword v168, v169, s[24:27], 0 offen sc1
s_mov_b32 s73, 20
s_branch L_SN
L_SC:
s_waitcnt vmcnt(12)
v_cmp_gt_u32 vcc, 8, v168
s_mov_b32 s73, 64
s_nop 3
s_cbranch_vccnz CK_S
CK_S_R:
L_SN:
s_min_u32 s74, s73, s67
s_cmp_lt_u32 s72, s67
s_cbranch_scc1 L_SINGLE
v_cndmask_b32 v120, v120, v6, s[56:57]
v_cndmask_b32 v144, v144, v6, s[56:57]
v_mov_b32 v136, v6
v_cndmask_b32 v121, v121, v6, s[58:59]
v_cndmask_b32 v145, v145, v6, s[58:59]
v_mov_b32 v137, v6
v_cndmask_b32 v122, v122, v6, s[60:61]
v_cndmask_b32 v146, v146, v6, s[60:61]
v_mov_b32 v138, v6
v_cndmask_b32 v123, v123, v6, s[62:63]
v_cndmask_b32 v147, v147, v6, s[62:63]
v_mov_b32 v139, v6
s_nop 1
v_mfma_f32_16x16x32_bf16 v[236:239], a[192:195], v[212:215], v[120:123]
s_add_u32 s75, s75, 16384
ds_read_b128 a[80:83], v5 offset:12288
ds_read_b128 a[84:87], v5 offset:13312
v_mfma_f32_16x16x32_bf16 v[236:239], a[196:199], v[88:91], v[236:239]
s_and_b32 s75, s75, 131071
v_exp_f32 v85, v85
v_mfma_f32_16x16x32_bf16 v[236:239], a[200:203], v[224:227], v[236:239]
s_cmp_eq_u32 s68, s71
ds_read_b128 a[88:91], v5 offset:14336
v_cvt_pk_bf16_f32 v78, v84, v85
v_mfma_f32_16x16x32_bf16 v[236:239], a[204:207], v[52:55], v[236:239]
s_waitcnt vmcnt(8)
v_exp_f32 v86, v86
v_mfma_f32_16x16x32_bf16 v[248:251], a[192:195], v[220:223], v[128:131]
s_barrier
v_mfma_f32_16x16x32_bf16 v[248:251], a[196:199], v[160:163], v[248:251]
s_cselect_b32 s64, s77, s68
v_exp_f32 v87, v87
v_mfma_f32_16x16x32_bf16 v[248:251], a[200:203], v[192:195], v[248:251]
ds_read_b128 a[92:95], v5 offset:15360
v_cvt_pk_bf16_f32 v79, v86, v87
v_mfma_f32_16x16x32_bf16 v[248:251], a[204:207], v[60:63], v[248:251]
v_add_u32 v5, s75, v4
v_mfma_f32_16x16x32_bf16 v[36:39], a[208:211], v[212:215], v[136:139]
v_mfma_f32_16x16x32_bf16 v[36:39], a[212:215], v[88:91], v[36:39]
s_mov_b32 m0, s70
v_exp_f32 v236, v236
v_mfma_f32_16x16x32_bf16 v[36:39], a[216:219], v[224:227], v[36:39]
buffer_load_dwordx4 v4, s[24:27], s64 offen offset:0 sc1 lds
v_mfma_f32_16x16x32_bf16 v[36:39], a[220:223], v[52:55], v[36:39]
s_add_u32 s68, s64, 16384
v_exp_f32 v237, v237
v_mfma_f32_16x16x32_bf16 v[92:95], a[208:211], v[220:223], v[144:147]
v_cvt_pk_bf16_f32 v228, v236, v237
v_mfma_f32_16x16x32_bf16 v[92:95], a[212:215], v[160:163], v[92:95]
s_add_u32 s70, s70, 16384
v_exp_f32 v238, v238
v_mfma_f32_16x16x32_bf16 v[92:95], a[216:219], v[192:195], v[92:95]
v_mfma_f32_16x16x32_bf16 v[92:95], a[220:223], v[60:63], v[92:95]
s_waitcnt lgkmcnt(0)
v_exp_f32 v239, v239
v_mfma_f32_16x16x32_bf16 v[100:103], a[64:67], v[200:203], v[100:103]
v_cvt_pk_bf16_f32 v229, v238, v239
v_mfma_f32_16x16x32_bf16 v[116:119], a[64:67], v[76:79], v[116:119]
s_and_b32 s70, s70, 131071
v_exp_f32 v248, v248
v_mfma_f32_16x16x32_bf16 v[148:151], a[68:71], v[200:203], v[148:151]
buffer_load_dwordx4 v4, s[24:27], s64 offen offset:1024 sc1 lds
v_mfma_f32_16x16x32_bf16 v[132:135], a[68:71], v[76:79], v[132:135]
s_add_u32 s72, s72, 1
v_exp_f32 v249, v249
v_mfma_f32_16x16x32_bf16 v[156:159], a[72:75], v[200:203], v[156:159]
v_cvt_pk_bf16_f32 v176, v248, v249
v_mfma_f32_16x16x32_bf16 v[164:167], a[72:75], v[76:79], v[164:167]
v_exp_f32 v250, v250
v_mfma_f32_16x16x32_bf16 v[196:199], a[76:79], v[200:203], v[196:199]
ds_read_b128 a[64:67], v5 offset:8192
v_mfma_f32_16x16x32_bf16 v[188:191], a[76:79], v[76:79], v[188:191]
v_exp_f32 v251, v251
v_mfma_f32_16x16x32_bf16 v[108:111], a[80:83], v[200:203], v[108:111]
ds_read_b128 a[68:71], v5 offset:9216
v_cvt_pk_bf16_f32 v177, v250, v251
v_mfma_f32_16x16x32_bf16 v[40:43], a[80:83], v[76:79], v[40:43]
v_exp_f32 v36, v36
v_mfma_f32_16x16x32_bf16 v[140:143], a[84:87], v[200:203], v[140:143]
buffer_load_dwordx4 v4, s[24:27], s64 offen offset:2048 sc1 lds
v_mfma_f32_16x16x32_bf16 v[124:127], a[84:87], v[76:79], v[124:127]
v_exp_f32 v37, v37
v_mfma_f32_16x16x32_bf16 v[48:51], a[88:91], v[200:203], v[48:51]
ds_read_b128 a[72:75], v5 offset:10240
v_cvt_pk_bf16_f32 v230, v36, v37
v_mfma_f32_16x16x32_bf16 v[172:175], a[88:91], v[76:79], v[172:175]
v_exp_f32 v38, v38
v_mfma_f32_16x16x32_bf16 v[56:59], a[92:95], v[200:203], v[56:59]
buffer_load_dwordx4 v4, s[24:27], s64 offen offset:3072 sc1 lds
v_mfma_f32_16x16x32_bf16 v[180:183], a[92:95], v[76:79], v[180:183]
v_exp_f32 v39, v39
v_mfma_f32_16x16x32_bf16 a[232:235], a[240:243], v[200:203], a[232:235]
ds_read_b128 a[76:79], v5 offset:11264
v_cvt_pk_bf16_f32 v231, v38, v39
v_mfma_f32_16x16x32_bf16 a[236:239], a[240:243], v[76:79], a[236:239]
v_exp_f32 v92, v92
ds_read_b128 a[80:83], v5 offset:12288
ds_read_b128 a[84:87], v5 offset:13312
ds_read_b128 a[88:91], v5 offset:14336
ds_read_b128 a[92:95], v5 offset:15360
v_exp_f32 v93, v93
v_exp_f32 v94, v94
v_exp_f32 v95, v95
s_cmp_lt_u32 s3, 1
s_cbranch_scc1 L_XB1
s_barrier
s_mov_b32 m0, s70
s_mov_b32 s64, s68
s_add_u32 s68, s68, 16384
s_add_u32 s70, s70, 16384
s_and_b32 s70, s70, 131071
buffer_load_dwordx4 v4, s[24:27], s64 offen offset:0 sc1 lds
buffer_load_dwordx4 v4, s[24:27], s64 offen offset:1024 sc1 lds
buffer_load_dwordx4 v4, s[24:27], s64 offen offset:2048 sc1 lds
buffer_load_dwordx4 v4, s[24:27], s64 offen offset:3072 sc1 lds
L_XB1:
v_cvt_pk_bf16_f32 v178, v92, v93
v_cvt_pk_bf16_f32 v179, v94, v95
s_lshl_b32 s53, s4, 18
s_add_u32 s53, s53, 45088768
s_lshl_b32 s54, s66, 9
s_add_u32 s54, s54, s53
s_lshl_b32 s55, s67, 9
s_add_u32 s55, s55, s53
s_add_u32 m0, s83, 0
s_add_u32 s64, s54, 65280
s_mov_b32 exec_hi, 0xffff
buffer_load_dwordx4 v4, s[24:27], s64 offen sc1 lds
s_mov_b32 exec_hi, -1
s_waitcnt lgkmcnt(0)
v_mfma_f32_16x16x32_bf16 v[100:103], a[64:67], v[228:231], v[100:103]
s_add_u32 m0, s83, 768
s_add_u32 s64, s54, 98048
v_mfma_f32_16x16x32_bf16 v[116:119], a[64:67], v[176:179], v[116:119]
s_mov_b32 exec_hi, 0xffff
buffer_load_dwordx4 v4, s[24:27], s64 offen sc1 lds
s_mov_b32 exec_hi, -1
v_mfma_f32_16x16x32_bf16 v[148:151], a[68:71], v[228:231], v[148:151]
s_add_u32 m0, s83, 1536
s_add_u32 s64, s54, 130816
v_mfma_f32_16x16x32_bf16 v[132:135], a[68:71], v[176:179], v[132:135]
s_mov_b32 exec_hi, 0xffff
buffer_load_dwordx4 v4, s[24:27], s64 offen sc1 lds
s_mov_b32 exec_hi, -1
v_mfma_f32_16x16x32_bf16 v[156:159], a[72:75], v[228:231], v[156:159]
s_add_u32 m0, s83, 2304
s_add_u32 s64, s54, 163584
v_mfma_f32_16x16x32_bf16 v[164:167], a[72:75], v[176:179], v[164:167]
s_mov_b32 exec_hi, 0xffff
buffer_load_dwordx4 v4, s[24:27], s64 offen sc1 lds
s_mov_b32 exec_hi, -1
v_mfma_f32_16x16x32_bf16 v[196:199], a[76:79], v[228:231], v[196:199]
s_add_u32 m0, s83, 3072
s_add_u32 s64, s54, 196352
v_mfma_f32_16x16x32_bf16 v[188:191], a[76:79], v[176:179], v[188:191]
s_mov_b32 exec_hi, 0xffff
buffer_load_dwordx4 v4, s[24:27], s64 offen sc1 lds
s_mov_b32 exec_hi, -1
v_mfma_f32_16x16x32_bf16 v[108:111], a[80:83], v[228:231], v[108:111]
s_add_u32 m0, s83, 3840
s_add_u32 s64, s55, 65280
v_mfma_f32_16x16x32_bf16 v[40:43], a[80:83], v[176:179], v[40:43]
s_mov_b32 exec_hi, 0xffff
buffer_load_dwordx4 v4, s[24:27], s64 offen sc1 lds
s_mov_b32 exec_hi, -1
v_mfma_f32_16x16x32_bf16 v[140:143], a[84:87], v[228:231], v[140:143]
s_add_u32 m0, s83, 4608
s_add_u32 s64, s55, 98048
v_mfma_f32_16x16x32_bf16 v[124:127], a[84:87], v[176:179], v[124:127]
s_mov_b32 exec_hi, 0xffff
buffer_load_dwordx4 v4, s[24:27], s64 offen sc1 lds
s_mov_b32 exec_hi, -1
v_mfma_f32_16x16x32_bf16 v[48:51], a[88:91], v[228:231], v[48:51]
s_add_u32 m0, s83, 5376
s_add_u32 s64, s55, 130816
v_mfma_f32_16x16x32_bf16 v[172:175], a[88:91], v[176:179], v[172:175]
s_mov_b32 exec_hi, 0xffff
buffer_load_dwordx4 v4, s[24:27], s64 offen sc1 lds
s_mov_b32 exec_hi, -1
v_mfma_f32_16x16x32_bf16 v[56:59], a[92:95], v[228:231], v[56:59]
s_add_u32 m0, s83, 6144
s_add_u32 s64, s55, 163584
v_mfma_f32_16x16x32_bf16 v[180:183], a[92:95], v[176:179], v[180:183]
s_mov_b32 exec_hi, 0xffff
buffer_load_dwordx4 v4, s[24:27], s64 offen sc1 lds
s_mov_b32 exec_hi, -1
v_mfma_f32_16x16x32_bf16 a[232:235], a[240:243], v[228:231], a[232:235]
s_add_u32 m0, s83, 6912
s_add_u32 s64, s55, 196352
v_mfma_f32_16x16x32_bf16 a[236:239], a[240:243], v[176:179], a[236:239]
s_mov_b32 exec_hi, 0xffff
buffer_load_dwordx4 v4, s[24:27], s64 offen sc1 lds
s_mov_b32 exec_hi, -1
v_and_b32 v154, 31, v1
v_cmp_lt_u32 vcc, 31, v1
v_mov_b32 v152, s66
v_mov_b32 v155, s67
v_cndmask_b32 v152, v152, v155, vcc
v_lshl_add_u32 v152, v152, 5, v154
v_lshlrev_b32 v155, 4, v152
buffer_load_dwordx4 v[216:219], v155, s[24:27], s53 offen sc1
s_add_u32 s53, s53, 32768
buffer_load_dwordx4 v[96:99], v155, s[24:27], s53 offen sc1
v_lshrrev_b32 v153, 5, v1
v_mul_u32_u24 v153, 3840, v153
v_lshl_add_u32 v153, v154, 4, v153
v_add_u32 v153, s83, v153
s_cmp_lt_u32 s3, 2
s_cbranch_scc1 L_XB2
s_barrier
s_mov_b32 m0, s70
s_mov_b32 s64, s68
s_add_u32 s68, s68, 16384
s_add_u32 s70, s70, 16384
s_and_b32 s70, s70, 131071
buffer_load_dwordx4 v4, s[24:27], s64 offen offset:0 sc1 lds
buffer_load_dwordx4 v4, s[24:27], s64 offen offset:1024 sc1 lds
buffer_load_dwordx4 v4, s[24:27], s64 offen offset:2048 sc1 lds
buffer_load_dwordx4 v4, s[24:27], s64 offen offset:3072 sc1 lds
L_XB2:
v_accvgpr_read_b32 v72, a232
v_accvgpr_read_b32 v74, a236
v_cmp_nle_f32 vcc, v72, v7
v_cmp_nle_f32 s[96:97], v74, v7
s_nop 3
s_or_b64 vcc, vcc, s[96:97]
s_cbranch_vccnz SLOW1
SLOW1_R:
v_mul_f32 v10, 0x3fb8aa3b, v10
v_mul_f32 v11, 0x3fb8aa3b, v11
v_exp_f32 v10, v10
v_exp_f32 v11, v11
s_nop 0
v_fma_f32 v72, v72, v10, v72
v_fma_f32 v74, v74, v11, v74
v_rcp_f32 v72, v72
v_rcp_f32 v74, v74
s_add_u32 s52, s79, 4096
v_mov_b32 v73, v72
v_mov_b32 v75, v74
v_pk_mul_f32 v[100:101], v[100:101], v[72:73]
v_pk_mul_f32 v[102:103], v[102:103], v[72:73]
v_pk_mul_f32 v[148:149], v[148:149], v[72:73]
v_pk_mul_f32 v[150:151], v[150:151], v[72:73]
v_cvt_pk_bf16_f32 v100, v100, v101
v_cvt_pk_bf16_f32 v101, v102, v103
v_cvt_pk_bf16_f32 v102, v148, v149
v_cvt_pk_bf16_f32 v103, v150, v151
buffer_store_dwordx4 v[100:103], v4, s[24:27], s79 offen offset:0 sc1
v_pk_mul_f32 v[116:117], v[116:117], v[74:75]
v_pk_mul_f32 v[118:119], v[118:119], v[74:75]
v_pk_mul_f32 v[132:133], v[132:133], v[74:75]
v_pk_mul_f32 v[134:135], v[134:135], v[74:75]
v_cvt_pk_bf16_f32 v116, v116, v117
v_cvt_pk_bf16_f32 v117, v118, v119
v_cvt_pk_bf16_f32 v118, v132, v133
v_cvt_pk_bf16_f32 v119, v134, v135
buffer_store_dwordx4 v[116:119], v4, s[24:27], s79 offen offset:1024 sc1
v_pk_mul_f32 v[156:157], v[156:157], v[72:73]
v_pk_mul_f32 v[158:159], v[158:159], v[72:73]
v_pk_mul_f32 v[196:197], v[196:197], v[72:73]
v_pk_mul_f32 v[198:199], v[198:199], v[72:73]
v_cvt_pk_bf16_f32 v156, v156, v157
v_cvt_pk_bf16_f32 v157, v158, v159
v_cvt_pk_bf16_f32 v158, v196, v197
v_cvt_pk_bf16_f32 v159, v198, v199
buffer_store_dwordx4 v[156:159], v4, s[24:27], s79 offen offset:2048 sc1
v_pk_mul_f32 v[164:165], v[164:165], v[74:75]
v_pk_mul_f32 v[166:167], v[166:167], v[74:75]
v_pk_mul_f32 v[188:189], v[188:189], v[74:75]
v_pk_mul_f32 v[190:191], v[190:191], v[74:75]
v_cvt_pk_bf16_f32 v164, v164, v165
v_cvt_pk_bf16_f32 v165, v166, v167
v_cvt_pk_bf16_f32 v166, v188, v189
v_cvt_pk_bf16_f32 v167, v190, v191
buffer_store_dwordx4 v[164:167], v4, s[24:27], s79 offen offset:3072 sc1
v_pk_mul_f32 v[108:109], v[108:109], v[72:73]
v_pk_mul_f32 v[110:111], v[110:111], v[72:73]
v_pk_mul_f32 v[140:141], v[140:141], v[72:73]
v_pk_mul_f32 v[142:143], v[142:143], v[72:73]
v_cvt_pk_bf16_f32 v108, v108, v109
v_cvt_pk_bf16_f32 v109, v110, v111
v_cvt_pk_bf16_f32 v110, v140, v141
v_cvt_pk_bf16_f32 v111, v142, v143
buffer_store_dwordx4 v[108:111], v4, s[24:27], s52 offen offset:0 sc1
v_pk_mul_f32 v[40:41], v[40:41], v[74:75]
v_pk_mul_f32 v[42:43], v[42:43], v[74:75]
v_pk_mul_f32 v[124:125], v[124:125], v[74:75]
v_pk_mul_f32 v[126:127], v[126:127], v[74:75]
v_cvt_pk_bf16_f32 v40, v40, v41
v_cvt_pk_bf16_f32 v41, v42, v43
v_cvt_pk_bf16_f32 v42, v124, v125
v_cvt_pk_bf16_f32 v43, v126, v127
buffer_store_dwordx4 v[40:43], v4, s[24:27], s52 offen offset:1024 sc1
v_pk_mul_f32 v[48:49], v[48:49], v[72:73]
v_pk_mul_f32 v[50:51], v[50:51], v[72:73]
v_pk_mul_f32 v[56:57], v[56:57], v[72:73]
v_pk_mul_f32 v[58:59], v[58:59], v[72:73]
v_cvt_pk_bf16_f32 v48, v48, v49
v_cvt_pk_bf16_f32 v49, v50, v51
v_cvt_pk_bf16_f32 v50, v56, v57
v_cvt_pk_bf16_f32 v51, v58, v59
buffer_store_dwordx4 v[48:51], v4, s[24:27], s52 offen offset:2048 sc1
v_pk_mul_f32 v[172:173], v[172:173], v[74:75]
v_pk_mul_f32 v[174:175], v[174:175], v[74:75]
v_pk_mul_f32 v[180:181], v[180:181], v[74:75]
v_pk_mul_f32 v[182:183], v[182:183], v[74:75]
v_cvt_pk_bf16_f32 v172, v172, v173
v_cvt_pk_bf16_f32 v173, v174, v175
v_cvt_pk_bf16_f32 v174, v180, v181
v_cvt_pk_bf16_f32 v175, v182, v183
buffer_store_dwordx4 v[172:175], v4, s[24:27], s52 offen offset:3072 sc1
s_cmp_lt_u32 s3, 3
s_cbranch_scc1 L_XB3
s_barrier
s_mov_b32 m0, s70
s_mov_b32 s64, s68
s_add_u32 s68, s68, 16384
s_add_u32 s70, s70, 16384
s_and_b32 s70, s70, 131071
buffer_load_dwordx4 v4, s[24:27], s64 offen offset:0 sc1 lds
buffer_load_dwordx4 v4, s[24:27], s64 offen offset:1024 sc1 lds
buffer_load_dwordx4 v4, s[24:27], s64 offen offset:2048 sc1 lds
buffer_load_dwordx4 v4, s[24:27], s64 offen offset:3072 sc1 lds
L_XB3:
s_cmp_lg_u32 s76, 0
s_cbranch_scc1 L_NOSE2
v_accvgpr_read_b32 v72, a224
v_accvgpr_read_b32 v74, a228
v_cmp_nle_f32 vcc, v72, v7
v_cmp_nle_f32 s[96:97], v74, v7
s_nop 3
s_or_b64 vcc, vcc, s[96:97]
s_cbranch_vccnz SLOW0
SLOW0_R:
v_mul_f32 v8, 0x3fb8aa3b, v8
v_mul_f32 v9, 0x3fb8aa3b, v9
v_exp_f32 v8, v8
v_exp_f32 v9, v9
s_nop 0
v_fma_f32 v72, v72, v8, v72
v_fma_f32 v74, v74, v9, v74
v_rcp_f32 v72, v72
v_rcp_f32 v74, v74
s_add_u32 s52, s78, 4096
v_mov_b32 v73, v72
v_mov_b32 v75, v74
v_accvgpr_read_b32 v16, a0
v_accvgpr_read_b32 v17, a1
v_accvgpr_read_b32 v18, a2
v_accvgpr_read_b32 v19, a3
v_accvgpr_read_b32 v20, a4
v_accvgpr_read_b32 v21, a5
v_accvgpr_read_b32 v22, a6
v_accvgpr_read_b32 v23, a7
v_pk_mul_f32 v[16:17], v[16:17], v[72:73]
v_pk_mul_f32 v[18:19], v[18:19], v[72:73]
v_pk_mul_f32 v[20:21], v[20:21], v[72:73]
v_pk_mul_f32 v[22:23], v[22:23], v[72:73]
v_cvt_pk_bf16_f32 v16, v16, v17
v_cvt_pk_bf16_f32 v17, v18, v19
v_cvt_pk_bf16_f32 v18, v20, v21
v_cvt_pk_bf16_f32 v19, v22, v23
buffer_store_dwordx4 v[16:19], v4, s[24:27], s78 offen offset:0 sc1
v_accvgpr_read_b32 v24, a32
v_accvgpr_read_b32 v25, a33
v_accvgpr_read_b32 v26, a34
v_accvgpr_read_b32 v27, a35
v_accvgpr_read_b32 v28, a36
v_accvgpr_read_b32 v29, a37
v_accvgpr_read_b32 v30, a38
v_accvgpr_read_b32 v31, a39
v_pk_mul_f32 v[24:25], v[24:25], v[74:75]
v_pk_mul_f32 v[26:27], v[26:27], v[74:75]
v_pk_mul_f32 v[28:29], v[28:29], v[74:75]
v_pk_mul_f32 v[30:31], v[30:31], v[74:75]
v_cvt_pk_bf16_f32 v24, v24, v25
v_cvt_pk_bf16_f32 v25, v26, v27
v_cvt_pk_bf16_f32 v26, v28, v29
v_cvt_pk_bf16_f32 v27, v30, v31
buffer_store_dwordx4 v[24:27], v4, s[24:27], s78 offen offset:1024 sc1
v_accvgpr_read_b32 v16, a8
v_accvgpr_read_b32 v17, a9
v_accvgpr_read_b32 v18, a10
v_accvgpr_read_b32 v19, a11
v_accvgpr_read_b32 v20, a12
v_accvgpr_read_b32 v21, a13
v_accvgpr_read_b32 v22, a14
v_accvgpr_read_b32 v23, a15
v_pk_mul_f32 v[16:17], v[16:17], v[72:73]
v_pk_mul_f32 v[18:19], v[18:19], v[72:73]
v_pk_mul_f32 v[20:21], v[20:21], v[72:73]
v_pk_mul_f32 v[22:23], v[22:23], v[72:73]
v_cvt_pk_bf16_f32 v16, v16, v17
v_cvt_pk_bf16_f32 v17, v18, v19
v_cvt_pk_bf16_f32 v18, v20, v21
v_cvt_pk_bf16_f32 v19, v22, v23
buffer_store_dwordx4 v[16:19], v4, s[24:27], s78 offen offset:2048 sc1
v_accvgpr_read_b32 v24, a40
v_accvgpr_read_b32 v25, a41
v_accvgpr_read_b32 v26, a42
v_accvgpr_read_b32 v27, a43
v_accvgpr_read_b32 v28, a44
v_accvgpr_read_b32 v29, a45
v_accvgpr_read_b32 v30, a46
v_accvgpr_read_b32 v31, a47
v_pk_mul_f32 v[24:25], v[24:25], v[74:75]
v_pk_mul_f32 v[26:27], v[26:27], v[74:75]
v_pk_mul_f32 v[28:29], v[28:29], v[74:75]
v_pk_mul_f32 v[30:31], v[30:31], v[74:75]
v_cvt_pk_bf16_f32 v24, v24, v25
v_cvt_pk_bf16_f32 v25, v26, v27
v_cvt_pk_bf16_f32 v26, v28, v29
v_cvt_pk_bf16_f32 v27, v30, v31
buffer_store_dwordx4 v[24:27], v4, s[24:27], s78 offen offset:3072 sc1
v_accvgpr_read_b32 v16, a16
v_accvgpr_read_b32 v17, a17
v_accvgpr_read_b32 v18, a18
v_accvgpr_read_b32 v19, a19
v_accvgpr_read_b32 v20, a20
v_accvgpr_read_b32 v21, a21
v_accvgpr_read_b32 v22, a22
v_accvgpr_read_b32 v23, a23
v_pk_mul_f32 v[16:17], v[16:17], v[72:73]
v_pk_mul_f32 v[18:19], v[18:19], v[72:73]
v_pk_mul_f32 v[20:21], v[20:21], v[72:73]
v_pk_mul_f32 v[22:23], v[22:23], v[72:73]
v_cvt_pk_bf16_f32 v16, v16, v17
v_cvt_pk_bf16_f32 v17, v18, v19
v_cvt_pk_bf16_f32 v18, v20, v21
v_cvt_pk_bf16_f32 v19, v22, v23
buffer_store_dwordx4 v[16:19], v4, s[24:27], s52 offen offset:0 sc1
v_accvgpr_read_b32 v24, a48
v_accvgpr_read_b32 v25, a49
v_accvgpr_read_b32 v26, a50
v_accvgpr_read_b32 v27, a51
v_accvgpr_read_b32 v28, a52
v_accvgpr_read_b32 v29, a53
v_accvgpr_read_b32 v30, a54
v_accvgpr_read_b32 v31, a55
v_pk_mul_f32 v[24:25], v[24:25], v[74:75]
v_pk_mul_f32 v[26:27], v[26:27], v[74:75]
v_pk_mul_f32 v[28:29], v[28:29], v[74:75]
v_pk_mul_f32 v[30:31], v[30:31], v[74:75]
v_cvt_pk_bf16_f32 v24, v24, v25
v_cvt_pk_bf16_f32 v25, v26, v27
v_cvt_pk_bf16_f32 v26, v28, v29
v_cvt_pk_bf16_f32 v27, v30, v31
buffer_store_dwordx4 v[24:27], v4, s[24:27], s52 offen offset:1024 sc1
v_accvgpr_read_b32 v16, a24
v_accvgpr_read_b32 v17, a25
v_accvgpr_read_b32 v18, a26
v_accvgpr_read_b32 v19, a27
v_accvgpr_read_b32 v20, a28
v_accvgpr_read_b32 v21, a29
v_accvgpr_read_b32 v22, a30
v_accvgpr_read_b32 v23, a31
v_pk_mul_f32 v[16:17], v[16:17], v[72:73]
v_pk_mul_f32 v[18:19], v[18:19], v[72:73]
v_pk_mul_f32 v[20:21], v[20:21], v[72:73]
v_pk_mul_f32 v[22:23], v[22:23], v[72:73]
v_cvt_pk_bf16_f32 v16, v16, v17
v_cvt_pk_bf16_f32 v17, v18, v19
v_cvt_pk_bf16_f32 v18, v20, v21
v_cvt_pk_bf16_f32 v19, v22, v23
buffer_store_dwordx4 v[16:19], v4, s[24:27], s52 offen offset:2048 sc1
v_accvgpr_read_b32 v24, a56
v_accvgpr_read_b32 v25, a57
v_accvgpr_read_b32 v26, a58
v_accvgpr_read_b32 v27, a59
v_accvgpr_read_b32 v28, a60
v_accvgpr_read_b32 v29, a61
v_accvgpr_read_b32 v30, a62
v_accvgpr_read_b32 v31, a63
v_pk_mul_f32 v[24:25], v[24:25], v[74:75]
v_pk_mul_f32 v[26:27], v[26:27], v[74:75]
v_pk_mul_f32 v[28:29], v[28:29], v[74:75]
v_pk_mul_f32 v[30:31], v[30:31], v[74:75]
v_cvt_pk_bf16_f32 v24, v24, v25
v_cvt_pk_bf16_f32 v25, v26, v27
v_cvt_pk_bf16_f32 v26, v28, v29
v_cvt_pk_bf16_f32 v27, v30, v31
buffer_store_dwordx4 v[24:27], v4, s[24:27], s52 offen offset:3072 sc1
L_NOSE2:
v_mov_b32 v5, v152
v_mov_b32 v6, v153
s_lshl_b32 s74, s66, 10
s_lshr_b32 s52, s4, 3
s_lshl_b32 s52, s52, 7
s_add_u32 s74, s74, s52
s_add_u32 s74, s74, 75497472
s_waitcnt vmcnt(8)
v_mov_b32 v16, v216
v_mov_b32 v17, v217
v_mov_b32 v18, v218
v_mov_b32 v19, v219
v_mov_b32 v20, v96
v_mov_b32 v21, v97
v_mov_b32 v22, v98
v_mov_b32 v23, v99
s_barrier
ds_read_b128 v[96:99], v6 offset:3328
ds_read_b128 v[32:35], v6 offset:256
ds_read_b128 v[36:39], v6 offset:1024
ds_read_b128 v[100:103], v6 offset:3296
ds_read_b128 v[40:43], v6 offset:224
ds_read_b128 v[44:47], v6 offset:992
ds_read_b128 v[104:107], v6 offset:3264
ds_read_b128 v[48:51], v6 offset:192
ds_read_b128 v[52:55], v6 offset:960
ds_read_b128 v[108:111], v6 offset:3232
ds_read_b128 v[56:59], v6 offset:160
ds_read_b128 v[60:63], v6 offset:928
ds_read_b128 v[112:115], v6 offset:3200
ds_read_b128 v[64:67], v6 offset:128
ds_read_b128 v[68:71], v6 offset:896
ds_read_b128 v[116:119], v6 offset:3168
ds_read_b128 v[72:75], v6 offset:96
ds_read_b128 v[76:79], v6 offset:864
ds_read_b128 v[120:123], v6 offset:3136
ds_read_b128 v[80:83], v6 offset:64
ds_read_b128 v[84:87], v6 offset:832
ds_read_b128 v[124:127], v6 offset:3104
ds_read_b128 v[88:91], v6 offset:32
ds_read_b128 v[92:95], v6 offset:800
s_waitcnt lgkmcnt(0)
ds_read_b128 v[128:131], v6 offset:1792
ds_read_b128 v[132:135], v6 offset:2560
ds_read_b128 v[136:139], v6 offset:1760
ds_read_b128 v[140:143], v6 offset:2528
ds_read_b128 v[144:147], v6 offset:1728
ds_read_b128 v[148:151], v6 offset:2496
ds_read_b128 v[152:155], v6 offset:1696
ds_read_b128 v[156:159], v6 offset:2464
ds_read_b128 v[160:163], v6 offset:1664
ds_read_b128 v[164:167], v6 offset:2432
ds_read_b128 v[168:171], v6 offset:1632
ds_read_b128 v[172:175], v6 offset:2400
ds_read_b128 v[176:179], v6 offset:1600
ds_read_b128 v[180:183], v6 offset:2368
ds_read_b128 v[184:187], v6 offset:1568
ds_read_b128 v[188:191], v6 offset:2336
v_and_b32 v9, 0xffff, v97
v_and_b32 v11, 0xffff0000, v97
v_dot2_f32_bf16 v24, v98, v99, 0
v_dot2_f32_bf16 v25, v102, v99, 0
v_dot2_f32_bf16 v26, v106, v99, 0
v_dot2_f32_bf16 v27, v110, v99, 0
v_dot2_f32_bf16 v28, v114, v99, 0
v_dot2_f32_bf16 v29, v118, v99, 0
v_dot2_f32_bf16 v30, v122, v99, 0
v_dot2_f32_bf16 v31, v126, v99, 0
v_dot2_f32_bf16 v24, v96, v9, v24
v_dot2_f32_bf16 v25, v100, v9, v25
v_dot2_f32_bf16 v26, v104, v9, v26
v_dot2_f32_bf16 v27, v108, v9, v27
v_dot2_f32_bf16 v28, v112, v9, v28
v_dot2_f32_bf16 v29, v116, v9, v29
v_dot2_f32_bf16 v30, v120, v9, v30
v_dot2_f32_bf16 v31, v124, v9, v31
v_dot2_f32_bf16 v24, v16, v32, v24
v_dot2_f32_bf16 v25, v16, v40, v25
v_dot2_f32_bf16 v26, v16, v48, v26
v_dot2_f32_bf16 v27, v16, v56, v27
v_dot2_f32_bf16 v28, v16, v64, v28
v_dot2_f32_bf16 v29, v16, v72, v29
v_dot2_f32_bf16 v30, v16, v80, v30
v_dot2_f32_bf16 v31, v16, v88, v31
v_dot2_f32_bf16 v24, v17, v33, v24
v_dot2_f32_bf16 v25, v17, v41, v25
v_dot2_f32_bf16 v26, v17, v49, v26
v_dot2_f32_bf16 v27, v17, v57, v27
v_dot2_f32_bf16 v28, v17, v65, v28
v_dot2_f32_bf16 v29, v17, v73, v29
v_dot2_f32_bf16 v30, v17, v81, v30
v_dot2_f32_bf16 v31, v17, v89, v31
v_dot2_f32_bf16 v24, v18, v34, v24
v_dot2_f32_bf16 v25, v18, v42, v25
v_dot2_f32_bf16 v26, v18, v50, v26
v_dot2_f32_bf16 v27, v18, v58, v27
v_dot2_f32_bf16 v28, v18, v66, v28
v_dot2_f32_bf16 v29, v18, v74, v29
v_dot2_f32_bf16 v30, v18, v82, v30
v_dot2_f32_bf16 v31, v18, v90, v31
v_dot2_f32_bf16 v24, v19, v35, v24
v_dot2_f32_bf16 v25, v19, v43, v25
v_dot2_f32_bf16 v26, v19, v51, v26
v_dot2_f32_bf16 v27, v19, v59, v27
v_dot2_f32_bf16 v28, v19, v67, v28
v_dot2_f32_bf16 v29, v19, v75, v29
v_dot2_f32_bf16 v30, v19, v83, v30
v_dot2_f32_bf16 v31, v19, v91, v31
v_dot2_f32_bf16 v24, v20, v36, v24
v_dot2_f32_bf16 v25, v20, v44, v25
v_dot2_f32_bf16 v26, v20, v52, v26
v_dot2_f32_bf16 v27, v20, v60, v27
v_dot2_f32_bf16 v28, v20, v68, v28
v_dot2_f32_bf16 v29, v20, v76, v29
v_dot2_f32_bf16 v30, v20, v84, v30
v_dot2_f32_bf16 v31, v20, v92, v31
v_dot2_f32_bf16 v24, v21, v37, v24
v_dot2_f32_bf16 v25, v21, v45, v25
v_dot2_f32_bf16 v26, v21, v53, v26
v_dot2_f32_bf16 v27, v21, v61, v27
v_dot2_f32_bf16 v28, v21, v69, v28
v_dot2_f32_bf16 v29, v21, v77, v29
v_dot2_f32_bf16 v30, v21, v85, v30
v_dot2_f32_bf16 v31, v21, v93, v31
v_dot2_f32_bf16 v24, v22, v38, v24
v_dot2_f32_bf16 v25, v22, v46, v25
v_dot2_f32_bf16 v26, v22, v54, v26
v_dot2_f32_bf16 v27, v22, v62, v27
v_dot2_f32_bf16 v28, v22, v70, v28
v_dot2_f32_bf16 v29, v22, v78, v29
v_dot2_f32_bf16 v30, v22, v86, v30
v_dot2_f32_bf16 v31, v22, v94, v31
v_dot2_f32_bf16 v24, v23, v39, v24
v_dot2_f32_bf16 v25, v23, v47, v25
v_dot2_f32_bf16 v26, v23, v55, v26
v_dot2_f32_bf16 v27, v23, v63, v27
v_dot2_f32_bf16 v28, v23, v71, v28
v_dot2_f32_bf16 v29, v23, v79, v29
v_dot2_f32_bf16 v30, v23, v87, v30
v_dot2_f32_bf16 v31, v23, v95, v31
s_waitcnt vmcnt(0)
buffer_atomic_add v1, v0, s[24:27], s74 offen offset:0 sc1
s_mov_b32 m0, s70
s_mov_b32 s64, s68
s_add_u32 s68, s68, 16384
s_add_u32 s70, s70, 16384
s_and_b32 s70, s70, 131071
buffer_load_dwordx4 v4, s[24:27], s64 offen offset:0 sc1 lds
v_mov_b32 v9, 0xf149f2ca
v_mul_f32 v11, 0xbfb8aa3b, v11
v_exp_f32 v11, v11
v_cmp_gt_u32 vcc, 2, v5
v_cmp_gt_u32 s[56:57], 4, v5
s_nop 0
v_cndmask_b32 v25, v25, v9, vcc
v_cndmask_b32 v26, v26, v9, s[56:57]
v_cmp_gt_u32 vcc, 6, v5
v_cmp_gt_u32 s[56:57], 8, v5
s_nop 0
v_cndmask_b32 v27, v27, v9, vcc
buffer_load_dwordx4 v4, s[24:27], s64 offen offset:1024 sc1 lds
v_cndmask_b32 v28, v28, v9, s[56:57]
v_cmp_gt_u32 vcc, 10, v5
v_cmp_gt_u32 s[56:57], 12, v5
s_nop 0
v_cndmask_b32 v29, v29, v9, vcc
v_cndmask_b32 v30, v30, v9, s[56:57]
v_cmp_gt_u32 vcc, 14, v5
s_nop 0
s_nop 0
v_cndmask_b32 v31, v31, v9, vcc
v_max3_f32 v10, v24, v25, v26
v_max3_f32 v10, v10, v27, v28
buffer_load_dwordx4 v4, s[24:27], s64 offen offset:2048 sc1 lds
v_max3_f32 v10, v10, v29, v30
v_max_f32 v10, v10, v31
v_sub_f32 v24, v24, v10
v_sub_f32 v25, v25, v10
v_sub_f32 v26, v26, v10
v_sub_f32 v27, v27, v10
v_sub_f32 v28, v28, v10
v_sub_f32 v29, v29, v10
v_sub_f32 v30, v30, v10
v_sub_f32 v31, v31, v10
v_mul_f32 v24, 0x3eae1a93, v24
v_mul_f32 v25, 0x3eae1a93, v25
buffer_load_dwordx4 v4, s[24:27], s64 offen offset:3072 sc1 lds
v_mul_f32 v26, 0x3eae1a93, v26
v_mul_f32 v27, 0x3eae1a93, v27
v_mul_f32 v28, 0x3eae1a93, v28
v_mul_f32 v29, 0x3eae1a93, v29
v_mul_f32 v30, 0x3eae1a93, v30
v_mul_f32 v31, 0x3eae1a93, v31
v_exp_f32 v24, v24
v_exp_f32 v25, v25
v_exp_f32 v26, v26
v_exp_f32 v27, v27
v_exp_f32 v28, v28
v_exp_f32 v29, v29
s_mov_b32 m0, s70
s_mov_b32 s64, s68
s_add_u32 s68, s68, 16384
s_add_u32 s70, s70, 16384
s_and_b32 s70, s70, 131071
buffer_load_dwordx4 v4, s[24:27], s64 offen offset:0 sc1 lds
v_exp_f32 v30, v30
v_exp_f32 v31, v31
v_cvt_pk_bf16_f32 v32, v24, 0
v_cvt_pk_bf16_f32 v40, v25, 0
v_cvt_pk_bf16_f32 v48, v26, 0
v_cvt_pk_bf16_f32 v56, v27, 0
v_cvt_pk_bf16_f32 v64, v28, 0
v_cvt_pk_bf16_f32 v72, v29, 0
v_cvt_pk_bf16_f32 v80, v30, 0
v_cvt_pk_bf16_f32 v88, v31, 0
v_lshlrev_b32 v33, 16, v32
v_lshlrev_b32 v41, 16, v40
buffer_load_dwordx4 v4, s[24:27], s64 offen offset:1024 sc1 lds
v_lshlrev_b32 v49, 16, v48
v_lshlrev_b32 v57, 16, v56
v_lshlrev_b32 v65, 16, v64
v_lshlrev_b32 v73, 16, v72
v_lshlrev_b32 v81, 16, v80
v_lshlrev_b32 v89, 16, v88
v_add_f32 v10, v33, v41
v_add_f32 v10, v10, v49
v_add_f32 v10, v10, v57
v_add_f32 v10, v10, v65
v_add_f32 v10, v10, v73
v_add_f32 v10, v10, v81
buffer_load_dwordx4 v4, s[24:27], s64 offen offset:2048 sc1 lds
v_add_f32 v10, v10, v89
v_fma_f32 v10, v10, v11, v10
v_rcp_f32 v10, v10
s_waitcnt lgkmcnt(0)
v_dot2_f32_bf16 v192, v128, v32, 0
v_dot2_f32_bf16 v193, v128, v33, 0
v_dot2_f32_bf16 v194, v129, v32, 0
v_dot2_f32_bf16 v195, v129, v33, 0
v_dot2_f32_bf16 v196, v130, v32, 0
v_dot2_f32_bf16 v197, v130, v33, 0
v_dot2_f32_bf16 v198, v131, v32, 0
v_dot2_f32_bf16 v199, v131, v33, 0
buffer_load_dwordx4 v4, s[24:27], s64 offen offset:3072 sc1 lds
v_dot2_f32_bf16 v200, v132, v32, 0
v_dot2_f32_bf16 v201, v132, v33, 0
v_dot2_f32_bf16 v202, v133, v32, 0
v_dot2_f32_bf16 v203, v133, v33, 0
v_dot2_f32_bf16 v204, v134, v32, 0
v_dot2_f32_bf16 v205, v134, v33, 0
v_dot2_f32_bf16 v206, v135, v32, 0
v_dot2_f32_bf16 v207, v135, v33, 0
v_dot2_f32_bf16 v208, v96, v33, 0
v_dot2_f32_bf16 v209, v98, v33, 0
v_dot2_f32_bf16 v192, v136, v40, v192
v_dot2_f32_bf16 v193, v136, v41, v193
v_dot2_f32_bf16 v194, v137, v40, v194
v_dot2_f32_bf16 v195, v137, v41, v195
v_dot2_f32_bf16 v196, v138, v40, v196
v_dot2_f32_bf16 v197, v138, v41, v197
v_dot2_f32_bf16 v198, v139, v40, v198
v_dot2_f32_bf16 v199, v139, v41, v199
v_dot2_f32_bf16 v200, v140, v40, v200
v_dot2_f32_bf16 v201, v140, v41, v201
v_dot2_f32_bf16 v202, v141, v40, v202
v_dot2_f32_bf16 v203, v141, v41, v203
v_dot2_f32_bf16 v204, v142, v40, v204
v_dot2_f32_bf16 v205, v142, v41, v205
v_dot2_f32_bf16 v206, v143, v40, v206
v_dot2_f32_bf16 v207, v143, v41, v207
v_dot2_f32_bf16 v208, v100, v41, v208
v_dot2_f32_bf16 v209, v102, v41, v209
v_dot2_f32_bf16 v192, v144, v48, v192
v_dot2_f32_bf16 v193, v144, v49, v193
v_dot2_f32_bf16 v194, v145, v48, v194
v_dot2_f32_bf16 v195, v145, v49, v195
v_dot2_f32_bf16 v196, v146, v48, v196
v_dot2_f32_bf16 v197, v146, v49, v197
v_dot2_f32_bf16 v198, v147, v48, v198
v_dot2_f32_bf16 v199, v147, v49, v199
v_dot2_f32_bf16 v200, v148, v48, v200
v_dot2_f32_bf16 v201, v148, v49, v201
v_dot2_f32_bf16 v202, v149, v48, v202
v_dot2_f32_bf16 v203, v149, v49, v203
v_dot2_f32_bf16 v204, v150, v48, v204
v_dot2_f32_bf16 v205, v150, v49, v205
v_dot2_f32_bf16 v206, v151, v48, v206
v_dot2_f32_bf16 v207, v151, v49, v207
v_dot2_f32_bf16 v208, v104, v49, v208
v_dot2_f32_bf16 v209, v106, v49, v209
v_dot2_f32_bf16 v192, v152, v56, v192
v_dot2_f32_bf16 v193, v152, v57, v193
v_dot2_f32_bf16 v194, v153, v56, v194
v_dot2_f32_bf16 v195, v153, v57, v195
v_dot2_f32_bf16 v196, v154, v56, v196
v_dot2_f32_bf16 v197, v154, v57, v197
v_dot2_f32_bf16 v198, v155, v56, v198
v_dot2_f32_bf16 v199, v155, v57, v199
v_dot2_f32_bf16 v200, v156, v56, v200
v_dot2_f32_bf16 v201, v156, v57, v201
v_dot2_f32_bf16 v202, v157, v56, v202
v_dot2_f32_bf16 v203, v157, v57, v203
v_dot2_f32_bf16 v204, v158, v56, v204
v_dot2_f32_bf16 v205, v158, v57, v205
v_dot2_f32_bf16 v206, v159, v56, v206
v_dot2_f32_bf16 v207, v159, v57, v207
v_dot2_f32_bf16 v208, v108, v57, v208
v_dot2_f32_bf16 v209, v110, v57, v209
v_dot2_f32_bf16 v192, v160, v64, v192
v_dot2_f32_bf16 v193, v160, v65, v193
v_dot2_f32_bf16 v194, v161, v64, v194
v_dot2_f32_bf16 v195, v161, v65, v195
v_dot2_f32_bf16 v196, v162, v64, v196
v_dot2_f32_bf16 v197, v162, v65, v197
v_dot2_f32_bf16 v198, v163, v64, v198
v_dot2_f32_bf16 v199, v163, v65, v199
v_dot2_f32_bf16 v200, v164, v64, v200
v_dot2_f32_bf16 v201, v164, v65, v201
v_dot2_f32_bf16 v202, v165, v64, v202
v_dot2_f32_bf16 v203, v165, v65, v203
v_dot2_f32_bf16 v204, v166, v64, v204
v_dot2_f32_bf16 v205, v166, v65, v205
v_dot2_f32_bf16 v206, v167, v64, v206
v_dot2_f32_bf16 v207, v167, v65, v207
v_dot2_f32_bf16 v208, v112, v65, v208
v_dot2_f32_bf16 v209, v114, v65, v209
v_dot2_f32_bf16 v192, v168, v72, v192
v_dot2_f32_bf16 v193, v168, v73, v193
v_dot2_f32_bf16 v194, v169, v72, v194
v_dot2_f32_bf16 v195, v169, v73, v195
v_dot2_f32_bf16 v196, v170, v72, v196
v_dot2_f32_bf16 v197, v170, v73, v197
v_dot2_f32_bf16 v198, v171, v72, v198
v_dot2_f32_bf16 v199, v171, v73, v199
v_dot2_f32_bf16 v200, v172, v72, v200
v_dot2_f32_bf16 v201, v172, v73, v201
v_dot2_f32_bf16 v202, v173, v72, v202
v_dot2_f32_bf16 v203, v173, v73, v203
v_dot2_f32_bf16 v204, v174, v72, v204
v_dot2_f32_bf16 v205, v174, v73, v205
v_dot2_f32_bf16 v206, v175, v72, v206
v_dot2_f32_bf16 v207, v175, v73, v207
v_dot2_f32_bf16 v208, v116, v73, v208
v_dot2_f32_bf16 v209, v118, v73, v209
v_dot2_f32_bf16 v192, v176, v80, v192
v_dot2_f32_bf16 v193, v176, v81, v193
v_dot2_f32_bf16 v194, v177, v80, v194
v_dot2_f32_bf16 v195, v177, v81, v195
v_dot2_f32_bf16 v196, v178, v80, v196
v_dot2_f32_bf16 v197, v178, v81, v197
v_dot2_f32_bf16 v198, v179, v80, v198
v_dot2_f32_bf16 v199, v179, v81, v199
v_dot2_f32_bf16 v200, v180, v80, v200
v_dot2_f32_bf16 v201, v180, v81, v201
v_dot2_f32_bf16 v202, v181, v80, v202
v_dot2_f32_bf16 v203, v181, v81, v203
v_dot2_f32_bf16 v204, v182, v80, v204
v_dot2_f32_bf16 v205, v182, v81, v205
v_dot2_f32_bf16 v206, v183, v80, v206
v_dot2_f32_bf16 v207, v183, v81, v207
v_dot2_f32_bf16 v208, v120, v81, v208
v_dot2_f32_bf16 v209, v122, v81, v209
v_dot2_f32_bf16 v192, v184, v88, v192
v_dot2_f32_bf16 v193, v184, v89, v193
v_dot2_f32_bf16 v194, v185, v88, v194
v_dot2_f32_bf16 v195, v185, v89, v195
v_dot2_f32_bf16 v196, v186, v88, v196
v_dot2_f32_bf16 v197, v186, v89, v197
v_dot2_f32_bf16 v198, v187, v88, v198
v_dot2_f32_bf16 v199, v187, v89, v199
v_dot2_f32_bf16 v200, v188, v88, v200
v_dot2_f32_bf16 v201, v188, v89, v201
v_dot2_f32_bf16 v202, v189, v88, v202
v_dot2_f32_bf16 v203, v189, v89, v203
v_dot2_f32_bf16 v204, v190, v88, v204
v_dot2_f32_bf16 v205, v190, v89, v205
v_dot2_f32_bf16 v206, v191, v88, v206
v_dot2_f32_bf16 v207, v191, v89, v207
v_dot2_f32_bf16 v208, v124, v89, v208
v_dot2_f32_bf16 v209, v126, v89, v209
v_lshrrev_b32 v9, 5, v5
v_mul_u32_u24 v9, 303104, v9
v_and_b32 v11, 1, v3
v_lshl_add_u32 v9, v11, 10, v9
v_lshl_add_u32 v9, v2, 4, v9
v_mul_f32 v192, v10, v192
v_mul_f32 v193, v10, v193
v_mul_f32 v194, v10, v194
v_mul_f32 v195, v10, v195
v_mul_f32 v196, v10, v196
v_mul_f32 v197, v10, v197
v_mul_f32 v198, v10, v198
v_mul_f32 v199, v10, v199
v_mul_f32 v200, v10, v200
v_mul_f32 v201, v10, v201
v_mul_f32 v202, v10, v202
v_mul_f32 v203, v10, v203
v_mul_f32 v204, v10, v204
v_mul_f32 v205, v10, v205
v_mul_f32 v206, v10, v206
v_mul_f32 v207, v10, v207
v_mul_f32 v208, v10, v208
v_mul_f32 v209, v10, v209
v_cvt_pk_bf16_f32 v192, v192, v193
v_cvt_pk_bf16_f32 v193, v194, v195
v_cvt_pk_bf16_f32 v194, v196, v197
v_cvt_pk_bf16_f32 v195, v198, v199
v_cvt_pk_bf16_f32 v196, v200, v201
v_cvt_pk_bf16_f32 v197, v202, v203
v_cvt_pk_bf16_f32 v198, v204, v205
v_cvt_pk_bf16_f32 v199, v206, v207
v_cvt_pk_bf16_f32 v200, v208, v209
s_lshr_b32 s53, s4, 3
s_mul_i32 s53, s53, 75776
s_add_u32 s53, s53, 54591488
s_bfe_u32 s54, s4, 131073
s_lshl_b32 s54, s54, 11
s_add_u32 s54, s54, s53
s_and_b32 s55, s4, 1
s_lshl_b32 s55, s55, 9
s_add_u32 s54, s54, s55
buffer_store_dwordx4 v[192:195], v9, s[24:27], s54 offen sc1
buffer_store_dwordx4 v[196:199], v9, s[24:27], s54 offen offset:256 sc1
s_bfe_u32 s55, s4, 65538
s_lshl_b32 s55, s55, 8
s_add_u32 s54, s53, s55
s_and_b32 s55, s4, 3
s_lshl2_add_u32 s54, s55, s54
s_add_u32 s54, s54, 8192
buffer_store_dword v200, v9, s[24:27], s54 offen sc1
s_lshr_b32 s52, s3, 1
s_lshl1_add_u32 s52, s85, s52
s_lshl3_add_u32 s75, s52, s84
s_lshl_b32 s75, s75, 7
s_add_u32 s75, s75, 75497472
v_mov_b32 v10, 0
buffer_load_dword v12, v10, s[24:27], s75 offen sc1
s_sub_u32 s53, 63, s52
s_bitcmp1_b32 s3, 0
s_cselect_b32 s72, s53, s52
s_mul_i32 s76, s72, 303104
s_mul_i32 s53, s84, 75776
s_add_u32 s76, s76, s53
s_add_u32 s76, s76, 54525952
s_lshl2_add_u32 s52, s85, s86
s_lshl2_add_u32 s69, s52, s3
s_mul_i32 s69, s69, 28672
s_add_u32 s69, s69, 76546048
s_lshr_b32 s73, s52, 1
s_lshl_b32 s73, s73, 10
s_and_b32 s52, s52, 1
s_lshl_b32 s52, s52, 7
s_add_u32 s73, s73, s52
s_lshl2_add_u32 s73, s3, s73
s_add_u32 s73, s73, 75498112
s_and_b32 s52, s5, 1
s_lshl_b32 s52, s52, 16
v_add_u32 v7, s52, v4
v_xor_b32 v8, 0x10000, v7
v_cmp_gt_u32 vcc, 32, v1
v_mov_b32 v11, 2147418112
s_nop 0
v_cndmask_b32 v11, v11, v4, vcc
s_waitcnt vmcnt(0)
buffer_atomic_add v1, v0, s[24:27], s74 offen offset:4 sc1
v_cmp_gt_u32 vcc, 8, v12
s_nop 4
s_cbranch_vccnz CK_ZB
CK_ZB_R:
s_add_u32 s65, s76, 0
buffer_load_dwordx4 a[0:3], v4, s[24:27], s65 offen offset:0 sc1
buffer_load_dwordx4 a[4:7], v4, s[24:27], s65 offen offset:1024 sc1
buffer_load_dwordx4 a[8:11], v4, s[24:27], s65 offen offset:2048 sc1
buffer_load_dwordx4 a[12:15], v4, s[24:27], s65 offen offset:3072 sc1
s_add_u32 s65, s76, 4096
buffer_load_dwordx4 a[16:19], v4, s[24:27], s65 offen offset:0 sc1
buffer_load_dwordx4 a[20:23], v4, s[24:27], s65 offen offset:1024 sc1
buffer_load_dwordx4 a[24:27], v4, s[24:27], s65 offen offset:2048 sc1
buffer_load_dwordx4 a[28:31], v4, s[24:27], s65 offen offset:3072 sc1
s_add_u32 s65, s76, 8192
buffer_load_dwordx4 a[32:35], v4, s[24:27], s65 offen offset:0 sc1
buffer_load_dwordx4 a[36:39], v4, s[24:27], s65 offen offset:1024 sc1
s_barrier
ds_read_b128 v[144:147], v7 offset:49152
ds_read_b128 v[148:151], v7 offset:50176
ds_read_b128 v[152:155], v7 offset:51200
ds_read_b128 v[156:159], v7 offset:52224
ds_read_b128 v[160:163], v7 offset:53248
ds_read_b128 v[164:167], v7 offset:54272
s_waitcnt vmcnt(8) lgkmcnt(4)
v_mfma_f32_16x16x32_bf16 v[72:75], v[144:147], a[0:3], 0
ds_read_b128 v[168:171], v7 offset:55296
ds_read_b128 v[172:175], v7 offset:56320
v_mfma_f32_16x16x32_bf16 v[76:79], v[144:147], a[4:7], 0
buffer_load_dwordx4 a[40:43], v4, s[24:27], s65 offen offset:2048 sc1
v_mfma_f32_16x16x32_bf16 v[80:83], v[148:151], a[0:3], 0
ds_read_b128 v[144:147], v7 offset:57344
v_mfma_f32_16x16x32_bf16 v[84:87], v[148:151], a[4:7], 0
s_waitcnt lgkmcnt(5)
v_mfma_f32_16x16x32_bf16 v[88:91], v[152:155], a[0:3], 0
ds_read_b128 v[148:151], v7 offset:58368
v_mfma_f32_16x16x32_bf16 v[92:95], v[152:155], a[4:7], 0
buffer_load_dwordx4 a[44:47], v4, s[24:27], s65 offen offset:3072 sc1
v_mfma_f32_16x16x32_bf16 v[96:99], v[156:159], a[0:3], 0
ds_read_b128 v[152:155], v7 offset:59392
v_mfma_f32_16x16x32_bf16 v[100:103], v[156:159], a[4:7], 0
s_waitcnt lgkmcnt(5)
v_mfma_f32_16x16x32_bf16 v[104:107], v[160:163], a[0:3], 0
ds_read_b128 v[156:159], v7 offset:60416
v_mfma_f32_16x16x32_bf16 v[108:111], v[160:163], a[4:7], 0
s_add_u32 s65, s76, 12288
s_waitcnt vmcnt(8)
v_mfma_f32_16x16x32_bf16 v[72:75], v[164:167], a[8:11], v[72:75]
buffer_load_dwordx4 a[48:51], v4, s[24:27], s65 offen offset:0 sc1
v_mfma_f32_16x16x32_bf16 v[76:79], v[164:167], a[12:15], v[76:79]
s_waitcnt lgkmcnt(4)
ds_read_b128 v[160:163], v7 offset:61440
v_mfma_f32_16x16x32_bf16 v[80:83], v[168:171], a[8:11], v[80:83]
ds_read_b128 v[164:167], v7 offset:62464
v_mfma_f32_16x16x32_bf16 v[84:87], v[168:171], a[12:15], v[84:87]
v_mfma_f32_16x16x32_bf16 v[88:91], v[172:175], a[8:11], v[88:91]
s_waitcnt lgkmcnt(4)
ds_read_b128 v[168:171], v7 offset:63488
v_mfma_f32_16x16x32_bf16 v[92:95], v[172:175], a[12:15], v[92:95]
buffer_load_dwordx4 a[52:55], v4, s[24:27], s65 offen offset:1024 sc1
v_mfma_f32_16x16x32_bf16 v[96:99], v[144:147], a[8:11], v[96:99]
ds_read_b128 v[172:175], v7 offset:64512
v_mfma_f32_16x16x32_bf16 v[100:103], v[144:147], a[12:15], v[100:103]
v_mfma_f32_16x16x32_bf16 v[104:107], v[148:151], a[8:11], v[104:107]
ds_read_b128 v[144:147], v8 offset:0
v_mfma_f32_16x16x32_bf16 v[108:111], v[148:151], a[12:15], v[108:111]
s_waitcnt lgkmcnt(5)
s_waitcnt vmcnt(8)
v_mfma_f32_16x16x32_bf16 v[72:75], v[152:155], a[16:19], v[72:75]
buffer_load_dwordx4 a[56:59], v4, s[24:27], s65 offen offset:2048 sc1
v_mfma_f32_16x16x32_bf16 v[76:79], v[152:155], a[20:23], v[76:79]
ds_read_b128 v[148:151], v8 offset:1024
v_mfma_f32_16x16x32_bf16 v[80:83], v[156:159], a[16:19], v[80:83]
ds_read_b128 v[152:155], v8 offset:2048
v_mfma_f32_16x16x32_bf16 v[84:87], v[156:159], a[20:23], v[84:87]
s_waitcnt lgkmcnt(5)
v_mfma_f32_16x16x32_bf16 v[88:91], v[160:163], a[16:19], v[88:91]
ds_read_b128 v[156:159], v8 offset:3072
v_mfma_f32_16x16x32_bf16 v[92:95], v[160:163], a[20:23], v[92:95]
buffer_load_dwordx4 a[60:63], v4, s[24:27], s65 offen offset:3072 sc1
v_mfma_f32_16x16x32_bf16 v[96:99], v[164:167], a[16:19], v[96:99]
ds_read_b128 v[160:163], v8 offset:4096
v_mfma_f32_16x16x32_bf16 v[100:103], v[164:167], a[20:23], v[100:103]
s_waitcnt lgkmcnt(5)
v_mfma_f32_16x16x32_bf16 v[104:107], v[168:171], a[16:19], v[104:107]
ds_read_b128 v[164:167], v8 offset:5120
v_mfma_f32_16x16x32_bf16 v[108:111], v[168:171], a[20:23], v[108:111]
s_add_u32 s65, s76, 16384
s_waitcnt vmcnt(8)
v_mfma_f32_16x16x32_bf16 v[72:75], v[172:175], a[24:27], v[72:75]
buffer_load_dwordx4 a[64:67], v4, s[24:27], s65 offen offset:0 sc1
v_mfma_f32_16x16x32_bf16 v[76:79], v[172:175], a[28:31], v[76:79]
s_waitcnt lgkmcnt(4)
ds_read_b128 v[168:171], v8 offset:6144
v_mfma_f32_16x16x32_bf16 v[80:83], v[144:147], a[24:27], v[80:83]
ds_read_b128 v[172:175], v8 offset:7168
v_mfma_f32_16x16x32_bf16 v[84:87], v[144:147], a[28:31], v[84:87]
v_mfma_f32_16x16x32_bf16 v[88:91], v[148:151], a[24:27], v[88:91]
s_waitcnt lgkmcnt(4)
ds_read_b128 v[144:147], v8 offset:8192
v_mfma_f32_16x16x32_bf16 v[92:95], v[148:151], a[28:31], v[92:95]
buffer_load_dwordx4 a[68:71], v4, s[24:27], s65 offen offset:1024 sc1
v_mfma_f32_16x16x32_bf16 v[96:99], v[152:155], a[24:27], v[96:99]
ds_read_b128 v[148:151], v8 offset:9216
v_mfma_f32_16x16x32_bf16 v[100:103], v[152:155], a[28:31], v[100:103]
v_mfma_f32_16x16x32_bf16 v[104:107], v[156:159], a[24:27], v[104:107]
ds_read_b128 v[152:155], v8 offset:10240
v_mfma_f32_16x16x32_bf16 v[108:111], v[156:159], a[28:31], v[108:111]
s_waitcnt lgkmcnt(5)
s_waitcnt vmcnt(8)
v_mfma_f32_16x16x32_bf16 v[72:75], v[160:163], a[32:35], v[72:75]
buffer_load_dwordx4 a[72:75], v4, s[24:27], s65 offen offset:2048 sc1
v_mfma_f32_16x16x32_bf16 v[76:79], v[160:163], a[36:39], v[76:79]
ds_read_b128 v[156:159], v8 offset:11264
v_mfma_f32_16x16x32_bf16 v[80:83], v[164:167], a[32:35], v[80:83]
ds_read_b128 v[160:163], v8 offset:12288
v_mfma_f32_16x16x32_bf16 v[84:87], v[164:167], a[36:39], v[84:87]
s_waitcnt lgkmcnt(5)
v_mfma_f32_16x16x32_bf16 v[88:91], v[168:171], a[32:35], v[88:91]
ds_read_b128 v[164:167], v8 offset:13312
v_mfma_f32_16x16x32_bf16 v[92:95], v[168:171], a[36:39], v[92:95]
buffer_load_dwordx4 a[76:79], v4, s[24:27], s65 offen offset:3072 sc1
v_mfma_f32_16x16x32_bf16 v[96:99], v[172:175], a[32:35], v[96:99]
ds_read_b128 v[168:171], v8 offset:14336
v_mfma_f32_16x16x32_bf16 v[100:103], v[172:175], a[36:39], v[100:103]
s_waitcnt lgkmcnt(5)
v_mfma_f32_16x16x32_bf16 v[104:107], v[144:147], a[32:35], v[104:107]
s_waitcnt lgkmcnt(1)
s_waitcnt vmcnt(8)
ds_read_b128 v[172:175], v8 offset:15360
v_mfma_f32_16x16x32_bf16 v[108:111], v[144:147], a[36:39], v[108:111]
s_barrier
v_mfma_f32_16x16x32_bf16 v[72:75], v[148:151], a[40:43], v[72:75]
s_add_u32 s65, s76, 20480
s_waitcnt lgkmcnt(4)
ds_read_b128 v[144:147], v8 offset:16384
v_mfma_f32_16x16x32_bf16 v[76:79], v[148:151], a[44:47], v[76:79]
buffer_load_dwordx4 a[80:83], v4, s[24:27], s65 offen offset:0 sc1
v_mfma_f32_16x16x32_bf16 v[80:83], v[152:155], a[40:43], v[80:83]
s_mov_b32 m0, s70
s_mov_b32 s64, s68
s_add_u32 s68, s68, 16384
v_mfma_f32_16x16x32_bf16 v[84:87], v[152:155], a[44:47], v[84:87]
s_add_u32 s70, s70, 16384
s_and_b32 s70, s70, 131071
ds_read_b128 v[148:151], v8 offset:17408
v_mfma_f32_16x16x32_bf16 v[88:91], v[156:159], a[40:43], v[88:91]
buffer_load_dwordx4 v4, s[24:27], s64 offen offset:0 sc1 lds
v_mfma_f32_16x16x32_bf16 v[92:95], v[156:159], a[44:47], v[92:95]
buffer_load_dwordx4 a[84:87], v4, s[24:27], s65 offen offset:1024 sc1
v_mfma_f32_16x16x32_bf16 v[96:99], v[160:163], a[40:43], v[96:99]
ds_read_b128 v[152:155], v8 offset:18432
ds_read_b128 v[156:159], v8 offset:19456
v_mfma_f32_16x16x32_bf16 v[100:103], v[160:163], a[44:47], v[100:103]
v_mfma_f32_16x16x32_bf16 v[104:107], v[164:167], a[40:43], v[104:107]
ds_read_b128 v[160:163], v8 offset:20480
v_mfma_f32_16x16x32_bf16 v[108:111], v[164:167], a[44:47], v[108:111]
s_waitcnt lgkmcnt(5)
s_waitcnt vmcnt(9)
v_mfma_f32_16x16x32_bf16 v[72:75], v[168:171], a[48:51], v[72:75]
buffer_load_dwordx4 a[88:91], v4, s[24:27], s65 offen offset:2048 sc1
v_mfma_f32_16x16x32_bf16 v[76:79], v[168:171], a[52:55], v[76:79]
ds_read_b128 v[164:167], v8 offset:21504
v_mfma_f32_16x16x32_bf16 v[80:83], v[172:175], a[48:51], v[80:83]
ds_read_b128 v[168:171], v8 offset:22528
v_mfma_f32_16x16x32_bf16 v[84:87], v[172:175], a[52:55], v[84:87]
s_waitcnt lgkmcnt(5)
v_mfma_f32_16x16x32_bf16 v[88:91], v[144:147], a[48:51], v[88:91]
ds_read_b128 v[172:175], v8 offset:23552
v_mfma_f32_16x16x32_bf16 v[92:95], v[144:147], a[52:55], v[92:95]
buffer_load_dwordx4 a[92:95], v4, s[24:27], s65 offen offset:3072 sc1
v_mfma_f32_16x16x32_bf16 v[96:99], v[148:151], a[48:51], v[96:99]
buffer_load_dwordx4 v4, s[24:27], s64 offen offset:1024 sc1 lds
v_mfma_f32_16x16x32_bf16 v[100:103], v[148:151], a[52:55], v[100:103]
s_waitcnt lgkmcnt(4)
ds_read_b128 v[144:147], v8 offset:24576
v_mfma_f32_16x16x32_bf16 v[104:107], v[152:155], a[48:51], v[104:107]
ds_read_b128 v[148:151], v8 offset:25600
v_mfma_f32_16x16x32_bf16 v[108:111], v[152:155], a[52:55], v[108:111]
s_add_u32 s65, s76, 24576
s_waitcnt vmcnt(10)
v_mfma_f32_16x16x32_bf16 v[72:75], v[156:159], a[56:59], v[72:75]
buffer_load_dwordx4 a[96:99], v4, s[24:27], s65 offen offset:0 sc1
v_mfma_f32_16x16x32_bf16 v[76:79], v[156:159], a[60:63], v[76:79]
s_waitcnt lgkmcnt(4)
ds_read_b128 v[152:155], v8 offset:26624
v_mfma_f32_16x16x32_bf16 v[80:83], v[160:163], a[56:59], v[80:83]
ds_read_b128 v[156:159], v8 offset:27648
v_mfma_f32_16x16x32_bf16 v[84:87], v[160:163], a[60:63], v[84:87]
v_mfma_f32_16x16x32_bf16 v[88:91], v[164:167], a[56:59], v[88:91]
s_waitcnt lgkmcnt(4)
ds_read_b128 v[160:163], v8 offset:28672
v_mfma_f32_16x16x32_bf16 v[92:95], v[164:167], a[60:63], v[92:95]
buffer_load_dwordx4 a[100:103], v4, s[24:27], s65 offen offset:1024 sc1
v_mfma_f32_16x16x32_bf16 v[96:99], v[168:171], a[56:59], v[96:99]
ds_read_b128 v[164:167], v8 offset:29696
v_mfma_f32_16x16x32_bf16 v[100:103], v[168:171], a[60:63], v[100:103]
v_mfma_f32_16x16x32_bf16 v[104:107], v[172:175], a[56:59], v[104:107]
s_waitcnt lgkmcnt(4)
s_waitcnt vmcnt(10)
ds_read_b128 v[168:171], v8 offset:30720
v_mfma_f32_16x16x32_bf16 v[108:111], v[172:175], a[60:63], v[108:111]
buffer_load_dwordx4 v4, s[24:27], s64 offen offset:2048 sc1 lds
v_mfma_f32_16x16x32_bf16 v[72:75], v[144:147], a[64:67], v[72:75]
buffer_load_dwordx4 a[104:107], v4, s[24:27], s65 offen offset:2048 sc1
v_mfma_f32_16x16x32_bf16 v[76:79], v[144:147], a[68:71], v[76:79]
ds_read_b128 v[172:175], v8 offset:31744
v_mfma_f32_16x16x32_bf16 v[80:83], v[148:151], a[64:67], v[80:83]
ds_read_b128 v[144:147], v8 offset:32768
v_mfma_f32_16x16x32_bf16 v[84:87], v[148:151], a[68:71], v[84:87]
s_waitcnt lgkmcnt(5)
v_mfma_f32_16x16x32_bf16 v[88:91], v[152:155], a[64:67], v[88:91]
ds_read_b128 v[148:151], v8 offset:33792
v_mfma_f32_16x16x32_bf16 v[92:95], v[152:155], a[68:71], v[92:95]
buffer_load_dwordx4 a[108:111], v4, s[24:27], s65 offen offset:3072 sc1
v_mfma_f32_16x16x32_bf16 v[96:99], v[156:159], a[64:67], v[96:99]
ds_read_b128 v[152:155], v8 offset:34816
v_mfma_f32_16x16x32_bf16 v[100:103], v[156:159], a[68:71], v[100:103]
s_waitcnt lgkmcnt(5)
v_mfma_f32_16x16x32_bf16 v[104:107], v[160:163], a[64:67], v[104:107]
ds_read_b128 v[156:159], v8 offset:35840
v_mfma_f32_16x16x32_bf16 v[108:111], v[160:163], a[68:71], v[108:111]
s_add_u32 s65, s76, 28672
s_waitcnt vmcnt(11)
v_mfma_f32_16x16x32_bf16 v[72:75], v[164:167], a[72:75], v[72:75]
buffer_load_dwordx4 a[112:115], v4, s[24:27], s65 offen offset:0 sc1
v_mfma_f32_16x16x32_bf16 v[76:79], v[164:167], a[76:79], v[76:79]
s_waitcnt lgkmcnt(4)
ds_read_b128 v[160:163], v8 offset:36864
v_mfma_f32_16x16x32_bf16 v[80:83], v[168:171], a[72:75], v[80:83]
ds_read_b128 v[164:167], v8 offset:37888
v_mfma_f32_16x16x32_bf16 v[84:87], v[168:171], a[76:79], v[84:87]
buffer_load_dwordx4 v4, s[24:27], s64 offen offset:3072 sc1 lds
v_mfma_f32_16x16x32_bf16 v[88:91], v[172:175], a[72:75], v[88:91]
s_waitcnt lgkmcnt(4)
ds_read_b128 v[168:171], v8 offset:38912
v_mfma_f32_16x16x32_bf16 v[92:95], v[172:175], a[76:79], v[92:95]
buffer_load_dwordx4 a[116:119], v4, s[24:27], s65 offen offset:1024 sc1
v_mfma_f32_16x16x32_bf16 v[96:99], v[144:147], a[72:75], v[96:99]
ds_read_b128 v[172:175], v8 offset:39936
v_mfma_f32_16x16x32_bf16 v[100:103], v[144:147], a[76:79], v[100:103]
v_mfma_f32_16x16x32_bf16 v[104:107], v[148:151], a[72:75], v[104:107]
ds_read_b128 v[144:147], v8 offset:40960
v_mfma_f32_16x16x32_bf16 v[108:111], v[148:151], a[76:79], v[108:111]
s_waitcnt lgkmcnt(5)
s_waitcnt vmcnt(11)
v_mfma_f32_16x16x32_bf16 v[72:75], v[152:155], a[80:83], v[72:75]
buffer_load_dwordx4 a[120:123], v4, s[24:27], s65 offen offset:2048 sc1
v_mfma_f32_16x16x32_bf16 v[76:79], v[152:155], a[84:87], v[76:79]
ds_read_b128 v[148:151], v8 offset:41984
v_mfma_f32_16x16x32_bf16 v[80:83], v[156:159], a[80:83], v[80:83]
ds_read_b128 v[152:155], v8 offset:43008
v_mfma_f32_16x16x32_bf16 v[84:87], v[156:159], a[84:87], v[84:87]
s_waitcnt lgkmcnt(5)
v_mfma_f32_16x16x32_bf16 v[88:91], v[160:163], a[80:83], v[88:91]
ds_read_b128 v[156:159], v8 offset:44032
v_mfma_f32_16x16x32_bf16 v[92:95], v[160:163], a[84:87], v[92:95]
buffer_load_dwordx4 a[124:127], v4, s[24:27], s65 offen offset:3072 sc1
v_mfma_f32_16x16x32_bf16 v[96:99], v[164:167], a[80:83], v[96:99]
ds_read_b128 v[160:163], v8 offset:45056
v_mfma_f32_16x16x32_bf16 v[100:103], v[164:167], a[84:87], v[100:103]
s_waitcnt lgkmcnt(5)
v_mfma_f32_16x16x32_bf16 v[104:107], v[168:171], a[80:83], v[104:107]
ds_read_b128 v[164:167], v8 offset:46080
v_mfma_f32_16x16x32_bf16 v[108:111], v[168:171], a[84:87], v[108:111]
s_add_u32 s65, s76, 32768
s_waitcnt vmcnt(11)
v_mfma_f32_16x16x32_bf16 v[72:75], v[172:175], a[88:91], v[72:75]
buffer_load_dwordx4 a[128:131], v4, s[24:27], s65 offen offset:0 sc1
v_mfma_f32_16x16x32_bf16 v[76:79], v[172:175], a[92:95], v[76:79]
s_waitcnt lgkmcnt(4)
ds_read_b128 v[168:171], v8 offset:47104
v_mfma_f32_16x16x32_bf16 v[80:83], v[144:147], a[88:91], v[80:83]
ds_read_b128 v[172:175], v8 offset:48128
v_mfma_f32_16x16x32_bf16 v[84:87], v[144:147], a[92:95], v[84:87]
s_barrier
v_mfma_f32_16x16x32_bf16 v[88:91], v[148:151], a[88:91], v[88:91]
s_waitcnt lgkmcnt(4)
ds_read_b128 v[144:147], v8 offset:49152
v_mfma_f32_16x16x32_bf16 v[92:95], v[148:151], a[92:95], v[92:95]
buffer_load_dwordx4 a[132:135], v4, s[24:27], s65 offen offset:1024 sc1
v_mfma_f32_16x16x32_bf16 v[96:99], v[152:155], a[88:91], v[96:99]
s_mov_b32 m0, s70
s_mov_b32 s64, s68
s_add_u32 s68, s68, 16384
v_mfma_f32_16x16x32_bf16 v[100:103], v[152:155], a[92:95], v[100:103]
s_add_u32 s70, s70, 16384
s_and_b32 s70, s70, 131071
ds_read_b128 v[148:151], v8 offset:50176
v_mfma_f32_16x16x32_bf16 v[104:107], v[156:159], a[88:91], v[104:107]
buffer_load_dwordx4 v4, s[24:27], s64 offen offset:0 sc1 lds
v_mfma_f32_16x16x32_bf16 v[108:111], v[156:159], a[92:95], v[108:111]
s_waitcnt lgkmcnt(4)
s_waitcnt vmcnt(11)
ds_read_b128 v[152:155], v8 offset:51200
v_mfma_f32_16x16x32_bf16 v[72:75], v[160:163], a[96:99], v[72:75]
buffer_load_dwordx4 a[136:139], v4, s[24:27], s65 offen offset:2048 sc1
v_mfma_f32_16x16x32_bf16 v[76:79], v[160:163], a[100:103], v[76:79]
ds_read_b128 v[156:159], v8 offset:52224
v_mfma_f32_16x16x32_bf16 v[80:83], v[164:167], a[96:99], v[80:83]
ds_read_b128 v[160:163], v8 offset:53248
v_mfma_f32_16x16x32_bf16 v[84:87], v[164:167], a[100:103], v[84:87]
s_waitcnt lgkmcnt(5)
v_mfma_f32_16x16x32_bf16 v[88:91], v[168:171], a[96:99], v[88:91]
ds_read_b128 v[164:167], v8 offset:54272
v_mfma_f32_16x16x32_bf16 v[92:95], v[168:171], a[100:103], v[92:95]
buffer_load_dwordx4 a[140:143], v4, s[24:27], s65 offen offset:3072 sc1
v_mfma_f32_16x16x32_bf16 v[96:99], v[172:175], a[96:99], v[96:99]
ds_read_b128 v[168:171], v8 offset:55296
v_mfma_f32_16x16x32_bf16 v[100:103], v[172:175], a[100:103], v[100:103]
s_waitcnt lgkmcnt(5)
v_mfma_f32_16x16x32_bf16 v[104:107], v[144:147], a[96:99], v[104:107]
ds_read_b128 v[172:175], v8 offset:56320
v_mfma_f32_16x16x32_bf16 v[108:111], v[144:147], a[100:103], v[108:111]
s_add_u32 s65, s76, 36864
s_waitcnt lgkmcnt(4)
s_waitcnt vmcnt(10)
v_mfma_f32_16x16x32_bf16 v[72:75], v[148:151], a[104:107], v[72:75]
buffer_load_dwordx4 a[144:147], v4, s[24:27], s65 offen offset:0 sc1
v_mfma_f32_16x16x32_bf16 v[76:79], v[148:151], a[108:111], v[76:79]
buffer_load_dwordx4 v4, s[24:27], s64 offen offset:1024 sc1 lds
v_mfma_f32_16x16x32_bf16 v[80:83], v[152:155], a[104:107], v[80:83]
ds_read_b128 v[144:147], v8 offset:57344
ds_read_b128 v[148:151], v8 offset:58368
v_mfma_f32_16x16x32_bf16 v[84:87], v[152:155], a[108:111], v[84:87]
v_mfma_f32_16x16x32_bf16 v[88:91], v[156:159], a[104:107], v[88:91]
s_waitcnt lgkmcnt(4)
ds_read_b128 v[152:155], v8 offset:59392
v_mfma_f32_16x16x32_bf16 v[92:95], v[156:159], a[108:111], v[92:95]
buffer_load_dwordx4 a[148:151], v4, s[24:27], s65 offen offset:1024 sc1
v_mfma_f32_16x16x32_bf16 v[96:99], v[160:163], a[104:107], v[96:99]
ds_read_b128 v[156:159], v8 offset:60416
v_mfma_f32_16x16x32_bf16 v[100:103], v[160:163], a[108:111], v[100:103]
v_mfma_f32_16x16x32_bf16 v[104:107], v[164:167], a[104:107], v[104:107]
ds_read_b128 v[160:163], v8 offset:61440
v_mfma_f32_16x16x32_bf16 v[108:111], v[164:167], a[108:111], v[108:111]
s_waitcnt lgkmcnt(5)
s_waitcnt vmcnt(10)
v_mfma_f32_16x16x32_bf16 v[72:75], v[168:171], a[112:115], v[72:75]
buffer_load_dwordx4 a[152:155], v4, s[24:27], s65 offen offset:2048 sc1
v_mfma_f32_16x16x32_bf16 v[76:79], v[168:171], a[116:119], v[76:79]
ds_read_b128 v[164:167], v8 offset:62464
v_mfma_f32_16x16x32_bf16 v[80:83], v[172:175], a[112:115], v[80:83]
s_waitcnt lgkmcnt(4)
ds_read_b128 v[168:171], v8 offset:63488
v_mfma_f32_16x16x32_bf16 v[84:87], v[172:175], a[116:119], v[84:87]
buffer_load_dwordx4 v4, s[24:27], s64 offen offset:2048 sc1 lds
v_mfma_f32_16x16x32_bf16 v[88:91], v[144:147], a[112:115], v[88:91]
ds_read_b128 v[172:175], v8 offset:64512
v_mfma_f32_16x16x32_bf16 v[92:95], v[144:147], a[116:119], v[92:95]
buffer_load_dwordx4 a[156:159], v4, s[24:27], s65 offen offset:3072 sc1
v_mfma_f32_16x16x32_bf16 v[96:99], v[148:151], a[112:115], v[96:99]
ds_read_b128 v[144:147], v7 offset:0
v_mfma_f32_16x16x32_bf16 v[100:103], v[148:151], a[116:119], v[100:103]
s_waitcnt lgkmcnt(5)
v_mfma_f32_16x16x32_bf16 v[104:107], v[152:155], a[112:115], v[104:107]
ds_read_b128 v[148:151], v7 offset:1024
v_mfma_f32_16x16x32_bf16 v[108:111], v[152:155], a[116:119], v[108:111]
s_add_u32 s65, s76, 40960
s_waitcnt vmcnt(11)
v_mfma_f32_16x16x32_bf16 v[72:75], v[156:159], a[120:123], v[72:75]
buffer_load_dwordx4 a[160:163], v4, s[24:27], s65 offen offset:0 sc1
v_mfma_f32_16x16x32_bf16 v[76:79], v[156:159], a[124:127], v[76:79]
s_waitcnt lgkmcnt(4)
ds_read_b128 v[152:155], v7 offset:2048
v_mfma_f32_16x16x32_bf16 v[80:83], v[160:163], a[120:123], v[80:83]
ds_read_b128 v[156:159], v7 offset:3072
v_mfma_f32_16x16x32_bf16 v[84:87], v[160:163], a[124:127], v[84:87]
v_mfma_f32_16x16x32_bf16 v[88:91], v[164:167], a[120:123], v[88:91]
s_waitcnt lgkmcnt(4)
ds_read_b128 v[160:163], v7 offset:4096
v_mfma_f32_16x16x32_bf16 v[92:95], v[164:167], a[124:127], v[92:95]
buffer_load_dwordx4 a[164:167], v4, s[24:27], s65 offen offset:1024 sc1
v_mfma_f32_16x16x32_bf16 v[96:99], v[168:171], a[120:123], v[96:99]
ds_read_b128 v[164:167], v7 offset:5120
v_mfma_f32_16x16x32_bf16 v[100:103], v[168:171], a[124:127], v[100:103]
buffer_load_dwordx4 v4, s[24:27], s64 offen offset:3072 sc1 lds
v_mfma_f32_16x16x32_bf16 v[104:107], v[172:175], a[120:123], v[104:107]
ds_read_b128 v[168:171], v7 offset:6144
v_mfma_f32_16x16x32_bf16 v[108:111], v[172:175], a[124:127], v[108:111]
s_waitcnt lgkmcnt(5)
s_waitcnt vmcnt(12)
v_mfma_f32_16x16x32_bf16 v[72:75], v[144:147], a[128:131], v[72:75]
buffer_load_dwordx4 a[168:171], v4, s[24:27], s65 offen offset:2048 sc1
v_mfma_f32_16x16x32_bf16 v[76:79], v[144:147], a[132:135], v[76:79]
ds_read_b128 v[172:175], v7 offset:7168
v_mfma_f32_16x16x32_bf16 v[80:83], v[148:151], a[128:131], v[80:83]
ds_read_b128 v[144:147], v7 offset:8192
v_mfma_f32_16x16x32_bf16 v[84:87], v[148:151], a[132:135], v[84:87]
s_waitcnt lgkmcnt(5)
v_mfma_f32_16x16x32_bf16 v[88:91], v[152:155], a[128:131], v[88:91]
ds_read_b128 v[148:151], v7 offset:9216
v_mfma_f32_16x16x32_bf16 v[92:95], v[152:155], a[132:135], v[92:95]
buffer_load_dwordx4 a[172:175], v4, s[24:27], s65 offen offset:3072 sc1
v_mfma_f32_16x16x32_bf16 v[96:99], v[156:159], a[128:131], v[96:99]
ds_read_b128 v[152:155], v7 offset:10240
v_mfma_f32_16x16x32_bf16 v[100:103], v[156:159], a[132:135], v[100:103]
s_waitcnt lgkmcnt(5)
v_mfma_f32_16x16x32_bf16 v[104:107], v[160:163], a[128:131], v[104:107]
ds_read_b128 v[156:159], v7 offset:11264
v_mfma_f32_16x16x32_bf16 v[108:111], v[160:163], a[132:135], v[108:111]
s_add_u32 s65, s76, 45056
s_waitcnt vmcnt(11)
v_mfma_f32_16x16x32_bf16 v[72:75], v[164:167], a[136:139], v[72:75]
buffer_load_dwordx4 a[176:179], v4, s[24:27], s65 offen offset:0 sc1
v_mfma_f32_16x16x32_bf16 v[76:79], v[164:167], a[140:143], v[76:79]
s_waitcnt lgkmcnt(4)
ds_read_b128 v[160:163], v7 offset:12288
v_mfma_f32_16x16x32_bf16 v[80:83], v[168:171], a[136:139], v[80:83]
ds_read_b128 v[164:167], v7 offset:13312
v_mfma_f32_16x16x32_bf16 v[84:87], v[168:171], a[140:143], v[84:87]
v_mfma_f32_16x16x32_bf16 v[88:91], v[172:175], a[136:139], v[88:91]
s_waitcnt lgkmcnt(4)
ds_read_b128 v[168:171], v7 offset:14336
v_mfma_f32_16x16x32_bf16 v[92:95], v[172:175], a[140:143], v[92:95]
buffer_load_dwordx4 a[180:183], v4, s[24:27], s65 offen offset:1024 sc1
v_mfma_f32_16x16x32_bf16 v[96:99], v[144:147], a[136:139], v[96:99]
ds_read_b128 v[172:175], v7 offset:15360
v_mfma_f32_16x16x32_bf16 v[100:103], v[144:147], a[140:143], v[100:103]
s_barrier
v_mfma_f32_16x16x32_bf16 v[104:107], v[148:151], a[136:139], v[104:107]
s_waitcnt lgkmcnt(4)
s_waitcnt vmcnt(10)
ds_read_b128 v[144:147], v7 offset:16384
v_mfma_f32_16x16x32_bf16 v[108:111], v[148:151], a[140:143], v[108:111]
s_mov_b32 m0, s70
s_mov_b32 s64, s68
s_add_u32 s68, s68, 16384
v_mfma_f32_16x16x32_bf16 v[72:75], v[152:155], a[144:147], v[72:75]
buffer_load_dwordx4 a[184:187], v4, s[24:27], s65 offen offset:2048 sc1
v_mfma_f32_16x16x32_bf16 v[76:79], v[152:155], a[148:151], v[76:79]
s_add_u32 s70, s70, 16384
s_and_b32 s70, s70, 131071
ds_read_b128 v[148:151], v7 offset:17408
v_mfma_f32_16x16x32_bf16 v[80:83], v[156:159], a[144:147], v[80:83]
buffer_load_dwordx4 v4, s[24:27], s64 offen offset:0 sc1 lds
v_mfma_f32_16x16x32_bf16 v[84:87], v[156:159], a[148:151], v[84:87]
s_waitcnt lgkmcnt(4)
ds_read_b128 v[152:155], v7 offset:18432
v_mfma_f32_16x16x32_bf16 v[88:91], v[160:163], a[144:147], v[88:91]
ds_read_b128 v[156:159], v7 offset:19456
v_mfma_f32_16x16x32_bf16 v[92:95], v[160:163], a[148:151], v[92:95]
buffer_load_dwordx4 a[188:191], v4, s[24:27], s65 offen offset:3072 sc1
v_mfma_f32_16x16x32_bf16 v[96:99], v[164:167], a[144:147], v[96:99]
buffer_load_dwordx4 v4, s[24:27], s64 offen offset:1024 sc1 lds
v_mfma_f32_16x16x32_bf16 v[100:103], v[164:167], a[148:151], v[100:103]
s_waitcnt lgkmcnt(4)
ds_read_b128 v[160:163], v7 offset:20480
v_mfma_f32_16x16x32_bf16 v[104:107], v[168:171], a[144:147], v[104:107]
ds_read_b128 v[164:167], v7 offset:21504
v_mfma_f32_16x16x32_bf16 v[108:111], v[168:171], a[148:151], v[108:111]
s_add_u32 s65, s76, 49152
s_waitcnt vmcnt(11)
v_mfma_f32_16x16x32_bf16 v[72:75], v[172:175], a[152:155], v[72:75]
buffer_load_dwordx4 a[192:195], v4, s[24:27], s65 offen offset:0 sc1
v_mfma_f32_16x16x32_bf16 v[76:79], v[172:175], a[156:159], v[76:79]
s_waitcnt lgkmcnt(4)
ds_read_b128 v[168:171], v7 offset:22528
v_mfma_f32_16x16x32_bf16 v[80:83], v[144:147], a[152:155], v[80:83]
ds_read_b128 v[172:175], v7 offset:23552
v_mfma_f32_16x16x32_bf16 v[84:87], v[144:147], a[156:159], v[84:87]
buffer_load_dwordx4 v4, s[24:27], s64 offen offset:2048 sc1 lds
v_mfma_f32_16x16x32_bf16 v[88:91], v[148:151], a[152:155], v[88:91]
s_waitcnt lgkmcnt(4)
ds_read_b128 v[144:147], v7 offset:24576
v_mfma_f32_16x16x32_bf16 v[92:95], v[148:151], a[156:159], v[92:95]
buffer_load_dwordx4 a[196:199], v4, s[24:27], s65 offen offset:1024 sc1
v_mfma_f32_16x16x32_bf16 v[96:99], v[152:155], a[152:155], v[96:99]
ds_read_b128 v[148:151], v7 offset:25600
v_mfma_f32_16x16x32_bf16 v[100:103], v[152:155], a[156:159], v[100:103]
v_mfma_f32_16x16x32_bf16 v[104:107], v[156:159], a[152:155], v[104:107]
ds_read_b128 v[152:155], v7 offset:26624
v_mfma_f32_16x16x32_bf16 v[108:111], v[156:159], a[156:159], v[108:111]
s_waitcnt lgkmcnt(5)
s_waitcnt vmcnt(12)
v_mfma_f32_16x16x32_bf16 v[72:75], v[160:163], a[160:163], v[72:75]
buffer_load_dwordx4 a[200:203], v4, s[24:27], s65 offen offset:2048 sc1
v_mfma_f32_16x16x32_bf16 v[76:79], v[160:163], a[164:167], v[76:79]
buffer_load_dwordx4 v4, s[24:27], s64 offen offset:3072 sc1 lds
v_mfma_f32_16x16x32_bf16 v[80:83], v[164:167], a[160:163], v[80:83]
s_mov_b32 m0, s70
s_mov_b32 s64, s68
s_add_u32 s68, s68, 16384
v_mfma_f32_16x16x32_bf16 v[84:87], v[164:167], a[164:167], v[84:87]
s_waitcnt lgkmcnt(3)
ds_read_b128 v[156:159], v7 offset:27648
ds_read_b128 v[160:163], v7 offset:28672
v_mfma_f32_16x16x32_bf16 v[88:91], v[168:171], a[160:163], v[88:91]
s_waitcnt lgkmcnt(3)
ds_read_b128 v[164:167], v7 offset:29696
v_mfma_f32_16x16x32_bf16 v[92:95], v[168:171], a[164:167], v[92:95]
buffer_load_dwordx4 a[204:207], v4, s[24:27], s65 offen offset:3072 sc1
v_mfma_f32_16x16x32_bf16 v[96:99], v[172:175], a[160:163], v[96:99]
s_add_u32 s70, s70, 16384
s_and_b32 s70, s70, 131071
ds_read_b128 v[168:171], v7 offset:30720
v_mfma_f32_16x16x32_bf16 v[100:103], v[172:175], a[164:167], v[100:103]
buffer_load_dwordx4 v4, s[24:27], s64 offen offset:0 sc1 lds
v_mfma_f32_16x16x32_bf16 v[104:107], v[144:147], a[160:163], v[104:107]
ds_read_b128 v[172:175], v7 offset:31744
v_mfma_f32_16x16x32_bf16 v[108:111], v[144:147], a[164:167], v[108:111]
s_add_u32 s65, s76, 53248
s_waitcnt lgkmcnt(4)
s_waitcnt vmcnt(13)
v_mfma_f32_16x16x32_bf16 v[72:75], v[148:151], a[168:171], v[72:75]
buffer_load_dword v12, v10, s[24:27], s75 offen offset:4 sc1
v_mfma_f32_16x16x32_bf16 v[76:79], v[148:151], a[172:175], v[76:79]
buffer_load_dwordx4 a[208:211], v4, s[24:27], s65 offen offset:0 sc1
v_mfma_f32_16x16x32_bf16 v[80:83], v[152:155], a[168:171], v[80:83]
ds_read_b128 v[144:147], v7 offset:32768
ds_read_b128 v[148:151], v7 offset:33792
v_mfma_f32_16x16x32_bf16 v[84:87], v[152:155], a[172:175], v[84:87]
s_waitcnt lgkmcnt(4)
v_mfma_f32_16x16x32_bf16 v[88:91], v[156:159], a[168:171], v[88:91]
buffer_load_dwordx4 v4, s[24:27], s64 offen offset:1024 sc1 lds
v_mfma_f32_16x16x32_bf16 v[92:95], v[156:159], a[172:175], v[92:95]
buffer_load_dwordx4 a[212:215], v4, s[24:27], s65 offen offset:1024 sc1
v_mfma_f32_16x16x32_bf16 v[96:99], v[160:163], a[168:171], v[96:99]
ds_read_b128 v[152:155], v7 offset:34816
ds_read_b128 v[156:159], v7 offset:35840
v_mfma_f32_16x16x32_bf16 v[100:103], v[160:163], a[172:175], v[100:103]
v_mfma_f32_16x16x32_bf16 v[104:107], v[164:167], a[168:171], v[104:107]
ds_read_b128 v[160:163], v7 offset:36864
v_mfma_f32_16x16x32_bf16 v[108:111], v[164:167], a[172:175], v[108:111]
s_waitcnt lgkmcnt(5)
s_waitcnt vmcnt(15)
v_mfma_f32_16x16x32_bf16 v[72:75], v[168:171], a[176:179], v[72:75]
buffer_load_dwordx4 a[216:219], v4, s[24:27], s65 offen offset:2048 sc1
v_mfma_f32_16x16x32_bf16 v[76:79], v[168:171], a[180:183], v[76:79]
buffer_load_dwordx4 v4, s[24:27], s64 offen offset:2048 sc1 lds
v_mfma_f32_16x16x32_bf16 v[80:83], v[172:175], a[176:179], v[80:83]
ds_read_b128 v[164:167], v7 offset:37888
ds_read_b128 v[168:171], v7 offset:38912
v_mfma_f32_16x16x32_bf16 v[84:87], v[172:175], a[180:183], v[84:87]
s_waitcnt lgkmcnt(5)
v_mfma_f32_16x16x32_bf16 v[88:91], v[144:147], a[176:179], v[88:91]
ds_read_b128 v[172:175], v7 offset:39936
v_mfma_f32_16x16x32_bf16 v[92:95], v[144:147], a[180:183], v[92:95]
buffer_load_dwordx4 a[220:223], v4, s[24:27], s65 offen offset:3072 sc1
v_mfma_f32_16x16x32_bf16 v[96:99], v[148:151], a[176:179], v[96:99]
ds_read_b128 v[144:147], v7 offset:40960
v_mfma_f32_16x16x32_bf16 v[100:103], v[148:151], a[180:183], v[100:103]
s_waitcnt lgkmcnt(5)
v_mfma_f32_16x16x32_bf16 v[104:107], v[152:155], a[176:179], v[104:107]
buffer_load_dwordx4 v4, s[24:27], s64 offen offset:3072 sc1 lds
v_mfma_f32_16x16x32_bf16 v[108:111], v[152:155], a[180:183], v[108:111]
s_add_u32 s65, s76, 57344
s_waitcnt vmcnt(16)
ds_read_b128 v[148:151], v7 offset:41984
v_mfma_f32_16x16x32_bf16 v[72:75], v[156:159], a[184:187], v[72:75]
buffer_load_dwordx4 a[224:227], v4, s[24:27], s65 offen offset:0 sc1
v_mfma_f32_16x16x32_bf16 v[76:79], v[156:159], a[188:191], v[76:79]
s_waitcnt lgkmcnt(4)
ds_read_b128 v[152:155], v7 offset:43008
v_mfma_f32_16x16x32_bf16 v[80:83], v[160:163], a[184:187], v[80:83]
ds_read_b128 v[156:159], v7 offset:44032
v_mfma_f32_16x16x32_bf16 v[84:87], v[160:163], a[188:191], v[84:87]
v_mfma_f32_16x16x32_bf16 v[88:91], v[164:167], a[184:187], v[88:91]
s_waitcnt lgkmcnt(4)
ds_read_b128 v[160:163], v7 offset:45056
v_mfma_f32_16x16x32_bf16 v[92:95], v[164:167], a[188:191], v[92:95]
buffer_load_dwordx4 a[228:231], v4, s[24:27], s65 offen offset:1024 sc1
v_mfma_f32_16x16x32_bf16 v[96:99], v[168:171], a[184:187], v[96:99]
ds_read_b128 v[164:167], v7 offset:46080
v_mfma_f32_16x16x32_bf16 v[100:103], v[168:171], a[188:191], v[100:103]
v_mfma_f32_16x16x32_bf16 v[104:107], v[172:175], a[184:187], v[104:107]
ds_read_b128 v[168:171], v7 offset:47104
v_mfma_f32_16x16x32_bf16 v[108:111], v[172:175], a[188:191], v[108:111]
s_waitcnt lgkmcnt(5)
s_waitcnt vmcnt(14)
v_mfma_f32_16x16x32_bf16 v[72:75], v[144:147], a[192:195], v[72:75]
s_waitcnt vmcnt(25)
s_waitcnt lgkmcnt(3)
ds_read_b128 v[172:175], v7 offset:48128
v_mfma_f32_16x16x32_bf16 v[76:79], v[144:147], a[196:199], v[76:79]
s_barrier
v_mfma_f32_16x16x32_bf16 v[80:83], v[148:151], a[192:195], v[80:83]
buffer_load_dwordx4 a[232:235], v4, s[24:27], s65 offen offset:2048 sc1
v_mfma_f32_16x16x32_bf16 v[84:87], v[148:151], a[196:199], v[84:87]
s_mov_b32 m0, s70
s_mov_b32 s64, s68
s_add_u32 s68, s68, 16384
v_mfma_f32_16x16x32_bf16 v[88:91], v[152:155], a[192:195], v[88:91]
s_add_u32 s70, s70, 16384
s_and_b32 s70, s70, 131071
ds_read_b128 v[144:147], v7 offset:49152
v_mfma_f32_16x16x32_bf16 v[92:95], v[152:155], a[196:199], v[92:95]
buffer_load_dwordx4 a[236:239], v4, s[24:27], s65 offen offset:3072 sc1
v_mfma_f32_16x16x32_bf16 v[96:99], v[156:159], a[192:195], v[96:99]
buffer_load_dwordx4 v4, s[24:27], s64 offen offset:0 sc1 lds
v_mfma_f32_16x16x32_bf16 v[100:103], v[156:159], a[196:199], v[100:103]
s_waitcnt lgkmcnt(3)
ds_read_b128 v[148:151], v7 offset:50176
ds_read_b128 v[152:155], v7 offset:51200
v_mfma_f32_16x16x32_bf16 v[104:107], v[160:163], a[192:195], v[104:107]
ds_read_b128 v[156:159], v7 offset:52224
v_mfma_f32_16x16x32_bf16 v[108:111], v[160:163], a[196:199], v[108:111]
s_add_u32 s65, s76, 61440
s_waitcnt lgkmcnt(4)
s_waitcnt vmcnt(14)
v_mfma_f32_16x16x32_bf16 v[72:75], v[164:167], a[200:203], v[72:75]
buffer_load_dwordx4 a[240:243], v4, s[24:27], s65 offen offset:0 sc1
v_mfma_f32_16x16x32_bf16 v[76:79], v[164:167], a[204:207], v[76:79]
buffer_load_dwordx4 v4, s[24:27], s64 offen offset:1024 sc1 lds
v_mfma_f32_16x16x32_bf16 v[80:83], v[168:171], a[200:203], v[80:83]
ds_read_b128 v[160:163], v7 offset:53248
ds_read_b128 v[164:167], v7 offset:54272
v_mfma_f32_16x16x32_bf16 v[84:87], v[168:171], a[204:207], v[84:87]
v_mfma_f32_16x16x32_bf16 v[88:91], v[172:175], a[200:203], v[88:91]
s_waitcnt lgkmcnt(4)
ds_read_b128 v[168:171], v7 offset:55296
v_mfma_f32_16x16x32_bf16 v[92:95], v[172:175], a[204:207], v[92:95]
buffer_load_dwordx4 a[244:247], v4, s[24:27], s65 offen offset:1024 sc1
v_mfma_f32_16x16x32_bf16 v[96:99], v[144:147], a[200:203], v[96:99]
s_waitcnt vmcnt(15)
ds_read_b128 v[172:175], v7 offset:56320
v_mfma_f32_16x16x32_bf16 v[100:103], v[144:147], a[204:207], v[100:103]
v_cmp_gt_u32 vcc, 8, v12
v_mfma_f32_16x16x32_bf16 v[104:107], v[148:151], a[200:203], v[104:107]
buffer_load_dwordx4 v4, s[24:27], s64 offen offset:2048 sc1 lds
v_mfma_f32_16x16x32_bf16 v[108:111], v[148:151], a[204:207], v[108:111]
s_waitcnt lgkmcnt(4)
s_waitcnt vmcnt(13)
ds_read_b128 v[144:147], v7 offset:57344
v_mfma_f32_16x16x32_bf16 v[72:75], v[152:155], a[208:211], v[72:75]
buffer_load_dwordx4 a[248:251], v4, s[24:27], s65 offen offset:2048 sc1
v_mfma_f32_16x16x32_bf16 v[76:79], v[152:155], a[212:215], v[76:79]
ds_read_b128 v[148:151], v7 offset:58368
v_mfma_f32_16x16x32_bf16 v[80:83], v[156:159], a[208:211], v[80:83]
s_cbranch_vccnz CK_ZAA
CK_ZAA_R:
v_mfma_f32_16x16x32_bf16 v[84:87], v[156:159], a[212:215], v[84:87]
s_waitcnt lgkmcnt(4)
ds_read_b128 v[152:155], v7 offset:59392
v_mfma_f32_16x16x32_bf16 v[88:91], v[160:163], a[208:211], v[88:91]
buffer_load_dwordx4 v4, s[24:27], s64 offen offset:3072 sc1 lds
v_mfma_f32_16x16x32_bf16 v[92:95], v[160:163], a[212:215], v[92:95]
buffer_load_dwordx4 a[252:255], v4, s[24:27], s65 offen offset:3072 sc1
v_mfma_f32_16x16x32_bf16 v[96:99], v[164:167], a[208:211], v[96:99]
s_mov_b32 m0, s70
s_mov_b32 s64, s68
s_add_u32 s68, s68, 16384
v_mfma_f32_16x16x32_bf16 v[100:103], v[164:167], a[212:215], v[100:103]
s_waitcnt lgkmcnt(3)
ds_read_b128 v[156:159], v7 offset:60416
ds_read_b128 v[160:163], v7 offset:61440
v_mfma_f32_16x16x32_bf16 v[104:107], v[168:171], a[208:211], v[104:107]
s_waitcnt lgkmcnt(3)
s_waitcnt vmcnt(13)
ds_read_b128 v[164:167], v7 offset:62464
v_mfma_f32_16x16x32_bf16 v[108:111], v[168:171], a[212:215], v[108:111]
s_add_u32 s65, s76, 65536
s_add_u32 s70, s70, 16384
s_and_b32 s70, s70, 131071
v_mfma_f32_16x16x32_bf16 v[72:75], v[172:175], a[216:219], v[72:75]
buffer_load_dwordx4 v[32:35], v4, s[24:27], s65 offen offset:0 sc1
v_mfma_f32_16x16x32_bf16 v[76:79], v[172:175], a[220:223], v[76:79]
buffer_load_dwordx4 v4, s[24:27], s64 offen offset:0 sc1 lds
v_mfma_f32_16x16x32_bf16 v[80:83], v[144:147], a[216:219], v[80:83]
ds_read_b128 v[168:171], v7 offset:63488
ds_read_b128 v[172:175], v7 offset:64512
v_mfma_f32_16x16x32_bf16 v[84:87], v[144:147], a[220:223], v[84:87]
v_mfma_f32_16x16x32_bf16 v[88:91], v[148:151], a[216:219], v[88:91]
s_waitcnt lgkmcnt(4)
ds_read_b128 v[144:147], v8 offset:0
v_mfma_f32_16x16x32_bf16 v[92:95], v[148:151], a[220:223], v[92:95]
buffer_load_dwordx4 v[36:39], v4, s[24:27], s65 offen offset:1024 sc1
v_mfma_f32_16x16x32_bf16 v[96:99], v[152:155], a[216:219], v[96:99]
ds_read_b128 v[148:151], v8 offset:1024
v_mfma_f32_16x16x32_bf16 v[100:103], v[152:155], a[220:223], v[100:103]
v_mfma_f32_16x16x32_bf16 v[104:107], v[156:159], a[216:219], v[104:107]
buffer_load_dwordx4 v4, s[24:27], s64 offen offset:1024 sc1 lds
v_mfma_f32_16x16x32_bf16 v[108:111], v[156:159], a[220:223], v[108:111]
s_waitcnt lgkmcnt(4)
s_waitcnt vmcnt(14)
ds_read_b128 v[152:155], v8 offset:2048
v_mfma_f32_16x16x32_bf16 v[72:75], v[160:163], a[224:227], v[72:75]
buffer_load_dwordx4 v[40:43], v4, s[24:27], s65 offen offset:2048 sc1
v_mfma_f32_16x16x32_bf16 v[76:79], v[160:163], a[228:231], v[76:79]
ds_read_b128 v[156:159], v8 offset:3072
v_mfma_f32_16x16x32_bf16 v[80:83], v[164:167], a[224:227], v[80:83]
ds_read_b128 v[160:163], v8 offset:4096
v_mfma_f32_16x16x32_bf16 v[84:87], v[164:167], a[228:231], v[84:87]
s_waitcnt lgkmcnt(5)
v_mfma_f32_16x16x32_bf16 v[88:91], v[168:171], a[224:227], v[88:91]
ds_read_b128 v[164:167], v8 offset:5120
v_mfma_f32_16x16x32_bf16 v[92:95], v[168:171], a[228:231], v[92:95]
buffer_load_dwordx4 v[44:47], v4, s[24:27], s65 offen offset:3072 sc1
v_mfma_f32_16x16x32_bf16 v[96:99], v[172:175], a[224:227], v[96:99]
buffer_load_dwordx4 v4, s[24:27], s64 offen offset:2048 sc1 lds
v_mfma_f32_16x16x32_bf16 v[100:103], v[172:175], a[228:231], v[100:103]
s_waitcnt lgkmcnt(4)
ds_read_b128 v[168:171], v8 offset:6144
v_mfma_f32_16x16x32_bf16 v[104:107], v[144:147], a[224:227], v[104:107]
ds_read_b128 v[172:175], v8 offset:7168
v_mfma_f32_16x16x32_bf16 v[108:111], v[144:147], a[228:231], v[108:111]
s_add_u32 s65, s76, 69632
s_waitcnt vmcnt(15)
v_mfma_f32_16x16x32_bf16 v[72:75], v[148:151], a[232:235], v[72:75]
buffer_load_dwordx4 v[48:51], v4, s[24:27], s65 offen offset:0 sc1
v_mfma_f32_16x16x32_bf16 v[76:79], v[148:151], a[236:239], v[76:79]
s_waitcnt lgkmcnt(4)
ds_read_b128 v[144:147], v8 offset:8192
v_mfma_f32_16x16x32_bf16 v[80:83], v[152:155], a[232:235], v[80:83]
buffer_load_dwordx4 v4, s[24:27], s64 offen offset:3072 sc1 lds
v_mfma_f32_16x16x32_bf16 v[84:87], v[152:155], a[236:239], v[84:87]
ds_read_b128 v[148:151], v8 offset:9216
v_mfma_f32_16x16x32_bf16 v[88:91], v[156:159], a[232:235], v[88:91]
s_waitcnt lgkmcnt(4)
ds_read_b128 v[152:155], v8 offset:10240
v_mfma_f32_16x16x32_bf16 v[92:95], v[156:159], a[236:239], v[92:95]
buffer_load_dwordx4 v[52:55], v4, s[24:27], s65 offen offset:1024 sc1
v_mfma_f32_16x16x32_bf16 v[96:99], v[160:163], a[232:235], v[96:99]
ds_read_b128 v[156:159], v8 offset:11264
v_mfma_f32_16x16x32_bf16 v[100:103], v[160:163], a[236:239], v[100:103]
v_mfma_f32_16x16x32_bf16 v[104:107], v[164:167], a[232:235], v[104:107]
ds_read_b128 v[160:163], v8 offset:12288
v_mfma_f32_16x16x32_bf16 v[108:111], v[164:167], a[236:239], v[108:111]
s_waitcnt lgkmcnt(5)
s_waitcnt vmcnt(14)
v_mfma_f32_16x16x32_bf16 v[72:75], v[168:171], a[240:243], v[72:75]
buffer_load_dwordx4 v[56:59], v4, s[24:27], s65 offen offset:2048 sc1
v_mfma_f32_16x16x32_bf16 v[76:79], v[168:171], a[244:247], v[76:79]
ds_read_b128 v[164:167], v8 offset:13312
v_mfma_f32_16x16x32_bf16 v[80:83], v[172:175], a[240:243], v[80:83]
ds_read_b128 v[168:171], v8 offset:14336
v_mfma_f32_16x16x32_bf16 v[84:87], v[172:175], a[244:247], v[84:87]
s_waitcnt lgkmcnt(5)
s_waitcnt vmcnt(11)
v_mfma_f32_16x16x32_bf16 v[88:91], v[144:147], a[240:243], v[88:91]
s_waitcnt vmcnt(23)
s_waitcnt lgkmcnt(3)
ds_read_b128 v[172:175], v8 offset:15360
v_mfma_f32_16x16x32_bf16 v[92:95], v[144:147], a[244:247], v[92:95]
s_barrier
v_mfma_f32_16x16x32_bf16 v[96:99], v[148:151], a[240:243], v[96:99]
buffer_load_dwordx4 v[60:63], v4, s[24:27], s65 offen offset:3072 sc1
v_mfma_f32_16x16x32_bf16 v[100:103], v[148:151], a[244:247], v[100:103]
s_mov_b32 m0, s70
s_mov_b32 s64, s68
s_add_u32 s68, s68, 16384
v_mfma_f32_16x16x32_bf16 v[104:107], v[152:155], a[240:243], v[104:107]
s_add_u32 s70, s70, 16384
s_and_b32 s70, s70, 131071
ds_read_b128 v[144:147], v8 offset:16384
v_mfma_f32_16x16x32_bf16 v[108:111], v[152:155], a[244:247], v[108:111]
s_add_u32 s65, s76, 73728
s_waitcnt lgkmcnt(3)
ds_read_b128 v[148:151], v8 offset:17408
v_mfma_f32_16x16x32_bf16 v[72:75], v[156:159], a[248:251], v[72:75]
buffer_load_dwordx4 v[64:67], v11, s[24:27], s65 offen offset:0 sc1
v_mfma_f32_16x16x32_bf16 v[76:79], v[156:159], a[252:255], v[76:79]
buffer_load_dwordx4 v4, s[24:27], s64 offen offset:0 sc1 lds
v_mfma_f32_16x16x32_bf16 v[80:83], v[160:163], a[248:251], v[80:83]
ds_read_b128 v[152:155], v8 offset:18432
ds_read_b128 v[156:159], v8 offset:19456
v_mfma_f32_16x16x32_bf16 v[84:87], v[160:163], a[252:255], v[84:87]
s_waitcnt lgkmcnt(4)
v_mfma_f32_16x16x32_bf16 v[88:91], v[164:167], a[248:251], v[88:91]
buffer_load_dwordx4 v4, s[24:27], s64 offen offset:1024 sc1 lds
v_mfma_f32_16x16x32_bf16 v[92:95], v[164:167], a[252:255], v[92:95]
buffer_load_dwordx4 v[68:71], v11, s[24:27], s65 offen offset:1024 sc1
v_mfma_f32_16x16x32_bf16 v[96:99], v[168:171], a[248:251], v[96:99]
ds_read_b128 v[160:163], v8 offset:20480
ds_read_b128 v[164:167], v8 offset:21504
v_mfma_f32_16x16x32_bf16 v[100:103], v[168:171], a[252:255], v[100:103]
v_mfma_f32_16x16x32_bf16 v[104:107], v[172:175], a[248:251], v[104:107]
ds_read_b128 v[168:171], v8 offset:22528
v_mfma_f32_16x16x32_bf16 v[108:111], v[172:175], a[252:255], v[108:111]
s_waitcnt lgkmcnt(5)
s_waitcnt vmcnt(13)
v_mfma_f32_16x16x32_bf16 v[72:75], v[144:147], v[32:35], v[72:75]
ds_read_b128 v[172:175], v8 offset:23552
v_mfma_f32_16x16x32_bf16 v[76:79], v[144:147], v[36:39], v[76:79]
buffer_load_dwordx4 v4, s[24:27], s64 offen offset:2048 sc1 lds
v_mfma_f32_16x16x32_bf16 v[80:83], v[148:151], v[32:35], v[80:83]
ds_read_b128 v[144:147], v8 offset:24576
v_mfma_f32_16x16x32_bf16 v[84:87], v[148:151], v[36:39], v[84:87]
s_waitcnt lgkmcnt(5)
v_mfma_f32_16x16x32_bf16 v[88:91], v[152:155], v[32:35], v[88:91]
ds_read_b128 v[148:151], v8 offset:25600
v_mfma_f32_16x16x32_bf16 v[92:95], v[152:155], v[36:39], v[92:95]
v_mfma_f32_16x16x32_bf16 v[96:99], v[156:159], v[32:35], v[96:99]
ds_read_b128 v[152:155], v8 offset:26624
v_mfma_f32_16x16x32_bf16 v[100:103], v[156:159], v[36:39], v[100:103]
s_waitcnt lgkmcnt(5)
s_waitcnt vmcnt(11)
v_mfma_f32_16x16x32_bf16 v[104:107], v[160:163], v[32:35], v[104:107]
buffer_load_dwordx4 v4, s[24:27], s64 offen offset:3072 sc1 lds
v_mfma_f32_16x16x32_bf16 v[108:111], v[160:163], v[36:39], v[108:111]
s_mov_b32 m0, s70
s_mov_b32 s64, s68
s_add_u32 s68, s68, 16384
v_mfma_f32_16x16x32_bf16 v[72:75], v[164:167], v[40:43], v[72:75]
ds_read_b128 v[156:159], v8 offset:27648
ds_read_b128 v[160:163], v8 offset:28672
v_mfma_f32_16x16x32_bf16 v[76:79], v[164:167], v[44:47], v[76:79]
s_waitcnt lgkmcnt(5)
v_mfma_f32_16x16x32_bf16 v[80:83], v[168:171], v[40:43], v[80:83]
ds_read_b128 v[164:167], v8 offset:29696
v_mfma_f32_16x16x32_bf16 v[84:87], v[168:171], v[44:47], v[84:87]
s_add_u32 s70, s70, 16384
s_and_b32 s70, s70, 131071
v_mfma_f32_16x16x32_bf16 v[88:91], v[172:175], v[40:43], v[88:91]
s_waitcnt lgkmcnt(4)
ds_read_b128 v[168:171], v8 offset:30720
v_mfma_f32_16x16x32_bf16 v[92:95], v[172:175], v[44:47], v[92:95]
buffer_load_dwordx4 v4, s[24:27], s64 offen offset:0 sc1 lds
v_mfma_f32_16x16x32_bf16 v[96:99], v[144:147], v[40:43], v[96:99]
ds_read_b128 v[172:175], v8 offset:31744
v_mfma_f32_16x16x32_bf16 v[100:103], v[144:147], v[44:47], v[100:103]
v_mfma_f32_16x16x32_bf16 v[104:107], v[148:151], v[40:43], v[104:107]
ds_read_b128 v[144:147], v8 offset:32768
v_mfma_f32_16x16x32_bf16 v[108:111], v[148:151], v[44:47], v[108:111]
s_waitcnt lgkmcnt(5)
s_waitcnt vmcnt(9)
v_mfma_f32_16x16x32_bf16 v[72:75], v[152:155], v[48:51], v[72:75]
ds_read_b128 v[148:151], v8 offset:33792
v_mfma_f32_16x16x32_bf16 v[76:79], v[152:155], v[52:55], v[76:79]
v_mfma_f32_16x16x32_bf16 v[80:83], v[156:159], v[48:51], v[80:83]
buffer_load_dwordx4 v4, s[24:27], s64 offen offset:1024 sc1 lds
v_mfma_f32_16x16x32_bf16 v[84:87], v[156:159], v[52:55], v[84:87]
s_waitcnt lgkmcnt(4)
ds_read_b128 v[152:155], v8 offset:34816
v_mfma_f32_16x16x32_bf16 v[88:91], v[160:163], v[48:51], v[88:91]
ds_read_b128 v[156:159], v8 offset:35840
v_mfma_f32_16x16x32_bf16 v[92:95], v[160:163], v[52:55], v[92:95]
v_mfma_f32_16x16x32_bf16 v[96:99], v[164:167], v[48:51], v[96:99]
ds_read_b128 v[160:163], v8 offset:36864
v_mfma_f32_16x16x32_bf16 v[100:103], v[164:167], v[52:55], v[100:103]
s_waitcnt lgkmcnt(5)
v_mfma_f32_16x16x32_bf16 v[104:107], v[168:171], v[48:51], v[104:107]
s_waitcnt vmcnt(8)
ds_read_b128 v[164:167], v8 offset:37888
v_mfma_f32_16x16x32_bf16 v[108:111], v[168:171], v[52:55], v[108:111]
buffer_load_dwordx4 v4, s[24:27], s64 offen offset:2048 sc1 lds
v_mfma_f32_16x16x32_bf16 v[72:75], v[172:175], v[56:59], v[72:75]
ds_read_b128 v[168:171], v8 offset:38912
v_mfma_f32_16x16x32_bf16 v[76:79], v[172:175], v[60:63], v[76:79]
s_waitcnt lgkmcnt(5)
v_mfma_f32_16x16x32_bf16 v[80:83], v[144:147], v[56:59], v[80:83]
ds_read_b128 v[172:175], v8 offset:39936
v_mfma_f32_16x16x32_bf16 v[84:87], v[144:147], v[60:63], v[84:87]
v_mfma_f32_16x16x32_bf16 v[88:91], v[148:151], v[56:59], v[88:91]
ds_read_b128 v[144:147], v8 offset:40960
v_mfma_f32_16x16x32_bf16 v[92:95], v[148:151], v[60:63], v[92:95]
s_waitcnt lgkmcnt(5)
v_mfma_f32_16x16x32_bf16 v[96:99], v[152:155], v[56:59], v[96:99]
buffer_load_dwordx4 v4, s[24:27], s64 offen offset:3072 sc1 lds
v_mfma_f32_16x16x32_bf16 v[100:103], v[152:155], v[60:63], v[100:103]
ds_read_b128 v[148:151], v8 offset:41984
v_mfma_f32_16x16x32_bf16 v[104:107], v[156:159], v[56:59], v[104:107]
ds_read_b128 v[152:155], v8 offset:43008
v_mfma_f32_16x16x32_bf16 v[108:111], v[156:159], v[60:63], v[108:111]
s_waitcnt lgkmcnt(5)
s_waitcnt vmcnt(6)
v_mfma_f32_16x16x32_bf16 v[72:75], v[160:163], v[64:67], v[72:75]
ds_read_b128 v[156:159], v8 offset:44032
v_mfma_f32_16x16x32_bf16 v[76:79], v[160:163], v[68:71], v[76:79]
v_mfma_f32_16x16x32_bf16 v[80:83], v[164:167], v[64:67], v[80:83]
ds_read_b128 v[160:163], v8 offset:45056
v_mfma_f32_16x16x32_bf16 v[84:87], v[164:167], v[68:71], v[84:87]
s_waitcnt lgkmcnt(5)
v_mfma_f32_16x16x32_bf16 v[88:91], v[168:171], v[64:67], v[88:91]
ds_read_b128 v[164:167], v8 offset:46080
v_mfma_f32_16x16x32_bf16 v[92:95], v[168:171], v[68:71], v[92:95]
v_mfma_f32_16x16x32_bf16 v[96:99], v[172:175], v[64:67], v[96:99]
ds_read_b128 v[168:171], v8 offset:47104
v_mfma_f32_16x16x32_bf16 v[100:103], v[172:175], v[68:71], v[100:103]
s_waitcnt lgkmcnt(5)
v_mfma_f32_16x16x32_bf16 v[104:107], v[144:147], v[64:67], v[104:107]
s_waitcnt vmcnt(13)
ds_read_b128 v[172:175], v8 offset:48128
v_mfma_f32_16x16x32_bf16 v[108:111], v[144:147], v[68:71], v[108:111]
s_barrier
v_mfma_f32_16x16x32_bf16 v[112:115], v[148:151], a[0:3], 0
s_waitcnt lgkmcnt(4)
ds_read_b128 v[144:147], v8 offset:49152
v_mfma_f32_16x16x32_bf16 v[116:119], v[148:151], a[4:7], 0
s_mov_b32 m0, s70
s_mov_b32 s64, s68
s_add_u32 s68, s68, 16384
v_mfma_f32_16x16x32_bf16 v[120:123], v[152:155], a[0:3], 0
s_add_u32 s70, s70, 16384
s_and_b32 s70, s70, 131071
ds_read_b128 v[148:151], v8 offset:50176
v_mfma_f32_16x16x32_bf16 v[124:127], v[152:155], a[4:7], 0
buffer_load_dwordx4 v4, s[24:27], s64 offen offset:0 sc1 lds
v_mfma_f32_16x16x32_bf16 v[112:115], v[156:159], a[8:11], v[112:115]
ds_read_b128 v[152:155], v8 offset:51200
v_mfma_f32_16x16x32_bf16 v[116:119], v[156:159], a[12:15], v[116:119]
s_waitcnt lgkmcnt(5)
v_mfma_f32_16x16x32_bf16 v[120:123], v[160:163], a[8:11], v[120:123]
s_add_u32 s52, s84, 1
s_and_b32 s52, s52, 3
s_mul_i32 s52, s52, 6144
v_mfma_f32_16x16x32_bf16 v[124:127], v[160:163], a[12:15], v[124:127]
s_add_u32 s52, s52, s69
s_add_u32 s52, s52, 0
ds_read_b128 v[156:159], v8 offset:52224
v_mfma_f32_16x16x32_bf16 v[112:115], v[164:167], a[16:19], v[112:115]
buffer_load_dwordx4 v4, s[24:27], s64 offen offset:1024 sc1 lds
v_mfma_f32_16x16x32_bf16 v[116:119], v[164:167], a[20:23], v[116:119]
s_waitcnt lgkmcnt(4)
ds_read_b128 v[160:163], v8 offset:53248
v_cvt_pk_bf16_f32 v72, v72, v73
v_mfma_f32_16x16x32_bf16 v[120:123], v[168:171], a[16:19], v[120:123]
ds_read_b128 v[164:167], v8 offset:54272
v_cvt_pk_bf16_f32 v73, v74, v75
v_mfma_f32_16x16x32_bf16 v[124:127], v[168:171], a[20:23], v[124:127]
v_cvt_pk_bf16_f32 v74, v80, v81
v_cvt_pk_bf16_f32 v75, v82, v83
v_mfma_f32_16x16x32_bf16 v[112:115], v[172:175], a[24:27], v[112:115]
s_waitcnt lgkmcnt(4)
ds_read_b128 v[168:171], v8 offset:55296
v_cvt_pk_bf16_f32 v76, v76, v77
v_mfma_f32_16x16x32_bf16 v[116:119], v[172:175], a[28:31], v[116:119]
buffer_store_dwordx4 v[72:75], v4, s[24:27], s52 offen offset:0 sc1
v_mfma_f32_16x16x32_bf16 v[120:123], v[144:147], a[24:27], v[120:123]
ds_read_b128 v[172:175], v8 offset:56320
v_cvt_pk_bf16_f32 v77, v78, v79
v_mfma_f32_16x16x32_bf16 v[124:127], v[144:147], a[28:31], v[124:127]
buffer_load_dwordx4 v4, s[24:27], s64 offen offset:2048 sc1 lds
v_mfma_f32_16x16x32_bf16 v[112:115], v[148:151], a[32:35], v[112:115]
ds_read_b128 v[144:147], v8 offset:57344
v_cvt_pk_bf16_f32 v78, v84, v85
v_mfma_f32_16x16x32_bf16 v[116:119], v[148:151], a[36:39], v[116:119]
s_waitcnt lgkmcnt(5)
v_cvt_pk_bf16_f32 v79, v86, v87
v_cvt_pk_bf16_f32 v88, v88, v89
v_mfma_f32_16x16x32_bf16 v[120:123], v[152:155], a[32:35], v[120:123]
ds_read_b128 v[148:151], v8 offset:58368
v_cvt_pk_bf16_f32 v89, v90, v91
v_mfma_f32_16x16x32_bf16 v[124:127], v[152:155], a[36:39], v[124:127]
s_waitcnt lgkmcnt(4)
v_cvt_pk_bf16_f32 v90, v96, v97
v_cvt_pk_bf16_f32 v91, v98, v99
v_mfma_f32_16x16x32_bf16 v[112:115], v[156:159], a[40:43], v[112:115]
buffer_store_dwordx4 v[76:79], v4, s[24:27], s52 offen offset:1024 sc1
v_mfma_f32_16x16x32_bf16 v[116:119], v[156:159], a[44:47], v[116:119]
s_add_u32 s52, s84, 2
s_and_b32 s52, s52, 3
s_mul_i32 s52, s52, 6144
v_mfma_f32_16x16x32_bf16 v[120:123], v[160:163], a[40:43], v[120:123]
buffer_load_dwordx4 v4, s[24:27], s64 offen offset:3072 sc1 lds
v_mfma_f32_16x16x32_bf16 v[124:127], v[160:163], a[44:47], v[124:127]
s_mov_b32 m0, s70
s_mov_b32 s64, s68
s_add_u32 s68, s68, 16384
v_mfma_f32_16x16x32_bf16 v[112:115], v[164:167], a[48:51], v[112:115]
s_add_u32 s52, s52, s69
s_add_u32 s52, s52, 2048
ds_read_b128 v[152:155], v8 offset:59392
v_mfma_f32_16x16x32_bf16 v[116:119], v[164:167], a[52:55], v[116:119]
s_waitcnt lgkmcnt(3)
ds_read_b128 v[156:159], v8 offset:60416
ds_read_b128 v[160:163], v8 offset:61440
v_mfma_f32_16x16x32_bf16 v[120:123], v[168:171], a[48:51], v[120:123]
ds_read_b128 v[164:167], v8 offset:62464
v_cvt_pk_bf16_f32 v92, v92, v93
v_mfma_f32_16x16x32_bf16 v[124:127], v[168:171], a[52:55], v[124:127]
s_add_u32 s70, s70, 16384
s_and_b32 s70, s70, 131071
v_cvt_pk_bf16_f32 v93, v94, v95
v_mfma_f32_16x16x32_bf16 v[112:115], v[172:175], a[56:59], v[112:115]
s_waitcnt lgkmcnt(4)
ds_read_b128 v[168:171], v8 offset:63488
v_cvt_pk_bf16_f32 v94, v100, v101
v_mfma_f32_16x16x32_bf16 v[116:119], v[172:175], a[60:63], v[116:119]
buffer_load_dwordx4 v4, s[24:27], s64 offen offset:0 sc1 lds
v_mfma_f32_16x16x32_bf16 v[120:123], v[144:147], a[56:59], v[120:123]
buffer_store_dwordx4 v[88:91], v4, s[24:27], s52 offen offset:0 sc1
v_mfma_f32_16x16x32_bf16 v[124:127], v[144:147], a[60:63], v[124:127]
ds_read_b128 v[172:175], v8 offset:64512
v_cvt_pk_bf16_f32 v95, v102, v103
v_mfma_f32_16x16x32_bf16 v[112:115], v[148:151], a[64:67], v[112:115]
ds_read_b128 v[144:147], v7 offset:0
v_cvt_pk_bf16_f32 v228, v104, v105
v_mfma_f32_16x16x32_bf16 v[116:119], v[148:151], a[68:71], v[116:119]
s_waitcnt lgkmcnt(5)
v_cvt_pk_bf16_f32 v229, v106, v107
v_cvt_pk_bf16_f32 v230, v108, v109
v_mfma_f32_16x16x32_bf16 v[120:123], v[152:155], a[64:67], v[120:123]
ds_read_b128 v[148:151], v7 offset:1024
v_cvt_pk_bf16_f32 v231, v110, v111
v_mfma_f32_16x16x32_bf16 v[124:127], v[152:155], a[68:71], v[124:127]
s_waitcnt lgkmcnt(4)
v_mfma_f32_16x16x32_bf16 v[112:115], v[156:159], a[72:75], v[112:115]
buffer_load_dwordx4 v4, s[24:27], s64 offen offset:1024 sc1 lds
v_mfma_f32_16x16x32_bf16 v[116:119], v[156:159], a[76:79], v[116:119]
buffer_store_dwordx4 v[92:95], v4, s[24:27], s52 offen offset:1024 sc1
v_mfma_f32_16x16x32_bf16 v[120:123], v[160:163], a[72:75], v[120:123]
s_sub_u32 s52, s3, s84
s_and_b32 s52, s52, 3
s_lshl_b32 s53, s52, 10
v_mfma_f32_16x16x32_bf16 v[124:127], v[160:163], a[76:79], v[124:127]
s_add_u32 s53, s53, s69
s_add_u32 s53, s53, 23552
s_add_u32 s71, s69, 24576
v_mfma_f32_16x16x32_bf16 v[112:115], v[164:167], a[80:83], v[112:115]
s_cmp_eq_u32 s52, 0
s_cselect_b32 s53, 2147418112, s53
s_cselect_b32 s71, s71, 2147418112
v_mfma_f32_16x16x32_bf16 v[116:119], v[164:167], a[84:87], v[116:119]
s_waitcnt lgkmcnt(2)
ds_read_b128 v[152:155], v7 offset:2048
ds_read_b128 v[156:159], v7 offset:3072
v_mfma_f32_16x16x32_bf16 v[120:123], v[168:171], a[80:83], v[120:123]
ds_read_b128 v[160:163], v7 offset:4096
ds_read_b128 v[164:167], v7 offset:5120
v_mfma_f32_16x16x32_bf16 v[124:127], v[168:171], a[84:87], v[124:127]
buffer_load_dwordx4 v4, s[24:27], s64 offen offset:2048 sc1 lds
v_mfma_f32_16x16x32_bf16 v[112:115], v[172:175], a[88:91], v[112:115]
buffer_store_dwordx4 v[228:231], v4, s[24:27], s53 offen offset:0 sc1
v_mfma_f32_16x16x32_bf16 v[116:119], v[172:175], a[92:95], v[116:119]
s_waitcnt lgkmcnt(4)
ds_read_b128 v[168:171], v7 offset:6144
v_mfma_f32_16x16x32_bf16 v[120:123], v[144:147], a[88:91], v[120:123]
ds_read_b128 v[172:175], v7 offset:7168
v_mfma_f32_16x16x32_bf16 v[124:127], v[144:147], a[92:95], v[124:127]
v_mfma_f32_16x16x32_bf16 v[112:115], v[148:151], a[96:99], v[112:115]
ds_read_b128 v[144:147], v7 offset:8192
v_mfma_f32_16x16x32_bf16 v[116:119], v[148:151], a[100:103], v[116:119]
s_waitcnt lgkmcnt(5)
v_mfma_f32_16x16x32_bf16 v[120:123], v[152:155], a[96:99], v[120:123]
buffer_load_dwordx4 v4, s[24:27], s64 offen offset:3072 sc1 lds
v_mfma_f32_16x16x32_bf16 v[124:127], v[152:155], a[100:103], v[124:127]
ds_read_b128 v[148:151], v7 offset:9216
v_mfma_f32_16x16x32_bf16 v[112:115], v[156:159], a[104:107], v[112:115]
ds_read_b128 v[152:155], v7 offset:10240
v_mfma_f32_16x16x32_bf16 v[116:119], v[156:159], a[108:111], v[116:119]
s_waitcnt lgkmcnt(5)
v_mfma_f32_16x16x32_bf16 v[120:123], v[160:163], a[104:107], v[120:123]
ds_read_b128 v[156:159], v7 offset:11264
v_mfma_f32_16x16x32_bf16 v[124:127], v[160:163], a[108:111], v[124:127]
v_mfma_f32_16x16x32_bf16 v[112:115], v[164:167], a[112:115], v[112:115]
ds_read_b128 v[160:163], v7 offset:12288
v_mfma_f32_16x16x32_bf16 v[116:119], v[164:167], a[116:119], v[116:119]
s_waitcnt lgkmcnt(5)
v_mfma_f32_16x16x32_bf16 v[120:123], v[168:171], a[112:115], v[120:123]
ds_read_b128 v[164:167], v7 offset:13312
v_mfma_f32_16x16x32_bf16 v[124:127], v[168:171], a[116:119], v[124:127]
v_mfma_f32_16x16x32_bf16 v[112:115], v[172:175], a[120:123], v[112:115]
ds_read_b128 v[168:171], v7 offset:14336
v_mfma_f32_16x16x32_bf16 v[116:119], v[172:175], a[124:127], v[116:119]
s_waitcnt lgkmcnt(5)
v_mfma_f32_16x16x32_bf16 v[120:123], v[144:147], a[120:123], v[120:123]
s_waitcnt vmcnt(13)
ds_read_b128 v[172:175], v7 offset:15360
v_mfma_f32_16x16x32_bf16 v[124:127], v[144:147], a[124:127], v[124:127]
s_barrier
v_mfma_f32_16x16x32_bf16 v[112:115], v[148:151], a[128:131], v[112:115]
s_waitcnt lgkmcnt(4)
ds_read_b128 v[144:147], v7 offset:16384
v_mfma_f32_16x16x32_bf16 v[116:119], v[148:151], a[132:135], v[116:119]
s_mov_b32 m0, s70
s_mov_b32 s64, s68
s_add_u32 s68, s68, 16384
v_mfma_f32_16x16x32_bf16 v[120:123], v[152:155], a[128:131], v[120:123]
s_add_u32 s70, s70, 16384
s_and_b32 s70, s70, 131071
ds_read_b128 v[148:151], v7 offset:17408
v_mfma_f32_16x16x32_bf16 v[124:127], v[152:155], a[132:135], v[124:127]
buffer_load_dwordx4 v4, s[24:27], s64 offen offset:0 sc1 lds
v_mfma_f32_16x16x32_bf16 v[112:115], v[156:159], a[136:139], v[112:115]
ds_read_b128 v[152:155], v7 offset:18432
v_mfma_f32_16x16x32_bf16 v[116:119], v[156:159], a[140:143], v[116:119]
s_waitcnt lgkmcnt(5)
v_mfma_f32_16x16x32_bf16 v[120:123], v[160:163], a[136:139], v[120:123]
ds_read_b128 v[156:159], v7 offset:19456
v_mfma_f32_16x16x32_bf16 v[124:127], v[160:163], a[140:143], v[124:127]
v_mfma_f32_16x16x32_bf16 v[112:115], v[164:167], a[144:147], v[112:115]
buffer_load_dwordx4 v4, s[24:27], s64 offen offset:1024 sc1 lds
v_mfma_f32_16x16x32_bf16 v[116:119], v[164:167], a[148:151], v[116:119]
s_waitcnt lgkmcnt(4)
ds_read_b128 v[160:163], v7 offset:20480
v_mfma_f32_16x16x32_bf16 v[120:123], v[168:171], a[144:147], v[120:123]
ds_read_b128 v[164:167], v7 offset:21504
v_mfma_f32_16x16x32_bf16 v[124:127], v[168:171], a[148:151], v[124:127]
v_mfma_f32_16x16x32_bf16 v[112:115], v[172:175], a[152:155], v[112:115]
ds_read_b128 v[168:171], v7 offset:22528
v_mfma_f32_16x16x32_bf16 v[116:119], v[172:175], a[156:159], v[116:119]
s_waitcnt lgkmcnt(5)
v_mfma_f32_16x16x32_bf16 v[120:123], v[144:147], a[152:155], v[120:123]
ds_read_b128 v[172:175], v7 offset:23552
v_mfma_f32_16x16x32_bf16 v[124:127], v[144:147], a[156:159], v[124:127]
buffer_load_dwordx4 v4, s[24:27], s64 offen offset:2048 sc1 lds
v_mfma_f32_16x16x32_bf16 v[112:115], v[148:151], a[160:163], v[112:115]
ds_read_b128 v[144:147], v7 offset:24576
v_mfma_f32_16x16x32_bf16 v[116:119], v[148:151], a[164:167], v[116:119]
s_waitcnt lgkmcnt(5)
v_mfma_f32_16x16x32_bf16 v[120:123], v[152:155], a[160:163], v[120:123]
ds_read_b128 v[148:151], v7 offset:25600
v_mfma_f32_16x16x32_bf16 v[124:127], v[152:155], a[164:167], v[124:127]
v_mfma_f32_16x16x32_bf16 v[112:115], v[156:159], a[168:171], v[112:115]
ds_read_b128 v[152:155], v7 offset:26624
v_mfma_f32_16x16x32_bf16 v[116:119], v[156:159], a[172:175], v[116:119]
s_waitcnt lgkmcnt(5)
v_mfma_f32_16x16x32_bf16 v[120:123], v[160:163], a[168:171], v[120:123]
buffer_load_dwordx4 v4, s[24:27], s64 offen offset:3072 sc1 lds
v_mfma_f32_16x16x32_bf16 v[124:127], v[160:163], a[172:175], v[124:127]
s_mov_b32 m0, s70
s_mov_b32 s64, s68
s_add_u32 s68, s68, 16384
v_mfma_f32_16x16x32_bf16 v[112:115], v[164:167], a[176:179], v[112:115]
ds_read_b128 v[156:159], v7 offset:27648
ds_read_b128 v[160:163], v7 offset:28672
v_mfma_f32_16x16x32_bf16 v[116:119], v[164:167], a[180:183], v[116:119]
s_waitcnt lgkmcnt(5)
v_mfma_f32_16x16x32_bf16 v[120:123], v[168:171], a[176:179], v[120:123]
ds_read_b128 v[164:167], v7 offset:29696
v_mfma_f32_16x16x32_bf16 v[124:127], v[168:171], a[180:183], v[124:127]
s_add_u32 s70, s70, 16384
s_and_b32 s70, s70, 131071
v_mfma_f32_16x16x32_bf16 v[112:115], v[172:175], a[184:187], v[112:115]
s_waitcnt lgkmcnt(4)
ds_read_b128 v[168:171], v7 offset:30720
v_mfma_f32_16x16x32_bf16 v[116:119], v[172:175], a[188:191], v[116:119]
buffer_load_dwordx4 v4, s[24:27], s64 offen offset:0 sc1 lds
v_mfma_f32_16x16x32_bf16 v[120:123], v[144:147], a[184:187], v[120:123]
ds_read_b128 v[172:175], v7 offset:31744
v_mfma_f32_16x16x32_bf16 v[124:127], v[144:147], a[188:191], v[124:127]
v_mfma_f32_16x16x32_bf16 v[112:115], v[148:151], a[192:195], v[112:115]
ds_read_b128 v[144:147], v7 offset:32768
v_mfma_f32_16x16x32_bf16 v[116:119], v[148:151], a[196:199], v[116:119]
s_waitcnt lgkmcnt(5)
v_mfma_f32_16x16x32_bf16 v[120:123], v[152:155], a[192:195], v[120:123]
ds_read_b128 v[148:151], v7 offset:33792
v_mfma_f32_16x16x32_bf16 v[124:127], v[152:155], a[196:199], v[124:127]
v_mfma_f32_16x16x32_bf16 v[112:115], v[156:159], a[200:203], v[112:115]
buffer_load_dwordx4 v4, s[24:27], s64 offen offset:1024 sc1 lds
v_mfma_f32_16x16x32_bf16 v[116:119], v[156:159], a[204:207], v[116:119]
s_waitcnt lgkmcnt(4)
ds_read_b128 v[152:155], v7 offset:34816
v_mfma_f32_16x16x32_bf16 v[120:123], v[160:163], a[200:203], v[120:123]
ds_read_b128 v[156:159], v7 offset:35840
v_mfma_f32_16x16x32_bf16 v[124:127], v[160:163], a[204:207], v[124:127]
v_mfma_f32_16x16x32_bf16 v[112:115], v[164:167], a[208:211], v[112:115]
s_waitcnt vmcnt(7)
s_waitcnt lgkmcnt(4)
ds_read_b128 v[160:163], v7 offset:36864
v_mfma_f32_16x16x32_bf16 v[116:119], v[164:167], a[212:215], v[116:119]
buffer_atomic_add v1, v0, s[24:27], s73 offen offset:0 sc1
v_mfma_f32_16x16x32_bf16 v[120:123], v[168:171], a[208:211], v[120:123]
ds_read_b128 v[164:167], v7 offset:37888
v_mfma_f32_16x16x32_bf16 v[124:127], v[168:171], a[212:215], v[124:127]
buffer_load_dwordx4 v4, s[24:27], s64 offen offset:2048 sc1 lds
v_mfma_f32_16x16x32_bf16 v[112:115], v[172:175], a[216:219], v[112:115]
ds_read_b128 v[168:171], v7 offset:38912
v_mfma_f32_16x16x32_bf16 v[116:119], v[172:175], a[220:223], v[116:119]
s_waitcnt lgkmcnt(5)
v_mfma_f32_16x16x32_bf16 v[120:123], v[144:147], a[216:219], v[120:123]
ds_read_b128 v[172:175], v7 offset:39936
v_mfma_f32_16x16x32_bf16 v[124:127], v[144:147], a[220:223], v[124:127]
v_mfma_f32_16x16x32_bf16 v[112:115], v[148:151], a[224:227], v[112:115]
ds_read_b128 v[144:147], v7 offset:40960
v_mfma_f32_16x16x32_bf16 v[116:119], v[148:151], a[228:231], v[116:119]
s_waitcnt lgkmcnt(5)
v_mfma_f32_16x16x32_bf16 v[120:123], v[152:155], a[224:227], v[120:123]
buffer_load_dwordx4 v4, s[24:27], s64 offen offset:3072 sc1 lds
v_mfma_f32_16x16x32_bf16 v[124:127], v[152:155], a[228:231], v[124:127]
ds_read_b128 v[148:151], v7 offset:41984
v_mfma_f32_16x16x32_bf16 v[112:115], v[156:159], a[232:235], v[112:115]
ds_read_b128 v[152:155], v7 offset:43008
v_mfma_f32_16x16x32_bf16 v[116:119], v[156:159], a[236:239], v[116:119]
s_waitcnt lgkmcnt(5)
v_mfma_f32_16x16x32_bf16 v[120:123], v[160:163], a[232:235], v[120:123]
ds_read_b128 v[156:159], v7 offset:44032
v_mfma_f32_16x16x32_bf16 v[124:127], v[160:163], a[236:239], v[124:127]
v_mfma_f32_16x16x32_bf16 v[112:115], v[164:167], a[240:243], v[112:115]
ds_read_b128 v[160:163], v7 offset:45056
v_mfma_f32_16x16x32_bf16 v[116:119], v[164:167], a[244:247], v[116:119]
s_waitcnt lgkmcnt(5)
v_mfma_f32_16x16x32_bf16 v[120:123], v[168:171], a[240:243], v[120:123]
ds_read_b128 v[164:167], v7 offset:46080
v_mfma_f32_16x16x32_bf16 v[124:127], v[168:171], a[244:247], v[124:127]
v_mfma_f32_16x16x32_bf16 v[112:115], v[172:175], a[248:251], v[112:115]
ds_read_b128 v[168:171], v7 offset:47104
v_mfma_f32_16x16x32_bf16 v[116:119], v[172:175], a[252:255], v[116:119]
s_waitcnt lgkmcnt(5)
v_mfma_f32_16x16x32_bf16 v[120:123], v[144:147], a[248:251], v[120:123]
s_waitcnt vmcnt(9)
ds_read_b128 v[172:175], v7 offset:48128
v_mfma_f32_16x16x32_bf16 v[124:127], v[144:147], a[252:255], v[124:127]
s_barrier
v_mfma_f32_16x16x32_bf16 v[112:115], v[148:151], v[32:35], v[112:115]
s_waitcnt lgkmcnt(4)
ds_read_b128 v[144:147], v7 offset:49152
v_mfma_f32_16x16x32_bf16 v[116:119], v[148:151], v[36:39], v[116:119]
s_mov_b32 m0, s70
s_mov_b32 s64, s68
s_add_u32 s68, s68, 16384
v_mfma_f32_16x16x32_bf16 v[120:123], v[152:155], v[32:35], v[120:123]
s_add_u32 s70, s70, 16384
s_and_b32 s70, s70, 131071
ds_read_b128 v[148:151], v7 offset:50176
v_mfma_f32_16x16x32_bf16 v[124:127], v[152:155], v[36:39], v[124:127]
buffer_load_dwordx4 v4, s[24:27], s64 offen offset:0 sc1 lds
v_mfma_f32_16x16x32_bf16 v[112:115], v[156:159], v[40:43], v[112:115]
ds_read_b128 v[152:155], v7 offset:51200
v_mfma_f32_16x16x32_bf16 v[116:119], v[156:159], v[44:47], v[116:119]
s_waitcnt lgkmcnt(5)
v_mfma_f32_16x16x32_bf16 v[120:123], v[160:163], v[40:43], v[120:123]
ds_read_b128 v[156:159], v7 offset:52224
v_mfma_f32_16x16x32_bf16 v[124:127], v[160:163], v[44:47], v[124:127]
v_mfma_f32_16x16x32_bf16 v[112:115], v[164:167], v[48:51], v[112:115]
ds_read_b128 v[160:163], v7 offset:53248
v_mfma_f32_16x16x32_bf16 v[116:119], v[164:167], v[52:55], v[116:119]
s_waitcnt lgkmcnt(5)
v_mfma_f32_16x16x32_bf16 v[120:123], v[168:171], v[48:51], v[120:123]
ds_read_b128 v[164:167], v7 offset:54272
v_mfma_f32_16x16x32_bf16 v[124:127], v[168:171], v[52:55], v[124:127]
v_mfma_f32_16x16x32_bf16 v[112:115], v[172:175], v[56:59], v[112:115]
ds_read_b128 v[168:171], v7 offset:55296
v_mfma_f32_16x16x32_bf16 v[116:119], v[172:175], v[60:63], v[116:119]
s_waitcnt lgkmcnt(5)
v_mfma_f32_16x16x32_bf16 v[120:123], v[144:147], v[56:59], v[120:123]
s_waitcnt lgkmcnt(3)
ds_read_b128 v[172:175], v7 offset:56320
v_mfma_f32_16x16x32_bf16 v[124:127], v[144:147], v[60:63], v[124:127]
buffer_load_dwordx4 v4, s[24:27], s64 offen offset:1024 sc1 lds
v_mfma_f32_16x16x32_bf16 v[112:115], v[148:151], v[64:67], v[112:115]
s_add_u32 s52, s84, 3
s_and_b32 s52, s52, 3
s_mul_i32 s52, s52, 6144
v_mfma_f32_16x16x32_bf16 v[116:119], v[148:151], v[68:71], v[116:119]
s_add_u32 s52, s52, s69
s_add_u32 s52, s52, 4096
ds_read_b128 v[144:147], v7 offset:57344
v_mfma_f32_16x16x32_bf16 v[120:123], v[152:155], v[64:67], v[120:123]
ds_read_b128 v[148:151], v7 offset:58368
v_mfma_f32_16x16x32_bf16 v[124:127], v[152:155], v[68:71], v[124:127]
v_mfma_f32_16x16x32_bf16 v[128:131], v[156:159], a[0:3], 0
ds_read_b128 v[152:155], v7 offset:59392
v_mfma_f32_16x16x32_bf16 v[132:135], v[156:159], a[4:7], 0
s_waitcnt lgkmcnt(5)
v_mfma_f32_16x16x32_bf16 v[136:139], v[160:163], a[0:3], 0
ds_read_b128 v[156:159], v7 offset:60416
v_mfma_f32_16x16x32_bf16 v[140:143], v[160:163], a[4:7], 0
v_mfma_f32_16x16x32_bf16 v[128:131], v[164:167], a[8:11], v[128:131]
ds_read_b128 v[160:163], v7 offset:61440
v_mfma_f32_16x16x32_bf16 v[132:135], v[164:167], a[12:15], v[132:135]
s_waitcnt lgkmcnt(5)
v_mfma_f32_16x16x32_bf16 v[136:139], v[168:171], a[8:11], v[136:139]
ds_read_b128 v[164:167], v7 offset:62464
v_mfma_f32_16x16x32_bf16 v[140:143], v[168:171], a[12:15], v[140:143]
v_cvt_pk_bf16_f32 v112, v112, v113
v_cvt_pk_bf16_f32 v113, v114, v115
v_mfma_f32_16x16x32_bf16 v[128:131], v[172:175], a[16:19], v[128:131]
s_waitcnt lgkmcnt(4)
ds_read_b128 v[168:171], v7 offset:63488
v_cvt_pk_bf16_f32 v114, v120, v121
v_mfma_f32_16x16x32_bf16 v[132:135], v[172:175], a[20:23], v[132:135]
buffer_load_dwordx4 v4, s[24:27], s64 offen offset:2048 sc1 lds
v_mfma_f32_16x16x32_bf16 v[136:139], v[144:147], a[16:19], v[136:139]
ds_read_b128 v[172:175], v7 offset:64512
v_cvt_pk_bf16_f32 v115, v122, v123
v_mfma_f32_16x16x32_bf16 v[140:143], v[144:147], a[20:23], v[140:143]
v_cvt_pk_bf16_f32 v116, v116, v117
v_cvt_pk_bf16_f32 v117, v118, v119
v_mfma_f32_16x16x32_bf16 v[128:131], v[148:151], a[24:27], v[128:131]
s_waitcnt lgkmcnt(4)
ds_read_b128 v[144:147], v8 offset:0
v_cvt_pk_bf16_f32 v118, v124, v125
v_mfma_f32_16x16x32_bf16 v[132:135], v[148:151], a[28:31], v[132:135]
buffer_store_dwordx4 v[112:115], v4, s[24:27], s52 offen offset:0 sc1
v_mfma_f32_16x16x32_bf16 v[136:139], v[152:155], a[24:27], v[136:139]
ds_read_b128 v[148:151], v8 offset:1024
v_cvt_pk_bf16_f32 v119, v126, v127
v_mfma_f32_16x16x32_bf16 v[140:143], v[152:155], a[28:31], v[140:143]
v_mfma_f32_16x16x32_bf16 v[128:131], v[156:159], a[32:35], v[128:131]
ds_read_b128 v[152:155], v8 offset:2048
v_mfma_f32_16x16x32_bf16 v[132:135], v[156:159], a[36:39], v[132:135]
s_waitcnt lgkmcnt(5)
v_mfma_f32_16x16x32_bf16 v[136:139], v[160:163], a[32:35], v[136:139]
buffer_store_dwordx4 v[116:119], v4, s[24:27], s52 offen offset:1024 sc1
v_mfma_f32_16x16x32_bf16 v[140:143], v[160:163], a[36:39], v[140:143]
buffer_load_dword v12, v10, s[24:27], s73 offen sc1
v_mfma_f32_16x16x32_bf16 v[128:131], v[164:167], a[40:43], v[128:131]
ds_read_b128 v[156:159], v8 offset:3072
ds_read_b128 v[160:163], v8 offset:4096
v_mfma_f32_16x16x32_bf16 v[132:135], v[164:167], a[44:47], v[132:135]
s_waitcnt lgkmcnt(5)
v_mfma_f32_16x16x32_bf16 v[136:139], v[168:171], a[40:43], v[136:139]
ds_read_b128 v[164:167], v8 offset:5120
v_mfma_f32_16x16x32_bf16 v[140:143], v[168:171], a[44:47], v[140:143]
buffer_load_dwordx4 v4, s[24:27], s64 offen offset:3072 sc1 lds
v_mfma_f32_16x16x32_bf16 v[128:131], v[172:175], a[48:51], v[128:131]
ds_read_b128 v[168:171], v8 offset:6144
v_mfma_f32_16x16x32_bf16 v[132:135], v[172:175], a[52:55], v[132:135]
s_waitcnt lgkmcnt(5)
v_mfma_f32_16x16x32_bf16 v[136:139], v[144:147], a[48:51], v[136:139]
ds_read_b128 v[172:175], v8 offset:7168
v_mfma_f32_16x16x32_bf16 v[140:143], v[144:147], a[52:55], v[140:143]
v_mfma_f32_16x16x32_bf16 v[128:131], v[148:151], a[56:59], v[128:131]
ds_read_b128 v[144:147], v8 offset:8192
v_mfma_f32_16x16x32_bf16 v[132:135], v[148:151], a[60:63], v[132:135]
s_waitcnt lgkmcnt(5)
v_mfma_f32_16x16x32_bf16 v[136:139], v[152:155], a[56:59], v[136:139]
ds_read_b128 v[148:151], v8 offset:9216
v_mfma_f32_16x16x32_bf16 v[140:143], v[152:155], a[60:63], v[140:143]
v_mfma_f32_16x16x32_bf16 v[128:131], v[156:159], a[64:67], v[128:131]
ds_read_b128 v[152:155], v8 offset:10240
v_mfma_f32_16x16x32_bf16 v[132:135], v[156:159], a[68:71], v[132:135]
s_waitcnt lgkmcnt(5)
v_mfma_f32_16x16x32_bf16 v[136:139], v[160:163], a[64:67], v[136:139]
ds_read_b128 v[156:159], v8 offset:11264
v_mfma_f32_16x16x32_bf16 v[140:143], v[160:163], a[68:71], v[140:143]
v_mfma_f32_16x16x32_bf16 v[128:131], v[164:167], a[72:75], v[128:131]
ds_read_b128 v[160:163], v8 offset:12288
v_mfma_f32_16x16x32_bf16 v[132:135], v[164:167], a[76:79], v[132:135]
s_waitcnt lgkmcnt(5)
v_mfma_f32_16x16x32_bf16 v[136:139], v[168:171], a[72:75], v[136:139]
ds_read_b128 v[164:167], v8 offset:13312
v_mfma_f32_16x16x32_bf16 v[140:143], v[168:171], a[76:79], v[140:143]
v_mfma_f32_16x16x32_bf16 v[128:131], v[172:175], a[80:83], v[128:131]
ds_read_b128 v[168:171], v8 offset:14336
v_mfma_f32_16x16x32_bf16 v[132:135], v[172:175], a[84:87], v[132:135]
s_waitcnt lgkmcnt(5)
v_mfma_f32_16x16x32_bf16 v[136:139], v[144:147], a[80:83], v[136:139]
s_waitcnt vmcnt(7)
ds_read_b128 v[172:175], v8 offset:15360
v_mfma_f32_16x16x32_bf16 v[140:143], v[144:147], a[84:87], v[140:143]
s_barrier
v_mfma_f32_16x16x32_bf16 v[128:131], v[148:151], a[88:91], v[128:131]
ds_read_b128 v[144:147], v8 offset:16384
v_mfma_f32_16x16x32_bf16 v[132:135], v[148:151], a[92:95], v[132:135]
s_waitcnt lgkmcnt(5)
v_mfma_f32_16x16x32_bf16 v[136:139], v[152:155], a[88:91], v[136:139]
ds_read_b128 v[148:151], v8 offset:17408
v_mfma_f32_16x16x32_bf16 v[140:143], v[152:155], a[92:95], v[140:143]
v_mfma_f32_16x16x32_bf16 v[128:131], v[156:159], a[96:99], v[128:131]
ds_read_b128 v[152:155], v8 offset:18432
v_mfma_f32_16x16x32_bf16 v[132:135], v[156:159], a[100:103], v[132:135]
s_waitcnt lgkmcnt(5)
v_mfma_f32_16x16x32_bf16 v[136:139], v[160:163], a[96:99], v[136:139]
ds_read_b128 v[156:159], v8 offset:19456
v_mfma_f32_16x16x32_bf16 v[140:143], v[160:163], a[100:103], v[140:143]
v_mfma_f32_16x16x32_bf16 v[128:131], v[164:167], a[104:107], v[128:131]
ds_read_b128 v[160:163], v8 offset:20480
v_mfma_f32_16x16x32_bf16 v[132:135], v[164:167], a[108:111], v[132:135]
s_waitcnt lgkmcnt(5)
v_mfma_f32_16x16x32_bf16 v[136:139], v[168:171], a[104:107], v[136:139]
ds_read_b128 v[164:167], v8 offset:21504
v_mfma_f32_16x16x32_bf16 v[140:143], v[168:171], a[108:111], v[140:143]
v_mfma_f32_16x16x32_bf16 v[128:131], v[172:175], a[112:115], v[128:131]
ds_read_b128 v[168:171], v8 offset:22528
v_mfma_f32_16x16x32_bf16 v[132:135], v[172:175], a[116:119], v[132:135]
s_waitcnt lgkmcnt(5)
v_mfma_f32_16x16x32_bf16 v[136:139], v[144:147], a[112:115], v[136:139]
s_waitcnt vmcnt(1)
ds_read_b128 v[172:175], v8 offset:23552
v_mfma_f32_16x16x32_bf16 v[140:143], v[144:147], a[116:119], v[140:143]
v_cmp_gt_u32 vcc, 4, v12
v_mfma_f32_16x16x32_bf16 v[128:131], v[148:151], a[120:123], v[128:131]
ds_read_b128 v[144:147], v8 offset:24576
v_mfma_f32_16x16x32_bf16 v[132:135], v[148:151], a[124:127], v[132:135]
s_waitcnt lgkmcnt(5)
v_mfma_f32_16x16x32_bf16 v[136:139], v[152:155], a[120:123], v[136:139]
ds_read_b128 v[148:151], v8 offset:25600
v_mfma_f32_16x16x32_bf16 v[140:143], v[152:155], a[124:127], v[140:143]
s_waitcnt lgkmcnt(4)
v_mfma_f32_16x16x32_bf16 v[128:131], v[156:159], a[128:131], v[128:131]
s_cbranch_vccnz CK_P1
CK_P1_R:
v_mfma_f32_16x16x32_bf16 v[132:135], v[156:159], a[132:135], v[132:135]
buffer_atomic_add v1, v0, s[24:27], s73 offen offset:16 sc1
v_mfma_f32_16x16x32_bf16 v[136:139], v[160:163], a[128:131], v[136:139]
s_mul_i32 s52, s84, 6144
s_add_u32 s52, s52, s69
s_add_u32 s53, s52, 4096
v_mfma_f32_16x16x32_bf16 v[140:143], v[160:163], a[132:135], v[140:143]
ds_read_b128 v[152:155], v8 offset:26624
ds_read_b128 v[156:159], v8 offset:27648
v_mfma_f32_16x16x32_bf16 v[128:131], v[164:167], a[136:139], v[128:131]
buffer_load_dwordx4 v[176:179], v4, s[24:27], s52 offen offset:0 sc1
v_mfma_f32_16x16x32_bf16 v[132:135], v[164:167], a[140:143], v[132:135]
s_waitcnt lgkmcnt(4)
ds_read_b128 v[160:163], v8 offset:28672
v_mfma_f32_16x16x32_bf16 v[136:139], v[168:171], a[136:139], v[136:139]
buffer_load_dwordx4 v[180:183], v4, s[24:27], s52 offen offset:1024 sc1
v_mfma_f32_16x16x32_bf16 v[140:143], v[168:171], a[140:143], v[140:143]
ds_read_b128 v[164:167], v8 offset:29696
v_mfma_f32_16x16x32_bf16 v[128:131], v[172:175], a[144:147], v[128:131]
buffer_load_dwordx4 v[184:187], v4, s[24:27], s52 offen offset:2048 sc1
v_mfma_f32_16x16x32_bf16 v[132:135], v[172:175], a[148:151], v[132:135]
s_waitcnt lgkmcnt(4)
ds_read_b128 v[168:171], v8 offset:30720
v_mfma_f32_16x16x32_bf16 v[136:139], v[144:147], a[144:147], v[136:139]
buffer_load_dwordx4 v[188:191], v4, s[24:27], s52 offen offset:3072 sc1
v_mfma_f32_16x16x32_bf16 v[140:143], v[144:147], a[148:151], v[140:143]
ds_read_b128 v[172:175], v8 offset:31744
v_mfma_f32_16x16x32_bf16 v[128:131], v[148:151], a[152:155], v[128:131]
buffer_load_dwordx4 v[192:195], v4, s[24:27], s71 offen offset:0 sc1
v_mfma_f32_16x16x32_bf16 v[132:135], v[148:151], a[156:159], v[132:135]
s_waitcnt lgkmcnt(4)
ds_read_b128 v[144:147], v8 offset:32768
v_mfma_f32_16x16x32_bf16 v[136:139], v[152:155], a[152:155], v[136:139]
buffer_load_dwordx4 v[196:199], v4, s[24:27], s71 offen offset:1024 sc1
v_mfma_f32_16x16x32_bf16 v[140:143], v[152:155], a[156:159], v[140:143]
ds_read_b128 v[148:151], v8 offset:33792
v_mfma_f32_16x16x32_bf16 v[128:131], v[156:159], a[160:163], v[128:131]
buffer_load_dwordx4 v[200:203], v4, s[24:27], s71 offen offset:2048 sc1
v_mfma_f32_16x16x32_bf16 v[132:135], v[156:159], a[164:167], v[132:135]
s_waitcnt lgkmcnt(4)
ds_read_b128 v[152:155], v8 offset:34816
v_mfma_f32_16x16x32_bf16 v[136:139], v[160:163], a[160:163], v[136:139]
ds_read_b128 v[156:159], v8 offset:35840
v_mfma_f32_16x16x32_bf16 v[140:143], v[160:163], a[164:167], v[140:143]
v_mfma_f32_16x16x32_bf16 v[128:131], v[164:167], a[168:171], v[128:131]
ds_read_b128 v[160:163], v8 offset:36864
v_mfma_f32_16x16x32_bf16 v[132:135], v[164:167], a[172:175], v[132:135]
s_waitcnt lgkmcnt(5)
v_mfma_f32_16x16x32_bf16 v[136:139], v[168:171], a[168:171], v[136:139]
ds_read_b128 v[164:167], v8 offset:37888
v_mfma_f32_16x16x32_bf16 v[140:143], v[168:171], a[172:175], v[140:143]
v_mfma_f32_16x16x32_bf16 v[128:131], v[172:175], a[176:179], v[128:131]
ds_read_b128 v[168:171], v8 offset:38912
v_mfma_f32_16x16x32_bf16 v[132:135], v[172:175], a[180:183], v[132:135]
s_waitcnt lgkmcnt(5)
v_mfma_f32_16x16x32_bf16 v[136:139], v[144:147], a[176:179], v[136:139]
ds_read_b128 v[172:175], v8 offset:39936
v_mfma_f32_16x16x32_bf16 v[140:143], v[144:147], a[180:183], v[140:143]
v_mfma_f32_16x16x32_bf16 v[128:131], v[148:151], a[184:187], v[128:131]
ds_read_b128 v[144:147], v8 offset:40960
v_mfma_f32_16x16x32_bf16 v[132:135], v[148:151], a[188:191], v[132:135]
s_waitcnt lgkmcnt(5)
v_mfma_f32_16x16x32_bf16 v[136:139], v[152:155], a[184:187], v[136:139]
ds_read_b128 v[148:151], v8 offset:41984
v_mfma_f32_16x16x32_bf16 v[140:143], v[152:155], a[188:191], v[140:143]
v_mfma_f32_16x16x32_bf16 v[128:131], v[156:159], a[192:195], v[128:131]
ds_read_b128 v[152:155], v8 offset:43008
v_mfma_f32_16x16x32_bf16 v[132:135], v[156:159], a[196:199], v[132:135]
s_waitcnt lgkmcnt(5)
v_mfma_f32_16x16x32_bf16 v[136:139], v[160:163], a[192:195], v[136:139]
ds_read_b128 v[156:159], v8 offset:44032
v_mfma_f32_16x16x32_bf16 v[140:143], v[160:163], a[196:199], v[140:143]
v_mfma_f32_16x16x32_bf16 v[128:131], v[164:167], a[200:203], v[128:131]
ds_read_b128 v[160:163], v8 offset:45056
v_mfma_f32_16x16x32_bf16 v[132:135], v[164:167], a[204:207], v[132:135]
s_waitcnt lgkmcnt(5)
v_mfma_f32_16x16x32_bf16 v[136:139], v[168:171], a[200:203], v[136:139]
ds_read_b128 v[164:167], v8 offset:46080
v_mfma_f32_16x16x32_bf16 v[140:143], v[168:171], a[204:207], v[140:143]
v_mfma_f32_16x16x32_bf16 v[128:131], v[172:175], a[208:211], v[128:131]
ds_read_b128 v[168:171], v8 offset:47104
v_mfma_f32_16x16x32_bf16 v[132:135], v[172:175], a[212:215], v[132:135]
s_waitcnt lgkmcnt(5)
v_mfma_f32_16x16x32_bf16 v[136:139], v[144:147], a[208:211], v[136:139]
s_waitcnt vmcnt(8)
ds_read_b128 v[172:175], v8 offset:48128
v_mfma_f32_16x16x32_bf16 v[140:143], v[144:147], a[212:215], v[140:143]
s_barrier
v_mfma_f32_16x16x32_bf16 v[128:131], v[148:151], a[216:219], v[128:131]
ds_read_b128 v[144:147], v8 offset:49152
v_mfma_f32_16x16x32_bf16 v[132:135], v[148:151], a[220:223], v[132:135]
s_waitcnt lgkmcnt(5)
v_mfma_f32_16x16x32_bf16 v[136:139], v[152:155], a[216:219], v[136:139]
s_waitcnt vmcnt(0)
ds_read_b128 v[148:151], v8 offset:50176
v_lshlrev_b32 v212, 16, v176
v_mfma_f32_16x16x32_bf16 v[140:143], v[152:155], a[220:223], v[140:143]
v_and_b32 v213, 0xffff0000, v176
v_lshlrev_b32 v214, 16, v177
v_mfma_f32_16x16x32_bf16 v[128:131], v[156:159], a[224:227], v[128:131]
ds_read_b128 v[152:155], v8 offset:51200
v_and_b32 v215, 0xffff0000, v177
v_mfma_f32_16x16x32_bf16 v[132:135], v[156:159], a[228:231], v[132:135]
s_waitcnt lgkmcnt(5)
v_lshlrev_b32 v220, 16, v178
v_and_b32 v221, 0xffff0000, v178
v_mfma_f32_16x16x32_bf16 v[136:139], v[160:163], a[224:227], v[136:139]
ds_read_b128 v[156:159], v8 offset:52224
v_lshlrev_b32 v222, 16, v179
v_mfma_f32_16x16x32_bf16 v[140:143], v[160:163], a[228:231], v[140:143]
v_and_b32 v223, 0xffff0000, v179
v_lshlrev_b32 v216, 16, v180
v_mfma_f32_16x16x32_bf16 v[128:131], v[164:167], a[232:235], v[128:131]
ds_read_b128 v[160:163], v8 offset:53248
v_and_b32 v217, 0xffff0000, v180
v_mfma_f32_16x16x32_bf16 v[132:135], v[164:167], a[236:239], v[132:135]
s_waitcnt lgkmcnt(5)
v_lshlrev_b32 v218, 16, v181
v_and_b32 v219, 0xffff0000, v181
v_mfma_f32_16x16x32_bf16 v[136:139], v[168:171], a[232:235], v[136:139]
ds_read_b128 v[164:167], v8 offset:54272
v_lshlrev_b32 v224, 16, v182
v_mfma_f32_16x16x32_bf16 v[140:143], v[168:171], a[236:239], v[140:143]
v_and_b32 v225, 0xffff0000, v182
v_lshlrev_b32 v226, 16, v183
v_mfma_f32_16x16x32_bf16 v[128:131], v[172:175], a[240:243], v[128:131]
ds_read_b128 v[168:171], v8 offset:55296
v_and_b32 v227, 0xffff0000, v183
v_mfma_f32_16x16x32_bf16 v[132:135], v[172:175], a[244:247], v[132:135]
s_waitcnt lgkmcnt(5)
v_lshlrev_b32 v16, 16, v184
v_and_b32 v17, 0xffff0000, v184
v_mfma_f32_16x16x32_bf16 v[136:139], v[144:147], a[240:243], v[136:139]
ds_read_b128 v[172:175], v8 offset:56320
v_add_f32 v212, v212, v16
v_mfma_f32_16x16x32_bf16 v[140:143], v[144:147], a[244:247], v[140:143]
v_add_f32 v213, v213, v17
v_lshlrev_b32 v18, 16, v185
v_mfma_f32_16x16x32_bf16 v[128:131], v[148:151], a[248:251], v[128:131]
buffer_load_dword v12, v10, s[24:27], s73 offen offset:16 sc1
v_mfma_f32_16x16x32_bf16 v[132:135], v[148:151], a[252:255], v[132:135]
s_waitcnt lgkmcnt(4)
ds_read_b128 v[144:147], v8 offset:57344
v_and_b32 v19, 0xffff0000, v185
v_mfma_f32_16x16x32_bf16 v[136:139], v[152:155], a[248:251], v[136:139]
ds_read_b128 v[148:151], v8 offset:58368
v_add_f32 v214, v214, v18
v_mfma_f32_16x16x32_bf16 v[140:143], v[152:155], a[252:255], v[140:143]
v_add_f32 v215, v215, v19
v_lshlrev_b32 v20, 16, v186
v_mfma_f32_16x16x32_bf16 v[128:131], v[156:159], v[32:35], v[128:131]
ds_read_b128 v[152:155], v8 offset:59392
v_and_b32 v21, 0xffff0000, v186
v_mfma_f32_16x16x32_bf16 v[132:135], v[156:159], v[36:39], v[132:135]
s_waitcnt lgkmcnt(5)
v_add_f32 v220, v220, v20
v_add_f32 v221, v221, v21
v_mfma_f32_16x16x32_bf16 v[136:139], v[160:163], v[32:35], v[136:139]
ds_read_b128 v[156:159], v8 offset:60416
v_lshlrev_b32 v22, 16, v187
v_mfma_f32_16x16x32_bf16 v[140:143], v[160:163], v[36:39], v[140:143]
v_and_b32 v23, 0xffff0000, v187
v_add_f32 v222, v222, v22
v_mfma_f32_16x16x32_bf16 v[128:131], v[164:167], v[40:43], v[128:131]
ds_read_b128 v[160:163], v8 offset:61440
v_add_f32 v223, v223, v23
v_mfma_f32_16x16x32_bf16 v[132:135], v[164:167], v[44:47], v[132:135]
s_waitcnt lgkmcnt(5)
v_lshlrev_b32 v16, 16, v188
v_and_b32 v17, 0xffff0000, v188
v_mfma_f32_16x16x32_bf16 v[136:139], v[168:171], v[40:43], v[136:139]
v_add_f32 v216, v216, v16
v_add_f32 v217, v217, v17
v_mfma_f32_16x16x32_bf16 v[140:143], v[168:171], v[44:47], v[140:143]
v_lshlrev_b32 v18, 16, v189
v_and_b32 v19, 0xffff0000, v189
v_mfma_f32_16x16x32_bf16 v[128:131], v[172:175], v[48:51], v[128:131]
v_add_f32 v218, v218, v18
v_add_f32 v219, v219, v19
v_mfma_f32_16x16x32_bf16 v[132:135], v[172:175], v[52:55], v[132:135]
s_waitcnt lgkmcnt(3)
v_lshlrev_b32 v20, 16, v190
v_and_b32 v21, 0xffff0000, v190
v_mfma_f32_16x16x32_bf16 v[136:139], v[144:147], v[48:51], v[136:139]
v_add_f32 v224, v224, v20
v_add_f32 v225, v225, v21
v_mfma_f32_16x16x32_bf16 v[140:143], v[144:147], v[52:55], v[140:143]
v_lshlrev_b32 v22, 16, v191
v_and_b32 v23, 0xffff0000, v191
v_mfma_f32_16x16x32_bf16 v[128:131], v[148:151], v[56:59], v[128:131]
v_add_f32 v226, v226, v22
v_add_f32 v227, v227, v23
v_mfma_f32_16x16x32_bf16 v[132:135], v[148:151], v[60:63], v[132:135]
s_waitcnt lgkmcnt(1)
v_lshlrev_b32 v16, 16, v192
v_and_b32 v17, 0xffff0000, v192
v_mfma_f32_16x16x32_bf16 v[136:139], v[152:155], v[56:59], v[136:139]
v_add_f32 v104, v104, v16
v_add_f32 v105, v105, v17
v_mfma_f32_16x16x32_bf16 v[140:143], v[152:155], v[60:63], v[140:143]
v_lshlrev_b32 v18, 16, v193
v_and_b32 v19, 0xffff0000, v193
v_mfma_f32_16x16x32_bf16 v[128:131], v[156:159], v[64:67], v[128:131]
v_add_f32 v106, v106, v18
v_add_f32 v107, v107, v19
v_mfma_f32_16x16x32_bf16 v[132:135], v[156:159], v[68:71], v[132:135]
s_waitcnt lgkmcnt(0)
v_lshlrev_b32 v20, 16, v194
v_and_b32 v21, 0xffff0000, v194
v_mfma_f32_16x16x32_bf16 v[136:139], v[160:163], v[64:67], v[136:139]
v_add_f32 v108, v108, v20
v_add_f32 v109, v109, v21
v_mfma_f32_16x16x32_bf16 v[140:143], v[160:163], v[68:71], v[140:143]
v_lshlrev_b32 v22, 16, v195
v_and_b32 v23, 0xffff0000, v195
s_waitcnt vmcnt(0)
v_cmp_gt_u32 vcc, 4, v12
s_nop 4
s_cbranch_vccnz CK_P2
CK_P2_R:
buffer_load_dwordx4 v[204:207], v4, s[24:27], s53 offen offset:0 sc1
buffer_load_dwordx4 v[208:211], v4, s[24:27], s53 offen offset:1024 sc1
v_add_f32 v110, v110, v22
v_add_f32 v111, v111, v23
v_lshlrev_b32 v16, 16, v196
v_and_b32 v17, 0xffff0000, v196
v_add_f32 v104, v104, v16
v_add_f32 v105, v105, v17
v_lshlrev_b32 v18, 16, v197
v_and_b32 v19, 0xffff0000, v197
v_add_f32 v106, v106, v18
v_add_f32 v107, v107, v19
v_lshlrev_b32 v20, 16, v198
v_and_b32 v21, 0xffff0000, v198
v_add_f32 v108, v108, v20
v_add_f32 v109, v109, v21
v_lshlrev_b32 v22, 16, v199
v_and_b32 v23, 0xffff0000, v199
v_add_f32 v110, v110, v22
v_add_f32 v111, v111, v23
v_lshlrev_b32 v16, 16, v200
v_and_b32 v17, 0xffff0000, v200
v_add_f32 v104, v104, v16
v_add_f32 v105, v105, v17
v_lshlrev_b32 v18, 16, v201
v_and_b32 v19, 0xffff0000, v201
v_add_f32 v106, v106, v18
v_add_f32 v107, v107, v19
v_lshlrev_b32 v20, 16, v202
v_and_b32 v21, 0xffff0000, v202
v_add_f32 v108, v108, v20
v_add_f32 v109, v109, v21
v_lshlrev_b32 v22, 16, v203
v_and_b32 v23, 0xffff0000, v203
v_add_f32 v110, v110, v22
v_add_f32 v111, v111, v23
s_mul_i32 s52, s72, 36864
s_mul_i32 s53, s86, 288
s_add_u32 s52, s52, s53
s_add_u32 s54, s52, 256
s_cmp_eq_u32 s3, s84
s_cselect_b32 s54, s54, 2147418112
s_add_u32 s55, s54, 18432
s_lshl_b32 s53, s84, 6
s_add_u32 s52, s52, s53
s_add_u32 s53, s52, 18432
v_mul_u32_u24 v5, 1152, v2
v_lshl_add_u32 v6, v3, 3, v5
v_and_b32 v7, 1, v3
v_lshl_add_u32 v5, v7, 5, v5
v_lshrrev_b32 v7, 1, v3
v_lshl_add_u32 v5, v7, 4, v5
v_cvt_pk_bf16_f32 v228, v104, v105
v_cvt_pk_bf16_f32 v229, v106, v107
v_cvt_pk_bf16_f32 v230, v108, v109
v_cvt_pk_bf16_f32 v231, v110, v111
buffer_store_dwordx2 v[228:229], v6, s[44:47], s54 offen
buffer_store_dwordx2 v[230:231], v6, s[44:47], s55 offen
v_pk_add_f32 v[212:213], v[212:213], v[128:129]
v_pk_add_f32 v[214:215], v[214:215], v[130:131]
v_pk_add_f32 v[216:217], v[216:217], v[132:133]
v_pk_add_f32 v[218:219], v[218:219], v[134:135]
v_pk_add_f32 v[220:221], v[220:221], v[136:137]
v_pk_add_f32 v[222:223], v[222:223], v[138:139]
v_pk_add_f32 v[224:225], v[224:225], v[140:141]
v_pk_add_f32 v[226:227], v[226:227], v[142:143]
s_waitcnt vmcnt(2)
v_lshlrev_b32 v16, 16, v204
v_and_b32 v17, 0xffff0000, v204
v_add_f32 v212, v212, v16
v_add_f32 v213, v213, v17
v_lshlrev_b32 v18, 16, v205
v_and_b32 v19, 0xffff0000, v205
v_add_f32 v214, v214, v18
v_add_f32 v215, v215, v19
v_lshlrev_b32 v20, 16, v206
v_and_b32 v21, 0xffff0000, v206
v_add_f32 v220, v220, v20
v_add_f32 v221, v221, v21
v_lshlrev_b32 v22, 16, v207
v_and_b32 v23, 0xffff0000, v207
v_add_f32 v222, v222, v22
v_add_f32 v223, v223, v23
v_cvt_pk_bf16_f32 v212, v212, v213
v_cvt_pk_bf16_f32 v213, v214, v215
v_cvt_pk_bf16_f32 v214, v220, v221
v_cvt_pk_bf16_f32 v215, v222, v223
s_nop 1
v_permlane16_swap_b32 v212, v214
v_permlane16_swap_b32 v213, v215
buffer_store_dwordx4 v[212:215], v5, s[44:47], s52 offen
v_lshlrev_b32 v16, 16, v208
v_and_b32 v17, 0xffff0000, v208
v_add_f32 v216, v216, v16
v_add_f32 v217, v217, v17
v_lshlrev_b32 v18, 16, v209
v_and_b32 v19, 0xffff0000, v209
v_add_f32 v218, v218, v18
v_add_f32 v219, v219, v19
v_lshlrev_b32 v20, 16, v210
v_and_b32 v21, 0xffff0000, v210
v_add_f32 v224, v224, v20
v_add_f32 v225, v225, v21
v_lshlrev_b32 v22, 16, v211
v_and_b32 v23, 0xffff0000, v211
v_add_f32 v226, v226, v22
v_add_f32 v227, v227, v23
v_cvt_pk_bf16_f32 v216, v216, v217
v_cvt_pk_bf16_f32 v217, v218, v219
v_cvt_pk_bf16_f32 v218, v224, v225
v_cvt_pk_bf16_f32 v219, v226, v227
s_nop 1
v_permlane16_swap_b32 v216, v218
v_permlane16_swap_b32 v217, v219
buffer_store_dwordx4 v[216:219], v5, s[44:47], s53 offen
L_END:
s_endpgm
CK_Z:
s_mov_b32 s92, 0
CK_Z_L:
s_sleep 1
buffer_load_dword v23, v22, s[40:43], 0 offen sc1
s_add_u32 s92, s92, 1
s_waitcnt vmcnt(0)
v_cmp_gt_u32 vcc, 1, v23
s_cmp_gt_u32 s92, 0x20000
s_cbranch_scc1 CK_Z_R
s_nop 3
s_cbranch_vccnz CK_Z_L
s_branch CK_Z_R
CK_WA:
s_mov_b32 s92, 0
CK_WA_L:
s_sleep 1
buffer_load_dword v30, v29, s[24:27], s89 offen sc1
s_add_u32 s92, s92, 1
s_waitcnt vmcnt(0)
v_cmp_gt_u32 vcc, 18, v30
s_cmp_gt_u32 s92, 0x20000
s_cbranch_scc1 CK_WA_R
s_nop 3
s_cbranch_vccnz CK_WA_L
s_branch CK_WA_R
CK_ZA:
s_mov_b32 s92, 0
CK_ZA_L:
s_sleep 1
buffer_load_dword v30, v28, s[40:43], 0 offen sc1
s_add_u32 s92, s92, 1
s_waitcnt vmcnt(0)
v_cmp_gt_u32 vcc, 1, v30
s_cmp_gt_u32 s92, 0x20000
s_cbranch_scc1 CK_ZA_R
s_nop 3
s_cbranch_vccnz CK_ZA_L
s_branch CK_ZA_R
CK_KV:
s_mov_b32 s92, 0
CK_KV_L:
s_sleep 1
buffer_load_dword v30, v29, s[24:27], s89 offen offset:4 sc1
s_add_u32 s92, s92, 1
s_waitcnt vmcnt(0)
v_cmp_gt_u32 vcc, 8, v30
s_cmp_gt_u32 s92, 0x20000
s_cbranch_scc1 CK_KV_R
s_nop 3
s_cbranch_vccnz CK_KV_L
s_branch CK_KV_R
D0:
v_cndmask_b32 v216, v216, v6, s[56:57]
v_cndmask_b32 v112, v112, v6, s[56:57]
v_mov_b32 v104, v6
v_cndmask_b32 v217, v217, v6, s[58:59]
v_cndmask_b32 v113, v113, v6, s[58:59]
v_mov_b32 v105, v6
v_cndmask_b32 v218, v218, v6, s[60:61]
v_cndmask_b32 v114, v114, v6, s[60:61]
v_mov_b32 v106, v6
v_cndmask_b32 v219, v219, v6, s[62:63]
v_cndmask_b32 v115, v115, v6, s[62:63]
v_mov_b32 v107, v6
s_branch D0_R
CK_D:
s_mov_b32 s92, 0
CK_D_L:
s_sleep 1
buffer_load_dword v168, v169, s[24:27], 0 offen sc1
s_add_u32 s92, s92, 1
s_waitcnt vmcnt(0)
v_cmp_gt_u32 vcc, 8, v168
s_cmp_gt_u32 s92, 0x20000
s_cbranch_scc1 CK_D_R
s_nop 3
s_cbranch_vccnz CK_D_L
s_branch CK_D_R
CK_S:
s_mov_b32 s92, 0
CK_S_L:
s_sleep 1
buffer_load_dword v168, v169, s[24:27], 0 offen sc1
s_add_u32 s92, s92, 1
s_waitcnt vmcnt(0)
v_cmp_gt_u32 vcc, 8, v168
s_cmp_gt_u32 s92, 0x20000
s_cbranch_scc1 CK_S_R
s_nop 3
s_cbranch_vccnz CK_S_L
s_branch CK_S_R
CK_ZB:
s_mov_b32 s92, 0
CK_ZB_L:
s_sleep 1
buffer_load_dword v12, v10, s[24:27], s75 offen sc1
s_add_u32 s92, s92, 1
s_waitcnt vmcnt(0)
v_cmp_gt_u32 vcc, 8, v12
s_cmp_gt_u32 s92, 0x20000
s_cbranch_scc1 CK_ZB_R
s_nop 3
s_cbranch_vccnz CK_ZB_L
s_branch CK_ZB_R
CK_ZAA:
s_mov_b32 s92, 0
CK_ZAA_L:
s_sleep 1
buffer_load_dword v12, v10, s[24:27], s75 offen offset:4 sc1
s_add_u32 s92, s92, 1
s_waitcnt vmcnt(0)
v_cmp_gt_u32 vcc, 8, v12
s_cmp_gt_u32 s92, 0x20000
s_cbranch_scc1 CK_ZAA_R
s_nop 3
s_cbranch_vccnz CK_ZAA_L
s_branch CK_ZAA_R
CK_P1:
s_mov_b32 s92, 0
CK_P1_L:
s_sleep 1
buffer_load_dword v12, v10, s[24:27], s73 offen sc1
s_add_u32 s92, s92, 1
s_waitcnt vmcnt(0)
v_cmp_gt_u32 vcc, 4, v12
s_cmp_gt_u32 s92, 0x20000
s_cbranch_scc1 CK_P1_R
s_nop 3
s_cbranch_vccnz CK_P1_L
s_branch CK_P1_R
CK_P2:
s_mov_b32 s92, 0
CK_P2_L:
s_sleep 1
buffer_load_dword v12, v10, s[24:27], s73 offen offset:16 sc1
s_add_u32 s92, s92, 1
s_waitcnt vmcnt(0)
v_cmp_gt_u32 vcc, 4, v12
s_cmp_gt_u32 s92, 0x20000
s_cbranch_scc1 CK_P2_R
s_nop 3
s_cbranch_vccnz CK_P2_L
s_branch CK_P2_R
SLOW0:
v_add_u32 v20, 4096, v4
s_mov_b32 s54, 0
v_mov_b32 v16, v6
v_mov_b32 v18, v6
SLOW0_P:
s_mov_b32 s53, 0
s_mul_i32 s52, s4, 1064960
SLOW0_T:
s_add_u32 s55, s52, 24576
buffer_load_dwordx4 a[192:195], v4, s[24:27], s52 offen offset:0 sc1
buffer_load_dwordx4 a[196:199], v4, s[24:27], s52 offen offset:1024 sc1
buffer_load_dwordx4 a[200:203], v4, s[24:27], s52 offen offset:2048 sc1
buffer_load_dwordx4 a[204:207], v4, s[24:27], s52 offen offset:3072 sc1
buffer_load_dwordx4 a[208:211], v20, s[24:27], s52 offen offset:0 sc1
buffer_load_dwordx4 a[212:215], v20, s[24:27], s52 offen offset:1024 sc1
buffer_load_dwordx4 a[216:219], v20, s[24:27], s52 offen offset:2048 sc1
buffer_load_dwordx4 a[220:223], v20, s[24:27], s52 offen offset:3072 sc1
buffer_load_dwordx4 a[64:67], v4, s[24:27], s55 offen offset:0 sc1
buffer_load_dwordx4 a[68:71], v4, s[24:27], s55 offen offset:1024 sc1
buffer_load_dwordx4 a[72:75], v4, s[24:27], s55 offen offset:2048 sc1
buffer_load_dwordx4 a[76:79], v4, s[24:27], s55 offen offset:3072 sc1
buffer_load_dwordx4 a[80:83], v20, s[24:27], s55 offen offset:0 sc1
buffer_load_dwordx4 a[84:87], v20, s[24:27], s55 offen offset:1024 sc1
buffer_load_dwordx4 a[88:91], v20, s[24:27], s55 offen offset:2048 sc1
buffer_load_dwordx4 a[92:95], v20, s[24:27], s55 offen offset:3072 sc1
s_waitcnt vmcnt(0)
v_mfma_f32_16x16x32_bf16 v[236:239], a[192:195], v[64:67], 0
v_mfma_f32_16x16x32_bf16 v[236:239], a[196:199], v[244:247], v[236:239]
v_mfma_f32_16x16x32_bf16 v[236:239], a[200:203], v[240:243], v[236:239]
v_mfma_f32_16x16x32_bf16 v[236:239], a[204:207], v[44:47], v[236:239]
v_mfma_f32_16x16x32_bf16 v[248:251], a[192:195], v[204:207], 0
v_mfma_f32_16x16x32_bf16 v[248:251], a[196:199], v[252:255], v[248:251]
v_mfma_f32_16x16x32_bf16 v[248:251], a[200:203], v[232:235], v[248:251]
v_mfma_f32_16x16x32_bf16 v[248:251], a[204:207], v[32:35], v[248:251]
v_mfma_f32_16x16x32_bf16 v[36:39], a[208:211], v[64:67], 0
v_mfma_f32_16x16x32_bf16 v[36:39], a[212:215], v[244:247], v[36:39]
v_mfma_f32_16x16x32_bf16 v[36:39], a[216:219], v[240:243], v[36:39]
v_mfma_f32_16x16x32_bf16 v[36:39], a[220:223], v[44:47], v[36:39]
v_mfma_f32_16x16x32_bf16 v[92:95], a[208:211], v[204:207], 0
v_mfma_f32_16x16x32_bf16 v[92:95], a[212:215], v[252:255], v[92:95]
v_mfma_f32_16x16x32_bf16 v[92:95], a[216:219], v[232:235], v[92:95]
v_mfma_f32_16x16x32_bf16 v[92:95], a[220:223], v[32:35], v[92:95]
s_nop 7
s_cmp_lg_u32 s53, s66
s_cbranch_scc1 SLOW0_U
v_cndmask_b32 v236, v236, v6, s[56:57]
v_cndmask_b32 v92, v92, v6, s[56:57]
v_mov_b32 v36, v6
v_cndmask_b32 v237, v237, v6, s[58:59]
v_cndmask_b32 v93, v93, v6, s[58:59]
v_mov_b32 v37, v6
v_cndmask_b32 v238, v238, v6, s[60:61]
v_cndmask_b32 v94, v94, v6, s[60:61]
v_mov_b32 v38, v6
v_cndmask_b32 v239, v239, v6, s[62:63]
v_cndmask_b32 v95, v95, v6, s[62:63]
v_mov_b32 v39, v6
SLOW0_U:
s_cmp_lg_u32 s54, 0
s_cbranch_scc1 SLOW0_A
v_max3_f32 v16, v16, v236, v237
v_max3_f32 v16, v16, v238, v239
v_max3_f32 v18, v18, v248, v249
v_max3_f32 v18, v18, v250, v251
v_max3_f32 v16, v16, v36, v37
v_max3_f32 v16, v16, v38, v39
v_max3_f32 v18, v18, v92, v93
v_max3_f32 v18, v18, v94, v95
s_branch SLOW0_N
SLOW0_A:
v_sub_f32 v236, v236, v16
v_sub_f32 v237, v237, v16
v_sub_f32 v238, v238, v16
v_sub_f32 v239, v239, v16
v_sub_f32 v248, v248, v18
v_sub_f32 v249, v249, v18
v_sub_f32 v250, v250, v18
v_sub_f32 v251, v251, v18
v_sub_f32 v36, v36, v16
v_sub_f32 v37, v37, v16
v_sub_f32 v38, v38, v16
v_sub_f32 v39, v39, v16
v_sub_f32 v92, v92, v18
v_sub_f32 v93, v93, v18
v_sub_f32 v94, v94, v18
v_sub_f32 v95, v95, v18
v_exp_f32 v236, v236
v_exp_f32 v237, v237
v_exp_f32 v238, v238
v_exp_f32 v239, v239
v_exp_f32 v248, v248
v_exp_f32 v249, v249
v_exp_f32 v250, v250
v_exp_f32 v251, v251
v_exp_f32 v36, v36
v_exp_f32 v37, v37
v_exp_f32 v38, v38
v_exp_f32 v39, v39
v_exp_f32 v92, v92
v_exp_f32 v93, v93
v_exp_f32 v94, v94
v_exp_f32 v95, v95
s_nop 0
v_cvt_pk_bf16_f32 v228, v236, v237
v_cvt_pk_bf16_f32 v229, v238, v239
v_cvt_pk_bf16_f32 v176, v248, v249
v_cvt_pk_bf16_f32 v177, v250, v251
v_cvt_pk_bf16_f32 v230, v36, v37
v_cvt_pk_bf16_f32 v231, v38, v39
v_cvt_pk_bf16_f32 v178, v92, v93
v_cvt_pk_bf16_f32 v179, v94, v95
s_nop 1
v_mfma_f32_16x16x32_bf16 a[0:3], a[64:67], v[228:231], a[0:3]
v_mfma_f32_16x16x32_bf16 a[32:35], a[64:67], v[176:179], a[32:35]
v_mfma_f32_16x16x32_bf16 a[4:7], a[68:71], v[228:231], a[4:7]
v_mfma_f32_16x16x32_bf16 a[36:39], a[68:71], v[176:179], a[36:39]
v_mfma_f32_16x16x32_bf16 a[8:11], a[72:75], v[228:231], a[8:11]
v_mfma_f32_16x16x32_bf16 a[40:43], a[72:75], v[176:179], a[40:43]
v_mfma_f32_16x16x32_bf16 a[12:15], a[76:79], v[228:231], a[12:15]
v_mfma_f32_16x16x32_bf16 a[44:47], a[76:79], v[176:179], a[44:47]
v_mfma_f32_16x16x32_bf16 a[16:19], a[80:83], v[228:231], a[16:19]
v_mfma_f32_16x16x32_bf16 a[48:51], a[80:83], v[176:179], a[48:51]
v_mfma_f32_16x16x32_bf16 a[20:23], a[84:87], v[228:231], a[20:23]
v_mfma_f32_16x16x32_bf16 a[52:55], a[84:87], v[176:179], a[52:55]
v_mfma_f32_16x16x32_bf16 a[24:27], a[88:91], v[228:231], a[24:27]
v_mfma_f32_16x16x32_bf16 a[56:59], a[88:91], v[176:179], a[56:59]
v_mfma_f32_16x16x32_bf16 a[28:31], a[92:95], v[228:231], a[28:31]
v_mfma_f32_16x16x32_bf16 a[60:63], a[92:95], v[176:179], a[60:63]
v_mfma_f32_16x16x32_bf16 a[224:227], a[240:243], v[228:231], a[224:227]
v_mfma_f32_16x16x32_bf16 a[228:231], a[240:243], v[176:179], a[228:231]
SLOW0_N:
s_add_u32 s52, s52, 16384
s_add_u32 s53, s53, 1
s_cmp_le_u32 s53, s66
s_cbranch_scc1 SLOW0_T
s_cmp_lg_u32 s54, 0
s_cbranch_scc1 SLOW0_E
v_mov_b32 v17, v16
v_mov_b32 v19, v18
s_nop 1
v_permlane32_swap_b32 v17, v16
v_permlane32_swap_b32 v19, v18
s_nop 1
v_max_f32 v16, v16, v17
v_max_f32 v18, v18, v19
v_mov_b32 v17, v16
v_mov_b32 v19, v18
s_nop 1
v_permlane16_swap_b32 v17, v16
v_permlane16_swap_b32 v19, v18
s_nop 1
v_max_f32 v16, v16, v17
v_max_f32 v18, v18, v19
v_accvgpr_write_b32 a0, 0
v_accvgpr_write_b32 a1, 0
v_accvgpr_write_b32 a2, 0
v_accvgpr_write_b32 a3, 0
v_accvgpr_write_b32 a4, 0
v_accvgpr_write_b32 a5, 0
v_accvgpr_write_b32 a6, 0
v_accvgpr_write_b32 a7, 0
v_accvgpr_write_b32 a8, 0
v_accvgpr_write_b32 a9, 0
v_accvgpr_write_b32 a10, 0
v_accvgpr_write_b32 a11, 0
v_accvgpr_write_b32 a12, 0
v_accvgpr_write_b32 a13, 0
v_accvgpr_write_b32 a14, 0
v_accvgpr_write_b32 a15, 0
v_accvgpr_write_b32 a16, 0
v_accvgpr_write_b32 a17, 0
v_accvgpr_write_b32 a18, 0
v_accvgpr_write_b32 a19, 0
v_accvgpr_write_b32 a20, 0
v_accvgpr_write_b32 a21, 0
v_accvgpr_write_b32 a22, 0
v_accvgpr_write_b32 a23, 0
v_accvgpr_write_b32 a24, 0
v_accvgpr_write_b32 a25, 0
v_accvgpr_write_b32 a26, 0
v_accvgpr_write_b32 a27, 0
v_accvgpr_write_b32 a28, 0
v_accvgpr_write_b32 a29, 0
v_accvgpr_write_b32 a30, 0
v_accvgpr_write_b32 a31, 0
v_accvgpr_write_b32 a32, 0
v_accvgpr_write_b32 a33, 0
v_accvgpr_write_b32 a34, 0
v_accvgpr_write_b32 a35, 0
v_accvgpr_write_b32 a36, 0
v_accvgpr_write_b32 a37, 0
v_accvgpr_write_b32 a38, 0
v_accvgpr_write_b32 a39, 0
v_accvgpr_write_b32 a40, 0
v_accvgpr_write_b32 a41, 0
v_accvgpr_write_b32 a42, 0
v_accvgpr_write_b32 a43, 0
v_accvgpr_write_b32 a44, 0
v_accvgpr_write_b32 a45, 0
v_accvgpr_write_b32 a46, 0
v_accvgpr_write_b32 a47, 0
v_accvgpr_write_b32 a48, 0
v_accvgpr_write_b32 a49, 0
v_accvgpr_write_b32 a50, 0
v_accvgpr_write_b32 a51, 0
v_accvgpr_write_b32 a52, 0
v_accvgpr_write_b32 a53, 0
v_accvgpr_write_b32 a54, 0
v_accvgpr_write_b32 a55, 0
v_accvgpr_write_b32 a56, 0
v_accvgpr_write_b32 a57, 0
v_accvgpr_write_b32 a58, 0
v_accvgpr_write_b32 a59, 0
v_accvgpr_write_b32 a60, 0
v_accvgpr_write_b32 a61, 0
v_accvgpr_write_b32 a62, 0
v_accvgpr_write_b32 a63, 0
v_accvgpr_write_b32 a224, 0
v_accvgpr_write_b32 a225, 0
v_accvgpr_write_b32 a226, 0
v_accvgpr_write_b32 a227, 0
v_accvgpr_write_b32 a228, 0
v_accvgpr_write_b32 a229, 0
v_accvgpr_write_b32 a230, 0
v_accvgpr_write_b32 a231, 0
s_mov_b32 s54, 1
s_branch SLOW0_P
SLOW0_E:
s_nop 7
v_accvgpr_read_b32 v72, a224
v_accvgpr_read_b32 v74, a228
s_branch SLOW0_R
SLOW1:
v_add_u32 v20, 4096, v4
s_mov_b32 s54, 0
v_mov_b32 v16, v6
v_mov_b32 v18, v6
SLOW1_P:
s_mov_b32 s53, 0
s_mul_i32 s52, s4, 1064960
SLOW1_T:
s_add_u32 s55, s52, 24576
buffer_load_dwordx4 a[192:195], v4, s[24:27], s52 offen offset:0 sc1
buffer_load_dwordx4 a[196:199], v4, s[24:27], s52 offen offset:1024 sc1
buffer_load_dwordx4 a[200:203], v4, s[24:27], s52 offen offset:2048 sc1
buffer_load_dwordx4 a[204:207], v4, s[24:27], s52 offen offset:3072 sc1
buffer_load_dwordx4 a[208:211], v20, s[24:27], s52 offen offset:0 sc1
buffer_load_dwordx4 a[212:215], v20, s[24:27], s52 offen offset:1024 sc1
buffer_load_dwordx4 a[216:219], v20, s[24:27], s52 offen offset:2048 sc1
buffer_load_dwordx4 a[220:223], v20, s[24:27], s52 offen offset:3072 sc1
buffer_load_dwordx4 a[64:67], v4, s[24:27], s55 offen offset:0 sc1
buffer_load_dwordx4 a[68:71], v4, s[24:27], s55 offen offset:1024 sc1
buffer_load_dwordx4 a[72:75], v4, s[24:27], s55 offen offset:2048 sc1
buffer_load_dwordx4 a[76:79], v4, s[24:27], s55 offen offset:3072 sc1
buffer_load_dwordx4 a[80:83], v20, s[24:27], s55 offen offset:0 sc1
buffer_load_dwordx4 a[84:87], v20, s[24:27], s55 offen offset:1024 sc1
buffer_load_dwordx4 a[88:91], v20, s[24:27], s55 offen offset:2048 sc1
buffer_load_dwordx4 a[92:95], v20, s[24:27], s55 offen offset:3072 sc1
s_waitcnt vmcnt(0)
v_mfma_f32_16x16x32_bf16 v[236:239], a[192:195], v[212:215], 0
v_mfma_f32_16x16x32_bf16 v[236:239], a[196:199], v[88:91], v[236:239]
v_mfma_f32_16x16x32_bf16 v[236:239], a[200:203], v[224:227], v[236:239]
v_mfma_f32_16x16x32_bf16 v[236:239], a[204:207], v[52:55], v[236:239]
v_mfma_f32_16x16x32_bf16 v[248:251], a[192:195], v[220:223], 0
v_mfma_f32_16x16x32_bf16 v[248:251], a[196:199], v[160:163], v[248:251]
v_mfma_f32_16x16x32_bf16 v[248:251], a[200:203], v[192:195], v[248:251]
v_mfma_f32_16x16x32_bf16 v[248:251], a[204:207], v[60:63], v[248:251]
v_mfma_f32_16x16x32_bf16 v[36:39], a[208:211], v[212:215], 0
v_mfma_f32_16x16x32_bf16 v[36:39], a[212:215], v[88:91], v[36:39]
v_mfma_f32_16x16x32_bf16 v[36:39], a[216:219], v[224:227], v[36:39]
v_mfma_f32_16x16x32_bf16 v[36:39], a[220:223], v[52:55], v[36:39]
v_mfma_f32_16x16x32_bf16 v[92:95], a[208:211], v[220:223], 0
v_mfma_f32_16x16x32_bf16 v[92:95], a[212:215], v[160:163], v[92:95]
v_mfma_f32_16x16x32_bf16 v[92:95], a[216:219], v[192:195], v[92:95]
v_mfma_f32_16x16x32_bf16 v[92:95], a[220:223], v[60:63], v[92:95]
s_nop 7
s_cmp_lg_u32 s53, s67
s_cbranch_scc1 SLOW1_U
v_cndmask_b32 v236, v236, v6, s[56:57]
v_cndmask_b32 v92, v92, v6, s[56:57]
v_mov_b32 v36, v6
v_cndmask_b32 v237, v237, v6, s[58:59]
v_cndmask_b32 v93, v93, v6, s[58:59]
v_mov_b32 v37, v6
v_cndmask_b32 v238, v238, v6, s[60:61]
v_cndmask_b32 v94, v94, v6, s[60:61]
v_mov_b32 v38, v6
v_cndmask_b32 v239, v239, v6, s[62:63]
v_cndmask_b32 v95, v95, v6, s[62:63]
v_mov_b32 v39, v6
SLOW1_U:
s_cmp_lg_u32 s54, 0
s_cbranch_scc1 SLOW1_A
v_max3_f32 v16, v16, v236, v237
v_max3_f32 v16, v16, v238, v239
v_max3_f32 v18, v18, v248, v249
v_max3_f32 v18, v18, v250, v251
v_max3_f32 v16, v16, v36, v37
v_max3_f32 v16, v16, v38, v39
v_max3_f32 v18, v18, v92, v93
v_max3_f32 v18, v18, v94, v95
s_branch SLOW1_N
SLOW1_A:
v_sub_f32 v236, v236, v16
v_sub_f32 v237, v237, v16
v_sub_f32 v238, v238, v16
v_sub_f32 v239, v239, v16
v_sub_f32 v248, v248, v18
v_sub_f32 v249, v249, v18
v_sub_f32 v250, v250, v18
v_sub_f32 v251, v251, v18
v_sub_f32 v36, v36, v16
v_sub_f32 v37, v37, v16
v_sub_f32 v38, v38, v16
v_sub_f32 v39, v39, v16
v_sub_f32 v92, v92, v18
v_sub_f32 v93, v93, v18
v_sub_f32 v94, v94, v18
v_sub_f32 v95, v95, v18
v_exp_f32 v236, v236
v_exp_f32 v237, v237
v_exp_f32 v238, v238
v_exp_f32 v239, v239
v_exp_f32 v248, v248
v_exp_f32 v249, v249
v_exp_f32 v250, v250
v_exp_f32 v251, v251
v_exp_f32 v36, v36
v_exp_f32 v37, v37
v_exp_f32 v38, v38
v_exp_f32 v39, v39
v_exp_f32 v92, v92
v_exp_f32 v93, v93
v_exp_f32 v94, v94
v_exp_f32 v95, v95
s_nop 0
v_cvt_pk_bf16_f32 v228, v236, v237
v_cvt_pk_bf16_f32 v229, v238, v239
v_cvt_pk_bf16_f32 v176, v248, v249
v_cvt_pk_bf16_f32 v177, v250, v251
v_cvt_pk_bf16_f32 v230, v36, v37
v_cvt_pk_bf16_f32 v231, v38, v39
v_cvt_pk_bf16_f32 v178, v92, v93
v_cvt_pk_bf16_f32 v179, v94, v95
s_nop 1
v_mfma_f32_16x16x32_bf16 v[100:103], a[64:67], v[228:231], v[100:103]
v_mfma_f32_16x16x32_bf16 v[116:119], a[64:67], v[176:179], v[116:119]
v_mfma_f32_16x16x32_bf16 v[148:151], a[68:71], v[228:231], v[148:151]
v_mfma_f32_16x16x32_bf16 v[132:135], a[68:71], v[176:179], v[132:135]
v_mfma_f32_16x16x32_bf16 v[156:159], a[72:75], v[228:231], v[156:159]
v_mfma_f32_16x16x32_bf16 v[164:167], a[72:75], v[176:179], v[164:167]
v_mfma_f32_16x16x32_bf16 v[196:199], a[76:79], v[228:231], v[196:199]
v_mfma_f32_16x16x32_bf16 v[188:191], a[76:79], v[176:179], v[188:191]
v_mfma_f32_16x16x32_bf16 v[108:111], a[80:83], v[228:231], v[108:111]
v_mfma_f32_16x16x32_bf16 v[40:43], a[80:83], v[176:179], v[40:43]
v_mfma_f32_16x16x32_bf16 v[140:143], a[84:87], v[228:231], v[140:143]
v_mfma_f32_16x16x32_bf16 v[124:127], a[84:87], v[176:179], v[124:127]
v_mfma_f32_16x16x32_bf16 v[48:51], a[88:91], v[228:231], v[48:51]
v_mfma_f32_16x16x32_bf16 v[172:175], a[88:91], v[176:179], v[172:175]
v_mfma_f32_16x16x32_bf16 v[56:59], a[92:95], v[228:231], v[56:59]
v_mfma_f32_16x16x32_bf16 v[180:183], a[92:95], v[176:179], v[180:183]
v_mfma_f32_16x16x32_bf16 a[232:235], a[240:243], v[228:231], a[232:235]
v_mfma_f32_16x16x32_bf16 a[236:239], a[240:243], v[176:179], a[236:239]
SLOW1_N:
s_add_u32 s52, s52, 16384
s_add_u32 s53, s53, 1
s_cmp_le_u32 s53, s67
s_cbranch_scc1 SLOW1_T
s_cmp_lg_u32 s54, 0
s_cbranch_scc1 SLOW1_E
v_mov_b32 v17, v16
v_mov_b32 v19, v18
s_nop 1
v_permlane32_swap_b32 v17, v16
v_permlane32_swap_b32 v19, v18
s_nop 1
v_max_f32 v16, v16, v17
v_max_f32 v18, v18, v19
v_mov_b32 v17, v16
v_mov_b32 v19, v18
s_nop 1
v_permlane16_swap_b32 v17, v16
v_permlane16_swap_b32 v19, v18
s_nop 1
v_max_f32 v16, v16, v17
v_max_f32 v18, v18, v19
v_mov_b32 v100, 0
v_mov_b32 v101, 0
v_mov_b32 v102, 0
v_mov_b32 v103, 0
v_mov_b32 v148, 0
v_mov_b32 v149, 0
v_mov_b32 v150, 0
v_mov_b32 v151, 0
v_mov_b32 v156, 0
v_mov_b32 v157, 0
v_mov_b32 v158, 0
v_mov_b32 v159, 0
v_mov_b32 v196, 0
v_mov_b32 v197, 0
v_mov_b32 v198, 0
v_mov_b32 v199, 0
v_mov_b32 v108, 0
v_mov_b32 v109, 0
v_mov_b32 v110, 0
v_mov_b32 v111, 0
v_mov_b32 v140, 0
v_mov_b32 v141, 0
v_mov_b32 v142, 0
v_mov_b32 v143, 0
v_mov_b32 v48, 0
v_mov_b32 v49, 0
v_mov_b32 v50, 0
v_mov_b32 v51, 0
v_mov_b32 v56, 0
v_mov_b32 v57, 0
v_mov_b32 v58, 0
v_mov_b32 v59, 0
v_mov_b32 v116, 0
v_mov_b32 v117, 0
v_mov_b32 v118, 0
v_mov_b32 v119, 0
v_mov_b32 v132, 0
v_mov_b32 v133, 0
v_mov_b32 v134, 0
v_mov_b32 v135, 0
v_mov_b32 v164, 0
v_mov_b32 v165, 0
v_mov_b32 v166, 0
v_mov_b32 v167, 0
v_mov_b32 v188, 0
v_mov_b32 v189, 0
v_mov_b32 v190, 0
v_mov_b32 v191, 0
v_mov_b32 v40, 0
v_mov_b32 v41, 0
v_mov_b32 v42, 0
v_mov_b32 v43, 0
v_mov_b32 v124, 0
v_mov_b32 v125, 0
v_mov_b32 v126, 0
v_mov_b32 v127, 0
v_mov_b32 v172, 0
v_mov_b32 v173, 0
v_mov_b32 v174, 0
v_mov_b32 v175, 0
v_mov_b32 v180, 0
v_mov_b32 v181, 0
v_mov_b32 v182, 0
v_mov_b32 v183, 0
v_accvgpr_write_b32 a232, 0
v_accvgpr_write_b32 a233, 0
v_accvgpr_write_b32 a234, 0
v_accvgpr_write_b32 a235, 0
v_accvgpr_write_b32 a236, 0
v_accvgpr_write_b32 a237, 0
v_accvgpr_write_b32 a238, 0
v_accvgpr_write_b32 a239, 0
s_mov_b32 s54, 1
s_branch SLOW1_P
SLOW1_E:
s_nop 7
v_accvgpr_read_b32 v72, a232
v_accvgpr_read_b32 v74, a236
s_branch SLOW1_R
.section .rodata,"a"
.p2align 6
.amdhsa_kernel gated_mix__sliding_local_dilated__compressed_kv_cla__prompt_kernel
  .amdhsa_next_free_vgpr 512
  .amdhsa_next_free_sgpr 102
  .amdhsa_accum_offset 256
  .amdhsa_group_segment_fixed_size 0
  .amdhsa_kernarg_size 104
  .amdhsa_user_sgpr_count 2
  .amdhsa_user_sgpr_kernarg_segment_ptr 1
  .amdhsa_system_sgpr_workgroup_id_x 1
.end_amdhsa_kernel
```

```asm
; @launch grid=(256,1,1) block=(256,1,1) lds=163840
.amdgcn_target "amdgcn-amd-amdhsa--gfx950"
.text

.globl gated_mix__sliding_local_dilated__compressed_kv_cla__prompt_kernel
.p2align 8
.type gated_mix__sliding_local_dilated__compressed_kv_cla__prompt_kernel,@function
gated_mix__sliding_local_dilated__compressed_kv_cla__prompt_kernel:
s_cmp_ge_u32 s2, 256
s_cbranch_scc1 L_END
s_load_dwordx2 s[8:9], s[0:1], 32
s_load_dwordx2 s[16:17], s[0:1], 48
s_load_dwordx2 s[52:53], s[0:1], 56
s_load_dwordx2 s[24:25], s[0:1], 96
s_load_dwordx2 s[12:13], s[0:1], 0
s_load_dwordx2 s[20:21], s[0:1], 40
s_load_dwordx2 s[28:29], s[0:1], 8
s_load_dwordx2 s[48:49], s[0:1], 16
s_load_dwordx2 s[32:33], s[0:1], 64
s_load_dwordx2 s[36:37], s[0:1], 72
s_load_dwordx2 s[40:41], s[0:1], 88
s_load_dwordx2 s[44:45], s[0:1], 80
s_getpc_b64 s[96:97]
s_lshr_b32 s6, s2, 3
s_lshl_b32 s98, s6, 11
s_add_u32 s96, s96, s98
s_addc_u32 s97, s97, 0
v_lshlrev_b32 v16, 3, v0
v_mov_b32 v17, s97
v_add_co_u32 v16, vcc, s96, v16
v_lshrrev_b32 v5, 6, v0
v_and_b32 v1, 63, v0
v_addc_co_u32 v17, vcc, 0, v17, vcc
v_readfirstlane_b32 s3, v5
global_load_dwordx2 a[252:253], v[16:17], off
v_and_b32 v2, 15, v0
v_lshrrev_b32 v3, 4, v1
v_lshlrev_b32 v4, 4, v1
s_and_b32 s7, s2, 7
s_and_b32 s65, s6, 3
s_lshl2_add_u32 s4, s7, s65
s_lshr_b32 s5, s6, 2
s_lshl2_add_u32 s66, s5, s3
s_sub_u32 s67, 63, s66
v_lshrrev_b32 v16, 3, v1
v_and_b32 v17, 7, v1
v_xor_b32 v18, v17, v3
v_lshlrev_b32 v19, 10, v16
v_lshl_add_u32 v5, v18, 4, v19
v_xor_b32 v18, 4, v18
v_lshl_add_u32 v6, v18, 4, v19
v_add_u32 v6, 7168, v6
v_and_b32 v18, 1, v3
v_lshlrev_b32 v18, 1, v18
v_xor_b32 v18, v17, v18
v_lshlrev_b32 v19, 13, v16
v_lshl_add_u32 v7, v18, 4, v19
v_xor_b32 v18, 4, v18
v_lshl_add_u32 v8, v18, 4, v19
v_add_u32 v8, 64512, v8
s_add_u32 s69, s65, s5
s_and_b32 s69, s69, 1
s_mul_i32 s64, s7, 2
s_and_b32 s64, s64, 7
s_or_b32 s69, s69, s64
s_add_u32 s93, s65, s5
s_and_b32 s93, s93, 1
s_mul_i32 s64, s7, 2
s_and_b32 s64, s64, 7
s_or_b32 s93, s93, s64
s_lshl_b32 s70, s69, 7
s_lshl_b32 s75, s69, 19
s_lshr_b32 s54, s3, 1
s_and_b32 s55, s3, 1
s_lshl3_add_u32 s87, s54, s5
s_lshl_b32 s64, s55, 5
s_add_u32 s68, s87, s64
s_lshl_b32 s68, s68, 15
s_lshl_b32 s73, s3, 13
s_add_u32 s73, s73, 65536
s_lshl1_add_u32 s74, s4, s55
s_lshl_b32 s74, s74, 7
s_lshl_b32 s77, s3, 12
s_add_u32 s71, s68, s70
s_add_u32 s76, s74, s75
s_mov_b32 s10, 2097152
s_mov_b32 s11, 0x20000
s_mov_b32 s18, 4194304
s_mov_b32 s19, 0x20000
s_cmp_lt_u32 s3, 2
s_waitcnt lgkmcnt(0)
s_cselect_b32 s16, s16, s52
s_cselect_b32 s17, s17, s53
s_add_u32 m0, s73, 0
s_add_u32 s64, s71, 0
buffer_load_dwordx4 v5, s[8:11], s64 offen lds
buffer_load_dwordx4 v6, s[8:11], s64 offen offset:1024 lds
s_add_u32 m0, s73, 2048
s_add_u32 s64, s71, 16384
buffer_load_dwordx4 v5, s[8:11], s64 offen lds
buffer_load_dwordx4 v6, s[8:11], s64 offen offset:1024 lds
s_add_u32 m0, s77, 0
s_add_u32 s64, s76, 0
buffer_load_dwordx4 v7, s[16:19], s64 offen lds
buffer_load_dwordx4 v8, s[16:19], s64 offen offset:1024 lds
s_add_u32 m0, s77, 2048
s_add_u32 s64, s76, 131072
buffer_load_dwordx4 v7, s[16:19], s64 offen lds
buffer_load_dwordx4 v8, s[16:19], s64 offen offset:1024 lds
s_add_u32 m0, s73, 4096
s_add_u32 s64, s71, 524288
buffer_load_dwordx4 v5, s[8:11], s64 offen lds
buffer_load_dwordx4 v6, s[8:11], s64 offen offset:1024 lds
s_add_u32 m0, s73, 6144
s_add_u32 s64, s71, 540672
buffer_load_dwordx4 v5, s[8:11], s64 offen lds
buffer_load_dwordx4 v6, s[8:11], s64 offen offset:1024 lds
s_mov_b32 s26, 268435456
s_mov_b32 s27, 0x20000
s_mov_b32 s14, 2359296
s_mov_b32 s15, 0x20000
s_mov_b32 s22, 4718592
s_mov_b32 s23, 0x20000
s_mov_b32 s30, 1990656
s_mov_b32 s31, 0x20000
s_mov_b32 s34, 4718592
s_mov_b32 s35, 0x20000
s_mov_b32 s38, 1152
s_mov_b32 s39, 0x20000
s_mov_b32 s42, 256
s_mov_b32 s43, 0x20000
s_mov_b32 s46, 2359296
s_mov_b32 s47, 0x20000
s_mov_b32 s50, 663552
s_mov_b32 s51, 0x20000
s_lshl_b32 s89, s4, 10
s_add_u32 s89, s89, 167772160
s_lshr_b32 s94, s4, 4
s_xor_b32 s94, s94, 0
s_lshl_b32 s94, s94, 13
s_and_b32 s95, s4, 15
s_lshl_b32 s95, s95, 22
s_add_u32 s95, s95, s94
s_cmp_eq_u32 s66, 0
s_cselect_b32 s52, s89, 2147418112
s_lshl_b32 s53, s5, 10
s_add_u32 s53, s53, s95
s_add_u32 s53, s53, 3145728
s_cmp_eq_u32 s3, 1
s_cselect_b32 s52, s53, s52
s_bfe_u32 s53, s2, 65537
s_xor_b32 s53, s53, 0
s_lshl3_add_u32 s53, s53, s55
s_lshl_b32 s53, s53, 10
s_and_b32 s64, s2, 1
s_mul_i32 s64, s64, 270336
s_add_u32 s53, s53, s64
s_add_u32 s53, s53, 67330048
s_lshr_b32 s79, s2, 2
s_lshr_b32 s64, s79, 2
s_lshl_b32 s64, s64, 22
s_add_u32 s64, s64, s53
s_and_b32 s65, s79, 3
s_mul_i32 s65, s65, 540672
s_add_u32 s64, s64, s65
s_cmp_ge_u32 s3, 2
s_cselect_b32 s52, s64, s52
v_mov_b32 v16, 0
v_mov_b32 v17, 0
v_mov_b32 v18, 0
v_mov_b32 v19, 0
buffer_store_dwordx4 v[16:19], v4, s[24:27], s52 offen sc1
s_add_u32 s89, s89, 512
s_cmp_eq_u32 s3, 0
s_cselect_b32 s90, s89, 2147418112
v_mov_b32 v24, 2147418112
v_cmp_eq_u32 vcc, 1, v1
s_lshl_b32 s52, s54, 7
s_lshl_b32 s53, s55, 12
v_cndmask_b32 v0, v24, 0, vcc
v_lshrrev_b32 v16, 1, v2
v_xor_b32 v16, v16, v3
v_add_u32 v17, s52, v2
v_lshlrev_b32 v17, 7, v17
v_add_u32 v17, 65536, v17
v_lshl_add_u32 v9, v16, 4, v17
v_xor_b32 v10, 64, v9
v_bfe_u32 v16, v1, 2, 2
v_lshl_add_u32 v17, v3, 3, v16
v_lshlrev_b32 v17, 7, v17
v_and_b32 v18, 3, v1
v_lshl_add_u32 v17, v18, 3, v17
v_add_u32 v17, s53, v17
v_lshrrev_b32 v16, 1, v16
v_and_b32 v18, 1, v3
v_lshl_add_u32 v16, v18, 1, v16
v_xor_b32 v18, 0, v16
v_lshl_add_u32 v11, v18, 5, v17
v_xor_b32 v18, 1, v16
v_lshl_add_u32 v12, v18, 5, v17
v_xor_b32 v18, 2, v16
v_lshl_add_u32 v13, v18, 5, v17
v_xor_b32 v18, 3, v16
v_lshl_add_u32 v14, v18, 5, v17
s_mul_i32 s87, s87, 49152
s_add_u32 s87, s87, s95
s_add_u32 s88, s87, s53
s_add_u32 s88, s88, 73728
s_lshr_b32 s53, s53, 1
s_add_u32 s87, s87, s53
s_lshl_b32 s80, s3, 10
s_bfe_u32 s64, s4, 65539
s_lshl_b32 s64, s64, 22
s_add_u32 s64, s64, s94
s_add_u32 s64, s64, 150994944
s_and_b32 s78, s4, 7
s_mul_i32 s78, s78, 221184
s_add_u32 s78, s78, s80
s_add_u32 s78, s78, s64
s_add_u32 s80, s80, 8192
s_mov_b32 s91, 0x3e0293ee
s_mov_b32 s85, 0x05040100
s_mov_b32 s86, 0x07060302
s_lshl2_add_u32 s52, s7, s3
s_xor_b32 s92, s6, 31
s_mul_i32 s81, s92, 110592
s_mul_i32 s65, s52, 36
s_add_u32 s81, s81, s65
s_and_b32 s82, s52, 7
s_mul_i32 s82, s82, 221184
s_add_u32 s82, s82, s64
s_lshr_b32 s64, s92, 1
s_and_b32 s65, s92, 1
s_mul_i32 s64, s64, 6
s_add_u32 s64, s64, s65
s_lshl_b32 s64, s64, 12
s_add_u32 s82, s82, s64
s_lshl_b32 s83, s92, 6
s_lshl_b32 s84, s52, 10
s_add_u32 s84, s84, 167772672
s_cmp_lt_u32 s92, 18
s_cselect_b32 s82, s82, 2147418112
s_cselect_b32 s84, s84, 2147418112
v_lshrrev_b32 v18, 2, v2
v_and_b32 v19, 3, v2
v_mul_u32_u24 v20, 1152, v18
v_cmp_eq_u32 vcc, 2, v19
v_lshl_add_u32 v20, v19, 3, v20
v_add_u32 v21, 1, v19
v_cndmask_b32 v21, v21, 0, vcc
v_cmp_eq_u32 vcc, 3, v18
v_mul_u32_u24 v21, 1152, v21
v_add_u32 v21, 32, v21
v_cndmask_b32 v20, v20, v21, vcc
v_cmp_eq_u32 vcc, 15, v2
v_mul_u32_u24 v21, 27648, v3
v_add_u32 v20, v20, v21
v_lshlrev_b32 v21, 4, v3
v_cndmask_b32 v26, v20, v24, vcc
v_cndmask_b32 v27, v24, v21, vcc
v_and_b32 v18, 7, v1
v_cmp_gt_u32 vcc, 48, v1
v_mul_u32_u24 v18, 3456, v18
v_mul_u32_u24 v19, 1152, v3
v_bfe_u32 v20, v1, 3, 1
v_mul_u32_u24 v20, 140, v20
v_add3_u32 v18, v18, v19, v20
v_cndmask_b32 v28, v24, v18, vcc
s_add_u32 m0, s77, 16384
s_add_u32 s64, s76, 262144
buffer_load_dwordx4 v7, s[16:19], s64 offen lds
buffer_load_dwordx4 v8, s[16:19], s64 offen offset:1024 lds
s_add_u32 m0, s77, 18432
s_add_u32 s64, s76, 393216
buffer_load_dwordx4 v7, s[16:19], s64 offen lds
buffer_load_dwordx4 v8, s[16:19], s64 offen offset:1024 lds
s_xor_b32 s71, s70, 128
s_add_u32 s71, s68, s71
s_add_u32 m0, s73, 32768
s_add_u32 s64, s71, 0
buffer_load_dwordx4 v5, s[8:11], s64 offen lds
buffer_load_dwordx4 v6, s[8:11], s64 offen offset:1024 lds
s_add_u32 m0, s73, 34816
s_add_u32 s64, s71, 16384
buffer_load_dwordx4 v5, s[8:11], s64 offen lds
buffer_load_dwordx4 v6, s[8:11], s64 offen offset:1024 lds
s_waitcnt vmcnt(8)
s_barrier
ds_read_b128 a[64:67], v9 offset:0
ds_read_b128 a[68:71], v9 offset:2048
ds_read_b128 a[72:75], v9 offset:4096
ds_read_b128 a[76:79], v9 offset:6144
ds_read_b128 a[80:83], v9 offset:8192
ds_read_b128 a[84:87], v9 offset:10240
ds_read_b128 a[88:91], v9 offset:12288
ds_read_b128 a[92:95], v9 offset:14336
ds_read_b64_tr_b16 a[112:113], v11 offset:8192
ds_read_b64_tr_b16 a[114:115], v11 offset:8704
ds_read_b64_tr_b16 a[116:117], v12 offset:8192
ds_read_b64_tr_b16 a[118:119], v12 offset:8704
ds_read_b64_tr_b16 a[120:121], v13 offset:8192
ds_read_b64_tr_b16 a[122:123], v13 offset:8704
ds_read_b64_tr_b16 a[124:125], v14 offset:8192
ds_read_b64_tr_b16 a[126:127], v14 offset:8704
ds_read_b64_tr_b16 a[96:97], v11 offset:0
ds_read_b64_tr_b16 a[98:99], v11 offset:512
ds_read_b64_tr_b16 a[100:101], v12 offset:0
ds_read_b64_tr_b16 a[102:103], v12 offset:512
ds_read_b64_tr_b16 a[104:105], v13 offset:0
ds_read_b64_tr_b16 a[106:107], v13 offset:512
ds_read_b64_tr_b16 a[108:109], v14 offset:0
ds_read_b64_tr_b16 a[110:111], v14 offset:512
s_lshl_b32 s52, s4, 2
s_cmp_eq_u32 s66, 0
s_cselect_b32 s52, s52, 2147418112
buffer_store_dword v1, v0, s[40:43], s52 offen sc1
s_waitcnt lgkmcnt(0)
v_mfma_f32_16x16x32_bf16 v[160:163], a[96:99], a[64:67], 0
s_waitcnt vmcnt(5)
v_mfma_f32_16x16x32_bf16 v[164:167], a[100:103], a[64:67], 0
s_barrier
v_mfma_f32_16x16x32_bf16 v[168:171], a[104:107], a[64:67], 0
ds_read_b128 a[128:131], v10 offset:0
v_mfma_f32_16x16x32_bf16 v[172:175], a[108:111], a[64:67], 0
s_add_u32 m0, s73, 36864
s_add_u32 s64, s71, 524288
v_mfma_f32_16x16x32_bf16 v[32:35], a[64:67], a[112:115], 0
buffer_load_dwordx4 v5, s[8:11], s64 offen lds
v_mfma_f32_16x16x32_bf16 v[40:43], a[64:67], a[116:119], 0
ds_read_b64_tr_b16 a[176:177], v11 offset:24576
ds_read_b64_tr_b16 a[178:179], v11 offset:25088
v_mfma_f32_16x16x32_bf16 v[48:51], a[64:67], a[120:123], 0
v_mfma_f32_16x16x32_bf16 v[56:59], a[64:67], a[124:127], 0
v_mfma_f32_16x16x32_bf16 v[60:63], a[68:71], a[124:127], 0
buffer_load_dwordx4 v6, s[8:11], s64 offen offset:1024 lds
v_mfma_f32_16x16x32_bf16 v[52:55], a[68:71], a[120:123], 0
ds_read_b128 a[132:135], v10 offset:2048
v_mfma_f32_16x16x32_bf16 v[44:47], a[68:71], a[116:119], 0
v_mfma_f32_16x16x32_bf16 v[36:39], a[68:71], a[112:115], 0
s_add_u32 m0, s73, 38912
s_add_u32 s64, s71, 540672
v_mfma_f32_16x16x32_bf16 v[188:191], a[108:111], a[68:71], 0
ds_read_b64_tr_b16 a[180:181], v12 offset:24576
ds_read_b64_tr_b16 a[182:183], v12 offset:25088
v_mfma_f32_16x16x32_bf16 v[184:187], a[104:107], a[68:71], 0
buffer_load_dwordx4 v5, s[8:11], s64 offen lds
v_mfma_f32_16x16x32_bf16 v[180:183], a[100:103], a[68:71], 0
ds_read_b128 a[136:139], v10 offset:4096
v_mfma_f32_16x16x32_bf16 v[176:179], a[96:99], a[68:71], 0
v_mfma_f32_16x16x32_bf16 v[192:195], a[96:99], a[72:75], 0
v_mfma_f32_16x16x32_bf16 v[196:199], a[100:103], a[72:75], 0
ds_read_b64_tr_b16 a[184:185], v13 offset:24576
ds_read_b64_tr_b16 a[186:187], v13 offset:25088
v_mfma_f32_16x16x32_bf16 v[200:203], a[104:107], a[72:75], 0
buffer_load_dwordx4 v6, s[8:11], s64 offen offset:1024 lds
v_mfma_f32_16x16x32_bf16 v[204:207], a[108:111], a[72:75], 0
s_xor_b32 s76, s75, 524288
s_add_u32 s76, s74, s76
v_mfma_f32_16x16x32_bf16 v[64:67], a[72:75], a[112:115], 0
ds_read_b128 a[140:143], v10 offset:6144
v_mfma_f32_16x16x32_bf16 v[72:75], a[72:75], a[116:119], 0
s_add_u32 m0, s77, 32768
s_add_u32 s64, s76, 0
v_mfma_f32_16x16x32_bf16 v[80:83], a[72:75], a[120:123], 0
v_mfma_f32_16x16x32_bf16 v[88:91], a[72:75], a[124:127], 0
buffer_load_dwordx4 v7, s[16:19], s64 offen lds
v_mfma_f32_16x16x32_bf16 v[92:95], a[76:79], a[124:127], 0
ds_read_b64_tr_b16 a[188:189], v14 offset:24576
ds_read_b64_tr_b16 a[190:191], v14 offset:25088
v_mfma_f32_16x16x32_bf16 v[84:87], a[76:79], a[120:123], 0
v_mfma_f32_16x16x32_bf16 v[76:79], a[76:79], a[116:119], 0
ds_read_b128 a[144:147], v10 offset:8192
v_mfma_f32_16x16x32_bf16 v[68:71], a[76:79], a[112:115], 0
v_mfma_f32_16x16x32_bf16 v[220:223], a[108:111], a[76:79], 0
buffer_load_dwordx4 v8, s[16:19], s64 offen offset:1024 lds
v_mfma_f32_16x16x32_bf16 v[216:219], a[104:107], a[76:79], 0
ds_read_b64_tr_b16 a[160:161], v11 offset:16384
ds_read_b64_tr_b16 a[162:163], v11 offset:16896
v_mfma_f32_16x16x32_bf16 v[212:215], a[100:103], a[76:79], 0
v_mfma_f32_16x16x32_bf16 v[208:211], a[96:99], a[76:79], 0
s_add_u32 m0, s77, 34816
s_add_u32 s64, s76, 131072
v_mfma_f32_16x16x32_bf16 v[224:227], a[96:99], a[80:83], 0
ds_read_b128 a[148:151], v10 offset:10240
v_mfma_f32_16x16x32_bf16 v[228:231], a[100:103], a[80:83], 0
buffer_load_dwordx4 v7, s[16:19], s64 offen lds
v_mfma_f32_16x16x32_bf16 v[232:235], a[104:107], a[80:83], 0
v_mfma_f32_16x16x32_bf16 v[236:239], a[108:111], a[80:83], 0
ds_read_b64_tr_b16 a[164:165], v12 offset:16384
ds_read_b64_tr_b16 a[166:167], v12 offset:16896
v_mfma_f32_16x16x32_bf16 v[96:99], a[80:83], a[112:115], 0
v_mfma_f32_16x16x32_bf16 v[104:107], a[80:83], a[116:119], 0
buffer_load_dwordx4 v8, s[16:19], s64 offen offset:1024 lds
v_mfma_f32_16x16x32_bf16 v[112:115], a[80:83], a[120:123], 0
ds_read_b128 a[152:155], v10 offset:12288
v_mfma_f32_16x16x32_bf16 v[120:123], a[80:83], a[124:127], 0
v_mfma_f32_16x16x32_bf16 v[124:127], a[84:87], a[124:127], 0
s_add_u32 m0, s77, 49152
s_add_u32 s64, s76, 262144
v_mfma_f32_16x16x32_bf16 v[116:119], a[84:87], a[120:123], 0
ds_read_b64_tr_b16 a[168:169], v13 offset:16384
ds_read_b64_tr_b16 a[170:171], v13 offset:16896
v_mfma_f32_16x16x32_bf16 v[108:111], a[84:87], a[116:119], 0
buffer_load_dwordx4 v7, s[16:19], s64 offen lds
v_mfma_f32_16x16x32_bf16 v[100:103], a[84:87], a[112:115], 0
v_mfma_f32_16x16x32_bf16 v[252:255], a[108:111], a[84:87], 0
ds_read_b128 a[156:159], v10 offset:14336
v_mfma_f32_16x16x32_bf16 v[248:251], a[104:107], a[84:87], 0
v_mfma_f32_16x16x32_bf16 v[244:247], a[100:103], a[84:87], 0
v_mfma_f32_16x16x32_bf16 v[240:243], a[96:99], a[84:87], 0
buffer_load_dwordx4 v8, s[16:19], s64 offen offset:1024 lds
v_mfma_f32_16x16x32_bf16 a[0:3], a[96:99], a[88:91], 0
ds_read_b64_tr_b16 a[172:173], v14 offset:16384
ds_read_b64_tr_b16 a[174:175], v14 offset:16896
v_mfma_f32_16x16x32_bf16 a[4:7], a[100:103], a[88:91], 0
v_mfma_f32_16x16x32_bf16 a[8:11], a[104:107], a[88:91], 0
s_add_u32 m0, s77, 51200
s_add_u32 s64, s76, 393216
v_mfma_f32_16x16x32_bf16 a[12:15], a[108:111], a[88:91], 0
v_mfma_f32_16x16x32_bf16 v[128:131], a[88:91], a[112:115], 0
buffer_load_dwordx4 v7, s[16:19], s64 offen lds
v_mfma_f32_16x16x32_bf16 v[136:139], a[88:91], a[116:119], 0
v_mfma_f32_16x16x32_bf16 v[144:147], a[88:91], a[120:123], 0
v_mfma_f32_16x16x32_bf16 v[152:155], a[88:91], a[124:127], 0
v_mfma_f32_16x16x32_bf16 v[156:159], a[92:95], a[124:127], 0
v_add_u32 v9, 32768, v9
v_add_u32 v10, 32768, v10
v_mfma_f32_16x16x32_bf16 v[148:151], a[92:95], a[120:123], 0
buffer_load_dwordx4 v8, s[16:19], s64 offen offset:1024 lds
v_mfma_f32_16x16x32_bf16 v[140:143], a[92:95], a[116:119], 0
v_mfma_f32_16x16x32_bf16 v[132:135], a[92:95], a[112:115], 0
v_mfma_f32_16x16x32_bf16 a[28:31], a[108:111], a[92:95], 0
v_mfma_f32_16x16x32_bf16 a[24:27], a[104:107], a[92:95], 0
v_mfma_f32_16x16x32_bf16 a[20:23], a[100:103], a[92:95], 0
v_mfma_f32_16x16x32_bf16 a[16:19], a[96:99], a[92:95], 0
s_waitcnt lgkmcnt(0)
v_mfma_f32_16x16x32_bf16 v[160:163], a[160:163], a[128:131], v[160:163]
s_waitcnt vmcnt(4)
v_mfma_f32_16x16x32_bf16 v[164:167], a[164:167], a[128:131], v[164:167]
s_barrier
v_mfma_f32_16x16x32_bf16 v[168:171], a[168:171], a[128:131], v[168:171]
ds_read_b128 a[64:67], v9 offset:0
v_mfma_f32_16x16x32_bf16 v[172:175], a[172:175], a[128:131], v[172:175]
s_xor_b32 s71, s70, 256
s_add_u32 s71, s68, s71
v_mfma_f32_16x16x32_bf16 v[32:35], a[128:131], a[176:179], v[32:35]
s_add_u32 m0, s73, 65536
s_add_u32 s64, s71, 0
v_mfma_f32_16x16x32_bf16 v[40:43], a[128:131], a[180:183], v[40:43]
buffer_load_dwordx4 v5, s[8:11], s64 offen lds
v_mfma_f32_16x16x32_bf16 v[48:51], a[128:131], a[184:187], v[48:51]
ds_read_b64_tr_b16 a[112:113], v11 offset:40960
ds_read_b64_tr_b16 a[114:115], v11 offset:41472
v_mfma_f32_16x16x32_bf16 v[56:59], a[128:131], a[188:191], v[56:59]
v_mfma_f32_16x16x32_bf16 v[60:63], a[132:135], a[188:191], v[60:63]
buffer_load_dwordx4 v6, s[8:11], s64 offen offset:1024 lds
v_mfma_f32_16x16x32_bf16 v[52:55], a[132:135], a[184:187], v[52:55]
ds_read_b128 a[68:71], v9 offset:2048
v_mfma_f32_16x16x32_bf16 v[44:47], a[132:135], a[180:183], v[44:47]
v_mfma_f32_16x16x32_bf16 v[36:39], a[132:135], a[176:179], v[36:39]
s_add_u32 m0, s73, 67584
s_add_u32 s64, s71, 16384
v_mfma_f32_16x16x32_bf16 v[188:191], a[172:175], a[132:135], v[188:191]
ds_read_b64_tr_b16 a[116:117], v12 offset:40960
ds_read_b64_tr_b16 a[118:119], v12 offset:41472
v_mfma_f32_16x16x32_bf16 v[184:187], a[168:171], a[132:135], v[184:187]
buffer_load_dwordx4 v5, s[8:11], s64 offen lds
v_mfma_f32_16x16x32_bf16 v[180:183], a[164:167], a[132:135], v[180:183]
ds_read_b128 a[72:75], v9 offset:4096
v_mfma_f32_16x16x32_bf16 v[176:179], a[160:163], a[132:135], v[176:179]
v_mfma_f32_16x16x32_bf16 v[192:195], a[160:163], a[136:139], v[192:195]
v_mfma_f32_16x16x32_bf16 v[196:199], a[164:167], a[136:139], v[196:199]
ds_read_b64_tr_b16 a[120:121], v13 offset:40960
ds_read_b64_tr_b16 a[122:123], v13 offset:41472
v_mfma_f32_16x16x32_bf16 v[200:203], a[168:171], a[136:139], v[200:203]
buffer_load_dwordx4 v6, s[8:11], s64 offen offset:1024 lds
v_mfma_f32_16x16x32_bf16 v[204:207], a[172:175], a[136:139], v[204:207]
s_xor_b32 s76, s75, 1048576
s_add_u32 s76, s74, s76
v_mfma_f32_16x16x32_bf16 v[64:67], a[136:139], a[176:179], v[64:67]
ds_read_b128 a[76:79], v9 offset:6144
v_mfma_f32_16x16x32_bf16 v[72:75], a[136:139], a[180:183], v[72:75]
s_add_u32 m0, s77, 0
s_add_u32 s64, s76, 0
v_mfma_f32_16x16x32_bf16 v[80:83], a[136:139], a[184:187], v[80:83]
v_mfma_f32_16x16x32_bf16 v[88:91], a[136:139], a[188:191], v[88:91]
buffer_load_dwordx4 v7, s[16:19], s64 offen lds
v_mfma_f32_16x16x32_bf16 v[92:95], a[140:143], a[188:191], v[92:95]
ds_read_b64_tr_b16 a[124:125], v14 offset:40960
ds_read_b64_tr_b16 a[126:127], v14 offset:41472
v_mfma_f32_16x16x32_bf16 v[84:87], a[140:143], a[184:187], v[84:87]
v_mfma_f32_16x16x32_bf16 v[76:79], a[140:143], a[180:183], v[76:79]
ds_read_b128 a[80:83], v9 offset:8192
v_mfma_f32_16x16x32_bf16 v[68:71], a[140:143], a[176:179], v[68:71]
v_mfma_f32_16x16x32_bf16 v[220:223], a[172:175], a[140:143], v[220:223]
buffer_load_dwordx4 v8, s[16:19], s64 offen offset:1024 lds
v_mfma_f32_16x16x32_bf16 v[216:219], a[168:171], a[140:143], v[216:219]
ds_read_b64_tr_b16 a[96:97], v11 offset:32768
ds_read_b64_tr_b16 a[98:99], v11 offset:33280
v_mfma_f32_16x16x32_bf16 v[212:215], a[164:167], a[140:143], v[212:215]
v_mfma_f32_16x16x32_bf16 v[208:211], a[160:163], a[140:143], v[208:211]
s_add_u32 m0, s77, 2048
s_add_u32 s64, s76, 131072
v_mfma_f32_16x16x32_bf16 v[224:227], a[160:163], a[144:147], v[224:227]
ds_read_b128 a[84:87], v9 offset:10240
v_mfma_f32_16x16x32_bf16 v[228:231], a[164:167], a[144:147], v[228:231]
buffer_load_dwordx4 v7, s[16:19], s64 offen lds
v_mfma_f32_16x16x32_bf16 v[232:235], a[168:171], a[144:147], v[232:235]
v_mfma_f32_16x16x32_bf16 v[236:239], a[172:175], a[144:147], v[236:239]
ds_read_b64_tr_b16 a[100:101], v12 offset:32768
ds_read_b64_tr_b16 a[102:103], v12 offset:33280
v_mfma_f32_16x16x32_bf16 v[96:99], a[144:147], a[176:179], v[96:99]
v_mfma_f32_16x16x32_bf16 v[104:107], a[144:147], a[180:183], v[104:107]
buffer_load_dwordx4 v8, s[16:19], s64 offen offset:1024 lds
v_mfma_f32_16x16x32_bf16 v[112:115], a[144:147], a[184:187], v[112:115]
ds_read_b128 a[88:91], v9 offset:12288
v_mfma_f32_16x16x32_bf16 v[120:123], a[144:147], a[188:191], v[120:123]
v_mfma_f32_16x16x32_bf16 v[124:127], a[148:151], a[188:191], v[124:127]
s_add_u32 m0, s73, 69632
s_add_u32 s64, s71, 524288
v_mfma_f32_16x16x32_bf16 v[116:119], a[148:151], a[184:187], v[116:119]
ds_read_b64_tr_b16 a[104:105], v13 offset:32768
ds_read_b64_tr_b16 a[106:107], v13 offset:33280
v_mfma_f32_16x16x32_bf16 v[108:111], a[148:151], a[180:183], v[108:111]
buffer_load_dwordx4 v5, s[8:11], s64 offen lds
v_mfma_f32_16x16x32_bf16 v[100:103], a[148:151], a[176:179], v[100:103]
v_mfma_f32_16x16x32_bf16 v[252:255], a[172:175], a[148:151], v[252:255]
ds_read_b128 a[92:95], v9 offset:14336
v_mfma_f32_16x16x32_bf16 v[248:251], a[168:171], a[148:151], v[248:251]
v_mfma_f32_16x16x32_bf16 v[244:247], a[164:167], a[148:151], v[244:247]
v_mfma_f32_16x16x32_bf16 v[240:243], a[160:163], a[148:151], v[240:243]
buffer_load_dwordx4 v6, s[8:11], s64 offen offset:1024 lds
v_mfma_f32_16x16x32_bf16 a[0:3], a[160:163], a[152:155], a[0:3]
ds_read_b64_tr_b16 a[108:109], v14 offset:32768
ds_read_b64_tr_b16 a[110:111], v14 offset:33280
v_mfma_f32_16x16x32_bf16 a[4:7], a[164:167], a[152:155], a[4:7]
v_mfma_f32_16x16x32_bf16 a[8:11], a[168:171], a[152:155], a[8:11]
s_add_u32 m0, s73, 71680
s_add_u32 s64, s71, 540672
v_mfma_f32_16x16x32_bf16 a[12:15], a[172:175], a[152:155], a[12:15]
v_mfma_f32_16x16x32_bf16 v[128:131], a[152:155], a[176:179], v[128:131]
buffer_load_dwordx4 v5, s[8:11], s64 offen lds
v_mfma_f32_16x16x32_bf16 v[136:139], a[152:155], a[180:183], v[136:139]
v_mfma_f32_16x16x32_bf16 v[144:147], a[152:155], a[184:187], v[144:147]
v_mfma_f32_16x16x32_bf16 v[152:155], a[152:155], a[188:191], v[152:155]
v_mfma_f32_16x16x32_bf16 v[156:159], a[156:159], a[188:191], v[156:159]
v_mfma_f32_16x16x32_bf16 v[148:151], a[156:159], a[184:187], v[148:151]
buffer_load_dwordx4 v6, s[8:11], s64 offen offset:1024 lds
v_mfma_f32_16x16x32_bf16 v[140:143], a[156:159], a[180:183], v[140:143]
v_mfma_f32_16x16x32_bf16 v[132:135], a[156:159], a[176:179], v[132:135]
v_mfma_f32_16x16x32_bf16 a[28:31], a[172:175], a[156:159], a[28:31]
v_mfma_f32_16x16x32_bf16 a[24:27], a[168:171], a[156:159], a[24:27]
v_mfma_f32_16x16x32_bf16 a[20:23], a[164:167], a[156:159], a[20:23]
v_mfma_f32_16x16x32_bf16 a[16:19], a[160:163], a[156:159], a[16:19]
s_waitcnt lgkmcnt(0)
v_mfma_f32_16x16x32_bf16 v[160:163], a[96:99], a[64:67], v[160:163]
s_waitcnt vmcnt(12)
v_mfma_f32_16x16x32_bf16 v[164:167], a[100:103], a[64:67], v[164:167]
s_barrier
v_mfma_f32_16x16x32_bf16 v[168:171], a[104:107], a[64:67], v[168:171]
ds_read_b128 a[128:131], v10 offset:0
v_mfma_f32_16x16x32_bf16 v[172:175], a[108:111], a[64:67], v[172:175]
s_add_u32 m0, s77, 16384
s_add_u32 s64, s76, 262144
v_mfma_f32_16x16x32_bf16 v[32:35], a[64:67], a[112:115], v[32:35]
buffer_load_dwordx4 v7, s[16:19], s64 offen lds
v_mfma_f32_16x16x32_bf16 v[40:43], a[64:67], a[116:119], v[40:43]
ds_read_b64_tr_b16 a[176:177], v11 offset:57344
ds_read_b64_tr_b16 a[178:179], v11 offset:57856
v_mfma_f32_16x16x32_bf16 v[48:51], a[64:67], a[120:123], v[48:51]
v_mfma_f32_16x16x32_bf16 v[56:59], a[64:67], a[124:127], v[56:59]
v_mfma_f32_16x16x32_bf16 v[60:63], a[68:71], a[124:127], v[60:63]
buffer_load_dwordx4 v8, s[16:19], s64 offen offset:1024 lds
v_mfma_f32_16x16x32_bf16 v[52:55], a[68:71], a[120:123], v[52:55]
ds_read_b128 a[132:135], v10 offset:2048
v_mfma_f32_16x16x32_bf16 v[44:47], a[68:71], a[116:119], v[44:47]
v_mfma_f32_16x16x32_bf16 v[36:39], a[68:71], a[112:115], v[36:39]
s_add_u32 m0, s77, 18432
s_add_u32 s64, s76, 393216
v_mfma_f32_16x16x32_bf16 v[188:191], a[108:111], a[68:71], v[188:191]
ds_read_b64_tr_b16 a[180:181], v12 offset:57344
ds_read_b64_tr_b16 a[182:183], v12 offset:57856
v_mfma_f32_16x16x32_bf16 v[184:187], a[104:107], a[68:71], v[184:187]
buffer_load_dwordx4 v7, s[16:19], s64 offen lds
v_mfma_f32_16x16x32_bf16 v[180:183], a[100:103], a[68:71], v[180:183]
ds_read_b128 a[136:139], v10 offset:4096
v_mfma_f32_16x16x32_bf16 v[176:179], a[96:99], a[68:71], v[176:179]
v_mfma_f32_16x16x32_bf16 v[192:195], a[96:99], a[72:75], v[192:195]
v_mfma_f32_16x16x32_bf16 v[196:199], a[100:103], a[72:75], v[196:199]
ds_read_b64_tr_b16 a[184:185], v13 offset:57344
ds_read_b64_tr_b16 a[186:187], v13 offset:57856
v_mfma_f32_16x16x32_bf16 v[200:203], a[104:107], a[72:75], v[200:203]
buffer_load_dwordx4 v8, s[16:19], s64 offen offset:1024 lds
v_mfma_f32_16x16x32_bf16 v[204:207], a[108:111], a[72:75], v[204:207]
s_xor_b32 s71, s70, 384
s_add_u32 s71, s68, s71
v_mfma_f32_16x16x32_bf16 v[64:67], a[72:75], a[112:115], v[64:67]
ds_read_b128 a[140:143], v10 offset:6144
v_mfma_f32_16x16x32_bf16 v[72:75], a[72:75], a[116:119], v[72:75]
s_add_u32 m0, s73, 0
s_add_u32 s64, s71, 0
v_mfma_f32_16x16x32_bf16 v[80:83], a[72:75], a[120:123], v[80:83]
v_mfma_f32_16x16x32_bf16 v[88:91], a[72:75], a[124:127], v[88:91]
buffer_load_dwordx4 v5, s[8:11], s64 offen lds
v_mfma_f32_16x16x32_bf16 v[92:95], a[76:79], a[124:127], v[92:95]
ds_read_b64_tr_b16 a[188:189], v14 offset:57344
ds_read_b64_tr_b16 a[190:191], v14 offset:57856
v_mfma_f32_16x16x32_bf16 v[84:87], a[76:79], a[120:123], v[84:87]
v_mfma_f32_16x16x32_bf16 v[76:79], a[76:79], a[116:119], v[76:79]
ds_read_b128 a[144:147], v10 offset:8192
v_mfma_f32_16x16x32_bf16 v[68:71], a[76:79], a[112:115], v[68:71]
v_mfma_f32_16x16x32_bf16 v[220:223], a[108:111], a[76:79], v[220:223]
buffer_load_dwordx4 v6, s[8:11], s64 offen offset:1024 lds
v_mfma_f32_16x16x32_bf16 v[216:219], a[104:107], a[76:79], v[216:219]
ds_read_b64_tr_b16 a[160:161], v11 offset:49152
ds_read_b64_tr_b16 a[162:163], v11 offset:49664
v_mfma_f32_16x16x32_bf16 v[212:215], a[100:103], a[76:79], v[212:215]
v_mfma_f32_16x16x32_bf16 v[208:211], a[96:99], a[76:79], v[208:211]
s_add_u32 m0, s73, 2048
s_add_u32 s64, s71, 16384
v_mfma_f32_16x16x32_bf16 v[224:227], a[96:99], a[80:83], v[224:227]
ds_read_b128 a[148:151], v10 offset:10240
v_mfma_f32_16x16x32_bf16 v[228:231], a[100:103], a[80:83], v[228:231]
buffer_load_dwordx4 v5, s[8:11], s64 offen lds
v_mfma_f32_16x16x32_bf16 v[232:235], a[104:107], a[80:83], v[232:235]
v_mfma_f32_16x16x32_bf16 v[236:239], a[108:111], a[80:83], v[236:239]
ds_read_b64_tr_b16 a[164:165], v12 offset:49152
ds_read_b64_tr_b16 a[166:167], v12 offset:49664
v_mfma_f32_16x16x32_bf16 v[96:99], a[80:83], a[112:115], v[96:99]
v_mfma_f32_16x16x32_bf16 v[104:107], a[80:83], a[116:119], v[104:107]
buffer_load_dwordx4 v6, s[8:11], s64 offen offset:1024 lds
v_mfma_f32_16x16x32_bf16 v[112:115], a[80:83], a[120:123], v[112:115]
s_xor_b32 s76, s75, 1572864
s_add_u32 s76, s74, s76
ds_read_b128 a[152:155], v10 offset:12288
v_mfma_f32_16x16x32_bf16 v[120:123], a[80:83], a[124:127], v[120:123]
v_mfma_f32_16x16x32_bf16 v[124:127], a[84:87], a[124:127], v[124:127]
s_add_u32 m0, s77, 32768
s_add_u32 s64, s76, 0
v_mfma_f32_16x16x32_bf16 v[116:119], a[84:87], a[120:123], v[116:119]
ds_read_b64_tr_b16 a[168:169], v13 offset:49152
ds_read_b64_tr_b16 a[170:171], v13 offset:49664
v_mfma_f32_16x16x32_bf16 v[108:111], a[84:87], a[116:119], v[108:111]
buffer_load_dwordx4 v7, s[16:19], s64 offen lds
v_mfma_f32_16x16x32_bf16 v[100:103], a[84:87], a[112:115], v[100:103]
v_mfma_f32_16x16x32_bf16 v[252:255], a[108:111], a[84:87], v[252:255]
ds_read_b128 a[156:159], v10 offset:14336
v_mfma_f32_16x16x32_bf16 v[248:251], a[104:107], a[84:87], v[248:251]
v_mfma_f32_16x16x32_bf16 v[244:247], a[100:103], a[84:87], v[244:247]
v_mfma_f32_16x16x32_bf16 v[240:243], a[96:99], a[84:87], v[240:243]
buffer_load_dwordx4 v8, s[16:19], s64 offen offset:1024 lds
v_mfma_f32_16x16x32_bf16 a[0:3], a[96:99], a[88:91], a[0:3]
ds_read_b64_tr_b16 a[172:173], v14 offset:49152
ds_read_b64_tr_b16 a[174:175], v14 offset:49664
v_mfma_f32_16x16x32_bf16 a[4:7], a[100:103], a[88:91], a[4:7]
v_mfma_f32_16x16x32_bf16 a[8:11], a[104:107], a[88:91], a[8:11]
s_add_u32 m0, s77, 34816
s_add_u32 s64, s76, 131072
v_mfma_f32_16x16x32_bf16 a[12:15], a[108:111], a[88:91], a[12:15]
v_mfma_f32_16x16x32_bf16 v[128:131], a[88:91], a[112:115], v[128:131]
buffer_load_dwordx4 v7, s[16:19], s64 offen lds
v_mfma_f32_16x16x32_bf16 v[136:139], a[88:91], a[116:119], v[136:139]
v_mfma_f32_16x16x32_bf16 v[144:147], a[88:91], a[120:123], v[144:147]
v_mfma_f32_16x16x32_bf16 v[152:155], a[88:91], a[124:127], v[152:155]
v_mfma_f32_16x16x32_bf16 v[156:159], a[92:95], a[124:127], v[156:159]
v_add_u32 v9, 32768, v9
v_add_u32 v10, 32768, v10
v_mfma_f32_16x16x32_bf16 v[148:151], a[92:95], a[120:123], v[148:151]
buffer_load_dwordx4 v8, s[16:19], s64 offen offset:1024 lds
v_mfma_f32_16x16x32_bf16 v[140:143], a[92:95], a[116:119], v[140:143]
v_mfma_f32_16x16x32_bf16 v[132:135], a[92:95], a[112:115], v[132:135]
v_mfma_f32_16x16x32_bf16 a[28:31], a[108:111], a[92:95], a[28:31]
v_mfma_f32_16x16x32_bf16 a[24:27], a[104:107], a[92:95], a[24:27]
v_mfma_f32_16x16x32_bf16 a[20:23], a[100:103], a[92:95], a[20:23]
v_mfma_f32_16x16x32_bf16 a[16:19], a[96:99], a[92:95], a[16:19]
s_waitcnt lgkmcnt(0)
v_mfma_f32_16x16x32_bf16 v[160:163], a[160:163], a[128:131], v[160:163]
s_waitcnt vmcnt(12)
v_mfma_f32_16x16x32_bf16 v[164:167], a[164:167], a[128:131], v[164:167]
s_barrier
v_mfma_f32_16x16x32_bf16 v[168:171], a[168:171], a[128:131], v[168:171]
s_xor_b32 s52, s6, 31
s_mul_i32 s52, s52, 110592
ds_read_b128 a[64:67], v9 offset:0
v_mfma_f32_16x16x32_bf16 v[172:175], a[172:175], a[128:131], v[172:175]
s_add_u32 m0, s73, 4096
s_add_u32 s64, s71, 524288
s_mul_i32 s53, s3, 27648
v_mfma_f32_16x16x32_bf16 v[32:35], a[128:131], a[176:179], v[32:35]
buffer_load_dwordx4 v5, s[8:11], s64 offen lds
v_mfma_f32_16x16x32_bf16 v[40:43], a[128:131], a[180:183], v[40:43]
s_add_u32 s52, s52, s53
ds_read_b64_tr_b16 a[112:113], v11 offset:8192
ds_read_b64_tr_b16 a[114:115], v11 offset:8704
v_mfma_f32_16x16x32_bf16 v[48:51], a[128:131], a[184:187], v[48:51]
s_mul_i32 s53, s7, 144
s_add_u32 s52, s52, s53
v_mfma_f32_16x16x32_bf16 v[56:59], a[128:131], a[188:191], v[56:59]
buffer_load_dword a252, v28, s[28:31], s52 offen
v_mfma_f32_16x16x32_bf16 v[60:63], a[132:135], a[188:191], v[60:63]
buffer_load_dwordx4 v6, s[8:11], s64 offen offset:1024 lds
v_mfma_f32_16x16x32_bf16 v[52:55], a[132:135], a[184:187], v[52:55]
ds_read_b128 a[68:71], v9 offset:2048
v_mfma_f32_16x16x32_bf16 v[44:47], a[132:135], a[180:183], v[44:47]
v_mfma_f32_16x16x32_bf16 v[36:39], a[132:135], a[176:179], v[36:39]
s_add_u32 m0, s73, 6144
s_add_u32 s64, s71, 540672
v_mfma_f32_16x16x32_bf16 v[188:191], a[172:175], a[132:135], v[188:191]
ds_read_b64_tr_b16 a[116:117], v12 offset:8192
ds_read_b64_tr_b16 a[118:119], v12 offset:8704
v_mfma_f32_16x16x32_bf16 v[184:187], a[168:171], a[132:135], v[184:187]
buffer_load_dwordx4 v5, s[8:11], s64 offen lds
v_mfma_f32_16x16x32_bf16 v[180:183], a[164:167], a[132:135], v[180:183]
ds_read_b128 a[72:75], v9 offset:4096
v_mfma_f32_16x16x32_bf16 v[176:179], a[160:163], a[132:135], v[176:179]
v_mfma_f32_16x16x32_bf16 v[192:195], a[160:163], a[136:139], v[192:195]
v_mfma_f32_16x16x32_bf16 v[196:199], a[164:167], a[136:139], v[196:199]
ds_read_b64_tr_b16 a[120:121], v13 offset:8192
ds_read_b64_tr_b16 a[122:123], v13 offset:8704
v_mfma_f32_16x16x32_bf16 v[200:203], a[168:171], a[136:139], v[200:203]
buffer_load_dwordx4 v6, s[8:11], s64 offen offset:1024 lds
v_mfma_f32_16x16x32_bf16 v[204:207], a[172:175], a[136:139], v[204:207]
v_mfma_f32_16x16x32_bf16 v[64:67], a[136:139], a[176:179], v[64:67]
ds_read_b128 a[76:79], v9 offset:6144
v_mfma_f32_16x16x32_bf16 v[72:75], a[136:139], a[180:183], v[72:75]
s_add_u32 m0, s77, 49152
s_add_u32 s64, s76, 262144
v_mfma_f32_16x16x32_bf16 v[80:83], a[136:139], a[184:187], v[80:83]
v_mfma_f32_16x16x32_bf16 v[88:91], a[136:139], a[188:191], v[88:91]
buffer_load_dwordx4 v7, s[16:19], s64 offen lds
v_mfma_f32_16x16x32_bf16 v[92:95], a[140:143], a[188:191], v[92:95]
ds_read_b64_tr_b16 a[124:125], v14 offset:8192
ds_read_b64_tr_b16 a[126:127], v14 offset:8704
v_mfma_f32_16x16x32_bf16 v[84:87], a[140:143], a[184:187], v[84:87]
v_mfma_f32_16x16x32_bf16 v[76:79], a[140:143], a[180:183], v[76:79]
ds_read_b128 a[80:83], v9 offset:8192
v_mfma_f32_16x16x32_bf16 v[68:71], a[140:143], a[176:179], v[68:71]
v_mfma_f32_16x16x32_bf16 v[220:223], a[172:175], a[140:143], v[220:223]
buffer_load_dwordx4 v8, s[16:19], s64 offen offset:1024 lds
v_mfma_f32_16x16x32_bf16 v[216:219], a[168:171], a[140:143], v[216:219]
ds_read_b64_tr_b16 a[96:97], v11 offset:0
ds_read_b64_tr_b16 a[98:99], v11 offset:512
v_mfma_f32_16x16x32_bf16 v[212:215], a[164:167], a[140:143], v[212:215]
v_mfma_f32_16x16x32_bf16 v[208:211], a[160:163], a[140:143], v[208:211]
s_add_u32 m0, s77, 51200
s_add_u32 s64, s76, 393216
v_mfma_f32_16x16x32_bf16 v[224:227], a[160:163], a[144:147], v[224:227]
ds_read_b128 a[84:87], v9 offset:10240
v_mfma_f32_16x16x32_bf16 v[228:231], a[164:167], a[144:147], v[228:231]
buffer_load_dwordx4 v7, s[16:19], s64 offen lds
v_mfma_f32_16x16x32_bf16 v[232:235], a[168:171], a[144:147], v[232:235]
v_mfma_f32_16x16x32_bf16 v[236:239], a[172:175], a[144:147], v[236:239]
ds_read_b64_tr_b16 a[100:101], v12 offset:0
ds_read_b64_tr_b16 a[102:103], v12 offset:512
v_mfma_f32_16x16x32_bf16 v[96:99], a[144:147], a[176:179], v[96:99]
v_mfma_f32_16x16x32_bf16 v[104:107], a[144:147], a[180:183], v[104:107]
buffer_load_dwordx4 v8, s[16:19], s64 offen offset:1024 lds
v_mfma_f32_16x16x32_bf16 v[112:115], a[144:147], a[184:187], v[112:115]
s_xor_b32 s71, s70, 512
s_add_u32 s71, s68, s71
ds_read_b128 a[88:91], v9 offset:12288
v_mfma_f32_16x16x32_bf16 v[120:123], a[144:147], a[188:191], v[120:123]
v_mfma_f32_16x16x32_bf16 v[124:127], a[148:151], a[188:191], v[124:127]
s_add_u32 m0, s73, 32768
s_add_u32 s64, s71, 0
v_mfma_f32_16x16x32_bf16 v[116:119], a[148:151], a[184:187], v[116:119]
ds_read_b64_tr_b16 a[104:105], v13 offset:0
ds_read_b64_tr_b16 a[106:107], v13 offset:512
v_mfma_f32_16x16x32_bf16 v[108:111], a[148:151], a[180:183], v[108:111]
buffer_load_dwordx4 v5, s[8:11], s64 offen lds
v_mfma_f32_16x16x32_bf16 v[100:103], a[148:151], a[176:179], v[100:103]
v_mfma_f32_16x16x32_bf16 v[252:255], a[172:175], a[148:151], v[252:255]
ds_read_b128 a[92:95], v9 offset:14336
v_mfma_f32_16x16x32_bf16 v[248:251], a[168:171], a[148:151], v[248:251]
v_mfma_f32_16x16x32_bf16 v[244:247], a[164:167], a[148:151], v[244:247]
v_mfma_f32_16x16x32_bf16 v[240:243], a[160:163], a[148:151], v[240:243]
buffer_load_dwordx4 v6, s[8:11], s64 offen offset:1024 lds
v_mfma_f32_16x16x32_bf16 a[0:3], a[160:163], a[152:155], a[0:3]
ds_read_b64_tr_b16 a[108:109], v14 offset:0
ds_read_b64_tr_b16 a[110:111], v14 offset:512
v_mfma_f32_16x16x32_bf16 a[4:7], a[164:167], a[152:155], a[4:7]
v_mfma_f32_16x16x32_bf16 a[8:11], a[168:171], a[152:155], a[8:11]
s_add_u32 m0, s73, 34816
s_add_u32 s64, s71, 16384
v_mfma_f32_16x16x32_bf16 a[12:15], a[172:175], a[152:155], a[12:15]
v_mfma_f32_16x16x32_bf16 v[128:131], a[152:155], a[176:179], v[128:131]
buffer_load_dwordx4 v5, s[8:11], s64 offen lds
v_mfma_f32_16x16x32_bf16 v[136:139], a[152:155], a[180:183], v[136:139]
v_mfma_f32_16x16x32_bf16 v[144:147], a[152:155], a[184:187], v[144:147]
v_mfma_f32_16x16x32_bf16 v[152:155], a[152:155], a[188:191], v[152:155]
v_mfma_f32_16x16x32_bf16 v[156:159], a[156:159], a[188:191], v[156:159]
v_mfma_f32_16x16x32_bf16 v[148:151], a[156:159], a[184:187], v[148:151]
buffer_load_dwordx4 v6, s[8:11], s64 offen offset:1024 lds
v_mfma_f32_16x16x32_bf16 v[140:143], a[156:159], a[180:183], v[140:143]
v_mfma_f32_16x16x32_bf16 v[132:135], a[156:159], a[176:179], v[132:135]
v_mfma_f32_16x16x32_bf16 a[28:31], a[172:175], a[156:159], a[28:31]
v_mfma_f32_16x16x32_bf16 a[24:27], a[168:171], a[156:159], a[24:27]
v_mfma_f32_16x16x32_bf16 a[20:23], a[164:167], a[156:159], a[20:23]
v_mfma_f32_16x16x32_bf16 a[16:19], a[160:163], a[156:159], a[16:19]
s_waitcnt lgkmcnt(0)
v_mfma_f32_16x16x32_bf16 v[160:163], a[96:99], a[64:67], v[160:163]
s_waitcnt vmcnt(21)
v_mfma_f32_16x16x32_bf16 v[164:167], a[100:103], a[64:67], v[164:167]
s_barrier
v_mfma_f32_16x16x32_bf16 v[168:171], a[104:107], a[64:67], v[168:171]
ds_read_b128 a[128:131], v10 offset:0
v_mfma_f32_16x16x32_bf16 v[172:175], a[108:111], a[64:67], v[172:175]
s_xor_b32 s76, s75, 2097152
s_add_u32 s76, s74, s76
v_mfma_f32_16x16x32_bf16 v[32:35], a[64:67], a[112:115], v[32:35]
s_add_u32 m0, s77, 0
s_add_u32 s64, s76, 0
v_mfma_f32_16x16x32_bf16 v[40:43], a[64:67], a[116:119], v[40:43]
buffer_load_dwordx4 v7, s[16:19], s64 offen lds
v_mfma_f32_16x16x32_bf16 v[48:51], a[64:67], a[120:123], v[48:51]
ds_read_b64_tr_b16 a[176:177], v11 offset:24576
ds_read_b64_tr_b16 a[178:179], v11 offset:25088
v_mfma_f32_16x16x32_bf16 v[56:59], a[64:67], a[124:127], v[56:59]
v_mfma_f32_16x16x32_bf16 v[60:63], a[68:71], a[124:127], v[60:63]
ds_read_b128 a[132:135], v10 offset:2048
v_mfma_f32_16x16x32_bf16 v[52:55], a[68:71], a[120:123], v[52:55]
v_mfma_f32_16x16x32_bf16 v[44:47], a[68:71], a[116:119], v[44:47]
v_mfma_f32_16x16x32_bf16 v[36:39], a[68:71], a[112:115], v[36:39]
buffer_load_dwordx4 v8, s[16:19], s64 offen offset:1024 lds
v_mfma_f32_16x16x32_bf16 v[188:191], a[108:111], a[68:71], v[188:191]
ds_read_b64_tr_b16 a[180:181], v12 offset:24576
ds_read_b64_tr_b16 a[182:183], v12 offset:25088
v_mfma_f32_16x16x32_bf16 v[184:187], a[104:107], a[68:71], v[184:187]
v_mfma_f32_16x16x32_bf16 v[180:183], a[100:103], a[68:71], v[180:183]
ds_read_b128 a[136:139], v10 offset:4096
v_mfma_f32_16x16x32_bf16 v[176:179], a[96:99], a[68:71], v[176:179]
v_mfma_f32_16x16x32_bf16 v[192:195], a[96:99], a[72:75], v[192:195]
s_add_u32 m0, s77, 2048
s_add_u32 s64, s76, 131072
v_mfma_f32_16x16x32_bf16 v[196:199], a[100:103], a[72:75], v[196:199]
ds_read_b64_tr_b16 a[184:185], v13 offset:24576
ds_read_b64_tr_b16 a[186:187], v13 offset:25088
v_mfma_f32_16x16x32_bf16 v[200:203], a[104:107], a[72:75], v[200:203]
buffer_load_dwordx4 v7, s[16:19], s64 offen lds
v_mfma_f32_16x16x32_bf16 v[204:207], a[108:111], a[72:75], v[204:207]
v_mfma_f32_16x16x32_bf16 v[64:67], a[72:75], a[112:115], v[64:67]
ds_read_b128 a[140:143], v10 offset:6144
v_mfma_f32_16x16x32_bf16 v[72:75], a[72:75], a[116:119], v[72:75]
v_mfma_f32_16x16x32_bf16 v[80:83], a[72:75], a[120:123], v[80:83]
v_mfma_f32_16x16x32_bf16 v[88:91], a[72:75], a[124:127], v[88:91]
ds_read_b64_tr_b16 a[188:189], v14 offset:24576
ds_read_b64_tr_b16 a[190:191], v14 offset:25088
v_mfma_f32_16x16x32_bf16 v[92:95], a[76:79], a[124:127], v[92:95]
v_mfma_f32_16x16x32_bf16 v[84:87], a[76:79], a[120:123], v[84:87]
buffer_load_dwordx4 v8, s[16:19], s64 offen offset:1024 lds
v_mfma_f32_16x16x32_bf16 v[76:79], a[76:79], a[116:119], v[76:79]
ds_read_b128 a[144:147], v10 offset:8192
v_mfma_f32_16x16x32_bf16 v[68:71], a[76:79], a[112:115], v[68:71]
v_mfma_f32_16x16x32_bf16 v[220:223], a[108:111], a[76:79], v[220:223]
v_mfma_f32_16x16x32_bf16 v[216:219], a[104:107], a[76:79], v[216:219]
ds_read_b64_tr_b16 a[160:161], v11 offset:16384
ds_read_b64_tr_b16 a[162:163], v11 offset:16896
v_mfma_f32_16x16x32_bf16 v[212:215], a[100:103], a[76:79], v[212:215]
v_mfma_f32_16x16x32_bf16 v[208:211], a[96:99], a[76:79], v[208:211]
s_add_u32 m0, s73, 36864
s_add_u32 s64, s71, 524288
v_mfma_f32_16x16x32_bf16 v[224:227], a[96:99], a[80:83], v[224:227]
ds_read_b128 a[148:151], v10 offset:10240
v_mfma_f32_16x16x32_bf16 v[228:231], a[100:103], a[80:83], v[228:231]
buffer_load_dwordx4 v5, s[8:11], s64 offen lds
v_mfma_f32_16x16x32_bf16 v[232:235], a[104:107], a[80:83], v[232:235]
v_mfma_f32_16x16x32_bf16 v[236:239], a[108:111], a[80:83], v[236:239]
ds_read_b64_tr_b16 a[164:165], v12 offset:16384
ds_read_b64_tr_b16 a[166:167], v12 offset:16896
v_mfma_f32_16x16x32_bf16 v[96:99], a[80:83], a[112:115], v[96:99]
v_mfma_f32_16x16x32_bf16 v[104:107], a[80:83], a[116:119], v[104:107]
v_mfma_f32_16x16x32_bf16 v[112:115], a[80:83], a[120:123], v[112:115]
ds_read_b128 a[152:155], v10 offset:12288
v_mfma_f32_16x16x32_bf16 v[120:123], a[80:83], a[124:127], v[120:123]
v_mfma_f32_16x16x32_bf16 v[124:127], a[84:87], a[124:127], v[124:127]
buffer_load_dwordx4 v6, s[8:11], s64 offen offset:1024 lds
v_mfma_f32_16x16x32_bf16 v[116:119], a[84:87], a[120:123], v[116:119]
ds_read_b64_tr_b16 a[168:169], v13 offset:16384
ds_read_b64_tr_b16 a[170:171], v13 offset:16896
v_mfma_f32_16x16x32_bf16 v[108:111], a[84:87], a[116:119], v[108:111]
v_mfma_f32_16x16x32_bf16 v[100:103], a[84:87], a[112:115], v[100:103]
v_mfma_f32_16x16x32_bf16 v[252:255], a[108:111], a[84:87], v[252:255]
ds_read_b128 a[156:159], v10 offset:14336
v_mfma_f32_16x16x32_bf16 v[248:251], a[104:107], a[84:87], v[248:251]
s_add_u32 m0, s73, 38912
s_add_u32 s64, s71, 540672
v_mfma_f32_16x16x32_bf16 v[244:247], a[100:103], a[84:87], v[244:247]
v_mfma_f32_16x16x32_bf16 v[240:243], a[96:99], a[84:87], v[240:243]
buffer_load_dwordx4 v5, s[8:11], s64 offen lds
v_mfma_f32_16x16x32_bf16 a[0:3], a[96:99], a[88:91], a[0:3]
ds_read_b64_tr_b16 a[172:173], v14 offset:16384
ds_read_b64_tr_b16 a[174:175], v14 offset:16896
v_mfma_f32_16x16x32_bf16 a[4:7], a[100:103], a[88:91], a[4:7]
v_mfma_f32_16x16x32_bf16 a[8:11], a[104:107], a[88:91], a[8:11]
v_mfma_f32_16x16x32_bf16 a[12:15], a[108:111], a[88:91], a[12:15]
v_mfma_f32_16x16x32_bf16 v[128:131], a[88:91], a[112:115], v[128:131]
v_mfma_f32_16x16x32_bf16 v[136:139], a[88:91], a[116:119], v[136:139]
v_mfma_f32_16x16x32_bf16 v[144:147], a[88:91], a[120:123], v[144:147]
buffer_load_dwordx4 v6, s[8:11], s64 offen offset:1024 lds
v_mfma_f32_16x16x32_bf16 v[152:155], a[88:91], a[124:127], v[152:155]
v_mfma_f32_16x16x32_bf16 v[156:159], a[92:95], a[124:127], v[156:159]
v_add_u32 v9, -65536, v9
v_add_u32 v10, -65536, v10
v_mfma_f32_16x16x32_bf16 v[148:151], a[92:95], a[120:123], v[148:151]
v_mfma_f32_16x16x32_bf16 v[140:143], a[92:95], a[116:119], v[140:143]
v_mfma_f32_16x16x32_bf16 v[132:135], a[92:95], a[112:115], v[132:135]
v_mfma_f32_16x16x32_bf16 a[28:31], a[108:111], a[92:95], a[28:31]
v_mfma_f32_16x16x32_bf16 a[24:27], a[104:107], a[92:95], a[24:27]
v_mfma_f32_16x16x32_bf16 a[20:23], a[100:103], a[92:95], a[20:23]
v_mfma_f32_16x16x32_bf16 a[16:19], a[96:99], a[92:95], a[16:19]
s_waitcnt lgkmcnt(0)
v_mfma_f32_16x16x32_bf16 v[160:163], a[160:163], a[128:131], v[160:163]
s_waitcnt vmcnt(16)
v_mfma_f32_16x16x32_bf16 v[164:167], a[164:167], a[128:131], v[164:167]
s_barrier
v_mfma_f32_16x16x32_bf16 v[168:171], a[168:171], a[128:131], v[168:171]
s_add_u32 s52, s81, 0
ds_read_b128 a[64:67], v9 offset:0
v_mfma_f32_16x16x32_bf16 v[172:175], a[172:175], a[128:131], v[172:175]
s_add_u32 m0, s77, 16384
s_add_u32 s64, s76, 262144
v_mfma_f32_16x16x32_bf16 v[32:35], a[128:131], a[176:179], v[32:35]
buffer_load_dwordx4 v7, s[16:19], s64 offen lds
v_mfma_f32_16x16x32_bf16 v[40:43], a[128:131], a[180:183], v[40:43]
ds_read_b64_tr_b16 a[112:113], v11 offset:40960
ds_read_b64_tr_b16 a[114:115], v11 offset:41472
v_mfma_f32_16x16x32_bf16 v[48:51], a[128:131], a[184:187], v[48:51]
buffer_load_dwordx2 a[192:193], v26, s[28:31], s52 offen
v_mfma_f32_16x16x32_bf16 v[56:59], a[128:131], a[188:191], v[56:59]
v_mfma_f32_16x16x32_bf16 v[60:63], a[132:135], a[188:191], v[60:63]
ds_read_b128 a[68:71], v9 offset:2048
v_mfma_f32_16x16x32_bf16 v[52:55], a[132:135], a[184:187], v[52:55]
v_mfma_f32_16x16x32_bf16 v[44:47], a[132:135], a[180:183], v[44:47]
v_mfma_f32_16x16x32_bf16 v[36:39], a[132:135], a[176:179], v[36:39]
buffer_load_dwordx4 v8, s[16:19], s64 offen offset:1024 lds
v_mfma_f32_16x16x32_bf16 v[188:191], a[172:175], a[132:135], v[188:191]
s_add_u32 s52, s81, 3456
ds_read_b64_tr_b16 a[116:117], v12 offset:40960
ds_read_b64_tr_b16 a[118:119], v12 offset:41472
v_mfma_f32_16x16x32_bf16 v[184:187], a[168:171], a[132:135], v[184:187]
buffer_load_dwordx2 a[194:195], v26, s[28:31], s52 offen
v_mfma_f32_16x16x32_bf16 v[180:183], a[164:167], a[132:135], v[180:183]
ds_read_b128 a[72:75], v9 offset:4096
v_mfma_f32_16x16x32_bf16 v[176:179], a[160:163], a[132:135], v[176:179]
v_mfma_f32_16x16x32_bf16 v[192:195], a[160:163], a[136:139], v[192:195]
s_add_u32 m0, s77, 18432
s_add_u32 s64, s76, 393216
v_mfma_f32_16x16x32_bf16 v[196:199], a[164:167], a[136:139], v[196:199]
ds_read_b64_tr_b16 a[120:121], v13 offset:40960
ds_read_b64_tr_b16 a[122:123], v13 offset:41472
v_mfma_f32_16x16x32_bf16 v[200:203], a[168:171], a[136:139], v[200:203]
buffer_load_dwordx4 v7, s[16:19], s64 offen lds
v_mfma_f32_16x16x32_bf16 v[204:207], a[172:175], a[136:139], v[204:207]
s_add_u32 s52, s81, 6912
v_mfma_f32_16x16x32_bf16 v[64:67], a[136:139], a[176:179], v[64:67]
ds_read_b128 a[76:79], v9 offset:6144
v_mfma_f32_16x16x32_bf16 v[72:75], a[136:139], a[180:183], v[72:75]
buffer_load_dwordx2 a[196:197], v26, s[28:31], s52 offen
v_mfma_f32_16x16x32_bf16 v[80:83], a[136:139], a[184:187], v[80:83]
v_mfma_f32_16x16x32_bf16 v[88:91], a[136:139], a[188:191], v[88:91]
ds_read_b64_tr_b16 a[124:125], v14 offset:40960
ds_read_b64_tr_b16 a[126:127], v14 offset:41472
v_mfma_f32_16x16x32_bf16 v[92:95], a[140:143], a[188:191], v[92:95]
v_mfma_f32_16x16x32_bf16 v[84:87], a[140:143], a[184:187], v[84:87]
buffer_load_dwordx4 v8, s[16:19], s64 offen offset:1024 lds
v_mfma_f32_16x16x32_bf16 v[76:79], a[140:143], a[180:183], v[76:79]
s_xor_b32 s71, s70, 640
s_add_u32 s71, s68, s71
ds_read_b128 a[80:83], v9 offset:8192
v_mfma_f32_16x16x32_bf16 v[68:71], a[140:143], a[176:179], v[68:71]
s_add_u32 s52, s81, 10368
v_mfma_f32_16x16x32_bf16 v[220:223], a[172:175], a[140:143], v[220:223]
buffer_load_dwordx2 a[198:199], v26, s[28:31], s52 offen
v_mfma_f32_16x16x32_bf16 v[216:219], a[168:171], a[140:143], v[216:219]
ds_read_b64_tr_b16 a[96:97], v11 offset:32768
ds_read_b64_tr_b16 a[98:99], v11 offset:33280
v_mfma_f32_16x16x32_bf16 v[212:215], a[164:167], a[140:143], v[212:215]
v_mfma_f32_16x16x32_bf16 v[208:211], a[160:163], a[140:143], v[208:211]
s_add_u32 m0, s73, 65536
s_add_u32 s64, s71, 0
v_mfma_f32_16x16x32_bf16 v[224:227], a[160:163], a[144:147], v[224:227]
ds_read_b128 a[84:87], v9 offset:10240
v_mfma_f32_16x16x32_bf16 v[228:231], a[164:167], a[144:147], v[228:231]
buffer_load_dwordx4 v5, s[8:11], s64 offen lds
v_mfma_f32_16x16x32_bf16 v[232:235], a[168:171], a[144:147], v[232:235]
s_add_u32 s52, s81, 13824
v_mfma_f32_16x16x32_bf16 v[236:239], a[172:175], a[144:147], v[236:239]
ds_read_b64_tr_b16 a[100:101], v12 offset:32768
ds_read_b64_tr_b16 a[102:103], v12 offset:33280
v_mfma_f32_16x16x32_bf16 v[96:99], a[144:147], a[176:179], v[96:99]
buffer_load_dwordx2 a[200:201], v26, s[28:31], s52 offen
v_mfma_f32_16x16x32_bf16 v[104:107], a[144:147], a[180:183], v[104:107]
v_mfma_f32_16x16x32_bf16 v[112:115], a[144:147], a[184:187], v[112:115]
ds_read_b128 a[88:91], v9 offset:12288
v_mfma_f32_16x16x32_bf16 v[120:123], a[144:147], a[188:191], v[120:123]
v_mfma_f32_16x16x32_bf16 v[124:127], a[148:151], a[188:191], v[124:127]
buffer_load_dwordx4 v6, s[8:11], s64 offen offset:1024 lds
v_mfma_f32_16x16x32_bf16 v[116:119], a[148:151], a[184:187], v[116:119]
s_add_u32 s52, s81, 17280
ds_read_b64_tr_b16 a[104:105], v13 offset:32768
ds_read_b64_tr_b16 a[106:107], v13 offset:33280
v_mfma_f32_16x16x32_bf16 v[108:111], a[148:151], a[180:183], v[108:111]
buffer_load_dwordx2 a[202:203], v26, s[28:31], s52 offen
v_mfma_f32_16x16x32_bf16 v[100:103], a[148:151], a[176:179], v[100:103]
v_mfma_f32_16x16x32_bf16 v[252:255], a[172:175], a[148:151], v[252:255]
ds_read_b128 a[92:95], v9 offset:14336
v_mfma_f32_16x16x32_bf16 v[248:251], a[168:171], a[148:151], v[248:251]
s_add_u32 m0, s73, 67584
s_add_u32 s64, s71, 16384
v_mfma_f32_16x16x32_bf16 v[244:247], a[164:167], a[148:151], v[244:247]
v_mfma_f32_16x16x32_bf16 v[240:243], a[160:163], a[148:151], v[240:243]
buffer_load_dwordx4 v5, s[8:11], s64 offen lds
v_mfma_f32_16x16x32_bf16 a[0:3], a[160:163], a[152:155], a[0:3]
s_add_u32 s52, s81, 20736
ds_read_b64_tr_b16 a[108:109], v14 offset:32768
ds_read_b64_tr_b16 a[110:111], v14 offset:33280
v_mfma_f32_16x16x32_bf16 a[4:7], a[164:167], a[152:155], a[4:7]
buffer_load_dwordx2 a[204:205], v26, s[28:31], s52 offen
v_mfma_f32_16x16x32_bf16 a[8:11], a[168:171], a[152:155], a[8:11]
v_mfma_f32_16x16x32_bf16 a[12:15], a[172:175], a[152:155], a[12:15]
v_mfma_f32_16x16x32_bf16 v[128:131], a[152:155], a[176:179], v[128:131]
v_mfma_f32_16x16x32_bf16 v[136:139], a[152:155], a[180:183], v[136:139]
v_mfma_f32_16x16x32_bf16 v[144:147], a[152:155], a[184:187], v[144:147]
buffer_load_dwordx4 v6, s[8:11], s64 offen offset:1024 lds
v_mfma_f32_16x16x32_bf16 v[152:155], a[152:155], a[188:191], v[152:155]
s_add_u32 s52, s81, 24192
v_mfma_f32_16x16x32_bf16 v[156:159], a[156:159], a[188:191], v[156:159]
buffer_load_dwordx2 a[206:207], v26, s[28:31], s52 offen
v_mfma_f32_16x16x32_bf16 v[148:151], a[156:159], a[184:187], v[148:151]
v_mfma_f32_16x16x32_bf16 v[140:143], a[156:159], a[180:183], v[140:143]
v_mfma_f32_16x16x32_bf16 v[132:135], a[156:159], a[176:179], v[132:135]
v_mfma_f32_16x16x32_bf16 a[28:31], a[172:175], a[156:159], a[28:31]
v_mfma_f32_16x16x32_bf16 a[24:27], a[168:171], a[156:159], a[24:27]
buffer_load_dwordx4 a[208:211], v27, s[36:39], s83 offen
v_mfma_f32_16x16x32_bf16 a[20:23], a[164:167], a[156:159], a[20:23]
v_mfma_f32_16x16x32_bf16 a[16:19], a[160:163], a[156:159], a[16:19]
s_waitcnt lgkmcnt(0)
v_mfma_f32_16x16x32_bf16 v[160:163], a[96:99], a[64:67], v[160:163]
s_waitcnt vmcnt(29)
v_mfma_f32_16x16x32_bf16 v[164:167], a[100:103], a[64:67], v[164:167]
s_barrier
v_mfma_f32_16x16x32_bf16 v[168:171], a[104:107], a[64:67], v[168:171]
ds_read_b128 a[128:131], v10 offset:0
v_mfma_f32_16x16x32_bf16 v[172:175], a[108:111], a[64:67], v[172:175]
s_xor_b32 s76, s75, 2621440
s_add_u32 s76, s74, s76
v_mfma_f32_16x16x32_bf16 v[32:35], a[64:67], a[112:115], v[32:35]
s_add_u32 m0, s77, 32768
s_add_u32 s64, s76, 0
v_mfma_f32_16x16x32_bf16 v[40:43], a[64:67], a[116:119], v[40:43]
buffer_load_dwordx4 v7, s[16:19], s64 offen lds
v_mfma_f32_16x16x32_bf16 v[48:51], a[64:67], a[120:123], v[48:51]
ds_read_b64_tr_b16 a[176:177], v11 offset:57344
ds_read_b64_tr_b16 a[178:179], v11 offset:57856
v_mfma_f32_16x16x32_bf16 v[56:59], a[64:67], a[124:127], v[56:59]
v_mfma_f32_16x16x32_bf16 v[60:63], a[68:71], a[124:127], v[60:63]
ds_read_b128 a[132:135], v10 offset:2048
v_mfma_f32_16x16x32_bf16 v[52:55], a[68:71], a[120:123], v[52:55]
v_mfma_f32_16x16x32_bf16 v[44:47], a[68:71], a[116:119], v[44:47]
v_mfma_f32_16x16x32_bf16 v[36:39], a[68:71], a[112:115], v[36:39]
buffer_load_dwordx4 v8, s[16:19], s64 offen offset:1024 lds
v_mfma_f32_16x16x32_bf16 v[188:191], a[108:111], a[68:71], v[188:191]
ds_read_b64_tr_b16 a[180:181], v12 offset:57344
ds_read_b64_tr_b16 a[182:183], v12 offset:57856
v_mfma_f32_16x16x32_bf16 v[184:187], a[104:107], a[68:71], v[184:187]
v_mfma_f32_16x16x32_bf16 v[180:183], a[100:103], a[68:71], v[180:183]
ds_read_b128 a[136:139], v10 offset:4096
v_mfma_f32_16x16x32_bf16 v[176:179], a[96:99], a[68:71], v[176:179]
v_mfma_f32_16x16x32_bf16 v[192:195], a[96:99], a[72:75], v[192:195]
s_add_u32 m0, s77, 34816
s_add_u32 s64, s76, 131072
v_mfma_f32_16x16x32_bf16 v[196:199], a[100:103], a[72:75], v[196:199]
ds_read_b64_tr_b16 a[184:185], v13 offset:57344
ds_read_b64_tr_b16 a[186:187], v13 offset:57856
v_mfma_f32_16x16x32_bf16 v[200:203], a[104:107], a[72:75], v[200:203]
buffer_load_dwordx4 v7, s[16:19], s64 offen lds
v_mfma_f32_16x16x32_bf16 v[204:207], a[108:111], a[72:75], v[204:207]
v_mfma_f32_16x16x32_bf16 v[64:67], a[72:75], a[112:115], v[64:67]
ds_read_b128 a[140:143], v10 offset:6144
v_mfma_f32_16x16x32_bf16 v[72:75], a[72:75], a[116:119], v[72:75]
v_mfma_f32_16x16x32_bf16 v[80:83], a[72:75], a[120:123], v[80:83]
v_mfma_f32_16x16x32_bf16 v[88:91], a[72:75], a[124:127], v[88:91]
ds_read_b64_tr_b16 a[188:189], v14 offset:57344
ds_read_b64_tr_b16 a[190:191], v14 offset:57856
v_mfma_f32_16x16x32_bf16 v[92:95], a[76:79], a[124:127], v[92:95]
v_mfma_f32_16x16x32_bf16 v[84:87], a[76:79], a[120:123], v[84:87]
buffer_load_dwordx4 v8, s[16:19], s64 offen offset:1024 lds
v_mfma_f32_16x16x32_bf16 v[76:79], a[76:79], a[116:119], v[76:79]
ds_read_b128 a[144:147], v10 offset:8192
v_mfma_f32_16x16x32_bf16 v[68:71], a[76:79], a[112:115], v[68:71]
v_mfma_f32_16x16x32_bf16 v[220:223], a[108:111], a[76:79], v[220:223]
v_mfma_f32_16x16x32_bf16 v[216:219], a[104:107], a[76:79], v[216:219]
ds_read_b64_tr_b16 a[160:161], v11 offset:49152
ds_read_b64_tr_b16 a[162:163], v11 offset:49664
v_mfma_f32_16x16x32_bf16 v[212:215], a[100:103], a[76:79], v[212:215]
v_mfma_f32_16x16x32_bf16 v[208:211], a[96:99], a[76:79], v[208:211]
s_add_u32 m0, s73, 69632
s_add_u32 s64, s71, 524288
v_mfma_f32_16x16x32_bf16 v[224:227], a[96:99], a[80:83], v[224:227]
ds_read_b128 a[148:151], v10 offset:10240
v_mfma_f32_16x16x32_bf16 v[228:231], a[100:103], a[80:83], v[228:231]
buffer_load_dwordx4 v5, s[8:11], s64 offen lds
v_mfma_f32_16x16x32_bf16 v[232:235], a[104:107], a[80:83], v[232:235]
v_mfma_f32_16x16x32_bf16 v[236:239], a[108:111], a[80:83], v[236:239]
ds_read_b64_tr_b16 a[164:165], v12 offset:49152
ds_read_b64_tr_b16 a[166:167], v12 offset:49664
v_mfma_f32_16x16x32_bf16 v[96:99], a[80:83], a[112:115], v[96:99]
v_mfma_f32_16x16x32_bf16 v[104:107], a[80:83], a[116:119], v[104:107]
s_waitcnt vmcnt(5)
v_mfma_f32_16x16x32_bf16 v[112:115], a[80:83], a[120:123], v[112:115]
ds_read_b128 a[152:155], v10 offset:12288
v_accvgpr_read_b32 v16, a192
v_mfma_f32_16x16x32_bf16 v[120:123], a[80:83], a[124:127], v[120:123]
v_accvgpr_read_b32 v17, a194
v_accvgpr_read_b32 v18, a196
v_mfma_f32_16x16x32_bf16 v[124:127], a[84:87], a[124:127], v[124:127]
buffer_load_dwordx4 v6, s[8:11], s64 offen offset:1024 lds
v_mfma_f32_16x16x32_bf16 v[116:119], a[84:87], a[120:123], v[116:119]
ds_read_b64_tr_b16 a[168:169], v13 offset:49152
ds_read_b64_tr_b16 a[170:171], v13 offset:49664
v_mfma_f32_16x16x32_bf16 v[108:111], a[84:87], a[116:119], v[108:111]
v_accvgpr_read_b32 v19, a198
v_accvgpr_read_b32 v20, a200
v_mfma_f32_16x16x32_bf16 v[100:103], a[84:87], a[112:115], v[100:103]
v_accvgpr_read_b32 v21, a202
v_accvgpr_read_b32 v22, a204
v_mfma_f32_16x16x32_bf16 v[252:255], a[108:111], a[84:87], v[252:255]
ds_read_b128 a[156:159], v10 offset:14336
v_accvgpr_read_b32 v23, a206
v_mfma_f32_16x16x32_bf16 v[248:251], a[104:107], a[84:87], v[248:251]
s_add_u32 m0, s73, 71680
s_add_u32 s64, s71, 540672
v_mfma_f32_16x16x32_bf16 v[244:247], a[100:103], a[84:87], v[244:247]
v_perm_b32 v24, v17, v16, s85
v_perm_b32 v25, v19, v18, s85
v_mfma_f32_16x16x32_bf16 v[240:243], a[96:99], a[84:87], v[240:243]
buffer_load_dwordx4 v5, s[8:11], s64 offen lds
v_mfma_f32_16x16x32_bf16 a[0:3], a[96:99], a[88:91], a[0:3]
ds_read_b64_tr_b16 a[172:173], v14 offset:49152
ds_read_b64_tr_b16 a[174:175], v14 offset:49664
v_mfma_f32_16x16x32_bf16 a[4:7], a[100:103], a[88:91], a[4:7]
v_perm_b32 v26, v21, v20, s85
v_perm_b32 v27, v23, v22, s85
v_mfma_f32_16x16x32_bf16 a[8:11], a[104:107], a[88:91], a[8:11]
v_perm_b32 v28, v17, v16, s86
v_perm_b32 v29, v19, v18, s86
v_mfma_f32_16x16x32_bf16 a[12:15], a[108:111], a[88:91], a[12:15]
v_perm_b32 v30, v21, v20, s86
v_perm_b32 v31, v23, v22, s86
v_mfma_f32_16x16x32_bf16 v[128:131], a[88:91], a[112:115], v[128:131]
v_accvgpr_read_b32 v16, a208
v_accvgpr_read_b32 v17, a209
v_mfma_f32_16x16x32_bf16 v[136:139], a[88:91], a[116:119], v[136:139]
v_accvgpr_read_b32 v18, a210
v_accvgpr_read_b32 v19, a211
v_mfma_f32_16x16x32_bf16 v[144:147], a[88:91], a[120:123], v[144:147]
buffer_load_dwordx4 v6, s[8:11], s64 offen offset:1024 lds
v_mfma_f32_16x16x32_bf16 v[152:155], a[88:91], a[124:127], v[152:155]
v_or_b32 v24, v24, v16
v_or_b32 v25, v25, v17
v_mfma_f32_16x16x32_bf16 v[156:159], a[92:95], a[124:127], v[156:159]
v_add_u32 v9, 32768, v9
v_add_u32 v10, 32768, v10
v_mfma_f32_16x16x32_bf16 v[148:151], a[92:95], a[120:123], v[148:151]
v_or_b32 v26, v26, v18
v_or_b32 v27, v27, v19
v_mfma_f32_16x16x32_bf16 v[140:143], a[92:95], a[116:119], v[140:143]
buffer_store_dwordx4 v[24:27], v4, s[24:27], s82 offen offset:0 sc1
v_mfma_f32_16x16x32_bf16 v[132:135], a[92:95], a[112:115], v[132:135]
v_mfma_f32_16x16x32_bf16 a[28:31], a[108:111], a[92:95], a[28:31]
v_mfma_f32_16x16x32_bf16 a[24:27], a[104:107], a[92:95], a[24:27]
v_mfma_f32_16x16x32_bf16 a[20:23], a[100:103], a[92:95], a[20:23]
v_mfma_f32_16x16x32_bf16 a[16:19], a[96:99], a[92:95], a[16:19]
s_waitcnt lgkmcnt(0)
v_mfma_f32_16x16x32_bf16 v[160:163], a[160:163], a[128:131], v[160:163]
s_waitcnt vmcnt(26)
v_mfma_f32_16x16x32_bf16 v[164:167], a[164:167], a[128:131], v[164:167]
s_barrier
v_mfma_f32_16x16x32_bf16 v[168:171], a[168:171], a[128:131], v[168:171]
ds_read_b128 a[64:67], v9 offset:0
v_mfma_f32_16x16x32_bf16 v[172:175], a[172:175], a[128:131], v[172:175]
s_add_u32 m0, s77, 49152
s_add_u32 s64, s76, 262144
v_mfma_f32_16x16x32_bf16 v[32:35], a[128:131], a[176:179], v[32:35]
buffer_load_dwordx4 v7, s[16:19], s64 offen lds
v_mfma_f32_16x16x32_bf16 v[40:43], a[128:131], a[180:183], v[40:43]
ds_read_b64_tr_b16 a[112:113], v11 offset:8192
ds_read_b64_tr_b16 a[114:115], v11 offset:8704
v_mfma_f32_16x16x32_bf16 v[48:51], a[128:131], a[184:187], v[48:51]
buffer_store_dwordx4 v[28:31], v4, s[24:27], s82 offen offset:1024 sc1
v_mfma_f32_16x16x32_bf16 v[56:59], a[128:131], a[188:191], v[56:59]
v_accvgpr_read_b32 v16, a193
v_accvgpr_read_b32 v17, a195
v_mfma_f32_16x16x32_bf16 v[60:63], a[132:135], a[188:191], v[60:63]
ds_read_b128 a[68:71], v9 offset:2048
v_accvgpr_read_b32 v18, a197
v_mfma_f32_16x16x32_bf16 v[52:55], a[132:135], a[184:187], v[52:55]
v_accvgpr_read_b32 v19, a199
v_accvgpr_read_b32 v20, a201
v_mfma_f32_16x16x32_bf16 v[44:47], a[132:135], a[180:183], v[44:47]
v_accvgpr_read_b32 v21, a203
v_accvgpr_read_b32 v22, a205
v_mfma_f32_16x16x32_bf16 v[36:39], a[132:135], a[176:179], v[36:39]
buffer_load_dwordx4 v8, s[16:19], s64 offen offset:1024 lds
v_mfma_f32_16x16x32_bf16 v[188:191], a[172:175], a[132:135], v[188:191]
ds_read_b64_tr_b16 a[116:117], v12 offset:8192
ds_read_b64_tr_b16 a[118:119], v12 offset:8704
v_mfma_f32_16x16x32_bf16 v[184:187], a[168:171], a[132:135], v[184:187]
v_accvgpr_read_b32 v23, a207
v_mfma_f32_16x16x32_bf16 v[180:183], a[164:167], a[132:135], v[180:183]
ds_read_b128 a[72:75], v9 offset:4096
v_mfma_f32_16x16x32_bf16 v[176:179], a[160:163], a[132:135], v[176:179]
v_perm_b32 v24, v17, v16, s85
v_perm_b32 v25, v19, v18, s85
v_mfma_f32_16x16x32_bf16 v[192:195], a[160:163], a[136:139], v[192:195]
s_add_u32 m0, s77, 51200
s_add_u32 s64, s76, 393216
v_perm_b32 v26, v21, v20, s85
v_mfma_f32_16x16x32_bf16 v[196:199], a[164:167], a[136:139], v[196:199]
ds_read_b64_tr_b16 a[120:121], v13 offset:8192
ds_read_b64_tr_b16 a[122:123], v13 offset:8704
v_mfma_f32_16x16x32_bf16 v[200:203], a[168:171], a[136:139], v[200:203]
buffer_load_dwordx4 v7, s[16:19], s64 offen lds
v_mfma_f32_16x16x32_bf16 v[204:207], a[172:175], a[136:139], v[204:207]
v_perm_b32 v27, v23, v22, s85
v_perm_b32 v28, v17, v16, s86
v_mfma_f32_16x16x32_bf16 v[64:67], a[136:139], a[176:179], v[64:67]
ds_read_b128 a[76:79], v9 offset:6144
v_perm_b32 v29, v19, v18, s86
v_mfma_f32_16x16x32_bf16 v[72:75], a[136:139], a[180:183], v[72:75]
v_perm_b32 v30, v21, v20, s86
v_perm_b32 v31, v23, v22, s86
v_mfma_f32_16x16x32_bf16 v[80:83], a[136:139], a[184:187], v[80:83]
buffer_store_dwordx4 v[24:27], v4, s[24:27], s82 offen offset:2048 sc1
v_mfma_f32_16x16x32_bf16 v[88:91], a[136:139], a[188:191], v[88:91]
ds_read_b64_tr_b16 a[124:125], v14 offset:8192
ds_read_b64_tr_b16 a[126:127], v14 offset:8704
v_mfma_f32_16x16x32_bf16 v[92:95], a[140:143], a[188:191], v[92:95]
v_mfma_f32_16x16x32_bf16 v[84:87], a[140:143], a[184:187], v[84:87]
buffer_load_dwordx4 v8, s[16:19], s64 offen offset:1024 lds
v_mfma_f32_16x16x32_bf16 v[76:79], a[140:143], a[180:183], v[76:79]
s_xor_b32 s71, s70, 768
s_add_u32 s71, s68, s71
ds_read_b128 a[80:83], v9 offset:8192
v_mfma_f32_16x16x32_bf16 v[68:71], a[140:143], a[176:179], v[68:71]
v_mfma_f32_16x16x32_bf16 v[220:223], a[172:175], a[140:143], v[220:223]
buffer_store_dwordx4 v[28:31], v4, s[24:27], s82 offen offset:3072 sc1
v_mfma_f32_16x16x32_bf16 v[216:219], a[168:171], a[140:143], v[216:219]
s_lshl_b32 s52, s7, 4
ds_read_b64_tr_b16 a[96:97], v11 offset:0
ds_read_b64_tr_b16 a[98:99], v11 offset:512
v_mfma_f32_16x16x32_bf16 v[212:215], a[164:167], a[140:143], v[212:215]
v_and_b32 v22, 3, v1
v_lshl_add_u32 v22, v22, 2, s52
v_mfma_f32_16x16x32_bf16 v[208:211], a[160:163], a[140:143], v[208:211]
s_add_u32 m0, s73, 0
s_add_u32 s64, s71, 0
v_mfma_f32_16x16x32_bf16 v[224:227], a[160:163], a[144:147], v[224:227]
ds_read_b128 a[84:87], v9 offset:10240
v_mfma_f32_16x16x32_bf16 v[228:231], a[164:167], a[144:147], v[228:231]
buffer_load_dwordx4 v5, s[8:11], s64 offen lds
v_mfma_f32_16x16x32_bf16 v[232:235], a[168:171], a[144:147], v[232:235]
buffer_load_dword v23, v22, s[40:43], 0 offen sc1
v_mfma_f32_16x16x32_bf16 v[236:239], a[172:175], a[144:147], v[236:239]
ds_read_b64_tr_b16 a[100:101], v12 offset:0
ds_read_b64_tr_b16 a[102:103], v12 offset:512
v_mfma_f32_16x16x32_bf16 v[96:99], a[144:147], a[176:179], v[96:99]
v_mfma_f32_16x16x32_bf16 v[104:107], a[144:147], a[180:183], v[104:107]
v_mfma_f32_16x16x32_bf16 v[112:115], a[144:147], a[184:187], v[112:115]
ds_read_b128 a[88:91], v9 offset:12288
v_mfma_f32_16x16x32_bf16 v[120:123], a[144:147], a[188:191], v[120:123]
v_mfma_f32_16x16x32_bf16 v[124:127], a[148:151], a[188:191], v[124:127]
buffer_load_dwordx4 v6, s[8:11], s64 offen offset:1024 lds
v_mfma_f32_16x16x32_bf16 v[116:119], a[148:151], a[184:187], v[116:119]
ds_read_b64_tr_b16 a[104:105], v13 offset:0
ds_read_b64_tr_b16 a[106:107], v13 offset:512
v_mfma_f32_16x16x32_bf16 v[108:111], a[148:151], a[180:183], v[108:111]
v_mfma_f32_16x16x32_bf16 v[100:103], a[148:151], a[176:179], v[100:103]
v_mfma_f32_16x16x32_bf16 v[252:255], a[172:175], a[148:151], v[252:255]
ds_read_b128 a[92:95], v9 offset:14336
v_mfma_f32_16x16x32_bf16 v[248:251], a[168:171], a[148:151], v[248:251]
s_add_u32 m0, s73, 2048
s_add_u32 s64, s71, 16384
v_mfma_f32_16x16x32_bf16 v[244:247], a[164:167], a[148:151], v[244:247]
v_mfma_f32_16x16x32_bf16 v[240:243], a[160:163], a[148:151], v[240:243]
buffer_load_dwordx4 v5, s[8:11], s64 offen lds
v_mfma_f32_16x16x32_bf16 a[0:3], a[160:163], a[152:155], a[0:3]
ds_read_b64_tr_b16 a[108:109], v14 offset:0
ds_read_b64_tr_b16 a[110:111], v14 offset:512
v_mfma_f32_16x16x32_bf16 a[4:7], a[164:167], a[152:155], a[4:7]
v_mfma_f32_16x16x32_bf16 a[8:11], a[168:171], a[152:155], a[8:11]
v_mfma_f32_16x16x32_bf16 a[12:15], a[172:175], a[152:155], a[12:15]
v_mfma_f32_16x16x32_bf16 v[128:131], a[152:155], a[176:179], v[128:131]
v_mfma_f32_16x16x32_bf16 v[136:139], a[152:155], a[180:183], v[136:139]
v_mfma_f32_16x16x32_bf16 v[144:147], a[152:155], a[184:187], v[144:147]
buffer_load_dwordx4 v6, s[8:11], s64 offen offset:1024 lds
v_mfma_f32_16x16x32_bf16 v[152:155], a[152:155], a[188:191], v[152:155]
v_mfma_f32_16x16x32_bf16 v[156:159], a[156:159], a[188:191], v[156:159]
v_mfma_f32_16x16x32_bf16 v[148:151], a[156:159], a[184:187], v[148:151]
v_mfma_f32_16x16x32_bf16 v[140:143], a[156:159], a[180:183], v[140:143]
v_mfma_f32_16x16x32_bf16 v[132:135], a[156:159], a[176:179], v[132:135]
v_mfma_f32_16x16x32_bf16 a[28:31], a[172:175], a[156:159], a[28:31]
v_mfma_f32_16x16x32_bf16 a[24:27], a[168:171], a[156:159], a[24:27]
v_mfma_f32_16x16x32_bf16 a[20:23], a[164:167], a[156:159], a[20:23]
v_mfma_f32_16x16x32_bf16 a[16:19], a[160:163], a[156:159], a[16:19]
s_waitcnt lgkmcnt(0)
v_mfma_f32_16x16x32_bf16 v[160:163], a[96:99], a[64:67], v[160:163]
s_waitcnt vmcnt(31)
v_mfma_f32_16x16x32_bf16 v[164:167], a[100:103], a[64:67], v[164:167]
s_barrier
v_mfma_f32_16x16x32_bf16 v[168:171], a[104:107], a[64:67], v[168:171]
ds_read_b128 a[128:131], v10 offset:0
v_mfma_f32_16x16x32_bf16 v[172:175], a[108:111], a[64:67], v[172:175]
s_xor_b32 s76, s75, 3145728
s_add_u32 s76, s74, s76
v_mfma_f32_16x16x32_bf16 v[32:35], a[64:67], a[112:115], v[32:35]
s_add_u32 m0, s77, 0
s_add_u32 s64, s76, 0
v_mfma_f32_16x16x32_bf16 v[40:43], a[64:67], a[116:119], v[40:43]
buffer_load_dwordx4 v7, s[16:19], s64 offen lds
v_mfma_f32_16x16x32_bf16 v[48:51], a[64:67], a[120:123], v[48:51]
ds_read_b64_tr_b16 a[176:177], v11 offset:24576
ds_read_b64_tr_b16 a[178:179], v11 offset:25088
v_mfma_f32_16x16x32_bf16 v[56:59], a[64:67], a[124:127], v[56:59]
v_mfma_f32_16x16x32_bf16 v[60:63], a[68:71], a[124:127], v[60:63]
ds_read_b128 a[132:135], v10 offset:2048
v_mfma_f32_16x16x32_bf16 v[52:55], a[68:71], a[120:123], v[52:55]
v_mfma_f32_16x16x32_bf16 v[44:47], a[68:71], a[116:119], v[44:47]
v_mfma_f32_16x16x32_bf16 v[36:39], a[68:71], a[112:115], v[36:39]
buffer_load_dwordx4 v8, s[16:19], s64 offen offset:1024 lds
v_mfma_f32_16x16x32_bf16 v[188:191], a[108:111], a[68:71], v[188:191]
ds_read_b64_tr_b16 a[180:181], v12 offset:24576
ds_read_b64_tr_b16 a[182:183], v12 offset:25088
v_mfma_f32_16x16x32_bf16 v[184:187], a[104:107], a[68:71], v[184:187]
v_mfma_f32_16x16x32_bf16 v[180:183], a[100:103], a[68:71], v[180:183]
ds_read_b128 a[136:139], v10 offset:4096
v_mfma_f32_16x16x32_bf16 v[176:179], a[96:99], a[68:71], v[176:179]
v_mfma_f32_16x16x32_bf16 v[192:195], a[96:99], a[72:75], v[192:195]
s_add_u32 m0, s77, 2048
s_add_u32 s64, s76, 131072
s_waitcnt vmcnt(5)
v_mfma_f32_16x16x32_bf16 v[196:199], a[100:103], a[72:75], v[196:199]
ds_read_b64_tr_b16 a[184:185], v13 offset:24576
ds_read_b64_tr_b16 a[186:187], v13 offset:25088
v_mfma_f32_16x16x32_bf16 v[200:203], a[104:107], a[72:75], v[200:203]
buffer_load_dwordx4 v7, s[16:19], s64 offen lds
v_mfma_f32_16x16x32_bf16 v[204:207], a[108:111], a[72:75], v[204:207]
v_cmp_gt_u32 vcc, 1, v23
v_mfma_f32_16x16x32_bf16 v[64:67], a[72:75], a[112:115], v[64:67]
ds_read_b128 a[140:143], v10 offset:6144
v_mfma_f32_16x16x32_bf16 v[72:75], a[72:75], a[116:119], v[72:75]
v_mfma_f32_16x16x32_bf16 v[80:83], a[72:75], a[120:123], v[80:83]
v_mfma_f32_16x16x32_bf16 v[88:91], a[72:75], a[124:127], v[88:91]
ds_read_b64_tr_b16 a[188:189], v14 offset:24576
ds_read_b64_tr_b16 a[190:191], v14 offset:25088
v_mfma_f32_16x16x32_bf16 v[92:95], a[76:79], a[124:127], v[92:95]
s_cbranch_vccnz CK_Z
CK_Z_R:
v_mfma_f32_16x16x32_bf16 v[84:87], a[76:79], a[120:123], v[84:87]
buffer_load_dwordx4 v8, s[16:19], s64 offen offset:1024 lds
v_mfma_f32_16x16x32_bf16 v[76:79], a[76:79], a[116:119], v[76:79]
ds_read_b128 a[144:147], v10 offset:8192
v_mfma_f32_16x16x32_bf16 v[68:71], a[76:79], a[112:115], v[68:71]
buffer_atomic_add v1, v0, s[24:27], s84 offen offset:0 sc1
v_mfma_f32_16x16x32_bf16 v[220:223], a[108:111], a[76:79], v[220:223]
s_mul_i32 s52, s66, 147456
s_lshl_b32 s53, s4, 8
s_add_u32 s52, s52, s53
v_mfma_f32_16x16x32_bf16 v[216:219], a[104:107], a[76:79], v[216:219]
s_lshl2_add_u32 s53, s2, s3
ds_read_b64_tr_b16 a[160:161], v11 offset:16384
ds_read_b64_tr_b16 a[162:163], v11 offset:16896
v_mfma_f32_16x16x32_bf16 v[212:215], a[100:103], a[76:79], v[212:215]
s_mul_i32 s53, s53, 2304
v_lshrrev_b32 v16, 1, v1
v_and_b32 v17, 1, v1
v_mfma_f32_16x16x32_bf16 v[208:211], a[96:99], a[76:79], v[208:211]
s_add_u32 m0, s73, 4096
s_add_u32 s64, s71, 524288
v_lshlrev_b32 v16, 13, v16
v_mfma_f32_16x16x32_bf16 v[224:227], a[96:99], a[80:83], v[224:227]
ds_read_b128 a[148:151], v10 offset:10240
v_lshl_add_u32 v16, v17, 7, v16
v_mfma_f32_16x16x32_bf16 v[228:231], a[100:103], a[80:83], v[228:231]
buffer_load_dwordx4 v5, s[8:11], s64 offen lds
v_mfma_f32_16x16x32_bf16 v[232:235], a[104:107], a[80:83], v[232:235]
v_mov_b32 v17, 2147418112
v_cmp_gt_u32 s[96:97], 18, v1
v_mfma_f32_16x16x32_bf16 v[236:239], a[108:111], a[80:83], v[236:239]
ds_read_b64_tr_b16 a[164:165], v12 offset:16384
ds_read_b64_tr_b16 a[166:167], v12 offset:16896
v_mfma_f32_16x16x32_bf16 v[96:99], a[80:83], a[112:115], v[96:99]
v_lshlrev_b32 v18, 7, v1
v_mov_b32 v29, 0
v_mfma_f32_16x16x32_bf16 v[104:107], a[80:83], a[116:119], v[104:107]
v_mfma_f32_16x16x32_bf16 v[112:115], a[80:83], a[120:123], v[112:115]
ds_read_b128 a[152:155], v10 offset:12288
v_cndmask_b32 v16, v17, v16, s[96:97]
v_mfma_f32_16x16x32_bf16 v[120:123], a[80:83], a[124:127], v[120:123]
v_cndmask_b32 v18, v17, v18, s[96:97]
v_mfma_f32_16x16x32_bf16 v[124:127], a[84:87], a[124:127], v[124:127]
buffer_load_dwordx4 v6, s[8:11], s64 offen offset:1024 lds
v_mfma_f32_16x16x32_bf16 v[116:119], a[84:87], a[120:123], v[116:119]
ds_read_b64_tr_b16 a[168:169], v13 offset:16384
ds_read_b64_tr_b16 a[170:171], v13 offset:16896
v_mfma_f32_16x16x32_bf16 v[108:111], a[84:87], a[116:119], v[108:111]
buffer_load_dword a253, v18, s[12:15], s53 offen
v_mfma_f32_16x16x32_bf16 v[100:103], a[84:87], a[112:115], v[100:103]
v_mfma_f32_16x16x32_bf16 v[252:255], a[108:111], a[84:87], v[252:255]
ds_read_b128 a[156:159], v10 offset:14336
v_mfma_f32_16x16x32_bf16 v[248:251], a[104:107], a[84:87], v[248:251]
s_add_u32 m0, s73, 6144
s_add_u32 s64, s71, 540672
v_mfma_f32_16x16x32_bf16 v[244:247], a[100:103], a[84:87], v[244:247]
v_mfma_f32_16x16x32_bf16 v[240:243], a[96:99], a[84:87], v[240:243]
buffer_load_dwordx4 v5, s[8:11], s64 offen lds
v_mfma_f32_16x16x32_bf16 a[0:3], a[96:99], a[88:91], a[0:3]
ds_read_b64_tr_b16 a[172:173], v14 offset:16384
ds_read_b64_tr_b16 a[174:175], v14 offset:16896
v_mfma_f32_16x16x32_bf16 a[4:7], a[100:103], a[88:91], a[4:7]
v_mfma_f32_16x16x32_bf16 a[8:11], a[104:107], a[88:91], a[8:11]
v_mfma_f32_16x16x32_bf16 a[12:15], a[108:111], a[88:91], a[12:15]
v_mfma_f32_16x16x32_bf16 v[128:131], a[88:91], a[112:115], v[128:131]
v_mfma_f32_16x16x32_bf16 v[136:139], a[88:91], a[116:119], v[136:139]
v_mfma_f32_16x16x32_bf16 v[144:147], a[88:91], a[120:123], v[144:147]
buffer_load_dwordx4 v6, s[8:11], s64 offen offset:1024 lds
v_mfma_f32_16x16x32_bf16 v[152:155], a[88:91], a[124:127], v[152:155]
v_mfma_f32_16x16x32_bf16 v[156:159], a[92:95], a[124:127], v[156:159]
v_add_u32 v9, 32768, v9
v_add_u32 v10, 32768, v10
v_mfma_f32_16x16x32_bf16 v[148:151], a[92:95], a[120:123], v[148:151]
v_mfma_f32_16x16x32_bf16 v[140:143], a[92:95], a[116:119], v[140:143]
v_mfma_f32_16x16x32_bf16 v[132:135], a[92:95], a[112:115], v[132:135]
v_mfma_f32_16x16x32_bf16 a[28:31], a[108:111], a[92:95], a[28:31]
v_mfma_f32_16x16x32_bf16 a[24:27], a[104:107], a[92:95], a[24:27]
v_mfma_f32_16x16x32_bf16 a[20:23], a[100:103], a[92:95], a[20:23]
v_mfma_f32_16x16x32_bf16 a[16:19], a[96:99], a[92:95], a[16:19]
s_waitcnt lgkmcnt(0)
v_mfma_f32_16x16x32_bf16 v[160:163], a[160:163], a[128:131], v[160:163]
s_waitcnt vmcnt(23)
v_mfma_f32_16x16x32_bf16 v[164:167], a[164:167], a[128:131], v[164:167]
s_barrier
v_mfma_f32_16x16x32_bf16 v[168:171], a[168:171], a[128:131], v[168:171]
ds_read_b128 a[64:67], v9 offset:0
v_mfma_f32_16x16x32_bf16 v[172:175], a[172:175], a[128:131], v[172:175]
s_add_u32 m0, s77, 16384
s_add_u32 s64, s76, 262144
v_mfma_f32_16x16x32_bf16 v[32:35], a[128:131], a[176:179], v[32:35]
buffer_load_dwordx4 v7, s[16:19], s64 offen lds
v_mfma_f32_16x16x32_bf16 v[40:43], a[128:131], a[180:183], v[40:43]
ds_read_b64_tr_b16 a[112:113], v11 offset:40960
ds_read_b64_tr_b16 a[114:115], v11 offset:41472
v_mfma_f32_16x16x32_bf16 v[48:51], a[128:131], a[184:187], v[48:51]
buffer_load_dword a252, v16, s[20:23], s52 offen
v_mfma_f32_16x16x32_bf16 v[56:59], a[128:131], a[188:191], v[56:59]
s_add_u32 s52, s52, 73728
v_mfma_f32_16x16x32_bf16 v[60:63], a[132:135], a[188:191], v[60:63]
ds_read_b128 a[68:71], v9 offset:2048
v_mfma_f32_16x16x32_bf16 v[52:55], a[132:135], a[184:187], v[52:55]
v_mfma_f32_16x16x32_bf16 v[44:47], a[132:135], a[180:183], v[44:47]
v_mfma_f32_16x16x32_bf16 v[36:39], a[132:135], a[176:179], v[36:39]
buffer_load_dwordx4 v8, s[16:19], s64 offen offset:1024 lds
v_mfma_f32_16x16x32_bf16 v[188:191], a[172:175], a[132:135], v[188:191]
ds_read_b64_tr_b16 a[116:117], v12 offset:40960
ds_read_b64_tr_b16 a[118:119], v12 offset:41472
v_mfma_f32_16x16x32_bf16 v[184:187], a[168:171], a[132:135], v[184:187]
v_mfma_f32_16x16x32_bf16 v[180:183], a[164:167], a[132:135], v[180:183]
ds_read_b128 a[72:75], v9 offset:4096
v_mfma_f32_16x16x32_bf16 v[176:179], a[160:163], a[132:135], v[176:179]
v_mfma_f32_16x16x32_bf16 v[192:195], a[160:163], a[136:139], v[192:195]
s_add_u32 m0, s77, 18432
s_add_u32 s64, s76, 393216
v_mfma_f32_16x16x32_bf16 v[196:199], a[164:167], a[136:139], v[196:199]
ds_read_b64_tr_b16 a[120:121], v13 offset:40960
ds_read_b64_tr_b16 a[122:123], v13 offset:41472
v_mfma_f32_16x16x32_bf16 v[200:203], a[168:171], a[136:139], v[200:203]
buffer_load_dwordx4 v7, s[16:19], s64 offen lds
v_mfma_f32_16x16x32_bf16 v[204:207], a[172:175], a[136:139], v[204:207]
v_mfma_f32_16x16x32_bf16 v[64:67], a[136:139], a[176:179], v[64:67]
ds_read_b128 a[76:79], v9 offset:6144
v_mfma_f32_16x16x32_bf16 v[72:75], a[136:139], a[180:183], v[72:75]
v_mfma_f32_16x16x32_bf16 v[80:83], a[136:139], a[184:187], v[80:83]
v_mfma_f32_16x16x32_bf16 v[88:91], a[136:139], a[188:191], v[88:91]
ds_read_b64_tr_b16 a[124:125], v14 offset:40960
ds_read_b64_tr_b16 a[126:127], v14 offset:41472
v_mfma_f32_16x16x32_bf16 v[92:95], a[140:143], a[188:191], v[92:95]
v_mfma_f32_16x16x32_bf16 v[84:87], a[140:143], a[184:187], v[84:87]
buffer_load_dwordx4 v8, s[16:19], s64 offen offset:1024 lds
v_mfma_f32_16x16x32_bf16 v[76:79], a[140:143], a[180:183], v[76:79]
s_xor_b32 s71, s70, 896
s_add_u32 s71, s68, s71
ds_read_b128 a[80:83], v9 offset:8192
v_mfma_f32_16x16x32_bf16 v[68:71], a[140:143], a[176:179], v[68:71]
v_mfma_f32_16x16x32_bf16 v[220:223], a[172:175], a[140:143], v[220:223]
v_mfma_f32_16x16x32_bf16 v[216:219], a[168:171], a[140:143], v[216:219]
ds_read_b64_tr_b16 a[96:97], v11 offset:32768
ds_read_b64_tr_b16 a[98:99], v11 offset:33280
v_mfma_f32_16x16x32_bf16 v[212:215], a[164:167], a[140:143], v[212:215]
v_mfma_f32_16x16x32_bf16 v[208:211], a[160:163], a[140:143], v[208:211]
s_add_u32 m0, s73, 32768
s_add_u32 s64, s71, 0
v_mfma_f32_16x16x32_bf16 v[224:227], a[160:163], a[144:147], v[224:227]
ds_read_b128 a[84:87], v9 offset:10240
v_mfma_f32_16x16x32_bf16 v[228:231], a[164:167], a[144:147], v[228:231]
buffer_load_dwordx4 v5, s[8:11], s64 offen lds
v_mfma_f32_16x16x32_bf16 v[232:235], a[168:171], a[144:147], v[232:235]
v_mfma_f32_16x16x32_bf16 v[236:239], a[172:175], a[144:147], v[236:239]
ds_read_b64_tr_b16 a[100:101], v12 offset:32768
ds_read_b64_tr_b16 a[102:103], v12 offset:33280
v_mfma_f32_16x16x32_bf16 v[96:99], a[144:147], a[176:179], v[96:99]
v_mfma_f32_16x16x32_bf16 v[104:107], a[144:147], a[180:183], v[104:107]
v_mfma_f32_16x16x32_bf16 v[112:115], a[144:147], a[184:187], v[112:115]
ds_read_b128 a[88:91], v9 offset:12288
v_mfma_f32_16x16x32_bf16 v[120:123], a[144:147], a[188:191], v[120:123]
v_mfma_f32_16x16x32_bf16 v[124:127], a[148:151], a[188:191], v[124:127]
buffer_load_dwordx4 v6, s[8:11], s64 offen offset:1024 lds
v_mfma_f32_16x16x32_bf16 v[116:119], a[148:151], a[184:187], v[116:119]
ds_read_b64_tr_b16 a[104:105], v13 offset:32768
ds_read_b64_tr_b16 a[106:107], v13 offset:33280
v_mfma_f32_16x16x32_bf16 v[108:111], a[148:151], a[180:183], v[108:111]
v_mfma_f32_16x16x32_bf16 v[100:103], a[148:151], a[176:179], v[100:103]
v_mfma_f32_16x16x32_bf16 v[252:255], a[172:175], a[148:151], v[252:255]
ds_read_b128 a[92:95], v9 offset:14336
v_mfma_f32_16x16x32_bf16 v[248:251], a[168:171], a[148:151], v[248:251]
s_add_u32 m0, s73, 34816
s_add_u32 s64, s71, 16384
v_mfma_f32_16x16x32_bf16 v[244:247], a[164:167], a[148:151], v[244:247]
v_mfma_f32_16x16x32_bf16 v[240:243], a[160:163], a[148:151], v[240:243]
buffer_load_dwordx4 v5, s[8:11], s64 offen lds
v_mfma_f32_16x16x32_bf16 a[0:3], a[160:163], a[152:155], a[0:3]
ds_read_b64_tr_b16 a[108:109], v14 offset:32768
ds_read_b64_tr_b16 a[110:111], v14 offset:33280
v_mfma_f32_16x16x32_bf16 a[4:7], a[164:167], a[152:155], a[4:7]
v_mfma_f32_16x16x32_bf16 a[8:11], a[168:171], a[152:155], a[8:11]
v_mfma_f32_16x16x32_bf16 a[12:15], a[172:175], a[152:155], a[12:15]
v_mfma_f32_16x16x32_bf16 v[128:131], a[152:155], a[176:179], v[128:131]
v_mfma_f32_16x16x32_bf16 v[136:139], a[152:155], a[180:183], v[136:139]
v_mfma_f32_16x16x32_bf16 v[144:147], a[152:155], a[184:187], v[144:147]
buffer_load_dwordx4 v6, s[8:11], s64 offen offset:1024 lds
v_mfma_f32_16x16x32_bf16 v[152:155], a[152:155], a[188:191], v[152:155]
v_mfma_f32_16x16x32_bf16 v[156:159], a[156:159], a[188:191], v[156:159]
v_mfma_f32_16x16x32_bf16 v[148:151], a[156:159], a[184:187], v[148:151]
v_mfma_f32_16x16x32_bf16 v[140:143], a[156:159], a[180:183], v[140:143]
v_mfma_f32_16x16x32_bf16 v[132:135], a[156:159], a[176:179], v[132:135]
v_mfma_f32_16x16x32_bf16 a[28:31], a[172:175], a[156:159], a[28:31]
v_mfma_f32_16x16x32_bf16 a[24:27], a[168:171], a[156:159], a[24:27]
v_mfma_f32_16x16x32_bf16 a[20:23], a[164:167], a[156:159], a[20:23]
v_mfma_f32_16x16x32_bf16 a[16:19], a[160:163], a[156:159], a[16:19]
s_waitcnt lgkmcnt(0)
v_mfma_f32_16x16x32_bf16 v[160:163], a[96:99], a[64:67], v[160:163]
s_waitcnt vmcnt(25)
v_mfma_f32_16x16x32_bf16 v[164:167], a[100:103], a[64:67], v[164:167]
s_barrier
v_mfma_f32_16x16x32_bf16 v[168:171], a[104:107], a[64:67], v[168:171]
ds_read_b128 a[128:131], v10 offset:0
v_mfma_f32_16x16x32_bf16 v[172:175], a[108:111], a[64:67], v[172:175]
s_xor_b32 s76, s75, 3670016
s_add_u32 s76, s74, s76
v_mfma_f32_16x16x32_bf16 v[32:35], a[64:67], a[112:115], v[32:35]
s_add_u32 m0, s77, 32768
s_add_u32 s64, s76, 0
v_mfma_f32_16x16x32_bf16 v[40:43], a[64:67], a[116:119], v[40:43]
buffer_load_dwordx4 v7, s[16:19], s64 offen lds
v_mfma_f32_16x16x32_bf16 v[48:51], a[64:67], a[120:123], v[48:51]
ds_read_b64_tr_b16 a[176:177], v11 offset:57344
ds_read_b64_tr_b16 a[178:179], v11 offset:57856
v_mfma_f32_16x16x32_bf16 v[56:59], a[64:67], a[124:127], v[56:59]
buffer_load_dword a252, v16, s[20:23], s52 offen
v_mfma_f32_16x16x32_bf16 v[60:63], a[68:71], a[124:127], v[60:63]
s_lshr_b32 s52, s2, 1
s_lshl2_add_u32 s52, s52, s3
ds_read_b128 a[132:135], v10 offset:2048
v_mfma_f32_16x16x32_bf16 v[52:55], a[68:71], a[120:123], v[52:55]
s_mul_i32 s52, s52, 9216
s_and_b32 s53, s2, 1
s_lshl_b32 s53, s53, 9
v_mfma_f32_16x16x32_bf16 v[44:47], a[68:71], a[116:119], v[44:47]
s_add_u32 s52, s52, s53
s_lshl2_add_u32 s53, s2, s3
s_mul_i32 s53, s53, 768
v_mfma_f32_16x16x32_bf16 v[36:39], a[68:71], a[112:115], v[36:39]
buffer_load_dwordx4 v8, s[16:19], s64 offen offset:1024 lds
v_mfma_f32_16x16x32_bf16 v[188:191], a[108:111], a[68:71], v[188:191]
ds_read_b64_tr_b16 a[180:181], v12 offset:57344
ds_read_b64_tr_b16 a[182:183], v12 offset:57856
v_mfma_f32_16x16x32_bf16 v[184:187], a[104:107], a[68:71], v[184:187]
v_cmp_gt_u32 s[96:97], 40, v1
v_and_b32 v16, 7, v1
v_mfma_f32_16x16x32_bf16 v[180:183], a[100:103], a[68:71], v[180:183]
ds_read_b128 a[136:139], v10 offset:4096
v_mul_u32_u24 v16, 1152, v16
v_mfma_f32_16x16x32_bf16 v[176:179], a[96:99], a[68:71], v[176:179]
v_lshrrev_b32 v19, 3, v1
v_lshl_add_u32 v16, v19, 7, v16
v_mfma_f32_16x16x32_bf16 v[192:195], a[96:99], a[72:75], v[192:195]
s_add_u32 m0, s77, 34816
s_add_u32 s64, s76, 131072
v_cndmask_b32 v16, v17, v16, s[96:97]
v_mfma_f32_16x16x32_bf16 v[196:199], a[100:103], a[72:75], v[196:199]
ds_read_b64_tr_b16 a[184:185], v13 offset:57344
ds_read_b64_tr_b16 a[186:187], v13 offset:57856
v_mfma_f32_16x16x32_bf16 v[200:203], a[104:107], a[72:75], v[200:203]
buffer_load_dwordx4 v7, s[16:19], s64 offen lds
v_mfma_f32_16x16x32_bf16 v[204:207], a[108:111], a[72:75], v[204:207]
v_cmp_gt_u32 s[96:97], 6, v1
v_mfma_f32_16x16x32_bf16 v[64:67], a[72:75], a[112:115], v[64:67]
ds_read_b128 a[140:143], v10 offset:6144
v_mfma_f32_16x16x32_bf16 v[72:75], a[72:75], a[116:119], v[72:75]
v_cndmask_b32 v18, v17, v18, s[96:97]
v_mfma_f32_16x16x32_bf16 v[80:83], a[72:75], a[120:123], v[80:83]
v_mfma_f32_16x16x32_bf16 v[88:91], a[72:75], a[124:127], v[88:91]
ds_read_b64_tr_b16 a[188:189], v14 offset:57344
ds_read_b64_tr_b16 a[190:191], v14 offset:57856
v_mfma_f32_16x16x32_bf16 v[92:95], a[76:79], a[124:127], v[92:95]
v_mfma_f32_16x16x32_bf16 v[84:87], a[76:79], a[120:123], v[84:87]
buffer_load_dwordx4 v8, s[16:19], s64 offen offset:1024 lds
v_mfma_f32_16x16x32_bf16 v[76:79], a[76:79], a[116:119], v[76:79]
ds_read_b128 a[144:147], v10 offset:8192
v_mfma_f32_16x16x32_bf16 v[68:71], a[76:79], a[112:115], v[68:71]
v_mfma_f32_16x16x32_bf16 v[220:223], a[108:111], a[76:79], v[220:223]
v_mfma_f32_16x16x32_bf16 v[216:219], a[104:107], a[76:79], v[216:219]
ds_read_b64_tr_b16 a[160:161], v11 offset:49152
ds_read_b64_tr_b16 a[162:163], v11 offset:49664
v_mfma_f32_16x16x32_bf16 v[212:215], a[100:103], a[76:79], v[212:215]
v_mfma_f32_16x16x32_bf16 v[208:211], a[96:99], a[76:79], v[208:211]
s_add_u32 m0, s73, 36864
s_add_u32 s64, s71, 524288
v_mfma_f32_16x16x32_bf16 v[224:227], a[96:99], a[80:83], v[224:227]
ds_read_b128 a[148:151], v10 offset:10240
v_mfma_f32_16x16x32_bf16 v[228:231], a[100:103], a[80:83], v[228:231]
buffer_load_dwordx4 v5, s[8:11], s64 offen lds
v_mfma_f32_16x16x32_bf16 v[232:235], a[104:107], a[80:83], v[232:235]
v_mfma_f32_16x16x32_bf16 v[236:239], a[108:111], a[80:83], v[236:239]
ds_read_b64_tr_b16 a[164:165], v12 offset:49152
ds_read_b64_tr_b16 a[166:167], v12 offset:49664
v_mfma_f32_16x16x32_bf16 v[96:99], a[80:83], a[112:115], v[96:99]
v_mfma_f32_16x16x32_bf16 v[104:107], a[80:83], a[116:119], v[104:107]
v_mfma_f32_16x16x32_bf16 v[112:115], a[80:83], a[120:123], v[112:115]
ds_read_b128 a[152:155], v10 offset:12288
v_mfma_f32_16x16x32_bf16 v[120:123], a[80:83], a[124:127], v[120:123]
v_mfma_f32_16x16x32_bf16 v[124:127], a[84:87], a[124:127], v[124:127]
buffer_load_dwordx4 v6, s[8:11], s64 offen offset:1024 lds
v_mfma_f32_16x16x32_bf16 v[116:119], a[84:87], a[120:123], v[116:119]
ds_read_b64_tr_b16 a[168:169], v13 offset:49152
ds_read_b64_tr_b16 a[170:171], v13 offset:49664
v_mfma_f32_16x16x32_bf16 v[108:111], a[84:87], a[116:119], v[108:111]
buffer_load_dword v30, v29, s[24:27], s89 offen sc1
v_mfma_f32_16x16x32_bf16 v[100:103], a[84:87], a[112:115], v[100:103]
v_mfma_f32_16x16x32_bf16 v[252:255], a[108:111], a[84:87], v[252:255]
ds_read_b128 a[156:159], v10 offset:14336
v_mfma_f32_16x16x32_bf16 v[248:251], a[104:107], a[84:87], v[248:251]
s_add_u32 m0, s73, 38912
s_add_u32 s64, s71, 540672
v_mfma_f32_16x16x32_bf16 v[244:247], a[100:103], a[84:87], v[244:247]
v_mfma_f32_16x16x32_bf16 v[240:243], a[96:99], a[84:87], v[240:243]
buffer_load_dwordx4 v5, s[8:11], s64 offen lds
v_mfma_f32_16x16x32_bf16 a[0:3], a[96:99], a[88:91], a[0:3]
ds_read_b64_tr_b16 a[172:173], v14 offset:49152
ds_read_b64_tr_b16 a[174:175], v14 offset:49664
v_mfma_f32_16x16x32_bf16 a[4:7], a[100:103], a[88:91], a[4:7]
v_mfma_f32_16x16x32_bf16 a[8:11], a[104:107], a[88:91], a[8:11]
v_mfma_f32_16x16x32_bf16 a[12:15], a[108:111], a[88:91], a[12:15]
v_mfma_f32_16x16x32_bf16 v[128:131], a[88:91], a[112:115], v[128:131]
v_mfma_f32_16x16x32_bf16 v[136:139], a[88:91], a[116:119], v[136:139]
v_mfma_f32_16x16x32_bf16 v[144:147], a[88:91], a[120:123], v[144:147]
buffer_load_dwordx4 v6, s[8:11], s64 offen offset:1024 lds
v_mfma_f32_16x16x32_bf16 v[152:155], a[88:91], a[124:127], v[152:155]
v_mfma_f32_16x16x32_bf16 v[156:159], a[92:95], a[124:127], v[156:159]
v_add_u32 v9, -65536, v9
v_add_u32 v10, -65536, v10
v_mfma_f32_16x16x32_bf16 v[148:151], a[92:95], a[120:123], v[148:151]
v_mfma_f32_16x16x32_bf16 v[140:143], a[92:95], a[116:119], v[140:143]
v_mfma_f32_16x16x32_bf16 v[132:135], a[92:95], a[112:115], v[132:135]
v_mfma_f32_16x16x32_bf16 a[28:31], a[108:111], a[92:95], a[28:31]
v_mfma_f32_16x16x32_bf16 a[24:27], a[104:107], a[92:95], a[24:27]
v_mfma_f32_16x16x32_bf16 a[20:23], a[100:103], a[92:95], a[20:23]
v_mfma_f32_16x16x32_bf16 a[16:19], a[96:99], a[92:95], a[16:19]
s_waitcnt lgkmcnt(0)
v_mfma_f32_16x16x32_bf16 v[160:163], a[160:163], a[128:131], v[160:163]
s_waitcnt vmcnt(19)
v_mfma_f32_16x16x32_bf16 v[164:167], a[164:167], a[128:131], v[164:167]
s_barrier
v_mfma_f32_16x16x32_bf16 v[168:171], a[168:171], a[128:131], v[168:171]
ds_read_b128 a[64:67], v9 offset:0
v_mfma_f32_16x16x32_bf16 v[172:175], a[172:175], a[128:131], v[172:175]
s_add_u32 m0, s77, 49152
s_add_u32 s64, s76, 262144
v_mfma_f32_16x16x32_bf16 v[32:35], a[128:131], a[176:179], v[32:35]
buffer_load_dwordx4 v7, s[16:19], s64 offen lds
v_mfma_f32_16x16x32_bf16 v[40:43], a[128:131], a[180:183], v[40:43]
ds_read_b64_tr_b16 a[112:113], v11 offset:8192
ds_read_b64_tr_b16 a[114:115], v11 offset:8704
v_mfma_f32_16x16x32_bf16 v[48:51], a[128:131], a[184:187], v[48:51]
v_mfma_f32_16x16x32_bf16 v[56:59], a[128:131], a[188:191], v[56:59]
v_mfma_f32_16x16x32_bf16 v[60:63], a[132:135], a[188:191], v[60:63]
ds_read_b128 a[68:71], v9 offset:2048
v_mfma_f32_16x16x32_bf16 v[52:55], a[132:135], a[184:187], v[52:55]
v_mfma_f32_16x16x32_bf16 v[44:47], a[132:135], a[180:183], v[44:47]
v_mfma_f32_16x16x32_bf16 v[36:39], a[132:135], a[176:179], v[36:39]
buffer_load_dwordx4 v8, s[16:19], s64 offen offset:1024 lds
v_mfma_f32_16x16x32_bf16 v[188:191], a[172:175], a[132:135], v[188:191]
ds_read_b64_tr_b16 a[116:117], v12 offset:8192
ds_read_b64_tr_b16 a[118:119], v12 offset:8704
v_mfma_f32_16x16x32_bf16 v[184:187], a[168:171], a[132:135], v[184:187]
v_mfma_f32_16x16x32_bf16 v[180:183], a[164:167], a[132:135], v[180:183]
ds_read_b128 a[72:75], v9 offset:4096
v_mfma_f32_16x16x32_bf16 v[176:179], a[160:163], a[132:135], v[176:179]
v_mfma_f32_16x16x32_bf16 v[192:195], a[160:163], a[136:139], v[192:195]
s_add_u32 m0, s77, 51200
s_add_u32 s64, s76, 393216
v_mfma_f32_16x16x32_bf16 v[196:199], a[164:167], a[136:139], v[196:199]
ds_read_b64_tr_b16 a[120:121], v13 offset:8192
ds_read_b64_tr_b16 a[122:123], v13 offset:8704
v_mfma_f32_16x16x32_bf16 v[200:203], a[168:171], a[136:139], v[200:203]
buffer_load_dwordx4 v7, s[16:19], s64 offen lds
v_mfma_f32_16x16x32_bf16 v[204:207], a[172:175], a[136:139], v[204:207]
v_mfma_f32_16x16x32_bf16 v[64:67], a[136:139], a[176:179], v[64:67]
ds_read_b128 a[76:79], v9 offset:6144
v_mfma_f32_16x16x32_bf16 v[72:75], a[136:139], a[180:183], v[72:75]
v_mfma_f32_16x16x32_bf16 v[80:83], a[136:139], a[184:187], v[80:83]
v_mfma_f32_16x16x32_bf16 v[88:91], a[136:139], a[188:191], v[88:91]
ds_read_b64_tr_b16 a[124:125], v14 offset:8192
ds_read_b64_tr_b16 a[126:127], v14 offset:8704
v_mfma_f32_16x16x32_bf16 v[92:95], a[140:143], a[188:191], v[92:95]
v_mfma_f32_16x16x32_bf16 v[84:87], a[140:143], a[184:187], v[84:87]
buffer_load_dwordx4 v8, s[16:19], s64 offen offset:1024 lds
v_mfma_f32_16x16x32_bf16 v[76:79], a[140:143], a[180:183], v[76:79]
s_lshl_b32 s70, s93, 7
s_mul_i32 s68, s66, 36864
s_mul_i32 s69, s67, 36864
v_mfma_f32_16x16x32_bf16 v[68:71], a[140:143], a[176:179], v[68:71]
v_lshrrev_b32 v31, 3, v1
v_lshl_add_u32 v5, v31, 7, v5
v_mfma_f32_16x16x32_bf16 v[220:223], a[172:175], a[140:143], v[220:223]
v_lshl_add_u32 v6, v31, 7, v6
v_add_u32 v6, 1024, v6
v_mfma_f32_16x16x32_bf16 v[216:219], a[168:171], a[140:143], v[216:219]
s_xor_b32 s65, s70, 0
s_add_u32 s71, s68, s65
s_add_u32 s72, s69, s65
v_mfma_f32_16x16x32_bf16 v[212:215], a[164:167], a[140:143], v[212:215]
ds_read_b128 a[80:83], v9 offset:8192
v_mfma_f32_16x16x32_bf16 v[208:211], a[160:163], a[140:143], v[208:211]
s_add_u32 m0, s73, 65536
s_add_u32 s64, s71, 0
v_mfma_f32_16x16x32_bf16 v[224:227], a[160:163], a[144:147], v[224:227]
ds_read_b64_tr_b16 a[96:97], v11 offset:0
ds_read_b64_tr_b16 a[98:99], v11 offset:512
v_mfma_f32_16x16x32_bf16 v[228:231], a[164:167], a[144:147], v[228:231]
buffer_load_dwordx4 v5, s[12:15], s64 offen lds
v_mfma_f32_16x16x32_bf16 v[232:235], a[168:171], a[144:147], v[232:235]
ds_read_b128 a[84:87], v9 offset:10240
v_mfma_f32_16x16x32_bf16 v[236:239], a[172:175], a[144:147], v[236:239]
ds_read_b64_tr_b16 a[100:101], v12 offset:0
ds_read_b64_tr_b16 a[102:103], v12 offset:512
v_mfma_f32_16x16x32_bf16 v[96:99], a[144:147], a[176:179], v[96:99]
v_mfma_f32_16x16x32_bf16 v[104:107], a[144:147], a[180:183], v[104:107]
v_mfma_f32_16x16x32_bf16 v[112:115], a[144:147], a[184:187], v[112:115]
ds_read_b128 a[88:91], v9 offset:12288
v_mfma_f32_16x16x32_bf16 v[120:123], a[144:147], a[188:191], v[120:123]
v_mfma_f32_16x16x32_bf16 v[124:127], a[148:151], a[188:191], v[124:127]
buffer_load_dwordx4 v6, s[12:15], s64 offen offset:1024 lds
v_mfma_f32_16x16x32_bf16 v[116:119], a[148:151], a[184:187], v[116:119]
ds_read_b64_tr_b16 a[104:105], v13 offset:0
ds_read_b64_tr_b16 a[106:107], v13 offset:512
v_mfma_f32_16x16x32_bf16 v[108:111], a[148:151], a[180:183], v[108:111]
v_mfma_f32_16x16x32_bf16 v[100:103], a[148:151], a[176:179], v[100:103]
v_mfma_f32_16x16x32_bf16 v[252:255], a[172:175], a[148:151], v[252:255]
ds_read_b128 a[92:95], v9 offset:14336
v_mfma_f32_16x16x32_bf16 v[248:251], a[168:171], a[148:151], v[248:251]
s_add_u32 m0, s73, 67584
s_add_u32 s64, s71, 18432
v_mfma_f32_16x16x32_bf16 v[244:247], a[164:167], a[148:151], v[244:247]
v_mfma_f32_16x16x32_bf16 v[240:243], a[160:163], a[148:151], v[240:243]
buffer_load_dwordx4 v5, s[12:15], s64 offen lds
v_mfma_f32_16x16x32_bf16 a[0:3], a[160:163], a[152:155], a[0:3]
ds_read_b64_tr_b16 a[108:109], v14 offset:0
ds_read_b64_tr_b16 a[110:111], v14 offset:512
v_mfma_f32_16x16x32_bf16 a[4:7], a[164:167], a[152:155], a[4:7]
v_mfma_f32_16x16x32_bf16 a[8:11], a[168:171], a[152:155], a[8:11]
s_waitcnt vmcnt(9)
v_mfma_f32_16x16x32_bf16 a[12:15], a[172:175], a[152:155], a[12:15]
v_cmp_gt_u32 vcc, 18, v30
v_mfma_f32_16x16x32_bf16 v[128:131], a[152:155], a[176:179], v[128:131]
v_mfma_f32_16x16x32_bf16 v[136:139], a[152:155], a[180:183], v[136:139]
v_mfma_f32_16x16x32_bf16 v[144:147], a[152:155], a[184:187], v[144:147]
buffer_load_dwordx4 v6, s[12:15], s64 offen offset:1024 lds
v_mfma_f32_16x16x32_bf16 v[152:155], a[152:155], a[188:191], v[152:155]
v_mfma_f32_16x16x32_bf16 v[156:159], a[156:159], a[188:191], v[156:159]
s_cbranch_vccnz CK_WA
CK_WA_R:
v_mfma_f32_16x16x32_bf16 v[148:151], a[156:159], a[184:187], v[148:151]
v_mfma_f32_16x16x32_bf16 v[140:143], a[156:159], a[180:183], v[140:143]
v_mfma_f32_16x16x32_bf16 v[132:135], a[156:159], a[176:179], v[132:135]
v_mfma_f32_16x16x32_bf16 a[28:31], a[172:175], a[156:159], a[28:31]
v_mfma_f32_16x16x32_bf16 a[24:27], a[168:171], a[156:159], a[24:27]
v_mfma_f32_16x16x32_bf16 a[20:23], a[164:167], a[156:159], a[20:23]
v_mfma_f32_16x16x32_bf16 a[16:19], a[160:163], a[156:159], a[16:19]
s_waitcnt lgkmcnt(0)
v_mfma_f32_16x16x32_bf16 v[160:163], a[96:99], a[64:67], v[160:163]
s_waitcnt vmcnt(22)
v_mfma_f32_16x16x32_bf16 v[164:167], a[100:103], a[64:67], v[164:167]
s_barrier
v_mfma_f32_16x16x32_bf16 v[168:171], a[104:107], a[64:67], v[168:171]
ds_read_b128 a[128:131], v10 offset:0
v_mfma_f32_16x16x32_bf16 v[172:175], a[108:111], a[64:67], v[172:175]
s_lshr_b32 s65, s3, 1
s_lshl_b32 s75, s65, 17
s_add_u32 s74, s74, s75
v_mfma_f32_16x16x32_bf16 v[32:35], a[64:67], a[112:115], v[32:35]
s_lshl_b32 s65, s65, 11
s_and_b32 s77, s77, 4096
s_add_u32 s77, s77, s65
v_mfma_f32_16x16x32_bf16 v[40:43], a[64:67], a[116:119], v[40:43]
s_xor_b32 s75, s93, 0
s_lshl_b32 s76, s75, 19
s_add_u32 s76, s76, s74
v_mfma_f32_16x16x32_bf16 v[48:51], a[64:67], a[120:123], v[48:51]
s_mul_i32 s79, s75, 24576
s_add_u32 s79, s79, s78
v_mfma_f32_16x16x32_bf16 v[56:59], a[64:67], a[124:127], v[56:59]
s_add_u32 m0, s77, 0
s_add_u32 s64, s76, 0
v_mfma_f32_16x16x32_bf16 v[60:63], a[68:71], a[124:127], v[60:63]
buffer_load_dwordx4 v7, s[20:23], s64 offen lds
v_mfma_f32_16x16x32_bf16 v[52:55], a[68:71], a[120:123], v[52:55]
ds_read_b64_tr_b16 a[176:177], v11 offset:24576
ds_read_b64_tr_b16 a[178:179], v11 offset:25088
v_mfma_f32_16x16x32_bf16 v[44:47], a[68:71], a[116:119], v[44:47]
ds_read_b128 a[132:135], v10 offset:2048
v_mfma_f32_16x16x32_bf16 v[36:39], a[68:71], a[112:115], v[36:39]
ds_read_b64_tr_b16 a[180:181], v12 offset:24576
ds_read_b64_tr_b16 a[182:183], v12 offset:25088
v_mfma_f32_16x16x32_bf16 v[188:191], a[108:111], a[68:71], v[188:191]
buffer_load_dwordx4 v8, s[20:23], s64 offen offset:1024 lds
v_mfma_f32_16x16x32_bf16 v[184:187], a[104:107], a[68:71], v[184:187]
buffer_load_dword a252, v16, s[32:35], s52 offen
v_mfma_f32_16x16x32_bf16 v[180:183], a[100:103], a[68:71], v[180:183]
ds_read_b128 a[136:139], v10 offset:4096
v_mfma_f32_16x16x32_bf16 v[176:179], a[96:99], a[68:71], v[176:179]
buffer_load_dword a253, v18, s[48:51], s53 offen
v_mfma_f32_16x16x32_bf16 v[192:195], a[96:99], a[72:75], v[192:195]
v_mfma_f32_16x16x32_bf16 v[196:199], a[100:103], a[72:75], v[196:199]
ds_read_b64_tr_b16 a[184:185], v13 offset:24576
ds_read_b64_tr_b16 a[186:187], v13 offset:25088
v_mfma_f32_16x16x32_bf16 v[200:203], a[104:107], a[72:75], v[200:203]
s_add_u32 m0, s80, 0
s_add_u32 s64, s79, 0
v_mfma_f32_16x16x32_bf16 v[204:207], a[108:111], a[72:75], v[204:207]
v_mfma_f32_16x16x32_bf16 v[64:67], a[72:75], a[112:115], v[64:67]
buffer_load_dwordx4 v4, s[24:27], s64 offen sc1 lds
v_mfma_f32_16x16x32_bf16 v[72:75], a[72:75], a[116:119], v[72:75]
ds_read_b128 a[140:143], v10 offset:6144
v_mfma_f32_16x16x32_bf16 v[80:83], a[72:75], a[120:123], v[80:83]
v_mfma_f32_16x16x32_bf16 v[88:91], a[72:75], a[124:127], v[88:91]
ds_read_b64_tr_b16 a[188:189], v14 offset:24576
ds_read_b64_tr_b16 a[190:191], v14 offset:25088
v_mfma_f32_16x16x32_bf16 v[92:95], a[76:79], a[124:127], v[92:95]
v_mfma_f32_16x16x32_bf16 v[84:87], a[76:79], a[120:123], v[84:87]
v_mfma_f32_16x16x32_bf16 v[76:79], a[76:79], a[116:119], v[76:79]
s_add_u32 m0, s73, 69632
s_add_u32 s64, s72, 0
ds_read_b128 a[144:147], v10 offset:8192
v_mfma_f32_16x16x32_bf16 v[68:71], a[76:79], a[112:115], v[68:71]
v_mfma_f32_16x16x32_bf16 v[220:223], a[108:111], a[76:79], v[220:223]
buffer_load_dwordx4 v5, s[12:15], s64 offen lds
v_mfma_f32_16x16x32_bf16 v[216:219], a[104:107], a[76:79], v[216:219]
ds_read_b64_tr_b16 a[160:161], v11 offset:16384
ds_read_b64_tr_b16 a[162:163], v11 offset:16896
v_mfma_f32_16x16x32_bf16 v[212:215], a[100:103], a[76:79], v[212:215]
v_mfma_f32_16x16x32_bf16 v[208:211], a[96:99], a[76:79], v[208:211]
v_mfma_f32_16x16x32_bf16 v[224:227], a[96:99], a[80:83], v[224:227]
ds_read_b128 a[148:151], v10 offset:10240
v_mfma_f32_16x16x32_bf16 v[228:231], a[100:103], a[80:83], v[228:231]
v_mfma_f32_16x16x32_bf16 v[232:235], a[104:107], a[80:83], v[232:235]
v_mfma_f32_16x16x32_bf16 v[236:239], a[108:111], a[80:83], v[236:239]
ds_read_b64_tr_b16 a[164:165], v12 offset:16384
ds_read_b64_tr_b16 a[166:167], v12 offset:16896
v_mfma_f32_16x16x32_bf16 v[96:99], a[80:83], a[112:115], v[96:99]
v_mfma_f32_16x16x32_bf16 v[104:107], a[80:83], a[116:119], v[104:107]
buffer_load_dwordx4 v6, s[12:15], s64 offen offset:1024 lds
v_mfma_f32_16x16x32_bf16 v[112:115], a[80:83], a[120:123], v[112:115]
ds_read_b128 a[152:155], v10 offset:12288
v_mfma_f32_16x16x32_bf16 v[120:123], a[80:83], a[124:127], v[120:123]
v_mfma_f32_16x16x32_bf16 v[124:127], a[84:87], a[124:127], v[124:127]
v_mfma_f32_16x16x32_bf16 v[116:119], a[84:87], a[120:123], v[116:119]
ds_read_b64_tr_b16 a[168:169], v13 offset:16384
ds_read_b64_tr_b16 a[170:171], v13 offset:16896
v_mfma_f32_16x16x32_bf16 v[108:111], a[84:87], a[116:119], v[108:111]
v_mfma_f32_16x16x32_bf16 v[100:103], a[84:87], a[112:115], v[100:103]
s_add_u32 m0, s73, 71680
s_add_u32 s64, s72, 18432
v_mfma_f32_16x16x32_bf16 v[252:255], a[108:111], a[84:87], v[252:255]
ds_read_b128 a[156:159], v10 offset:14336
v_mfma_f32_16x16x32_bf16 v[248:251], a[104:107], a[84:87], v[248:251]
buffer_load_dwordx4 v5, s[12:15], s64 offen lds
v_mfma_f32_16x16x32_bf16 v[244:247], a[100:103], a[84:87], v[244:247]
v_mfma_f32_16x16x32_bf16 v[240:243], a[96:99], a[84:87], v[240:243]
ds_read_b64_tr_b16 a[172:173], v14 offset:16384
ds_read_b64_tr_b16 a[174:175], v14 offset:16896
v_mfma_f32_16x16x32_bf16 a[0:3], a[96:99], a[88:91], a[0:3]
v_mfma_f32_16x16x32_bf16 a[4:7], a[100:103], a[88:91], a[4:7]
v_mfma_f32_16x16x32_bf16 a[8:11], a[104:107], a[88:91], a[8:11]
v_mfma_f32_16x16x32_bf16 a[12:15], a[108:111], a[88:91], a[12:15]
v_mfma_f32_16x16x32_bf16 v[128:131], a[88:91], a[112:115], v[128:131]
v_mfma_f32_16x16x32_bf16 v[136:139], a[88:91], a[116:119], v[136:139]
buffer_load_dwordx4 v6, s[12:15], s64 offen offset:1024 lds
v_mfma_f32_16x16x32_bf16 v[144:147], a[88:91], a[120:123], v[144:147]
v_mfma_f32_16x16x32_bf16 v[152:155], a[88:91], a[124:127], v[152:155]
v_mfma_f32_16x16x32_bf16 v[156:159], a[92:95], a[124:127], v[156:159]
v_add_u32 v9, 32768, v9
v_add_u32 v10, 32768, v10
v_mfma_f32_16x16x32_bf16 v[148:151], a[92:95], a[120:123], v[148:151]
v_mfma_f32_16x16x32_bf16 v[140:143], a[92:95], a[116:119], v[140:143]
v_mfma_f32_16x16x32_bf16 v[132:135], a[92:95], a[112:115], v[132:135]
v_mfma_f32_16x16x32_bf16 a[28:31], a[108:111], a[92:95], a[28:31]
v_mfma_f32_16x16x32_bf16 a[24:27], a[104:107], a[92:95], a[24:27]
v_mfma_f32_16x16x32_bf16 a[20:23], a[100:103], a[92:95], a[20:23]
v_mfma_f32_16x16x32_bf16 a[16:19], a[96:99], a[92:95], a[16:19]
s_waitcnt lgkmcnt(0)
v_mfma_f32_16x16x32_bf16 v[160:163], a[160:163], a[128:131], v[160:163]
s_waitcnt vmcnt(17)
v_mfma_f32_16x16x32_bf16 v[164:167], a[164:167], a[128:131], v[164:167]
s_barrier
v_mfma_f32_16x16x32_bf16 v[168:171], a[168:171], a[128:131], v[168:171]
ds_read_b128 a[64:67], v9 offset:0
v_mfma_f32_16x16x32_bf16 v[172:175], a[172:175], a[128:131], v[172:175]
s_add_u32 m0, s77, 16384
s_add_u32 s64, s76, 262144
v_mfma_f32_16x16x32_bf16 v[32:35], a[128:131], a[176:179], v[32:35]
buffer_load_dwordx4 v7, s[20:23], s64 offen lds
v_mfma_f32_16x16x32_bf16 v[40:43], a[128:131], a[180:183], v[40:43]
ds_read_b64_tr_b16 a[112:113], v11 offset:40960
ds_read_b64_tr_b16 a[114:115], v11 offset:41472
v_mfma_f32_16x16x32_bf16 v[48:51], a[128:131], a[184:187], v[48:51]
v_mfma_f32_16x16x32_bf16 v[56:59], a[128:131], a[188:191], v[56:59]
v_mfma_f32_16x16x32_bf16 v[60:63], a[132:135], a[188:191], v[60:63]
ds_read_b128 a[68:71], v9 offset:2048
v_mfma_f32_16x16x32_bf16 v[52:55], a[132:135], a[184:187], v[52:55]
v_mfma_f32_16x16x32_bf16 v[44:47], a[132:135], a[180:183], v[44:47]
v_mfma_f32_16x16x32_bf16 v[36:39], a[132:135], a[176:179], v[36:39]
ds_read_b64_tr_b16 a[116:117], v12 offset:40960
ds_read_b64_tr_b16 a[118:119], v12 offset:41472
v_mfma_f32_16x16x32_bf16 v[188:191], a[172:175], a[132:135], v[188:191]
buffer_load_dwordx4 v8, s[20:23], s64 offen offset:1024 lds
v_mfma_f32_16x16x32_bf16 v[184:187], a[168:171], a[132:135], v[184:187]
v_mfma_f32_16x16x32_bf16 v[180:183], a[164:167], a[132:135], v[180:183]
ds_read_b128 a[72:75], v9 offset:4096
v_mfma_f32_16x16x32_bf16 v[176:179], a[160:163], a[132:135], v[176:179]
v_mfma_f32_16x16x32_bf16 v[192:195], a[160:163], a[136:139], v[192:195]
v_mfma_f32_16x16x32_bf16 v[196:199], a[164:167], a[136:139], v[196:199]
ds_read_b64_tr_b16 a[120:121], v13 offset:40960
ds_read_b64_tr_b16 a[122:123], v13 offset:41472
v_mfma_f32_16x16x32_bf16 v[200:203], a[168:171], a[136:139], v[200:203]
s_add_u32 m0, s80, 16384
s_add_u32 s64, s79, 4096
v_mfma_f32_16x16x32_bf16 v[204:207], a[172:175], a[136:139], v[204:207]
v_mfma_f32_16x16x32_bf16 v[64:67], a[136:139], a[176:179], v[64:67]
buffer_load_dwordx4 v4, s[24:27], s64 offen sc1 lds
v_mfma_f32_16x16x32_bf16 v[72:75], a[136:139], a[180:183], v[72:75]
s_xor_b32 s65, s70, 128
s_add_u32 s71, s68, s65
s_add_u32 s72, s69, s65
v_mfma_f32_16x16x32_bf16 v[80:83], a[136:139], a[184:187], v[80:83]
ds_read_b128 a[76:79], v9 offset:6144
v_mfma_f32_16x16x32_bf16 v[88:91], a[136:139], a[188:191], v[88:91]
ds_read_b64_tr_b16 a[124:125], v14 offset:40960
ds_read_b64_tr_b16 a[126:127], v14 offset:41472
v_mfma_f32_16x16x32_bf16 v[92:95], a[140:143], a[188:191], v[92:95]
v_mfma_f32_16x16x32_bf16 v[84:87], a[140:143], a[184:187], v[84:87]
v_mfma_f32_16x16x32_bf16 v[76:79], a[140:143], a[180:183], v[76:79]
s_add_u32 m0, s73, 0
s_add_u32 s64, s71, 0
ds_read_b128 a[80:83], v9 offset:8192
v_mfma_f32_16x16x32_bf16 v[68:71], a[140:143], a[176:179], v[68:71]
v_mfma_f32_16x16x32_bf16 v[220:223], a[172:175], a[140:143], v[220:223]
buffer_load_dwordx4 v5, s[12:15], s64 offen lds
v_mfma_f32_16x16x32_bf16 v[216:219], a[168:171], a[140:143], v[216:219]
ds_read_b64_tr_b16 a[96:97], v11 offset:32768
ds_read_b64_tr_b16 a[98:99], v11 offset:33280
v_mfma_f32_16x16x32_bf16 v[212:215], a[164:167], a[140:143], v[212:215]
v_mfma_f32_16x16x32_bf16 v[208:211], a[160:163], a[140:143], v[208:211]
v_mfma_f32_16x16x32_bf16 v[224:227], a[160:163], a[144:147], v[224:227]
ds_read_b128 a[84:87], v9 offset:10240
v_mfma_f32_16x16x32_bf16 v[228:231], a[164:167], a[144:147], v[228:231]
v_mfma_f32_16x16x32_bf16 v[232:235], a[168:171], a[144:147], v[232:235]
v_mfma_f32_16x16x32_bf16 v[236:239], a[172:175], a[144:147], v[236:239]
ds_read_b64_tr_b16 a[100:101], v12 offset:32768
ds_read_b64_tr_b16 a[102:103], v12 offset:33280
v_mfma_f32_16x16x32_bf16 v[96:99], a[144:147], a[176:179], v[96:99]
v_mfma_f32_16x16x32_bf16 v[104:107], a[144:147], a[180:183], v[104:107]
buffer_load_dwordx4 v6, s[12:15], s64 offen offset:1024 lds
v_mfma_f32_16x16x32_bf16 v[112:115], a[144:147], a[184:187], v[112:115]
ds_read_b128 a[88:91], v9 offset:12288
v_mfma_f32_16x16x32_bf16 v[120:123], a[144:147], a[188:191], v[120:123]
v_mfma_f32_16x16x32_bf16 v[124:127], a[148:151], a[188:191], v[124:127]
v_mfma_f32_16x16x32_bf16 v[116:119], a[148:151], a[184:187], v[116:119]
ds_read_b64_tr_b16 a[104:105], v13 offset:32768
ds_read_b64_tr_b16 a[106:107], v13 offset:33280
v_mfma_f32_16x16x32_bf16 v[108:111], a[148:151], a[180:183], v[108:111]
v_mfma_f32_16x16x32_bf16 v[100:103], a[148:151], a[176:179], v[100:103]
s_add_u32 m0, s73, 2048
s_add_u32 s64, s71, 18432
v_mfma_f32_16x16x32_bf16 v[252:255], a[172:175], a[148:151], v[252:255]
ds_read_b128 a[92:95], v9 offset:14336
v_mfma_f32_16x16x32_bf16 v[248:251], a[168:171], a[148:151], v[248:251]
buffer_load_dwordx4 v5, s[12:15], s64 offen lds
v_mfma_f32_16x16x32_bf16 v[244:247], a[164:167], a[148:151], v[244:247]
v_mfma_f32_16x16x32_bf16 v[240:243], a[160:163], a[148:151], v[240:243]
ds_read_b64_tr_b16 a[108:109], v14 offset:32768
ds_read_b64_tr_b16 a[110:111], v14 offset:33280
v_mfma_f32_16x16x32_bf16 a[0:3], a[160:163], a[152:155], a[0:3]
v_mfma_f32_16x16x32_bf16 a[4:7], a[164:167], a[152:155], a[4:7]
v_mfma_f32_16x16x32_bf16 a[8:11], a[168:171], a[152:155], a[8:11]
v_mfma_f32_16x16x32_bf16 a[12:15], a[172:175], a[152:155], a[12:15]
v_mfma_f32_16x16x32_bf16 v[128:131], a[152:155], a[176:179], v[128:131]
v_mfma_f32_16x16x32_bf16 v[136:139], a[152:155], a[180:183], v[136:139]
buffer_load_dwordx4 v6, s[12:15], s64 offen offset:1024 lds
v_mfma_f32_16x16x32_bf16 v[144:147], a[152:155], a[184:187], v[144:147]
v_mfma_f32_16x16x32_bf16 v[152:155], a[152:155], a[188:191], v[152:155]
v_mfma_f32_16x16x32_bf16 v[156:159], a[156:159], a[188:191], v[156:159]
v_mfma_f32_16x16x32_bf16 v[148:151], a[156:159], a[184:187], v[148:151]
v_mfma_f32_16x16x32_bf16 v[140:143], a[156:159], a[180:183], v[140:143]
v_mfma_f32_16x16x32_bf16 v[132:135], a[156:159], a[176:179], v[132:135]
v_mfma_f32_16x16x32_bf16 a[28:31], a[172:175], a[156:159], a[28:31]
v_mfma_f32_16x16x32_bf16 a[24:27], a[168:171], a[156:159], a[24:27]
v_mfma_f32_16x16x32_bf16 a[20:23], a[164:167], a[156:159], a[20:23]
v_mfma_f32_16x16x32_bf16 a[16:19], a[160:163], a[156:159], a[16:19]
s_waitcnt lgkmcnt(0)
v_mfma_f32_16x16x32_bf16 v[32:35], a[64:67], a[112:115], v[32:35]
s_waitcnt vmcnt(20)
v_mfma_f32_16x16x32_bf16 v[36:39], a[68:71], a[112:115], v[36:39]
s_barrier
v_mfma_f32_16x16x32_bf16 v[40:43], a[64:67], a[116:119], v[40:43]
ds_read_b128 a[128:131], v10 offset:0
ds_read_b128 a[132:135], v10 offset:2048
v_mfma_f32_16x16x32_bf16 v[44:47], a[68:71], a[116:119], v[44:47]
ds_read_b128 a[136:139], v10 offset:4096
ds_read_b128 a[140:143], v10 offset:6144
v_mfma_f32_16x16x32_bf16 v[48:51], a[64:67], a[120:123], v[48:51]
ds_read_b128 a[144:147], v10 offset:8192
ds_read_b128 a[148:151], v10 offset:10240
v_mfma_f32_16x16x32_bf16 v[52:55], a[68:71], a[120:123], v[52:55]
ds_read_b128 a[152:155], v10 offset:12288
ds_read_b128 a[156:159], v10 offset:14336
v_mfma_f32_16x16x32_bf16 v[56:59], a[64:67], a[124:127], v[56:59]
ds_read_b64_tr_b16 a[176:177], v11 offset:57344
ds_read_b64_tr_b16 a[178:179], v11 offset:57856
v_mfma_f32_16x16x32_bf16 v[60:63], a[68:71], a[124:127], v[60:63]
ds_read_b64_tr_b16 a[180:181], v12 offset:57344
ds_read_b64_tr_b16 a[182:183], v12 offset:57856
v_mfma_f32_16x16x32_bf16 v[64:67], a[72:75], a[112:115], v[64:67]
ds_read_b64_tr_b16 a[184:185], v13 offset:57344
ds_read_b64_tr_b16 a[186:187], v13 offset:57856
v_mfma_f32_16x16x32_bf16 v[68:71], a[76:79], a[112:115], v[68:71]
ds_read_b64_tr_b16 a[188:189], v14 offset:57344
ds_read_b64_tr_b16 a[190:191], v14 offset:57856
v_mfma_f32_16x16x32_bf16 v[72:75], a[72:75], a[116:119], v[72:75]
ds_read_b64_tr_b16 a[160:161], v11 offset:49152
ds_read_b64_tr_b16 a[162:163], v11 offset:49664
v_mfma_f32_16x16x32_bf16 v[76:79], a[76:79], a[116:119], v[76:79]
ds_read_b64_tr_b16 a[164:165], v12 offset:49152
ds_read_b64_tr_b16 a[166:167], v12 offset:49664
v_mfma_f32_16x16x32_bf16 v[80:83], a[72:75], a[120:123], v[80:83]
ds_read_b64_tr_b16 a[168:169], v13 offset:49152
ds_read_b64_tr_b16 a[170:171], v13 offset:49664
v_mfma_f32_16x16x32_bf16 v[84:87], a[76:79], a[120:123], v[84:87]
ds_read_b64_tr_b16 a[172:173], v14 offset:49152
ds_read_b64_tr_b16 a[174:175], v14 offset:49664
v_mfma_f32_16x16x32_bf16 v[88:91], a[72:75], a[124:127], v[88:91]
v_mfma_f32_16x16x32_bf16 v[92:95], a[76:79], a[124:127], v[92:95]
s_xor_b32 s75, s93, 1
s_lshl_b32 s76, s75, 19
s_add_u32 s76, s76, s74
v_mfma_f32_16x16x32_bf16 v[96:99], a[80:83], a[112:115], v[96:99]
s_mul_i32 s79, s75, 24576
s_add_u32 s79, s79, s78
v_mfma_f32_16x16x32_bf16 v[100:103], a[84:87], a[112:115], v[100:103]
s_add_u32 m0, s77, 32768
s_add_u32 s64, s76, 0
v_mfma_f32_16x16x32_bf16 v[104:107], a[80:83], a[116:119], v[104:107]
buffer_load_dwordx4 v7, s[20:23], s64 offen lds
v_mfma_f32_16x16x32_bf16 v[108:111], a[84:87], a[116:119], v[108:111]
v_mfma_f32_16x16x32_bf16 v[112:115], a[80:83], a[120:123], v[112:115]
v_mfma_f32_16x16x32_bf16 v[116:119], a[84:87], a[120:123], v[116:119]
v_mfma_f32_16x16x32_bf16 v[120:123], a[80:83], a[124:127], v[120:123]
buffer_load_dwordx4 v8, s[20:23], s64 offen offset:1024 lds
v_mfma_f32_16x16x32_bf16 v[124:127], a[84:87], a[124:127], v[124:127]
v_mfma_f32_16x16x32_bf16 v[128:131], a[88:91], a[112:115], v[128:131]
v_mfma_f32_16x16x32_bf16 v[132:135], a[92:95], a[112:115], v[132:135]
v_add_u32 v9, 32768, v9
v_add_u32 v10, 32768, v10
v_mfma_f32_16x16x32_bf16 v[136:139], a[88:91], a[116:119], v[136:139]
s_lshr_b32 s55, s3, 1
s_lshl_b32 s55, s55, 14
s_lshl_b32 s54, s3, 13
v_mfma_f32_16x16x32_bf16 v[140:143], a[92:95], a[116:119], v[140:143]
s_add_u32 m0, s80, 32768
s_add_u32 s64, s79, 0
s_sub_u32 s55, s54, s55
v_mfma_f32_16x16x32_bf16 v[144:147], a[88:91], a[120:123], v[144:147]
s_and_b32 s54, s3, 1
s_lshl_b32 s54, s54, 12
v_mfma_f32_16x16x32_bf16 v[148:151], a[92:95], a[120:123], v[148:151]
buffer_load_dwordx4 v4, s[24:27], s64 offen sc1 lds
v_mfma_f32_16x16x32_bf16 v[152:155], a[88:91], a[124:127], v[152:155]
v_add_u32 v9, s55, v9
v_add_u32 v10, s55, v10
v_mfma_f32_16x16x32_bf16 v[156:159], a[92:95], a[124:127], v[156:159]
s_waitcnt lgkmcnt(0)
v_subrev_u32 v11, s54, v11
v_subrev_u32 v12, s54, v12
v_mfma_f32_16x16x32_bf16 v[32:35], a[128:131], a[176:179], v[32:35]
v_subrev_u32 v13, s54, v13
v_subrev_u32 v14, s54, v14
v_mfma_f32_16x16x32_bf16 v[36:39], a[132:135], a[176:179], v[36:39]
s_add_u32 m0, s73, 4096
s_add_u32 s64, s72, 0
v_mfma_f32_16x16x32_bf16 v[40:43], a[128:131], a[180:183], v[40:43]
v_mfma_f32_16x16x32_bf16 v[44:47], a[132:135], a[180:183], v[44:47]
buffer_load_dwordx4 v5, s[12:15], s64 offen lds
v_mfma_f32_16x16x32_bf16 v[48:51], a[128:131], a[184:187], v[48:51]
v_mfma_f32_16x16x32_bf16 v[52:55], a[132:135], a[184:187], v[52:55]
v_mfma_f32_16x16x32_bf16 v[56:59], a[128:131], a[188:191], v[56:59]
v_mfma_f32_16x16x32_bf16 v[60:63], a[132:135], a[188:191], v[60:63]
v_mfma_f32_16x16x32_bf16 v[64:67], a[136:139], a[176:179], v[64:67]
v_cvt_pk_bf16_f32 v32, v32, v33
v_cvt_pk_bf16_f32 v33, v34, v35
v_mfma_f32_16x16x32_bf16 v[68:71], a[140:143], a[176:179], v[68:71]
v_cvt_pk_bf16_f32 v34, v36, v37
v_cvt_pk_bf16_f32 v35, v38, v39
v_mfma_f32_16x16x32_bf16 v[72:75], a[136:139], a[180:183], v[72:75]
buffer_load_dwordx4 v6, s[12:15], s64 offen offset:1024 lds
v_mfma_f32_16x16x32_bf16 v[76:79], a[140:143], a[180:183], v[76:79]
v_cvt_pk_bf16_f32 v40, v40, v41
v_cvt_pk_bf16_f32 v41, v42, v43
v_mfma_f32_16x16x32_bf16 v[80:83], a[136:139], a[184:187], v[80:83]
v_cvt_pk_bf16_f32 v42, v44, v45
v_cvt_pk_bf16_f32 v43, v46, v47
v_mfma_f32_16x16x32_bf16 v[84:87], a[140:143], a[184:187], v[84:87]
v_cvt_pk_bf16_f32 v48, v48, v49
v_cvt_pk_bf16_f32 v49, v50, v51
v_mfma_f32_16x16x32_bf16 v[88:91], a[136:139], a[188:191], v[88:91]
s_add_u32 m0, s73, 6144
s_add_u32 s64, s72, 18432
s_add_u32 s53, s88, 0
v_mfma_f32_16x16x32_bf16 v[92:95], a[140:143], a[188:191], v[92:95]
buffer_store_dwordx4 v[32:35], v4, s[24:27], s53 offen offset:0 sc1
v_mfma_f32_16x16x32_bf16 v[96:99], a[144:147], a[176:179], v[96:99]
buffer_load_dwordx4 v5, s[12:15], s64 offen lds
v_mfma_f32_16x16x32_bf16 v[100:103], a[148:151], a[176:179], v[100:103]
v_cvt_pk_bf16_f32 v50, v52, v53
v_cvt_pk_bf16_f32 v51, v54, v55
v_mfma_f32_16x16x32_bf16 v[104:107], a[144:147], a[180:183], v[104:107]
v_cvt_pk_bf16_f32 v56, v56, v57
v_cvt_pk_bf16_f32 v57, v58, v59
v_mfma_f32_16x16x32_bf16 v[108:111], a[148:151], a[180:183], v[108:111]
v_cvt_pk_bf16_f32 v58, v60, v61
v_cvt_pk_bf16_f32 v59, v62, v63
v_mfma_f32_16x16x32_bf16 v[112:115], a[144:147], a[184:187], v[112:115]
v_cvt_pk_bf16_f32 v64, v64, v65
v_cvt_pk_bf16_f32 v65, v66, v67
v_mfma_f32_16x16x32_bf16 v[116:119], a[148:151], a[184:187], v[116:119]
v_cvt_pk_bf16_f32 v66, v68, v69
v_cvt_pk_bf16_f32 v67, v70, v71
v_mfma_f32_16x16x32_bf16 v[120:123], a[144:147], a[188:191], v[120:123]
v_cvt_pk_bf16_f32 v72, v72, v73
v_cvt_pk_bf16_f32 v73, v74, v75
v_mfma_f32_16x16x32_bf16 v[124:127], a[148:151], a[188:191], v[124:127]
buffer_load_dwordx4 v6, s[12:15], s64 offen offset:1024 lds
v_mfma_f32_16x16x32_bf16 v[128:131], a[152:155], a[176:179], v[128:131]
v_cvt_pk_bf16_f32 v74, v76, v77
v_cvt_pk_bf16_f32 v75, v78, v79
v_mfma_f32_16x16x32_bf16 v[132:135], a[156:159], a[176:179], v[132:135]
v_cvt_pk_bf16_f32 v80, v80, v81
v_cvt_pk_bf16_f32 v81, v82, v83
v_mfma_f32_16x16x32_bf16 v[136:139], a[152:155], a[180:183], v[136:139]
v_cvt_pk_bf16_f32 v82, v84, v85
v_cvt_pk_bf16_f32 v83, v86, v87
v_mfma_f32_16x16x32_bf16 v[140:143], a[156:159], a[180:183], v[140:143]
v_cvt_pk_bf16_f32 v88, v88, v89
v_cvt_pk_bf16_f32 v89, v90, v91
v_mfma_f32_16x16x32_bf16 v[144:147], a[152:155], a[184:187], v[144:147]
v_cvt_pk_bf16_f32 v90, v92, v93
v_cvt_pk_bf16_f32 v91, v94, v95
v_mfma_f32_16x16x32_bf16 v[148:151], a[156:159], a[184:187], v[148:151]
v_cvt_pk_bf16_f32 v96, v96, v97
v_cvt_pk_bf16_f32 v97, v98, v99
v_mfma_f32_16x16x32_bf16 v[152:155], a[152:155], a[188:191], v[152:155]
v_cvt_pk_bf16_f32 v98, v100, v101
v_cvt_pk_bf16_f32 v99, v102, v103
v_mfma_f32_16x16x32_bf16 v[156:159], a[156:159], a[188:191], v[156:159]
v_cvt_pk_bf16_f32 v104, v104, v105
v_cvt_pk_bf16_f32 v105, v106, v107
v_mfma_f32_16x16x32_bf16 v[160:163], a[96:99], a[64:67], v[160:163]
s_waitcnt vmcnt(15)
v_cvt_pk_bf16_f32 v106, v108, v109
v_cvt_pk_bf16_f32 v107, v110, v111
v_mfma_f32_16x16x32_bf16 v[160:163], a[160:163], a[128:131], v[160:163]
s_barrier
v_mfma_f32_16x16x32_bf16 v[164:167], a[100:103], a[64:67], v[164:167]
ds_read_b128 a[112:115], v9 offset:0
ds_read_b128 a[116:119], v9 offset:2048
v_mfma_f32_16x16x32_bf16 v[164:167], a[164:167], a[128:131], v[164:167]
s_add_u32 m0, s77, 49152
s_add_u32 s64, s76, 262144
v_cvt_pk_bf16_f32 v112, v112, v113
v_mfma_f32_16x16x32_bf16 v[168:171], a[104:107], a[64:67], v[168:171]
buffer_load_dwordx4 v7, s[20:23], s64 offen lds
v_mfma_f32_16x16x32_bf16 v[168:171], a[168:171], a[128:131], v[168:171]
ds_read_b128 a[120:123], v9 offset:4096
ds_read_b128 a[124:127], v9 offset:6144
v_mfma_f32_16x16x32_bf16 v[172:175], a[108:111], a[64:67], v[172:175]
v_cvt_pk_bf16_f32 v113, v114, v115
v_cvt_pk_bf16_f32 v114, v116, v117
v_mfma_f32_16x16x32_bf16 v[172:175], a[172:175], a[128:131], v[172:175]
ds_read_b64_tr_b16 a[176:177], v11 offset:0
ds_read_b64_tr_b16 a[178:179], v11 offset:512
v_mfma_f32_16x16x32_bf16 v[176:179], a[96:99], a[68:71], v[176:179]
v_cvt_pk_bf16_f32 v115, v118, v119
v_cvt_pk_bf16_f32 v120, v120, v121
v_mfma_f32_16x16x32_bf16 v[176:179], a[160:163], a[132:135], v[176:179]
s_add_u32 s53, s88, 0
ds_read_b64_tr_b16 a[180:181], v12 offset:0
ds_read_b64_tr_b16 a[182:183], v12 offset:512
v_mfma_f32_16x16x32_bf16 v[180:183], a[100:103], a[68:71], v[180:183]
buffer_store_dwordx4 v[40:43], v4, s[24:27], s53 offen offset:1024 sc1
v_mfma_f32_16x16x32_bf16 v[180:183], a[164:167], a[132:135], v[180:183]
ds_read_b64_tr_b16 a[184:185], v13 offset:0
ds_read_b64_tr_b16 a[186:187], v13 offset:512
v_mfma_f32_16x16x32_bf16 v[184:187], a[104:107], a[68:71], v[184:187]
buffer_load_dwordx4 v8, s[20:23], s64 offen offset:1024 lds
v_mfma_f32_16x16x32_bf16 v[184:187], a[168:171], a[132:135], v[184:187]
ds_read_b64_tr_b16 a[188:189], v14 offset:0
ds_read_b64_tr_b16 a[190:191], v14 offset:512
v_mfma_f32_16x16x32_bf16 v[188:191], a[108:111], a[68:71], v[188:191]
ds_read_b64_tr_b16 a[64:65], v11 offset:4096
ds_read_b64_tr_b16 a[66:67], v11 offset:4608
v_mfma_f32_16x16x32_bf16 v[188:191], a[172:175], a[132:135], v[188:191]
ds_read_b64_tr_b16 a[128:129], v12 offset:4096
ds_read_b64_tr_b16 a[130:131], v12 offset:4608
v_mfma_f32_16x16x32_bf16 v[192:195], a[96:99], a[72:75], v[192:195]
ds_read_b64_tr_b16 a[68:69], v13 offset:4096
ds_read_b64_tr_b16 a[70:71], v13 offset:4608
v_mfma_f32_16x16x32_bf16 v[192:195], a[160:163], a[136:139], v[192:195]
ds_read_b64_tr_b16 a[132:133], v14 offset:4096
ds_read_b64_tr_b16 a[134:135], v14 offset:4608
v_mfma_f32_16x16x32_bf16 v[196:199], a[100:103], a[72:75], v[196:199]
s_add_u32 m0, s80, 49152
s_add_u32 s64, s79, 4096
v_cvt_pk_bf16_f32 v121, v122, v123
v_mfma_f32_16x16x32_bf16 v[196:199], a[164:167], a[136:139], v[196:199]
v_cvt_pk_bf16_f32 v122, v124, v125
v_cvt_pk_bf16_f32 v123, v126, v127
v_mfma_f32_16x16x32_bf16 v[200:203], a[104:107], a[72:75], v[200:203]
buffer_load_dwordx4 v4, s[24:27], s64 offen sc1 lds
v_mfma_f32_16x16x32_bf16 v[200:203], a[168:171], a[136:139], v[200:203]
s_xor_b32 s65, s70, 256
s_add_u32 s71, s68, s65
s_add_u32 s72, s69, s65
v_mfma_f32_16x16x32_bf16 v[204:207], a[108:111], a[72:75], v[204:207]
v_cvt_pk_bf16_f32 v128, v128, v129
v_cvt_pk_bf16_f32 v129, v130, v131
v_mfma_f32_16x16x32_bf16 v[204:207], a[172:175], a[136:139], v[204:207]
v_cvt_pk_bf16_f32 v130, v132, v133
v_cvt_pk_bf16_f32 v131, v134, v135
v_mfma_f32_16x16x32_bf16 v[208:211], a[96:99], a[76:79], v[208:211]
ds_read_b128 a[72:75], v4 offset:8192
ds_read_b128 a[136:139], v4 offset:9216
v_mfma_f32_16x16x32_bf16 v[208:211], a[160:163], a[140:143], v[208:211]
v_cvt_pk_bf16_f32 v136, v136, v137
v_cvt_pk_bf16_f32 v137, v138, v139
v_mfma_f32_16x16x32_bf16 v[212:215], a[100:103], a[76:79], v[212:215]
s_add_u32 m0, s73, 32768
s_add_u32 s64, s71, 0
v_cvt_pk_bf16_f32 v138, v140, v141
v_mfma_f32_16x16x32_bf16 v[212:215], a[164:167], a[140:143], v[212:215]
v_cvt_pk_bf16_f32 v139, v142, v143
v_cvt_pk_bf16_f32 v144, v144, v145
v_mfma_f32_16x16x32_bf16 v[216:219], a[104:107], a[76:79], v[216:219]
buffer_load_dwordx4 v5, s[12:15], s64 offen lds
v_mfma_f32_16x16x32_bf16 v[216:219], a[168:171], a[140:143], v[216:219]
v_cvt_pk_bf16_f32 v145, v146, v147
v_cvt_pk_bf16_f32 v146, v148, v149
v_mfma_f32_16x16x32_bf16 v[220:223], a[108:111], a[76:79], v[220:223]
v_cvt_pk_bf16_f32 v147, v150, v151
v_cvt_pk_bf16_f32 v152, v152, v153
v_mfma_f32_16x16x32_bf16 v[220:223], a[172:175], a[140:143], v[220:223]
v_cvt_pk_bf16_f32 v153, v154, v155
v_cvt_pk_bf16_f32 v154, v156, v157
v_mfma_f32_16x16x32_bf16 v[224:227], a[96:99], a[80:83], v[224:227]
ds_read_b128 a[76:79], v4 offset:10240
ds_read_b128 a[140:143], v4 offset:11264
v_mfma_f32_16x16x32_bf16 v[224:227], a[160:163], a[144:147], v[224:227]
v_cvt_pk_bf16_f32 v155, v158, v159
v_mul_f32 v160, s91, v160
v_mfma_f32_16x16x32_bf16 v[228:231], a[100:103], a[80:83], v[228:231]
v_mul_f32 v161, s91, v161
v_mul_f32 v162, s91, v162
v_mfma_f32_16x16x32_bf16 v[228:231], a[164:167], a[144:147], v[228:231]
v_mul_f32 v163, s91, v163
v_mul_f32 v164, s91, v164
v_mfma_f32_16x16x32_bf16 v[232:235], a[104:107], a[80:83], v[232:235]
s_add_u32 s53, s88, 0
v_mul_f32 v165, s91, v165
v_mul_f32 v166, s91, v166
v_mfma_f32_16x16x32_bf16 v[232:235], a[168:171], a[144:147], v[232:235]
buffer_load_dwordx4 v6, s[12:15], s64 offen offset:1024 lds
v_mfma_f32_16x16x32_bf16 v[236:239], a[108:111], a[80:83], v[236:239]
buffer_store_dwordx4 v[48:51], v4, s[24:27], s53 offen offset:2048 sc1
v_mfma_f32_16x16x32_bf16 v[236:239], a[172:175], a[144:147], v[236:239]
v_mul_f32 v167, s91, v167
v_cvt_pk_bf16_f32 v160, v160, v161
v_mfma_f32_16x16x32_bf16 v[240:243], a[96:99], a[84:87], v[240:243]
v_cvt_pk_bf16_f32 v161, v162, v163
v_cvt_pk_bf16_f32 v162, v164, v165
v_mfma_f32_16x16x32_bf16 v[240:243], a[160:163], a[148:151], v[240:243]
v_cvt_pk_bf16_f32 v163, v166, v167
v_mul_f32 v168, s91, v168
v_mfma_f32_16x16x32_bf16 v[244:247], a[100:103], a[84:87], v[244:247]
v_mul_f32 v169, s91, v169
v_mul_f32 v170, s91, v170
v_mfma_f32_16x16x32_bf16 v[244:247], a[164:167], a[148:151], v[244:247]
s_add_u32 m0, s73, 34816
s_add_u32 s64, s71, 18432
v_mul_f32 v171, s91, v171
v_mfma_f32_16x16x32_bf16 v[248:251], a[104:107], a[84:87], v[248:251]
v_mul_f32 v172, s91, v172
v_mul_f32 v173, s91, v173
v_mfma_f32_16x16x32_bf16 v[248:251], a[168:171], a[148:151], v[248:251]
buffer_load_dwordx4 v5, s[12:15], s64 offen lds
v_mfma_f32_16x16x32_bf16 v[252:255], a[108:111], a[84:87], v[252:255]
v_mul_f32 v174, s91, v174
v_mul_f32 v175, s91, v175
v_mfma_f32_16x16x32_bf16 v[252:255], a[172:175], a[148:151], v[252:255]
v_cvt_pk_bf16_f32 v168, v168, v169
v_cvt_pk_bf16_f32 v169, v170, v171
v_mfma_f32_16x16x32_bf16 a[0:3], a[96:99], a[88:91], a[0:3]
v_cvt_pk_bf16_f32 v170, v172, v173
v_cvt_pk_bf16_f32 v171, v174, v175
v_mfma_f32_16x16x32_bf16 a[0:3], a[160:163], a[152:155], a[0:3]
v_mul_f32 v176, s91, v176
v_mul_f32 v177, s91, v177
v_mfma_f32_16x16x32_bf16 a[4:7], a[100:103], a[88:91], a[4:7]
v_mul_f32 v178, s91, v178
v_mul_f32 v179, s91, v179
v_mfma_f32_16x16x32_bf16 a[4:7], a[164:167], a[152:155], a[4:7]
v_mul_f32 v180, s91, v180
v_mul_f32 v181, s91, v181
v_mfma_f32_16x16x32_bf16 a[8:11], a[104:107], a[88:91], a[8:11]
v_mul_f32 v182, s91, v182
v_mul_f32 v183, s91, v183
v_mfma_f32_16x16x32_bf16 a[8:11], a[168:171], a[152:155], a[8:11]
buffer_load_dwordx4 v6, s[12:15], s64 offen offset:1024 lds
v_mfma_f32_16x16x32_bf16 a[12:15], a[108:111], a[88:91], a[12:15]
v_cvt_pk_bf16_f32 v176, v176, v177
v_cvt_pk_bf16_f32 v177, v178, v179
v_mfma_f32_16x16x32_bf16 a[12:15], a[172:175], a[152:155], a[12:15]
v_cvt_pk_bf16_f32 v178, v180, v181
v_cvt_pk_bf16_f32 v179, v182, v183
v_mfma_f32_16x16x32_bf16 a[16:19], a[96:99], a[92:95], a[16:19]
v_mul_f32 v184, s91, v184
v_mul_f32 v185, s91, v185
v_mfma_f32_16x16x32_bf16 a[16:19], a[160:163], a[156:159], a[16:19]
v_mul_f32 v186, s91, v186
v_mul_f32 v187, s91, v187
v_mfma_f32_16x16x32_bf16 a[20:23], a[100:103], a[92:95], a[20:23]
v_mul_f32 v188, s91, v188
v_mul_f32 v189, s91, v189
v_mfma_f32_16x16x32_bf16 a[20:23], a[164:167], a[156:159], a[20:23]
v_mul_f32 v190, s91, v190
v_mul_f32 v191, s91, v191
v_mfma_f32_16x16x32_bf16 a[24:27], a[104:107], a[92:95], a[24:27]
v_cvt_pk_bf16_f32 v184, v184, v185
v_cvt_pk_bf16_f32 v185, v186, v187
v_mfma_f32_16x16x32_bf16 a[24:27], a[168:171], a[156:159], a[24:27]
v_cvt_pk_bf16_f32 v186, v188, v189
v_cvt_pk_bf16_f32 v187, v190, v191
v_mfma_f32_16x16x32_bf16 a[28:31], a[108:111], a[92:95], a[28:31]
v_mul_f32 v192, s91, v192
v_mul_f32 v193, s91, v193
v_mfma_f32_16x16x32_bf16 a[28:31], a[172:175], a[156:159], a[28:31]
s_waitcnt lgkmcnt(0)
s_add_u32 s53, s88, 0
v_mul_f32 v194, s91, v194
v_mfma_f32_16x16x32_bf16 a[32:35], a[176:179], a[112:115], 0
s_waitcnt vmcnt(21)
v_mul_f32 v195, s91, v195
v_mul_f32 v196, s91, v196
v_mfma_f32_16x16x32_bf16 a[36:39], a[176:179], a[116:119], 0
s_barrier
v_mfma_f32_16x16x32_bf16 a[40:43], a[176:179], a[120:123], 0
ds_read_b128 a[96:99], v10 offset:0
v_mul_f32 v197, s91, v197
v_mfma_f32_16x16x32_bf16 a[44:47], a[176:179], a[124:127], 0
s_xor_b32 s75, s93, 2
s_lshl_b32 s76, s75, 19
s_add_u32 s76, s76, s74
v_mfma_f32_16x16x32_bf16 a[48:51], a[180:183], a[124:127], 0
s_mul_i32 s79, s75, 24576
s_add_u32 s79, s79, s78
v_mul_f32 v198, s91, v198
v_mfma_f32_16x16x32_bf16 a[52:55], a[180:183], a[120:123], 0
s_add_u32 m0, s77, 0
s_add_u32 s64, s76, 0
v_mul_f32 v199, s91, v199
v_mfma_f32_16x16x32_bf16 a[56:59], a[180:183], a[116:119], 0
buffer_load_dwordx4 v7, s[20:23], s64 offen lds
v_mfma_f32_16x16x32_bf16 a[60:63], a[180:183], a[112:115], 0
ds_read_b64_tr_b16 a[160:161], v11 offset:16384
ds_read_b64_tr_b16 a[162:163], v11 offset:16896
v_mfma_f32_16x16x32_bf16 a[192:195], a[184:187], a[112:115], 0
ds_read_b128 a[100:103], v10 offset:2048
v_cvt_pk_bf16_f32 v192, v192, v193
v_mfma_f32_16x16x32_bf16 a[196:199], a[184:187], a[116:119], 0
ds_read_b64_tr_b16 a[164:165], v12 offset:16384
ds_read_b64_tr_b16 a[166:167], v12 offset:16896
v_mfma_f32_16x16x32_bf16 a[200:203], a[184:187], a[120:123], 0
buffer_load_dwordx4 v8, s[20:23], s64 offen offset:1024 lds
v_mfma_f32_16x16x32_bf16 a[204:207], a[184:187], a[124:127], 0
ds_read_b128 a[104:107], v10 offset:4096
v_cvt_pk_bf16_f32 v193, v194, v195
v_mfma_f32_16x16x32_bf16 a[208:211], a[188:191], a[124:127], 0
ds_read_b64_tr_b16 a[168:169], v13 offset:16384
ds_read_b64_tr_b16 a[170:171], v13 offset:16896
v_mfma_f32_16x16x32_bf16 a[212:215], a[188:191], a[120:123], 0
ds_read_b128 a[108:111], v10 offset:6144
v_cvt_pk_bf16_f32 v194, v196, v197
v_mfma_f32_16x16x32_bf16 a[216:219], a[188:191], a[116:119], 0
s_add_u32 m0, s80, 0
s_add_u32 s64, s79, 0
v_cvt_pk_bf16_f32 v195, v198, v199
v_mfma_f32_16x16x32_bf16 a[220:223], a[188:191], a[112:115], 0
ds_read_b64_tr_b16 a[172:173], v14 offset:16384
ds_read_b64_tr_b16 a[174:175], v14 offset:16896
v_mfma_f32_16x16x32_bf16 a[224:227], a[64:67], a[112:115], 0
buffer_load_dwordx4 v4, s[24:27], s64 offen sc1 lds
v_mfma_f32_16x16x32_bf16 a[228:231], a[64:67], a[116:119], 0
ds_read_b128 a[88:91], v4 offset:24576
v_mul_f32 v200, s91, v200
v_mfma_f32_16x16x32_bf16 a[232:235], a[64:67], a[120:123], 0
ds_read_b64_tr_b16 a[80:81], v11 offset:20480
ds_read_b64_tr_b16 a[82:83], v11 offset:20992
v_mfma_f32_16x16x32_bf16 a[236:239], a[64:67], a[124:127], 0
buffer_store_dwordx4 v[56:59], v4, s[24:27], s53 offen offset:3072 sc1
v_mfma_f32_16x16x32_bf16 a[240:243], a[128:131], a[124:127], 0
s_add_u32 m0, s73, 36864
s_add_u32 s64, s72, 0
ds_read_b128 a[152:155], v4 offset:25600
v_mfma_f32_16x16x32_bf16 a[244:247], a[128:131], a[120:123], 0
v_mul_f32 v201, s91, v201
v_mul_f32 v202, s91, v202
v_mfma_f32_16x16x32_bf16 a[248:251], a[128:131], a[116:119], 0
buffer_load_dwordx4 v5, s[12:15], s64 offen lds
v_mfma_f32_16x16x32_bf16 v[36:39], a[128:131], a[112:115], 0
ds_read_b64_tr_b16 a[144:145], v12 offset:20480
ds_read_b64_tr_b16 a[146:147], v12 offset:20992
v_mfma_f32_16x16x32_bf16 v[44:47], a[68:71], a[112:115], 0
ds_read_b128 a[92:95], v4 offset:26624
v_mul_f32 v203, s91, v203
v_mfma_f32_16x16x32_bf16 v[32:35], a[68:71], a[116:119], 0
v_mul_f32 v204, s91, v204
v_mul_f32 v205, s91, v205
v_mfma_f32_16x16x32_bf16 v[52:55], a[68:71], a[120:123], 0
s_add_u32 s53, s88, 786432
ds_read_b64_tr_b16 a[84:85], v13 offset:20480
ds_read_b64_tr_b16 a[86:87], v13 offset:20992
v_mfma_f32_16x16x32_bf16 v[60:63], a[68:71], a[124:127], 0
buffer_store_dwordx4 v[64:67], v4, s[24:27], s53 offen offset:0 sc1
v_mfma_f32_16x16x32_bf16 v[68:71], a[132:135], a[124:127], 0
buffer_load_dwordx4 v6, s[12:15], s64 offen offset:1024 lds
v_mfma_f32_16x16x32_bf16 v[76:79], a[132:135], a[120:123], 0
ds_read_b128 a[156:159], v4 offset:27648
v_mul_f32 v206, s91, v206
v_mfma_f32_16x16x32_bf16 v[84:87], a[132:135], a[116:119], 0
ds_read_b64_tr_b16 a[148:149], v14 offset:20480
ds_read_b64_tr_b16 a[150:151], v14 offset:20992
v_mfma_f32_16x16x32_bf16 v[92:95], a[132:135], a[112:115], 0
v_mul_f32 v207, s91, v207
v_cvt_pk_bf16_f32 v200, v200, v201
v_mfma_f32_16x16x32_bf16 v[100:103], a[72:75], a[112:115], 0
s_add_u32 m0, s73, 38912
s_add_u32 s64, s72, 18432
v_cvt_pk_bf16_f32 v201, v202, v203
v_mfma_f32_16x16x32_bf16 v[108:111], a[72:75], a[116:119], 0
v_cvt_pk_bf16_f32 v202, v204, v205
v_cvt_pk_bf16_f32 v203, v206, v207
v_mfma_f32_16x16x32_bf16 v[116:119], a[72:75], a[120:123], 0
buffer_load_dwordx4 v5, s[12:15], s64 offen lds
v_mfma_f32_16x16x32_bf16 v[40:43], a[72:75], a[124:127], 0
v_mul_f32 v208, s91, v208
v_mul_f32 v209, s91, v209
v_mfma_f32_16x16x32_bf16 v[124:127], a[136:139], a[124:127], 0
v_mul_f32 v210, s91, v210
v_mul_f32 v211, s91, v211
v_mfma_f32_16x16x32_bf16 v[132:135], a[136:139], a[120:123], 0
v_mul_f32 v212, s91, v212
v_mul_f32 v213, s91, v213
v_mfma_f32_16x16x32_bf16 v[140:143], a[136:139], a[116:119], 0
v_mul_f32 v214, s91, v214
v_mul_f32 v215, s91, v215
v_mfma_f32_16x16x32_bf16 v[148:151], a[136:139], a[112:115], 0
v_cvt_pk_bf16_f32 v208, v208, v209
v_cvt_pk_bf16_f32 v209, v210, v211
v_mfma_f32_16x16x32_bf16 v[156:159], a[76:79], a[112:115], 0
buffer_load_dwordx4 v6, s[12:15], s64 offen offset:1024 lds
v_mfma_f32_16x16x32_bf16 v[48:51], a[76:79], a[116:119], 0
v_add_u32 v9, -65536, v9
v_add_u32 v10, -65536, v10
v_mfma_f32_16x16x32_bf16 v[164:167], a[76:79], a[120:123], 0
v_cvt_pk_bf16_f32 v210, v212, v213
v_cvt_pk_bf16_f32 v211, v214, v215
v_mfma_f32_16x16x32_bf16 v[172:175], a[76:79], a[124:127], 0
v_mul_f32 v216, s91, v216
v_mul_f32 v217, s91, v217
v_mfma_f32_16x16x32_bf16 v[180:183], a[140:143], a[124:127], 0
v_mul_f32 v218, s91, v218
v_mul_f32 v219, s91, v219
v_mfma_f32_16x16x32_bf16 v[188:191], a[140:143], a[120:123], 0
v_mul_f32 v220, s91, v220
v_mul_f32 v221, s91, v221
v_mfma_f32_16x16x32_bf16 v[196:199], a[140:143], a[116:119], 0
v_mul_f32 v222, s91, v222
v_mul_f32 v223, s91, v223
v_mfma_f32_16x16x32_bf16 v[56:59], a[140:143], a[112:115], 0
s_waitcnt lgkmcnt(0)
v_cvt_pk_bf16_f32 v216, v216, v217
v_cvt_pk_bf16_f32 v217, v218, v219
v_mfma_f32_16x16x32_bf16 a[32:35], a[160:163], a[96:99], a[32:35]
s_waitcnt vmcnt(18)
v_cvt_pk_bf16_f32 v218, v220, v221
v_cvt_pk_bf16_f32 v219, v222, v223
v_mfma_f32_16x16x32_bf16 a[36:39], a[160:163], a[100:103], a[36:39]
s_barrier
v_mfma_f32_16x16x32_bf16 a[40:43], a[160:163], a[104:107], a[40:43]
ds_read_b128 a[112:115], v9 offset:0
v_mul_f32 v224, s91, v224
v_mfma_f32_16x16x32_bf16 a[44:47], a[160:163], a[108:111], a[44:47]
s_add_u32 m0, s77, 16384
s_add_u32 s64, s76, 262144
v_mul_f32 v225, s91, v225
v_mfma_f32_16x16x32_bf16 a[48:51], a[164:167], a[108:111], a[48:51]
buffer_load_dwordx4 v7, s[20:23], s64 offen lds
v_mfma_f32_16x16x32_bf16 a[52:55], a[164:167], a[104:107], a[52:55]
s_add_u32 s53, s88, 786432
ds_read_b64_tr_b16 a[176:177], v11 offset:32768
ds_read_b64_tr_b16 a[178:179], v11 offset:33280
v_mfma_f32_16x16x32_bf16 a[56:59], a[164:167], a[100:103], a[56:59]
ds_read_b128 a[116:119], v9 offset:2048
v_mul_f32 v226, s91, v226
v_mfma_f32_16x16x32_bf16 a[60:63], a[164:167], a[96:99], a[60:63]
ds_read_b64_tr_b16 a[180:181], v12 offset:32768
ds_read_b64_tr_b16 a[182:183], v12 offset:33280
v_mfma_f32_16x16x32_bf16 a[192:195], a[168:171], a[96:99], a[192:195]
ds_read_b128 a[120:123], v9 offset:4096
v_mul_f32 v227, s91, v227
v_mfma_f32_16x16x32_bf16 a[196:199], a[168:171], a[100:103], a[196:199]
buffer_store_dwordx4 v[72:75], v4, s[24:27], s53 offen offset:1024 sc1
v_mfma_f32_16x16x32_bf16 a[200:203], a[168:171], a[104:107], a[200:203]
buffer_load_dwordx4 v8, s[20:23], s64 offen offset:1024 lds
v_mfma_f32_16x16x32_bf16 a[204:207], a[168:171], a[108:111], a[204:207]
ds_read_b64_tr_b16 a[184:185], v13 offset:32768
ds_read_b64_tr_b16 a[186:187], v13 offset:33280
v_mfma_f32_16x16x32_bf16 a[208:211], a[172:175], a[108:111], a[208:211]
ds_read_b128 a[124:127], v9 offset:6144
v_mul_f32 v228, s91, v228
v_mfma_f32_16x16x32_bf16 a[212:215], a[172:175], a[104:107], a[212:215]
v_mul_f32 v229, s91, v229
v_mul_f32 v230, s91, v230
v_mfma_f32_16x16x32_bf16 a[216:219], a[172:175], a[100:103], a[216:219]
s_add_u32 m0, s80, 16384
s_add_u32 s64, s79, 4096
v_mul_f32 v231, s91, v231
v_mfma_f32_16x16x32_bf16 a[220:223], a[172:175], a[96:99], a[220:223]
ds_read_b64_tr_b16 a[188:189], v14 offset:32768
ds_read_b64_tr_b16 a[190:191], v14 offset:33280
v_mfma_f32_16x16x32_bf16 a[224:227], a[80:83], a[96:99], a[224:227]
buffer_load_dwordx4 v4, s[24:27], s64 offen sc1 lds
v_mfma_f32_16x16x32_bf16 a[228:231], a[80:83], a[100:103], a[228:231]
s_xor_b32 s65, s70, 384
s_add_u32 s71, s68, s65
s_add_u32 s72, s69, s65
v_mfma_f32_16x16x32_bf16 a[232:235], a[80:83], a[104:107], a[232:235]
ds_read_b128 a[72:75], v4 offset:40960
v_cvt_pk_bf16_f32 v224, v224, v225
v_mfma_f32_16x16x32_bf16 a[236:239], a[80:83], a[108:111], a[236:239]
ds_read_b64_tr_b16 a[64:65], v11 offset:36864
ds_read_b64_tr_b16 a[66:67], v11 offset:37376
v_mfma_f32_16x16x32_bf16 a[240:243], a[144:147], a[108:111], a[240:243]
s_add_u32 m0, s73, 65536
s_add_u32 s64, s71, 0
ds_read_b128 a[136:139], v4 offset:41984
v_mfma_f32_16x16x32_bf16 a[244:247], a[144:147], a[104:107], a[244:247]
v_cvt_pk_bf16_f32 v225, v226, v227
v_cvt_pk_bf16_f32 v226, v228, v229
v_mfma_f32_16x16x32_bf16 a[248:251], a[144:147], a[100:103], a[248:251]
buffer_load_dwordx4 v5, s[12:15], s64 offen lds
v_mfma_f32_16x16x32_bf16 v[36:39], a[144:147], a[96:99], v[36:39]
ds_read_b64_tr_b16 a[128:129], v12 offset:36864
ds_read_b64_tr_b16 a[130:131], v12 offset:37376
v_mfma_f32_16x16x32_bf16 v[44:47], a[84:87], a[96:99], v[44:47]
ds_read_b128 a[76:79], v4 offset:43008
v_cvt_pk_bf16_f32 v227, v230, v231
v_mfma_f32_16x16x32_bf16 v[32:35], a[84:87], a[100:103], v[32:35]
v_mul_f32 v232, s91, v232
v_mul_f32 v233, s91, v233
v_mfma_f32_16x16x32_bf16 v[52:55], a[84:87], a[104:107], v[52:55]
ds_read_b64_tr_b16 a[68:69], v13 offset:36864
ds_read_b64_tr_b16 a[70:71], v13 offset:37376
v_mfma_f32_16x16x32_bf16 v[60:63], a[84:87], a[108:111], v[60:63]
v_mul_f32 v234, s91, v234
v_mul_f32 v235, s91, v235
v_mfma_f32_16x16x32_bf16 v[68:71], a[148:151], a[108:111], v[68:71]
buffer_load_dwordx4 v6, s[12:15], s64 offen offset:1024 lds
v_mfma_f32_16x16x32_bf16 v[76:79], a[148:151], a[104:107], v[76:79]
ds_read_b128 a[140:143], v4 offset:44032
v_mul_f32 v236, s91, v236
v_mfma_f32_16x16x32_bf16 v[84:87], a[148:151], a[100:103], v[84:87]
ds_read_b64_tr_b16 a[132:133], v14 offset:36864
ds_read_b64_tr_b16 a[134:135], v14 offset:37376
v_mfma_f32_16x16x32_bf16 v[92:95], a[148:151], a[96:99], v[92:95]
v_mul_f32 v237, s91, v237
v_mul_f32 v238, s91, v238
v_mfma_f32_16x16x32_bf16 v[100:103], a[88:91], a[96:99], v[100:103]
s_add_u32 m0, s73, 67584
s_add_u32 s64, s71, 18432
s_add_u32 s53, s88, 786432
v_mfma_f32_16x16x32_bf16 v[108:111], a[88:91], a[100:103], v[108:111]
buffer_store_dwordx4 v[80:83], v4, s[24:27], s53 offen offset:2048 sc1
v_mfma_f32_16x16x32_bf16 v[116:119], a[88:91], a[104:107], v[116:119]
buffer_load_dwordx4 v5, s[12:15], s64 offen lds
v_mfma_f32_16x16x32_bf16 v[40:43], a[88:91], a[108:111], v[40:43]
v_mul_f32 v239, s91, v239
v_cvt_pk_bf16_f32 v232, v232, v233
v_mfma_f32_16x16x32_bf16 v[124:127], a[152:155], a[108:111], v[124:127]
v_cvt_pk_bf16_f32 v233, v234, v235
v_cvt_pk_bf16_f32 v234, v236, v237
v_mfma_f32_16x16x32_bf16 v[132:135], a[152:155], a[104:107], v[132:135]
v_cvt_pk_bf16_f32 v235, v238, v239
v_mul_f32 v240, s91, v240
v_mfma_f32_16x16x32_bf16 v[140:143], a[152:155], a[100:103], v[140:143]
v_mul_f32 v241, s91, v241
v_mul_f32 v242, s91, v242
v_mfma_f32_16x16x32_bf16 v[148:151], a[152:155], a[96:99], v[148:151]
v_mul_f32 v243, s91, v243
v_mul_f32 v244, s91, v244
v_mfma_f32_16x16x32_bf16 v[156:159], a[92:95], a[96:99], v[156:159]
buffer_load_dwordx4 v6, s[12:15], s64 offen offset:1024 lds
v_mfma_f32_16x16x32_bf16 v[48:51], a[92:95], a[100:103], v[48:51]
v_mul_f32 v245, s91, v245
v_mul_f32 v246, s91, v246
v_mfma_f32_16x16x32_bf16 v[164:167], a[92:95], a[104:107], v[164:167]
v_mul_f32 v247, s91, v247
v_cvt_pk_bf16_f32 v240, v240, v241
v_mfma_f32_16x16x32_bf16 v[172:175], a[92:95], a[108:111], v[172:175]
v_cvt_pk_bf16_f32 v241, v242, v243
v_cvt_pk_bf16_f32 v242, v244, v245
v_mfma_f32_16x16x32_bf16 v[180:183], a[156:159], a[108:111], v[180:183]
v_cvt_pk_bf16_f32 v243, v246, v247
v_mul_f32 v248, s91, v248
v_mfma_f32_16x16x32_bf16 v[188:191], a[156:159], a[104:107], v[188:191]
v_mul_f32 v249, s91, v249
v_mul_f32 v250, s91, v250
v_mfma_f32_16x16x32_bf16 v[196:199], a[156:159], a[100:103], v[196:199]
v_mul_f32 v251, s91, v251
v_mul_f32 v252, s91, v252
v_mfma_f32_16x16x32_bf16 v[56:59], a[156:159], a[96:99], v[56:59]
s_waitcnt lgkmcnt(0)
v_mul_f32 v253, s91, v253
v_mul_f32 v254, s91, v254
v_mfma_f32_16x16x32_bf16 a[32:35], a[176:179], a[112:115], a[32:35]
s_waitcnt vmcnt(23)
v_mul_f32 v255, s91, v255
v_cvt_pk_bf16_f32 v248, v248, v249
v_mfma_f32_16x16x32_bf16 a[36:39], a[176:179], a[116:119], a[36:39]
s_barrier
v_mfma_f32_16x16x32_bf16 a[40:43], a[176:179], a[120:123], a[40:43]
ds_read_b128 a[96:99], v10 offset:0
v_cvt_pk_bf16_f32 v249, v250, v251
v_mfma_f32_16x16x32_bf16 a[44:47], a[176:179], a[124:127], a[44:47]
s_xor_b32 s75, s93, 3
s_lshl_b32 s76, s75, 19
s_add_u32 s76, s76, s74
v_mfma_f32_16x16x32_bf16 a[48:51], a[180:183], a[124:127], a[48:51]
s_mul_i32 s79, s75, 24576
s_add_u32 s79, s79, s78
v_cvt_pk_bf16_f32 v250, v252, v253
v_mfma_f32_16x16x32_bf16 a[52:55], a[180:183], a[120:123], a[52:55]
s_add_u32 m0, s77, 32768
s_add_u32 s64, s76, 0
v_cvt_pk_bf16_f32 v251, v254, v255
v_mfma_f32_16x16x32_bf16 a[56:59], a[180:183], a[116:119], a[56:59]
buffer_load_dwordx4 v7, s[20:23], s64 offen lds
v_mfma_f32_16x16x32_bf16 a[60:63], a[180:183], a[112:115], a[60:63]
ds_read_b64_tr_b16 a[160:161], v11 offset:49152
ds_read_b64_tr_b16 a[162:163], v11 offset:49664
v_mfma_f32_16x16x32_bf16 a[192:195], a[184:187], a[112:115], a[192:195]
ds_read_b128 a[100:103], v10 offset:2048
v_accvgpr_read_b32 v16, a0
v_mfma_f32_16x16x32_bf16 a[196:199], a[184:187], a[116:119], a[196:199]
ds_read_b64_tr_b16 a[164:165], v12 offset:49152
ds_read_b64_tr_b16 a[166:167], v12 offset:49664
v_mfma_f32_16x16x32_bf16 a[200:203], a[184:187], a[120:123], a[200:203]
buffer_load_dwordx4 v8, s[20:23], s64 offen offset:1024 lds
v_mfma_f32_16x16x32_bf16 a[204:207], a[184:187], a[124:127], a[204:207]
s_add_u32 s53, s88, 786432
ds_read_b128 a[104:107], v10 offset:4096
v_accvgpr_read_b32 v17, a1
v_mfma_f32_16x16x32_bf16 a[208:211], a[188:191], a[124:127], a[208:211]
ds_read_b64_tr_b16 a[168:169], v13 offset:49152
ds_read_b64_tr_b16 a[170:171], v13 offset:49664
v_mfma_f32_16x16x32_bf16 a[212:215], a[188:191], a[120:123], a[212:215]
ds_read_b128 a[108:111], v10 offset:6144
v_accvgpr_read_b32 v18, a2
v_mfma_f32_16x16x32_bf16 a[216:219], a[188:191], a[116:119], a[216:219]
s_add_u32 m0, s80, 32768
s_add_u32 s64, s79, 0
v_accvgpr_read_b32 v19, a3
v_mfma_f32_16x16x32_bf16 a[220:223], a[188:191], a[112:115], a[220:223]
ds_read_b64_tr_b16 a[172:173], v14 offset:49152
ds_read_b64_tr_b16 a[174:175], v14 offset:49664
v_mfma_f32_16x16x32_bf16 a[224:227], a[64:67], a[112:115], a[224:227]
buffer_load_dwordx4 v4, s[24:27], s64 offen sc1 lds
v_mfma_f32_16x16x32_bf16 a[228:231], a[64:67], a[116:119], a[228:231]
ds_read_b128 a[88:91], v4 offset:57344
v_accvgpr_read_b32 v20, a4
v_mfma_f32_16x16x32_bf16 a[232:235], a[64:67], a[120:123], a[232:235]
ds_read_b64_tr_b16 a[80:81], v11 offset:53248
ds_read_b64_tr_b16 a[82:83], v11 offset:53760
v_mfma_f32_16x16x32_bf16 a[236:239], a[64:67], a[124:127], a[236:239]
buffer_store_dwordx4 v[88:91], v4, s[24:27], s53 offen offset:3072 sc1
v_mfma_f32_16x16x32_bf16 a[240:243], a[128:131], a[124:127], a[240:243]
s_add_u32 m0, s73, 69632
s_add_u32 s64, s72, 0
ds_read_b128 a[152:155], v4 offset:58368
v_mfma_f32_16x16x32_bf16 a[244:247], a[128:131], a[120:123], a[244:247]
v_accvgpr_read_b32 v21, a5
v_accvgpr_read_b32 v22, a6
v_mfma_f32_16x16x32_bf16 a[248:251], a[128:131], a[116:119], a[248:251]
buffer_load_dwordx4 v5, s[12:15], s64 offen lds
v_mfma_f32_16x16x32_bf16 v[36:39], a[128:131], a[112:115], v[36:39]
ds_read_b64_tr_b16 a[144:145], v12 offset:53248
ds_read_b64_tr_b16 a[146:147], v12 offset:53760
v_mfma_f32_16x16x32_bf16 v[44:47], a[68:71], a[112:115], v[44:47]
ds_read_b128 a[92:95], v4 offset:59392
v_accvgpr_read_b32 v23, a7
v_mfma_f32_16x16x32_bf16 v[32:35], a[68:71], a[116:119], v[32:35]
v_mul_f32 v16, s91, v16
v_mul_f32 v17, s91, v17
v_mfma_f32_16x16x32_bf16 v[52:55], a[68:71], a[120:123], v[52:55]
ds_read_b64_tr_b16 a[84:85], v13 offset:53248
ds_read_b64_tr_b16 a[86:87], v13 offset:53760
v_mfma_f32_16x16x32_bf16 v[60:63], a[68:71], a[124:127], v[60:63]
v_mul_f32 v18, s91, v18
v_mul_f32 v19, s91, v19
v_mfma_f32_16x16x32_bf16 v[68:71], a[132:135], a[124:127], v[68:71]
buffer_load_dwordx4 v6, s[12:15], s64 offen offset:1024 lds
v_mfma_f32_16x16x32_bf16 v[76:79], a[132:135], a[120:123], v[76:79]
ds_read_b128 a[156:159], v4 offset:60416
v_mul_f32 v20, s91, v20
v_mfma_f32_16x16x32_bf16 v[84:87], a[132:135], a[116:119], v[84:87]
ds_read_b64_tr_b16 a[148:149], v14 offset:53248
ds_read_b64_tr_b16 a[150:151], v14 offset:53760
v_mfma_f32_16x16x32_bf16 v[92:95], a[132:135], a[112:115], v[92:95]
v_mul_f32 v21, s91, v21
v_mul_f32 v22, s91, v22
v_mfma_f32_16x16x32_bf16 v[100:103], a[72:75], a[112:115], v[100:103]
s_add_u32 m0, s73, 71680
s_add_u32 s64, s72, 18432
v_mul_f32 v23, s91, v23
v_mfma_f32_16x16x32_bf16 v[108:111], a[72:75], a[116:119], v[108:111]
v_cvt_pk_bf16_f32 v16, v16, v17
v_cvt_pk_bf16_f32 v17, v18, v19
v_mfma_f32_16x16x32_bf16 v[116:119], a[72:75], a[120:123], v[116:119]
buffer_load_dwordx4 v5, s[12:15], s64 offen lds
v_mfma_f32_16x16x32_bf16 v[40:43], a[72:75], a[124:127], v[40:43]
v_cvt_pk_bf16_f32 v18, v20, v21
v_cvt_pk_bf16_f32 v19, v22, v23
v_mfma_f32_16x16x32_bf16 v[124:127], a[136:139], a[124:127], v[124:127]
v_accvgpr_write_b32 a0, v16
v_accvgpr_write_b32 a1, v17
v_mfma_f32_16x16x32_bf16 v[132:135], a[136:139], a[120:123], v[132:135]
v_accvgpr_write_b32 a2, v18
v_accvgpr_write_b32 a3, v19
v_mfma_f32_16x16x32_bf16 v[140:143], a[136:139], a[116:119], v[140:143]
s_add_u32 s53, s87, 0
v_accvgpr_read_b32 v16, a8
v_accvgpr_read_b32 v17, a9
v_mfma_f32_16x16x32_bf16 v[148:151], a[136:139], a[112:115], v[148:151]
buffer_store_dwordx4 v[160:163], v4, s[24:27], s53 offen offset:0 sc1
v_mfma_f32_16x16x32_bf16 v[156:159], a[76:79], a[112:115], v[156:159]
buffer_load_dwordx4 v6, s[12:15], s64 offen offset:1024 lds
v_mfma_f32_16x16x32_bf16 v[48:51], a[76:79], a[116:119], v[48:51]
v_add_u32 v9, 32768, v9
v_add_u32 v10, 32768, v10
v_mfma_f32_16x16x32_bf16 v[164:167], a[76:79], a[120:123], v[164:167]
v_accvgpr_read_b32 v18, a10
v_accvgpr_read_b32 v19, a11
v_mfma_f32_16x16x32_bf16 v[172:175], a[76:79], a[124:127], v[172:175]
v_accvgpr_read_b32 v20, a12
v_accvgpr_read_b32 v21, a13
v_mfma_f32_16x16x32_bf16 v[180:183], a[140:143], a[124:127], v[180:183]
v_accvgpr_read_b32 v22, a14
v_accvgpr_read_b32 v23, a15
v_mfma_f32_16x16x32_bf16 v[188:191], a[140:143], a[120:123], v[188:191]
v_mul_f32 v16, s91, v16
v_mul_f32 v17, s91, v17
v_mfma_f32_16x16x32_bf16 v[196:199], a[140:143], a[116:119], v[196:199]
v_mul_f32 v18, s91, v18
v_mul_f32 v19, s91, v19
v_mfma_f32_16x16x32_bf16 v[56:59], a[140:143], a[112:115], v[56:59]
s_waitcnt lgkmcnt(0)
v_mul_f32 v20, s91, v20
v_mul_f32 v21, s91, v21
v_mfma_f32_16x16x32_bf16 a[32:35], a[160:163], a[96:99], a[32:35]
s_waitcnt vmcnt(18)
v_mul_f32 v22, s91, v22
v_mul_f32 v23, s91, v23
v_mfma_f32_16x16x32_bf16 a[36:39], a[160:163], a[100:103], a[36:39]
s_barrier
v_mfma_f32_16x16x32_bf16 a[40:43], a[160:163], a[104:107], a[40:43]
ds_read_b128 a[112:115], v9 offset:0
v_cvt_pk_bf16_f32 v16, v16, v17
v_mfma_f32_16x16x32_bf16 a[44:47], a[160:163], a[108:111], a[44:47]
s_add_u32 m0, s77, 49152
s_add_u32 s64, s76, 262144
v_cvt_pk_bf16_f32 v17, v18, v19
v_mfma_f32_16x16x32_bf16 a[48:51], a[164:167], a[108:111], a[48:51]
buffer_load_dwordx4 v7, s[20:23], s64 offen lds
v_mfma_f32_16x16x32_bf16 a[52:55], a[164:167], a[104:107], a[52:55]
ds_read_b64_tr_b16 a[176:177], v11 offset:0
ds_read_b64_tr_b16 a[178:179], v11 offset:512
v_mfma_f32_16x16x32_bf16 a[56:59], a[164:167], a[100:103], a[56:59]
ds_read_b128 a[116:119], v9 offset:2048
v_cvt_pk_bf16_f32 v18, v20, v21
v_mfma_f32_16x16x32_bf16 a[60:63], a[164:167], a[96:99], a[60:63]
ds_read_b64_tr_b16 a[180:181], v12 offset:0
ds_read_b64_tr_b16 a[182:183], v12 offset:512
v_mfma_f32_16x16x32_bf16 a[192:195], a[168:171], a[96:99], a[192:195]
ds_read_b128 a[120:123], v9 offset:4096
v_cvt_pk_bf16_f32 v19, v22, v23
v_mfma_f32_16x16x32_bf16 a[196:199], a[168:171], a[100:103], a[196:199]
v_accvgpr_write_b32 a8, v16
v_accvgpr_write_b32 a9, v17
v_mfma_f32_16x16x32_bf16 a[200:203], a[168:171], a[104:107], a[200:203]
buffer_load_dwordx4 v8, s[20:23], s64 offen offset:1024 lds
v_mfma_f32_16x16x32_bf16 a[204:207], a[168:171], a[108:111], a[204:207]
ds_read_b64_tr_b16 a[184:185], v13 offset:0
ds_read_b64_tr_b16 a[186:187], v13 offset:512
v_mfma_f32_16x16x32_bf16 a[208:211], a[172:175], a[108:111], a[208:211]
ds_read_b128 a[124:127], v9 offset:6144
v_accvgpr_write_b32 a10, v18
v_mfma_f32_16x16x32_bf16 a[212:215], a[172:175], a[104:107], a[212:215]
v_accvgpr_write_b32 a11, v19
v_accvgpr_read_b32 v16, a16
v_mfma_f32_16x16x32_bf16 a[216:219], a[172:175], a[100:103], a[216:219]
s_add_u32 m0, s80, 49152
s_add_u32 s64, s79, 4096
v_accvgpr_read_b32 v17, a17
v_mfma_f32_16x16x32_bf16 a[220:223], a[172:175], a[96:99], a[220:223]
ds_read_b64_tr_b16 a[188:189], v14 offset:0
ds_read_b64_tr_b16 a[190:191], v14 offset:512
v_mfma_f32_16x16x32_bf16 a[224:227], a[80:83], a[96:99], a[224:227]
buffer_load_dwordx4 v4, s[24:27], s64 offen sc1 lds
v_mfma_f32_16x16x32_bf16 a[228:231], a[80:83], a[100:103], a[228:231]
s_xor_b32 s65, s70, 512
s_add_u32 s71, s68, s65
s_add_u32 s72, s69, s65
v_mfma_f32_16x16x32_bf16 a[232:235], a[80:83], a[104:107], a[232:235]
s_add_u32 s53, s87, 0
ds_read_b128 a[72:75], v4 offset:8192
v_accvgpr_read_b32 v18, a18
v_mfma_f32_16x16x32_bf16 a[236:239], a[80:83], a[108:111], a[236:239]
ds_read_b64_tr_b16 a[64:65], v11 offset:4096
ds_read_b64_tr_b16 a[66:67], v11 offset:4608
v_mfma_f32_16x16x32_bf16 a[240:243], a[144:147], a[108:111], a[240:243]
s_add_u32 m0, s73, 0
s_add_u32 s64, s71, 0
ds_read_b128 a[136:139], v4 offset:9216
v_mfma_f32_16x16x32_bf16 a[244:247], a[144:147], a[104:107], a[244:247]
buffer_store_dwordx4 v[168:171], v4, s[24:27], s53 offen offset:1024 sc1
v_mfma_f32_16x16x32_bf16 a[248:251], a[144:147], a[100:103], a[248:251]
buffer_load_dwordx4 v5, s[12:15], s64 offen lds
v_mfma_f32_16x16x32_bf16 v[36:39], a[144:147], a[96:99], v[36:39]
ds_read_b64_tr_b16 a[128:129], v12 offset:4096
ds_read_b64_tr_b16 a[130:131], v12 offset:4608
v_mfma_f32_16x16x32_bf16 v[44:47], a[84:87], a[96:99], v[44:47]
ds_read_b128 a[76:79], v4 offset:10240
v_accvgpr_read_b32 v19, a19
v_mfma_f32_16x16x32_bf16 v[32:35], a[84:87], a[100:103], v[32:35]
v_accvgpr_read_b32 v20, a20
v_accvgpr_read_b32 v21, a21
v_mfma_f32_16x16x32_bf16 v[52:55], a[84:87], a[104:107], v[52:55]
ds_read_b64_tr_b16 a[68:69], v13 offset:4096
ds_read_b64_tr_b16 a[70:71], v13 offset:4608
v_mfma_f32_16x16x32_bf16 v[60:63], a[84:87], a[108:111], v[60:63]
v_accvgpr_read_b32 v22, a22
v_accvgpr_read_b32 v23, a23
v_mfma_f32_16x16x32_bf16 v[68:71], a[148:151], a[108:111], v[68:71]
buffer_load_dwordx4 v6, s[12:15], s64 offen offset:1024 lds
v_mfma_f32_16x16x32_bf16 v[76:79], a[148:151], a[104:107], v[76:79]
ds_read_b128 a[140:143], v4 offset:11264
v_mul_f32 v16, s91, v16
v_mfma_f32_16x16x32_bf16 v[84:87], a[148:151], a[100:103], v[84:87]
ds_read_b64_tr_b16 a[132:133], v14 offset:4096
ds_read_b64_tr_b16 a[134:135], v14 offset:4608
v_mfma_f32_16x16x32_bf16 v[92:95], a[148:151], a[96:99], v[92:95]
v_mul_f32 v17, s91, v17
v_mul_f32 v18, s91, v18
v_mfma_f32_16x16x32_bf16 v[100:103], a[88:91], a[96:99], v[100:103]
s_add_u32 m0, s73, 2048
s_add_u32 s64, s71, 18432
v_mul_f32 v19, s91, v19
v_mfma_f32_16x16x32_bf16 v[108:111], a[88:91], a[100:103], v[108:111]
v_mul_f32 v20, s91, v20
v_mul_f32 v21, s91, v21
v_mfma_f32_16x16x32_bf16 v[116:119], a[88:91], a[104:107], v[116:119]
buffer_load_dwordx4 v5, s[12:15], s64 offen lds
v_mfma_f32_16x16x32_bf16 v[40:43], a[88:91], a[108:111], v[40:43]
v_mul_f32 v22, s91, v22
v_mul_f32 v23, s91, v23
v_mfma_f32_16x16x32_bf16 v[124:127], a[152:155], a[108:111], v[124:127]
v_cvt_pk_bf16_f32 v16, v16, v17
v_cvt_pk_bf16_f32 v17, v18, v19
v_mfma_f32_16x16x32_bf16 v[132:135], a[152:155], a[104:107], v[132:135]
v_cvt_pk_bf16_f32 v18, v20, v21
v_cvt_pk_bf16_f32 v19, v22, v23
v_mfma_f32_16x16x32_bf16 v[140:143], a[152:155], a[100:103], v[140:143]
v_accvgpr_write_b32 a16, v16
v_accvgpr_write_b32 a17, v17
v_mfma_f32_16x16x32_bf16 v[148:151], a[152:155], a[96:99], v[148:151]
v_accvgpr_write_b32 a18, v18
v_accvgpr_write_b32 a19, v19
v_mfma_f32_16x16x32_bf16 v[156:159], a[92:95], a[96:99], v[156:159]
buffer_load_dwordx4 v6, s[12:15], s64 offen offset:1024 lds
v_mfma_f32_16x16x32_bf16 v[48:51], a[92:95], a[100:103], v[48:51]
v_accvgpr_read_b32 v16, a24
v_accvgpr_read_b32 v17, a25
v_mfma_f32_16x16x32_bf16 v[164:167], a[92:95], a[104:107], v[164:167]
v_accvgpr_read_b32 v18, a26
v_accvgpr_read_b32 v19, a27
v_mfma_f32_16x16x32_bf16 v[172:175], a[92:95], a[108:111], v[172:175]
v_accvgpr_read_b32 v20, a28
v_accvgpr_read_b32 v21, a29
v_mfma_f32_16x16x32_bf16 v[180:183], a[156:159], a[108:111], v[180:183]
s_add_u32 s53, s87, 4096
v_accvgpr_read_b32 v22, a30
v_accvgpr_read_b32 v23, a31
v_mfma_f32_16x16x32_bf16 v[188:191], a[156:159], a[104:107], v[188:191]
buffer_store_dwordx4 v[176:179], v4, s[24:27], s53 offen offset:0 sc1
v_mfma_f32_16x16x32_bf16 v[196:199], a[156:159], a[100:103], v[196:199]
v_mul_f32 v16, s91, v16
v_mul_f32 v17, s91, v17
v_mfma_f32_16x16x32_bf16 v[56:59], a[156:159], a[96:99], v[56:59]
s_waitcnt lgkmcnt(0)
v_mul_f32 v18, s91, v18
v_mul_f32 v19, s91, v19
v_mfma_f32_16x16x32_bf16 a[32:35], a[176:179], a[112:115], a[32:35]
s_waitcnt vmcnt(23)
v_mul_f32 v20, s91, v20
v_mul_f32 v21, s91, v21
v_mfma_f32_16x16x32_bf16 a[36:39], a[176:179], a[116:119], a[36:39]
s_barrier
v_mfma_f32_16x16x32_bf16 a[40:43], a[176:179], a[120:123], a[40:43]
ds_read_b128 a[96:99], v10 offset:0
v_mul_f32 v22, s91, v22
v_mfma_f32_16x16x32_bf16 a[44:47], a[176:179], a[124:127], a[44:47]
s_xor_b32 s75, s93, 4
s_lshl_b32 s76, s75, 19
s_add_u32 s76, s76, s74
v_mfma_f32_16x16x32_bf16 a[48:51], a[180:183], a[124:127], a[48:51]
s_mul_i32 s79, s75, 24576
s_add_u32 s79, s79, s78
v_mul_f32 v23, s91, v23
v_mfma_f32_16x16x32_bf16 a[52:55], a[180:183], a[120:123], a[52:55]
s_add_u32 m0, s77, 0
s_add_u32 s64, s76, 0
v_cvt_pk_bf16_f32 v16, v16, v17
v_mfma_f32_16x16x32_bf16 a[56:59], a[180:183], a[116:119], a[56:59]
buffer_load_dwordx4 v7, s[20:23], s64 offen lds
v_mfma_f32_16x16x32_bf16 a[60:63], a[180:183], a[112:115], a[60:63]
ds_read_b64_tr_b16 a[160:161], v11 offset:16384
ds_read_b64_tr_b16 a[162:163], v11 offset:16896
v_mfma_f32_16x16x32_bf16 a[192:195], a[184:187], a[112:115], a[192:195]
ds_read_b128 a[100:103], v10 offset:2048
v_cvt_pk_bf16_f32 v17, v18, v19
v_mfma_f32_16x16x32_bf16 a[196:199], a[184:187], a[116:119], a[196:199]
ds_read_b64_tr_b16 a[164:165], v12 offset:16384
ds_read_b64_tr_b16 a[166:167], v12 offset:16896
v_mfma_f32_16x16x32_bf16 a[200:203], a[184:187], a[120:123], a[200:203]
buffer_load_dwordx4 v8, s[20:23], s64 offen offset:1024 lds
v_mfma_f32_16x16x32_bf16 a[204:207], a[184:187], a[124:127], a[204:207]
ds_read_b128 a[104:107], v10 offset:4096
v_cvt_pk_bf16_f32 v18, v20, v21
v_mfma_f32_16x16x32_bf16 a[208:211], a[188:191], a[124:127], a[208:211]
ds_read_b64_tr_b16 a[168:169], v13 offset:16384
ds_read_b64_tr_b16 a[170:171], v13 offset:16896
v_mfma_f32_16x16x32_bf16 a[212:215], a[188:191], a[120:123], a[212:215]
ds_read_b128 a[108:111], v10 offset:6144
v_cvt_pk_bf16_f32 v19, v22, v23
v_mfma_f32_16x16x32_bf16 a[216:219], a[188:191], a[116:119], a[216:219]
s_add_u32 m0, s80, 0
s_add_u32 s64, s79, 0
v_accvgpr_write_b32 a24, v16
v_mfma_f32_16x16x32_bf16 a[220:223], a[188:191], a[112:115], a[220:223]
ds_read_b64_tr_b16 a[172:173], v14 offset:16384
ds_read_b64_tr_b16 a[174:175], v14 offset:16896
v_mfma_f32_16x16x32_bf16 a[224:227], a[64:67], a[112:115], a[224:227]
buffer_load_dwordx4 v4, s[24:27], s64 offen sc1 lds
v_mfma_f32_16x16x32_bf16 a[228:231], a[64:67], a[116:119], a[228:231]
ds_read_b128 a[88:91], v4 offset:24576
v_accvgpr_write_b32 a25, v17
v_mfma_f32_16x16x32_bf16 a[232:235], a[64:67], a[120:123], a[232:235]
ds_read_b64_tr_b16 a[80:81], v11 offset:20480
ds_read_b64_tr_b16 a[82:83], v11 offset:20992
v_mfma_f32_16x16x32_bf16 a[236:239], a[64:67], a[124:127], a[236:239]
v_accvgpr_write_b32 a26, v18
v_accvgpr_write_b32 a27, v19
v_mfma_f32_16x16x32_bf16 a[240:243], a[128:131], a[124:127], a[240:243]
s_add_u32 m0, s73, 4096
s_add_u32 s64, s72, 0
ds_read_b128 a[152:155], v4 offset:25600
v_mfma_f32_16x16x32_bf16 a[244:247], a[128:131], a[120:123], a[244:247]
v_accvgpr_write_b32 a4, v248
v_accvgpr_write_b32 a5, v249
v_mfma_f32_16x16x32_bf16 a[248:251], a[128:131], a[116:119], a[248:251]
buffer_load_dwordx4 v5, s[12:15], s64 offen lds
v_mfma_f32_16x16x32_bf16 v[36:39], a[128:131], a[112:115], v[36:39]
s_add_u32 s53, s87, 4096
ds_read_b64_tr_b16 a[144:145], v12 offset:20480
ds_read_b64_tr_b16 a[146:147], v12 offset:20992
v_mfma_f32_16x16x32_bf16 v[44:47], a[68:71], a[112:115], v[44:47]
ds_read_b128 a[92:95], v4 offset:26624
v_accvgpr_write_b32 a6, v250
v_mfma_f32_16x16x32_bf16 v[32:35], a[68:71], a[116:119], v[32:35]
buffer_store_dwordx4 v[184:187], v4, s[24:27], s53 offen offset:1024 sc1
v_mfma_f32_16x16x32_bf16 v[52:55], a[68:71], a[120:123], v[52:55]
ds_read_b64_tr_b16 a[84:85], v13 offset:20480
ds_read_b64_tr_b16 a[86:87], v13 offset:20992
v_mfma_f32_16x16x32_bf16 v[60:63], a[68:71], a[124:127], v[60:63]
v_accvgpr_write_b32 a7, v251
v_accvgpr_write_b32 a12, v240
v_mfma_f32_16x16x32_bf16 v[68:71], a[132:135], a[124:127], v[68:71]
buffer_load_dwordx4 v6, s[12:15], s64 offen offset:1024 lds
v_mfma_f32_16x16x32_bf16 v[76:79], a[132:135], a[120:123], v[76:79]
ds_read_b128 a[156:159], v4 offset:27648
v_accvgpr_write_b32 a13, v241
v_mfma_f32_16x16x32_bf16 v[84:87], a[132:135], a[116:119], v[84:87]
ds_read_b64_tr_b16 a[148:149], v14 offset:20480
ds_read_b64_tr_b16 a[150:151], v14 offset:20992
v_mfma_f32_16x16x32_bf16 v[92:95], a[132:135], a[112:115], v[92:95]
v_accvgpr_write_b32 a14, v242
v_accvgpr_write_b32 a15, v243
v_mfma_f32_16x16x32_bf16 v[100:103], a[72:75], a[112:115], v[100:103]
s_add_u32 m0, s73, 6144
s_add_u32 s64, s72, 18432
v_accvgpr_write_b32 a20, v232
v_mfma_f32_16x16x32_bf16 v[108:111], a[72:75], a[116:119], v[108:111]
v_accvgpr_write_b32 a21, v233
v_accvgpr_write_b32 a22, v234
v_mfma_f32_16x16x32_bf16 v[116:119], a[72:75], a[120:123], v[116:119]
buffer_load_dwordx4 v5, s[12:15], s64 offen lds
v_mfma_f32_16x16x32_bf16 v[40:43], a[72:75], a[124:127], v[40:43]
v_accvgpr_write_b32 a23, v235
v_accvgpr_write_b32 a28, v224
v_mfma_f32_16x16x32_bf16 v[124:127], a[136:139], a[124:127], v[124:127]
v_accvgpr_write_b32 a29, v225
v_accvgpr_write_b32 a30, v226
v_mfma_f32_16x16x32_bf16 v[132:135], a[136:139], a[120:123], v[132:135]
v_accvgpr_write_b32 a31, v227
v_and_b32 v28, 31, v1
v_mfma_f32_16x16x32_bf16 v[140:143], a[136:139], a[116:119], v[140:143]
v_lshlrev_b32 v28, 2, v28
v_mfma_f32_16x16x32_bf16 v[148:151], a[136:139], a[112:115], v[148:151]
buffer_load_dword v30, v28, s[40:43], 0 offen sc1
v_mfma_f32_16x16x32_bf16 v[156:159], a[76:79], a[112:115], v[156:159]
buffer_load_dwordx4 v6, s[12:15], s64 offen offset:1024 lds
v_mfma_f32_16x16x32_bf16 v[48:51], a[76:79], a[116:119], v[48:51]
v_add_u32 v9, 32768, v9
v_add_u32 v10, 32768, v10
v_mfma_f32_16x16x32_bf16 v[164:167], a[76:79], a[120:123], v[164:167]
v_mfma_f32_16x16x32_bf16 v[172:175], a[76:79], a[124:127], v[172:175]
v_mfma_f32_16x16x32_bf16 v[180:183], a[140:143], a[124:127], v[180:183]
v_mfma_f32_16x16x32_bf16 v[188:191], a[140:143], a[120:123], v[188:191]
v_mfma_f32_16x16x32_bf16 v[196:199], a[140:143], a[116:119], v[196:199]
v_mfma_f32_16x16x32_bf16 v[56:59], a[140:143], a[112:115], v[56:59]
s_waitcnt lgkmcnt(0)
v_mfma_f32_16x16x32_bf16 a[32:35], a[160:163], a[96:99], a[32:35]
s_waitcnt vmcnt(18)
v_mfma_f32_16x16x32_bf16 a[36:39], a[160:163], a[100:103], a[36:39]
s_barrier
v_mfma_f32_16x16x32_bf16 a[40:43], a[160:163], a[104:107], a[40:43]
s_add_u32 s53, s87, 786432
ds_read_b128 a[112:115], v9 offset:0
v_mfma_f32_16x16x32_bf16 a[44:47], a[160:163], a[108:111], a[44:47]
s_add_u32 m0, s77, 16384
s_add_u32 s64, s76, 262144
v_mfma_f32_16x16x32_bf16 a[48:51], a[164:167], a[108:111], a[48:51]
buffer_load_dwordx4 v7, s[20:23], s64 offen lds
v_mfma_f32_16x16x32_bf16 a[52:55], a[164:167], a[104:107], a[52:55]
ds_read_b64_tr_b16 a[176:177], v11 offset:32768
ds_read_b64_tr_b16 a[178:179], v11 offset:33280
v_mfma_f32_16x16x32_bf16 a[56:59], a[164:167], a[100:103], a[56:59]
ds_read_b128 a[116:119], v9 offset:2048
v_mfma_f32_16x16x32_bf16 a[60:63], a[164:167], a[96:99], a[60:63]
ds_read_b64_tr_b16 a[180:181], v12 offset:32768
ds_read_b64_tr_b16 a[182:183], v12 offset:33280
v_mfma_f32_16x16x32_bf16 a[192:195], a[168:171], a[96:99], a[192:195]
ds_read_b128 a[120:123], v9 offset:4096
v_accvgpr_read_b32 v64, a32
v_mfma_f32_16x16x32_bf16 a[196:199], a[168:171], a[100:103], a[196:199]
buffer_store_dwordx4 v[192:195], v4, s[24:27], s53 offen offset:0 sc1
v_mfma_f32_16x16x32_bf16 a[200:203], a[168:171], a[104:107], a[200:203]
buffer_load_dwordx4 v8, s[20:23], s64 offen offset:1024 lds
v_mfma_f32_16x16x32_bf16 a[204:207], a[168:171], a[108:111], a[204:207]
ds_read_b64_tr_b16 a[184:185], v13 offset:32768
ds_read_b64_tr_b16 a[186:187], v13 offset:33280
v_mfma_f32_16x16x32_bf16 a[208:211], a[172:175], a[108:111], a[208:211]
ds_read_b128 a[124:127], v9 offset:6144
v_accvgpr_read_b32 v65, a33
v_mfma_f32_16x16x32_bf16 a[212:215], a[172:175], a[104:107], a[212:215]
v_accvgpr_read_b32 v66, a34
v_accvgpr_read_b32 v67, a35
v_mfma_f32_16x16x32_bf16 a[216:219], a[172:175], a[100:103], a[216:219]
s_add_u32 m0, s80, 16384
s_add_u32 s64, s79, 4096
v_accvgpr_write_b32 a32, v152
v_mfma_f32_16x16x32_bf16 a[220:223], a[172:175], a[96:99], a[220:223]
ds_read_b64_tr_b16 a[188:189], v14 offset:32768
ds_read_b64_tr_b16 a[190:191], v14 offset:33280
v_mfma_f32_16x16x32_bf16 a[224:227], a[80:83], a[96:99], a[224:227]
buffer_load_dwordx4 v4, s[24:27], s64 offen sc1 lds
v_mfma_f32_16x16x32_bf16 a[228:231], a[80:83], a[100:103], a[228:231]
s_xor_b32 s65, s70, 640
s_add_u32 s71, s68, s65
s_add_u32 s72, s69, s65
v_mfma_f32_16x16x32_bf16 a[232:235], a[80:83], a[104:107], a[232:235]
ds_read_b128 a[72:75], v4 offset:40960
v_accvgpr_write_b32 a33, v153
v_mfma_f32_16x16x32_bf16 a[236:239], a[80:83], a[108:111], a[236:239]
ds_read_b64_tr_b16 a[64:65], v11 offset:36864
ds_read_b64_tr_b16 a[66:67], v11 offset:37376
v_mfma_f32_16x16x32_bf16 a[240:243], a[144:147], a[108:111], a[240:243]
s_add_u32 m0, s73, 32768
s_add_u32 s64, s71, 0
ds_read_b128 a[136:139], v4 offset:41984
v_mfma_f32_16x16x32_bf16 a[244:247], a[144:147], a[104:107], a[244:247]
v_accvgpr_write_b32 a34, v154
v_accvgpr_write_b32 a35, v155
v_mfma_f32_16x16x32_bf16 a[248:251], a[144:147], a[100:103], a[248:251]
buffer_load_dwordx4 v5, s[12:15], s64 offen lds
v_mfma_f32_16x16x32_bf16 v[36:39], a[144:147], a[96:99], v[36:39]
ds_read_b64_tr_b16 a[128:129], v12 offset:36864
ds_read_b64_tr_b16 a[130:131], v12 offset:37376
v_mfma_f32_16x16x32_bf16 v[44:47], a[84:87], a[96:99], v[44:47]
ds_read_b128 a[76:79], v4 offset:43008
v_accvgpr_read_b32 v204, a36
v_mfma_f32_16x16x32_bf16 v[32:35], a[84:87], a[100:103], v[32:35]
v_accvgpr_read_b32 v205, a37
v_accvgpr_read_b32 v206, a38
v_mfma_f32_16x16x32_bf16 v[52:55], a[84:87], a[104:107], v[52:55]
ds_read_b64_tr_b16 a[68:69], v13 offset:36864
ds_read_b64_tr_b16 a[70:71], v13 offset:37376
v_mfma_f32_16x16x32_bf16 v[60:63], a[84:87], a[108:111], v[60:63]
v_accvgpr_read_b32 v207, a39
v_accvgpr_read_b32 v212, a40
v_mfma_f32_16x16x32_bf16 v[68:71], a[148:151], a[108:111], v[68:71]
buffer_load_dwordx4 v6, s[12:15], s64 offen offset:1024 lds
v_mfma_f32_16x16x32_bf16 v[76:79], a[148:151], a[104:107], v[76:79]
s_add_u32 s53, s87, 786432
ds_read_b128 a[140:143], v4 offset:44032
v_accvgpr_read_b32 v213, a41
v_mfma_f32_16x16x32_bf16 v[84:87], a[148:151], a[100:103], v[84:87]
s_waitcnt vmcnt(7)
ds_read_b64_tr_b16 a[132:133], v14 offset:36864
ds_read_b64_tr_b16 a[134:135], v14 offset:37376
v_mfma_f32_16x16x32_bf16 v[92:95], a[148:151], a[96:99], v[92:95]
buffer_store_dwordx4 v[200:203], v4, s[24:27], s53 offen offset:1024 sc1
v_mfma_f32_16x16x32_bf16 v[100:103], a[88:91], a[96:99], v[100:103]
s_add_u32 m0, s73, 34816
s_add_u32 s64, s71, 18432
v_accvgpr_read_b32 v214, a42
v_mfma_f32_16x16x32_bf16 v[108:111], a[88:91], a[100:103], v[108:111]
v_accvgpr_read_b32 v215, a43
v_accvgpr_read_b32 v220, a44
v_mfma_f32_16x16x32_bf16 v[116:119], a[88:91], a[104:107], v[116:119]
buffer_load_dwordx4 v5, s[12:15], s64 offen lds
v_mfma_f32_16x16x32_bf16 v[40:43], a[88:91], a[108:111], v[40:43]
v_accvgpr_read_b32 v221, a45
v_accvgpr_read_b32 v222, a46
v_mfma_f32_16x16x32_bf16 v[124:127], a[152:155], a[108:111], v[124:127]
v_accvgpr_read_b32 v223, a47
v_cmp_gt_u32 vcc, 1, v30
v_mfma_f32_16x16x32_bf16 v[132:135], a[152:155], a[104:107], v[132:135]
v_mfma_f32_16x16x32_bf16 v[140:143], a[152:155], a[100:103], v[140:143]
v_mfma_f32_16x16x32_bf16 v[148:151], a[152:155], a[96:99], v[148:151]
v_mfma_f32_16x16x32_bf16 v[156:159], a[92:95], a[96:99], v[156:159]
buffer_load_dwordx4 v6, s[12:15], s64 offen offset:1024 lds
v_mfma_f32_16x16x32_bf16 v[48:51], a[92:95], a[100:103], v[48:51]
s_cbranch_vccnz CK_ZA
CK_ZA_R:
v_mfma_f32_16x16x32_bf16 v[164:167], a[92:95], a[104:107], v[164:167]
v_mfma_f32_16x16x32_bf16 v[172:175], a[92:95], a[108:111], v[172:175]
v_mfma_f32_16x16x32_bf16 v[180:183], a[156:159], a[108:111], v[180:183]
v_mfma_f32_16x16x32_bf16 v[188:191], a[156:159], a[104:107], v[188:191]
v_mfma_f32_16x16x32_bf16 v[196:199], a[156:159], a[100:103], v[196:199]
v_mfma_f32_16x16x32_bf16 v[56:59], a[156:159], a[96:99], v[56:59]
s_waitcnt lgkmcnt(0)
v_mfma_f32_16x16x32_bf16 v[64:67], a[176:179], a[112:115], v[64:67]
s_waitcnt vmcnt(24)
v_mfma_f32_16x16x32_bf16 v[204:207], a[176:179], a[116:119], v[204:207]
s_barrier
v_mfma_f32_16x16x32_bf16 v[212:215], a[176:179], a[120:123], v[212:215]
ds_read_b128 a[96:99], v10 offset:0
v_mfma_f32_16x16x32_bf16 v[220:223], a[176:179], a[124:127], v[220:223]
s_xor_b32 s75, s93, 5
s_lshl_b32 s76, s75, 19
s_add_u32 s76, s76, s74
v_mfma_f32_16x16x32_bf16 a[48:51], a[180:183], a[124:127], a[48:51]
s_mul_i32 s79, s75, 24576
s_add_u32 s79, s79, s78
v_mfma_f32_16x16x32_bf16 a[52:55], a[180:183], a[120:123], a[52:55]
s_add_u32 m0, s77, 32768
s_add_u32 s64, s76, 0
v_mfma_f32_16x16x32_bf16 a[56:59], a[180:183], a[116:119], a[56:59]
buffer_load_dwordx4 v7, s[20:23], s64 offen lds
v_mfma_f32_16x16x32_bf16 a[60:63], a[180:183], a[112:115], a[60:63]
ds_read_b64_tr_b16 a[160:161], v11 offset:49152
ds_read_b64_tr_b16 a[162:163], v11 offset:49664
v_mfma_f32_16x16x32_bf16 a[192:195], a[184:187], a[112:115], a[192:195]
s_add_u32 s53, s87, 790528
ds_read_b128 a[100:103], v10 offset:2048
v_mfma_f32_16x16x32_bf16 a[196:199], a[184:187], a[116:119], a[196:199]
ds_read_b64_tr_b16 a[164:165], v12 offset:49152
ds_read_b64_tr_b16 a[166:167], v12 offset:49664
v_mfma_f32_16x16x32_bf16 a[200:203], a[184:187], a[120:123], a[200:203]
buffer_load_dwordx4 v8, s[20:23], s64 offen offset:1024 lds
v_mfma_f32_16x16x32_bf16 a[204:207], a[184:187], a[124:127], a[204:207]
ds_read_b128 a[104:107], v10 offset:4096
v_mfma_f32_16x16x32_bf16 a[208:211], a[188:191], a[124:127], a[208:211]
ds_read_b64_tr_b16 a[168:169], v13 offset:49152
ds_read_b64_tr_b16 a[170:171], v13 offset:49664
v_mfma_f32_16x16x32_bf16 a[212:215], a[188:191], a[120:123], a[212:215]
ds_read_b128 a[108:111], v10 offset:6144
v_accvgpr_read_b32 v72, a48
v_mfma_f32_16x16x32_bf16 a[216:219], a[188:191], a[116:119], a[216:219]
s_add_u32 m0, s80, 32768
s_add_u32 s64, s79, 0
v_accvgpr_read_b32 v73, a49
v_mfma_f32_16x16x32_bf16 a[220:223], a[188:191], a[112:115], a[220:223]
ds_read_b64_tr_b16 a[172:173], v14 offset:49152
ds_read_b64_tr_b16 a[174:175], v14 offset:49664
v_mfma_f32_16x16x32_bf16 a[224:227], a[64:67], a[112:115], a[224:227]
buffer_load_dwordx4 v4, s[24:27], s64 offen sc1 lds
v_mfma_f32_16x16x32_bf16 a[228:231], a[64:67], a[116:119], a[228:231]
ds_read_b128 a[88:91], v4 offset:57344
v_accvgpr_read_b32 v74, a50
v_mfma_f32_16x16x32_bf16 a[232:235], a[64:67], a[120:123], a[232:235]
ds_read_b64_tr_b16 a[80:81], v11 offset:53248
ds_read_b64_tr_b16 a[82:83], v11 offset:53760
v_mfma_f32_16x16x32_bf16 a[236:239], a[64:67], a[124:127], a[236:239]
buffer_store_dwordx4 v[208:211], v4, s[24:27], s53 offen offset:0 sc1
v_mfma_f32_16x16x32_bf16 a[240:243], a[128:131], a[124:127], a[240:243]
s_add_u32 m0, s73, 36864
s_add_u32 s64, s72, 0
ds_read_b128 a[152:155], v4 offset:58368
v_mfma_f32_16x16x32_bf16 a[244:247], a[128:131], a[120:123], a[244:247]
v_accvgpr_read_b32 v75, a51
v_accvgpr_read_b32 v228, a52
v_mfma_f32_16x16x32_bf16 a[248:251], a[128:131], a[116:119], a[248:251]
buffer_load_dwordx4 v5, s[12:15], s64 offen lds
v_mfma_f32_16x16x32_bf16 v[36:39], a[128:131], a[112:115], v[36:39]
ds_read_b64_tr_b16 a[144:145], v12 offset:53248
ds_read_b64_tr_b16 a[146:147], v12 offset:53760
v_mfma_f32_16x16x32_bf16 v[44:47], a[68:71], a[112:115], v[44:47]
ds_read_b128 a[92:95], v4 offset:59392
v_accvgpr_read_b32 v229, a53
v_mfma_f32_16x16x32_bf16 v[32:35], a[68:71], a[116:119], v[32:35]
v_accvgpr_read_b32 v230, a54
v_accvgpr_read_b32 v231, a55
v_mfma_f32_16x16x32_bf16 v[52:55], a[68:71], a[120:123], v[52:55]
ds_read_b64_tr_b16 a[84:85], v13 offset:53248
ds_read_b64_tr_b16 a[86:87], v13 offset:53760
v_mfma_f32_16x16x32_bf16 v[60:63], a[68:71], a[124:127], v[60:63]
v_accvgpr_read_b32 v80, a56
v_accvgpr_read_b32 v81, a57
v_mfma_f32_16x16x32_bf16 v[68:71], a[132:135], a[124:127], v[68:71]
buffer_load_dwordx4 v6, s[12:15], s64 offen offset:1024 lds
v_mfma_f32_16x16x32_bf16 v[76:79], a[132:135], a[120:123], v[76:79]
ds_read_b128 a[156:159], v4 offset:60416
v_accvgpr_read_b32 v82, a58
v_mfma_f32_16x16x32_bf16 v[84:87], a[132:135], a[116:119], v[84:87]
ds_read_b64_tr_b16 a[148:149], v14 offset:53248
ds_read_b64_tr_b16 a[150:151], v14 offset:53760
v_mfma_f32_16x16x32_bf16 v[92:95], a[132:135], a[112:115], v[92:95]
v_accvgpr_read_b32 v83, a59
v_accvgpr_read_b32 v236, a60
v_mfma_f32_16x16x32_bf16 v[100:103], a[72:75], a[112:115], v[100:103]
s_add_u32 m0, s73, 38912
s_add_u32 s64, s72, 18432
v_accvgpr_read_b32 v237, a61
v_mfma_f32_16x16x32_bf16 v[108:111], a[72:75], a[116:119], v[108:111]
v_accvgpr_read_b32 v238, a62
v_accvgpr_read_b32 v239, a63
v_mfma_f32_16x16x32_bf16 v[116:119], a[72:75], a[120:123], v[116:119]
buffer_load_dwordx4 v5, s[12:15], s64 offen lds
v_mfma_f32_16x16x32_bf16 v[40:43], a[72:75], a[124:127], v[40:43]
s_add_u32 s53, s87, 790528
v_accvgpr_read_b32 v244, a192
v_accvgpr_read_b32 v245, a193
v_mfma_f32_16x16x32_bf16 v[124:127], a[136:139], a[124:127], v[124:127]
buffer_store_dwordx4 v[216:219], v4, s[24:27], s53 offen offset:1024 sc1
v_mfma_f32_16x16x32_bf16 v[132:135], a[136:139], a[120:123], v[132:135]
v_accvgpr_read_b32 v246, a194
v_accvgpr_read_b32 v247, a195
v_mfma_f32_16x16x32_bf16 v[140:143], a[136:139], a[116:119], v[140:143]
v_accvgpr_read_b32 v252, a196
v_accvgpr_read_b32 v253, a197
v_mfma_f32_16x16x32_bf16 v[148:151], a[136:139], a[112:115], v[148:151]
v_accvgpr_read_b32 v254, a198
v_accvgpr_read_b32 v255, a199
v_mfma_f32_16x16x32_bf16 v[156:159], a[76:79], a[112:115], v[156:159]
buffer_load_dwordx4 v6, s[12:15], s64 offen offset:1024 lds
v_mfma_f32_16x16x32_bf16 v[48:51], a[76:79], a[116:119], v[48:51]
v_add_u32 v9, -65536, v9
v_add_u32 v10, -65536, v10
v_mfma_f32_16x16x32_bf16 v[164:167], a[76:79], a[120:123], v[164:167]
v_accvgpr_read_b32 v88, a200
v_accvgpr_read_b32 v89, a201
v_mfma_f32_16x16x32_bf16 v[172:175], a[76:79], a[124:127], v[172:175]
v_accvgpr_read_b32 v90, a202
v_accvgpr_read_b32 v91, a203
v_mfma_f32_16x16x32_bf16 v[180:183], a[140:143], a[124:127], v[180:183]
v_mfma_f32_16x16x32_bf16 v[188:191], a[140:143], a[120:123], v[188:191]
v_mfma_f32_16x16x32_bf16 v[196:199], a[140:143], a[116:119], v[196:199]
v_mfma_f32_16x16x32_bf16 v[56:59], a[140:143], a[112:115], v[56:59]
s_waitcnt lgkmcnt(0)
v_mfma_f32_16x16x32_bf16 v[64:67], a[160:163], a[96:99], v[64:67]
s_waitcnt vmcnt(18)
v_mfma_f32_16x16x32_bf16 v[204:207], a[160:163], a[100:103], v[204:207]
s_barrier
v_mfma_f32_16x16x32_bf16 v[212:215], a[160:163], a[104:107], v[212:215]
ds_read_b128 a[112:115], v9 offset:0
v_mfma_f32_16x16x32_bf16 v[220:223], a[160:163], a[108:111], v[220:223]
s_add_u32 m0, s77, 49152
s_add_u32 s64, s76, 262144
v_mfma_f32_16x16x32_bf16 v[72:75], a[164:167], a[108:111], v[72:75]
buffer_load_dwordx4 v7, s[20:23], s64 offen lds
v_mfma_f32_16x16x32_bf16 v[228:231], a[164:167], a[104:107], v[228:231]
ds_read_b64_tr_b16 a[176:177], v11 offset:0
ds_read_b64_tr_b16 a[178:179], v11 offset:512
v_mfma_f32_16x16x32_bf16 v[80:83], a[164:167], a[100:103], v[80:83]
ds_read_b128 a[116:119], v9 offset:2048
v_mfma_f32_16x16x32_bf16 v[236:239], a[164:167], a[96:99], v[236:239]
ds_read_b64_tr_b16 a[180:181], v12 offset:0
ds_read_b64_tr_b16 a[182:183], v12 offset:512
v_mfma_f32_16x16x32_bf16 v[244:247], a[168:171], a[96:99], v[244:247]
ds_read_b128 a[120:123], v9 offset:4096
v_mfma_f32_16x16x32_bf16 v[252:255], a[168:171], a[100:103], v[252:255]
v_mfma_f32_16x16x32_bf16 v[88:91], a[168:171], a[104:107], v[88:91]
buffer_load_dwordx4 v8, s[20:23], s64 offen offset:1024 lds
v_mfma_f32_16x16x32_bf16 a[204:207], a[168:171], a[108:111], a[204:207]
ds_read_b64_tr_b16 a[184:185], v13 offset:0
ds_read_b64_tr_b16 a[186:187], v13 offset:512
v_mfma_f32_16x16x32_bf16 a[208:211], a[172:175], a[108:111], a[208:211]
ds_read_b128 a[124:127], v9 offset:6144
v_mfma_f32_16x16x32_bf16 a[212:215], a[172:175], a[104:107], a[212:215]
v_mfma_f32_16x16x32_bf16 a[216:219], a[172:175], a[100:103], a[216:219]
s_add_u32 m0, s80, 49152
s_add_u32 s64, s79, 4096
s_add_u32 s53, s88, 1572864
v_mfma_f32_16x16x32_bf16 a[220:223], a[172:175], a[96:99], a[220:223]
ds_read_b64_tr_b16 a[188:189], v14 offset:0
ds_read_b64_tr_b16 a[190:191], v14 offset:512
v_mfma_f32_16x16x32_bf16 a[224:227], a[80:83], a[96:99], a[224:227]
buffer_load_dwordx4 v4, s[24:27], s64 offen sc1 lds
v_mfma_f32_16x16x32_bf16 a[228:231], a[80:83], a[100:103], a[228:231]
s_xor_b32 s65, s70, 768
s_add_u32 s71, s68, s65
s_add_u32 s72, s69, s65
v_mfma_f32_16x16x32_bf16 a[232:235], a[80:83], a[104:107], a[232:235]
ds_read_b128 a[72:75], v4 offset:8192
v_mfma_f32_16x16x32_bf16 a[236:239], a[80:83], a[108:111], a[236:239]
ds_read_b64_tr_b16 a[64:65], v11 offset:4096
ds_read_b64_tr_b16 a[66:67], v11 offset:4608
v_mfma_f32_16x16x32_bf16 a[240:243], a[144:147], a[108:111], a[240:243]
s_add_u32 m0, s73, 65536
s_add_u32 s64, s71, 0
ds_read_b128 a[136:139], v4 offset:9216
v_mfma_f32_16x16x32_bf16 a[244:247], a[144:147], a[104:107], a[244:247]
buffer_store_dwordx4 v[96:99], v4, s[24:27], s53 offen offset:0 sc1
v_mfma_f32_16x16x32_bf16 a[248:251], a[144:147], a[100:103], a[248:251]
buffer_load_dwordx4 v5, s[12:15], s64 offen lds
v_mfma_f32_16x16x32_bf16 v[36:39], a[144:147], a[96:99], v[36:39]
ds_read_b64_tr_b16 a[128:129], v12 offset:4096
ds_read_b64_tr_b16 a[130:131], v12 offset:4608
v_mfma_f32_16x16x32_bf16 v[44:47], a[84:87], a[96:99], v[44:47]
ds_read_b128 a[76:79], v4 offset:10240
v_accvgpr_read_b32 v160, a204
v_mfma_f32_16x16x32_bf16 v[32:35], a[84:87], a[100:103], v[32:35]
v_accvgpr_read_b32 v161, a205
v_accvgpr_read_b32 v162, a206
v_mfma_f32_16x16x32_bf16 v[52:55], a[84:87], a[104:107], v[52:55]
ds_read_b64_tr_b16 a[68:69], v13 offset:4096
ds_read_b64_tr_b16 a[70:71], v13 offset:4608
v_mfma_f32_16x16x32_bf16 v[60:63], a[84:87], a[108:111], v[60:63]
v_accvgpr_read_b32 v163, a207
v_accvgpr_read_b32 v168, a208
v_mfma_f32_16x16x32_bf16 v[68:71], a[148:151], a[108:111], v[68:71]
buffer_load_dwordx4 v6, s[12:15], s64 offen offset:1024 lds
v_mfma_f32_16x16x32_bf16 v[76:79], a[148:151], a[104:107], v[76:79]
ds_read_b128 a[140:143], v4 offset:11264
v_accvgpr_read_b32 v169, a209
v_mfma_f32_16x16x32_bf16 v[84:87], a[148:151], a[100:103], v[84:87]
ds_read_b64_tr_b16 a[132:133], v14 offset:4096
ds_read_b64_tr_b16 a[134:135], v14 offset:4608
v_mfma_f32_16x16x32_bf16 v[92:95], a[148:151], a[96:99], v[92:95]
v_accvgpr_read_b32 v170, a210
v_accvgpr_read_b32 v171, a211
v_mfma_f32_16x16x32_bf16 v[100:103], a[88:91], a[96:99], v[100:103]
s_add_u32 m0, s73, 67584
s_add_u32 s64, s71, 18432
v_accvgpr_read_b32 v176, a212
v_mfma_f32_16x16x32_bf16 v[108:111], a[88:91], a[100:103], v[108:111]
v_accvgpr_read_b32 v177, a213
v_accvgpr_read_b32 v178, a214
v_mfma_f32_16x16x32_bf16 v[116:119], a[88:91], a[104:107], v[116:119]
buffer_load_dwordx4 v5, s[12:15], s64 offen lds
v_mfma_f32_16x16x32_bf16 v[40:43], a[88:91], a[108:111], v[40:43]
v_accvgpr_read_b32 v179, a215
v_accvgpr_read_b32 v184, a216
v_mfma_f32_16x16x32_bf16 v[124:127], a[152:155], a[108:111], v[124:127]
v_accvgpr_read_b32 v185, a217
v_accvgpr_read_b32 v186, a218
v_mfma_f32_16x16x32_bf16 v[132:135], a[152:155], a[104:107], v[132:135]
v_accvgpr_read_b32 v187, a219
v_accvgpr_read_b32 v248, a220
v_mfma_f32_16x16x32_bf16 v[140:143], a[152:155], a[100:103], v[140:143]
v_accvgpr_read_b32 v249, a221
v_accvgpr_read_b32 v250, a222
v_mfma_f32_16x16x32_bf16 v[148:151], a[152:155], a[96:99], v[148:151]
v_accvgpr_read_b32 v251, a223
v_accvgpr_read_b32 v240, a224
v_mfma_f32_16x16x32_bf16 v[156:159], a[92:95], a[96:99], v[156:159]
buffer_load_dwordx4 v6, s[12:15], s64 offen offset:1024 lds
v_mfma_f32_16x16x32_bf16 v[48:51], a[92:95], a[100:103], v[48:51]
s_add_u32 s53, s88, 1572864
v_accvgpr_read_b32 v241, a225
v_accvgpr_read_b32 v242, a226
v_mfma_f32_16x16x32_bf16 v[164:167], a[92:95], a[104:107], v[164:167]
buffer_store_dwordx4 v[104:107], v4, s[24:27], s53 offen offset:1024 sc1
v_mfma_f32_16x16x32_bf16 v[172:175], a[92:95], a[108:111], v[172:175]
v_accvgpr_read_b32 v243, a227
v_accvgpr_read_b32 v232, a228
v_mfma_f32_16x16x32_bf16 v[180:183], a[156:159], a[108:111], v[180:183]
v_accvgpr_read_b32 v233, a229
v_accvgpr_read_b32 v234, a230
v_mfma_f32_16x16x32_bf16 v[188:191], a[156:159], a[104:107], v[188:191]
v_accvgpr_read_b32 v235, a231
v_accvgpr_read_b32 v224, a232
v_mfma_f32_16x16x32_bf16 v[196:199], a[156:159], a[100:103], v[196:199]
v_accvgpr_read_b32 v225, a233
v_accvgpr_read_b32 v226, a234
v_mfma_f32_16x16x32_bf16 v[56:59], a[156:159], a[96:99], v[56:59]
s_waitcnt lgkmcnt(0)
v_accvgpr_read_b32 v227, a235
v_accvgpr_read_b32 v192, a236
v_mfma_f32_16x16x32_bf16 v[64:67], a[176:179], a[112:115], v[64:67]
s_waitcnt vmcnt(23)
v_accvgpr_read_b32 v193, a237
v_accvgpr_read_b32 v194, a238
v_mfma_f32_16x16x32_bf16 v[204:207], a[176:179], a[116:119], v[204:207]
s_barrier
v_mfma_f32_16x16x32_bf16 v[212:215], a[176:179], a[120:123], v[212:215]
ds_read_b128 a[96:99], v10 offset:0
v_accvgpr_read_b32 v195, a239
v_mfma_f32_16x16x32_bf16 v[220:223], a[176:179], a[124:127], v[220:223]
s_xor_b32 s75, s93, 6
s_lshl_b32 s76, s75, 19
s_add_u32 s76, s76, s74
v_mfma_f32_16x16x32_bf16 v[72:75], a[180:183], a[124:127], v[72:75]
s_mul_i32 s79, s75, 24576
s_add_u32 s79, s79, s78
v_accvgpr_read_b32 v152, a240
v_mfma_f32_16x16x32_bf16 v[228:231], a[180:183], a[120:123], v[228:231]
s_add_u32 m0, s77, 0
s_add_u32 s64, s76, 0
v_accvgpr_read_b32 v153, a241
v_mfma_f32_16x16x32_bf16 v[80:83], a[180:183], a[116:119], v[80:83]
buffer_load_dwordx4 v7, s[20:23], s64 offen lds
v_mfma_f32_16x16x32_bf16 v[236:239], a[180:183], a[112:115], v[236:239]
ds_read_b64_tr_b16 a[160:161], v11 offset:16384
ds_read_b64_tr_b16 a[162:163], v11 offset:16896
v_mfma_f32_16x16x32_bf16 v[244:247], a[184:187], a[112:115], v[244:247]
ds_read_b128 a[100:103], v10 offset:2048
v_accvgpr_read_b32 v154, a242
v_mfma_f32_16x16x32_bf16 v[252:255], a[184:187], a[116:119], v[252:255]
ds_read_b64_tr_b16 a[164:165], v12 offset:16384
ds_read_b64_tr_b16 a[166:167], v12 offset:16896
v_mfma_f32_16x16x32_bf16 v[88:91], a[184:187], a[120:123], v[88:91]
buffer_load_dwordx4 v8, s[20:23], s64 offen offset:1024 lds
v_mfma_f32_16x16x32_bf16 v[160:163], a[184:187], a[124:127], v[160:163]
ds_read_b128 a[104:107], v10 offset:4096
v_accvgpr_read_b32 v155, a243
v_mfma_f32_16x16x32_bf16 v[168:171], a[188:191], a[124:127], v[168:171]
ds_read_b64_tr_b16 a[168:169], v13 offset:16384
ds_read_b64_tr_b16 a[170:171], v13 offset:16896
v_mfma_f32_16x16x32_bf16 v[176:179], a[188:191], a[120:123], v[176:179]
ds_read_b128 a[108:111], v10 offset:6144
v_mfma_f32_16x16x32_bf16 v[184:187], a[188:191], a[116:119], v[184:187]
s_add_u32 m0, s80, 0
s_add_u32 s64, s79, 0
v_mfma_f32_16x16x32_bf16 v[248:251], a[188:191], a[112:115], v[248:251]
ds_read_b64_tr_b16 a[172:173], v14 offset:16384
ds_read_b64_tr_b16 a[174:175], v14 offset:16896
v_mfma_f32_16x16x32_bf16 v[240:243], a[64:67], a[112:115], v[240:243]
buffer_load_dwordx4 v4, s[24:27], s64 offen sc1 lds
v_mfma_f32_16x16x32_bf16 v[232:235], a[64:67], a[116:119], v[232:235]
ds_read_b128 a[88:91], v4 offset:24576
v_mfma_f32_16x16x32_bf16 v[224:227], a[64:67], a[120:123], v[224:227]
ds_read_b64_tr_b16 a[80:81], v11 offset:20480
ds_read_b64_tr_b16 a[82:83], v11 offset:20992
v_mfma_f32_16x16x32_bf16 v[192:195], a[64:67], a[124:127], v[192:195]
v_mfma_f32_16x16x32_bf16 v[152:155], a[128:131], a[124:127], v[152:155]
s_add_u32 m0, s73, 69632
s_add_u32 s64, s72, 0
ds_read_b128 a[152:155], v4 offset:25600
v_mfma_f32_16x16x32_bf16 a[244:247], a[128:131], a[120:123], a[244:247]
s_add_u32 s53, s88, 1572864
v_mfma_f32_16x16x32_bf16 a[248:251], a[128:131], a[116:119], a[248:251]
buffer_load_dwordx4 v5, s[12:15], s64 offen lds
v_mfma_f32_16x16x32_bf16 v[36:39], a[128:131], a[112:115], v[36:39]
ds_read_b64_tr_b16 a[144:145], v12 offset:20480
ds_read_b64_tr_b16 a[146:147], v12 offset:20992
v_mfma_f32_16x16x32_bf16 v[44:47], a[68:71], a[112:115], v[44:47]
ds_read_b128 a[92:95], v4 offset:26624
v_mfma_f32_16x16x32_bf16 v[32:35], a[68:71], a[116:119], v[32:35]
buffer_store_dwordx4 v[112:115], v4, s[24:27], s53 offen offset:2048 sc1
v_mfma_f32_16x16x32_bf16 v[52:55], a[68:71], a[120:123], v[52:55]
ds_read_b64_tr_b16 a[84:85], v13 offset:20480
ds_read_b64_tr_b16 a[86:87], v13 offset:20992
v_mfma_f32_16x16x32_bf16 v[60:63], a[68:71], a[124:127], v[60:63]
v_mfma_f32_16x16x32_bf16 v[68:71], a[132:135], a[124:127], v[68:71]
buffer_load_dwordx4 v6, s[12:15], s64 offen offset:1024 lds
v_mfma_f32_16x16x32_bf16 v[76:79], a[132:135], a[120:123], v[76:79]
ds_read_b128 a[156:159], v4 offset:27648
v_accvgpr_read_b32 v200, a244
v_mfma_f32_16x16x32_bf16 v[84:87], a[132:135], a[116:119], v[84:87]
ds_read_b64_tr_b16 a[148:149], v14 offset:20480
ds_read_b64_tr_b16 a[150:151], v14 offset:20992
v_mfma_f32_16x16x32_bf16 v[92:95], a[132:135], a[112:115], v[92:95]
v_accvgpr_read_b32 v201, a245
v_accvgpr_read_b32 v202, a246
v_mfma_f32_16x16x32_bf16 v[100:103], a[72:75], a[112:115], v[100:103]
s_add_u32 m0, s73, 71680
s_add_u32 s64, s72, 18432
v_accvgpr_read_b32 v203, a247
v_mfma_f32_16x16x32_bf16 v[108:111], a[72:75], a[116:119], v[108:111]
v_accvgpr_read_b32 v208, a248
v_accvgpr_read_b32 v209, a249
v_mfma_f32_16x16x32_bf16 v[116:119], a[72:75], a[120:123], v[116:119]
buffer_load_dwordx4 v5, s[12:15], s64 offen lds
v_mfma_f32_16x16x32_bf16 v[40:43], a[72:75], a[124:127], v[40:43]
v_accvgpr_read_b32 v210, a250
v_accvgpr_read_b32 v211, a251
v_mfma_f32_16x16x32_bf16 v[124:127], a[136:139], a[124:127], v[124:127]
s_lshr_b32 s84, s7, 1
s_and_b32 s85, s7, 1
s_xor_b32 s52, s5, 7
v_mfma_f32_16x16x32_bf16 v[132:135], a[136:139], a[120:123], v[132:135]
s_lshl1_add_u32 s85, s52, s85
s_and_b32 s86, s6, 3
s_lshl_b32 s83, s3, 13
v_mfma_f32_16x16x32_bf16 v[140:143], a[136:139], a[116:119], v[140:143]
s_add_u32 s83, s83, 131072
s_mul_i32 s52, s2, 5462
s_lshr_b32 s52, s52, 16
v_mfma_f32_16x16x32_bf16 v[148:151], a[136:139], a[112:115], v[148:151]
s_mul_i32 s54, s52, 12
s_sub_u32 s54, s2, s54
s_mul_i32 s54, s54, 3
v_mfma_f32_16x16x32_bf16 v[156:159], a[76:79], a[112:115], v[156:159]
buffer_load_dwordx4 v6, s[12:15], s64 offen offset:1024 lds
v_mfma_f32_16x16x32_bf16 v[48:51], a[76:79], a[116:119], v[48:51]
s_add_u32 s54, s54, s3
v_add_u32 v9, 32768, v9
v_add_u32 v10, 32768, v10
v_mfma_f32_16x16x32_bf16 v[164:167], a[76:79], a[120:123], v[164:167]
s_mul_i32 s55, s52, 13108
s_lshr_b32 s55, s55, 16
s_mul_i32 s82, s55, 5
v_mfma_f32_16x16x32_bf16 v[172:175], a[76:79], a[124:127], v[172:175]
s_sub_u32 s52, s52, s82
v_mfma_f32_16x16x32_bf16 v[180:183], a[140:143], a[124:127], v[180:183]
v_lshrrev_b32 v16, 1, v1
v_and_b32 v17, 1, v1
v_mfma_f32_16x16x32_bf16 v[188:191], a[140:143], a[120:123], v[188:191]
v_mul_u32_u24 v18, 1152, v16
v_lshl_add_u32 v18, v17, 4, v18
v_mfma_f32_16x16x32_bf16 v[196:199], a[140:143], a[116:119], v[196:199]
v_mov_b32 v24, v18
v_lshrrev_b32 v18, 4, v16
v_mfma_f32_16x16x32_bf16 v[56:59], a[140:143], a[112:115], v[56:59]
s_waitcnt lgkmcnt(0)
s_add_u32 s53, s88, 1572864
v_bfe_u32 v19, v16, 2, 2
v_mfma_f32_16x16x32_bf16 v[64:67], a[160:163], a[96:99], v[64:67]
s_waitcnt vmcnt(17)
v_and_b32 v16, 3, v16
v_lshrrev_b32 v20, 1, v19
v_mfma_f32_16x16x32_bf16 v[204:207], a[160:163], a[100:103], v[204:207]
s_barrier
v_mfma_f32_16x16x32_bf16 v[212:215], a[160:163], a[104:107], v[212:215]
ds_read_b128 a[112:115], v9 offset:0
v_mul_u32_u24 v20, 18, v20
v_mfma_f32_16x16x32_bf16 v[220:223], a[160:163], a[108:111], v[220:223]
s_add_u32 m0, s77, 16384
s_add_u32 s64, s76, 262144
v_and_b32 v21, 1, v19
v_mfma_f32_16x16x32_bf16 v[72:75], a[164:167], a[108:111], v[72:75]
buffer_load_dwordx4 v7, s[20:23], s64 offen lds
v_mfma_f32_16x16x32_bf16 v[228:231], a[164:167], a[104:107], v[228:231]
ds_read_b64_tr_b16 a[176:177], v11 offset:32768
ds_read_b64_tr_b16 a[178:179], v11 offset:33280
v_mfma_f32_16x16x32_bf16 v[80:83], a[164:167], a[100:103], v[80:83]
ds_read_b128 a[116:119], v9 offset:2048
v_lshl_add_u32 v20, v21, 1, v20
v_mfma_f32_16x16x32_bf16 v[236:239], a[164:167], a[96:99], v[236:239]
ds_read_b64_tr_b16 a[180:181], v12 offset:32768
ds_read_b64_tr_b16 a[182:183], v12 offset:33280
v_mfma_f32_16x16x32_bf16 v[244:247], a[168:171], a[96:99], v[244:247]
ds_read_b128 a[120:123], v9 offset:4096
v_lshl_add_u32 v20, v16, 2, v20
v_mfma_f32_16x16x32_bf16 v[252:255], a[168:171], a[100:103], v[252:255]
buffer_store_dwordx4 v[120:123], v4, s[24:27], s53 offen offset:3072 sc1
v_mfma_f32_16x16x32_bf16 v[88:91], a[168:171], a[104:107], v[88:91]
buffer_load_dwordx4 v8, s[20:23], s64 offen offset:1024 lds
v_mfma_f32_16x16x32_bf16 v[160:163], a[168:171], a[108:111], v[160:163]
ds_read_b64_tr_b16 a[184:185], v13 offset:32768
ds_read_b64_tr_b16 a[186:187], v13 offset:33280
v_mfma_f32_16x16x32_bf16 v[168:171], a[172:175], a[108:111], v[168:171]
ds_read_b128 a[124:127], v9 offset:6144
v_add_u32 v20, v20, v18
v_mfma_f32_16x16x32_bf16 v[176:179], a[172:175], a[104:107], v[176:179]
buffer_atomic_add v1, v0, s[24:27], s90 offen offset:4 sc1
v_mfma_f32_16x16x32_bf16 v[184:187], a[172:175], a[100:103], v[184:187]
s_add_u32 m0, s80, 16384
s_add_u32 s64, s79, 4096
v_mad_u32_u24 v20, s52, 36, v20
v_mfma_f32_16x16x32_bf16 v[248:251], a[172:175], a[96:99], v[248:251]
ds_read_b64_tr_b16 a[188:189], v14 offset:32768
ds_read_b64_tr_b16 a[190:191], v14 offset:33280
v_mfma_f32_16x16x32_bf16 v[240:243], a[80:83], a[96:99], v[240:243]
buffer_load_dwordx4 v4, s[24:27], s64 offen sc1 lds
v_mfma_f32_16x16x32_bf16 v[232:235], a[80:83], a[100:103], v[232:235]
s_xor_b32 s65, s70, 896
s_add_u32 s71, s68, s65
s_add_u32 s72, s69, s65
v_mfma_f32_16x16x32_bf16 v[224:227], a[80:83], a[104:107], v[224:227]
ds_read_b128 a[72:75], v4 offset:40960
v_lshlrev_b32 v21, 1, v18
v_mfma_f32_16x16x32_bf16 v[192:195], a[80:83], a[108:111], v[192:195]
ds_read_b64_tr_b16 a[64:65], v11 offset:36864
ds_read_b64_tr_b16 a[66:67], v11 offset:37376
v_mfma_f32_16x16x32_bf16 v[152:155], a[144:147], a[108:111], v[152:155]
s_add_u32 m0, s73, 0
s_add_u32 s64, s71, 0
ds_read_b128 a[136:139], v4 offset:41984
v_mfma_f32_16x16x32_bf16 v[200:203], a[144:147], a[104:107], v[200:203]
v_lshl_add_u32 v21, v19, 2, v21
v_lshrrev_b32 v22, 1, v16
v_mfma_f32_16x16x32_bf16 v[208:211], a[144:147], a[100:103], v[208:211]
buffer_load_dwordx4 v5, s[12:15], s64 offen lds
v_mfma_f32_16x16x32_bf16 v[36:39], a[144:147], a[96:99], v[36:39]
ds_read_b64_tr_b16 a[128:129], v12 offset:36864
ds_read_b64_tr_b16 a[130:131], v12 offset:37376
v_mfma_f32_16x16x32_bf16 v[44:47], a[84:87], a[96:99], v[44:47]
ds_read_b128 a[76:79], v4 offset:43008
v_add_u32 v21, v21, v22
v_mfma_f32_16x16x32_bf16 v[32:35], a[84:87], a[100:103], v[32:35]
v_mul_u32_u24 v21, 18, v21
v_and_b32 v22, 1, v16
v_mfma_f32_16x16x32_bf16 v[52:55], a[84:87], a[104:107], v[52:55]
s_add_u32 s53, s88, 2359296
ds_read_b64_tr_b16 a[68:69], v13 offset:36864
ds_read_b64_tr_b16 a[70:71], v13 offset:37376
v_mfma_f32_16x16x32_bf16 v[60:63], a[84:87], a[108:111], v[60:63]
buffer_store_dwordx4 v[128:131], v4, s[24:27], s53 offen offset:0 sc1
v_mfma_f32_16x16x32_bf16 v[68:71], a[148:151], a[108:111], v[68:71]
buffer_load_dwordx4 v6, s[12:15], s64 offen offset:1024 lds
v_mfma_f32_16x16x32_bf16 v[76:79], a[148:151], a[104:107], v[76:79]
ds_read_b128 a[140:143], v4 offset:44032
v_add3_u32 v21, v21, v22, 16
v_mfma_f32_16x16x32_bf16 v[84:87], a[148:151], a[100:103], v[84:87]
ds_read_b64_tr_b16 a[132:133], v14 offset:36864
ds_read_b64_tr_b16 a[134:135], v14 offset:37376
v_mfma_f32_16x16x32_bf16 v[92:95], a[148:151], a[96:99], v[92:95]
v_cmp_lt_u32 s[96:97], 1, v19
v_mov_b32 v22, 0x100000
v_mfma_f32_16x16x32_bf16 v[100:103], a[88:91], a[96:99], v[100:103]
s_add_u32 m0, s73, 2048
s_add_u32 s64, s71, 18432
v_mul_u32_u24 v23, 1, v23
v_mfma_f32_16x16x32_bf16 v[108:111], a[88:91], a[100:103], v[108:111]
v_cndmask_b32 v21, v21, v22, s[96:97]
v_mov_b32 v22, s52
v_mfma_f32_16x16x32_bf16 v[116:119], a[88:91], a[104:107], v[116:119]
buffer_load_dwordx4 v5, s[12:15], s64 offen lds
v_mfma_f32_16x16x32_bf16 v[40:43], a[88:91], a[108:111], v[40:43]
v_cmp_eq_u32 s[96:97], 4, v22
v_mfma_f32_16x16x32_bf16 v[124:127], a[152:155], a[108:111], v[124:127]
v_mfma_f32_16x16x32_bf16 v[132:135], a[152:155], a[104:107], v[132:135]
v_cndmask_b32 v20, v20, v21, s[96:97]
v_mul_u32_u24 v20, 1152, v20
v_mfma_f32_16x16x32_bf16 v[140:143], a[152:155], a[100:103], v[140:143]
v_lshl_add_u32 v20, v17, 4, v20
v_mov_b32 v25, v20
v_mfma_f32_16x16x32_bf16 v[148:151], a[152:155], a[96:99], v[148:151]
v_mov_b32 v16, s54
v_mov_b32 v17, s55
v_mfma_f32_16x16x32_bf16 v[156:159], a[92:95], a[96:99], v[156:159]
buffer_load_dwordx4 v6, s[12:15], s64 offen offset:1024 lds
v_mfma_f32_16x16x32_bf16 v[48:51], a[92:95], a[100:103], v[48:51]
v_add_u32 v18, 32, v22
v_mfma_f32_16x16x32_bf16 v[164:167], a[92:95], a[104:107], v[164:167]
s_mul_i32 s82, s55, 165888
s_lshl_b32 s54, s54, 5
s_add_u32 s82, s82, s54
v_mfma_f32_16x16x32_bf16 v[172:175], a[92:95], a[108:111], v[172:175]
s_and_b32 s52, s2, 1
s_lshr_b32 s54, s3, 1
s_lshl1_add_u32 s52, s52, s54
v_mfma_f32_16x16x32_bf16 v[180:183], a[156:159], a[108:111], v[180:183]
s_mul_i32 s52, s52, 9
s_and_b32 s54, s3, 1
s_mul_i32 s55, s54, 5
v_mfma_f32_16x16x32_bf16 v[188:191], a[156:159], a[104:107], v[188:191]
s_add_u32 s52, s52, s55
s_lshr_b32 s55, s2, 1
s_mul_i32 s81, s55, 1152
v_mfma_f32_16x16x32_bf16 v[196:199], a[156:159], a[100:103], v[196:199]
s_add_u32 s81, s81, s52
s_lshl_b32 s81, s81, 5
v_mfma_f32_16x16x32_bf16 v[56:59], a[156:159], a[96:99], v[56:59]
s_waitcnt lgkmcnt(0)
v_cmp_gt_u32 s[96:97], 5, v1
v_add_u32 v19, s52, v1
v_mfma_f32_16x16x32_bf16 v[64:67], a[176:179], a[112:115], v[64:67]
s_waitcnt vmcnt(24)
v_lshrrev_b32 v20, 5, s55
v_and_b32 v21, 31, s55
v_mfma_f32_16x16x32_bf16 v[204:207], a[176:179], a[116:119], v[204:207]
s_barrier
v_mfma_f32_16x16x32_bf16 v[212:215], a[176:179], a[120:123], v[212:215]
ds_read_b128 a[96:99], v10 offset:0
v_cndmask_b32 v16, v16, v19, s[96:97]
v_mfma_f32_16x16x32_bf16 v[220:223], a[176:179], a[124:127], v[220:223]
s_xor_b32 s75, s93, 7
s_lshl_b32 s76, s75, 19
s_add_u32 s76, s76, s74
v_mfma_f32_16x16x32_bf16 v[72:75], a[180:183], a[124:127], v[72:75]
s_mul_i32 s79, s75, 24576
s_add_u32 s79, s79, s78
v_cndmask_b32 v17, v17, v20, s[96:97]
v_mfma_f32_16x16x32_bf16 v[228:231], a[180:183], a[120:123], v[228:231]
s_add_u32 m0, s77, 32768
s_add_u32 s64, s76, 0
s_add_u32 s53, s88, 2359296
v_mfma_f32_16x16x32_bf16 v[80:83], a[180:183], a[116:119], v[80:83]
buffer_load_dwordx4 v7, s[20:23], s64 offen lds
v_mfma_f32_16x16x32_bf16 v[236:239], a[180:183], a[112:115], v[236:239]
ds_read_b64_tr_b16 a[160:161], v11 offset:49152
ds_read_b64_tr_b16 a[162:163], v11 offset:49664
v_mfma_f32_16x16x32_bf16 v[244:247], a[184:187], a[112:115], v[244:247]
ds_read_b128 a[100:103], v10 offset:2048
v_cndmask_b32 v18, v18, v21, s[96:97]
v_mfma_f32_16x16x32_bf16 v[252:255], a[184:187], a[116:119], v[252:255]
ds_read_b64_tr_b16 a[164:165], v12 offset:49152
ds_read_b64_tr_b16 a[166:167], v12 offset:49664
v_mfma_f32_16x16x32_bf16 v[88:91], a[184:187], a[120:123], v[88:91]
buffer_load_dwordx4 v8, s[20:23], s64 offen offset:1024 lds
v_mfma_f32_16x16x32_bf16 v[160:163], a[184:187], a[124:127], v[160:163]
ds_read_b128 a[104:107], v10 offset:4096
v_mul_u32_u24 v19, 7282, v16
v_mfma_f32_16x16x32_bf16 v[168:171], a[188:191], a[124:127], v[168:171]
ds_read_b64_tr_b16 a[168:169], v13 offset:49152
ds_read_b64_tr_b16 a[170:171], v13 offset:49664
v_mfma_f32_16x16x32_bf16 v[176:179], a[188:191], a[120:123], v[176:179]
ds_read_b128 a[108:111], v10 offset:6144
v_lshrrev_b32 v19, 16, v19
v_mfma_f32_16x16x32_bf16 v[184:187], a[188:191], a[116:119], v[184:187]
s_add_u32 m0, s80, 32768
s_add_u32 s64, s79, 0
v_mul_u32_u24 v20, 9, v19
v_mfma_f32_16x16x32_bf16 v[248:251], a[188:191], a[112:115], v[248:251]
ds_read_b64_tr_b16 a[172:173], v14 offset:49152
ds_read_b64_tr_b16 a[174:175], v14 offset:49664
v_mfma_f32_16x16x32_bf16 v[240:243], a[64:67], a[112:115], v[240:243]
buffer_load_dwordx4 v4, s[24:27], s64 offen sc1 lds
v_mfma_f32_16x16x32_bf16 v[232:235], a[64:67], a[116:119], v[232:235]
ds_read_b128 a[88:91], v4 offset:57344
v_sub_u32 v16, v16, v20
v_mfma_f32_16x16x32_bf16 v[224:227], a[64:67], a[120:123], v[224:227]
ds_read_b64_tr_b16 a[80:81], v11 offset:53248
ds_read_b64_tr_b16 a[82:83], v11 offset:53760
v_mfma_f32_16x16x32_bf16 v[192:195], a[64:67], a[124:127], v[192:195]
buffer_store_dwordx4 v[136:139], v4, s[24:27], s53 offen offset:1024 sc1
v_mfma_f32_16x16x32_bf16 v[152:155], a[128:131], a[124:127], v[152:155]
s_add_u32 m0, s73, 4096
s_add_u32 s64, s72, 0
ds_read_b128 a[152:155], v4 offset:58368
v_mfma_f32_16x16x32_bf16 v[200:203], a[128:131], a[120:123], v[200:203]
v_and_b32 v20, 1, v19
v_lshlrev_b32 v20, 2, v20
v_mfma_f32_16x16x32_bf16 v[208:211], a[128:131], a[116:119], v[208:211]
buffer_load_dwordx4 v5, s[12:15], s64 offen lds
v_mfma_f32_16x16x32_bf16 v[36:39], a[128:131], a[112:115], v[36:39]
ds_read_b64_tr_b16 a[144:145], v12 offset:53248
ds_read_b64_tr_b16 a[146:147], v12 offset:53760
v_mfma_f32_16x16x32_bf16 v[44:47], a[68:71], a[112:115], v[44:47]
ds_read_b128 a[92:95], v4 offset:59392
v_cndmask_b32 v20, 0, v20, s[96:97]
v_mfma_f32_16x16x32_bf16 v[32:35], a[68:71], a[116:119], v[32:35]
v_xor_b32 v18, v18, v20
v_lshlrev_b32 v19, 22, v19
v_mfma_f32_16x16x32_bf16 v[52:55], a[68:71], a[120:123], v[52:55]
ds_read_b64_tr_b16 a[84:85], v13 offset:53248
ds_read_b64_tr_b16 a[86:87], v13 offset:53760
v_mfma_f32_16x16x32_bf16 v[60:63], a[68:71], a[124:127], v[60:63]
v_and_b32 v20, 1, v17
v_mul_u32_u24 v20, 1056768, v20
v_mfma_f32_16x16x32_bf16 v[68:71], a[132:135], a[124:127], v[68:71]
buffer_load_dwordx4 v6, s[12:15], s64 offen offset:1024 lds
v_mfma_f32_16x16x32_bf16 v[76:79], a[132:135], a[120:123], v[76:79]
ds_read_b128 a[156:159], v4 offset:60416
v_lshrrev_b32 v21, 1, v17
v_mfma_f32_16x16x32_bf16 v[84:87], a[132:135], a[116:119], v[84:87]
ds_read_b64_tr_b16 a[148:149], v14 offset:53248
ds_read_b64_tr_b16 a[150:151], v14 offset:53760
v_mfma_f32_16x16x32_bf16 v[92:95], a[132:135], a[112:115], v[92:95]
v_xor_b32 v21, 0, v21
v_lshlrev_b32 v21, 13, v21
v_mfma_f32_16x16x32_bf16 v[100:103], a[72:75], a[112:115], v[100:103]
s_add_u32 m0, s73, 6144
s_add_u32 s64, s72, 18432
s_add_u32 s53, s88, 2359296
v_mfma_f32_16x16x32_bf16 v[108:111], a[72:75], a[116:119], v[108:111]
buffer_store_dwordx4 v[144:147], v4, s[24:27], s53 offen offset:2048 sc1
v_mfma_f32_16x16x32_bf16 v[116:119], a[72:75], a[120:123], v[116:119]
buffer_load_dwordx4 v5, s[12:15], s64 offen lds
v_mfma_f32_16x16x32_bf16 v[40:43], a[72:75], a[124:127], v[40:43]
v_add3_u32 v19, v19, v20, v21
v_lshrrev_b32 v20, 1, v16
v_mfma_f32_16x16x32_bf16 v[124:127], a[136:139], a[124:127], v[124:127]
v_sub_u32 v20, v20, v17
v_add_u32 v20, 3, v20
v_mfma_f32_16x16x32_bf16 v[132:135], a[136:139], a[120:123], v[132:135]
v_and_b32 v20, 3, v20
v_cmp_eq_u32 s[96:97], 8, v16
v_mfma_f32_16x16x32_bf16 v[140:143], a[136:139], a[116:119], v[140:143]
v_and_b32 v16, 1, v16
v_lshlrev_b32 v21, 1, v20
v_mfma_f32_16x16x32_bf16 v[148:151], a[136:139], a[112:115], v[148:151]
v_lshlrev_b32 v22, 1, v18
v_min_u32 v23, 16, v18
v_mfma_f32_16x16x32_bf16 v[156:159], a[76:79], a[112:115], v[156:159]
buffer_load_dwordx4 v6, s[12:15], s64 offen offset:1024 lds
v_mfma_f32_16x16x32_bf16 v[48:51], a[76:79], a[116:119], v[48:51]
v_add_u32 v9, 32768, v9
v_add_u32 v10, 32768, v10
v_mfma_f32_16x16x32_bf16 v[164:167], a[76:79], a[120:123], v[164:167]
v_add_u32 v21, 1, v21
v_cndmask_b32 v21, v21, 0, s[96:97]
v_mfma_f32_16x16x32_bf16 v[172:175], a[76:79], a[124:127], v[172:175]
v_cndmask_b32 v20, v20, 0, s[96:97]
v_mad_u32_u24 v21, v18, 5, v21
v_mfma_f32_16x16x32_bf16 v[180:183], a[140:143], a[124:127], v[180:183]
v_lshl_add_u32 v21, v23, 1, v21
v_mad_u32_u24 v22, v20, 37, v22
v_mfma_f32_16x16x32_bf16 v[188:191], a[140:143], a[120:123], v[188:191]
v_mad_u32_u24 v22, v20, 37, v22
v_lshl_add_u32 v20, v20, 6, v18
v_mfma_f32_16x16x32_bf16 v[196:199], a[140:143], a[116:119], v[196:199]
v_mov_b32 v23, 144
v_cmp_gt_u32 s[96:97], v23, v20
v_mfma_f32_16x16x32_bf16 v[56:59], a[140:143], a[112:115], v[56:59]
s_waitcnt lgkmcnt(0)
v_add_u32 v22, 37, v22
v_add_u32 v19, 134217728, v19
v_mfma_f32_16x16x32_bf16 v[64:67], a[160:163], a[96:99], v[64:67]
s_waitcnt vmcnt(19)
v_cndmask_b32 v21, v22, v21, s[96:97]
v_add_u32 v21, v21, v16
v_mfma_f32_16x16x32_bf16 v[204:207], a[160:163], a[100:103], v[204:207]
s_barrier
v_mfma_f32_16x16x32_bf16 v[212:215], a[160:163], a[104:107], v[212:215]
ds_read_b128 a[112:115], v9 offset:0
v_and_b32 v22, -8, v21
v_mfma_f32_16x16x32_bf16 v[220:223], a[160:163], a[108:111], v[220:223]
s_add_u32 m0, s77, 49152
s_add_u32 s64, s76, 262144
v_mad_u32_u24 v21, v22, 2, v21
v_mfma_f32_16x16x32_bf16 v[72:75], a[164:167], a[108:111], v[72:75]
buffer_load_dwordx4 v7, s[20:23], s64 offen lds
v_mfma_f32_16x16x32_bf16 v[228:231], a[164:167], a[104:107], v[228:231]
ds_read_b64_tr_b16 a[176:177], v11 offset:0
ds_read_b64_tr_b16 a[178:179], v11 offset:512
v_mfma_f32_16x16x32_bf16 v[80:83], a[164:167], a[100:103], v[80:83]
ds_read_b128 a[116:119], v9 offset:2048
v_lshl_add_u32 v19, v21, 10, v19
v_mfma_f32_16x16x32_bf16 v[236:239], a[164:167], a[96:99], v[236:239]
ds_read_b64_tr_b16 a[180:181], v12 offset:0
ds_read_b64_tr_b16 a[182:183], v12 offset:512
v_mfma_f32_16x16x32_bf16 v[244:247], a[168:171], a[96:99], v[244:247]
s_cmp_eq_u32 s54, 1
s_cselect_b32 s96, 16, 0
ds_read_b128 a[120:123], v9 offset:4096
v_mfma_f32_16x16x32_bf16 v[252:255], a[168:171], a[100:103], v[252:255]
buffer_load_dword v30, v29, s[24:27], s89 offen offset:4 sc1
v_mfma_f32_16x16x32_bf16 v[88:91], a[168:171], a[104:107], v[88:91]
buffer_load_dwordx4 v8, s[20:23], s64 offen offset:1024 lds
v_mfma_f32_16x16x32_bf16 v[160:163], a[168:171], a[108:111], v[160:163]
s_add_u32 s53, s88, 2359296
ds_read_b64_tr_b16 a[184:185], v13 offset:0
ds_read_b64_tr_b16 a[186:187], v13 offset:512
v_mfma_f32_16x16x32_bf16 v[168:171], a[172:175], a[108:111], v[168:171]
s_cmp_eq_u32 s3, 3
s_cselect_b32 s52, 32, 0
ds_read_b128 a[124:127], v9 offset:6144
v_mfma_f32_16x16x32_bf16 v[176:179], a[172:175], a[104:107], v[176:179]
buffer_store_dwordx4 a[32:35], v4, s[24:27], s53 offen offset:3072 sc1
v_mfma_f32_16x16x32_bf16 v[184:187], a[172:175], a[100:103], v[184:187]
s_add_u32 m0, s80, 49152
s_add_u32 s64, s79, 4096
s_or_b32 s96, s96, s52
v_mfma_f32_16x16x32_bf16 v[248:251], a[172:175], a[96:99], v[248:251]
ds_read_b64_tr_b16 a[188:189], v14 offset:0
ds_read_b64_tr_b16 a[190:191], v14 offset:512
v_mfma_f32_16x16x32_bf16 v[240:243], a[80:83], a[96:99], v[240:243]
buffer_load_dwordx4 v4, s[24:27], s64 offen sc1 lds
v_mfma_f32_16x16x32_bf16 v[232:235], a[80:83], a[100:103], v[232:235]
s_mov_b32 s65, 1024
s_add_u32 s71, s68, s65
s_add_u32 s72, s69, s65
v_mfma_f32_16x16x32_bf16 v[224:227], a[80:83], a[104:107], v[224:227]
s_cmp_ge_u32 s2, 240
s_cselect_b32 s52, 32, 0
ds_read_b128 a[72:75], v4 offset:8192
v_mfma_f32_16x16x32_bf16 v[192:195], a[80:83], a[108:111], v[192:195]
s_or_b32 s96, s96, s52
ds_read_b64_tr_b16 a[64:65], v11 offset:4096
ds_read_b64_tr_b16 a[66:67], v11 offset:4608
v_mfma_f32_16x16x32_bf16 v[152:155], a[144:147], a[108:111], v[152:155]
s_add_u32 m0, s73, 32768
s_add_u32 s64, s71, 0
ds_read_b128 a[136:139], v4 offset:9216
v_mfma_f32_16x16x32_bf16 v[200:203], a[144:147], a[104:107], v[200:203]
s_mov_b32 s97, 0
v_mfma_f32_16x16x32_bf16 v[208:211], a[144:147], a[100:103], v[208:211]
buffer_load_dwordx4 v5, s[12:15], s64 offen lds
v_mfma_f32_16x16x32_bf16 v[36:39], a[144:147], a[96:99], v[36:39]
ds_read_b64_tr_b16 a[128:129], v12 offset:4096
ds_read_b64_tr_b16 a[130:131], v12 offset:4608
v_mfma_f32_16x16x32_bf16 v[44:47], a[84:87], a[96:99], v[44:47]
ds_read_b128 a[76:79], v4 offset:10240
v_mov_b32 v20, 2147418112
v_mfma_f32_16x16x32_bf16 v[32:35], a[84:87], a[100:103], v[32:35]
v_cndmask_b32 v26, v19, v20, s[96:97]
v_lshlrev_b32 v27, 3, v1
v_mfma_f32_16x16x32_bf16 v[52:55], a[84:87], a[104:107], v[52:55]
ds_read_b64_tr_b16 a[68:69], v13 offset:4096
ds_read_b64_tr_b16 a[70:71], v13 offset:4608
v_mfma_f32_16x16x32_bf16 v[60:63], a[84:87], a[108:111], v[60:63]
v_add_u32 v27, s83, v27
v_lshrrev_b32 v22, 3, v1
v_mfma_f32_16x16x32_bf16 v[68:71], a[148:151], a[108:111], v[68:71]
buffer_load_dwordx4 v6, s[12:15], s64 offen offset:1024 lds
v_mfma_f32_16x16x32_bf16 v[76:79], a[148:151], a[104:107], v[76:79]
ds_read_b128 a[140:143], v4 offset:11264
v_mul_u32_u24 v22, 1152, v22
v_mfma_f32_16x16x32_bf16 v[84:87], a[148:151], a[100:103], v[84:87]
ds_read_b64_tr_b16 a[132:133], v14 offset:4096
ds_read_b64_tr_b16 a[134:135], v14 offset:4608
v_mfma_f32_16x16x32_bf16 v[92:95], a[148:151], a[96:99], v[92:95]
v_and_b32 v23, 7, v1
v_lshl_add_u32 v22, v23, 4, v22
v_mfma_f32_16x16x32_bf16 v[100:103], a[88:91], a[96:99], v[100:103]
s_add_u32 m0, s73, 34816
s_add_u32 s64, s71, 18432
v_lshrrev_b32 v23, 2, v1
v_mfma_f32_16x16x32_bf16 v[108:111], a[88:91], a[100:103], v[108:111]
v_mul_u32_u24 v23, 96, v23
v_add_u32 v23, v23, v27
v_mfma_f32_16x16x32_bf16 v[116:119], a[88:91], a[104:107], v[116:119]
buffer_load_dwordx4 v5, s[12:15], s64 offen lds
v_mfma_f32_16x16x32_bf16 v[40:43], a[88:91], a[108:111], v[40:43]
v_mov_b32 v16, 0x3f803f80
v_accvgpr_write_b32 a240, v16
v_mfma_f32_16x16x32_bf16 v[124:127], a[152:155], a[108:111], v[124:127]
v_accvgpr_write_b32 a241, v16
v_accvgpr_write_b32 a242, v16
v_mfma_f32_16x16x32_bf16 v[132:135], a[152:155], a[104:107], v[132:135]
v_accvgpr_write_b32 a243, v16
v_accvgpr_write_b32 a232, 0
v_mfma_f32_16x16x32_bf16 v[140:143], a[152:155], a[100:103], v[140:143]
s_add_u32 s53, s87, 1572864
v_accvgpr_write_b32 a233, 0
v_accvgpr_write_b32 a234, 0
v_mfma_f32_16x16x32_bf16 v[148:151], a[152:155], a[96:99], v[148:151]
buffer_store_dwordx4 a[28:31], v4, s[24:27], s53 offen offset:0 sc1
v_mfma_f32_16x16x32_bf16 v[156:159], a[92:95], a[96:99], v[156:159]
buffer_load_dwordx4 v6, s[12:15], s64 offen offset:1024 lds
v_mfma_f32_16x16x32_bf16 v[48:51], a[92:95], a[100:103], v[48:51]
v_accvgpr_write_b32 a235, 0
v_accvgpr_write_b32 a236, 0
v_mfma_f32_16x16x32_bf16 v[164:167], a[92:95], a[104:107], v[164:167]
v_accvgpr_write_b32 a237, 0
v_accvgpr_write_b32 a238, 0
v_mfma_f32_16x16x32_bf16 v[172:175], a[92:95], a[108:111], v[172:175]
v_accvgpr_write_b32 a239, 0
v_lshlrev_b32 v16, 2, v3
v_mfma_f32_16x16x32_bf16 v[180:183], a[156:159], a[108:111], v[180:183]
v_sub_u32 v16, v2, v16
v_cmp_gt_i32 s[56:57], 0, v16
v_mfma_f32_16x16x32_bf16 v[188:191], a[156:159], a[104:107], v[188:191]
v_cmp_gt_i32 s[58:59], 1, v16
v_cmp_gt_i32 s[60:61], 2, v16
v_mfma_f32_16x16x32_bf16 v[196:199], a[156:159], a[100:103], v[196:199]
v_cmp_gt_i32 s[62:63], 3, v16
v_cmp_eq_u32 s[96:97], 3, v3
v_mfma_f32_16x16x32_bf16 v[56:59], a[156:159], a[96:99], v[56:59]
s_waitcnt lgkmcnt(0)
v_add_u32 v17, 48, v2
v_lshlrev_b32 v17, 2, v17
v_mfma_f32_16x16x32_bf16 v[64:67], a[176:179], a[112:115], v[64:67]
s_waitcnt vmcnt(24)
v_lshlrev_b32 v18, 16, v3
v_lshl_add_u32 v18, v2, 4, v18
v_mfma_f32_16x16x32_bf16 v[204:207], a[176:179], a[116:119], v[204:207]
s_barrier
v_mfma_f32_16x16x32_bf16 v[212:215], a[176:179], a[120:123], v[212:215]
ds_read_b128 a[96:99], v10 offset:0
v_add_u32 v19, 0x8000, v18
v_mfma_f32_16x16x32_bf16 v[220:223], a[176:179], a[124:127], v[220:223]
s_mov_b32 s75, 8
s_lshl_b32 s76, s75, 19
s_add_u32 s76, s76, s74
v_mfma_f32_16x16x32_bf16 v[72:75], a[180:183], a[124:127], v[72:75]
s_mul_i32 s79, s75, 24576
s_add_u32 s79, s79, s78
v_cndmask_b32 v19, v19, v20, s[96:97]
v_mfma_f32_16x16x32_bf16 v[228:231], a[180:183], a[120:123], v[228:231]
s_add_u32 m0, s77, 0
s_add_u32 s64, s76, 0
v_mov_b32 v216, 0
v_mfma_f32_16x16x32_bf16 v[80:83], a[180:183], a[116:119], v[80:83]
buffer_load_dwordx4 v7, s[20:23], s64 offen lds
v_mfma_f32_16x16x32_bf16 v[236:239], a[180:183], a[112:115], v[236:239]
ds_read_b64_tr_b16 a[160:161], v11 offset:16384
ds_read_b64_tr_b16 a[162:163], v11 offset:16896
v_mfma_f32_16x16x32_bf16 v[244:247], a[184:187], a[112:115], v[244:247]
ds_read_b128 a[100:103], v10 offset:2048
v_mov_b32 v217, 0
v_mfma_f32_16x16x32_bf16 v[252:255], a[184:187], a[116:119], v[252:255]
ds_read_b64_tr_b16 a[164:165], v12 offset:16384
ds_read_b64_tr_b16 a[166:167], v12 offset:16896
v_mfma_f32_16x16x32_bf16 v[88:91], a[184:187], a[120:123], v[88:91]
buffer_load_dwordx4 v8, s[20:23], s64 offen offset:1024 lds
v_mfma_f32_16x16x32_bf16 v[160:163], a[184:187], a[124:127], v[160:163]
ds_read_b128 a[104:107], v10 offset:4096
v_mov_b32 v218, 0
v_mfma_f32_16x16x32_bf16 v[168:171], a[188:191], a[124:127], v[168:171]
ds_read_b64_tr_b16 a[168:169], v13 offset:16384
ds_read_b64_tr_b16 a[170:171], v13 offset:16896
v_mfma_f32_16x16x32_bf16 v[176:179], a[188:191], a[120:123], v[176:179]
ds_read_b128 a[108:111], v10 offset:6144
v_mov_b32 v219, 0
v_mfma_f32_16x16x32_bf16 v[184:187], a[188:191], a[116:119], v[184:187]
s_add_u32 m0, s80, 0
s_add_u32 s64, s79, 0
v_mov_b32 v96, 0
v_mfma_f32_16x16x32_bf16 v[248:251], a[188:191], a[112:115], v[248:251]
ds_read_b64_tr_b16 a[172:173], v14 offset:16384
ds_read_b64_tr_b16 a[174:175], v14 offset:16896
v_mfma_f32_16x16x32_bf16 v[240:243], a[64:67], a[112:115], v[240:243]
buffer_load_dwordx4 v4, s[24:27], s64 offen sc1 lds
v_mfma_f32_16x16x32_bf16 v[232:235], a[64:67], a[116:119], v[232:235]
s_add_u32 s53, s87, 1572864
ds_read_b128 a[88:91], v4 offset:24576
v_mov_b32 v97, 0
v_mfma_f32_16x16x32_bf16 v[224:227], a[64:67], a[120:123], v[224:227]
ds_read_b64_tr_b16 a[80:81], v11 offset:20480
ds_read_b64_tr_b16 a[82:83], v11 offset:20992
v_mfma_f32_16x16x32_bf16 v[192:195], a[64:67], a[124:127], v[192:195]
buffer_store_dwordx4 a[20:23], v4, s[24:27], s53 offen offset:1024 sc1
v_mfma_f32_16x16x32_bf16 v[152:155], a[128:131], a[124:127], v[152:155]
s_add_u32 m0, s73, 36864
s_add_u32 s64, s72, 0
ds_read_b128 a[152:155], v4 offset:25600
v_mfma_f32_16x16x32_bf16 v[200:203], a[128:131], a[120:123], v[200:203]
v_mov_b32 v98, 0
v_mov_b32 v99, 0
v_mfma_f32_16x16x32_bf16 v[208:211], a[128:131], a[116:119], v[208:211]
buffer_load_dwordx4 v5, s[12:15], s64 offen lds
v_mfma_f32_16x16x32_bf16 v[36:39], a[128:131], a[112:115], v[36:39]
ds_read_b64_tr_b16 a[144:145], v12 offset:20480
ds_read_b64_tr_b16 a[146:147], v12 offset:20992
v_mfma_f32_16x16x32_bf16 v[44:47], a[68:71], a[112:115], v[44:47]
ds_read_b128 a[92:95], v4 offset:26624
v_mov_b32 v104, 0
v_mfma_f32_16x16x32_bf16 v[32:35], a[68:71], a[116:119], v[32:35]
v_mov_b32 v105, 0
v_mov_b32 v106, 0
v_mfma_f32_16x16x32_bf16 v[52:55], a[68:71], a[120:123], v[52:55]
ds_read_b64_tr_b16 a[84:85], v13 offset:20480
ds_read_b64_tr_b16 a[86:87], v13 offset:20992
v_mfma_f32_16x16x32_bf16 v[60:63], a[68:71], a[124:127], v[60:63]
v_mov_b32 v107, 0
v_mov_b32 v112, 0
v_mfma_f32_16x16x32_bf16 v[68:71], a[132:135], a[124:127], v[68:71]
buffer_load_dwordx4 v6, s[12:15], s64 offen offset:1024 lds
v_mfma_f32_16x16x32_bf16 v[76:79], a[132:135], a[120:123], v[76:79]
ds_read_b128 a[156:159], v4 offset:27648
v_mov_b32 v113, 0
v_mfma_f32_16x16x32_bf16 v[84:87], a[132:135], a[116:119], v[84:87]
ds_read_b64_tr_b16 a[148:149], v14 offset:20480
ds_read_b64_tr_b16 a[150:151], v14 offset:20992
v_mfma_f32_16x16x32_bf16 v[92:95], a[132:135], a[112:115], v[92:95]
v_mov_b32 v114, 0
v_mov_b32 v115, 0
v_mfma_f32_16x16x32_bf16 v[100:103], a[72:75], a[112:115], v[100:103]
s_add_u32 m0, s73, 38912
s_add_u32 s64, s72, 18432
v_mov_b32 v120, 0
v_mfma_f32_16x16x32_bf16 v[108:111], a[72:75], a[116:119], v[108:111]
v_mov_b32 v121, 0
v_mov_b32 v122, 0
v_mfma_f32_16x16x32_bf16 v[116:119], a[72:75], a[120:123], v[116:119]
buffer_load_dwordx4 v5, s[12:15], s64 offen lds
v_mfma_f32_16x16x32_bf16 v[40:43], a[72:75], a[124:127], v[40:43]
v_mov_b32 v123, 0
v_mov_b32 v128, 0
v_mfma_f32_16x16x32_bf16 v[124:127], a[136:139], a[124:127], v[124:127]
v_mov_b32 v129, 0
v_mov_b32 v130, 0
v_mfma_f32_16x16x32_bf16 v[132:135], a[136:139], a[120:123], v[132:135]
v_mov_b32 v131, 0
v_mov_b32 v136, 0
v_mfma_f32_16x16x32_bf16 v[140:143], a[136:139], a[116:119], v[140:143]
v_mov_b32 v137, 0
v_mov_b32 v138, 0
v_mfma_f32_16x16x32_bf16 v[148:151], a[136:139], a[112:115], v[148:151]
v_mov_b32 v139, 0
v_mov_b32 v144, 0
v_mfma_f32_16x16x32_bf16 v[156:159], a[76:79], a[112:115], v[156:159]
buffer_load_dwordx4 v6, s[12:15], s64 offen offset:1024 lds
v_mfma_f32_16x16x32_bf16 v[48:51], a[76:79], a[116:119], v[48:51]
v_add_u32 v9, -65536, v9
v_add_u32 v10, -65536, v10
v_mfma_f32_16x16x32_bf16 v[164:167], a[76:79], a[120:123], v[164:167]
v_mov_b32 v145, 0
v_mov_b32 v146, 0
v_mfma_f32_16x16x32_bf16 v[172:175], a[76:79], a[124:127], v[172:175]
v_mov_b32 v147, 0
v_mfma_f32_16x16x32_bf16 v[180:183], a[140:143], a[124:127], v[180:183]
s_add_u32 s53, s87, 1576960
v_mfma_f32_16x16x32_bf16 v[188:191], a[140:143], a[120:123], v[188:191]
buffer_store_dwordx4 a[12:15], v4, s[24:27], s53 offen offset:0 sc1
v_mfma_f32_16x16x32_bf16 v[196:199], a[140:143], a[116:119], v[196:199]
v_mfma_f32_16x16x32_bf16 v[56:59], a[140:143], a[112:115], v[56:59]
s_waitcnt lgkmcnt(0)
v_mfma_f32_16x16x32_bf16 v[64:67], a[160:163], a[96:99], v[64:67]
s_waitcnt vmcnt(19)
v_mfma_f32_16x16x32_bf16 v[204:207], a[160:163], a[100:103], v[204:207]
s_barrier
v_mfma_f32_16x16x32_bf16 v[212:215], a[160:163], a[104:107], v[212:215]
ds_read_b128 a[112:115], v9 offset:0
v_mfma_f32_16x16x32_bf16 v[220:223], a[160:163], a[108:111], v[220:223]
s_add_u32 m0, s77, 16384
s_add_u32 s64, s76, 262144
v_mfma_f32_16x16x32_bf16 v[72:75], a[164:167], a[108:111], v[72:75]
buffer_load_dwordx4 v7, s[20:23], s64 offen lds
v_mfma_f32_16x16x32_bf16 v[228:231], a[164:167], a[104:107], v[228:231]
ds_read_b64_tr_b16 a[176:177], v11 offset:32768
ds_read_b64_tr_b16 a[178:179], v11 offset:33280
v_mfma_f32_16x16x32_bf16 v[80:83], a[164:167], a[100:103], v[80:83]
ds_read_b128 a[116:119], v9 offset:2048
v_mfma_f32_16x16x32_bf16 v[236:239], a[164:167], a[96:99], v[236:239]
ds_read_b64_tr_b16 a[180:181], v12 offset:32768
ds_read_b64_tr_b16 a[182:183], v12 offset:33280
v_mfma_f32_16x16x32_bf16 v[244:247], a[168:171], a[96:99], v[244:247]
buffer_load_dwordx4 v8, s[20:23], s64 offen offset:1024 lds
v_mfma_f32_16x16x32_bf16 v[252:255], a[168:171], a[100:103], v[252:255]
ds_read_b128 a[120:123], v9 offset:4096
v_mfma_f32_16x16x32_bf16 v[88:91], a[168:171], a[104:107], v[88:91]
ds_read_b64_tr_b16 a[184:185], v13 offset:32768
ds_read_b64_tr_b16 a[186:187], v13 offset:33280
v_mfma_f32_16x16x32_bf16 v[160:163], a[168:171], a[108:111], v[160:163]
s_add_u32 m0, s80, 16384
s_add_u32 s64, s79, 4096
v_mfma_f32_16x16x32_bf16 v[168:171], a[172:175], a[108:111], v[168:171]
ds_read_b128 a[124:127], v9 offset:6144
v_mfma_f32_16x16x32_bf16 v[176:179], a[172:175], a[104:107], v[176:179]
buffer_load_dwordx4 v4, s[24:27], s64 offen sc1 lds
v_mfma_f32_16x16x32_bf16 v[184:187], a[172:175], a[100:103], v[184:187]
ds_read_b64_tr_b16 a[188:189], v14 offset:32768
ds_read_b64_tr_b16 a[190:191], v14 offset:33280
v_mfma_f32_16x16x32_bf16 v[248:251], a[172:175], a[96:99], v[248:251]
v_mfma_f32_16x16x32_bf16 v[240:243], a[80:83], a[96:99], v[240:243]
s_add_u32 m0, s83, 0
s_add_u32 s64, s81, 0
ds_read_b128 a[72:75], v4 offset:40960
v_mfma_f32_16x16x32_bf16 v[232:235], a[80:83], a[100:103], v[232:235]
v_mfma_f32_16x16x32_bf16 v[224:227], a[80:83], a[104:107], v[224:227]
buffer_load_dwordx4 v22, s[32:35], s64 offen lds
v_mfma_f32_16x16x32_bf16 v[192:195], a[80:83], a[108:111], v[192:195]
ds_read_b64_tr_b16 a[64:65], v11 offset:36864
ds_read_b64_tr_b16 a[66:67], v11 offset:37376
v_mfma_f32_16x16x32_bf16 v[152:155], a[144:147], a[108:111], v[152:155]
s_add_u32 m0, s83, 1024
s_add_u32 s64, s81, 9216
ds_read_b128 a[136:139], v4 offset:41984
v_mfma_f32_16x16x32_bf16 v[200:203], a[144:147], a[104:107], v[200:203]
v_mfma_f32_16x16x32_bf16 v[208:211], a[144:147], a[100:103], v[208:211]
buffer_load_dwordx4 v22, s[32:35], s64 offen lds
v_mfma_f32_16x16x32_bf16 v[36:39], a[144:147], a[96:99], v[36:39]
s_add_u32 s53, s87, 1576960
ds_read_b64_tr_b16 a[128:129], v12 offset:36864
ds_read_b64_tr_b16 a[130:131], v12 offset:37376
v_mfma_f32_16x16x32_bf16 v[44:47], a[84:87], a[96:99], v[44:47]
ds_read_b128 a[76:79], v4 offset:43008
v_mfma_f32_16x16x32_bf16 v[32:35], a[84:87], a[100:103], v[32:35]
s_add_u32 m0, s83, 2048
s_add_u32 s64, s81, 18432
v_mfma_f32_16x16x32_bf16 v[52:55], a[84:87], a[104:107], v[52:55]
ds_read_b64_tr_b16 a[68:69], v13 offset:36864
ds_read_b64_tr_b16 a[70:71], v13 offset:37376
v_mfma_f32_16x16x32_bf16 v[60:63], a[84:87], a[108:111], v[60:63]
buffer_load_dwordx4 v22, s[32:35], s64 offen lds
v_mfma_f32_16x16x32_bf16 v[68:71], a[148:151], a[108:111], v[68:71]
ds_read_b128 a[140:143], v4 offset:44032
v_mfma_f32_16x16x32_bf16 v[76:79], a[148:151], a[104:107], v[76:79]
buffer_store_dwordx4 a[4:7], v4, s[24:27], s53 offen offset:1024 sc1
v_mfma_f32_16x16x32_bf16 v[84:87], a[148:151], a[100:103], v[84:87]
s_add_u32 m0, s83, 3072
s_add_u32 s64, s81, 27648
v_mfma_f32_16x16x32_bf16 v[92:95], a[148:151], a[96:99], v[92:95]
ds_read_b64_tr_b16 a[132:133], v14 offset:36864
ds_read_b64_tr_b16 a[134:135], v14 offset:37376
v_mfma_f32_16x16x32_bf16 v[100:103], a[88:91], a[96:99], v[100:103]
buffer_load_dwordx4 v22, s[32:35], s64 offen lds
v_mfma_f32_16x16x32_bf16 v[108:111], a[88:91], a[100:103], v[108:111]
v_mfma_f32_16x16x32_bf16 v[116:119], a[88:91], a[104:107], v[116:119]
s_add_u32 m0, s83, 4096
s_add_u32 s64, s81, 128
s_waitcnt vmcnt(25)
v_mfma_f32_16x16x32_bf16 v[40:43], a[88:91], a[108:111], v[40:43]
v_cmp_gt_u32 vcc, 8, v30
v_mfma_f32_16x16x32_bf16 v[124:127], a[152:155], a[108:111], v[124:127]
buffer_load_dwordx4 v24, s[32:35], s64 offen lds
v_mfma_f32_16x16x32_bf16 v[132:135], a[152:155], a[104:107], v[132:135]
v_mfma_f32_16x16x32_bf16 v[140:143], a[152:155], a[100:103], v[140:143]
v_mfma_f32_16x16x32_bf16 v[148:151], a[152:155], a[96:99], v[148:151]
s_add_u32 m0, s83, 5120
s_add_u32 s64, s82, 0
v_mfma_f32_16x16x32_bf16 v[156:159], a[92:95], a[96:99], v[156:159]
s_cbranch_vccnz CK_KV
CK_KV_R:
v_mfma_f32_16x16x32_bf16 v[48:51], a[92:95], a[100:103], v[48:51]
buffer_load_dwordx4 v25, s[48:51], s64 offen lds
v_mfma_f32_16x16x32_bf16 v[164:167], a[92:95], a[104:107], v[164:167]
v_mfma_f32_16x16x32_bf16 v[172:175], a[92:95], a[108:111], v[172:175]
v_mfma_f32_16x16x32_bf16 v[180:183], a[156:159], a[108:111], v[180:183]
v_mfma_f32_16x16x32_bf16 v[188:191], a[156:159], a[104:107], v[188:191]
v_mfma_f32_16x16x32_bf16 v[196:199], a[156:159], a[100:103], v[196:199]
v_mfma_f32_16x16x32_bf16 v[56:59], a[156:159], a[96:99], v[56:59]
s_waitcnt lgkmcnt(0)
v_mfma_f32_16x16x32_bf16 v[64:67], a[176:179], a[112:115], v[64:67]
s_waitcnt vmcnt(24)
v_mov_b32 v6, 0xf149f2ca
v_mfma_f32_16x16x32_bf16 v[204:207], a[176:179], a[116:119], v[204:207]
s_barrier
v_mfma_f32_16x16x32_bf16 v[212:215], a[176:179], a[120:123], v[212:215]
s_add_u32 s53, s87, 2359296
ds_read_b128 a[96:99], v10 offset:0
v_mfma_f32_16x16x32_bf16 v[220:223], a[176:179], a[124:127], v[220:223]
s_lshl_b32 s70, s3, 12
s_and_b32 s68, s70, 8192
s_mul_i32 s68, s68, 2
v_mfma_f32_16x16x32_bf16 v[72:75], a[180:183], a[124:127], v[72:75]
s_add_u32 s68, s68, s70
s_add_u32 s68, s68, s95
v_mfma_f32_16x16x32_bf16 v[228:231], a[180:183], a[120:123], v[228:231]
s_add_u32 m0, s70, 32768
s_cmp_lt_u32 s3, 2
s_cselect_b32 s64, s68, 2147418112
v_mfma_f32_16x16x32_bf16 v[80:83], a[180:183], a[116:119], v[80:83]
buffer_load_dwordx4 v4, s[24:27], s64 offen offset:0 sc1 lds
v_mfma_f32_16x16x32_bf16 v[236:239], a[180:183], a[112:115], v[236:239]
ds_read_b64_tr_b16 a[160:161], v11 offset:49152
ds_read_b64_tr_b16 a[162:163], v11 offset:49664
v_mfma_f32_16x16x32_bf16 v[244:247], a[184:187], a[112:115], v[244:247]
ds_read_b128 a[100:103], v10 offset:2048
v_mfma_f32_16x16x32_bf16 v[252:255], a[184:187], a[116:119], v[252:255]
ds_read_b64_tr_b16 a[164:165], v12 offset:49152
ds_read_b64_tr_b16 a[166:167], v12 offset:49664
v_mfma_f32_16x16x32_bf16 v[88:91], a[184:187], a[120:123], v[88:91]
ds_read_b128 a[104:107], v10 offset:4096
v_mfma_f32_16x16x32_bf16 v[160:163], a[184:187], a[124:127], v[160:163]
ds_read_b64_tr_b16 a[168:169], v13 offset:49152
ds_read_b64_tr_b16 a[170:171], v13 offset:49664
v_mfma_f32_16x16x32_bf16 v[168:171], a[188:191], a[124:127], v[168:171]
ds_read_b128 a[108:111], v10 offset:6144
v_mfma_f32_16x16x32_bf16 v[176:179], a[188:191], a[120:123], v[176:179]
buffer_store_dwordx4 a[0:3], v4, s[24:27], s53 offen offset:0 sc1
v_mfma_f32_16x16x32_bf16 v[184:187], a[188:191], a[116:119], v[184:187]
buffer_load_dwordx4 v4, s[24:27], s64 offen offset:1024 sc1 lds
v_mfma_f32_16x16x32_bf16 v[248:251], a[188:191], a[112:115], v[248:251]
ds_read_b64_tr_b16 a[172:173], v14 offset:49152
ds_read_b64_tr_b16 a[174:175], v14 offset:49664
v_mfma_f32_16x16x32_bf16 v[240:243], a[64:67], a[112:115], v[240:243]
ds_read_b128 a[88:91], v4 offset:57344
v_mfma_f32_16x16x32_bf16 v[232:235], a[64:67], a[116:119], v[232:235]
s_cmp_eq_u32 s66, 0
s_cbranch_scc1 D0
D0_R:
v_mfma_f32_16x16x32_bf16 v[224:227], a[64:67], a[120:123], v[224:227]
s_lshl_b32 s52, s4, 18
ds_read_b64_tr_b16 a[80:81], v11 offset:53248
ds_read_b64_tr_b16 a[82:83], v11 offset:53760
v_mfma_f32_16x16x32_bf16 v[192:195], a[64:67], a[124:127], v[192:195]
s_add_u32 s52, s52, 159383552
s_lshl_b32 s54, s66, 9
s_add_u32 s54, s54, s52
v_mfma_f32_16x16x32_bf16 v[152:155], a[128:131], a[124:127], v[152:155]
s_lshl_b32 s55, s67, 9
s_add_u32 s55, s55, s52
ds_read_b128 a[152:155], v4 offset:58368
v_mfma_f32_16x16x32_bf16 v[200:203], a[128:131], a[120:123], v[200:203]
v_mfma_f32_16x16x32_bf16 v[208:211], a[128:131], a[116:119], v[208:211]
ds_read_b64_tr_b16 a[144:145], v12 offset:53248
ds_read_b64_tr_b16 a[146:147], v12 offset:53760
v_mfma_f32_16x16x32_bf16 v[36:39], a[128:131], a[112:115], v[36:39]
v_mfma_f32_16x16x32_bf16 v[44:47], a[68:71], a[112:115], v[44:47]
ds_read_b128 a[92:95], v4 offset:59392
v_mfma_f32_16x16x32_bf16 v[32:35], a[68:71], a[116:119], v[32:35]
buffer_load_dwordx4 v4, s[24:27], s64 offen offset:2048 sc1 lds
v_mfma_f32_16x16x32_bf16 v[52:55], a[68:71], a[120:123], v[52:55]
ds_read_b64_tr_b16 a[84:85], v13 offset:53248
ds_read_b64_tr_b16 a[86:87], v13 offset:53760
v_mfma_f32_16x16x32_bf16 v[60:63], a[68:71], a[124:127], v[60:63]
v_mfma_f32_16x16x32_bf16 v[68:71], a[132:135], a[124:127], v[68:71]
ds_read_b128 a[156:159], v4 offset:60416
v_mfma_f32_16x16x32_bf16 v[76:79], a[132:135], a[120:123], v[76:79]
s_add_u32 s53, s87, 2359296
v_mfma_f32_16x16x32_bf16 v[84:87], a[132:135], a[116:119], v[84:87]
ds_read_b64_tr_b16 a[148:149], v14 offset:53248
ds_read_b64_tr_b16 a[150:151], v14 offset:53760
v_mfma_f32_16x16x32_bf16 v[92:95], a[132:135], a[112:115], v[92:95]
buffer_store_dwordx4 a[8:11], v4, s[24:27], s53 offen offset:1024 sc1
v_mfma_f32_16x16x32_bf16 v[100:103], a[72:75], a[112:115], v[100:103]
v_mfma_f32_16x16x32_bf16 v[108:111], a[72:75], a[116:119], v[108:111]
v_mfma_f32_16x16x32_bf16 v[116:119], a[72:75], a[120:123], v[116:119]
v_mfma_f32_16x16x32_bf16 v[40:43], a[72:75], a[124:127], v[40:43]
buffer_load_dwordx4 v4, s[24:27], s64 offen offset:3072 sc1 lds
v_mfma_f32_16x16x32_bf16 v[124:127], a[136:139], a[124:127], v[124:127]
v_mfma_f32_16x16x32_bf16 v[132:135], a[136:139], a[120:123], v[132:135]
v_mfma_f32_16x16x32_bf16 v[140:143], a[136:139], a[116:119], v[140:143]
v_mfma_f32_16x16x32_bf16 v[148:151], a[136:139], a[112:115], v[148:151]
v_mfma_f32_16x16x32_bf16 v[156:159], a[76:79], a[112:115], v[156:159]
v_add_u32 v9, 32768, v9
v_add_u32 v10, 32768, v10
v_mfma_f32_16x16x32_bf16 v[48:51], a[76:79], a[116:119], v[48:51]
v_mfma_f32_16x16x32_bf16 v[164:167], a[76:79], a[120:123], v[164:167]
v_mfma_f32_16x16x32_bf16 v[172:175], a[76:79], a[124:127], v[172:175]
v_mfma_f32_16x16x32_bf16 v[180:183], a[140:143], a[124:127], v[180:183]
v_mfma_f32_16x16x32_bf16 v[188:191], a[140:143], a[120:123], v[188:191]
v_mfma_f32_16x16x32_bf16 v[196:199], a[140:143], a[116:119], v[196:199]
v_mfma_f32_16x16x32_bf16 v[56:59], a[140:143], a[112:115], v[56:59]
s_waitcnt lgkmcnt(0)
v_mfma_f32_16x16x32_bf16 v[64:67], a[160:163], a[96:99], v[64:67]
s_waitcnt vmcnt(17)
v_mfma_f32_16x16x32_bf16 v[204:207], a[160:163], a[100:103], v[204:207]
s_barrier
v_mfma_f32_16x16x32_bf16 v[212:215], a[160:163], a[104:107], v[212:215]
ds_read_b128 a[112:115], v9 offset:0
v_mfma_f32_16x16x32_bf16 v[220:223], a[160:163], a[108:111], v[220:223]
s_add_u32 m0, s70, 49152
s_add_u32 s64, s68, 49152
s_waitcnt vmcnt(6)
v_mfma_f32_16x16x32_bf16 v[72:75], a[164:167], a[108:111], v[72:75]
buffer_load_dwordx4 v4, s[24:27], s64 offen offset:0 sc1 lds
v_mfma_f32_16x16x32_bf16 v[228:231], a[164:167], a[104:107], v[228:231]
ds_read_b64_tr_b16 a[176:177], v11 offset:0
ds_read_b64_tr_b16 a[178:179], v11 offset:512
v_mfma_f32_16x16x32_bf16 v[80:83], a[164:167], a[100:103], v[80:83]
ds_read_b128 a[116:119], v9 offset:2048
v_mfma_f32_16x16x32_bf16 v[236:239], a[164:167], a[96:99], v[236:239]
ds_read_b64_tr_b16 a[180:181], v12 offset:0
ds_read_b64_tr_b16 a[182:183], v12 offset:512
v_mfma_f32_16x16x32_bf16 v[244:247], a[168:171], a[96:99], v[244:247]
s_add_u32 s53, s87, 2363392
ds_read_b128 a[120:123], v9 offset:4096
v_mfma_f32_16x16x32_bf16 v[252:255], a[168:171], a[100:103], v[252:255]
buffer_store_dwordx4 a[16:19], v4, s[24:27], s53 offen offset:0 sc1
v_mfma_f32_16x16x32_bf16 v[88:91], a[168:171], a[104:107], v[88:91]
ds_read_b64_tr_b16 a[184:185], v13 offset:0
ds_read_b64_tr_b16 a[186:187], v13 offset:512
v_mfma_f32_16x16x32_bf16 v[160:163], a[168:171], a[108:111], v[160:163]
ds_read_b64_tr_b16 a[192:193], v23 offset:0
ds_read_b64_tr_b16 a[194:195], v23 offset:2048
v_mfma_f32_16x16x32_bf16 v[168:171], a[172:175], a[108:111], v[168:171]
ds_read_b128 a[124:127], v9 offset:6144
v_mfma_f32_16x16x32_bf16 v[176:179], a[172:175], a[104:107], v[176:179]
ds_read_b64_tr_b16 a[196:197], v23 offset:32
ds_read_b64_tr_b16 a[198:199], v23 offset:2080
v_mfma_f32_16x16x32_bf16 v[184:187], a[172:175], a[100:103], v[184:187]
buffer_load_dwordx4 v4, s[24:27], s64 offen offset:1024 sc1 lds
v_mfma_f32_16x16x32_bf16 v[248:251], a[172:175], a[96:99], v[248:251]
ds_read_b64_tr_b16 a[188:189], v14 offset:0
ds_read_b64_tr_b16 a[190:191], v14 offset:512
v_mfma_f32_16x16x32_bf16 v[240:243], a[80:83], a[96:99], v[240:243]
ds_read_b128 a[72:75], v4 offset:8192
v_mfma_f32_16x16x32_bf16 v[232:235], a[80:83], a[100:103], v[232:235]
ds_read_b64_tr_b16 a[200:201], v23 offset:64
ds_read_b64_tr_b16 a[202:203], v23 offset:2112
v_mfma_f32_16x16x32_bf16 v[224:227], a[80:83], a[104:107], v[224:227]
ds_read_b64_tr_b16 a[64:65], v11 offset:4096
ds_read_b64_tr_b16 a[66:67], v11 offset:4608
v_mfma_f32_16x16x32_bf16 v[192:195], a[80:83], a[108:111], v[192:195]
ds_read_b64_tr_b16 a[204:205], v23 offset:96
ds_read_b64_tr_b16 a[206:207], v23 offset:2144
v_mfma_f32_16x16x32_bf16 v[152:155], a[144:147], a[108:111], v[152:155]
ds_read_b128 a[136:139], v4 offset:9216
v_mfma_f32_16x16x32_bf16 v[200:203], a[144:147], a[104:107], v[200:203]
ds_read_b64_tr_b16 a[208:209], v27 offset:4096
ds_read_b64_tr_b16 a[210:211], v27 offset:4608
v_mfma_f32_16x16x32_bf16 v[208:211], a[144:147], a[100:103], v[208:211]
ds_read_b64_tr_b16 a[128:129], v12 offset:4096
ds_read_b64_tr_b16 a[130:131], v12 offset:4608
v_mfma_f32_16x16x32_bf16 v[36:39], a[144:147], a[96:99], v[36:39]
ds_read_b64_tr_b16 a[212:213], v27 offset:5120
ds_read_b64_tr_b16 a[214:215], v27 offset:5632
v_mfma_f32_16x16x32_bf16 v[44:47], a[84:87], a[96:99], v[44:47]
ds_read_b128 a[76:79], v4 offset:10240
v_readlane_b32 s81, v26, 0
v_mfma_f32_16x16x32_bf16 v[32:35], a[84:87], a[100:103], v[32:35]
buffer_load_dwordx4 v4, s[24:27], s64 offen offset:2048 sc1 lds
v_mfma_f32_16x16x32_bf16 v[52:55], a[84:87], a[104:107], v[52:55]
ds_read_b64_tr_b16 a[68:69], v13 offset:4096
ds_read_b64_tr_b16 a[70:71], v13 offset:4608
v_mfma_f32_16x16x32_bf16 v[60:63], a[84:87], a[108:111], v[60:63]
v_readlane_b32 s82, v26, 1
v_readlane_b32 s71, v26, 2
v_mfma_f32_16x16x32_bf16 v[68:71], a[148:151], a[108:111], v[68:71]
ds_read_b128 a[140:143], v4 offset:11264
v_readlane_b32 s72, v26, 3
v_mfma_f32_16x16x32_bf16 v[76:79], a[148:151], a[104:107], v[76:79]
v_readlane_b32 s74, v26, 4
v_readlane_b32 s75, v26, 5
v_mfma_f32_16x16x32_bf16 v[84:87], a[148:151], a[100:103], v[84:87]
ds_read_b64_tr_b16 a[132:133], v14 offset:4096
ds_read_b64_tr_b16 a[134:135], v14 offset:4608
v_mfma_f32_16x16x32_bf16 v[92:95], a[148:151], a[96:99], v[92:95]
v_mfma_f32_16x16x32_bf16 v[100:103], a[88:91], a[96:99], v[100:103]
v_mfma_f32_16x16x32_bf16 v[108:111], a[88:91], a[100:103], v[108:111]
v_mfma_f32_16x16x32_bf16 v[116:119], a[88:91], a[104:107], v[116:119]
v_mfma_f32_16x16x32_bf16 v[40:43], a[88:91], a[108:111], v[40:43]
buffer_load_dwordx4 v4, s[24:27], s64 offen offset:3072 sc1 lds
v_mfma_f32_16x16x32_bf16 v[124:127], a[152:155], a[108:111], v[124:127]
s_add_u32 s53, s87, 2363392
v_mfma_f32_16x16x32_bf16 v[132:135], a[152:155], a[104:107], v[132:135]
buffer_store_dwordx4 a[24:27], v4, s[24:27], s53 offen offset:1024 sc1
v_mfma_f32_16x16x32_bf16 v[140:143], a[152:155], a[100:103], v[140:143]
v_mfma_f32_16x16x32_bf16 v[148:151], a[152:155], a[96:99], v[148:151]
v_mfma_f32_16x16x32_bf16 v[156:159], a[92:95], a[96:99], v[156:159]
v_mfma_f32_16x16x32_bf16 v[48:51], a[92:95], a[100:103], v[48:51]
v_mfma_f32_16x16x32_bf16 v[164:167], a[92:95], a[104:107], v[164:167]
v_mfma_f32_16x16x32_bf16 v[172:175], a[92:95], a[108:111], v[172:175]
v_mfma_f32_16x16x32_bf16 v[180:183], a[156:159], a[108:111], v[180:183]
v_mfma_f32_16x16x32_bf16 v[188:191], a[156:159], a[104:107], v[188:191]
v_mfma_f32_16x16x32_bf16 v[196:199], a[156:159], a[100:103], v[196:199]
v_mfma_f32_16x16x32_bf16 v[56:59], a[156:159], a[96:99], v[56:59]
s_waitcnt lgkmcnt(0)
v_mfma_f32_16x16x32_bf16 v[64:67], a[176:179], a[112:115], v[64:67]
s_waitcnt vmcnt(19)
v_mfma_f32_16x16x32_bf16 v[236:239], a[180:183], a[112:115], v[236:239]
s_barrier
v_mfma_f32_16x16x32_bf16 v[244:247], a[184:187], a[112:115], v[244:247]
ds_read_b128 a[96:99], v10 offset:0
ds_read_b128 a[100:103], v10 offset:2048
v_mfma_f32_16x16x32_bf16 v[248:251], a[188:191], a[112:115], v[248:251]
ds_read_b128 a[104:107], v10 offset:4096
ds_read_b128 a[108:111], v10 offset:6144
v_mfma_f32_16x16x32_bf16 v[240:243], a[64:67], a[112:115], v[240:243]
ds_read_b64_tr_b16 a[160:161], v11 offset:16384
ds_read_b64_tr_b16 a[162:163], v11 offset:16896
v_mfma_f32_16x16x32_bf16 v[36:39], a[128:131], a[112:115], v[36:39]
ds_read_b64_tr_b16 a[164:165], v12 offset:16384
ds_read_b64_tr_b16 a[166:167], v12 offset:16896
v_mfma_f32_16x16x32_bf16 v[44:47], a[68:71], a[112:115], v[44:47]
ds_read_b64_tr_b16 a[168:169], v13 offset:16384
ds_read_b64_tr_b16 a[170:171], v13 offset:16896
v_mfma_f32_16x16x32_bf16 v[92:95], a[132:135], a[112:115], v[92:95]
ds_read_b64_tr_b16 a[172:173], v14 offset:16384
ds_read_b64_tr_b16 a[174:175], v14 offset:16896
v_mfma_f32_16x16x32_bf16 v[204:207], a[176:179], a[116:119], v[204:207]
ds_read_b64_tr_b16 a[80:81], v11 offset:20480
ds_read_b64_tr_b16 a[82:83], v11 offset:20992
v_mfma_f32_16x16x32_bf16 v[80:83], a[180:183], a[116:119], v[80:83]
ds_read_b64_tr_b16 a[144:145], v12 offset:20480
ds_read_b64_tr_b16 a[146:147], v12 offset:20992
v_mfma_f32_16x16x32_bf16 v[252:255], a[184:187], a[116:119], v[252:255]
ds_read_b64_tr_b16 a[84:85], v13 offset:20480
ds_read_b64_tr_b16 a[86:87], v13 offset:20992
v_mfma_f32_16x16x32_bf16 v[184:187], a[188:191], a[116:119], v[184:187]
ds_read_b64_tr_b16 a[148:149], v14 offset:20480
ds_read_b64_tr_b16 a[150:151], v14 offset:20992
v_mfma_f32_16x16x32_bf16 v[232:235], a[64:67], a[116:119], v[232:235]
ds_read_b128 a[88:91], v4 offset:24576
ds_read_b128 a[152:155], v4 offset:25600
v_mfma_f32_16x16x32_bf16 v[208:211], a[128:131], a[116:119], v[208:211]
ds_read_b128 a[92:95], v4 offset:26624
ds_read_b128 a[156:159], v4 offset:27648
v_mfma_f32_16x16x32_bf16 v[32:35], a[68:71], a[116:119], v[32:35]
buffer_store_dwordx4 a[192:195], v4, s[24:27], s81 offen sc1
v_mfma_f32_16x16x32_bf16 v[84:87], a[132:135], a[116:119], v[84:87]
s_add_u32 m0, s70, 65536
s_add_u32 s64, s68, 98304
v_mfma_f32_16x16x32_bf16 v[212:215], a[176:179], a[120:123], v[212:215]
buffer_load_dwordx4 v4, s[24:27], s64 offen offset:0 sc1 lds
v_mfma_f32_16x16x32_bf16 v[228:231], a[180:183], a[120:123], v[228:231]
v_mfma_f32_16x16x32_bf16 v[88:91], a[184:187], a[120:123], v[88:91]
v_mfma_f32_16x16x32_bf16 v[176:179], a[188:191], a[120:123], v[176:179]
buffer_store_dwordx4 a[196:199], v4, s[24:27], s82 offen sc1
v_mfma_f32_16x16x32_bf16 v[224:227], a[64:67], a[120:123], v[224:227]
v_mfma_f32_16x16x32_bf16 v[200:203], a[128:131], a[120:123], v[200:203]
v_mfma_f32_16x16x32_bf16 v[52:55], a[68:71], a[120:123], v[52:55]
v_mfma_f32_16x16x32_bf16 v[76:79], a[132:135], a[120:123], v[76:79]
s_waitcnt lgkmcnt(0)
v_mfma_f32_16x16x32_bf16 v[64:67], a[160:163], a[96:99], v[64:67]
buffer_load_dwordx4 v4, s[24:27], s64 offen offset:1024 sc1 lds
v_mfma_f32_16x16x32_bf16 v[236:239], a[164:167], a[96:99], v[236:239]
buffer_store_dwordx4 a[200:203], v4, s[24:27], s71 offen sc1
v_mfma_f32_16x16x32_bf16 v[244:247], a[168:171], a[96:99], v[244:247]
v_mfma_f32_16x16x32_bf16 v[248:251], a[172:175], a[96:99], v[248:251]
v_mfma_f32_16x16x32_bf16 v[240:243], a[80:83], a[96:99], v[240:243]
v_mfma_f32_16x16x32_bf16 v[36:39], a[144:147], a[96:99], v[36:39]
v_mfma_f32_16x16x32_bf16 v[44:47], a[84:87], a[96:99], v[44:47]
buffer_store_dwordx4 a[204:207], v4, s[24:27], s72 offen sc1
v_mfma_f32_16x16x32_bf16 v[92:95], a[148:151], a[96:99], v[92:95]
buffer_load_dwordx4 v4, s[24:27], s64 offen offset:2048 sc1 lds
v_mfma_f32_16x16x32_bf16 v[204:207], a[160:163], a[100:103], v[204:207]
v_cvt_pk_bf16_f32 v64, v64, v65
v_cvt_pk_bf16_f32 v65, v66, v67
v_mfma_f32_16x16x32_bf16 v[80:83], a[164:167], a[100:103], v[80:83]
v_cvt_pk_bf16_f32 v66, v236, v237
v_cvt_pk_bf16_f32 v67, v238, v239
v_mfma_f32_16x16x32_bf16 v[252:255], a[168:171], a[100:103], v[252:255]
v_cvt_pk_bf16_f32 v244, v244, v245
v_cvt_pk_bf16_f32 v245, v246, v247
v_mfma_f32_16x16x32_bf16 v[184:187], a[172:175], a[100:103], v[184:187]
buffer_store_dwordx4 a[208:211], v4, s[24:27], s74 offen sc1
v_mfma_f32_16x16x32_bf16 v[232:235], a[80:83], a[100:103], v[232:235]
v_cvt_pk_bf16_f32 v246, v248, v249
v_cvt_pk_bf16_f32 v247, v250, v251
v_mfma_f32_16x16x32_bf16 v[208:211], a[144:147], a[100:103], v[208:211]
v_cvt_pk_bf16_f32 v240, v240, v241
v_cvt_pk_bf16_f32 v241, v242, v243
v_mfma_f32_16x16x32_bf16 v[32:35], a[84:87], a[100:103], v[32:35]
buffer_load_dwordx4 v4, s[24:27], s64 offen offset:3072 sc1 lds
v_mfma_f32_16x16x32_bf16 v[84:87], a[148:151], a[100:103], v[84:87]
v_cvt_pk_bf16_f32 v242, v36, v37
v_cvt_pk_bf16_f32 v243, v38, v39
v_mfma_f32_16x16x32_bf16 v[212:215], a[160:163], a[104:107], v[212:215]
buffer_store_dwordx4 a[212:215], v4, s[24:27], s75 offen sc1
v_mfma_f32_16x16x32_bf16 v[228:231], a[164:167], a[104:107], v[228:231]
v_cvt_pk_bf16_f32 v44, v44, v45
v_cvt_pk_bf16_f32 v45, v46, v47
v_mfma_f32_16x16x32_bf16 v[88:91], a[168:171], a[104:107], v[88:91]
v_cvt_pk_bf16_f32 v46, v92, v93
v_cvt_pk_bf16_f32 v47, v94, v95
v_mfma_f32_16x16x32_bf16 v[176:179], a[172:175], a[104:107], v[176:179]
v_cvt_pk_bf16_f32 v204, v204, v205
v_cvt_pk_bf16_f32 v205, v206, v207
v_mfma_f32_16x16x32_bf16 v[224:227], a[80:83], a[104:107], v[224:227]
v_cvt_pk_bf16_f32 v206, v80, v81
v_cvt_pk_bf16_f32 v207, v82, v83
v_mfma_f32_16x16x32_bf16 v[200:203], a[144:147], a[104:107], v[200:203]
v_cvt_pk_bf16_f32 v252, v252, v253
v_cvt_pk_bf16_f32 v253, v254, v255
v_mfma_f32_16x16x32_bf16 v[52:55], a[84:87], a[104:107], v[52:55]
v_cvt_pk_bf16_f32 v254, v184, v185
v_cvt_pk_bf16_f32 v255, v186, v187
v_mfma_f32_16x16x32_bf16 v[76:79], a[148:151], a[104:107], v[76:79]
v_cvt_pk_bf16_f32 v232, v232, v233
v_cvt_pk_bf16_f32 v233, v234, v235
v_mfma_f32_16x16x32_bf16 v[220:223], a[176:179], a[124:127], v[220:223]
s_waitcnt vmcnt(16)
v_cvt_pk_bf16_f32 v234, v208, v209
v_cvt_pk_bf16_f32 v235, v210, v211
v_mfma_f32_16x16x32_bf16 v[220:223], a[160:163], a[108:111], v[220:223]
s_barrier
v_mfma_f32_16x16x32_bf16 v[72:75], a[180:183], a[124:127], v[72:75]
v_cvt_pk_bf16_f32 v32, v32, v33
v_cvt_pk_bf16_f32 v33, v34, v35
v_mfma_f32_16x16x32_bf16 v[72:75], a[164:167], a[108:111], v[72:75]
s_add_u32 m0, s70, 81920
s_add_u32 s64, s68, 147456
v_cvt_pk_bf16_f32 v34, v84, v85
v_mfma_f32_16x16x32_bf16 v[160:163], a[184:187], a[124:127], v[160:163]
buffer_load_dwordx4 v4, s[24:27], s64 offen offset:0 sc1 lds
v_mfma_f32_16x16x32_bf16 v[160:163], a[168:171], a[108:111], v[160:163]
v_cvt_pk_bf16_f32 v35, v86, v87
v_cvt_pk_bf16_f32 v212, v212, v213
v_mfma_f32_16x16x32_bf16 v[168:171], a[188:191], a[124:127], v[168:171]
v_cvt_pk_bf16_f32 v213, v214, v215
v_cvt_pk_bf16_f32 v214, v228, v229
v_mfma_f32_16x16x32_bf16 v[168:171], a[172:175], a[108:111], v[168:171]
v_cvt_pk_bf16_f32 v215, v230, v231
v_cvt_pk_bf16_f32 v88, v88, v89
v_mfma_f32_16x16x32_bf16 v[192:195], a[64:67], a[124:127], v[192:195]
v_cvt_pk_bf16_f32 v89, v90, v91
v_cvt_pk_bf16_f32 v90, v176, v177
v_mfma_f32_16x16x32_bf16 v[192:195], a[80:83], a[108:111], v[192:195]
v_cvt_pk_bf16_f32 v91, v178, v179
v_cvt_pk_bf16_f32 v224, v224, v225
v_mfma_f32_16x16x32_bf16 v[152:155], a[128:131], a[124:127], v[152:155]
v_cvt_pk_bf16_f32 v225, v226, v227
v_cvt_pk_bf16_f32 v226, v200, v201
v_mfma_f32_16x16x32_bf16 v[152:155], a[144:147], a[108:111], v[152:155]
v_cvt_pk_bf16_f32 v227, v202, v203
v_cvt_pk_bf16_f32 v52, v52, v53
v_mfma_f32_16x16x32_bf16 v[60:63], a[68:71], a[124:127], v[60:63]
v_cvt_pk_bf16_f32 v53, v54, v55
v_cvt_pk_bf16_f32 v54, v76, v77
v_mfma_f32_16x16x32_bf16 v[60:63], a[84:87], a[108:111], v[60:63]
v_cvt_pk_bf16_f32 v55, v78, v79
v_cvt_pk_bf16_f32 v220, v220, v221
v_mfma_f32_16x16x32_bf16 v[68:71], a[132:135], a[124:127], v[68:71]
buffer_load_dwordx4 v4, s[24:27], s64 offen offset:1024 sc1 lds
v_mfma_f32_16x16x32_bf16 v[68:71], a[148:151], a[108:111], v[68:71]
v_cvt_pk_bf16_f32 v221, v222, v223
v_cvt_pk_bf16_f32 v222, v72, v73
v_mfma_f32_16x16x32_bf16 v[100:103], a[72:75], a[112:115], v[100:103]
v_cvt_pk_bf16_f32 v223, v74, v75
v_cvt_pk_bf16_f32 v160, v160, v161
v_mfma_f32_16x16x32_bf16 v[100:103], a[88:91], a[96:99], v[100:103]
v_cvt_pk_bf16_f32 v161, v162, v163
v_cvt_pk_bf16_f32 v162, v168, v169
v_mfma_f32_16x16x32_bf16 v[148:151], a[136:139], a[112:115], v[148:151]
v_cvt_pk_bf16_f32 v163, v170, v171
v_cvt_pk_bf16_f32 v192, v192, v193
v_mfma_f32_16x16x32_bf16 v[148:151], a[152:155], a[96:99], v[148:151]
v_cvt_pk_bf16_f32 v193, v194, v195
v_cvt_pk_bf16_f32 v194, v152, v153
v_mfma_f32_16x16x32_bf16 v[156:159], a[76:79], a[112:115], v[156:159]
ds_read_b128 a[192:195], v4 offset:32768
v_cvt_pk_bf16_f32 v195, v154, v155
v_mfma_f32_16x16x32_bf16 v[156:159], a[92:95], a[96:99], v[156:159]
ds_read_b128 a[196:199], v4 offset:33792
ds_read_b128 a[200:203], v4 offset:34816
v_mfma_f32_16x16x32_bf16 v[56:59], a[140:143], a[112:115], v[56:59]
v_cvt_pk_bf16_f32 v60, v60, v61
v_cvt_pk_bf16_f32 v61, v62, v63
v_mfma_f32_16x16x32_bf16 v[56:59], a[156:159], a[96:99], v[56:59]
v_cvt_pk_bf16_f32 v62, v68, v69
v_cvt_pk_bf16_f32 v63, v70, v71
v_mfma_f32_16x16x32_bf16 v[108:111], a[72:75], a[116:119], v[108:111]
ds_read_b128 a[204:207], v4 offset:35840
ds_read_b128 a[208:211], v4 offset:36864
v_mfma_f32_16x16x32_bf16 v[108:111], a[88:91], a[100:103], v[108:111]
buffer_load_dwordx4 v4, s[24:27], s64 offen offset:2048 sc1 lds
v_mfma_f32_16x16x32_bf16 v[140:143], a[136:139], a[116:119], v[140:143]
ds_read_b128 a[212:215], v4 offset:37888
ds_read_b128 a[216:219], v4 offset:38912
v_mfma_f32_16x16x32_bf16 v[140:143], a[152:155], a[100:103], v[140:143]
ds_read_b128 a[220:223], v4 offset:39936
v_mfma_f32_16x16x32_bf16 v[48:51], a[76:79], a[116:119], v[48:51]
v_mfma_f32_16x16x32_bf16 v[48:51], a[92:95], a[100:103], v[48:51]
v_mfma_f32_16x16x32_bf16 v[196:199], a[140:143], a[116:119], v[196:199]
ds_bpermute_b32 v8, v17, v103
v_cvt_pk_bf16_f32 v100, v100, v101
v_mfma_f32_16x16x32_bf16 v[196:199], a[156:159], a[100:103], v[196:199]
v_cvt_pk_bf16_f32 v101, v102, v103
v_cvt_pk_bf16_f32 v102, v148, v149
v_mfma_f32_16x16x32_bf16 v[116:119], a[72:75], a[120:123], v[116:119]
v_cvt_pk_bf16_f32 v103, v150, v151
v_mfma_f32_16x16x32_bf16 v[116:119], a[88:91], a[104:107], v[116:119]
buffer_store_dwordx4 v[100:103], v18, s[24:27], s54 offen offset:0 sc1
v_mfma_f32_16x16x32_bf16 v[132:135], a[136:139], a[120:123], v[132:135]
v_cvt_pk_bf16_f32 v156, v156, v157
v_cvt_pk_bf16_f32 v157, v158, v159
v_mfma_f32_16x16x32_bf16 v[132:135], a[152:155], a[104:107], v[132:135]
buffer_load_dwordx4 v4, s[24:27], s64 offen offset:3072 sc1 lds
v_mfma_f32_16x16x32_bf16 v[164:167], a[76:79], a[120:123], v[164:167]
v_cvt_pk_bf16_f32 v158, v56, v57
v_cvt_pk_bf16_f32 v159, v58, v59
v_mfma_f32_16x16x32_bf16 v[164:167], a[92:95], a[104:107], v[164:167]
buffer_store_dwordx4 v[156:159], v19, s[24:27], s54 offen offset:0 sc1
v_mfma_f32_16x16x32_bf16 v[188:191], a[140:143], a[120:123], v[188:191]
ds_bpermute_b32 v9, v17, v111
v_cvt_pk_bf16_f32 v108, v108, v109
v_mfma_f32_16x16x32_bf16 v[188:191], a[156:159], a[104:107], v[188:191]
v_cvt_pk_bf16_f32 v109, v110, v111
v_cvt_pk_bf16_f32 v110, v140, v141
v_mfma_f32_16x16x32_bf16 v[40:43], a[72:75], a[124:127], v[40:43]
v_cvt_pk_bf16_f32 v111, v142, v143
v_mfma_f32_16x16x32_bf16 v[40:43], a[88:91], a[108:111], v[40:43]
buffer_store_dwordx4 v[108:111], v18, s[24:27], s54 offen offset:256 sc1
v_mfma_f32_16x16x32_bf16 v[124:127], a[136:139], a[124:127], v[124:127]
v_cvt_pk_bf16_f32 v48, v48, v49
v_cvt_pk_bf16_f32 v49, v50, v51
v_mfma_f32_16x16x32_bf16 v[124:127], a[152:155], a[108:111], v[124:127]
v_cvt_pk_bf16_f32 v50, v196, v197
v_cvt_pk_bf16_f32 v51, v198, v199
v_mfma_f32_16x16x32_bf16 v[172:175], a[76:79], a[124:127], v[172:175]
buffer_store_dwordx4 v[48:51], v19, s[24:27], s54 offen offset:256 sc1
v_mfma_f32_16x16x32_bf16 v[172:175], a[92:95], a[108:111], v[172:175]
v_mfma_f32_16x16x32_bf16 v[180:183], a[140:143], a[124:127], v[180:183]
ds_bpermute_b32 v10, v17, v119
v_cvt_pk_bf16_f32 v116, v116, v117
v_mfma_f32_16x16x32_bf16 v[180:183], a[156:159], a[108:111], v[180:183]
s_waitcnt lgkmcnt(0)
v_cvt_pk_bf16_f32 v117, v118, v119
v_cvt_pk_bf16_f32 v118, v132, v133
v_mfma_f32_16x16x32_bf16 v[236:239], a[192:195], v[64:67], v[216:219]
v_cvt_pk_bf16_f32 v119, v134, v135
v_mfma_f32_16x16x32_bf16 v[236:239], a[196:199], v[244:247], v[236:239]
buffer_store_dwordx4 v[116:119], v18, s[24:27], s55 offen offset:0 sc1
v_mfma_f32_16x16x32_bf16 v[236:239], a[200:203], v[240:243], v[236:239]
v_cvt_pk_bf16_f32 v164, v164, v165
v_cvt_pk_bf16_f32 v165, v166, v167
v_mfma_f32_16x16x32_bf16 v[236:239], a[204:207], v[44:47], v[236:239]
v_cvt_pk_bf16_f32 v166, v188, v189
v_cvt_pk_bf16_f32 v167, v190, v191
v_mfma_f32_16x16x32_bf16 v[248:251], a[192:195], v[204:207], v[96:99]
buffer_store_dwordx4 v[164:167], v19, s[24:27], s55 offen offset:0 sc1
v_mfma_f32_16x16x32_bf16 v[248:251], a[196:199], v[252:255], v[248:251]
v_mfma_f32_16x16x32_bf16 v[248:251], a[200:203], v[232:235], v[248:251]
ds_bpermute_b32 v11, v17, v43
v_cvt_pk_bf16_f32 v40, v40, v41
v_mfma_f32_16x16x32_bf16 v[248:251], a[204:207], v[32:35], v[248:251]
v_cvt_pk_bf16_f32 v41, v42, v43
v_cvt_pk_bf16_f32 v42, v124, v125
v_mfma_f32_16x16x32_bf16 v[36:39], a[208:211], v[64:67], v[104:107]
v_cvt_pk_bf16_f32 v43, v126, v127
v_mfma_f32_16x16x32_bf16 v[36:39], a[212:215], v[244:247], v[36:39]
buffer_store_dwordx4 v[40:43], v18, s[24:27], s55 offen offset:256 sc1
v_mfma_f32_16x16x32_bf16 v[36:39], a[216:219], v[240:243], v[36:39]
v_cvt_pk_bf16_f32 v172, v172, v173
v_cvt_pk_bf16_f32 v173, v174, v175
v_mfma_f32_16x16x32_bf16 v[36:39], a[220:223], v[44:47], v[36:39]
v_cvt_pk_bf16_f32 v174, v180, v181
v_cvt_pk_bf16_f32 v175, v182, v183
v_mfma_f32_16x16x32_bf16 v[92:95], a[208:211], v[204:207], v[112:115]
buffer_store_dwordx4 v[172:175], v19, s[24:27], s55 offen offset:256 sc1
v_mfma_f32_16x16x32_bf16 v[92:95], a[212:215], v[252:255], v[92:95]
v_mfma_f32_16x16x32_bf16 v[92:95], a[216:219], v[232:235], v[92:95]
v_mfma_f32_16x16x32_bf16 v[92:95], a[220:223], v[32:35], v[92:95]
s_waitcnt vmcnt(23)
v_mfma_f32_16x16x32_bf16 v[80:83], a[192:195], v[212:215], v[120:123]
s_barrier
v_mfma_f32_16x16x32_bf16 v[80:83], a[196:199], v[88:91], v[80:83]
v_mfma_f32_16x16x32_bf16 v[80:83], a[200:203], v[224:227], v[80:83]
v_mfma_f32_16x16x32_bf16 v[80:83], a[204:207], v[52:55], v[80:83]
v_mfma_f32_16x16x32_bf16 v[184:187], a[192:195], v[220:223], v[128:131]
v_mfma_f32_16x16x32_bf16 v[184:187], a[196:199], v[160:163], v[184:187]
v_mfma_f32_16x16x32_bf16 v[184:187], a[200:203], v[192:195], v[184:187]
v_mfma_f32_16x16x32_bf16 v[184:187], a[204:207], v[60:63], v[184:187]
v_mfma_f32_16x16x32_bf16 v[208:211], a[208:211], v[212:215], v[136:139]
v_mfma_f32_16x16x32_bf16 v[208:211], a[212:215], v[88:91], v[208:211]
v_mfma_f32_16x16x32_bf16 v[208:211], a[216:219], v[224:227], v[208:211]
v_mfma_f32_16x16x32_bf16 v[208:211], a[220:223], v[52:55], v[208:211]
v_mfma_f32_16x16x32_bf16 v[84:87], a[208:211], v[220:223], v[144:147]
v_mfma_f32_16x16x32_bf16 v[84:87], a[212:215], v[160:163], v[84:87]
v_mfma_f32_16x16x32_bf16 v[84:87], a[216:219], v[192:195], v[84:87]
v_mfma_f32_16x16x32_bf16 v[84:87], a[220:223], v[60:63], v[84:87]
ds_read_b128 a[64:67], v4 offset:57344
ds_read_b128 a[68:71], v4 offset:58368
ds_read_b128 a[72:75], v4 offset:59392
ds_read_b128 a[76:79], v4 offset:60416
ds_read_b128 a[80:83], v4 offset:61440
ds_read_b128 a[84:87], v4 offset:62464
ds_read_b128 a[88:91], v4 offset:63488
ds_read_b128 a[92:95], v4 offset:64512
s_add_u32 m0, s70, 98304
s_add_u32 s64, s68, 196608
buffer_load_dwordx4 v4, s[24:27], s64 offen offset:0 sc1 lds
v_max3_f32 v24, v236, v237, v238
v_max3_f32 v25, v239, v36, v37
v_max3_f32 v26, v248, v249, v250
v_max3_f32 v27, v251, v92, v93
v_max3_f32 v24, v24, v38, v39
v_max_f32 v24, v24, v25
v_max3_f32 v26, v26, v94, v95
v_max_f32 v26, v26, v27
buffer_load_dwordx4 v4, s[24:27], s64 offen offset:1024 sc1 lds
v_mov_b32 v25, v24
v_mov_b32 v27, v26
s_nop 1
v_permlane32_swap_b32 v25, v24
v_permlane32_swap_b32 v27, v26
s_nop 0
v_max_f32 v24, v24, v25
v_max_f32 v26, v26, v27
buffer_load_dwordx4 v4, s[24:27], s64 offen offset:2048 sc1 lds
v_mov_b32 v25, v24
v_mov_b32 v27, v26
s_nop 1
v_permlane16_swap_b32 v25, v24
v_permlane16_swap_b32 v27, v26
s_nop 0
v_max_f32 v24, v24, v25
v_max_f32 v26, v26, v27
buffer_load_dwordx4 v4, s[24:27], s64 offen offset:3072 sc1 lds
v_sub_f32 v236, v236, v24
v_sub_f32 v237, v237, v24
v_sub_f32 v238, v238, v24
v_sub_f32 v239, v239, v24
v_sub_f32 v248, v248, v26
v_sub_f32 v249, v249, v26
v_sub_f32 v250, v250, v26
v_sub_f32 v251, v251, v26
s_add_u32 m0, s70, 114688
s_add_u32 s64, s68, 245760
buffer_load_dwordx4 v4, s[24:27], s64 offen offset:0 sc1 lds
v_sub_f32 v36, v36, v24
v_sub_f32 v37, v37, v24
v_sub_f32 v38, v38, v24
v_sub_f32 v39, v39, v24
v_sub_f32 v92, v92, v26
v_sub_f32 v93, v93, v26
v_sub_f32 v94, v94, v26
v_sub_f32 v95, v95, v26
buffer_load_dwordx4 v4, s[24:27], s64 offen offset:1024 sc1 lds
v_sub_f32 v216, v216, v24
v_sub_f32 v217, v217, v24
v_sub_f32 v218, v218, v24
v_sub_f32 v219, v219, v24
v_sub_f32 v96, v96, v26
v_sub_f32 v97, v97, v26
v_sub_f32 v98, v98, v26
v_sub_f32 v99, v99, v26
buffer_load_dwordx4 v4, s[24:27], s64 offen offset:2048 sc1 lds
v_sub_f32 v104, v104, v24
v_sub_f32 v105, v105, v24
v_sub_f32 v106, v106, v24
v_sub_f32 v107, v107, v24
v_sub_f32 v112, v112, v26
v_sub_f32 v113, v113, v26
v_sub_f32 v114, v114, v26
v_sub_f32 v115, v115, v26
buffer_load_dwordx4 v4, s[24:27], s64 offen offset:3072 sc1 lds
v_exp_f32 v236, v236
v_exp_f32 v237, v237
v_exp_f32 v238, v238
v_exp_f32 v239, v239
v_cvt_pk_bf16_f32 v228, v236, v237
v_exp_f32 v248, v248
v_exp_f32 v249, v249
v_cvt_pk_bf16_f32 v229, v238, v239
s_add_u32 m0, s70, 131072
s_add_u32 s64, s68, 294912
s_cmp_ge_u32 s3, 1
s_cselect_b32 s64, s64, 2147418112
buffer_load_dwordx4 v4, s[24:27], s64 offen offset:0 sc1 lds
v_exp_f32 v250, v250
v_exp_f32 v251, v251
v_cvt_pk_bf16_f32 v176, v248, v249
v_exp_f32 v36, v36
v_exp_f32 v37, v37
v_cvt_pk_bf16_f32 v177, v250, v251
v_exp_f32 v38, v38
v_exp_f32 v39, v39
buffer_load_dwordx4 v4, s[24:27], s64 offen offset:1024 sc1 lds
v_cvt_pk_bf16_f32 v230, v36, v37
v_exp_f32 v92, v92
v_exp_f32 v93, v93
v_cvt_pk_bf16_f32 v231, v38, v39
v_exp_f32 v94, v94
v_exp_f32 v95, v95
v_cvt_pk_bf16_f32 v178, v92, v93
v_max3_f32 v24, v80, v81, v82
buffer_load_dwordx4 v4, s[24:27], s64 offen offset:2048 sc1 lds
v_cvt_pk_bf16_f32 v179, v94, v95
v_max3_f32 v25, v83, v208, v209
v_max3_f32 v26, v184, v185, v186
v_max3_f32 v27, v187, v84, v85
v_max3_f32 v24, v24, v210, v211
v_max_f32 v24, v24, v25
v_max3_f32 v26, v26, v86, v87
v_max_f32 v26, v26, v27
buffer_load_dwordx4 v4, s[24:27], s64 offen offset:3072 sc1 lds
v_mov_b32 v25, v24
v_mov_b32 v27, v26
s_nop 1
v_permlane32_swap_b32 v25, v24
v_permlane32_swap_b32 v27, v26
s_nop 0
v_max_f32 v24, v24, v25
v_max_f32 v26, v26, v27
s_add_u32 m0, s70, 147456
s_add_u32 s64, s68, 344064
s_cmp_ge_u32 s3, 2
s_cselect_b32 s64, s64, 2147418112
buffer_load_dwordx4 v4, s[24:27], s64 offen offset:0 sc1 lds
v_mov_b32 v25, v24
v_mov_b32 v27, v26
s_nop 1
v_permlane16_swap_b32 v25, v24
v_permlane16_swap_b32 v27, v26
s_nop 0
v_max_f32 v24, v24, v25
v_max_f32 v26, v26, v27
buffer_load_dwordx4 v4, s[24:27], s64 offen offset:1024 sc1 lds
v_sub_f32 v80, v80, v24
v_sub_f32 v81, v81, v24
v_sub_f32 v82, v82, v24
v_sub_f32 v83, v83, v24
v_sub_f32 v184, v184, v26
v_sub_f32 v185, v185, v26
v_sub_f32 v186, v186, v26
v_sub_f32 v187, v187, v26
buffer_load_dwordx4 v4, s[24:27], s64 offen offset:2048 sc1 lds
v_sub_f32 v208, v208, v24
v_sub_f32 v209, v209, v24
v_sub_f32 v210, v210, v24
v_sub_f32 v211, v211, v24
v_sub_f32 v84, v84, v26
v_sub_f32 v85, v85, v26
v_sub_f32 v86, v86, v26
v_sub_f32 v87, v87, v26
buffer_load_dwordx4 v4, s[24:27], s64 offen offset:3072 sc1 lds
v_sub_f32 v120, v120, v24
v_sub_f32 v121, v121, v24
v_sub_f32 v122, v122, v24
v_sub_f32 v123, v123, v24
v_sub_f32 v128, v128, v26
v_sub_f32 v129, v129, v26
v_sub_f32 v130, v130, v26
v_sub_f32 v131, v131, v26
s_add_u32 m0, s70, 0
s_add_u32 s64, s68, 393216
s_cmp_ge_u32 s3, 3
s_cselect_b32 s64, s64, 2147418112
buffer_load_dwordx4 v4, s[24:27], s64 offen offset:0 sc1 lds
v_sub_f32 v136, v136, v24
v_sub_f32 v137, v137, v24
v_sub_f32 v138, v138, v24
v_sub_f32 v139, v139, v24
v_sub_f32 v144, v144, v26
v_sub_f32 v145, v145, v26
v_sub_f32 v146, v146, v26
v_sub_f32 v147, v147, v26
buffer_load_dwordx4 v4, s[24:27], s64 offen offset:1024 sc1 lds
v_mov_b32 v100, 0
v_mov_b32 v101, 0
v_mov_b32 v102, 0
v_mov_b32 v103, 0
v_mov_b32 v148, 0
v_mov_b32 v149, 0
v_mov_b32 v150, 0
v_mov_b32 v151, 0
buffer_load_dwordx4 v4, s[24:27], s64 offen offset:2048 sc1 lds
v_mov_b32 v156, 0
v_mov_b32 v157, 0
v_mov_b32 v158, 0
v_mov_b32 v159, 0
v_mov_b32 v56, 0
v_mov_b32 v57, 0
v_mov_b32 v58, 0
v_mov_b32 v59, 0
buffer_load_dwordx4 v4, s[24:27], s64 offen offset:3072 sc1 lds
v_mov_b32 v108, 0
v_mov_b32 v109, 0
v_mov_b32 v110, 0
v_mov_b32 v111, 0
v_mov_b32 v140, 0
v_mov_b32 v141, 0
v_mov_b32 v142, 0
v_mov_b32 v143, 0
v_mov_b32 v48, 0
v_mov_b32 v49, 0
v_mov_b32 v50, 0
v_mov_b32 v51, 0
v_mov_b32 v196, 0
v_mov_b32 v197, 0
v_mov_b32 v198, 0
v_mov_b32 v199, 0
v_mov_b32 v116, 0
v_mov_b32 v117, 0
v_mov_b32 v118, 0
v_mov_b32 v119, 0
v_mov_b32 v132, 0
v_mov_b32 v133, 0
v_mov_b32 v134, 0
v_mov_b32 v135, 0
v_mov_b32 v164, 0
v_mov_b32 v165, 0
v_mov_b32 v166, 0
v_mov_b32 v167, 0
v_mov_b32 v188, 0
v_mov_b32 v189, 0
v_mov_b32 v190, 0
v_mov_b32 v191, 0
v_mov_b32 v40, 0
v_mov_b32 v41, 0
v_mov_b32 v42, 0
v_mov_b32 v43, 0
v_mov_b32 v124, 0
v_mov_b32 v125, 0
v_mov_b32 v126, 0
v_mov_b32 v127, 0
v_mov_b32 v172, 0
v_mov_b32 v173, 0
v_mov_b32 v174, 0
v_mov_b32 v175, 0
v_mov_b32 v180, 0
v_mov_b32 v181, 0
v_mov_b32 v182, 0
v_mov_b32 v183, 0
ds_read_b128 a[192:195], v4 offset:49152
ds_read_b128 a[196:199], v4 offset:50176
ds_read_b128 a[200:203], v4 offset:51200
ds_read_b128 a[204:207], v4 offset:52224
ds_read_b128 a[208:211], v4 offset:53248
ds_read_b128 a[212:215], v4 offset:54272
ds_read_b128 a[216:219], v4 offset:55296
ds_read_b128 a[220:223], v4 offset:56320
s_waitcnt lgkmcnt(8)
s_and_b32 s77, s84, 1
s_mul_i32 s77, s77, 1056768
s_lshl_b32 s52, s86, 22
s_add_u32 s77, s77, s52
s_mov_b32 s80, s70
s_cmp_lt_u32 s3, 2
s_cselect_b32 s53, 8, -2
s_add_u32 s53, s53, s3
v_mfma_f32_16x16x32_bf16 a[0:3], a[64:67], v[228:231], 0
s_mul_i32 s52, s5, 196608
v_exp_f32 v80, v80
v_mfma_f32_16x16x32_bf16 a[32:35], a[64:67], v[176:179], 0
s_sub_u32 s52, 3194880, s52
v_exp_f32 v81, v81
v_mfma_f32_16x16x32_bf16 a[4:7], a[68:71], v[228:231], 0
s_add_u32 s71, s68, s52
v_exp_f32 v82, v82
v_mfma_f32_16x16x32_bf16 a[36:39], a[68:71], v[176:179], 0
s_and_b32 s52, s68, 0xffff
v_exp_f32 v83, v83
v_mfma_f32_16x16x32_bf16 a[8:11], a[72:75], v[228:231], 0
s_add_u32 s77, s77, s52
v_cvt_pk_bf16_f32 v200, v80, v81
v_cvt_pk_bf16_f32 v201, v82, v83
v_mfma_f32_16x16x32_bf16 a[40:43], a[72:75], v[176:179], 0
s_add_u32 s77, s77, 134217728
v_exp_f32 v184, v184
v_mfma_f32_16x16x32_bf16 a[12:15], a[76:79], v[228:231], 0
s_add_u32 s52, s3, 6
v_exp_f32 v185, v185
v_mfma_f32_16x16x32_bf16 a[44:47], a[76:79], v[176:179], 0
s_mul_i32 s52, s52, 49152
v_exp_f32 v186, v186
v_mfma_f32_16x16x32_bf16 a[16:19], a[80:83], v[228:231], 0
s_add_u32 s68, s68, s52
v_exp_f32 v187, v187
v_mfma_f32_16x16x32_bf16 a[48:51], a[80:83], v[176:179], 0
s_lshl_b32 s53, s53, 14
v_cvt_pk_bf16_f32 v76, v184, v185
v_cvt_pk_bf16_f32 v77, v186, v187
v_mfma_f32_16x16x32_bf16 a[20:23], a[84:87], v[228:231], 0
s_add_u32 s70, s70, s53
v_exp_f32 v208, v208
v_mfma_f32_16x16x32_bf16 a[52:55], a[84:87], v[176:179], 0
s_mov_b32 s75, 65536
v_exp_f32 v209, v209
v_mfma_f32_16x16x32_bf16 a[24:27], a[88:91], v[228:231], 0
s_mov_b32 s72, 1
v_exp_f32 v210, v210
v_mfma_f32_16x16x32_bf16 a[56:59], a[88:91], v[176:179], 0
s_mov_b32 s73, 3
v_exp_f32 v211, v211
v_mfma_f32_16x16x32_bf16 a[28:31], a[92:95], v[228:231], 0
s_lshl2_add_u32 s69, s5, 4
v_cvt_pk_bf16_f32 v202, v208, v209
v_cvt_pk_bf16_f32 v203, v210, v211
v_mfma_f32_16x16x32_bf16 a[60:63], a[92:95], v[176:179], 0
s_min_u32 s74, s73, s66
v_exp_f32 v84, v84
v_mfma_f32_16x16x32_bf16 a[224:227], a[240:243], v[228:231], 0
v_mfma_f32_16x16x32_bf16 a[228:231], a[240:243], v[176:179], 0
s_cmp_lt_u32 s66, 2
s_waitcnt vmcnt(27) lgkmcnt(0)
s_cbranch_scc1 L_NE
L_DUAL:
v_mfma_f32_16x16x32_bf16 v[236:239], a[192:195], v[64:67], v[216:219]
s_barrier
v_mfma_f32_16x16x32_bf16 v[236:239], a[196:199], v[244:247], v[236:239]
s_cmp_eq_u32 s68, s71
v_exp_f32 v85, v85
v_mfma_f32_16x16x32_bf16 v[236:239], a[200:203], v[240:243], v[236:239]
s_cselect_b32 s64, s77, s68
v_add_u32 v5, s75, v4
v_cvt_pk_bf16_f32 v78, v84, v85
v_mfma_f32_16x16x32_bf16 v[236:239], a[204:207], v[44:47], v[236:239]
s_mov_b32 m0, s70
v_exp_f32 v86, v86
v_mfma_f32_16x16x32_bf16 v[248:251], a[192:195], v[204:207], v[96:99]
buffer_load_dwordx4 v4, s[24:27], s64 offen offset:0 sc1 lds
v_mfma_f32_16x16x32_bf16 v[248:251], a[196:199], v[252:255], v[248:251]
s_add_u32 s75, s75, 16384
v_exp_f32 v87, v87
v_mfma_f32_16x16x32_bf16 v[248:251], a[200:203], v[232:235], v[248:251]
v_cvt_pk_bf16_f32 v79, v86, v87
v_mfma_f32_16x16x32_bf16 v[248:251], a[204:207], v[32:35], v[248:251]
s_cmp_ge_u32 s75, 163840
v_exp_f32 v236, v236
v_mfma_f32_16x16x32_bf16 v[36:39], a[208:211], v[64:67], v[104:107]
v_mfma_f32_16x16x32_bf16 v[36:39], a[212:215], v[244:247], v[36:39]
s_cselect_b32 s75, 0, s75
v_exp_f32 v237, v237
v_mfma_f32_16x16x32_bf16 v[36:39], a[216:219], v[240:243], v[36:39]
v_cvt_pk_bf16_f32 v228, v236, v237
v_mfma_f32_16x16x32_bf16 v[36:39], a[220:223], v[44:47], v[36:39]
s_add_u32 s68, s64, 49152
v_exp_f32 v238, v238
v_mfma_f32_16x16x32_bf16 v[92:95], a[208:211], v[204:207], v[112:115]
buffer_load_dwordx4 v4, s[24:27], s64 offen offset:1024 sc1 lds
v_mfma_f32_16x16x32_bf16 v[92:95], a[212:215], v[252:255], v[92:95]
s_add_u32 s70, s70, 16384
v_exp_f32 v239, v239
v_mfma_f32_16x16x32_bf16 v[92:95], a[216:219], v[232:235], v[92:95]
v_cvt_pk_bf16_f32 v229, v238, v239
v_mfma_f32_16x16x32_bf16 v[92:95], a[220:223], v[32:35], v[92:95]
v_exp_f32 v248, v248
v_mfma_f32_16x16x32_bf16 v[100:103], a[64:67], v[200:203], v[100:103]
v_mfma_f32_16x16x32_bf16 v[116:119], a[64:67], v[76:79], v[116:119]
s_cmp_ge_u32 s70, 163840
v_exp_f32 v249, v249
v_mfma_f32_16x16x32_bf16 v[148:151], a[68:71], v[200:203], v[148:151]
ds_read_b128 a[64:67], v5 offset:8192
v_cvt_pk_bf16_f32 v176, v248, v249
v_mfma_f32_16x16x32_bf16 v[132:135], a[68:71], v[76:79], v[132:135]
s_cselect_b32 s70, s80, s70
v_exp_f32 v250, v250
v_mfma_f32_16x16x32_bf16 v[156:159], a[72:75], v[200:203], v[156:159]
buffer_load_dwordx4 v4, s[24:27], s64 offen offset:2048 sc1 lds
v_mfma_f32_16x16x32_bf16 v[164:167], a[72:75], v[76:79], v[164:167]
v_exp_f32 v251, v251
v_mfma_f32_16x16x32_bf16 v[56:59], a[76:79], v[200:203], v[56:59]
ds_read_b128 a[68:71], v5 offset:9216
v_cvt_pk_bf16_f32 v177, v250, v251
v_mfma_f32_16x16x32_bf16 v[188:191], a[76:79], v[76:79], v[188:191]
v_exp_f32 v36, v36
v_mfma_f32_16x16x32_bf16 v[108:111], a[80:83], v[200:203], v[108:111]
ds_read_b128 a[72:75], v5 offset:10240
v_mfma_f32_16x16x32_bf16 v[40:43], a[80:83], v[76:79], v[40:43]
v_exp_f32 v37, v37
v_mfma_f32_16x16x32_bf16 v[140:143], a[84:87], v[200:203], v[140:143]
ds_read_b128 a[76:79], v5 offset:11264
v_cvt_pk_bf16_f32 v230, v36, v37
v_mfma_f32_16x16x32_bf16 v[124:127], a[84:87], v[76:79], v[124:127]
v_exp_f32 v38, v38
v_mfma_f32_16x16x32_bf16 v[48:51], a[88:91], v[200:203], v[48:51]
buffer_load_dwordx4 v4, s[24:27], s64 offen offset:3072 sc1 lds
v_mfma_f32_16x16x32_bf16 v[172:175], a[88:91], v[76:79], v[172:175]
v_exp_f32 v39, v39
v_mfma_f32_16x16x32_bf16 v[196:199], a[92:95], v[200:203], v[196:199]
ds_read_b128 a[80:83], v5 offset:12288
v_cvt_pk_bf16_f32 v231, v38, v39
v_mfma_f32_16x16x32_bf16 v[180:183], a[92:95], v[76:79], v[180:183]
v_exp_f32 v92, v92
v_mfma_f32_16x16x32_bf16 a[232:235], a[240:243], v[200:203], a[232:235]
ds_read_b128 a[84:87], v5 offset:13312
v_mfma_f32_16x16x32_bf16 a[236:239], a[240:243], v[76:79], a[236:239]
ds_read_b128 a[88:91], v5 offset:14336
v_mfma_f32_16x16x32_bf16 v[80:83], a[192:195], v[212:215], v[120:123]
ds_read_b128 a[92:95], v5 offset:15360
v_mfma_f32_16x16x32_bf16 v[80:83], a[196:199], v[88:91], v[80:83]
v_exp_f32 v93, v93
v_mfma_f32_16x16x32_bf16 v[80:83], a[200:203], v[224:227], v[80:83]
v_cvt_pk_bf16_f32 v178, v92, v93
v_mfma_f32_16x16x32_bf16 v[80:83], a[204:207], v[52:55], v[80:83]
v_exp_f32 v94, v94
v_mfma_f32_16x16x32_bf16 v[184:187], a[192:195], v[220:223], v[128:131]
s_nop 0
v_mfma_f32_16x16x32_bf16 v[184:187], a[196:199], v[160:163], v[184:187]
v_exp_f32 v95, v95
v_mfma_f32_16x16x32_bf16 v[184:187], a[200:203], v[192:195], v[184:187]
ds_read_b128 a[192:195], v5 offset:0
v_cvt_pk_bf16_f32 v179, v94, v95
v_mfma_f32_16x16x32_bf16 v[184:187], a[204:207], v[60:63], v[184:187]
v_exp_f32 v80, v80
v_mfma_f32_16x16x32_bf16 v[208:211], a[208:211], v[212:215], v[136:139]
ds_read_b128 a[196:199], v5 offset:1024
v_mfma_f32_16x16x32_bf16 v[208:211], a[212:215], v[88:91], v[208:211]
v_exp_f32 v81, v81
v_mfma_f32_16x16x32_bf16 v[208:211], a[216:219], v[224:227], v[208:211]
ds_read_b128 a[200:203], v5 offset:2048
v_cvt_pk_bf16_f32 v200, v80, v81
v_mfma_f32_16x16x32_bf16 v[208:211], a[220:223], v[52:55], v[208:211]
v_exp_f32 v82, v82
v_mfma_f32_16x16x32_bf16 v[84:87], a[208:211], v[220:223], v[144:147]
ds_read_b128 a[204:207], v5 offset:3072
v_mfma_f32_16x16x32_bf16 v[84:87], a[212:215], v[160:163], v[84:87]
v_exp_f32 v83, v83
v_mfma_f32_16x16x32_bf16 v[84:87], a[216:219], v[192:195], v[84:87]
ds_read_b128 a[208:211], v5 offset:4096
v_cvt_pk_bf16_f32 v201, v82, v83
v_mfma_f32_16x16x32_bf16 v[84:87], a[220:223], v[60:63], v[84:87]
s_waitcnt lgkmcnt(5)
v_exp_f32 v184, v184
v_mfma_f32_16x16x32_bf16 a[0:3], a[64:67], v[228:231], a[0:3]
ds_read_b128 a[212:215], v5 offset:5120
v_mfma_f32_16x16x32_bf16 a[32:35], a[64:67], v[176:179], a[32:35]
v_exp_f32 v185, v185
v_mfma_f32_16x16x32_bf16 a[4:7], a[68:71], v[228:231], a[4:7]
ds_read_b128 a[216:219], v5 offset:6144
v_cvt_pk_bf16_f32 v76, v184, v185
v_mfma_f32_16x16x32_bf16 a[36:39], a[68:71], v[176:179], a[36:39]
v_exp_f32 v186, v186
v_mfma_f32_16x16x32_bf16 a[8:11], a[72:75], v[228:231], a[8:11]
ds_read_b128 a[220:223], v5 offset:7168
v_mfma_f32_16x16x32_bf16 a[40:43], a[72:75], v[176:179], a[40:43]
s_add_u32 s72, s72, 1
v_exp_f32 v187, v187
v_mfma_f32_16x16x32_bf16 a[12:15], a[76:79], v[228:231], a[12:15]
v_cvt_pk_bf16_f32 v77, v186, v187
v_mfma_f32_16x16x32_bf16 a[44:47], a[76:79], v[176:179], a[44:47]
v_exp_f32 v208, v208
v_mfma_f32_16x16x32_bf16 a[16:19], a[80:83], v[228:231], a[16:19]
v_mfma_f32_16x16x32_bf16 a[48:51], a[80:83], v[176:179], a[48:51]
v_exp_f32 v209, v209
v_mfma_f32_16x16x32_bf16 a[20:23], a[84:87], v[228:231], a[20:23]
v_cvt_pk_bf16_f32 v202, v208, v209
v_mfma_f32_16x16x32_bf16 a[52:55], a[84:87], v[176:179], a[52:55]
v_exp_f32 v210, v210
v_mfma_f32_16x16x32_bf16 a[24:27], a[88:91], v[228:231], a[24:27]
v_mfma_f32_16x16x32_bf16 a[56:59], a[88:91], v[176:179], a[56:59]
s_cmp_lt_u32 s72, s74
v_exp_f32 v211, v211
v_mfma_f32_16x16x32_bf16 a[28:31], a[92:95], v[228:231], a[28:31]
v_cvt_pk_bf16_f32 v203, v210, v211
v_mfma_f32_16x16x32_bf16 a[60:63], a[92:95], v[176:179], a[60:63]
s_waitcnt vmcnt(8) lgkmcnt(0)
v_exp_f32 v84, v84
v_mfma_f32_16x16x32_bf16 a[224:227], a[240:243], v[228:231], a[224:227]
v_mfma_f32_16x16x32_bf16 a[228:231], a[240:243], v[176:179], a[228:231]
s_cbranch_scc1 L_DUAL
L_DISP:
s_cmp_lg_u32 s72, s73
s_cbranch_scc1 L_NE
s_cmp_eq_u32 s72, 11
s_cbranch_scc1 L_E2
s_cmp_eq_u32 s72, 8
s_cbranch_scc1 L_E1
s_cmp_lg_u32 s72, 3
s_cbranch_scc1 L_NE
s_waitcnt vmcnt(8)
buffer_atomic_add v1, v0, s[24:27], s89 offen offset:8 sc1
s_mov_b32 s73, 8
s_branch L_NE
L_E1:
v_and_b32 v169, 31, v1
v_lshlrev_b32 v169, 10, v169
v_add_u32 v169, 167772680, v169
buffer_load_dword v168, v169, s[24:27], 0 offen sc1
s_mov_b32 s73, 11
s_branch L_NE
L_E2:
s_waitcnt vmcnt(8)
v_cmp_gt_u32 vcc, 32, v168
s_mov_b32 s73, 32
s_nop 3
s_cbranch_vccnz CK_Q
CK_Q_R:
L_NE:
s_min_u32 s74, s73, s66
s_cmp_lt_u32 s72, s66
s_cbranch_scc1 L_DUAL
s_cmp_gt_u32 s72, s66
s_cbranch_scc1 L_POST
v_cndmask_b32 v216, v216, v6, s[56:57]
v_cndmask_b32 v112, v112, v6, s[56:57]
v_mov_b32 v104, v6
v_cndmask_b32 v217, v217, v6, s[58:59]
v_cndmask_b32 v113, v113, v6, s[58:59]
v_mov_b32 v105, v6
v_cndmask_b32 v218, v218, v6, s[60:61]
v_cndmask_b32 v114, v114, v6, s[60:61]
v_mov_b32 v106, v6
v_cndmask_b32 v219, v219, v6, s[62:63]
v_cndmask_b32 v115, v115, v6, s[62:63]
v_mov_b32 v107, v6
s_nop 0
s_branch L_DUAL
L_POST:
s_min_u32 s74, s73, s69
s_cmp_lg_u32 s72, s69
s_cbranch_scc1 L_SINGLE
L_SE:
s_bfe_u32 s52, s4, 65539
s_mul_i32 s52, s52, 270336
s_add_u32 s52, s52, s94
s_add_u32 s52, s52, 67108864
s_and_b32 s53, s4, 7
s_mul_i32 s53, s53, 24576
s_add_u32 s52, s52, s53
s_lshr_b32 s78, s66, 2
s_lshl_b32 s78, s78, 22
s_add_u32 s78, s78, s52
s_and_b32 s65, s66, 3
s_mul_i32 s65, s65, 540672
s_add_u32 s78, s78, s65
s_lshr_b32 s79, s67, 2
s_lshl_b32 s79, s79, 22
s_add_u32 s79, s79, s52
s_and_b32 s65, s67, 3
s_mul_i32 s65, s65, 540672
s_add_u32 s79, s79, s65
s_mov_b32 s76, 0
v_mov_b32 v7, 0x5d800000
s_mov_b32 s69, 64
v_accvgpr_read_b32 v72, a224
v_accvgpr_read_b32 v74, a228
v_cmp_nle_f32 vcc, v72, v7
v_cmp_nle_f32 s[96:97], v74, v7
s_nop 3
s_or_b64 vcc, vcc, s[96:97]
s_cbranch_vccnz L_NS
v_mul_f32 v8, 0x3fb8aa3b, v8
v_mul_f32 v9, 0x3fb8aa3b, v9
v_exp_f32 v8, v8
v_exp_f32 v9, v9
s_nop 0
v_fma_f32 v72, v72, v8, v72
v_fma_f32 v74, v74, v9, v74
v_rcp_f32 v72, v72
v_rcp_f32 v74, v74
s_add_u32 s52, s78, 4096
v_mov_b32 v73, v72
v_mov_b32 v75, v74
v_accvgpr_read_b32 v16, a0
v_accvgpr_read_b32 v17, a1
v_accvgpr_read_b32 v18, a2
v_accvgpr_read_b32 v19, a3
v_accvgpr_read_b32 v20, a4
v_accvgpr_read_b32 v21, a5
v_accvgpr_read_b32 v22, a6
v_accvgpr_read_b32 v23, a7
v_pk_mul_f32 v[16:17], v[16:17], v[72:73]
v_pk_mul_f32 v[18:19], v[18:19], v[72:73]
v_pk_mul_f32 v[20:21], v[20:21], v[72:73]
v_pk_mul_f32 v[22:23], v[22:23], v[72:73]
v_cvt_pk_bf16_f32 v16, v16, v17
v_cvt_pk_bf16_f32 v17, v18, v19
v_cvt_pk_bf16_f32 v18, v20, v21
v_cvt_pk_bf16_f32 v19, v22, v23
buffer_store_dwordx4 v[16:19], v4, s[24:27], s78 offen offset:0 sc1
v_accvgpr_read_b32 v24, a32
v_accvgpr_read_b32 v25, a33
v_accvgpr_read_b32 v26, a34
v_accvgpr_read_b32 v27, a35
v_accvgpr_read_b32 v28, a36
v_accvgpr_read_b32 v29, a37
v_accvgpr_read_b32 v30, a38
v_accvgpr_read_b32 v31, a39
v_pk_mul_f32 v[24:25], v[24:25], v[74:75]
v_pk_mul_f32 v[26:27], v[26:27], v[74:75]
v_pk_mul_f32 v[28:29], v[28:29], v[74:75]
v_pk_mul_f32 v[30:31], v[30:31], v[74:75]
v_cvt_pk_bf16_f32 v24, v24, v25
v_cvt_pk_bf16_f32 v25, v26, v27
v_cvt_pk_bf16_f32 v26, v28, v29
v_cvt_pk_bf16_f32 v27, v30, v31
buffer_store_dwordx4 v[24:27], v4, s[24:27], s78 offen offset:1024 sc1
v_accvgpr_read_b32 v16, a8
v_accvgpr_read_b32 v17, a9
v_accvgpr_read_b32 v18, a10
v_accvgpr_read_b32 v19, a11
v_accvgpr_read_b32 v20, a12
v_accvgpr_read_b32 v21, a13
v_accvgpr_read_b32 v22, a14
v_accvgpr_read_b32 v23, a15
v_pk_mul_f32 v[16:17], v[16:17], v[72:73]
v_pk_mul_f32 v[18:19], v[18:19], v[72:73]
v_pk_mul_f32 v[20:21], v[20:21], v[72:73]
v_pk_mul_f32 v[22:23], v[22:23], v[72:73]
v_cvt_pk_bf16_f32 v16, v16, v17
v_cvt_pk_bf16_f32 v17, v18, v19
v_cvt_pk_bf16_f32 v18, v20, v21
v_cvt_pk_bf16_f32 v19, v22, v23
buffer_store_dwordx4 v[16:19], v4, s[24:27], s78 offen offset:2048 sc1
v_accvgpr_read_b32 v24, a40
v_accvgpr_read_b32 v25, a41
v_accvgpr_read_b32 v26, a42
v_accvgpr_read_b32 v27, a43
v_accvgpr_read_b32 v28, a44
v_accvgpr_read_b32 v29, a45
v_accvgpr_read_b32 v30, a46
v_accvgpr_read_b32 v31, a47
v_pk_mul_f32 v[24:25], v[24:25], v[74:75]
v_pk_mul_f32 v[26:27], v[26:27], v[74:75]
v_pk_mul_f32 v[28:29], v[28:29], v[74:75]
v_pk_mul_f32 v[30:31], v[30:31], v[74:75]
v_cvt_pk_bf16_f32 v24, v24, v25
v_cvt_pk_bf16_f32 v25, v26, v27
v_cvt_pk_bf16_f32 v26, v28, v29
v_cvt_pk_bf16_f32 v27, v30, v31
buffer_store_dwordx4 v[24:27], v4, s[24:27], s78 offen offset:3072 sc1
v_accvgpr_read_b32 v16, a16
v_accvgpr_read_b32 v17, a17
v_accvgpr_read_b32 v18, a18
v_accvgpr_read_b32 v19, a19
v_accvgpr_read_b32 v20, a20
v_accvgpr_read_b32 v21, a21
v_accvgpr_read_b32 v22, a22
v_accvgpr_read_b32 v23, a23
v_pk_mul_f32 v[16:17], v[16:17], v[72:73]
v_pk_mul_f32 v[18:19], v[18:19], v[72:73]
v_pk_mul_f32 v[20:21], v[20:21], v[72:73]
v_pk_mul_f32 v[22:23], v[22:23], v[72:73]
v_cvt_pk_bf16_f32 v16, v16, v17
v_cvt_pk_bf16_f32 v17, v18, v19
v_cvt_pk_bf16_f32 v18, v20, v21
v_cvt_pk_bf16_f32 v19, v22, v23
buffer_store_dwordx4 v[16:19], v4, s[24:27], s52 offen offset:0 sc1
v_accvgpr_read_b32 v24, a48
v_accvgpr_read_b32 v25, a49
v_accvgpr_read_b32 v26, a50
v_accvgpr_read_b32 v27, a51
v_accvgpr_read_b32 v28, a52
v_accvgpr_read_b32 v29, a53
v_accvgpr_read_b32 v30, a54
v_accvgpr_read_b32 v31, a55
v_pk_mul_f32 v[24:25], v[24:25], v[74:75]
v_pk_mul_f32 v[26:27], v[26:27], v[74:75]
v_pk_mul_f32 v[28:29], v[28:29], v[74:75]
v_pk_mul_f32 v[30:31], v[30:31], v[74:75]
v_cvt_pk_bf16_f32 v24, v24, v25
v_cvt_pk_bf16_f32 v25, v26, v27
v_cvt_pk_bf16_f32 v26, v28, v29
v_cvt_pk_bf16_f32 v27, v30, v31
buffer_store_dwordx4 v[24:27], v4, s[24:27], s52 offen offset:1024 sc1
v_accvgpr_read_b32 v16, a24
v_accvgpr_read_b32 v17, a25
v_accvgpr_read_b32 v18, a26
v_accvgpr_read_b32 v19, a27
v_accvgpr_read_b32 v20, a28
v_accvgpr_read_b32 v21, a29
v_accvgpr_read_b32 v22, a30
v_accvgpr_read_b32 v23, a31
v_pk_mul_f32 v[16:17], v[16:17], v[72:73]
v_pk_mul_f32 v[18:19], v[18:19], v[72:73]
v_pk_mul_f32 v[20:21], v[20:21], v[72:73]
v_pk_mul_f32 v[22:23], v[22:23], v[72:73]
v_cvt_pk_bf16_f32 v16, v16, v17
v_cvt_pk_bf16_f32 v17, v18, v19
v_cvt_pk_bf16_f32 v18, v20, v21
v_cvt_pk_bf16_f32 v19, v22, v23
buffer_store_dwordx4 v[16:19], v4, s[24:27], s52 offen offset:2048 sc1
v_accvgpr_read_b32 v24, a56
v_accvgpr_read_b32 v25, a57
v_accvgpr_read_b32 v26, a58
v_accvgpr_read_b32 v27, a59
v_accvgpr_read_b32 v28, a60
v_accvgpr_read_b32 v29, a61
v_accvgpr_read_b32 v30, a62
v_accvgpr_read_b32 v31, a63
v_pk_mul_f32 v[24:25], v[24:25], v[74:75]
v_pk_mul_f32 v[26:27], v[26:27], v[74:75]
v_pk_mul_f32 v[28:29], v[28:29], v[74:75]
v_pk_mul_f32 v[30:31], v[30:31], v[74:75]
v_cvt_pk_bf16_f32 v24, v24, v25
v_cvt_pk_bf16_f32 v25, v26, v27
v_cvt_pk_bf16_f32 v26, v28, v29
v_cvt_pk_bf16_f32 v27, v30, v31
buffer_store_dwordx4 v[24:27], v4, s[24:27], s52 offen offset:3072 sc1
s_mov_b32 s76, 1
L_NS:
s_mov_b32 s74, s73
s_cmp_eq_u32 s72, 32
s_cbranch_scc1 L_FIN
L_SINGLE:
v_mfma_f32_16x16x32_bf16 v[236:239], a[192:195], v[212:215], v[120:123]
s_barrier
v_mfma_f32_16x16x32_bf16 v[236:239], a[196:199], v[88:91], v[236:239]
s_cmp_eq_u32 s68, s71
v_exp_f32 v85, v85
v_mfma_f32_16x16x32_bf16 v[236:239], a[200:203], v[224:227], v[236:239]
s_cselect_b32 s64, s77, s68
v_add_u32 v5, s75, v4
v_cvt_pk_bf16_f32 v78, v84, v85
v_mfma_f32_16x16x32_bf16 v[236:239], a[204:207], v[52:55], v[236:239]
s_mov_b32 m0, s70
v_exp_f32 v86, v86
v_mfma_f32_16x16x32_bf16 v[248:251], a[192:195], v[220:223], v[128:131]
buffer_load_dwordx4 v4, s[24:27], s64 offen offset:0 sc1 lds
v_mfma_f32_16x16x32_bf16 v[248:251], a[196:199], v[160:163], v[248:251]
s_add_u32 s75, s75, 16384
v_exp_f32 v87, v87
v_mfma_f32_16x16x32_bf16 v[248:251], a[200:203], v[192:195], v[248:251]
ds_read_b128 a[192:195], v5 offset:0
v_cvt_pk_bf16_f32 v79, v86, v87
v_mfma_f32_16x16x32_bf16 v[248:251], a[204:207], v[60:63], v[248:251]
s_cmp_ge_u32 s75, 163840
v_exp_f32 v236, v236
v_mfma_f32_16x16x32_bf16 v[36:39], a[208:211], v[212:215], v[136:139]
ds_read_b128 a[196:199], v5 offset:1024
ds_read_b128 a[200:203], v5 offset:2048
v_mfma_f32_16x16x32_bf16 v[36:39], a[212:215], v[88:91], v[36:39]
s_cselect_b32 s75, 0, s75
v_exp_f32 v237, v237
v_mfma_f32_16x16x32_bf16 v[36:39], a[216:219], v[224:227], v[36:39]
ds_read_b128 a[204:207], v5 offset:3072
v_cvt_pk_bf16_f32 v228, v236, v237
v_mfma_f32_16x16x32_bf16 v[36:39], a[220:223], v[52:55], v[36:39]
s_add_u32 s68, s64, 49152
v_exp_f32 v238, v238
v_mfma_f32_16x16x32_bf16 v[92:95], a[208:211], v[220:223], v[144:147]
buffer_load_dwordx4 v4, s[24:27], s64 offen offset:1024 sc1 lds
v_mfma_f32_16x16x32_bf16 v[92:95], a[212:215], v[160:163], v[92:95]
s_add_u32 s70, s70, 16384
v_exp_f32 v239, v239
v_mfma_f32_16x16x32_bf16 v[92:95], a[216:219], v[192:195], v[92:95]
ds_read_b128 a[208:211], v5 offset:4096
v_cvt_pk_bf16_f32 v229, v238, v239
v_mfma_f32_16x16x32_bf16 v[92:95], a[220:223], v[60:63], v[92:95]
s_waitcnt lgkmcnt(5)
v_exp_f32 v248, v248
v_mfma_f32_16x16x32_bf16 v[100:103], a[64:67], v[200:203], v[100:103]
ds_read_b128 a[212:215], v5 offset:5120
ds_read_b128 a[216:219], v5 offset:6144
v_mfma_f32_16x16x32_bf16 v[116:119], a[64:67], v[76:79], v[116:119]
s_cmp_ge_u32 s70, 163840
v_exp_f32 v249, v249
v_mfma_f32_16x16x32_bf16 v[148:151], a[68:71], v[200:203], v[148:151]
ds_read_b128 a[220:223], v5 offset:7168
v_cvt_pk_bf16_f32 v176, v248, v249
v_mfma_f32_16x16x32_bf16 v[132:135], a[68:71], v[76:79], v[132:135]
s_cselect_b32 s70, s80, s70
v_exp_f32 v250, v250
v_mfma_f32_16x16x32_bf16 v[156:159], a[72:75], v[200:203], v[156:159]
buffer_load_dwordx4 v4, s[24:27], s64 offen offset:2048 sc1 lds
v_mfma_f32_16x16x32_bf16 v[164:167], a[72:75], v[76:79], v[164:167]
v_exp_f32 v251, v251
v_mfma_f32_16x16x32_bf16 v[56:59], a[76:79], v[200:203], v[56:59]
ds_read_b128 a[64:67], v5 offset:8192
v_cvt_pk_bf16_f32 v177, v250, v251
v_mfma_f32_16x16x32_bf16 v[188:191], a[76:79], v[76:79], v[188:191]
v_exp_f32 v36, v36
v_mfma_f32_16x16x32_bf16 v[108:111], a[80:83], v[200:203], v[108:111]
ds_read_b128 a[68:71], v5 offset:9216
ds_read_b128 a[72:75], v5 offset:10240
v_mfma_f32_16x16x32_bf16 v[40:43], a[80:83], v[76:79], v[40:43]
v_exp_f32 v37, v37
v_mfma_f32_16x16x32_bf16 v[140:143], a[84:87], v[200:203], v[140:143]
ds_read_b128 a[76:79], v5 offset:11264
v_cvt_pk_bf16_f32 v230, v36, v37
v_mfma_f32_16x16x32_bf16 v[124:127], a[84:87], v[76:79], v[124:127]
s_cmp_eq_u32 s68, s71
v_exp_f32 v38, v38
v_mfma_f32_16x16x32_bf16 v[48:51], a[88:91], v[200:203], v[48:51]
buffer_load_dwordx4 v4, s[24:27], s64 offen offset:3072 sc1 lds
v_mfma_f32_16x16x32_bf16 v[172:175], a[88:91], v[76:79], v[172:175]
s_cselect_b32 s64, s77, s68
v_exp_f32 v39, v39
v_mfma_f32_16x16x32_bf16 v[196:199], a[92:95], v[200:203], v[196:199]
ds_read_b128 a[80:83], v5 offset:12288
v_cvt_pk_bf16_f32 v231, v38, v39
v_mfma_f32_16x16x32_bf16 v[180:183], a[92:95], v[76:79], v[180:183]
s_waitcnt lgkmcnt(5)
v_exp_f32 v92, v92
v_mfma_f32_16x16x32_bf16 a[232:235], a[240:243], v[200:203], a[232:235]
ds_read_b128 a[84:87], v5 offset:13312
ds_read_b128 a[88:91], v5 offset:14336
v_mfma_f32_16x16x32_bf16 a[236:239], a[240:243], v[76:79], a[236:239]
s_mov_b32 m0, s70
ds_read_b128 a[92:95], v5 offset:15360
v_mfma_f32_16x16x32_bf16 v[80:83], a[192:195], v[212:215], v[120:123]
buffer_load_dwordx4 v4, s[24:27], s64 offen offset:0 sc1 lds
v_mfma_f32_16x16x32_bf16 v[80:83], a[196:199], v[88:91], v[80:83]
v_exp_f32 v93, v93
v_mfma_f32_16x16x32_bf16 v[80:83], a[200:203], v[224:227], v[80:83]
v_add_u32 v5, s75, v4
v_cvt_pk_bf16_f32 v178, v92, v93
v_mfma_f32_16x16x32_bf16 v[80:83], a[204:207], v[52:55], v[80:83]
v_exp_f32 v94, v94
v_mfma_f32_16x16x32_bf16 v[184:187], a[192:195], v[220:223], v[128:131]
buffer_load_dwordx4 v4, s[24:27], s64 offen offset:1024 sc1 lds
v_mfma_f32_16x16x32_bf16 v[184:187], a[196:199], v[160:163], v[184:187]
s_add_u32 s75, s75, 16384
v_exp_f32 v95, v95
v_mfma_f32_16x16x32_bf16 v[184:187], a[200:203], v[192:195], v[184:187]
ds_read_b128 a[192:195], v5 offset:0
v_cvt_pk_bf16_f32 v179, v94, v95
v_mfma_f32_16x16x32_bf16 v[184:187], a[204:207], v[60:63], v[184:187]
s_cmp_ge_u32 s75, 163840
v_exp_f32 v80, v80
v_mfma_f32_16x16x32_bf16 v[208:211], a[208:211], v[212:215], v[136:139]
ds_read_b128 a[196:199], v5 offset:1024
ds_read_b128 a[200:203], v5 offset:2048
v_mfma_f32_16x16x32_bf16 v[208:211], a[212:215], v[88:91], v[208:211]
s_cselect_b32 s75, 0, s75
v_exp_f32 v81, v81
v_mfma_f32_16x16x32_bf16 v[208:211], a[216:219], v[224:227], v[208:211]
ds_read_b128 a[204:207], v5 offset:3072
v_cvt_pk_bf16_f32 v200, v80, v81
v_mfma_f32_16x16x32_bf16 v[208:211], a[220:223], v[52:55], v[208:211]
s_add_u32 s68, s64, 49152
v_exp_f32 v82, v82
v_mfma_f32_16x16x32_bf16 v[84:87], a[208:211], v[220:223], v[144:147]
buffer_load_dwordx4 v4, s[24:27], s64 offen offset:2048 sc1 lds
v_mfma_f32_16x16x32_bf16 v[84:87], a[212:215], v[160:163], v[84:87]
s_add_u32 s70, s70, 16384
v_exp_f32 v83, v83
v_mfma_f32_16x16x32_bf16 v[84:87], a[216:219], v[192:195], v[84:87]
ds_read_b128 a[208:211], v5 offset:4096
v_cvt_pk_bf16_f32 v201, v82, v83
v_mfma_f32_16x16x32_bf16 v[84:87], a[220:223], v[60:63], v[84:87]
s_waitcnt lgkmcnt(5)
v_exp_f32 v184, v184
v_mfma_f32_16x16x32_bf16 v[100:103], a[64:67], v[228:231], v[100:103]
ds_read_b128 a[212:215], v5 offset:5120
ds_read_b128 a[216:219], v5 offset:6144
v_mfma_f32_16x16x32_bf16 v[116:119], a[64:67], v[176:179], v[116:119]
s_cmp_ge_u32 s70, 163840
v_exp_f32 v185, v185
v_mfma_f32_16x16x32_bf16 v[148:151], a[68:71], v[228:231], v[148:151]
ds_read_b128 a[220:223], v5 offset:7168
v_cvt_pk_bf16_f32 v76, v184, v185
v_mfma_f32_16x16x32_bf16 v[132:135], a[68:71], v[176:179], v[132:135]
s_cselect_b32 s70, s80, s70
v_exp_f32 v186, v186
v_mfma_f32_16x16x32_bf16 v[156:159], a[72:75], v[228:231], v[156:159]
buffer_load_dwordx4 v4, s[24:27], s64 offen offset:3072 sc1 lds
v_mfma_f32_16x16x32_bf16 v[164:167], a[72:75], v[176:179], v[164:167]
s_add_u32 s72, s72, 1
v_exp_f32 v187, v187
v_mfma_f32_16x16x32_bf16 v[56:59], a[76:79], v[228:231], v[56:59]
ds_read_b128 a[64:67], v5 offset:8192
v_cvt_pk_bf16_f32 v77, v186, v187
v_mfma_f32_16x16x32_bf16 v[188:191], a[76:79], v[176:179], v[188:191]
v_exp_f32 v208, v208
v_mfma_f32_16x16x32_bf16 v[108:111], a[80:83], v[228:231], v[108:111]
ds_read_b128 a[68:71], v5 offset:9216
ds_read_b128 a[72:75], v5 offset:10240
v_mfma_f32_16x16x32_bf16 v[40:43], a[80:83], v[176:179], v[40:43]
v_exp_f32 v209, v209
v_mfma_f32_16x16x32_bf16 v[140:143], a[84:87], v[228:231], v[140:143]
ds_read_b128 a[76:79], v5 offset:11264
v_cvt_pk_bf16_f32 v202, v208, v209
v_mfma_f32_16x16x32_bf16 v[124:127], a[84:87], v[176:179], v[124:127]
v_exp_f32 v210, v210
v_mfma_f32_16x16x32_bf16 v[48:51], a[88:91], v[228:231], v[48:51]
ds_read_b128 a[80:83], v5 offset:12288
ds_read_b128 a[84:87], v5 offset:13312
v_mfma_f32_16x16x32_bf16 v[172:175], a[88:91], v[176:179], v[172:175]
s_cmp_lt_u32 s72, s74
v_exp_f32 v211, v211
v_mfma_f32_16x16x32_bf16 v[196:199], a[92:95], v[228:231], v[196:199]
ds_read_b128 a[88:91], v5 offset:14336
v_cvt_pk_bf16_f32 v203, v210, v211
v_mfma_f32_16x16x32_bf16 v[180:183], a[92:95], v[176:179], v[180:183]
s_waitcnt vmcnt(8) lgkmcnt(7)
v_exp_f32 v84, v84
v_mfma_f32_16x16x32_bf16 a[232:235], a[240:243], v[228:231], a[232:235]
ds_read_b128 a[92:95], v5 offset:15360
v_mfma_f32_16x16x32_bf16 a[236:239], a[240:243], v[176:179], a[236:239]
s_cbranch_scc1 L_SINGLE
s_cmp_lt_u32 s72, 32
s_cbranch_scc1 L_DISP
s_cmp_eq_u32 s69, 32
s_cbranch_scc1 L_SE
L_FIN:
v_cndmask_b32 v120, v120, v6, s[56:57]
v_cndmask_b32 v144, v144, v6, s[56:57]
v_mov_b32 v136, v6
v_cndmask_b32 v121, v121, v6, s[58:59]
v_cndmask_b32 v145, v145, v6, s[58:59]
v_mov_b32 v137, v6
v_cndmask_b32 v122, v122, v6, s[60:61]
v_cndmask_b32 v146, v146, v6, s[60:61]
v_mov_b32 v138, v6
v_cndmask_b32 v123, v123, v6, s[62:63]
v_cndmask_b32 v147, v147, v6, s[62:63]
v_mov_b32 v139, v6
s_sub_u32 s91, s70, s80
s_mov_b32 s83, s75
s_lshl_b32 s53, s4, 18
s_add_u32 s53, s53, 159383552
s_lshl_b32 s54, s66, 9
s_add_u32 s54, s54, s53
s_lshl_b32 s55, s67, 9
s_add_u32 s55, s55, s53
v_mfma_f32_16x16x32_bf16 v[236:239], a[192:195], v[212:215], v[120:123]
s_barrier
v_mfma_f32_16x16x32_bf16 v[236:239], a[196:199], v[88:91], v[236:239]
s_add_u32 m0, s83, 0
v_exp_f32 v85, v85
v_mfma_f32_16x16x32_bf16 v[236:239], a[200:203], v[224:227], v[236:239]
s_add_u32 s64, s54, 65280
v_add_u32 v5, s75, v4
v_cvt_pk_bf16_f32 v78, v84, v85
v_mfma_f32_16x16x32_bf16 v[236:239], a[204:207], v[52:55], v[236:239]
v_exp_f32 v86, v86
v_mfma_f32_16x16x32_bf16 v[248:251], a[192:195], v[220:223], v[128:131]
s_mov_b32 exec_hi, 0xffff
buffer_load_dwordx4 v4, s[24:27], s64 offen sc1 lds
s_mov_b32 exec_hi, -1
v_mfma_f32_16x16x32_bf16 v[248:251], a[196:199], v[160:163], v[248:251]
s_add_u32 m0, s83, 768
v_exp_f32 v87, v87
v_mfma_f32_16x16x32_bf16 v[248:251], a[200:203], v[192:195], v[248:251]
s_add_u32 s64, s54, 98048
v_cvt_pk_bf16_f32 v79, v86, v87
v_mfma_f32_16x16x32_bf16 v[248:251], a[204:207], v[60:63], v[248:251]
v_exp_f32 v236, v236
v_mfma_f32_16x16x32_bf16 v[36:39], a[208:211], v[212:215], v[136:139]
s_mov_b32 exec_hi, 0xffff
buffer_load_dwordx4 v4, s[24:27], s64 offen sc1 lds
s_mov_b32 exec_hi, -1
v_mfma_f32_16x16x32_bf16 v[36:39], a[212:215], v[88:91], v[36:39]
s_add_u32 m0, s83, 1536
v_exp_f32 v237, v237
v_mfma_f32_16x16x32_bf16 v[36:39], a[216:219], v[224:227], v[36:39]
s_add_u32 s64, s54, 130816
v_cvt_pk_bf16_f32 v228, v236, v237
v_mfma_f32_16x16x32_bf16 v[36:39], a[220:223], v[52:55], v[36:39]
v_exp_f32 v238, v238
v_mfma_f32_16x16x32_bf16 v[92:95], a[208:211], v[220:223], v[144:147]
s_mov_b32 exec_hi, 0xffff
buffer_load_dwordx4 v4, s[24:27], s64 offen sc1 lds
s_mov_b32 exec_hi, -1
v_mfma_f32_16x16x32_bf16 v[92:95], a[212:215], v[160:163], v[92:95]
s_add_u32 m0, s83, 2304
v_exp_f32 v239, v239
v_mfma_f32_16x16x32_bf16 v[92:95], a[216:219], v[192:195], v[92:95]
s_add_u32 s64, s54, 163584
v_cvt_pk_bf16_f32 v229, v238, v239
v_mfma_f32_16x16x32_bf16 v[92:95], a[220:223], v[60:63], v[92:95]
s_waitcnt lgkmcnt(0)
v_exp_f32 v248, v248
v_mfma_f32_16x16x32_bf16 v[100:103], a[64:67], v[200:203], v[100:103]
s_mov_b32 exec_hi, 0xffff
buffer_load_dwordx4 v4, s[24:27], s64 offen sc1 lds
s_mov_b32 exec_hi, -1
v_mfma_f32_16x16x32_bf16 v[116:119], a[64:67], v[76:79], v[116:119]
s_add_u32 m0, s83, 3072
v_exp_f32 v249, v249
v_mfma_f32_16x16x32_bf16 v[148:151], a[68:71], v[200:203], v[148:151]
s_add_u32 s64, s54, 196352
ds_read_b128 a[64:67], v5 offset:8192
v_cvt_pk_bf16_f32 v176, v248, v249
v_mfma_f32_16x16x32_bf16 v[132:135], a[68:71], v[76:79], v[132:135]
v_exp_f32 v250, v250
v_mfma_f32_16x16x32_bf16 v[156:159], a[72:75], v[200:203], v[156:159]
s_mov_b32 exec_hi, 0xffff
buffer_load_dwordx4 v4, s[24:27], s64 offen sc1 lds
s_mov_b32 exec_hi, -1
v_mfma_f32_16x16x32_bf16 v[164:167], a[72:75], v[76:79], v[164:167]
v_exp_f32 v251, v251
v_mfma_f32_16x16x32_bf16 v[56:59], a[76:79], v[200:203], v[56:59]
ds_read_b128 a[68:71], v5 offset:9216
v_cvt_pk_bf16_f32 v177, v250, v251
v_mfma_f32_16x16x32_bf16 v[188:191], a[76:79], v[76:79], v[188:191]
v_exp_f32 v36, v36
v_mfma_f32_16x16x32_bf16 v[108:111], a[80:83], v[200:203], v[108:111]
ds_read_b128 a[72:75], v5 offset:10240
v_mfma_f32_16x16x32_bf16 v[40:43], a[80:83], v[76:79], v[40:43]
s_add_u32 m0, s83, 3840
v_exp_f32 v37, v37
v_mfma_f32_16x16x32_bf16 v[140:143], a[84:87], v[200:203], v[140:143]
s_add_u32 s64, s55, 65280
ds_read_b128 a[76:79], v5 offset:11264
v_cvt_pk_bf16_f32 v230, v36, v37
v_mfma_f32_16x16x32_bf16 v[124:127], a[84:87], v[76:79], v[124:127]
v_exp_f32 v38, v38
v_mfma_f32_16x16x32_bf16 v[48:51], a[88:91], v[200:203], v[48:51]
s_mov_b32 exec_hi, 0xffff
buffer_load_dwordx4 v4, s[24:27], s64 offen sc1 lds
s_mov_b32 exec_hi, -1
v_mfma_f32_16x16x32_bf16 v[172:175], a[88:91], v[76:79], v[172:175]
v_exp_f32 v39, v39
v_mfma_f32_16x16x32_bf16 v[196:199], a[92:95], v[200:203], v[196:199]
ds_read_b128 a[80:83], v5 offset:12288
v_cvt_pk_bf16_f32 v231, v38, v39
v_mfma_f32_16x16x32_bf16 v[180:183], a[92:95], v[76:79], v[180:183]
v_exp_f32 v92, v92
v_mfma_f32_16x16x32_bf16 a[232:235], a[240:243], v[200:203], a[232:235]
ds_read_b128 a[84:87], v5 offset:13312
ds_read_b128 a[88:91], v5 offset:14336
v_mfma_f32_16x16x32_bf16 a[236:239], a[240:243], v[76:79], a[236:239]
ds_read_b128 a[92:95], v5 offset:15360
v_exp_f32 v93, v93
v_exp_f32 v94, v94
v_exp_f32 v95, v95
v_cmp_lt_u32 vcc, 31, v1
v_cvt_pk_bf16_f32 v178, v92, v93
v_cvt_pk_bf16_f32 v179, v94, v95
s_waitcnt lgkmcnt(0)
s_add_u32 m0, s83, 4608
v_mfma_f32_16x16x32_bf16 v[100:103], a[64:67], v[228:231], v[100:103]
s_add_u32 s64, s55, 98048
v_and_b32 v154, 31, v1
v_mov_b32 v152, s66
v_mfma_f32_16x16x32_bf16 v[116:119], a[64:67], v[176:179], v[116:119]
s_mov_b32 exec_hi, 0xffff
buffer_load_dwordx4 v4, s[24:27], s64 offen sc1 lds
s_mov_b32 exec_hi, -1
v_mfma_f32_16x16x32_bf16 v[148:151], a[68:71], v[228:231], v[148:151]
v_mov_b32 v155, s67
v_cndmask_b32 v152, v152, v155, vcc
v_mfma_f32_16x16x32_bf16 v[132:135], a[68:71], v[176:179], v[132:135]
s_add_u32 m0, s83, 5376
s_add_u32 s64, s55, 130816
v_lshl_add_u32 v152, v152, 5, v154
v_mfma_f32_16x16x32_bf16 v[156:159], a[72:75], v[228:231], v[156:159]
s_mov_b32 exec_hi, 0xffff
buffer_load_dwordx4 v4, s[24:27], s64 offen sc1 lds
s_mov_b32 exec_hi, -1
v_mfma_f32_16x16x32_bf16 v[164:167], a[72:75], v[176:179], v[164:167]
v_lshlrev_b32 v155, 4, v152
v_lshrrev_b32 v153, 5, v1
v_mfma_f32_16x16x32_bf16 v[56:59], a[76:79], v[228:231], v[56:59]
s_add_u32 m0, s83, 6144
s_add_u32 s64, s55, 163584
v_mul_u32_u24 v153, 3840, v153
v_mfma_f32_16x16x32_bf16 v[188:191], a[76:79], v[176:179], v[188:191]
s_mov_b32 exec_hi, 0xffff
buffer_load_dwordx4 v4, s[24:27], s64 offen sc1 lds
s_mov_b32 exec_hi, -1
v_mfma_f32_16x16x32_bf16 v[108:111], a[80:83], v[228:231], v[108:111]
v_lshl_add_u32 v153, v154, 4, v153
v_add_u32 v153, s83, v153
v_mfma_f32_16x16x32_bf16 v[40:43], a[80:83], v[176:179], v[40:43]
s_add_u32 m0, s83, 6912
s_add_u32 s64, s55, 196352
v_mfma_f32_16x16x32_bf16 v[140:143], a[84:87], v[228:231], v[140:143]
s_mov_b32 exec_hi, 0xffff
buffer_load_dwordx4 v4, s[24:27], s64 offen sc1 lds
s_mov_b32 exec_hi, -1
v_mfma_f32_16x16x32_bf16 v[124:127], a[84:87], v[176:179], v[124:127]
v_mfma_f32_16x16x32_bf16 v[48:51], a[88:91], v[228:231], v[48:51]
buffer_load_dwordx4 v[216:219], v155, s[24:27], s53 offen sc1
v_mfma_f32_16x16x32_bf16 v[172:175], a[88:91], v[176:179], v[172:175]
s_add_u32 s53, s53, 32768
s_lshl_b32 s74, s66, 10
s_lshr_b32 s52, s4, 3
v_mfma_f32_16x16x32_bf16 v[196:199], a[92:95], v[228:231], v[196:199]
buffer_load_dwordx4 v[96:99], v155, s[24:27], s53 offen sc1
v_mfma_f32_16x16x32_bf16 v[180:183], a[92:95], v[176:179], v[180:183]
s_lshl_b32 s52, s52, 7
s_add_u32 s74, s74, s52
s_add_u32 s74, s74, 167772160
v_mfma_f32_16x16x32_bf16 a[232:235], a[240:243], v[228:231], a[232:235]
v_mfma_f32_16x16x32_bf16 a[236:239], a[240:243], v[176:179], a[236:239]
s_lshr_b32 s52, s3, 1
s_lshl1_add_u32 s72, s85, s52
s_lshl3_add_u32 s75, s72, s84
s_lshl_b32 s75, s75, 7
s_add_u32 s75, s75, 167772160
s_and_b32 s82, s86, 1
v_mov_b32 v13, 0
s_nop 0
v_accvgpr_read_b32 v72, a232
v_accvgpr_read_b32 v74, a236
v_cmp_nle_f32 vcc, v72, v7
v_cmp_nle_f32 s[96:97], v74, v7
s_nop 3
s_or_b64 vcc, vcc, s[96:97]
s_cbranch_vccnz SLOW1
SLOW1_R:
s_mov_b32 m0, s70
s_mov_b32 s64, s68
s_add_u32 s68, s68, 49152
s_add_u32 s70, s70, 16384
s_cmp_ge_u32 s70, 163840
s_cselect_b32 s70, s80, s70
buffer_load_dwordx4 v4, s[24:27], s64 offen offset:0 sc1 lds
v_mul_f32 v10, 0x3fb8aa3b, v10
v_mul_f32 v11, 0x3fb8aa3b, v11
v_exp_f32 v10, v10
v_exp_f32 v11, v11
s_nop 0
v_fma_f32 v72, v72, v10, v72
v_fma_f32 v74, v74, v11, v74
v_rcp_f32 v72, v72
v_rcp_f32 v74, v74
buffer_load_dwordx4 v4, s[24:27], s64 offen offset:1024 sc1 lds
s_add_u32 s52, s79, 4096
v_mov_b32 v73, v72
v_mov_b32 v75, v74
v_pk_mul_f32 v[100:101], v[100:101], v[72:73]
v_pk_mul_f32 v[102:103], v[102:103], v[72:73]
v_pk_mul_f32 v[148:149], v[148:149], v[72:73]
v_pk_mul_f32 v[150:151], v[150:151], v[72:73]
v_cvt_pk_bf16_f32 v100, v100, v101
v_cvt_pk_bf16_f32 v101, v102, v103
buffer_load_dwordx4 v4, s[24:27], s64 offen offset:2048 sc1 lds
v_cvt_pk_bf16_f32 v102, v148, v149
v_cvt_pk_bf16_f32 v103, v150, v151
buffer_store_dwordx4 v[100:103], v4, s[24:27], s79 offen offset:0 sc1
v_pk_mul_f32 v[116:117], v[116:117], v[74:75]
v_pk_mul_f32 v[118:119], v[118:119], v[74:75]
v_pk_mul_f32 v[132:133], v[132:133], v[74:75]
v_pk_mul_f32 v[134:135], v[134:135], v[74:75]
v_cvt_pk_bf16_f32 v116, v116, v117
v_cvt_pk_bf16_f32 v117, v118, v119
buffer_load_dwordx4 v4, s[24:27], s64 offen offset:3072 sc1 lds
v_cvt_pk_bf16_f32 v118, v132, v133
v_cvt_pk_bf16_f32 v119, v134, v135
buffer_store_dwordx4 v[116:119], v4, s[24:27], s79 offen offset:1024 sc1
v_pk_mul_f32 v[156:157], v[156:157], v[72:73]
v_pk_mul_f32 v[158:159], v[158:159], v[72:73]
v_pk_mul_f32 v[56:57], v[56:57], v[72:73]
v_pk_mul_f32 v[58:59], v[58:59], v[72:73]
v_cvt_pk_bf16_f32 v156, v156, v157
v_cvt_pk_bf16_f32 v157, v158, v159
s_mov_b32 m0, s70
s_mov_b32 s64, s68
s_add_u32 s68, s68, 49152
s_add_u32 s70, s70, 16384
s_cmp_ge_u32 s70, 163840
s_cselect_b32 s70, s80, s70
buffer_load_dwordx4 v4, s[24:27], s64 offen offset:0 sc1 lds
v_cvt_pk_bf16_f32 v158, v56, v57
v_cvt_pk_bf16_f32 v159, v58, v59
buffer_store_dwordx4 v[156:159], v4, s[24:27], s79 offen offset:2048 sc1
v_pk_mul_f32 v[164:165], v[164:165], v[74:75]
v_pk_mul_f32 v[166:167], v[166:167], v[74:75]
v_pk_mul_f32 v[188:189], v[188:189], v[74:75]
v_pk_mul_f32 v[190:191], v[190:191], v[74:75]
v_cvt_pk_bf16_f32 v164, v164, v165
v_cvt_pk_bf16_f32 v165, v166, v167
buffer_load_dwordx4 v4, s[24:27], s64 offen offset:1024 sc1 lds
v_cvt_pk_bf16_f32 v166, v188, v189
v_cvt_pk_bf16_f32 v167, v190, v191
buffer_store_dwordx4 v[164:167], v4, s[24:27], s79 offen offset:3072 sc1
v_pk_mul_f32 v[108:109], v[108:109], v[72:73]
v_pk_mul_f32 v[110:111], v[110:111], v[72:73]
v_pk_mul_f32 v[140:141], v[140:141], v[72:73]
v_pk_mul_f32 v[142:143], v[142:143], v[72:73]
v_cvt_pk_bf16_f32 v108, v108, v109
v_cvt_pk_bf16_f32 v109, v110, v111
buffer_load_dwordx4 v4, s[24:27], s64 offen offset:2048 sc1 lds
v_cvt_pk_bf16_f32 v110, v140, v141
v_cvt_pk_bf16_f32 v111, v142, v143
buffer_store_dwordx4 v[108:111], v4, s[24:27], s52 offen offset:0 sc1
v_pk_mul_f32 v[40:41], v[40:41], v[74:75]
v_pk_mul_f32 v[42:43], v[42:43], v[74:75]
v_pk_mul_f32 v[124:125], v[124:125], v[74:75]
v_pk_mul_f32 v[126:127], v[126:127], v[74:75]
v_cvt_pk_bf16_f32 v40, v40, v41
v_cvt_pk_bf16_f32 v41, v42, v43
buffer_load_dwordx4 v4, s[24:27], s64 offen offset:3072 sc1 lds
v_cvt_pk_bf16_f32 v42, v124, v125
v_cvt_pk_bf16_f32 v43, v126, v127
buffer_store_dwordx4 v[40:43], v4, s[24:27], s52 offen offset:1024 sc1
v_pk_mul_f32 v[48:49], v[48:49], v[72:73]
v_pk_mul_f32 v[50:51], v[50:51], v[72:73]
v_pk_mul_f32 v[196:197], v[196:197], v[72:73]
v_pk_mul_f32 v[198:199], v[198:199], v[72:73]
v_cvt_pk_bf16_f32 v48, v48, v49
v_cvt_pk_bf16_f32 v49, v50, v51
v_cvt_pk_bf16_f32 v50, v196, v197
v_cvt_pk_bf16_f32 v51, v198, v199
buffer_store_dwordx4 v[48:51], v4, s[24:27], s52 offen offset:2048 sc1
v_pk_mul_f32 v[172:173], v[172:173], v[74:75]
v_pk_mul_f32 v[174:175], v[174:175], v[74:75]
v_pk_mul_f32 v[180:181], v[180:181], v[74:75]
v_pk_mul_f32 v[182:183], v[182:183], v[74:75]
v_cvt_pk_bf16_f32 v172, v172, v173
v_cvt_pk_bf16_f32 v173, v174, v175
v_cvt_pk_bf16_f32 v174, v180, v181
v_cvt_pk_bf16_f32 v175, v182, v183
buffer_store_dwordx4 v[172:175], v4, s[24:27], s52 offen offset:3072 sc1
s_cmp_eq_u32 s76, 0
s_cbranch_scc1 L_SE2
L_LA:
v_mov_b32 v5, v152
v_mov_b32 v6, v153
s_waitcnt vmcnt(16)
v_mov_b32 v16, v216
v_mov_b32 v17, v217
v_mov_b32 v18, v218
v_mov_b32 v19, v219
v_mov_b32 v20, v96
v_mov_b32 v21, v97
v_mov_b32 v22, v98
v_mov_b32 v23, v99
ds_read_b128 v[96:99], v6 offset:3328
ds_read_b128 v[32:35], v6 offset:256
ds_read_b128 v[36:39], v6 offset:1024
ds_read_b128 v[100:103], v6 offset:3296
ds_read_b128 v[40:43], v6 offset:224
ds_read_b128 v[44:47], v6 offset:992
ds_read_b128 v[104:107], v6 offset:3264
ds_read_b128 v[48:51], v6 offset:192
ds_read_b128 v[52:55], v6 offset:960
ds_read_b128 v[108:111], v6 offset:3232
ds_read_b128 v[56:59], v6 offset:160
ds_read_b128 v[60:63], v6 offset:928
ds_read_b128 v[112:115], v6 offset:3200
ds_read_b128 v[64:67], v6 offset:128
ds_read_b128 v[68:71], v6 offset:896
ds_read_b128 v[116:119], v6 offset:3168
ds_read_b128 v[72:75], v6 offset:96
ds_read_b128 v[76:79], v6 offset:864
ds_read_b128 v[120:123], v6 offset:3136
ds_read_b128 v[80:83], v6 offset:64
ds_read_b128 v[84:87], v6 offset:832
ds_read_b128 v[124:127], v6 offset:3104
ds_read_b128 v[88:91], v6 offset:32
ds_read_b128 v[92:95], v6 offset:800
ds_read_b128 v[128:131], v6 offset:1792
ds_read_b128 v[132:135], v6 offset:2560
ds_read_b128 v[136:139], v6 offset:1760
ds_read_b128 v[140:143], v6 offset:2528
ds_read_b128 v[144:147], v6 offset:1728
ds_read_b128 v[148:151], v6 offset:2496
ds_read_b128 v[152:155], v6 offset:1696
ds_read_b128 v[156:159], v6 offset:2464
ds_read_b128 v[160:163], v6 offset:1664
ds_read_b128 v[164:167], v6 offset:2432
ds_read_b128 v[168:171], v6 offset:1632
ds_read_b128 v[172:175], v6 offset:2400
ds_read_b128 v[176:179], v6 offset:1600
ds_read_b128 v[180:183], v6 offset:2368
ds_read_b128 v[184:187], v6 offset:1568
ds_read_b128 v[188:191], v6 offset:2336
s_bfe_u32 s53, s4, 65539
s_mul_i32 s53, s53, 270336
s_add_u32 s53, s53, s94
s_add_u32 s53, s53, 67108864
s_and_b32 s52, s3, 1
s_lshl_b32 s52, s52, 10
s_add_u32 s52, s52, s53
s_sub_u32 s54, 63, s72
s_lshr_b32 s77, s72, 2
s_lshl_b32 s77, s77, 22
s_add_u32 s77, s77, s52
s_and_b32 s65, s72, 3
s_mul_i32 s65, s65, 540672
s_add_u32 s77, s77, s65
s_lshr_b32 s81, s54, 2
s_lshl_b32 s81, s81, 22
s_add_u32 s81, s81, s52
s_and_b32 s65, s54, 3
s_mul_i32 s65, s65, 540672
s_add_u32 s81, s81, s65
s_add_u32 s91, s91, 114688
s_sub_u32 s52, s91, 163840
s_cmp_ge_u32 s91, 163840
s_cselect_b32 s91, s52, s91
v_add_u32 v14, 4096, v4
v_add_u32 v7, s91, v4
s_waitcnt lgkmcnt(0)
s_barrier
s_mov_b32 m0, s70
s_mov_b32 s64, s68
s_add_u32 s68, s68, 49152
s_add_u32 s70, s70, 16384
s_cmp_ge_u32 s70, 163840
s_cselect_b32 s70, s80, s70
buffer_load_dwordx4 v4, s[24:27], s64 offen offset:0 sc1 lds
v_and_b32 v9, 0xffff, v97
v_and_b32 v11, 0xffff0000, v97
v_dot2_f32_bf16 v24, v98, v99, 0
v_dot2_f32_bf16 v25, v102, v99, 0
v_dot2_f32_bf16 v26, v106, v99, 0
v_dot2_f32_bf16 v27, v110, v99, 0
v_dot2_f32_bf16 v28, v114, v99, 0
v_dot2_f32_bf16 v29, v118, v99, 0
v_dot2_f32_bf16 v30, v122, v99, 0
v_dot2_f32_bf16 v31, v126, v99, 0
v_dot2c_f32_bf16 v24, v96, v9
v_dot2c_f32_bf16 v25, v100, v9
v_dot2c_f32_bf16 v26, v104, v9
v_dot2c_f32_bf16 v27, v108, v9
v_dot2c_f32_bf16 v28, v112, v9
v_dot2c_f32_bf16 v29, v116, v9
v_dot2c_f32_bf16 v30, v120, v9
v_dot2c_f32_bf16 v31, v124, v9
v_dot2c_f32_bf16 v24, v16, v32
v_dot2c_f32_bf16 v25, v16, v40
v_dot2c_f32_bf16 v26, v16, v48
v_dot2c_f32_bf16 v27, v16, v56
v_dot2c_f32_bf16 v28, v16, v64
v_dot2c_f32_bf16 v29, v16, v72
v_dot2c_f32_bf16 v30, v16, v80
buffer_load_dwordx4 v4, s[24:27], s64 offen offset:1024 sc1 lds
v_dot2c_f32_bf16 v31, v16, v88
v_dot2c_f32_bf16 v24, v17, v33
v_dot2c_f32_bf16 v25, v17, v41
v_dot2c_f32_bf16 v26, v17, v49
v_dot2c_f32_bf16 v27, v17, v57
v_dot2c_f32_bf16 v28, v17, v65
v_dot2c_f32_bf16 v29, v17, v73
v_dot2c_f32_bf16 v30, v17, v81
v_dot2c_f32_bf16 v31, v17, v89
v_dot2c_f32_bf16 v24, v18, v34
v_dot2c_f32_bf16 v25, v18, v42
v_dot2c_f32_bf16 v26, v18, v50
v_dot2c_f32_bf16 v27, v18, v58
v_dot2c_f32_bf16 v28, v18, v66
v_dot2c_f32_bf16 v29, v18, v74
v_dot2c_f32_bf16 v30, v18, v82
v_dot2c_f32_bf16 v31, v18, v90
v_dot2c_f32_bf16 v24, v19, v35
v_dot2c_f32_bf16 v25, v19, v43
v_dot2c_f32_bf16 v26, v19, v51
v_dot2c_f32_bf16 v27, v19, v59
v_dot2c_f32_bf16 v28, v19, v67
v_dot2c_f32_bf16 v29, v19, v75
v_dot2c_f32_bf16 v30, v19, v83
v_dot2c_f32_bf16 v31, v19, v91
buffer_load_dwordx4 v4, s[24:27], s64 offen offset:2048 sc1 lds
v_dot2c_f32_bf16 v24, v20, v36
v_dot2c_f32_bf16 v25, v20, v44
v_dot2c_f32_bf16 v26, v20, v52
v_dot2c_f32_bf16 v27, v20, v60
v_dot2c_f32_bf16 v28, v20, v68
v_dot2c_f32_bf16 v29, v20, v76
v_dot2c_f32_bf16 v30, v20, v84
v_dot2c_f32_bf16 v31, v20, v92
v_dot2c_f32_bf16 v24, v21, v37
v_dot2c_f32_bf16 v25, v21, v45
v_dot2c_f32_bf16 v26, v21, v53
v_dot2c_f32_bf16 v27, v21, v61
v_dot2c_f32_bf16 v28, v21, v69
v_dot2c_f32_bf16 v29, v21, v77
v_dot2c_f32_bf16 v30, v21, v85
v_dot2c_f32_bf16 v31, v21, v93
v_dot2c_f32_bf16 v24, v22, v38
v_dot2c_f32_bf16 v25, v22, v46
v_dot2c_f32_bf16 v26, v22, v54
v_dot2c_f32_bf16 v27, v22, v62
v_dot2c_f32_bf16 v28, v22, v70
v_dot2c_f32_bf16 v29, v22, v78
v_dot2c_f32_bf16 v30, v22, v86
v_dot2c_f32_bf16 v31, v22, v94
v_dot2c_f32_bf16 v24, v23, v39
buffer_load_dwordx4 v4, s[24:27], s64 offen offset:3072 sc1 lds
v_dot2c_f32_bf16 v25, v23, v47
v_dot2c_f32_bf16 v26, v23, v55
v_dot2c_f32_bf16 v27, v23, v63
v_dot2c_f32_bf16 v28, v23, v71
v_dot2c_f32_bf16 v29, v23, v79
v_dot2c_f32_bf16 v30, v23, v87
v_dot2c_f32_bf16 v31, v23, v95
v_mov_b32 v9, 0xf149f2ca
v_mul_f32 v11, 0xbfb8aa3b, v11
v_exp_f32 v11, v11
v_cmp_gt_u32 vcc, 2, v5
v_cmp_gt_u32 s[56:57], 4, v5
s_nop 0
v_cndmask_b32 v25, v25, v9, vcc
v_cndmask_b32 v26, v26, v9, s[56:57]
v_cmp_gt_u32 vcc, 6, v5
v_cmp_gt_u32 s[56:57], 8, v5
s_nop 0
v_cndmask_b32 v27, v27, v9, vcc
v_cndmask_b32 v28, v28, v9, s[56:57]
v_cmp_gt_u32 vcc, 10, v5
v_cmp_gt_u32 s[56:57], 12, v5
s_nop 0
v_cndmask_b32 v29, v29, v9, vcc
v_cndmask_b32 v30, v30, v9, s[56:57]
s_mov_b32 m0, s70
s_mov_b32 s64, s68
s_add_u32 s68, s68, 49152
s_add_u32 s70, s70, 16384
s_cmp_ge_u32 s70, 163840
s_cselect_b32 s70, s80, s70
buffer_load_dwordx4 v4, s[24:27], s64 offen offset:0 sc1 lds
v_cmp_gt_u32 vcc, 14, v5
s_nop 0
s_nop 0
v_cndmask_b32 v31, v31, v9, vcc
v_max3_f32 v10, v24, v25, v26
v_max3_f32 v10, v10, v27, v28
v_max3_f32 v10, v10, v29, v30
v_max_f32 v10, v10, v31
s_mov_b32 s52, 0x3eae1a93
v_sub_f32 v24, v24, v10
v_sub_f32 v25, v25, v10
v_sub_f32 v26, v26, v10
v_sub_f32 v27, v27, v10
v_sub_f32 v28, v28, v10
v_sub_f32 v29, v29, v10
v_sub_f32 v30, v30, v10
v_sub_f32 v31, v31, v10
v_mul_f32 v24, s52, v24
v_mul_f32 v25, s52, v25
v_mul_f32 v26, s52, v26
v_mul_f32 v27, s52, v27
v_mul_f32 v28, s52, v28
v_mul_f32 v29, s52, v29
v_mul_f32 v30, s52, v30
v_mul_f32 v31, s52, v31
buffer_load_dwordx4 v4, s[24:27], s64 offen offset:1024 sc1 lds
v_exp_f32 v24, v24
v_exp_f32 v25, v25
v_exp_f32 v26, v26
v_exp_f32 v27, v27
v_exp_f32 v28, v28
v_exp_f32 v29, v29
v_exp_f32 v30, v30
v_exp_f32 v31, v31
v_cvt_pk_bf16_f32 v32, v24, 0
v_cvt_pk_bf16_f32 v40, v25, 0
v_cvt_pk_bf16_f32 v48, v26, 0
v_cvt_pk_bf16_f32 v56, v27, 0
v_cvt_pk_bf16_f32 v64, v28, 0
v_cvt_pk_bf16_f32 v72, v29, 0
v_cvt_pk_bf16_f32 v80, v30, 0
v_cvt_pk_bf16_f32 v88, v31, 0
v_lshlrev_b32 v33, 16, v32
v_lshlrev_b32 v41, 16, v40
v_lshlrev_b32 v49, 16, v48
v_lshlrev_b32 v57, 16, v56
v_lshlrev_b32 v65, 16, v64
v_lshlrev_b32 v73, 16, v72
v_lshlrev_b32 v81, 16, v80
v_lshlrev_b32 v89, 16, v88
v_add_f32 v10, v33, v41
s_waitcnt vmcnt(6)
buffer_atomic_add v1, v0, s[24:27], s74 offen offset:0 sc1
buffer_load_dwordx4 v4, s[24:27], s64 offen offset:2048 sc1 lds
v_add_f32 v10, v10, v49
v_add_f32 v10, v10, v57
v_add_f32 v10, v10, v65
v_add_f32 v10, v10, v73
v_add_f32 v10, v10, v81
v_add_f32 v10, v10, v89
v_fmac_f32 v10, v10, v11
v_rcp_f32 v10, v10
v_dot2_f32_bf16 v192, v128, v32, 0
v_dot2_f32_bf16 v193, v128, v33, 0
v_dot2_f32_bf16 v194, v129, v32, 0
v_dot2_f32_bf16 v195, v129, v33, 0
buffer_load_dwordx4 v4, s[24:27], s64 offen offset:3072 sc1 lds
v_dot2_f32_bf16 v196, v130, v32, 0
v_dot2_f32_bf16 v197, v130, v33, 0
v_dot2_f32_bf16 v198, v131, v32, 0
v_dot2_f32_bf16 v199, v131, v33, 0
v_dot2_f32_bf16 v200, v132, v32, 0
v_dot2_f32_bf16 v201, v132, v33, 0
v_dot2_f32_bf16 v202, v133, v32, 0
v_dot2_f32_bf16 v203, v133, v33, 0
v_dot2_f32_bf16 v204, v134, v32, 0
v_dot2_f32_bf16 v205, v134, v33, 0
v_dot2_f32_bf16 v206, v135, v32, 0
v_dot2_f32_bf16 v207, v135, v33, 0
s_mov_b32 m0, s70
s_mov_b32 s64, s68
s_add_u32 s68, s68, 49152
s_add_u32 s70, s70, 16384
s_cmp_ge_u32 s70, 163840
s_cselect_b32 s70, s80, s70
buffer_load_dwordx4 v4, s[24:27], s64 offen offset:0 sc1 lds
v_dot2_f32_bf16 v208, v96, v33, 0
v_dot2_f32_bf16 v209, v98, v33, 0
v_dot2c_f32_bf16 v192, v136, v40
v_dot2c_f32_bf16 v193, v136, v41
v_dot2c_f32_bf16 v194, v137, v40
v_dot2c_f32_bf16 v195, v137, v41
v_dot2c_f32_bf16 v196, v138, v40
v_dot2c_f32_bf16 v197, v138, v41
v_dot2c_f32_bf16 v198, v139, v40
v_dot2c_f32_bf16 v199, v139, v41
v_dot2c_f32_bf16 v200, v140, v40
v_dot2c_f32_bf16 v201, v140, v41
buffer_load_dwordx4 v4, s[24:27], s64 offen offset:1024 sc1 lds
v_dot2c_f32_bf16 v202, v141, v40
v_dot2c_f32_bf16 v203, v141, v41
v_dot2c_f32_bf16 v204, v142, v40
v_dot2c_f32_bf16 v205, v142, v41
v_dot2c_f32_bf16 v206, v143, v40
v_dot2c_f32_bf16 v207, v143, v41
v_dot2c_f32_bf16 v208, v100, v41
v_dot2c_f32_bf16 v209, v102, v41
v_dot2c_f32_bf16 v192, v144, v48
v_dot2c_f32_bf16 v193, v144, v49
v_dot2c_f32_bf16 v194, v145, v48
v_dot2c_f32_bf16 v195, v145, v49
buffer_load_dwordx4 v4, s[24:27], s64 offen offset:2048 sc1 lds
v_dot2c_f32_bf16 v196, v146, v48
v_dot2c_f32_bf16 v197, v146, v49
v_dot2c_f32_bf16 v198, v147, v48
v_dot2c_f32_bf16 v199, v147, v49
v_dot2c_f32_bf16 v200, v148, v48
v_dot2c_f32_bf16 v201, v148, v49
v_dot2c_f32_bf16 v202, v149, v48
v_dot2c_f32_bf16 v203, v149, v49
v_dot2c_f32_bf16 v204, v150, v48
v_dot2c_f32_bf16 v205, v150, v49
v_dot2c_f32_bf16 v206, v151, v48
v_dot2c_f32_bf16 v207, v151, v49
buffer_load_dwordx4 v4, s[24:27], s64 offen offset:3072 sc1 lds
v_dot2c_f32_bf16 v208, v104, v49
v_dot2c_f32_bf16 v209, v106, v49
v_dot2c_f32_bf16 v192, v152, v56
v_dot2c_f32_bf16 v193, v152, v57
v_dot2c_f32_bf16 v194, v153, v56
v_dot2c_f32_bf16 v195, v153, v57
v_dot2c_f32_bf16 v196, v154, v56
v_dot2c_f32_bf16 v197, v154, v57
v_dot2c_f32_bf16 v198, v155, v56
v_dot2c_f32_bf16 v199, v155, v57
v_dot2c_f32_bf16 v200, v156, v56
v_dot2c_f32_bf16 v201, v156, v57
s_mov_b32 m0, s70
s_mov_b32 s64, s68
s_add_u32 s68, s68, 49152
s_add_u32 s70, s70, 16384
s_cmp_ge_u32 s70, 163840
s_cselect_b32 s70, s80, s70
buffer_load_dwordx4 v4, s[24:27], s64 offen offset:0 sc1 lds
v_dot2c_f32_bf16 v202, v157, v56
v_dot2c_f32_bf16 v203, v157, v57
v_dot2c_f32_bf16 v204, v158, v56
v_dot2c_f32_bf16 v205, v158, v57
v_dot2c_f32_bf16 v206, v159, v56
v_dot2c_f32_bf16 v207, v159, v57
v_dot2c_f32_bf16 v208, v108, v57
v_dot2c_f32_bf16 v209, v110, v57
v_dot2c_f32_bf16 v192, v160, v64
v_dot2c_f32_bf16 v193, v160, v65
v_dot2c_f32_bf16 v194, v161, v64
v_dot2c_f32_bf16 v195, v161, v65
buffer_load_dwordx4 v4, s[24:27], s64 offen offset:1024 sc1 lds
v_dot2c_f32_bf16 v196, v162, v64
v_dot2c_f32_bf16 v197, v162, v65
v_dot2c_f32_bf16 v198, v163, v64
v_dot2c_f32_bf16 v199, v163, v65
v_dot2c_f32_bf16 v200, v164, v64
v_dot2c_f32_bf16 v201, v164, v65
v_dot2c_f32_bf16 v202, v165, v64
v_dot2c_f32_bf16 v203, v165, v65
v_dot2c_f32_bf16 v204, v166, v64
v_dot2c_f32_bf16 v205, v166, v65
v_dot2c_f32_bf16 v206, v167, v64
v_dot2c_f32_bf16 v207, v167, v65
buffer_load_dwordx4 v4, s[24:27], s64 offen offset:2048 sc1 lds
v_dot2c_f32_bf16 v208, v112, v65
v_dot2c_f32_bf16 v209, v114, v65
v_dot2c_f32_bf16 v192, v168, v72
v_dot2c_f32_bf16 v193, v168, v73
v_dot2c_f32_bf16 v194, v169, v72
v_dot2c_f32_bf16 v195, v169, v73
v_dot2c_f32_bf16 v196, v170, v72
v_dot2c_f32_bf16 v197, v170, v73
v_dot2c_f32_bf16 v198, v171, v72
v_dot2c_f32_bf16 v199, v171, v73
v_dot2c_f32_bf16 v200, v172, v72
v_dot2c_f32_bf16 v201, v172, v73
buffer_load_dword v12, v13, s[24:27], s75 offen sc1
v_dot2c_f32_bf16 v202, v173, v72
v_dot2c_f32_bf16 v203, v173, v73
v_dot2c_f32_bf16 v204, v174, v72
v_dot2c_f32_bf16 v205, v174, v73
v_dot2c_f32_bf16 v206, v175, v72
v_dot2c_f32_bf16 v207, v175, v73
v_dot2c_f32_bf16 v208, v116, v73
v_dot2c_f32_bf16 v209, v118, v73
v_dot2c_f32_bf16 v192, v176, v80
v_dot2c_f32_bf16 v193, v176, v81
v_dot2c_f32_bf16 v194, v177, v80
v_dot2c_f32_bf16 v195, v177, v81
buffer_load_dwordx4 v4, s[24:27], s64 offen offset:3072 sc1 lds
v_dot2c_f32_bf16 v196, v178, v80
v_dot2c_f32_bf16 v197, v178, v81
v_dot2c_f32_bf16 v198, v179, v80
v_dot2c_f32_bf16 v199, v179, v81
v_dot2c_f32_bf16 v200, v180, v80
v_dot2c_f32_bf16 v201, v180, v81
v_dot2c_f32_bf16 v202, v181, v80
v_dot2c_f32_bf16 v203, v181, v81
v_dot2c_f32_bf16 v204, v182, v80
v_dot2c_f32_bf16 v205, v182, v81
v_dot2c_f32_bf16 v206, v183, v80
v_dot2c_f32_bf16 v207, v183, v81
s_mov_b32 m0, s70
s_mov_b32 s64, s68
s_add_u32 s68, s68, 49152
s_add_u32 s70, s70, 16384
s_cmp_ge_u32 s70, 163840
s_cselect_b32 s70, s80, s70
buffer_load_dwordx4 v4, s[24:27], s64 offen offset:0 sc1 lds
v_dot2c_f32_bf16 v208, v120, v81
v_dot2c_f32_bf16 v209, v122, v81
v_dot2c_f32_bf16 v192, v184, v88
v_dot2c_f32_bf16 v193, v184, v89
v_dot2c_f32_bf16 v194, v185, v88
v_dot2c_f32_bf16 v195, v185, v89
v_dot2c_f32_bf16 v196, v186, v88
v_dot2c_f32_bf16 v197, v186, v89
v_dot2c_f32_bf16 v198, v187, v88
v_dot2c_f32_bf16 v199, v187, v89
v_dot2c_f32_bf16 v200, v188, v88
v_dot2c_f32_bf16 v201, v188, v89
buffer_load_dwordx4 v4, s[24:27], s64 offen offset:1024 sc1 lds
v_dot2c_f32_bf16 v202, v189, v88
v_dot2c_f32_bf16 v203, v189, v89
v_dot2c_f32_bf16 v204, v190, v88
v_dot2c_f32_bf16 v205, v190, v89
v_dot2c_f32_bf16 v206, v191, v88
v_dot2c_f32_bf16 v207, v191, v89
v_dot2c_f32_bf16 v208, v124, v89
v_dot2c_f32_bf16 v209, v126, v89
v_bfe_u32 v9, v5, 5, 2
v_mul_u32_u24 v9, 540672, v9
v_lshrrev_b32 v11, 7, v5
v_lshl_add_u32 v9, v11, 22, v9
buffer_load_dwordx4 v4, s[24:27], s64 offen offset:2048 sc1 lds
v_and_b32 v11, 1, v3
v_lshl_add_u32 v9, v11, 10, v9
v_lshl_add_u32 v9, v2, 4, v9
v_mul_f32 v192, v10, v192
v_mul_f32 v193, v10, v193
v_mul_f32 v194, v10, v194
v_mul_f32 v195, v10, v195
v_mul_f32 v196, v10, v196
v_mul_f32 v197, v10, v197
v_mul_f32 v198, v10, v198
v_mul_f32 v199, v10, v199
v_mul_f32 v200, v10, v200
buffer_load_dwordx4 v4, s[24:27], s64 offen offset:3072 sc1 lds
v_mul_f32 v201, v10, v201
v_mul_f32 v202, v10, v202
v_mul_f32 v203, v10, v203
v_mul_f32 v204, v10, v204
v_mul_f32 v205, v10, v205
v_mul_f32 v206, v10, v206
v_mul_f32 v207, v10, v207
v_mul_f32 v208, v10, v208
v_mul_f32 v209, v10, v209
v_cvt_pk_bf16_f32 v192, v192, v193
v_cvt_pk_bf16_f32 v193, v194, v195
v_cvt_pk_bf16_f32 v194, v196, v197
v_cvt_pk_bf16_f32 v195, v198, v199
v_cvt_pk_bf16_f32 v196, v200, v201
v_cvt_pk_bf16_f32 v197, v202, v203
v_cvt_pk_bf16_f32 v198, v204, v205
v_cvt_pk_bf16_f32 v199, v206, v207
v_cvt_pk_bf16_f32 v200, v208, v209
s_add_u32 s53, s53, 196608
s_bfe_u32 s54, s4, 131073
s_lshl_b32 s54, s54, 11
s_add_u32 s54, s54, s53
s_and_b32 s55, s4, 1
s_lshl_b32 s55, s55, 9
s_add_u32 s54, s54, s55
s_lshl2_add_u32 s52, s85, s86
s_lshl2_add_u32 s69, s52, s3
s_mul_i32 s69, s69, 28672
s_add_u32 s69, s69, 168820736
s_lshr_b32 s73, s52, 1
s_lshl_b32 s73, s73, 10
s_and_b32 s52, s52, 1
s_lshl_b32 s52, s52, 7
s_add_u32 s73, s73, s52
s_lshl2_add_u32 s73, s3, s73
s_add_u32 s73, s73, 167772800
ds_read_b128 v[144:147], v7 offset:0
ds_read_b128 v[148:151], v7 offset:1024
ds_read_b128 v[152:155], v7 offset:2048
ds_read_b128 v[156:159], v7 offset:3072
ds_read_b128 v[160:163], v7 offset:4096
ds_read_b128 v[164:167], v7 offset:5120
v_mov_b32 v10, 0
s_waitcnt vmcnt(5)
v_cmp_gt_u32 vcc, 8, v12
s_mov_b32 s92, 0
s_nop 3
s_cbranch_vccz L_ZBX
L_ZB:
s_sleep 2
buffer_load_dword v12, v13, s[24:27], s75 offen sc1
s_add_u32 s92, s92, 1
s_waitcnt vmcnt(0)
v_cmp_gt_u32 vcc, 8, v12
s_cmp_gt_u32 s92, 0x20000
s_cbranch_scc1 L_ZBX
s_nop 2
s_cbranch_vccnz L_ZB
L_ZBX:
s_xor_b32 s65, s82, 0
s_mul_i32 s65, s65, 24576
s_add_u32 s65, s65, s77
buffer_load_dwordx4 a[0:3], v4, s[24:27], s65 offen offset:0 sc1
s_xor_b32 s93, s82, 0
s_mul_i32 s93, s93, 24576
s_add_u32 s93, s93, s81
buffer_load_dwordx4 a[4:7], v4, s[24:27], s93 offen offset:0 sc1
buffer_load_dwordx4 a[8:11], v4, s[24:27], s65 offen offset:2048 sc1
buffer_load_dwordx4 a[12:15], v4, s[24:27], s93 offen offset:2048 sc1
buffer_load_dwordx4 a[16:19], v14, s[24:27], s65 offen offset:0 sc1
buffer_load_dwordx4 a[20:23], v14, s[24:27], s93 offen offset:0 sc1
buffer_load_dwordx4 a[24:27], v14, s[24:27], s65 offen offset:2048 sc1
buffer_load_dwordx4 a[28:31], v14, s[24:27], s93 offen offset:2048 sc1
buffer_store_dwordx4 v[192:195], v9, s[24:27], s54 offen sc1
buffer_store_dwordx4 v[196:199], v9, s[24:27], s54 offen offset:256 sc1
s_bfe_u32 s55, s4, 65538
s_lshl_b32 s55, s55, 8
s_add_u32 s54, s53, s55
s_and_b32 s55, s4, 3
s_lshl2_add_u32 s54, s55, s54
s_add_u32 s54, s54, 24576
buffer_store_dword v200, v9, s[24:27], s54 offen sc1
s_waitcnt vmcnt(9) lgkmcnt(4)
v_mfma_f32_16x16x32_bf16 v[120:123], v[144:147], a[0:3], 0
s_add_u32 s91, s91, 16384
ds_read_b128 v[168:171], v7 offset:6144
v_mfma_f32_16x16x32_bf16 v[124:127], v[144:147], a[4:7], 0
s_xor_b32 s65, s82, 1
s_mul_i32 s65, s65, 24576
s_add_u32 s65, s65, s77
v_mfma_f32_16x16x32_bf16 v[72:75], v[148:151], a[0:3], 0
s_waitcnt lgkmcnt(3)
ds_read_b128 v[172:175], v7 offset:7168
v_mfma_f32_16x16x32_bf16 v[76:79], v[148:151], a[4:7], 0
buffer_load_dwordx4 a[32:35], v4, s[24:27], s65 offen offset:0 sc1
v_mfma_f32_16x16x32_bf16 v[80:83], v[152:155], a[0:3], 0
s_xor_b32 s93, s82, 1
s_mul_i32 s93, s93, 24576
s_add_u32 s93, s93, s81
v_mfma_f32_16x16x32_bf16 v[84:87], v[152:155], a[4:7], 0
s_cmp_ge_u32 s91, 163840
s_cselect_b32 s91, 0, s91
ds_read_b128 v[144:147], v7 offset:8192
v_mfma_f32_16x16x32_bf16 v[88:91], v[156:159], a[0:3], 0
buffer_load_dwordx4 a[36:39], v4, s[24:27], s93 offen offset:0 sc1
v_mfma_f32_16x16x32_bf16 v[92:95], v[156:159], a[4:7], 0
s_waitcnt lgkmcnt(3)
ds_read_b128 v[148:151], v7 offset:9216
v_add_u32 v8, s91, v4
v_mfma_f32_16x16x32_bf16 v[96:99], v[160:163], a[0:3], 0
ds_read_b128 v[152:155], v7 offset:10240
v_mfma_f32_16x16x32_bf16 v[100:103], v[160:163], a[4:7], 0
ds_read_b128 v[156:159], v7 offset:11264
v_mfma_f32_16x16x32_bf16 v[104:107], v[164:167], a[0:3], 0
buffer_load_dwordx4 a[40:43], v4, s[24:27], s65 offen offset:2048 sc1
v_mfma_f32_16x16x32_bf16 v[108:111], v[164:167], a[4:7], 0
s_waitcnt lgkmcnt(4)
ds_read_b128 v[160:163], v7 offset:12288
v_mfma_f32_16x16x32_bf16 v[112:115], v[168:171], a[0:3], 0
s_waitcnt vmcnt(10)
ds_read_b128 v[164:167], v7 offset:13312
v_mfma_f32_16x16x32_bf16 v[116:119], v[168:171], a[4:7], 0
buffer_load_dwordx4 a[44:47], v4, s[24:27], s93 offen offset:2048 sc1
v_mfma_f32_16x16x32_bf16 v[120:123], v[172:175], a[8:11], v[120:123]
ds_read_b128 v[168:171], v7 offset:14336
v_mfma_f32_16x16x32_bf16 v[124:127], v[172:175], a[12:15], v[124:127]
s_waitcnt lgkmcnt(5)
v_mfma_f32_16x16x32_bf16 v[72:75], v[144:147], a[8:11], v[72:75]
ds_read_b128 v[172:175], v7 offset:15360
v_mfma_f32_16x16x32_bf16 v[76:79], v[144:147], a[12:15], v[76:79]
s_add_u32 s91, s91, 16384
s_cmp_ge_u32 s91, 163840
s_cselect_b32 s91, 0, s91
v_mfma_f32_16x16x32_bf16 v[80:83], v[148:151], a[8:11], v[80:83]
ds_read_b128 v[144:147], v8 offset:0
v_add_u32 v7, s91, v4
v_mfma_f32_16x16x32_bf16 v[84:87], v[148:151], a[12:15], v[84:87]
s_waitcnt lgkmcnt(5)
v_mfma_f32_16x16x32_bf16 v[88:91], v[152:155], a[8:11], v[88:91]
ds_read_b128 v[148:151], v8 offset:1024
v_mfma_f32_16x16x32_bf16 v[92:95], v[152:155], a[12:15], v[92:95]
v_mfma_f32_16x16x32_bf16 v[96:99], v[156:159], a[8:11], v[96:99]
buffer_load_dwordx4 a[48:51], v14, s[24:27], s65 offen offset:0 sc1
v_mfma_f32_16x16x32_bf16 v[100:103], v[156:159], a[12:15], v[100:103]
s_waitcnt lgkmcnt(4)
ds_read_b128 v[152:155], v8 offset:2048
v_mfma_f32_16x16x32_bf16 v[104:107], v[160:163], a[8:11], v[104:107]
ds_read_b128 v[156:159], v8 offset:3072
v_mfma_f32_16x16x32_bf16 v[108:111], v[160:163], a[12:15], v[108:111]
buffer_load_dwordx4 a[52:55], v14, s[24:27], s93 offen offset:0 sc1
v_mfma_f32_16x16x32_bf16 v[112:115], v[164:167], a[8:11], v[112:115]
ds_read_b128 v[160:163], v8 offset:4096
v_mfma_f32_16x16x32_bf16 v[116:119], v[164:167], a[12:15], v[116:119]
s_waitcnt lgkmcnt(5) vmcnt(11)
v_mfma_f32_16x16x32_bf16 v[120:123], v[168:171], a[16:19], v[120:123]
ds_read_b128 v[164:167], v8 offset:5120
v_mfma_f32_16x16x32_bf16 v[124:127], v[168:171], a[20:23], v[124:127]
v_mfma_f32_16x16x32_bf16 v[72:75], v[172:175], a[16:19], v[72:75]
ds_read_b128 v[168:171], v8 offset:6144
v_mfma_f32_16x16x32_bf16 v[76:79], v[172:175], a[20:23], v[76:79]
s_waitcnt lgkmcnt(5)
v_mfma_f32_16x16x32_bf16 v[80:83], v[144:147], a[16:19], v[80:83]
buffer_load_dwordx4 a[56:59], v14, s[24:27], s65 offen offset:2048 sc1
v_mfma_f32_16x16x32_bf16 v[84:87], v[144:147], a[20:23], v[84:87]
ds_read_b128 v[172:175], v8 offset:7168
v_mfma_f32_16x16x32_bf16 v[88:91], v[148:151], a[16:19], v[88:91]
ds_read_b128 v[144:147], v8 offset:8192
v_mfma_f32_16x16x32_bf16 v[92:95], v[148:151], a[20:23], v[92:95]
s_waitcnt lgkmcnt(5)
v_mfma_f32_16x16x32_bf16 v[96:99], v[152:155], a[16:19], v[96:99]
ds_read_b128 v[148:151], v8 offset:9216
v_mfma_f32_16x16x32_bf16 v[100:103], v[152:155], a[20:23], v[100:103]
buffer_load_dwordx4 a[60:63], v14, s[24:27], s93 offen offset:2048 sc1
v_mfma_f32_16x16x32_bf16 v[104:107], v[156:159], a[16:19], v[104:107]
ds_read_b128 v[152:155], v8 offset:10240
v_mfma_f32_16x16x32_bf16 v[108:111], v[156:159], a[20:23], v[108:111]
s_waitcnt lgkmcnt(5)
v_mfma_f32_16x16x32_bf16 v[112:115], v[160:163], a[16:19], v[112:115]
s_xor_b32 s65, s82, 2
s_mul_i32 s65, s65, 24576
s_add_u32 s65, s65, s77
v_mfma_f32_16x16x32_bf16 v[116:119], v[160:163], a[20:23], v[116:119]
s_waitcnt vmcnt(11)
ds_read_b128 v[156:159], v8 offset:11264
v_mfma_f32_16x16x32_bf16 v[120:123], v[164:167], a[24:27], v[120:123]
buffer_load_dwordx4 a[64:67], v4, s[24:27], s65 offen offset:0 sc1
v_mfma_f32_16x16x32_bf16 v[124:127], v[164:167], a[28:31], v[124:127]
s_waitcnt lgkmcnt(4)
ds_read_b128 v[160:163], v8 offset:12288
v_mfma_f32_16x16x32_bf16 v[72:75], v[168:171], a[24:27], v[72:75]
ds_read_b128 v[164:167], v8 offset:13312
v_mfma_f32_16x16x32_bf16 v[76:79], v[168:171], a[28:31], v[76:79]
s_xor_b32 s93, s82, 2
s_mul_i32 s93, s93, 24576
s_add_u32 s93, s93, s81
v_mfma_f32_16x16x32_bf16 v[80:83], v[172:175], a[24:27], v[80:83]
s_waitcnt lgkmcnt(4)
ds_read_b128 v[168:171], v8 offset:14336
v_mfma_f32_16x16x32_bf16 v[84:87], v[172:175], a[28:31], v[84:87]
buffer_load_dwordx4 a[68:71], v4, s[24:27], s93 offen offset:0 sc1
v_mfma_f32_16x16x32_bf16 v[88:91], v[144:147], a[24:27], v[88:91]
ds_read_b128 v[172:175], v8 offset:15360
v_mfma_f32_16x16x32_bf16 v[92:95], v[144:147], a[28:31], v[92:95]
s_barrier
v_mfma_f32_16x16x32_bf16 v[96:99], v[148:151], a[24:27], v[96:99]
s_add_u32 s91, s91, 16384
ds_read_b128 v[144:147], v7 offset:0
v_mfma_f32_16x16x32_bf16 v[100:103], v[148:151], a[28:31], v[100:103]
s_waitcnt lgkmcnt(5)
s_cmp_ge_u32 s91, 163840
s_cselect_b32 s91, 0, s91
v_mfma_f32_16x16x32_bf16 v[104:107], v[152:155], a[24:27], v[104:107]
buffer_load_dwordx4 a[72:75], v4, s[24:27], s65 offen offset:2048 sc1
v_mfma_f32_16x16x32_bf16 v[108:111], v[152:155], a[28:31], v[108:111]
ds_read_b128 v[148:151], v7 offset:1024
v_add_u32 v8, s91, v4
v_mfma_f32_16x16x32_bf16 v[112:115], v[156:159], a[24:27], v[112:115]
ds_read_b128 v[152:155], v7 offset:2048
v_mfma_f32_16x16x32_bf16 v[116:119], v[156:159], a[28:31], v[116:119]
s_waitcnt lgkmcnt(5) vmcnt(9)
v_mfma_f32_16x16x32_bf16 v[120:123], v[160:163], a[32:35], v[120:123]
s_waitcnt vmcnt(11)
ds_read_b128 v[156:159], v7 offset:3072
v_mfma_f32_16x16x32_bf16 v[124:127], v[160:163], a[36:39], v[124:127]
buffer_atomic_add v1, v0, s[24:27], s74 offen offset:4 sc1
v_mfma_f32_16x16x32_bf16 v[72:75], v[164:167], a[32:35], v[72:75]
buffer_load_dwordx4 a[76:79], v4, s[24:27], s93 offen offset:2048 sc1
v_mfma_f32_16x16x32_bf16 v[76:79], v[164:167], a[36:39], v[76:79]
s_waitcnt lgkmcnt(4)
ds_read_b128 v[160:163], v7 offset:4096
v_mfma_f32_16x16x32_bf16 v[80:83], v[168:171], a[32:35], v[80:83]
ds_read_b128 v[164:167], v7 offset:5120
v_mfma_f32_16x16x32_bf16 v[84:87], v[168:171], a[36:39], v[84:87]
v_mfma_f32_16x16x32_bf16 v[88:91], v[172:175], a[32:35], v[88:91]
s_waitcnt lgkmcnt(4)
ds_read_b128 v[168:171], v7 offset:6144
v_mfma_f32_16x16x32_bf16 v[92:95], v[172:175], a[36:39], v[92:95]
buffer_load_dwordx4 a[80:83], v14, s[24:27], s65 offen offset:0 sc1
v_mfma_f32_16x16x32_bf16 v[96:99], v[144:147], a[32:35], v[96:99]
ds_read_b128 v[172:175], v7 offset:7168
v_mfma_f32_16x16x32_bf16 v[100:103], v[144:147], a[36:39], v[100:103]
v_mfma_f32_16x16x32_bf16 v[104:107], v[148:151], a[32:35], v[104:107]
ds_read_b128 v[144:147], v7 offset:8192
v_mfma_f32_16x16x32_bf16 v[108:111], v[148:151], a[36:39], v[108:111]
s_waitcnt lgkmcnt(5)
v_mfma_f32_16x16x32_bf16 v[112:115], v[152:155], a[32:35], v[112:115]
buffer_load_dwordx4 a[84:87], v14, s[24:27], s93 offen offset:0 sc1
v_mfma_f32_16x16x32_bf16 v[116:119], v[152:155], a[36:39], v[116:119]
s_waitcnt vmcnt(11)
ds_read_b128 v[148:151], v7 offset:9216
v_mfma_f32_16x16x32_bf16 v[120:123], v[156:159], a[40:43], v[120:123]
ds_read_b128 v[152:155], v7 offset:10240
v_mfma_f32_16x16x32_bf16 v[124:127], v[156:159], a[44:47], v[124:127]
s_waitcnt lgkmcnt(5)
v_mfma_f32_16x16x32_bf16 v[72:75], v[160:163], a[40:43], v[72:75]
ds_read_b128 v[156:159], v7 offset:11264
v_mfma_f32_16x16x32_bf16 v[76:79], v[160:163], a[44:47], v[76:79]
buffer_load_dwordx4 a[88:91], v14, s[24:27], s65 offen offset:2048 sc1
v_mfma_f32_16x16x32_bf16 v[80:83], v[164:167], a[40:43], v[80:83]
ds_read_b128 v[160:163], v7 offset:12288
v_mfma_f32_16x16x32_bf16 v[84:87], v[164:167], a[44:47], v[84:87]
s_waitcnt lgkmcnt(5)
v_mfma_f32_16x16x32_bf16 v[88:91], v[168:171], a[40:43], v[88:91]
ds_read_b128 v[164:167], v7 offset:13312
v_mfma_f32_16x16x32_bf16 v[92:95], v[168:171], a[44:47], v[92:95]
v_mfma_f32_16x16x32_bf16 v[96:99], v[172:175], a[40:43], v[96:99]
buffer_load_dwordx4 a[92:95], v14, s[24:27], s93 offen offset:2048 sc1
v_mfma_f32_16x16x32_bf16 v[100:103], v[172:175], a[44:47], v[100:103]
s_waitcnt lgkmcnt(4)
ds_read_b128 v[168:171], v7 offset:14336
v_mfma_f32_16x16x32_bf16 v[104:107], v[144:147], a[40:43], v[104:107]
ds_read_b128 v[172:175], v7 offset:15360
v_mfma_f32_16x16x32_bf16 v[108:111], v[144:147], a[44:47], v[108:111]
s_xor_b32 s65, s82, 3
s_mul_i32 s65, s65, 24576
s_add_u32 s65, s65, s77
v_mfma_f32_16x16x32_bf16 v[112:115], v[148:151], a[40:43], v[112:115]
s_waitcnt lgkmcnt(4) vmcnt(11)
s_add_u32 s91, s91, 16384
ds_read_b128 v[144:147], v8 offset:0
v_mfma_f32_16x16x32_bf16 v[116:119], v[148:151], a[44:47], v[116:119]
buffer_load_dwordx4 a[96:99], v4, s[24:27], s65 offen offset:0 sc1
v_mfma_f32_16x16x32_bf16 v[120:123], v[152:155], a[48:51], v[120:123]
s_cmp_ge_u32 s91, 163840
s_cselect_b32 s91, 0, s91
ds_read_b128 v[148:151], v8 offset:1024
v_mfma_f32_16x16x32_bf16 v[124:127], v[152:155], a[52:55], v[124:127]
v_add_u32 v7, s91, v4
v_mfma_f32_16x16x32_bf16 v[72:75], v[156:159], a[48:51], v[72:75]
s_xor_b32 s93, s82, 3
s_mul_i32 s93, s93, 24576
s_add_u32 s93, s93, s81
v_mfma_f32_16x16x32_bf16 v[76:79], v[156:159], a[52:55], v[76:79]
s_waitcnt lgkmcnt(4)
ds_read_b128 v[152:155], v8 offset:2048
v_mfma_f32_16x16x32_bf16 v[80:83], v[160:163], a[48:51], v[80:83]
buffer_load_dwordx4 a[100:103], v4, s[24:27], s93 offen offset:0 sc1
v_mfma_f32_16x16x32_bf16 v[84:87], v[160:163], a[52:55], v[84:87]
ds_read_b128 v[156:159], v8 offset:3072
v_mfma_f32_16x16x32_bf16 v[88:91], v[164:167], a[48:51], v[88:91]
ds_read_b128 v[160:163], v8 offset:4096
v_mfma_f32_16x16x32_bf16 v[92:95], v[164:167], a[52:55], v[92:95]
s_waitcnt lgkmcnt(5)
v_mfma_f32_16x16x32_bf16 v[96:99], v[168:171], a[48:51], v[96:99]
ds_read_b128 v[164:167], v8 offset:5120
v_mfma_f32_16x16x32_bf16 v[100:103], v[168:171], a[52:55], v[100:103]
buffer_load_dwordx4 a[104:107], v4, s[24:27], s65 offen offset:2048 sc1
v_mfma_f32_16x16x32_bf16 v[104:107], v[172:175], a[48:51], v[104:107]
ds_read_b128 v[168:171], v8 offset:6144
v_mfma_f32_16x16x32_bf16 v[108:111], v[172:175], a[52:55], v[108:111]
s_waitcnt lgkmcnt(5)
v_mfma_f32_16x16x32_bf16 v[112:115], v[144:147], a[48:51], v[112:115]
ds_read_b128 v[172:175], v8 offset:7168
v_mfma_f32_16x16x32_bf16 v[116:119], v[144:147], a[52:55], v[116:119]
s_waitcnt vmcnt(12)
v_mfma_f32_16x16x32_bf16 v[120:123], v[148:151], a[56:59], v[120:123]
buffer_load_dwordx4 a[108:111], v4, s[24:27], s93 offen offset:2048 sc1
v_mfma_f32_16x16x32_bf16 v[124:127], v[148:151], a[60:63], v[124:127]
s_waitcnt lgkmcnt(4)
ds_read_b128 v[144:147], v8 offset:8192
v_mfma_f32_16x16x32_bf16 v[72:75], v[152:155], a[56:59], v[72:75]
s_add_u32 s52, s84, 1
ds_read_b128 v[148:151], v8 offset:9216
v_mfma_f32_16x16x32_bf16 v[76:79], v[152:155], a[60:63], v[76:79]
v_mfma_f32_16x16x32_bf16 v[80:83], v[156:159], a[56:59], v[80:83]
ds_read_b128 v[152:155], v8 offset:10240
v_mfma_f32_16x16x32_bf16 v[84:87], v[156:159], a[60:63], v[84:87]
s_and_b32 s52, s52, 3
s_waitcnt lgkmcnt(5)
v_mfma_f32_16x16x32_bf16 v[88:91], v[160:163], a[56:59], v[88:91]
buffer_load_dwordx4 a[112:115], v14, s[24:27], s65 offen offset:0 sc1
v_mfma_f32_16x16x32_bf16 v[92:95], v[160:163], a[60:63], v[92:95]
ds_read_b128 v[156:159], v8 offset:11264
v_mfma_f32_16x16x32_bf16 v[96:99], v[164:167], a[56:59], v[96:99]
s_mul_i32 s52, s52, 6144
ds_read_b128 v[160:163], v8 offset:12288
v_mfma_f32_16x16x32_bf16 v[100:103], v[164:167], a[60:63], v[100:103]
s_waitcnt lgkmcnt(5)
v_mfma_f32_16x16x32_bf16 v[104:107], v[168:171], a[56:59], v[104:107]
buffer_load_dwordx4 a[116:119], v14, s[24:27], s93 offen offset:0 sc1
v_mfma_f32_16x16x32_bf16 v[108:111], v[168:171], a[60:63], v[108:111]
s_add_u32 s52, s52, s69
ds_read_b128 v[164:167], v8 offset:13312
v_mfma_f32_16x16x32_bf16 v[112:115], v[172:175], a[56:59], v[112:115]
ds_read_b128 v[168:171], v8 offset:14336
v_mfma_f32_16x16x32_bf16 v[116:119], v[172:175], a[60:63], v[116:119]
s_waitcnt lgkmcnt(5) vmcnt(13)
v_mfma_f32_16x16x32_bf16 v[120:123], v[144:147], a[64:67], v[120:123]
s_waitcnt vmcnt(52)
s_add_u32 s52, s52, 0
ds_read_b128 v[172:175], v8 offset:15360
v_mfma_f32_16x16x32_bf16 v[124:127], v[144:147], a[68:71], v[124:127]
s_barrier
v_mfma_f32_16x16x32_bf16 v[72:75], v[148:151], a[64:67], v[72:75]
buffer_load_dwordx4 a[120:123], v14, s[24:27], s65 offen offset:2048 sc1
v_mfma_f32_16x16x32_bf16 v[76:79], v[148:151], a[68:71], v[76:79]
s_add_u32 s53, s84, 2
s_waitcnt lgkmcnt(4)
ds_read_b128 v[144:147], v7 offset:0
v_mfma_f32_16x16x32_bf16 v[80:83], v[152:155], a[64:67], v[80:83]
s_add_u32 s91, s91, 16384
ds_read_b128 v[148:151], v7 offset:1024
v_mfma_f32_16x16x32_bf16 v[84:87], v[152:155], a[68:71], v[84:87]
s_cmp_ge_u32 s91, 163840
s_cselect_b32 s91, 0, s91
v_add_u32 v8, s91, v4
v_mfma_f32_16x16x32_bf16 v[88:91], v[156:159], a[64:67], v[88:91]
s_and_b32 s53, s53, 3
s_waitcnt lgkmcnt(4)
ds_read_b128 v[152:155], v7 offset:2048
v_mfma_f32_16x16x32_bf16 v[92:95], v[156:159], a[68:71], v[92:95]
buffer_load_dwordx4 a[124:127], v14, s[24:27], s93 offen offset:2048 sc1
v_mfma_f32_16x16x32_bf16 v[96:99], v[160:163], a[64:67], v[96:99]
ds_read_b128 v[156:159], v7 offset:3072
v_mfma_f32_16x16x32_bf16 v[100:103], v[160:163], a[68:71], v[100:103]
s_mul_i32 s53, s53, 6144
v_mfma_f32_16x16x32_bf16 v[104:107], v[164:167], a[64:67], v[104:107]
s_xor_b32 s65, s82, 4
s_mul_i32 s65, s65, 24576
s_add_u32 s65, s65, s77
v_mfma_f32_16x16x32_bf16 v[108:111], v[164:167], a[68:71], v[108:111]
s_waitcnt lgkmcnt(4)
ds_read_b128 v[160:163], v7 offset:4096
v_mfma_f32_16x16x32_bf16 v[112:115], v[168:171], a[64:67], v[112:115]
s_add_u32 s53, s53, s69
s_waitcnt vmcnt(12)
ds_read_b128 v[164:167], v7 offset:5120
v_mfma_f32_16x16x32_bf16 v[116:119], v[168:171], a[68:71], v[116:119]
buffer_load_dwordx4 a[128:131], v4, s[24:27], s65 offen offset:0 sc1
v_mfma_f32_16x16x32_bf16 v[120:123], v[172:175], a[72:75], v[120:123]
ds_read_b128 v[168:171], v7 offset:6144
v_mfma_f32_16x16x32_bf16 v[124:127], v[172:175], a[76:79], v[124:127]
s_add_u32 s53, s53, 2048
s_waitcnt lgkmcnt(5)
v_mfma_f32_16x16x32_bf16 v[72:75], v[144:147], a[72:75], v[72:75]
s_xor_b32 s93, s82, 4
s_mul_i32 s93, s93, 24576
s_add_u32 s93, s93, s81
v_mfma_f32_16x16x32_bf16 v[76:79], v[144:147], a[76:79], v[76:79]
buffer_load_dwordx4 a[132:135], v4, s[24:27], s93 offen offset:0 sc1
v_mfma_f32_16x16x32_bf16 v[80:83], v[148:151], a[72:75], v[80:83]
s_add_u32 s54, s84, 3
ds_read_b128 v[172:175], v7 offset:7168
v_mfma_f32_16x16x32_bf16 v[84:87], v[148:151], a[76:79], v[84:87]
s_waitcnt lgkmcnt(4)
ds_read_b128 v[144:147], v7 offset:8192
v_mfma_f32_16x16x32_bf16 v[88:91], v[152:155], a[72:75], v[88:91]
ds_read_b128 v[148:151], v7 offset:9216
v_mfma_f32_16x16x32_bf16 v[92:95], v[152:155], a[76:79], v[92:95]
s_and_b32 s54, s54, 3
v_mfma_f32_16x16x32_bf16 v[96:99], v[156:159], a[72:75], v[96:99]
buffer_load_dwordx4 a[136:139], v4, s[24:27], s65 offen offset:2048 sc1
v_mfma_f32_16x16x32_bf16 v[100:103], v[156:159], a[76:79], v[100:103]
s_waitcnt lgkmcnt(4)
ds_read_b128 v[152:155], v7 offset:10240
v_mfma_f32_16x16x32_bf16 v[104:107], v[160:163], a[72:75], v[104:107]
s_mul_i32 s54, s54, 6144
ds_read_b128 v[156:159], v7 offset:11264
v_mfma_f32_16x16x32_bf16 v[108:111], v[160:163], a[76:79], v[108:111]
v_mfma_f32_16x16x32_bf16 v[112:115], v[164:167], a[72:75], v[112:115]
ds_read_b128 v[160:163], v7 offset:12288
v_mfma_f32_16x16x32_bf16 v[116:119], v[164:167], a[76:79], v[116:119]
s_add_u32 s54, s54, s69
s_waitcnt lgkmcnt(5) vmcnt(13)
v_mfma_f32_16x16x32_bf16 v[120:123], v[168:171], a[80:83], v[120:123]
buffer_load_dwordx4 a[140:143], v4, s[24:27], s93 offen offset:2048 sc1
v_mfma_f32_16x16x32_bf16 v[124:127], v[168:171], a[84:87], v[124:127]
ds_read_b128 v[164:167], v7 offset:13312
v_mfma_f32_16x16x32_bf16 v[72:75], v[172:175], a[80:83], v[72:75]
s_add_u32 s54, s54, 4096
ds_read_b128 v[168:171], v7 offset:14336
v_mfma_f32_16x16x32_bf16 v[76:79], v[172:175], a[84:87], v[76:79]
s_waitcnt lgkmcnt(5)
v_mfma_f32_16x16x32_bf16 v[80:83], v[144:147], a[80:83], v[80:83]
buffer_load_dwordx4 a[144:147], v14, s[24:27], s65 offen offset:0 sc1
v_mfma_f32_16x16x32_bf16 v[84:87], v[144:147], a[84:87], v[84:87]
s_sub_u32 s55, s3, s84
ds_read_b128 v[172:175], v7 offset:15360
v_mfma_f32_16x16x32_bf16 v[88:91], v[148:151], a[80:83], v[88:91]
s_add_u32 s91, s91, 16384
ds_read_b128 v[144:147], v8 offset:0
v_mfma_f32_16x16x32_bf16 v[92:95], v[148:151], a[84:87], v[92:95]
s_waitcnt lgkmcnt(5)
s_cmp_ge_u32 s91, 163840
s_cselect_b32 s91, 0, s91
v_mfma_f32_16x16x32_bf16 v[96:99], v[152:155], a[80:83], v[96:99]
s_and_b32 s55, s55, 3
ds_read_b128 v[148:151], v8 offset:1024
v_add_u32 v7, s91, v4
v_mfma_f32_16x16x32_bf16 v[100:103], v[152:155], a[84:87], v[100:103]
buffer_load_dwordx4 a[148:151], v14, s[24:27], s93 offen offset:0 sc1
v_mfma_f32_16x16x32_bf16 v[104:107], v[156:159], a[80:83], v[104:107]
ds_read_b128 v[152:155], v8 offset:2048
v_mfma_f32_16x16x32_bf16 v[108:111], v[156:159], a[84:87], v[108:111]
s_lshl_b32 s55, s55, 10
s_waitcnt lgkmcnt(5)
v_mfma_f32_16x16x32_bf16 v[112:115], v[160:163], a[80:83], v[112:115]
ds_read_b128 v[156:159], v8 offset:3072
v_mfma_f32_16x16x32_bf16 v[116:119], v[160:163], a[84:87], v[116:119]
s_waitcnt vmcnt(14)
v_mfma_f32_16x16x32_bf16 v[120:123], v[164:167], a[88:91], v[120:123]
s_add_u32 s55, s55, s69
s_waitcnt lgkmcnt(4)
ds_read_b128 v[160:163], v8 offset:4096
v_mfma_f32_16x16x32_bf16 v[124:127], v[164:167], a[92:95], v[124:127]
buffer_load_dwordx4 a[152:155], v14, s[24:27], s65 offen offset:2048 sc1
v_mfma_f32_16x16x32_bf16 v[72:75], v[168:171], a[88:91], v[72:75]
ds_read_b128 v[164:167], v8 offset:5120
v_mfma_f32_16x16x32_bf16 v[76:79], v[168:171], a[92:95], v[76:79]
s_add_u32 s55, s55, 23552
v_mfma_f32_16x16x32_bf16 v[80:83], v[172:175], a[88:91], v[80:83]
s_waitcnt lgkmcnt(4)
ds_read_b128 v[168:171], v8 offset:6144
v_mfma_f32_16x16x32_bf16 v[84:87], v[172:175], a[92:95], v[84:87]
buffer_load_dwordx4 a[156:159], v14, s[24:27], s93 offen offset:2048 sc1
v_mfma_f32_16x16x32_bf16 v[88:91], v[144:147], a[88:91], v[88:91]
s_add_u32 s71, s69, 24576
ds_read_b128 v[172:175], v8 offset:7168
v_mfma_f32_16x16x32_bf16 v[92:95], v[144:147], a[92:95], v[92:95]
s_waitcnt lgkmcnt(4)
v_mfma_f32_16x16x32_bf16 v[96:99], v[148:151], a[88:91], v[96:99]
s_xor_b32 s65, s82, 5
s_mul_i32 s65, s65, 24576
s_add_u32 s65, s65, s77
v_mfma_f32_16x16x32_bf16 v[100:103], v[148:151], a[92:95], v[100:103]
s_cmp_eq_u32 s3, s84
s_cselect_b32 s55, 2147418112, s55
s_cselect_b32 s71, s71, 2147418112
v_mfma_f32_16x16x32_bf16 v[104:107], v[152:155], a[88:91], v[104:107]
buffer_load_dwordx4 a[160:163], v4, s[24:27], s65 offen offset:0 sc1
v_mfma_f32_16x16x32_bf16 v[108:111], v[152:155], a[92:95], v[108:111]
ds_read_b128 v[144:147], v8 offset:8192
v_mfma_f32_16x16x32_bf16 v[112:115], v[156:159], a[88:91], v[112:115]
s_mul_i32 s83, s84, 6144
ds_read_b128 v[148:151], v8 offset:9216
v_mfma_f32_16x16x32_bf16 v[116:119], v[156:159], a[92:95], v[116:119]
s_waitcnt lgkmcnt(4) vmcnt(15)
ds_read_b128 v[152:155], v8 offset:10240
v_mfma_f32_16x16x32_bf16 v[120:123], v[160:163], a[96:99], v[120:123]
s_xor_b32 s93, s82, 5
s_mul_i32 s93, s93, 24576
s_add_u32 s93, s93, s81
v_mfma_f32_16x16x32_bf16 v[124:127], v[160:163], a[100:103], v[124:127]
s_add_u32 s69, s69, s83
ds_read_b128 v[156:159], v8 offset:11264
v_mfma_f32_16x16x32_bf16 v[72:75], v[164:167], a[96:99], v[72:75]
buffer_load_dwordx4 a[164:167], v4, s[24:27], s93 offen offset:0 sc1
v_mfma_f32_16x16x32_bf16 v[76:79], v[164:167], a[100:103], v[76:79]
s_waitcnt lgkmcnt(4)
ds_read_b128 v[160:163], v8 offset:12288
v_mfma_f32_16x16x32_bf16 v[80:83], v[168:171], a[96:99], v[80:83]
s_add_u32 s83, s69, 4096
ds_read_b128 v[164:167], v8 offset:13312
v_mfma_f32_16x16x32_bf16 v[84:87], v[168:171], a[100:103], v[84:87]
v_mfma_f32_16x16x32_bf16 v[88:91], v[172:175], a[96:99], v[88:91]
s_waitcnt lgkmcnt(4)
ds_read_b128 v[168:171], v8 offset:14336
v_mfma_f32_16x16x32_bf16 v[92:95], v[172:175], a[100:103], v[92:95]
buffer_load_dwordx4 a[168:171], v4, s[24:27], s65 offen offset:2048 sc1
v_mfma_f32_16x16x32_bf16 v[96:99], v[144:147], a[96:99], v[96:99]
s_waitcnt vmcnt(56)
ds_read_b128 v[172:175], v8 offset:15360
v_mfma_f32_16x16x32_bf16 v[100:103], v[144:147], a[100:103], v[100:103]
s_barrier
v_mfma_f32_16x16x32_bf16 v[104:107], v[148:151], a[96:99], v[104:107]
s_add_u32 s91, s91, 16384
ds_read_b128 v[144:147], v7 offset:0
v_mfma_f32_16x16x32_bf16 v[108:111], v[148:151], a[100:103], v[108:111]
s_waitcnt lgkmcnt(5)
s_cmp_ge_u32 s91, 163840
s_cselect_b32 s91, 0, s91
v_mfma_f32_16x16x32_bf16 v[112:115], v[152:155], a[96:99], v[112:115]
buffer_load_dwordx4 a[172:175], v4, s[24:27], s93 offen offset:2048 sc1
v_mfma_f32_16x16x32_bf16 v[116:119], v[152:155], a[100:103], v[116:119]
s_waitcnt vmcnt(16)
ds_read_b128 v[148:151], v7 offset:1024
v_add_u32 v8, s91, v4
v_mfma_f32_16x16x32_bf16 v[120:123], v[156:159], a[104:107], v[120:123]
s_waitcnt lgkmcnt(4)
ds_read_b128 v[152:155], v7 offset:2048
v_mfma_f32_16x16x32_bf16 v[124:127], v[156:159], a[108:111], v[124:127]
s_mov_b32 m0, s70
s_mov_b32 s64, s68
s_add_u32 s68, s68, 49152
v_mfma_f32_16x16x32_bf16 v[72:75], v[160:163], a[104:107], v[72:75]
ds_read_b128 v[156:159], v7 offset:3072
v_mfma_f32_16x16x32_bf16 v[76:79], v[160:163], a[108:111], v[76:79]
s_add_u32 s70, s70, 16384
s_cmp_ge_u32 s70, 163840
s_cselect_b32 s70, s80, s70
v_mfma_f32_16x16x32_bf16 v[80:83], v[164:167], a[104:107], v[80:83]
buffer_load_dwordx4 v4, s[24:27], s64 offen offset:0 sc1 lds
v_mfma_f32_16x16x32_bf16 v[84:87], v[164:167], a[108:111], v[84:87]
s_waitcnt lgkmcnt(4)
ds_read_b128 v[160:163], v7 offset:4096
v_mfma_f32_16x16x32_bf16 v[88:91], v[168:171], a[104:107], v[88:91]
ds_read_b128 v[164:167], v7 offset:5120
v_mfma_f32_16x16x32_bf16 v[92:95], v[168:171], a[108:111], v[92:95]
v_mfma_f32_16x16x32_bf16 v[96:99], v[172:175], a[104:107], v[96:99]
buffer_load_dwordx4 v4, s[24:27], s64 offen offset:1024 sc1 lds
v_mfma_f32_16x16x32_bf16 v[100:103], v[172:175], a[108:111], v[100:103]
s_waitcnt lgkmcnt(4)
ds_read_b128 v[168:171], v7 offset:6144
v_mfma_f32_16x16x32_bf16 v[104:107], v[144:147], a[104:107], v[104:107]
ds_read_b128 v[172:175], v7 offset:7168
v_mfma_f32_16x16x32_bf16 v[108:111], v[144:147], a[108:111], v[108:111]
v_mfma_f32_16x16x32_bf16 v[112:115], v[148:151], a[104:107], v[112:115]
s_waitcnt lgkmcnt(4) vmcnt(16)
ds_read_b128 v[144:147], v7 offset:8192
v_mfma_f32_16x16x32_bf16 v[116:119], v[148:151], a[108:111], v[116:119]
buffer_load_dwordx4 v4, s[24:27], s64 offen offset:2048 sc1 lds
v_mfma_f32_16x16x32_bf16 v[120:123], v[152:155], a[112:115], v[120:123]
ds_read_b128 v[148:151], v7 offset:9216
v_mfma_f32_16x16x32_bf16 v[124:127], v[152:155], a[116:119], v[124:127]
v_mfma_f32_16x16x32_bf16 v[72:75], v[156:159], a[112:115], v[72:75]
ds_read_b128 v[152:155], v7 offset:10240
v_mfma_f32_16x16x32_bf16 v[76:79], v[156:159], a[116:119], v[76:79]
s_waitcnt lgkmcnt(5)
v_mfma_f32_16x16x32_bf16 v[80:83], v[160:163], a[112:115], v[80:83]
buffer_load_dwordx4 a[176:179], v14, s[24:27], s65 offen offset:0 sc1
v_mfma_f32_16x16x32_bf16 v[84:87], v[160:163], a[116:119], v[84:87]
ds_read_b128 v[156:159], v7 offset:11264
v_mov_b32 v13, 0xffff0000
v_mfma_f32_16x16x32_bf16 v[88:91], v[164:167], a[112:115], v[88:91]
ds_read_b128 v[160:163], v7 offset:12288
v_mul_u32_u24 v5, 1152, v2
v_mfma_f32_16x16x32_bf16 v[92:95], v[164:167], a[116:119], v[92:95]
s_waitcnt lgkmcnt(5)
v_lshl_add_u32 v6, v3, 3, v5
v_and_b32 v9, 1, v3
v_mfma_f32_16x16x32_bf16 v[96:99], v[168:171], a[112:115], v[96:99]
ds_read_b128 v[164:167], v7 offset:13312
v_lshl_add_u32 v5, v9, 5, v5
v_mfma_f32_16x16x32_bf16 v[100:103], v[168:171], a[116:119], v[100:103]
buffer_load_dwordx4 a[180:183], v14, s[24:27], s93 offen offset:0 sc1
v_mfma_f32_16x16x32_bf16 v[104:107], v[172:175], a[112:115], v[104:107]
ds_read_b128 v[168:171], v7 offset:14336
v_lshrrev_b32 v9, 1, v3
v_mfma_f32_16x16x32_bf16 v[108:111], v[172:175], a[116:119], v[108:111]
s_waitcnt lgkmcnt(5)
v_lshl_add_u32 v5, v9, 4, v5
v_mfma_f32_16x16x32_bf16 v[112:115], v[144:147], a[112:115], v[112:115]
ds_read_b128 v[172:175], v7 offset:15360
v_mfma_f32_16x16x32_bf16 v[116:119], v[144:147], a[116:119], v[116:119]
s_waitcnt vmcnt(17)
s_add_u32 s91, s91, 16384
v_mfma_f32_16x16x32_bf16 v[120:123], v[148:151], a[120:123], v[120:123]
buffer_load_dwordx4 v4, s[24:27], s64 offen offset:3072 sc1 lds
v_mfma_f32_16x16x32_bf16 v[124:127], v[148:151], a[124:127], v[124:127]
s_waitcnt lgkmcnt(4)
ds_read_b128 v[144:147], v8 offset:0
v_mfma_f32_16x16x32_bf16 v[72:75], v[152:155], a[120:123], v[72:75]
s_cmp_ge_u32 s91, 163840
s_cselect_b32 s91, 0, s91
ds_read_b128 v[148:151], v8 offset:1024
v_mfma_f32_16x16x32_bf16 v[76:79], v[152:155], a[124:127], v[76:79]
s_mov_b32 m0, s70
s_mov_b32 s64, s68
s_add_u32 s68, s68, 49152
v_mfma_f32_16x16x32_bf16 v[80:83], v[156:159], a[120:123], v[80:83]
s_waitcnt lgkmcnt(4)
ds_read_b128 v[152:155], v8 offset:2048
v_add_u32 v7, s91, v4
v_mfma_f32_16x16x32_bf16 v[84:87], v[156:159], a[124:127], v[84:87]
s_add_u32 s70, s70, 16384
s_cmp_ge_u32 s70, 163840
s_cselect_b32 s70, s80, s70
v_mfma_f32_16x16x32_bf16 v[88:91], v[160:163], a[120:123], v[88:91]
buffer_load_dwordx4 v4, s[24:27], s64 offen offset:0 sc1 lds
v_mfma_f32_16x16x32_bf16 v[92:95], v[160:163], a[124:127], v[92:95]
ds_read_b128 v[156:159], v8 offset:3072
v_mfma_f32_16x16x32_bf16 v[96:99], v[164:167], a[120:123], v[96:99]
ds_read_b128 v[160:163], v8 offset:4096
v_mfma_f32_16x16x32_bf16 v[100:103], v[164:167], a[124:127], v[100:103]
s_waitcnt lgkmcnt(5)
v_mfma_f32_16x16x32_bf16 v[104:107], v[168:171], a[120:123], v[104:107]
buffer_load_dwordx4 v4, s[24:27], s64 offen offset:1024 sc1 lds
v_mfma_f32_16x16x32_bf16 v[108:111], v[168:171], a[124:127], v[108:111]
ds_read_b128 v[164:167], v8 offset:5120
v_mfma_f32_16x16x32_bf16 v[112:115], v[172:175], a[120:123], v[112:115]
ds_read_b128 v[168:171], v8 offset:6144
v_mfma_f32_16x16x32_bf16 v[116:119], v[172:175], a[124:127], v[116:119]
s_waitcnt lgkmcnt(5) vmcnt(18)
v_mfma_f32_16x16x32_bf16 v[120:123], v[144:147], a[128:131], v[120:123]
ds_read_b128 v[172:175], v8 offset:7168
v_mfma_f32_16x16x32_bf16 v[124:127], v[144:147], a[132:135], v[124:127]
v_mfma_f32_16x16x32_bf16 v[72:75], v[148:151], a[128:131], v[72:75]
buffer_load_dwordx4 a[184:187], v14, s[24:27], s65 offen offset:2048 sc1
v_mfma_f32_16x16x32_bf16 v[76:79], v[148:151], a[132:135], v[76:79]
s_waitcnt lgkmcnt(4)
ds_read_b128 v[144:147], v8 offset:8192
v_mfma_f32_16x16x32_bf16 v[80:83], v[152:155], a[128:131], v[80:83]
ds_read_b128 v[148:151], v8 offset:9216
v_mfma_f32_16x16x32_bf16 v[84:87], v[152:155], a[132:135], v[84:87]
v_mfma_f32_16x16x32_bf16 v[88:91], v[156:159], a[128:131], v[88:91]
s_waitcnt lgkmcnt(4)
ds_read_b128 v[152:155], v8 offset:10240
v_mfma_f32_16x16x32_bf16 v[92:95], v[156:159], a[132:135], v[92:95]
buffer_load_dwordx4 a[188:191], v14, s[24:27], s93 offen offset:2048 sc1
v_mfma_f32_16x16x32_bf16 v[96:99], v[160:163], a[128:131], v[96:99]
ds_read_b128 v[156:159], v8 offset:11264
v_mfma_f32_16x16x32_bf16 v[100:103], v[160:163], a[132:135], v[100:103]
s_waitcnt vmcnt(18)
v_mfma_f32_16x16x32_bf16 v[120:123], v[164:167], a[136:139], v[120:123]
ds_read_b128 v[160:163], v8 offset:12288
v_mfma_f32_16x16x32_bf16 v[124:127], v[164:167], a[140:143], v[124:127]
s_waitcnt lgkmcnt(5)
v_mfma_f32_16x16x32_bf16 v[72:75], v[168:171], a[136:139], v[72:75]
buffer_load_dwordx4 v4, s[24:27], s64 offen offset:2048 sc1 lds
v_mfma_f32_16x16x32_bf16 v[76:79], v[168:171], a[140:143], v[76:79]
ds_read_b128 v[164:167], v8 offset:13312
v_mfma_f32_16x16x32_bf16 v[80:83], v[172:175], a[136:139], v[80:83]
s_waitcnt lgkmcnt(4)
ds_read_b128 v[168:171], v8 offset:14336
v_mfma_f32_16x16x32_bf16 v[84:87], v[172:175], a[140:143], v[84:87]
buffer_load_dwordx4 v4, s[24:27], s64 offen offset:3072 sc1 lds
v_mfma_f32_16x16x32_bf16 v[88:91], v[144:147], a[136:139], v[88:91]
s_waitcnt vmcnt(60)
ds_read_b128 v[172:175], v8 offset:15360
v_mfma_f32_16x16x32_bf16 v[92:95], v[144:147], a[140:143], v[92:95]
s_barrier
v_mfma_f32_16x16x32_bf16 v[96:99], v[148:151], a[136:139], v[96:99]
s_xor_b32 s65, s82, 6
s_mul_i32 s65, s65, 24576
s_add_u32 s65, s65, s77
v_mfma_f32_16x16x32_bf16 v[100:103], v[148:151], a[140:143], v[100:103]
s_waitcnt lgkmcnt(4) vmcnt(18)
s_add_u32 s91, s91, 16384
ds_read_b128 v[144:147], v7 offset:0
v_mfma_f32_16x16x32_bf16 v[120:123], v[152:155], a[144:147], v[120:123]
buffer_load_dwordx4 a[192:195], v4, s[24:27], s65 offen offset:0 sc1
v_mfma_f32_16x16x32_bf16 v[124:127], v[152:155], a[148:151], v[124:127]
s_xor_b32 s93, s82, 6
s_mul_i32 s93, s93, 24576
s_add_u32 s93, s93, s81
v_mfma_f32_16x16x32_bf16 v[72:75], v[156:159], a[144:147], v[72:75]
s_waitcnt lgkmcnt(3)
ds_read_b128 v[148:151], v7 offset:1024
v_mfma_f32_16x16x32_bf16 v[76:79], v[156:159], a[148:151], v[76:79]
buffer_load_dwordx4 a[196:199], v4, s[24:27], s93 offen offset:0 sc1
v_mfma_f32_16x16x32_bf16 v[80:83], v[160:163], a[144:147], v[80:83]
s_cmp_ge_u32 s91, 163840
s_cselect_b32 s91, 0, s91
ds_read_b128 v[152:155], v7 offset:2048
v_mfma_f32_16x16x32_bf16 v[84:87], v[160:163], a[148:151], v[84:87]
ds_read_b128 v[156:159], v7 offset:3072
v_add_u32 v8, s91, v4
v_mfma_f32_16x16x32_bf16 v[88:91], v[164:167], a[144:147], v[88:91]
ds_read_b128 v[160:163], v7 offset:4096
v_mfma_f32_16x16x32_bf16 v[92:95], v[164:167], a[148:151], v[92:95]
s_waitcnt lgkmcnt(5)
v_mfma_f32_16x16x32_bf16 v[96:99], v[168:171], a[144:147], v[96:99]
ds_read_b128 v[164:167], v7 offset:5120
v_mfma_f32_16x16x32_bf16 v[100:103], v[168:171], a[148:151], v[100:103]
s_waitcnt lgkmcnt(4) vmcnt(18)
v_mfma_f32_16x16x32_bf16 v[120:123], v[172:175], a[152:155], v[120:123]
buffer_load_dword v12, v10, s[24:27], s75 offen offset:4 sc1
v_mfma_f32_16x16x32_bf16 v[124:127], v[172:175], a[156:159], v[124:127]
buffer_load_dwordx4 a[200:203], v4, s[24:27], s65 offen offset:2048 sc1
v_mfma_f32_16x16x32_bf16 v[72:75], v[144:147], a[152:155], v[72:75]
ds_read_b128 v[168:171], v7 offset:6144
v_mfma_f32_16x16x32_bf16 v[76:79], v[144:147], a[156:159], v[76:79]
ds_read_b128 v[172:175], v7 offset:7168
v_mfma_f32_16x16x32_bf16 v[80:83], v[148:151], a[152:155], v[80:83]
buffer_load_dwordx4 a[204:207], v4, s[24:27], s93 offen offset:2048 sc1
v_mfma_f32_16x16x32_bf16 v[84:87], v[148:151], a[156:159], v[84:87]
s_waitcnt lgkmcnt(4)
ds_read_b128 v[144:147], v7 offset:8192
v_mfma_f32_16x16x32_bf16 v[88:91], v[152:155], a[152:155], v[88:91]
ds_read_b128 v[148:151], v7 offset:9216
v_mfma_f32_16x16x32_bf16 v[92:95], v[152:155], a[156:159], v[92:95]
v_mfma_f32_16x16x32_bf16 v[96:99], v[156:159], a[152:155], v[96:99]
ds_read_b128 v[152:155], v7 offset:10240
v_mfma_f32_16x16x32_bf16 v[100:103], v[156:159], a[156:159], v[100:103]
s_waitcnt lgkmcnt(5) vmcnt(19)
v_mfma_f32_16x16x32_bf16 v[120:123], v[160:163], a[160:163], v[120:123]
buffer_load_dwordx4 a[208:211], v14, s[24:27], s65 offen offset:0 sc1
v_mfma_f32_16x16x32_bf16 v[124:127], v[160:163], a[164:167], v[124:127]
ds_read_b128 v[156:159], v7 offset:11264
v_mfma_f32_16x16x32_bf16 v[72:75], v[164:167], a[160:163], v[72:75]
s_waitcnt lgkmcnt(4)
ds_read_b128 v[160:163], v7 offset:12288
v_mfma_f32_16x16x32_bf16 v[76:79], v[164:167], a[164:167], v[76:79]
buffer_load_dwordx4 a[212:215], v14, s[24:27], s93 offen offset:0 sc1
v_mfma_f32_16x16x32_bf16 v[80:83], v[168:171], a[160:163], v[80:83]
ds_read_b128 v[164:167], v7 offset:13312
v_mfma_f32_16x16x32_bf16 v[84:87], v[168:171], a[164:167], v[84:87]
v_mfma_f32_16x16x32_bf16 v[88:91], v[172:175], a[160:163], v[88:91]
ds_read_b128 v[168:171], v7 offset:14336
v_mfma_f32_16x16x32_bf16 v[92:95], v[172:175], a[164:167], v[92:95]
s_waitcnt lgkmcnt(5)
v_mfma_f32_16x16x32_bf16 v[96:99], v[144:147], a[160:163], v[96:99]
ds_read_b128 v[172:175], v7 offset:15360
v_mfma_f32_16x16x32_bf16 v[100:103], v[144:147], a[164:167], v[100:103]
s_waitcnt vmcnt(19)
s_add_u32 s91, s91, 16384
v_mfma_f32_16x16x32_bf16 v[120:123], v[148:151], a[168:171], v[120:123]
buffer_load_dwordx4 a[216:219], v14, s[24:27], s65 offen offset:2048 sc1
v_mfma_f32_16x16x32_bf16 v[124:127], v[148:151], a[172:175], v[124:127]
s_waitcnt lgkmcnt(4)
ds_read_b128 v[144:147], v8 offset:0
v_mfma_f32_16x16x32_bf16 v[72:75], v[152:155], a[168:171], v[72:75]
s_cmp_ge_u32 s91, 163840
s_cselect_b32 s91, 0, s91
ds_read_b128 v[148:151], v8 offset:1024
v_mfma_f32_16x16x32_bf16 v[76:79], v[152:155], a[172:175], v[76:79]
buffer_load_dwordx4 a[220:223], v14, s[24:27], s93 offen offset:2048 sc1
v_mfma_f32_16x16x32_bf16 v[80:83], v[156:159], a[168:171], v[80:83]
s_mov_b32 m0, s70
s_mov_b32 s64, s68
s_add_u32 s68, s68, 49152
v_mfma_f32_16x16x32_bf16 v[84:87], v[156:159], a[172:175], v[84:87]
s_waitcnt lgkmcnt(4)
ds_read_b128 v[152:155], v8 offset:2048
v_add_u32 v7, s91, v4
v_mfma_f32_16x16x32_bf16 v[88:91], v[160:163], a[168:171], v[88:91]
s_add_u32 s70, s70, 16384
s_cmp_ge_u32 s70, 163840
s_cselect_b32 s70, s80, s70
v_mfma_f32_16x16x32_bf16 v[92:95], v[160:163], a[172:175], v[92:95]
buffer_load_dwordx4 v4, s[24:27], s64 offen offset:0 sc1 lds
v_mfma_f32_16x16x32_bf16 v[96:99], v[164:167], a[168:171], v[96:99]
ds_read_b128 v[156:159], v8 offset:3072
v_mfma_f32_16x16x32_bf16 v[100:103], v[164:167], a[172:175], v[100:103]
s_waitcnt lgkmcnt(4) vmcnt(17)
ds_read_b128 v[160:163], v8 offset:4096
v_mfma_f32_16x16x32_bf16 v[120:123], v[168:171], a[176:179], v[120:123]
buffer_load_dwordx4 v4, s[24:27], s64 offen offset:1024 sc1 lds
v_mfma_f32_16x16x32_bf16 v[124:127], v[168:171], a[180:183], v[124:127]
s_xor_b32 s65, s82, 7
s_mul_i32 s65, s65, 24576
s_add_u32 s65, s65, s77
v_mfma_f32_16x16x32_bf16 v[72:75], v[172:175], a[176:179], v[72:75]
s_waitcnt lgkmcnt(3)
ds_read_b128 v[164:167], v8 offset:5120
v_mfma_f32_16x16x32_bf16 v[76:79], v[172:175], a[180:183], v[76:79]
buffer_load_dwordx4 a[224:227], v4, s[24:27], s65 offen offset:0 sc1
v_mfma_f32_16x16x32_bf16 v[80:83], v[144:147], a[176:179], v[80:83]
s_xor_b32 s93, s82, 7
s_mul_i32 s93, s93, 24576
s_add_u32 s93, s93, s81
v_mfma_f32_16x16x32_bf16 v[84:87], v[144:147], a[180:183], v[84:87]
ds_read_b128 v[168:171], v8 offset:6144
v_mfma_f32_16x16x32_bf16 v[88:91], v[148:151], a[176:179], v[88:91]
buffer_load_dwordx4 a[228:231], v4, s[24:27], s93 offen offset:0 sc1
v_mfma_f32_16x16x32_bf16 v[92:95], v[148:151], a[180:183], v[92:95]
s_waitcnt lgkmcnt(3)
ds_read_b128 v[172:175], v8 offset:7168
v_mfma_f32_16x16x32_bf16 v[96:99], v[152:155], a[176:179], v[96:99]
s_waitcnt vmcnt(15)
ds_read_b128 v[144:147], v8 offset:8192
v_mfma_f32_16x16x32_bf16 v[100:103], v[152:155], a[180:183], v[100:103]
buffer_load_dwordx4 v4, s[24:27], s64 offen offset:2048 sc1 lds
v_mfma_f32_16x16x32_bf16 v[120:123], v[156:159], a[184:187], v[120:123]
ds_read_b128 v[148:151], v8 offset:9216
v_mfma_f32_16x16x32_bf16 v[124:127], v[156:159], a[188:191], v[124:127]
s_waitcnt lgkmcnt(4)
ds_read_b128 v[152:155], v8 offset:10240
v_mfma_f32_16x16x32_bf16 v[72:75], v[160:163], a[184:187], v[72:75]
buffer_load_dwordx4 v4, s[24:27], s64 offen offset:3072 sc1 lds
v_mfma_f32_16x16x32_bf16 v[76:79], v[160:163], a[188:191], v[76:79]
ds_read_b128 v[156:159], v8 offset:11264
v_mfma_f32_16x16x32_bf16 v[80:83], v[164:167], a[184:187], v[80:83]
s_waitcnt lgkmcnt(4)
ds_read_b128 v[160:163], v8 offset:12288
v_mfma_f32_16x16x32_bf16 v[84:87], v[164:167], a[188:191], v[84:87]
buffer_load_dwordx4 a[232:235], v4, s[24:27], s65 offen offset:2048 sc1
v_mfma_f32_16x16x32_bf16 v[88:91], v[168:171], a[184:187], v[88:91]
s_waitcnt vmcnt(13)
ds_read_b128 v[164:167], v8 offset:13312
v_mfma_f32_16x16x32_bf16 v[92:95], v[168:171], a[188:191], v[92:95]
s_waitcnt lgkmcnt(4) vmcnt(14)
v_cmp_gt_u32 vcc, 8, v12
v_mfma_f32_16x16x32_bf16 v[96:99], v[172:175], a[184:187], v[96:99]
buffer_load_dwordx4 a[236:239], v4, s[24:27], s93 offen offset:2048 sc1
v_mfma_f32_16x16x32_bf16 v[100:103], v[172:175], a[188:191], v[100:103]
s_mov_b32 m0, s70
s_mov_b32 s64, s68
s_add_u32 s68, s68, 49152
v_mfma_f32_16x16x32_bf16 v[120:123], v[144:147], a[192:195], v[120:123]
s_waitcnt vmcnt(17) lgkmcnt(2)
ds_read_b128 v[168:171], v8 offset:14336
v_mfma_f32_16x16x32_bf16 v[124:127], v[144:147], a[196:199], v[124:127]
s_barrier
v_mfma_f32_16x16x32_bf16 v[72:75], v[148:151], a[192:195], v[72:75]
s_cbranch_vccnz CK_ZAA
CK_ZAA_R:
v_mfma_f32_16x16x32_bf16 v[76:79], v[148:151], a[196:199], v[76:79]
s_add_u32 s70, s70, 16384
s_cmp_ge_u32 s70, 163840
s_cselect_b32 s70, s80, s70
v_mfma_f32_16x16x32_bf16 v[80:83], v[152:155], a[192:195], v[80:83]
buffer_load_dwordx4 v4, s[24:27], s64 offen offset:0 sc1 lds
v_mfma_f32_16x16x32_bf16 v[84:87], v[152:155], a[196:199], v[84:87]
ds_read_b128 v[172:175], v8 offset:15360
v_mfma_f32_16x16x32_bf16 v[88:91], v[156:159], a[192:195], v[88:91]
s_waitcnt lgkmcnt(2)
s_add_u32 s91, s91, 16384
ds_read_b128 v[144:147], v7 offset:0
v_mfma_f32_16x16x32_bf16 v[92:95], v[156:159], a[196:199], v[92:95]
buffer_load_dwordx4 v4, s[24:27], s64 offen offset:1024 sc1 lds
v_mfma_f32_16x16x32_bf16 v[96:99], v[160:163], a[192:195], v[96:99]
s_cmp_ge_u32 s91, 163840
s_cselect_b32 s91, 0, s91
ds_read_b128 v[148:151], v7 offset:1024
v_mfma_f32_16x16x32_bf16 v[100:103], v[160:163], a[196:199], v[100:103]
s_waitcnt vmcnt(14)
ds_read_b128 v[152:155], v7 offset:2048
v_add_u32 v8, s91, v4
v_mfma_f32_16x16x32_bf16 v[120:123], v[164:167], a[200:203], v[120:123]
buffer_load_dwordx4 v4, s[24:27], s64 offen offset:2048 sc1 lds
v_mfma_f32_16x16x32_bf16 v[124:127], v[164:167], a[204:207], v[124:127]
s_waitcnt lgkmcnt(3)
ds_read_b128 v[156:159], v7 offset:3072
v_mfma_f32_16x16x32_bf16 v[72:75], v[168:171], a[200:203], v[72:75]
ds_read_b128 v[160:163], v7 offset:4096
v_mfma_f32_16x16x32_bf16 v[76:79], v[168:171], a[204:207], v[76:79]
buffer_load_dwordx4 v4, s[24:27], s64 offen offset:3072 sc1 lds
v_mfma_f32_16x16x32_bf16 v[80:83], v[172:175], a[200:203], v[80:83]
ds_read_b128 v[164:167], v7 offset:5120
v_mfma_f32_16x16x32_bf16 v[84:87], v[172:175], a[204:207], v[84:87]
s_waitcnt lgkmcnt(4)
ds_read_b128 v[168:171], v7 offset:6144
v_mfma_f32_16x16x32_bf16 v[88:91], v[144:147], a[200:203], v[88:91]
buffer_load_dwordx4 a[240:243], v14, s[24:27], s65 offen offset:0 sc1
v_mfma_f32_16x16x32_bf16 v[92:95], v[144:147], a[204:207], v[92:95]
ds_read_b128 v[172:175], v7 offset:7168
v_mfma_f32_16x16x32_bf16 v[96:99], v[148:151], a[200:203], v[96:99]
s_waitcnt lgkmcnt(4) vmcnt(15)
ds_read_b128 v[144:147], v7 offset:8192
v_mfma_f32_16x16x32_bf16 v[100:103], v[148:151], a[204:207], v[100:103]
buffer_load_dwordx4 a[244:247], v14, s[24:27], s93 offen offset:0 sc1
v_mfma_f32_16x16x32_bf16 v[120:123], v[152:155], a[208:211], v[120:123]
ds_read_b128 v[148:151], v7 offset:9216
v_mfma_f32_16x16x32_bf16 v[124:127], v[152:155], a[212:215], v[124:127]
v_mfma_f32_16x16x32_bf16 v[72:75], v[156:159], a[208:211], v[72:75]
buffer_load_dwordx4 a[248:251], v14, s[24:27], s65 offen offset:2048 sc1
v_mfma_f32_16x16x32_bf16 v[76:79], v[156:159], a[212:215], v[76:79]
s_waitcnt lgkmcnt(4)
ds_read_b128 v[152:155], v7 offset:10240
v_mfma_f32_16x16x32_bf16 v[80:83], v[160:163], a[208:211], v[80:83]
ds_read_b128 v[156:159], v7 offset:11264
v_mfma_f32_16x16x32_bf16 v[84:87], v[160:163], a[212:215], v[84:87]
buffer_load_dwordx4 a[252:255], v14, s[24:27], s93 offen offset:2048 sc1
v_mfma_f32_16x16x32_bf16 v[88:91], v[164:167], a[208:211], v[88:91]
s_add_u32 s65, s77, 196608
ds_read_b128 v[160:163], v7 offset:12288
v_mfma_f32_16x16x32_bf16 v[92:95], v[164:167], a[212:215], v[92:95]
s_waitcnt lgkmcnt(5)
v_mfma_f32_16x16x32_bf16 v[96:99], v[168:171], a[208:211], v[96:99]
buffer_load_dwordx4 v[32:35], v4, s[24:27], s65 offen offset:0 sc1
v_mfma_f32_16x16x32_bf16 v[100:103], v[168:171], a[212:215], v[100:103]
s_add_u32 s93, s81, 196608
s_waitcnt vmcnt(17)
ds_read_b128 v[164:167], v7 offset:13312
v_mfma_f32_16x16x32_bf16 v[120:123], v[172:175], a[216:219], v[120:123]
s_waitcnt lgkmcnt(4)
ds_read_b128 v[168:171], v7 offset:14336
v_mfma_f32_16x16x32_bf16 v[124:127], v[172:175], a[220:223], v[124:127]
buffer_load_dwordx4 v[36:39], v4, s[24:27], s93 offen offset:0 sc1
v_mfma_f32_16x16x32_bf16 v[72:75], v[144:147], a[216:219], v[72:75]
ds_read_b128 v[172:175], v7 offset:15360
v_mfma_f32_16x16x32_bf16 v[76:79], v[144:147], a[220:223], v[76:79]
s_add_u32 s91, s91, 16384
s_cmp_ge_u32 s91, 163840
s_cselect_b32 s91, 0, s91
v_mfma_f32_16x16x32_bf16 v[80:83], v[148:151], a[216:219], v[80:83]
buffer_load_dwordx4 v[40:43], v4, s[24:27], s65 offen offset:2048 sc1
v_mfma_f32_16x16x32_bf16 v[84:87], v[148:151], a[220:223], v[84:87]
s_waitcnt lgkmcnt(4)
ds_read_b128 v[144:147], v8 offset:0
v_add_u32 v7, s91, v4
v_mfma_f32_16x16x32_bf16 v[88:91], v[152:155], a[216:219], v[88:91]
ds_read_b128 v[148:151], v8 offset:1024
v_mfma_f32_16x16x32_bf16 v[92:95], v[152:155], a[220:223], v[92:95]
buffer_load_dwordx4 v[44:47], v4, s[24:27], s93 offen offset:2048 sc1
v_mfma_f32_16x16x32_bf16 v[96:99], v[156:159], a[216:219], v[96:99]
ds_read_b128 v[152:155], v8 offset:2048
v_mfma_f32_16x16x32_bf16 v[100:103], v[156:159], a[220:223], v[100:103]
s_waitcnt lgkmcnt(5) vmcnt(16)
v_mfma_f32_16x16x32_bf16 v[120:123], v[160:163], a[224:227], v[120:123]
buffer_load_dwordx4 v[48:51], v14, s[24:27], s65 offen offset:0 sc1
v_mfma_f32_16x16x32_bf16 v[124:127], v[160:163], a[228:231], v[124:127]
ds_read_b128 v[156:159], v8 offset:3072
v_mfma_f32_16x16x32_bf16 v[72:75], v[164:167], a[224:227], v[72:75]
s_waitcnt lgkmcnt(4)
ds_read_b128 v[160:163], v8 offset:4096
v_mfma_f32_16x16x32_bf16 v[76:79], v[164:167], a[228:231], v[76:79]
buffer_load_dwordx4 v[52:55], v14, s[24:27], s93 offen offset:0 sc1
v_mfma_f32_16x16x32_bf16 v[80:83], v[168:171], a[224:227], v[80:83]
s_mov_b32 m0, s70
s_mov_b32 s64, s68
s_add_u32 s68, s68, 49152
v_mfma_f32_16x16x32_bf16 v[84:87], v[168:171], a[228:231], v[84:87]
s_waitcnt lgkmcnt(3)
ds_read_b128 v[164:167], v8 offset:5120
v_mfma_f32_16x16x32_bf16 v[88:91], v[172:175], a[224:227], v[88:91]
s_add_u32 s70, s70, 16384
s_cmp_ge_u32 s70, 163840
s_cselect_b32 s70, s80, s70
v_mfma_f32_16x16x32_bf16 v[92:95], v[172:175], a[228:231], v[92:95]
buffer_load_dwordx4 v4, s[24:27], s64 offen offset:0 sc1 lds
v_mfma_f32_16x16x32_bf16 v[96:99], v[144:147], a[224:227], v[96:99]
ds_read_b128 v[168:171], v8 offset:6144
v_mfma_f32_16x16x32_bf16 v[100:103], v[144:147], a[228:231], v[100:103]
s_waitcnt vmcnt(15)
ds_read_b128 v[172:175], v8 offset:7168
v_mfma_f32_16x16x32_bf16 v[120:123], v[148:151], a[232:235], v[120:123]
buffer_load_dwordx4 v4, s[24:27], s64 offen offset:1024 sc1 lds
v_mfma_f32_16x16x32_bf16 v[124:127], v[148:151], a[236:239], v[124:127]
s_waitcnt lgkmcnt(4)
ds_read_b128 v[144:147], v8 offset:8192
v_mfma_f32_16x16x32_bf16 v[72:75], v[152:155], a[232:235], v[72:75]
ds_read_b128 v[148:151], v8 offset:9216
v_mfma_f32_16x16x32_bf16 v[76:79], v[152:155], a[236:239], v[76:79]
buffer_load_dwordx4 v4, s[24:27], s64 offen offset:2048 sc1 lds
v_mfma_f32_16x16x32_bf16 v[80:83], v[156:159], a[232:235], v[80:83]
ds_read_b128 v[152:155], v8 offset:10240
v_mfma_f32_16x16x32_bf16 v[84:87], v[156:159], a[236:239], v[84:87]
s_waitcnt lgkmcnt(5)
v_mfma_f32_16x16x32_bf16 v[88:91], v[160:163], a[232:235], v[88:91]
buffer_load_dwordx4 v4, s[24:27], s64 offen offset:3072 sc1 lds
v_mfma_f32_16x16x32_bf16 v[92:95], v[160:163], a[236:239], v[92:95]
ds_read_b128 v[156:159], v8 offset:11264
v_mfma_f32_16x16x32_bf16 v[96:99], v[164:167], a[232:235], v[96:99]
s_waitcnt lgkmcnt(4) vmcnt(12)
ds_read_b128 v[160:163], v8 offset:12288
v_mfma_f32_16x16x32_bf16 v[100:103], v[164:167], a[236:239], v[100:103]
buffer_load_dwordx4 v[56:59], v14, s[24:27], s65 offen offset:2048 sc1
v_mfma_f32_16x16x32_bf16 v[120:123], v[168:171], a[240:243], v[120:123]
ds_read_b128 v[164:167], v8 offset:13312
v_mfma_f32_16x16x32_bf16 v[124:127], v[168:171], a[244:247], v[124:127]
s_waitcnt lgkmcnt(4)
v_mfma_f32_16x16x32_bf16 v[72:75], v[172:175], a[240:243], v[72:75]
buffer_load_dwordx4 v[60:63], v14, s[24:27], s93 offen offset:2048 sc1
v_mfma_f32_16x16x32_bf16 v[76:79], v[172:175], a[244:247], v[76:79]
s_mov_b32 m0, s70
s_mov_b32 s64, s68
s_add_u32 s68, s68, 49152
v_mfma_f32_16x16x32_bf16 v[80:83], v[144:147], a[240:243], v[80:83]
s_waitcnt vmcnt(16) lgkmcnt(2)
ds_read_b128 v[168:171], v8 offset:14336
v_mfma_f32_16x16x32_bf16 v[84:87], v[144:147], a[244:247], v[84:87]
s_barrier
v_mfma_f32_16x16x32_bf16 v[88:91], v[148:151], a[240:243], v[88:91]
s_add_u32 s70, s70, 16384
s_cmp_ge_u32 s70, 163840
s_cselect_b32 s70, s80, s70
v_mfma_f32_16x16x32_bf16 v[92:95], v[148:151], a[244:247], v[92:95]
buffer_load_dwordx4 v4, s[24:27], s64 offen offset:0 sc1 lds
v_mfma_f32_16x16x32_bf16 v[96:99], v[152:155], a[240:243], v[96:99]
ds_read_b128 v[172:175], v8 offset:15360
v_mfma_f32_16x16x32_bf16 v[100:103], v[152:155], a[244:247], v[100:103]
s_waitcnt vmcnt(13)
s_add_u32 s91, s91, 16384
ds_read_b128 v[144:147], v7 offset:0
v_mfma_f32_16x16x32_bf16 v[120:123], v[156:159], a[248:251], v[120:123]
buffer_load_dwordx4 v4, s[24:27], s64 offen offset:1024 sc1 lds
v_mfma_f32_16x16x32_bf16 v[124:127], v[156:159], a[252:255], v[124:127]
s_add_u32 s65, s77, 221184
s_waitcnt lgkmcnt(3)
ds_read_b128 v[148:151], v7 offset:1024
v_mfma_f32_16x16x32_bf16 v[72:75], v[160:163], a[248:251], v[72:75]
s_cmp_ge_u32 s91, 163840
s_cselect_b32 s91, 0, s91
ds_read_b128 v[152:155], v7 offset:2048
v_mfma_f32_16x16x32_bf16 v[76:79], v[160:163], a[252:255], v[76:79]
buffer_load_dwordx4 v[64:67], v4, s[24:27], s65 offen offset:0 sc1
v_mfma_f32_16x16x32_bf16 v[80:83], v[164:167], a[248:251], v[80:83]
s_add_u32 s93, s81, 221184
ds_read_b128 v[156:159], v7 offset:3072
v_add_u32 v8, s91, v4
v_mfma_f32_16x16x32_bf16 v[84:87], v[164:167], a[252:255], v[84:87]
s_waitcnt lgkmcnt(4)
ds_read_b128 v[160:163], v7 offset:4096
v_mfma_f32_16x16x32_bf16 v[88:91], v[168:171], a[248:251], v[88:91]
buffer_load_dwordx4 v[68:71], v4, s[24:27], s93 offen offset:0 sc1
v_mfma_f32_16x16x32_bf16 v[92:95], v[168:171], a[252:255], v[92:95]
ds_read_b128 v[164:167], v7 offset:5120
v_mfma_f32_16x16x32_bf16 v[96:99], v[172:175], a[248:251], v[96:99]
s_waitcnt lgkmcnt(4) vmcnt(14)
ds_read_b128 v[168:171], v7 offset:6144
v_mfma_f32_16x16x32_bf16 v[100:103], v[172:175], a[252:255], v[100:103]
buffer_load_dwordx4 v4, s[24:27], s64 offen offset:2048 sc1 lds
v_mfma_f32_16x16x32_bf16 v[120:123], v[144:147], v[32:35], v[120:123]
ds_read_b128 v[172:175], v7 offset:7168
v_mfma_f32_16x16x32_bf16 v[124:127], v[144:147], v[36:39], v[124:127]
v_mfma_f32_16x16x32_bf16 v[72:75], v[148:151], v[32:35], v[72:75]
buffer_load_dwordx4 v4, s[24:27], s64 offen offset:3072 sc1 lds
v_mfma_f32_16x16x32_bf16 v[76:79], v[148:151], v[36:39], v[76:79]
s_waitcnt lgkmcnt(4)
ds_read_b128 v[144:147], v7 offset:8192
v_mfma_f32_16x16x32_bf16 v[80:83], v[152:155], v[32:35], v[80:83]
ds_read_b128 v[148:151], v7 offset:9216
v_mfma_f32_16x16x32_bf16 v[84:87], v[152:155], v[36:39], v[84:87]
v_mfma_f32_16x16x32_bf16 v[88:91], v[156:159], v[32:35], v[88:91]
ds_read_b128 v[152:155], v7 offset:10240
v_mfma_f32_16x16x32_bf16 v[92:95], v[156:159], v[36:39], v[92:95]
s_waitcnt lgkmcnt(5)
v_mfma_f32_16x16x32_bf16 v[96:99], v[160:163], v[32:35], v[96:99]
ds_read_b128 v[156:159], v7 offset:11264
v_mfma_f32_16x16x32_bf16 v[100:103], v[160:163], v[36:39], v[100:103]
s_waitcnt vmcnt(14)
v_mfma_f32_16x16x32_bf16 v[120:123], v[164:167], v[40:43], v[120:123]
ds_read_b128 v[160:163], v7 offset:12288
v_mfma_f32_16x16x32_bf16 v[124:127], v[164:167], v[44:47], v[124:127]
s_waitcnt lgkmcnt(5)
v_mfma_f32_16x16x32_bf16 v[72:75], v[168:171], v[40:43], v[72:75]
ds_read_b128 v[164:167], v7 offset:13312
v_mfma_f32_16x16x32_bf16 v[76:79], v[168:171], v[44:47], v[76:79]
v_mfma_f32_16x16x32_bf16 v[80:83], v[172:175], v[40:43], v[80:83]
ds_read_b128 v[168:171], v7 offset:14336
v_mfma_f32_16x16x32_bf16 v[84:87], v[172:175], v[44:47], v[84:87]
s_waitcnt lgkmcnt(5)
v_mfma_f32_16x16x32_bf16 v[88:91], v[144:147], v[40:43], v[88:91]
ds_read_b128 v[172:175], v7 offset:15360
v_mfma_f32_16x16x32_bf16 v[92:95], v[144:147], v[44:47], v[92:95]
s_add_u32 s91, s91, 16384
s_cmp_ge_u32 s91, 163840
s_cselect_b32 s91, 0, s91
v_mfma_f32_16x16x32_bf16 v[96:99], v[148:151], v[40:43], v[96:99]
ds_read_b128 v[144:147], v8 offset:0
v_add_u32 v7, s91, v4
v_mfma_f32_16x16x32_bf16 v[100:103], v[148:151], v[44:47], v[100:103]
s_waitcnt lgkmcnt(5) vmcnt(12)
v_mfma_f32_16x16x32_bf16 v[120:123], v[152:155], v[48:51], v[120:123]
ds_read_b128 v[148:151], v8 offset:1024
v_mfma_f32_16x16x32_bf16 v[124:127], v[152:155], v[52:55], v[124:127]
v_mfma_f32_16x16x32_bf16 v[72:75], v[156:159], v[48:51], v[72:75]
s_mov_b32 m0, s70
s_mov_b32 s64, s68
s_add_u32 s68, s68, 49152
v_mfma_f32_16x16x32_bf16 v[76:79], v[156:159], v[52:55], v[76:79]
s_waitcnt lgkmcnt(4)
ds_read_b128 v[152:155], v8 offset:2048
v_mfma_f32_16x16x32_bf16 v[80:83], v[160:163], v[48:51], v[80:83]
s_add_u32 s70, s70, 16384
s_cmp_ge_u32 s70, 163840
s_cselect_b32 s70, s80, s70
v_mfma_f32_16x16x32_bf16 v[84:87], v[160:163], v[52:55], v[84:87]
buffer_load_dwordx4 v4, s[24:27], s64 offen offset:0 sc1 lds
v_mfma_f32_16x16x32_bf16 v[88:91], v[164:167], v[48:51], v[88:91]
ds_read_b128 v[156:159], v8 offset:3072
v_mfma_f32_16x16x32_bf16 v[92:95], v[164:167], v[52:55], v[92:95]
s_waitcnt lgkmcnt(4)
ds_read_b128 v[160:163], v8 offset:4096
v_mfma_f32_16x16x32_bf16 v[96:99], v[168:171], v[48:51], v[96:99]
buffer_load_dwordx4 v4, s[24:27], s64 offen offset:1024 sc1 lds
v_mfma_f32_16x16x32_bf16 v[100:103], v[168:171], v[52:55], v[100:103]
s_waitcnt vmcnt(8)
ds_read_b128 v[164:167], v8 offset:5120
v_mfma_f32_16x16x32_bf16 v[120:123], v[172:175], v[56:59], v[120:123]
s_waitcnt lgkmcnt(4)
ds_read_b128 v[168:171], v8 offset:6144
v_mfma_f32_16x16x32_bf16 v[124:127], v[172:175], v[60:63], v[124:127]
buffer_load_dwordx4 v4, s[24:27], s64 offen offset:2048 sc1 lds
v_mfma_f32_16x16x32_bf16 v[72:75], v[144:147], v[56:59], v[72:75]
ds_read_b128 v[172:175], v8 offset:7168
v_mfma_f32_16x16x32_bf16 v[76:79], v[144:147], v[60:63], v[76:79]
v_mfma_f32_16x16x32_bf16 v[80:83], v[148:151], v[56:59], v[80:83]
buffer_load_dwordx4 v4, s[24:27], s64 offen offset:3072 sc1 lds
v_mfma_f32_16x16x32_bf16 v[84:87], v[148:151], v[60:63], v[84:87]
s_waitcnt lgkmcnt(4)
ds_read_b128 v[144:147], v8 offset:8192
v_mfma_f32_16x16x32_bf16 v[88:91], v[152:155], v[56:59], v[88:91]
s_mov_b32 m0, s70
s_mov_b32 s64, s68
s_add_u32 s68, s68, 49152
v_mfma_f32_16x16x32_bf16 v[92:95], v[152:155], v[60:63], v[92:95]
s_waitcnt lgkmcnt(3) vmcnt(6)
ds_read_b128 v[148:151], v8 offset:9216
v_mfma_f32_16x16x32_bf16 v[96:99], v[156:159], v[56:59], v[96:99]
s_add_u32 s70, s70, 16384
s_cmp_ge_u32 s70, 163840
s_cselect_b32 s70, s80, s70
v_mfma_f32_16x16x32_bf16 v[100:103], v[156:159], v[60:63], v[100:103]
buffer_load_dwordx4 v4, s[24:27], s64 offen offset:0 sc1 lds
v_mfma_f32_16x16x32_bf16 v[120:123], v[160:163], v[64:67], v[120:123]
ds_read_b128 v[152:155], v8 offset:10240
v_mfma_f32_16x16x32_bf16 v[124:127], v[160:163], v[68:71], v[124:127]
ds_read_b128 v[156:159], v8 offset:11264
v_mfma_f32_16x16x32_bf16 v[72:75], v[164:167], v[64:67], v[72:75]
buffer_load_dwordx4 v4, s[24:27], s64 offen offset:1024 sc1 lds
v_mfma_f32_16x16x32_bf16 v[76:79], v[164:167], v[68:71], v[76:79]
s_waitcnt lgkmcnt(4)
ds_read_b128 v[160:163], v8 offset:12288
v_mfma_f32_16x16x32_bf16 v[80:83], v[168:171], v[64:67], v[80:83]
ds_read_b128 v[164:167], v8 offset:13312
v_mfma_f32_16x16x32_bf16 v[84:87], v[168:171], v[68:71], v[84:87]
buffer_load_dwordx4 v4, s[24:27], s64 offen offset:2048 sc1 lds
v_mfma_f32_16x16x32_bf16 v[88:91], v[172:175], v[64:67], v[88:91]
ds_read_b128 v[168:171], v8 offset:14336
v_mfma_f32_16x16x32_bf16 v[92:95], v[172:175], v[68:71], v[92:95]
s_waitcnt lgkmcnt(5)
v_mfma_f32_16x16x32_bf16 v[96:99], v[144:147], v[64:67], v[96:99]
s_waitcnt vmcnt(7)
ds_read_b128 v[172:175], v8 offset:15360
v_cvt_pk_bf16_f32 v228, v120, v121
v_mfma_f32_16x16x32_bf16 v[100:103], v[144:147], v[68:71], v[100:103]
s_barrier
v_mfma_f32_16x16x32_bf16 v[104:107], v[148:151], a[128:131], v[104:107]
s_add_u32 s91, s91, 16384
ds_read_b128 v[144:147], v7 offset:0
v_cvt_pk_bf16_f32 v229, v122, v123
v_mfma_f32_16x16x32_bf16 v[108:111], v[148:151], a[132:135], v[108:111]
s_waitcnt lgkmcnt(5)
v_cvt_pk_bf16_f32 v230, v124, v125
v_mfma_f32_16x16x32_bf16 v[112:115], v[152:155], a[128:131], v[112:115]
ds_read_b128 v[148:151], v7 offset:1024
v_cvt_pk_bf16_f32 v231, v126, v127
v_mfma_f32_16x16x32_bf16 v[116:119], v[152:155], a[132:135], v[116:119]
buffer_store_dwordx4 v[228:231], v4, s[24:27], s55 offen offset:0 sc1
v_mfma_f32_16x16x32_bf16 v[104:107], v[156:159], a[136:139], v[104:107]
buffer_load_dwordx4 v4, s[24:27], s64 offen offset:3072 sc1 lds
v_mfma_f32_16x16x32_bf16 v[108:111], v[156:159], a[140:143], v[108:111]
s_waitcnt lgkmcnt(4)
ds_read_b128 v[152:155], v7 offset:2048
v_cvt_pk_bf16_f32 v72, v72, v73
v_mfma_f32_16x16x32_bf16 v[112:115], v[160:163], a[136:139], v[112:115]
ds_read_b128 v[156:159], v7 offset:3072
v_cvt_pk_bf16_f32 v73, v74, v75
v_mfma_f32_16x16x32_bf16 v[116:119], v[160:163], a[140:143], v[116:119]
s_cmp_ge_u32 s91, 163840
s_cselect_b32 s91, 0, s91
v_cvt_pk_bf16_f32 v74, v80, v81
v_mfma_f32_16x16x32_bf16 v[104:107], v[164:167], a[144:147], v[104:107]
s_waitcnt lgkmcnt(4)
ds_read_b128 v[160:163], v7 offset:4096
v_cvt_pk_bf16_f32 v75, v82, v83
v_mfma_f32_16x16x32_bf16 v[108:111], v[164:167], a[148:151], v[108:111]
buffer_store_dwordx4 v[72:75], v4, s[24:27], s52 offen offset:0 sc1
v_mfma_f32_16x16x32_bf16 v[112:115], v[168:171], a[144:147], v[112:115]
ds_read_b128 v[164:167], v7 offset:5120
v_cvt_pk_bf16_f32 v76, v76, v77
v_mfma_f32_16x16x32_bf16 v[116:119], v[168:171], a[148:151], v[116:119]
v_cvt_pk_bf16_f32 v77, v78, v79
v_add_u32 v8, s91, v4
v_mfma_f32_16x16x32_bf16 v[104:107], v[172:175], a[152:155], v[104:107]
ds_read_b128 v[168:171], v7 offset:6144
v_cvt_pk_bf16_f32 v78, v84, v85
v_mfma_f32_16x16x32_bf16 v[108:111], v[172:175], a[156:159], v[108:111]
s_waitcnt lgkmcnt(5)
v_cvt_pk_bf16_f32 v79, v86, v87
v_mfma_f32_16x16x32_bf16 v[112:115], v[144:147], a[152:155], v[112:115]
buffer_store_dwordx4 v[76:79], v4, s[24:27], s52 offen offset:1024 sc1
v_mfma_f32_16x16x32_bf16 v[116:119], v[144:147], a[156:159], v[116:119]
ds_read_b128 v[172:175], v7 offset:7168
v_cvt_pk_bf16_f32 v88, v88, v89
v_mfma_f32_16x16x32_bf16 v[104:107], v[148:151], a[160:163], v[104:107]
ds_read_b128 v[144:147], v7 offset:8192
v_cvt_pk_bf16_f32 v89, v90, v91
v_mfma_f32_16x16x32_bf16 v[108:111], v[148:151], a[164:167], v[108:111]
s_waitcnt lgkmcnt(5)
v_cvt_pk_bf16_f32 v90, v96, v97
v_mfma_f32_16x16x32_bf16 v[112:115], v[152:155], a[160:163], v[112:115]
ds_read_b128 v[148:151], v7 offset:9216
v_cvt_pk_bf16_f32 v91, v98, v99
v_mfma_f32_16x16x32_bf16 v[116:119], v[152:155], a[164:167], v[116:119]
buffer_store_dwordx4 v[88:91], v4, s[24:27], s53 offen offset:0 sc1
v_mfma_f32_16x16x32_bf16 v[104:107], v[156:159], a[168:171], v[104:107]
ds_read_b128 v[152:155], v7 offset:10240
v_cvt_pk_bf16_f32 v92, v92, v93
v_mfma_f32_16x16x32_bf16 v[108:111], v[156:159], a[172:175], v[108:111]
s_waitcnt lgkmcnt(5)
v_cvt_pk_bf16_f32 v93, v94, v95
v_mfma_f32_16x16x32_bf16 v[112:115], v[160:163], a[168:171], v[112:115]
ds_read_b128 v[156:159], v7 offset:11264
v_cvt_pk_bf16_f32 v94, v100, v101
v_mfma_f32_16x16x32_bf16 v[116:119], v[160:163], a[172:175], v[116:119]
v_cvt_pk_bf16_f32 v95, v102, v103
v_mfma_f32_16x16x32_bf16 v[104:107], v[164:167], a[176:179], v[104:107]
buffer_store_dwordx4 v[92:95], v4, s[24:27], s53 offen offset:1024 sc1
v_mfma_f32_16x16x32_bf16 v[108:111], v[164:167], a[180:183], v[108:111]
s_waitcnt lgkmcnt(4)
ds_read_b128 v[160:163], v7 offset:12288
v_mfma_f32_16x16x32_bf16 v[112:115], v[168:171], a[176:179], v[112:115]
ds_read_b128 v[164:167], v7 offset:13312
v_mfma_f32_16x16x32_bf16 v[116:119], v[168:171], a[180:183], v[116:119]
v_mfma_f32_16x16x32_bf16 v[104:107], v[172:175], a[184:187], v[104:107]
ds_read_b128 v[168:171], v7 offset:14336
v_mfma_f32_16x16x32_bf16 v[108:111], v[172:175], a[188:191], v[108:111]
s_waitcnt lgkmcnt(5)
v_mfma_f32_16x16x32_bf16 v[112:115], v[144:147], a[184:187], v[112:115]
ds_read_b128 v[172:175], v7 offset:15360
v_mfma_f32_16x16x32_bf16 v[116:119], v[144:147], a[188:191], v[116:119]
s_add_u32 s91, s91, 16384
s_cmp_ge_u32 s91, 163840
s_cselect_b32 s91, 0, s91
v_mfma_f32_16x16x32_bf16 v[104:107], v[148:151], a[192:195], v[104:107]
ds_read_b128 v[144:147], v8 offset:0
v_add_u32 v7, s91, v4
v_mfma_f32_16x16x32_bf16 v[108:111], v[148:151], a[196:199], v[108:111]
s_waitcnt lgkmcnt(5)
v_mfma_f32_16x16x32_bf16 v[112:115], v[152:155], a[192:195], v[112:115]
ds_read_b128 v[148:151], v8 offset:1024
v_mfma_f32_16x16x32_bf16 v[116:119], v[152:155], a[196:199], v[116:119]
v_mfma_f32_16x16x32_bf16 v[104:107], v[156:159], a[200:203], v[104:107]
s_mov_b32 m0, s70
s_mov_b32 s64, s68
s_add_u32 s68, s68, 49152
v_mfma_f32_16x16x32_bf16 v[108:111], v[156:159], a[204:207], v[108:111]
s_waitcnt lgkmcnt(4)
ds_read_b128 v[152:155], v8 offset:2048
v_mfma_f32_16x16x32_bf16 v[112:115], v[160:163], a[200:203], v[112:115]
s_add_u32 s70, s70, 16384
s_cmp_ge_u32 s70, 163840
s_cselect_b32 s70, s80, s70
v_mfma_f32_16x16x32_bf16 v[116:119], v[160:163], a[204:207], v[116:119]
buffer_load_dwordx4 v4, s[24:27], s64 offen offset:0 sc1 lds
v_mfma_f32_16x16x32_bf16 v[104:107], v[164:167], a[208:211], v[104:107]
ds_read_b128 v[156:159], v8 offset:3072
v_mfma_f32_16x16x32_bf16 v[108:111], v[164:167], a[212:215], v[108:111]
s_waitcnt lgkmcnt(4)
ds_read_b128 v[160:163], v8 offset:4096
v_mfma_f32_16x16x32_bf16 v[112:115], v[168:171], a[208:211], v[112:115]
buffer_load_dwordx4 v4, s[24:27], s64 offen offset:1024 sc1 lds
v_mfma_f32_16x16x32_bf16 v[116:119], v[168:171], a[212:215], v[116:119]
ds_read_b128 v[164:167], v8 offset:5120
v_mfma_f32_16x16x32_bf16 v[104:107], v[172:175], a[216:219], v[104:107]
s_waitcnt lgkmcnt(4)
ds_read_b128 v[168:171], v8 offset:6144
v_mfma_f32_16x16x32_bf16 v[108:111], v[172:175], a[220:223], v[108:111]
buffer_load_dwordx4 v4, s[24:27], s64 offen offset:2048 sc1 lds
v_mfma_f32_16x16x32_bf16 v[112:115], v[144:147], a[216:219], v[112:115]
ds_read_b128 v[172:175], v8 offset:7168
v_mfma_f32_16x16x32_bf16 v[116:119], v[144:147], a[220:223], v[116:119]
v_mfma_f32_16x16x32_bf16 v[104:107], v[148:151], a[224:227], v[104:107]
buffer_load_dwordx4 v4, s[24:27], s64 offen offset:3072 sc1 lds
v_mfma_f32_16x16x32_bf16 v[108:111], v[148:151], a[228:231], v[108:111]
s_waitcnt lgkmcnt(4)
ds_read_b128 v[144:147], v8 offset:8192
v_mfma_f32_16x16x32_bf16 v[112:115], v[152:155], a[224:227], v[112:115]
s_mov_b32 m0, s70
s_mov_b32 s64, s68
s_add_u32 s68, s68, 49152
v_mfma_f32_16x16x32_bf16 v[116:119], v[152:155], a[228:231], v[116:119]
s_waitcnt lgkmcnt(3)
ds_read_b128 v[148:151], v8 offset:9216
v_mfma_f32_16x16x32_bf16 v[104:107], v[156:159], a[232:235], v[104:107]
s_add_u32 s70, s70, 16384
s_cmp_ge_u32 s70, 163840
s_cselect_b32 s70, s80, s70
v_mfma_f32_16x16x32_bf16 v[108:111], v[156:159], a[236:239], v[108:111]
buffer_load_dwordx4 v4, s[24:27], s64 offen offset:0 sc1 lds
v_mfma_f32_16x16x32_bf16 v[112:115], v[160:163], a[232:235], v[112:115]
ds_read_b128 v[152:155], v8 offset:10240
v_mfma_f32_16x16x32_bf16 v[116:119], v[160:163], a[236:239], v[116:119]
ds_read_b128 v[156:159], v8 offset:11264
v_mfma_f32_16x16x32_bf16 v[104:107], v[164:167], a[240:243], v[104:107]
buffer_load_dwordx4 v4, s[24:27], s64 offen offset:1024 sc1 lds
v_mfma_f32_16x16x32_bf16 v[108:111], v[164:167], a[244:247], v[108:111]
s_waitcnt lgkmcnt(4)
ds_read_b128 v[160:163], v8 offset:12288
v_mfma_f32_16x16x32_bf16 v[112:115], v[168:171], a[240:243], v[112:115]
ds_read_b128 v[164:167], v8 offset:13312
v_mfma_f32_16x16x32_bf16 v[116:119], v[168:171], a[244:247], v[116:119]
buffer_load_dwordx4 v4, s[24:27], s64 offen offset:2048 sc1 lds
v_mfma_f32_16x16x32_bf16 v[104:107], v[172:175], a[248:251], v[104:107]
ds_read_b128 v[168:171], v8 offset:14336
v_mfma_f32_16x16x32_bf16 v[108:111], v[172:175], a[252:255], v[108:111]
s_waitcnt lgkmcnt(5)
v_mfma_f32_16x16x32_bf16 v[112:115], v[144:147], a[248:251], v[112:115]
s_waitcnt vmcnt(11)
ds_read_b128 v[172:175], v8 offset:15360
v_mfma_f32_16x16x32_bf16 v[116:119], v[144:147], a[252:255], v[116:119]
s_barrier
v_mfma_f32_16x16x32_bf16 v[104:107], v[148:151], v[32:35], v[104:107]
buffer_load_dwordx4 v4, s[24:27], s64 offen offset:3072 sc1 lds
v_mfma_f32_16x16x32_bf16 v[108:111], v[148:151], v[36:39], v[108:111]
s_waitcnt lgkmcnt(4)
s_add_u32 s91, s91, 16384
ds_read_b128 v[144:147], v7 offset:0
v_mfma_f32_16x16x32_bf16 v[112:115], v[152:155], v[32:35], v[112:115]
s_cmp_ge_u32 s91, 163840
s_cselect_b32 s91, 0, s91
ds_read_b128 v[148:151], v7 offset:1024
v_mfma_f32_16x16x32_bf16 v[116:119], v[152:155], v[36:39], v[116:119]
v_add_u32 v8, s91, v4
v_mfma_f32_16x16x32_bf16 v[104:107], v[156:159], v[40:43], v[104:107]
ds_read_b128 v[152:155], v7 offset:2048
v_mfma_f32_16x16x32_bf16 v[108:111], v[156:159], v[44:47], v[108:111]
s_waitcnt lgkmcnt(5)
v_mfma_f32_16x16x32_bf16 v[112:115], v[160:163], v[40:43], v[112:115]
ds_read_b128 v[156:159], v7 offset:3072
v_mfma_f32_16x16x32_bf16 v[116:119], v[160:163], v[44:47], v[116:119]
v_mfma_f32_16x16x32_bf16 v[104:107], v[164:167], v[48:51], v[104:107]
ds_read_b128 v[160:163], v7 offset:4096
v_mfma_f32_16x16x32_bf16 v[108:111], v[164:167], v[52:55], v[108:111]
s_waitcnt lgkmcnt(5)
v_mfma_f32_16x16x32_bf16 v[112:115], v[168:171], v[48:51], v[112:115]
s_waitcnt vmcnt(8)
ds_read_b128 v[164:167], v7 offset:5120
v_mfma_f32_16x16x32_bf16 v[116:119], v[168:171], v[52:55], v[116:119]
buffer_atomic_add v1, v0, s[24:27], s73 offen offset:0 sc1
v_mfma_f32_16x16x32_bf16 v[104:107], v[172:175], v[56:59], v[104:107]
ds_read_b128 v[168:171], v7 offset:6144
v_mfma_f32_16x16x32_bf16 v[108:111], v[172:175], v[60:63], v[108:111]
s_waitcnt lgkmcnt(5)
v_mfma_f32_16x16x32_bf16 v[112:115], v[144:147], v[56:59], v[112:115]
ds_read_b128 v[172:175], v7 offset:7168
v_mfma_f32_16x16x32_bf16 v[116:119], v[144:147], v[60:63], v[116:119]
v_mfma_f32_16x16x32_bf16 v[104:107], v[148:151], v[64:67], v[104:107]
ds_read_b128 v[144:147], v7 offset:8192
v_mfma_f32_16x16x32_bf16 v[108:111], v[148:151], v[68:71], v[108:111]
s_waitcnt lgkmcnt(5)
v_mfma_f32_16x16x32_bf16 v[112:115], v[152:155], v[64:67], v[112:115]
ds_read_b128 v[148:151], v7 offset:9216
v_mfma_f32_16x16x32_bf16 v[116:119], v[152:155], v[68:71], v[116:119]
v_mfma_f32_16x16x32_bf16 v[128:131], v[156:159], a[0:3], 0
ds_read_b128 v[152:155], v7 offset:10240
v_mfma_f32_16x16x32_bf16 v[132:135], v[156:159], a[4:7], 0
s_waitcnt lgkmcnt(5)
v_mfma_f32_16x16x32_bf16 v[136:139], v[160:163], a[0:3], 0
ds_read_b128 v[156:159], v7 offset:11264
v_mfma_f32_16x16x32_bf16 v[140:143], v[160:163], a[4:7], 0
v_mfma_f32_16x16x32_bf16 v[128:131], v[164:167], a[8:11], v[128:131]
ds_read_b128 v[160:163], v7 offset:12288
v_mfma_f32_16x16x32_bf16 v[132:135], v[164:167], a[12:15], v[132:135]
s_waitcnt lgkmcnt(5)
v_cvt_pk_bf16_f32 v104, v104, v105
v_mfma_f32_16x16x32_bf16 v[136:139], v[168:171], a[8:11], v[136:139]
ds_read_b128 v[164:167], v7 offset:13312
v_cvt_pk_bf16_f32 v105, v106, v107
v_mfma_f32_16x16x32_bf16 v[140:143], v[168:171], a[12:15], v[140:143]
v_cvt_pk_bf16_f32 v106, v112, v113
v_mfma_f32_16x16x32_bf16 v[128:131], v[172:175], a[16:19], v[128:131]
s_waitcnt lgkmcnt(4)
ds_read_b128 v[168:171], v7 offset:14336
v_cvt_pk_bf16_f32 v107, v114, v115
v_mfma_f32_16x16x32_bf16 v[132:135], v[172:175], a[20:23], v[132:135]
buffer_store_dwordx4 v[104:107], v4, s[24:27], s54 offen offset:0 sc1
v_mfma_f32_16x16x32_bf16 v[136:139], v[144:147], a[16:19], v[136:139]
ds_read_b128 v[172:175], v7 offset:15360
v_cvt_pk_bf16_f32 v108, v108, v109
v_mfma_f32_16x16x32_bf16 v[140:143], v[144:147], a[20:23], v[140:143]
s_add_u32 s91, s91, 16384
v_cvt_pk_bf16_f32 v109, v110, v111
v_mfma_f32_16x16x32_bf16 v[128:131], v[148:151], a[24:27], v[128:131]
ds_read_b128 v[144:147], v8 offset:0
v_cvt_pk_bf16_f32 v110, v116, v117
v_mfma_f32_16x16x32_bf16 v[132:135], v[148:151], a[28:31], v[132:135]
s_waitcnt lgkmcnt(5)
v_cvt_pk_bf16_f32 v111, v118, v119
v_mfma_f32_16x16x32_bf16 v[136:139], v[152:155], a[24:27], v[136:139]
buffer_store_dwordx4 v[108:111], v4, s[24:27], s54 offen offset:1024 sc1
v_mfma_f32_16x16x32_bf16 v[140:143], v[152:155], a[28:31], v[140:143]
s_cmp_ge_u32 s91, 163840
s_cselect_b32 s91, 0, s91
ds_read_b128 v[148:151], v8 offset:1024
v_mfma_f32_16x16x32_bf16 v[128:131], v[156:159], a[32:35], v[128:131]
s_mov_b32 m0, s70
s_mov_b32 s64, s68
s_add_u32 s68, s68, 49152
v_mfma_f32_16x16x32_bf16 v[132:135], v[156:159], a[36:39], v[132:135]
s_waitcnt lgkmcnt(4)
ds_read_b128 v[152:155], v8 offset:2048
v_add_u32 v7, s91, v4
v_mfma_f32_16x16x32_bf16 v[136:139], v[160:163], a[32:35], v[136:139]
s_cmp_lt_u32 s3, 3
s_cselect_b32 s68, s64, 2147418112
ds_read_b128 v[156:159], v8 offset:3072
v_mfma_f32_16x16x32_bf16 v[140:143], v[160:163], a[36:39], v[140:143]
buffer_load_dwordx4 v4, s[24:27], s64 offen offset:0 sc1 lds
v_mfma_f32_16x16x32_bf16 v[128:131], v[164:167], a[40:43], v[128:131]
ds_read_b128 v[160:163], v8 offset:4096
v_mfma_f32_16x16x32_bf16 v[132:135], v[164:167], a[44:47], v[132:135]
s_waitcnt lgkmcnt(5)
v_mfma_f32_16x16x32_bf16 v[136:139], v[168:171], a[40:43], v[136:139]
buffer_load_dwordx4 v4, s[24:27], s68 offen offset:1024 sc1 lds
v_mfma_f32_16x16x32_bf16 v[140:143], v[168:171], a[44:47], v[140:143]
ds_read_b128 v[164:167], v8 offset:5120
v_mfma_f32_16x16x32_bf16 v[128:131], v[172:175], a[48:51], v[128:131]
s_waitcnt lgkmcnt(4)
ds_read_b128 v[168:171], v8 offset:6144
v_mfma_f32_16x16x32_bf16 v[132:135], v[172:175], a[52:55], v[132:135]
buffer_load_dwordx4 v4, s[24:27], s68 offen offset:2048 sc1 lds
v_mfma_f32_16x16x32_bf16 v[136:139], v[144:147], a[48:51], v[136:139]
ds_read_b128 v[172:175], v8 offset:7168
v_mfma_f32_16x16x32_bf16 v[140:143], v[144:147], a[52:55], v[140:143]
v_mfma_f32_16x16x32_bf16 v[128:131], v[148:151], a[56:59], v[128:131]
buffer_load_dwordx4 v4, s[24:27], s68 offen offset:3072 sc1 lds
v_mfma_f32_16x16x32_bf16 v[132:135], v[148:151], a[60:63], v[132:135]
s_waitcnt lgkmcnt(4)
ds_read_b128 v[144:147], v8 offset:8192
v_mfma_f32_16x16x32_bf16 v[136:139], v[152:155], a[56:59], v[136:139]
ds_read_b128 v[148:151], v8 offset:9216
v_mfma_f32_16x16x32_bf16 v[140:143], v[152:155], a[60:63], v[140:143]
buffer_load_dword v12, v10, s[24:27], s73 offen sc1
v_mfma_f32_16x16x32_bf16 v[128:131], v[156:159], a[64:67], v[128:131]
ds_read_b128 v[152:155], v8 offset:10240
v_mfma_f32_16x16x32_bf16 v[132:135], v[156:159], a[68:71], v[132:135]
s_waitcnt lgkmcnt(5)
v_mfma_f32_16x16x32_bf16 v[136:139], v[160:163], a[64:67], v[136:139]
ds_read_b128 v[156:159], v8 offset:11264
v_mfma_f32_16x16x32_bf16 v[140:143], v[160:163], a[68:71], v[140:143]
v_mfma_f32_16x16x32_bf16 v[128:131], v[164:167], a[72:75], v[128:131]
ds_read_b128 v[160:163], v8 offset:12288
v_mfma_f32_16x16x32_bf16 v[132:135], v[164:167], a[76:79], v[132:135]
s_waitcnt lgkmcnt(5)
v_mfma_f32_16x16x32_bf16 v[136:139], v[168:171], a[72:75], v[136:139]
ds_read_b128 v[164:167], v8 offset:13312
v_mfma_f32_16x16x32_bf16 v[140:143], v[168:171], a[76:79], v[140:143]
v_mfma_f32_16x16x32_bf16 v[128:131], v[172:175], a[80:83], v[128:131]
ds_read_b128 v[168:171], v8 offset:14336
v_mfma_f32_16x16x32_bf16 v[132:135], v[172:175], a[84:87], v[132:135]
s_waitcnt lgkmcnt(5)
v_mfma_f32_16x16x32_bf16 v[136:139], v[144:147], a[80:83], v[136:139]
s_waitcnt vmcnt(8)
ds_read_b128 v[172:175], v8 offset:15360
v_mfma_f32_16x16x32_bf16 v[140:143], v[144:147], a[84:87], v[140:143]
s_barrier
v_mfma_f32_16x16x32_bf16 v[128:131], v[148:151], a[88:91], v[128:131]
s_add_u32 s91, s91, 16384
ds_read_b128 v[144:147], v7 offset:0
v_mfma_f32_16x16x32_bf16 v[132:135], v[148:151], a[92:95], v[132:135]
s_waitcnt lgkmcnt(5)
s_cmp_ge_u32 s91, 163840
s_cselect_b32 s91, 0, s91
v_mfma_f32_16x16x32_bf16 v[136:139], v[152:155], a[88:91], v[136:139]
ds_read_b128 v[148:151], v7 offset:1024
v_add_u32 v8, s91, v4
v_mfma_f32_16x16x32_bf16 v[140:143], v[152:155], a[92:95], v[140:143]
v_mfma_f32_16x16x32_bf16 v[128:131], v[156:159], a[96:99], v[128:131]
ds_read_b128 v[152:155], v7 offset:2048
v_mfma_f32_16x16x32_bf16 v[132:135], v[156:159], a[100:103], v[132:135]
s_waitcnt lgkmcnt(5)
v_mfma_f32_16x16x32_bf16 v[136:139], v[160:163], a[96:99], v[136:139]
ds_read_b128 v[156:159], v7 offset:3072
v_mfma_f32_16x16x32_bf16 v[140:143], v[160:163], a[100:103], v[140:143]
v_mfma_f32_16x16x32_bf16 v[128:131], v[164:167], a[104:107], v[128:131]
ds_read_b128 v[160:163], v7 offset:4096
v_mfma_f32_16x16x32_bf16 v[132:135], v[164:167], a[108:111], v[132:135]
s_waitcnt lgkmcnt(5)
v_mfma_f32_16x16x32_bf16 v[136:139], v[168:171], a[104:107], v[136:139]
s_waitcnt vmcnt(5)
ds_read_b128 v[164:167], v7 offset:5120
v_mfma_f32_16x16x32_bf16 v[140:143], v[168:171], a[108:111], v[140:143]
buffer_atomic_add v1, v0, s[24:27], s73 offen offset:16 sc1
v_mfma_f32_16x16x32_bf16 v[128:131], v[172:175], a[112:115], v[128:131]
ds_read_b128 v[168:171], v7 offset:6144
v_mfma_f32_16x16x32_bf16 v[132:135], v[172:175], a[116:119], v[132:135]
s_waitcnt lgkmcnt(5)
v_mfma_f32_16x16x32_bf16 v[136:139], v[144:147], a[112:115], v[136:139]
ds_read_b128 v[172:175], v7 offset:7168
v_mfma_f32_16x16x32_bf16 v[140:143], v[144:147], a[116:119], v[140:143]
v_mfma_f32_16x16x32_bf16 v[128:131], v[148:151], a[120:123], v[128:131]
ds_read_b128 v[144:147], v7 offset:8192
v_mfma_f32_16x16x32_bf16 v[132:135], v[148:151], a[124:127], v[132:135]
s_waitcnt vmcnt(1) lgkmcnt(5)
v_mfma_f32_16x16x32_bf16 v[136:139], v[152:155], a[120:123], v[136:139]
ds_read_b128 v[148:151], v7 offset:9216
v_cmp_gt_u32 vcc, 4, v12
v_mfma_f32_16x16x32_bf16 v[140:143], v[152:155], a[124:127], v[140:143]
v_mfma_f32_16x16x32_bf16 v[128:131], v[156:159], a[128:131], v[128:131]
ds_read_b128 v[152:155], v7 offset:10240
v_mfma_f32_16x16x32_bf16 v[132:135], v[156:159], a[132:135], v[132:135]
s_waitcnt lgkmcnt(5)
v_mfma_f32_16x16x32_bf16 v[136:139], v[160:163], a[128:131], v[136:139]
ds_read_b128 v[156:159], v7 offset:11264
v_mfma_f32_16x16x32_bf16 v[140:143], v[160:163], a[132:135], v[140:143]
s_cbranch_vccnz CK_P1
CK_P1_R:
v_mfma_f32_16x16x32_bf16 v[128:131], v[164:167], a[136:139], v[128:131]
ds_read_b128 v[160:163], v7 offset:12288
v_mfma_f32_16x16x32_bf16 v[132:135], v[164:167], a[140:143], v[132:135]
s_waitcnt lgkmcnt(5)
v_mfma_f32_16x16x32_bf16 v[136:139], v[168:171], a[136:139], v[136:139]
buffer_load_dwordx4 v[176:179], v4, s[24:27], s69 offen offset:0 sc1
v_mfma_f32_16x16x32_bf16 v[140:143], v[168:171], a[140:143], v[140:143]
ds_read_b128 v[164:167], v7 offset:13312
v_mfma_f32_16x16x32_bf16 v[128:131], v[172:175], a[144:147], v[128:131]
s_waitcnt lgkmcnt(4)
ds_read_b128 v[168:171], v7 offset:14336
v_mfma_f32_16x16x32_bf16 v[132:135], v[172:175], a[148:151], v[132:135]
buffer_load_dwordx4 v[180:183], v4, s[24:27], s69 offen offset:1024 sc1
v_mfma_f32_16x16x32_bf16 v[136:139], v[144:147], a[144:147], v[136:139]
ds_read_b128 v[172:175], v7 offset:15360
v_mfma_f32_16x16x32_bf16 v[140:143], v[144:147], a[148:151], v[140:143]
s_add_u32 s91, s91, 16384
s_cmp_ge_u32 s91, 163840
s_cselect_b32 s91, 0, s91
v_mfma_f32_16x16x32_bf16 v[128:131], v[148:151], a[152:155], v[128:131]
buffer_load_dwordx4 v[184:187], v4, s[24:27], s69 offen offset:2048 sc1
v_mfma_f32_16x16x32_bf16 v[132:135], v[148:151], a[156:159], v[132:135]
s_waitcnt lgkmcnt(4)
ds_read_b128 v[144:147], v8 offset:0
v_add_u32 v7, s91, v4
v_mfma_f32_16x16x32_bf16 v[136:139], v[152:155], a[152:155], v[136:139]
ds_read_b128 v[148:151], v8 offset:1024
v_mfma_f32_16x16x32_bf16 v[140:143], v[152:155], a[156:159], v[140:143]
buffer_load_dwordx4 v[188:191], v4, s[24:27], s69 offen offset:3072 sc1
v_mfma_f32_16x16x32_bf16 v[128:131], v[156:159], a[160:163], v[128:131]
ds_read_b128 v[152:155], v8 offset:2048
v_mfma_f32_16x16x32_bf16 v[132:135], v[156:159], a[164:167], v[132:135]
s_waitcnt lgkmcnt(5)
v_mfma_f32_16x16x32_bf16 v[136:139], v[160:163], a[160:163], v[136:139]
buffer_load_dwordx4 v[192:195], v4, s[24:27], s71 offen offset:0 sc1
v_mfma_f32_16x16x32_bf16 v[140:143], v[160:163], a[164:167], v[140:143]
ds_read_b128 v[156:159], v8 offset:3072
v_mfma_f32_16x16x32_bf16 v[128:131], v[164:167], a[168:171], v[128:131]
s_waitcnt lgkmcnt(4)
ds_read_b128 v[160:163], v8 offset:4096
v_mfma_f32_16x16x32_bf16 v[132:135], v[164:167], a[172:175], v[132:135]
buffer_load_dwordx4 v[196:199], v4, s[24:27], s71 offen offset:1024 sc1
v_mfma_f32_16x16x32_bf16 v[136:139], v[168:171], a[168:171], v[136:139]
ds_read_b128 v[164:167], v8 offset:5120
v_mfma_f32_16x16x32_bf16 v[140:143], v[168:171], a[172:175], v[140:143]
v_mfma_f32_16x16x32_bf16 v[128:131], v[172:175], a[176:179], v[128:131]
buffer_load_dwordx4 v[200:203], v4, s[24:27], s71 offen offset:2048 sc1
v_mfma_f32_16x16x32_bf16 v[132:135], v[172:175], a[180:183], v[132:135]
s_waitcnt lgkmcnt(4)
ds_read_b128 v[168:171], v8 offset:6144
v_mfma_f32_16x16x32_bf16 v[136:139], v[144:147], a[176:179], v[136:139]
ds_read_b128 v[172:175], v8 offset:7168
v_mfma_f32_16x16x32_bf16 v[140:143], v[144:147], a[180:183], v[140:143]
v_mfma_f32_16x16x32_bf16 v[128:131], v[148:151], a[184:187], v[128:131]
ds_read_b128 v[144:147], v8 offset:8192
v_mfma_f32_16x16x32_bf16 v[132:135], v[148:151], a[188:191], v[132:135]
s_waitcnt lgkmcnt(5)
v_mfma_f32_16x16x32_bf16 v[136:139], v[152:155], a[184:187], v[136:139]
ds_read_b128 v[148:151], v8 offset:9216
v_mfma_f32_16x16x32_bf16 v[140:143], v[152:155], a[188:191], v[140:143]
v_mfma_f32_16x16x32_bf16 v[128:131], v[156:159], a[192:195], v[128:131]
ds_read_b128 v[152:155], v8 offset:10240
v_mfma_f32_16x16x32_bf16 v[132:135], v[156:159], a[196:199], v[132:135]
s_waitcnt lgkmcnt(5)
v_mfma_f32_16x16x32_bf16 v[136:139], v[160:163], a[192:195], v[136:139]
ds_read_b128 v[156:159], v8 offset:11264
v_mfma_f32_16x16x32_bf16 v[140:143], v[160:163], a[196:199], v[140:143]
v_mfma_f32_16x16x32_bf16 v[128:131], v[164:167], a[200:203], v[128:131]
ds_read_b128 v[160:163], v8 offset:12288
v_mfma_f32_16x16x32_bf16 v[132:135], v[164:167], a[204:207], v[132:135]
s_waitcnt lgkmcnt(5)
v_mfma_f32_16x16x32_bf16 v[136:139], v[168:171], a[200:203], v[136:139]
ds_read_b128 v[164:167], v8 offset:13312
v_mfma_f32_16x16x32_bf16 v[140:143], v[168:171], a[204:207], v[140:143]
v_mfma_f32_16x16x32_bf16 v[128:131], v[172:175], a[208:211], v[128:131]
ds_read_b128 v[168:171], v8 offset:14336
v_mfma_f32_16x16x32_bf16 v[132:135], v[172:175], a[212:215], v[132:135]
s_waitcnt lgkmcnt(5)
v_mfma_f32_16x16x32_bf16 v[136:139], v[144:147], a[208:211], v[136:139]
s_waitcnt vmcnt(9)
ds_read_b128 v[172:175], v8 offset:15360
v_mfma_f32_16x16x32_bf16 v[140:143], v[144:147], a[212:215], v[140:143]
s_barrier
v_mfma_f32_16x16x32_bf16 v[128:131], v[148:151], a[216:219], v[128:131]
ds_read_b128 v[144:147], v7 offset:0
v_mfma_f32_16x16x32_bf16 v[132:135], v[148:151], a[220:223], v[132:135]
s_waitcnt lgkmcnt(5)
v_mfma_f32_16x16x32_bf16 v[136:139], v[152:155], a[216:219], v[136:139]
ds_read_b128 v[148:151], v7 offset:1024
v_mfma_f32_16x16x32_bf16 v[140:143], v[152:155], a[220:223], v[140:143]
v_mfma_f32_16x16x32_bf16 v[128:131], v[156:159], a[224:227], v[128:131]
ds_read_b128 v[152:155], v7 offset:2048
v_mfma_f32_16x16x32_bf16 v[132:135], v[156:159], a[228:231], v[132:135]
s_waitcnt lgkmcnt(5)
v_mfma_f32_16x16x32_bf16 v[136:139], v[160:163], a[224:227], v[136:139]
ds_read_b128 v[156:159], v7 offset:3072
v_mfma_f32_16x16x32_bf16 v[140:143], v[160:163], a[228:231], v[140:143]
v_mfma_f32_16x16x32_bf16 v[128:131], v[164:167], a[232:235], v[128:131]
ds_read_b128 v[160:163], v7 offset:4096
v_mfma_f32_16x16x32_bf16 v[132:135], v[164:167], a[236:239], v[132:135]
s_waitcnt lgkmcnt(5)
v_mfma_f32_16x16x32_bf16 v[136:139], v[168:171], a[232:235], v[136:139]
ds_read_b128 v[164:167], v7 offset:5120
v_mfma_f32_16x16x32_bf16 v[140:143], v[168:171], a[236:239], v[140:143]
v_mfma_f32_16x16x32_bf16 v[128:131], v[172:175], a[240:243], v[128:131]
ds_read_b128 v[168:171], v7 offset:6144
v_mfma_f32_16x16x32_bf16 v[132:135], v[172:175], a[244:247], v[132:135]
s_waitcnt lgkmcnt(5)
v_mfma_f32_16x16x32_bf16 v[136:139], v[144:147], a[240:243], v[136:139]
ds_read_b128 v[172:175], v7 offset:7168
v_mfma_f32_16x16x32_bf16 v[140:143], v[144:147], a[244:247], v[140:143]
v_mfma_f32_16x16x32_bf16 v[128:131], v[148:151], a[248:251], v[128:131]
ds_read_b128 v[144:147], v7 offset:8192
v_mfma_f32_16x16x32_bf16 v[132:135], v[148:151], a[252:255], v[132:135]
s_waitcnt lgkmcnt(5)
v_mfma_f32_16x16x32_bf16 v[136:139], v[152:155], a[248:251], v[136:139]
ds_read_b128 v[148:151], v7 offset:9216
v_mfma_f32_16x16x32_bf16 v[140:143], v[152:155], a[252:255], v[140:143]
v_mfma_f32_16x16x32_bf16 v[128:131], v[156:159], v[32:35], v[128:131]
buffer_load_dword v12, v10, s[24:27], s73 offen offset:16 sc1
v_mfma_f32_16x16x32_bf16 v[132:135], v[156:159], v[36:39], v[132:135]
s_waitcnt lgkmcnt(4)
ds_read_b128 v[152:155], v7 offset:10240
v_mfma_f32_16x16x32_bf16 v[136:139], v[160:163], v[32:35], v[136:139]
ds_read_b128 v[156:159], v7 offset:11264
v_mfma_f32_16x16x32_bf16 v[140:143], v[160:163], v[36:39], v[140:143]
v_mfma_f32_16x16x32_bf16 v[128:131], v[164:167], v[40:43], v[128:131]
ds_read_b128 v[160:163], v7 offset:12288
v_mfma_f32_16x16x32_bf16 v[132:135], v[164:167], v[44:47], v[132:135]
s_waitcnt lgkmcnt(5)
v_mfma_f32_16x16x32_bf16 v[136:139], v[168:171], v[40:43], v[136:139]
v_mfma_f32_16x16x32_bf16 v[140:143], v[168:171], v[44:47], v[140:143]
v_mfma_f32_16x16x32_bf16 v[128:131], v[172:175], v[48:51], v[128:131]
v_mfma_f32_16x16x32_bf16 v[132:135], v[172:175], v[52:55], v[132:135]
s_waitcnt lgkmcnt(3)
v_mfma_f32_16x16x32_bf16 v[136:139], v[144:147], v[48:51], v[136:139]
v_mfma_f32_16x16x32_bf16 v[140:143], v[144:147], v[52:55], v[140:143]
v_mfma_f32_16x16x32_bf16 v[128:131], v[148:151], v[56:59], v[128:131]
v_mfma_f32_16x16x32_bf16 v[132:135], v[148:151], v[60:63], v[132:135]
s_waitcnt lgkmcnt(1)
v_mfma_f32_16x16x32_bf16 v[136:139], v[152:155], v[56:59], v[136:139]
v_mfma_f32_16x16x32_bf16 v[140:143], v[152:155], v[60:63], v[140:143]
v_mfma_f32_16x16x32_bf16 v[128:131], v[156:159], v[64:67], v[128:131]
v_mfma_f32_16x16x32_bf16 v[132:135], v[156:159], v[68:71], v[132:135]
s_waitcnt lgkmcnt(0)
v_mfma_f32_16x16x32_bf16 v[136:139], v[160:163], v[64:67], v[136:139]
v_mfma_f32_16x16x32_bf16 v[140:143], v[160:163], v[68:71], v[140:143]
s_waitcnt vmcnt(0)
v_cmp_gt_u32 vcc, 4, v12
s_nop 4
s_cbranch_vccnz CK_P2
CK_P2_R:
buffer_load_dwordx4 v[204:207], v4, s[24:27], s83 offen offset:0 sc1
buffer_load_dwordx4 v[208:211], v4, s[24:27], s83 offen offset:1024 sc1
s_and_b32 s54, s3, 1
s_mul_i32 s54, s54, 18432
s_mul_i32 s55, s86, 288
s_add_u32 s54, s54, s55
s_add_u32 s54, s54, 256
s_sub_u32 s55, 63, s72
s_mul_i32 s55, s55, 36864
s_add_u32 s55, s55, s54
s_mul_i32 s52, s72, 36864
s_add_u32 s54, s54, s52
s_lshl_b32 s53, s84, 6
s_sub_u32 s53, s53, 256
s_add_u32 s52, s54, s53
s_add_u32 s53, s55, s53
v_lshlrev_b32 v16, 16, v176
v_and_b32 v17, v13, v176
v_lshlrev_b32 v18, 16, v177
v_and_b32 v19, v13, v177
v_lshlrev_b32 v20, 16, v178
v_and_b32 v21, v13, v178
v_lshlrev_b32 v22, 16, v179
v_and_b32 v23, v13, v179
v_pk_add_f32 v[128:129], v[128:129], v[16:17]
v_pk_add_f32 v[130:131], v[130:131], v[18:19]
v_pk_add_f32 v[136:137], v[136:137], v[20:21]
v_pk_add_f32 v[138:139], v[138:139], v[22:23]
v_lshlrev_b32 v16, 16, v180
v_and_b32 v17, v13, v180
v_lshlrev_b32 v18, 16, v181
v_and_b32 v19, v13, v181
v_lshlrev_b32 v20, 16, v182
v_and_b32 v21, v13, v182
v_lshlrev_b32 v22, 16, v183
v_and_b32 v23, v13, v183
v_pk_add_f32 v[132:133], v[132:133], v[16:17]
v_pk_add_f32 v[134:135], v[134:135], v[18:19]
v_pk_add_f32 v[140:141], v[140:141], v[20:21]
v_pk_add_f32 v[142:143], v[142:143], v[22:23]
v_lshlrev_b32 v16, 16, v184
v_and_b32 v17, v13, v184
v_lshlrev_b32 v18, 16, v185
v_and_b32 v19, v13, v185
v_lshlrev_b32 v20, 16, v186
v_and_b32 v21, v13, v186
v_lshlrev_b32 v22, 16, v187
v_and_b32 v23, v13, v187
v_pk_add_f32 v[128:129], v[128:129], v[16:17]
v_pk_add_f32 v[130:131], v[130:131], v[18:19]
v_pk_add_f32 v[136:137], v[136:137], v[20:21]
v_pk_add_f32 v[138:139], v[138:139], v[22:23]
v_lshlrev_b32 v16, 16, v188
v_and_b32 v17, v13, v188
v_lshlrev_b32 v18, 16, v189
v_and_b32 v19, v13, v189
v_lshlrev_b32 v20, 16, v190
v_and_b32 v21, v13, v190
v_lshlrev_b32 v22, 16, v191
v_and_b32 v23, v13, v191
v_pk_add_f32 v[132:133], v[132:133], v[16:17]
v_pk_add_f32 v[134:135], v[134:135], v[18:19]
v_pk_add_f32 v[140:141], v[140:141], v[20:21]
v_pk_add_f32 v[142:143], v[142:143], v[22:23]
s_cmp_lg_u32 s3, s84
s_cbranch_scc1 L_NO9
v_lshlrev_b32 v16, 16, v192
v_and_b32 v17, v13, v192
v_lshlrev_b32 v18, 16, v193
v_and_b32 v19, v13, v193
v_lshlrev_b32 v20, 16, v194
v_and_b32 v21, v13, v194
v_lshlrev_b32 v22, 16, v195
v_and_b32 v23, v13, v195
v_pk_add_f32 v[120:121], v[120:121], v[16:17]
v_pk_add_f32 v[122:123], v[122:123], v[18:19]
v_pk_add_f32 v[124:125], v[124:125], v[20:21]
v_pk_add_f32 v[126:127], v[126:127], v[22:23]
v_lshlrev_b32 v16, 16, v196
v_and_b32 v17, v13, v196
v_lshlrev_b32 v18, 16, v197
v_and_b32 v19, v13, v197
v_lshlrev_b32 v20, 16, v198
v_and_b32 v21, v13, v198
v_lshlrev_b32 v22, 16, v199
v_and_b32 v23, v13, v199
v_pk_add_f32 v[120:121], v[120:121], v[16:17]
v_pk_add_f32 v[122:123], v[122:123], v[18:19]
v_pk_add_f32 v[124:125], v[124:125], v[20:21]
v_pk_add_f32 v[126:127], v[126:127], v[22:23]
v_lshlrev_b32 v16, 16, v200
v_and_b32 v17, v13, v200
v_lshlrev_b32 v18, 16, v201
v_and_b32 v19, v13, v201
v_lshlrev_b32 v20, 16, v202
v_and_b32 v21, v13, v202
v_lshlrev_b32 v22, 16, v203
v_and_b32 v23, v13, v203
v_pk_add_f32 v[120:121], v[120:121], v[16:17]
v_pk_add_f32 v[122:123], v[122:123], v[18:19]
v_pk_add_f32 v[124:125], v[124:125], v[20:21]
v_pk_add_f32 v[126:127], v[126:127], v[22:23]
v_cvt_pk_bf16_f32 v228, v120, v121
v_cvt_pk_bf16_f32 v229, v122, v123
v_cvt_pk_bf16_f32 v230, v124, v125
v_cvt_pk_bf16_f32 v231, v126, v127
s_waitcnt vmcnt(0)
buffer_store_dwordx2 v[228:229], v6, s[44:47], s54 offen sc1
buffer_store_dwordx2 v[230:231], v6, s[44:47], s55 offen sc1
s_branch L_9D
L_NO9:
s_waitcnt vmcnt(0)
L_9D:
v_lshlrev_b32 v16, 16, v204
v_and_b32 v17, v13, v204
v_lshlrev_b32 v18, 16, v205
v_and_b32 v19, v13, v205
v_lshlrev_b32 v20, 16, v206
v_and_b32 v21, v13, v206
v_lshlrev_b32 v22, 16, v207
v_and_b32 v23, v13, v207
v_pk_add_f32 v[128:129], v[128:129], v[16:17]
v_pk_add_f32 v[130:131], v[130:131], v[18:19]
v_pk_add_f32 v[136:137], v[136:137], v[20:21]
v_pk_add_f32 v[138:139], v[138:139], v[22:23]
v_cvt_pk_bf16_f32 v128, v128, v129
v_cvt_pk_bf16_f32 v129, v130, v131
v_cvt_pk_bf16_f32 v130, v136, v137
v_cvt_pk_bf16_f32 v131, v138, v139
s_nop 1
v_permlane16_swap_b32 v128, v130
v_permlane16_swap_b32 v129, v131
buffer_store_dwordx4 v[128:131], v5, s[44:47], s52 offen sc1
v_lshlrev_b32 v16, 16, v208
v_and_b32 v17, v13, v208
v_lshlrev_b32 v18, 16, v209
v_and_b32 v19, v13, v209
v_lshlrev_b32 v20, 16, v210
v_and_b32 v21, v13, v210
v_lshlrev_b32 v22, 16, v211
v_and_b32 v23, v13, v211
v_pk_add_f32 v[132:133], v[132:133], v[16:17]
v_pk_add_f32 v[134:135], v[134:135], v[18:19]
v_pk_add_f32 v[140:141], v[140:141], v[20:21]
v_pk_add_f32 v[142:143], v[142:143], v[22:23]
v_cvt_pk_bf16_f32 v132, v132, v133
v_cvt_pk_bf16_f32 v133, v134, v135
v_cvt_pk_bf16_f32 v134, v140, v141
v_cvt_pk_bf16_f32 v135, v142, v143
s_nop 1
v_permlane16_swap_b32 v132, v134
v_permlane16_swap_b32 v133, v135
buffer_store_dwordx4 v[132:135], v5, s[44:47], s53 offen sc1
L_END:
s_endpgm
L_SE2:
v_accvgpr_read_b32 v72, a224
v_accvgpr_read_b32 v74, a228
v_cmp_nle_f32 vcc, v72, v7
v_cmp_nle_f32 s[96:97], v74, v7
s_nop 3
s_or_b64 vcc, vcc, s[96:97]
s_cbranch_vccnz SLOW0
SLOW0_R:
v_mul_f32 v8, 0x3fb8aa3b, v8
v_mul_f32 v9, 0x3fb8aa3b, v9
v_exp_f32 v8, v8
v_exp_f32 v9, v9
s_nop 0
v_fma_f32 v72, v72, v8, v72
v_fma_f32 v74, v74, v9, v74
v_rcp_f32 v72, v72
v_rcp_f32 v74, v74
s_add_u32 s52, s78, 4096
v_mov_b32 v73, v72
v_mov_b32 v75, v74
v_accvgpr_read_b32 v16, a0
v_accvgpr_read_b32 v17, a1
v_accvgpr_read_b32 v18, a2
v_accvgpr_read_b32 v19, a3
v_accvgpr_read_b32 v20, a4
v_accvgpr_read_b32 v21, a5
v_accvgpr_read_b32 v22, a6
v_accvgpr_read_b32 v23, a7
v_pk_mul_f32 v[16:17], v[16:17], v[72:73]
v_pk_mul_f32 v[18:19], v[18:19], v[72:73]
v_pk_mul_f32 v[20:21], v[20:21], v[72:73]
v_pk_mul_f32 v[22:23], v[22:23], v[72:73]
v_cvt_pk_bf16_f32 v16, v16, v17
v_cvt_pk_bf16_f32 v17, v18, v19
v_cvt_pk_bf16_f32 v18, v20, v21
v_cvt_pk_bf16_f32 v19, v22, v23
buffer_store_dwordx4 v[16:19], v4, s[24:27], s78 offen offset:0 sc1
v_accvgpr_read_b32 v24, a32
v_accvgpr_read_b32 v25, a33
v_accvgpr_read_b32 v26, a34
v_accvgpr_read_b32 v27, a35
v_accvgpr_read_b32 v28, a36
v_accvgpr_read_b32 v29, a37
v_accvgpr_read_b32 v30, a38
v_accvgpr_read_b32 v31, a39
v_pk_mul_f32 v[24:25], v[24:25], v[74:75]
v_pk_mul_f32 v[26:27], v[26:27], v[74:75]
v_pk_mul_f32 v[28:29], v[28:29], v[74:75]
v_pk_mul_f32 v[30:31], v[30:31], v[74:75]
v_cvt_pk_bf16_f32 v24, v24, v25
v_cvt_pk_bf16_f32 v25, v26, v27
v_cvt_pk_bf16_f32 v26, v28, v29
v_cvt_pk_bf16_f32 v27, v30, v31
buffer_store_dwordx4 v[24:27], v4, s[24:27], s78 offen offset:1024 sc1
v_accvgpr_read_b32 v16, a8
v_accvgpr_read_b32 v17, a9
v_accvgpr_read_b32 v18, a10
v_accvgpr_read_b32 v19, a11
v_accvgpr_read_b32 v20, a12
v_accvgpr_read_b32 v21, a13
v_accvgpr_read_b32 v22, a14
v_accvgpr_read_b32 v23, a15
v_pk_mul_f32 v[16:17], v[16:17], v[72:73]
v_pk_mul_f32 v[18:19], v[18:19], v[72:73]
v_pk_mul_f32 v[20:21], v[20:21], v[72:73]
v_pk_mul_f32 v[22:23], v[22:23], v[72:73]
v_cvt_pk_bf16_f32 v16, v16, v17
v_cvt_pk_bf16_f32 v17, v18, v19
v_cvt_pk_bf16_f32 v18, v20, v21
v_cvt_pk_bf16_f32 v19, v22, v23
buffer_store_dwordx4 v[16:19], v4, s[24:27], s78 offen offset:2048 sc1
v_accvgpr_read_b32 v24, a40
v_accvgpr_read_b32 v25, a41
v_accvgpr_read_b32 v26, a42
v_accvgpr_read_b32 v27, a43
v_accvgpr_read_b32 v28, a44
v_accvgpr_read_b32 v29, a45
v_accvgpr_read_b32 v30, a46
v_accvgpr_read_b32 v31, a47
v_pk_mul_f32 v[24:25], v[24:25], v[74:75]
v_pk_mul_f32 v[26:27], v[26:27], v[74:75]
v_pk_mul_f32 v[28:29], v[28:29], v[74:75]
v_pk_mul_f32 v[30:31], v[30:31], v[74:75]
v_cvt_pk_bf16_f32 v24, v24, v25
v_cvt_pk_bf16_f32 v25, v26, v27
v_cvt_pk_bf16_f32 v26, v28, v29
v_cvt_pk_bf16_f32 v27, v30, v31
buffer_store_dwordx4 v[24:27], v4, s[24:27], s78 offen offset:3072 sc1
v_accvgpr_read_b32 v16, a16
v_accvgpr_read_b32 v17, a17
v_accvgpr_read_b32 v18, a18
v_accvgpr_read_b32 v19, a19
v_accvgpr_read_b32 v20, a20
v_accvgpr_read_b32 v21, a21
v_accvgpr_read_b32 v22, a22
v_accvgpr_read_b32 v23, a23
v_pk_mul_f32 v[16:17], v[16:17], v[72:73]
v_pk_mul_f32 v[18:19], v[18:19], v[72:73]
v_pk_mul_f32 v[20:21], v[20:21], v[72:73]
v_pk_mul_f32 v[22:23], v[22:23], v[72:73]
v_cvt_pk_bf16_f32 v16, v16, v17
v_cvt_pk_bf16_f32 v17, v18, v19
v_cvt_pk_bf16_f32 v18, v20, v21
v_cvt_pk_bf16_f32 v19, v22, v23
buffer_store_dwordx4 v[16:19], v4, s[24:27], s52 offen offset:0 sc1
v_accvgpr_read_b32 v24, a48
v_accvgpr_read_b32 v25, a49
v_accvgpr_read_b32 v26, a50
v_accvgpr_read_b32 v27, a51
v_accvgpr_read_b32 v28, a52
v_accvgpr_read_b32 v29, a53
v_accvgpr_read_b32 v30, a54
v_accvgpr_read_b32 v31, a55
v_pk_mul_f32 v[24:25], v[24:25], v[74:75]
v_pk_mul_f32 v[26:27], v[26:27], v[74:75]
v_pk_mul_f32 v[28:29], v[28:29], v[74:75]
v_pk_mul_f32 v[30:31], v[30:31], v[74:75]
v_cvt_pk_bf16_f32 v24, v24, v25
v_cvt_pk_bf16_f32 v25, v26, v27
v_cvt_pk_bf16_f32 v26, v28, v29
v_cvt_pk_bf16_f32 v27, v30, v31
buffer_store_dwordx4 v[24:27], v4, s[24:27], s52 offen offset:1024 sc1
v_accvgpr_read_b32 v16, a24
v_accvgpr_read_b32 v17, a25
v_accvgpr_read_b32 v18, a26
v_accvgpr_read_b32 v19, a27
v_accvgpr_read_b32 v20, a28
v_accvgpr_read_b32 v21, a29
v_accvgpr_read_b32 v22, a30
v_accvgpr_read_b32 v23, a31
v_pk_mul_f32 v[16:17], v[16:17], v[72:73]
v_pk_mul_f32 v[18:19], v[18:19], v[72:73]
v_pk_mul_f32 v[20:21], v[20:21], v[72:73]
v_pk_mul_f32 v[22:23], v[22:23], v[72:73]
v_cvt_pk_bf16_f32 v16, v16, v17
v_cvt_pk_bf16_f32 v17, v18, v19
v_cvt_pk_bf16_f32 v18, v20, v21
v_cvt_pk_bf16_f32 v19, v22, v23
buffer_store_dwordx4 v[16:19], v4, s[24:27], s52 offen offset:2048 sc1
v_accvgpr_read_b32 v24, a56
v_accvgpr_read_b32 v25, a57
v_accvgpr_read_b32 v26, a58
v_accvgpr_read_b32 v27, a59
v_accvgpr_read_b32 v28, a60
v_accvgpr_read_b32 v29, a61
v_accvgpr_read_b32 v30, a62
v_accvgpr_read_b32 v31, a63
v_pk_mul_f32 v[24:25], v[24:25], v[74:75]
v_pk_mul_f32 v[26:27], v[26:27], v[74:75]
v_pk_mul_f32 v[28:29], v[28:29], v[74:75]
v_pk_mul_f32 v[30:31], v[30:31], v[74:75]
v_cvt_pk_bf16_f32 v24, v24, v25
v_cvt_pk_bf16_f32 v25, v26, v27
v_cvt_pk_bf16_f32 v26, v28, v29
v_cvt_pk_bf16_f32 v27, v30, v31
buffer_store_dwordx4 v[24:27], v4, s[24:27], s52 offen offset:3072 sc1
s_branch L_LA
CK_Z:
s_mov_b32 s92, 0
CK_Z_L:
s_sleep 1
buffer_load_dword v23, v22, s[40:43], 0 offen sc1
s_add_u32 s92, s92, 1
s_waitcnt vmcnt(0)
v_cmp_gt_u32 vcc, 1, v23
s_cmp_gt_u32 s92, 0x20000
s_cbranch_scc1 CK_Z_R
s_nop 3
s_cbranch_vccnz CK_Z_L
s_branch CK_Z_R
CK_WA:
s_mov_b32 s92, 0
CK_WA_L:
s_sleep 1
buffer_load_dword v30, v29, s[24:27], s89 offen sc1
s_add_u32 s92, s92, 1
s_waitcnt vmcnt(0)
v_cmp_gt_u32 vcc, 18, v30
s_cmp_gt_u32 s92, 0x20000
s_cbranch_scc1 CK_WA_R
s_nop 3
s_cbranch_vccnz CK_WA_L
s_branch CK_WA_R
CK_ZA:
s_mov_b32 s92, 0
CK_ZA_L:
s_sleep 1
buffer_load_dword v30, v28, s[40:43], 0 offen sc1
s_add_u32 s92, s92, 1
s_waitcnt vmcnt(0)
v_cmp_gt_u32 vcc, 1, v30
s_cmp_gt_u32 s92, 0x20000
s_cbranch_scc1 CK_ZA_R
s_nop 3
s_cbranch_vccnz CK_ZA_L
s_branch CK_ZA_R
CK_KV:
s_mov_b32 s92, 0
CK_KV_L:
s_sleep 1
buffer_load_dword v30, v29, s[24:27], s89 offen offset:4 sc1
s_add_u32 s92, s92, 1
s_waitcnt vmcnt(0)
v_cmp_gt_u32 vcc, 8, v30
s_cmp_gt_u32 s92, 0x20000
s_cbranch_scc1 CK_KV_R
s_nop 3
s_cbranch_vccnz CK_KV_L
s_branch CK_KV_R
D0:
v_cndmask_b32 v216, v216, v6, s[56:57]
v_cndmask_b32 v112, v112, v6, s[56:57]
v_mov_b32 v104, v6
v_cndmask_b32 v217, v217, v6, s[58:59]
v_cndmask_b32 v113, v113, v6, s[58:59]
v_mov_b32 v105, v6
v_cndmask_b32 v218, v218, v6, s[60:61]
v_cndmask_b32 v114, v114, v6, s[60:61]
v_mov_b32 v106, v6
v_cndmask_b32 v219, v219, v6, s[62:63]
v_cndmask_b32 v115, v115, v6, s[62:63]
v_mov_b32 v107, v6
s_branch D0_R
CK_Q:
s_mov_b32 s92, 0
CK_Q_L:
s_sleep 1
buffer_load_dword v168, v169, s[24:27], 0 offen sc1
s_add_u32 s92, s92, 1
s_waitcnt vmcnt(0)
v_cmp_gt_u32 vcc, 32, v168
s_cmp_gt_u32 s92, 0x20000
s_cbranch_scc1 CK_Q_R
s_nop 3
s_cbranch_vccnz CK_Q_L
s_branch CK_Q_R
CK_ZAA:
s_mov_b32 s92, 0
CK_ZAA_L:
s_sleep 1
buffer_load_dword v12, v10, s[24:27], s75 offen offset:4 sc1
s_add_u32 s92, s92, 1
s_waitcnt vmcnt(0)
v_cmp_gt_u32 vcc, 8, v12
s_cmp_gt_u32 s92, 0x20000
s_cbranch_scc1 CK_ZAA_R
s_nop 3
s_cbranch_vccnz CK_ZAA_L
s_branch CK_ZAA_R
CK_P1:
s_mov_b32 s92, 0
CK_P1_L:
s_sleep 1
buffer_load_dword v12, v10, s[24:27], s73 offen sc1
s_add_u32 s92, s92, 1
s_waitcnt vmcnt(0)
v_cmp_gt_u32 vcc, 4, v12
s_cmp_gt_u32 s92, 0x20000
s_cbranch_scc1 CK_P1_R
s_nop 3
s_cbranch_vccnz CK_P1_L
s_branch CK_P1_R
CK_P2:
s_mov_b32 s92, 0
CK_P2_L:
s_sleep 1
buffer_load_dword v12, v10, s[24:27], s73 offen offset:16 sc1
s_add_u32 s92, s92, 1
s_waitcnt vmcnt(0)
v_cmp_gt_u32 vcc, 4, v12
s_cmp_gt_u32 s92, 0x20000
s_cbranch_scc1 CK_P2_R
s_nop 3
s_cbranch_vccnz CK_P2_L
s_branch CK_P2_R
SLOW0:
v_add_u32 v20, 4096, v4
s_mov_b32 s54, 0
v_mov_b32 v16, v6
v_mov_b32 v18, v6
SLOW0_P:
s_mov_b32 s53, 0
s_mov_b32 s52, s95
SLOW0_T:
s_add_u32 s55, s52, 73728
buffer_load_dwordx4 a[192:195], v4, s[24:27], s52 offen offset:0 sc1
buffer_load_dwordx4 a[196:199], v4, s[24:27], s52 offen offset:1024 sc1
buffer_load_dwordx4 a[200:203], v4, s[24:27], s52 offen offset:2048 sc1
buffer_load_dwordx4 a[204:207], v4, s[24:27], s52 offen offset:3072 sc1
buffer_load_dwordx4 a[208:211], v20, s[24:27], s52 offen offset:0 sc1
buffer_load_dwordx4 a[212:215], v20, s[24:27], s52 offen offset:1024 sc1
buffer_load_dwordx4 a[216:219], v20, s[24:27], s52 offen offset:2048 sc1
buffer_load_dwordx4 a[220:223], v20, s[24:27], s52 offen offset:3072 sc1
buffer_load_dwordx4 a[64:67], v4, s[24:27], s55 offen offset:0 sc1
buffer_load_dwordx4 a[68:71], v4, s[24:27], s55 offen offset:1024 sc1
buffer_load_dwordx4 a[72:75], v4, s[24:27], s55 offen offset:2048 sc1
buffer_load_dwordx4 a[76:79], v4, s[24:27], s55 offen offset:3072 sc1
buffer_load_dwordx4 a[80:83], v20, s[24:27], s55 offen offset:0 sc1
buffer_load_dwordx4 a[84:87], v20, s[24:27], s55 offen offset:1024 sc1
buffer_load_dwordx4 a[88:91], v20, s[24:27], s55 offen offset:2048 sc1
buffer_load_dwordx4 a[92:95], v20, s[24:27], s55 offen offset:3072 sc1
s_waitcnt vmcnt(0)
v_mfma_f32_16x16x32_bf16 v[236:239], a[192:195], v[64:67], 0
v_mfma_f32_16x16x32_bf16 v[236:239], a[196:199], v[244:247], v[236:239]
v_mfma_f32_16x16x32_bf16 v[236:239], a[200:203], v[240:243], v[236:239]
v_mfma_f32_16x16x32_bf16 v[236:239], a[204:207], v[44:47], v[236:239]
v_mfma_f32_16x16x32_bf16 v[248:251], a[192:195], v[204:207], 0
v_mfma_f32_16x16x32_bf16 v[248:251], a[196:199], v[252:255], v[248:251]
v_mfma_f32_16x16x32_bf16 v[248:251], a[200:203], v[232:235], v[248:251]
v_mfma_f32_16x16x32_bf16 v[248:251], a[204:207], v[32:35], v[248:251]
v_mfma_f32_16x16x32_bf16 v[36:39], a[208:211], v[64:67], 0
v_mfma_f32_16x16x32_bf16 v[36:39], a[212:215], v[244:247], v[36:39]
v_mfma_f32_16x16x32_bf16 v[36:39], a[216:219], v[240:243], v[36:39]
v_mfma_f32_16x16x32_bf16 v[36:39], a[220:223], v[44:47], v[36:39]
v_mfma_f32_16x16x32_bf16 v[92:95], a[208:211], v[204:207], 0
v_mfma_f32_16x16x32_bf16 v[92:95], a[212:215], v[252:255], v[92:95]
v_mfma_f32_16x16x32_bf16 v[92:95], a[216:219], v[232:235], v[92:95]
v_mfma_f32_16x16x32_bf16 v[92:95], a[220:223], v[32:35], v[92:95]
s_nop 7
s_cmp_lg_u32 s53, s66
s_cbranch_scc1 SLOW0_U
v_cndmask_b32 v236, v236, v6, s[56:57]
v_cndmask_b32 v92, v92, v6, s[56:57]
v_mov_b32 v36, v6
v_cndmask_b32 v237, v237, v6, s[58:59]
v_cndmask_b32 v93, v93, v6, s[58:59]
v_mov_b32 v37, v6
v_cndmask_b32 v238, v238, v6, s[60:61]
v_cndmask_b32 v94, v94, v6, s[60:61]
v_mov_b32 v38, v6
v_cndmask_b32 v239, v239, v6, s[62:63]
v_cndmask_b32 v95, v95, v6, s[62:63]
v_mov_b32 v39, v6
SLOW0_U:
s_cmp_lg_u32 s54, 0
s_cbranch_scc1 SLOW0_A
v_max3_f32 v16, v16, v236, v237
v_max3_f32 v16, v16, v238, v239
v_max3_f32 v18, v18, v248, v249
v_max3_f32 v18, v18, v250, v251
v_max3_f32 v16, v16, v36, v37
v_max3_f32 v16, v16, v38, v39
v_max3_f32 v18, v18, v92, v93
v_max3_f32 v18, v18, v94, v95
s_branch SLOW0_N
SLOW0_A:
v_sub_f32 v236, v236, v16
v_sub_f32 v237, v237, v16
v_sub_f32 v238, v238, v16
v_sub_f32 v239, v239, v16
v_sub_f32 v248, v248, v18
v_sub_f32 v249, v249, v18
v_sub_f32 v250, v250, v18
v_sub_f32 v251, v251, v18
v_sub_f32 v36, v36, v16
v_sub_f32 v37, v37, v16
v_sub_f32 v38, v38, v16
v_sub_f32 v39, v39, v16
v_sub_f32 v92, v92, v18
v_sub_f32 v93, v93, v18
v_sub_f32 v94, v94, v18
v_sub_f32 v95, v95, v18
v_exp_f32 v236, v236
v_exp_f32 v237, v237
v_exp_f32 v238, v238
v_exp_f32 v239, v239
v_exp_f32 v248, v248
v_exp_f32 v249, v249
v_exp_f32 v250, v250
v_exp_f32 v251, v251
v_exp_f32 v36, v36
v_exp_f32 v37, v37
v_exp_f32 v38, v38
v_exp_f32 v39, v39
v_exp_f32 v92, v92
v_exp_f32 v93, v93
v_exp_f32 v94, v94
v_exp_f32 v95, v95
s_nop 0
v_cvt_pk_bf16_f32 v228, v236, v237
v_cvt_pk_bf16_f32 v229, v238, v239
v_cvt_pk_bf16_f32 v176, v248, v249
v_cvt_pk_bf16_f32 v177, v250, v251
v_cvt_pk_bf16_f32 v230, v36, v37
v_cvt_pk_bf16_f32 v231, v38, v39
v_cvt_pk_bf16_f32 v178, v92, v93
v_cvt_pk_bf16_f32 v179, v94, v95
s_nop 1
v_mfma_f32_16x16x32_bf16 a[0:3], a[64:67], v[228:231], a[0:3]
v_mfma_f32_16x16x32_bf16 a[32:35], a[64:67], v[176:179], a[32:35]
v_mfma_f32_16x16x32_bf16 a[4:7], a[68:71], v[228:231], a[4:7]
v_mfma_f32_16x16x32_bf16 a[36:39], a[68:71], v[176:179], a[36:39]
v_mfma_f32_16x16x32_bf16 a[8:11], a[72:75], v[228:231], a[8:11]
v_mfma_f32_16x16x32_bf16 a[40:43], a[72:75], v[176:179], a[40:43]
v_mfma_f32_16x16x32_bf16 a[12:15], a[76:79], v[228:231], a[12:15]
v_mfma_f32_16x16x32_bf16 a[44:47], a[76:79], v[176:179], a[44:47]
v_mfma_f32_16x16x32_bf16 a[16:19], a[80:83], v[228:231], a[16:19]
v_mfma_f32_16x16x32_bf16 a[48:51], a[80:83], v[176:179], a[48:51]
v_mfma_f32_16x16x32_bf16 a[20:23], a[84:87], v[228:231], a[20:23]
v_mfma_f32_16x16x32_bf16 a[52:55], a[84:87], v[176:179], a[52:55]
v_mfma_f32_16x16x32_bf16 a[24:27], a[88:91], v[228:231], a[24:27]
v_mfma_f32_16x16x32_bf16 a[56:59], a[88:91], v[176:179], a[56:59]
v_mfma_f32_16x16x32_bf16 a[28:31], a[92:95], v[228:231], a[28:31]
v_mfma_f32_16x16x32_bf16 a[60:63], a[92:95], v[176:179], a[60:63]
v_mfma_f32_16x16x32_bf16 a[224:227], a[240:243], v[228:231], a[224:227]
v_mfma_f32_16x16x32_bf16 a[228:231], a[240:243], v[176:179], a[228:231]
SLOW0_N:
s_add_u32 s52, s52, 49152
s_add_u32 s53, s53, 1
s_cmp_le_u32 s53, s66
s_cbranch_scc1 SLOW0_T
s_cmp_lg_u32 s54, 0
s_cbranch_scc1 SLOW0_E
v_mov_b32 v17, v16
v_mov_b32 v19, v18
s_nop 1
v_permlane32_swap_b32 v17, v16
v_permlane32_swap_b32 v19, v18
s_nop 1
v_max_f32 v16, v16, v17
v_max_f32 v18, v18, v19
v_mov_b32 v17, v16
v_mov_b32 v19, v18
s_nop 1
v_permlane16_swap_b32 v17, v16
v_permlane16_swap_b32 v19, v18
s_nop 1
v_max_f32 v16, v16, v17
v_max_f32 v18, v18, v19
v_accvgpr_write_b32 a0, 0
v_accvgpr_write_b32 a1, 0
v_accvgpr_write_b32 a2, 0
v_accvgpr_write_b32 a3, 0
v_accvgpr_write_b32 a4, 0
v_accvgpr_write_b32 a5, 0
v_accvgpr_write_b32 a6, 0
v_accvgpr_write_b32 a7, 0
v_accvgpr_write_b32 a8, 0
v_accvgpr_write_b32 a9, 0
v_accvgpr_write_b32 a10, 0
v_accvgpr_write_b32 a11, 0
v_accvgpr_write_b32 a12, 0
v_accvgpr_write_b32 a13, 0
v_accvgpr_write_b32 a14, 0
v_accvgpr_write_b32 a15, 0
v_accvgpr_write_b32 a16, 0
v_accvgpr_write_b32 a17, 0
v_accvgpr_write_b32 a18, 0
v_accvgpr_write_b32 a19, 0
v_accvgpr_write_b32 a20, 0
v_accvgpr_write_b32 a21, 0
v_accvgpr_write_b32 a22, 0
v_accvgpr_write_b32 a23, 0
v_accvgpr_write_b32 a24, 0
v_accvgpr_write_b32 a25, 0
v_accvgpr_write_b32 a26, 0
v_accvgpr_write_b32 a27, 0
v_accvgpr_write_b32 a28, 0
v_accvgpr_write_b32 a29, 0
v_accvgpr_write_b32 a30, 0
v_accvgpr_write_b32 a31, 0
v_accvgpr_write_b32 a32, 0
v_accvgpr_write_b32 a33, 0
v_accvgpr_write_b32 a34, 0
v_accvgpr_write_b32 a35, 0
v_accvgpr_write_b32 a36, 0
v_accvgpr_write_b32 a37, 0
v_accvgpr_write_b32 a38, 0
v_accvgpr_write_b32 a39, 0
v_accvgpr_write_b32 a40, 0
v_accvgpr_write_b32 a41, 0
v_accvgpr_write_b32 a42, 0
v_accvgpr_write_b32 a43, 0
v_accvgpr_write_b32 a44, 0
v_accvgpr_write_b32 a45, 0
v_accvgpr_write_b32 a46, 0
v_accvgpr_write_b32 a47, 0
v_accvgpr_write_b32 a48, 0
v_accvgpr_write_b32 a49, 0
v_accvgpr_write_b32 a50, 0
v_accvgpr_write_b32 a51, 0
v_accvgpr_write_b32 a52, 0
v_accvgpr_write_b32 a53, 0
v_accvgpr_write_b32 a54, 0
v_accvgpr_write_b32 a55, 0
v_accvgpr_write_b32 a56, 0
v_accvgpr_write_b32 a57, 0
v_accvgpr_write_b32 a58, 0
v_accvgpr_write_b32 a59, 0
v_accvgpr_write_b32 a60, 0
v_accvgpr_write_b32 a61, 0
v_accvgpr_write_b32 a62, 0
v_accvgpr_write_b32 a63, 0
v_accvgpr_write_b32 a224, 0
v_accvgpr_write_b32 a225, 0
v_accvgpr_write_b32 a226, 0
v_accvgpr_write_b32 a227, 0
v_accvgpr_write_b32 a228, 0
v_accvgpr_write_b32 a229, 0
v_accvgpr_write_b32 a230, 0
v_accvgpr_write_b32 a231, 0
s_mov_b32 s54, 1
s_branch SLOW0_P
SLOW0_E:
s_nop 7
v_accvgpr_read_b32 v72, a224
v_accvgpr_read_b32 v74, a228
s_branch SLOW0_R
SLOW1:
v_add_u32 v20, 4096, v4
s_mov_b32 s54, 0
v_mov_b32 v16, v6
v_mov_b32 v18, v6
SLOW1_P:
s_mov_b32 s53, 0
s_mov_b32 s52, s95
SLOW1_T:
s_add_u32 s55, s52, 73728
buffer_load_dwordx4 a[192:195], v4, s[24:27], s52 offen offset:0 sc1
buffer_load_dwordx4 a[196:199], v4, s[24:27], s52 offen offset:1024 sc1
buffer_load_dwordx4 a[200:203], v4, s[24:27], s52 offen offset:2048 sc1
buffer_load_dwordx4 a[204:207], v4, s[24:27], s52 offen offset:3072 sc1
buffer_load_dwordx4 a[208:211], v20, s[24:27], s52 offen offset:0 sc1
buffer_load_dwordx4 a[212:215], v20, s[24:27], s52 offen offset:1024 sc1
buffer_load_dwordx4 a[216:219], v20, s[24:27], s52 offen offset:2048 sc1
buffer_load_dwordx4 a[220:223], v20, s[24:27], s52 offen offset:3072 sc1
buffer_load_dwordx4 a[64:67], v4, s[24:27], s55 offen offset:0 sc1
buffer_load_dwordx4 a[68:71], v4, s[24:27], s55 offen offset:1024 sc1
buffer_load_dwordx4 a[72:75], v4, s[24:27], s55 offen offset:2048 sc1
buffer_load_dwordx4 a[76:79], v4, s[24:27], s55 offen offset:3072 sc1
buffer_load_dwordx4 a[80:83], v20, s[24:27], s55 offen offset:0 sc1
buffer_load_dwordx4 a[84:87], v20, s[24:27], s55 offen offset:1024 sc1
buffer_load_dwordx4 a[88:91], v20, s[24:27], s55 offen offset:2048 sc1
buffer_load_dwordx4 a[92:95], v20, s[24:27], s55 offen offset:3072 sc1
s_waitcnt vmcnt(0)
v_mfma_f32_16x16x32_bf16 v[236:239], a[192:195], v[212:215], 0
v_mfma_f32_16x16x32_bf16 v[236:239], a[196:199], v[88:91], v[236:239]
v_mfma_f32_16x16x32_bf16 v[236:239], a[200:203], v[224:227], v[236:239]
v_mfma_f32_16x16x32_bf16 v[236:239], a[204:207], v[52:55], v[236:239]
v_mfma_f32_16x16x32_bf16 v[248:251], a[192:195], v[220:223], 0
v_mfma_f32_16x16x32_bf16 v[248:251], a[196:199], v[160:163], v[248:251]
v_mfma_f32_16x16x32_bf16 v[248:251], a[200:203], v[192:195], v[248:251]
v_mfma_f32_16x16x32_bf16 v[248:251], a[204:207], v[60:63], v[248:251]
v_mfma_f32_16x16x32_bf16 v[36:39], a[208:211], v[212:215], 0
v_mfma_f32_16x16x32_bf16 v[36:39], a[212:215], v[88:91], v[36:39]
v_mfma_f32_16x16x32_bf16 v[36:39], a[216:219], v[224:227], v[36:39]
v_mfma_f32_16x16x32_bf16 v[36:39], a[220:223], v[52:55], v[36:39]
v_mfma_f32_16x16x32_bf16 v[92:95], a[208:211], v[220:223], 0
v_mfma_f32_16x16x32_bf16 v[92:95], a[212:215], v[160:163], v[92:95]
v_mfma_f32_16x16x32_bf16 v[92:95], a[216:219], v[192:195], v[92:95]
v_mfma_f32_16x16x32_bf16 v[92:95], a[220:223], v[60:63], v[92:95]
s_nop 7
s_cmp_lg_u32 s53, s67
s_cbranch_scc1 SLOW1_U
v_cndmask_b32 v236, v236, v6, s[56:57]
v_cndmask_b32 v92, v92, v6, s[56:57]
v_mov_b32 v36, v6
v_cndmask_b32 v237, v237, v6, s[58:59]
v_cndmask_b32 v93, v93, v6, s[58:59]
v_mov_b32 v37, v6
v_cndmask_b32 v238, v238, v6, s[60:61]
v_cndmask_b32 v94, v94, v6, s[60:61]
v_mov_b32 v38, v6
v_cndmask_b32 v239, v239, v6, s[62:63]
v_cndmask_b32 v95, v95, v6, s[62:63]
v_mov_b32 v39, v6
SLOW1_U:
s_cmp_lg_u32 s54, 0
s_cbranch_scc1 SLOW1_A
v_max3_f32 v16, v16, v236, v237
v_max3_f32 v16, v16, v238, v239
v_max3_f32 v18, v18, v248, v249
v_max3_f32 v18, v18, v250, v251
v_max3_f32 v16, v16, v36, v37
v_max3_f32 v16, v16, v38, v39
v_max3_f32 v18, v18, v92, v93
v_max3_f32 v18, v18, v94, v95
s_branch SLOW1_N
SLOW1_A:
v_sub_f32 v236, v236, v16
v_sub_f32 v237, v237, v16
v_sub_f32 v238, v238, v16
v_sub_f32 v239, v239, v16
v_sub_f32 v248, v248, v18
v_sub_f32 v249, v249, v18
v_sub_f32 v250, v250, v18
v_sub_f32 v251, v251, v18
v_sub_f32 v36, v36, v16
v_sub_f32 v37, v37, v16
v_sub_f32 v38, v38, v16
v_sub_f32 v39, v39, v16
v_sub_f32 v92, v92, v18
v_sub_f32 v93, v93, v18
v_sub_f32 v94, v94, v18
v_sub_f32 v95, v95, v18
v_exp_f32 v236, v236
v_exp_f32 v237, v237
v_exp_f32 v238, v238
v_exp_f32 v239, v239
v_exp_f32 v248, v248
v_exp_f32 v249, v249
v_exp_f32 v250, v250
v_exp_f32 v251, v251
v_exp_f32 v36, v36
v_exp_f32 v37, v37
v_exp_f32 v38, v38
v_exp_f32 v39, v39
v_exp_f32 v92, v92
v_exp_f32 v93, v93
v_exp_f32 v94, v94
v_exp_f32 v95, v95
s_nop 0
v_cvt_pk_bf16_f32 v228, v236, v237
v_cvt_pk_bf16_f32 v229, v238, v239
v_cvt_pk_bf16_f32 v176, v248, v249
v_cvt_pk_bf16_f32 v177, v250, v251
v_cvt_pk_bf16_f32 v230, v36, v37
v_cvt_pk_bf16_f32 v231, v38, v39
v_cvt_pk_bf16_f32 v178, v92, v93
v_cvt_pk_bf16_f32 v179, v94, v95
s_nop 1
v_mfma_f32_16x16x32_bf16 v[100:103], a[64:67], v[228:231], v[100:103]
v_mfma_f32_16x16x32_bf16 v[116:119], a[64:67], v[176:179], v[116:119]
v_mfma_f32_16x16x32_bf16 v[148:151], a[68:71], v[228:231], v[148:151]
v_mfma_f32_16x16x32_bf16 v[132:135], a[68:71], v[176:179], v[132:135]
v_mfma_f32_16x16x32_bf16 v[156:159], a[72:75], v[228:231], v[156:159]
v_mfma_f32_16x16x32_bf16 v[164:167], a[72:75], v[176:179], v[164:167]
v_mfma_f32_16x16x32_bf16 v[56:59], a[76:79], v[228:231], v[56:59]
v_mfma_f32_16x16x32_bf16 v[188:191], a[76:79], v[176:179], v[188:191]
v_mfma_f32_16x16x32_bf16 v[108:111], a[80:83], v[228:231], v[108:111]
v_mfma_f32_16x16x32_bf16 v[40:43], a[80:83], v[176:179], v[40:43]
v_mfma_f32_16x16x32_bf16 v[140:143], a[84:87], v[228:231], v[140:143]
v_mfma_f32_16x16x32_bf16 v[124:127], a[84:87], v[176:179], v[124:127]
v_mfma_f32_16x16x32_bf16 v[48:51], a[88:91], v[228:231], v[48:51]
v_mfma_f32_16x16x32_bf16 v[172:175], a[88:91], v[176:179], v[172:175]
v_mfma_f32_16x16x32_bf16 v[196:199], a[92:95], v[228:231], v[196:199]
v_mfma_f32_16x16x32_bf16 v[180:183], a[92:95], v[176:179], v[180:183]
v_mfma_f32_16x16x32_bf16 a[232:235], a[240:243], v[228:231], a[232:235]
v_mfma_f32_16x16x32_bf16 a[236:239], a[240:243], v[176:179], a[236:239]
SLOW1_N:
s_add_u32 s52, s52, 49152
s_add_u32 s53, s53, 1
s_cmp_le_u32 s53, s67
s_cbranch_scc1 SLOW1_T
s_cmp_lg_u32 s54, 0
s_cbranch_scc1 SLOW1_E
v_mov_b32 v17, v16
v_mov_b32 v19, v18
s_nop 1
v_permlane32_swap_b32 v17, v16
v_permlane32_swap_b32 v19, v18
s_nop 1
v_max_f32 v16, v16, v17
v_max_f32 v18, v18, v19
v_mov_b32 v17, v16
v_mov_b32 v19, v18
s_nop 1
v_permlane16_swap_b32 v17, v16
v_permlane16_swap_b32 v19, v18
s_nop 1
v_max_f32 v16, v16, v17
v_max_f32 v18, v18, v19
v_mov_b32 v100, 0
v_mov_b32 v101, 0
v_mov_b32 v102, 0
v_mov_b32 v103, 0
v_mov_b32 v148, 0
v_mov_b32 v149, 0
v_mov_b32 v150, 0
v_mov_b32 v151, 0
v_mov_b32 v156, 0
v_mov_b32 v157, 0
v_mov_b32 v158, 0
v_mov_b32 v159, 0
v_mov_b32 v56, 0
v_mov_b32 v57, 0
v_mov_b32 v58, 0
v_mov_b32 v59, 0
v_mov_b32 v108, 0
v_mov_b32 v109, 0
v_mov_b32 v110, 0
v_mov_b32 v111, 0
v_mov_b32 v140, 0
v_mov_b32 v141, 0
v_mov_b32 v142, 0
v_mov_b32 v143, 0
v_mov_b32 v48, 0
v_mov_b32 v49, 0
v_mov_b32 v50, 0
v_mov_b32 v51, 0
v_mov_b32 v196, 0
v_mov_b32 v197, 0
v_mov_b32 v198, 0
v_mov_b32 v199, 0
v_mov_b32 v116, 0
v_mov_b32 v117, 0
v_mov_b32 v118, 0
v_mov_b32 v119, 0
v_mov_b32 v132, 0
v_mov_b32 v133, 0
v_mov_b32 v134, 0
v_mov_b32 v135, 0
v_mov_b32 v164, 0
v_mov_b32 v165, 0
v_mov_b32 v166, 0
v_mov_b32 v167, 0
v_mov_b32 v188, 0
v_mov_b32 v189, 0
v_mov_b32 v190, 0
v_mov_b32 v191, 0
v_mov_b32 v40, 0
v_mov_b32 v41, 0
v_mov_b32 v42, 0
v_mov_b32 v43, 0
v_mov_b32 v124, 0
v_mov_b32 v125, 0
v_mov_b32 v126, 0
v_mov_b32 v127, 0
v_mov_b32 v172, 0
v_mov_b32 v173, 0
v_mov_b32 v174, 0
v_mov_b32 v175, 0
v_mov_b32 v180, 0
v_mov_b32 v181, 0
v_mov_b32 v182, 0
v_mov_b32 v183, 0
v_accvgpr_write_b32 a232, 0
v_accvgpr_write_b32 a233, 0
v_accvgpr_write_b32 a234, 0
v_accvgpr_write_b32 a235, 0
v_accvgpr_write_b32 a236, 0
v_accvgpr_write_b32 a237, 0
v_accvgpr_write_b32 a238, 0
v_accvgpr_write_b32 a239, 0
s_mov_b32 s54, 1
s_branch SLOW1_P
SLOW1_E:
s_nop 7
v_accvgpr_read_b32 v72, a232
v_accvgpr_read_b32 v74, a236
s_branch SLOW1_R
.section .rodata,"a"
.p2align 6
.amdhsa_kernel gated_mix__sliding_local_dilated__compressed_kv_cla__prompt_kernel
  .amdhsa_next_free_vgpr 512
  .amdhsa_next_free_sgpr 102
  .amdhsa_accum_offset 256
  .amdhsa_group_segment_fixed_size 0
  .amdhsa_kernarg_size 104
  .amdhsa_user_sgpr_count 2
  .amdhsa_user_sgpr_kernarg_segment_ptr 1
  .amdhsa_system_sgpr_workgroup_id_x 1
.end_amdhsa_kernel
```

```asm
; @launch grid=(256,1,1) block=(256,1,1) lds=163840
.amdgcn_target "amdgcn-amd-amdhsa--gfx950"
.text

.globl gated_mix__sliding_local_dilated__compressed_kv_cla__prompt_kernel
.p2align 8
.type gated_mix__sliding_local_dilated__compressed_kv_cla__prompt_kernel,@function
gated_mix__sliding_local_dilated__compressed_kv_cla__prompt_kernel:
s_cmp_ge_u32 s2, 256
s_cbranch_scc1 L_END
s_load_dwordx2 s[8:9], s[0:1], 32
s_load_dwordx2 s[16:17], s[0:1], 48
s_load_dwordx2 s[52:53], s[0:1], 56
s_load_dwordx2 s[24:25], s[0:1], 96
s_load_dwordx2 s[12:13], s[0:1], 0
s_load_dwordx2 s[20:21], s[0:1], 40
s_load_dwordx2 s[28:29], s[0:1], 8
s_load_dwordx2 s[48:49], s[0:1], 16
s_load_dwordx2 s[32:33], s[0:1], 64
s_load_dwordx2 s[36:37], s[0:1], 72
s_load_dwordx2 s[40:41], s[0:1], 88
s_load_dwordx2 s[44:45], s[0:1], 80
s_getpc_b64 s[96:97]
L_PC:
s_lshr_b32 s6, s2, 3
s_lshl_b32 s98, s6, 11
s_add_u32 s98, s98, L_MAIN-L_PC
s_add_u32 s96, s96, s98
s_addc_u32 s97, s97, 0
v_lshlrev_b32 v16, 3, v0
v_mov_b32 v17, s97
v_add_co_u32 v16, vcc, s96, v16
v_lshrrev_b32 v5, 6, v0
v_and_b32 v1, 63, v0
v_addc_co_u32 v17, vcc, 0, v17, vcc
v_readfirstlane_b32 s3, v5
global_load_dwordx2 a[252:253], v[16:17], off
v_and_b32 v2, 15, v0
v_lshrrev_b32 v3, 4, v1
v_lshlrev_b32 v4, 4, v1
s_and_b32 s7, s2, 7
s_and_b32 s65, s6, 3
s_lshl2_add_u32 s4, s7, s65
s_lshr_b32 s5, s6, 2
s_lshl2_add_u32 s66, s5, s3
s_sub_u32 s67, 63, s66
v_lshrrev_b32 v16, 3, v1
v_and_b32 v17, 7, v1
v_xor_b32 v18, v17, v3
v_lshlrev_b32 v19, 10, v16
v_lshl_add_u32 v5, v18, 4, v19
v_xor_b32 v18, 4, v18
v_lshl_add_u32 v6, v18, 4, v19
v_add_u32 v6, 7168, v6
v_and_b32 v18, 1, v3
v_lshlrev_b32 v18, 1, v18
v_xor_b32 v18, v17, v18
v_lshlrev_b32 v19, 13, v16
v_lshl_add_u32 v7, v18, 4, v19
v_xor_b32 v18, 4, v18
v_lshl_add_u32 v8, v18, 4, v19
v_add_u32 v8, 64512, v8
s_add_u32 s69, s65, s5
s_and_b32 s69, s69, 1
s_mul_i32 s64, s7, 2
s_and_b32 s64, s64, 7
s_or_b32 s69, s69, s64
s_add_u32 s93, s65, s5
s_and_b32 s93, s93, 1
s_mul_i32 s64, s7, 2
s_and_b32 s64, s64, 7
s_or_b32 s93, s93, s64
s_lshl_b32 s70, s69, 7
s_lshl_b32 s75, s69, 19
s_lshr_b32 s54, s3, 1
s_and_b32 s55, s3, 1
s_lshl3_add_u32 s87, s54, s5
s_lshl_b32 s64, s55, 5
s_add_u32 s68, s87, s64
s_lshl_b32 s68, s68, 15
s_lshl_b32 s73, s3, 13
s_add_u32 s73, s73, 65536
s_lshl1_add_u32 s74, s4, s55
s_lshl_b32 s74, s74, 7
s_lshl_b32 s77, s3, 12
s_add_u32 s71, s68, s70
s_add_u32 s76, s74, s75
s_mov_b32 s10, 2097152
s_mov_b32 s11, 0x20000
s_mov_b32 s18, 4194304
s_mov_b32 s19, 0x20000
s_cmp_lt_u32 s3, 2
s_waitcnt lgkmcnt(0)
s_cselect_b32 s16, s16, s52
s_cselect_b32 s17, s17, s53
s_add_u32 m0, s73, 0
s_add_u32 s64, s71, 0
buffer_load_dwordx4 v5, s[8:11], s64 offen lds
buffer_load_dwordx4 v6, s[8:11], s64 offen offset:1024 lds
s_add_u32 m0, s73, 2048
s_add_u32 s64, s71, 16384
buffer_load_dwordx4 v5, s[8:11], s64 offen lds
buffer_load_dwordx4 v6, s[8:11], s64 offen offset:1024 lds
s_add_u32 m0, s77, 0
s_add_u32 s64, s76, 0
buffer_load_dwordx4 v7, s[16:19], s64 offen lds
buffer_load_dwordx4 v8, s[16:19], s64 offen offset:1024 lds
s_add_u32 m0, s77, 2048
s_add_u32 s64, s76, 131072
buffer_load_dwordx4 v7, s[16:19], s64 offen lds
buffer_load_dwordx4 v8, s[16:19], s64 offen offset:1024 lds
s_add_u32 m0, s73, 4096
s_add_u32 s64, s71, 524288
buffer_load_dwordx4 v5, s[8:11], s64 offen lds
buffer_load_dwordx4 v6, s[8:11], s64 offen offset:1024 lds
s_add_u32 m0, s73, 6144
s_add_u32 s64, s71, 540672
buffer_load_dwordx4 v5, s[8:11], s64 offen lds
buffer_load_dwordx4 v6, s[8:11], s64 offen offset:1024 lds
s_mov_b32 s26, 268435456
s_mov_b32 s27, 0x20000
s_mov_b32 s14, 2359296
s_mov_b32 s15, 0x20000
s_mov_b32 s22, 4718592
s_mov_b32 s23, 0x20000
s_mov_b32 s30, 1990656
s_mov_b32 s31, 0x20000
s_mov_b32 s34, 4718592
s_mov_b32 s35, 0x20000
s_mov_b32 s38, 1152
s_mov_b32 s39, 0x20000
s_mov_b32 s42, 256
s_mov_b32 s43, 0x20000
s_mov_b32 s46, 2359296
s_mov_b32 s47, 0x20000
s_mov_b32 s50, 663552
s_mov_b32 s51, 0x20000
s_lshl_b32 s89, s4, 10
s_add_u32 s89, s89, 75497472
s_mul_i32 s94, s4, 1064960
s_cmp_eq_u32 s66, 0
s_cselect_b32 s52, s89, 2147418112
s_lshl_b32 s53, s5, 10
s_add_u32 s53, s53, s94
s_add_u32 s53, s53, 1048576
s_cmp_eq_u32 s3, 1
s_cselect_b32 s52, s53, s52
s_mul_i32 s53, s2, 74
s_add_u32 s53, s53, s55
s_lshl_b32 s53, s53, 10
s_add_u32 s53, s53, 54599680
s_cmp_ge_u32 s3, 2
s_cselect_b32 s52, s53, s52
v_mov_b32 v16, 0
v_mov_b32 v17, 0
v_mov_b32 v18, 0
v_mov_b32 v19, 0
buffer_store_dwordx4 v[16:19], v4, s[24:27], s52 offen sc1
s_add_u32 s89, s89, 512
s_cmp_eq_u32 s3, 0
s_cselect_b32 s90, s89, 2147418112
v_mov_b32 v24, 2147418112
v_cmp_eq_u32 vcc, 1, v1
s_lshl_b32 s52, s54, 7
s_lshl_b32 s53, s55, 12
v_cndmask_b32 v0, v24, 0, vcc
v_lshrrev_b32 v16, 1, v2
v_xor_b32 v16, v16, v3
v_add_u32 v17, s52, v2
v_lshlrev_b32 v17, 7, v17
v_add_u32 v17, 65536, v17
v_lshl_add_u32 v9, v16, 4, v17
v_xor_b32 v10, 64, v9
v_bfe_u32 v16, v1, 2, 2
v_lshl_add_u32 v17, v3, 3, v16
v_lshlrev_b32 v17, 7, v17
v_and_b32 v18, 3, v1
v_lshl_add_u32 v17, v18, 3, v17
v_add_u32 v17, s53, v17
v_lshrrev_b32 v16, 1, v16
v_and_b32 v18, 1, v3
v_lshl_add_u32 v16, v18, 1, v16
v_xor_b32 v18, 0, v16
v_lshl_add_u32 v11, v18, 5, v17
v_xor_b32 v18, 1, v16
v_lshl_add_u32 v12, v18, 5, v17
v_xor_b32 v18, 2, v16
v_lshl_add_u32 v13, v18, 5, v17
v_xor_b32 v18, 3, v16
v_lshl_add_u32 v14, v18, 5, v17
s_mul_i32 s87, s87, 16384
s_add_u32 s87, s87, s94
s_add_u32 s88, s87, s53
s_add_u32 s88, s88, 24576
s_lshr_b32 s53, s53, 1
s_add_u32 s87, s87, s53
s_lshl_b32 s80, s3, 10
s_mul_i32 s78, s4, 73728
s_add_u32 s78, s78, s80
s_add_u32 s78, s78, 35651584
s_add_u32 s80, s80, 8192
s_mov_b32 s91, 0x3e0293ee
s_mov_b32 s85, 0x05040100
s_mov_b32 s86, 0x07060302
s_lshl2_add_u32 s52, s7, s3
s_xor_b32 s92, s6, 31
s_mul_i32 s81, s92, 110592
s_mul_i32 s65, s52, 36
s_add_u32 s81, s81, s65
s_mul_i32 s82, s52, 18
s_add_u32 s82, s82, s92
s_lshl_b32 s82, s82, 12
s_add_u32 s82, s82, 35651584
s_lshl_b32 s83, s92, 6
s_lshl_b32 s84, s52, 10
s_add_u32 s84, s84, 75497984
s_cmp_lt_u32 s92, 18
s_cselect_b32 s82, s82, 2147418112
s_cselect_b32 s84, s84, 2147418112
v_lshrrev_b32 v18, 2, v2
v_and_b32 v19, 3, v2
v_mul_u32_u24 v20, 1152, v18
v_cmp_eq_u32 vcc, 2, v19
v_lshl_add_u32 v20, v19, 3, v20
v_add_u32 v21, 1, v19
v_cndmask_b32 v21, v21, 0, vcc
v_cmp_eq_u32 vcc, 3, v18
v_mul_u32_u24 v21, 1152, v21
v_add_u32 v21, 32, v21
v_cndmask_b32 v20, v20, v21, vcc
v_cmp_eq_u32 vcc, 15, v2
v_mul_u32_u24 v21, 27648, v3
v_add_u32 v20, v20, v21
v_lshlrev_b32 v21, 4, v3
v_cndmask_b32 v26, v20, v24, vcc
v_cndmask_b32 v27, v24, v21, vcc
v_and_b32 v18, 7, v1
v_cmp_gt_u32 vcc, 48, v1
v_mul_u32_u24 v18, 3456, v18
v_mul_u32_u24 v19, 1152, v3
v_bfe_u32 v20, v1, 3, 1
v_mul_u32_u24 v20, 140, v20
v_add3_u32 v18, v18, v19, v20
v_cndmask_b32 v28, v24, v18, vcc
s_mov_b64 exec, 0
s_cmp_eq_u32 s3, 0
s_cbranch_scc1 L_PAD0
s_cmp_eq_u32 s3, 1
s_cbranch_scc1 L_PAD1
s_cmp_eq_u32 s3, 2
s_cbranch_scc1 L_PAD2
s_branch L_PAD3
.p2align 12
.fill 416, 4, 0xbf800000
L_MAIN:
s_mov_b64 exec, -1
s_add_u32 m0, s77, 16384
s_add_u32 s64, s76, 262144
buffer_load_dwordx4 v7, s[16:19], s64 offen lds
buffer_load_dwordx4 v8, s[16:19], s64 offen offset:1024 lds
s_add_u32 m0, s77, 18432
s_add_u32 s64, s76, 393216
buffer_load_dwordx4 v7, s[16:19], s64 offen lds
buffer_load_dwordx4 v8, s[16:19], s64 offen offset:1024 lds
s_xor_b32 s71, s70, 128
s_add_u32 s71, s68, s71
s_add_u32 m0, s73, 32768
s_add_u32 s64, s71, 0
buffer_load_dwordx4 v5, s[8:11], s64 offen lds
buffer_load_dwordx4 v6, s[8:11], s64 offen offset:1024 lds
s_add_u32 m0, s73, 34816
s_add_u32 s64, s71, 16384
buffer_load_dwordx4 v5, s[8:11], s64 offen lds
buffer_load_dwordx4 v6, s[8:11], s64 offen offset:1024 lds
s_waitcnt vmcnt(8)
s_barrier
ds_read_b128 a[64:67], v9 offset:0
ds_read_b128 a[68:71], v9 offset:2048
ds_read_b128 a[72:75], v9 offset:4096
ds_read_b128 a[76:79], v9 offset:6144
ds_read_b128 a[80:83], v9 offset:8192
ds_read_b128 a[84:87], v9 offset:10240
ds_read_b128 a[88:91], v9 offset:12288
ds_read_b128 a[92:95], v9 offset:14336
ds_read_b64_tr_b16 a[112:113], v11 offset:8192
ds_read_b64_tr_b16 a[114:115], v11 offset:8704
ds_read_b64_tr_b16 a[116:117], v12 offset:8192
ds_read_b64_tr_b16 a[118:119], v12 offset:8704
ds_read_b64_tr_b16 a[120:121], v13 offset:8192
ds_read_b64_tr_b16 a[122:123], v13 offset:8704
ds_read_b64_tr_b16 a[124:125], v14 offset:8192
ds_read_b64_tr_b16 a[126:127], v14 offset:8704
ds_read_b64_tr_b16 a[96:97], v11 offset:0
ds_read_b64_tr_b16 a[98:99], v11 offset:512
ds_read_b64_tr_b16 a[100:101], v12 offset:0
ds_read_b64_tr_b16 a[102:103], v12 offset:512
ds_read_b64_tr_b16 a[104:105], v13 offset:0
ds_read_b64_tr_b16 a[106:107], v13 offset:512
ds_read_b64_tr_b16 a[108:109], v14 offset:0
ds_read_b64_tr_b16 a[110:111], v14 offset:512
s_lshl_b32 s52, s4, 2
s_cmp_eq_u32 s66, 0
s_cselect_b32 s52, s52, 2147418112
buffer_store_dword v1, v0, s[40:43], s52 offen sc1
s_waitcnt lgkmcnt(0)
v_mfma_f32_16x16x32_bf16 v[160:163], a[96:99], a[64:67], 0
s_waitcnt vmcnt(5)
v_mfma_f32_16x16x32_bf16 v[164:167], a[100:103], a[64:67], 0
s_barrier
v_mfma_f32_16x16x32_bf16 v[168:171], a[104:107], a[64:67], 0
ds_read_b128 a[128:131], v10 offset:0
v_mfma_f32_16x16x32_bf16 v[172:175], a[108:111], a[64:67], 0
s_add_u32 m0, s73, 36864
s_add_u32 s64, s71, 524288
v_mfma_f32_16x16x32_bf16 v[32:35], a[64:67], a[112:115], 0
buffer_load_dwordx4 v5, s[8:11], s64 offen lds
v_mfma_f32_16x16x32_bf16 v[40:43], a[64:67], a[116:119], 0
ds_read_b64_tr_b16 a[176:177], v11 offset:24576
ds_read_b64_tr_b16 a[178:179], v11 offset:25088
v_mfma_f32_16x16x32_bf16 v[48:51], a[64:67], a[120:123], 0
v_mfma_f32_16x16x32_bf16 v[56:59], a[64:67], a[124:127], 0
v_mfma_f32_16x16x32_bf16 v[60:63], a[68:71], a[124:127], 0
buffer_load_dwordx4 v6, s[8:11], s64 offen offset:1024 lds
v_mfma_f32_16x16x32_bf16 v[52:55], a[68:71], a[120:123], 0
ds_read_b128 a[132:135], v10 offset:2048
v_mfma_f32_16x16x32_bf16 v[44:47], a[68:71], a[116:119], 0
v_mfma_f32_16x16x32_bf16 v[36:39], a[68:71], a[112:115], 0
s_add_u32 m0, s73, 38912
s_add_u32 s64, s71, 540672
v_mfma_f32_16x16x32_bf16 v[188:191], a[108:111], a[68:71], 0
ds_read_b64_tr_b16 a[180:181], v12 offset:24576
ds_read_b64_tr_b16 a[182:183], v12 offset:25088
v_mfma_f32_16x16x32_bf16 v[184:187], a[104:107], a[68:71], 0
buffer_load_dwordx4 v5, s[8:11], s64 offen lds
v_mfma_f32_16x16x32_bf16 v[180:183], a[100:103], a[68:71], 0
ds_read_b128 a[136:139], v10 offset:4096
v_mfma_f32_16x16x32_bf16 v[176:179], a[96:99], a[68:71], 0
v_mfma_f32_16x16x32_bf16 v[192:195], a[96:99], a[72:75], 0
v_mfma_f32_16x16x32_bf16 v[196:199], a[100:103], a[72:75], 0
ds_read_b64_tr_b16 a[184:185], v13 offset:24576
ds_read_b64_tr_b16 a[186:187], v13 offset:25088
v_mfma_f32_16x16x32_bf16 v[200:203], a[104:107], a[72:75], 0
buffer_load_dwordx4 v6, s[8:11], s64 offen offset:1024 lds
v_mfma_f32_16x16x32_bf16 v[204:207], a[108:111], a[72:75], 0
s_xor_b32 s76, s75, 524288
s_add_u32 s76, s74, s76
v_mfma_f32_16x16x32_bf16 v[64:67], a[72:75], a[112:115], 0
ds_read_b128 a[140:143], v10 offset:6144
v_mfma_f32_16x16x32_bf16 v[72:75], a[72:75], a[116:119], 0
s_add_u32 m0, s77, 32768
s_add_u32 s64, s76, 0
v_mfma_f32_16x16x32_bf16 v[80:83], a[72:75], a[120:123], 0
v_mfma_f32_16x16x32_bf16 v[88:91], a[72:75], a[124:127], 0
buffer_load_dwordx4 v7, s[16:19], s64 offen lds
v_mfma_f32_16x16x32_bf16 v[92:95], a[76:79], a[124:127], 0
ds_read_b64_tr_b16 a[188:189], v14 offset:24576
ds_read_b64_tr_b16 a[190:191], v14 offset:25088
v_mfma_f32_16x16x32_bf16 v[84:87], a[76:79], a[120:123], 0
v_mfma_f32_16x16x32_bf16 v[76:79], a[76:79], a[116:119], 0
ds_read_b128 a[144:147], v10 offset:8192
v_mfma_f32_16x16x32_bf16 v[68:71], a[76:79], a[112:115], 0
v_mfma_f32_16x16x32_bf16 v[220:223], a[108:111], a[76:79], 0
buffer_load_dwordx4 v8, s[16:19], s64 offen offset:1024 lds
v_mfma_f32_16x16x32_bf16 v[216:219], a[104:107], a[76:79], 0
ds_read_b64_tr_b16 a[160:161], v11 offset:16384
ds_read_b64_tr_b16 a[162:163], v11 offset:16896
v_mfma_f32_16x16x32_bf16 v[212:215], a[100:103], a[76:79], 0
v_mfma_f32_16x16x32_bf16 v[208:211], a[96:99], a[76:79], 0
s_add_u32 m0, s77, 34816
s_add_u32 s64, s76, 131072
v_mfma_f32_16x16x32_bf16 v[224:227], a[96:99], a[80:83], 0
ds_read_b128 a[148:151], v10 offset:10240
v_mfma_f32_16x16x32_bf16 v[228:231], a[100:103], a[80:83], 0
buffer_load_dwordx4 v7, s[16:19], s64 offen lds
v_mfma_f32_16x16x32_bf16 v[232:235], a[104:107], a[80:83], 0
v_mfma_f32_16x16x32_bf16 v[236:239], a[108:111], a[80:83], 0
ds_read_b64_tr_b16 a[164:165], v12 offset:16384
ds_read_b64_tr_b16 a[166:167], v12 offset:16896
v_mfma_f32_16x16x32_bf16 v[96:99], a[80:83], a[112:115], 0
v_mfma_f32_16x16x32_bf16 v[104:107], a[80:83], a[116:119], 0
buffer_load_dwordx4 v8, s[16:19], s64 offen offset:1024 lds
v_mfma_f32_16x16x32_bf16 v[112:115], a[80:83], a[120:123], 0
ds_read_b128 a[152:155], v10 offset:12288
v_mfma_f32_16x16x32_bf16 v[120:123], a[80:83], a[124:127], 0
v_mfma_f32_16x16x32_bf16 v[124:127], a[84:87], a[124:127], 0
s_add_u32 m0, s77, 49152
s_add_u32 s64, s76, 262144
v_mfma_f32_16x16x32_bf16 v[116:119], a[84:87], a[120:123], 0
ds_read_b64_tr_b16 a[168:169], v13 offset:16384
ds_read_b64_tr_b16 a[170:171], v13 offset:16896
v_mfma_f32_16x16x32_bf16 v[108:111], a[84:87], a[116:119], 0
buffer_load_dwordx4 v7, s[16:19], s64 offen lds
v_mfma_f32_16x16x32_bf16 v[100:103], a[84:87], a[112:115], 0
v_mfma_f32_16x16x32_bf16 v[252:255], a[108:111], a[84:87], 0
ds_read_b128 a[156:159], v10 offset:14336
v_mfma_f32_16x16x32_bf16 v[248:251], a[104:107], a[84:87], 0
v_mfma_f32_16x16x32_bf16 v[244:247], a[100:103], a[84:87], 0
v_mfma_f32_16x16x32_bf16 v[240:243], a[96:99], a[84:87], 0
buffer_load_dwordx4 v8, s[16:19], s64 offen offset:1024 lds
v_mfma_f32_16x16x32_bf16 a[0:3], a[96:99], a[88:91], 0
ds_read_b64_tr_b16 a[172:173], v14 offset:16384
ds_read_b64_tr_b16 a[174:175], v14 offset:16896
v_mfma_f32_16x16x32_bf16 a[4:7], a[100:103], a[88:91], 0
v_mfma_f32_16x16x32_bf16 a[8:11], a[104:107], a[88:91], 0
s_add_u32 m0, s77, 51200
s_add_u32 s64, s76, 393216
v_mfma_f32_16x16x32_bf16 a[12:15], a[108:111], a[88:91], 0
v_mfma_f32_16x16x32_bf16 v[128:131], a[88:91], a[112:115], 0
buffer_load_dwordx4 v7, s[16:19], s64 offen lds
v_mfma_f32_16x16x32_bf16 v[136:139], a[88:91], a[116:119], 0
v_mfma_f32_16x16x32_bf16 v[144:147], a[88:91], a[120:123], 0
v_mfma_f32_16x16x32_bf16 v[152:155], a[88:91], a[124:127], 0
v_mfma_f32_16x16x32_bf16 v[156:159], a[92:95], a[124:127], 0
v_add_u32 v9, 32768, v9
v_add_u32 v10, 32768, v10
v_mfma_f32_16x16x32_bf16 v[148:151], a[92:95], a[120:123], 0
buffer_load_dwordx4 v8, s[16:19], s64 offen offset:1024 lds
v_mfma_f32_16x16x32_bf16 v[140:143], a[92:95], a[116:119], 0
v_mfma_f32_16x16x32_bf16 v[132:135], a[92:95], a[112:115], 0
v_mfma_f32_16x16x32_bf16 a[28:31], a[108:111], a[92:95], 0
v_mfma_f32_16x16x32_bf16 a[24:27], a[104:107], a[92:95], 0
v_mfma_f32_16x16x32_bf16 a[20:23], a[100:103], a[92:95], 0
v_mfma_f32_16x16x32_bf16 a[16:19], a[96:99], a[92:95], 0
s_waitcnt lgkmcnt(0)
v_mfma_f32_16x16x32_bf16 v[160:163], a[160:163], a[128:131], v[160:163]
s_waitcnt vmcnt(4)
v_mfma_f32_16x16x32_bf16 v[164:167], a[164:167], a[128:131], v[164:167]
s_barrier
v_mfma_f32_16x16x32_bf16 v[168:171], a[168:171], a[128:131], v[168:171]
ds_read_b128 a[64:67], v9 offset:0
v_mfma_f32_16x16x32_bf16 v[172:175], a[172:175], a[128:131], v[172:175]
s_xor_b32 s71, s70, 256
s_add_u32 s71, s68, s71
v_mfma_f32_16x16x32_bf16 v[32:35], a[128:131], a[176:179], v[32:35]
s_add_u32 m0, s73, 65536
s_add_u32 s64, s71, 0
v_mfma_f32_16x16x32_bf16 v[40:43], a[128:131], a[180:183], v[40:43]
buffer_load_dwordx4 v5, s[8:11], s64 offen lds
v_mfma_f32_16x16x32_bf16 v[48:51], a[128:131], a[184:187], v[48:51]
ds_read_b64_tr_b16 a[112:113], v11 offset:40960
ds_read_b64_tr_b16 a[114:115], v11 offset:41472
v_mfma_f32_16x16x32_bf16 v[56:59], a[128:131], a[188:191], v[56:59]
v_mfma_f32_16x16x32_bf16 v[60:63], a[132:135], a[188:191], v[60:63]
buffer_load_dwordx4 v6, s[8:11], s64 offen offset:1024 lds
v_mfma_f32_16x16x32_bf16 v[52:55], a[132:135], a[184:187], v[52:55]
ds_read_b128 a[68:71], v9 offset:2048
v_mfma_f32_16x16x32_bf16 v[44:47], a[132:135], a[180:183], v[44:47]
v_mfma_f32_16x16x32_bf16 v[36:39], a[132:135], a[176:179], v[36:39]
s_add_u32 m0, s73, 67584
s_add_u32 s64, s71, 16384
v_mfma_f32_16x16x32_bf16 v[188:191], a[172:175], a[132:135], v[188:191]
ds_read_b64_tr_b16 a[116:117], v12 offset:40960
ds_read_b64_tr_b16 a[118:119], v12 offset:41472
v_mfma_f32_16x16x32_bf16 v[184:187], a[168:171], a[132:135], v[184:187]
buffer_load_dwordx4 v5, s[8:11], s64 offen lds
v_mfma_f32_16x16x32_bf16 v[180:183], a[164:167], a[132:135], v[180:183]
ds_read_b128 a[72:75], v9 offset:4096
v_mfma_f32_16x16x32_bf16 v[176:179], a[160:163], a[132:135], v[176:179]
v_mfma_f32_16x16x32_bf16 v[192:195], a[160:163], a[136:139], v[192:195]
v_mfma_f32_16x16x32_bf16 v[196:199], a[164:167], a[136:139], v[196:199]
ds_read_b64_tr_b16 a[120:121], v13 offset:40960
ds_read_b64_tr_b16 a[122:123], v13 offset:41472
v_mfma_f32_16x16x32_bf16 v[200:203], a[168:171], a[136:139], v[200:203]
buffer_load_dwordx4 v6, s[8:11], s64 offen offset:1024 lds
v_mfma_f32_16x16x32_bf16 v[204:207], a[172:175], a[136:139], v[204:207]
s_xor_b32 s76, s75, 1048576
s_add_u32 s76, s74, s76
v_mfma_f32_16x16x32_bf16 v[64:67], a[136:139], a[176:179], v[64:67]
ds_read_b128 a[76:79], v9 offset:6144
v_mfma_f32_16x16x32_bf16 v[72:75], a[136:139], a[180:183], v[72:75]
s_add_u32 m0, s77, 0
s_add_u32 s64, s76, 0
v_mfma_f32_16x16x32_bf16 v[80:83], a[136:139], a[184:187], v[80:83]
v_mfma_f32_16x16x32_bf16 v[88:91], a[136:139], a[188:191], v[88:91]
buffer_load_dwordx4 v7, s[16:19], s64 offen lds
v_mfma_f32_16x16x32_bf16 v[92:95], a[140:143], a[188:191], v[92:95]
ds_read_b64_tr_b16 a[124:125], v14 offset:40960
ds_read_b64_tr_b16 a[126:127], v14 offset:41472
v_mfma_f32_16x16x32_bf16 v[84:87], a[140:143], a[184:187], v[84:87]
v_mfma_f32_16x16x32_bf16 v[76:79], a[140:143], a[180:183], v[76:79]
ds_read_b128 a[80:83], v9 offset:8192
v_mfma_f32_16x16x32_bf16 v[68:71], a[140:143], a[176:179], v[68:71]
v_mfma_f32_16x16x32_bf16 v[220:223], a[172:175], a[140:143], v[220:223]
buffer_load_dwordx4 v8, s[16:19], s64 offen offset:1024 lds
v_mfma_f32_16x16x32_bf16 v[216:219], a[168:171], a[140:143], v[216:219]
ds_read_b64_tr_b16 a[96:97], v11 offset:32768
ds_read_b64_tr_b16 a[98:99], v11 offset:33280
v_mfma_f32_16x16x32_bf16 v[212:215], a[164:167], a[140:143], v[212:215]
v_mfma_f32_16x16x32_bf16 v[208:211], a[160:163], a[140:143], v[208:211]
s_add_u32 m0, s77, 2048
s_add_u32 s64, s76, 131072
v_mfma_f32_16x16x32_bf16 v[224:227], a[160:163], a[144:147], v[224:227]
ds_read_b128 a[84:87], v9 offset:10240
v_mfma_f32_16x16x32_bf16 v[228:231], a[164:167], a[144:147], v[228:231]
buffer_load_dwordx4 v7, s[16:19], s64 offen lds
v_mfma_f32_16x16x32_bf16 v[232:235], a[168:171], a[144:147], v[232:235]
v_mfma_f32_16x16x32_bf16 v[236:239], a[172:175], a[144:147], v[236:239]
ds_read_b64_tr_b16 a[100:101], v12 offset:32768
ds_read_b64_tr_b16 a[102:103], v12 offset:33280
v_mfma_f32_16x16x32_bf16 v[96:99], a[144:147], a[176:179], v[96:99]
v_mfma_f32_16x16x32_bf16 v[104:107], a[144:147], a[180:183], v[104:107]
buffer_load_dwordx4 v8, s[16:19], s64 offen offset:1024 lds
v_mfma_f32_16x16x32_bf16 v[112:115], a[144:147], a[184:187], v[112:115]
ds_read_b128 a[88:91], v9 offset:12288
v_mfma_f32_16x16x32_bf16 v[120:123], a[144:147], a[188:191], v[120:123]
v_mfma_f32_16x16x32_bf16 v[124:127], a[148:151], a[188:191], v[124:127]
s_add_u32 m0, s73, 69632
s_add_u32 s64, s71, 524288
v_mfma_f32_16x16x32_bf16 v[116:119], a[148:151], a[184:187], v[116:119]
ds_read_b64_tr_b16 a[104:105], v13 offset:32768
ds_read_b64_tr_b16 a[106:107], v13 offset:33280
v_mfma_f32_16x16x32_bf16 v[108:111], a[148:151], a[180:183], v[108:111]
buffer_load_dwordx4 v5, s[8:11], s64 offen lds
v_mfma_f32_16x16x32_bf16 v[100:103], a[148:151], a[176:179], v[100:103]
v_mfma_f32_16x16x32_bf16 v[252:255], a[172:175], a[148:151], v[252:255]
ds_read_b128 a[92:95], v9 offset:14336
v_mfma_f32_16x16x32_bf16 v[248:251], a[168:171], a[148:151], v[248:251]
v_mfma_f32_16x16x32_bf16 v[244:247], a[164:167], a[148:151], v[244:247]
v_mfma_f32_16x16x32_bf16 v[240:243], a[160:163], a[148:151], v[240:243]
buffer_load_dwordx4 v6, s[8:11], s64 offen offset:1024 lds
v_mfma_f32_16x16x32_bf16 a[0:3], a[160:163], a[152:155], a[0:3]
ds_read_b64_tr_b16 a[108:109], v14 offset:32768
ds_read_b64_tr_b16 a[110:111], v14 offset:33280
v_mfma_f32_16x16x32_bf16 a[4:7], a[164:167], a[152:155], a[4:7]
v_mfma_f32_16x16x32_bf16 a[8:11], a[168:171], a[152:155], a[8:11]
s_add_u32 m0, s73, 71680
s_add_u32 s64, s71, 540672
v_mfma_f32_16x16x32_bf16 a[12:15], a[172:175], a[152:155], a[12:15]
v_mfma_f32_16x16x32_bf16 v[128:131], a[152:155], a[176:179], v[128:131]
buffer_load_dwordx4 v5, s[8:11], s64 offen lds
v_mfma_f32_16x16x32_bf16 v[136:139], a[152:155], a[180:183], v[136:139]
v_mfma_f32_16x16x32_bf16 v[144:147], a[152:155], a[184:187], v[144:147]
v_mfma_f32_16x16x32_bf16 v[152:155], a[152:155], a[188:191], v[152:155]
v_mfma_f32_16x16x32_bf16 v[156:159], a[156:159], a[188:191], v[156:159]
v_mfma_f32_16x16x32_bf16 v[148:151], a[156:159], a[184:187], v[148:151]
buffer_load_dwordx4 v6, s[8:11], s64 offen offset:1024 lds
v_mfma_f32_16x16x32_bf16 v[140:143], a[156:159], a[180:183], v[140:143]
v_mfma_f32_16x16x32_bf16 v[132:135], a[156:159], a[176:179], v[132:135]
v_mfma_f32_16x16x32_bf16 a[28:31], a[172:175], a[156:159], a[28:31]
v_mfma_f32_16x16x32_bf16 a[24:27], a[168:171], a[156:159], a[24:27]
v_mfma_f32_16x16x32_bf16 a[20:23], a[164:167], a[156:159], a[20:23]
v_mfma_f32_16x16x32_bf16 a[16:19], a[160:163], a[156:159], a[16:19]
s_waitcnt lgkmcnt(0)
v_mfma_f32_16x16x32_bf16 v[160:163], a[96:99], a[64:67], v[160:163]
s_waitcnt vmcnt(12)
v_mfma_f32_16x16x32_bf16 v[164:167], a[100:103], a[64:67], v[164:167]
s_barrier
v_mfma_f32_16x16x32_bf16 v[168:171], a[104:107], a[64:67], v[168:171]
ds_read_b128 a[128:131], v10 offset:0
v_mfma_f32_16x16x32_bf16 v[172:175], a[108:111], a[64:67], v[172:175]
s_add_u32 m0, s77, 16384
s_add_u32 s64, s76, 262144
v_mfma_f32_16x16x32_bf16 v[32:35], a[64:67], a[112:115], v[32:35]
buffer_load_dwordx4 v7, s[16:19], s64 offen lds
v_mfma_f32_16x16x32_bf16 v[40:43], a[64:67], a[116:119], v[40:43]
ds_read_b64_tr_b16 a[176:177], v11 offset:57344
ds_read_b64_tr_b16 a[178:179], v11 offset:57856
v_mfma_f32_16x16x32_bf16 v[48:51], a[64:67], a[120:123], v[48:51]
v_mfma_f32_16x16x32_bf16 v[56:59], a[64:67], a[124:127], v[56:59]
v_mfma_f32_16x16x32_bf16 v[60:63], a[68:71], a[124:127], v[60:63]
buffer_load_dwordx4 v8, s[16:19], s64 offen offset:1024 lds
v_mfma_f32_16x16x32_bf16 v[52:55], a[68:71], a[120:123], v[52:55]
ds_read_b128 a[132:135], v10 offset:2048
v_mfma_f32_16x16x32_bf16 v[44:47], a[68:71], a[116:119], v[44:47]
v_mfma_f32_16x16x32_bf16 v[36:39], a[68:71], a[112:115], v[36:39]
s_add_u32 m0, s77, 18432
s_add_u32 s64, s76, 393216
v_mfma_f32_16x16x32_bf16 v[188:191], a[108:111], a[68:71], v[188:191]
ds_read_b64_tr_b16 a[180:181], v12 offset:57344
ds_read_b64_tr_b16 a[182:183], v12 offset:57856
v_mfma_f32_16x16x32_bf16 v[184:187], a[104:107], a[68:71], v[184:187]
buffer_load_dwordx4 v7, s[16:19], s64 offen lds
v_mfma_f32_16x16x32_bf16 v[180:183], a[100:103], a[68:71], v[180:183]
L_PAD0:
s_cbranch_execz L_PAD4
ds_read_b128 a[136:139], v10 offset:4096
v_mfma_f32_16x16x32_bf16 v[176:179], a[96:99], a[68:71], v[176:179]
v_mfma_f32_16x16x32_bf16 v[192:195], a[96:99], a[72:75], v[192:195]
v_mfma_f32_16x16x32_bf16 v[196:199], a[100:103], a[72:75], v[196:199]
ds_read_b64_tr_b16 a[184:185], v13 offset:57344
ds_read_b64_tr_b16 a[186:187], v13 offset:57856
v_mfma_f32_16x16x32_bf16 v[200:203], a[104:107], a[72:75], v[200:203]
buffer_load_dwordx4 v8, s[16:19], s64 offen offset:1024 lds
v_mfma_f32_16x16x32_bf16 v[204:207], a[108:111], a[72:75], v[204:207]
s_xor_b32 s71, s70, 384
s_add_u32 s71, s68, s71
v_mfma_f32_16x16x32_bf16 v[64:67], a[72:75], a[112:115], v[64:67]
ds_read_b128 a[140:143], v10 offset:6144
v_mfma_f32_16x16x32_bf16 v[72:75], a[72:75], a[116:119], v[72:75]
s_add_u32 m0, s73, 0
s_add_u32 s64, s71, 0
v_mfma_f32_16x16x32_bf16 v[80:83], a[72:75], a[120:123], v[80:83]
v_mfma_f32_16x16x32_bf16 v[88:91], a[72:75], a[124:127], v[88:91]
buffer_load_dwordx4 v5, s[8:11], s64 offen lds
v_mfma_f32_16x16x32_bf16 v[92:95], a[76:79], a[124:127], v[92:95]
ds_read_b64_tr_b16 a[188:189], v14 offset:57344
ds_read_b64_tr_b16 a[190:191], v14 offset:57856
v_mfma_f32_16x16x32_bf16 v[84:87], a[76:79], a[120:123], v[84:87]
v_mfma_f32_16x16x32_bf16 v[76:79], a[76:79], a[116:119], v[76:79]
ds_read_b128 a[144:147], v10 offset:8192
v_mfma_f32_16x16x32_bf16 v[68:71], a[76:79], a[112:115], v[68:71]
v_mfma_f32_16x16x32_bf16 v[220:223], a[108:111], a[76:79], v[220:223]
buffer_load_dwordx4 v6, s[8:11], s64 offen offset:1024 lds
v_mfma_f32_16x16x32_bf16 v[216:219], a[104:107], a[76:79], v[216:219]
ds_read_b64_tr_b16 a[160:161], v11 offset:49152
ds_read_b64_tr_b16 a[162:163], v11 offset:49664
v_mfma_f32_16x16x32_bf16 v[212:215], a[100:103], a[76:79], v[212:215]
v_mfma_f32_16x16x32_bf16 v[208:211], a[96:99], a[76:79], v[208:211]
s_add_u32 m0, s73, 2048
s_add_u32 s64, s71, 16384
v_mfma_f32_16x16x32_bf16 v[224:227], a[96:99], a[80:83], v[224:227]
ds_read_b128 a[148:151], v10 offset:10240
v_mfma_f32_16x16x32_bf16 v[228:231], a[100:103], a[80:83], v[228:231]
buffer_load_dwordx4 v5, s[8:11], s64 offen lds
v_mfma_f32_16x16x32_bf16 v[232:235], a[104:107], a[80:83], v[232:235]
v_mfma_f32_16x16x32_bf16 v[236:239], a[108:111], a[80:83], v[236:239]
ds_read_b64_tr_b16 a[164:165], v12 offset:49152
ds_read_b64_tr_b16 a[166:167], v12 offset:49664
v_mfma_f32_16x16x32_bf16 v[96:99], a[80:83], a[112:115], v[96:99]
v_mfma_f32_16x16x32_bf16 v[104:107], a[80:83], a[116:119], v[104:107]
buffer_load_dwordx4 v6, s[8:11], s64 offen offset:1024 lds
v_mfma_f32_16x16x32_bf16 v[112:115], a[80:83], a[120:123], v[112:115]
s_xor_b32 s76, s75, 1572864
s_add_u32 s76, s74, s76
ds_read_b128 a[152:155], v10 offset:12288
v_mfma_f32_16x16x32_bf16 v[120:123], a[80:83], a[124:127], v[120:123]
v_mfma_f32_16x16x32_bf16 v[124:127], a[84:87], a[124:127], v[124:127]
s_add_u32 m0, s77, 32768
s_add_u32 s64, s76, 0
v_mfma_f32_16x16x32_bf16 v[116:119], a[84:87], a[120:123], v[116:119]
ds_read_b64_tr_b16 a[168:169], v13 offset:49152
ds_read_b64_tr_b16 a[170:171], v13 offset:49664
v_mfma_f32_16x16x32_bf16 v[108:111], a[84:87], a[116:119], v[108:111]
buffer_load_dwordx4 v7, s[16:19], s64 offen lds
v_mfma_f32_16x16x32_bf16 v[100:103], a[84:87], a[112:115], v[100:103]
v_mfma_f32_16x16x32_bf16 v[252:255], a[108:111], a[84:87], v[252:255]
ds_read_b128 a[156:159], v10 offset:14336
v_mfma_f32_16x16x32_bf16 v[248:251], a[104:107], a[84:87], v[248:251]
v_mfma_f32_16x16x32_bf16 v[244:247], a[100:103], a[84:87], v[244:247]
v_mfma_f32_16x16x32_bf16 v[240:243], a[96:99], a[84:87], v[240:243]
buffer_load_dwordx4 v8, s[16:19], s64 offen offset:1024 lds
v_mfma_f32_16x16x32_bf16 a[0:3], a[96:99], a[88:91], a[0:3]
ds_read_b64_tr_b16 a[172:173], v14 offset:49152
ds_read_b64_tr_b16 a[174:175], v14 offset:49664
v_mfma_f32_16x16x32_bf16 a[4:7], a[100:103], a[88:91], a[4:7]
v_mfma_f32_16x16x32_bf16 a[8:11], a[104:107], a[88:91], a[8:11]
s_add_u32 m0, s77, 34816
s_add_u32 s64, s76, 131072
v_mfma_f32_16x16x32_bf16 a[12:15], a[108:111], a[88:91], a[12:15]
v_mfma_f32_16x16x32_bf16 v[128:131], a[88:91], a[112:115], v[128:131]
buffer_load_dwordx4 v7, s[16:19], s64 offen lds
v_mfma_f32_16x16x32_bf16 v[136:139], a[88:91], a[116:119], v[136:139]
v_mfma_f32_16x16x32_bf16 v[144:147], a[88:91], a[120:123], v[144:147]
v_mfma_f32_16x16x32_bf16 v[152:155], a[88:91], a[124:127], v[152:155]
v_mfma_f32_16x16x32_bf16 v[156:159], a[92:95], a[124:127], v[156:159]
v_add_u32 v9, 32768, v9
v_add_u32 v10, 32768, v10
v_mfma_f32_16x16x32_bf16 v[148:151], a[92:95], a[120:123], v[148:151]
buffer_load_dwordx4 v8, s[16:19], s64 offen offset:1024 lds
v_mfma_f32_16x16x32_bf16 v[140:143], a[92:95], a[116:119], v[140:143]
v_mfma_f32_16x16x32_bf16 v[132:135], a[92:95], a[112:115], v[132:135]
v_mfma_f32_16x16x32_bf16 a[28:31], a[108:111], a[92:95], a[28:31]
v_mfma_f32_16x16x32_bf16 a[24:27], a[104:107], a[92:95], a[24:27]
v_mfma_f32_16x16x32_bf16 a[20:23], a[100:103], a[92:95], a[20:23]
v_mfma_f32_16x16x32_bf16 a[16:19], a[96:99], a[92:95], a[16:19]
s_waitcnt lgkmcnt(0)
v_mfma_f32_16x16x32_bf16 v[160:163], a[160:163], a[128:131], v[160:163]
s_waitcnt vmcnt(12)
v_mfma_f32_16x16x32_bf16 v[164:167], a[164:167], a[128:131], v[164:167]
s_barrier
v_mfma_f32_16x16x32_bf16 v[168:171], a[168:171], a[128:131], v[168:171]
s_xor_b32 s52, s6, 31
s_mul_i32 s52, s52, 110592
ds_read_b128 a[64:67], v9 offset:0
v_mfma_f32_16x16x32_bf16 v[172:175], a[172:175], a[128:131], v[172:175]
s_add_u32 m0, s73, 4096
s_add_u32 s64, s71, 524288
s_mul_i32 s53, s3, 27648
v_mfma_f32_16x16x32_bf16 v[32:35], a[128:131], a[176:179], v[32:35]
buffer_load_dwordx4 v5, s[8:11], s64 offen lds
v_mfma_f32_16x16x32_bf16 v[40:43], a[128:131], a[180:183], v[40:43]
s_add_u32 s52, s52, s53
ds_read_b64_tr_b16 a[112:113], v11 offset:8192
ds_read_b64_tr_b16 a[114:115], v11 offset:8704
v_mfma_f32_16x16x32_bf16 v[48:51], a[128:131], a[184:187], v[48:51]
s_mul_i32 s53, s7, 144
s_add_u32 s52, s52, s53
v_mfma_f32_16x16x32_bf16 v[56:59], a[128:131], a[188:191], v[56:59]
buffer_load_dword a252, v28, s[28:31], s52 offen
v_mfma_f32_16x16x32_bf16 v[60:63], a[132:135], a[188:191], v[60:63]
buffer_load_dwordx4 v6, s[8:11], s64 offen offset:1024 lds
v_mfma_f32_16x16x32_bf16 v[52:55], a[132:135], a[184:187], v[52:55]
ds_read_b128 a[68:71], v9 offset:2048
v_mfma_f32_16x16x32_bf16 v[44:47], a[132:135], a[180:183], v[44:47]
v_mfma_f32_16x16x32_bf16 v[36:39], a[132:135], a[176:179], v[36:39]
s_add_u32 m0, s73, 6144
s_add_u32 s64, s71, 540672
v_mfma_f32_16x16x32_bf16 v[188:191], a[172:175], a[132:135], v[188:191]
ds_read_b64_tr_b16 a[116:117], v12 offset:8192
ds_read_b64_tr_b16 a[118:119], v12 offset:8704
v_mfma_f32_16x16x32_bf16 v[184:187], a[168:171], a[132:135], v[184:187]
buffer_load_dwordx4 v5, s[8:11], s64 offen lds
v_mfma_f32_16x16x32_bf16 v[180:183], a[164:167], a[132:135], v[180:183]
ds_read_b128 a[72:75], v9 offset:4096
v_mfma_f32_16x16x32_bf16 v[176:179], a[160:163], a[132:135], v[176:179]
v_mfma_f32_16x16x32_bf16 v[192:195], a[160:163], a[136:139], v[192:195]
v_mfma_f32_16x16x32_bf16 v[196:199], a[164:167], a[136:139], v[196:199]
ds_read_b64_tr_b16 a[120:121], v13 offset:8192
ds_read_b64_tr_b16 a[122:123], v13 offset:8704
v_mfma_f32_16x16x32_bf16 v[200:203], a[168:171], a[136:139], v[200:203]
buffer_load_dwordx4 v6, s[8:11], s64 offen offset:1024 lds
v_mfma_f32_16x16x32_bf16 v[204:207], a[172:175], a[136:139], v[204:207]
v_mfma_f32_16x16x32_bf16 v[64:67], a[136:139], a[176:179], v[64:67]
ds_read_b128 a[76:79], v9 offset:6144
v_mfma_f32_16x16x32_bf16 v[72:75], a[136:139], a[180:183], v[72:75]
s_add_u32 m0, s77, 49152
s_add_u32 s64, s76, 262144
v_mfma_f32_16x16x32_bf16 v[80:83], a[136:139], a[184:187], v[80:83]
v_mfma_f32_16x16x32_bf16 v[88:91], a[136:139], a[188:191], v[88:91]
buffer_load_dwordx4 v7, s[16:19], s64 offen lds
v_mfma_f32_16x16x32_bf16 v[92:95], a[140:143], a[188:191], v[92:95]
ds_read_b64_tr_b16 a[124:125], v14 offset:8192
ds_read_b64_tr_b16 a[126:127], v14 offset:8704
v_mfma_f32_16x16x32_bf16 v[84:87], a[140:143], a[184:187], v[84:87]
v_mfma_f32_16x16x32_bf16 v[76:79], a[140:143], a[180:183], v[76:79]
ds_read_b128 a[80:83], v9 offset:8192
v_mfma_f32_16x16x32_bf16 v[68:71], a[140:143], a[176:179], v[68:71]
v_mfma_f32_16x16x32_bf16 v[220:223], a[172:175], a[140:143], v[220:223]
buffer_load_dwordx4 v8, s[16:19], s64 offen offset:1024 lds
v_mfma_f32_16x16x32_bf16 v[216:219], a[168:171], a[140:143], v[216:219]
ds_read_b64_tr_b16 a[96:97], v11 offset:0
ds_read_b64_tr_b16 a[98:99], v11 offset:512
v_mfma_f32_16x16x32_bf16 v[212:215], a[164:167], a[140:143], v[212:215]
v_mfma_f32_16x16x32_bf16 v[208:211], a[160:163], a[140:143], v[208:211]
s_add_u32 m0, s77, 51200
s_add_u32 s64, s76, 393216
v_mfma_f32_16x16x32_bf16 v[224:227], a[160:163], a[144:147], v[224:227]
ds_read_b128 a[84:87], v9 offset:10240
v_mfma_f32_16x16x32_bf16 v[228:231], a[164:167], a[144:147], v[228:231]
buffer_load_dwordx4 v7, s[16:19], s64 offen lds
v_mfma_f32_16x16x32_bf16 v[232:235], a[168:171], a[144:147], v[232:235]
v_mfma_f32_16x16x32_bf16 v[236:239], a[172:175], a[144:147], v[236:239]
ds_read_b64_tr_b16 a[100:101], v12 offset:0
ds_read_b64_tr_b16 a[102:103], v12 offset:512
v_mfma_f32_16x16x32_bf16 v[96:99], a[144:147], a[176:179], v[96:99]
v_mfma_f32_16x16x32_bf16 v[104:107], a[144:147], a[180:183], v[104:107]
buffer_load_dwordx4 v8, s[16:19], s64 offen offset:1024 lds
v_mfma_f32_16x16x32_bf16 v[112:115], a[144:147], a[184:187], v[112:115]
s_xor_b32 s71, s70, 512
s_add_u32 s71, s68, s71
ds_read_b128 a[88:91], v9 offset:12288
v_mfma_f32_16x16x32_bf16 v[120:123], a[144:147], a[188:191], v[120:123]
v_mfma_f32_16x16x32_bf16 v[124:127], a[148:151], a[188:191], v[124:127]
s_add_u32 m0, s73, 32768
s_add_u32 s64, s71, 0
v_mfma_f32_16x16x32_bf16 v[116:119], a[148:151], a[184:187], v[116:119]
ds_read_b64_tr_b16 a[104:105], v13 offset:0
ds_read_b64_tr_b16 a[106:107], v13 offset:512
v_mfma_f32_16x16x32_bf16 v[108:111], a[148:151], a[180:183], v[108:111]
buffer_load_dwordx4 v5, s[8:11], s64 offen lds
v_mfma_f32_16x16x32_bf16 v[100:103], a[148:151], a[176:179], v[100:103]
v_mfma_f32_16x16x32_bf16 v[252:255], a[172:175], a[148:151], v[252:255]
ds_read_b128 a[92:95], v9 offset:14336
v_mfma_f32_16x16x32_bf16 v[248:251], a[168:171], a[148:151], v[248:251]
v_mfma_f32_16x16x32_bf16 v[244:247], a[164:167], a[148:151], v[244:247]
v_mfma_f32_16x16x32_bf16 v[240:243], a[160:163], a[148:151], v[240:243]
buffer_load_dwordx4 v6, s[8:11], s64 offen offset:1024 lds
v_mfma_f32_16x16x32_bf16 a[0:3], a[160:163], a[152:155], a[0:3]
ds_read_b64_tr_b16 a[108:109], v14 offset:0
ds_read_b64_tr_b16 a[110:111], v14 offset:512
v_mfma_f32_16x16x32_bf16 a[4:7], a[164:167], a[152:155], a[4:7]
v_mfma_f32_16x16x32_bf16 a[8:11], a[168:171], a[152:155], a[8:11]
s_add_u32 m0, s73, 34816
s_add_u32 s64, s71, 16384
v_mfma_f32_16x16x32_bf16 a[12:15], a[172:175], a[152:155], a[12:15]
v_mfma_f32_16x16x32_bf16 v[128:131], a[152:155], a[176:179], v[128:131]
buffer_load_dwordx4 v5, s[8:11], s64 offen lds
v_mfma_f32_16x16x32_bf16 v[136:139], a[152:155], a[180:183], v[136:139]
v_mfma_f32_16x16x32_bf16 v[144:147], a[152:155], a[184:187], v[144:147]
v_mfma_f32_16x16x32_bf16 v[152:155], a[152:155], a[188:191], v[152:155]
v_mfma_f32_16x16x32_bf16 v[156:159], a[156:159], a[188:191], v[156:159]
v_mfma_f32_16x16x32_bf16 v[148:151], a[156:159], a[184:187], v[148:151]
buffer_load_dwordx4 v6, s[8:11], s64 offen offset:1024 lds
v_mfma_f32_16x16x32_bf16 v[140:143], a[156:159], a[180:183], v[140:143]
v_mfma_f32_16x16x32_bf16 v[132:135], a[156:159], a[176:179], v[132:135]
v_mfma_f32_16x16x32_bf16 a[28:31], a[172:175], a[156:159], a[28:31]
v_mfma_f32_16x16x32_bf16 a[24:27], a[168:171], a[156:159], a[24:27]
v_mfma_f32_16x16x32_bf16 a[20:23], a[164:167], a[156:159], a[20:23]
v_mfma_f32_16x16x32_bf16 a[16:19], a[160:163], a[156:159], a[16:19]
s_waitcnt lgkmcnt(0)
v_mfma_f32_16x16x32_bf16 v[160:163], a[96:99], a[64:67], v[160:163]
s_waitcnt vmcnt(21)
v_mfma_f32_16x16x32_bf16 v[164:167], a[100:103], a[64:67], v[164:167]
s_barrier
v_mfma_f32_16x16x32_bf16 v[168:171], a[104:107], a[64:67], v[168:171]
ds_read_b128 a[128:131], v10 offset:0
v_mfma_f32_16x16x32_bf16 v[172:175], a[108:111], a[64:67], v[172:175]
s_xor_b32 s76, s75, 2097152
s_add_u32 s76, s74, s76
v_mfma_f32_16x16x32_bf16 v[32:35], a[64:67], a[112:115], v[32:35]
s_add_u32 m0, s77, 0
s_add_u32 s64, s76, 0
v_mfma_f32_16x16x32_bf16 v[40:43], a[64:67], a[116:119], v[40:43]
buffer_load_dwordx4 v7, s[16:19], s64 offen lds
v_mfma_f32_16x16x32_bf16 v[48:51], a[64:67], a[120:123], v[48:51]
ds_read_b64_tr_b16 a[176:177], v11 offset:24576
ds_read_b64_tr_b16 a[178:179], v11 offset:25088
v_mfma_f32_16x16x32_bf16 v[56:59], a[64:67], a[124:127], v[56:59]
v_mfma_f32_16x16x32_bf16 v[60:63], a[68:71], a[124:127], v[60:63]
ds_read_b128 a[132:135], v10 offset:2048
v_mfma_f32_16x16x32_bf16 v[52:55], a[68:71], a[120:123], v[52:55]
v_mfma_f32_16x16x32_bf16 v[44:47], a[68:71], a[116:119], v[44:47]
v_mfma_f32_16x16x32_bf16 v[36:39], a[68:71], a[112:115], v[36:39]
buffer_load_dwordx4 v8, s[16:19], s64 offen offset:1024 lds
v_mfma_f32_16x16x32_bf16 v[188:191], a[108:111], a[68:71], v[188:191]
ds_read_b64_tr_b16 a[180:181], v12 offset:24576
ds_read_b64_tr_b16 a[182:183], v12 offset:25088
v_mfma_f32_16x16x32_bf16 v[184:187], a[104:107], a[68:71], v[184:187]
v_mfma_f32_16x16x32_bf16 v[180:183], a[100:103], a[68:71], v[180:183]
ds_read_b128 a[136:139], v10 offset:4096
v_mfma_f32_16x16x32_bf16 v[176:179], a[96:99], a[68:71], v[176:179]
v_mfma_f32_16x16x32_bf16 v[192:195], a[96:99], a[72:75], v[192:195]
s_add_u32 m0, s77, 2048
s_add_u32 s64, s76, 131072
v_mfma_f32_16x16x32_bf16 v[196:199], a[100:103], a[72:75], v[196:199]
ds_read_b64_tr_b16 a[184:185], v13 offset:24576
ds_read_b64_tr_b16 a[186:187], v13 offset:25088
v_mfma_f32_16x16x32_bf16 v[200:203], a[104:107], a[72:75], v[200:203]
buffer_load_dwordx4 v7, s[16:19], s64 offen lds
v_mfma_f32_16x16x32_bf16 v[204:207], a[108:111], a[72:75], v[204:207]
v_mfma_f32_16x16x32_bf16 v[64:67], a[72:75], a[112:115], v[64:67]
ds_read_b128 a[140:143], v10 offset:6144
v_mfma_f32_16x16x32_bf16 v[72:75], a[72:75], a[116:119], v[72:75]
v_mfma_f32_16x16x32_bf16 v[80:83], a[72:75], a[120:123], v[80:83]
v_mfma_f32_16x16x32_bf16 v[88:91], a[72:75], a[124:127], v[88:91]
ds_read_b64_tr_b16 a[188:189], v14 offset:24576
ds_read_b64_tr_b16 a[190:191], v14 offset:25088
v_mfma_f32_16x16x32_bf16 v[92:95], a[76:79], a[124:127], v[92:95]
v_mfma_f32_16x16x32_bf16 v[84:87], a[76:79], a[120:123], v[84:87]
buffer_load_dwordx4 v8, s[16:19], s64 offen offset:1024 lds
v_mfma_f32_16x16x32_bf16 v[76:79], a[76:79], a[116:119], v[76:79]
ds_read_b128 a[144:147], v10 offset:8192
v_mfma_f32_16x16x32_bf16 v[68:71], a[76:79], a[112:115], v[68:71]
v_mfma_f32_16x16x32_bf16 v[220:223], a[108:111], a[76:79], v[220:223]
v_mfma_f32_16x16x32_bf16 v[216:219], a[104:107], a[76:79], v[216:219]
ds_read_b64_tr_b16 a[160:161], v11 offset:16384
ds_read_b64_tr_b16 a[162:163], v11 offset:16896
v_mfma_f32_16x16x32_bf16 v[212:215], a[100:103], a[76:79], v[212:215]
v_mfma_f32_16x16x32_bf16 v[208:211], a[96:99], a[76:79], v[208:211]
s_add_u32 m0, s73, 36864
s_add_u32 s64, s71, 524288
v_mfma_f32_16x16x32_bf16 v[224:227], a[96:99], a[80:83], v[224:227]
ds_read_b128 a[148:151], v10 offset:10240
v_mfma_f32_16x16x32_bf16 v[228:231], a[100:103], a[80:83], v[228:231]
buffer_load_dwordx4 v5, s[8:11], s64 offen lds
v_mfma_f32_16x16x32_bf16 v[232:235], a[104:107], a[80:83], v[232:235]
v_mfma_f32_16x16x32_bf16 v[236:239], a[108:111], a[80:83], v[236:239]
ds_read_b64_tr_b16 a[164:165], v12 offset:16384
ds_read_b64_tr_b16 a[166:167], v12 offset:16896
v_mfma_f32_16x16x32_bf16 v[96:99], a[80:83], a[112:115], v[96:99]
v_mfma_f32_16x16x32_bf16 v[104:107], a[80:83], a[116:119], v[104:107]
v_mfma_f32_16x16x32_bf16 v[112:115], a[80:83], a[120:123], v[112:115]
ds_read_b128 a[152:155], v10 offset:12288
v_mfma_f32_16x16x32_bf16 v[120:123], a[80:83], a[124:127], v[120:123]
v_mfma_f32_16x16x32_bf16 v[124:127], a[84:87], a[124:127], v[124:127]
buffer_load_dwordx4 v6, s[8:11], s64 offen offset:1024 lds
v_mfma_f32_16x16x32_bf16 v[116:119], a[84:87], a[120:123], v[116:119]
ds_read_b64_tr_b16 a[168:169], v13 offset:16384
ds_read_b64_tr_b16 a[170:171], v13 offset:16896
v_mfma_f32_16x16x32_bf16 v[108:111], a[84:87], a[116:119], v[108:111]
v_mfma_f32_16x16x32_bf16 v[100:103], a[84:87], a[112:115], v[100:103]
v_mfma_f32_16x16x32_bf16 v[252:255], a[108:111], a[84:87], v[252:255]
ds_read_b128 a[156:159], v10 offset:14336
v_mfma_f32_16x16x32_bf16 v[248:251], a[104:107], a[84:87], v[248:251]
s_add_u32 m0, s73, 38912
s_add_u32 s64, s71, 540672
v_mfma_f32_16x16x32_bf16 v[244:247], a[100:103], a[84:87], v[244:247]
v_mfma_f32_16x16x32_bf16 v[240:243], a[96:99], a[84:87], v[240:243]
buffer_load_dwordx4 v5, s[8:11], s64 offen lds
v_mfma_f32_16x16x32_bf16 a[0:3], a[96:99], a[88:91], a[0:3]
ds_read_b64_tr_b16 a[172:173], v14 offset:16384
ds_read_b64_tr_b16 a[174:175], v14 offset:16896
v_mfma_f32_16x16x32_bf16 a[4:7], a[100:103], a[88:91], a[4:7]
v_mfma_f32_16x16x32_bf16 a[8:11], a[104:107], a[88:91], a[8:11]
v_mfma_f32_16x16x32_bf16 a[12:15], a[108:111], a[88:91], a[12:15]
v_mfma_f32_16x16x32_bf16 v[128:131], a[88:91], a[112:115], v[128:131]
v_mfma_f32_16x16x32_bf16 v[136:139], a[88:91], a[116:119], v[136:139]
v_mfma_f32_16x16x32_bf16 v[144:147], a[88:91], a[120:123], v[144:147]
buffer_load_dwordx4 v6, s[8:11], s64 offen offset:1024 lds
v_mfma_f32_16x16x32_bf16 v[152:155], a[88:91], a[124:127], v[152:155]
v_mfma_f32_16x16x32_bf16 v[156:159], a[92:95], a[124:127], v[156:159]
v_add_u32 v9, -65536, v9
v_add_u32 v10, -65536, v10
v_mfma_f32_16x16x32_bf16 v[148:151], a[92:95], a[120:123], v[148:151]
v_mfma_f32_16x16x32_bf16 v[140:143], a[92:95], a[116:119], v[140:143]
v_mfma_f32_16x16x32_bf16 v[132:135], a[92:95], a[112:115], v[132:135]
v_mfma_f32_16x16x32_bf16 a[28:31], a[108:111], a[92:95], a[28:31]
v_mfma_f32_16x16x32_bf16 a[24:27], a[104:107], a[92:95], a[24:27]
v_mfma_f32_16x16x32_bf16 a[20:23], a[100:103], a[92:95], a[20:23]
v_mfma_f32_16x16x32_bf16 a[16:19], a[96:99], a[92:95], a[16:19]
s_waitcnt lgkmcnt(0)
v_mfma_f32_16x16x32_bf16 v[160:163], a[160:163], a[128:131], v[160:163]
s_waitcnt vmcnt(16)
v_mfma_f32_16x16x32_bf16 v[164:167], a[164:167], a[128:131], v[164:167]
s_barrier
v_mfma_f32_16x16x32_bf16 v[168:171], a[168:171], a[128:131], v[168:171]
s_add_u32 s52, s81, 0
ds_read_b128 a[64:67], v9 offset:0
v_mfma_f32_16x16x32_bf16 v[172:175], a[172:175], a[128:131], v[172:175]
s_add_u32 m0, s77, 16384
s_add_u32 s64, s76, 262144
v_mfma_f32_16x16x32_bf16 v[32:35], a[128:131], a[176:179], v[32:35]
buffer_load_dwordx4 v7, s[16:19], s64 offen lds
v_mfma_f32_16x16x32_bf16 v[40:43], a[128:131], a[180:183], v[40:43]
ds_read_b64_tr_b16 a[112:113], v11 offset:40960
ds_read_b64_tr_b16 a[114:115], v11 offset:41472
v_mfma_f32_16x16x32_bf16 v[48:51], a[128:131], a[184:187], v[48:51]
buffer_load_dwordx2 a[192:193], v26, s[28:31], s52 offen
v_mfma_f32_16x16x32_bf16 v[56:59], a[128:131], a[188:191], v[56:59]
v_mfma_f32_16x16x32_bf16 v[60:63], a[132:135], a[188:191], v[60:63]
ds_read_b128 a[68:71], v9 offset:2048
v_mfma_f32_16x16x32_bf16 v[52:55], a[132:135], a[184:187], v[52:55]
v_mfma_f32_16x16x32_bf16 v[44:47], a[132:135], a[180:183], v[44:47]
v_mfma_f32_16x16x32_bf16 v[36:39], a[132:135], a[176:179], v[36:39]
buffer_load_dwordx4 v8, s[16:19], s64 offen offset:1024 lds
v_mfma_f32_16x16x32_bf16 v[188:191], a[172:175], a[132:135], v[188:191]
s_add_u32 s52, s81, 3456
ds_read_b64_tr_b16 a[116:117], v12 offset:40960
ds_read_b64_tr_b16 a[118:119], v12 offset:41472
v_mfma_f32_16x16x32_bf16 v[184:187], a[168:171], a[132:135], v[184:187]
buffer_load_dwordx2 a[194:195], v26, s[28:31], s52 offen
v_mfma_f32_16x16x32_bf16 v[180:183], a[164:167], a[132:135], v[180:183]
ds_read_b128 a[72:75], v9 offset:4096
v_mfma_f32_16x16x32_bf16 v[176:179], a[160:163], a[132:135], v[176:179]
v_mfma_f32_16x16x32_bf16 v[192:195], a[160:163], a[136:139], v[192:195]
s_add_u32 m0, s77, 18432
s_add_u32 s64, s76, 393216
v_mfma_f32_16x16x32_bf16 v[196:199], a[164:167], a[136:139], v[196:199]
ds_read_b64_tr_b16 a[120:121], v13 offset:40960
ds_read_b64_tr_b16 a[122:123], v13 offset:41472
v_mfma_f32_16x16x32_bf16 v[200:203], a[168:171], a[136:139], v[200:203]
buffer_load_dwordx4 v7, s[16:19], s64 offen lds
v_mfma_f32_16x16x32_bf16 v[204:207], a[172:175], a[136:139], v[204:207]
s_add_u32 s52, s81, 6912
v_mfma_f32_16x16x32_bf16 v[64:67], a[136:139], a[176:179], v[64:67]
ds_read_b128 a[76:79], v9 offset:6144
v_mfma_f32_16x16x32_bf16 v[72:75], a[136:139], a[180:183], v[72:75]
buffer_load_dwordx2 a[196:197], v26, s[28:31], s52 offen
v_mfma_f32_16x16x32_bf16 v[80:83], a[136:139], a[184:187], v[80:83]
v_mfma_f32_16x16x32_bf16 v[88:91], a[136:139], a[188:191], v[88:91]
ds_read_b64_tr_b16 a[124:125], v14 offset:40960
ds_read_b64_tr_b16 a[126:127], v14 offset:41472
v_mfma_f32_16x16x32_bf16 v[92:95], a[140:143], a[188:191], v[92:95]
v_mfma_f32_16x16x32_bf16 v[84:87], a[140:143], a[184:187], v[84:87]
buffer_load_dwordx4 v8, s[16:19], s64 offen offset:1024 lds
v_mfma_f32_16x16x32_bf16 v[76:79], a[140:143], a[180:183], v[76:79]
s_xor_b32 s71, s70, 640
s_add_u32 s71, s68, s71
ds_read_b128 a[80:83], v9 offset:8192
v_mfma_f32_16x16x32_bf16 v[68:71], a[140:143], a[176:179], v[68:71]
s_add_u32 s52, s81, 10368
v_mfma_f32_16x16x32_bf16 v[220:223], a[172:175], a[140:143], v[220:223]
buffer_load_dwordx2 a[198:199], v26, s[28:31], s52 offen
v_mfma_f32_16x16x32_bf16 v[216:219], a[168:171], a[140:143], v[216:219]
ds_read_b64_tr_b16 a[96:97], v11 offset:32768
ds_read_b64_tr_b16 a[98:99], v11 offset:33280
v_mfma_f32_16x16x32_bf16 v[212:215], a[164:167], a[140:143], v[212:215]
v_mfma_f32_16x16x32_bf16 v[208:211], a[160:163], a[140:143], v[208:211]
s_add_u32 m0, s73, 65536
s_add_u32 s64, s71, 0
v_mfma_f32_16x16x32_bf16 v[224:227], a[160:163], a[144:147], v[224:227]
ds_read_b128 a[84:87], v9 offset:10240
v_mfma_f32_16x16x32_bf16 v[228:231], a[164:167], a[144:147], v[228:231]
buffer_load_dwordx4 v5, s[8:11], s64 offen lds
v_mfma_f32_16x16x32_bf16 v[232:235], a[168:171], a[144:147], v[232:235]
s_add_u32 s52, s81, 13824
v_mfma_f32_16x16x32_bf16 v[236:239], a[172:175], a[144:147], v[236:239]
ds_read_b64_tr_b16 a[100:101], v12 offset:32768
ds_read_b64_tr_b16 a[102:103], v12 offset:33280
v_mfma_f32_16x16x32_bf16 v[96:99], a[144:147], a[176:179], v[96:99]
buffer_load_dwordx2 a[200:201], v26, s[28:31], s52 offen
v_mfma_f32_16x16x32_bf16 v[104:107], a[144:147], a[180:183], v[104:107]
v_mfma_f32_16x16x32_bf16 v[112:115], a[144:147], a[184:187], v[112:115]
ds_read_b128 a[88:91], v9 offset:12288
v_mfma_f32_16x16x32_bf16 v[120:123], a[144:147], a[188:191], v[120:123]
v_mfma_f32_16x16x32_bf16 v[124:127], a[148:151], a[188:191], v[124:127]
buffer_load_dwordx4 v6, s[8:11], s64 offen offset:1024 lds
v_mfma_f32_16x16x32_bf16 v[116:119], a[148:151], a[184:187], v[116:119]
s_add_u32 s52, s81, 17280
ds_read_b64_tr_b16 a[104:105], v13 offset:32768
ds_read_b64_tr_b16 a[106:107], v13 offset:33280
v_mfma_f32_16x16x32_bf16 v[108:111], a[148:151], a[180:183], v[108:111]
buffer_load_dwordx2 a[202:203], v26, s[28:31], s52 offen
v_mfma_f32_16x16x32_bf16 v[100:103], a[148:151], a[176:179], v[100:103]
v_mfma_f32_16x16x32_bf16 v[252:255], a[172:175], a[148:151], v[252:255]
ds_read_b128 a[92:95], v9 offset:14336
v_mfma_f32_16x16x32_bf16 v[248:251], a[168:171], a[148:151], v[248:251]
s_add_u32 m0, s73, 67584
s_add_u32 s64, s71, 16384
v_mfma_f32_16x16x32_bf16 v[244:247], a[164:167], a[148:151], v[244:247]
v_mfma_f32_16x16x32_bf16 v[240:243], a[160:163], a[148:151], v[240:243]
buffer_load_dwordx4 v5, s[8:11], s64 offen lds
v_mfma_f32_16x16x32_bf16 a[0:3], a[160:163], a[152:155], a[0:3]
s_add_u32 s52, s81, 20736
ds_read_b64_tr_b16 a[108:109], v14 offset:32768
ds_read_b64_tr_b16 a[110:111], v14 offset:33280
v_mfma_f32_16x16x32_bf16 a[4:7], a[164:167], a[152:155], a[4:7]
buffer_load_dwordx2 a[204:205], v26, s[28:31], s52 offen
v_mfma_f32_16x16x32_bf16 a[8:11], a[168:171], a[152:155], a[8:11]
v_mfma_f32_16x16x32_bf16 a[12:15], a[172:175], a[152:155], a[12:15]
v_mfma_f32_16x16x32_bf16 v[128:131], a[152:155], a[176:179], v[128:131]
v_mfma_f32_16x16x32_bf16 v[136:139], a[152:155], a[180:183], v[136:139]
v_mfma_f32_16x16x32_bf16 v[144:147], a[152:155], a[184:187], v[144:147]
buffer_load_dwordx4 v6, s[8:11], s64 offen offset:1024 lds
v_mfma_f32_16x16x32_bf16 v[152:155], a[152:155], a[188:191], v[152:155]
s_add_u32 s52, s81, 24192
v_mfma_f32_16x16x32_bf16 v[156:159], a[156:159], a[188:191], v[156:159]
buffer_load_dwordx2 a[206:207], v26, s[28:31], s52 offen
v_mfma_f32_16x16x32_bf16 v[148:151], a[156:159], a[184:187], v[148:151]
v_mfma_f32_16x16x32_bf16 v[140:143], a[156:159], a[180:183], v[140:143]
v_mfma_f32_16x16x32_bf16 v[132:135], a[156:159], a[176:179], v[132:135]
v_mfma_f32_16x16x32_bf16 a[28:31], a[172:175], a[156:159], a[28:31]
v_mfma_f32_16x16x32_bf16 a[24:27], a[168:171], a[156:159], a[24:27]
buffer_load_dwordx4 a[208:211], v27, s[36:39], s83 offen
v_mfma_f32_16x16x32_bf16 a[20:23], a[164:167], a[156:159], a[20:23]
v_mfma_f32_16x16x32_bf16 a[16:19], a[160:163], a[156:159], a[16:19]
s_waitcnt lgkmcnt(0)
v_mfma_f32_16x16x32_bf16 v[160:163], a[96:99], a[64:67], v[160:163]
s_waitcnt vmcnt(29)
v_mfma_f32_16x16x32_bf16 v[164:167], a[100:103], a[64:67], v[164:167]
s_barrier
v_mfma_f32_16x16x32_bf16 v[168:171], a[104:107], a[64:67], v[168:171]
ds_read_b128 a[128:131], v10 offset:0
v_mfma_f32_16x16x32_bf16 v[172:175], a[108:111], a[64:67], v[172:175]
s_xor_b32 s76, s75, 2621440
s_add_u32 s76, s74, s76
v_mfma_f32_16x16x32_bf16 v[32:35], a[64:67], a[112:115], v[32:35]
s_add_u32 m0, s77, 32768
s_add_u32 s64, s76, 0
v_mfma_f32_16x16x32_bf16 v[40:43], a[64:67], a[116:119], v[40:43]
buffer_load_dwordx4 v7, s[16:19], s64 offen lds
v_mfma_f32_16x16x32_bf16 v[48:51], a[64:67], a[120:123], v[48:51]
ds_read_b64_tr_b16 a[176:177], v11 offset:57344
ds_read_b64_tr_b16 a[178:179], v11 offset:57856
v_mfma_f32_16x16x32_bf16 v[56:59], a[64:67], a[124:127], v[56:59]
v_mfma_f32_16x16x32_bf16 v[60:63], a[68:71], a[124:127], v[60:63]
ds_read_b128 a[132:135], v10 offset:2048
v_mfma_f32_16x16x32_bf16 v[52:55], a[68:71], a[120:123], v[52:55]
v_mfma_f32_16x16x32_bf16 v[44:47], a[68:71], a[116:119], v[44:47]
v_mfma_f32_16x16x32_bf16 v[36:39], a[68:71], a[112:115], v[36:39]
buffer_load_dwordx4 v8, s[16:19], s64 offen offset:1024 lds
v_mfma_f32_16x16x32_bf16 v[188:191], a[108:111], a[68:71], v[188:191]
ds_read_b64_tr_b16 a[180:181], v12 offset:57344
ds_read_b64_tr_b16 a[182:183], v12 offset:57856
v_mfma_f32_16x16x32_bf16 v[184:187], a[104:107], a[68:71], v[184:187]
v_mfma_f32_16x16x32_bf16 v[180:183], a[100:103], a[68:71], v[180:183]
ds_read_b128 a[136:139], v10 offset:4096
v_mfma_f32_16x16x32_bf16 v[176:179], a[96:99], a[68:71], v[176:179]
v_mfma_f32_16x16x32_bf16 v[192:195], a[96:99], a[72:75], v[192:195]
s_add_u32 m0, s77, 34816
s_add_u32 s64, s76, 131072
v_mfma_f32_16x16x32_bf16 v[196:199], a[100:103], a[72:75], v[196:199]
ds_read_b64_tr_b16 a[184:185], v13 offset:57344
ds_read_b64_tr_b16 a[186:187], v13 offset:57856
v_mfma_f32_16x16x32_bf16 v[200:203], a[104:107], a[72:75], v[200:203]
buffer_load_dwordx4 v7, s[16:19], s64 offen lds
v_mfma_f32_16x16x32_bf16 v[204:207], a[108:111], a[72:75], v[204:207]
v_mfma_f32_16x16x32_bf16 v[64:67], a[72:75], a[112:115], v[64:67]
ds_read_b128 a[140:143], v10 offset:6144
v_mfma_f32_16x16x32_bf16 v[72:75], a[72:75], a[116:119], v[72:75]
v_mfma_f32_16x16x32_bf16 v[80:83], a[72:75], a[120:123], v[80:83]
v_mfma_f32_16x16x32_bf16 v[88:91], a[72:75], a[124:127], v[88:91]
ds_read_b64_tr_b16 a[188:189], v14 offset:57344
ds_read_b64_tr_b16 a[190:191], v14 offset:57856
v_mfma_f32_16x16x32_bf16 v[92:95], a[76:79], a[124:127], v[92:95]
v_mfma_f32_16x16x32_bf16 v[84:87], a[76:79], a[120:123], v[84:87]
buffer_load_dwordx4 v8, s[16:19], s64 offen offset:1024 lds
v_mfma_f32_16x16x32_bf16 v[76:79], a[76:79], a[116:119], v[76:79]
ds_read_b128 a[144:147], v10 offset:8192
v_mfma_f32_16x16x32_bf16 v[68:71], a[76:79], a[112:115], v[68:71]
v_mfma_f32_16x16x32_bf16 v[220:223], a[108:111], a[76:79], v[220:223]
v_mfma_f32_16x16x32_bf16 v[216:219], a[104:107], a[76:79], v[216:219]
ds_read_b64_tr_b16 a[160:161], v11 offset:49152
ds_read_b64_tr_b16 a[162:163], v11 offset:49664
v_mfma_f32_16x16x32_bf16 v[212:215], a[100:103], a[76:79], v[212:215]
v_mfma_f32_16x16x32_bf16 v[208:211], a[96:99], a[76:79], v[208:211]
s_add_u32 m0, s73, 69632
s_add_u32 s64, s71, 524288
v_mfma_f32_16x16x32_bf16 v[224:227], a[96:99], a[80:83], v[224:227]
ds_read_b128 a[148:151], v10 offset:10240
v_mfma_f32_16x16x32_bf16 v[228:231], a[100:103], a[80:83], v[228:231]
buffer_load_dwordx4 v5, s[8:11], s64 offen lds
v_mfma_f32_16x16x32_bf16 v[232:235], a[104:107], a[80:83], v[232:235]
v_mfma_f32_16x16x32_bf16 v[236:239], a[108:111], a[80:83], v[236:239]
ds_read_b64_tr_b16 a[164:165], v12 offset:49152
ds_read_b64_tr_b16 a[166:167], v12 offset:49664
v_mfma_f32_16x16x32_bf16 v[96:99], a[80:83], a[112:115], v[96:99]
v_mfma_f32_16x16x32_bf16 v[104:107], a[80:83], a[116:119], v[104:107]
s_waitcnt vmcnt(5)
v_mfma_f32_16x16x32_bf16 v[112:115], a[80:83], a[120:123], v[112:115]
L_PAD1:
s_cbranch_execz L_PAD5
ds_read_b128 a[152:155], v10 offset:12288
v_accvgpr_read_b32 v16, a192
v_mfma_f32_16x16x32_bf16 v[120:123], a[80:83], a[124:127], v[120:123]
v_accvgpr_read_b32 v17, a194
v_accvgpr_read_b32 v18, a196
v_mfma_f32_16x16x32_bf16 v[124:127], a[84:87], a[124:127], v[124:127]
buffer_load_dwordx4 v6, s[8:11], s64 offen offset:1024 lds
v_mfma_f32_16x16x32_bf16 v[116:119], a[84:87], a[120:123], v[116:119]
ds_read_b64_tr_b16 a[168:169], v13 offset:49152
ds_read_b64_tr_b16 a[170:171], v13 offset:49664
v_mfma_f32_16x16x32_bf16 v[108:111], a[84:87], a[116:119], v[108:111]
v_accvgpr_read_b32 v19, a198
v_accvgpr_read_b32 v20, a200
v_mfma_f32_16x16x32_bf16 v[100:103], a[84:87], a[112:115], v[100:103]
v_accvgpr_read_b32 v21, a202
v_accvgpr_read_b32 v22, a204
v_mfma_f32_16x16x32_bf16 v[252:255], a[108:111], a[84:87], v[252:255]
ds_read_b128 a[156:159], v10 offset:14336
v_accvgpr_read_b32 v23, a206
v_mfma_f32_16x16x32_bf16 v[248:251], a[104:107], a[84:87], v[248:251]
s_add_u32 m0, s73, 71680
s_add_u32 s64, s71, 540672
v_mfma_f32_16x16x32_bf16 v[244:247], a[100:103], a[84:87], v[244:247]
v_perm_b32 v24, v17, v16, s85
v_perm_b32 v25, v19, v18, s85
v_mfma_f32_16x16x32_bf16 v[240:243], a[96:99], a[84:87], v[240:243]
buffer_load_dwordx4 v5, s[8:11], s64 offen lds
v_mfma_f32_16x16x32_bf16 a[0:3], a[96:99], a[88:91], a[0:3]
ds_read_b64_tr_b16 a[172:173], v14 offset:49152
ds_read_b64_tr_b16 a[174:175], v14 offset:49664
v_mfma_f32_16x16x32_bf16 a[4:7], a[100:103], a[88:91], a[4:7]
v_perm_b32 v26, v21, v20, s85
v_perm_b32 v27, v23, v22, s85
v_mfma_f32_16x16x32_bf16 a[8:11], a[104:107], a[88:91], a[8:11]
v_perm_b32 v28, v17, v16, s86
v_perm_b32 v29, v19, v18, s86
v_mfma_f32_16x16x32_bf16 a[12:15], a[108:111], a[88:91], a[12:15]
v_perm_b32 v30, v21, v20, s86
v_perm_b32 v31, v23, v22, s86
v_mfma_f32_16x16x32_bf16 v[128:131], a[88:91], a[112:115], v[128:131]
v_accvgpr_read_b32 v16, a208
v_accvgpr_read_b32 v17, a209
v_mfma_f32_16x16x32_bf16 v[136:139], a[88:91], a[116:119], v[136:139]
v_accvgpr_read_b32 v18, a210
v_accvgpr_read_b32 v19, a211
v_mfma_f32_16x16x32_bf16 v[144:147], a[88:91], a[120:123], v[144:147]
buffer_load_dwordx4 v6, s[8:11], s64 offen offset:1024 lds
v_mfma_f32_16x16x32_bf16 v[152:155], a[88:91], a[124:127], v[152:155]
v_or_b32 v24, v24, v16
v_or_b32 v25, v25, v17
v_mfma_f32_16x16x32_bf16 v[156:159], a[92:95], a[124:127], v[156:159]
v_add_u32 v9, 32768, v9
v_add_u32 v10, 32768, v10
v_mfma_f32_16x16x32_bf16 v[148:151], a[92:95], a[120:123], v[148:151]
v_or_b32 v26, v26, v18
v_or_b32 v27, v27, v19
v_mfma_f32_16x16x32_bf16 v[140:143], a[92:95], a[116:119], v[140:143]
buffer_store_dwordx4 v[24:27], v4, s[24:27], s82 offen offset:0 sc1
v_mfma_f32_16x16x32_bf16 v[132:135], a[92:95], a[112:115], v[132:135]
v_mfma_f32_16x16x32_bf16 a[28:31], a[108:111], a[92:95], a[28:31]
v_mfma_f32_16x16x32_bf16 a[24:27], a[104:107], a[92:95], a[24:27]
v_mfma_f32_16x16x32_bf16 a[20:23], a[100:103], a[92:95], a[20:23]
v_mfma_f32_16x16x32_bf16 a[16:19], a[96:99], a[92:95], a[16:19]
s_waitcnt lgkmcnt(0)
v_mfma_f32_16x16x32_bf16 v[160:163], a[160:163], a[128:131], v[160:163]
s_waitcnt vmcnt(26)
v_mfma_f32_16x16x32_bf16 v[164:167], a[164:167], a[128:131], v[164:167]
s_barrier
v_mfma_f32_16x16x32_bf16 v[168:171], a[168:171], a[128:131], v[168:171]
ds_read_b128 a[64:67], v9 offset:0
v_mfma_f32_16x16x32_bf16 v[172:175], a[172:175], a[128:131], v[172:175]
s_add_u32 m0, s77, 49152
s_add_u32 s64, s76, 262144
v_mfma_f32_16x16x32_bf16 v[32:35], a[128:131], a[176:179], v[32:35]
buffer_load_dwordx4 v7, s[16:19], s64 offen lds
v_mfma_f32_16x16x32_bf16 v[40:43], a[128:131], a[180:183], v[40:43]
ds_read_b64_tr_b16 a[112:113], v11 offset:8192
ds_read_b64_tr_b16 a[114:115], v11 offset:8704
v_mfma_f32_16x16x32_bf16 v[48:51], a[128:131], a[184:187], v[48:51]
buffer_store_dwordx4 v[28:31], v4, s[24:27], s82 offen offset:1024 sc1
v_mfma_f32_16x16x32_bf16 v[56:59], a[128:131], a[188:191], v[56:59]
v_accvgpr_read_b32 v16, a193
v_accvgpr_read_b32 v17, a195
v_mfma_f32_16x16x32_bf16 v[60:63], a[132:135], a[188:191], v[60:63]
ds_read_b128 a[68:71], v9 offset:2048
v_accvgpr_read_b32 v18, a197
v_mfma_f32_16x16x32_bf16 v[52:55], a[132:135], a[184:187], v[52:55]
v_accvgpr_read_b32 v19, a199
v_accvgpr_read_b32 v20, a201
v_mfma_f32_16x16x32_bf16 v[44:47], a[132:135], a[180:183], v[44:47]
v_accvgpr_read_b32 v21, a203
v_accvgpr_read_b32 v22, a205
v_mfma_f32_16x16x32_bf16 v[36:39], a[132:135], a[176:179], v[36:39]
buffer_load_dwordx4 v8, s[16:19], s64 offen offset:1024 lds
v_mfma_f32_16x16x32_bf16 v[188:191], a[172:175], a[132:135], v[188:191]
ds_read_b64_tr_b16 a[116:117], v12 offset:8192
ds_read_b64_tr_b16 a[118:119], v12 offset:8704
v_mfma_f32_16x16x32_bf16 v[184:187], a[168:171], a[132:135], v[184:187]
v_accvgpr_read_b32 v23, a207
v_mfma_f32_16x16x32_bf16 v[180:183], a[164:167], a[132:135], v[180:183]
ds_read_b128 a[72:75], v9 offset:4096
v_mfma_f32_16x16x32_bf16 v[176:179], a[160:163], a[132:135], v[176:179]
v_perm_b32 v24, v17, v16, s85
v_perm_b32 v25, v19, v18, s85
v_mfma_f32_16x16x32_bf16 v[192:195], a[160:163], a[136:139], v[192:195]
s_add_u32 m0, s77, 51200
s_add_u32 s64, s76, 393216
v_perm_b32 v26, v21, v20, s85
v_mfma_f32_16x16x32_bf16 v[196:199], a[164:167], a[136:139], v[196:199]
ds_read_b64_tr_b16 a[120:121], v13 offset:8192
ds_read_b64_tr_b16 a[122:123], v13 offset:8704
v_mfma_f32_16x16x32_bf16 v[200:203], a[168:171], a[136:139], v[200:203]
buffer_load_dwordx4 v7, s[16:19], s64 offen lds
v_mfma_f32_16x16x32_bf16 v[204:207], a[172:175], a[136:139], v[204:207]
v_perm_b32 v27, v23, v22, s85
v_perm_b32 v28, v17, v16, s86
v_mfma_f32_16x16x32_bf16 v[64:67], a[136:139], a[176:179], v[64:67]
ds_read_b128 a[76:79], v9 offset:6144
v_perm_b32 v29, v19, v18, s86
v_mfma_f32_16x16x32_bf16 v[72:75], a[136:139], a[180:183], v[72:75]
v_perm_b32 v30, v21, v20, s86
v_perm_b32 v31, v23, v22, s86
v_mfma_f32_16x16x32_bf16 v[80:83], a[136:139], a[184:187], v[80:83]
buffer_store_dwordx4 v[24:27], v4, s[24:27], s82 offen offset:2048 sc1
v_mfma_f32_16x16x32_bf16 v[88:91], a[136:139], a[188:191], v[88:91]
ds_read_b64_tr_b16 a[124:125], v14 offset:8192
ds_read_b64_tr_b16 a[126:127], v14 offset:8704
v_mfma_f32_16x16x32_bf16 v[92:95], a[140:143], a[188:191], v[92:95]
v_mfma_f32_16x16x32_bf16 v[84:87], a[140:143], a[184:187], v[84:87]
buffer_load_dwordx4 v8, s[16:19], s64 offen offset:1024 lds
v_mfma_f32_16x16x32_bf16 v[76:79], a[140:143], a[180:183], v[76:79]
s_xor_b32 s71, s70, 768
s_add_u32 s71, s68, s71
ds_read_b128 a[80:83], v9 offset:8192
v_mfma_f32_16x16x32_bf16 v[68:71], a[140:143], a[176:179], v[68:71]
v_mfma_f32_16x16x32_bf16 v[220:223], a[172:175], a[140:143], v[220:223]
buffer_store_dwordx4 v[28:31], v4, s[24:27], s82 offen offset:3072 sc1
v_mfma_f32_16x16x32_bf16 v[216:219], a[168:171], a[140:143], v[216:219]
s_lshl_b32 s52, s7, 4
ds_read_b64_tr_b16 a[96:97], v11 offset:0
ds_read_b64_tr_b16 a[98:99], v11 offset:512
v_mfma_f32_16x16x32_bf16 v[212:215], a[164:167], a[140:143], v[212:215]
v_and_b32 v22, 3, v1
v_lshl_add_u32 v22, v22, 2, s52
v_mfma_f32_16x16x32_bf16 v[208:211], a[160:163], a[140:143], v[208:211]
s_add_u32 m0, s73, 0
s_add_u32 s64, s71, 0
v_mfma_f32_16x16x32_bf16 v[224:227], a[160:163], a[144:147], v[224:227]
ds_read_b128 a[84:87], v9 offset:10240
v_mfma_f32_16x16x32_bf16 v[228:231], a[164:167], a[144:147], v[228:231]
buffer_load_dwordx4 v5, s[8:11], s64 offen lds
v_mfma_f32_16x16x32_bf16 v[232:235], a[168:171], a[144:147], v[232:235]
buffer_load_dword v23, v22, s[40:43], 0 offen sc1
v_mfma_f32_16x16x32_bf16 v[236:239], a[172:175], a[144:147], v[236:239]
ds_read_b64_tr_b16 a[100:101], v12 offset:0
ds_read_b64_tr_b16 a[102:103], v12 offset:512
v_mfma_f32_16x16x32_bf16 v[96:99], a[144:147], a[176:179], v[96:99]
v_mfma_f32_16x16x32_bf16 v[104:107], a[144:147], a[180:183], v[104:107]
v_mfma_f32_16x16x32_bf16 v[112:115], a[144:147], a[184:187], v[112:115]
ds_read_b128 a[88:91], v9 offset:12288
v_mfma_f32_16x16x32_bf16 v[120:123], a[144:147], a[188:191], v[120:123]
v_mfma_f32_16x16x32_bf16 v[124:127], a[148:151], a[188:191], v[124:127]
buffer_load_dwordx4 v6, s[8:11], s64 offen offset:1024 lds
v_mfma_f32_16x16x32_bf16 v[116:119], a[148:151], a[184:187], v[116:119]
ds_read_b64_tr_b16 a[104:105], v13 offset:0
ds_read_b64_tr_b16 a[106:107], v13 offset:512
v_mfma_f32_16x16x32_bf16 v[108:111], a[148:151], a[180:183], v[108:111]
v_mfma_f32_16x16x32_bf16 v[100:103], a[148:151], a[176:179], v[100:103]
v_mfma_f32_16x16x32_bf16 v[252:255], a[172:175], a[148:151], v[252:255]
ds_read_b128 a[92:95], v9 offset:14336
v_mfma_f32_16x16x32_bf16 v[248:251], a[168:171], a[148:151], v[248:251]
s_add_u32 m0, s73, 2048
s_add_u32 s64, s71, 16384
v_mfma_f32_16x16x32_bf16 v[244:247], a[164:167], a[148:151], v[244:247]
v_mfma_f32_16x16x32_bf16 v[240:243], a[160:163], a[148:151], v[240:243]
buffer_load_dwordx4 v5, s[8:11], s64 offen lds
v_mfma_f32_16x16x32_bf16 a[0:3], a[160:163], a[152:155], a[0:3]
ds_read_b64_tr_b16 a[108:109], v14 offset:0
ds_read_b64_tr_b16 a[110:111], v14 offset:512
v_mfma_f32_16x16x32_bf16 a[4:7], a[164:167], a[152:155], a[4:7]
v_mfma_f32_16x16x32_bf16 a[8:11], a[168:171], a[152:155], a[8:11]
v_mfma_f32_16x16x32_bf16 a[12:15], a[172:175], a[152:155], a[12:15]
v_mfma_f32_16x16x32_bf16 v[128:131], a[152:155], a[176:179], v[128:131]
v_mfma_f32_16x16x32_bf16 v[136:139], a[152:155], a[180:183], v[136:139]
v_mfma_f32_16x16x32_bf16 v[144:147], a[152:155], a[184:187], v[144:147]
buffer_load_dwordx4 v6, s[8:11], s64 offen offset:1024 lds
v_mfma_f32_16x16x32_bf16 v[152:155], a[152:155], a[188:191], v[152:155]
v_mfma_f32_16x16x32_bf16 v[156:159], a[156:159], a[188:191], v[156:159]
v_mfma_f32_16x16x32_bf16 v[148:151], a[156:159], a[184:187], v[148:151]
v_mfma_f32_16x16x32_bf16 v[140:143], a[156:159], a[180:183], v[140:143]
v_mfma_f32_16x16x32_bf16 v[132:135], a[156:159], a[176:179], v[132:135]
v_mfma_f32_16x16x32_bf16 a[28:31], a[172:175], a[156:159], a[28:31]
v_mfma_f32_16x16x32_bf16 a[24:27], a[168:171], a[156:159], a[24:27]
v_mfma_f32_16x16x32_bf16 a[20:23], a[164:167], a[156:159], a[20:23]
v_mfma_f32_16x16x32_bf16 a[16:19], a[160:163], a[156:159], a[16:19]
s_waitcnt lgkmcnt(0)
v_mfma_f32_16x16x32_bf16 v[160:163], a[96:99], a[64:67], v[160:163]
s_waitcnt vmcnt(31)
v_mfma_f32_16x16x32_bf16 v[164:167], a[100:103], a[64:67], v[164:167]
s_barrier
v_mfma_f32_16x16x32_bf16 v[168:171], a[104:107], a[64:67], v[168:171]
ds_read_b128 a[128:131], v10 offset:0
v_mfma_f32_16x16x32_bf16 v[172:175], a[108:111], a[64:67], v[172:175]
s_xor_b32 s76, s75, 3145728
s_add_u32 s76, s74, s76
v_mfma_f32_16x16x32_bf16 v[32:35], a[64:67], a[112:115], v[32:35]
s_add_u32 m0, s77, 0
s_add_u32 s64, s76, 0
v_mfma_f32_16x16x32_bf16 v[40:43], a[64:67], a[116:119], v[40:43]
buffer_load_dwordx4 v7, s[16:19], s64 offen lds
v_mfma_f32_16x16x32_bf16 v[48:51], a[64:67], a[120:123], v[48:51]
ds_read_b64_tr_b16 a[176:177], v11 offset:24576
ds_read_b64_tr_b16 a[178:179], v11 offset:25088
v_mfma_f32_16x16x32_bf16 v[56:59], a[64:67], a[124:127], v[56:59]
v_mfma_f32_16x16x32_bf16 v[60:63], a[68:71], a[124:127], v[60:63]
ds_read_b128 a[132:135], v10 offset:2048
v_mfma_f32_16x16x32_bf16 v[52:55], a[68:71], a[120:123], v[52:55]
v_mfma_f32_16x16x32_bf16 v[44:47], a[68:71], a[116:119], v[44:47]
v_mfma_f32_16x16x32_bf16 v[36:39], a[68:71], a[112:115], v[36:39]
buffer_load_dwordx4 v8, s[16:19], s64 offen offset:1024 lds
v_mfma_f32_16x16x32_bf16 v[188:191], a[108:111], a[68:71], v[188:191]
ds_read_b64_tr_b16 a[180:181], v12 offset:24576
ds_read_b64_tr_b16 a[182:183], v12 offset:25088
v_mfma_f32_16x16x32_bf16 v[184:187], a[104:107], a[68:71], v[184:187]
v_mfma_f32_16x16x32_bf16 v[180:183], a[100:103], a[68:71], v[180:183]
ds_read_b128 a[136:139], v10 offset:4096
v_mfma_f32_16x16x32_bf16 v[176:179], a[96:99], a[68:71], v[176:179]
v_mfma_f32_16x16x32_bf16 v[192:195], a[96:99], a[72:75], v[192:195]
s_add_u32 m0, s77, 2048
s_add_u32 s64, s76, 131072
s_waitcnt vmcnt(5)
v_mfma_f32_16x16x32_bf16 v[196:199], a[100:103], a[72:75], v[196:199]
ds_read_b64_tr_b16 a[184:185], v13 offset:24576
ds_read_b64_tr_b16 a[186:187], v13 offset:25088
v_mfma_f32_16x16x32_bf16 v[200:203], a[104:107], a[72:75], v[200:203]
buffer_load_dwordx4 v7, s[16:19], s64 offen lds
v_mfma_f32_16x16x32_bf16 v[204:207], a[108:111], a[72:75], v[204:207]
v_cmp_gt_u32 vcc, 1, v23
v_mfma_f32_16x16x32_bf16 v[64:67], a[72:75], a[112:115], v[64:67]
ds_read_b128 a[140:143], v10 offset:6144
v_mfma_f32_16x16x32_bf16 v[72:75], a[72:75], a[116:119], v[72:75]
v_mfma_f32_16x16x32_bf16 v[80:83], a[72:75], a[120:123], v[80:83]
v_mfma_f32_16x16x32_bf16 v[88:91], a[72:75], a[124:127], v[88:91]
ds_read_b64_tr_b16 a[188:189], v14 offset:24576
ds_read_b64_tr_b16 a[190:191], v14 offset:25088
v_mfma_f32_16x16x32_bf16 v[92:95], a[76:79], a[124:127], v[92:95]
s_cbranch_vccnz CK_Z
CK_Z_R:
v_mfma_f32_16x16x32_bf16 v[84:87], a[76:79], a[120:123], v[84:87]
buffer_load_dwordx4 v8, s[16:19], s64 offen offset:1024 lds
v_mfma_f32_16x16x32_bf16 v[76:79], a[76:79], a[116:119], v[76:79]
ds_read_b128 a[144:147], v10 offset:8192
v_mfma_f32_16x16x32_bf16 v[68:71], a[76:79], a[112:115], v[68:71]
buffer_atomic_add v1, v0, s[24:27], s84 offen offset:0 sc1
v_mfma_f32_16x16x32_bf16 v[220:223], a[108:111], a[76:79], v[220:223]
s_mul_i32 s52, s66, 147456
s_lshl_b32 s53, s4, 8
s_add_u32 s52, s52, s53
v_mfma_f32_16x16x32_bf16 v[216:219], a[104:107], a[76:79], v[216:219]
s_lshl2_add_u32 s53, s2, s3
ds_read_b64_tr_b16 a[160:161], v11 offset:16384
ds_read_b64_tr_b16 a[162:163], v11 offset:16896
v_mfma_f32_16x16x32_bf16 v[212:215], a[100:103], a[76:79], v[212:215]
s_mul_i32 s53, s53, 2304
v_lshrrev_b32 v16, 1, v1
v_and_b32 v17, 1, v1
v_mfma_f32_16x16x32_bf16 v[208:211], a[96:99], a[76:79], v[208:211]
s_add_u32 m0, s73, 4096
s_add_u32 s64, s71, 524288
v_lshlrev_b32 v16, 13, v16
v_mfma_f32_16x16x32_bf16 v[224:227], a[96:99], a[80:83], v[224:227]
ds_read_b128 a[148:151], v10 offset:10240
v_lshl_add_u32 v16, v17, 7, v16
v_mfma_f32_16x16x32_bf16 v[228:231], a[100:103], a[80:83], v[228:231]
buffer_load_dwordx4 v5, s[8:11], s64 offen lds
v_mfma_f32_16x16x32_bf16 v[232:235], a[104:107], a[80:83], v[232:235]
v_mov_b32 v17, 2147418112
v_cmp_gt_u32 s[96:97], 18, v1
v_mfma_f32_16x16x32_bf16 v[236:239], a[108:111], a[80:83], v[236:239]
ds_read_b64_tr_b16 a[164:165], v12 offset:16384
ds_read_b64_tr_b16 a[166:167], v12 offset:16896
v_mfma_f32_16x16x32_bf16 v[96:99], a[80:83], a[112:115], v[96:99]
v_lshlrev_b32 v18, 7, v1
v_mov_b32 v29, 0
v_mfma_f32_16x16x32_bf16 v[104:107], a[80:83], a[116:119], v[104:107]
v_mfma_f32_16x16x32_bf16 v[112:115], a[80:83], a[120:123], v[112:115]
ds_read_b128 a[152:155], v10 offset:12288
v_cndmask_b32 v16, v17, v16, s[96:97]
v_mfma_f32_16x16x32_bf16 v[120:123], a[80:83], a[124:127], v[120:123]
v_cndmask_b32 v18, v17, v18, s[96:97]
v_mfma_f32_16x16x32_bf16 v[124:127], a[84:87], a[124:127], v[124:127]
buffer_load_dwordx4 v6, s[8:11], s64 offen offset:1024 lds
v_mfma_f32_16x16x32_bf16 v[116:119], a[84:87], a[120:123], v[116:119]
ds_read_b64_tr_b16 a[168:169], v13 offset:16384
ds_read_b64_tr_b16 a[170:171], v13 offset:16896
v_mfma_f32_16x16x32_bf16 v[108:111], a[84:87], a[116:119], v[108:111]
buffer_load_dword a253, v18, s[12:15], s53 offen
v_mfma_f32_16x16x32_bf16 v[100:103], a[84:87], a[112:115], v[100:103]
v_mfma_f32_16x16x32_bf16 v[252:255], a[108:111], a[84:87], v[252:255]
ds_read_b128 a[156:159], v10 offset:14336
v_mfma_f32_16x16x32_bf16 v[248:251], a[104:107], a[84:87], v[248:251]
s_add_u32 m0, s73, 6144
s_add_u32 s64, s71, 540672
v_mfma_f32_16x16x32_bf16 v[244:247], a[100:103], a[84:87], v[244:247]
v_mfma_f32_16x16x32_bf16 v[240:243], a[96:99], a[84:87], v[240:243]
buffer_load_dwordx4 v5, s[8:11], s64 offen lds
v_mfma_f32_16x16x32_bf16 a[0:3], a[96:99], a[88:91], a[0:3]
ds_read_b64_tr_b16 a[172:173], v14 offset:16384
ds_read_b64_tr_b16 a[174:175], v14 offset:16896
v_mfma_f32_16x16x32_bf16 a[4:7], a[100:103], a[88:91], a[4:7]
v_mfma_f32_16x16x32_bf16 a[8:11], a[104:107], a[88:91], a[8:11]
v_mfma_f32_16x16x32_bf16 a[12:15], a[108:111], a[88:91], a[12:15]
v_mfma_f32_16x16x32_bf16 v[128:131], a[88:91], a[112:115], v[128:131]
v_mfma_f32_16x16x32_bf16 v[136:139], a[88:91], a[116:119], v[136:139]
v_mfma_f32_16x16x32_bf16 v[144:147], a[88:91], a[120:123], v[144:147]
buffer_load_dwordx4 v6, s[8:11], s64 offen offset:1024 lds
v_mfma_f32_16x16x32_bf16 v[152:155], a[88:91], a[124:127], v[152:155]
v_mfma_f32_16x16x32_bf16 v[156:159], a[92:95], a[124:127], v[156:159]
v_add_u32 v9, 32768, v9
v_add_u32 v10, 32768, v10
v_mfma_f32_16x16x32_bf16 v[148:151], a[92:95], a[120:123], v[148:151]
v_mfma_f32_16x16x32_bf16 v[140:143], a[92:95], a[116:119], v[140:143]
v_mfma_f32_16x16x32_bf16 v[132:135], a[92:95], a[112:115], v[132:135]
v_mfma_f32_16x16x32_bf16 a[28:31], a[108:111], a[92:95], a[28:31]
v_mfma_f32_16x16x32_bf16 a[24:27], a[104:107], a[92:95], a[24:27]
v_mfma_f32_16x16x32_bf16 a[20:23], a[100:103], a[92:95], a[20:23]
v_mfma_f32_16x16x32_bf16 a[16:19], a[96:99], a[92:95], a[16:19]
s_waitcnt lgkmcnt(0)
v_mfma_f32_16x16x32_bf16 v[160:163], a[160:163], a[128:131], v[160:163]
s_waitcnt vmcnt(23)
v_mfma_f32_16x16x32_bf16 v[164:167], a[164:167], a[128:131], v[164:167]
s_barrier
v_mfma_f32_16x16x32_bf16 v[168:171], a[168:171], a[128:131], v[168:171]
ds_read_b128 a[64:67], v9 offset:0
v_mfma_f32_16x16x32_bf16 v[172:175], a[172:175], a[128:131], v[172:175]
s_add_u32 m0, s77, 16384
s_add_u32 s64, s76, 262144
v_mfma_f32_16x16x32_bf16 v[32:35], a[128:131], a[176:179], v[32:35]
buffer_load_dwordx4 v7, s[16:19], s64 offen lds
v_mfma_f32_16x16x32_bf16 v[40:43], a[128:131], a[180:183], v[40:43]
ds_read_b64_tr_b16 a[112:113], v11 offset:40960
ds_read_b64_tr_b16 a[114:115], v11 offset:41472
v_mfma_f32_16x16x32_bf16 v[48:51], a[128:131], a[184:187], v[48:51]
buffer_load_dword a252, v16, s[20:23], s52 offen
v_mfma_f32_16x16x32_bf16 v[56:59], a[128:131], a[188:191], v[56:59]
s_add_u32 s52, s52, 73728
v_mfma_f32_16x16x32_bf16 v[60:63], a[132:135], a[188:191], v[60:63]
ds_read_b128 a[68:71], v9 offset:2048
v_mfma_f32_16x16x32_bf16 v[52:55], a[132:135], a[184:187], v[52:55]
v_mfma_f32_16x16x32_bf16 v[44:47], a[132:135], a[180:183], v[44:47]
v_mfma_f32_16x16x32_bf16 v[36:39], a[132:135], a[176:179], v[36:39]
buffer_load_dwordx4 v8, s[16:19], s64 offen offset:1024 lds
v_mfma_f32_16x16x32_bf16 v[188:191], a[172:175], a[132:135], v[188:191]
ds_read_b64_tr_b16 a[116:117], v12 offset:40960
ds_read_b64_tr_b16 a[118:119], v12 offset:41472
v_mfma_f32_16x16x32_bf16 v[184:187], a[168:171], a[132:135], v[184:187]
v_mfma_f32_16x16x32_bf16 v[180:183], a[164:167], a[132:135], v[180:183]
ds_read_b128 a[72:75], v9 offset:4096
v_mfma_f32_16x16x32_bf16 v[176:179], a[160:163], a[132:135], v[176:179]
v_mfma_f32_16x16x32_bf16 v[192:195], a[160:163], a[136:139], v[192:195]
s_add_u32 m0, s77, 18432
s_add_u32 s64, s76, 393216
v_mfma_f32_16x16x32_bf16 v[196:199], a[164:167], a[136:139], v[196:199]
ds_read_b64_tr_b16 a[120:121], v13 offset:40960
ds_read_b64_tr_b16 a[122:123], v13 offset:41472
v_mfma_f32_16x16x32_bf16 v[200:203], a[168:171], a[136:139], v[200:203]
buffer_load_dwordx4 v7, s[16:19], s64 offen lds
v_mfma_f32_16x16x32_bf16 v[204:207], a[172:175], a[136:139], v[204:207]
v_mfma_f32_16x16x32_bf16 v[64:67], a[136:139], a[176:179], v[64:67]
ds_read_b128 a[76:79], v9 offset:6144
v_mfma_f32_16x16x32_bf16 v[72:75], a[136:139], a[180:183], v[72:75]
v_mfma_f32_16x16x32_bf16 v[80:83], a[136:139], a[184:187], v[80:83]
v_mfma_f32_16x16x32_bf16 v[88:91], a[136:139], a[188:191], v[88:91]
ds_read_b64_tr_b16 a[124:125], v14 offset:40960
ds_read_b64_tr_b16 a[126:127], v14 offset:41472
v_mfma_f32_16x16x32_bf16 v[92:95], a[140:143], a[188:191], v[92:95]
v_mfma_f32_16x16x32_bf16 v[84:87], a[140:143], a[184:187], v[84:87]
buffer_load_dwordx4 v8, s[16:19], s64 offen offset:1024 lds
v_mfma_f32_16x16x32_bf16 v[76:79], a[140:143], a[180:183], v[76:79]
s_xor_b32 s71, s70, 896
s_add_u32 s71, s68, s71
ds_read_b128 a[80:83], v9 offset:8192
v_mfma_f32_16x16x32_bf16 v[68:71], a[140:143], a[176:179], v[68:71]
v_mfma_f32_16x16x32_bf16 v[220:223], a[172:175], a[140:143], v[220:223]
v_mfma_f32_16x16x32_bf16 v[216:219], a[168:171], a[140:143], v[216:219]
ds_read_b64_tr_b16 a[96:97], v11 offset:32768
ds_read_b64_tr_b16 a[98:99], v11 offset:33280
v_mfma_f32_16x16x32_bf16 v[212:215], a[164:167], a[140:143], v[212:215]
v_mfma_f32_16x16x32_bf16 v[208:211], a[160:163], a[140:143], v[208:211]
s_add_u32 m0, s73, 32768
s_add_u32 s64, s71, 0
v_mfma_f32_16x16x32_bf16 v[224:227], a[160:163], a[144:147], v[224:227]
ds_read_b128 a[84:87], v9 offset:10240
v_mfma_f32_16x16x32_bf16 v[228:231], a[164:167], a[144:147], v[228:231]
buffer_load_dwordx4 v5, s[8:11], s64 offen lds
v_mfma_f32_16x16x32_bf16 v[232:235], a[168:171], a[144:147], v[232:235]
v_mfma_f32_16x16x32_bf16 v[236:239], a[172:175], a[144:147], v[236:239]
ds_read_b64_tr_b16 a[100:101], v12 offset:32768
ds_read_b64_tr_b16 a[102:103], v12 offset:33280
v_mfma_f32_16x16x32_bf16 v[96:99], a[144:147], a[176:179], v[96:99]
v_mfma_f32_16x16x32_bf16 v[104:107], a[144:147], a[180:183], v[104:107]
v_mfma_f32_16x16x32_bf16 v[112:115], a[144:147], a[184:187], v[112:115]
ds_read_b128 a[88:91], v9 offset:12288
v_mfma_f32_16x16x32_bf16 v[120:123], a[144:147], a[188:191], v[120:123]
v_mfma_f32_16x16x32_bf16 v[124:127], a[148:151], a[188:191], v[124:127]
buffer_load_dwordx4 v6, s[8:11], s64 offen offset:1024 lds
v_mfma_f32_16x16x32_bf16 v[116:119], a[148:151], a[184:187], v[116:119]
ds_read_b64_tr_b16 a[104:105], v13 offset:32768
ds_read_b64_tr_b16 a[106:107], v13 offset:33280
v_mfma_f32_16x16x32_bf16 v[108:111], a[148:151], a[180:183], v[108:111]
v_mfma_f32_16x16x32_bf16 v[100:103], a[148:151], a[176:179], v[100:103]
v_mfma_f32_16x16x32_bf16 v[252:255], a[172:175], a[148:151], v[252:255]
ds_read_b128 a[92:95], v9 offset:14336
v_mfma_f32_16x16x32_bf16 v[248:251], a[168:171], a[148:151], v[248:251]
s_add_u32 m0, s73, 34816
s_add_u32 s64, s71, 16384
v_mfma_f32_16x16x32_bf16 v[244:247], a[164:167], a[148:151], v[244:247]
v_mfma_f32_16x16x32_bf16 v[240:243], a[160:163], a[148:151], v[240:243]
buffer_load_dwordx4 v5, s[8:11], s64 offen lds
v_mfma_f32_16x16x32_bf16 a[0:3], a[160:163], a[152:155], a[0:3]
ds_read_b64_tr_b16 a[108:109], v14 offset:32768
ds_read_b64_tr_b16 a[110:111], v14 offset:33280
v_mfma_f32_16x16x32_bf16 a[4:7], a[164:167], a[152:155], a[4:7]
v_mfma_f32_16x16x32_bf16 a[8:11], a[168:171], a[152:155], a[8:11]
v_mfma_f32_16x16x32_bf16 a[12:15], a[172:175], a[152:155], a[12:15]
v_mfma_f32_16x16x32_bf16 v[128:131], a[152:155], a[176:179], v[128:131]
v_mfma_f32_16x16x32_bf16 v[136:139], a[152:155], a[180:183], v[136:139]
v_mfma_f32_16x16x32_bf16 v[144:147], a[152:155], a[184:187], v[144:147]
buffer_load_dwordx4 v6, s[8:11], s64 offen offset:1024 lds
v_mfma_f32_16x16x32_bf16 v[152:155], a[152:155], a[188:191], v[152:155]
v_mfma_f32_16x16x32_bf16 v[156:159], a[156:159], a[188:191], v[156:159]
v_mfma_f32_16x16x32_bf16 v[148:151], a[156:159], a[184:187], v[148:151]
v_mfma_f32_16x16x32_bf16 v[140:143], a[156:159], a[180:183], v[140:143]
v_mfma_f32_16x16x32_bf16 v[132:135], a[156:159], a[176:179], v[132:135]
v_mfma_f32_16x16x32_bf16 a[28:31], a[172:175], a[156:159], a[28:31]
v_mfma_f32_16x16x32_bf16 a[24:27], a[168:171], a[156:159], a[24:27]
v_mfma_f32_16x16x32_bf16 a[20:23], a[164:167], a[156:159], a[20:23]
v_mfma_f32_16x16x32_bf16 a[16:19], a[160:163], a[156:159], a[16:19]
s_waitcnt lgkmcnt(0)
v_mfma_f32_16x16x32_bf16 v[160:163], a[96:99], a[64:67], v[160:163]
s_waitcnt vmcnt(25)
v_mfma_f32_16x16x32_bf16 v[164:167], a[100:103], a[64:67], v[164:167]
s_barrier
v_mfma_f32_16x16x32_bf16 v[168:171], a[104:107], a[64:67], v[168:171]
ds_read_b128 a[128:131], v10 offset:0
v_mfma_f32_16x16x32_bf16 v[172:175], a[108:111], a[64:67], v[172:175]
s_xor_b32 s76, s75, 3670016
s_add_u32 s76, s74, s76
v_mfma_f32_16x16x32_bf16 v[32:35], a[64:67], a[112:115], v[32:35]
s_add_u32 m0, s77, 32768
s_add_u32 s64, s76, 0
v_mfma_f32_16x16x32_bf16 v[40:43], a[64:67], a[116:119], v[40:43]
buffer_load_dwordx4 v7, s[16:19], s64 offen lds
v_mfma_f32_16x16x32_bf16 v[48:51], a[64:67], a[120:123], v[48:51]
ds_read_b64_tr_b16 a[176:177], v11 offset:57344
ds_read_b64_tr_b16 a[178:179], v11 offset:57856
v_mfma_f32_16x16x32_bf16 v[56:59], a[64:67], a[124:127], v[56:59]
buffer_load_dword a252, v16, s[20:23], s52 offen
v_mfma_f32_16x16x32_bf16 v[60:63], a[68:71], a[124:127], v[60:63]
s_lshr_b32 s52, s2, 1
s_lshl2_add_u32 s52, s52, s3
ds_read_b128 a[132:135], v10 offset:2048
v_mfma_f32_16x16x32_bf16 v[52:55], a[68:71], a[120:123], v[52:55]
s_mul_i32 s52, s52, 9216
s_and_b32 s53, s2, 1
s_lshl_b32 s53, s53, 9
v_mfma_f32_16x16x32_bf16 v[44:47], a[68:71], a[116:119], v[44:47]
s_add_u32 s52, s52, s53
s_lshl2_add_u32 s53, s2, s3
s_mul_i32 s53, s53, 768
v_mfma_f32_16x16x32_bf16 v[36:39], a[68:71], a[112:115], v[36:39]
buffer_load_dwordx4 v8, s[16:19], s64 offen offset:1024 lds
v_mfma_f32_16x16x32_bf16 v[188:191], a[108:111], a[68:71], v[188:191]
ds_read_b64_tr_b16 a[180:181], v12 offset:57344
ds_read_b64_tr_b16 a[182:183], v12 offset:57856
v_mfma_f32_16x16x32_bf16 v[184:187], a[104:107], a[68:71], v[184:187]
v_cmp_gt_u32 s[96:97], 40, v1
v_and_b32 v16, 7, v1
v_mfma_f32_16x16x32_bf16 v[180:183], a[100:103], a[68:71], v[180:183]
ds_read_b128 a[136:139], v10 offset:4096
v_mul_u32_u24 v16, 1152, v16
v_mfma_f32_16x16x32_bf16 v[176:179], a[96:99], a[68:71], v[176:179]
v_lshrrev_b32 v19, 3, v1
v_lshl_add_u32 v16, v19, 7, v16
v_mfma_f32_16x16x32_bf16 v[192:195], a[96:99], a[72:75], v[192:195]
s_add_u32 m0, s77, 34816
s_add_u32 s64, s76, 131072
v_cndmask_b32 v16, v17, v16, s[96:97]
v_mfma_f32_16x16x32_bf16 v[196:199], a[100:103], a[72:75], v[196:199]
ds_read_b64_tr_b16 a[184:185], v13 offset:57344
ds_read_b64_tr_b16 a[186:187], v13 offset:57856
v_mfma_f32_16x16x32_bf16 v[200:203], a[104:107], a[72:75], v[200:203]
buffer_load_dwordx4 v7, s[16:19], s64 offen lds
v_mfma_f32_16x16x32_bf16 v[204:207], a[108:111], a[72:75], v[204:207]
v_cmp_gt_u32 s[96:97], 6, v1
v_mfma_f32_16x16x32_bf16 v[64:67], a[72:75], a[112:115], v[64:67]
ds_read_b128 a[140:143], v10 offset:6144
v_mfma_f32_16x16x32_bf16 v[72:75], a[72:75], a[116:119], v[72:75]
v_cndmask_b32 v18, v17, v18, s[96:97]
v_mfma_f32_16x16x32_bf16 v[80:83], a[72:75], a[120:123], v[80:83]
v_mfma_f32_16x16x32_bf16 v[88:91], a[72:75], a[124:127], v[88:91]
ds_read_b64_tr_b16 a[188:189], v14 offset:57344
ds_read_b64_tr_b16 a[190:191], v14 offset:57856
v_mfma_f32_16x16x32_bf16 v[92:95], a[76:79], a[124:127], v[92:95]
v_mfma_f32_16x16x32_bf16 v[84:87], a[76:79], a[120:123], v[84:87]
buffer_load_dwordx4 v8, s[16:19], s64 offen offset:1024 lds
v_mfma_f32_16x16x32_bf16 v[76:79], a[76:79], a[116:119], v[76:79]
ds_read_b128 a[144:147], v10 offset:8192
v_mfma_f32_16x16x32_bf16 v[68:71], a[76:79], a[112:115], v[68:71]
v_mfma_f32_16x16x32_bf16 v[220:223], a[108:111], a[76:79], v[220:223]
v_mfma_f32_16x16x32_bf16 v[216:219], a[104:107], a[76:79], v[216:219]
ds_read_b64_tr_b16 a[160:161], v11 offset:49152
ds_read_b64_tr_b16 a[162:163], v11 offset:49664
v_mfma_f32_16x16x32_bf16 v[212:215], a[100:103], a[76:79], v[212:215]
v_mfma_f32_16x16x32_bf16 v[208:211], a[96:99], a[76:79], v[208:211]
s_add_u32 m0, s73, 36864
s_add_u32 s64, s71, 524288
v_mfma_f32_16x16x32_bf16 v[224:227], a[96:99], a[80:83], v[224:227]
ds_read_b128 a[148:151], v10 offset:10240
v_mfma_f32_16x16x32_bf16 v[228:231], a[100:103], a[80:83], v[228:231]
buffer_load_dwordx4 v5, s[8:11], s64 offen lds
v_mfma_f32_16x16x32_bf16 v[232:235], a[104:107], a[80:83], v[232:235]
v_mfma_f32_16x16x32_bf16 v[236:239], a[108:111], a[80:83], v[236:239]
ds_read_b64_tr_b16 a[164:165], v12 offset:49152
ds_read_b64_tr_b16 a[166:167], v12 offset:49664
v_mfma_f32_16x16x32_bf16 v[96:99], a[80:83], a[112:115], v[96:99]
v_mfma_f32_16x16x32_bf16 v[104:107], a[80:83], a[116:119], v[104:107]
v_mfma_f32_16x16x32_bf16 v[112:115], a[80:83], a[120:123], v[112:115]
ds_read_b128 a[152:155], v10 offset:12288
v_mfma_f32_16x16x32_bf16 v[120:123], a[80:83], a[124:127], v[120:123]
v_mfma_f32_16x16x32_bf16 v[124:127], a[84:87], a[124:127], v[124:127]
buffer_load_dwordx4 v6, s[8:11], s64 offen offset:1024 lds
v_mfma_f32_16x16x32_bf16 v[116:119], a[84:87], a[120:123], v[116:119]
ds_read_b64_tr_b16 a[168:169], v13 offset:49152
ds_read_b64_tr_b16 a[170:171], v13 offset:49664
v_mfma_f32_16x16x32_bf16 v[108:111], a[84:87], a[116:119], v[108:111]
buffer_load_dword v30, v29, s[24:27], s89 offen sc1
v_mfma_f32_16x16x32_bf16 v[100:103], a[84:87], a[112:115], v[100:103]
L_PAD2:
s_cbranch_execz L_PAD6
v_mfma_f32_16x16x32_bf16 v[252:255], a[108:111], a[84:87], v[252:255]
ds_read_b128 a[156:159], v10 offset:14336
v_mfma_f32_16x16x32_bf16 v[248:251], a[104:107], a[84:87], v[248:251]
s_add_u32 m0, s73, 38912
s_add_u32 s64, s71, 540672
v_mfma_f32_16x16x32_bf16 v[244:247], a[100:103], a[84:87], v[244:247]
v_mfma_f32_16x16x32_bf16 v[240:243], a[96:99], a[84:87], v[240:243]
buffer_load_dwordx4 v5, s[8:11], s64 offen lds
v_mfma_f32_16x16x32_bf16 a[0:3], a[96:99], a[88:91], a[0:3]
ds_read_b64_tr_b16 a[172:173], v14 offset:49152
ds_read_b64_tr_b16 a[174:175], v14 offset:49664
v_mfma_f32_16x16x32_bf16 a[4:7], a[100:103], a[88:91], a[4:7]
v_mfma_f32_16x16x32_bf16 a[8:11], a[104:107], a[88:91], a[8:11]
v_mfma_f32_16x16x32_bf16 a[12:15], a[108:111], a[88:91], a[12:15]
v_mfma_f32_16x16x32_bf16 v[128:131], a[88:91], a[112:115], v[128:131]
v_mfma_f32_16x16x32_bf16 v[136:139], a[88:91], a[116:119], v[136:139]
v_mfma_f32_16x16x32_bf16 v[144:147], a[88:91], a[120:123], v[144:147]
buffer_load_dwordx4 v6, s[8:11], s64 offen offset:1024 lds
v_mfma_f32_16x16x32_bf16 v[152:155], a[88:91], a[124:127], v[152:155]
v_mfma_f32_16x16x32_bf16 v[156:159], a[92:95], a[124:127], v[156:159]
v_add_u32 v9, -65536, v9
v_add_u32 v10, -65536, v10
v_mfma_f32_16x16x32_bf16 v[148:151], a[92:95], a[120:123], v[148:151]
v_mfma_f32_16x16x32_bf16 v[140:143], a[92:95], a[116:119], v[140:143]
v_mfma_f32_16x16x32_bf16 v[132:135], a[92:95], a[112:115], v[132:135]
v_mfma_f32_16x16x32_bf16 a[28:31], a[108:111], a[92:95], a[28:31]
v_mfma_f32_16x16x32_bf16 a[24:27], a[104:107], a[92:95], a[24:27]
v_mfma_f32_16x16x32_bf16 a[20:23], a[100:103], a[92:95], a[20:23]
v_mfma_f32_16x16x32_bf16 a[16:19], a[96:99], a[92:95], a[16:19]
s_waitcnt lgkmcnt(0)
v_mfma_f32_16x16x32_bf16 v[160:163], a[160:163], a[128:131], v[160:163]
s_waitcnt vmcnt(19)
v_mfma_f32_16x16x32_bf16 v[164:167], a[164:167], a[128:131], v[164:167]
s_barrier
v_mfma_f32_16x16x32_bf16 v[168:171], a[168:171], a[128:131], v[168:171]
ds_read_b128 a[64:67], v9 offset:0
v_mfma_f32_16x16x32_bf16 v[172:175], a[172:175], a[128:131], v[172:175]
s_add_u32 m0, s77, 49152
s_add_u32 s64, s76, 262144
v_mfma_f32_16x16x32_bf16 v[32:35], a[128:131], a[176:179], v[32:35]
buffer_load_dwordx4 v7, s[16:19], s64 offen lds
v_mfma_f32_16x16x32_bf16 v[40:43], a[128:131], a[180:183], v[40:43]
ds_read_b64_tr_b16 a[112:113], v11 offset:8192
ds_read_b64_tr_b16 a[114:115], v11 offset:8704
v_mfma_f32_16x16x32_bf16 v[48:51], a[128:131], a[184:187], v[48:51]
v_mfma_f32_16x16x32_bf16 v[56:59], a[128:131], a[188:191], v[56:59]
v_mfma_f32_16x16x32_bf16 v[60:63], a[132:135], a[188:191], v[60:63]
ds_read_b128 a[68:71], v9 offset:2048
v_mfma_f32_16x16x32_bf16 v[52:55], a[132:135], a[184:187], v[52:55]
v_mfma_f32_16x16x32_bf16 v[44:47], a[132:135], a[180:183], v[44:47]
v_mfma_f32_16x16x32_bf16 v[36:39], a[132:135], a[176:179], v[36:39]
buffer_load_dwordx4 v8, s[16:19], s64 offen offset:1024 lds
v_mfma_f32_16x16x32_bf16 v[188:191], a[172:175], a[132:135], v[188:191]
ds_read_b64_tr_b16 a[116:117], v12 offset:8192
ds_read_b64_tr_b16 a[118:119], v12 offset:8704
v_mfma_f32_16x16x32_bf16 v[184:187], a[168:171], a[132:135], v[184:187]
v_mfma_f32_16x16x32_bf16 v[180:183], a[164:167], a[132:135], v[180:183]
ds_read_b128 a[72:75], v9 offset:4096
v_mfma_f32_16x16x32_bf16 v[176:179], a[160:163], a[132:135], v[176:179]
v_mfma_f32_16x16x32_bf16 v[192:195], a[160:163], a[136:139], v[192:195]
s_add_u32 m0, s77, 51200
s_add_u32 s64, s76, 393216
v_mfma_f32_16x16x32_bf16 v[196:199], a[164:167], a[136:139], v[196:199]
ds_read_b64_tr_b16 a[120:121], v13 offset:8192
ds_read_b64_tr_b16 a[122:123], v13 offset:8704
v_mfma_f32_16x16x32_bf16 v[200:203], a[168:171], a[136:139], v[200:203]
buffer_load_dwordx4 v7, s[16:19], s64 offen lds
v_mfma_f32_16x16x32_bf16 v[204:207], a[172:175], a[136:139], v[204:207]
v_mfma_f32_16x16x32_bf16 v[64:67], a[136:139], a[176:179], v[64:67]
ds_read_b128 a[76:79], v9 offset:6144
v_mfma_f32_16x16x32_bf16 v[72:75], a[136:139], a[180:183], v[72:75]
v_mfma_f32_16x16x32_bf16 v[80:83], a[136:139], a[184:187], v[80:83]
v_mfma_f32_16x16x32_bf16 v[88:91], a[136:139], a[188:191], v[88:91]
ds_read_b64_tr_b16 a[124:125], v14 offset:8192
ds_read_b64_tr_b16 a[126:127], v14 offset:8704
v_mfma_f32_16x16x32_bf16 v[92:95], a[140:143], a[188:191], v[92:95]
v_mfma_f32_16x16x32_bf16 v[84:87], a[140:143], a[184:187], v[84:87]
buffer_load_dwordx4 v8, s[16:19], s64 offen offset:1024 lds
v_mfma_f32_16x16x32_bf16 v[76:79], a[140:143], a[180:183], v[76:79]
s_lshl_b32 s70, s93, 7
s_mul_i32 s68, s66, 36864
s_mul_i32 s69, s67, 36864
v_mfma_f32_16x16x32_bf16 v[68:71], a[140:143], a[176:179], v[68:71]
v_lshrrev_b32 v31, 3, v1
v_lshl_add_u32 v5, v31, 7, v5
v_mfma_f32_16x16x32_bf16 v[220:223], a[172:175], a[140:143], v[220:223]
v_lshl_add_u32 v6, v31, 7, v6
v_add_u32 v6, 1024, v6
v_mfma_f32_16x16x32_bf16 v[216:219], a[168:171], a[140:143], v[216:219]
s_xor_b32 s65, s70, 0
s_add_u32 s71, s68, s65
s_add_u32 s72, s69, s65
v_mfma_f32_16x16x32_bf16 v[212:215], a[164:167], a[140:143], v[212:215]
ds_read_b128 a[80:83], v9 offset:8192
v_mfma_f32_16x16x32_bf16 v[208:211], a[160:163], a[140:143], v[208:211]
s_add_u32 m0, s73, 65536
s_add_u32 s64, s71, 0
v_mfma_f32_16x16x32_bf16 v[224:227], a[160:163], a[144:147], v[224:227]
ds_read_b64_tr_b16 a[96:97], v11 offset:0
ds_read_b64_tr_b16 a[98:99], v11 offset:512
v_mfma_f32_16x16x32_bf16 v[228:231], a[164:167], a[144:147], v[228:231]
buffer_load_dwordx4 v5, s[12:15], s64 offen lds
v_mfma_f32_16x16x32_bf16 v[232:235], a[168:171], a[144:147], v[232:235]
ds_read_b128 a[84:87], v9 offset:10240
v_mfma_f32_16x16x32_bf16 v[236:239], a[172:175], a[144:147], v[236:239]
ds_read_b64_tr_b16 a[100:101], v12 offset:0
ds_read_b64_tr_b16 a[102:103], v12 offset:512
v_mfma_f32_16x16x32_bf16 v[96:99], a[144:147], a[176:179], v[96:99]
v_mfma_f32_16x16x32_bf16 v[104:107], a[144:147], a[180:183], v[104:107]
v_mfma_f32_16x16x32_bf16 v[112:115], a[144:147], a[184:187], v[112:115]
ds_read_b128 a[88:91], v9 offset:12288
v_mfma_f32_16x16x32_bf16 v[120:123], a[144:147], a[188:191], v[120:123]
v_mfma_f32_16x16x32_bf16 v[124:127], a[148:151], a[188:191], v[124:127]
buffer_load_dwordx4 v6, s[12:15], s64 offen offset:1024 lds
v_mfma_f32_16x16x32_bf16 v[116:119], a[148:151], a[184:187], v[116:119]
ds_read_b64_tr_b16 a[104:105], v13 offset:0
ds_read_b64_tr_b16 a[106:107], v13 offset:512
v_mfma_f32_16x16x32_bf16 v[108:111], a[148:151], a[180:183], v[108:111]
v_mfma_f32_16x16x32_bf16 v[100:103], a[148:151], a[176:179], v[100:103]
v_mfma_f32_16x16x32_bf16 v[252:255], a[172:175], a[148:151], v[252:255]
ds_read_b128 a[92:95], v9 offset:14336
v_mfma_f32_16x16x32_bf16 v[248:251], a[168:171], a[148:151], v[248:251]
s_add_u32 m0, s73, 67584
s_add_u32 s64, s71, 18432
v_mfma_f32_16x16x32_bf16 v[244:247], a[164:167], a[148:151], v[244:247]
v_mfma_f32_16x16x32_bf16 v[240:243], a[160:163], a[148:151], v[240:243]
buffer_load_dwordx4 v5, s[12:15], s64 offen lds
v_mfma_f32_16x16x32_bf16 a[0:3], a[160:163], a[152:155], a[0:3]
ds_read_b64_tr_b16 a[108:109], v14 offset:0
ds_read_b64_tr_b16 a[110:111], v14 offset:512
v_mfma_f32_16x16x32_bf16 a[4:7], a[164:167], a[152:155], a[4:7]
v_mfma_f32_16x16x32_bf16 a[8:11], a[168:171], a[152:155], a[8:11]
s_waitcnt vmcnt(9)
v_mfma_f32_16x16x32_bf16 a[12:15], a[172:175], a[152:155], a[12:15]
v_cmp_gt_u32 vcc, 18, v30
v_mfma_f32_16x16x32_bf16 v[128:131], a[152:155], a[176:179], v[128:131]
v_mfma_f32_16x16x32_bf16 v[136:139], a[152:155], a[180:183], v[136:139]
v_mfma_f32_16x16x32_bf16 v[144:147], a[152:155], a[184:187], v[144:147]
buffer_load_dwordx4 v6, s[12:15], s64 offen offset:1024 lds
v_mfma_f32_16x16x32_bf16 v[152:155], a[152:155], a[188:191], v[152:155]
v_mfma_f32_16x16x32_bf16 v[156:159], a[156:159], a[188:191], v[156:159]
s_cbranch_vccnz CK_WA
CK_WA_R:
v_mfma_f32_16x16x32_bf16 v[148:151], a[156:159], a[184:187], v[148:151]
v_mfma_f32_16x16x32_bf16 v[140:143], a[156:159], a[180:183], v[140:143]
v_mfma_f32_16x16x32_bf16 v[132:135], a[156:159], a[176:179], v[132:135]
v_mfma_f32_16x16x32_bf16 a[28:31], a[172:175], a[156:159], a[28:31]
v_mfma_f32_16x16x32_bf16 a[24:27], a[168:171], a[156:159], a[24:27]
v_mfma_f32_16x16x32_bf16 a[20:23], a[164:167], a[156:159], a[20:23]
v_mfma_f32_16x16x32_bf16 a[16:19], a[160:163], a[156:159], a[16:19]
s_waitcnt lgkmcnt(0)
v_mfma_f32_16x16x32_bf16 v[160:163], a[96:99], a[64:67], v[160:163]
s_waitcnt vmcnt(22)
v_mfma_f32_16x16x32_bf16 v[164:167], a[100:103], a[64:67], v[164:167]
s_barrier
v_mfma_f32_16x16x32_bf16 v[168:171], a[104:107], a[64:67], v[168:171]
ds_read_b128 a[128:131], v10 offset:0
v_mfma_f32_16x16x32_bf16 v[172:175], a[108:111], a[64:67], v[172:175]
s_lshr_b32 s65, s3, 1
s_lshl_b32 s75, s65, 17
s_add_u32 s74, s74, s75
v_mfma_f32_16x16x32_bf16 v[32:35], a[64:67], a[112:115], v[32:35]
s_lshl_b32 s65, s65, 11
s_and_b32 s77, s77, 4096
s_add_u32 s77, s77, s65
v_mfma_f32_16x16x32_bf16 v[40:43], a[64:67], a[116:119], v[40:43]
s_xor_b32 s75, s93, 0
s_lshl_b32 s76, s75, 19
s_add_u32 s76, s76, s74
v_mfma_f32_16x16x32_bf16 v[48:51], a[64:67], a[120:123], v[48:51]
s_mul_i32 s79, s75, 8192
s_add_u32 s79, s79, s78
v_mfma_f32_16x16x32_bf16 v[56:59], a[64:67], a[124:127], v[56:59]
s_add_u32 m0, s77, 0
s_add_u32 s64, s76, 0
v_mfma_f32_16x16x32_bf16 v[60:63], a[68:71], a[124:127], v[60:63]
buffer_load_dwordx4 v7, s[20:23], s64 offen lds
v_mfma_f32_16x16x32_bf16 v[52:55], a[68:71], a[120:123], v[52:55]
ds_read_b64_tr_b16 a[176:177], v11 offset:24576
ds_read_b64_tr_b16 a[178:179], v11 offset:25088
v_mfma_f32_16x16x32_bf16 v[44:47], a[68:71], a[116:119], v[44:47]
ds_read_b128 a[132:135], v10 offset:2048
v_mfma_f32_16x16x32_bf16 v[36:39], a[68:71], a[112:115], v[36:39]
ds_read_b64_tr_b16 a[180:181], v12 offset:24576
ds_read_b64_tr_b16 a[182:183], v12 offset:25088
v_mfma_f32_16x16x32_bf16 v[188:191], a[108:111], a[68:71], v[188:191]
buffer_load_dwordx4 v8, s[20:23], s64 offen offset:1024 lds
v_mfma_f32_16x16x32_bf16 v[184:187], a[104:107], a[68:71], v[184:187]
buffer_load_dword a252, v16, s[32:35], s52 offen
v_mfma_f32_16x16x32_bf16 v[180:183], a[100:103], a[68:71], v[180:183]
ds_read_b128 a[136:139], v10 offset:4096
v_mfma_f32_16x16x32_bf16 v[176:179], a[96:99], a[68:71], v[176:179]
buffer_load_dword a253, v18, s[48:51], s53 offen
v_mfma_f32_16x16x32_bf16 v[192:195], a[96:99], a[72:75], v[192:195]
v_and_b32 v18, 1, v1
v_lshlrev_b32 v18, 21, v18
v_mfma_f32_16x16x32_bf16 v[196:199], a[100:103], a[72:75], v[196:199]
ds_read_b64_tr_b16 a[184:185], v13 offset:24576
ds_read_b64_tr_b16 a[186:187], v13 offset:25088
v_mfma_f32_16x16x32_bf16 v[200:203], a[104:107], a[72:75], v[200:203]
s_add_u32 m0, s80, 0
s_add_u32 s64, s79, 0
v_mfma_f32_16x16x32_bf16 v[204:207], a[108:111], a[72:75], v[204:207]
v_mfma_f32_16x16x32_bf16 v[64:67], a[72:75], a[112:115], v[64:67]
buffer_load_dwordx4 v4, s[24:27], s64 offen sc1 lds
v_mfma_f32_16x16x32_bf16 v[72:75], a[72:75], a[116:119], v[72:75]
ds_read_b128 a[140:143], v10 offset:6144
v_mfma_f32_16x16x32_bf16 v[80:83], a[72:75], a[120:123], v[80:83]
v_mfma_f32_16x16x32_bf16 v[88:91], a[72:75], a[124:127], v[88:91]
ds_read_b64_tr_b16 a[188:189], v14 offset:24576
ds_read_b64_tr_b16 a[190:191], v14 offset:25088
v_mfma_f32_16x16x32_bf16 v[92:95], a[76:79], a[124:127], v[92:95]
v_mfma_f32_16x16x32_bf16 v[84:87], a[76:79], a[120:123], v[84:87]
v_mfma_f32_16x16x32_bf16 v[76:79], a[76:79], a[116:119], v[76:79]
s_add_u32 m0, s73, 69632
s_add_u32 s64, s72, 0
ds_read_b128 a[144:147], v10 offset:8192
v_mfma_f32_16x16x32_bf16 v[68:71], a[76:79], a[112:115], v[68:71]
v_mfma_f32_16x16x32_bf16 v[220:223], a[108:111], a[76:79], v[220:223]
buffer_load_dwordx4 v5, s[12:15], s64 offen lds
v_mfma_f32_16x16x32_bf16 v[216:219], a[104:107], a[76:79], v[216:219]
ds_read_b64_tr_b16 a[160:161], v11 offset:16384
ds_read_b64_tr_b16 a[162:163], v11 offset:16896
v_mfma_f32_16x16x32_bf16 v[212:215], a[100:103], a[76:79], v[212:215]
v_mfma_f32_16x16x32_bf16 v[208:211], a[96:99], a[76:79], v[208:211]
v_mfma_f32_16x16x32_bf16 v[224:227], a[96:99], a[80:83], v[224:227]
ds_read_b128 a[148:151], v10 offset:10240
v_mfma_f32_16x16x32_bf16 v[228:231], a[100:103], a[80:83], v[228:231]
v_mfma_f32_16x16x32_bf16 v[232:235], a[104:107], a[80:83], v[232:235]
v_mfma_f32_16x16x32_bf16 v[236:239], a[108:111], a[80:83], v[236:239]
ds_read_b64_tr_b16 a[164:165], v12 offset:16384
ds_read_b64_tr_b16 a[166:167], v12 offset:16896
v_mfma_f32_16x16x32_bf16 v[96:99], a[80:83], a[112:115], v[96:99]
v_mfma_f32_16x16x32_bf16 v[104:107], a[80:83], a[116:119], v[104:107]
buffer_load_dwordx4 v6, s[12:15], s64 offen offset:1024 lds
v_mfma_f32_16x16x32_bf16 v[112:115], a[80:83], a[120:123], v[112:115]
ds_read_b128 a[152:155], v10 offset:12288
v_mfma_f32_16x16x32_bf16 v[120:123], a[80:83], a[124:127], v[120:123]
v_mfma_f32_16x16x32_bf16 v[124:127], a[84:87], a[124:127], v[124:127]
v_mfma_f32_16x16x32_bf16 v[116:119], a[84:87], a[120:123], v[116:119]
ds_read_b64_tr_b16 a[168:169], v13 offset:16384
ds_read_b64_tr_b16 a[170:171], v13 offset:16896
v_mfma_f32_16x16x32_bf16 v[108:111], a[84:87], a[116:119], v[108:111]
v_mfma_f32_16x16x32_bf16 v[100:103], a[84:87], a[112:115], v[100:103]
s_add_u32 m0, s73, 71680
s_add_u32 s64, s72, 18432
v_mfma_f32_16x16x32_bf16 v[252:255], a[108:111], a[84:87], v[252:255]
ds_read_b128 a[156:159], v10 offset:14336
v_mfma_f32_16x16x32_bf16 v[248:251], a[104:107], a[84:87], v[248:251]
buffer_load_dwordx4 v5, s[12:15], s64 offen lds
v_mfma_f32_16x16x32_bf16 v[244:247], a[100:103], a[84:87], v[244:247]
v_mfma_f32_16x16x32_bf16 v[240:243], a[96:99], a[84:87], v[240:243]
ds_read_b64_tr_b16 a[172:173], v14 offset:16384
ds_read_b64_tr_b16 a[174:175], v14 offset:16896
v_mfma_f32_16x16x32_bf16 a[0:3], a[96:99], a[88:91], a[0:3]
v_mfma_f32_16x16x32_bf16 a[4:7], a[100:103], a[88:91], a[4:7]
v_mfma_f32_16x16x32_bf16 a[8:11], a[104:107], a[88:91], a[8:11]
v_mfma_f32_16x16x32_bf16 a[12:15], a[108:111], a[88:91], a[12:15]
v_mfma_f32_16x16x32_bf16 v[128:131], a[88:91], a[112:115], v[128:131]
v_mfma_f32_16x16x32_bf16 v[136:139], a[88:91], a[116:119], v[136:139]
buffer_load_dwordx4 v6, s[12:15], s64 offen offset:1024 lds
v_mfma_f32_16x16x32_bf16 v[144:147], a[88:91], a[120:123], v[144:147]
v_mfma_f32_16x16x32_bf16 v[152:155], a[88:91], a[124:127], v[152:155]
v_mfma_f32_16x16x32_bf16 v[156:159], a[92:95], a[124:127], v[156:159]
v_add_u32 v9, 32768, v9
v_add_u32 v10, 32768, v10
v_mfma_f32_16x16x32_bf16 v[148:151], a[92:95], a[120:123], v[148:151]
v_mfma_f32_16x16x32_bf16 v[140:143], a[92:95], a[116:119], v[140:143]
v_mfma_f32_16x16x32_bf16 v[132:135], a[92:95], a[112:115], v[132:135]
v_mfma_f32_16x16x32_bf16 a[28:31], a[108:111], a[92:95], a[28:31]
v_mfma_f32_16x16x32_bf16 a[24:27], a[104:107], a[92:95], a[24:27]
v_mfma_f32_16x16x32_bf16 a[20:23], a[100:103], a[92:95], a[20:23]
v_mfma_f32_16x16x32_bf16 a[16:19], a[96:99], a[92:95], a[16:19]
s_waitcnt lgkmcnt(0)
v_mfma_f32_16x16x32_bf16 v[160:163], a[160:163], a[128:131], v[160:163]
s_waitcnt vmcnt(17)
v_mfma_f32_16x16x32_bf16 v[164:167], a[164:167], a[128:131], v[164:167]
s_barrier
v_mfma_f32_16x16x32_bf16 v[168:171], a[168:171], a[128:131], v[168:171]
ds_read_b128 a[64:67], v9 offset:0
v_mfma_f32_16x16x32_bf16 v[172:175], a[172:175], a[128:131], v[172:175]
s_add_u32 m0, s77, 16384
s_add_u32 s64, s76, 262144
v_mfma_f32_16x16x32_bf16 v[32:35], a[128:131], a[176:179], v[32:35]
buffer_load_dwordx4 v7, s[20:23], s64 offen lds
v_mfma_f32_16x16x32_bf16 v[40:43], a[128:131], a[180:183], v[40:43]
ds_read_b64_tr_b16 a[112:113], v11 offset:40960
ds_read_b64_tr_b16 a[114:115], v11 offset:41472
v_mfma_f32_16x16x32_bf16 v[48:51], a[128:131], a[184:187], v[48:51]
buffer_load_dword a253, v18, s[44:47], 0 offen
v_mfma_f32_16x16x32_bf16 v[56:59], a[128:131], a[188:191], v[56:59]
v_mfma_f32_16x16x32_bf16 v[60:63], a[132:135], a[188:191], v[60:63]
ds_read_b128 a[68:71], v9 offset:2048
v_mfma_f32_16x16x32_bf16 v[52:55], a[132:135], a[184:187], v[52:55]
v_mfma_f32_16x16x32_bf16 v[44:47], a[132:135], a[180:183], v[44:47]
v_mfma_f32_16x16x32_bf16 v[36:39], a[132:135], a[176:179], v[36:39]
ds_read_b64_tr_b16 a[116:117], v12 offset:40960
ds_read_b64_tr_b16 a[118:119], v12 offset:41472
v_mfma_f32_16x16x32_bf16 v[188:191], a[172:175], a[132:135], v[188:191]
buffer_load_dwordx4 v8, s[20:23], s64 offen offset:1024 lds
v_mfma_f32_16x16x32_bf16 v[184:187], a[168:171], a[132:135], v[184:187]
v_mfma_f32_16x16x32_bf16 v[180:183], a[164:167], a[132:135], v[180:183]
ds_read_b128 a[72:75], v9 offset:4096
v_mfma_f32_16x16x32_bf16 v[176:179], a[160:163], a[132:135], v[176:179]
v_mfma_f32_16x16x32_bf16 v[192:195], a[160:163], a[136:139], v[192:195]
v_mfma_f32_16x16x32_bf16 v[196:199], a[164:167], a[136:139], v[196:199]
ds_read_b64_tr_b16 a[120:121], v13 offset:40960
ds_read_b64_tr_b16 a[122:123], v13 offset:41472
v_mfma_f32_16x16x32_bf16 v[200:203], a[168:171], a[136:139], v[200:203]
s_add_u32 m0, s80, 16384
s_add_u32 s64, s79, 4096
v_mfma_f32_16x16x32_bf16 v[204:207], a[172:175], a[136:139], v[204:207]
v_mfma_f32_16x16x32_bf16 v[64:67], a[136:139], a[176:179], v[64:67]
buffer_load_dwordx4 v4, s[24:27], s64 offen sc1 lds
v_mfma_f32_16x16x32_bf16 v[72:75], a[136:139], a[180:183], v[72:75]
s_xor_b32 s65, s70, 128
s_add_u32 s71, s68, s65
s_add_u32 s72, s69, s65
v_mfma_f32_16x16x32_bf16 v[80:83], a[136:139], a[184:187], v[80:83]
ds_read_b128 a[76:79], v9 offset:6144
v_mfma_f32_16x16x32_bf16 v[88:91], a[136:139], a[188:191], v[88:91]
ds_read_b64_tr_b16 a[124:125], v14 offset:40960
ds_read_b64_tr_b16 a[126:127], v14 offset:41472
v_mfma_f32_16x16x32_bf16 v[92:95], a[140:143], a[188:191], v[92:95]
v_mfma_f32_16x16x32_bf16 v[84:87], a[140:143], a[184:187], v[84:87]
v_mfma_f32_16x16x32_bf16 v[76:79], a[140:143], a[180:183], v[76:79]
s_add_u32 m0, s73, 0
s_add_u32 s64, s71, 0
ds_read_b128 a[80:83], v9 offset:8192
v_mfma_f32_16x16x32_bf16 v[68:71], a[140:143], a[176:179], v[68:71]
v_mfma_f32_16x16x32_bf16 v[220:223], a[172:175], a[140:143], v[220:223]
buffer_load_dwordx4 v5, s[12:15], s64 offen lds
v_mfma_f32_16x16x32_bf16 v[216:219], a[168:171], a[140:143], v[216:219]
ds_read_b64_tr_b16 a[96:97], v11 offset:32768
ds_read_b64_tr_b16 a[98:99], v11 offset:33280
v_mfma_f32_16x16x32_bf16 v[212:215], a[164:167], a[140:143], v[212:215]
v_mfma_f32_16x16x32_bf16 v[208:211], a[160:163], a[140:143], v[208:211]
v_mfma_f32_16x16x32_bf16 v[224:227], a[160:163], a[144:147], v[224:227]
ds_read_b128 a[84:87], v9 offset:10240
v_mfma_f32_16x16x32_bf16 v[228:231], a[164:167], a[144:147], v[228:231]
v_mfma_f32_16x16x32_bf16 v[232:235], a[168:171], a[144:147], v[232:235]
v_mfma_f32_16x16x32_bf16 v[236:239], a[172:175], a[144:147], v[236:239]
ds_read_b64_tr_b16 a[100:101], v12 offset:32768
ds_read_b64_tr_b16 a[102:103], v12 offset:33280
v_mfma_f32_16x16x32_bf16 v[96:99], a[144:147], a[176:179], v[96:99]
v_mfma_f32_16x16x32_bf16 v[104:107], a[144:147], a[180:183], v[104:107]
buffer_load_dwordx4 v6, s[12:15], s64 offen offset:1024 lds
v_mfma_f32_16x16x32_bf16 v[112:115], a[144:147], a[184:187], v[112:115]
ds_read_b128 a[88:91], v9 offset:12288
v_mfma_f32_16x16x32_bf16 v[120:123], a[144:147], a[188:191], v[120:123]
v_mfma_f32_16x16x32_bf16 v[124:127], a[148:151], a[188:191], v[124:127]
v_mfma_f32_16x16x32_bf16 v[116:119], a[148:151], a[184:187], v[116:119]
ds_read_b64_tr_b16 a[104:105], v13 offset:32768
ds_read_b64_tr_b16 a[106:107], v13 offset:33280
v_mfma_f32_16x16x32_bf16 v[108:111], a[148:151], a[180:183], v[108:111]
v_mfma_f32_16x16x32_bf16 v[100:103], a[148:151], a[176:179], v[100:103]
s_add_u32 m0, s73, 2048
s_add_u32 s64, s71, 18432
v_mfma_f32_16x16x32_bf16 v[252:255], a[172:175], a[148:151], v[252:255]
ds_read_b128 a[92:95], v9 offset:14336
v_mfma_f32_16x16x32_bf16 v[248:251], a[168:171], a[148:151], v[248:251]
buffer_load_dwordx4 v5, s[12:15], s64 offen lds
v_mfma_f32_16x16x32_bf16 v[244:247], a[164:167], a[148:151], v[244:247]
v_mfma_f32_16x16x32_bf16 v[240:243], a[160:163], a[148:151], v[240:243]
ds_read_b64_tr_b16 a[108:109], v14 offset:32768
ds_read_b64_tr_b16 a[110:111], v14 offset:33280
v_mfma_f32_16x16x32_bf16 a[0:3], a[160:163], a[152:155], a[0:3]
v_mfma_f32_16x16x32_bf16 a[4:7], a[164:167], a[152:155], a[4:7]
v_mfma_f32_16x16x32_bf16 a[8:11], a[168:171], a[152:155], a[8:11]
v_mfma_f32_16x16x32_bf16 a[12:15], a[172:175], a[152:155], a[12:15]
v_mfma_f32_16x16x32_bf16 v[128:131], a[152:155], a[176:179], v[128:131]
v_mfma_f32_16x16x32_bf16 v[136:139], a[152:155], a[180:183], v[136:139]
buffer_load_dwordx4 v6, s[12:15], s64 offen offset:1024 lds
v_mfma_f32_16x16x32_bf16 v[144:147], a[152:155], a[184:187], v[144:147]
v_mfma_f32_16x16x32_bf16 v[152:155], a[152:155], a[188:191], v[152:155]
v_mfma_f32_16x16x32_bf16 v[156:159], a[156:159], a[188:191], v[156:159]
v_mfma_f32_16x16x32_bf16 v[148:151], a[156:159], a[184:187], v[148:151]
v_mfma_f32_16x16x32_bf16 v[140:143], a[156:159], a[180:183], v[140:143]
v_mfma_f32_16x16x32_bf16 v[132:135], a[156:159], a[176:179], v[132:135]
v_mfma_f32_16x16x32_bf16 a[28:31], a[172:175], a[156:159], a[28:31]
v_mfma_f32_16x16x32_bf16 a[24:27], a[168:171], a[156:159], a[24:27]
v_mfma_f32_16x16x32_bf16 a[20:23], a[164:167], a[156:159], a[20:23]
v_mfma_f32_16x16x32_bf16 a[16:19], a[160:163], a[156:159], a[16:19]
s_waitcnt lgkmcnt(0)
v_mfma_f32_16x16x32_bf16 v[32:35], a[64:67], a[112:115], v[32:35]
s_waitcnt vmcnt(21)
v_mfma_f32_16x16x32_bf16 v[36:39], a[68:71], a[112:115], v[36:39]
s_barrier
v_mfma_f32_16x16x32_bf16 v[40:43], a[64:67], a[116:119], v[40:43]
ds_read_b128 a[128:131], v10 offset:0
ds_read_b128 a[132:135], v10 offset:2048
v_mfma_f32_16x16x32_bf16 v[44:47], a[68:71], a[116:119], v[44:47]
ds_read_b128 a[136:139], v10 offset:4096
ds_read_b128 a[140:143], v10 offset:6144
v_mfma_f32_16x16x32_bf16 v[48:51], a[64:67], a[120:123], v[48:51]
ds_read_b128 a[144:147], v10 offset:8192
ds_read_b128 a[148:151], v10 offset:10240
v_mfma_f32_16x16x32_bf16 v[52:55], a[68:71], a[120:123], v[52:55]
ds_read_b128 a[152:155], v10 offset:12288
ds_read_b128 a[156:159], v10 offset:14336
v_mfma_f32_16x16x32_bf16 v[56:59], a[64:67], a[124:127], v[56:59]
ds_read_b64_tr_b16 a[176:177], v11 offset:57344
ds_read_b64_tr_b16 a[178:179], v11 offset:57856
v_mfma_f32_16x16x32_bf16 v[60:63], a[68:71], a[124:127], v[60:63]
ds_read_b64_tr_b16 a[180:181], v12 offset:57344
ds_read_b64_tr_b16 a[182:183], v12 offset:57856
v_mfma_f32_16x16x32_bf16 v[64:67], a[72:75], a[112:115], v[64:67]
ds_read_b64_tr_b16 a[184:185], v13 offset:57344
ds_read_b64_tr_b16 a[186:187], v13 offset:57856
v_mfma_f32_16x16x32_bf16 v[68:71], a[76:79], a[112:115], v[68:71]
ds_read_b64_tr_b16 a[188:189], v14 offset:57344
ds_read_b64_tr_b16 a[190:191], v14 offset:57856
v_mfma_f32_16x16x32_bf16 v[72:75], a[72:75], a[116:119], v[72:75]
ds_read_b64_tr_b16 a[160:161], v11 offset:49152
ds_read_b64_tr_b16 a[162:163], v11 offset:49664
v_mfma_f32_16x16x32_bf16 v[76:79], a[76:79], a[116:119], v[76:79]
ds_read_b64_tr_b16 a[164:165], v12 offset:49152
ds_read_b64_tr_b16 a[166:167], v12 offset:49664
v_mfma_f32_16x16x32_bf16 v[80:83], a[72:75], a[120:123], v[80:83]
ds_read_b64_tr_b16 a[168:169], v13 offset:49152
ds_read_b64_tr_b16 a[170:171], v13 offset:49664
v_mfma_f32_16x16x32_bf16 v[84:87], a[76:79], a[120:123], v[84:87]
ds_read_b64_tr_b16 a[172:173], v14 offset:49152
ds_read_b64_tr_b16 a[174:175], v14 offset:49664
v_mfma_f32_16x16x32_bf16 v[88:91], a[72:75], a[124:127], v[88:91]
v_mfma_f32_16x16x32_bf16 v[92:95], a[76:79], a[124:127], v[92:95]
s_xor_b32 s75, s93, 1
s_lshl_b32 s76, s75, 19
s_add_u32 s76, s76, s74
v_mfma_f32_16x16x32_bf16 v[96:99], a[80:83], a[112:115], v[96:99]
s_mul_i32 s79, s75, 8192
s_add_u32 s79, s79, s78
v_mfma_f32_16x16x32_bf16 v[100:103], a[84:87], a[112:115], v[100:103]
s_add_u32 m0, s77, 32768
s_add_u32 s64, s76, 0
v_mfma_f32_16x16x32_bf16 v[104:107], a[80:83], a[116:119], v[104:107]
buffer_load_dwordx4 v7, s[20:23], s64 offen lds
v_mfma_f32_16x16x32_bf16 v[108:111], a[84:87], a[116:119], v[108:111]
v_mfma_f32_16x16x32_bf16 v[112:115], a[80:83], a[120:123], v[112:115]
v_mfma_f32_16x16x32_bf16 v[116:119], a[84:87], a[120:123], v[116:119]
v_mfma_f32_16x16x32_bf16 v[120:123], a[80:83], a[124:127], v[120:123]
buffer_load_dwordx4 v8, s[20:23], s64 offen offset:1024 lds
v_mfma_f32_16x16x32_bf16 v[124:127], a[84:87], a[124:127], v[124:127]
v_mfma_f32_16x16x32_bf16 v[128:131], a[88:91], a[112:115], v[128:131]
v_mfma_f32_16x16x32_bf16 v[132:135], a[92:95], a[112:115], v[132:135]
v_add_u32 v9, 32768, v9
v_add_u32 v10, 32768, v10
v_mfma_f32_16x16x32_bf16 v[136:139], a[88:91], a[116:119], v[136:139]
s_lshr_b32 s55, s3, 1
s_lshl_b32 s55, s55, 14
s_lshl_b32 s54, s3, 13
v_mfma_f32_16x16x32_bf16 v[140:143], a[92:95], a[116:119], v[140:143]
s_add_u32 m0, s80, 32768
s_add_u32 s64, s79, 0
s_sub_u32 s55, s54, s55
v_mfma_f32_16x16x32_bf16 v[144:147], a[88:91], a[120:123], v[144:147]
s_and_b32 s54, s3, 1
s_lshl_b32 s54, s54, 12
v_mfma_f32_16x16x32_bf16 v[148:151], a[92:95], a[120:123], v[148:151]
buffer_load_dwordx4 v4, s[24:27], s64 offen sc1 lds
v_mfma_f32_16x16x32_bf16 v[152:155], a[88:91], a[124:127], v[152:155]
v_add_u32 v9, s55, v9
v_add_u32 v10, s55, v10
v_mfma_f32_16x16x32_bf16 v[156:159], a[92:95], a[124:127], v[156:159]
s_waitcnt lgkmcnt(0)
v_subrev_u32 v11, s54, v11
v_subrev_u32 v12, s54, v12
v_mfma_f32_16x16x32_bf16 v[32:35], a[128:131], a[176:179], v[32:35]
v_subrev_u32 v13, s54, v13
v_subrev_u32 v14, s54, v14
v_mfma_f32_16x16x32_bf16 v[36:39], a[132:135], a[176:179], v[36:39]
s_add_u32 m0, s73, 4096
s_add_u32 s64, s72, 0
v_mfma_f32_16x16x32_bf16 v[40:43], a[128:131], a[180:183], v[40:43]
v_mfma_f32_16x16x32_bf16 v[44:47], a[132:135], a[180:183], v[44:47]
buffer_load_dwordx4 v5, s[12:15], s64 offen lds
v_mfma_f32_16x16x32_bf16 v[48:51], a[128:131], a[184:187], v[48:51]
v_mfma_f32_16x16x32_bf16 v[52:55], a[132:135], a[184:187], v[52:55]
v_mfma_f32_16x16x32_bf16 v[56:59], a[128:131], a[188:191], v[56:59]
v_mfma_f32_16x16x32_bf16 v[60:63], a[132:135], a[188:191], v[60:63]
v_mfma_f32_16x16x32_bf16 v[64:67], a[136:139], a[176:179], v[64:67]
v_cvt_pk_bf16_f32 v32, v32, v33
v_cvt_pk_bf16_f32 v33, v34, v35
v_mfma_f32_16x16x32_bf16 v[68:71], a[140:143], a[176:179], v[68:71]
v_cvt_pk_bf16_f32 v34, v36, v37
v_cvt_pk_bf16_f32 v35, v38, v39
v_mfma_f32_16x16x32_bf16 v[72:75], a[136:139], a[180:183], v[72:75]
buffer_load_dwordx4 v6, s[12:15], s64 offen offset:1024 lds
v_mfma_f32_16x16x32_bf16 v[76:79], a[140:143], a[180:183], v[76:79]
v_cvt_pk_bf16_f32 v40, v40, v41
v_cvt_pk_bf16_f32 v41, v42, v43
v_mfma_f32_16x16x32_bf16 v[80:83], a[136:139], a[184:187], v[80:83]
v_cvt_pk_bf16_f32 v42, v44, v45
v_cvt_pk_bf16_f32 v43, v46, v47
v_mfma_f32_16x16x32_bf16 v[84:87], a[140:143], a[184:187], v[84:87]
v_cvt_pk_bf16_f32 v48, v48, v49
v_cvt_pk_bf16_f32 v49, v50, v51
v_mfma_f32_16x16x32_bf16 v[88:91], a[136:139], a[188:191], v[88:91]
s_add_u32 m0, s73, 6144
s_add_u32 s64, s72, 18432
s_add_u32 s53, s88, 0
v_mfma_f32_16x16x32_bf16 v[92:95], a[140:143], a[188:191], v[92:95]
buffer_store_dwordx4 v[32:35], v4, s[24:27], s53 offen offset:0 sc1
v_mfma_f32_16x16x32_bf16 v[96:99], a[144:147], a[176:179], v[96:99]
buffer_load_dwordx4 v5, s[12:15], s64 offen lds
v_mfma_f32_16x16x32_bf16 v[100:103], a[148:151], a[176:179], v[100:103]
v_cvt_pk_bf16_f32 v50, v52, v53
v_cvt_pk_bf16_f32 v51, v54, v55
v_mfma_f32_16x16x32_bf16 v[104:107], a[144:147], a[180:183], v[104:107]
v_cvt_pk_bf16_f32 v56, v56, v57
v_cvt_pk_bf16_f32 v57, v58, v59
v_mfma_f32_16x16x32_bf16 v[108:111], a[148:151], a[180:183], v[108:111]
v_cvt_pk_bf16_f32 v58, v60, v61
v_cvt_pk_bf16_f32 v59, v62, v63
v_mfma_f32_16x16x32_bf16 v[112:115], a[144:147], a[184:187], v[112:115]
v_cvt_pk_bf16_f32 v64, v64, v65
v_cvt_pk_bf16_f32 v65, v66, v67
v_mfma_f32_16x16x32_bf16 v[116:119], a[148:151], a[184:187], v[116:119]
v_cvt_pk_bf16_f32 v66, v68, v69
v_cvt_pk_bf16_f32 v67, v70, v71
v_mfma_f32_16x16x32_bf16 v[120:123], a[144:147], a[188:191], v[120:123]
v_cvt_pk_bf16_f32 v72, v72, v73
v_cvt_pk_bf16_f32 v73, v74, v75
v_mfma_f32_16x16x32_bf16 v[124:127], a[148:151], a[188:191], v[124:127]
buffer_load_dwordx4 v6, s[12:15], s64 offen offset:1024 lds
v_mfma_f32_16x16x32_bf16 v[128:131], a[152:155], a[176:179], v[128:131]
v_cvt_pk_bf16_f32 v74, v76, v77
v_cvt_pk_bf16_f32 v75, v78, v79
v_mfma_f32_16x16x32_bf16 v[132:135], a[156:159], a[176:179], v[132:135]
v_cvt_pk_bf16_f32 v80, v80, v81
v_cvt_pk_bf16_f32 v81, v82, v83
v_mfma_f32_16x16x32_bf16 v[136:139], a[152:155], a[180:183], v[136:139]
v_cvt_pk_bf16_f32 v82, v84, v85
v_cvt_pk_bf16_f32 v83, v86, v87
v_mfma_f32_16x16x32_bf16 v[140:143], a[156:159], a[180:183], v[140:143]
v_cvt_pk_bf16_f32 v88, v88, v89
v_cvt_pk_bf16_f32 v89, v90, v91
v_mfma_f32_16x16x32_bf16 v[144:147], a[152:155], a[184:187], v[144:147]
v_cvt_pk_bf16_f32 v90, v92, v93
v_cvt_pk_bf16_f32 v91, v94, v95
v_mfma_f32_16x16x32_bf16 v[148:151], a[156:159], a[184:187], v[148:151]
L_PAD3:
s_cbranch_execz L_PAD7
v_cvt_pk_bf16_f32 v96, v96, v97
v_cvt_pk_bf16_f32 v97, v98, v99
v_mfma_f32_16x16x32_bf16 v[152:155], a[152:155], a[188:191], v[152:155]
v_cvt_pk_bf16_f32 v98, v100, v101
v_cvt_pk_bf16_f32 v99, v102, v103
v_mfma_f32_16x16x32_bf16 v[156:159], a[156:159], a[188:191], v[156:159]
v_cvt_pk_bf16_f32 v104, v104, v105
v_cvt_pk_bf16_f32 v105, v106, v107
v_mfma_f32_16x16x32_bf16 v[160:163], a[96:99], a[64:67], v[160:163]
s_waitcnt vmcnt(16)
v_cvt_pk_bf16_f32 v106, v108, v109
v_cvt_pk_bf16_f32 v107, v110, v111
v_mfma_f32_16x16x32_bf16 v[160:163], a[160:163], a[128:131], v[160:163]
s_barrier
v_mfma_f32_16x16x32_bf16 v[164:167], a[100:103], a[64:67], v[164:167]
ds_read_b128 a[112:115], v9 offset:0
ds_read_b128 a[116:119], v9 offset:2048
v_mfma_f32_16x16x32_bf16 v[164:167], a[164:167], a[128:131], v[164:167]
s_add_u32 m0, s77, 49152
s_add_u32 s64, s76, 262144
v_cvt_pk_bf16_f32 v112, v112, v113
v_mfma_f32_16x16x32_bf16 v[168:171], a[104:107], a[64:67], v[168:171]
buffer_load_dwordx4 v7, s[20:23], s64 offen lds
v_mfma_f32_16x16x32_bf16 v[168:171], a[168:171], a[128:131], v[168:171]
ds_read_b128 a[120:123], v9 offset:4096
ds_read_b128 a[124:127], v9 offset:6144
v_mfma_f32_16x16x32_bf16 v[172:175], a[108:111], a[64:67], v[172:175]
v_cvt_pk_bf16_f32 v113, v114, v115
v_cvt_pk_bf16_f32 v114, v116, v117
v_mfma_f32_16x16x32_bf16 v[172:175], a[172:175], a[128:131], v[172:175]
ds_read_b64_tr_b16 a[176:177], v11 offset:0
ds_read_b64_tr_b16 a[178:179], v11 offset:512
v_mfma_f32_16x16x32_bf16 v[176:179], a[96:99], a[68:71], v[176:179]
v_cvt_pk_bf16_f32 v115, v118, v119
v_cvt_pk_bf16_f32 v120, v120, v121
v_mfma_f32_16x16x32_bf16 v[176:179], a[160:163], a[132:135], v[176:179]
s_add_u32 s53, s88, 0
ds_read_b64_tr_b16 a[180:181], v12 offset:0
ds_read_b64_tr_b16 a[182:183], v12 offset:512
v_mfma_f32_16x16x32_bf16 v[180:183], a[100:103], a[68:71], v[180:183]
buffer_store_dwordx4 v[40:43], v4, s[24:27], s53 offen offset:1024 sc1
v_mfma_f32_16x16x32_bf16 v[180:183], a[164:167], a[132:135], v[180:183]
ds_read_b64_tr_b16 a[184:185], v13 offset:0
ds_read_b64_tr_b16 a[186:187], v13 offset:512
v_mfma_f32_16x16x32_bf16 v[184:187], a[104:107], a[68:71], v[184:187]
buffer_load_dwordx4 v8, s[20:23], s64 offen offset:1024 lds
v_mfma_f32_16x16x32_bf16 v[184:187], a[168:171], a[132:135], v[184:187]
ds_read_b64_tr_b16 a[188:189], v14 offset:0
ds_read_b64_tr_b16 a[190:191], v14 offset:512
v_mfma_f32_16x16x32_bf16 v[188:191], a[108:111], a[68:71], v[188:191]
ds_read_b64_tr_b16 a[64:65], v11 offset:4096
ds_read_b64_tr_b16 a[66:67], v11 offset:4608
v_mfma_f32_16x16x32_bf16 v[188:191], a[172:175], a[132:135], v[188:191]
ds_read_b64_tr_b16 a[128:129], v12 offset:4096
ds_read_b64_tr_b16 a[130:131], v12 offset:4608
v_mfma_f32_16x16x32_bf16 v[192:195], a[96:99], a[72:75], v[192:195]
ds_read_b64_tr_b16 a[68:69], v13 offset:4096
ds_read_b64_tr_b16 a[70:71], v13 offset:4608
v_mfma_f32_16x16x32_bf16 v[192:195], a[160:163], a[136:139], v[192:195]
ds_read_b64_tr_b16 a[132:133], v14 offset:4096
ds_read_b64_tr_b16 a[134:135], v14 offset:4608
v_mfma_f32_16x16x32_bf16 v[196:199], a[100:103], a[72:75], v[196:199]
s_add_u32 m0, s80, 49152
s_add_u32 s64, s79, 4096
v_cvt_pk_bf16_f32 v121, v122, v123
v_mfma_f32_16x16x32_bf16 v[196:199], a[164:167], a[136:139], v[196:199]
v_cvt_pk_bf16_f32 v122, v124, v125
v_cvt_pk_bf16_f32 v123, v126, v127
v_mfma_f32_16x16x32_bf16 v[200:203], a[104:107], a[72:75], v[200:203]
buffer_load_dwordx4 v4, s[24:27], s64 offen sc1 lds
v_mfma_f32_16x16x32_bf16 v[200:203], a[168:171], a[136:139], v[200:203]
s_xor_b32 s65, s70, 256
s_add_u32 s71, s68, s65
s_add_u32 s72, s69, s65
v_mfma_f32_16x16x32_bf16 v[204:207], a[108:111], a[72:75], v[204:207]
v_cvt_pk_bf16_f32 v128, v128, v129
v_cvt_pk_bf16_f32 v129, v130, v131
v_mfma_f32_16x16x32_bf16 v[204:207], a[172:175], a[136:139], v[204:207]
v_cvt_pk_bf16_f32 v130, v132, v133
v_cvt_pk_bf16_f32 v131, v134, v135
v_mfma_f32_16x16x32_bf16 v[208:211], a[96:99], a[76:79], v[208:211]
ds_read_b128 a[72:75], v4 offset:8192
ds_read_b128 a[136:139], v4 offset:9216
v_mfma_f32_16x16x32_bf16 v[208:211], a[160:163], a[140:143], v[208:211]
v_cvt_pk_bf16_f32 v136, v136, v137
v_cvt_pk_bf16_f32 v137, v138, v139
v_mfma_f32_16x16x32_bf16 v[212:215], a[100:103], a[76:79], v[212:215]
s_add_u32 m0, s73, 32768
s_add_u32 s64, s71, 0
v_cvt_pk_bf16_f32 v138, v140, v141
v_mfma_f32_16x16x32_bf16 v[212:215], a[164:167], a[140:143], v[212:215]
v_cvt_pk_bf16_f32 v139, v142, v143
v_cvt_pk_bf16_f32 v144, v144, v145
v_mfma_f32_16x16x32_bf16 v[216:219], a[104:107], a[76:79], v[216:219]
buffer_load_dwordx4 v5, s[12:15], s64 offen lds
v_mfma_f32_16x16x32_bf16 v[216:219], a[168:171], a[140:143], v[216:219]
v_cvt_pk_bf16_f32 v145, v146, v147
v_cvt_pk_bf16_f32 v146, v148, v149
v_mfma_f32_16x16x32_bf16 v[220:223], a[108:111], a[76:79], v[220:223]
v_cvt_pk_bf16_f32 v147, v150, v151
v_cvt_pk_bf16_f32 v152, v152, v153
v_mfma_f32_16x16x32_bf16 v[220:223], a[172:175], a[140:143], v[220:223]
v_cvt_pk_bf16_f32 v153, v154, v155
v_cvt_pk_bf16_f32 v154, v156, v157
v_mfma_f32_16x16x32_bf16 v[224:227], a[96:99], a[80:83], v[224:227]
ds_read_b128 a[76:79], v4 offset:10240
ds_read_b128 a[140:143], v4 offset:11264
v_mfma_f32_16x16x32_bf16 v[224:227], a[160:163], a[144:147], v[224:227]
v_cvt_pk_bf16_f32 v155, v158, v159
v_mul_f32 v160, s91, v160
v_mfma_f32_16x16x32_bf16 v[228:231], a[100:103], a[80:83], v[228:231]
v_mul_f32 v161, s91, v161
v_mul_f32 v162, s91, v162
v_mfma_f32_16x16x32_bf16 v[228:231], a[164:167], a[144:147], v[228:231]
v_mul_f32 v163, s91, v163
v_mul_f32 v164, s91, v164
v_mfma_f32_16x16x32_bf16 v[232:235], a[104:107], a[80:83], v[232:235]
s_add_u32 s53, s88, 0
v_mul_f32 v165, s91, v165
v_mul_f32 v166, s91, v166
v_mfma_f32_16x16x32_bf16 v[232:235], a[168:171], a[144:147], v[232:235]
buffer_load_dwordx4 v6, s[12:15], s64 offen offset:1024 lds
v_mfma_f32_16x16x32_bf16 v[236:239], a[108:111], a[80:83], v[236:239]
buffer_store_dwordx4 v[48:51], v4, s[24:27], s53 offen offset:2048 sc1
v_mfma_f32_16x16x32_bf16 v[236:239], a[172:175], a[144:147], v[236:239]
v_mul_f32 v167, s91, v167
v_cvt_pk_bf16_f32 v160, v160, v161
v_mfma_f32_16x16x32_bf16 v[240:243], a[96:99], a[84:87], v[240:243]
v_cvt_pk_bf16_f32 v161, v162, v163
v_cvt_pk_bf16_f32 v162, v164, v165
v_mfma_f32_16x16x32_bf16 v[240:243], a[160:163], a[148:151], v[240:243]
v_cvt_pk_bf16_f32 v163, v166, v167
v_mul_f32 v168, s91, v168
v_mfma_f32_16x16x32_bf16 v[244:247], a[100:103], a[84:87], v[244:247]
v_mul_f32 v169, s91, v169
v_mul_f32 v170, s91, v170
v_mfma_f32_16x16x32_bf16 v[244:247], a[164:167], a[148:151], v[244:247]
s_add_u32 m0, s73, 34816
s_add_u32 s64, s71, 18432
v_mul_f32 v171, s91, v171
v_mfma_f32_16x16x32_bf16 v[248:251], a[104:107], a[84:87], v[248:251]
v_mul_f32 v172, s91, v172
v_mul_f32 v173, s91, v173
v_mfma_f32_16x16x32_bf16 v[248:251], a[168:171], a[148:151], v[248:251]
buffer_load_dwordx4 v5, s[12:15], s64 offen lds
v_mfma_f32_16x16x32_bf16 v[252:255], a[108:111], a[84:87], v[252:255]
v_mul_f32 v174, s91, v174
v_mul_f32 v175, s91, v175
v_mfma_f32_16x16x32_bf16 v[252:255], a[172:175], a[148:151], v[252:255]
v_cvt_pk_bf16_f32 v168, v168, v169
v_cvt_pk_bf16_f32 v169, v170, v171
v_mfma_f32_16x16x32_bf16 a[0:3], a[96:99], a[88:91], a[0:3]
v_cvt_pk_bf16_f32 v170, v172, v173
v_cvt_pk_bf16_f32 v171, v174, v175
v_mfma_f32_16x16x32_bf16 a[0:3], a[160:163], a[152:155], a[0:3]
v_mul_f32 v176, s91, v176
v_mul_f32 v177, s91, v177
v_mfma_f32_16x16x32_bf16 a[4:7], a[100:103], a[88:91], a[4:7]
v_mul_f32 v178, s91, v178
v_mul_f32 v179, s91, v179
v_mfma_f32_16x16x32_bf16 a[4:7], a[164:167], a[152:155], a[4:7]
v_mul_f32 v180, s91, v180
v_mul_f32 v181, s91, v181
v_mfma_f32_16x16x32_bf16 a[8:11], a[104:107], a[88:91], a[8:11]
v_mul_f32 v182, s91, v182
v_mul_f32 v183, s91, v183
v_mfma_f32_16x16x32_bf16 a[8:11], a[168:171], a[152:155], a[8:11]
buffer_load_dwordx4 v6, s[12:15], s64 offen offset:1024 lds
v_mfma_f32_16x16x32_bf16 a[12:15], a[108:111], a[88:91], a[12:15]
v_cvt_pk_bf16_f32 v176, v176, v177
v_cvt_pk_bf16_f32 v177, v178, v179
v_mfma_f32_16x16x32_bf16 a[12:15], a[172:175], a[152:155], a[12:15]
v_cvt_pk_bf16_f32 v178, v180, v181
v_cvt_pk_bf16_f32 v179, v182, v183
v_mfma_f32_16x16x32_bf16 a[16:19], a[96:99], a[92:95], a[16:19]
v_mul_f32 v184, s91, v184
v_mul_f32 v185, s91, v185
v_mfma_f32_16x16x32_bf16 a[16:19], a[160:163], a[156:159], a[16:19]
v_mul_f32 v186, s91, v186
v_mul_f32 v187, s91, v187
v_mfma_f32_16x16x32_bf16 a[20:23], a[100:103], a[92:95], a[20:23]
v_mul_f32 v188, s91, v188
v_mul_f32 v189, s91, v189
v_mfma_f32_16x16x32_bf16 a[20:23], a[164:167], a[156:159], a[20:23]
v_mul_f32 v190, s91, v190
v_mul_f32 v191, s91, v191
v_mfma_f32_16x16x32_bf16 a[24:27], a[104:107], a[92:95], a[24:27]
v_cvt_pk_bf16_f32 v184, v184, v185
v_cvt_pk_bf16_f32 v185, v186, v187
v_mfma_f32_16x16x32_bf16 a[24:27], a[168:171], a[156:159], a[24:27]
v_cvt_pk_bf16_f32 v186, v188, v189
v_cvt_pk_bf16_f32 v187, v190, v191
v_mfma_f32_16x16x32_bf16 a[28:31], a[108:111], a[92:95], a[28:31]
v_mul_f32 v192, s91, v192
v_mul_f32 v193, s91, v193
v_mfma_f32_16x16x32_bf16 a[28:31], a[172:175], a[156:159], a[28:31]
s_waitcnt lgkmcnt(0)
s_add_u32 s53, s88, 0
v_mul_f32 v194, s91, v194
v_mfma_f32_16x16x32_bf16 a[32:35], a[176:179], a[112:115], 0
s_waitcnt vmcnt(21)
v_mul_f32 v195, s91, v195
v_mul_f32 v196, s91, v196
v_mfma_f32_16x16x32_bf16 a[36:39], a[176:179], a[116:119], 0
s_barrier
v_mfma_f32_16x16x32_bf16 a[40:43], a[176:179], a[120:123], 0
ds_read_b128 a[96:99], v10 offset:0
v_mul_f32 v197, s91, v197
v_mfma_f32_16x16x32_bf16 a[44:47], a[176:179], a[124:127], 0
s_xor_b32 s75, s93, 2
s_lshl_b32 s76, s75, 19
s_add_u32 s76, s76, s74
v_mfma_f32_16x16x32_bf16 a[48:51], a[180:183], a[124:127], 0
s_mul_i32 s79, s75, 8192
s_add_u32 s79, s79, s78
v_mul_f32 v198, s91, v198
v_mfma_f32_16x16x32_bf16 a[52:55], a[180:183], a[120:123], 0
s_add_u32 m0, s77, 0
s_add_u32 s64, s76, 0
v_mul_f32 v199, s91, v199
v_mfma_f32_16x16x32_bf16 a[56:59], a[180:183], a[116:119], 0
buffer_load_dwordx4 v7, s[20:23], s64 offen lds
v_mfma_f32_16x16x32_bf16 a[60:63], a[180:183], a[112:115], 0
ds_read_b64_tr_b16 a[160:161], v11 offset:16384
ds_read_b64_tr_b16 a[162:163], v11 offset:16896
v_mfma_f32_16x16x32_bf16 a[192:195], a[184:187], a[112:115], 0
ds_read_b128 a[100:103], v10 offset:2048
v_cvt_pk_bf16_f32 v192, v192, v193
v_mfma_f32_16x16x32_bf16 a[196:199], a[184:187], a[116:119], 0
ds_read_b64_tr_b16 a[164:165], v12 offset:16384
ds_read_b64_tr_b16 a[166:167], v12 offset:16896
v_mfma_f32_16x16x32_bf16 a[200:203], a[184:187], a[120:123], 0
buffer_load_dwordx4 v8, s[20:23], s64 offen offset:1024 lds
v_mfma_f32_16x16x32_bf16 a[204:207], a[184:187], a[124:127], 0
ds_read_b128 a[104:107], v10 offset:4096
v_cvt_pk_bf16_f32 v193, v194, v195
v_mfma_f32_16x16x32_bf16 a[208:211], a[188:191], a[124:127], 0
ds_read_b64_tr_b16 a[168:169], v13 offset:16384
ds_read_b64_tr_b16 a[170:171], v13 offset:16896
v_mfma_f32_16x16x32_bf16 a[212:215], a[188:191], a[120:123], 0
ds_read_b128 a[108:111], v10 offset:6144
v_cvt_pk_bf16_f32 v194, v196, v197
v_mfma_f32_16x16x32_bf16 a[216:219], a[188:191], a[116:119], 0
s_add_u32 m0, s80, 0
s_add_u32 s64, s79, 0
v_cvt_pk_bf16_f32 v195, v198, v199
v_mfma_f32_16x16x32_bf16 a[220:223], a[188:191], a[112:115], 0
ds_read_b64_tr_b16 a[172:173], v14 offset:16384
ds_read_b64_tr_b16 a[174:175], v14 offset:16896
v_mfma_f32_16x16x32_bf16 a[224:227], a[64:67], a[112:115], 0
buffer_load_dwordx4 v4, s[24:27], s64 offen sc1 lds
v_mfma_f32_16x16x32_bf16 a[228:231], a[64:67], a[116:119], 0
ds_read_b128 a[88:91], v4 offset:24576
v_mul_f32 v200, s91, v200
v_mfma_f32_16x16x32_bf16 a[232:235], a[64:67], a[120:123], 0
ds_read_b64_tr_b16 a[80:81], v11 offset:20480
ds_read_b64_tr_b16 a[82:83], v11 offset:20992
v_mfma_f32_16x16x32_bf16 a[236:239], a[64:67], a[124:127], 0
buffer_store_dwordx4 v[56:59], v4, s[24:27], s53 offen offset:3072 sc1
v_mfma_f32_16x16x32_bf16 a[240:243], a[128:131], a[124:127], 0
s_add_u32 m0, s73, 36864
s_add_u32 s64, s72, 0
ds_read_b128 a[152:155], v4 offset:25600
v_mfma_f32_16x16x32_bf16 a[244:247], a[128:131], a[120:123], 0
v_mul_f32 v201, s91, v201
v_mul_f32 v202, s91, v202
v_mfma_f32_16x16x32_bf16 a[248:251], a[128:131], a[116:119], 0
buffer_load_dwordx4 v5, s[12:15], s64 offen lds
v_mfma_f32_16x16x32_bf16 v[36:39], a[128:131], a[112:115], 0
ds_read_b64_tr_b16 a[144:145], v12 offset:20480
ds_read_b64_tr_b16 a[146:147], v12 offset:20992
v_mfma_f32_16x16x32_bf16 v[44:47], a[68:71], a[112:115], 0
ds_read_b128 a[92:95], v4 offset:26624
v_mul_f32 v203, s91, v203
v_mfma_f32_16x16x32_bf16 v[32:35], a[68:71], a[116:119], 0
v_mul_f32 v204, s91, v204
v_mul_f32 v205, s91, v205
v_mfma_f32_16x16x32_bf16 v[52:55], a[68:71], a[120:123], 0
s_add_u32 s53, s88, 262144
ds_read_b64_tr_b16 a[84:85], v13 offset:20480
ds_read_b64_tr_b16 a[86:87], v13 offset:20992
v_mfma_f32_16x16x32_bf16 v[60:63], a[68:71], a[124:127], 0
buffer_store_dwordx4 v[64:67], v4, s[24:27], s53 offen offset:0 sc1
v_mfma_f32_16x16x32_bf16 v[68:71], a[132:135], a[124:127], 0
buffer_load_dwordx4 v6, s[12:15], s64 offen offset:1024 lds
v_mfma_f32_16x16x32_bf16 v[76:79], a[132:135], a[120:123], 0
ds_read_b128 a[156:159], v4 offset:27648
v_mul_f32 v206, s91, v206
v_mfma_f32_16x16x32_bf16 v[84:87], a[132:135], a[116:119], 0
ds_read_b64_tr_b16 a[148:149], v14 offset:20480
ds_read_b64_tr_b16 a[150:151], v14 offset:20992
v_mfma_f32_16x16x32_bf16 v[92:95], a[132:135], a[112:115], 0
v_mul_f32 v207, s91, v207
v_cvt_pk_bf16_f32 v200, v200, v201
v_mfma_f32_16x16x32_bf16 v[100:103], a[72:75], a[112:115], 0
s_add_u32 m0, s73, 38912
s_add_u32 s64, s72, 18432
v_cvt_pk_bf16_f32 v201, v202, v203
v_mfma_f32_16x16x32_bf16 v[108:111], a[72:75], a[116:119], 0
v_cvt_pk_bf16_f32 v202, v204, v205
v_cvt_pk_bf16_f32 v203, v206, v207
v_mfma_f32_16x16x32_bf16 v[116:119], a[72:75], a[120:123], 0
buffer_load_dwordx4 v5, s[12:15], s64 offen lds
v_mfma_f32_16x16x32_bf16 v[40:43], a[72:75], a[124:127], 0
v_mul_f32 v208, s91, v208
v_mul_f32 v209, s91, v209
v_mfma_f32_16x16x32_bf16 v[124:127], a[136:139], a[124:127], 0
v_mul_f32 v210, s91, v210
v_mul_f32 v211, s91, v211
v_mfma_f32_16x16x32_bf16 v[132:135], a[136:139], a[120:123], 0
v_mul_f32 v212, s91, v212
v_mul_f32 v213, s91, v213
v_mfma_f32_16x16x32_bf16 v[140:143], a[136:139], a[116:119], 0
v_mul_f32 v214, s91, v214
v_mul_f32 v215, s91, v215
v_mfma_f32_16x16x32_bf16 v[148:151], a[136:139], a[112:115], 0
v_cvt_pk_bf16_f32 v208, v208, v209
v_cvt_pk_bf16_f32 v209, v210, v211
v_mfma_f32_16x16x32_bf16 v[156:159], a[76:79], a[112:115], 0
buffer_load_dwordx4 v6, s[12:15], s64 offen offset:1024 lds
v_mfma_f32_16x16x32_bf16 v[48:51], a[76:79], a[116:119], 0
v_add_u32 v9, -65536, v9
v_add_u32 v10, -65536, v10
v_mfma_f32_16x16x32_bf16 v[164:167], a[76:79], a[120:123], 0
v_cvt_pk_bf16_f32 v210, v212, v213
v_cvt_pk_bf16_f32 v211, v214, v215
v_mfma_f32_16x16x32_bf16 v[172:175], a[76:79], a[124:127], 0
v_mul_f32 v216, s91, v216
v_mul_f32 v217, s91, v217
v_mfma_f32_16x16x32_bf16 v[180:183], a[140:143], a[124:127], 0
v_mul_f32 v218, s91, v218
v_mul_f32 v219, s91, v219
v_mfma_f32_16x16x32_bf16 v[188:191], a[140:143], a[120:123], 0
v_mul_f32 v220, s91, v220
v_mul_f32 v221, s91, v221
v_mfma_f32_16x16x32_bf16 v[196:199], a[140:143], a[116:119], 0
v_mul_f32 v222, s91, v222
v_mul_f32 v223, s91, v223
v_mfma_f32_16x16x32_bf16 v[56:59], a[140:143], a[112:115], 0
s_waitcnt lgkmcnt(0)
v_cvt_pk_bf16_f32 v216, v216, v217
v_cvt_pk_bf16_f32 v217, v218, v219
v_mfma_f32_16x16x32_bf16 a[32:35], a[160:163], a[96:99], a[32:35]
s_waitcnt vmcnt(18)
v_cvt_pk_bf16_f32 v218, v220, v221
v_cvt_pk_bf16_f32 v219, v222, v223
v_mfma_f32_16x16x32_bf16 a[36:39], a[160:163], a[100:103], a[36:39]
s_barrier
v_mfma_f32_16x16x32_bf16 a[40:43], a[160:163], a[104:107], a[40:43]
ds_read_b128 a[112:115], v9 offset:0
v_mul_f32 v224, s91, v224
v_mfma_f32_16x16x32_bf16 a[44:47], a[160:163], a[108:111], a[44:47]
s_add_u32 m0, s77, 16384
s_add_u32 s64, s76, 262144
v_mul_f32 v225, s91, v225
v_mfma_f32_16x16x32_bf16 a[48:51], a[164:167], a[108:111], a[48:51]
buffer_load_dwordx4 v7, s[20:23], s64 offen lds
v_mfma_f32_16x16x32_bf16 a[52:55], a[164:167], a[104:107], a[52:55]
s_add_u32 s53, s88, 262144
ds_read_b64_tr_b16 a[176:177], v11 offset:32768
ds_read_b64_tr_b16 a[178:179], v11 offset:33280
v_mfma_f32_16x16x32_bf16 a[56:59], a[164:167], a[100:103], a[56:59]
ds_read_b128 a[116:119], v9 offset:2048
v_mul_f32 v226, s91, v226
v_mfma_f32_16x16x32_bf16 a[60:63], a[164:167], a[96:99], a[60:63]
ds_read_b64_tr_b16 a[180:181], v12 offset:32768
ds_read_b64_tr_b16 a[182:183], v12 offset:33280
v_mfma_f32_16x16x32_bf16 a[192:195], a[168:171], a[96:99], a[192:195]
ds_read_b128 a[120:123], v9 offset:4096
v_mul_f32 v227, s91, v227
v_mfma_f32_16x16x32_bf16 a[196:199], a[168:171], a[100:103], a[196:199]
buffer_store_dwordx4 v[72:75], v4, s[24:27], s53 offen offset:1024 sc1
v_mfma_f32_16x16x32_bf16 a[200:203], a[168:171], a[104:107], a[200:203]
buffer_load_dwordx4 v8, s[20:23], s64 offen offset:1024 lds
v_mfma_f32_16x16x32_bf16 a[204:207], a[168:171], a[108:111], a[204:207]
ds_read_b64_tr_b16 a[184:185], v13 offset:32768
ds_read_b64_tr_b16 a[186:187], v13 offset:33280
v_mfma_f32_16x16x32_bf16 a[208:211], a[172:175], a[108:111], a[208:211]
ds_read_b128 a[124:127], v9 offset:6144
v_mul_f32 v228, s91, v228
v_mfma_f32_16x16x32_bf16 a[212:215], a[172:175], a[104:107], a[212:215]
v_mul_f32 v229, s91, v229
v_mul_f32 v230, s91, v230
v_mfma_f32_16x16x32_bf16 a[216:219], a[172:175], a[100:103], a[216:219]
s_add_u32 m0, s80, 16384
s_add_u32 s64, s79, 4096
v_mul_f32 v231, s91, v231
v_mfma_f32_16x16x32_bf16 a[220:223], a[172:175], a[96:99], a[220:223]
ds_read_b64_tr_b16 a[188:189], v14 offset:32768
ds_read_b64_tr_b16 a[190:191], v14 offset:33280
v_mfma_f32_16x16x32_bf16 a[224:227], a[80:83], a[96:99], a[224:227]
buffer_load_dwordx4 v4, s[24:27], s64 offen sc1 lds
v_mfma_f32_16x16x32_bf16 a[228:231], a[80:83], a[100:103], a[228:231]
s_xor_b32 s65, s70, 384
s_add_u32 s71, s68, s65
s_add_u32 s72, s69, s65
v_mfma_f32_16x16x32_bf16 a[232:235], a[80:83], a[104:107], a[232:235]
ds_read_b128 a[72:75], v4 offset:40960
v_cvt_pk_bf16_f32 v224, v224, v225
v_mfma_f32_16x16x32_bf16 a[236:239], a[80:83], a[108:111], a[236:239]
ds_read_b64_tr_b16 a[64:65], v11 offset:36864
ds_read_b64_tr_b16 a[66:67], v11 offset:37376
v_mfma_f32_16x16x32_bf16 a[240:243], a[144:147], a[108:111], a[240:243]
s_add_u32 m0, s73, 65536
s_add_u32 s64, s71, 0
ds_read_b128 a[136:139], v4 offset:41984
v_mfma_f32_16x16x32_bf16 a[244:247], a[144:147], a[104:107], a[244:247]
v_cvt_pk_bf16_f32 v225, v226, v227
v_cvt_pk_bf16_f32 v226, v228, v229
v_mfma_f32_16x16x32_bf16 a[248:251], a[144:147], a[100:103], a[248:251]
buffer_load_dwordx4 v5, s[12:15], s64 offen lds
v_mfma_f32_16x16x32_bf16 v[36:39], a[144:147], a[96:99], v[36:39]
ds_read_b64_tr_b16 a[128:129], v12 offset:36864
ds_read_b64_tr_b16 a[130:131], v12 offset:37376
v_mfma_f32_16x16x32_bf16 v[44:47], a[84:87], a[96:99], v[44:47]
ds_read_b128 a[76:79], v4 offset:43008
v_cvt_pk_bf16_f32 v227, v230, v231
v_mfma_f32_16x16x32_bf16 v[32:35], a[84:87], a[100:103], v[32:35]
v_mul_f32 v232, s91, v232
v_mul_f32 v233, s91, v233
v_mfma_f32_16x16x32_bf16 v[52:55], a[84:87], a[104:107], v[52:55]
ds_read_b64_tr_b16 a[68:69], v13 offset:36864
ds_read_b64_tr_b16 a[70:71], v13 offset:37376
v_mfma_f32_16x16x32_bf16 v[60:63], a[84:87], a[108:111], v[60:63]
v_mul_f32 v234, s91, v234
v_mul_f32 v235, s91, v235
v_mfma_f32_16x16x32_bf16 v[68:71], a[148:151], a[108:111], v[68:71]
buffer_load_dwordx4 v6, s[12:15], s64 offen offset:1024 lds
v_mfma_f32_16x16x32_bf16 v[76:79], a[148:151], a[104:107], v[76:79]
ds_read_b128 a[140:143], v4 offset:44032
v_mul_f32 v236, s91, v236
v_mfma_f32_16x16x32_bf16 v[84:87], a[148:151], a[100:103], v[84:87]
ds_read_b64_tr_b16 a[132:133], v14 offset:36864
ds_read_b64_tr_b16 a[134:135], v14 offset:37376
v_mfma_f32_16x16x32_bf16 v[92:95], a[148:151], a[96:99], v[92:95]
v_mul_f32 v237, s91, v237
v_mul_f32 v238, s91, v238
v_mfma_f32_16x16x32_bf16 v[100:103], a[88:91], a[96:99], v[100:103]
s_add_u32 m0, s73, 67584
s_add_u32 s64, s71, 18432
s_add_u32 s53, s88, 262144
v_mfma_f32_16x16x32_bf16 v[108:111], a[88:91], a[100:103], v[108:111]
buffer_store_dwordx4 v[80:83], v4, s[24:27], s53 offen offset:2048 sc1
v_mfma_f32_16x16x32_bf16 v[116:119], a[88:91], a[104:107], v[116:119]
buffer_load_dwordx4 v5, s[12:15], s64 offen lds
v_mfma_f32_16x16x32_bf16 v[40:43], a[88:91], a[108:111], v[40:43]
v_mul_f32 v239, s91, v239
v_cvt_pk_bf16_f32 v232, v232, v233
v_mfma_f32_16x16x32_bf16 v[124:127], a[152:155], a[108:111], v[124:127]
v_cvt_pk_bf16_f32 v233, v234, v235
v_cvt_pk_bf16_f32 v234, v236, v237
v_mfma_f32_16x16x32_bf16 v[132:135], a[152:155], a[104:107], v[132:135]
v_cvt_pk_bf16_f32 v235, v238, v239
v_mul_f32 v240, s91, v240
v_mfma_f32_16x16x32_bf16 v[140:143], a[152:155], a[100:103], v[140:143]
v_mul_f32 v241, s91, v241
v_mul_f32 v242, s91, v242
v_mfma_f32_16x16x32_bf16 v[148:151], a[152:155], a[96:99], v[148:151]
v_mul_f32 v243, s91, v243
v_mul_f32 v244, s91, v244
v_mfma_f32_16x16x32_bf16 v[156:159], a[92:95], a[96:99], v[156:159]
buffer_load_dwordx4 v6, s[12:15], s64 offen offset:1024 lds
v_mfma_f32_16x16x32_bf16 v[48:51], a[92:95], a[100:103], v[48:51]
v_mul_f32 v245, s91, v245
v_mul_f32 v246, s91, v246
v_mfma_f32_16x16x32_bf16 v[164:167], a[92:95], a[104:107], v[164:167]
v_mul_f32 v247, s91, v247
v_cvt_pk_bf16_f32 v240, v240, v241
v_mfma_f32_16x16x32_bf16 v[172:175], a[92:95], a[108:111], v[172:175]
v_cvt_pk_bf16_f32 v241, v242, v243
v_cvt_pk_bf16_f32 v242, v244, v245
v_mfma_f32_16x16x32_bf16 v[180:183], a[156:159], a[108:111], v[180:183]
v_cvt_pk_bf16_f32 v243, v246, v247
v_mul_f32 v248, s91, v248
v_mfma_f32_16x16x32_bf16 v[188:191], a[156:159], a[104:107], v[188:191]
v_mul_f32 v249, s91, v249
v_mul_f32 v250, s91, v250
v_mfma_f32_16x16x32_bf16 v[196:199], a[156:159], a[100:103], v[196:199]
v_mul_f32 v251, s91, v251
v_mul_f32 v252, s91, v252
v_mfma_f32_16x16x32_bf16 v[56:59], a[156:159], a[96:99], v[56:59]
s_waitcnt lgkmcnt(0)
v_mul_f32 v253, s91, v253
v_mul_f32 v254, s91, v254
v_mfma_f32_16x16x32_bf16 a[32:35], a[176:179], a[112:115], a[32:35]
s_waitcnt vmcnt(23)
v_mul_f32 v255, s91, v255
v_cvt_pk_bf16_f32 v248, v248, v249
v_mfma_f32_16x16x32_bf16 a[36:39], a[176:179], a[116:119], a[36:39]
s_barrier
v_mfma_f32_16x16x32_bf16 a[40:43], a[176:179], a[120:123], a[40:43]
ds_read_b128 a[96:99], v10 offset:0
v_cvt_pk_bf16_f32 v249, v250, v251
v_mfma_f32_16x16x32_bf16 a[44:47], a[176:179], a[124:127], a[44:47]
s_xor_b32 s75, s93, 3
s_lshl_b32 s76, s75, 19
s_add_u32 s76, s76, s74
v_mfma_f32_16x16x32_bf16 a[48:51], a[180:183], a[124:127], a[48:51]
s_mul_i32 s79, s75, 8192
s_add_u32 s79, s79, s78
v_cvt_pk_bf16_f32 v250, v252, v253
v_mfma_f32_16x16x32_bf16 a[52:55], a[180:183], a[120:123], a[52:55]
s_add_u32 m0, s77, 32768
s_add_u32 s64, s76, 0
v_cvt_pk_bf16_f32 v251, v254, v255
v_mfma_f32_16x16x32_bf16 a[56:59], a[180:183], a[116:119], a[56:59]
buffer_load_dwordx4 v7, s[20:23], s64 offen lds
v_mfma_f32_16x16x32_bf16 a[60:63], a[180:183], a[112:115], a[60:63]
ds_read_b64_tr_b16 a[160:161], v11 offset:49152
ds_read_b64_tr_b16 a[162:163], v11 offset:49664
v_mfma_f32_16x16x32_bf16 a[192:195], a[184:187], a[112:115], a[192:195]
ds_read_b128 a[100:103], v10 offset:2048
v_accvgpr_read_b32 v16, a0
v_mfma_f32_16x16x32_bf16 a[196:199], a[184:187], a[116:119], a[196:199]
ds_read_b64_tr_b16 a[164:165], v12 offset:49152
ds_read_b64_tr_b16 a[166:167], v12 offset:49664
v_mfma_f32_16x16x32_bf16 a[200:203], a[184:187], a[120:123], a[200:203]
buffer_load_dwordx4 v8, s[20:23], s64 offen offset:1024 lds
v_mfma_f32_16x16x32_bf16 a[204:207], a[184:187], a[124:127], a[204:207]
s_add_u32 s53, s88, 262144
ds_read_b128 a[104:107], v10 offset:4096
v_accvgpr_read_b32 v17, a1
v_mfma_f32_16x16x32_bf16 a[208:211], a[188:191], a[124:127], a[208:211]
ds_read_b64_tr_b16 a[168:169], v13 offset:49152
ds_read_b64_tr_b16 a[170:171], v13 offset:49664
v_mfma_f32_16x16x32_bf16 a[212:215], a[188:191], a[120:123], a[212:215]
ds_read_b128 a[108:111], v10 offset:6144
v_accvgpr_read_b32 v18, a2
v_mfma_f32_16x16x32_bf16 a[216:219], a[188:191], a[116:119], a[216:219]
s_add_u32 m0, s80, 32768
s_add_u32 s64, s79, 0
v_accvgpr_read_b32 v19, a3
v_mfma_f32_16x16x32_bf16 a[220:223], a[188:191], a[112:115], a[220:223]
ds_read_b64_tr_b16 a[172:173], v14 offset:49152
ds_read_b64_tr_b16 a[174:175], v14 offset:49664
v_mfma_f32_16x16x32_bf16 a[224:227], a[64:67], a[112:115], a[224:227]
buffer_load_dwordx4 v4, s[24:27], s64 offen sc1 lds
v_mfma_f32_16x16x32_bf16 a[228:231], a[64:67], a[116:119], a[228:231]
ds_read_b128 a[88:91], v4 offset:57344
v_accvgpr_read_b32 v20, a4
v_mfma_f32_16x16x32_bf16 a[232:235], a[64:67], a[120:123], a[232:235]
ds_read_b64_tr_b16 a[80:81], v11 offset:53248
ds_read_b64_tr_b16 a[82:83], v11 offset:53760
v_mfma_f32_16x16x32_bf16 a[236:239], a[64:67], a[124:127], a[236:239]
buffer_store_dwordx4 v[88:91], v4, s[24:27], s53 offen offset:3072 sc1
v_mfma_f32_16x16x32_bf16 a[240:243], a[128:131], a[124:127], a[240:243]
s_add_u32 m0, s73, 69632
s_add_u32 s64, s72, 0
ds_read_b128 a[152:155], v4 offset:58368
v_mfma_f32_16x16x32_bf16 a[244:247], a[128:131], a[120:123], a[244:247]
v_accvgpr_read_b32 v21, a5
v_accvgpr_read_b32 v22, a6
v_mfma_f32_16x16x32_bf16 a[248:251], a[128:131], a[116:119], a[248:251]
buffer_load_dwordx4 v5, s[12:15], s64 offen lds
v_mfma_f32_16x16x32_bf16 v[36:39], a[128:131], a[112:115], v[36:39]
ds_read_b64_tr_b16 a[144:145], v12 offset:53248
ds_read_b64_tr_b16 a[146:147], v12 offset:53760
v_mfma_f32_16x16x32_bf16 v[44:47], a[68:71], a[112:115], v[44:47]
ds_read_b128 a[92:95], v4 offset:59392
v_accvgpr_read_b32 v23, a7
v_mfma_f32_16x16x32_bf16 v[32:35], a[68:71], a[116:119], v[32:35]
v_mul_f32 v16, s91, v16
v_mul_f32 v17, s91, v17
v_mfma_f32_16x16x32_bf16 v[52:55], a[68:71], a[120:123], v[52:55]
ds_read_b64_tr_b16 a[84:85], v13 offset:53248
ds_read_b64_tr_b16 a[86:87], v13 offset:53760
v_mfma_f32_16x16x32_bf16 v[60:63], a[68:71], a[124:127], v[60:63]
v_mul_f32 v18, s91, v18
v_mul_f32 v19, s91, v19
v_mfma_f32_16x16x32_bf16 v[68:71], a[132:135], a[124:127], v[68:71]
buffer_load_dwordx4 v6, s[12:15], s64 offen offset:1024 lds
v_mfma_f32_16x16x32_bf16 v[76:79], a[132:135], a[120:123], v[76:79]
ds_read_b128 a[156:159], v4 offset:60416
v_mul_f32 v20, s91, v20
v_mfma_f32_16x16x32_bf16 v[84:87], a[132:135], a[116:119], v[84:87]
ds_read_b64_tr_b16 a[148:149], v14 offset:53248
ds_read_b64_tr_b16 a[150:151], v14 offset:53760
v_mfma_f32_16x16x32_bf16 v[92:95], a[132:135], a[112:115], v[92:95]
v_mul_f32 v21, s91, v21
v_mul_f32 v22, s91, v22
v_mfma_f32_16x16x32_bf16 v[100:103], a[72:75], a[112:115], v[100:103]
s_add_u32 m0, s73, 71680
s_add_u32 s64, s72, 18432
v_mul_f32 v23, s91, v23
v_mfma_f32_16x16x32_bf16 v[108:111], a[72:75], a[116:119], v[108:111]
L_PAD4:
s_cbranch_execz L_PAD8
v_cvt_pk_bf16_f32 v16, v16, v17
v_cvt_pk_bf16_f32 v17, v18, v19
v_mfma_f32_16x16x32_bf16 v[116:119], a[72:75], a[120:123], v[116:119]
buffer_load_dwordx4 v5, s[12:15], s64 offen lds
v_mfma_f32_16x16x32_bf16 v[40:43], a[72:75], a[124:127], v[40:43]
v_cvt_pk_bf16_f32 v18, v20, v21
v_cvt_pk_bf16_f32 v19, v22, v23
v_mfma_f32_16x16x32_bf16 v[124:127], a[136:139], a[124:127], v[124:127]
v_accvgpr_write_b32 a0, v16
v_accvgpr_write_b32 a1, v17
v_mfma_f32_16x16x32_bf16 v[132:135], a[136:139], a[120:123], v[132:135]
v_accvgpr_write_b32 a2, v18
v_accvgpr_write_b32 a3, v19
v_mfma_f32_16x16x32_bf16 v[140:143], a[136:139], a[116:119], v[140:143]
s_add_u32 s53, s87, 0
v_accvgpr_read_b32 v16, a8
v_accvgpr_read_b32 v17, a9
v_mfma_f32_16x16x32_bf16 v[148:151], a[136:139], a[112:115], v[148:151]
buffer_store_dwordx4 v[160:163], v4, s[24:27], s53 offen offset:0 sc1
v_mfma_f32_16x16x32_bf16 v[156:159], a[76:79], a[112:115], v[156:159]
buffer_load_dwordx4 v6, s[12:15], s64 offen offset:1024 lds
v_mfma_f32_16x16x32_bf16 v[48:51], a[76:79], a[116:119], v[48:51]
v_add_u32 v9, 32768, v9
v_add_u32 v10, 32768, v10
v_mfma_f32_16x16x32_bf16 v[164:167], a[76:79], a[120:123], v[164:167]
v_accvgpr_read_b32 v18, a10
v_accvgpr_read_b32 v19, a11
v_mfma_f32_16x16x32_bf16 v[172:175], a[76:79], a[124:127], v[172:175]
v_accvgpr_read_b32 v20, a12
v_accvgpr_read_b32 v21, a13
v_mfma_f32_16x16x32_bf16 v[180:183], a[140:143], a[124:127], v[180:183]
v_accvgpr_read_b32 v22, a14
v_accvgpr_read_b32 v23, a15
v_mfma_f32_16x16x32_bf16 v[188:191], a[140:143], a[120:123], v[188:191]
v_mul_f32 v16, s91, v16
v_mul_f32 v17, s91, v17
v_mfma_f32_16x16x32_bf16 v[196:199], a[140:143], a[116:119], v[196:199]
v_mul_f32 v18, s91, v18
v_mul_f32 v19, s91, v19
v_mfma_f32_16x16x32_bf16 v[56:59], a[140:143], a[112:115], v[56:59]
s_waitcnt lgkmcnt(0)
v_mul_f32 v20, s91, v20
v_mul_f32 v21, s91, v21
v_mfma_f32_16x16x32_bf16 a[32:35], a[160:163], a[96:99], a[32:35]
s_waitcnt vmcnt(18)
v_mul_f32 v22, s91, v22
v_mul_f32 v23, s91, v23
v_mfma_f32_16x16x32_bf16 a[36:39], a[160:163], a[100:103], a[36:39]
s_barrier
v_mfma_f32_16x16x32_bf16 a[40:43], a[160:163], a[104:107], a[40:43]
ds_read_b128 a[112:115], v9 offset:0
v_cvt_pk_bf16_f32 v16, v16, v17
v_mfma_f32_16x16x32_bf16 a[44:47], a[160:163], a[108:111], a[44:47]
s_add_u32 m0, s77, 49152
s_add_u32 s64, s76, 262144
v_cvt_pk_bf16_f32 v17, v18, v19
v_mfma_f32_16x16x32_bf16 a[48:51], a[164:167], a[108:111], a[48:51]
buffer_load_dwordx4 v7, s[20:23], s64 offen lds
v_mfma_f32_16x16x32_bf16 a[52:55], a[164:167], a[104:107], a[52:55]
ds_read_b64_tr_b16 a[176:177], v11 offset:0
ds_read_b64_tr_b16 a[178:179], v11 offset:512
v_mfma_f32_16x16x32_bf16 a[56:59], a[164:167], a[100:103], a[56:59]
ds_read_b128 a[116:119], v9 offset:2048
v_cvt_pk_bf16_f32 v18, v20, v21
v_mfma_f32_16x16x32_bf16 a[60:63], a[164:167], a[96:99], a[60:63]
ds_read_b64_tr_b16 a[180:181], v12 offset:0
ds_read_b64_tr_b16 a[182:183], v12 offset:512
v_mfma_f32_16x16x32_bf16 a[192:195], a[168:171], a[96:99], a[192:195]
ds_read_b128 a[120:123], v9 offset:4096
v_cvt_pk_bf16_f32 v19, v22, v23
v_mfma_f32_16x16x32_bf16 a[196:199], a[168:171], a[100:103], a[196:199]
v_accvgpr_write_b32 a8, v16
v_accvgpr_write_b32 a9, v17
v_mfma_f32_16x16x32_bf16 a[200:203], a[168:171], a[104:107], a[200:203]
buffer_load_dwordx4 v8, s[20:23], s64 offen offset:1024 lds
v_mfma_f32_16x16x32_bf16 a[204:207], a[168:171], a[108:111], a[204:207]
ds_read_b64_tr_b16 a[184:185], v13 offset:0
ds_read_b64_tr_b16 a[186:187], v13 offset:512
v_mfma_f32_16x16x32_bf16 a[208:211], a[172:175], a[108:111], a[208:211]
ds_read_b128 a[124:127], v9 offset:6144
v_accvgpr_write_b32 a10, v18
v_mfma_f32_16x16x32_bf16 a[212:215], a[172:175], a[104:107], a[212:215]
v_accvgpr_write_b32 a11, v19
v_accvgpr_read_b32 v16, a16
v_mfma_f32_16x16x32_bf16 a[216:219], a[172:175], a[100:103], a[216:219]
s_add_u32 m0, s80, 49152
s_add_u32 s64, s79, 4096
v_accvgpr_read_b32 v17, a17
v_mfma_f32_16x16x32_bf16 a[220:223], a[172:175], a[96:99], a[220:223]
ds_read_b64_tr_b16 a[188:189], v14 offset:0
ds_read_b64_tr_b16 a[190:191], v14 offset:512
v_mfma_f32_16x16x32_bf16 a[224:227], a[80:83], a[96:99], a[224:227]
buffer_load_dwordx4 v4, s[24:27], s64 offen sc1 lds
v_mfma_f32_16x16x32_bf16 a[228:231], a[80:83], a[100:103], a[228:231]
s_xor_b32 s65, s70, 512
s_add_u32 s71, s68, s65
s_add_u32 s72, s69, s65
v_mfma_f32_16x16x32_bf16 a[232:235], a[80:83], a[104:107], a[232:235]
s_add_u32 s53, s87, 0
ds_read_b128 a[72:75], v4 offset:8192
v_accvgpr_read_b32 v18, a18
v_mfma_f32_16x16x32_bf16 a[236:239], a[80:83], a[108:111], a[236:239]
ds_read_b64_tr_b16 a[64:65], v11 offset:4096
ds_read_b64_tr_b16 a[66:67], v11 offset:4608
v_mfma_f32_16x16x32_bf16 a[240:243], a[144:147], a[108:111], a[240:243]
s_add_u32 m0, s73, 0
s_add_u32 s64, s71, 0
ds_read_b128 a[136:139], v4 offset:9216
v_mfma_f32_16x16x32_bf16 a[244:247], a[144:147], a[104:107], a[244:247]
buffer_store_dwordx4 v[168:171], v4, s[24:27], s53 offen offset:1024 sc1
v_mfma_f32_16x16x32_bf16 a[248:251], a[144:147], a[100:103], a[248:251]
buffer_load_dwordx4 v5, s[12:15], s64 offen lds
v_mfma_f32_16x16x32_bf16 v[36:39], a[144:147], a[96:99], v[36:39]
ds_read_b64_tr_b16 a[128:129], v12 offset:4096
ds_read_b64_tr_b16 a[130:131], v12 offset:4608
v_mfma_f32_16x16x32_bf16 v[44:47], a[84:87], a[96:99], v[44:47]
ds_read_b128 a[76:79], v4 offset:10240
v_accvgpr_read_b32 v19, a19
v_mfma_f32_16x16x32_bf16 v[32:35], a[84:87], a[100:103], v[32:35]
v_accvgpr_read_b32 v20, a20
v_accvgpr_read_b32 v21, a21
v_mfma_f32_16x16x32_bf16 v[52:55], a[84:87], a[104:107], v[52:55]
ds_read_b64_tr_b16 a[68:69], v13 offset:4096
ds_read_b64_tr_b16 a[70:71], v13 offset:4608
v_mfma_f32_16x16x32_bf16 v[60:63], a[84:87], a[108:111], v[60:63]
v_accvgpr_read_b32 v22, a22
v_accvgpr_read_b32 v23, a23
v_mfma_f32_16x16x32_bf16 v[68:71], a[148:151], a[108:111], v[68:71]
buffer_load_dwordx4 v6, s[12:15], s64 offen offset:1024 lds
v_mfma_f32_16x16x32_bf16 v[76:79], a[148:151], a[104:107], v[76:79]
ds_read_b128 a[140:143], v4 offset:11264
v_mul_f32 v16, s91, v16
v_mfma_f32_16x16x32_bf16 v[84:87], a[148:151], a[100:103], v[84:87]
ds_read_b64_tr_b16 a[132:133], v14 offset:4096
ds_read_b64_tr_b16 a[134:135], v14 offset:4608
v_mfma_f32_16x16x32_bf16 v[92:95], a[148:151], a[96:99], v[92:95]
v_mul_f32 v17, s91, v17
v_mul_f32 v18, s91, v18
v_mfma_f32_16x16x32_bf16 v[100:103], a[88:91], a[96:99], v[100:103]
s_add_u32 m0, s73, 2048
s_add_u32 s64, s71, 18432
v_mul_f32 v19, s91, v19
v_mfma_f32_16x16x32_bf16 v[108:111], a[88:91], a[100:103], v[108:111]
v_mul_f32 v20, s91, v20
v_mul_f32 v21, s91, v21
v_mfma_f32_16x16x32_bf16 v[116:119], a[88:91], a[104:107], v[116:119]
buffer_load_dwordx4 v5, s[12:15], s64 offen lds
v_mfma_f32_16x16x32_bf16 v[40:43], a[88:91], a[108:111], v[40:43]
v_mul_f32 v22, s91, v22
v_mul_f32 v23, s91, v23
v_mfma_f32_16x16x32_bf16 v[124:127], a[152:155], a[108:111], v[124:127]
v_cvt_pk_bf16_f32 v16, v16, v17
v_cvt_pk_bf16_f32 v17, v18, v19
v_mfma_f32_16x16x32_bf16 v[132:135], a[152:155], a[104:107], v[132:135]
v_cvt_pk_bf16_f32 v18, v20, v21
v_cvt_pk_bf16_f32 v19, v22, v23
v_mfma_f32_16x16x32_bf16 v[140:143], a[152:155], a[100:103], v[140:143]
v_accvgpr_write_b32 a16, v16
v_accvgpr_write_b32 a17, v17
v_mfma_f32_16x16x32_bf16 v[148:151], a[152:155], a[96:99], v[148:151]
v_accvgpr_write_b32 a18, v18
v_accvgpr_write_b32 a19, v19
v_mfma_f32_16x16x32_bf16 v[156:159], a[92:95], a[96:99], v[156:159]
buffer_load_dwordx4 v6, s[12:15], s64 offen offset:1024 lds
v_mfma_f32_16x16x32_bf16 v[48:51], a[92:95], a[100:103], v[48:51]
v_accvgpr_read_b32 v16, a24
v_accvgpr_read_b32 v17, a25
v_mfma_f32_16x16x32_bf16 v[164:167], a[92:95], a[104:107], v[164:167]
v_accvgpr_read_b32 v18, a26
v_accvgpr_read_b32 v19, a27
v_mfma_f32_16x16x32_bf16 v[172:175], a[92:95], a[108:111], v[172:175]
v_accvgpr_read_b32 v20, a28
v_accvgpr_read_b32 v21, a29
v_mfma_f32_16x16x32_bf16 v[180:183], a[156:159], a[108:111], v[180:183]
s_add_u32 s53, s87, 4096
v_accvgpr_read_b32 v22, a30
v_accvgpr_read_b32 v23, a31
v_mfma_f32_16x16x32_bf16 v[188:191], a[156:159], a[104:107], v[188:191]
buffer_store_dwordx4 v[176:179], v4, s[24:27], s53 offen offset:0 sc1
v_mfma_f32_16x16x32_bf16 v[196:199], a[156:159], a[100:103], v[196:199]
v_mul_f32 v16, s91, v16
v_mul_f32 v17, s91, v17
v_mfma_f32_16x16x32_bf16 v[56:59], a[156:159], a[96:99], v[56:59]
s_waitcnt lgkmcnt(0)
v_mul_f32 v18, s91, v18
v_mul_f32 v19, s91, v19
v_mfma_f32_16x16x32_bf16 a[32:35], a[176:179], a[112:115], a[32:35]
s_waitcnt vmcnt(23)
v_mul_f32 v20, s91, v20
v_mul_f32 v21, s91, v21
v_mfma_f32_16x16x32_bf16 a[36:39], a[176:179], a[116:119], a[36:39]
s_barrier
v_mfma_f32_16x16x32_bf16 a[40:43], a[176:179], a[120:123], a[40:43]
ds_read_b128 a[96:99], v10 offset:0
v_mul_f32 v22, s91, v22
v_mfma_f32_16x16x32_bf16 a[44:47], a[176:179], a[124:127], a[44:47]
s_xor_b32 s75, s93, 4
s_lshl_b32 s76, s75, 19
s_add_u32 s76, s76, s74
v_mfma_f32_16x16x32_bf16 a[48:51], a[180:183], a[124:127], a[48:51]
s_mul_i32 s79, s75, 8192
s_add_u32 s79, s79, s78
v_mul_f32 v23, s91, v23
v_mfma_f32_16x16x32_bf16 a[52:55], a[180:183], a[120:123], a[52:55]
s_add_u32 m0, s77, 0
s_add_u32 s64, s76, 0
v_cvt_pk_bf16_f32 v16, v16, v17
v_mfma_f32_16x16x32_bf16 a[56:59], a[180:183], a[116:119], a[56:59]
buffer_load_dwordx4 v7, s[20:23], s64 offen lds
v_mfma_f32_16x16x32_bf16 a[60:63], a[180:183], a[112:115], a[60:63]
ds_read_b64_tr_b16 a[160:161], v11 offset:16384
ds_read_b64_tr_b16 a[162:163], v11 offset:16896
v_mfma_f32_16x16x32_bf16 a[192:195], a[184:187], a[112:115], a[192:195]
ds_read_b128 a[100:103], v10 offset:2048
v_cvt_pk_bf16_f32 v17, v18, v19
v_mfma_f32_16x16x32_bf16 a[196:199], a[184:187], a[116:119], a[196:199]
ds_read_b64_tr_b16 a[164:165], v12 offset:16384
ds_read_b64_tr_b16 a[166:167], v12 offset:16896
v_mfma_f32_16x16x32_bf16 a[200:203], a[184:187], a[120:123], a[200:203]
buffer_load_dwordx4 v8, s[20:23], s64 offen offset:1024 lds
v_mfma_f32_16x16x32_bf16 a[204:207], a[184:187], a[124:127], a[204:207]
ds_read_b128 a[104:107], v10 offset:4096
v_cvt_pk_bf16_f32 v18, v20, v21
v_mfma_f32_16x16x32_bf16 a[208:211], a[188:191], a[124:127], a[208:211]
ds_read_b64_tr_b16 a[168:169], v13 offset:16384
ds_read_b64_tr_b16 a[170:171], v13 offset:16896
v_mfma_f32_16x16x32_bf16 a[212:215], a[188:191], a[120:123], a[212:215]
ds_read_b128 a[108:111], v10 offset:6144
v_cvt_pk_bf16_f32 v19, v22, v23
v_mfma_f32_16x16x32_bf16 a[216:219], a[188:191], a[116:119], a[216:219]
s_add_u32 m0, s80, 0
s_add_u32 s64, s79, 0
v_accvgpr_write_b32 a24, v16
v_mfma_f32_16x16x32_bf16 a[220:223], a[188:191], a[112:115], a[220:223]
ds_read_b64_tr_b16 a[172:173], v14 offset:16384
ds_read_b64_tr_b16 a[174:175], v14 offset:16896
v_mfma_f32_16x16x32_bf16 a[224:227], a[64:67], a[112:115], a[224:227]
buffer_load_dwordx4 v4, s[24:27], s64 offen sc1 lds
v_mfma_f32_16x16x32_bf16 a[228:231], a[64:67], a[116:119], a[228:231]
ds_read_b128 a[88:91], v4 offset:24576
v_accvgpr_write_b32 a25, v17
v_mfma_f32_16x16x32_bf16 a[232:235], a[64:67], a[120:123], a[232:235]
ds_read_b64_tr_b16 a[80:81], v11 offset:20480
ds_read_b64_tr_b16 a[82:83], v11 offset:20992
v_mfma_f32_16x16x32_bf16 a[236:239], a[64:67], a[124:127], a[236:239]
v_accvgpr_write_b32 a26, v18
v_accvgpr_write_b32 a27, v19
v_mfma_f32_16x16x32_bf16 a[240:243], a[128:131], a[124:127], a[240:243]
s_add_u32 m0, s73, 4096
s_add_u32 s64, s72, 0
ds_read_b128 a[152:155], v4 offset:25600
v_mfma_f32_16x16x32_bf16 a[244:247], a[128:131], a[120:123], a[244:247]
v_accvgpr_write_b32 a4, v248
v_accvgpr_write_b32 a5, v249
v_mfma_f32_16x16x32_bf16 a[248:251], a[128:131], a[116:119], a[248:251]
buffer_load_dwordx4 v5, s[12:15], s64 offen lds
v_mfma_f32_16x16x32_bf16 v[36:39], a[128:131], a[112:115], v[36:39]
s_add_u32 s53, s87, 4096
ds_read_b64_tr_b16 a[144:145], v12 offset:20480
ds_read_b64_tr_b16 a[146:147], v12 offset:20992
v_mfma_f32_16x16x32_bf16 v[44:47], a[68:71], a[112:115], v[44:47]
ds_read_b128 a[92:95], v4 offset:26624
v_accvgpr_write_b32 a6, v250
v_mfma_f32_16x16x32_bf16 v[32:35], a[68:71], a[116:119], v[32:35]
buffer_store_dwordx4 v[184:187], v4, s[24:27], s53 offen offset:1024 sc1
v_mfma_f32_16x16x32_bf16 v[52:55], a[68:71], a[120:123], v[52:55]
ds_read_b64_tr_b16 a[84:85], v13 offset:20480
ds_read_b64_tr_b16 a[86:87], v13 offset:20992
v_mfma_f32_16x16x32_bf16 v[60:63], a[68:71], a[124:127], v[60:63]
v_accvgpr_write_b32 a7, v251
v_accvgpr_write_b32 a12, v240
v_mfma_f32_16x16x32_bf16 v[68:71], a[132:135], a[124:127], v[68:71]
buffer_load_dwordx4 v6, s[12:15], s64 offen offset:1024 lds
v_mfma_f32_16x16x32_bf16 v[76:79], a[132:135], a[120:123], v[76:79]
ds_read_b128 a[156:159], v4 offset:27648
v_accvgpr_write_b32 a13, v241
v_mfma_f32_16x16x32_bf16 v[84:87], a[132:135], a[116:119], v[84:87]
ds_read_b64_tr_b16 a[148:149], v14 offset:20480
ds_read_b64_tr_b16 a[150:151], v14 offset:20992
v_mfma_f32_16x16x32_bf16 v[92:95], a[132:135], a[112:115], v[92:95]
v_accvgpr_write_b32 a14, v242
v_accvgpr_write_b32 a15, v243
v_mfma_f32_16x16x32_bf16 v[100:103], a[72:75], a[112:115], v[100:103]
s_add_u32 m0, s73, 6144
s_add_u32 s64, s72, 18432
v_accvgpr_write_b32 a20, v232
v_mfma_f32_16x16x32_bf16 v[108:111], a[72:75], a[116:119], v[108:111]
v_accvgpr_write_b32 a21, v233
v_accvgpr_write_b32 a22, v234
v_mfma_f32_16x16x32_bf16 v[116:119], a[72:75], a[120:123], v[116:119]
buffer_load_dwordx4 v5, s[12:15], s64 offen lds
v_mfma_f32_16x16x32_bf16 v[40:43], a[72:75], a[124:127], v[40:43]
v_accvgpr_write_b32 a23, v235
v_accvgpr_write_b32 a28, v224
v_mfma_f32_16x16x32_bf16 v[124:127], a[136:139], a[124:127], v[124:127]
v_accvgpr_write_b32 a29, v225
v_accvgpr_write_b32 a30, v226
v_mfma_f32_16x16x32_bf16 v[132:135], a[136:139], a[120:123], v[132:135]
v_accvgpr_write_b32 a31, v227
v_and_b32 v28, 31, v1
v_mfma_f32_16x16x32_bf16 v[140:143], a[136:139], a[116:119], v[140:143]
v_lshlrev_b32 v28, 2, v28
v_mfma_f32_16x16x32_bf16 v[148:151], a[136:139], a[112:115], v[148:151]
buffer_load_dword v30, v28, s[40:43], 0 offen sc1
v_mfma_f32_16x16x32_bf16 v[156:159], a[76:79], a[112:115], v[156:159]
buffer_load_dwordx4 v6, s[12:15], s64 offen offset:1024 lds
v_mfma_f32_16x16x32_bf16 v[48:51], a[76:79], a[116:119], v[48:51]
v_add_u32 v9, 32768, v9
v_add_u32 v10, 32768, v10
v_mfma_f32_16x16x32_bf16 v[164:167], a[76:79], a[120:123], v[164:167]
v_mfma_f32_16x16x32_bf16 v[172:175], a[76:79], a[124:127], v[172:175]
v_mfma_f32_16x16x32_bf16 v[180:183], a[140:143], a[124:127], v[180:183]
v_mfma_f32_16x16x32_bf16 v[188:191], a[140:143], a[120:123], v[188:191]
v_mfma_f32_16x16x32_bf16 v[196:199], a[140:143], a[116:119], v[196:199]
v_mfma_f32_16x16x32_bf16 v[56:59], a[140:143], a[112:115], v[56:59]
s_waitcnt lgkmcnt(0)
v_mfma_f32_16x16x32_bf16 a[32:35], a[160:163], a[96:99], a[32:35]
s_waitcnt vmcnt(18)
v_mfma_f32_16x16x32_bf16 a[36:39], a[160:163], a[100:103], a[36:39]
s_barrier
v_mfma_f32_16x16x32_bf16 a[40:43], a[160:163], a[104:107], a[40:43]
s_add_u32 s53, s87, 262144
ds_read_b128 a[112:115], v9 offset:0
v_mfma_f32_16x16x32_bf16 a[44:47], a[160:163], a[108:111], a[44:47]
s_add_u32 m0, s77, 16384
s_add_u32 s64, s76, 262144
v_mfma_f32_16x16x32_bf16 a[48:51], a[164:167], a[108:111], a[48:51]
buffer_load_dwordx4 v7, s[20:23], s64 offen lds
v_mfma_f32_16x16x32_bf16 a[52:55], a[164:167], a[104:107], a[52:55]
ds_read_b64_tr_b16 a[176:177], v11 offset:32768
ds_read_b64_tr_b16 a[178:179], v11 offset:33280
v_mfma_f32_16x16x32_bf16 a[56:59], a[164:167], a[100:103], a[56:59]
ds_read_b128 a[116:119], v9 offset:2048
v_mfma_f32_16x16x32_bf16 a[60:63], a[164:167], a[96:99], a[60:63]
ds_read_b64_tr_b16 a[180:181], v12 offset:32768
ds_read_b64_tr_b16 a[182:183], v12 offset:33280
v_mfma_f32_16x16x32_bf16 a[192:195], a[168:171], a[96:99], a[192:195]
ds_read_b128 a[120:123], v9 offset:4096
v_accvgpr_read_b32 v64, a32
v_mfma_f32_16x16x32_bf16 a[196:199], a[168:171], a[100:103], a[196:199]
buffer_store_dwordx4 v[192:195], v4, s[24:27], s53 offen offset:0 sc1
v_mfma_f32_16x16x32_bf16 a[200:203], a[168:171], a[104:107], a[200:203]
buffer_load_dwordx4 v8, s[20:23], s64 offen offset:1024 lds
v_mfma_f32_16x16x32_bf16 a[204:207], a[168:171], a[108:111], a[204:207]
ds_read_b64_tr_b16 a[184:185], v13 offset:32768
ds_read_b64_tr_b16 a[186:187], v13 offset:33280
v_mfma_f32_16x16x32_bf16 a[208:211], a[172:175], a[108:111], a[208:211]
ds_read_b128 a[124:127], v9 offset:6144
v_accvgpr_read_b32 v65, a33
v_mfma_f32_16x16x32_bf16 a[212:215], a[172:175], a[104:107], a[212:215]
v_accvgpr_read_b32 v66, a34
v_accvgpr_read_b32 v67, a35
v_mfma_f32_16x16x32_bf16 a[216:219], a[172:175], a[100:103], a[216:219]
s_add_u32 m0, s80, 16384
s_add_u32 s64, s79, 4096
v_accvgpr_write_b32 a32, v152
v_mfma_f32_16x16x32_bf16 a[220:223], a[172:175], a[96:99], a[220:223]
ds_read_b64_tr_b16 a[188:189], v14 offset:32768
ds_read_b64_tr_b16 a[190:191], v14 offset:33280
v_mfma_f32_16x16x32_bf16 a[224:227], a[80:83], a[96:99], a[224:227]
buffer_load_dwordx4 v4, s[24:27], s64 offen sc1 lds
v_mfma_f32_16x16x32_bf16 a[228:231], a[80:83], a[100:103], a[228:231]
s_xor_b32 s65, s70, 640
s_add_u32 s71, s68, s65
s_add_u32 s72, s69, s65
v_mfma_f32_16x16x32_bf16 a[232:235], a[80:83], a[104:107], a[232:235]
ds_read_b128 a[72:75], v4 offset:40960
v_accvgpr_write_b32 a33, v153
v_mfma_f32_16x16x32_bf16 a[236:239], a[80:83], a[108:111], a[236:239]
ds_read_b64_tr_b16 a[64:65], v11 offset:36864
ds_read_b64_tr_b16 a[66:67], v11 offset:37376
v_mfma_f32_16x16x32_bf16 a[240:243], a[144:147], a[108:111], a[240:243]
s_add_u32 m0, s73, 32768
s_add_u32 s64, s71, 0
ds_read_b128 a[136:139], v4 offset:41984
v_mfma_f32_16x16x32_bf16 a[244:247], a[144:147], a[104:107], a[244:247]
v_accvgpr_write_b32 a34, v154
v_accvgpr_write_b32 a35, v155
v_mfma_f32_16x16x32_bf16 a[248:251], a[144:147], a[100:103], a[248:251]
buffer_load_dwordx4 v5, s[12:15], s64 offen lds
v_mfma_f32_16x16x32_bf16 v[36:39], a[144:147], a[96:99], v[36:39]
ds_read_b64_tr_b16 a[128:129], v12 offset:36864
ds_read_b64_tr_b16 a[130:131], v12 offset:37376
v_mfma_f32_16x16x32_bf16 v[44:47], a[84:87], a[96:99], v[44:47]
ds_read_b128 a[76:79], v4 offset:43008
v_accvgpr_read_b32 v204, a36
v_mfma_f32_16x16x32_bf16 v[32:35], a[84:87], a[100:103], v[32:35]
v_accvgpr_read_b32 v205, a37
v_accvgpr_read_b32 v206, a38
v_mfma_f32_16x16x32_bf16 v[52:55], a[84:87], a[104:107], v[52:55]
ds_read_b64_tr_b16 a[68:69], v13 offset:36864
ds_read_b64_tr_b16 a[70:71], v13 offset:37376
v_mfma_f32_16x16x32_bf16 v[60:63], a[84:87], a[108:111], v[60:63]
v_accvgpr_read_b32 v207, a39
v_accvgpr_read_b32 v212, a40
v_mfma_f32_16x16x32_bf16 v[68:71], a[148:151], a[108:111], v[68:71]
buffer_load_dwordx4 v6, s[12:15], s64 offen offset:1024 lds
v_mfma_f32_16x16x32_bf16 v[76:79], a[148:151], a[104:107], v[76:79]
s_add_u32 s53, s87, 262144
ds_read_b128 a[140:143], v4 offset:44032
v_accvgpr_read_b32 v213, a41
v_mfma_f32_16x16x32_bf16 v[84:87], a[148:151], a[100:103], v[84:87]
s_waitcnt vmcnt(7)
ds_read_b64_tr_b16 a[132:133], v14 offset:36864
ds_read_b64_tr_b16 a[134:135], v14 offset:37376
v_mfma_f32_16x16x32_bf16 v[92:95], a[148:151], a[96:99], v[92:95]
buffer_store_dwordx4 v[200:203], v4, s[24:27], s53 offen offset:1024 sc1
v_mfma_f32_16x16x32_bf16 v[100:103], a[88:91], a[96:99], v[100:103]
s_add_u32 m0, s73, 34816
s_add_u32 s64, s71, 18432
v_accvgpr_read_b32 v214, a42
v_mfma_f32_16x16x32_bf16 v[108:111], a[88:91], a[100:103], v[108:111]
v_accvgpr_read_b32 v215, a43
v_accvgpr_read_b32 v220, a44
v_mfma_f32_16x16x32_bf16 v[116:119], a[88:91], a[104:107], v[116:119]
buffer_load_dwordx4 v5, s[12:15], s64 offen lds
v_mfma_f32_16x16x32_bf16 v[40:43], a[88:91], a[108:111], v[40:43]
v_accvgpr_read_b32 v221, a45
v_accvgpr_read_b32 v222, a46
v_mfma_f32_16x16x32_bf16 v[124:127], a[152:155], a[108:111], v[124:127]
v_accvgpr_read_b32 v223, a47
v_cmp_gt_u32 vcc, 1, v30
v_mfma_f32_16x16x32_bf16 v[132:135], a[152:155], a[104:107], v[132:135]
v_mfma_f32_16x16x32_bf16 v[140:143], a[152:155], a[100:103], v[140:143]
v_mfma_f32_16x16x32_bf16 v[148:151], a[152:155], a[96:99], v[148:151]
v_mfma_f32_16x16x32_bf16 v[156:159], a[92:95], a[96:99], v[156:159]
buffer_load_dwordx4 v6, s[12:15], s64 offen offset:1024 lds
v_mfma_f32_16x16x32_bf16 v[48:51], a[92:95], a[100:103], v[48:51]
s_cbranch_vccnz CK_ZA
CK_ZA_R:
v_mfma_f32_16x16x32_bf16 v[164:167], a[92:95], a[104:107], v[164:167]
v_mfma_f32_16x16x32_bf16 v[172:175], a[92:95], a[108:111], v[172:175]
v_mfma_f32_16x16x32_bf16 v[180:183], a[156:159], a[108:111], v[180:183]
v_mfma_f32_16x16x32_bf16 v[188:191], a[156:159], a[104:107], v[188:191]
v_mfma_f32_16x16x32_bf16 v[196:199], a[156:159], a[100:103], v[196:199]
v_mfma_f32_16x16x32_bf16 v[56:59], a[156:159], a[96:99], v[56:59]
s_waitcnt lgkmcnt(0)
v_mfma_f32_16x16x32_bf16 v[64:67], a[176:179], a[112:115], v[64:67]
s_waitcnt vmcnt(24)
v_mfma_f32_16x16x32_bf16 v[204:207], a[176:179], a[116:119], v[204:207]
s_barrier
v_mfma_f32_16x16x32_bf16 v[212:215], a[176:179], a[120:123], v[212:215]
ds_read_b128 a[96:99], v10 offset:0
v_mfma_f32_16x16x32_bf16 v[220:223], a[176:179], a[124:127], v[220:223]
s_xor_b32 s75, s93, 5
s_lshl_b32 s76, s75, 19
s_add_u32 s76, s76, s74
v_mfma_f32_16x16x32_bf16 a[48:51], a[180:183], a[124:127], a[48:51]
s_mul_i32 s79, s75, 8192
s_add_u32 s79, s79, s78
v_mfma_f32_16x16x32_bf16 a[52:55], a[180:183], a[120:123], a[52:55]
s_add_u32 m0, s77, 32768
s_add_u32 s64, s76, 0
v_mfma_f32_16x16x32_bf16 a[56:59], a[180:183], a[116:119], a[56:59]
buffer_load_dwordx4 v7, s[20:23], s64 offen lds
v_mfma_f32_16x16x32_bf16 a[60:63], a[180:183], a[112:115], a[60:63]
ds_read_b64_tr_b16 a[160:161], v11 offset:49152
ds_read_b64_tr_b16 a[162:163], v11 offset:49664
v_mfma_f32_16x16x32_bf16 a[192:195], a[184:187], a[112:115], a[192:195]
s_add_u32 s53, s87, 266240
ds_read_b128 a[100:103], v10 offset:2048
v_mfma_f32_16x16x32_bf16 a[196:199], a[184:187], a[116:119], a[196:199]
ds_read_b64_tr_b16 a[164:165], v12 offset:49152
ds_read_b64_tr_b16 a[166:167], v12 offset:49664
v_mfma_f32_16x16x32_bf16 a[200:203], a[184:187], a[120:123], a[200:203]
buffer_load_dwordx4 v8, s[20:23], s64 offen offset:1024 lds
v_mfma_f32_16x16x32_bf16 a[204:207], a[184:187], a[124:127], a[204:207]
ds_read_b128 a[104:107], v10 offset:4096
v_mfma_f32_16x16x32_bf16 a[208:211], a[188:191], a[124:127], a[208:211]
ds_read_b64_tr_b16 a[168:169], v13 offset:49152
ds_read_b64_tr_b16 a[170:171], v13 offset:49664
v_mfma_f32_16x16x32_bf16 a[212:215], a[188:191], a[120:123], a[212:215]
ds_read_b128 a[108:111], v10 offset:6144
v_accvgpr_read_b32 v72, a48
v_mfma_f32_16x16x32_bf16 a[216:219], a[188:191], a[116:119], a[216:219]
s_add_u32 m0, s80, 32768
s_add_u32 s64, s79, 0
v_accvgpr_read_b32 v73, a49
v_mfma_f32_16x16x32_bf16 a[220:223], a[188:191], a[112:115], a[220:223]
ds_read_b64_tr_b16 a[172:173], v14 offset:49152
ds_read_b64_tr_b16 a[174:175], v14 offset:49664
v_mfma_f32_16x16x32_bf16 a[224:227], a[64:67], a[112:115], a[224:227]
buffer_load_dwordx4 v4, s[24:27], s64 offen sc1 lds
v_mfma_f32_16x16x32_bf16 a[228:231], a[64:67], a[116:119], a[228:231]
ds_read_b128 a[88:91], v4 offset:57344
v_accvgpr_read_b32 v74, a50
v_mfma_f32_16x16x32_bf16 a[232:235], a[64:67], a[120:123], a[232:235]
ds_read_b64_tr_b16 a[80:81], v11 offset:53248
ds_read_b64_tr_b16 a[82:83], v11 offset:53760
v_mfma_f32_16x16x32_bf16 a[236:239], a[64:67], a[124:127], a[236:239]
buffer_store_dwordx4 v[208:211], v4, s[24:27], s53 offen offset:0 sc1
v_mfma_f32_16x16x32_bf16 a[240:243], a[128:131], a[124:127], a[240:243]
s_add_u32 m0, s73, 36864
s_add_u32 s64, s72, 0
ds_read_b128 a[152:155], v4 offset:58368
v_mfma_f32_16x16x32_bf16 a[244:247], a[128:131], a[120:123], a[244:247]
v_accvgpr_read_b32 v75, a51
v_accvgpr_read_b32 v228, a52
v_mfma_f32_16x16x32_bf16 a[248:251], a[128:131], a[116:119], a[248:251]
buffer_load_dwordx4 v5, s[12:15], s64 offen lds
v_mfma_f32_16x16x32_bf16 v[36:39], a[128:131], a[112:115], v[36:39]
ds_read_b64_tr_b16 a[144:145], v12 offset:53248
ds_read_b64_tr_b16 a[146:147], v12 offset:53760
v_mfma_f32_16x16x32_bf16 v[44:47], a[68:71], a[112:115], v[44:47]
ds_read_b128 a[92:95], v4 offset:59392
v_accvgpr_read_b32 v229, a53
v_mfma_f32_16x16x32_bf16 v[32:35], a[68:71], a[116:119], v[32:35]
v_accvgpr_read_b32 v230, a54
v_accvgpr_read_b32 v231, a55
v_mfma_f32_16x16x32_bf16 v[52:55], a[68:71], a[120:123], v[52:55]
ds_read_b64_tr_b16 a[84:85], v13 offset:53248
ds_read_b64_tr_b16 a[86:87], v13 offset:53760
v_mfma_f32_16x16x32_bf16 v[60:63], a[68:71], a[124:127], v[60:63]
v_accvgpr_read_b32 v80, a56
v_accvgpr_read_b32 v81, a57
v_mfma_f32_16x16x32_bf16 v[68:71], a[132:135], a[124:127], v[68:71]
buffer_load_dwordx4 v6, s[12:15], s64 offen offset:1024 lds
v_mfma_f32_16x16x32_bf16 v[76:79], a[132:135], a[120:123], v[76:79]
ds_read_b128 a[156:159], v4 offset:60416
v_accvgpr_read_b32 v82, a58
v_mfma_f32_16x16x32_bf16 v[84:87], a[132:135], a[116:119], v[84:87]
ds_read_b64_tr_b16 a[148:149], v14 offset:53248
ds_read_b64_tr_b16 a[150:151], v14 offset:53760
v_mfma_f32_16x16x32_bf16 v[92:95], a[132:135], a[112:115], v[92:95]
v_accvgpr_read_b32 v83, a59
v_accvgpr_read_b32 v236, a60
v_mfma_f32_16x16x32_bf16 v[100:103], a[72:75], a[112:115], v[100:103]
s_add_u32 m0, s73, 38912
s_add_u32 s64, s72, 18432
v_accvgpr_read_b32 v237, a61
v_mfma_f32_16x16x32_bf16 v[108:111], a[72:75], a[116:119], v[108:111]
v_accvgpr_read_b32 v238, a62
v_accvgpr_read_b32 v239, a63
v_mfma_f32_16x16x32_bf16 v[116:119], a[72:75], a[120:123], v[116:119]
buffer_load_dwordx4 v5, s[12:15], s64 offen lds
v_mfma_f32_16x16x32_bf16 v[40:43], a[72:75], a[124:127], v[40:43]
s_add_u32 s53, s87, 266240
v_accvgpr_read_b32 v244, a192
v_accvgpr_read_b32 v245, a193
v_mfma_f32_16x16x32_bf16 v[124:127], a[136:139], a[124:127], v[124:127]
buffer_store_dwordx4 v[216:219], v4, s[24:27], s53 offen offset:1024 sc1
v_mfma_f32_16x16x32_bf16 v[132:135], a[136:139], a[120:123], v[132:135]
L_PAD5:
s_cbranch_execz L_PAD9
v_accvgpr_read_b32 v246, a194
v_accvgpr_read_b32 v247, a195
v_mfma_f32_16x16x32_bf16 v[140:143], a[136:139], a[116:119], v[140:143]
v_accvgpr_read_b32 v252, a196
v_accvgpr_read_b32 v253, a197
v_mfma_f32_16x16x32_bf16 v[148:151], a[136:139], a[112:115], v[148:151]
v_accvgpr_read_b32 v254, a198
v_accvgpr_read_b32 v255, a199
v_mfma_f32_16x16x32_bf16 v[156:159], a[76:79], a[112:115], v[156:159]
buffer_load_dwordx4 v6, s[12:15], s64 offen offset:1024 lds
v_mfma_f32_16x16x32_bf16 v[48:51], a[76:79], a[116:119], v[48:51]
v_add_u32 v9, -65536, v9
v_add_u32 v10, -65536, v10
v_mfma_f32_16x16x32_bf16 v[164:167], a[76:79], a[120:123], v[164:167]
v_accvgpr_read_b32 v88, a200
v_accvgpr_read_b32 v89, a201
v_mfma_f32_16x16x32_bf16 v[172:175], a[76:79], a[124:127], v[172:175]
v_accvgpr_read_b32 v90, a202
v_accvgpr_read_b32 v91, a203
v_mfma_f32_16x16x32_bf16 v[180:183], a[140:143], a[124:127], v[180:183]
v_mfma_f32_16x16x32_bf16 v[188:191], a[140:143], a[120:123], v[188:191]
v_mfma_f32_16x16x32_bf16 v[196:199], a[140:143], a[116:119], v[196:199]
v_mfma_f32_16x16x32_bf16 v[56:59], a[140:143], a[112:115], v[56:59]
s_waitcnt lgkmcnt(0)
v_mfma_f32_16x16x32_bf16 v[64:67], a[160:163], a[96:99], v[64:67]
s_waitcnt vmcnt(18)
v_mfma_f32_16x16x32_bf16 v[204:207], a[160:163], a[100:103], v[204:207]
s_barrier
v_mfma_f32_16x16x32_bf16 v[212:215], a[160:163], a[104:107], v[212:215]
ds_read_b128 a[112:115], v9 offset:0
v_mfma_f32_16x16x32_bf16 v[220:223], a[160:163], a[108:111], v[220:223]
s_add_u32 m0, s77, 49152
s_add_u32 s64, s76, 262144
v_mfma_f32_16x16x32_bf16 v[72:75], a[164:167], a[108:111], v[72:75]
buffer_load_dwordx4 v7, s[20:23], s64 offen lds
v_mfma_f32_16x16x32_bf16 v[228:231], a[164:167], a[104:107], v[228:231]
ds_read_b64_tr_b16 a[176:177], v11 offset:0
ds_read_b64_tr_b16 a[178:179], v11 offset:512
v_mfma_f32_16x16x32_bf16 v[80:83], a[164:167], a[100:103], v[80:83]
ds_read_b128 a[116:119], v9 offset:2048
v_mfma_f32_16x16x32_bf16 v[236:239], a[164:167], a[96:99], v[236:239]
ds_read_b64_tr_b16 a[180:181], v12 offset:0
ds_read_b64_tr_b16 a[182:183], v12 offset:512
v_mfma_f32_16x16x32_bf16 v[244:247], a[168:171], a[96:99], v[244:247]
ds_read_b128 a[120:123], v9 offset:4096
v_mfma_f32_16x16x32_bf16 v[252:255], a[168:171], a[100:103], v[252:255]
v_mfma_f32_16x16x32_bf16 v[88:91], a[168:171], a[104:107], v[88:91]
buffer_load_dwordx4 v8, s[20:23], s64 offen offset:1024 lds
v_mfma_f32_16x16x32_bf16 a[204:207], a[168:171], a[108:111], a[204:207]
ds_read_b64_tr_b16 a[184:185], v13 offset:0
ds_read_b64_tr_b16 a[186:187], v13 offset:512
v_mfma_f32_16x16x32_bf16 a[208:211], a[172:175], a[108:111], a[208:211]
ds_read_b128 a[124:127], v9 offset:6144
v_mfma_f32_16x16x32_bf16 a[212:215], a[172:175], a[104:107], a[212:215]
v_mfma_f32_16x16x32_bf16 a[216:219], a[172:175], a[100:103], a[216:219]
s_add_u32 m0, s80, 49152
s_add_u32 s64, s79, 4096
s_add_u32 s53, s88, 524288
v_mfma_f32_16x16x32_bf16 a[220:223], a[172:175], a[96:99], a[220:223]
ds_read_b64_tr_b16 a[188:189], v14 offset:0
ds_read_b64_tr_b16 a[190:191], v14 offset:512
v_mfma_f32_16x16x32_bf16 a[224:227], a[80:83], a[96:99], a[224:227]
buffer_load_dwordx4 v4, s[24:27], s64 offen sc1 lds
v_mfma_f32_16x16x32_bf16 a[228:231], a[80:83], a[100:103], a[228:231]
s_xor_b32 s65, s70, 768
s_add_u32 s71, s68, s65
s_add_u32 s72, s69, s65
v_mfma_f32_16x16x32_bf16 a[232:235], a[80:83], a[104:107], a[232:235]
ds_read_b128 a[72:75], v4 offset:8192
v_mfma_f32_16x16x32_bf16 a[236:239], a[80:83], a[108:111], a[236:239]
ds_read_b64_tr_b16 a[64:65], v11 offset:4096
ds_read_b64_tr_b16 a[66:67], v11 offset:4608
v_mfma_f32_16x16x32_bf16 a[240:243], a[144:147], a[108:111], a[240:243]
s_add_u32 m0, s73, 65536
s_add_u32 s64, s71, 0
ds_read_b128 a[136:139], v4 offset:9216
v_mfma_f32_16x16x32_bf16 a[244:247], a[144:147], a[104:107], a[244:247]
buffer_store_dwordx4 v[96:99], v4, s[24:27], s53 offen offset:0 sc1
v_mfma_f32_16x16x32_bf16 a[248:251], a[144:147], a[100:103], a[248:251]
buffer_load_dwordx4 v5, s[12:15], s64 offen lds
v_mfma_f32_16x16x32_bf16 v[36:39], a[144:147], a[96:99], v[36:39]
ds_read_b64_tr_b16 a[128:129], v12 offset:4096
ds_read_b64_tr_b16 a[130:131], v12 offset:4608
v_mfma_f32_16x16x32_bf16 v[44:47], a[84:87], a[96:99], v[44:47]
ds_read_b128 a[76:79], v4 offset:10240
v_accvgpr_read_b32 v160, a204
v_mfma_f32_16x16x32_bf16 v[32:35], a[84:87], a[100:103], v[32:35]
v_accvgpr_read_b32 v161, a205
v_accvgpr_read_b32 v162, a206
v_mfma_f32_16x16x32_bf16 v[52:55], a[84:87], a[104:107], v[52:55]
ds_read_b64_tr_b16 a[68:69], v13 offset:4096
ds_read_b64_tr_b16 a[70:71], v13 offset:4608
v_mfma_f32_16x16x32_bf16 v[60:63], a[84:87], a[108:111], v[60:63]
v_accvgpr_read_b32 v163, a207
v_accvgpr_read_b32 v168, a208
v_mfma_f32_16x16x32_bf16 v[68:71], a[148:151], a[108:111], v[68:71]
buffer_load_dwordx4 v6, s[12:15], s64 offen offset:1024 lds
v_mfma_f32_16x16x32_bf16 v[76:79], a[148:151], a[104:107], v[76:79]
ds_read_b128 a[140:143], v4 offset:11264
v_accvgpr_read_b32 v169, a209
v_mfma_f32_16x16x32_bf16 v[84:87], a[148:151], a[100:103], v[84:87]
ds_read_b64_tr_b16 a[132:133], v14 offset:4096
ds_read_b64_tr_b16 a[134:135], v14 offset:4608
v_mfma_f32_16x16x32_bf16 v[92:95], a[148:151], a[96:99], v[92:95]
v_accvgpr_read_b32 v170, a210
v_accvgpr_read_b32 v171, a211
v_mfma_f32_16x16x32_bf16 v[100:103], a[88:91], a[96:99], v[100:103]
s_add_u32 m0, s73, 67584
s_add_u32 s64, s71, 18432
v_accvgpr_read_b32 v176, a212
v_mfma_f32_16x16x32_bf16 v[108:111], a[88:91], a[100:103], v[108:111]
v_accvgpr_read_b32 v177, a213
v_accvgpr_read_b32 v178, a214
v_mfma_f32_16x16x32_bf16 v[116:119], a[88:91], a[104:107], v[116:119]
buffer_load_dwordx4 v5, s[12:15], s64 offen lds
v_mfma_f32_16x16x32_bf16 v[40:43], a[88:91], a[108:111], v[40:43]
v_accvgpr_read_b32 v179, a215
v_accvgpr_read_b32 v184, a216
v_mfma_f32_16x16x32_bf16 v[124:127], a[152:155], a[108:111], v[124:127]
v_accvgpr_read_b32 v185, a217
v_accvgpr_read_b32 v186, a218
v_mfma_f32_16x16x32_bf16 v[132:135], a[152:155], a[104:107], v[132:135]
v_accvgpr_read_b32 v187, a219
v_accvgpr_read_b32 v248, a220
v_mfma_f32_16x16x32_bf16 v[140:143], a[152:155], a[100:103], v[140:143]
v_accvgpr_read_b32 v249, a221
v_accvgpr_read_b32 v250, a222
v_mfma_f32_16x16x32_bf16 v[148:151], a[152:155], a[96:99], v[148:151]
v_accvgpr_read_b32 v251, a223
v_accvgpr_read_b32 v240, a224
v_mfma_f32_16x16x32_bf16 v[156:159], a[92:95], a[96:99], v[156:159]
buffer_load_dwordx4 v6, s[12:15], s64 offen offset:1024 lds
v_mfma_f32_16x16x32_bf16 v[48:51], a[92:95], a[100:103], v[48:51]
s_add_u32 s53, s88, 524288
v_accvgpr_read_b32 v241, a225
v_accvgpr_read_b32 v242, a226
v_mfma_f32_16x16x32_bf16 v[164:167], a[92:95], a[104:107], v[164:167]
buffer_store_dwordx4 v[104:107], v4, s[24:27], s53 offen offset:1024 sc1
v_mfma_f32_16x16x32_bf16 v[172:175], a[92:95], a[108:111], v[172:175]
v_accvgpr_read_b32 v243, a227
v_accvgpr_read_b32 v232, a228
v_mfma_f32_16x16x32_bf16 v[180:183], a[156:159], a[108:111], v[180:183]
v_accvgpr_read_b32 v233, a229
v_accvgpr_read_b32 v234, a230
v_mfma_f32_16x16x32_bf16 v[188:191], a[156:159], a[104:107], v[188:191]
v_accvgpr_read_b32 v235, a231
v_accvgpr_read_b32 v224, a232
v_mfma_f32_16x16x32_bf16 v[196:199], a[156:159], a[100:103], v[196:199]
v_accvgpr_read_b32 v225, a233
v_accvgpr_read_b32 v226, a234
v_mfma_f32_16x16x32_bf16 v[56:59], a[156:159], a[96:99], v[56:59]
s_waitcnt lgkmcnt(0)
v_accvgpr_read_b32 v227, a235
v_accvgpr_read_b32 v192, a236
v_mfma_f32_16x16x32_bf16 v[64:67], a[176:179], a[112:115], v[64:67]
s_waitcnt vmcnt(23)
v_accvgpr_read_b32 v193, a237
v_accvgpr_read_b32 v194, a238
v_mfma_f32_16x16x32_bf16 v[204:207], a[176:179], a[116:119], v[204:207]
s_barrier
v_mfma_f32_16x16x32_bf16 v[212:215], a[176:179], a[120:123], v[212:215]
ds_read_b128 a[96:99], v10 offset:0
v_accvgpr_read_b32 v195, a239
v_mfma_f32_16x16x32_bf16 v[220:223], a[176:179], a[124:127], v[220:223]
s_xor_b32 s75, s93, 6
s_lshl_b32 s76, s75, 19
s_add_u32 s76, s76, s74
v_mfma_f32_16x16x32_bf16 v[72:75], a[180:183], a[124:127], v[72:75]
s_mul_i32 s79, s75, 8192
s_add_u32 s79, s79, s78
v_accvgpr_read_b32 v152, a240
v_mfma_f32_16x16x32_bf16 v[228:231], a[180:183], a[120:123], v[228:231]
s_add_u32 m0, s77, 0
s_add_u32 s64, s76, 0
v_accvgpr_read_b32 v153, a241
v_mfma_f32_16x16x32_bf16 v[80:83], a[180:183], a[116:119], v[80:83]
buffer_load_dwordx4 v7, s[20:23], s64 offen lds
v_mfma_f32_16x16x32_bf16 v[236:239], a[180:183], a[112:115], v[236:239]
ds_read_b64_tr_b16 a[160:161], v11 offset:16384
ds_read_b64_tr_b16 a[162:163], v11 offset:16896
v_mfma_f32_16x16x32_bf16 v[244:247], a[184:187], a[112:115], v[244:247]
ds_read_b128 a[100:103], v10 offset:2048
v_accvgpr_read_b32 v154, a242
v_mfma_f32_16x16x32_bf16 v[252:255], a[184:187], a[116:119], v[252:255]
ds_read_b64_tr_b16 a[164:165], v12 offset:16384
ds_read_b64_tr_b16 a[166:167], v12 offset:16896
v_mfma_f32_16x16x32_bf16 v[88:91], a[184:187], a[120:123], v[88:91]
buffer_load_dwordx4 v8, s[20:23], s64 offen offset:1024 lds
v_mfma_f32_16x16x32_bf16 v[160:163], a[184:187], a[124:127], v[160:163]
ds_read_b128 a[104:107], v10 offset:4096
v_accvgpr_read_b32 v155, a243
v_mfma_f32_16x16x32_bf16 v[168:171], a[188:191], a[124:127], v[168:171]
ds_read_b64_tr_b16 a[168:169], v13 offset:16384
ds_read_b64_tr_b16 a[170:171], v13 offset:16896
v_mfma_f32_16x16x32_bf16 v[176:179], a[188:191], a[120:123], v[176:179]
ds_read_b128 a[108:111], v10 offset:6144
v_mfma_f32_16x16x32_bf16 v[184:187], a[188:191], a[116:119], v[184:187]
s_add_u32 m0, s80, 0
s_add_u32 s64, s79, 0
v_mfma_f32_16x16x32_bf16 v[248:251], a[188:191], a[112:115], v[248:251]
ds_read_b64_tr_b16 a[172:173], v14 offset:16384
ds_read_b64_tr_b16 a[174:175], v14 offset:16896
v_mfma_f32_16x16x32_bf16 v[240:243], a[64:67], a[112:115], v[240:243]
buffer_load_dwordx4 v4, s[24:27], s64 offen sc1 lds
v_mfma_f32_16x16x32_bf16 v[232:235], a[64:67], a[116:119], v[232:235]
ds_read_b128 a[88:91], v4 offset:24576
v_mfma_f32_16x16x32_bf16 v[224:227], a[64:67], a[120:123], v[224:227]
ds_read_b64_tr_b16 a[80:81], v11 offset:20480
ds_read_b64_tr_b16 a[82:83], v11 offset:20992
v_mfma_f32_16x16x32_bf16 v[192:195], a[64:67], a[124:127], v[192:195]
v_mfma_f32_16x16x32_bf16 v[152:155], a[128:131], a[124:127], v[152:155]
s_add_u32 m0, s73, 69632
s_add_u32 s64, s72, 0
ds_read_b128 a[152:155], v4 offset:25600
v_mfma_f32_16x16x32_bf16 a[244:247], a[128:131], a[120:123], a[244:247]
s_add_u32 s53, s88, 524288
v_mfma_f32_16x16x32_bf16 a[248:251], a[128:131], a[116:119], a[248:251]
buffer_load_dwordx4 v5, s[12:15], s64 offen lds
v_mfma_f32_16x16x32_bf16 v[36:39], a[128:131], a[112:115], v[36:39]
ds_read_b64_tr_b16 a[144:145], v12 offset:20480
ds_read_b64_tr_b16 a[146:147], v12 offset:20992
v_mfma_f32_16x16x32_bf16 v[44:47], a[68:71], a[112:115], v[44:47]
ds_read_b128 a[92:95], v4 offset:26624
v_mfma_f32_16x16x32_bf16 v[32:35], a[68:71], a[116:119], v[32:35]
buffer_store_dwordx4 v[112:115], v4, s[24:27], s53 offen offset:2048 sc1
v_mfma_f32_16x16x32_bf16 v[52:55], a[68:71], a[120:123], v[52:55]
ds_read_b64_tr_b16 a[84:85], v13 offset:20480
ds_read_b64_tr_b16 a[86:87], v13 offset:20992
v_mfma_f32_16x16x32_bf16 v[60:63], a[68:71], a[124:127], v[60:63]
v_mfma_f32_16x16x32_bf16 v[68:71], a[132:135], a[124:127], v[68:71]
buffer_load_dwordx4 v6, s[12:15], s64 offen offset:1024 lds
v_mfma_f32_16x16x32_bf16 v[76:79], a[132:135], a[120:123], v[76:79]
ds_read_b128 a[156:159], v4 offset:27648
v_accvgpr_read_b32 v200, a244
v_mfma_f32_16x16x32_bf16 v[84:87], a[132:135], a[116:119], v[84:87]
ds_read_b64_tr_b16 a[148:149], v14 offset:20480
ds_read_b64_tr_b16 a[150:151], v14 offset:20992
v_mfma_f32_16x16x32_bf16 v[92:95], a[132:135], a[112:115], v[92:95]
v_accvgpr_read_b32 v201, a245
v_accvgpr_read_b32 v202, a246
v_mfma_f32_16x16x32_bf16 v[100:103], a[72:75], a[112:115], v[100:103]
s_add_u32 m0, s73, 71680
s_add_u32 s64, s72, 18432
v_accvgpr_read_b32 v203, a247
v_mfma_f32_16x16x32_bf16 v[108:111], a[72:75], a[116:119], v[108:111]
v_accvgpr_read_b32 v208, a248
v_accvgpr_read_b32 v209, a249
v_mfma_f32_16x16x32_bf16 v[116:119], a[72:75], a[120:123], v[116:119]
buffer_load_dwordx4 v5, s[12:15], s64 offen lds
v_mfma_f32_16x16x32_bf16 v[40:43], a[72:75], a[124:127], v[40:43]
v_accvgpr_read_b32 v210, a250
v_accvgpr_read_b32 v211, a251
v_mfma_f32_16x16x32_bf16 v[124:127], a[136:139], a[124:127], v[124:127]
s_lshr_b32 s84, s7, 1
s_and_b32 s85, s7, 1
s_xor_b32 s52, s5, 7
v_mfma_f32_16x16x32_bf16 v[132:135], a[136:139], a[120:123], v[132:135]
s_lshl1_add_u32 s85, s52, s85
s_and_b32 s86, s6, 3
s_lshl_b32 s83, s3, 13
v_mfma_f32_16x16x32_bf16 v[140:143], a[136:139], a[116:119], v[140:143]
s_add_u32 s83, s83, 131072
s_mul_i32 s52, s2, 5462
s_lshr_b32 s52, s52, 16
v_mfma_f32_16x16x32_bf16 v[148:151], a[136:139], a[112:115], v[148:151]
s_mul_i32 s54, s52, 12
s_sub_u32 s54, s2, s54
s_mul_i32 s54, s54, 3
v_mfma_f32_16x16x32_bf16 v[156:159], a[76:79], a[112:115], v[156:159]
buffer_load_dwordx4 v6, s[12:15], s64 offen offset:1024 lds
v_mfma_f32_16x16x32_bf16 v[48:51], a[76:79], a[116:119], v[48:51]
s_add_u32 s54, s54, s3
v_add_u32 v9, 32768, v9
v_add_u32 v10, 32768, v10
v_mfma_f32_16x16x32_bf16 v[164:167], a[76:79], a[120:123], v[164:167]
s_mul_i32 s55, s52, 13108
s_lshr_b32 s55, s55, 16
s_mul_i32 s82, s55, 5
v_mfma_f32_16x16x32_bf16 v[172:175], a[76:79], a[124:127], v[172:175]
s_sub_u32 s52, s52, s82
v_mfma_f32_16x16x32_bf16 v[180:183], a[140:143], a[124:127], v[180:183]
v_lshrrev_b32 v16, 1, v1
v_and_b32 v17, 1, v1
v_mfma_f32_16x16x32_bf16 v[188:191], a[140:143], a[120:123], v[188:191]
v_mul_u32_u24 v18, 1152, v16
v_lshl_add_u32 v18, v17, 4, v18
v_mfma_f32_16x16x32_bf16 v[196:199], a[140:143], a[116:119], v[196:199]
v_mov_b32 v24, v18
v_lshrrev_b32 v18, 4, v16
v_mfma_f32_16x16x32_bf16 v[56:59], a[140:143], a[112:115], v[56:59]
s_waitcnt lgkmcnt(0)
s_add_u32 s53, s88, 524288
v_bfe_u32 v19, v16, 2, 2
v_mfma_f32_16x16x32_bf16 v[64:67], a[160:163], a[96:99], v[64:67]
s_waitcnt vmcnt(17)
v_and_b32 v16, 3, v16
v_lshrrev_b32 v20, 1, v19
v_mfma_f32_16x16x32_bf16 v[204:207], a[160:163], a[100:103], v[204:207]
s_barrier
v_mfma_f32_16x16x32_bf16 v[212:215], a[160:163], a[104:107], v[212:215]
ds_read_b128 a[112:115], v9 offset:0
v_mul_u32_u24 v20, 18, v20
v_mfma_f32_16x16x32_bf16 v[220:223], a[160:163], a[108:111], v[220:223]
s_add_u32 m0, s77, 16384
s_add_u32 s64, s76, 262144
v_and_b32 v21, 1, v19
v_mfma_f32_16x16x32_bf16 v[72:75], a[164:167], a[108:111], v[72:75]
buffer_load_dwordx4 v7, s[20:23], s64 offen lds
v_mfma_f32_16x16x32_bf16 v[228:231], a[164:167], a[104:107], v[228:231]
ds_read_b64_tr_b16 a[176:177], v11 offset:32768
ds_read_b64_tr_b16 a[178:179], v11 offset:33280
v_mfma_f32_16x16x32_bf16 v[80:83], a[164:167], a[100:103], v[80:83]
ds_read_b128 a[116:119], v9 offset:2048
v_lshl_add_u32 v20, v21, 1, v20
v_mfma_f32_16x16x32_bf16 v[236:239], a[164:167], a[96:99], v[236:239]
ds_read_b64_tr_b16 a[180:181], v12 offset:32768
ds_read_b64_tr_b16 a[182:183], v12 offset:33280
v_mfma_f32_16x16x32_bf16 v[244:247], a[168:171], a[96:99], v[244:247]
ds_read_b128 a[120:123], v9 offset:4096
v_lshl_add_u32 v20, v16, 2, v20
v_mfma_f32_16x16x32_bf16 v[252:255], a[168:171], a[100:103], v[252:255]
buffer_store_dwordx4 v[120:123], v4, s[24:27], s53 offen offset:3072 sc1
v_mfma_f32_16x16x32_bf16 v[88:91], a[168:171], a[104:107], v[88:91]
buffer_load_dwordx4 v8, s[20:23], s64 offen offset:1024 lds
v_mfma_f32_16x16x32_bf16 v[160:163], a[168:171], a[108:111], v[160:163]
ds_read_b64_tr_b16 a[184:185], v13 offset:32768
ds_read_b64_tr_b16 a[186:187], v13 offset:33280
v_mfma_f32_16x16x32_bf16 v[168:171], a[172:175], a[108:111], v[168:171]
ds_read_b128 a[124:127], v9 offset:6144
v_add_u32 v20, v20, v18
v_mfma_f32_16x16x32_bf16 v[176:179], a[172:175], a[104:107], v[176:179]
buffer_atomic_add v1, v0, s[24:27], s90 offen offset:4 sc1
v_mfma_f32_16x16x32_bf16 v[184:187], a[172:175], a[100:103], v[184:187]
s_add_u32 m0, s80, 16384
s_add_u32 s64, s79, 4096
v_mad_u32_u24 v20, s52, 36, v20
v_mfma_f32_16x16x32_bf16 v[248:251], a[172:175], a[96:99], v[248:251]
ds_read_b64_tr_b16 a[188:189], v14 offset:32768
ds_read_b64_tr_b16 a[190:191], v14 offset:33280
v_mfma_f32_16x16x32_bf16 v[240:243], a[80:83], a[96:99], v[240:243]
buffer_load_dwordx4 v4, s[24:27], s64 offen sc1 lds
v_mfma_f32_16x16x32_bf16 v[232:235], a[80:83], a[100:103], v[232:235]
s_xor_b32 s65, s70, 896
s_add_u32 s71, s68, s65
s_add_u32 s72, s69, s65
v_mfma_f32_16x16x32_bf16 v[224:227], a[80:83], a[104:107], v[224:227]
ds_read_b128 a[72:75], v4 offset:40960
v_lshlrev_b32 v21, 1, v18
v_mfma_f32_16x16x32_bf16 v[192:195], a[80:83], a[108:111], v[192:195]
ds_read_b64_tr_b16 a[64:65], v11 offset:36864
ds_read_b64_tr_b16 a[66:67], v11 offset:37376
v_mfma_f32_16x16x32_bf16 v[152:155], a[144:147], a[108:111], v[152:155]
s_add_u32 m0, s73, 0
s_add_u32 s64, s71, 0
ds_read_b128 a[136:139], v4 offset:41984
v_mfma_f32_16x16x32_bf16 v[200:203], a[144:147], a[104:107], v[200:203]
v_lshl_add_u32 v21, v19, 2, v21
v_lshrrev_b32 v22, 1, v16
v_mfma_f32_16x16x32_bf16 v[208:211], a[144:147], a[100:103], v[208:211]
buffer_load_dwordx4 v5, s[12:15], s64 offen lds
v_mfma_f32_16x16x32_bf16 v[36:39], a[144:147], a[96:99], v[36:39]
ds_read_b64_tr_b16 a[128:129], v12 offset:36864
ds_read_b64_tr_b16 a[130:131], v12 offset:37376
v_mfma_f32_16x16x32_bf16 v[44:47], a[84:87], a[96:99], v[44:47]
ds_read_b128 a[76:79], v4 offset:43008
v_add_u32 v21, v21, v22
v_mfma_f32_16x16x32_bf16 v[32:35], a[84:87], a[100:103], v[32:35]
v_mul_u32_u24 v21, 18, v21
v_and_b32 v22, 1, v16
v_mfma_f32_16x16x32_bf16 v[52:55], a[84:87], a[104:107], v[52:55]
s_add_u32 s53, s88, 786432
ds_read_b64_tr_b16 a[68:69], v13 offset:36864
ds_read_b64_tr_b16 a[70:71], v13 offset:37376
v_mfma_f32_16x16x32_bf16 v[60:63], a[84:87], a[108:111], v[60:63]
buffer_store_dwordx4 v[128:131], v4, s[24:27], s53 offen offset:0 sc1
v_mfma_f32_16x16x32_bf16 v[68:71], a[148:151], a[108:111], v[68:71]
buffer_load_dwordx4 v6, s[12:15], s64 offen offset:1024 lds
v_mfma_f32_16x16x32_bf16 v[76:79], a[148:151], a[104:107], v[76:79]
ds_read_b128 a[140:143], v4 offset:44032
v_add3_u32 v21, v21, v22, 16
v_mfma_f32_16x16x32_bf16 v[84:87], a[148:151], a[100:103], v[84:87]
ds_read_b64_tr_b16 a[132:133], v14 offset:36864
ds_read_b64_tr_b16 a[134:135], v14 offset:37376
v_mfma_f32_16x16x32_bf16 v[92:95], a[148:151], a[96:99], v[92:95]
v_cmp_lt_u32 s[96:97], 1, v19
v_mov_b32 v22, 0x100000
v_mfma_f32_16x16x32_bf16 v[100:103], a[88:91], a[96:99], v[100:103]
s_add_u32 m0, s73, 2048
s_add_u32 s64, s71, 18432
v_mul_u32_u24 v23, 1, v23
v_mfma_f32_16x16x32_bf16 v[108:111], a[88:91], a[100:103], v[108:111]
v_cndmask_b32 v21, v21, v22, s[96:97]
v_mov_b32 v22, s52
v_mfma_f32_16x16x32_bf16 v[116:119], a[88:91], a[104:107], v[116:119]
buffer_load_dwordx4 v5, s[12:15], s64 offen lds
v_mfma_f32_16x16x32_bf16 v[40:43], a[88:91], a[108:111], v[40:43]
v_cmp_eq_u32 s[96:97], 4, v22
v_mfma_f32_16x16x32_bf16 v[124:127], a[152:155], a[108:111], v[124:127]
v_mfma_f32_16x16x32_bf16 v[132:135], a[152:155], a[104:107], v[132:135]
v_cndmask_b32 v20, v20, v21, s[96:97]
v_mul_u32_u24 v20, 1152, v20
v_mfma_f32_16x16x32_bf16 v[140:143], a[152:155], a[100:103], v[140:143]
v_lshl_add_u32 v20, v17, 4, v20
v_mov_b32 v25, v20
v_mfma_f32_16x16x32_bf16 v[148:151], a[152:155], a[96:99], v[148:151]
v_mov_b32 v16, s54
v_mov_b32 v17, s55
v_mfma_f32_16x16x32_bf16 v[156:159], a[92:95], a[96:99], v[156:159]
buffer_load_dwordx4 v6, s[12:15], s64 offen offset:1024 lds
v_mfma_f32_16x16x32_bf16 v[48:51], a[92:95], a[100:103], v[48:51]
v_add_u32 v18, 32, v22
v_mfma_f32_16x16x32_bf16 v[164:167], a[92:95], a[104:107], v[164:167]
s_mul_i32 s82, s55, 165888
s_lshl_b32 s54, s54, 5
s_add_u32 s82, s82, s54
v_mfma_f32_16x16x32_bf16 v[172:175], a[92:95], a[108:111], v[172:175]
s_and_b32 s52, s2, 1
s_lshr_b32 s54, s3, 1
s_lshl1_add_u32 s52, s52, s54
v_mfma_f32_16x16x32_bf16 v[180:183], a[156:159], a[108:111], v[180:183]
s_mul_i32 s52, s52, 9
s_and_b32 s54, s3, 1
s_mul_i32 s55, s54, 5
v_mfma_f32_16x16x32_bf16 v[188:191], a[156:159], a[104:107], v[188:191]
s_add_u32 s52, s52, s55
s_lshr_b32 s55, s2, 1
s_mul_i32 s81, s55, 1152
v_mfma_f32_16x16x32_bf16 v[196:199], a[156:159], a[100:103], v[196:199]
s_add_u32 s81, s81, s52
s_lshl_b32 s81, s81, 5
v_mfma_f32_16x16x32_bf16 v[56:59], a[156:159], a[96:99], v[56:59]
s_waitcnt lgkmcnt(0)
v_cmp_gt_u32 s[96:97], 5, v1
v_add_u32 v19, s52, v1
v_mfma_f32_16x16x32_bf16 v[64:67], a[176:179], a[112:115], v[64:67]
s_waitcnt vmcnt(24)
v_lshrrev_b32 v20, 5, s55
v_and_b32 v21, 31, s55
v_mfma_f32_16x16x32_bf16 v[204:207], a[176:179], a[116:119], v[204:207]
s_barrier
v_mfma_f32_16x16x32_bf16 v[212:215], a[176:179], a[120:123], v[212:215]
ds_read_b128 a[96:99], v10 offset:0
v_cndmask_b32 v16, v16, v19, s[96:97]
v_mfma_f32_16x16x32_bf16 v[220:223], a[176:179], a[124:127], v[220:223]
s_xor_b32 s75, s93, 7
s_lshl_b32 s76, s75, 19
s_add_u32 s76, s76, s74
v_mfma_f32_16x16x32_bf16 v[72:75], a[180:183], a[124:127], v[72:75]
s_mul_i32 s79, s75, 8192
s_add_u32 s79, s79, s78
v_cndmask_b32 v17, v17, v20, s[96:97]
v_mfma_f32_16x16x32_bf16 v[228:231], a[180:183], a[120:123], v[228:231]
s_add_u32 m0, s77, 32768
s_add_u32 s64, s76, 0
s_add_u32 s53, s88, 786432
v_mfma_f32_16x16x32_bf16 v[80:83], a[180:183], a[116:119], v[80:83]
buffer_load_dwordx4 v7, s[20:23], s64 offen lds
v_mfma_f32_16x16x32_bf16 v[236:239], a[180:183], a[112:115], v[236:239]
ds_read_b64_tr_b16 a[160:161], v11 offset:49152
ds_read_b64_tr_b16 a[162:163], v11 offset:49664
v_mfma_f32_16x16x32_bf16 v[244:247], a[184:187], a[112:115], v[244:247]
ds_read_b128 a[100:103], v10 offset:2048
v_cndmask_b32 v18, v18, v21, s[96:97]
v_mfma_f32_16x16x32_bf16 v[252:255], a[184:187], a[116:119], v[252:255]
ds_read_b64_tr_b16 a[164:165], v12 offset:49152
ds_read_b64_tr_b16 a[166:167], v12 offset:49664
v_mfma_f32_16x16x32_bf16 v[88:91], a[184:187], a[120:123], v[88:91]
buffer_load_dwordx4 v8, s[20:23], s64 offen offset:1024 lds
v_mfma_f32_16x16x32_bf16 v[160:163], a[184:187], a[124:127], v[160:163]
ds_read_b128 a[104:107], v10 offset:4096
v_mul_u32_u24 v19, 7282, v16
v_mfma_f32_16x16x32_bf16 v[168:171], a[188:191], a[124:127], v[168:171]
ds_read_b64_tr_b16 a[168:169], v13 offset:49152
ds_read_b64_tr_b16 a[170:171], v13 offset:49664
v_mfma_f32_16x16x32_bf16 v[176:179], a[188:191], a[120:123], v[176:179]
ds_read_b128 a[108:111], v10 offset:6144
v_lshrrev_b32 v19, 16, v19
v_mfma_f32_16x16x32_bf16 v[184:187], a[188:191], a[116:119], v[184:187]
s_add_u32 m0, s80, 32768
s_add_u32 s64, s79, 0
v_mul_u32_u24 v20, 9, v19
v_mfma_f32_16x16x32_bf16 v[248:251], a[188:191], a[112:115], v[248:251]
ds_read_b64_tr_b16 a[172:173], v14 offset:49152
ds_read_b64_tr_b16 a[174:175], v14 offset:49664
v_mfma_f32_16x16x32_bf16 v[240:243], a[64:67], a[112:115], v[240:243]
buffer_load_dwordx4 v4, s[24:27], s64 offen sc1 lds
v_mfma_f32_16x16x32_bf16 v[232:235], a[64:67], a[116:119], v[232:235]
ds_read_b128 a[88:91], v4 offset:57344
v_sub_u32 v16, v16, v20
v_mfma_f32_16x16x32_bf16 v[224:227], a[64:67], a[120:123], v[224:227]
ds_read_b64_tr_b16 a[80:81], v11 offset:53248
ds_read_b64_tr_b16 a[82:83], v11 offset:53760
v_mfma_f32_16x16x32_bf16 v[192:195], a[64:67], a[124:127], v[192:195]
buffer_store_dwordx4 v[136:139], v4, s[24:27], s53 offen offset:1024 sc1
v_mfma_f32_16x16x32_bf16 v[152:155], a[128:131], a[124:127], v[152:155]
s_add_u32 m0, s73, 4096
s_add_u32 s64, s72, 0
ds_read_b128 a[152:155], v4 offset:58368
v_mfma_f32_16x16x32_bf16 v[200:203], a[128:131], a[120:123], v[200:203]
v_and_b32 v20, 1, v19
v_lshlrev_b32 v20, 2, v20
v_mfma_f32_16x16x32_bf16 v[208:211], a[128:131], a[116:119], v[208:211]
buffer_load_dwordx4 v5, s[12:15], s64 offen lds
v_mfma_f32_16x16x32_bf16 v[36:39], a[128:131], a[112:115], v[36:39]
ds_read_b64_tr_b16 a[144:145], v12 offset:53248
ds_read_b64_tr_b16 a[146:147], v12 offset:53760
v_mfma_f32_16x16x32_bf16 v[44:47], a[68:71], a[112:115], v[44:47]
ds_read_b128 a[92:95], v4 offset:59392
v_cndmask_b32 v20, 0, v20, s[96:97]
v_mfma_f32_16x16x32_bf16 v[32:35], a[68:71], a[116:119], v[32:35]
v_xor_b32 v18, v18, v20
v_lshl_add_u32 v19, v19, 2, v17
v_mfma_f32_16x16x32_bf16 v[52:55], a[68:71], a[120:123], v[52:55]
ds_read_b64_tr_b16 a[84:85], v13 offset:53248
ds_read_b64_tr_b16 a[86:87], v13 offset:53760
v_mfma_f32_16x16x32_bf16 v[60:63], a[68:71], a[124:127], v[60:63]
v_mul_u32_u24 v19, 344064, v19
v_lshrrev_b32 v20, 1, v16
v_mfma_f32_16x16x32_bf16 v[68:71], a[132:135], a[124:127], v[68:71]
buffer_load_dwordx4 v6, s[12:15], s64 offen offset:1024 lds
v_mfma_f32_16x16x32_bf16 v[76:79], a[132:135], a[120:123], v[76:79]
ds_read_b128 a[156:159], v4 offset:60416
v_sub_u32 v20, v20, v17
v_mfma_f32_16x16x32_bf16 v[84:87], a[132:135], a[116:119], v[84:87]
ds_read_b64_tr_b16 a[148:149], v14 offset:53248
ds_read_b64_tr_b16 a[150:151], v14 offset:53760
v_mfma_f32_16x16x32_bf16 v[92:95], a[132:135], a[112:115], v[92:95]
v_add_u32 v20, 3, v20
v_and_b32 v20, 3, v20
v_mfma_f32_16x16x32_bf16 v[100:103], a[72:75], a[112:115], v[100:103]
s_add_u32 m0, s73, 6144
s_add_u32 s64, s72, 18432
s_add_u32 s53, s88, 786432
v_mfma_f32_16x16x32_bf16 v[108:111], a[72:75], a[116:119], v[108:111]
buffer_store_dwordx4 v[144:147], v4, s[24:27], s53 offen offset:2048 sc1
v_mfma_f32_16x16x32_bf16 v[116:119], a[72:75], a[120:123], v[116:119]
buffer_load_dwordx4 v5, s[12:15], s64 offen lds
v_mfma_f32_16x16x32_bf16 v[40:43], a[72:75], a[124:127], v[40:43]
v_cmp_eq_u32 s[96:97], 8, v16
v_and_b32 v16, 1, v16
v_mfma_f32_16x16x32_bf16 v[124:127], a[136:139], a[124:127], v[124:127]
v_lshlrev_b32 v21, 1, v20
v_lshlrev_b32 v22, 1, v18
v_mfma_f32_16x16x32_bf16 v[132:135], a[136:139], a[120:123], v[132:135]
v_min_u32 v23, 16, v18
v_mfma_f32_16x16x32_bf16 v[140:143], a[136:139], a[116:119], v[140:143]
v_add_u32 v21, 1, v21
v_cndmask_b32 v21, v21, 0, s[96:97]
v_mfma_f32_16x16x32_bf16 v[148:151], a[136:139], a[112:115], v[148:151]
v_cndmask_b32 v20, v20, 0, s[96:97]
v_mad_u32_u24 v21, v18, 5, v21
v_mfma_f32_16x16x32_bf16 v[156:159], a[76:79], a[112:115], v[156:159]
buffer_load_dwordx4 v6, s[12:15], s64 offen offset:1024 lds
v_mfma_f32_16x16x32_bf16 v[48:51], a[76:79], a[116:119], v[48:51]
v_add_u32 v9, 32768, v9
v_add_u32 v10, 32768, v10
v_mfma_f32_16x16x32_bf16 v[164:167], a[76:79], a[120:123], v[164:167]
v_lshl_add_u32 v21, v23, 1, v21
v_mad_u32_u24 v22, v20, 37, v22
v_mfma_f32_16x16x32_bf16 v[172:175], a[76:79], a[124:127], v[172:175]
L_PAD6:
s_cbranch_execz L_PAD10
v_mad_u32_u24 v22, v20, 37, v22
v_lshl_add_u32 v20, v20, 6, v18
v_mfma_f32_16x16x32_bf16 v[180:183], a[140:143], a[124:127], v[180:183]
v_mov_b32 v23, 144
v_cmp_gt_u32 s[96:97], v23, v20
v_mfma_f32_16x16x32_bf16 v[188:191], a[140:143], a[120:123], v[188:191]
v_add_u32 v22, 37, v22
v_add_u32 v19, 38797312, v19
v_mfma_f32_16x16x32_bf16 v[196:199], a[140:143], a[116:119], v[196:199]
v_cndmask_b32 v21, v22, v21, s[96:97]
v_add_u32 v21, v21, v16
v_mfma_f32_16x16x32_bf16 v[56:59], a[140:143], a[112:115], v[56:59]
s_waitcnt lgkmcnt(0)
v_lshl_add_u32 v19, v21, 10, v19
v_mfma_f32_16x16x32_bf16 v[64:67], a[160:163], a[96:99], v[64:67]
s_waitcnt vmcnt(19)
s_cmp_eq_u32 s54, 1
s_cselect_b32 s96, 16, 0
v_mfma_f32_16x16x32_bf16 v[204:207], a[160:163], a[100:103], v[204:207]
s_barrier
v_mfma_f32_16x16x32_bf16 v[212:215], a[160:163], a[104:107], v[212:215]
s_cmp_eq_u32 s3, 3
s_cselect_b32 s52, 32, 0
ds_read_b128 a[112:115], v9 offset:0
v_mfma_f32_16x16x32_bf16 v[220:223], a[160:163], a[108:111], v[220:223]
s_add_u32 m0, s77, 49152
s_add_u32 s64, s76, 262144
s_or_b32 s96, s96, s52
v_mfma_f32_16x16x32_bf16 v[72:75], a[164:167], a[108:111], v[72:75]
buffer_load_dwordx4 v7, s[20:23], s64 offen lds
v_mfma_f32_16x16x32_bf16 v[228:231], a[164:167], a[104:107], v[228:231]
ds_read_b64_tr_b16 a[176:177], v11 offset:0
ds_read_b64_tr_b16 a[178:179], v11 offset:512
v_mfma_f32_16x16x32_bf16 v[80:83], a[164:167], a[100:103], v[80:83]
s_cmp_ge_u32 s2, 240
s_cselect_b32 s52, 32, 0
ds_read_b128 a[116:119], v9 offset:2048
v_mfma_f32_16x16x32_bf16 v[236:239], a[164:167], a[96:99], v[236:239]
s_or_b32 s96, s96, s52
ds_read_b64_tr_b16 a[180:181], v12 offset:0
ds_read_b64_tr_b16 a[182:183], v12 offset:512
v_mfma_f32_16x16x32_bf16 v[244:247], a[168:171], a[96:99], v[244:247]
s_mov_b32 s97, 0
ds_read_b128 a[120:123], v9 offset:4096
v_mfma_f32_16x16x32_bf16 v[252:255], a[168:171], a[100:103], v[252:255]
buffer_load_dword v30, v29, s[24:27], s89 offen offset:4 sc1
v_mfma_f32_16x16x32_bf16 v[88:91], a[168:171], a[104:107], v[88:91]
buffer_load_dwordx4 v8, s[20:23], s64 offen offset:1024 lds
v_mfma_f32_16x16x32_bf16 v[160:163], a[168:171], a[108:111], v[160:163]
s_add_u32 s53, s88, 786432
ds_read_b64_tr_b16 a[184:185], v13 offset:0
ds_read_b64_tr_b16 a[186:187], v13 offset:512
v_mfma_f32_16x16x32_bf16 v[168:171], a[172:175], a[108:111], v[168:171]
ds_read_b128 a[124:127], v9 offset:6144
v_mov_b32 v20, 2147418112
v_mfma_f32_16x16x32_bf16 v[176:179], a[172:175], a[104:107], v[176:179]
buffer_store_dwordx4 a[32:35], v4, s[24:27], s53 offen offset:3072 sc1
v_mfma_f32_16x16x32_bf16 v[184:187], a[172:175], a[100:103], v[184:187]
s_add_u32 m0, s80, 49152
s_add_u32 s64, s79, 4096
v_cndmask_b32 v26, v19, v20, s[96:97]
v_mfma_f32_16x16x32_bf16 v[248:251], a[172:175], a[96:99], v[248:251]
ds_read_b64_tr_b16 a[188:189], v14 offset:0
ds_read_b64_tr_b16 a[190:191], v14 offset:512
v_mfma_f32_16x16x32_bf16 v[240:243], a[80:83], a[96:99], v[240:243]
buffer_load_dwordx4 v4, s[24:27], s64 offen sc1 lds
v_mfma_f32_16x16x32_bf16 v[232:235], a[80:83], a[100:103], v[232:235]
s_mov_b32 s65, 1024
s_add_u32 s71, s68, s65
s_add_u32 s72, s69, s65
v_mfma_f32_16x16x32_bf16 v[224:227], a[80:83], a[104:107], v[224:227]
ds_read_b128 a[72:75], v4 offset:8192
v_lshlrev_b32 v27, 3, v1
v_mfma_f32_16x16x32_bf16 v[192:195], a[80:83], a[108:111], v[192:195]
ds_read_b64_tr_b16 a[64:65], v11 offset:4096
ds_read_b64_tr_b16 a[66:67], v11 offset:4608
v_mfma_f32_16x16x32_bf16 v[152:155], a[144:147], a[108:111], v[152:155]
s_add_u32 m0, s73, 32768
s_add_u32 s64, s71, 0
ds_read_b128 a[136:139], v4 offset:9216
v_mfma_f32_16x16x32_bf16 v[200:203], a[144:147], a[104:107], v[200:203]
v_add_u32 v27, s83, v27
v_lshrrev_b32 v22, 3, v1
v_mfma_f32_16x16x32_bf16 v[208:211], a[144:147], a[100:103], v[208:211]
buffer_load_dwordx4 v5, s[12:15], s64 offen lds
v_mfma_f32_16x16x32_bf16 v[36:39], a[144:147], a[96:99], v[36:39]
ds_read_b64_tr_b16 a[128:129], v12 offset:4096
ds_read_b64_tr_b16 a[130:131], v12 offset:4608
v_mfma_f32_16x16x32_bf16 v[44:47], a[84:87], a[96:99], v[44:47]
ds_read_b128 a[76:79], v4 offset:10240
v_mul_u32_u24 v22, 1152, v22
v_mfma_f32_16x16x32_bf16 v[32:35], a[84:87], a[100:103], v[32:35]
v_and_b32 v23, 7, v1
v_lshl_add_u32 v22, v23, 4, v22
v_mfma_f32_16x16x32_bf16 v[52:55], a[84:87], a[104:107], v[52:55]
ds_read_b64_tr_b16 a[68:69], v13 offset:4096
ds_read_b64_tr_b16 a[70:71], v13 offset:4608
v_mfma_f32_16x16x32_bf16 v[60:63], a[84:87], a[108:111], v[60:63]
v_lshrrev_b32 v23, 2, v1
v_mul_u32_u24 v23, 96, v23
v_mfma_f32_16x16x32_bf16 v[68:71], a[148:151], a[108:111], v[68:71]
buffer_load_dwordx4 v6, s[12:15], s64 offen offset:1024 lds
v_mfma_f32_16x16x32_bf16 v[76:79], a[148:151], a[104:107], v[76:79]
ds_read_b128 a[140:143], v4 offset:11264
v_add_u32 v23, v23, v27
v_mfma_f32_16x16x32_bf16 v[84:87], a[148:151], a[100:103], v[84:87]
ds_read_b64_tr_b16 a[132:133], v14 offset:4096
ds_read_b64_tr_b16 a[134:135], v14 offset:4608
v_mfma_f32_16x16x32_bf16 v[92:95], a[148:151], a[96:99], v[92:95]
v_mov_b32 v16, 0x3f803f80
v_accvgpr_write_b32 a240, v16
v_mfma_f32_16x16x32_bf16 v[100:103], a[88:91], a[96:99], v[100:103]
s_add_u32 m0, s73, 34816
s_add_u32 s64, s71, 18432
v_accvgpr_write_b32 a241, v16
v_mfma_f32_16x16x32_bf16 v[108:111], a[88:91], a[100:103], v[108:111]
v_accvgpr_write_b32 a242, v16
v_accvgpr_write_b32 a243, v16
v_mfma_f32_16x16x32_bf16 v[116:119], a[88:91], a[104:107], v[116:119]
buffer_load_dwordx4 v5, s[12:15], s64 offen lds
v_mfma_f32_16x16x32_bf16 v[40:43], a[88:91], a[108:111], v[40:43]
v_accvgpr_write_b32 a232, 0
v_accvgpr_write_b32 a233, 0
v_mfma_f32_16x16x32_bf16 v[124:127], a[152:155], a[108:111], v[124:127]
v_accvgpr_write_b32 a234, 0
v_accvgpr_write_b32 a235, 0
v_mfma_f32_16x16x32_bf16 v[132:135], a[152:155], a[104:107], v[132:135]
v_accvgpr_write_b32 a236, 0
v_accvgpr_write_b32 a237, 0
v_mfma_f32_16x16x32_bf16 v[140:143], a[152:155], a[100:103], v[140:143]
s_add_u32 s53, s87, 524288
v_accvgpr_write_b32 a238, 0
v_accvgpr_write_b32 a239, 0
v_mfma_f32_16x16x32_bf16 v[148:151], a[152:155], a[96:99], v[148:151]
buffer_store_dwordx4 a[28:31], v4, s[24:27], s53 offen offset:0 sc1
v_mfma_f32_16x16x32_bf16 v[156:159], a[92:95], a[96:99], v[156:159]
buffer_load_dwordx4 v6, s[12:15], s64 offen offset:1024 lds
v_mfma_f32_16x16x32_bf16 v[48:51], a[92:95], a[100:103], v[48:51]
v_lshlrev_b32 v16, 2, v3
v_sub_u32 v16, v2, v16
v_mfma_f32_16x16x32_bf16 v[164:167], a[92:95], a[104:107], v[164:167]
v_cmp_gt_i32 s[56:57], 0, v16
v_cmp_gt_i32 s[58:59], 1, v16
v_mfma_f32_16x16x32_bf16 v[172:175], a[92:95], a[108:111], v[172:175]
v_cmp_gt_i32 s[60:61], 2, v16
v_cmp_gt_i32 s[62:63], 3, v16
v_mfma_f32_16x16x32_bf16 v[180:183], a[156:159], a[108:111], v[180:183]
v_cmp_eq_u32 s[96:97], 3, v3
v_add_u32 v17, 48, v2
v_mfma_f32_16x16x32_bf16 v[188:191], a[156:159], a[104:107], v[188:191]
v_lshlrev_b32 v17, 2, v17
v_lshlrev_b32 v18, 16, v3
v_mfma_f32_16x16x32_bf16 v[196:199], a[156:159], a[100:103], v[196:199]
v_lshl_add_u32 v18, v2, 4, v18
v_add_u32 v19, 0x8000, v18
v_mfma_f32_16x16x32_bf16 v[56:59], a[156:159], a[96:99], v[56:59]
s_waitcnt lgkmcnt(0)
v_cndmask_b32 v19, v19, v20, s[96:97]
v_mov_b32 v216, 0
v_mfma_f32_16x16x32_bf16 v[64:67], a[176:179], a[112:115], v[64:67]
s_waitcnt vmcnt(24)
v_mov_b32 v217, 0
v_mov_b32 v218, 0
v_mfma_f32_16x16x32_bf16 v[204:207], a[176:179], a[116:119], v[204:207]
s_barrier
v_mfma_f32_16x16x32_bf16 v[212:215], a[176:179], a[120:123], v[212:215]
ds_read_b128 a[96:99], v10 offset:0
v_mov_b32 v219, 0
v_mfma_f32_16x16x32_bf16 v[220:223], a[176:179], a[124:127], v[220:223]
s_mov_b32 s75, 8
s_lshl_b32 s76, s75, 19
s_add_u32 s76, s76, s74
v_mfma_f32_16x16x32_bf16 v[72:75], a[180:183], a[124:127], v[72:75]
s_mul_i32 s79, s75, 8192
s_add_u32 s79, s79, s78
v_mov_b32 v96, 0
v_mfma_f32_16x16x32_bf16 v[228:231], a[180:183], a[120:123], v[228:231]
s_add_u32 m0, s77, 0
s_add_u32 s64, s76, 0
v_mov_b32 v97, 0
v_mfma_f32_16x16x32_bf16 v[80:83], a[180:183], a[116:119], v[80:83]
buffer_load_dwordx4 v7, s[20:23], s64 offen lds
v_mfma_f32_16x16x32_bf16 v[236:239], a[180:183], a[112:115], v[236:239]
ds_read_b64_tr_b16 a[160:161], v11 offset:16384
ds_read_b64_tr_b16 a[162:163], v11 offset:16896
v_mfma_f32_16x16x32_bf16 v[244:247], a[184:187], a[112:115], v[244:247]
ds_read_b128 a[100:103], v10 offset:2048
v_mov_b32 v98, 0
v_mfma_f32_16x16x32_bf16 v[252:255], a[184:187], a[116:119], v[252:255]
ds_read_b64_tr_b16 a[164:165], v12 offset:16384
ds_read_b64_tr_b16 a[166:167], v12 offset:16896
v_mfma_f32_16x16x32_bf16 v[88:91], a[184:187], a[120:123], v[88:91]
buffer_load_dwordx4 v8, s[20:23], s64 offen offset:1024 lds
v_mfma_f32_16x16x32_bf16 v[160:163], a[184:187], a[124:127], v[160:163]
ds_read_b128 a[104:107], v10 offset:4096
v_mov_b32 v99, 0
v_mfma_f32_16x16x32_bf16 v[168:171], a[188:191], a[124:127], v[168:171]
ds_read_b64_tr_b16 a[168:169], v13 offset:16384
ds_read_b64_tr_b16 a[170:171], v13 offset:16896
v_mfma_f32_16x16x32_bf16 v[176:179], a[188:191], a[120:123], v[176:179]
ds_read_b128 a[108:111], v10 offset:6144
v_mov_b32 v104, 0
v_mfma_f32_16x16x32_bf16 v[184:187], a[188:191], a[116:119], v[184:187]
s_add_u32 m0, s80, 0
s_add_u32 s64, s79, 0
v_mov_b32 v105, 0
v_mfma_f32_16x16x32_bf16 v[248:251], a[188:191], a[112:115], v[248:251]
ds_read_b64_tr_b16 a[172:173], v14 offset:16384
ds_read_b64_tr_b16 a[174:175], v14 offset:16896
v_mfma_f32_16x16x32_bf16 v[240:243], a[64:67], a[112:115], v[240:243]
buffer_load_dwordx4 v4, s[24:27], s64 offen sc1 lds
v_mfma_f32_16x16x32_bf16 v[232:235], a[64:67], a[116:119], v[232:235]
s_add_u32 s53, s87, 524288
ds_read_b128 a[88:91], v4 offset:24576
v_mov_b32 v106, 0
v_mfma_f32_16x16x32_bf16 v[224:227], a[64:67], a[120:123], v[224:227]
ds_read_b64_tr_b16 a[80:81], v11 offset:20480
ds_read_b64_tr_b16 a[82:83], v11 offset:20992
v_mfma_f32_16x16x32_bf16 v[192:195], a[64:67], a[124:127], v[192:195]
buffer_store_dwordx4 a[20:23], v4, s[24:27], s53 offen offset:1024 sc1
v_mfma_f32_16x16x32_bf16 v[152:155], a[128:131], a[124:127], v[152:155]
s_add_u32 m0, s73, 36864
s_add_u32 s64, s72, 0
ds_read_b128 a[152:155], v4 offset:25600
v_mfma_f32_16x16x32_bf16 v[200:203], a[128:131], a[120:123], v[200:203]
v_mov_b32 v107, 0
v_mov_b32 v112, 0
v_mfma_f32_16x16x32_bf16 v[208:211], a[128:131], a[116:119], v[208:211]
buffer_load_dwordx4 v5, s[12:15], s64 offen lds
v_mfma_f32_16x16x32_bf16 v[36:39], a[128:131], a[112:115], v[36:39]
ds_read_b64_tr_b16 a[144:145], v12 offset:20480
ds_read_b64_tr_b16 a[146:147], v12 offset:20992
v_mfma_f32_16x16x32_bf16 v[44:47], a[68:71], a[112:115], v[44:47]
ds_read_b128 a[92:95], v4 offset:26624
v_mov_b32 v113, 0
v_mfma_f32_16x16x32_bf16 v[32:35], a[68:71], a[116:119], v[32:35]
v_mov_b32 v114, 0
v_mov_b32 v115, 0
v_mfma_f32_16x16x32_bf16 v[52:55], a[68:71], a[120:123], v[52:55]
ds_read_b64_tr_b16 a[84:85], v13 offset:20480
ds_read_b64_tr_b16 a[86:87], v13 offset:20992
v_mfma_f32_16x16x32_bf16 v[60:63], a[68:71], a[124:127], v[60:63]
v_mov_b32 v120, 0
v_mov_b32 v121, 0
v_mfma_f32_16x16x32_bf16 v[68:71], a[132:135], a[124:127], v[68:71]
buffer_load_dwordx4 v6, s[12:15], s64 offen offset:1024 lds
v_mfma_f32_16x16x32_bf16 v[76:79], a[132:135], a[120:123], v[76:79]
ds_read_b128 a[156:159], v4 offset:27648
v_mov_b32 v122, 0
v_mfma_f32_16x16x32_bf16 v[84:87], a[132:135], a[116:119], v[84:87]
ds_read_b64_tr_b16 a[148:149], v14 offset:20480
ds_read_b64_tr_b16 a[150:151], v14 offset:20992
v_mfma_f32_16x16x32_bf16 v[92:95], a[132:135], a[112:115], v[92:95]
v_mov_b32 v123, 0
v_mov_b32 v128, 0
v_mfma_f32_16x16x32_bf16 v[100:103], a[72:75], a[112:115], v[100:103]
s_add_u32 m0, s73, 38912
s_add_u32 s64, s72, 18432
v_mov_b32 v129, 0
v_mfma_f32_16x16x32_bf16 v[108:111], a[72:75], a[116:119], v[108:111]
v_mov_b32 v130, 0
v_mov_b32 v131, 0
v_mfma_f32_16x16x32_bf16 v[116:119], a[72:75], a[120:123], v[116:119]
buffer_load_dwordx4 v5, s[12:15], s64 offen lds
v_mfma_f32_16x16x32_bf16 v[40:43], a[72:75], a[124:127], v[40:43]
v_mov_b32 v136, 0
v_mov_b32 v137, 0
v_mfma_f32_16x16x32_bf16 v[124:127], a[136:139], a[124:127], v[124:127]
v_mov_b32 v138, 0
v_mov_b32 v139, 0
v_mfma_f32_16x16x32_bf16 v[132:135], a[136:139], a[120:123], v[132:135]
v_mov_b32 v144, 0
v_mov_b32 v145, 0
v_mfma_f32_16x16x32_bf16 v[140:143], a[136:139], a[116:119], v[140:143]
v_mov_b32 v146, 0
v_mov_b32 v147, 0
v_mfma_f32_16x16x32_bf16 v[148:151], a[136:139], a[112:115], v[148:151]
v_mfma_f32_16x16x32_bf16 v[156:159], a[76:79], a[112:115], v[156:159]
buffer_load_dwordx4 v6, s[12:15], s64 offen offset:1024 lds
v_mfma_f32_16x16x32_bf16 v[48:51], a[76:79], a[116:119], v[48:51]
v_add_u32 v9, -65536, v9
v_add_u32 v10, -65536, v10
v_mfma_f32_16x16x32_bf16 v[164:167], a[76:79], a[120:123], v[164:167]
v_mfma_f32_16x16x32_bf16 v[172:175], a[76:79], a[124:127], v[172:175]
v_mfma_f32_16x16x32_bf16 v[180:183], a[140:143], a[124:127], v[180:183]
s_add_u32 s53, s87, 528384
v_mfma_f32_16x16x32_bf16 v[188:191], a[140:143], a[120:123], v[188:191]
buffer_store_dwordx4 a[12:15], v4, s[24:27], s53 offen offset:0 sc1
v_mfma_f32_16x16x32_bf16 v[196:199], a[140:143], a[116:119], v[196:199]
v_mfma_f32_16x16x32_bf16 v[56:59], a[140:143], a[112:115], v[56:59]
s_waitcnt lgkmcnt(0)
v_mfma_f32_16x16x32_bf16 v[64:67], a[160:163], a[96:99], v[64:67]
s_waitcnt vmcnt(19)
v_mfma_f32_16x16x32_bf16 v[204:207], a[160:163], a[100:103], v[204:207]
s_barrier
v_mfma_f32_16x16x32_bf16 v[212:215], a[160:163], a[104:107], v[212:215]
ds_read_b128 a[112:115], v9 offset:0
v_mfma_f32_16x16x32_bf16 v[220:223], a[160:163], a[108:111], v[220:223]
s_add_u32 m0, s77, 16384
s_add_u32 s64, s76, 262144
v_mfma_f32_16x16x32_bf16 v[72:75], a[164:167], a[108:111], v[72:75]
buffer_load_dwordx4 v7, s[20:23], s64 offen lds
v_mfma_f32_16x16x32_bf16 v[228:231], a[164:167], a[104:107], v[228:231]
ds_read_b64_tr_b16 a[176:177], v11 offset:32768
ds_read_b64_tr_b16 a[178:179], v11 offset:33280
v_mfma_f32_16x16x32_bf16 v[80:83], a[164:167], a[100:103], v[80:83]
ds_read_b128 a[116:119], v9 offset:2048
v_mfma_f32_16x16x32_bf16 v[236:239], a[164:167], a[96:99], v[236:239]
ds_read_b64_tr_b16 a[180:181], v12 offset:32768
ds_read_b64_tr_b16 a[182:183], v12 offset:33280
v_mfma_f32_16x16x32_bf16 v[244:247], a[168:171], a[96:99], v[244:247]
buffer_load_dwordx4 v8, s[20:23], s64 offen offset:1024 lds
v_mfma_f32_16x16x32_bf16 v[252:255], a[168:171], a[100:103], v[252:255]
ds_read_b128 a[120:123], v9 offset:4096
v_mfma_f32_16x16x32_bf16 v[88:91], a[168:171], a[104:107], v[88:91]
ds_read_b64_tr_b16 a[184:185], v13 offset:32768
ds_read_b64_tr_b16 a[186:187], v13 offset:33280
v_mfma_f32_16x16x32_bf16 v[160:163], a[168:171], a[108:111], v[160:163]
s_add_u32 m0, s80, 16384
s_add_u32 s64, s79, 4096
v_mfma_f32_16x16x32_bf16 v[168:171], a[172:175], a[108:111], v[168:171]
ds_read_b128 a[124:127], v9 offset:6144
v_mfma_f32_16x16x32_bf16 v[176:179], a[172:175], a[104:107], v[176:179]
buffer_load_dwordx4 v4, s[24:27], s64 offen sc1 lds
v_mfma_f32_16x16x32_bf16 v[184:187], a[172:175], a[100:103], v[184:187]
ds_read_b64_tr_b16 a[188:189], v14 offset:32768
ds_read_b64_tr_b16 a[190:191], v14 offset:33280
v_mfma_f32_16x16x32_bf16 v[248:251], a[172:175], a[96:99], v[248:251]
v_mfma_f32_16x16x32_bf16 v[240:243], a[80:83], a[96:99], v[240:243]
s_add_u32 m0, s83, 0
s_add_u32 s64, s81, 0
ds_read_b128 a[72:75], v4 offset:40960
v_mfma_f32_16x16x32_bf16 v[232:235], a[80:83], a[100:103], v[232:235]
v_mfma_f32_16x16x32_bf16 v[224:227], a[80:83], a[104:107], v[224:227]
buffer_load_dwordx4 v22, s[32:35], s64 offen lds
v_mfma_f32_16x16x32_bf16 v[192:195], a[80:83], a[108:111], v[192:195]
ds_read_b64_tr_b16 a[64:65], v11 offset:36864
ds_read_b64_tr_b16 a[66:67], v11 offset:37376
v_mfma_f32_16x16x32_bf16 v[152:155], a[144:147], a[108:111], v[152:155]
s_add_u32 m0, s83, 1024
s_add_u32 s64, s81, 9216
ds_read_b128 a[136:139], v4 offset:41984
v_mfma_f32_16x16x32_bf16 v[200:203], a[144:147], a[104:107], v[200:203]
v_mfma_f32_16x16x32_bf16 v[208:211], a[144:147], a[100:103], v[208:211]
buffer_load_dwordx4 v22, s[32:35], s64 offen lds
v_mfma_f32_16x16x32_bf16 v[36:39], a[144:147], a[96:99], v[36:39]
s_add_u32 s53, s87, 528384
ds_read_b64_tr_b16 a[128:129], v12 offset:36864
ds_read_b64_tr_b16 a[130:131], v12 offset:37376
v_mfma_f32_16x16x32_bf16 v[44:47], a[84:87], a[96:99], v[44:47]
ds_read_b128 a[76:79], v4 offset:43008
v_mfma_f32_16x16x32_bf16 v[32:35], a[84:87], a[100:103], v[32:35]
s_add_u32 m0, s83, 2048
s_add_u32 s64, s81, 18432
v_mfma_f32_16x16x32_bf16 v[52:55], a[84:87], a[104:107], v[52:55]
ds_read_b64_tr_b16 a[68:69], v13 offset:36864
ds_read_b64_tr_b16 a[70:71], v13 offset:37376
v_mfma_f32_16x16x32_bf16 v[60:63], a[84:87], a[108:111], v[60:63]
buffer_load_dwordx4 v22, s[32:35], s64 offen lds
v_mfma_f32_16x16x32_bf16 v[68:71], a[148:151], a[108:111], v[68:71]
ds_read_b128 a[140:143], v4 offset:44032
v_mfma_f32_16x16x32_bf16 v[76:79], a[148:151], a[104:107], v[76:79]
buffer_store_dwordx4 a[4:7], v4, s[24:27], s53 offen offset:1024 sc1
v_mfma_f32_16x16x32_bf16 v[84:87], a[148:151], a[100:103], v[84:87]
s_add_u32 m0, s83, 3072
s_add_u32 s64, s81, 27648
v_mfma_f32_16x16x32_bf16 v[92:95], a[148:151], a[96:99], v[92:95]
ds_read_b64_tr_b16 a[132:133], v14 offset:36864
ds_read_b64_tr_b16 a[134:135], v14 offset:37376
v_mfma_f32_16x16x32_bf16 v[100:103], a[88:91], a[96:99], v[100:103]
buffer_load_dwordx4 v22, s[32:35], s64 offen lds
v_mfma_f32_16x16x32_bf16 v[108:111], a[88:91], a[100:103], v[108:111]
v_mfma_f32_16x16x32_bf16 v[116:119], a[88:91], a[104:107], v[116:119]
s_add_u32 m0, s83, 4096
s_add_u32 s64, s81, 128
s_waitcnt vmcnt(25)
v_mfma_f32_16x16x32_bf16 v[40:43], a[88:91], a[108:111], v[40:43]
v_cmp_gt_u32 vcc, 8, v30
v_mfma_f32_16x16x32_bf16 v[124:127], a[152:155], a[108:111], v[124:127]
buffer_load_dwordx4 v24, s[32:35], s64 offen lds
v_mfma_f32_16x16x32_bf16 v[132:135], a[152:155], a[104:107], v[132:135]
v_mfma_f32_16x16x32_bf16 v[140:143], a[152:155], a[100:103], v[140:143]
v_mfma_f32_16x16x32_bf16 v[148:151], a[152:155], a[96:99], v[148:151]
s_add_u32 m0, s83, 5120
s_add_u32 s64, s82, 0
v_mfma_f32_16x16x32_bf16 v[156:159], a[92:95], a[96:99], v[156:159]
s_cbranch_vccnz CK_KV
CK_KV_R:
v_mfma_f32_16x16x32_bf16 v[48:51], a[92:95], a[100:103], v[48:51]
buffer_load_dwordx4 v25, s[48:51], s64 offen lds
v_mfma_f32_16x16x32_bf16 v[164:167], a[92:95], a[104:107], v[164:167]
v_mfma_f32_16x16x32_bf16 v[172:175], a[92:95], a[108:111], v[172:175]
v_mfma_f32_16x16x32_bf16 v[180:183], a[156:159], a[108:111], v[180:183]
v_mfma_f32_16x16x32_bf16 v[188:191], a[156:159], a[104:107], v[188:191]
v_mfma_f32_16x16x32_bf16 v[196:199], a[156:159], a[100:103], v[196:199]
v_mfma_f32_16x16x32_bf16 v[56:59], a[156:159], a[96:99], v[56:59]
s_waitcnt lgkmcnt(0)
v_mfma_f32_16x16x32_bf16 v[64:67], a[176:179], a[112:115], v[64:67]
s_waitcnt vmcnt(24)
v_mov_b32 v6, 0xf149f2ca
v_mfma_f32_16x16x32_bf16 v[204:207], a[176:179], a[116:119], v[204:207]
s_barrier
v_mfma_f32_16x16x32_bf16 v[212:215], a[176:179], a[120:123], v[212:215]
s_add_u32 s53, s87, 786432
ds_read_b128 a[96:99], v10 offset:0
v_mfma_f32_16x16x32_bf16 v[220:223], a[176:179], a[124:127], v[220:223]
s_lshl_b32 s70, s3, 12
s_add_u32 s68, s70, s94
v_mfma_f32_16x16x32_bf16 v[72:75], a[180:183], a[124:127], v[72:75]
s_add_u32 m0, s70, 32768
s_cmp_lt_u32 s3, 2
s_cselect_b32 s64, s68, 2147418112
v_mfma_f32_16x16x32_bf16 v[228:231], a[180:183], a[120:123], v[228:231]
buffer_load_dwordx4 v4, s[24:27], s64 offen offset:0 sc1 lds
v_mfma_f32_16x16x32_bf16 v[80:83], a[180:183], a[116:119], v[80:83]
ds_read_b64_tr_b16 a[160:161], v11 offset:49152
ds_read_b64_tr_b16 a[162:163], v11 offset:49664
v_mfma_f32_16x16x32_bf16 v[236:239], a[180:183], a[112:115], v[236:239]
ds_read_b128 a[100:103], v10 offset:2048
v_mfma_f32_16x16x32_bf16 v[244:247], a[184:187], a[112:115], v[244:247]
ds_read_b64_tr_b16 a[164:165], v12 offset:49152
ds_read_b64_tr_b16 a[166:167], v12 offset:49664
v_mfma_f32_16x16x32_bf16 v[252:255], a[184:187], a[116:119], v[252:255]
ds_read_b128 a[104:107], v10 offset:4096
v_mfma_f32_16x16x32_bf16 v[88:91], a[184:187], a[120:123], v[88:91]
ds_read_b64_tr_b16 a[168:169], v13 offset:49152
ds_read_b64_tr_b16 a[170:171], v13 offset:49664
v_mfma_f32_16x16x32_bf16 v[160:163], a[184:187], a[124:127], v[160:163]
buffer_store_dwordx4 a[0:3], v4, s[24:27], s53 offen offset:0 sc1
v_mfma_f32_16x16x32_bf16 v[168:171], a[188:191], a[124:127], v[168:171]
ds_read_b128 a[108:111], v10 offset:6144
v_mfma_f32_16x16x32_bf16 v[176:179], a[188:191], a[120:123], v[176:179]
s_cmp_eq_u32 s66, 0
s_cbranch_scc1 D0
D0_R:
v_mfma_f32_16x16x32_bf16 v[184:187], a[188:191], a[116:119], v[184:187]
buffer_load_dwordx4 v4, s[24:27], s64 offen offset:1024 sc1 lds
v_mfma_f32_16x16x32_bf16 v[248:251], a[188:191], a[112:115], v[248:251]
s_lshl_b32 s52, s4, 18
ds_read_b64_tr_b16 a[172:173], v14 offset:49152
ds_read_b64_tr_b16 a[174:175], v14 offset:49664
v_mfma_f32_16x16x32_bf16 v[240:243], a[64:67], a[112:115], v[240:243]
s_add_u32 s52, s52, 45088768
s_lshl_b32 s54, s66, 9
ds_read_b128 a[88:91], v4 offset:57344
v_mfma_f32_16x16x32_bf16 v[232:235], a[64:67], a[116:119], v[232:235]
s_add_u32 s54, s54, s52
s_lshl_b32 s55, s67, 9
s_add_u32 s55, s55, s52
v_mfma_f32_16x16x32_bf16 v[224:227], a[64:67], a[120:123], v[224:227]
ds_read_b64_tr_b16 a[80:81], v11 offset:53248
ds_read_b64_tr_b16 a[82:83], v11 offset:53760
v_mfma_f32_16x16x32_bf16 v[192:195], a[64:67], a[124:127], v[192:195]
v_mfma_f32_16x16x32_bf16 v[152:155], a[128:131], a[124:127], v[152:155]
ds_read_b128 a[152:155], v4 offset:58368
v_mfma_f32_16x16x32_bf16 v[200:203], a[128:131], a[120:123], v[200:203]
v_mfma_f32_16x16x32_bf16 v[208:211], a[128:131], a[116:119], v[208:211]
ds_read_b64_tr_b16 a[144:145], v12 offset:53248
ds_read_b64_tr_b16 a[146:147], v12 offset:53760
v_mfma_f32_16x16x32_bf16 v[36:39], a[128:131], a[112:115], v[36:39]
v_mfma_f32_16x16x32_bf16 v[44:47], a[68:71], a[112:115], v[44:47]
ds_read_b128 a[92:95], v4 offset:59392
v_mfma_f32_16x16x32_bf16 v[32:35], a[68:71], a[116:119], v[32:35]
buffer_load_dwordx4 v4, s[24:27], s64 offen offset:2048 sc1 lds
v_mfma_f32_16x16x32_bf16 v[52:55], a[68:71], a[120:123], v[52:55]
ds_read_b64_tr_b16 a[84:85], v13 offset:53248
ds_read_b64_tr_b16 a[86:87], v13 offset:53760
v_mfma_f32_16x16x32_bf16 v[60:63], a[68:71], a[124:127], v[60:63]
v_mfma_f32_16x16x32_bf16 v[68:71], a[132:135], a[124:127], v[68:71]
ds_read_b128 a[156:159], v4 offset:60416
v_mfma_f32_16x16x32_bf16 v[76:79], a[132:135], a[120:123], v[76:79]
s_add_u32 s53, s87, 786432
v_mfma_f32_16x16x32_bf16 v[84:87], a[132:135], a[116:119], v[84:87]
ds_read_b64_tr_b16 a[148:149], v14 offset:53248
ds_read_b64_tr_b16 a[150:151], v14 offset:53760
v_mfma_f32_16x16x32_bf16 v[92:95], a[132:135], a[112:115], v[92:95]
buffer_store_dwordx4 a[8:11], v4, s[24:27], s53 offen offset:1024 sc1
v_mfma_f32_16x16x32_bf16 v[100:103], a[72:75], a[112:115], v[100:103]
v_mfma_f32_16x16x32_bf16 v[108:111], a[72:75], a[116:119], v[108:111]
v_mfma_f32_16x16x32_bf16 v[116:119], a[72:75], a[120:123], v[116:119]
v_mfma_f32_16x16x32_bf16 v[40:43], a[72:75], a[124:127], v[40:43]
buffer_load_dwordx4 v4, s[24:27], s64 offen offset:3072 sc1 lds
v_mfma_f32_16x16x32_bf16 v[124:127], a[136:139], a[124:127], v[124:127]
v_mfma_f32_16x16x32_bf16 v[132:135], a[136:139], a[120:123], v[132:135]
v_mfma_f32_16x16x32_bf16 v[140:143], a[136:139], a[116:119], v[140:143]
v_mfma_f32_16x16x32_bf16 v[148:151], a[136:139], a[112:115], v[148:151]
v_mfma_f32_16x16x32_bf16 v[156:159], a[76:79], a[112:115], v[156:159]
v_add_u32 v9, 32768, v9
v_add_u32 v10, 32768, v10
v_mfma_f32_16x16x32_bf16 v[48:51], a[76:79], a[116:119], v[48:51]
v_mfma_f32_16x16x32_bf16 v[164:167], a[76:79], a[120:123], v[164:167]
v_mfma_f32_16x16x32_bf16 v[172:175], a[76:79], a[124:127], v[172:175]
v_mfma_f32_16x16x32_bf16 v[180:183], a[140:143], a[124:127], v[180:183]
v_mfma_f32_16x16x32_bf16 v[188:191], a[140:143], a[120:123], v[188:191]
v_mfma_f32_16x16x32_bf16 v[196:199], a[140:143], a[116:119], v[196:199]
v_mfma_f32_16x16x32_bf16 v[56:59], a[140:143], a[112:115], v[56:59]
s_waitcnt lgkmcnt(0)
v_mfma_f32_16x16x32_bf16 v[64:67], a[160:163], a[96:99], v[64:67]
s_waitcnt vmcnt(17)
v_mfma_f32_16x16x32_bf16 v[204:207], a[160:163], a[100:103], v[204:207]
s_barrier
v_mfma_f32_16x16x32_bf16 v[212:215], a[160:163], a[104:107], v[212:215]
ds_read_b128 a[112:115], v9 offset:0
v_mfma_f32_16x16x32_bf16 v[220:223], a[160:163], a[108:111], v[220:223]
s_add_u32 m0, s70, 49152
s_add_u32 s64, s68, 16384
s_waitcnt vmcnt(6)
v_mfma_f32_16x16x32_bf16 v[72:75], a[164:167], a[108:111], v[72:75]
buffer_load_dwordx4 v4, s[24:27], s64 offen offset:0 sc1 lds
v_mfma_f32_16x16x32_bf16 v[228:231], a[164:167], a[104:107], v[228:231]
ds_read_b64_tr_b16 a[176:177], v11 offset:0
ds_read_b64_tr_b16 a[178:179], v11 offset:512
v_mfma_f32_16x16x32_bf16 v[80:83], a[164:167], a[100:103], v[80:83]
ds_read_b128 a[116:119], v9 offset:2048
v_mfma_f32_16x16x32_bf16 v[236:239], a[164:167], a[96:99], v[236:239]
ds_read_b64_tr_b16 a[180:181], v12 offset:0
ds_read_b64_tr_b16 a[182:183], v12 offset:512
v_mfma_f32_16x16x32_bf16 v[244:247], a[168:171], a[96:99], v[244:247]
s_add_u32 s53, s87, 790528
ds_read_b128 a[120:123], v9 offset:4096
v_mfma_f32_16x16x32_bf16 v[252:255], a[168:171], a[100:103], v[252:255]
buffer_store_dwordx4 a[16:19], v4, s[24:27], s53 offen offset:0 sc1
v_mfma_f32_16x16x32_bf16 v[88:91], a[168:171], a[104:107], v[88:91]
ds_read_b64_tr_b16 a[184:185], v13 offset:0
ds_read_b64_tr_b16 a[186:187], v13 offset:512
v_mfma_f32_16x16x32_bf16 v[160:163], a[168:171], a[108:111], v[160:163]
ds_read_b64_tr_b16 a[192:193], v23 offset:0
ds_read_b64_tr_b16 a[194:195], v23 offset:2048
v_mfma_f32_16x16x32_bf16 v[168:171], a[172:175], a[108:111], v[168:171]
ds_read_b128 a[124:127], v9 offset:6144
v_mfma_f32_16x16x32_bf16 v[176:179], a[172:175], a[104:107], v[176:179]
ds_read_b64_tr_b16 a[196:197], v23 offset:32
ds_read_b64_tr_b16 a[198:199], v23 offset:2080
v_mfma_f32_16x16x32_bf16 v[184:187], a[172:175], a[100:103], v[184:187]
buffer_load_dwordx4 v4, s[24:27], s64 offen offset:1024 sc1 lds
v_mfma_f32_16x16x32_bf16 v[248:251], a[172:175], a[96:99], v[248:251]
ds_read_b64_tr_b16 a[188:189], v14 offset:0
ds_read_b64_tr_b16 a[190:191], v14 offset:512
v_mfma_f32_16x16x32_bf16 v[240:243], a[80:83], a[96:99], v[240:243]
ds_read_b128 a[72:75], v4 offset:8192
v_mfma_f32_16x16x32_bf16 v[232:235], a[80:83], a[100:103], v[232:235]
ds_read_b64_tr_b16 a[200:201], v23 offset:64
ds_read_b64_tr_b16 a[202:203], v23 offset:2112
v_mfma_f32_16x16x32_bf16 v[224:227], a[80:83], a[104:107], v[224:227]
ds_read_b64_tr_b16 a[64:65], v11 offset:4096
ds_read_b64_tr_b16 a[66:67], v11 offset:4608
v_mfma_f32_16x16x32_bf16 v[192:195], a[80:83], a[108:111], v[192:195]
ds_read_b64_tr_b16 a[204:205], v23 offset:96
ds_read_b64_tr_b16 a[206:207], v23 offset:2144
v_mfma_f32_16x16x32_bf16 v[152:155], a[144:147], a[108:111], v[152:155]
ds_read_b128 a[136:139], v4 offset:9216
v_mfma_f32_16x16x32_bf16 v[200:203], a[144:147], a[104:107], v[200:203]
ds_read_b64_tr_b16 a[208:209], v27 offset:4096
ds_read_b64_tr_b16 a[210:211], v27 offset:4608
v_mfma_f32_16x16x32_bf16 v[208:211], a[144:147], a[100:103], v[208:211]
ds_read_b64_tr_b16 a[128:129], v12 offset:4096
ds_read_b64_tr_b16 a[130:131], v12 offset:4608
v_mfma_f32_16x16x32_bf16 v[36:39], a[144:147], a[96:99], v[36:39]
ds_read_b64_tr_b16 a[212:213], v27 offset:5120
ds_read_b64_tr_b16 a[214:215], v27 offset:5632
v_mfma_f32_16x16x32_bf16 v[44:47], a[84:87], a[96:99], v[44:47]
ds_read_b128 a[76:79], v4 offset:10240
v_readlane_b32 s81, v26, 0
v_mfma_f32_16x16x32_bf16 v[32:35], a[84:87], a[100:103], v[32:35]
buffer_load_dwordx4 v4, s[24:27], s64 offen offset:2048 sc1 lds
v_mfma_f32_16x16x32_bf16 v[52:55], a[84:87], a[104:107], v[52:55]
L_PAD7:
s_cbranch_execz L_PAD11
ds_read_b64_tr_b16 a[68:69], v13 offset:4096
ds_read_b64_tr_b16 a[70:71], v13 offset:4608
v_mfma_f32_16x16x32_bf16 v[60:63], a[84:87], a[108:111], v[60:63]
v_readlane_b32 s82, v26, 1
v_readlane_b32 s71, v26, 2
v_mfma_f32_16x16x32_bf16 v[68:71], a[148:151], a[108:111], v[68:71]
ds_read_b128 a[140:143], v4 offset:11264
v_readlane_b32 s72, v26, 3
v_mfma_f32_16x16x32_bf16 v[76:79], a[148:151], a[104:107], v[76:79]
v_readlane_b32 s74, v26, 4
v_readlane_b32 s75, v26, 5
v_mfma_f32_16x16x32_bf16 v[84:87], a[148:151], a[100:103], v[84:87]
ds_read_b64_tr_b16 a[132:133], v14 offset:4096
ds_read_b64_tr_b16 a[134:135], v14 offset:4608
v_mfma_f32_16x16x32_bf16 v[92:95], a[148:151], a[96:99], v[92:95]
v_mfma_f32_16x16x32_bf16 v[100:103], a[88:91], a[96:99], v[100:103]
v_mfma_f32_16x16x32_bf16 v[108:111], a[88:91], a[100:103], v[108:111]
v_mfma_f32_16x16x32_bf16 v[116:119], a[88:91], a[104:107], v[116:119]
v_mfma_f32_16x16x32_bf16 v[40:43], a[88:91], a[108:111], v[40:43]
buffer_load_dwordx4 v4, s[24:27], s64 offen offset:3072 sc1 lds
v_mfma_f32_16x16x32_bf16 v[124:127], a[152:155], a[108:111], v[124:127]
s_add_u32 s53, s87, 790528
v_mfma_f32_16x16x32_bf16 v[132:135], a[152:155], a[104:107], v[132:135]
buffer_store_dwordx4 a[24:27], v4, s[24:27], s53 offen offset:1024 sc1
v_mfma_f32_16x16x32_bf16 v[140:143], a[152:155], a[100:103], v[140:143]
v_mfma_f32_16x16x32_bf16 v[148:151], a[152:155], a[96:99], v[148:151]
v_mfma_f32_16x16x32_bf16 v[156:159], a[92:95], a[96:99], v[156:159]
v_mfma_f32_16x16x32_bf16 v[48:51], a[92:95], a[100:103], v[48:51]
v_mfma_f32_16x16x32_bf16 v[164:167], a[92:95], a[104:107], v[164:167]
v_mfma_f32_16x16x32_bf16 v[172:175], a[92:95], a[108:111], v[172:175]
v_mfma_f32_16x16x32_bf16 v[180:183], a[156:159], a[108:111], v[180:183]
v_mfma_f32_16x16x32_bf16 v[188:191], a[156:159], a[104:107], v[188:191]
v_mfma_f32_16x16x32_bf16 v[196:199], a[156:159], a[100:103], v[196:199]
v_mfma_f32_16x16x32_bf16 v[56:59], a[156:159], a[96:99], v[56:59]
s_waitcnt lgkmcnt(0)
v_mfma_f32_16x16x32_bf16 v[64:67], a[176:179], a[112:115], v[64:67]
s_waitcnt vmcnt(19)
v_mfma_f32_16x16x32_bf16 v[236:239], a[180:183], a[112:115], v[236:239]
s_barrier
v_mfma_f32_16x16x32_bf16 v[244:247], a[184:187], a[112:115], v[244:247]
ds_read_b128 a[96:99], v10 offset:0
ds_read_b128 a[100:103], v10 offset:2048
v_mfma_f32_16x16x32_bf16 v[248:251], a[188:191], a[112:115], v[248:251]
ds_read_b128 a[104:107], v10 offset:4096
ds_read_b128 a[108:111], v10 offset:6144
v_mfma_f32_16x16x32_bf16 v[240:243], a[64:67], a[112:115], v[240:243]
ds_read_b64_tr_b16 a[160:161], v11 offset:16384
ds_read_b64_tr_b16 a[162:163], v11 offset:16896
v_mfma_f32_16x16x32_bf16 v[36:39], a[128:131], a[112:115], v[36:39]
ds_read_b64_tr_b16 a[164:165], v12 offset:16384
ds_read_b64_tr_b16 a[166:167], v12 offset:16896
v_mfma_f32_16x16x32_bf16 v[44:47], a[68:71], a[112:115], v[44:47]
ds_read_b64_tr_b16 a[168:169], v13 offset:16384
ds_read_b64_tr_b16 a[170:171], v13 offset:16896
v_mfma_f32_16x16x32_bf16 v[92:95], a[132:135], a[112:115], v[92:95]
ds_read_b64_tr_b16 a[172:173], v14 offset:16384
ds_read_b64_tr_b16 a[174:175], v14 offset:16896
v_mfma_f32_16x16x32_bf16 v[204:207], a[176:179], a[116:119], v[204:207]
ds_read_b64_tr_b16 a[80:81], v11 offset:20480
ds_read_b64_tr_b16 a[82:83], v11 offset:20992
v_mfma_f32_16x16x32_bf16 v[80:83], a[180:183], a[116:119], v[80:83]
ds_read_b64_tr_b16 a[144:145], v12 offset:20480
ds_read_b64_tr_b16 a[146:147], v12 offset:20992
v_mfma_f32_16x16x32_bf16 v[252:255], a[184:187], a[116:119], v[252:255]
ds_read_b64_tr_b16 a[84:85], v13 offset:20480
ds_read_b64_tr_b16 a[86:87], v13 offset:20992
v_mfma_f32_16x16x32_bf16 v[184:187], a[188:191], a[116:119], v[184:187]
ds_read_b64_tr_b16 a[148:149], v14 offset:20480
ds_read_b64_tr_b16 a[150:151], v14 offset:20992
v_mfma_f32_16x16x32_bf16 v[232:235], a[64:67], a[116:119], v[232:235]
ds_read_b128 a[88:91], v4 offset:24576
ds_read_b128 a[152:155], v4 offset:25600
v_mfma_f32_16x16x32_bf16 v[208:211], a[128:131], a[116:119], v[208:211]
ds_read_b128 a[92:95], v4 offset:26624
ds_read_b128 a[156:159], v4 offset:27648
v_mfma_f32_16x16x32_bf16 v[32:35], a[68:71], a[116:119], v[32:35]
buffer_store_dwordx4 a[192:195], v4, s[24:27], s81 offen sc1
v_mfma_f32_16x16x32_bf16 v[84:87], a[132:135], a[116:119], v[84:87]
s_add_u32 m0, s70, 65536
s_add_u32 s64, s68, 32768
v_mfma_f32_16x16x32_bf16 v[212:215], a[176:179], a[120:123], v[212:215]
buffer_load_dwordx4 v4, s[24:27], s64 offen offset:0 sc1 lds
v_mfma_f32_16x16x32_bf16 v[228:231], a[180:183], a[120:123], v[228:231]
v_mfma_f32_16x16x32_bf16 v[88:91], a[184:187], a[120:123], v[88:91]
v_mfma_f32_16x16x32_bf16 v[176:179], a[188:191], a[120:123], v[176:179]
buffer_store_dwordx4 a[196:199], v4, s[24:27], s82 offen sc1
v_mfma_f32_16x16x32_bf16 v[224:227], a[64:67], a[120:123], v[224:227]
v_mfma_f32_16x16x32_bf16 v[200:203], a[128:131], a[120:123], v[200:203]
v_mfma_f32_16x16x32_bf16 v[52:55], a[68:71], a[120:123], v[52:55]
v_mfma_f32_16x16x32_bf16 v[76:79], a[132:135], a[120:123], v[76:79]
s_waitcnt lgkmcnt(0)
v_mfma_f32_16x16x32_bf16 v[64:67], a[160:163], a[96:99], v[64:67]
buffer_load_dwordx4 v4, s[24:27], s64 offen offset:1024 sc1 lds
v_mfma_f32_16x16x32_bf16 v[236:239], a[164:167], a[96:99], v[236:239]
buffer_store_dwordx4 a[200:203], v4, s[24:27], s71 offen sc1
v_mfma_f32_16x16x32_bf16 v[244:247], a[168:171], a[96:99], v[244:247]
v_mfma_f32_16x16x32_bf16 v[248:251], a[172:175], a[96:99], v[248:251]
v_mfma_f32_16x16x32_bf16 v[240:243], a[80:83], a[96:99], v[240:243]
v_mfma_f32_16x16x32_bf16 v[36:39], a[144:147], a[96:99], v[36:39]
v_mfma_f32_16x16x32_bf16 v[44:47], a[84:87], a[96:99], v[44:47]
buffer_store_dwordx4 a[204:207], v4, s[24:27], s72 offen sc1
v_mfma_f32_16x16x32_bf16 v[92:95], a[148:151], a[96:99], v[92:95]
buffer_load_dwordx4 v4, s[24:27], s64 offen offset:2048 sc1 lds
v_mfma_f32_16x16x32_bf16 v[204:207], a[160:163], a[100:103], v[204:207]
v_cvt_pk_bf16_f32 v64, v64, v65
v_cvt_pk_bf16_f32 v65, v66, v67
v_mfma_f32_16x16x32_bf16 v[80:83], a[164:167], a[100:103], v[80:83]
v_cvt_pk_bf16_f32 v66, v236, v237
v_cvt_pk_bf16_f32 v67, v238, v239
v_mfma_f32_16x16x32_bf16 v[252:255], a[168:171], a[100:103], v[252:255]
v_cvt_pk_bf16_f32 v244, v244, v245
v_cvt_pk_bf16_f32 v245, v246, v247
v_mfma_f32_16x16x32_bf16 v[184:187], a[172:175], a[100:103], v[184:187]
buffer_store_dwordx4 a[208:211], v4, s[24:27], s74 offen sc1
v_mfma_f32_16x16x32_bf16 v[232:235], a[80:83], a[100:103], v[232:235]
v_cvt_pk_bf16_f32 v246, v248, v249
v_cvt_pk_bf16_f32 v247, v250, v251
v_mfma_f32_16x16x32_bf16 v[208:211], a[144:147], a[100:103], v[208:211]
v_cvt_pk_bf16_f32 v240, v240, v241
v_cvt_pk_bf16_f32 v241, v242, v243
v_mfma_f32_16x16x32_bf16 v[32:35], a[84:87], a[100:103], v[32:35]
buffer_load_dwordx4 v4, s[24:27], s64 offen offset:3072 sc1 lds
v_mfma_f32_16x16x32_bf16 v[84:87], a[148:151], a[100:103], v[84:87]
v_cvt_pk_bf16_f32 v242, v36, v37
v_cvt_pk_bf16_f32 v243, v38, v39
v_mfma_f32_16x16x32_bf16 v[212:215], a[160:163], a[104:107], v[212:215]
buffer_store_dwordx4 a[212:215], v4, s[24:27], s75 offen sc1
v_mfma_f32_16x16x32_bf16 v[228:231], a[164:167], a[104:107], v[228:231]
v_cvt_pk_bf16_f32 v44, v44, v45
v_cvt_pk_bf16_f32 v45, v46, v47
v_mfma_f32_16x16x32_bf16 v[88:91], a[168:171], a[104:107], v[88:91]
v_cvt_pk_bf16_f32 v46, v92, v93
v_cvt_pk_bf16_f32 v47, v94, v95
v_mfma_f32_16x16x32_bf16 v[176:179], a[172:175], a[104:107], v[176:179]
v_cvt_pk_bf16_f32 v204, v204, v205
v_cvt_pk_bf16_f32 v205, v206, v207
v_mfma_f32_16x16x32_bf16 v[224:227], a[80:83], a[104:107], v[224:227]
v_cvt_pk_bf16_f32 v206, v80, v81
v_cvt_pk_bf16_f32 v207, v82, v83
v_mfma_f32_16x16x32_bf16 v[200:203], a[144:147], a[104:107], v[200:203]
v_cvt_pk_bf16_f32 v252, v252, v253
v_cvt_pk_bf16_f32 v253, v254, v255
v_mfma_f32_16x16x32_bf16 v[52:55], a[84:87], a[104:107], v[52:55]
v_cvt_pk_bf16_f32 v254, v184, v185
v_cvt_pk_bf16_f32 v255, v186, v187
v_mfma_f32_16x16x32_bf16 v[76:79], a[148:151], a[104:107], v[76:79]
v_cvt_pk_bf16_f32 v232, v232, v233
v_cvt_pk_bf16_f32 v233, v234, v235
v_mfma_f32_16x16x32_bf16 v[220:223], a[176:179], a[124:127], v[220:223]
s_waitcnt vmcnt(16)
v_cvt_pk_bf16_f32 v234, v208, v209
v_cvt_pk_bf16_f32 v235, v210, v211
v_mfma_f32_16x16x32_bf16 v[220:223], a[160:163], a[108:111], v[220:223]
s_barrier
v_mfma_f32_16x16x32_bf16 v[72:75], a[180:183], a[124:127], v[72:75]
v_cvt_pk_bf16_f32 v32, v32, v33
v_cvt_pk_bf16_f32 v33, v34, v35
v_mfma_f32_16x16x32_bf16 v[72:75], a[164:167], a[108:111], v[72:75]
s_add_u32 m0, s70, 81920
s_add_u32 s64, s68, 49152
v_cvt_pk_bf16_f32 v34, v84, v85
v_mfma_f32_16x16x32_bf16 v[160:163], a[184:187], a[124:127], v[160:163]
buffer_load_dwordx4 v4, s[24:27], s64 offen offset:0 sc1 lds
v_mfma_f32_16x16x32_bf16 v[160:163], a[168:171], a[108:111], v[160:163]
v_cvt_pk_bf16_f32 v35, v86, v87
v_cvt_pk_bf16_f32 v212, v212, v213
v_mfma_f32_16x16x32_bf16 v[168:171], a[188:191], a[124:127], v[168:171]
v_cvt_pk_bf16_f32 v213, v214, v215
v_cvt_pk_bf16_f32 v214, v228, v229
v_mfma_f32_16x16x32_bf16 v[168:171], a[172:175], a[108:111], v[168:171]
v_cvt_pk_bf16_f32 v215, v230, v231
v_cvt_pk_bf16_f32 v88, v88, v89
v_mfma_f32_16x16x32_bf16 v[192:195], a[64:67], a[124:127], v[192:195]
v_cvt_pk_bf16_f32 v89, v90, v91
v_cvt_pk_bf16_f32 v90, v176, v177
v_mfma_f32_16x16x32_bf16 v[192:195], a[80:83], a[108:111], v[192:195]
v_cvt_pk_bf16_f32 v91, v178, v179
v_cvt_pk_bf16_f32 v224, v224, v225
v_mfma_f32_16x16x32_bf16 v[152:155], a[128:131], a[124:127], v[152:155]
v_cvt_pk_bf16_f32 v225, v226, v227
v_cvt_pk_bf16_f32 v226, v200, v201
v_mfma_f32_16x16x32_bf16 v[152:155], a[144:147], a[108:111], v[152:155]
v_cvt_pk_bf16_f32 v227, v202, v203
v_cvt_pk_bf16_f32 v52, v52, v53
v_mfma_f32_16x16x32_bf16 v[60:63], a[68:71], a[124:127], v[60:63]
v_cvt_pk_bf16_f32 v53, v54, v55
v_cvt_pk_bf16_f32 v54, v76, v77
v_mfma_f32_16x16x32_bf16 v[60:63], a[84:87], a[108:111], v[60:63]
v_cvt_pk_bf16_f32 v55, v78, v79
v_cvt_pk_bf16_f32 v220, v220, v221
v_mfma_f32_16x16x32_bf16 v[68:71], a[132:135], a[124:127], v[68:71]
buffer_load_dwordx4 v4, s[24:27], s64 offen offset:1024 sc1 lds
v_mfma_f32_16x16x32_bf16 v[68:71], a[148:151], a[108:111], v[68:71]
v_cvt_pk_bf16_f32 v221, v222, v223
v_cvt_pk_bf16_f32 v222, v72, v73
v_mfma_f32_16x16x32_bf16 v[100:103], a[72:75], a[112:115], v[100:103]
v_cvt_pk_bf16_f32 v223, v74, v75
v_cvt_pk_bf16_f32 v160, v160, v161
v_mfma_f32_16x16x32_bf16 v[100:103], a[88:91], a[96:99], v[100:103]
v_cvt_pk_bf16_f32 v161, v162, v163
v_cvt_pk_bf16_f32 v162, v168, v169
v_mfma_f32_16x16x32_bf16 v[148:151], a[136:139], a[112:115], v[148:151]
v_cvt_pk_bf16_f32 v163, v170, v171
v_cvt_pk_bf16_f32 v192, v192, v193
v_mfma_f32_16x16x32_bf16 v[148:151], a[152:155], a[96:99], v[148:151]
v_cvt_pk_bf16_f32 v193, v194, v195
v_cvt_pk_bf16_f32 v194, v152, v153
v_mfma_f32_16x16x32_bf16 v[156:159], a[76:79], a[112:115], v[156:159]
ds_read_b128 a[192:195], v4 offset:32768
v_cvt_pk_bf16_f32 v195, v154, v155
v_mfma_f32_16x16x32_bf16 v[156:159], a[92:95], a[96:99], v[156:159]
ds_read_b128 a[196:199], v4 offset:33792
ds_read_b128 a[200:203], v4 offset:34816
v_mfma_f32_16x16x32_bf16 v[56:59], a[140:143], a[112:115], v[56:59]
v_cvt_pk_bf16_f32 v60, v60, v61
v_cvt_pk_bf16_f32 v61, v62, v63
v_mfma_f32_16x16x32_bf16 v[56:59], a[156:159], a[96:99], v[56:59]
v_cvt_pk_bf16_f32 v62, v68, v69
v_cvt_pk_bf16_f32 v63, v70, v71
v_mfma_f32_16x16x32_bf16 v[108:111], a[72:75], a[116:119], v[108:111]
ds_read_b128 a[204:207], v4 offset:35840
ds_read_b128 a[208:211], v4 offset:36864
v_mfma_f32_16x16x32_bf16 v[108:111], a[88:91], a[100:103], v[108:111]
buffer_load_dwordx4 v4, s[24:27], s64 offen offset:2048 sc1 lds
v_mfma_f32_16x16x32_bf16 v[140:143], a[136:139], a[116:119], v[140:143]
ds_read_b128 a[212:215], v4 offset:37888
ds_read_b128 a[216:219], v4 offset:38912
v_mfma_f32_16x16x32_bf16 v[140:143], a[152:155], a[100:103], v[140:143]
ds_read_b128 a[220:223], v4 offset:39936
v_mfma_f32_16x16x32_bf16 v[48:51], a[76:79], a[116:119], v[48:51]
v_mfma_f32_16x16x32_bf16 v[48:51], a[92:95], a[100:103], v[48:51]
v_mfma_f32_16x16x32_bf16 v[196:199], a[140:143], a[116:119], v[196:199]
ds_bpermute_b32 v8, v17, v103
v_cvt_pk_bf16_f32 v100, v100, v101
v_mfma_f32_16x16x32_bf16 v[196:199], a[156:159], a[100:103], v[196:199]
v_cvt_pk_bf16_f32 v101, v102, v103
v_cvt_pk_bf16_f32 v102, v148, v149
v_mfma_f32_16x16x32_bf16 v[116:119], a[72:75], a[120:123], v[116:119]
v_cvt_pk_bf16_f32 v103, v150, v151
v_mfma_f32_16x16x32_bf16 v[116:119], a[88:91], a[104:107], v[116:119]
buffer_store_dwordx4 v[100:103], v18, s[24:27], s54 offen offset:0 sc1
v_mfma_f32_16x16x32_bf16 v[132:135], a[136:139], a[120:123], v[132:135]
v_cvt_pk_bf16_f32 v156, v156, v157
v_cvt_pk_bf16_f32 v157, v158, v159
v_mfma_f32_16x16x32_bf16 v[132:135], a[152:155], a[104:107], v[132:135]
buffer_load_dwordx4 v4, s[24:27], s64 offen offset:3072 sc1 lds
v_mfma_f32_16x16x32_bf16 v[164:167], a[76:79], a[120:123], v[164:167]
v_cvt_pk_bf16_f32 v158, v56, v57
v_cvt_pk_bf16_f32 v159, v58, v59
v_mfma_f32_16x16x32_bf16 v[164:167], a[92:95], a[104:107], v[164:167]
buffer_store_dwordx4 v[156:159], v19, s[24:27], s54 offen offset:0 sc1
v_mfma_f32_16x16x32_bf16 v[188:191], a[140:143], a[120:123], v[188:191]
ds_bpermute_b32 v9, v17, v111
v_cvt_pk_bf16_f32 v108, v108, v109
v_mfma_f32_16x16x32_bf16 v[188:191], a[156:159], a[104:107], v[188:191]
v_cvt_pk_bf16_f32 v109, v110, v111
v_cvt_pk_bf16_f32 v110, v140, v141
v_mfma_f32_16x16x32_bf16 v[40:43], a[72:75], a[124:127], v[40:43]
v_cvt_pk_bf16_f32 v111, v142, v143
v_mfma_f32_16x16x32_bf16 v[40:43], a[88:91], a[108:111], v[40:43]
buffer_store_dwordx4 v[108:111], v18, s[24:27], s54 offen offset:256 sc1
v_mfma_f32_16x16x32_bf16 v[124:127], a[136:139], a[124:127], v[124:127]
v_cvt_pk_bf16_f32 v48, v48, v49
v_cvt_pk_bf16_f32 v49, v50, v51
v_mfma_f32_16x16x32_bf16 v[124:127], a[152:155], a[108:111], v[124:127]
v_cvt_pk_bf16_f32 v50, v196, v197
v_cvt_pk_bf16_f32 v51, v198, v199
v_mfma_f32_16x16x32_bf16 v[172:175], a[76:79], a[124:127], v[172:175]
buffer_store_dwordx4 v[48:51], v19, s[24:27], s54 offen offset:256 sc1
v_mfma_f32_16x16x32_bf16 v[172:175], a[92:95], a[108:111], v[172:175]
v_mfma_f32_16x16x32_bf16 v[180:183], a[140:143], a[124:127], v[180:183]
ds_bpermute_b32 v10, v17, v119
v_cvt_pk_bf16_f32 v116, v116, v117
v_mfma_f32_16x16x32_bf16 v[180:183], a[156:159], a[108:111], v[180:183]
s_waitcnt lgkmcnt(0)
v_cvt_pk_bf16_f32 v117, v118, v119
v_cvt_pk_bf16_f32 v118, v132, v133
v_mfma_f32_16x16x32_bf16 v[236:239], a[192:195], v[64:67], v[216:219]
v_cvt_pk_bf16_f32 v119, v134, v135
v_mfma_f32_16x16x32_bf16 v[236:239], a[196:199], v[244:247], v[236:239]
buffer_store_dwordx4 v[116:119], v18, s[24:27], s55 offen offset:0 sc1
v_mfma_f32_16x16x32_bf16 v[236:239], a[200:203], v[240:243], v[236:239]
v_cvt_pk_bf16_f32 v164, v164, v165
v_cvt_pk_bf16_f32 v165, v166, v167
v_mfma_f32_16x16x32_bf16 v[236:239], a[204:207], v[44:47], v[236:239]
v_cvt_pk_bf16_f32 v166, v188, v189
v_cvt_pk_bf16_f32 v167, v190, v191
v_mfma_f32_16x16x32_bf16 v[248:251], a[192:195], v[204:207], v[96:99]
buffer_store_dwordx4 v[164:167], v19, s[24:27], s55 offen offset:0 sc1
v_mfma_f32_16x16x32_bf16 v[248:251], a[196:199], v[252:255], v[248:251]
v_mfma_f32_16x16x32_bf16 v[248:251], a[200:203], v[232:235], v[248:251]
ds_bpermute_b32 v11, v17, v43
v_cvt_pk_bf16_f32 v40, v40, v41
v_mfma_f32_16x16x32_bf16 v[248:251], a[204:207], v[32:35], v[248:251]
v_cvt_pk_bf16_f32 v41, v42, v43
v_cvt_pk_bf16_f32 v42, v124, v125
v_mfma_f32_16x16x32_bf16 v[36:39], a[208:211], v[64:67], v[104:107]
v_cvt_pk_bf16_f32 v43, v126, v127
v_mfma_f32_16x16x32_bf16 v[36:39], a[212:215], v[244:247], v[36:39]
buffer_store_dwordx4 v[40:43], v18, s[24:27], s55 offen offset:256 sc1
v_mfma_f32_16x16x32_bf16 v[36:39], a[216:219], v[240:243], v[36:39]
v_cvt_pk_bf16_f32 v172, v172, v173
v_cvt_pk_bf16_f32 v173, v174, v175
v_mfma_f32_16x16x32_bf16 v[36:39], a[220:223], v[44:47], v[36:39]
v_cvt_pk_bf16_f32 v174, v180, v181
v_cvt_pk_bf16_f32 v175, v182, v183
v_mfma_f32_16x16x32_bf16 v[92:95], a[208:211], v[204:207], v[112:115]
buffer_store_dwordx4 v[172:175], v19, s[24:27], s55 offen offset:256 sc1
v_mfma_f32_16x16x32_bf16 v[92:95], a[212:215], v[252:255], v[92:95]
v_mfma_f32_16x16x32_bf16 v[92:95], a[216:219], v[232:235], v[92:95]
v_mfma_f32_16x16x32_bf16 v[92:95], a[220:223], v[32:35], v[92:95]
s_waitcnt vmcnt(23)
v_mfma_f32_16x16x32_bf16 v[80:83], a[192:195], v[212:215], v[120:123]
s_barrier
v_mfma_f32_16x16x32_bf16 v[80:83], a[196:199], v[88:91], v[80:83]
v_mfma_f32_16x16x32_bf16 v[80:83], a[200:203], v[224:227], v[80:83]
v_mfma_f32_16x16x32_bf16 v[80:83], a[204:207], v[52:55], v[80:83]
v_mfma_f32_16x16x32_bf16 v[184:187], a[192:195], v[220:223], v[128:131]
v_mfma_f32_16x16x32_bf16 v[184:187], a[196:199], v[160:163], v[184:187]
v_mfma_f32_16x16x32_bf16 v[184:187], a[200:203], v[192:195], v[184:187]
v_mfma_f32_16x16x32_bf16 v[184:187], a[204:207], v[60:63], v[184:187]
v_mfma_f32_16x16x32_bf16 v[208:211], a[208:211], v[212:215], v[136:139]
v_mfma_f32_16x16x32_bf16 v[208:211], a[212:215], v[88:91], v[208:211]
v_mfma_f32_16x16x32_bf16 v[208:211], a[216:219], v[224:227], v[208:211]
v_mfma_f32_16x16x32_bf16 v[208:211], a[220:223], v[52:55], v[208:211]
v_mfma_f32_16x16x32_bf16 v[84:87], a[208:211], v[220:223], v[144:147]
v_mfma_f32_16x16x32_bf16 v[84:87], a[212:215], v[160:163], v[84:87]
v_mfma_f32_16x16x32_bf16 v[84:87], a[216:219], v[192:195], v[84:87]
v_mfma_f32_16x16x32_bf16 v[84:87], a[220:223], v[60:63], v[84:87]
ds_read_b128 a[64:67], v4 offset:57344
ds_read_b128 a[68:71], v4 offset:58368
ds_read_b128 a[72:75], v4 offset:59392
ds_read_b128 a[76:79], v4 offset:60416
ds_read_b128 a[80:83], v4 offset:61440
ds_read_b128 a[84:87], v4 offset:62464
ds_read_b128 a[88:91], v4 offset:63488
ds_read_b128 a[92:95], v4 offset:64512
s_add_u32 m0, s70, 98304
s_add_u32 s64, s68, 65536
buffer_load_dwordx4 v4, s[24:27], s64 offen offset:0 sc1 lds
v_max3_f32 v24, v236, v237, v238
v_max3_f32 v25, v239, v36, v37
v_max3_f32 v26, v248, v249, v250
v_max3_f32 v27, v251, v92, v93
v_max3_f32 v24, v24, v38, v39
v_max_f32 v24, v24, v25
buffer_load_dwordx4 v4, s[24:27], s64 offen offset:1024 sc1 lds
v_max3_f32 v26, v26, v94, v95
v_max_f32 v26, v26, v27
v_mov_b32 v25, v24
v_mov_b32 v27, v26
s_nop 1
v_permlane32_swap_b32 v25, v24
buffer_load_dwordx4 v4, s[24:27], s64 offen offset:2048 sc1 lds
v_permlane32_swap_b32 v27, v26
s_nop 0
v_max_f32 v24, v24, v25
v_max_f32 v26, v26, v27
v_mov_b32 v25, v24
v_mov_b32 v27, v26
buffer_load_dwordx4 v4, s[24:27], s64 offen offset:3072 sc1 lds
s_nop 1
v_permlane16_swap_b32 v25, v24
v_permlane16_swap_b32 v27, v26
s_nop 0
v_max_f32 v24, v24, v25
v_max_f32 v26, v26, v27
s_add_u32 m0, s70, 114688
s_add_u32 s64, s68, 81920
buffer_load_dwordx4 v4, s[24:27], s64 offen offset:0 sc1 lds
v_pk_add_f32 v[236:237], v[236:237], v[24:25] op_sel_hi:[1,0] neg_lo:[0,1] neg_hi:[0,1]
v_pk_add_f32 v[238:239], v[238:239], v[24:25] op_sel_hi:[1,0] neg_lo:[0,1] neg_hi:[0,1]
v_pk_add_f32 v[248:249], v[248:249], v[26:27] op_sel_hi:[1,0] neg_lo:[0,1] neg_hi:[0,1]
v_pk_add_f32 v[250:251], v[250:251], v[26:27] op_sel_hi:[1,0] neg_lo:[0,1] neg_hi:[0,1]
v_pk_add_f32 v[36:37], v[36:37], v[24:25] op_sel_hi:[1,0] neg_lo:[0,1] neg_hi:[0,1]
v_pk_add_f32 v[38:39], v[38:39], v[24:25] op_sel_hi:[1,0] neg_lo:[0,1] neg_hi:[0,1]
buffer_load_dwordx4 v4, s[24:27], s64 offen offset:1024 sc1 lds
v_pk_add_f32 v[92:93], v[92:93], v[26:27] op_sel_hi:[1,0] neg_lo:[0,1] neg_hi:[0,1]
v_pk_add_f32 v[94:95], v[94:95], v[26:27] op_sel_hi:[1,0] neg_lo:[0,1] neg_hi:[0,1]
v_pk_add_f32 v[216:217], v[216:217], v[24:25] op_sel_hi:[1,0] neg_lo:[0,1] neg_hi:[0,1]
v_pk_add_f32 v[218:219], v[218:219], v[24:25] op_sel_hi:[1,0] neg_lo:[0,1] neg_hi:[0,1]
v_pk_add_f32 v[96:97], v[96:97], v[26:27] op_sel_hi:[1,0] neg_lo:[0,1] neg_hi:[0,1]
v_pk_add_f32 v[98:99], v[98:99], v[26:27] op_sel_hi:[1,0] neg_lo:[0,1] neg_hi:[0,1]
buffer_load_dwordx4 v4, s[24:27], s64 offen offset:2048 sc1 lds
v_pk_add_f32 v[104:105], v[104:105], v[24:25] op_sel_hi:[1,0] neg_lo:[0,1] neg_hi:[0,1]
v_pk_add_f32 v[106:107], v[106:107], v[24:25] op_sel_hi:[1,0] neg_lo:[0,1] neg_hi:[0,1]
v_pk_add_f32 v[112:113], v[112:113], v[26:27] op_sel_hi:[1,0] neg_lo:[0,1] neg_hi:[0,1]
v_pk_add_f32 v[114:115], v[114:115], v[26:27] op_sel_hi:[1,0] neg_lo:[0,1] neg_hi:[0,1]
v_exp_f32 v236, v236
v_exp_f32 v237, v237
buffer_load_dwordx4 v4, s[24:27], s64 offen offset:3072 sc1 lds
v_exp_f32 v238, v238
v_exp_f32 v239, v239
v_cvt_pk_bf16_f32 v228, v236, v237
v_exp_f32 v248, v248
v_exp_f32 v249, v249
v_cvt_pk_bf16_f32 v229, v238, v239
s_add_u32 m0, s70, 131072
s_add_u32 s64, s68, 98304
s_cmp_ge_u32 s3, 1
s_cselect_b32 s64, s64, 2147418112
buffer_load_dwordx4 v4, s[24:27], s64 offen offset:0 sc1 lds
v_exp_f32 v250, v250
v_exp_f32 v251, v251
v_cvt_pk_bf16_f32 v176, v248, v249
v_exp_f32 v36, v36
v_exp_f32 v37, v37
v_cvt_pk_bf16_f32 v177, v250, v251
buffer_load_dwordx4 v4, s[24:27], s64 offen offset:1024 sc1 lds
v_exp_f32 v38, v38
v_exp_f32 v39, v39
v_cvt_pk_bf16_f32 v230, v36, v37
v_exp_f32 v92, v92
v_exp_f32 v93, v93
v_cvt_pk_bf16_f32 v231, v38, v39
buffer_load_dwordx4 v4, s[24:27], s64 offen offset:2048 sc1 lds
v_exp_f32 v94, v94
v_exp_f32 v95, v95
v_cvt_pk_bf16_f32 v178, v92, v93
v_max3_f32 v24, v80, v81, v82
v_cvt_pk_bf16_f32 v179, v94, v95
v_max3_f32 v25, v83, v208, v209
buffer_load_dwordx4 v4, s[24:27], s64 offen offset:3072 sc1 lds
v_max3_f32 v26, v184, v185, v186
v_max3_f32 v27, v187, v84, v85
v_max3_f32 v24, v24, v210, v211
v_max_f32 v24, v24, v25
v_max3_f32 v26, v26, v86, v87
v_max_f32 v26, v26, v27
s_add_u32 m0, s70, 147456
s_add_u32 s64, s68, 114688
s_cmp_ge_u32 s3, 2
s_cselect_b32 s64, s64, 2147418112
buffer_load_dwordx4 v4, s[24:27], s64 offen offset:0 sc1 lds
v_mov_b32 v25, v24
v_mov_b32 v27, v26
s_nop 1
v_permlane32_swap_b32 v25, v24
v_permlane32_swap_b32 v27, v26
s_nop 0
buffer_load_dwordx4 v4, s[24:27], s64 offen offset:1024 sc1 lds
v_max_f32 v24, v24, v25
v_max_f32 v26, v26, v27
v_mov_b32 v25, v24
v_mov_b32 v27, v26
s_nop 1
v_permlane16_swap_b32 v25, v24
buffer_load_dwordx4 v4, s[24:27], s64 offen offset:2048 sc1 lds
v_permlane16_swap_b32 v27, v26
s_nop 0
v_max_f32 v24, v24, v25
v_max_f32 v26, v26, v27
v_pk_add_f32 v[80:81], v[80:81], v[24:25] op_sel_hi:[1,0] neg_lo:[0,1] neg_hi:[0,1]
v_pk_add_f32 v[82:83], v[82:83], v[24:25] op_sel_hi:[1,0] neg_lo:[0,1] neg_hi:[0,1]
buffer_load_dwordx4 v4, s[24:27], s64 offen offset:3072 sc1 lds
v_pk_add_f32 v[184:185], v[184:185], v[26:27] op_sel_hi:[1,0] neg_lo:[0,1] neg_hi:[0,1]
v_pk_add_f32 v[186:187], v[186:187], v[26:27] op_sel_hi:[1,0] neg_lo:[0,1] neg_hi:[0,1]
v_pk_add_f32 v[208:209], v[208:209], v[24:25] op_sel_hi:[1,0] neg_lo:[0,1] neg_hi:[0,1]
v_pk_add_f32 v[210:211], v[210:211], v[24:25] op_sel_hi:[1,0] neg_lo:[0,1] neg_hi:[0,1]
v_pk_add_f32 v[84:85], v[84:85], v[26:27] op_sel_hi:[1,0] neg_lo:[0,1] neg_hi:[0,1]
v_pk_add_f32 v[86:87], v[86:87], v[26:27] op_sel_hi:[1,0] neg_lo:[0,1] neg_hi:[0,1]
s_add_u32 m0, s70, 0
s_add_u32 s64, s68, 131072
s_cmp_ge_u32 s3, 3
s_cselect_b32 s64, s64, 2147418112
buffer_load_dwordx4 v4, s[24:27], s64 offen offset:0 sc1 lds
v_pk_add_f32 v[120:121], v[120:121], v[24:25] op_sel_hi:[1,0] neg_lo:[0,1] neg_hi:[0,1]
v_pk_add_f32 v[122:123], v[122:123], v[24:25] op_sel_hi:[1,0] neg_lo:[0,1] neg_hi:[0,1]
v_pk_add_f32 v[128:129], v[128:129], v[26:27] op_sel_hi:[1,0] neg_lo:[0,1] neg_hi:[0,1]
v_pk_add_f32 v[130:131], v[130:131], v[26:27] op_sel_hi:[1,0] neg_lo:[0,1] neg_hi:[0,1]
v_pk_add_f32 v[136:137], v[136:137], v[24:25] op_sel_hi:[1,0] neg_lo:[0,1] neg_hi:[0,1]
v_pk_add_f32 v[138:139], v[138:139], v[24:25] op_sel_hi:[1,0] neg_lo:[0,1] neg_hi:[0,1]
buffer_load_dwordx4 v4, s[24:27], s64 offen offset:1024 sc1 lds
v_pk_add_f32 v[144:145], v[144:145], v[26:27] op_sel_hi:[1,0] neg_lo:[0,1] neg_hi:[0,1]
v_pk_add_f32 v[146:147], v[146:147], v[26:27] op_sel_hi:[1,0] neg_lo:[0,1] neg_hi:[0,1]
v_mov_b64 v[100:101], 0
v_mov_b64 v[102:103], 0
v_mov_b64 v[148:149], 0
v_mov_b64 v[150:151], 0
buffer_load_dwordx4 v4, s[24:27], s64 offen offset:2048 sc1 lds
v_mov_b64 v[156:157], 0
v_mov_b64 v[158:159], 0
v_mov_b64 v[56:57], 0
v_mov_b64 v[58:59], 0
v_mov_b64 v[108:109], 0
v_mov_b64 v[110:111], 0
buffer_load_dwordx4 v4, s[24:27], s64 offen offset:3072 sc1 lds
v_mov_b64 v[140:141], 0
v_mov_b64 v[142:143], 0
v_mov_b64 v[48:49], 0
v_mov_b64 v[50:51], 0
v_mov_b64 v[196:197], 0
v_mov_b64 v[198:199], 0
v_mov_b64 v[116:117], 0
v_mov_b64 v[118:119], 0
v_mov_b64 v[132:133], 0
v_mov_b64 v[134:135], 0
v_mov_b64 v[164:165], 0
v_mov_b64 v[166:167], 0
v_mov_b64 v[188:189], 0
v_mov_b64 v[190:191], 0
v_mov_b64 v[40:41], 0
v_mov_b64 v[42:43], 0
v_mov_b64 v[124:125], 0
v_mov_b64 v[126:127], 0
v_mov_b64 v[172:173], 0
v_mov_b64 v[174:175], 0
v_mov_b64 v[180:181], 0
v_mov_b64 v[182:183], 0
ds_read_b128 a[192:195], v4 offset:49152
ds_read_b128 a[196:199], v4 offset:50176
ds_read_b128 a[200:203], v4 offset:51200
ds_read_b128 a[204:207], v4 offset:52224
ds_read_b128 a[208:211], v4 offset:53248
ds_read_b128 a[212:215], v4 offset:54272
ds_read_b128 a[216:219], v4 offset:55296
ds_read_b128 a[220:223], v4 offset:56320
s_waitcnt lgkmcnt(8)
s_lshl2_add_u32 s77, s86, s84
s_mul_i32 s77, s77, 344064
s_mov_b32 s80, s70
s_cmp_lt_u32 s3, 2
s_cselect_b32 s53, 8, -2
s_add_u32 s53, s53, s3
v_mfma_f32_16x16x32_bf16 a[0:3], a[64:67], v[228:231], 0
s_mul_i32 s52, s5, 65536
v_exp_f32 v80, v80
v_mfma_f32_16x16x32_bf16 a[32:35], a[64:67], v[176:179], 0
s_sub_u32 s52, 1064960, s52
v_exp_f32 v81, v81
v_mfma_f32_16x16x32_bf16 a[4:7], a[68:71], v[228:231], 0
s_add_u32 s71, s68, s52
v_exp_f32 v82, v82
v_mfma_f32_16x16x32_bf16 a[36:39], a[68:71], v[176:179], 0
s_add_u32 s77, s77, s80
v_exp_f32 v83, v83
v_mfma_f32_16x16x32_bf16 a[8:11], a[72:75], v[228:231], 0
s_add_u32 s77, s77, 38797312
v_cvt_pk_bf16_f32 v200, v80, v81
v_cvt_pk_bf16_f32 v201, v82, v83
v_mfma_f32_16x16x32_bf16 a[40:43], a[72:75], v[176:179], 0
s_add_u32 s52, s3, 6
v_exp_f32 v184, v184
v_mfma_f32_16x16x32_bf16 a[12:15], a[76:79], v[228:231], 0
s_mul_i32 s52, s52, 16384
v_exp_f32 v185, v185
v_mfma_f32_16x16x32_bf16 a[44:47], a[76:79], v[176:179], 0
s_add_u32 s68, s68, s52
v_exp_f32 v186, v186
v_mfma_f32_16x16x32_bf16 a[16:19], a[80:83], v[228:231], 0
s_lshl_b32 s53, s53, 14
v_exp_f32 v187, v187
v_mfma_f32_16x16x32_bf16 a[48:51], a[80:83], v[176:179], 0
s_add_u32 s70, s70, s53
v_cvt_pk_bf16_f32 v76, v184, v185
v_cvt_pk_bf16_f32 v77, v186, v187
v_mfma_f32_16x16x32_bf16 a[20:23], a[84:87], v[228:231], 0
s_mov_b32 s75, 65536
v_exp_f32 v208, v208
v_mfma_f32_16x16x32_bf16 a[52:55], a[84:87], v[176:179], 0
s_mov_b32 s72, 1
v_exp_f32 v209, v209
v_mfma_f32_16x16x32_bf16 a[24:27], a[88:91], v[228:231], 0
s_mov_b32 s73, 3
v_exp_f32 v210, v210
v_mfma_f32_16x16x32_bf16 a[56:59], a[88:91], v[176:179], 0
s_lshl2_add_u32 s69, s5, 4
v_exp_f32 v211, v211
v_mfma_f32_16x16x32_bf16 a[28:31], a[92:95], v[228:231], 0
s_min_u32 s74, s73, s66
v_cvt_pk_bf16_f32 v202, v208, v209
v_cvt_pk_bf16_f32 v203, v210, v211
v_mfma_f32_16x16x32_bf16 a[60:63], a[92:95], v[176:179], 0
s_mov_b32 s93, 3
v_exp_f32 v84, v84
v_mfma_f32_16x16x32_bf16 a[224:227], a[240:243], v[228:231], 0
L_PAD8:
s_cbranch_execz L_PAD12
v_mfma_f32_16x16x32_bf16 a[228:231], a[240:243], v[176:179], 0
s_cmp_lt_u32 s66, 2
s_waitcnt vmcnt(27) lgkmcnt(0)
s_cbranch_scc1 L_NE
L_DUAL:
v_mfma_f32_16x16x32_bf16 v[236:239], a[192:195], v[64:67], v[216:219]
s_barrier
v_mfma_f32_16x16x32_bf16 v[236:239], a[196:199], v[244:247], v[236:239]
s_cmp_eq_u32 s68, s71
v_exp_f32 v85, v85
v_mfma_f32_16x16x32_bf16 v[236:239], a[200:203], v[240:243], v[236:239]
s_cselect_b32 s64, s77, s68
v_add_u32 v5, s75, v4
v_cvt_pk_bf16_f32 v78, v84, v85
v_mfma_f32_16x16x32_bf16 v[236:239], a[204:207], v[44:47], v[236:239]
s_mov_b32 m0, s70
v_exp_f32 v86, v86
v_mfma_f32_16x16x32_bf16 v[248:251], a[192:195], v[204:207], v[96:99]
buffer_load_dwordx4 v4, s[24:27], s64 offen offset:0 sc1 lds
v_mfma_f32_16x16x32_bf16 v[248:251], a[196:199], v[252:255], v[248:251]
s_add_u32 s75, s75, 16384
v_exp_f32 v87, v87
v_mfma_f32_16x16x32_bf16 v[248:251], a[200:203], v[232:235], v[248:251]
v_cvt_pk_bf16_f32 v79, v86, v87
v_mfma_f32_16x16x32_bf16 v[248:251], a[204:207], v[32:35], v[248:251]
s_cmp_ge_u32 s75, 163840
v_exp_f32 v236, v236
v_mfma_f32_16x16x32_bf16 v[36:39], a[208:211], v[64:67], v[104:107]
v_mfma_f32_16x16x32_bf16 v[36:39], a[212:215], v[244:247], v[36:39]
s_cselect_b32 s75, 0, s75
v_exp_f32 v237, v237
v_mfma_f32_16x16x32_bf16 v[36:39], a[216:219], v[240:243], v[36:39]
v_cvt_pk_bf16_f32 v228, v236, v237
v_mfma_f32_16x16x32_bf16 v[36:39], a[220:223], v[44:47], v[36:39]
s_add_u32 s68, s64, 16384
v_exp_f32 v238, v238
v_mfma_f32_16x16x32_bf16 v[92:95], a[208:211], v[204:207], v[112:115]
buffer_load_dwordx4 v4, s[24:27], s64 offen offset:1024 sc1 lds
v_mfma_f32_16x16x32_bf16 v[92:95], a[212:215], v[252:255], v[92:95]
s_add_u32 s70, s70, 16384
v_exp_f32 v239, v239
v_mfma_f32_16x16x32_bf16 v[92:95], a[216:219], v[232:235], v[92:95]
v_cvt_pk_bf16_f32 v229, v238, v239
v_mfma_f32_16x16x32_bf16 v[92:95], a[220:223], v[32:35], v[92:95]
v_exp_f32 v248, v248
v_mfma_f32_16x16x32_bf16 v[100:103], a[64:67], v[200:203], v[100:103]
v_mfma_f32_16x16x32_bf16 v[116:119], a[64:67], v[76:79], v[116:119]
s_cmp_ge_u32 s70, 163840
v_exp_f32 v249, v249
v_mfma_f32_16x16x32_bf16 v[148:151], a[68:71], v[200:203], v[148:151]
ds_read_b128 a[64:67], v5 offset:8192
v_cvt_pk_bf16_f32 v176, v248, v249
v_mfma_f32_16x16x32_bf16 v[132:135], a[68:71], v[76:79], v[132:135]
s_cselect_b32 s70, s80, s70
v_exp_f32 v250, v250
v_mfma_f32_16x16x32_bf16 v[156:159], a[72:75], v[200:203], v[156:159]
buffer_load_dwordx4 v4, s[24:27], s64 offen offset:2048 sc1 lds
v_mfma_f32_16x16x32_bf16 v[164:167], a[72:75], v[76:79], v[164:167]
v_exp_f32 v251, v251
v_mfma_f32_16x16x32_bf16 v[56:59], a[76:79], v[200:203], v[56:59]
ds_read_b128 a[68:71], v5 offset:9216
v_cvt_pk_bf16_f32 v177, v250, v251
v_mfma_f32_16x16x32_bf16 v[188:191], a[76:79], v[76:79], v[188:191]
v_exp_f32 v36, v36
v_mfma_f32_16x16x32_bf16 v[108:111], a[80:83], v[200:203], v[108:111]
ds_read_b128 a[72:75], v5 offset:10240
v_mfma_f32_16x16x32_bf16 v[40:43], a[80:83], v[76:79], v[40:43]
v_exp_f32 v37, v37
v_mfma_f32_16x16x32_bf16 v[140:143], a[84:87], v[200:203], v[140:143]
ds_read_b128 a[76:79], v5 offset:11264
v_cvt_pk_bf16_f32 v230, v36, v37
v_mfma_f32_16x16x32_bf16 v[124:127], a[84:87], v[76:79], v[124:127]
v_exp_f32 v38, v38
v_mfma_f32_16x16x32_bf16 v[48:51], a[88:91], v[200:203], v[48:51]
buffer_load_dwordx4 v4, s[24:27], s64 offen offset:3072 sc1 lds
v_mfma_f32_16x16x32_bf16 v[172:175], a[88:91], v[76:79], v[172:175]
v_exp_f32 v39, v39
v_mfma_f32_16x16x32_bf16 v[196:199], a[92:95], v[200:203], v[196:199]
ds_read_b128 a[80:83], v5 offset:12288
v_cvt_pk_bf16_f32 v231, v38, v39
v_mfma_f32_16x16x32_bf16 v[180:183], a[92:95], v[76:79], v[180:183]
v_exp_f32 v92, v92
v_mfma_f32_16x16x32_bf16 a[232:235], a[240:243], v[200:203], a[232:235]
ds_read_b128 a[84:87], v5 offset:13312
v_mfma_f32_16x16x32_bf16 a[236:239], a[240:243], v[76:79], a[236:239]
ds_read_b128 a[88:91], v5 offset:14336
v_mfma_f32_16x16x32_bf16 v[80:83], a[192:195], v[212:215], v[120:123]
ds_read_b128 a[92:95], v5 offset:15360
v_mfma_f32_16x16x32_bf16 v[80:83], a[196:199], v[88:91], v[80:83]
v_exp_f32 v93, v93
v_mfma_f32_16x16x32_bf16 v[80:83], a[200:203], v[224:227], v[80:83]
v_cvt_pk_bf16_f32 v178, v92, v93
v_mfma_f32_16x16x32_bf16 v[80:83], a[204:207], v[52:55], v[80:83]
v_exp_f32 v94, v94
v_mfma_f32_16x16x32_bf16 v[184:187], a[192:195], v[220:223], v[128:131]
s_nop 0
v_mfma_f32_16x16x32_bf16 v[184:187], a[196:199], v[160:163], v[184:187]
v_exp_f32 v95, v95
v_mfma_f32_16x16x32_bf16 v[184:187], a[200:203], v[192:195], v[184:187]
ds_read_b128 a[192:195], v5 offset:0
v_cvt_pk_bf16_f32 v179, v94, v95
v_mfma_f32_16x16x32_bf16 v[184:187], a[204:207], v[60:63], v[184:187]
v_exp_f32 v80, v80
v_mfma_f32_16x16x32_bf16 v[208:211], a[208:211], v[212:215], v[136:139]
ds_read_b128 a[196:199], v5 offset:1024
v_mfma_f32_16x16x32_bf16 v[208:211], a[212:215], v[88:91], v[208:211]
v_exp_f32 v81, v81
v_mfma_f32_16x16x32_bf16 v[208:211], a[216:219], v[224:227], v[208:211]
ds_read_b128 a[200:203], v5 offset:2048
v_cvt_pk_bf16_f32 v200, v80, v81
v_mfma_f32_16x16x32_bf16 v[208:211], a[220:223], v[52:55], v[208:211]
v_exp_f32 v82, v82
v_mfma_f32_16x16x32_bf16 v[84:87], a[208:211], v[220:223], v[144:147]
ds_read_b128 a[204:207], v5 offset:3072
v_mfma_f32_16x16x32_bf16 v[84:87], a[212:215], v[160:163], v[84:87]
v_exp_f32 v83, v83
v_mfma_f32_16x16x32_bf16 v[84:87], a[216:219], v[192:195], v[84:87]
ds_read_b128 a[208:211], v5 offset:4096
v_cvt_pk_bf16_f32 v201, v82, v83
v_mfma_f32_16x16x32_bf16 v[84:87], a[220:223], v[60:63], v[84:87]
s_waitcnt lgkmcnt(5)
v_exp_f32 v184, v184
v_mfma_f32_16x16x32_bf16 a[0:3], a[64:67], v[228:231], a[0:3]
ds_read_b128 a[212:215], v5 offset:5120
v_mfma_f32_16x16x32_bf16 a[32:35], a[64:67], v[176:179], a[32:35]
v_exp_f32 v185, v185
v_mfma_f32_16x16x32_bf16 a[4:7], a[68:71], v[228:231], a[4:7]
ds_read_b128 a[216:219], v5 offset:6144
v_cvt_pk_bf16_f32 v76, v184, v185
v_mfma_f32_16x16x32_bf16 a[36:39], a[68:71], v[176:179], a[36:39]
v_exp_f32 v186, v186
v_mfma_f32_16x16x32_bf16 a[8:11], a[72:75], v[228:231], a[8:11]
ds_read_b128 a[220:223], v5 offset:7168
v_mfma_f32_16x16x32_bf16 a[40:43], a[72:75], v[176:179], a[40:43]
s_add_u32 s72, s72, 1
v_exp_f32 v187, v187
v_mfma_f32_16x16x32_bf16 a[12:15], a[76:79], v[228:231], a[12:15]
v_cvt_pk_bf16_f32 v77, v186, v187
v_mfma_f32_16x16x32_bf16 a[44:47], a[76:79], v[176:179], a[44:47]
v_exp_f32 v208, v208
v_mfma_f32_16x16x32_bf16 a[16:19], a[80:83], v[228:231], a[16:19]
v_mfma_f32_16x16x32_bf16 a[48:51], a[80:83], v[176:179], a[48:51]
v_exp_f32 v209, v209
v_mfma_f32_16x16x32_bf16 a[20:23], a[84:87], v[228:231], a[20:23]
v_cvt_pk_bf16_f32 v202, v208, v209
v_mfma_f32_16x16x32_bf16 a[52:55], a[84:87], v[176:179], a[52:55]
v_exp_f32 v210, v210
v_mfma_f32_16x16x32_bf16 a[24:27], a[88:91], v[228:231], a[24:27]
v_mfma_f32_16x16x32_bf16 a[56:59], a[88:91], v[176:179], a[56:59]
s_cmp_lt_u32 s72, s74
v_exp_f32 v211, v211
v_mfma_f32_16x16x32_bf16 a[28:31], a[92:95], v[228:231], a[28:31]
v_cvt_pk_bf16_f32 v203, v210, v211
v_mfma_f32_16x16x32_bf16 a[60:63], a[92:95], v[176:179], a[60:63]
s_waitcnt vmcnt(8) lgkmcnt(0)
v_exp_f32 v84, v84
v_mfma_f32_16x16x32_bf16 a[224:227], a[240:243], v[228:231], a[224:227]
v_mfma_f32_16x16x32_bf16 a[228:231], a[240:243], v[176:179], a[228:231]
s_cbranch_scc1 L_DUAL
L_DISP:
s_cmp_eq_u32 s72, s93
s_cbranch_scc1 L_STOP
L_NE:
s_mov_b32 s74, s93
s_cmp_gt_u32 s72, s66
s_cbranch_scc1 L_SINGLE
v_cndmask_b32 v216, v216, v6, s[56:57]
v_cndmask_b32 v112, v112, v6, s[56:57]
v_mov_b32 v104, v6
v_cndmask_b32 v217, v217, v6, s[58:59]
v_cndmask_b32 v113, v113, v6, s[58:59]
v_mov_b32 v105, v6
v_cndmask_b32 v218, v218, v6, s[60:61]
v_cndmask_b32 v114, v114, v6, s[60:61]
v_mov_b32 v106, v6
v_cndmask_b32 v219, v219, v6, s[62:63]
v_cndmask_b32 v115, v115, v6, s[62:63]
v_mov_b32 v107, v6
s_mov_b32 s74, 0
s_branch L_DUAL
L_STOP:
s_cmp_eq_u32 s72, 3
s_cbranch_scc1 L_E0
s_cmp_eq_u32 s72, 9
s_cbranch_scc1 L_E1
s_cmp_lg_u32 s72, 11
s_cbranch_scc1 L_SE
v_cmp_gt_u32 vcc, 32, v168
s_mov_b32 s73, 32
s_min_u32 s93, s73, s69
s_min_u32 s74, s93, s66
s_nop 1
s_cbranch_vccnz CK_Q
CK_Q_R:
s_cmp_lt_u32 s72, s66
s_cbranch_scc1 L_DUAL
s_mov_b32 s74, s93
s_cmp_gt_u32 s72, s66
s_cbranch_scc1 L_SINGLE
s_branch L_NE
L_E0:
buffer_atomic_add v1, v0, s[24:27], s89 offen offset:8 sc1
s_mov_b32 s73, 9
s_min_u32 s93, s73, s69
s_min_u32 s74, s93, s66
s_cmp_lt_u32 s72, s66
s_cbranch_scc1 L_DUAL
s_mov_b32 s74, s93
s_cmp_gt_u32 s72, s66
s_cbranch_scc1 L_SINGLE
s_branch L_NE
L_E1:
v_and_b32 v169, 31, v1
v_lshlrev_b32 v169, 10, v169
v_add_u32 v169, 75497992, v169
buffer_load_dword v168, v169, s[24:27], 0 offen sc1
s_mov_b32 s73, 11
s_min_u32 s93, s73, s69
s_min_u32 s74, s93, s66
s_cmp_lt_u32 s72, s66
s_cbranch_scc1 L_DUAL
s_mov_b32 s74, s93
s_cmp_gt_u32 s72, s66
s_cbranch_scc1 L_SINGLE
s_branch L_NE
L_SE:
s_lshr_b32 s52, s4, 3
s_mul_i32 s52, s52, 75776
s_add_u32 s52, s52, 54525952
s_and_b32 s53, s4, 7
s_mul_i32 s53, s53, 8192
s_add_u32 s52, s52, s53
s_mul_i32 s78, s66, 303104
s_add_u32 s78, s78, s52
s_mul_i32 s79, s67, 303104
s_add_u32 s79, s79, s52
s_mov_b32 s76, 0
v_mov_b32 v7, 0x5d800000
s_mov_b32 s69, 64
v_accvgpr_read_b32 v72, a224
v_accvgpr_read_b32 v74, a228
v_cmp_nle_f32 vcc, v72, v7
v_cmp_nle_f32 s[96:97], v74, v7
s_nop 3
s_or_b64 vcc, vcc, s[96:97]
s_cbranch_vccnz L_NS
v_mul_f32 v8, 0x3fb8aa3b, v8
v_mul_f32 v9, 0x3fb8aa3b, v9
v_exp_f32 v8, v8
v_exp_f32 v9, v9
s_nop 0
v_fma_f32 v72, v72, v8, v72
v_fma_f32 v74, v74, v9, v74
v_rcp_f32 v72, v72
v_rcp_f32 v74, v74
s_add_u32 s52, s78, 4096
v_mov_b32 v73, v72
v_mov_b32 v75, v74
v_accvgpr_read_b32 v16, a0
v_accvgpr_read_b32 v17, a1
v_accvgpr_read_b32 v18, a2
v_accvgpr_read_b32 v19, a3
v_accvgpr_read_b32 v20, a4
v_accvgpr_read_b32 v21, a5
v_accvgpr_read_b32 v22, a6
v_accvgpr_read_b32 v23, a7
v_pk_mul_f32 v[16:17], v[16:17], v[72:73]
v_pk_mul_f32 v[18:19], v[18:19], v[72:73]
v_pk_mul_f32 v[20:21], v[20:21], v[72:73]
v_pk_mul_f32 v[22:23], v[22:23], v[72:73]
v_cvt_pk_bf16_f32 v16, v16, v17
v_cvt_pk_bf16_f32 v17, v18, v19
v_cvt_pk_bf16_f32 v18, v20, v21
v_cvt_pk_bf16_f32 v19, v22, v23
buffer_store_dwordx4 v[16:19], v4, s[24:27], s78 offen offset:0 sc1
v_accvgpr_read_b32 v24, a32
v_accvgpr_read_b32 v25, a33
v_accvgpr_read_b32 v26, a34
v_accvgpr_read_b32 v27, a35
v_accvgpr_read_b32 v28, a36
v_accvgpr_read_b32 v29, a37
v_accvgpr_read_b32 v30, a38
v_accvgpr_read_b32 v31, a39
v_pk_mul_f32 v[24:25], v[24:25], v[74:75]
v_pk_mul_f32 v[26:27], v[26:27], v[74:75]
v_pk_mul_f32 v[28:29], v[28:29], v[74:75]
v_pk_mul_f32 v[30:31], v[30:31], v[74:75]
v_cvt_pk_bf16_f32 v24, v24, v25
v_cvt_pk_bf16_f32 v25, v26, v27
v_cvt_pk_bf16_f32 v26, v28, v29
v_cvt_pk_bf16_f32 v27, v30, v31
buffer_store_dwordx4 v[24:27], v4, s[24:27], s78 offen offset:1024 sc1
v_accvgpr_read_b32 v16, a8
v_accvgpr_read_b32 v17, a9
v_accvgpr_read_b32 v18, a10
v_accvgpr_read_b32 v19, a11
v_accvgpr_read_b32 v20, a12
v_accvgpr_read_b32 v21, a13
v_accvgpr_read_b32 v22, a14
v_accvgpr_read_b32 v23, a15
v_pk_mul_f32 v[16:17], v[16:17], v[72:73]
v_pk_mul_f32 v[18:19], v[18:19], v[72:73]
v_pk_mul_f32 v[20:21], v[20:21], v[72:73]
v_pk_mul_f32 v[22:23], v[22:23], v[72:73]
v_cvt_pk_bf16_f32 v16, v16, v17
v_cvt_pk_bf16_f32 v17, v18, v19
v_cvt_pk_bf16_f32 v18, v20, v21
v_cvt_pk_bf16_f32 v19, v22, v23
buffer_store_dwordx4 v[16:19], v4, s[24:27], s78 offen offset:2048 sc1
v_accvgpr_read_b32 v24, a40
v_accvgpr_read_b32 v25, a41
v_accvgpr_read_b32 v26, a42
v_accvgpr_read_b32 v27, a43
v_accvgpr_read_b32 v28, a44
v_accvgpr_read_b32 v29, a45
v_accvgpr_read_b32 v30, a46
v_accvgpr_read_b32 v31, a47
v_pk_mul_f32 v[24:25], v[24:25], v[74:75]
v_pk_mul_f32 v[26:27], v[26:27], v[74:75]
v_pk_mul_f32 v[28:29], v[28:29], v[74:75]
v_pk_mul_f32 v[30:31], v[30:31], v[74:75]
v_cvt_pk_bf16_f32 v24, v24, v25
v_cvt_pk_bf16_f32 v25, v26, v27
v_cvt_pk_bf16_f32 v26, v28, v29
v_cvt_pk_bf16_f32 v27, v30, v31
buffer_store_dwordx4 v[24:27], v4, s[24:27], s78 offen offset:3072 sc1
v_accvgpr_read_b32 v16, a16
v_accvgpr_read_b32 v17, a17
v_accvgpr_read_b32 v18, a18
v_accvgpr_read_b32 v19, a19
v_accvgpr_read_b32 v20, a20
v_accvgpr_read_b32 v21, a21
v_accvgpr_read_b32 v22, a22
v_accvgpr_read_b32 v23, a23
v_pk_mul_f32 v[16:17], v[16:17], v[72:73]
v_pk_mul_f32 v[18:19], v[18:19], v[72:73]
v_pk_mul_f32 v[20:21], v[20:21], v[72:73]
v_pk_mul_f32 v[22:23], v[22:23], v[72:73]
v_cvt_pk_bf16_f32 v16, v16, v17
v_cvt_pk_bf16_f32 v17, v18, v19
v_cvt_pk_bf16_f32 v18, v20, v21
v_cvt_pk_bf16_f32 v19, v22, v23
buffer_store_dwordx4 v[16:19], v4, s[24:27], s52 offen offset:0 sc1
v_accvgpr_read_b32 v24, a48
v_accvgpr_read_b32 v25, a49
v_accvgpr_read_b32 v26, a50
v_accvgpr_read_b32 v27, a51
v_accvgpr_read_b32 v28, a52
v_accvgpr_read_b32 v29, a53
v_accvgpr_read_b32 v30, a54
v_accvgpr_read_b32 v31, a55
v_pk_mul_f32 v[24:25], v[24:25], v[74:75]
v_pk_mul_f32 v[26:27], v[26:27], v[74:75]
v_pk_mul_f32 v[28:29], v[28:29], v[74:75]
v_pk_mul_f32 v[30:31], v[30:31], v[74:75]
v_cvt_pk_bf16_f32 v24, v24, v25
v_cvt_pk_bf16_f32 v25, v26, v27
v_cvt_pk_bf16_f32 v26, v28, v29
v_cvt_pk_bf16_f32 v27, v30, v31
buffer_store_dwordx4 v[24:27], v4, s[24:27], s52 offen offset:1024 sc1
v_accvgpr_read_b32 v16, a24
v_accvgpr_read_b32 v17, a25
v_accvgpr_read_b32 v18, a26
v_accvgpr_read_b32 v19, a27
v_accvgpr_read_b32 v20, a28
v_accvgpr_read_b32 v21, a29
v_accvgpr_read_b32 v22, a30
v_accvgpr_read_b32 v23, a31
v_pk_mul_f32 v[16:17], v[16:17], v[72:73]
v_pk_mul_f32 v[18:19], v[18:19], v[72:73]
v_pk_mul_f32 v[20:21], v[20:21], v[72:73]
v_pk_mul_f32 v[22:23], v[22:23], v[72:73]
v_cvt_pk_bf16_f32 v16, v16, v17
v_cvt_pk_bf16_f32 v17, v18, v19
v_cvt_pk_bf16_f32 v18, v20, v21
v_cvt_pk_bf16_f32 v19, v22, v23
buffer_store_dwordx4 v[16:19], v4, s[24:27], s52 offen offset:2048 sc1
v_accvgpr_read_b32 v24, a56
v_accvgpr_read_b32 v25, a57
v_accvgpr_read_b32 v26, a58
v_accvgpr_read_b32 v27, a59
v_accvgpr_read_b32 v28, a60
v_accvgpr_read_b32 v29, a61
v_accvgpr_read_b32 v30, a62
v_accvgpr_read_b32 v31, a63
v_pk_mul_f32 v[24:25], v[24:25], v[74:75]
v_pk_mul_f32 v[26:27], v[26:27], v[74:75]
v_pk_mul_f32 v[28:29], v[28:29], v[74:75]
v_pk_mul_f32 v[30:31], v[30:31], v[74:75]
v_cvt_pk_bf16_f32 v24, v24, v25
v_cvt_pk_bf16_f32 v25, v26, v27
v_cvt_pk_bf16_f32 v26, v28, v29
v_cvt_pk_bf16_f32 v27, v30, v31
buffer_store_dwordx4 v[24:27], v4, s[24:27], s52 offen offset:3072 sc1
s_mov_b32 s76, 1
L_NS:
s_mov_b32 s74, s73
s_mov_b32 s93, s73
s_cmp_eq_u32 s72, 32
s_cbranch_scc1 L_FIN
L_SINGLE:
v_mfma_f32_16x16x32_bf16 v[236:239], a[192:195], v[212:215], v[120:123]
s_barrier
v_mfma_f32_16x16x32_bf16 v[236:239], a[196:199], v[88:91], v[236:239]
s_cmp_eq_u32 s68, s71
v_exp_f32 v85, v85
v_mfma_f32_16x16x32_bf16 v[236:239], a[200:203], v[224:227], v[236:239]
s_cselect_b32 s64, s77, s68
v_add_u32 v5, s75, v4
v_cvt_pk_bf16_f32 v78, v84, v85
v_mfma_f32_16x16x32_bf16 v[236:239], a[204:207], v[52:55], v[236:239]
s_mov_b32 m0, s70
v_exp_f32 v86, v86
v_mfma_f32_16x16x32_bf16 v[248:251], a[192:195], v[220:223], v[128:131]
buffer_load_dwordx4 v4, s[24:27], s64 offen offset:0 sc1 lds
v_mfma_f32_16x16x32_bf16 v[248:251], a[196:199], v[160:163], v[248:251]
s_add_u32 s75, s75, 16384
v_exp_f32 v87, v87
v_mfma_f32_16x16x32_bf16 v[248:251], a[200:203], v[192:195], v[248:251]
ds_read_b128 a[192:195], v5 offset:0
v_cvt_pk_bf16_f32 v79, v86, v87
v_mfma_f32_16x16x32_bf16 v[248:251], a[204:207], v[60:63], v[248:251]
s_cmp_ge_u32 s75, 163840
v_exp_f32 v236, v236
v_mfma_f32_16x16x32_bf16 v[36:39], a[208:211], v[212:215], v[136:139]
ds_read_b128 a[196:199], v5 offset:1024
ds_read_b128 a[200:203], v5 offset:2048
v_mfma_f32_16x16x32_bf16 v[36:39], a[212:215], v[88:91], v[36:39]
s_cselect_b32 s75, 0, s75
v_exp_f32 v237, v237
v_mfma_f32_16x16x32_bf16 v[36:39], a[216:219], v[224:227], v[36:39]
ds_read_b128 a[204:207], v5 offset:3072
v_cvt_pk_bf16_f32 v228, v236, v237
v_mfma_f32_16x16x32_bf16 v[36:39], a[220:223], v[52:55], v[36:39]
s_add_u32 s68, s64, 16384
v_exp_f32 v238, v238
v_mfma_f32_16x16x32_bf16 v[92:95], a[208:211], v[220:223], v[144:147]
buffer_load_dwordx4 v4, s[24:27], s64 offen offset:1024 sc1 lds
v_mfma_f32_16x16x32_bf16 v[92:95], a[212:215], v[160:163], v[92:95]
s_add_u32 s70, s70, 16384
v_exp_f32 v239, v239
v_mfma_f32_16x16x32_bf16 v[92:95], a[216:219], v[192:195], v[92:95]
ds_read_b128 a[208:211], v5 offset:4096
v_cvt_pk_bf16_f32 v229, v238, v239
v_mfma_f32_16x16x32_bf16 v[92:95], a[220:223], v[60:63], v[92:95]
s_waitcnt lgkmcnt(5)
v_exp_f32 v248, v248
v_mfma_f32_16x16x32_bf16 v[100:103], a[64:67], v[200:203], v[100:103]
ds_read_b128 a[212:215], v5 offset:5120
ds_read_b128 a[216:219], v5 offset:6144
v_mfma_f32_16x16x32_bf16 v[116:119], a[64:67], v[76:79], v[116:119]
s_cmp_ge_u32 s70, 163840
v_exp_f32 v249, v249
v_mfma_f32_16x16x32_bf16 v[148:151], a[68:71], v[200:203], v[148:151]
ds_read_b128 a[220:223], v5 offset:7168
v_cvt_pk_bf16_f32 v176, v248, v249
v_mfma_f32_16x16x32_bf16 v[132:135], a[68:71], v[76:79], v[132:135]
s_cselect_b32 s70, s80, s70
v_exp_f32 v250, v250
v_mfma_f32_16x16x32_bf16 v[156:159], a[72:75], v[200:203], v[156:159]
buffer_load_dwordx4 v4, s[24:27], s64 offen offset:2048 sc1 lds
v_mfma_f32_16x16x32_bf16 v[164:167], a[72:75], v[76:79], v[164:167]
v_exp_f32 v251, v251
v_mfma_f32_16x16x32_bf16 v[56:59], a[76:79], v[200:203], v[56:59]
ds_read_b128 a[64:67], v5 offset:8192
v_cvt_pk_bf16_f32 v177, v250, v251
v_mfma_f32_16x16x32_bf16 v[188:191], a[76:79], v[76:79], v[188:191]
v_exp_f32 v36, v36
v_mfma_f32_16x16x32_bf16 v[108:111], a[80:83], v[200:203], v[108:111]
ds_read_b128 a[68:71], v5 offset:9216
ds_read_b128 a[72:75], v5 offset:10240
v_mfma_f32_16x16x32_bf16 v[40:43], a[80:83], v[76:79], v[40:43]
v_exp_f32 v37, v37
v_mfma_f32_16x16x32_bf16 v[140:143], a[84:87], v[200:203], v[140:143]
ds_read_b128 a[76:79], v5 offset:11264
v_cvt_pk_bf16_f32 v230, v36, v37
v_mfma_f32_16x16x32_bf16 v[124:127], a[84:87], v[76:79], v[124:127]
s_cmp_eq_u32 s68, s71
v_exp_f32 v38, v38
v_mfma_f32_16x16x32_bf16 v[48:51], a[88:91], v[200:203], v[48:51]
buffer_load_dwordx4 v4, s[24:27], s64 offen offset:3072 sc1 lds
v_mfma_f32_16x16x32_bf16 v[172:175], a[88:91], v[76:79], v[172:175]
s_cselect_b32 s64, s77, s68
v_exp_f32 v39, v39
v_mfma_f32_16x16x32_bf16 v[196:199], a[92:95], v[200:203], v[196:199]
ds_read_b128 a[80:83], v5 offset:12288
v_cvt_pk_bf16_f32 v231, v38, v39
v_mfma_f32_16x16x32_bf16 v[180:183], a[92:95], v[76:79], v[180:183]
s_waitcnt lgkmcnt(5)
v_exp_f32 v92, v92
v_mfma_f32_16x16x32_bf16 a[232:235], a[240:243], v[200:203], a[232:235]
ds_read_b128 a[84:87], v5 offset:13312
ds_read_b128 a[88:91], v5 offset:14336
v_mfma_f32_16x16x32_bf16 a[236:239], a[240:243], v[76:79], a[236:239]
s_mov_b32 m0, s70
ds_read_b128 a[92:95], v5 offset:15360
v_mfma_f32_16x16x32_bf16 v[80:83], a[192:195], v[212:215], v[120:123]
buffer_load_dwordx4 v4, s[24:27], s64 offen offset:0 sc1 lds
v_mfma_f32_16x16x32_bf16 v[80:83], a[196:199], v[88:91], v[80:83]
v_exp_f32 v93, v93
v_mfma_f32_16x16x32_bf16 v[80:83], a[200:203], v[224:227], v[80:83]
v_add_u32 v5, s75, v4
v_cvt_pk_bf16_f32 v178, v92, v93
v_mfma_f32_16x16x32_bf16 v[80:83], a[204:207], v[52:55], v[80:83]
v_exp_f32 v94, v94
v_mfma_f32_16x16x32_bf16 v[184:187], a[192:195], v[220:223], v[128:131]
buffer_load_dwordx4 v4, s[24:27], s64 offen offset:1024 sc1 lds
v_mfma_f32_16x16x32_bf16 v[184:187], a[196:199], v[160:163], v[184:187]
s_add_u32 s75, s75, 16384
v_exp_f32 v95, v95
v_mfma_f32_16x16x32_bf16 v[184:187], a[200:203], v[192:195], v[184:187]
ds_read_b128 a[192:195], v5 offset:0
v_cvt_pk_bf16_f32 v179, v94, v95
v_mfma_f32_16x16x32_bf16 v[184:187], a[204:207], v[60:63], v[184:187]
s_cmp_ge_u32 s75, 163840
v_exp_f32 v80, v80
v_mfma_f32_16x16x32_bf16 v[208:211], a[208:211], v[212:215], v[136:139]
ds_read_b128 a[196:199], v5 offset:1024
ds_read_b128 a[200:203], v5 offset:2048
v_mfma_f32_16x16x32_bf16 v[208:211], a[212:215], v[88:91], v[208:211]
s_cselect_b32 s75, 0, s75
v_exp_f32 v81, v81
v_mfma_f32_16x16x32_bf16 v[208:211], a[216:219], v[224:227], v[208:211]
ds_read_b128 a[204:207], v5 offset:3072
v_cvt_pk_bf16_f32 v200, v80, v81
v_mfma_f32_16x16x32_bf16 v[208:211], a[220:223], v[52:55], v[208:211]
s_add_u32 s68, s64, 16384
v_exp_f32 v82, v82
v_mfma_f32_16x16x32_bf16 v[84:87], a[208:211], v[220:223], v[144:147]
buffer_load_dwordx4 v4, s[24:27], s64 offen offset:2048 sc1 lds
v_mfma_f32_16x16x32_bf16 v[84:87], a[212:215], v[160:163], v[84:87]
s_add_u32 s70, s70, 16384
v_exp_f32 v83, v83
v_mfma_f32_16x16x32_bf16 v[84:87], a[216:219], v[192:195], v[84:87]
ds_read_b128 a[208:211], v5 offset:4096
v_cvt_pk_bf16_f32 v201, v82, v83
v_mfma_f32_16x16x32_bf16 v[84:87], a[220:223], v[60:63], v[84:87]
s_waitcnt lgkmcnt(5)
v_exp_f32 v184, v184
v_mfma_f32_16x16x32_bf16 v[100:103], a[64:67], v[228:231], v[100:103]
ds_read_b128 a[212:215], v5 offset:5120
ds_read_b128 a[216:219], v5 offset:6144
v_mfma_f32_16x16x32_bf16 v[116:119], a[64:67], v[176:179], v[116:119]
s_cmp_ge_u32 s70, 163840
v_exp_f32 v185, v185
v_mfma_f32_16x16x32_bf16 v[148:151], a[68:71], v[228:231], v[148:151]
ds_read_b128 a[220:223], v5 offset:7168
v_cvt_pk_bf16_f32 v76, v184, v185
v_mfma_f32_16x16x32_bf16 v[132:135], a[68:71], v[176:179], v[132:135]
s_cselect_b32 s70, s80, s70
v_exp_f32 v186, v186
v_mfma_f32_16x16x32_bf16 v[156:159], a[72:75], v[228:231], v[156:159]
buffer_load_dwordx4 v4, s[24:27], s64 offen offset:3072 sc1 lds
v_mfma_f32_16x16x32_bf16 v[164:167], a[72:75], v[176:179], v[164:167]
s_add_u32 s72, s72, 1
v_exp_f32 v187, v187
v_mfma_f32_16x16x32_bf16 v[56:59], a[76:79], v[228:231], v[56:59]
ds_read_b128 a[64:67], v5 offset:8192
v_cvt_pk_bf16_f32 v77, v186, v187
v_mfma_f32_16x16x32_bf16 v[188:191], a[76:79], v[176:179], v[188:191]
v_exp_f32 v208, v208
v_mfma_f32_16x16x32_bf16 v[108:111], a[80:83], v[228:231], v[108:111]
ds_read_b128 a[68:71], v5 offset:9216
ds_read_b128 a[72:75], v5 offset:10240
v_mfma_f32_16x16x32_bf16 v[40:43], a[80:83], v[176:179], v[40:43]
v_exp_f32 v209, v209
v_mfma_f32_16x16x32_bf16 v[140:143], a[84:87], v[228:231], v[140:143]
ds_read_b128 a[76:79], v5 offset:11264
v_cvt_pk_bf16_f32 v202, v208, v209
v_mfma_f32_16x16x32_bf16 v[124:127], a[84:87], v[176:179], v[124:127]
v_exp_f32 v210, v210
v_mfma_f32_16x16x32_bf16 v[48:51], a[88:91], v[228:231], v[48:51]
ds_read_b128 a[80:83], v5 offset:12288
ds_read_b128 a[84:87], v5 offset:13312
v_mfma_f32_16x16x32_bf16 v[172:175], a[88:91], v[176:179], v[172:175]
s_cmp_lt_u32 s72, s74
v_exp_f32 v211, v211
v_mfma_f32_16x16x32_bf16 v[196:199], a[92:95], v[228:231], v[196:199]
ds_read_b128 a[88:91], v5 offset:14336
v_cvt_pk_bf16_f32 v203, v210, v211
v_mfma_f32_16x16x32_bf16 v[180:183], a[92:95], v[176:179], v[180:183]
s_waitcnt vmcnt(8) lgkmcnt(7)
v_exp_f32 v84, v84
v_mfma_f32_16x16x32_bf16 a[232:235], a[240:243], v[228:231], a[232:235]
ds_read_b128 a[92:95], v5 offset:15360
v_mfma_f32_16x16x32_bf16 a[236:239], a[240:243], v[176:179], a[236:239]
s_cbranch_scc1 L_SINGLE
s_cmp_eq_u32 s72, s69
s_cbranch_scc1 L_SE
s_cmp_lt_u32 s72, 32
s_cbranch_scc1 L_STOP
L_FIN:
v_cndmask_b32 v120, v120, v6, s[56:57]
v_cndmask_b32 v144, v144, v6, s[56:57]
v_mov_b32 v136, v6
v_cndmask_b32 v121, v121, v6, s[58:59]
v_cndmask_b32 v145, v145, v6, s[58:59]
v_mov_b32 v137, v6
v_cndmask_b32 v122, v122, v6, s[60:61]
v_cndmask_b32 v146, v146, v6, s[60:61]
v_mov_b32 v138, v6
v_cndmask_b32 v123, v123, v6, s[62:63]
v_cndmask_b32 v147, v147, v6, s[62:63]
v_mov_b32 v139, v6
s_sub_u32 s91, s70, s80
s_mov_b32 s83, s75
s_lshl_b32 s53, s4, 18
s_add_u32 s53, s53, 45088768
s_lshl_b32 s54, s66, 9
s_add_u32 s54, s54, s53
s_lshl_b32 s55, s67, 9
s_add_u32 s55, s55, s53
v_mfma_f32_16x16x32_bf16 v[236:239], a[192:195], v[212:215], v[120:123]
s_barrier
v_mfma_f32_16x16x32_bf16 v[236:239], a[196:199], v[88:91], v[236:239]
s_add_u32 m0, s83, 0
v_exp_f32 v85, v85
v_mfma_f32_16x16x32_bf16 v[236:239], a[200:203], v[224:227], v[236:239]
L_PAD9:
s_cbranch_execz L_PAD13
s_add_u32 s64, s54, 65280
v_add_u32 v5, s75, v4
v_cvt_pk_bf16_f32 v78, v84, v85
v_mfma_f32_16x16x32_bf16 v[236:239], a[204:207], v[52:55], v[236:239]
v_exp_f32 v86, v86
v_mfma_f32_16x16x32_bf16 v[248:251], a[192:195], v[220:223], v[128:131]
s_mov_b32 exec_hi, 0xffff
buffer_load_dwordx4 v4, s[24:27], s64 offen sc1 lds
s_mov_b32 exec_hi, -1
v_mfma_f32_16x16x32_bf16 v[248:251], a[196:199], v[160:163], v[248:251]
s_add_u32 m0, s83, 768
v_exp_f32 v87, v87
v_mfma_f32_16x16x32_bf16 v[248:251], a[200:203], v[192:195], v[248:251]
s_add_u32 s64, s54, 98048
v_cvt_pk_bf16_f32 v79, v86, v87
v_mfma_f32_16x16x32_bf16 v[248:251], a[204:207], v[60:63], v[248:251]
v_exp_f32 v236, v236
v_mfma_f32_16x16x32_bf16 v[36:39], a[208:211], v[212:215], v[136:139]
s_mov_b32 exec_hi, 0xffff
buffer_load_dwordx4 v4, s[24:27], s64 offen sc1 lds
s_mov_b32 exec_hi, -1
v_mfma_f32_16x16x32_bf16 v[36:39], a[212:215], v[88:91], v[36:39]
s_add_u32 m0, s83, 1536
v_exp_f32 v237, v237
v_mfma_f32_16x16x32_bf16 v[36:39], a[216:219], v[224:227], v[36:39]
s_add_u32 s64, s54, 130816
v_cvt_pk_bf16_f32 v228, v236, v237
v_mfma_f32_16x16x32_bf16 v[36:39], a[220:223], v[52:55], v[36:39]
v_exp_f32 v238, v238
v_mfma_f32_16x16x32_bf16 v[92:95], a[208:211], v[220:223], v[144:147]
s_mov_b32 exec_hi, 0xffff
buffer_load_dwordx4 v4, s[24:27], s64 offen sc1 lds
s_mov_b32 exec_hi, -1
v_mfma_f32_16x16x32_bf16 v[92:95], a[212:215], v[160:163], v[92:95]
s_add_u32 m0, s83, 2304
v_exp_f32 v239, v239
v_mfma_f32_16x16x32_bf16 v[92:95], a[216:219], v[192:195], v[92:95]
s_add_u32 s64, s54, 163584
v_cvt_pk_bf16_f32 v229, v238, v239
v_mfma_f32_16x16x32_bf16 v[92:95], a[220:223], v[60:63], v[92:95]
s_waitcnt lgkmcnt(0)
v_exp_f32 v248, v248
v_mfma_f32_16x16x32_bf16 v[100:103], a[64:67], v[200:203], v[100:103]
s_mov_b32 exec_hi, 0xffff
buffer_load_dwordx4 v4, s[24:27], s64 offen sc1 lds
s_mov_b32 exec_hi, -1
v_mfma_f32_16x16x32_bf16 v[116:119], a[64:67], v[76:79], v[116:119]
s_add_u32 m0, s83, 3072
v_exp_f32 v249, v249
v_mfma_f32_16x16x32_bf16 v[148:151], a[68:71], v[200:203], v[148:151]
s_add_u32 s64, s54, 196352
ds_read_b128 a[64:67], v5 offset:8192
v_cvt_pk_bf16_f32 v176, v248, v249
v_mfma_f32_16x16x32_bf16 v[132:135], a[68:71], v[76:79], v[132:135]
v_exp_f32 v250, v250
v_mfma_f32_16x16x32_bf16 v[156:159], a[72:75], v[200:203], v[156:159]
s_mov_b32 exec_hi, 0xffff
buffer_load_dwordx4 v4, s[24:27], s64 offen sc1 lds
s_mov_b32 exec_hi, -1
v_mfma_f32_16x16x32_bf16 v[164:167], a[72:75], v[76:79], v[164:167]
v_exp_f32 v251, v251
v_mfma_f32_16x16x32_bf16 v[56:59], a[76:79], v[200:203], v[56:59]
ds_read_b128 a[68:71], v5 offset:9216
v_cvt_pk_bf16_f32 v177, v250, v251
v_mfma_f32_16x16x32_bf16 v[188:191], a[76:79], v[76:79], v[188:191]
v_exp_f32 v36, v36
v_mfma_f32_16x16x32_bf16 v[108:111], a[80:83], v[200:203], v[108:111]
ds_read_b128 a[72:75], v5 offset:10240
v_mfma_f32_16x16x32_bf16 v[40:43], a[80:83], v[76:79], v[40:43]
s_add_u32 m0, s83, 3840
v_exp_f32 v37, v37
v_mfma_f32_16x16x32_bf16 v[140:143], a[84:87], v[200:203], v[140:143]
s_add_u32 s64, s55, 65280
ds_read_b128 a[76:79], v5 offset:11264
v_cvt_pk_bf16_f32 v230, v36, v37
v_mfma_f32_16x16x32_bf16 v[124:127], a[84:87], v[76:79], v[124:127]
v_exp_f32 v38, v38
v_mfma_f32_16x16x32_bf16 v[48:51], a[88:91], v[200:203], v[48:51]
s_mov_b32 exec_hi, 0xffff
buffer_load_dwordx4 v4, s[24:27], s64 offen sc1 lds
s_mov_b32 exec_hi, -1
v_mfma_f32_16x16x32_bf16 v[172:175], a[88:91], v[76:79], v[172:175]
v_exp_f32 v39, v39
v_mfma_f32_16x16x32_bf16 v[196:199], a[92:95], v[200:203], v[196:199]
ds_read_b128 a[80:83], v5 offset:12288
v_cvt_pk_bf16_f32 v231, v38, v39
v_mfma_f32_16x16x32_bf16 v[180:183], a[92:95], v[76:79], v[180:183]
v_exp_f32 v92, v92
v_mfma_f32_16x16x32_bf16 a[232:235], a[240:243], v[200:203], a[232:235]
ds_read_b128 a[84:87], v5 offset:13312
ds_read_b128 a[88:91], v5 offset:14336
v_mfma_f32_16x16x32_bf16 a[236:239], a[240:243], v[76:79], a[236:239]
ds_read_b128 a[92:95], v5 offset:15360
v_exp_f32 v93, v93
v_exp_f32 v94, v94
v_exp_f32 v95, v95
v_cmp_lt_u32 vcc, 31, v1
v_cvt_pk_bf16_f32 v178, v92, v93
v_cvt_pk_bf16_f32 v179, v94, v95
s_waitcnt lgkmcnt(0)
s_add_u32 m0, s83, 4608
v_mfma_f32_16x16x32_bf16 v[100:103], a[64:67], v[228:231], v[100:103]
s_add_u32 s64, s55, 98048
v_and_b32 v154, 31, v1
v_mov_b32 v152, s66
v_mfma_f32_16x16x32_bf16 v[116:119], a[64:67], v[176:179], v[116:119]
s_mov_b32 exec_hi, 0xffff
buffer_load_dwordx4 v4, s[24:27], s64 offen sc1 lds
s_mov_b32 exec_hi, -1
v_mfma_f32_16x16x32_bf16 v[148:151], a[68:71], v[228:231], v[148:151]
v_mov_b32 v155, s67
v_cndmask_b32 v152, v152, v155, vcc
v_mfma_f32_16x16x32_bf16 v[132:135], a[68:71], v[176:179], v[132:135]
s_add_u32 m0, s83, 5376
s_add_u32 s64, s55, 130816
v_lshl_add_u32 v152, v152, 5, v154
v_mfma_f32_16x16x32_bf16 v[156:159], a[72:75], v[228:231], v[156:159]
s_mov_b32 exec_hi, 0xffff
buffer_load_dwordx4 v4, s[24:27], s64 offen sc1 lds
s_mov_b32 exec_hi, -1
v_mfma_f32_16x16x32_bf16 v[164:167], a[72:75], v[176:179], v[164:167]
v_lshlrev_b32 v155, 4, v152
v_lshrrev_b32 v153, 5, v1
v_mfma_f32_16x16x32_bf16 v[56:59], a[76:79], v[228:231], v[56:59]
s_add_u32 m0, s83, 6144
s_add_u32 s64, s55, 163584
v_mul_u32_u24 v153, 3840, v153
v_mfma_f32_16x16x32_bf16 v[188:191], a[76:79], v[176:179], v[188:191]
s_mov_b32 exec_hi, 0xffff
buffer_load_dwordx4 v4, s[24:27], s64 offen sc1 lds
s_mov_b32 exec_hi, -1
v_mfma_f32_16x16x32_bf16 v[108:111], a[80:83], v[228:231], v[108:111]
v_lshl_add_u32 v153, v154, 4, v153
v_add_u32 v153, s83, v153
v_mfma_f32_16x16x32_bf16 v[40:43], a[80:83], v[176:179], v[40:43]
s_add_u32 m0, s83, 6912
s_add_u32 s64, s55, 196352
v_mfma_f32_16x16x32_bf16 v[140:143], a[84:87], v[228:231], v[140:143]
s_mov_b32 exec_hi, 0xffff
buffer_load_dwordx4 v4, s[24:27], s64 offen sc1 lds
s_mov_b32 exec_hi, -1
v_mfma_f32_16x16x32_bf16 v[124:127], a[84:87], v[176:179], v[124:127]
v_mfma_f32_16x16x32_bf16 v[48:51], a[88:91], v[228:231], v[48:51]
buffer_load_dwordx4 v[216:219], v155, s[24:27], s53 offen sc1
v_mfma_f32_16x16x32_bf16 v[172:175], a[88:91], v[176:179], v[172:175]
s_add_u32 s53, s53, 32768
s_lshl_b32 s74, s66, 10
s_lshr_b32 s52, s4, 3
v_mfma_f32_16x16x32_bf16 v[196:199], a[92:95], v[228:231], v[196:199]
buffer_load_dwordx4 v[96:99], v155, s[24:27], s53 offen sc1
v_mfma_f32_16x16x32_bf16 v[180:183], a[92:95], v[176:179], v[180:183]
s_lshl_b32 s52, s52, 7
s_add_u32 s74, s74, s52
s_add_u32 s74, s74, 75497472
v_mfma_f32_16x16x32_bf16 a[232:235], a[240:243], v[228:231], a[232:235]
v_mfma_f32_16x16x32_bf16 a[236:239], a[240:243], v[176:179], a[236:239]
s_lshr_b32 s52, s3, 1
s_lshl1_add_u32 s72, s85, s52
s_lshl3_add_u32 s75, s72, s84
s_lshl_b32 s75, s75, 7
s_add_u32 s75, s75, 75497472
s_and_b32 s82, s86, 1
s_lshl_b32 s82, s82, 13
v_mov_b32 v13, 0
s_nop 0
v_accvgpr_read_b32 v72, a232
v_accvgpr_read_b32 v74, a236
v_cmp_nle_f32 vcc, v72, v7
v_cmp_nle_f32 s[96:97], v74, v7
s_nop 3
s_or_b64 vcc, vcc, s[96:97]
s_cbranch_vccnz SLOW1
SLOW1_R:
s_mov_b32 m0, s70
s_mov_b32 s64, s68
s_add_u32 s68, s68, 16384
s_add_u32 s70, s70, 16384
s_cmp_ge_u32 s70, 163840
s_cselect_b32 s70, s80, s70
buffer_load_dwordx4 v4, s[24:27], s64 offen offset:0 sc1 lds
v_mul_f32 v10, 0x3fb8aa3b, v10
v_mul_f32 v11, 0x3fb8aa3b, v11
v_exp_f32 v10, v10
v_exp_f32 v11, v11
s_nop 0
v_fma_f32 v72, v72, v10, v72
v_fma_f32 v74, v74, v11, v74
v_rcp_f32 v72, v72
v_rcp_f32 v74, v74
buffer_load_dwordx4 v4, s[24:27], s64 offen offset:1024 sc1 lds
s_add_u32 s52, s79, 4096
v_mov_b32 v73, v72
v_mov_b32 v75, v74
v_pk_mul_f32 v[100:101], v[100:101], v[72:73]
v_pk_mul_f32 v[102:103], v[102:103], v[72:73]
v_pk_mul_f32 v[148:149], v[148:149], v[72:73]
v_pk_mul_f32 v[150:151], v[150:151], v[72:73]
v_cvt_pk_bf16_f32 v100, v100, v101
v_cvt_pk_bf16_f32 v101, v102, v103
buffer_load_dwordx4 v4, s[24:27], s64 offen offset:2048 sc1 lds
v_cvt_pk_bf16_f32 v102, v148, v149
v_cvt_pk_bf16_f32 v103, v150, v151
buffer_store_dwordx4 v[100:103], v4, s[24:27], s79 offen offset:0 sc1
v_pk_mul_f32 v[116:117], v[116:117], v[74:75]
v_pk_mul_f32 v[118:119], v[118:119], v[74:75]
v_pk_mul_f32 v[132:133], v[132:133], v[74:75]
v_pk_mul_f32 v[134:135], v[134:135], v[74:75]
v_cvt_pk_bf16_f32 v116, v116, v117
v_cvt_pk_bf16_f32 v117, v118, v119
buffer_load_dwordx4 v4, s[24:27], s64 offen offset:3072 sc1 lds
v_cvt_pk_bf16_f32 v118, v132, v133
v_cvt_pk_bf16_f32 v119, v134, v135
buffer_store_dwordx4 v[116:119], v4, s[24:27], s79 offen offset:1024 sc1
v_pk_mul_f32 v[156:157], v[156:157], v[72:73]
v_pk_mul_f32 v[158:159], v[158:159], v[72:73]
v_pk_mul_f32 v[56:57], v[56:57], v[72:73]
v_pk_mul_f32 v[58:59], v[58:59], v[72:73]
v_cvt_pk_bf16_f32 v156, v156, v157
v_cvt_pk_bf16_f32 v157, v158, v159
s_mov_b32 m0, s70
s_mov_b32 s64, s68
s_add_u32 s68, s68, 16384
s_add_u32 s70, s70, 16384
s_cmp_ge_u32 s70, 163840
s_cselect_b32 s70, s80, s70
buffer_load_dwordx4 v4, s[24:27], s64 offen offset:0 sc1 lds
v_cvt_pk_bf16_f32 v158, v56, v57
v_cvt_pk_bf16_f32 v159, v58, v59
buffer_store_dwordx4 v[156:159], v4, s[24:27], s79 offen offset:2048 sc1
v_pk_mul_f32 v[164:165], v[164:165], v[74:75]
v_pk_mul_f32 v[166:167], v[166:167], v[74:75]
v_pk_mul_f32 v[188:189], v[188:189], v[74:75]
v_pk_mul_f32 v[190:191], v[190:191], v[74:75]
v_cvt_pk_bf16_f32 v164, v164, v165
v_cvt_pk_bf16_f32 v165, v166, v167
buffer_load_dwordx4 v4, s[24:27], s64 offen offset:1024 sc1 lds
v_cvt_pk_bf16_f32 v166, v188, v189
v_cvt_pk_bf16_f32 v167, v190, v191
buffer_store_dwordx4 v[164:167], v4, s[24:27], s79 offen offset:3072 sc1
v_pk_mul_f32 v[108:109], v[108:109], v[72:73]
v_pk_mul_f32 v[110:111], v[110:111], v[72:73]
v_pk_mul_f32 v[140:141], v[140:141], v[72:73]
v_pk_mul_f32 v[142:143], v[142:143], v[72:73]
v_cvt_pk_bf16_f32 v108, v108, v109
v_cvt_pk_bf16_f32 v109, v110, v111
buffer_load_dwordx4 v4, s[24:27], s64 offen offset:2048 sc1 lds
v_cvt_pk_bf16_f32 v110, v140, v141
v_cvt_pk_bf16_f32 v111, v142, v143
buffer_store_dwordx4 v[108:111], v4, s[24:27], s52 offen offset:0 sc1
v_pk_mul_f32 v[40:41], v[40:41], v[74:75]
v_pk_mul_f32 v[42:43], v[42:43], v[74:75]
v_pk_mul_f32 v[124:125], v[124:125], v[74:75]
v_pk_mul_f32 v[126:127], v[126:127], v[74:75]
v_cvt_pk_bf16_f32 v40, v40, v41
v_cvt_pk_bf16_f32 v41, v42, v43
buffer_load_dwordx4 v4, s[24:27], s64 offen offset:3072 sc1 lds
v_cvt_pk_bf16_f32 v42, v124, v125
v_cvt_pk_bf16_f32 v43, v126, v127
buffer_store_dwordx4 v[40:43], v4, s[24:27], s52 offen offset:1024 sc1
v_pk_mul_f32 v[48:49], v[48:49], v[72:73]
v_pk_mul_f32 v[50:51], v[50:51], v[72:73]
v_pk_mul_f32 v[196:197], v[196:197], v[72:73]
v_pk_mul_f32 v[198:199], v[198:199], v[72:73]
v_cvt_pk_bf16_f32 v48, v48, v49
v_cvt_pk_bf16_f32 v49, v50, v51
v_cvt_pk_bf16_f32 v50, v196, v197
v_cvt_pk_bf16_f32 v51, v198, v199
buffer_store_dwordx4 v[48:51], v4, s[24:27], s52 offen offset:2048 sc1
v_pk_mul_f32 v[172:173], v[172:173], v[74:75]
v_pk_mul_f32 v[174:175], v[174:175], v[74:75]
v_pk_mul_f32 v[180:181], v[180:181], v[74:75]
v_pk_mul_f32 v[182:183], v[182:183], v[74:75]
v_cvt_pk_bf16_f32 v172, v172, v173
v_cvt_pk_bf16_f32 v173, v174, v175
v_cvt_pk_bf16_f32 v174, v180, v181
v_cvt_pk_bf16_f32 v175, v182, v183
buffer_store_dwordx4 v[172:175], v4, s[24:27], s52 offen offset:3072 sc1
s_cmp_eq_u32 s76, 0
s_cbranch_scc1 L_SE2
L_LA:
v_mov_b32 v5, v152
v_mov_b32 v6, v153
s_waitcnt vmcnt(16)
v_mov_b32 v16, v216
v_mov_b32 v17, v217
v_mov_b32 v18, v218
v_mov_b32 v19, v219
v_mov_b32 v20, v96
v_mov_b32 v21, v97
v_mov_b32 v22, v98
v_mov_b32 v23, v99
ds_read_b128 v[96:99], v6 offset:3328
ds_read_b128 v[32:35], v6 offset:256
ds_read_b128 v[36:39], v6 offset:1024
ds_read_b128 v[100:103], v6 offset:3296
ds_read_b128 v[40:43], v6 offset:224
ds_read_b128 v[44:47], v6 offset:992
ds_read_b128 v[104:107], v6 offset:3264
ds_read_b128 v[48:51], v6 offset:192
ds_read_b128 v[52:55], v6 offset:960
ds_read_b128 v[108:111], v6 offset:3232
ds_read_b128 v[56:59], v6 offset:160
ds_read_b128 v[60:63], v6 offset:928
ds_read_b128 v[112:115], v6 offset:3200
ds_read_b128 v[64:67], v6 offset:128
ds_read_b128 v[68:71], v6 offset:896
ds_read_b128 v[116:119], v6 offset:3168
ds_read_b128 v[72:75], v6 offset:96
ds_read_b128 v[76:79], v6 offset:864
ds_read_b128 v[120:123], v6 offset:3136
ds_read_b128 v[80:83], v6 offset:64
ds_read_b128 v[84:87], v6 offset:832
ds_read_b128 v[124:127], v6 offset:3104
ds_read_b128 v[88:91], v6 offset:32
ds_read_b128 v[92:95], v6 offset:800
ds_read_b128 v[128:131], v6 offset:1792
ds_read_b128 v[132:135], v6 offset:2560
ds_read_b128 v[136:139], v6 offset:1760
ds_read_b128 v[140:143], v6 offset:2528
ds_read_b128 v[144:147], v6 offset:1728
ds_read_b128 v[148:151], v6 offset:2496
ds_read_b128 v[152:155], v6 offset:1696
ds_read_b128 v[156:159], v6 offset:2464
ds_read_b128 v[160:163], v6 offset:1664
ds_read_b128 v[164:167], v6 offset:2432
ds_read_b128 v[168:171], v6 offset:1632
ds_read_b128 v[172:175], v6 offset:2400
ds_read_b128 v[176:179], v6 offset:1600
ds_read_b128 v[180:183], v6 offset:2368
ds_read_b128 v[184:187], v6 offset:1568
ds_read_b128 v[188:191], v6 offset:2336
s_lshr_b32 s53, s4, 3
s_mul_i32 s53, s53, 75776
s_add_u32 s53, s53, 54525952
s_and_b32 s52, s3, 1
s_lshl_b32 s52, s52, 10
s_add_u32 s52, s52, s53
s_sub_u32 s54, 63, s72
s_mul_i32 s77, s72, 303104
s_add_u32 s77, s77, s52
s_mul_i32 s81, s54, 303104
s_add_u32 s81, s81, s52
s_add_u32 s91, s91, 114688
s_sub_u32 s52, s91, 163840
s_cmp_ge_u32 s91, 163840
s_cselect_b32 s91, s52, s91
v_add_u32 v14, 4096, v4
v_add_u32 v7, s91, v4
s_waitcnt lgkmcnt(0)
s_barrier
s_mov_b32 m0, s70
s_mov_b32 s64, s68
s_add_u32 s68, s68, 16384
s_add_u32 s70, s70, 16384
s_cmp_ge_u32 s70, 163840
s_cselect_b32 s70, s80, s70
buffer_load_dwordx4 v4, s[24:27], s64 offen offset:0 sc1 lds
v_and_b32 v9, 0xffff, v97
v_and_b32 v11, 0xffff0000, v97
v_dot2_f32_bf16 v24, v98, v99, 0
v_dot2_f32_bf16 v25, v102, v99, 0
v_dot2_f32_bf16 v26, v106, v99, 0
v_dot2_f32_bf16 v27, v110, v99, 0
v_dot2_f32_bf16 v28, v114, v99, 0
v_dot2_f32_bf16 v29, v118, v99, 0
v_dot2_f32_bf16 v30, v122, v99, 0
v_dot2_f32_bf16 v31, v126, v99, 0
v_dot2c_f32_bf16 v24, v96, v9
v_dot2c_f32_bf16 v25, v100, v9
v_dot2c_f32_bf16 v26, v104, v9
v_dot2c_f32_bf16 v27, v108, v9
v_dot2c_f32_bf16 v28, v112, v9
v_dot2c_f32_bf16 v29, v116, v9
v_dot2c_f32_bf16 v30, v120, v9
v_dot2c_f32_bf16 v31, v124, v9
v_dot2c_f32_bf16 v24, v16, v32
v_dot2c_f32_bf16 v25, v16, v40
v_dot2c_f32_bf16 v26, v16, v48
v_dot2c_f32_bf16 v27, v16, v56
v_dot2c_f32_bf16 v28, v16, v64
v_dot2c_f32_bf16 v29, v16, v72
v_dot2c_f32_bf16 v30, v16, v80
buffer_load_dwordx4 v4, s[24:27], s64 offen offset:1024 sc1 lds
v_dot2c_f32_bf16 v31, v16, v88
v_dot2c_f32_bf16 v24, v17, v33
v_dot2c_f32_bf16 v25, v17, v41
v_dot2c_f32_bf16 v26, v17, v49
v_dot2c_f32_bf16 v27, v17, v57
v_dot2c_f32_bf16 v28, v17, v65
v_dot2c_f32_bf16 v29, v17, v73
v_dot2c_f32_bf16 v30, v17, v81
v_dot2c_f32_bf16 v31, v17, v89
v_dot2c_f32_bf16 v24, v18, v34
v_dot2c_f32_bf16 v25, v18, v42
v_dot2c_f32_bf16 v26, v18, v50
v_dot2c_f32_bf16 v27, v18, v58
v_dot2c_f32_bf16 v28, v18, v66
v_dot2c_f32_bf16 v29, v18, v74
v_dot2c_f32_bf16 v30, v18, v82
v_dot2c_f32_bf16 v31, v18, v90
v_dot2c_f32_bf16 v24, v19, v35
v_dot2c_f32_bf16 v25, v19, v43
v_dot2c_f32_bf16 v26, v19, v51
v_dot2c_f32_bf16 v27, v19, v59
v_dot2c_f32_bf16 v28, v19, v67
v_dot2c_f32_bf16 v29, v19, v75
v_dot2c_f32_bf16 v30, v19, v83
v_dot2c_f32_bf16 v31, v19, v91
buffer_load_dwordx4 v4, s[24:27], s64 offen offset:2048 sc1 lds
v_dot2c_f32_bf16 v24, v20, v36
v_dot2c_f32_bf16 v25, v20, v44
v_dot2c_f32_bf16 v26, v20, v52
v_dot2c_f32_bf16 v27, v20, v60
v_dot2c_f32_bf16 v28, v20, v68
v_dot2c_f32_bf16 v29, v20, v76
v_dot2c_f32_bf16 v30, v20, v84
v_dot2c_f32_bf16 v31, v20, v92
v_dot2c_f32_bf16 v24, v21, v37
v_dot2c_f32_bf16 v25, v21, v45
v_dot2c_f32_bf16 v26, v21, v53
v_dot2c_f32_bf16 v27, v21, v61
v_dot2c_f32_bf16 v28, v21, v69
v_dot2c_f32_bf16 v29, v21, v77
v_dot2c_f32_bf16 v30, v21, v85
v_dot2c_f32_bf16 v31, v21, v93
v_dot2c_f32_bf16 v24, v22, v38
v_dot2c_f32_bf16 v25, v22, v46
v_dot2c_f32_bf16 v26, v22, v54
v_dot2c_f32_bf16 v27, v22, v62
v_dot2c_f32_bf16 v28, v22, v70
v_dot2c_f32_bf16 v29, v22, v78
v_dot2c_f32_bf16 v30, v22, v86
v_dot2c_f32_bf16 v31, v22, v94
v_dot2c_f32_bf16 v24, v23, v39
buffer_load_dwordx4 v4, s[24:27], s64 offen offset:3072 sc1 lds
v_dot2c_f32_bf16 v25, v23, v47
v_dot2c_f32_bf16 v26, v23, v55
v_dot2c_f32_bf16 v27, v23, v63
v_dot2c_f32_bf16 v28, v23, v71
v_dot2c_f32_bf16 v29, v23, v79
v_dot2c_f32_bf16 v30, v23, v87
v_dot2c_f32_bf16 v31, v23, v95
v_mov_b32 v9, 0xf149f2ca
v_mul_f32 v11, 0xbfb8aa3b, v11
v_exp_f32 v11, v11
v_cmp_gt_u32 vcc, 2, v5
v_cmp_gt_u32 s[56:57], 4, v5
s_nop 0
v_cndmask_b32 v25, v25, v9, vcc
v_cndmask_b32 v26, v26, v9, s[56:57]
v_cmp_gt_u32 vcc, 6, v5
v_cmp_gt_u32 s[56:57], 8, v5
s_nop 0
v_cndmask_b32 v27, v27, v9, vcc
v_cndmask_b32 v28, v28, v9, s[56:57]
v_cmp_gt_u32 vcc, 10, v5
v_cmp_gt_u32 s[56:57], 12, v5
s_nop 0
v_cndmask_b32 v29, v29, v9, vcc
v_cndmask_b32 v30, v30, v9, s[56:57]
s_mov_b32 m0, s70
s_mov_b32 s64, s68
s_add_u32 s68, s68, 16384
s_add_u32 s70, s70, 16384
s_cmp_ge_u32 s70, 163840
s_cselect_b32 s70, s80, s70
buffer_load_dwordx4 v4, s[24:27], s64 offen offset:0 sc1 lds
v_cmp_gt_u32 vcc, 14, v5
s_nop 0
s_nop 0
v_cndmask_b32 v31, v31, v9, vcc
v_max3_f32 v10, v24, v25, v26
v_max3_f32 v10, v10, v27, v28
v_max3_f32 v10, v10, v29, v30
v_max_f32 v10, v10, v31
s_mov_b32 s52, 0x3eae1a93
v_sub_f32 v24, v24, v10
v_sub_f32 v25, v25, v10
v_sub_f32 v26, v26, v10
v_sub_f32 v27, v27, v10
v_sub_f32 v28, v28, v10
v_sub_f32 v29, v29, v10
v_sub_f32 v30, v30, v10
v_sub_f32 v31, v31, v10
v_mul_f32 v24, s52, v24
v_mul_f32 v25, s52, v25
v_mul_f32 v26, s52, v26
v_mul_f32 v27, s52, v27
v_mul_f32 v28, s52, v28
v_mul_f32 v29, s52, v29
v_mul_f32 v30, s52, v30
v_mul_f32 v31, s52, v31
buffer_load_dwordx4 v4, s[24:27], s64 offen offset:1024 sc1 lds
v_exp_f32 v24, v24
v_exp_f32 v25, v25
v_exp_f32 v26, v26
v_exp_f32 v27, v27
v_exp_f32 v28, v28
v_exp_f32 v29, v29
v_exp_f32 v30, v30
v_exp_f32 v31, v31
v_cvt_pk_bf16_f32 v32, v24, 0
v_cvt_pk_bf16_f32 v40, v25, 0
v_cvt_pk_bf16_f32 v48, v26, 0
v_cvt_pk_bf16_f32 v56, v27, 0
v_cvt_pk_bf16_f32 v64, v28, 0
v_cvt_pk_bf16_f32 v72, v29, 0
v_cvt_pk_bf16_f32 v80, v30, 0
v_cvt_pk_bf16_f32 v88, v31, 0
v_lshlrev_b32 v33, 16, v32
v_lshlrev_b32 v41, 16, v40
v_lshlrev_b32 v49, 16, v48
v_lshlrev_b32 v57, 16, v56
v_lshlrev_b32 v65, 16, v64
v_lshlrev_b32 v73, 16, v72
v_lshlrev_b32 v81, 16, v80
v_lshlrev_b32 v89, 16, v88
v_add_f32 v10, v33, v41
s_waitcnt vmcnt(6)
buffer_atomic_add v1, v0, s[24:27], s74 offen offset:0 sc1
buffer_load_dwordx4 v4, s[24:27], s64 offen offset:2048 sc1 lds
v_add_f32 v10, v10, v49
v_add_f32 v10, v10, v57
v_add_f32 v10, v10, v65
v_add_f32 v10, v10, v73
v_add_f32 v10, v10, v81
v_add_f32 v10, v10, v89
v_fmac_f32 v10, v10, v11
v_rcp_f32 v10, v10
v_dot2_f32_bf16 v192, v128, v32, 0
v_dot2_f32_bf16 v193, v128, v33, 0
v_dot2_f32_bf16 v194, v129, v32, 0
v_dot2_f32_bf16 v195, v129, v33, 0
buffer_load_dwordx4 v4, s[24:27], s64 offen offset:3072 sc1 lds
v_dot2_f32_bf16 v196, v130, v32, 0
v_dot2_f32_bf16 v197, v130, v33, 0
v_dot2_f32_bf16 v198, v131, v32, 0
v_dot2_f32_bf16 v199, v131, v33, 0
v_dot2_f32_bf16 v200, v132, v32, 0
v_dot2_f32_bf16 v201, v132, v33, 0
v_dot2_f32_bf16 v202, v133, v32, 0
v_dot2_f32_bf16 v203, v133, v33, 0
v_dot2_f32_bf16 v204, v134, v32, 0
v_dot2_f32_bf16 v205, v134, v33, 0
v_dot2_f32_bf16 v206, v135, v32, 0
v_dot2_f32_bf16 v207, v135, v33, 0
s_mov_b32 m0, s70
s_mov_b32 s64, s68
s_add_u32 s68, s68, 16384
s_add_u32 s70, s70, 16384
s_cmp_ge_u32 s70, 163840
s_cselect_b32 s70, s80, s70
buffer_load_dwordx4 v4, s[24:27], s64 offen offset:0 sc1 lds
v_dot2_f32_bf16 v208, v96, v33, 0
v_dot2_f32_bf16 v209, v98, v33, 0
v_dot2c_f32_bf16 v192, v136, v40
v_dot2c_f32_bf16 v193, v136, v41
v_dot2c_f32_bf16 v194, v137, v40
v_dot2c_f32_bf16 v195, v137, v41
v_dot2c_f32_bf16 v196, v138, v40
v_dot2c_f32_bf16 v197, v138, v41
v_dot2c_f32_bf16 v198, v139, v40
v_dot2c_f32_bf16 v199, v139, v41
v_dot2c_f32_bf16 v200, v140, v40
v_dot2c_f32_bf16 v201, v140, v41
buffer_load_dwordx4 v4, s[24:27], s64 offen offset:1024 sc1 lds
v_dot2c_f32_bf16 v202, v141, v40
v_dot2c_f32_bf16 v203, v141, v41
v_dot2c_f32_bf16 v204, v142, v40
v_dot2c_f32_bf16 v205, v142, v41
v_dot2c_f32_bf16 v206, v143, v40
v_dot2c_f32_bf16 v207, v143, v41
v_dot2c_f32_bf16 v208, v100, v41
v_dot2c_f32_bf16 v209, v102, v41
v_dot2c_f32_bf16 v192, v144, v48
v_dot2c_f32_bf16 v193, v144, v49
v_dot2c_f32_bf16 v194, v145, v48
v_dot2c_f32_bf16 v195, v145, v49
buffer_load_dwordx4 v4, s[24:27], s64 offen offset:2048 sc1 lds
v_dot2c_f32_bf16 v196, v146, v48
v_dot2c_f32_bf16 v197, v146, v49
v_dot2c_f32_bf16 v198, v147, v48
v_dot2c_f32_bf16 v199, v147, v49
v_dot2c_f32_bf16 v200, v148, v48
v_dot2c_f32_bf16 v201, v148, v49
v_dot2c_f32_bf16 v202, v149, v48
v_dot2c_f32_bf16 v203, v149, v49
v_dot2c_f32_bf16 v204, v150, v48
v_dot2c_f32_bf16 v205, v150, v49
v_dot2c_f32_bf16 v206, v151, v48
v_dot2c_f32_bf16 v207, v151, v49
buffer_load_dwordx4 v4, s[24:27], s64 offen offset:3072 sc1 lds
v_dot2c_f32_bf16 v208, v104, v49
v_dot2c_f32_bf16 v209, v106, v49
v_dot2c_f32_bf16 v192, v152, v56
v_dot2c_f32_bf16 v193, v152, v57
v_dot2c_f32_bf16 v194, v153, v56
v_dot2c_f32_bf16 v195, v153, v57
v_dot2c_f32_bf16 v196, v154, v56
v_dot2c_f32_bf16 v197, v154, v57
v_dot2c_f32_bf16 v198, v155, v56
v_dot2c_f32_bf16 v199, v155, v57
v_dot2c_f32_bf16 v200, v156, v56
v_dot2c_f32_bf16 v201, v156, v57
s_mov_b32 m0, s70
s_mov_b32 s64, s68
s_add_u32 s68, s68, 16384
s_add_u32 s70, s70, 16384
s_cmp_ge_u32 s70, 163840
s_cselect_b32 s70, s80, s70
buffer_load_dwordx4 v4, s[24:27], s64 offen offset:0 sc1 lds
v_dot2c_f32_bf16 v202, v157, v56
v_dot2c_f32_bf16 v203, v157, v57
v_dot2c_f32_bf16 v204, v158, v56
v_dot2c_f32_bf16 v205, v158, v57
v_dot2c_f32_bf16 v206, v159, v56
v_dot2c_f32_bf16 v207, v159, v57
v_dot2c_f32_bf16 v208, v108, v57
v_dot2c_f32_bf16 v209, v110, v57
v_dot2c_f32_bf16 v192, v160, v64
v_dot2c_f32_bf16 v193, v160, v65
v_dot2c_f32_bf16 v194, v161, v64
v_dot2c_f32_bf16 v195, v161, v65
buffer_load_dwordx4 v4, s[24:27], s64 offen offset:1024 sc1 lds
v_dot2c_f32_bf16 v196, v162, v64
v_dot2c_f32_bf16 v197, v162, v65
v_dot2c_f32_bf16 v198, v163, v64
v_dot2c_f32_bf16 v199, v163, v65
v_dot2c_f32_bf16 v200, v164, v64
v_dot2c_f32_bf16 v201, v164, v65
v_dot2c_f32_bf16 v202, v165, v64
v_dot2c_f32_bf16 v203, v165, v65
v_dot2c_f32_bf16 v204, v166, v64
v_dot2c_f32_bf16 v205, v166, v65
v_dot2c_f32_bf16 v206, v167, v64
v_dot2c_f32_bf16 v207, v167, v65
buffer_load_dwordx4 v4, s[24:27], s64 offen offset:2048 sc1 lds
v_dot2c_f32_bf16 v208, v112, v65
v_dot2c_f32_bf16 v209, v114, v65
v_dot2c_f32_bf16 v192, v168, v72
v_dot2c_f32_bf16 v193, v168, v73
v_dot2c_f32_bf16 v194, v169, v72
v_dot2c_f32_bf16 v195, v169, v73
v_dot2c_f32_bf16 v196, v170, v72
v_dot2c_f32_bf16 v197, v170, v73
v_dot2c_f32_bf16 v198, v171, v72
v_dot2c_f32_bf16 v199, v171, v73
v_dot2c_f32_bf16 v200, v172, v72
v_dot2c_f32_bf16 v201, v172, v73
buffer_load_dword v12, v13, s[24:27], s75 offen sc1
v_dot2c_f32_bf16 v202, v173, v72
v_dot2c_f32_bf16 v203, v173, v73
v_dot2c_f32_bf16 v204, v174, v72
v_dot2c_f32_bf16 v205, v174, v73
v_dot2c_f32_bf16 v206, v175, v72
v_dot2c_f32_bf16 v207, v175, v73
v_dot2c_f32_bf16 v208, v116, v73
v_dot2c_f32_bf16 v209, v118, v73
v_dot2c_f32_bf16 v192, v176, v80
v_dot2c_f32_bf16 v193, v176, v81
v_dot2c_f32_bf16 v194, v177, v80
v_dot2c_f32_bf16 v195, v177, v81
buffer_load_dwordx4 v4, s[24:27], s64 offen offset:3072 sc1 lds
v_dot2c_f32_bf16 v196, v178, v80
v_dot2c_f32_bf16 v197, v178, v81
v_dot2c_f32_bf16 v198, v179, v80
v_dot2c_f32_bf16 v199, v179, v81
v_dot2c_f32_bf16 v200, v180, v80
v_dot2c_f32_bf16 v201, v180, v81
v_dot2c_f32_bf16 v202, v181, v80
v_dot2c_f32_bf16 v203, v181, v81
v_dot2c_f32_bf16 v204, v182, v80
v_dot2c_f32_bf16 v205, v182, v81
v_dot2c_f32_bf16 v206, v183, v80
v_dot2c_f32_bf16 v207, v183, v81
s_mov_b32 m0, s70
s_mov_b32 s64, s68
s_add_u32 s68, s68, 16384
s_add_u32 s70, s70, 16384
s_cmp_ge_u32 s70, 163840
s_cselect_b32 s70, s80, s70
buffer_load_dwordx4 v4, s[24:27], s64 offen offset:0 sc1 lds
v_dot2c_f32_bf16 v208, v120, v81
v_dot2c_f32_bf16 v209, v122, v81
v_dot2c_f32_bf16 v192, v184, v88
v_dot2c_f32_bf16 v193, v184, v89
L_PAD10:
s_cbranch_execz L_MAIN
v_dot2c_f32_bf16 v194, v185, v88
v_dot2c_f32_bf16 v195, v185, v89
v_dot2c_f32_bf16 v196, v186, v88
v_dot2c_f32_bf16 v197, v186, v89
v_dot2c_f32_bf16 v198, v187, v88
v_dot2c_f32_bf16 v199, v187, v89
v_dot2c_f32_bf16 v200, v188, v88
v_dot2c_f32_bf16 v201, v188, v89
buffer_load_dwordx4 v4, s[24:27], s64 offen offset:1024 sc1 lds
v_dot2c_f32_bf16 v202, v189, v88
v_dot2c_f32_bf16 v203, v189, v89
v_dot2c_f32_bf16 v204, v190, v88
v_dot2c_f32_bf16 v205, v190, v89
v_dot2c_f32_bf16 v206, v191, v88
v_dot2c_f32_bf16 v207, v191, v89
v_dot2c_f32_bf16 v208, v124, v89
v_dot2c_f32_bf16 v209, v126, v89
v_lshrrev_b32 v9, 5, v5
v_mul_u32_u24 v9, 303104, v9
v_and_b32 v11, 1, v3
v_lshl_add_u32 v9, v11, 10, v9
buffer_load_dwordx4 v4, s[24:27], s64 offen offset:2048 sc1 lds
v_lshl_add_u32 v9, v2, 4, v9
v_mul_f32 v192, v10, v192
v_mul_f32 v193, v10, v193
v_mul_f32 v194, v10, v194
v_mul_f32 v195, v10, v195
v_mul_f32 v196, v10, v196
v_mul_f32 v197, v10, v197
v_mul_f32 v198, v10, v198
v_mul_f32 v199, v10, v199
v_mul_f32 v200, v10, v200
v_mul_f32 v201, v10, v201
v_mul_f32 v202, v10, v202
buffer_load_dwordx4 v4, s[24:27], s64 offen offset:3072 sc1 lds
v_mul_f32 v203, v10, v203
v_mul_f32 v204, v10, v204
v_mul_f32 v205, v10, v205
v_mul_f32 v206, v10, v206
v_mul_f32 v207, v10, v207
v_mul_f32 v208, v10, v208
v_mul_f32 v209, v10, v209
v_cvt_pk_bf16_f32 v192, v192, v193
v_cvt_pk_bf16_f32 v193, v194, v195
v_cvt_pk_bf16_f32 v194, v196, v197
v_cvt_pk_bf16_f32 v195, v198, v199
v_cvt_pk_bf16_f32 v196, v200, v201
v_cvt_pk_bf16_f32 v197, v202, v203
v_cvt_pk_bf16_f32 v198, v204, v205
v_cvt_pk_bf16_f32 v199, v206, v207
v_cvt_pk_bf16_f32 v200, v208, v209
s_add_u32 s53, s53, 65536
s_bfe_u32 s54, s4, 131073
s_lshl_b32 s54, s54, 11
s_add_u32 s54, s54, s53
s_and_b32 s55, s4, 1
s_lshl_b32 s55, s55, 9
s_add_u32 s54, s54, s55
s_lshl2_add_u32 s52, s85, s86
s_lshl2_add_u32 s69, s52, s3
s_mul_i32 s69, s69, 28672
s_add_u32 s69, s69, 76546048
s_lshr_b32 s73, s52, 1
s_lshl_b32 s73, s73, 10
s_and_b32 s52, s52, 1
s_lshl_b32 s52, s52, 7
s_add_u32 s73, s73, s52
s_lshl2_add_u32 s73, s3, s73
s_add_u32 s73, s73, 75498112
ds_read_b128 v[144:147], v7 offset:0
ds_read_b128 v[148:151], v7 offset:1024
ds_read_b128 v[152:155], v7 offset:2048
ds_read_b128 v[156:159], v7 offset:3072
ds_read_b128 v[160:163], v7 offset:4096
ds_read_b128 v[164:167], v7 offset:5120
v_mov_b32 v10, 0
s_waitcnt vmcnt(5)
v_cmp_gt_u32 vcc, 8, v12
s_mov_b32 s92, 0
s_nop 3
s_cbranch_vccz L_ZBX
L_ZB:
s_sleep 2
buffer_load_dword v12, v13, s[24:27], s75 offen sc1
s_add_u32 s92, s92, 1
s_waitcnt vmcnt(0)
v_cmp_gt_u32 vcc, 8, v12
s_cmp_gt_u32 s92, 0x20000
s_cbranch_scc1 L_ZBX
s_nop 2
s_cbranch_vccnz L_ZB
L_ZBX:
s_xor_b32 s65, s82, 0
s_add_u32 s65, s65, s77
buffer_load_dwordx4 a[0:3], v4, s[24:27], s65 offen offset:0 sc1
s_xor_b32 s93, s82, 0
s_add_u32 s93, s93, s81
buffer_load_dwordx4 a[4:7], v4, s[24:27], s93 offen offset:0 sc1
buffer_load_dwordx4 a[8:11], v4, s[24:27], s65 offen offset:2048 sc1
buffer_load_dwordx4 a[12:15], v4, s[24:27], s93 offen offset:2048 sc1
buffer_load_dwordx4 a[16:19], v14, s[24:27], s65 offen offset:0 sc1
buffer_load_dwordx4 a[20:23], v14, s[24:27], s93 offen offset:0 sc1
buffer_load_dwordx4 a[24:27], v14, s[24:27], s65 offen offset:2048 sc1
buffer_load_dwordx4 a[28:31], v14, s[24:27], s93 offen offset:2048 sc1
buffer_store_dwordx4 v[192:195], v9, s[24:27], s54 offen sc1
buffer_store_dwordx4 v[196:199], v9, s[24:27], s54 offen offset:256 sc1
s_bfe_u32 s55, s4, 65538
s_lshl_b32 s55, s55, 8
s_add_u32 s54, s53, s55
s_and_b32 s55, s4, 3
s_lshl2_add_u32 s54, s55, s54
s_add_u32 s54, s54, 8192
buffer_store_dword v200, v9, s[24:27], s54 offen sc1
s_waitcnt vmcnt(9) lgkmcnt(4)
v_mfma_f32_16x16x32_bf16 v[120:123], v[144:147], a[0:3], 0
s_add_u32 s91, s91, 16384
ds_read_b128 v[168:171], v7 offset:6144
v_mfma_f32_16x16x32_bf16 v[124:127], v[144:147], a[4:7], 0
s_xor_b32 s65, s82, 8192
s_add_u32 s65, s65, s77
ds_read_b128 v[172:175], v7 offset:7168
v_mfma_f32_16x16x32_bf16 v[72:75], v[148:151], a[0:3], 0
s_waitcnt lgkmcnt(4)
ds_read_b128 v[144:147], v7 offset:8192
v_mfma_f32_16x16x32_bf16 v[76:79], v[148:151], a[4:7], 0
buffer_load_dwordx4 a[32:35], v4, s[24:27], s65 offen offset:0 sc1
v_mfma_f32_16x16x32_bf16 v[80:83], v[152:155], a[0:3], 0
s_xor_b32 s93, s82, 8192
s_add_u32 s93, s93, s81
ds_read_b128 v[148:151], v7 offset:9216
v_mfma_f32_16x16x32_bf16 v[84:87], v[152:155], a[4:7], 0
s_cmp_ge_u32 s91, 163840
s_cselect_b32 s91, 0, s91
v_add_u32 v8, s91, v4
v_mfma_f32_16x16x32_bf16 v[88:91], v[156:159], a[0:3], 0
buffer_load_dwordx4 a[36:39], v4, s[24:27], s93 offen offset:0 sc1
v_mfma_f32_16x16x32_bf16 v[92:95], v[156:159], a[4:7], 0
s_waitcnt lgkmcnt(4)
ds_read_b128 v[152:155], v7 offset:10240
v_mfma_f32_16x16x32_bf16 v[96:99], v[160:163], a[0:3], 0
ds_read_b128 v[156:159], v7 offset:11264
v_mfma_f32_16x16x32_bf16 v[100:103], v[160:163], a[4:7], 0
v_mfma_f32_16x16x32_bf16 v[104:107], v[164:167], a[0:3], 0
buffer_load_dwordx4 a[40:43], v4, s[24:27], s65 offen offset:2048 sc1
v_mfma_f32_16x16x32_bf16 v[108:111], v[164:167], a[4:7], 0
s_waitcnt lgkmcnt(4)
ds_read_b128 v[160:163], v7 offset:12288
v_mfma_f32_16x16x32_bf16 v[112:115], v[168:171], a[0:3], 0
s_waitcnt vmcnt(10)
ds_read_b128 v[164:167], v7 offset:13312
v_mfma_f32_16x16x32_bf16 v[116:119], v[168:171], a[4:7], 0
buffer_load_dwordx4 a[44:47], v4, s[24:27], s93 offen offset:2048 sc1
v_mfma_f32_16x16x32_bf16 v[120:123], v[172:175], a[8:11], v[120:123]
ds_read_b128 v[168:171], v7 offset:14336
v_mfma_f32_16x16x32_bf16 v[124:127], v[172:175], a[12:15], v[124:127]
s_waitcnt lgkmcnt(5)
v_mfma_f32_16x16x32_bf16 v[72:75], v[144:147], a[8:11], v[72:75]
ds_read_b128 v[172:175], v7 offset:15360
v_mfma_f32_16x16x32_bf16 v[76:79], v[144:147], a[12:15], v[76:79]
s_add_u32 s91, s91, 16384
s_cmp_ge_u32 s91, 163840
s_cselect_b32 s91, 0, s91
v_mfma_f32_16x16x32_bf16 v[80:83], v[148:151], a[8:11], v[80:83]
ds_read_b128 v[144:147], v8 offset:0
v_add_u32 v7, s91, v4
v_mfma_f32_16x16x32_bf16 v[84:87], v[148:151], a[12:15], v[84:87]
s_waitcnt lgkmcnt(5)
v_mfma_f32_16x16x32_bf16 v[88:91], v[152:155], a[8:11], v[88:91]
ds_read_b128 v[148:151], v8 offset:1024
v_mfma_f32_16x16x32_bf16 v[92:95], v[152:155], a[12:15], v[92:95]
v_mfma_f32_16x16x32_bf16 v[96:99], v[156:159], a[8:11], v[96:99]
buffer_load_dwordx4 a[48:51], v14, s[24:27], s65 offen offset:0 sc1
v_mfma_f32_16x16x32_bf16 v[100:103], v[156:159], a[12:15], v[100:103]
s_waitcnt lgkmcnt(4)
ds_read_b128 v[152:155], v8 offset:2048
v_mfma_f32_16x16x32_bf16 v[104:107], v[160:163], a[8:11], v[104:107]
ds_read_b128 v[156:159], v8 offset:3072
v_mfma_f32_16x16x32_bf16 v[108:111], v[160:163], a[12:15], v[108:111]
buffer_load_dwordx4 a[52:55], v14, s[24:27], s93 offen offset:0 sc1
v_mfma_f32_16x16x32_bf16 v[112:115], v[164:167], a[8:11], v[112:115]
ds_read_b128 v[160:163], v8 offset:4096
v_mfma_f32_16x16x32_bf16 v[116:119], v[164:167], a[12:15], v[116:119]
s_waitcnt lgkmcnt(5) vmcnt(11)
v_mfma_f32_16x16x32_bf16 v[120:123], v[168:171], a[16:19], v[120:123]
ds_read_b128 v[164:167], v8 offset:5120
v_mfma_f32_16x16x32_bf16 v[124:127], v[168:171], a[20:23], v[124:127]
v_mfma_f32_16x16x32_bf16 v[72:75], v[172:175], a[16:19], v[72:75]
ds_read_b128 v[168:171], v8 offset:6144
v_mfma_f32_16x16x32_bf16 v[76:79], v[172:175], a[20:23], v[76:79]
s_waitcnt lgkmcnt(5)
v_mfma_f32_16x16x32_bf16 v[80:83], v[144:147], a[16:19], v[80:83]
buffer_load_dwordx4 a[56:59], v14, s[24:27], s65 offen offset:2048 sc1
v_mfma_f32_16x16x32_bf16 v[84:87], v[144:147], a[20:23], v[84:87]
ds_read_b128 v[172:175], v8 offset:7168
v_mfma_f32_16x16x32_bf16 v[88:91], v[148:151], a[16:19], v[88:91]
ds_read_b128 v[144:147], v8 offset:8192
v_mfma_f32_16x16x32_bf16 v[92:95], v[148:151], a[20:23], v[92:95]
s_waitcnt lgkmcnt(5)
v_mfma_f32_16x16x32_bf16 v[96:99], v[152:155], a[16:19], v[96:99]
ds_read_b128 v[148:151], v8 offset:9216
v_mfma_f32_16x16x32_bf16 v[100:103], v[152:155], a[20:23], v[100:103]
buffer_load_dwordx4 a[60:63], v14, s[24:27], s93 offen offset:2048 sc1
v_mfma_f32_16x16x32_bf16 v[104:107], v[156:159], a[16:19], v[104:107]
ds_read_b128 v[152:155], v8 offset:10240
v_mfma_f32_16x16x32_bf16 v[108:111], v[156:159], a[20:23], v[108:111]
s_waitcnt lgkmcnt(5)
v_mfma_f32_16x16x32_bf16 v[112:115], v[160:163], a[16:19], v[112:115]
s_xor_b32 s65, s82, 16384
s_add_u32 s65, s65, s77
ds_read_b128 v[156:159], v8 offset:11264
v_mfma_f32_16x16x32_bf16 v[116:119], v[160:163], a[20:23], v[116:119]
s_waitcnt vmcnt(11)
v_mfma_f32_16x16x32_bf16 v[120:123], v[164:167], a[24:27], v[120:123]
buffer_load_dwordx4 a[64:67], v4, s[24:27], s65 offen offset:0 sc1
v_mfma_f32_16x16x32_bf16 v[124:127], v[164:167], a[28:31], v[124:127]
s_waitcnt lgkmcnt(4)
ds_read_b128 v[160:163], v8 offset:12288
v_mfma_f32_16x16x32_bf16 v[72:75], v[168:171], a[24:27], v[72:75]
ds_read_b128 v[164:167], v8 offset:13312
v_mfma_f32_16x16x32_bf16 v[76:79], v[168:171], a[28:31], v[76:79]
s_xor_b32 s93, s82, 16384
s_add_u32 s93, s93, s81
v_mfma_f32_16x16x32_bf16 v[80:83], v[172:175], a[24:27], v[80:83]
s_waitcnt lgkmcnt(4)
ds_read_b128 v[168:171], v8 offset:14336
v_mfma_f32_16x16x32_bf16 v[84:87], v[172:175], a[28:31], v[84:87]
buffer_load_dwordx4 a[68:71], v4, s[24:27], s93 offen offset:0 sc1
v_mfma_f32_16x16x32_bf16 v[88:91], v[144:147], a[24:27], v[88:91]
ds_read_b128 v[172:175], v8 offset:15360
v_mfma_f32_16x16x32_bf16 v[92:95], v[144:147], a[28:31], v[92:95]
s_barrier
v_mfma_f32_16x16x32_bf16 v[96:99], v[148:151], a[24:27], v[96:99]
s_add_u32 s91, s91, 16384
ds_read_b128 v[144:147], v7 offset:0
v_mfma_f32_16x16x32_bf16 v[100:103], v[148:151], a[28:31], v[100:103]
s_waitcnt lgkmcnt(5)
s_cmp_ge_u32 s91, 163840
s_cselect_b32 s91, 0, s91
v_mfma_f32_16x16x32_bf16 v[104:107], v[152:155], a[24:27], v[104:107]
buffer_load_dwordx4 a[72:75], v4, s[24:27], s65 offen offset:2048 sc1
v_mfma_f32_16x16x32_bf16 v[108:111], v[152:155], a[28:31], v[108:111]
ds_read_b128 v[148:151], v7 offset:1024
v_add_u32 v8, s91, v4
v_mfma_f32_16x16x32_bf16 v[112:115], v[156:159], a[24:27], v[112:115]
ds_read_b128 v[152:155], v7 offset:2048
v_mfma_f32_16x16x32_bf16 v[116:119], v[156:159], a[28:31], v[116:119]
s_waitcnt lgkmcnt(5) vmcnt(9)
v_mfma_f32_16x16x32_bf16 v[120:123], v[160:163], a[32:35], v[120:123]
s_waitcnt vmcnt(11)
ds_read_b128 v[156:159], v7 offset:3072
v_mfma_f32_16x16x32_bf16 v[124:127], v[160:163], a[36:39], v[124:127]
buffer_atomic_add v1, v0, s[24:27], s74 offen offset:4 sc1
v_mfma_f32_16x16x32_bf16 v[72:75], v[164:167], a[32:35], v[72:75]
buffer_load_dwordx4 a[76:79], v4, s[24:27], s93 offen offset:2048 sc1
v_mfma_f32_16x16x32_bf16 v[76:79], v[164:167], a[36:39], v[76:79]
s_waitcnt lgkmcnt(4)
ds_read_b128 v[160:163], v7 offset:4096
v_mfma_f32_16x16x32_bf16 v[80:83], v[168:171], a[32:35], v[80:83]
ds_read_b128 v[164:167], v7 offset:5120
v_mfma_f32_16x16x32_bf16 v[84:87], v[168:171], a[36:39], v[84:87]
v_mfma_f32_16x16x32_bf16 v[88:91], v[172:175], a[32:35], v[88:91]
s_waitcnt lgkmcnt(4)
ds_read_b128 v[168:171], v7 offset:6144
v_mfma_f32_16x16x32_bf16 v[92:95], v[172:175], a[36:39], v[92:95]
buffer_load_dwordx4 a[80:83], v14, s[24:27], s65 offen offset:0 sc1
v_mfma_f32_16x16x32_bf16 v[96:99], v[144:147], a[32:35], v[96:99]
ds_read_b128 v[172:175], v7 offset:7168
v_mfma_f32_16x16x32_bf16 v[100:103], v[144:147], a[36:39], v[100:103]
v_mfma_f32_16x16x32_bf16 v[104:107], v[148:151], a[32:35], v[104:107]
ds_read_b128 v[144:147], v7 offset:8192
v_mfma_f32_16x16x32_bf16 v[108:111], v[148:151], a[36:39], v[108:111]
s_waitcnt lgkmcnt(5)
v_mfma_f32_16x16x32_bf16 v[112:115], v[152:155], a[32:35], v[112:115]
buffer_load_dwordx4 a[84:87], v14, s[24:27], s93 offen offset:0 sc1
v_mfma_f32_16x16x32_bf16 v[116:119], v[152:155], a[36:39], v[116:119]
s_waitcnt vmcnt(11)
ds_read_b128 v[148:151], v7 offset:9216
v_mfma_f32_16x16x32_bf16 v[120:123], v[156:159], a[40:43], v[120:123]
ds_read_b128 v[152:155], v7 offset:10240
v_mfma_f32_16x16x32_bf16 v[124:127], v[156:159], a[44:47], v[124:127]
s_waitcnt lgkmcnt(5)
v_mfma_f32_16x16x32_bf16 v[72:75], v[160:163], a[40:43], v[72:75]
ds_read_b128 v[156:159], v7 offset:11264
v_mfma_f32_16x16x32_bf16 v[76:79], v[160:163], a[44:47], v[76:79]
buffer_load_dwordx4 a[88:91], v14, s[24:27], s65 offen offset:2048 sc1
v_mfma_f32_16x16x32_bf16 v[80:83], v[164:167], a[40:43], v[80:83]
ds_read_b128 v[160:163], v7 offset:12288
v_mfma_f32_16x16x32_bf16 v[84:87], v[164:167], a[44:47], v[84:87]
s_waitcnt lgkmcnt(5)
v_mfma_f32_16x16x32_bf16 v[88:91], v[168:171], a[40:43], v[88:91]
ds_read_b128 v[164:167], v7 offset:13312
v_mfma_f32_16x16x32_bf16 v[92:95], v[168:171], a[44:47], v[92:95]
v_mfma_f32_16x16x32_bf16 v[96:99], v[172:175], a[40:43], v[96:99]
buffer_load_dwordx4 a[92:95], v14, s[24:27], s93 offen offset:2048 sc1
v_mfma_f32_16x16x32_bf16 v[100:103], v[172:175], a[44:47], v[100:103]
s_waitcnt lgkmcnt(4)
ds_read_b128 v[168:171], v7 offset:14336
v_mfma_f32_16x16x32_bf16 v[104:107], v[144:147], a[40:43], v[104:107]
ds_read_b128 v[172:175], v7 offset:15360
v_mfma_f32_16x16x32_bf16 v[108:111], v[144:147], a[44:47], v[108:111]
s_xor_b32 s65, s82, 24576
s_add_u32 s65, s65, s77
s_add_u32 s91, s91, 16384
v_mfma_f32_16x16x32_bf16 v[112:115], v[148:151], a[40:43], v[112:115]
s_waitcnt lgkmcnt(4) vmcnt(11)
ds_read_b128 v[144:147], v8 offset:0
v_mfma_f32_16x16x32_bf16 v[116:119], v[148:151], a[44:47], v[116:119]
buffer_load_dwordx4 a[96:99], v4, s[24:27], s65 offen offset:0 sc1
v_mfma_f32_16x16x32_bf16 v[120:123], v[152:155], a[48:51], v[120:123]
s_cmp_ge_u32 s91, 163840
s_cselect_b32 s91, 0, s91
ds_read_b128 v[148:151], v8 offset:1024
v_mfma_f32_16x16x32_bf16 v[124:127], v[152:155], a[52:55], v[124:127]
v_add_u32 v7, s91, v4
v_mfma_f32_16x16x32_bf16 v[72:75], v[156:159], a[48:51], v[72:75]
s_xor_b32 s93, s82, 24576
s_add_u32 s93, s93, s81
ds_read_b128 v[152:155], v8 offset:2048
v_mfma_f32_16x16x32_bf16 v[76:79], v[156:159], a[52:55], v[76:79]
s_waitcnt lgkmcnt(5)
v_mfma_f32_16x16x32_bf16 v[80:83], v[160:163], a[48:51], v[80:83]
buffer_load_dwordx4 a[100:103], v4, s[24:27], s93 offen offset:0 sc1
v_mfma_f32_16x16x32_bf16 v[84:87], v[160:163], a[52:55], v[84:87]
ds_read_b128 v[156:159], v8 offset:3072
v_mfma_f32_16x16x32_bf16 v[88:91], v[164:167], a[48:51], v[88:91]
ds_read_b128 v[160:163], v8 offset:4096
v_mfma_f32_16x16x32_bf16 v[92:95], v[164:167], a[52:55], v[92:95]
s_waitcnt lgkmcnt(5)
v_mfma_f32_16x16x32_bf16 v[96:99], v[168:171], a[48:51], v[96:99]
ds_read_b128 v[164:167], v8 offset:5120
v_mfma_f32_16x16x32_bf16 v[100:103], v[168:171], a[52:55], v[100:103]
buffer_load_dwordx4 a[104:107], v4, s[24:27], s65 offen offset:2048 sc1
v_mfma_f32_16x16x32_bf16 v[104:107], v[172:175], a[48:51], v[104:107]
ds_read_b128 v[168:171], v8 offset:6144
v_mfma_f32_16x16x32_bf16 v[108:111], v[172:175], a[52:55], v[108:111]
s_waitcnt lgkmcnt(5)
v_mfma_f32_16x16x32_bf16 v[112:115], v[144:147], a[48:51], v[112:115]
ds_read_b128 v[172:175], v8 offset:7168
v_mfma_f32_16x16x32_bf16 v[116:119], v[144:147], a[52:55], v[116:119]
s_waitcnt vmcnt(12)
v_mfma_f32_16x16x32_bf16 v[120:123], v[148:151], a[56:59], v[120:123]
buffer_load_dwordx4 a[108:111], v4, s[24:27], s93 offen offset:2048 sc1
v_mfma_f32_16x16x32_bf16 v[124:127], v[148:151], a[60:63], v[124:127]
s_waitcnt lgkmcnt(4)
ds_read_b128 v[144:147], v8 offset:8192
v_mfma_f32_16x16x32_bf16 v[72:75], v[152:155], a[56:59], v[72:75]
s_add_u32 s52, s84, 1
ds_read_b128 v[148:151], v8 offset:9216
v_mfma_f32_16x16x32_bf16 v[76:79], v[152:155], a[60:63], v[76:79]
v_mfma_f32_16x16x32_bf16 v[80:83], v[156:159], a[56:59], v[80:83]
ds_read_b128 v[152:155], v8 offset:10240
v_mfma_f32_16x16x32_bf16 v[84:87], v[156:159], a[60:63], v[84:87]
s_and_b32 s52, s52, 3
s_waitcnt lgkmcnt(5)
v_mfma_f32_16x16x32_bf16 v[88:91], v[160:163], a[56:59], v[88:91]
buffer_load_dwordx4 a[112:115], v14, s[24:27], s65 offen offset:0 sc1
v_mfma_f32_16x16x32_bf16 v[92:95], v[160:163], a[60:63], v[92:95]
ds_read_b128 v[156:159], v8 offset:11264
v_mfma_f32_16x16x32_bf16 v[96:99], v[164:167], a[56:59], v[96:99]
s_mul_i32 s52, s52, 6144
ds_read_b128 v[160:163], v8 offset:12288
v_mfma_f32_16x16x32_bf16 v[100:103], v[164:167], a[60:63], v[100:103]
s_waitcnt lgkmcnt(5)
v_mfma_f32_16x16x32_bf16 v[104:107], v[168:171], a[56:59], v[104:107]
buffer_load_dwordx4 a[116:119], v14, s[24:27], s93 offen offset:0 sc1
v_mfma_f32_16x16x32_bf16 v[108:111], v[168:171], a[60:63], v[108:111]
s_add_u32 s52, s52, s69
ds_read_b128 v[164:167], v8 offset:13312
v_mfma_f32_16x16x32_bf16 v[112:115], v[172:175], a[56:59], v[112:115]
ds_read_b128 v[168:171], v8 offset:14336
v_mfma_f32_16x16x32_bf16 v[116:119], v[172:175], a[60:63], v[116:119]
s_waitcnt lgkmcnt(5) vmcnt(13)
v_mfma_f32_16x16x32_bf16 v[120:123], v[144:147], a[64:67], v[120:123]
s_waitcnt vmcnt(52)
s_add_u32 s52, s52, 0
ds_read_b128 v[172:175], v8 offset:15360
v_mfma_f32_16x16x32_bf16 v[124:127], v[144:147], a[68:71], v[124:127]
s_barrier
v_mfma_f32_16x16x32_bf16 v[72:75], v[148:151], a[64:67], v[72:75]
buffer_load_dwordx4 a[120:123], v14, s[24:27], s65 offen offset:2048 sc1
v_mfma_f32_16x16x32_bf16 v[76:79], v[148:151], a[68:71], v[76:79]
s_add_u32 s53, s84, 2
s_waitcnt lgkmcnt(4)
ds_read_b128 v[144:147], v7 offset:0
v_mfma_f32_16x16x32_bf16 v[80:83], v[152:155], a[64:67], v[80:83]
s_add_u32 s91, s91, 16384
ds_read_b128 v[148:151], v7 offset:1024
v_mfma_f32_16x16x32_bf16 v[84:87], v[152:155], a[68:71], v[84:87]
s_cmp_ge_u32 s91, 163840
s_cselect_b32 s91, 0, s91
v_add_u32 v8, s91, v4
v_mfma_f32_16x16x32_bf16 v[88:91], v[156:159], a[64:67], v[88:91]
s_and_b32 s53, s53, 3
s_waitcnt lgkmcnt(4)
ds_read_b128 v[152:155], v7 offset:2048
v_mfma_f32_16x16x32_bf16 v[92:95], v[156:159], a[68:71], v[92:95]
buffer_load_dwordx4 a[124:127], v14, s[24:27], s93 offen offset:2048 sc1
v_mfma_f32_16x16x32_bf16 v[96:99], v[160:163], a[64:67], v[96:99]
ds_read_b128 v[156:159], v7 offset:3072
v_mfma_f32_16x16x32_bf16 v[100:103], v[160:163], a[68:71], v[100:103]
s_mul_i32 s53, s53, 6144
v_mfma_f32_16x16x32_bf16 v[104:107], v[164:167], a[64:67], v[104:107]
s_xor_b32 s65, s82, 32768
s_add_u32 s65, s65, s77
ds_read_b128 v[160:163], v7 offset:4096
v_mfma_f32_16x16x32_bf16 v[108:111], v[164:167], a[68:71], v[108:111]
s_waitcnt lgkmcnt(5)
v_mfma_f32_16x16x32_bf16 v[112:115], v[168:171], a[64:67], v[112:115]
s_add_u32 s53, s53, s69
s_waitcnt vmcnt(12)
ds_read_b128 v[164:167], v7 offset:5120
v_mfma_f32_16x16x32_bf16 v[116:119], v[168:171], a[68:71], v[116:119]
buffer_load_dwordx4 a[128:131], v4, s[24:27], s65 offen offset:0 sc1
v_mfma_f32_16x16x32_bf16 v[120:123], v[172:175], a[72:75], v[120:123]
s_waitcnt lgkmcnt(4)
ds_read_b128 v[168:171], v7 offset:6144
v_mfma_f32_16x16x32_bf16 v[124:127], v[172:175], a[76:79], v[124:127]
s_add_u32 s53, s53, 2048
s_xor_b32 s93, s82, 32768
s_add_u32 s93, s93, s81
v_mfma_f32_16x16x32_bf16 v[72:75], v[144:147], a[72:75], v[72:75]
ds_read_b128 v[172:175], v7 offset:7168
v_mfma_f32_16x16x32_bf16 v[76:79], v[144:147], a[76:79], v[76:79]
buffer_load_dwordx4 a[132:135], v4, s[24:27], s93 offen offset:0 sc1
v_mfma_f32_16x16x32_bf16 v[80:83], v[148:151], a[72:75], v[80:83]
s_add_u32 s54, s84, 3
ds_read_b128 v[144:147], v7 offset:8192
v_mfma_f32_16x16x32_bf16 v[84:87], v[148:151], a[76:79], v[84:87]
s_waitcnt lgkmcnt(5)
v_mfma_f32_16x16x32_bf16 v[88:91], v[152:155], a[72:75], v[88:91]
ds_read_b128 v[148:151], v7 offset:9216
v_mfma_f32_16x16x32_bf16 v[92:95], v[152:155], a[76:79], v[92:95]
s_and_b32 s54, s54, 3
v_mfma_f32_16x16x32_bf16 v[96:99], v[156:159], a[72:75], v[96:99]
buffer_load_dwordx4 a[136:139], v4, s[24:27], s65 offen offset:2048 sc1
v_mfma_f32_16x16x32_bf16 v[100:103], v[156:159], a[76:79], v[100:103]
s_waitcnt lgkmcnt(4)
ds_read_b128 v[152:155], v7 offset:10240
v_mfma_f32_16x16x32_bf16 v[104:107], v[160:163], a[72:75], v[104:107]
s_mul_i32 s54, s54, 6144
ds_read_b128 v[156:159], v7 offset:11264
v_mfma_f32_16x16x32_bf16 v[108:111], v[160:163], a[76:79], v[108:111]
v_mfma_f32_16x16x32_bf16 v[112:115], v[164:167], a[72:75], v[112:115]
ds_read_b128 v[160:163], v7 offset:12288
v_mfma_f32_16x16x32_bf16 v[116:119], v[164:167], a[76:79], v[116:119]
s_add_u32 s54, s54, s69
s_waitcnt lgkmcnt(5) vmcnt(13)
v_mfma_f32_16x16x32_bf16 v[120:123], v[168:171], a[80:83], v[120:123]
buffer_load_dwordx4 a[140:143], v4, s[24:27], s93 offen offset:2048 sc1
v_mfma_f32_16x16x32_bf16 v[124:127], v[168:171], a[84:87], v[124:127]
ds_read_b128 v[164:167], v7 offset:13312
v_mfma_f32_16x16x32_bf16 v[72:75], v[172:175], a[80:83], v[72:75]
s_add_u32 s54, s54, 4096
ds_read_b128 v[168:171], v7 offset:14336
v_mfma_f32_16x16x32_bf16 v[76:79], v[172:175], a[84:87], v[76:79]
s_waitcnt lgkmcnt(5)
v_mfma_f32_16x16x32_bf16 v[80:83], v[144:147], a[80:83], v[80:83]
buffer_load_dwordx4 a[144:147], v14, s[24:27], s65 offen offset:0 sc1
v_mfma_f32_16x16x32_bf16 v[84:87], v[144:147], a[84:87], v[84:87]
s_sub_u32 s55, s3, s84
ds_read_b128 v[172:175], v7 offset:15360
v_mfma_f32_16x16x32_bf16 v[88:91], v[148:151], a[80:83], v[88:91]
s_add_u32 s91, s91, 16384
ds_read_b128 v[144:147], v8 offset:0
v_mfma_f32_16x16x32_bf16 v[92:95], v[148:151], a[84:87], v[92:95]
s_waitcnt lgkmcnt(5)
s_cmp_ge_u32 s91, 163840
s_cselect_b32 s91, 0, s91
v_mfma_f32_16x16x32_bf16 v[96:99], v[152:155], a[80:83], v[96:99]
s_and_b32 s55, s55, 3
ds_read_b128 v[148:151], v8 offset:1024
v_add_u32 v7, s91, v4
v_mfma_f32_16x16x32_bf16 v[100:103], v[152:155], a[84:87], v[100:103]
buffer_load_dwordx4 a[148:151], v14, s[24:27], s93 offen offset:0 sc1
v_mfma_f32_16x16x32_bf16 v[104:107], v[156:159], a[80:83], v[104:107]
ds_read_b128 v[152:155], v8 offset:2048
v_mfma_f32_16x16x32_bf16 v[108:111], v[156:159], a[84:87], v[108:111]
s_lshl_b32 s55, s55, 10
s_waitcnt lgkmcnt(5)
v_mfma_f32_16x16x32_bf16 v[112:115], v[160:163], a[80:83], v[112:115]
ds_read_b128 v[156:159], v8 offset:3072
v_mfma_f32_16x16x32_bf16 v[116:119], v[160:163], a[84:87], v[116:119]
s_waitcnt vmcnt(14)
v_mfma_f32_16x16x32_bf16 v[120:123], v[164:167], a[88:91], v[120:123]
s_add_u32 s55, s55, s69
s_waitcnt lgkmcnt(4)
ds_read_b128 v[160:163], v8 offset:4096
v_mfma_f32_16x16x32_bf16 v[124:127], v[164:167], a[92:95], v[124:127]
buffer_load_dwordx4 a[152:155], v14, s[24:27], s65 offen offset:2048 sc1
v_mfma_f32_16x16x32_bf16 v[72:75], v[168:171], a[88:91], v[72:75]
ds_read_b128 v[164:167], v8 offset:5120
v_mfma_f32_16x16x32_bf16 v[76:79], v[168:171], a[92:95], v[76:79]
s_add_u32 s55, s55, 23552
v_mfma_f32_16x16x32_bf16 v[80:83], v[172:175], a[88:91], v[80:83]
s_waitcnt lgkmcnt(4)
ds_read_b128 v[168:171], v8 offset:6144
v_mfma_f32_16x16x32_bf16 v[84:87], v[172:175], a[92:95], v[84:87]
buffer_load_dwordx4 a[156:159], v14, s[24:27], s93 offen offset:2048 sc1
v_mfma_f32_16x16x32_bf16 v[88:91], v[144:147], a[88:91], v[88:91]
s_add_u32 s71, s69, 24576
ds_read_b128 v[172:175], v8 offset:7168
v_mfma_f32_16x16x32_bf16 v[92:95], v[144:147], a[92:95], v[92:95]
s_waitcnt lgkmcnt(4)
v_mfma_f32_16x16x32_bf16 v[96:99], v[148:151], a[88:91], v[96:99]
s_xor_b32 s65, s82, 40960
s_add_u32 s65, s65, s77
ds_read_b128 v[144:147], v8 offset:8192
v_mfma_f32_16x16x32_bf16 v[100:103], v[148:151], a[92:95], v[100:103]
s_cmp_eq_u32 s3, s84
s_cselect_b32 s55, 2147418112, s55
s_cselect_b32 s71, s71, 2147418112
v_mfma_f32_16x16x32_bf16 v[104:107], v[152:155], a[88:91], v[104:107]
buffer_load_dwordx4 a[160:163], v4, s[24:27], s65 offen offset:0 sc1
v_mfma_f32_16x16x32_bf16 v[108:111], v[152:155], a[92:95], v[108:111]
ds_read_b128 v[148:151], v8 offset:9216
v_mfma_f32_16x16x32_bf16 v[112:115], v[156:159], a[88:91], v[112:115]
s_mul_i32 s83, s84, 6144
ds_read_b128 v[152:155], v8 offset:10240
v_mfma_f32_16x16x32_bf16 v[116:119], v[156:159], a[92:95], v[116:119]
s_waitcnt lgkmcnt(5) vmcnt(15)
v_mfma_f32_16x16x32_bf16 v[120:123], v[160:163], a[96:99], v[120:123]
s_xor_b32 s93, s82, 40960
s_add_u32 s93, s93, s81
ds_read_b128 v[156:159], v8 offset:11264
v_mfma_f32_16x16x32_bf16 v[124:127], v[160:163], a[100:103], v[124:127]
s_add_u32 s69, s69, s83
v_mfma_f32_16x16x32_bf16 v[72:75], v[164:167], a[96:99], v[72:75]
buffer_load_dwordx4 a[164:167], v4, s[24:27], s93 offen offset:0 sc1
v_mfma_f32_16x16x32_bf16 v[76:79], v[164:167], a[100:103], v[76:79]
s_waitcnt lgkmcnt(4)
ds_read_b128 v[160:163], v8 offset:12288
v_mfma_f32_16x16x32_bf16 v[80:83], v[168:171], a[96:99], v[80:83]
s_add_u32 s83, s69, 4096
ds_read_b128 v[164:167], v8 offset:13312
v_mfma_f32_16x16x32_bf16 v[84:87], v[168:171], a[100:103], v[84:87]
v_mfma_f32_16x16x32_bf16 v[88:91], v[172:175], a[96:99], v[88:91]
s_waitcnt lgkmcnt(4)
ds_read_b128 v[168:171], v8 offset:14336
v_mfma_f32_16x16x32_bf16 v[92:95], v[172:175], a[100:103], v[92:95]
buffer_load_dwordx4 a[168:171], v4, s[24:27], s65 offen offset:2048 sc1
v_mfma_f32_16x16x32_bf16 v[96:99], v[144:147], a[96:99], v[96:99]
s_waitcnt vmcnt(56)
ds_read_b128 v[172:175], v8 offset:15360
v_mfma_f32_16x16x32_bf16 v[100:103], v[144:147], a[100:103], v[100:103]
s_barrier
v_mfma_f32_16x16x32_bf16 v[104:107], v[148:151], a[96:99], v[104:107]
s_add_u32 s91, s91, 16384
ds_read_b128 v[144:147], v7 offset:0
v_mfma_f32_16x16x32_bf16 v[108:111], v[148:151], a[100:103], v[108:111]
s_waitcnt lgkmcnt(5)
s_cmp_ge_u32 s91, 163840
s_cselect_b32 s91, 0, s91
v_mfma_f32_16x16x32_bf16 v[112:115], v[152:155], a[96:99], v[112:115]
buffer_load_dwordx4 a[172:175], v4, s[24:27], s93 offen offset:2048 sc1
v_mfma_f32_16x16x32_bf16 v[116:119], v[152:155], a[100:103], v[116:119]
s_waitcnt vmcnt(16)
ds_read_b128 v[148:151], v7 offset:1024
v_add_u32 v8, s91, v4
v_mfma_f32_16x16x32_bf16 v[120:123], v[156:159], a[104:107], v[120:123]
s_waitcnt lgkmcnt(4)
ds_read_b128 v[152:155], v7 offset:2048
v_mfma_f32_16x16x32_bf16 v[124:127], v[156:159], a[108:111], v[124:127]
s_mov_b32 m0, s70
s_mov_b32 s64, s68
s_add_u32 s68, s68, 16384
v_mfma_f32_16x16x32_bf16 v[72:75], v[160:163], a[104:107], v[72:75]
ds_read_b128 v[156:159], v7 offset:3072
v_mfma_f32_16x16x32_bf16 v[76:79], v[160:163], a[108:111], v[76:79]
s_add_u32 s70, s70, 16384
s_cmp_ge_u32 s70, 163840
s_cselect_b32 s70, s80, s70
v_mfma_f32_16x16x32_bf16 v[80:83], v[164:167], a[104:107], v[80:83]
buffer_load_dwordx4 v4, s[24:27], s64 offen offset:0 sc1 lds
v_mfma_f32_16x16x32_bf16 v[84:87], v[164:167], a[108:111], v[84:87]
s_waitcnt lgkmcnt(4)
ds_read_b128 v[160:163], v7 offset:4096
v_mfma_f32_16x16x32_bf16 v[88:91], v[168:171], a[104:107], v[88:91]
ds_read_b128 v[164:167], v7 offset:5120
v_mfma_f32_16x16x32_bf16 v[92:95], v[168:171], a[108:111], v[92:95]
v_mfma_f32_16x16x32_bf16 v[96:99], v[172:175], a[104:107], v[96:99]
buffer_load_dwordx4 v4, s[24:27], s64 offen offset:1024 sc1 lds
v_mfma_f32_16x16x32_bf16 v[100:103], v[172:175], a[108:111], v[100:103]
s_waitcnt lgkmcnt(4)
ds_read_b128 v[168:171], v7 offset:6144
v_mfma_f32_16x16x32_bf16 v[104:107], v[144:147], a[104:107], v[104:107]
ds_read_b128 v[172:175], v7 offset:7168
v_mfma_f32_16x16x32_bf16 v[108:111], v[144:147], a[108:111], v[108:111]
v_mfma_f32_16x16x32_bf16 v[112:115], v[148:151], a[104:107], v[112:115]
s_waitcnt lgkmcnt(4) vmcnt(16)
ds_read_b128 v[144:147], v7 offset:8192
v_mfma_f32_16x16x32_bf16 v[116:119], v[148:151], a[108:111], v[116:119]
buffer_load_dwordx4 v4, s[24:27], s64 offen offset:2048 sc1 lds
v_mfma_f32_16x16x32_bf16 v[120:123], v[152:155], a[112:115], v[120:123]
ds_read_b128 v[148:151], v7 offset:9216
v_mfma_f32_16x16x32_bf16 v[124:127], v[152:155], a[116:119], v[124:127]
v_mfma_f32_16x16x32_bf16 v[72:75], v[156:159], a[112:115], v[72:75]
ds_read_b128 v[152:155], v7 offset:10240
v_mfma_f32_16x16x32_bf16 v[76:79], v[156:159], a[116:119], v[76:79]
s_waitcnt lgkmcnt(5)
v_mfma_f32_16x16x32_bf16 v[80:83], v[160:163], a[112:115], v[80:83]
buffer_load_dwordx4 a[176:179], v14, s[24:27], s65 offen offset:0 sc1
v_mfma_f32_16x16x32_bf16 v[84:87], v[160:163], a[116:119], v[84:87]
L_PAD11:
s_cbranch_execz L_MAIN
ds_read_b128 v[156:159], v7 offset:11264
v_mov_b32 v13, 0xffff0000
v_mfma_f32_16x16x32_bf16 v[88:91], v[164:167], a[112:115], v[88:91]
ds_read_b128 v[160:163], v7 offset:12288
v_mul_u32_u24 v5, 1152, v2
v_mfma_f32_16x16x32_bf16 v[92:95], v[164:167], a[116:119], v[92:95]
s_waitcnt lgkmcnt(5)
v_lshl_add_u32 v6, v3, 3, v5
v_and_b32 v9, 1, v3
v_mfma_f32_16x16x32_bf16 v[96:99], v[168:171], a[112:115], v[96:99]
ds_read_b128 v[164:167], v7 offset:13312
v_lshl_add_u32 v5, v9, 5, v5
v_mfma_f32_16x16x32_bf16 v[100:103], v[168:171], a[116:119], v[100:103]
buffer_load_dwordx4 a[180:183], v14, s[24:27], s93 offen offset:0 sc1
v_mfma_f32_16x16x32_bf16 v[104:107], v[172:175], a[112:115], v[104:107]
ds_read_b128 v[168:171], v7 offset:14336
v_lshrrev_b32 v9, 1, v3
v_mfma_f32_16x16x32_bf16 v[108:111], v[172:175], a[116:119], v[108:111]
s_waitcnt lgkmcnt(5)
v_lshl_add_u32 v5, v9, 4, v5
v_mfma_f32_16x16x32_bf16 v[112:115], v[144:147], a[112:115], v[112:115]
ds_read_b128 v[172:175], v7 offset:15360
v_mfma_f32_16x16x32_bf16 v[116:119], v[144:147], a[116:119], v[116:119]
s_waitcnt vmcnt(17)
s_add_u32 s91, s91, 16384
v_mfma_f32_16x16x32_bf16 v[120:123], v[148:151], a[120:123], v[120:123]
buffer_load_dwordx4 v4, s[24:27], s64 offen offset:3072 sc1 lds
v_mfma_f32_16x16x32_bf16 v[124:127], v[148:151], a[124:127], v[124:127]
s_waitcnt lgkmcnt(4)
ds_read_b128 v[144:147], v8 offset:0
v_mfma_f32_16x16x32_bf16 v[72:75], v[152:155], a[120:123], v[72:75]
s_cmp_ge_u32 s91, 163840
s_cselect_b32 s91, 0, s91
ds_read_b128 v[148:151], v8 offset:1024
v_mfma_f32_16x16x32_bf16 v[76:79], v[152:155], a[124:127], v[76:79]
s_mov_b32 m0, s70
s_mov_b32 s64, s68
s_add_u32 s68, s68, 16384
v_mfma_f32_16x16x32_bf16 v[80:83], v[156:159], a[120:123], v[80:83]
s_waitcnt lgkmcnt(4)
ds_read_b128 v[152:155], v8 offset:2048
v_add_u32 v7, s91, v4
v_mfma_f32_16x16x32_bf16 v[84:87], v[156:159], a[124:127], v[84:87]
s_add_u32 s70, s70, 16384
s_cmp_ge_u32 s70, 163840
s_cselect_b32 s70, s80, s70
v_mfma_f32_16x16x32_bf16 v[88:91], v[160:163], a[120:123], v[88:91]
buffer_load_dwordx4 v4, s[24:27], s64 offen offset:0 sc1 lds
v_mfma_f32_16x16x32_bf16 v[92:95], v[160:163], a[124:127], v[92:95]
ds_read_b128 v[156:159], v8 offset:3072
v_mfma_f32_16x16x32_bf16 v[96:99], v[164:167], a[120:123], v[96:99]
ds_read_b128 v[160:163], v8 offset:4096
v_mfma_f32_16x16x32_bf16 v[100:103], v[164:167], a[124:127], v[100:103]
s_waitcnt lgkmcnt(5)
v_mfma_f32_16x16x32_bf16 v[104:107], v[168:171], a[120:123], v[104:107]
buffer_load_dwordx4 v4, s[24:27], s64 offen offset:1024 sc1 lds
v_mfma_f32_16x16x32_bf16 v[108:111], v[168:171], a[124:127], v[108:111]
ds_read_b128 v[164:167], v8 offset:5120
v_mfma_f32_16x16x32_bf16 v[112:115], v[172:175], a[120:123], v[112:115]
ds_read_b128 v[168:171], v8 offset:6144
v_mfma_f32_16x16x32_bf16 v[116:119], v[172:175], a[124:127], v[116:119]
s_waitcnt lgkmcnt(5) vmcnt(18)
v_mfma_f32_16x16x32_bf16 v[120:123], v[144:147], a[128:131], v[120:123]
ds_read_b128 v[172:175], v8 offset:7168
v_mfma_f32_16x16x32_bf16 v[124:127], v[144:147], a[132:135], v[124:127]
v_mfma_f32_16x16x32_bf16 v[72:75], v[148:151], a[128:131], v[72:75]
buffer_load_dwordx4 a[184:187], v14, s[24:27], s65 offen offset:2048 sc1
v_mfma_f32_16x16x32_bf16 v[76:79], v[148:151], a[132:135], v[76:79]
s_waitcnt lgkmcnt(4)
ds_read_b128 v[144:147], v8 offset:8192
v_mfma_f32_16x16x32_bf16 v[80:83], v[152:155], a[128:131], v[80:83]
ds_read_b128 v[148:151], v8 offset:9216
v_mfma_f32_16x16x32_bf16 v[84:87], v[152:155], a[132:135], v[84:87]
v_mfma_f32_16x16x32_bf16 v[88:91], v[156:159], a[128:131], v[88:91]
s_waitcnt lgkmcnt(4)
ds_read_b128 v[152:155], v8 offset:10240
v_mfma_f32_16x16x32_bf16 v[92:95], v[156:159], a[132:135], v[92:95]
buffer_load_dwordx4 a[188:191], v14, s[24:27], s93 offen offset:2048 sc1
v_mfma_f32_16x16x32_bf16 v[96:99], v[160:163], a[128:131], v[96:99]
ds_read_b128 v[156:159], v8 offset:11264
v_mfma_f32_16x16x32_bf16 v[100:103], v[160:163], a[132:135], v[100:103]
s_waitcnt vmcnt(18)
v_mfma_f32_16x16x32_bf16 v[120:123], v[164:167], a[136:139], v[120:123]
ds_read_b128 v[160:163], v8 offset:12288
v_mfma_f32_16x16x32_bf16 v[124:127], v[164:167], a[140:143], v[124:127]
s_waitcnt lgkmcnt(5)
v_mfma_f32_16x16x32_bf16 v[72:75], v[168:171], a[136:139], v[72:75]
buffer_load_dwordx4 v4, s[24:27], s64 offen offset:2048 sc1 lds
v_mfma_f32_16x16x32_bf16 v[76:79], v[168:171], a[140:143], v[76:79]
ds_read_b128 v[164:167], v8 offset:13312
v_mfma_f32_16x16x32_bf16 v[80:83], v[172:175], a[136:139], v[80:83]
s_waitcnt lgkmcnt(4)
ds_read_b128 v[168:171], v8 offset:14336
v_mfma_f32_16x16x32_bf16 v[84:87], v[172:175], a[140:143], v[84:87]
buffer_load_dwordx4 v4, s[24:27], s64 offen offset:3072 sc1 lds
v_mfma_f32_16x16x32_bf16 v[88:91], v[144:147], a[136:139], v[88:91]
s_waitcnt vmcnt(60)
ds_read_b128 v[172:175], v8 offset:15360
v_mfma_f32_16x16x32_bf16 v[92:95], v[144:147], a[140:143], v[92:95]
s_barrier
v_mfma_f32_16x16x32_bf16 v[96:99], v[148:151], a[136:139], v[96:99]
s_xor_b32 s65, s82, 49152
s_add_u32 s65, s65, s77
ds_read_b128 v[144:147], v7 offset:0
v_mfma_f32_16x16x32_bf16 v[100:103], v[148:151], a[140:143], v[100:103]
s_waitcnt lgkmcnt(5) vmcnt(18)
s_add_u32 s91, s91, 16384
v_mfma_f32_16x16x32_bf16 v[120:123], v[152:155], a[144:147], v[120:123]
buffer_load_dwordx4 a[192:195], v4, s[24:27], s65 offen offset:0 sc1
v_mfma_f32_16x16x32_bf16 v[124:127], v[152:155], a[148:151], v[124:127]
s_xor_b32 s93, s82, 49152
s_add_u32 s93, s93, s81
ds_read_b128 v[148:151], v7 offset:1024
v_mfma_f32_16x16x32_bf16 v[72:75], v[156:159], a[144:147], v[72:75]
s_waitcnt lgkmcnt(4)
ds_read_b128 v[152:155], v7 offset:2048
v_mfma_f32_16x16x32_bf16 v[76:79], v[156:159], a[148:151], v[76:79]
buffer_load_dwordx4 a[196:199], v4, s[24:27], s93 offen offset:0 sc1
v_mfma_f32_16x16x32_bf16 v[80:83], v[160:163], a[144:147], v[80:83]
s_cmp_ge_u32 s91, 163840
s_cselect_b32 s91, 0, s91
ds_read_b128 v[156:159], v7 offset:3072
v_mfma_f32_16x16x32_bf16 v[84:87], v[160:163], a[148:151], v[84:87]
v_add_u32 v8, s91, v4
v_mfma_f32_16x16x32_bf16 v[88:91], v[164:167], a[144:147], v[88:91]
ds_read_b128 v[160:163], v7 offset:4096
v_mfma_f32_16x16x32_bf16 v[92:95], v[164:167], a[148:151], v[92:95]
s_waitcnt lgkmcnt(5)
v_mfma_f32_16x16x32_bf16 v[96:99], v[168:171], a[144:147], v[96:99]
ds_read_b128 v[164:167], v7 offset:5120
v_mfma_f32_16x16x32_bf16 v[100:103], v[168:171], a[148:151], v[100:103]
s_waitcnt lgkmcnt(4) vmcnt(18)
v_mfma_f32_16x16x32_bf16 v[120:123], v[172:175], a[152:155], v[120:123]
buffer_load_dword v12, v10, s[24:27], s75 offen offset:4 sc1
v_mfma_f32_16x16x32_bf16 v[124:127], v[172:175], a[156:159], v[124:127]
buffer_load_dwordx4 a[200:203], v4, s[24:27], s65 offen offset:2048 sc1
v_mfma_f32_16x16x32_bf16 v[72:75], v[144:147], a[152:155], v[72:75]
ds_read_b128 v[168:171], v7 offset:6144
v_mfma_f32_16x16x32_bf16 v[76:79], v[144:147], a[156:159], v[76:79]
ds_read_b128 v[172:175], v7 offset:7168
v_mfma_f32_16x16x32_bf16 v[80:83], v[148:151], a[152:155], v[80:83]
buffer_load_dwordx4 a[204:207], v4, s[24:27], s93 offen offset:2048 sc1
v_mfma_f32_16x16x32_bf16 v[84:87], v[148:151], a[156:159], v[84:87]
s_waitcnt lgkmcnt(4)
ds_read_b128 v[144:147], v7 offset:8192
v_mfma_f32_16x16x32_bf16 v[88:91], v[152:155], a[152:155], v[88:91]
ds_read_b128 v[148:151], v7 offset:9216
v_mfma_f32_16x16x32_bf16 v[92:95], v[152:155], a[156:159], v[92:95]
v_mfma_f32_16x16x32_bf16 v[96:99], v[156:159], a[152:155], v[96:99]
ds_read_b128 v[152:155], v7 offset:10240
v_mfma_f32_16x16x32_bf16 v[100:103], v[156:159], a[156:159], v[100:103]
s_waitcnt lgkmcnt(5) vmcnt(19)
v_mfma_f32_16x16x32_bf16 v[120:123], v[160:163], a[160:163], v[120:123]
buffer_load_dwordx4 a[208:211], v14, s[24:27], s65 offen offset:0 sc1
v_mfma_f32_16x16x32_bf16 v[124:127], v[160:163], a[164:167], v[124:127]
ds_read_b128 v[156:159], v7 offset:11264
v_mfma_f32_16x16x32_bf16 v[72:75], v[164:167], a[160:163], v[72:75]
s_waitcnt lgkmcnt(4)
ds_read_b128 v[160:163], v7 offset:12288
v_mfma_f32_16x16x32_bf16 v[76:79], v[164:167], a[164:167], v[76:79]
buffer_load_dwordx4 a[212:215], v14, s[24:27], s93 offen offset:0 sc1
v_mfma_f32_16x16x32_bf16 v[80:83], v[168:171], a[160:163], v[80:83]
ds_read_b128 v[164:167], v7 offset:13312
v_mfma_f32_16x16x32_bf16 v[84:87], v[168:171], a[164:167], v[84:87]
v_mfma_f32_16x16x32_bf16 v[88:91], v[172:175], a[160:163], v[88:91]
ds_read_b128 v[168:171], v7 offset:14336
v_mfma_f32_16x16x32_bf16 v[92:95], v[172:175], a[164:167], v[92:95]
s_waitcnt lgkmcnt(5)
v_mfma_f32_16x16x32_bf16 v[96:99], v[144:147], a[160:163], v[96:99]
ds_read_b128 v[172:175], v7 offset:15360
v_mfma_f32_16x16x32_bf16 v[100:103], v[144:147], a[164:167], v[100:103]
s_waitcnt vmcnt(19)
s_add_u32 s91, s91, 16384
v_mfma_f32_16x16x32_bf16 v[120:123], v[148:151], a[168:171], v[120:123]
buffer_load_dwordx4 a[216:219], v14, s[24:27], s65 offen offset:2048 sc1
v_mfma_f32_16x16x32_bf16 v[124:127], v[148:151], a[172:175], v[124:127]
s_waitcnt lgkmcnt(4)
ds_read_b128 v[144:147], v8 offset:0
v_mfma_f32_16x16x32_bf16 v[72:75], v[152:155], a[168:171], v[72:75]
s_cmp_ge_u32 s91, 163840
s_cselect_b32 s91, 0, s91
ds_read_b128 v[148:151], v8 offset:1024
v_mfma_f32_16x16x32_bf16 v[76:79], v[152:155], a[172:175], v[76:79]
buffer_load_dwordx4 a[220:223], v14, s[24:27], s93 offen offset:2048 sc1
v_mfma_f32_16x16x32_bf16 v[80:83], v[156:159], a[168:171], v[80:83]
s_mov_b32 m0, s70
s_mov_b32 s64, s68
s_add_u32 s68, s68, 16384
v_mfma_f32_16x16x32_bf16 v[84:87], v[156:159], a[172:175], v[84:87]
s_waitcnt lgkmcnt(4)
ds_read_b128 v[152:155], v8 offset:2048
v_add_u32 v7, s91, v4
v_mfma_f32_16x16x32_bf16 v[88:91], v[160:163], a[168:171], v[88:91]
s_add_u32 s70, s70, 16384
s_cmp_ge_u32 s70, 163840
s_cselect_b32 s70, s80, s70
v_mfma_f32_16x16x32_bf16 v[92:95], v[160:163], a[172:175], v[92:95]
buffer_load_dwordx4 v4, s[24:27], s64 offen offset:0 sc1 lds
v_mfma_f32_16x16x32_bf16 v[96:99], v[164:167], a[168:171], v[96:99]
ds_read_b128 v[156:159], v8 offset:3072
v_mfma_f32_16x16x32_bf16 v[100:103], v[164:167], a[172:175], v[100:103]
s_waitcnt lgkmcnt(4) vmcnt(17)
ds_read_b128 v[160:163], v8 offset:4096
v_mfma_f32_16x16x32_bf16 v[120:123], v[168:171], a[176:179], v[120:123]
buffer_load_dwordx4 v4, s[24:27], s64 offen offset:1024 sc1 lds
v_mfma_f32_16x16x32_bf16 v[124:127], v[168:171], a[180:183], v[124:127]
s_xor_b32 s65, s82, 57344
s_add_u32 s65, s65, s77
ds_read_b128 v[164:167], v8 offset:5120
v_mfma_f32_16x16x32_bf16 v[72:75], v[172:175], a[176:179], v[72:75]
s_waitcnt lgkmcnt(4)
ds_read_b128 v[168:171], v8 offset:6144
v_mfma_f32_16x16x32_bf16 v[76:79], v[172:175], a[180:183], v[76:79]
buffer_load_dwordx4 a[224:227], v4, s[24:27], s65 offen offset:0 sc1
v_mfma_f32_16x16x32_bf16 v[80:83], v[144:147], a[176:179], v[80:83]
s_xor_b32 s93, s82, 57344
s_add_u32 s93, s93, s81
ds_read_b128 v[172:175], v8 offset:7168
v_mfma_f32_16x16x32_bf16 v[84:87], v[144:147], a[180:183], v[84:87]
v_mfma_f32_16x16x32_bf16 v[88:91], v[148:151], a[176:179], v[88:91]
buffer_load_dwordx4 a[228:231], v4, s[24:27], s93 offen offset:0 sc1
v_mfma_f32_16x16x32_bf16 v[92:95], v[148:151], a[180:183], v[92:95]
s_waitcnt lgkmcnt(4)
ds_read_b128 v[144:147], v8 offset:8192
v_mfma_f32_16x16x32_bf16 v[96:99], v[152:155], a[176:179], v[96:99]
s_waitcnt vmcnt(15)
ds_read_b128 v[148:151], v8 offset:9216
v_mfma_f32_16x16x32_bf16 v[100:103], v[152:155], a[180:183], v[100:103]
buffer_load_dwordx4 v4, s[24:27], s64 offen offset:2048 sc1 lds
v_mfma_f32_16x16x32_bf16 v[120:123], v[156:159], a[184:187], v[120:123]
ds_read_b128 v[152:155], v8 offset:10240
v_mfma_f32_16x16x32_bf16 v[124:127], v[156:159], a[188:191], v[124:127]
s_waitcnt lgkmcnt(5)
v_mfma_f32_16x16x32_bf16 v[72:75], v[160:163], a[184:187], v[72:75]
buffer_load_dwordx4 v4, s[24:27], s64 offen offset:3072 sc1 lds
v_mfma_f32_16x16x32_bf16 v[76:79], v[160:163], a[188:191], v[76:79]
ds_read_b128 v[156:159], v8 offset:11264
v_mfma_f32_16x16x32_bf16 v[80:83], v[164:167], a[184:187], v[80:83]
s_waitcnt lgkmcnt(4)
ds_read_b128 v[160:163], v8 offset:12288
v_mfma_f32_16x16x32_bf16 v[84:87], v[164:167], a[188:191], v[84:87]
buffer_load_dwordx4 a[232:235], v4, s[24:27], s65 offen offset:2048 sc1
v_mfma_f32_16x16x32_bf16 v[88:91], v[168:171], a[184:187], v[88:91]
s_waitcnt vmcnt(13)
ds_read_b128 v[164:167], v8 offset:13312
v_mfma_f32_16x16x32_bf16 v[92:95], v[168:171], a[188:191], v[92:95]
s_waitcnt lgkmcnt(4) vmcnt(14)
v_cmp_gt_u32 vcc, 8, v12
v_mfma_f32_16x16x32_bf16 v[96:99], v[172:175], a[184:187], v[96:99]
buffer_load_dwordx4 a[236:239], v4, s[24:27], s93 offen offset:2048 sc1
v_mfma_f32_16x16x32_bf16 v[100:103], v[172:175], a[188:191], v[100:103]
s_mov_b32 m0, s70
s_mov_b32 s64, s68
s_add_u32 s68, s68, 16384
v_mfma_f32_16x16x32_bf16 v[120:123], v[144:147], a[192:195], v[120:123]
s_waitcnt vmcnt(17) lgkmcnt(2)
ds_read_b128 v[168:171], v8 offset:14336
v_mfma_f32_16x16x32_bf16 v[124:127], v[144:147], a[196:199], v[124:127]
s_barrier
v_mfma_f32_16x16x32_bf16 v[72:75], v[148:151], a[192:195], v[72:75]
s_cbranch_vccnz CK_ZAA
CK_ZAA_R:
v_mfma_f32_16x16x32_bf16 v[76:79], v[148:151], a[196:199], v[76:79]
s_add_u32 s70, s70, 16384
s_cmp_ge_u32 s70, 163840
s_cselect_b32 s70, s80, s70
v_mfma_f32_16x16x32_bf16 v[80:83], v[152:155], a[192:195], v[80:83]
buffer_load_dwordx4 v4, s[24:27], s64 offen offset:0 sc1 lds
v_mfma_f32_16x16x32_bf16 v[84:87], v[152:155], a[196:199], v[84:87]
ds_read_b128 v[172:175], v8 offset:15360
v_mfma_f32_16x16x32_bf16 v[88:91], v[156:159], a[192:195], v[88:91]
s_waitcnt lgkmcnt(2)
s_add_u32 s91, s91, 16384
ds_read_b128 v[144:147], v7 offset:0
v_mfma_f32_16x16x32_bf16 v[92:95], v[156:159], a[196:199], v[92:95]
buffer_load_dwordx4 v4, s[24:27], s64 offen offset:1024 sc1 lds
v_mfma_f32_16x16x32_bf16 v[96:99], v[160:163], a[192:195], v[96:99]
s_cmp_ge_u32 s91, 163840
s_cselect_b32 s91, 0, s91
ds_read_b128 v[148:151], v7 offset:1024
v_mfma_f32_16x16x32_bf16 v[100:103], v[160:163], a[196:199], v[100:103]
s_waitcnt vmcnt(14)
ds_read_b128 v[152:155], v7 offset:2048
v_add_u32 v8, s91, v4
v_mfma_f32_16x16x32_bf16 v[120:123], v[164:167], a[200:203], v[120:123]
buffer_load_dwordx4 v4, s[24:27], s64 offen offset:2048 sc1 lds
v_mfma_f32_16x16x32_bf16 v[124:127], v[164:167], a[204:207], v[124:127]
s_waitcnt lgkmcnt(3)
ds_read_b128 v[156:159], v7 offset:3072
v_mfma_f32_16x16x32_bf16 v[72:75], v[168:171], a[200:203], v[72:75]
ds_read_b128 v[160:163], v7 offset:4096
v_mfma_f32_16x16x32_bf16 v[76:79], v[168:171], a[204:207], v[76:79]
buffer_load_dwordx4 v4, s[24:27], s64 offen offset:3072 sc1 lds
v_mfma_f32_16x16x32_bf16 v[80:83], v[172:175], a[200:203], v[80:83]
ds_read_b128 v[164:167], v7 offset:5120
v_mfma_f32_16x16x32_bf16 v[84:87], v[172:175], a[204:207], v[84:87]
s_waitcnt lgkmcnt(4)
ds_read_b128 v[168:171], v7 offset:6144
v_mfma_f32_16x16x32_bf16 v[88:91], v[144:147], a[200:203], v[88:91]
buffer_load_dwordx4 a[240:243], v14, s[24:27], s65 offen offset:0 sc1
v_mfma_f32_16x16x32_bf16 v[92:95], v[144:147], a[204:207], v[92:95]
ds_read_b128 v[172:175], v7 offset:7168
v_mfma_f32_16x16x32_bf16 v[96:99], v[148:151], a[200:203], v[96:99]
s_waitcnt lgkmcnt(4) vmcnt(15)
ds_read_b128 v[144:147], v7 offset:8192
v_mfma_f32_16x16x32_bf16 v[100:103], v[148:151], a[204:207], v[100:103]
buffer_load_dwordx4 a[244:247], v14, s[24:27], s93 offen offset:0 sc1
v_mfma_f32_16x16x32_bf16 v[120:123], v[152:155], a[208:211], v[120:123]
ds_read_b128 v[148:151], v7 offset:9216
v_mfma_f32_16x16x32_bf16 v[124:127], v[152:155], a[212:215], v[124:127]
v_mfma_f32_16x16x32_bf16 v[72:75], v[156:159], a[208:211], v[72:75]
buffer_load_dwordx4 a[248:251], v14, s[24:27], s65 offen offset:2048 sc1
v_mfma_f32_16x16x32_bf16 v[76:79], v[156:159], a[212:215], v[76:79]
s_waitcnt lgkmcnt(4)
ds_read_b128 v[152:155], v7 offset:10240
v_mfma_f32_16x16x32_bf16 v[80:83], v[160:163], a[208:211], v[80:83]
ds_read_b128 v[156:159], v7 offset:11264
v_mfma_f32_16x16x32_bf16 v[84:87], v[160:163], a[212:215], v[84:87]
buffer_load_dwordx4 a[252:255], v14, s[24:27], s93 offen offset:2048 sc1
v_mfma_f32_16x16x32_bf16 v[88:91], v[164:167], a[208:211], v[88:91]
s_add_u32 s65, s77, 65536
ds_read_b128 v[160:163], v7 offset:12288
v_mfma_f32_16x16x32_bf16 v[92:95], v[164:167], a[212:215], v[92:95]
s_waitcnt lgkmcnt(5)
v_mfma_f32_16x16x32_bf16 v[96:99], v[168:171], a[208:211], v[96:99]
buffer_load_dwordx4 v[32:35], v4, s[24:27], s65 offen offset:0 sc1
v_mfma_f32_16x16x32_bf16 v[100:103], v[168:171], a[212:215], v[100:103]
s_add_u32 s93, s81, 65536
s_waitcnt vmcnt(17)
ds_read_b128 v[164:167], v7 offset:13312
v_mfma_f32_16x16x32_bf16 v[120:123], v[172:175], a[216:219], v[120:123]
s_waitcnt lgkmcnt(4)
ds_read_b128 v[168:171], v7 offset:14336
v_mfma_f32_16x16x32_bf16 v[124:127], v[172:175], a[220:223], v[124:127]
buffer_load_dwordx4 v[36:39], v4, s[24:27], s93 offen offset:0 sc1
v_mfma_f32_16x16x32_bf16 v[72:75], v[144:147], a[216:219], v[72:75]
ds_read_b128 v[172:175], v7 offset:15360
v_mfma_f32_16x16x32_bf16 v[76:79], v[144:147], a[220:223], v[76:79]
s_add_u32 s91, s91, 16384
s_cmp_ge_u32 s91, 163840
s_cselect_b32 s91, 0, s91
v_mfma_f32_16x16x32_bf16 v[80:83], v[148:151], a[216:219], v[80:83]
buffer_load_dwordx4 v[40:43], v4, s[24:27], s65 offen offset:2048 sc1
v_mfma_f32_16x16x32_bf16 v[84:87], v[148:151], a[220:223], v[84:87]
s_waitcnt lgkmcnt(4)
ds_read_b128 v[144:147], v8 offset:0
v_add_u32 v7, s91, v4
v_mfma_f32_16x16x32_bf16 v[88:91], v[152:155], a[216:219], v[88:91]
ds_read_b128 v[148:151], v8 offset:1024
v_mfma_f32_16x16x32_bf16 v[92:95], v[152:155], a[220:223], v[92:95]
buffer_load_dwordx4 v[44:47], v4, s[24:27], s93 offen offset:2048 sc1
v_mfma_f32_16x16x32_bf16 v[96:99], v[156:159], a[216:219], v[96:99]
ds_read_b128 v[152:155], v8 offset:2048
v_mfma_f32_16x16x32_bf16 v[100:103], v[156:159], a[220:223], v[100:103]
s_waitcnt lgkmcnt(5) vmcnt(16)
v_mfma_f32_16x16x32_bf16 v[120:123], v[160:163], a[224:227], v[120:123]
buffer_load_dwordx4 v[48:51], v14, s[24:27], s65 offen offset:0 sc1
v_mfma_f32_16x16x32_bf16 v[124:127], v[160:163], a[228:231], v[124:127]
ds_read_b128 v[156:159], v8 offset:3072
v_mfma_f32_16x16x32_bf16 v[72:75], v[164:167], a[224:227], v[72:75]
s_waitcnt lgkmcnt(4)
ds_read_b128 v[160:163], v8 offset:4096
v_mfma_f32_16x16x32_bf16 v[76:79], v[164:167], a[228:231], v[76:79]
buffer_load_dwordx4 v[52:55], v14, s[24:27], s93 offen offset:0 sc1
v_mfma_f32_16x16x32_bf16 v[80:83], v[168:171], a[224:227], v[80:83]
s_mov_b32 m0, s70
s_mov_b32 s64, s68
s_add_u32 s68, s68, 16384
v_mfma_f32_16x16x32_bf16 v[84:87], v[168:171], a[228:231], v[84:87]
s_waitcnt lgkmcnt(3)
ds_read_b128 v[164:167], v8 offset:5120
v_mfma_f32_16x16x32_bf16 v[88:91], v[172:175], a[224:227], v[88:91]
s_add_u32 s70, s70, 16384
s_cmp_ge_u32 s70, 163840
s_cselect_b32 s70, s80, s70
v_mfma_f32_16x16x32_bf16 v[92:95], v[172:175], a[228:231], v[92:95]
buffer_load_dwordx4 v4, s[24:27], s64 offen offset:0 sc1 lds
v_mfma_f32_16x16x32_bf16 v[96:99], v[144:147], a[224:227], v[96:99]
ds_read_b128 v[168:171], v8 offset:6144
v_mfma_f32_16x16x32_bf16 v[100:103], v[144:147], a[228:231], v[100:103]
s_waitcnt vmcnt(15)
ds_read_b128 v[172:175], v8 offset:7168
v_mfma_f32_16x16x32_bf16 v[120:123], v[148:151], a[232:235], v[120:123]
buffer_load_dwordx4 v4, s[24:27], s64 offen offset:1024 sc1 lds
v_mfma_f32_16x16x32_bf16 v[124:127], v[148:151], a[236:239], v[124:127]
s_waitcnt lgkmcnt(4)
ds_read_b128 v[144:147], v8 offset:8192
v_mfma_f32_16x16x32_bf16 v[72:75], v[152:155], a[232:235], v[72:75]
ds_read_b128 v[148:151], v8 offset:9216
v_mfma_f32_16x16x32_bf16 v[76:79], v[152:155], a[236:239], v[76:79]
buffer_load_dwordx4 v4, s[24:27], s64 offen offset:2048 sc1 lds
v_mfma_f32_16x16x32_bf16 v[80:83], v[156:159], a[232:235], v[80:83]
ds_read_b128 v[152:155], v8 offset:10240
v_mfma_f32_16x16x32_bf16 v[84:87], v[156:159], a[236:239], v[84:87]
s_waitcnt lgkmcnt(5)
v_mfma_f32_16x16x32_bf16 v[88:91], v[160:163], a[232:235], v[88:91]
buffer_load_dwordx4 v4, s[24:27], s64 offen offset:3072 sc1 lds
v_mfma_f32_16x16x32_bf16 v[92:95], v[160:163], a[236:239], v[92:95]
ds_read_b128 v[156:159], v8 offset:11264
v_mfma_f32_16x16x32_bf16 v[96:99], v[164:167], a[232:235], v[96:99]
s_waitcnt lgkmcnt(4) vmcnt(12)
ds_read_b128 v[160:163], v8 offset:12288
v_mfma_f32_16x16x32_bf16 v[100:103], v[164:167], a[236:239], v[100:103]
buffer_load_dwordx4 v[56:59], v14, s[24:27], s65 offen offset:2048 sc1
v_mfma_f32_16x16x32_bf16 v[120:123], v[168:171], a[240:243], v[120:123]
ds_read_b128 v[164:167], v8 offset:13312
v_mfma_f32_16x16x32_bf16 v[124:127], v[168:171], a[244:247], v[124:127]
s_waitcnt lgkmcnt(4)
v_mfma_f32_16x16x32_bf16 v[72:75], v[172:175], a[240:243], v[72:75]
buffer_load_dwordx4 v[60:63], v14, s[24:27], s93 offen offset:2048 sc1
v_mfma_f32_16x16x32_bf16 v[76:79], v[172:175], a[244:247], v[76:79]
s_mov_b32 m0, s70
s_mov_b32 s64, s68
s_add_u32 s68, s68, 16384
v_mfma_f32_16x16x32_bf16 v[80:83], v[144:147], a[240:243], v[80:83]
s_waitcnt vmcnt(16) lgkmcnt(2)
ds_read_b128 v[168:171], v8 offset:14336
v_mfma_f32_16x16x32_bf16 v[84:87], v[144:147], a[244:247], v[84:87]
s_barrier
v_mfma_f32_16x16x32_bf16 v[88:91], v[148:151], a[240:243], v[88:91]
s_add_u32 s70, s70, 16384
s_cmp_ge_u32 s70, 163840
s_cselect_b32 s70, s80, s70
v_mfma_f32_16x16x32_bf16 v[92:95], v[148:151], a[244:247], v[92:95]
buffer_load_dwordx4 v4, s[24:27], s64 offen offset:0 sc1 lds
v_mfma_f32_16x16x32_bf16 v[96:99], v[152:155], a[240:243], v[96:99]
ds_read_b128 v[172:175], v8 offset:15360
v_mfma_f32_16x16x32_bf16 v[100:103], v[152:155], a[244:247], v[100:103]
s_waitcnt vmcnt(13)
s_add_u32 s91, s91, 16384
ds_read_b128 v[144:147], v7 offset:0
v_mfma_f32_16x16x32_bf16 v[120:123], v[156:159], a[248:251], v[120:123]
buffer_load_dwordx4 v4, s[24:27], s64 offen offset:1024 sc1 lds
v_mfma_f32_16x16x32_bf16 v[124:127], v[156:159], a[252:255], v[124:127]
s_add_u32 s65, s77, 73728
s_waitcnt lgkmcnt(3)
ds_read_b128 v[148:151], v7 offset:1024
v_mfma_f32_16x16x32_bf16 v[72:75], v[160:163], a[248:251], v[72:75]
s_cmp_ge_u32 s91, 163840
s_cselect_b32 s91, 0, s91
ds_read_b128 v[152:155], v7 offset:2048
v_mfma_f32_16x16x32_bf16 v[76:79], v[160:163], a[252:255], v[76:79]
buffer_load_dwordx4 v[64:67], v4, s[24:27], s65 offen offset:0 sc1
v_mfma_f32_16x16x32_bf16 v[80:83], v[164:167], a[248:251], v[80:83]
s_add_u32 s93, s81, 73728
ds_read_b128 v[156:159], v7 offset:3072
v_add_u32 v8, s91, v4
v_mfma_f32_16x16x32_bf16 v[84:87], v[164:167], a[252:255], v[84:87]
s_waitcnt lgkmcnt(4)
ds_read_b128 v[160:163], v7 offset:4096
v_mfma_f32_16x16x32_bf16 v[88:91], v[168:171], a[248:251], v[88:91]
buffer_load_dwordx4 v[68:71], v4, s[24:27], s93 offen offset:0 sc1
v_mfma_f32_16x16x32_bf16 v[92:95], v[168:171], a[252:255], v[92:95]
ds_read_b128 v[164:167], v7 offset:5120
v_mfma_f32_16x16x32_bf16 v[96:99], v[172:175], a[248:251], v[96:99]
s_waitcnt lgkmcnt(4) vmcnt(14)
ds_read_b128 v[168:171], v7 offset:6144
v_mfma_f32_16x16x32_bf16 v[100:103], v[172:175], a[252:255], v[100:103]
buffer_load_dwordx4 v4, s[24:27], s64 offen offset:2048 sc1 lds
v_mfma_f32_16x16x32_bf16 v[120:123], v[144:147], v[32:35], v[120:123]
ds_read_b128 v[172:175], v7 offset:7168
v_mfma_f32_16x16x32_bf16 v[124:127], v[144:147], v[36:39], v[124:127]
v_mfma_f32_16x16x32_bf16 v[72:75], v[148:151], v[32:35], v[72:75]
buffer_load_dwordx4 v4, s[24:27], s64 offen offset:3072 sc1 lds
v_mfma_f32_16x16x32_bf16 v[76:79], v[148:151], v[36:39], v[76:79]
s_waitcnt lgkmcnt(4)
ds_read_b128 v[144:147], v7 offset:8192
v_mfma_f32_16x16x32_bf16 v[80:83], v[152:155], v[32:35], v[80:83]
ds_read_b128 v[148:151], v7 offset:9216
v_mfma_f32_16x16x32_bf16 v[84:87], v[152:155], v[36:39], v[84:87]
v_mfma_f32_16x16x32_bf16 v[88:91], v[156:159], v[32:35], v[88:91]
ds_read_b128 v[152:155], v7 offset:10240
v_mfma_f32_16x16x32_bf16 v[92:95], v[156:159], v[36:39], v[92:95]
s_waitcnt lgkmcnt(5)
v_mfma_f32_16x16x32_bf16 v[96:99], v[160:163], v[32:35], v[96:99]
ds_read_b128 v[156:159], v7 offset:11264
v_mfma_f32_16x16x32_bf16 v[100:103], v[160:163], v[36:39], v[100:103]
s_waitcnt vmcnt(14)
v_mfma_f32_16x16x32_bf16 v[120:123], v[164:167], v[40:43], v[120:123]
ds_read_b128 v[160:163], v7 offset:12288
v_mfma_f32_16x16x32_bf16 v[124:127], v[164:167], v[44:47], v[124:127]
s_waitcnt lgkmcnt(5)
v_mfma_f32_16x16x32_bf16 v[72:75], v[168:171], v[40:43], v[72:75]
ds_read_b128 v[164:167], v7 offset:13312
v_mfma_f32_16x16x32_bf16 v[76:79], v[168:171], v[44:47], v[76:79]
v_mfma_f32_16x16x32_bf16 v[80:83], v[172:175], v[40:43], v[80:83]
ds_read_b128 v[168:171], v7 offset:14336
v_mfma_f32_16x16x32_bf16 v[84:87], v[172:175], v[44:47], v[84:87]
s_waitcnt lgkmcnt(5)
v_mfma_f32_16x16x32_bf16 v[88:91], v[144:147], v[40:43], v[88:91]
ds_read_b128 v[172:175], v7 offset:15360
v_mfma_f32_16x16x32_bf16 v[92:95], v[144:147], v[44:47], v[92:95]
s_add_u32 s91, s91, 16384
s_cmp_ge_u32 s91, 163840
s_cselect_b32 s91, 0, s91
v_mfma_f32_16x16x32_bf16 v[96:99], v[148:151], v[40:43], v[96:99]
ds_read_b128 v[144:147], v8 offset:0
v_add_u32 v7, s91, v4
v_mfma_f32_16x16x32_bf16 v[100:103], v[148:151], v[44:47], v[100:103]
s_waitcnt lgkmcnt(5) vmcnt(12)
v_mfma_f32_16x16x32_bf16 v[120:123], v[152:155], v[48:51], v[120:123]
ds_read_b128 v[148:151], v8 offset:1024
v_mfma_f32_16x16x32_bf16 v[124:127], v[152:155], v[52:55], v[124:127]
v_mfma_f32_16x16x32_bf16 v[72:75], v[156:159], v[48:51], v[72:75]
s_mov_b32 m0, s70
s_mov_b32 s64, s68
s_add_u32 s68, s68, 16384
v_mfma_f32_16x16x32_bf16 v[76:79], v[156:159], v[52:55], v[76:79]
s_waitcnt lgkmcnt(4)
ds_read_b128 v[152:155], v8 offset:2048
v_mfma_f32_16x16x32_bf16 v[80:83], v[160:163], v[48:51], v[80:83]
s_add_u32 s70, s70, 16384
s_cmp_ge_u32 s70, 163840
s_cselect_b32 s70, s80, s70
v_mfma_f32_16x16x32_bf16 v[84:87], v[160:163], v[52:55], v[84:87]
buffer_load_dwordx4 v4, s[24:27], s64 offen offset:0 sc1 lds
v_mfma_f32_16x16x32_bf16 v[88:91], v[164:167], v[48:51], v[88:91]
ds_read_b128 v[156:159], v8 offset:3072
v_mfma_f32_16x16x32_bf16 v[92:95], v[164:167], v[52:55], v[92:95]
s_waitcnt lgkmcnt(4)
ds_read_b128 v[160:163], v8 offset:4096
v_mfma_f32_16x16x32_bf16 v[96:99], v[168:171], v[48:51], v[96:99]
buffer_load_dwordx4 v4, s[24:27], s64 offen offset:1024 sc1 lds
v_mfma_f32_16x16x32_bf16 v[100:103], v[168:171], v[52:55], v[100:103]
s_waitcnt vmcnt(8)
ds_read_b128 v[164:167], v8 offset:5120
v_mfma_f32_16x16x32_bf16 v[120:123], v[172:175], v[56:59], v[120:123]
s_waitcnt lgkmcnt(4)
ds_read_b128 v[168:171], v8 offset:6144
v_mfma_f32_16x16x32_bf16 v[124:127], v[172:175], v[60:63], v[124:127]
buffer_load_dwordx4 v4, s[24:27], s64 offen offset:2048 sc1 lds
v_mfma_f32_16x16x32_bf16 v[72:75], v[144:147], v[56:59], v[72:75]
ds_read_b128 v[172:175], v8 offset:7168
v_mfma_f32_16x16x32_bf16 v[76:79], v[144:147], v[60:63], v[76:79]
v_mfma_f32_16x16x32_bf16 v[80:83], v[148:151], v[56:59], v[80:83]
buffer_load_dwordx4 v4, s[24:27], s64 offen offset:3072 sc1 lds
v_mfma_f32_16x16x32_bf16 v[84:87], v[148:151], v[60:63], v[84:87]
s_waitcnt lgkmcnt(4)
ds_read_b128 v[144:147], v8 offset:8192
v_mfma_f32_16x16x32_bf16 v[88:91], v[152:155], v[56:59], v[88:91]
s_mov_b32 m0, s70
s_mov_b32 s64, s68
s_add_u32 s68, s68, 16384
v_mfma_f32_16x16x32_bf16 v[92:95], v[152:155], v[60:63], v[92:95]
s_waitcnt lgkmcnt(3) vmcnt(6)
ds_read_b128 v[148:151], v8 offset:9216
v_mfma_f32_16x16x32_bf16 v[96:99], v[156:159], v[56:59], v[96:99]
s_add_u32 s70, s70, 16384
s_cmp_ge_u32 s70, 163840
s_cselect_b32 s70, s80, s70
v_mfma_f32_16x16x32_bf16 v[100:103], v[156:159], v[60:63], v[100:103]
buffer_load_dwordx4 v4, s[24:27], s64 offen offset:0 sc1 lds
v_mfma_f32_16x16x32_bf16 v[120:123], v[160:163], v[64:67], v[120:123]
ds_read_b128 v[152:155], v8 offset:10240
v_mfma_f32_16x16x32_bf16 v[124:127], v[160:163], v[68:71], v[124:127]
ds_read_b128 v[156:159], v8 offset:11264
v_mfma_f32_16x16x32_bf16 v[72:75], v[164:167], v[64:67], v[72:75]
buffer_load_dwordx4 v4, s[24:27], s64 offen offset:1024 sc1 lds
v_mfma_f32_16x16x32_bf16 v[76:79], v[164:167], v[68:71], v[76:79]
s_waitcnt lgkmcnt(4)
ds_read_b128 v[160:163], v8 offset:12288
v_mfma_f32_16x16x32_bf16 v[80:83], v[168:171], v[64:67], v[80:83]
ds_read_b128 v[164:167], v8 offset:13312
v_mfma_f32_16x16x32_bf16 v[84:87], v[168:171], v[68:71], v[84:87]
buffer_load_dwordx4 v4, s[24:27], s64 offen offset:2048 sc1 lds
v_mfma_f32_16x16x32_bf16 v[88:91], v[172:175], v[64:67], v[88:91]
L_PAD12:
s_cbranch_execz L_MAIN
ds_read_b128 v[168:171], v8 offset:14336
v_mfma_f32_16x16x32_bf16 v[92:95], v[172:175], v[68:71], v[92:95]
s_waitcnt lgkmcnt(5)
v_mfma_f32_16x16x32_bf16 v[96:99], v[144:147], v[64:67], v[96:99]
s_waitcnt vmcnt(7)
ds_read_b128 v[172:175], v8 offset:15360
v_cvt_pk_bf16_f32 v228, v120, v121
v_mfma_f32_16x16x32_bf16 v[100:103], v[144:147], v[68:71], v[100:103]
s_barrier
v_mfma_f32_16x16x32_bf16 v[104:107], v[148:151], a[128:131], v[104:107]
s_add_u32 s91, s91, 16384
ds_read_b128 v[144:147], v7 offset:0
v_cvt_pk_bf16_f32 v229, v122, v123
v_mfma_f32_16x16x32_bf16 v[108:111], v[148:151], a[132:135], v[108:111]
s_waitcnt lgkmcnt(5)
v_cvt_pk_bf16_f32 v230, v124, v125
v_mfma_f32_16x16x32_bf16 v[112:115], v[152:155], a[128:131], v[112:115]
ds_read_b128 v[148:151], v7 offset:1024
v_cvt_pk_bf16_f32 v231, v126, v127
v_mfma_f32_16x16x32_bf16 v[116:119], v[152:155], a[132:135], v[116:119]
buffer_store_dwordx4 v[228:231], v4, s[24:27], s55 offen offset:0 sc1
v_mfma_f32_16x16x32_bf16 v[104:107], v[156:159], a[136:139], v[104:107]
buffer_load_dwordx4 v4, s[24:27], s64 offen offset:3072 sc1 lds
v_mfma_f32_16x16x32_bf16 v[108:111], v[156:159], a[140:143], v[108:111]
s_waitcnt lgkmcnt(4)
ds_read_b128 v[152:155], v7 offset:2048
v_cvt_pk_bf16_f32 v72, v72, v73
v_mfma_f32_16x16x32_bf16 v[112:115], v[160:163], a[136:139], v[112:115]
ds_read_b128 v[156:159], v7 offset:3072
v_cvt_pk_bf16_f32 v73, v74, v75
v_mfma_f32_16x16x32_bf16 v[116:119], v[160:163], a[140:143], v[116:119]
s_cmp_ge_u32 s91, 163840
s_cselect_b32 s91, 0, s91
v_cvt_pk_bf16_f32 v74, v80, v81
v_mfma_f32_16x16x32_bf16 v[104:107], v[164:167], a[144:147], v[104:107]
s_waitcnt lgkmcnt(4)
ds_read_b128 v[160:163], v7 offset:4096
v_cvt_pk_bf16_f32 v75, v82, v83
v_mfma_f32_16x16x32_bf16 v[108:111], v[164:167], a[148:151], v[108:111]
buffer_store_dwordx4 v[72:75], v4, s[24:27], s52 offen offset:0 sc1
v_mfma_f32_16x16x32_bf16 v[112:115], v[168:171], a[144:147], v[112:115]
ds_read_b128 v[164:167], v7 offset:5120
v_cvt_pk_bf16_f32 v76, v76, v77
v_mfma_f32_16x16x32_bf16 v[116:119], v[168:171], a[148:151], v[116:119]
v_cvt_pk_bf16_f32 v77, v78, v79
v_add_u32 v8, s91, v4
v_mfma_f32_16x16x32_bf16 v[104:107], v[172:175], a[152:155], v[104:107]
ds_read_b128 v[168:171], v7 offset:6144
v_cvt_pk_bf16_f32 v78, v84, v85
v_mfma_f32_16x16x32_bf16 v[108:111], v[172:175], a[156:159], v[108:111]
s_waitcnt lgkmcnt(5)
v_cvt_pk_bf16_f32 v79, v86, v87
v_mfma_f32_16x16x32_bf16 v[112:115], v[144:147], a[152:155], v[112:115]
buffer_store_dwordx4 v[76:79], v4, s[24:27], s52 offen offset:1024 sc1
v_mfma_f32_16x16x32_bf16 v[116:119], v[144:147], a[156:159], v[116:119]
ds_read_b128 v[172:175], v7 offset:7168
v_cvt_pk_bf16_f32 v88, v88, v89
v_mfma_f32_16x16x32_bf16 v[104:107], v[148:151], a[160:163], v[104:107]
ds_read_b128 v[144:147], v7 offset:8192
v_cvt_pk_bf16_f32 v89, v90, v91
v_mfma_f32_16x16x32_bf16 v[108:111], v[148:151], a[164:167], v[108:111]
s_waitcnt lgkmcnt(5)
v_cvt_pk_bf16_f32 v90, v96, v97
v_mfma_f32_16x16x32_bf16 v[112:115], v[152:155], a[160:163], v[112:115]
ds_read_b128 v[148:151], v7 offset:9216
v_cvt_pk_bf16_f32 v91, v98, v99
v_mfma_f32_16x16x32_bf16 v[116:119], v[152:155], a[164:167], v[116:119]
buffer_store_dwordx4 v[88:91], v4, s[24:27], s53 offen offset:0 sc1
v_mfma_f32_16x16x32_bf16 v[104:107], v[156:159], a[168:171], v[104:107]
ds_read_b128 v[152:155], v7 offset:10240
v_cvt_pk_bf16_f32 v92, v92, v93
v_mfma_f32_16x16x32_bf16 v[108:111], v[156:159], a[172:175], v[108:111]
s_waitcnt lgkmcnt(5)
v_cvt_pk_bf16_f32 v93, v94, v95
v_mfma_f32_16x16x32_bf16 v[112:115], v[160:163], a[168:171], v[112:115]
ds_read_b128 v[156:159], v7 offset:11264
v_cvt_pk_bf16_f32 v94, v100, v101
v_mfma_f32_16x16x32_bf16 v[116:119], v[160:163], a[172:175], v[116:119]
v_cvt_pk_bf16_f32 v95, v102, v103
v_mfma_f32_16x16x32_bf16 v[104:107], v[164:167], a[176:179], v[104:107]
buffer_store_dwordx4 v[92:95], v4, s[24:27], s53 offen offset:1024 sc1
v_mfma_f32_16x16x32_bf16 v[108:111], v[164:167], a[180:183], v[108:111]
s_waitcnt lgkmcnt(4)
ds_read_b128 v[160:163], v7 offset:12288
v_mfma_f32_16x16x32_bf16 v[112:115], v[168:171], a[176:179], v[112:115]
ds_read_b128 v[164:167], v7 offset:13312
v_mfma_f32_16x16x32_bf16 v[116:119], v[168:171], a[180:183], v[116:119]
v_mfma_f32_16x16x32_bf16 v[104:107], v[172:175], a[184:187], v[104:107]
ds_read_b128 v[168:171], v7 offset:14336
v_mfma_f32_16x16x32_bf16 v[108:111], v[172:175], a[188:191], v[108:111]
s_waitcnt lgkmcnt(5)
v_mfma_f32_16x16x32_bf16 v[112:115], v[144:147], a[184:187], v[112:115]
ds_read_b128 v[172:175], v7 offset:15360
v_mfma_f32_16x16x32_bf16 v[116:119], v[144:147], a[188:191], v[116:119]
s_add_u32 s91, s91, 16384
s_cmp_ge_u32 s91, 163840
s_cselect_b32 s91, 0, s91
v_mfma_f32_16x16x32_bf16 v[104:107], v[148:151], a[192:195], v[104:107]
ds_read_b128 v[144:147], v8 offset:0
v_add_u32 v7, s91, v4
v_mfma_f32_16x16x32_bf16 v[108:111], v[148:151], a[196:199], v[108:111]
s_waitcnt lgkmcnt(5)
v_mfma_f32_16x16x32_bf16 v[112:115], v[152:155], a[192:195], v[112:115]
ds_read_b128 v[148:151], v8 offset:1024
v_mfma_f32_16x16x32_bf16 v[116:119], v[152:155], a[196:199], v[116:119]
v_mfma_f32_16x16x32_bf16 v[104:107], v[156:159], a[200:203], v[104:107]
s_mov_b32 m0, s70
s_mov_b32 s64, s68
s_add_u32 s68, s68, 16384
v_mfma_f32_16x16x32_bf16 v[108:111], v[156:159], a[204:207], v[108:111]
s_waitcnt lgkmcnt(4)
ds_read_b128 v[152:155], v8 offset:2048
v_mfma_f32_16x16x32_bf16 v[112:115], v[160:163], a[200:203], v[112:115]
s_add_u32 s70, s70, 16384
s_cmp_ge_u32 s70, 163840
s_cselect_b32 s70, s80, s70
v_mfma_f32_16x16x32_bf16 v[116:119], v[160:163], a[204:207], v[116:119]
buffer_load_dwordx4 v4, s[24:27], s64 offen offset:0 sc1 lds
v_mfma_f32_16x16x32_bf16 v[104:107], v[164:167], a[208:211], v[104:107]
ds_read_b128 v[156:159], v8 offset:3072
v_mfma_f32_16x16x32_bf16 v[108:111], v[164:167], a[212:215], v[108:111]
s_waitcnt lgkmcnt(4)
ds_read_b128 v[160:163], v8 offset:4096
v_mfma_f32_16x16x32_bf16 v[112:115], v[168:171], a[208:211], v[112:115]
buffer_load_dwordx4 v4, s[24:27], s64 offen offset:1024 sc1 lds
v_mfma_f32_16x16x32_bf16 v[116:119], v[168:171], a[212:215], v[116:119]
ds_read_b128 v[164:167], v8 offset:5120
v_mfma_f32_16x16x32_bf16 v[104:107], v[172:175], a[216:219], v[104:107]
s_waitcnt lgkmcnt(4)
ds_read_b128 v[168:171], v8 offset:6144
v_mfma_f32_16x16x32_bf16 v[108:111], v[172:175], a[220:223], v[108:111]
buffer_load_dwordx4 v4, s[24:27], s64 offen offset:2048 sc1 lds
v_mfma_f32_16x16x32_bf16 v[112:115], v[144:147], a[216:219], v[112:115]
ds_read_b128 v[172:175], v8 offset:7168
v_mfma_f32_16x16x32_bf16 v[116:119], v[144:147], a[220:223], v[116:119]
v_mfma_f32_16x16x32_bf16 v[104:107], v[148:151], a[224:227], v[104:107]
buffer_load_dwordx4 v4, s[24:27], s64 offen offset:3072 sc1 lds
v_mfma_f32_16x16x32_bf16 v[108:111], v[148:151], a[228:231], v[108:111]
s_waitcnt lgkmcnt(4)
ds_read_b128 v[144:147], v8 offset:8192
v_mfma_f32_16x16x32_bf16 v[112:115], v[152:155], a[224:227], v[112:115]
s_mov_b32 m0, s70
s_mov_b32 s64, s68
s_add_u32 s68, s68, 16384
v_mfma_f32_16x16x32_bf16 v[116:119], v[152:155], a[228:231], v[116:119]
s_waitcnt lgkmcnt(3)
ds_read_b128 v[148:151], v8 offset:9216
v_mfma_f32_16x16x32_bf16 v[104:107], v[156:159], a[232:235], v[104:107]
s_add_u32 s70, s70, 16384
s_cmp_ge_u32 s70, 163840
s_cselect_b32 s70, s80, s70
v_mfma_f32_16x16x32_bf16 v[108:111], v[156:159], a[236:239], v[108:111]
buffer_load_dwordx4 v4, s[24:27], s64 offen offset:0 sc1 lds
v_mfma_f32_16x16x32_bf16 v[112:115], v[160:163], a[232:235], v[112:115]
ds_read_b128 v[152:155], v8 offset:10240
v_mfma_f32_16x16x32_bf16 v[116:119], v[160:163], a[236:239], v[116:119]
ds_read_b128 v[156:159], v8 offset:11264
v_mfma_f32_16x16x32_bf16 v[104:107], v[164:167], a[240:243], v[104:107]
buffer_load_dwordx4 v4, s[24:27], s64 offen offset:1024 sc1 lds
v_mfma_f32_16x16x32_bf16 v[108:111], v[164:167], a[244:247], v[108:111]
s_waitcnt lgkmcnt(4)
ds_read_b128 v[160:163], v8 offset:12288
v_mfma_f32_16x16x32_bf16 v[112:115], v[168:171], a[240:243], v[112:115]
ds_read_b128 v[164:167], v8 offset:13312
v_mfma_f32_16x16x32_bf16 v[116:119], v[168:171], a[244:247], v[116:119]
buffer_load_dwordx4 v4, s[24:27], s64 offen offset:2048 sc1 lds
v_mfma_f32_16x16x32_bf16 v[104:107], v[172:175], a[248:251], v[104:107]
ds_read_b128 v[168:171], v8 offset:14336
v_mfma_f32_16x16x32_bf16 v[108:111], v[172:175], a[252:255], v[108:111]
s_waitcnt lgkmcnt(5)
v_mfma_f32_16x16x32_bf16 v[112:115], v[144:147], a[248:251], v[112:115]
s_waitcnt vmcnt(11)
ds_read_b128 v[172:175], v8 offset:15360
v_mfma_f32_16x16x32_bf16 v[116:119], v[144:147], a[252:255], v[116:119]
s_barrier
v_mfma_f32_16x16x32_bf16 v[104:107], v[148:151], v[32:35], v[104:107]
buffer_load_dwordx4 v4, s[24:27], s64 offen offset:3072 sc1 lds
v_mfma_f32_16x16x32_bf16 v[108:111], v[148:151], v[36:39], v[108:111]
s_waitcnt lgkmcnt(4)
s_add_u32 s91, s91, 16384
ds_read_b128 v[144:147], v7 offset:0
v_mfma_f32_16x16x32_bf16 v[112:115], v[152:155], v[32:35], v[112:115]
s_cmp_ge_u32 s91, 163840
s_cselect_b32 s91, 0, s91
ds_read_b128 v[148:151], v7 offset:1024
v_mfma_f32_16x16x32_bf16 v[116:119], v[152:155], v[36:39], v[116:119]
v_add_u32 v8, s91, v4
v_mfma_f32_16x16x32_bf16 v[104:107], v[156:159], v[40:43], v[104:107]
ds_read_b128 v[152:155], v7 offset:2048
v_mfma_f32_16x16x32_bf16 v[108:111], v[156:159], v[44:47], v[108:111]
s_waitcnt lgkmcnt(5)
v_mfma_f32_16x16x32_bf16 v[112:115], v[160:163], v[40:43], v[112:115]
ds_read_b128 v[156:159], v7 offset:3072
v_mfma_f32_16x16x32_bf16 v[116:119], v[160:163], v[44:47], v[116:119]
v_mfma_f32_16x16x32_bf16 v[104:107], v[164:167], v[48:51], v[104:107]
ds_read_b128 v[160:163], v7 offset:4096
v_mfma_f32_16x16x32_bf16 v[108:111], v[164:167], v[52:55], v[108:111]
s_waitcnt lgkmcnt(5)
v_mfma_f32_16x16x32_bf16 v[112:115], v[168:171], v[48:51], v[112:115]
s_waitcnt vmcnt(8)
ds_read_b128 v[164:167], v7 offset:5120
v_mfma_f32_16x16x32_bf16 v[116:119], v[168:171], v[52:55], v[116:119]
buffer_atomic_add v1, v0, s[24:27], s73 offen offset:0 sc1
v_mfma_f32_16x16x32_bf16 v[104:107], v[172:175], v[56:59], v[104:107]
ds_read_b128 v[168:171], v7 offset:6144
v_mfma_f32_16x16x32_bf16 v[108:111], v[172:175], v[60:63], v[108:111]
s_waitcnt lgkmcnt(5)
v_mfma_f32_16x16x32_bf16 v[112:115], v[144:147], v[56:59], v[112:115]
ds_read_b128 v[172:175], v7 offset:7168
v_mfma_f32_16x16x32_bf16 v[116:119], v[144:147], v[60:63], v[116:119]
v_mfma_f32_16x16x32_bf16 v[104:107], v[148:151], v[64:67], v[104:107]
ds_read_b128 v[144:147], v7 offset:8192
v_mfma_f32_16x16x32_bf16 v[108:111], v[148:151], v[68:71], v[108:111]
s_waitcnt lgkmcnt(5)
v_mfma_f32_16x16x32_bf16 v[112:115], v[152:155], v[64:67], v[112:115]
ds_read_b128 v[148:151], v7 offset:9216
v_mfma_f32_16x16x32_bf16 v[116:119], v[152:155], v[68:71], v[116:119]
v_mfma_f32_16x16x32_bf16 v[128:131], v[156:159], a[0:3], 0
ds_read_b128 v[152:155], v7 offset:10240
v_mfma_f32_16x16x32_bf16 v[132:135], v[156:159], a[4:7], 0
s_waitcnt lgkmcnt(5)
v_mfma_f32_16x16x32_bf16 v[136:139], v[160:163], a[0:3], 0
ds_read_b128 v[156:159], v7 offset:11264
v_mfma_f32_16x16x32_bf16 v[140:143], v[160:163], a[4:7], 0
v_mfma_f32_16x16x32_bf16 v[128:131], v[164:167], a[8:11], v[128:131]
ds_read_b128 v[160:163], v7 offset:12288
v_mfma_f32_16x16x32_bf16 v[132:135], v[164:167], a[12:15], v[132:135]
s_waitcnt lgkmcnt(5)
v_cvt_pk_bf16_f32 v104, v104, v105
v_mfma_f32_16x16x32_bf16 v[136:139], v[168:171], a[8:11], v[136:139]
ds_read_b128 v[164:167], v7 offset:13312
v_cvt_pk_bf16_f32 v105, v106, v107
v_mfma_f32_16x16x32_bf16 v[140:143], v[168:171], a[12:15], v[140:143]
v_cvt_pk_bf16_f32 v106, v112, v113
v_mfma_f32_16x16x32_bf16 v[128:131], v[172:175], a[16:19], v[128:131]
s_waitcnt lgkmcnt(4)
ds_read_b128 v[168:171], v7 offset:14336
v_cvt_pk_bf16_f32 v107, v114, v115
v_mfma_f32_16x16x32_bf16 v[132:135], v[172:175], a[20:23], v[132:135]
buffer_store_dwordx4 v[104:107], v4, s[24:27], s54 offen offset:0 sc1
v_mfma_f32_16x16x32_bf16 v[136:139], v[144:147], a[16:19], v[136:139]
ds_read_b128 v[172:175], v7 offset:15360
v_cvt_pk_bf16_f32 v108, v108, v109
v_mfma_f32_16x16x32_bf16 v[140:143], v[144:147], a[20:23], v[140:143]
s_add_u32 s91, s91, 16384
v_cvt_pk_bf16_f32 v109, v110, v111
v_mfma_f32_16x16x32_bf16 v[128:131], v[148:151], a[24:27], v[128:131]
ds_read_b128 v[144:147], v8 offset:0
v_cvt_pk_bf16_f32 v110, v116, v117
v_mfma_f32_16x16x32_bf16 v[132:135], v[148:151], a[28:31], v[132:135]
s_waitcnt lgkmcnt(5)
v_cvt_pk_bf16_f32 v111, v118, v119
v_mfma_f32_16x16x32_bf16 v[136:139], v[152:155], a[24:27], v[136:139]
buffer_store_dwordx4 v[108:111], v4, s[24:27], s54 offen offset:1024 sc1
v_mfma_f32_16x16x32_bf16 v[140:143], v[152:155], a[28:31], v[140:143]
s_cmp_ge_u32 s91, 163840
s_cselect_b32 s91, 0, s91
ds_read_b128 v[148:151], v8 offset:1024
v_mfma_f32_16x16x32_bf16 v[128:131], v[156:159], a[32:35], v[128:131]
s_mov_b32 m0, s70
s_mov_b32 s64, s68
s_add_u32 s68, s68, 16384
v_mfma_f32_16x16x32_bf16 v[132:135], v[156:159], a[36:39], v[132:135]
s_waitcnt lgkmcnt(4)
ds_read_b128 v[152:155], v8 offset:2048
v_add_u32 v7, s91, v4
v_mfma_f32_16x16x32_bf16 v[136:139], v[160:163], a[32:35], v[136:139]
s_cmp_lt_u32 s3, 3
s_cselect_b32 s68, s64, 2147418112
ds_read_b128 v[156:159], v8 offset:3072
v_mfma_f32_16x16x32_bf16 v[140:143], v[160:163], a[36:39], v[140:143]
buffer_load_dwordx4 v4, s[24:27], s64 offen offset:0 sc1 lds
v_mfma_f32_16x16x32_bf16 v[128:131], v[164:167], a[40:43], v[128:131]
ds_read_b128 v[160:163], v8 offset:4096
v_mfma_f32_16x16x32_bf16 v[132:135], v[164:167], a[44:47], v[132:135]
s_waitcnt lgkmcnt(5)
v_mfma_f32_16x16x32_bf16 v[136:139], v[168:171], a[40:43], v[136:139]
buffer_load_dwordx4 v4, s[24:27], s68 offen offset:1024 sc1 lds
v_mfma_f32_16x16x32_bf16 v[140:143], v[168:171], a[44:47], v[140:143]
ds_read_b128 v[164:167], v8 offset:5120
v_mfma_f32_16x16x32_bf16 v[128:131], v[172:175], a[48:51], v[128:131]
s_waitcnt lgkmcnt(4)
ds_read_b128 v[168:171], v8 offset:6144
v_mfma_f32_16x16x32_bf16 v[132:135], v[172:175], a[52:55], v[132:135]
buffer_load_dwordx4 v4, s[24:27], s68 offen offset:2048 sc1 lds
v_mfma_f32_16x16x32_bf16 v[136:139], v[144:147], a[48:51], v[136:139]
ds_read_b128 v[172:175], v8 offset:7168
v_mfma_f32_16x16x32_bf16 v[140:143], v[144:147], a[52:55], v[140:143]
v_mfma_f32_16x16x32_bf16 v[128:131], v[148:151], a[56:59], v[128:131]
buffer_load_dwordx4 v4, s[24:27], s68 offen offset:3072 sc1 lds
v_mfma_f32_16x16x32_bf16 v[132:135], v[148:151], a[60:63], v[132:135]
s_waitcnt lgkmcnt(4)
ds_read_b128 v[144:147], v8 offset:8192
v_mfma_f32_16x16x32_bf16 v[136:139], v[152:155], a[56:59], v[136:139]
ds_read_b128 v[148:151], v8 offset:9216
v_mfma_f32_16x16x32_bf16 v[140:143], v[152:155], a[60:63], v[140:143]
buffer_load_dword v12, v10, s[24:27], s73 offen sc1
v_mfma_f32_16x16x32_bf16 v[128:131], v[156:159], a[64:67], v[128:131]
ds_read_b128 v[152:155], v8 offset:10240
v_mfma_f32_16x16x32_bf16 v[132:135], v[156:159], a[68:71], v[132:135]
s_waitcnt lgkmcnt(5)
v_mfma_f32_16x16x32_bf16 v[136:139], v[160:163], a[64:67], v[136:139]
ds_read_b128 v[156:159], v8 offset:11264
v_mfma_f32_16x16x32_bf16 v[140:143], v[160:163], a[68:71], v[140:143]
v_mfma_f32_16x16x32_bf16 v[128:131], v[164:167], a[72:75], v[128:131]
ds_read_b128 v[160:163], v8 offset:12288
v_mfma_f32_16x16x32_bf16 v[132:135], v[164:167], a[76:79], v[132:135]
s_waitcnt lgkmcnt(5)
v_mfma_f32_16x16x32_bf16 v[136:139], v[168:171], a[72:75], v[136:139]
ds_read_b128 v[164:167], v8 offset:13312
v_mfma_f32_16x16x32_bf16 v[140:143], v[168:171], a[76:79], v[140:143]
v_mfma_f32_16x16x32_bf16 v[128:131], v[172:175], a[80:83], v[128:131]
ds_read_b128 v[168:171], v8 offset:14336
v_mfma_f32_16x16x32_bf16 v[132:135], v[172:175], a[84:87], v[132:135]
s_waitcnt lgkmcnt(5)
v_mfma_f32_16x16x32_bf16 v[136:139], v[144:147], a[80:83], v[136:139]
s_waitcnt vmcnt(8)
ds_read_b128 v[172:175], v8 offset:15360
v_mfma_f32_16x16x32_bf16 v[140:143], v[144:147], a[84:87], v[140:143]
s_barrier
v_mfma_f32_16x16x32_bf16 v[128:131], v[148:151], a[88:91], v[128:131]
s_add_u32 s91, s91, 16384
ds_read_b128 v[144:147], v7 offset:0
v_mfma_f32_16x16x32_bf16 v[132:135], v[148:151], a[92:95], v[132:135]
s_waitcnt lgkmcnt(5)
s_cmp_ge_u32 s91, 163840
s_cselect_b32 s91, 0, s91
v_mfma_f32_16x16x32_bf16 v[136:139], v[152:155], a[88:91], v[136:139]
ds_read_b128 v[148:151], v7 offset:1024
v_add_u32 v8, s91, v4
v_mfma_f32_16x16x32_bf16 v[140:143], v[152:155], a[92:95], v[140:143]
v_mfma_f32_16x16x32_bf16 v[128:131], v[156:159], a[96:99], v[128:131]
ds_read_b128 v[152:155], v7 offset:2048
v_mfma_f32_16x16x32_bf16 v[132:135], v[156:159], a[100:103], v[132:135]
s_waitcnt lgkmcnt(5)
v_mfma_f32_16x16x32_bf16 v[136:139], v[160:163], a[96:99], v[136:139]
ds_read_b128 v[156:159], v7 offset:3072
v_mfma_f32_16x16x32_bf16 v[140:143], v[160:163], a[100:103], v[140:143]
v_mfma_f32_16x16x32_bf16 v[128:131], v[164:167], a[104:107], v[128:131]
ds_read_b128 v[160:163], v7 offset:4096
v_mfma_f32_16x16x32_bf16 v[132:135], v[164:167], a[108:111], v[132:135]
s_waitcnt lgkmcnt(5)
v_mfma_f32_16x16x32_bf16 v[136:139], v[168:171], a[104:107], v[136:139]
s_waitcnt vmcnt(5)
ds_read_b128 v[164:167], v7 offset:5120
v_mfma_f32_16x16x32_bf16 v[140:143], v[168:171], a[108:111], v[140:143]
buffer_atomic_add v1, v0, s[24:27], s73 offen offset:16 sc1
v_mfma_f32_16x16x32_bf16 v[128:131], v[172:175], a[112:115], v[128:131]
ds_read_b128 v[168:171], v7 offset:6144
v_mfma_f32_16x16x32_bf16 v[132:135], v[172:175], a[116:119], v[132:135]
s_waitcnt lgkmcnt(5)
v_mfma_f32_16x16x32_bf16 v[136:139], v[144:147], a[112:115], v[136:139]
ds_read_b128 v[172:175], v7 offset:7168
v_mfma_f32_16x16x32_bf16 v[140:143], v[144:147], a[116:119], v[140:143]
v_mfma_f32_16x16x32_bf16 v[128:131], v[148:151], a[120:123], v[128:131]
ds_read_b128 v[144:147], v7 offset:8192
v_mfma_f32_16x16x32_bf16 v[132:135], v[148:151], a[124:127], v[132:135]
s_waitcnt vmcnt(1) lgkmcnt(5)
v_mfma_f32_16x16x32_bf16 v[136:139], v[152:155], a[120:123], v[136:139]
ds_read_b128 v[148:151], v7 offset:9216
v_cmp_gt_u32 vcc, 4, v12
v_mfma_f32_16x16x32_bf16 v[140:143], v[152:155], a[124:127], v[140:143]
v_mfma_f32_16x16x32_bf16 v[128:131], v[156:159], a[128:131], v[128:131]
ds_read_b128 v[152:155], v7 offset:10240
v_mfma_f32_16x16x32_bf16 v[132:135], v[156:159], a[132:135], v[132:135]
s_waitcnt lgkmcnt(5)
v_mfma_f32_16x16x32_bf16 v[136:139], v[160:163], a[128:131], v[136:139]
ds_read_b128 v[156:159], v7 offset:11264
v_mfma_f32_16x16x32_bf16 v[140:143], v[160:163], a[132:135], v[140:143]
s_cbranch_vccnz CK_P1
CK_P1_R:
v_mfma_f32_16x16x32_bf16 v[128:131], v[164:167], a[136:139], v[128:131]
ds_read_b128 v[160:163], v7 offset:12288
v_mfma_f32_16x16x32_bf16 v[132:135], v[164:167], a[140:143], v[132:135]
s_waitcnt lgkmcnt(5)
v_mfma_f32_16x16x32_bf16 v[136:139], v[168:171], a[136:139], v[136:139]
buffer_load_dwordx4 v[176:179], v4, s[24:27], s69 offen offset:0 sc1
v_mfma_f32_16x16x32_bf16 v[140:143], v[168:171], a[140:143], v[140:143]
ds_read_b128 v[164:167], v7 offset:13312
v_mfma_f32_16x16x32_bf16 v[128:131], v[172:175], a[144:147], v[128:131]
s_waitcnt lgkmcnt(4)
ds_read_b128 v[168:171], v7 offset:14336
v_mfma_f32_16x16x32_bf16 v[132:135], v[172:175], a[148:151], v[132:135]
buffer_load_dwordx4 v[180:183], v4, s[24:27], s69 offen offset:1024 sc1
v_mfma_f32_16x16x32_bf16 v[136:139], v[144:147], a[144:147], v[136:139]
ds_read_b128 v[172:175], v7 offset:15360
v_mfma_f32_16x16x32_bf16 v[140:143], v[144:147], a[148:151], v[140:143]
s_add_u32 s91, s91, 16384
s_cmp_ge_u32 s91, 163840
s_cselect_b32 s91, 0, s91
v_mfma_f32_16x16x32_bf16 v[128:131], v[148:151], a[152:155], v[128:131]
buffer_load_dwordx4 v[184:187], v4, s[24:27], s69 offen offset:2048 sc1
v_mfma_f32_16x16x32_bf16 v[132:135], v[148:151], a[156:159], v[132:135]
s_waitcnt lgkmcnt(4)
ds_read_b128 v[144:147], v8 offset:0
v_add_u32 v7, s91, v4
v_mfma_f32_16x16x32_bf16 v[136:139], v[152:155], a[152:155], v[136:139]
ds_read_b128 v[148:151], v8 offset:1024
v_mfma_f32_16x16x32_bf16 v[140:143], v[152:155], a[156:159], v[140:143]
buffer_load_dwordx4 v[188:191], v4, s[24:27], s69 offen offset:3072 sc1
v_mfma_f32_16x16x32_bf16 v[128:131], v[156:159], a[160:163], v[128:131]
ds_read_b128 v[152:155], v8 offset:2048
v_mfma_f32_16x16x32_bf16 v[132:135], v[156:159], a[164:167], v[132:135]
s_waitcnt lgkmcnt(5)
v_mfma_f32_16x16x32_bf16 v[136:139], v[160:163], a[160:163], v[136:139]
buffer_load_dwordx4 v[192:195], v4, s[24:27], s71 offen offset:0 sc1
v_mfma_f32_16x16x32_bf16 v[140:143], v[160:163], a[164:167], v[140:143]
ds_read_b128 v[156:159], v8 offset:3072
v_mfma_f32_16x16x32_bf16 v[128:131], v[164:167], a[168:171], v[128:131]
s_waitcnt lgkmcnt(4)
ds_read_b128 v[160:163], v8 offset:4096
v_mfma_f32_16x16x32_bf16 v[132:135], v[164:167], a[172:175], v[132:135]
buffer_load_dwordx4 v[196:199], v4, s[24:27], s71 offen offset:1024 sc1
v_mfma_f32_16x16x32_bf16 v[136:139], v[168:171], a[168:171], v[136:139]
ds_read_b128 v[164:167], v8 offset:5120
v_mfma_f32_16x16x32_bf16 v[140:143], v[168:171], a[172:175], v[140:143]
v_mfma_f32_16x16x32_bf16 v[128:131], v[172:175], a[176:179], v[128:131]
buffer_load_dwordx4 v[200:203], v4, s[24:27], s71 offen offset:2048 sc1
v_mfma_f32_16x16x32_bf16 v[132:135], v[172:175], a[180:183], v[132:135]
s_waitcnt lgkmcnt(4)
ds_read_b128 v[168:171], v8 offset:6144
v_mfma_f32_16x16x32_bf16 v[136:139], v[144:147], a[176:179], v[136:139]
ds_read_b128 v[172:175], v8 offset:7168
v_mfma_f32_16x16x32_bf16 v[140:143], v[144:147], a[180:183], v[140:143]
v_mfma_f32_16x16x32_bf16 v[128:131], v[148:151], a[184:187], v[128:131]
ds_read_b128 v[144:147], v8 offset:8192
v_mfma_f32_16x16x32_bf16 v[132:135], v[148:151], a[188:191], v[132:135]
s_waitcnt lgkmcnt(5)
v_mfma_f32_16x16x32_bf16 v[136:139], v[152:155], a[184:187], v[136:139]
ds_read_b128 v[148:151], v8 offset:9216
v_mfma_f32_16x16x32_bf16 v[140:143], v[152:155], a[188:191], v[140:143]
v_mfma_f32_16x16x32_bf16 v[128:131], v[156:159], a[192:195], v[128:131]
ds_read_b128 v[152:155], v8 offset:10240
v_mfma_f32_16x16x32_bf16 v[132:135], v[156:159], a[196:199], v[132:135]
s_waitcnt lgkmcnt(5)
v_mfma_f32_16x16x32_bf16 v[136:139], v[160:163], a[192:195], v[136:139]
ds_read_b128 v[156:159], v8 offset:11264
v_mfma_f32_16x16x32_bf16 v[140:143], v[160:163], a[196:199], v[140:143]
v_mfma_f32_16x16x32_bf16 v[128:131], v[164:167], a[200:203], v[128:131]
ds_read_b128 v[160:163], v8 offset:12288
v_mfma_f32_16x16x32_bf16 v[132:135], v[164:167], a[204:207], v[132:135]
s_waitcnt lgkmcnt(5)
v_mfma_f32_16x16x32_bf16 v[136:139], v[168:171], a[200:203], v[136:139]
ds_read_b128 v[164:167], v8 offset:13312
v_mfma_f32_16x16x32_bf16 v[140:143], v[168:171], a[204:207], v[140:143]
v_mfma_f32_16x16x32_bf16 v[128:131], v[172:175], a[208:211], v[128:131]
ds_read_b128 v[168:171], v8 offset:14336
v_mfma_f32_16x16x32_bf16 v[132:135], v[172:175], a[212:215], v[132:135]
s_waitcnt lgkmcnt(5)
v_mfma_f32_16x16x32_bf16 v[136:139], v[144:147], a[208:211], v[136:139]
s_waitcnt vmcnt(9)
ds_read_b128 v[172:175], v8 offset:15360
v_mfma_f32_16x16x32_bf16 v[140:143], v[144:147], a[212:215], v[140:143]
s_barrier
v_mfma_f32_16x16x32_bf16 v[128:131], v[148:151], a[216:219], v[128:131]
ds_read_b128 v[144:147], v7 offset:0
v_mfma_f32_16x16x32_bf16 v[132:135], v[148:151], a[220:223], v[132:135]
s_waitcnt lgkmcnt(5)
v_mfma_f32_16x16x32_bf16 v[136:139], v[152:155], a[216:219], v[136:139]
ds_read_b128 v[148:151], v7 offset:1024
v_mfma_f32_16x16x32_bf16 v[140:143], v[152:155], a[220:223], v[140:143]
v_mfma_f32_16x16x32_bf16 v[128:131], v[156:159], a[224:227], v[128:131]
ds_read_b128 v[152:155], v7 offset:2048
v_mfma_f32_16x16x32_bf16 v[132:135], v[156:159], a[228:231], v[132:135]
s_waitcnt lgkmcnt(5)
v_mfma_f32_16x16x32_bf16 v[136:139], v[160:163], a[224:227], v[136:139]
ds_read_b128 v[156:159], v7 offset:3072
v_mfma_f32_16x16x32_bf16 v[140:143], v[160:163], a[228:231], v[140:143]
v_mfma_f32_16x16x32_bf16 v[128:131], v[164:167], a[232:235], v[128:131]
ds_read_b128 v[160:163], v7 offset:4096
v_mfma_f32_16x16x32_bf16 v[132:135], v[164:167], a[236:239], v[132:135]
s_waitcnt lgkmcnt(5)
v_mfma_f32_16x16x32_bf16 v[136:139], v[168:171], a[232:235], v[136:139]
ds_read_b128 v[164:167], v7 offset:5120
v_mfma_f32_16x16x32_bf16 v[140:143], v[168:171], a[236:239], v[140:143]
v_mfma_f32_16x16x32_bf16 v[128:131], v[172:175], a[240:243], v[128:131]
ds_read_b128 v[168:171], v7 offset:6144
v_mfma_f32_16x16x32_bf16 v[132:135], v[172:175], a[244:247], v[132:135]
s_waitcnt lgkmcnt(5)
v_mfma_f32_16x16x32_bf16 v[136:139], v[144:147], a[240:243], v[136:139]
ds_read_b128 v[172:175], v7 offset:7168
v_mfma_f32_16x16x32_bf16 v[140:143], v[144:147], a[244:247], v[140:143]
v_mfma_f32_16x16x32_bf16 v[128:131], v[148:151], a[248:251], v[128:131]
ds_read_b128 v[144:147], v7 offset:8192
v_mfma_f32_16x16x32_bf16 v[132:135], v[148:151], a[252:255], v[132:135]
s_waitcnt lgkmcnt(5)
v_mfma_f32_16x16x32_bf16 v[136:139], v[152:155], a[248:251], v[136:139]
ds_read_b128 v[148:151], v7 offset:9216
v_mfma_f32_16x16x32_bf16 v[140:143], v[152:155], a[252:255], v[140:143]
v_mfma_f32_16x16x32_bf16 v[128:131], v[156:159], v[32:35], v[128:131]
buffer_load_dword v12, v10, s[24:27], s73 offen offset:16 sc1
v_mfma_f32_16x16x32_bf16 v[132:135], v[156:159], v[36:39], v[132:135]
s_waitcnt lgkmcnt(4)
ds_read_b128 v[152:155], v7 offset:10240
v_mfma_f32_16x16x32_bf16 v[136:139], v[160:163], v[32:35], v[136:139]
ds_read_b128 v[156:159], v7 offset:11264
v_mfma_f32_16x16x32_bf16 v[140:143], v[160:163], v[36:39], v[140:143]
v_mfma_f32_16x16x32_bf16 v[128:131], v[164:167], v[40:43], v[128:131]
ds_read_b128 v[160:163], v7 offset:12288
v_mfma_f32_16x16x32_bf16 v[132:135], v[164:167], v[44:47], v[132:135]
s_waitcnt lgkmcnt(5)
v_mfma_f32_16x16x32_bf16 v[136:139], v[168:171], v[40:43], v[136:139]
v_mfma_f32_16x16x32_bf16 v[140:143], v[168:171], v[44:47], v[140:143]
v_mfma_f32_16x16x32_bf16 v[128:131], v[172:175], v[48:51], v[128:131]
v_mfma_f32_16x16x32_bf16 v[132:135], v[172:175], v[52:55], v[132:135]
s_waitcnt lgkmcnt(3)
v_mfma_f32_16x16x32_bf16 v[136:139], v[144:147], v[48:51], v[136:139]
v_mfma_f32_16x16x32_bf16 v[140:143], v[144:147], v[52:55], v[140:143]
v_mfma_f32_16x16x32_bf16 v[128:131], v[148:151], v[56:59], v[128:131]
v_mfma_f32_16x16x32_bf16 v[132:135], v[148:151], v[60:63], v[132:135]
s_waitcnt lgkmcnt(1)
v_mfma_f32_16x16x32_bf16 v[136:139], v[152:155], v[56:59], v[136:139]
v_mfma_f32_16x16x32_bf16 v[140:143], v[152:155], v[60:63], v[140:143]
v_mfma_f32_16x16x32_bf16 v[128:131], v[156:159], v[64:67], v[128:131]
v_mfma_f32_16x16x32_bf16 v[132:135], v[156:159], v[68:71], v[132:135]
s_waitcnt lgkmcnt(0)
v_mfma_f32_16x16x32_bf16 v[136:139], v[160:163], v[64:67], v[136:139]
v_mfma_f32_16x16x32_bf16 v[140:143], v[160:163], v[68:71], v[140:143]
s_waitcnt vmcnt(0)
v_cmp_gt_u32 vcc, 4, v12
s_nop 4
s_cbranch_vccnz CK_P2
CK_P2_R:
buffer_load_dwordx4 v[204:207], v4, s[24:27], s83 offen offset:0 sc1
buffer_load_dwordx4 v[208:211], v4, s[24:27], s83 offen offset:1024 sc1
s_and_b32 s54, s3, 1
s_mul_i32 s54, s54, 18432
s_mul_i32 s55, s86, 288
s_add_u32 s54, s54, s55
s_add_u32 s54, s54, 256
s_sub_u32 s55, 63, s72
s_mul_i32 s55, s55, 36864
s_add_u32 s55, s55, s54
s_mul_i32 s52, s72, 36864
s_add_u32 s54, s54, s52
s_lshl_b32 s53, s84, 6
s_sub_u32 s53, s53, 256
s_add_u32 s52, s54, s53
s_add_u32 s53, s55, s53
v_lshlrev_b32 v16, 16, v176
v_and_b32 v17, v13, v176
v_lshlrev_b32 v18, 16, v177
v_and_b32 v19, v13, v177
v_lshlrev_b32 v20, 16, v178
v_and_b32 v21, v13, v178
v_lshlrev_b32 v22, 16, v179
v_and_b32 v23, v13, v179
v_pk_add_f32 v[128:129], v[128:129], v[16:17]
v_pk_add_f32 v[130:131], v[130:131], v[18:19]
v_pk_add_f32 v[136:137], v[136:137], v[20:21]
v_pk_add_f32 v[138:139], v[138:139], v[22:23]
v_lshlrev_b32 v16, 16, v180
v_and_b32 v17, v13, v180
v_lshlrev_b32 v18, 16, v181
v_and_b32 v19, v13, v181
v_lshlrev_b32 v20, 16, v182
v_and_b32 v21, v13, v182
v_lshlrev_b32 v22, 16, v183
v_and_b32 v23, v13, v183
v_pk_add_f32 v[132:133], v[132:133], v[16:17]
v_pk_add_f32 v[134:135], v[134:135], v[18:19]
v_pk_add_f32 v[140:141], v[140:141], v[20:21]
v_pk_add_f32 v[142:143], v[142:143], v[22:23]
v_lshlrev_b32 v16, 16, v184
v_and_b32 v17, v13, v184
v_lshlrev_b32 v18, 16, v185
v_and_b32 v19, v13, v185
v_lshlrev_b32 v20, 16, v186
v_and_b32 v21, v13, v186
v_lshlrev_b32 v22, 16, v187
v_and_b32 v23, v13, v187
v_pk_add_f32 v[128:129], v[128:129], v[16:17]
v_pk_add_f32 v[130:131], v[130:131], v[18:19]
v_pk_add_f32 v[136:137], v[136:137], v[20:21]
v_pk_add_f32 v[138:139], v[138:139], v[22:23]
v_lshlrev_b32 v16, 16, v188
v_and_b32 v17, v13, v188
v_lshlrev_b32 v18, 16, v189
v_and_b32 v19, v13, v189
v_lshlrev_b32 v20, 16, v190
v_and_b32 v21, v13, v190
v_lshlrev_b32 v22, 16, v191
v_and_b32 v23, v13, v191
v_pk_add_f32 v[132:133], v[132:133], v[16:17]
v_pk_add_f32 v[134:135], v[134:135], v[18:19]
v_pk_add_f32 v[140:141], v[140:141], v[20:21]
L_PAD13:
s_cbranch_execz L_MAIN
v_pk_add_f32 v[142:143], v[142:143], v[22:23]
s_cmp_lg_u32 s3, s84
s_cbranch_scc1 L_NO9
v_lshlrev_b32 v16, 16, v192
v_and_b32 v17, v13, v192
v_lshlrev_b32 v18, 16, v193
v_and_b32 v19, v13, v193
v_lshlrev_b32 v20, 16, v194
v_and_b32 v21, v13, v194
v_lshlrev_b32 v22, 16, v195
v_and_b32 v23, v13, v195
v_pk_add_f32 v[120:121], v[120:121], v[16:17]
v_pk_add_f32 v[122:123], v[122:123], v[18:19]
v_pk_add_f32 v[124:125], v[124:125], v[20:21]
v_pk_add_f32 v[126:127], v[126:127], v[22:23]
v_lshlrev_b32 v16, 16, v196
v_and_b32 v17, v13, v196
v_lshlrev_b32 v18, 16, v197
v_and_b32 v19, v13, v197
v_lshlrev_b32 v20, 16, v198
v_and_b32 v21, v13, v198
v_lshlrev_b32 v22, 16, v199
v_and_b32 v23, v13, v199
v_pk_add_f32 v[120:121], v[120:121], v[16:17]
v_pk_add_f32 v[122:123], v[122:123], v[18:19]
v_pk_add_f32 v[124:125], v[124:125], v[20:21]
v_pk_add_f32 v[126:127], v[126:127], v[22:23]
v_lshlrev_b32 v16, 16, v200
v_and_b32 v17, v13, v200
v_lshlrev_b32 v18, 16, v201
v_and_b32 v19, v13, v201
v_lshlrev_b32 v20, 16, v202
v_and_b32 v21, v13, v202
v_lshlrev_b32 v22, 16, v203
v_and_b32 v23, v13, v203
v_pk_add_f32 v[120:121], v[120:121], v[16:17]
v_pk_add_f32 v[122:123], v[122:123], v[18:19]
v_pk_add_f32 v[124:125], v[124:125], v[20:21]
v_pk_add_f32 v[126:127], v[126:127], v[22:23]
v_cvt_pk_bf16_f32 v228, v120, v121
v_cvt_pk_bf16_f32 v229, v122, v123
v_cvt_pk_bf16_f32 v230, v124, v125
v_cvt_pk_bf16_f32 v231, v126, v127
s_waitcnt vmcnt(0)
buffer_store_dwordx2 v[228:229], v6, s[44:47], s54 offen sc1
buffer_store_dwordx2 v[230:231], v6, s[44:47], s55 offen sc1
s_branch L_9D
L_NO9:
s_waitcnt vmcnt(0)
L_9D:
v_lshlrev_b32 v16, 16, v204
v_and_b32 v17, v13, v204
v_lshlrev_b32 v18, 16, v205
v_and_b32 v19, v13, v205
v_lshlrev_b32 v20, 16, v206
v_and_b32 v21, v13, v206
v_lshlrev_b32 v22, 16, v207
v_and_b32 v23, v13, v207
v_pk_add_f32 v[128:129], v[128:129], v[16:17]
v_pk_add_f32 v[130:131], v[130:131], v[18:19]
v_pk_add_f32 v[136:137], v[136:137], v[20:21]
v_pk_add_f32 v[138:139], v[138:139], v[22:23]
v_cvt_pk_bf16_f32 v128, v128, v129
v_cvt_pk_bf16_f32 v129, v130, v131
v_cvt_pk_bf16_f32 v130, v136, v137
v_cvt_pk_bf16_f32 v131, v138, v139
s_nop 1
v_permlane16_swap_b32 v128, v130
v_permlane16_swap_b32 v129, v131
buffer_store_dwordx4 v[128:131], v5, s[44:47], s52 offen sc1
v_lshlrev_b32 v16, 16, v208
v_and_b32 v17, v13, v208
v_lshlrev_b32 v18, 16, v209
v_and_b32 v19, v13, v209
v_lshlrev_b32 v20, 16, v210
v_and_b32 v21, v13, v210
v_lshlrev_b32 v22, 16, v211
v_and_b32 v23, v13, v211
v_pk_add_f32 v[132:133], v[132:133], v[16:17]
v_pk_add_f32 v[134:135], v[134:135], v[18:19]
v_pk_add_f32 v[140:141], v[140:141], v[20:21]
v_pk_add_f32 v[142:143], v[142:143], v[22:23]
v_cvt_pk_bf16_f32 v132, v132, v133
v_cvt_pk_bf16_f32 v133, v134, v135
v_cvt_pk_bf16_f32 v134, v140, v141
v_cvt_pk_bf16_f32 v135, v142, v143
s_nop 1
v_permlane16_swap_b32 v132, v134
v_permlane16_swap_b32 v133, v135
buffer_store_dwordx4 v[132:135], v5, s[44:47], s53 offen sc1
L_END:
s_endpgm
L_SE2:
v_accvgpr_read_b32 v72, a224
v_accvgpr_read_b32 v74, a228
v_cmp_nle_f32 vcc, v72, v7
v_cmp_nle_f32 s[96:97], v74, v7
s_nop 3
s_or_b64 vcc, vcc, s[96:97]
s_cbranch_vccnz SLOW0
SLOW0_R:
v_mul_f32 v8, 0x3fb8aa3b, v8
v_mul_f32 v9, 0x3fb8aa3b, v9
v_exp_f32 v8, v8
v_exp_f32 v9, v9
s_nop 0
v_fma_f32 v72, v72, v8, v72
v_fma_f32 v74, v74, v9, v74
v_rcp_f32 v72, v72
v_rcp_f32 v74, v74
s_add_u32 s52, s78, 4096
v_mov_b32 v73, v72
v_mov_b32 v75, v74
v_accvgpr_read_b32 v16, a0
v_accvgpr_read_b32 v17, a1
v_accvgpr_read_b32 v18, a2
v_accvgpr_read_b32 v19, a3
v_accvgpr_read_b32 v20, a4
v_accvgpr_read_b32 v21, a5
v_accvgpr_read_b32 v22, a6
v_accvgpr_read_b32 v23, a7
v_pk_mul_f32 v[16:17], v[16:17], v[72:73]
v_pk_mul_f32 v[18:19], v[18:19], v[72:73]
v_pk_mul_f32 v[20:21], v[20:21], v[72:73]
v_pk_mul_f32 v[22:23], v[22:23], v[72:73]
v_cvt_pk_bf16_f32 v16, v16, v17
v_cvt_pk_bf16_f32 v17, v18, v19
v_cvt_pk_bf16_f32 v18, v20, v21
v_cvt_pk_bf16_f32 v19, v22, v23
buffer_store_dwordx4 v[16:19], v4, s[24:27], s78 offen offset:0 sc1
v_accvgpr_read_b32 v24, a32
v_accvgpr_read_b32 v25, a33
v_accvgpr_read_b32 v26, a34
v_accvgpr_read_b32 v27, a35
v_accvgpr_read_b32 v28, a36
v_accvgpr_read_b32 v29, a37
v_accvgpr_read_b32 v30, a38
v_accvgpr_read_b32 v31, a39
v_pk_mul_f32 v[24:25], v[24:25], v[74:75]
v_pk_mul_f32 v[26:27], v[26:27], v[74:75]
v_pk_mul_f32 v[28:29], v[28:29], v[74:75]
v_pk_mul_f32 v[30:31], v[30:31], v[74:75]
v_cvt_pk_bf16_f32 v24, v24, v25
v_cvt_pk_bf16_f32 v25, v26, v27
v_cvt_pk_bf16_f32 v26, v28, v29
v_cvt_pk_bf16_f32 v27, v30, v31
buffer_store_dwordx4 v[24:27], v4, s[24:27], s78 offen offset:1024 sc1
v_accvgpr_read_b32 v16, a8
v_accvgpr_read_b32 v17, a9
v_accvgpr_read_b32 v18, a10
v_accvgpr_read_b32 v19, a11
v_accvgpr_read_b32 v20, a12
v_accvgpr_read_b32 v21, a13
v_accvgpr_read_b32 v22, a14
v_accvgpr_read_b32 v23, a15
v_pk_mul_f32 v[16:17], v[16:17], v[72:73]
v_pk_mul_f32 v[18:19], v[18:19], v[72:73]
v_pk_mul_f32 v[20:21], v[20:21], v[72:73]
v_pk_mul_f32 v[22:23], v[22:23], v[72:73]
v_cvt_pk_bf16_f32 v16, v16, v17
v_cvt_pk_bf16_f32 v17, v18, v19
v_cvt_pk_bf16_f32 v18, v20, v21
v_cvt_pk_bf16_f32 v19, v22, v23
buffer_store_dwordx4 v[16:19], v4, s[24:27], s78 offen offset:2048 sc1
v_accvgpr_read_b32 v24, a40
v_accvgpr_read_b32 v25, a41
v_accvgpr_read_b32 v26, a42
v_accvgpr_read_b32 v27, a43
v_accvgpr_read_b32 v28, a44
v_accvgpr_read_b32 v29, a45
v_accvgpr_read_b32 v30, a46
v_accvgpr_read_b32 v31, a47
v_pk_mul_f32 v[24:25], v[24:25], v[74:75]
v_pk_mul_f32 v[26:27], v[26:27], v[74:75]
v_pk_mul_f32 v[28:29], v[28:29], v[74:75]
v_pk_mul_f32 v[30:31], v[30:31], v[74:75]
v_cvt_pk_bf16_f32 v24, v24, v25
v_cvt_pk_bf16_f32 v25, v26, v27
v_cvt_pk_bf16_f32 v26, v28, v29
v_cvt_pk_bf16_f32 v27, v30, v31
buffer_store_dwordx4 v[24:27], v4, s[24:27], s78 offen offset:3072 sc1
v_accvgpr_read_b32 v16, a16
v_accvgpr_read_b32 v17, a17
v_accvgpr_read_b32 v18, a18
v_accvgpr_read_b32 v19, a19
v_accvgpr_read_b32 v20, a20
v_accvgpr_read_b32 v21, a21
v_accvgpr_read_b32 v22, a22
v_accvgpr_read_b32 v23, a23
v_pk_mul_f32 v[16:17], v[16:17], v[72:73]
v_pk_mul_f32 v[18:19], v[18:19], v[72:73]
v_pk_mul_f32 v[20:21], v[20:21], v[72:73]
v_pk_mul_f32 v[22:23], v[22:23], v[72:73]
v_cvt_pk_bf16_f32 v16, v16, v17
v_cvt_pk_bf16_f32 v17, v18, v19
v_cvt_pk_bf16_f32 v18, v20, v21
v_cvt_pk_bf16_f32 v19, v22, v23
buffer_store_dwordx4 v[16:19], v4, s[24:27], s52 offen offset:0 sc1
v_accvgpr_read_b32 v24, a48
v_accvgpr_read_b32 v25, a49
v_accvgpr_read_b32 v26, a50
v_accvgpr_read_b32 v27, a51
v_accvgpr_read_b32 v28, a52
v_accvgpr_read_b32 v29, a53
v_accvgpr_read_b32 v30, a54
v_accvgpr_read_b32 v31, a55
v_pk_mul_f32 v[24:25], v[24:25], v[74:75]
v_pk_mul_f32 v[26:27], v[26:27], v[74:75]
v_pk_mul_f32 v[28:29], v[28:29], v[74:75]
v_pk_mul_f32 v[30:31], v[30:31], v[74:75]
v_cvt_pk_bf16_f32 v24, v24, v25
v_cvt_pk_bf16_f32 v25, v26, v27
v_cvt_pk_bf16_f32 v26, v28, v29
v_cvt_pk_bf16_f32 v27, v30, v31
buffer_store_dwordx4 v[24:27], v4, s[24:27], s52 offen offset:1024 sc1
v_accvgpr_read_b32 v16, a24
v_accvgpr_read_b32 v17, a25
v_accvgpr_read_b32 v18, a26
v_accvgpr_read_b32 v19, a27
v_accvgpr_read_b32 v20, a28
v_accvgpr_read_b32 v21, a29
v_accvgpr_read_b32 v22, a30
v_accvgpr_read_b32 v23, a31
v_pk_mul_f32 v[16:17], v[16:17], v[72:73]
v_pk_mul_f32 v[18:19], v[18:19], v[72:73]
v_pk_mul_f32 v[20:21], v[20:21], v[72:73]
v_pk_mul_f32 v[22:23], v[22:23], v[72:73]
v_cvt_pk_bf16_f32 v16, v16, v17
v_cvt_pk_bf16_f32 v17, v18, v19
v_cvt_pk_bf16_f32 v18, v20, v21
v_cvt_pk_bf16_f32 v19, v22, v23
buffer_store_dwordx4 v[16:19], v4, s[24:27], s52 offen offset:2048 sc1
v_accvgpr_read_b32 v24, a56
v_accvgpr_read_b32 v25, a57
v_accvgpr_read_b32 v26, a58
v_accvgpr_read_b32 v27, a59
v_accvgpr_read_b32 v28, a60
v_accvgpr_read_b32 v29, a61
v_accvgpr_read_b32 v30, a62
v_accvgpr_read_b32 v31, a63
v_pk_mul_f32 v[24:25], v[24:25], v[74:75]
v_pk_mul_f32 v[26:27], v[26:27], v[74:75]
v_pk_mul_f32 v[28:29], v[28:29], v[74:75]
v_pk_mul_f32 v[30:31], v[30:31], v[74:75]
v_cvt_pk_bf16_f32 v24, v24, v25
v_cvt_pk_bf16_f32 v25, v26, v27
v_cvt_pk_bf16_f32 v26, v28, v29
v_cvt_pk_bf16_f32 v27, v30, v31
buffer_store_dwordx4 v[24:27], v4, s[24:27], s52 offen offset:3072 sc1
s_branch L_LA
CK_Z:
s_mov_b32 s92, 0
CK_Z_L:
s_sleep 1
buffer_load_dword v23, v22, s[40:43], 0 offen sc1
s_add_u32 s92, s92, 1
s_waitcnt vmcnt(0)
v_cmp_gt_u32 vcc, 1, v23
s_cmp_gt_u32 s92, 0x20000
s_cbranch_scc1 CK_Z_R
s_nop 3
s_cbranch_vccnz CK_Z_L
s_branch CK_Z_R
CK_WA:
s_mov_b32 s92, 0
CK_WA_L:
s_sleep 1
buffer_load_dword v30, v29, s[24:27], s89 offen sc1
s_add_u32 s92, s92, 1
s_waitcnt vmcnt(0)
v_cmp_gt_u32 vcc, 18, v30
s_cmp_gt_u32 s92, 0x20000
s_cbranch_scc1 CK_WA_R
s_nop 3
s_cbranch_vccnz CK_WA_L
s_branch CK_WA_R
CK_ZA:
s_mov_b32 s92, 0
CK_ZA_L:
s_sleep 1
buffer_load_dword v30, v28, s[40:43], 0 offen sc1
s_add_u32 s92, s92, 1
s_waitcnt vmcnt(0)
v_cmp_gt_u32 vcc, 1, v30
s_cmp_gt_u32 s92, 0x20000
s_cbranch_scc1 CK_ZA_R
s_nop 3
s_cbranch_vccnz CK_ZA_L
s_branch CK_ZA_R
CK_KV:
s_mov_b32 s92, 0
CK_KV_L:
s_sleep 1
buffer_load_dword v30, v29, s[24:27], s89 offen offset:4 sc1
s_add_u32 s92, s92, 1
s_waitcnt vmcnt(0)
v_cmp_gt_u32 vcc, 8, v30
s_cmp_gt_u32 s92, 0x20000
s_cbranch_scc1 CK_KV_R
s_nop 3
s_cbranch_vccnz CK_KV_L
s_branch CK_KV_R
D0:
v_cndmask_b32 v216, v216, v6, s[56:57]
v_cndmask_b32 v112, v112, v6, s[56:57]
v_mov_b32 v104, v6
v_cndmask_b32 v217, v217, v6, s[58:59]
v_cndmask_b32 v113, v113, v6, s[58:59]
v_mov_b32 v105, v6
v_cndmask_b32 v218, v218, v6, s[60:61]
v_cndmask_b32 v114, v114, v6, s[60:61]
v_mov_b32 v106, v6
v_cndmask_b32 v219, v219, v6, s[62:63]
v_cndmask_b32 v115, v115, v6, s[62:63]
v_mov_b32 v107, v6
s_branch D0_R
CK_Q:
s_mov_b32 s92, 0
CK_Q_L:
s_sleep 1
buffer_load_dword v168, v169, s[24:27], 0 offen sc1
s_add_u32 s92, s92, 1
s_waitcnt vmcnt(0)
v_cmp_gt_u32 vcc, 32, v168
s_cmp_gt_u32 s92, 0x20000
s_cbranch_scc1 CK_Q_R
s_nop 3
s_cbranch_vccnz CK_Q_L
s_branch CK_Q_R
CK_ZAA:
s_mov_b32 s92, 0
CK_ZAA_L:
s_sleep 1
buffer_load_dword v12, v10, s[24:27], s75 offen offset:4 sc1
s_add_u32 s92, s92, 1
s_waitcnt vmcnt(0)
v_cmp_gt_u32 vcc, 8, v12
s_cmp_gt_u32 s92, 0x20000
s_cbranch_scc1 CK_ZAA_R
s_nop 3
s_cbranch_vccnz CK_ZAA_L
s_branch CK_ZAA_R
CK_P1:
s_mov_b32 s92, 0
CK_P1_L:
s_sleep 1
buffer_load_dword v12, v10, s[24:27], s73 offen sc1
s_add_u32 s92, s92, 1
s_waitcnt vmcnt(0)
v_cmp_gt_u32 vcc, 4, v12
s_cmp_gt_u32 s92, 0x20000
s_cbranch_scc1 CK_P1_R
s_nop 3
s_cbranch_vccnz CK_P1_L
s_branch CK_P1_R
CK_P2:
s_mov_b32 s92, 0
CK_P2_L:
s_sleep 1
buffer_load_dword v12, v10, s[24:27], s73 offen offset:16 sc1
s_add_u32 s92, s92, 1
s_waitcnt vmcnt(0)
v_cmp_gt_u32 vcc, 4, v12
s_cmp_gt_u32 s92, 0x20000
s_cbranch_scc1 CK_P2_R
s_nop 3
s_cbranch_vccnz CK_P2_L
s_branch CK_P2_R
SLOW0:
v_add_u32 v20, 4096, v4
s_mov_b32 s54, 0
v_mov_b32 v16, v6
v_mov_b32 v18, v6
SLOW0_P:
s_mov_b32 s53, 0
s_mov_b32 s52, s94
SLOW0_T:
s_add_u32 s55, s52, 24576
buffer_load_dwordx4 a[192:195], v4, s[24:27], s52 offen offset:0 sc1
buffer_load_dwordx4 a[196:199], v4, s[24:27], s52 offen offset:1024 sc1
buffer_load_dwordx4 a[200:203], v4, s[24:27], s52 offen offset:2048 sc1
buffer_load_dwordx4 a[204:207], v4, s[24:27], s52 offen offset:3072 sc1
buffer_load_dwordx4 a[208:211], v20, s[24:27], s52 offen offset:0 sc1
buffer_load_dwordx4 a[212:215], v20, s[24:27], s52 offen offset:1024 sc1
buffer_load_dwordx4 a[216:219], v20, s[24:27], s52 offen offset:2048 sc1
buffer_load_dwordx4 a[220:223], v20, s[24:27], s52 offen offset:3072 sc1
buffer_load_dwordx4 a[64:67], v4, s[24:27], s55 offen offset:0 sc1
buffer_load_dwordx4 a[68:71], v4, s[24:27], s55 offen offset:1024 sc1
buffer_load_dwordx4 a[72:75], v4, s[24:27], s55 offen offset:2048 sc1
buffer_load_dwordx4 a[76:79], v4, s[24:27], s55 offen offset:3072 sc1
buffer_load_dwordx4 a[80:83], v20, s[24:27], s55 offen offset:0 sc1
buffer_load_dwordx4 a[84:87], v20, s[24:27], s55 offen offset:1024 sc1
buffer_load_dwordx4 a[88:91], v20, s[24:27], s55 offen offset:2048 sc1
buffer_load_dwordx4 a[92:95], v20, s[24:27], s55 offen offset:3072 sc1
s_waitcnt vmcnt(0)
v_mfma_f32_16x16x32_bf16 v[236:239], a[192:195], v[64:67], 0
v_mfma_f32_16x16x32_bf16 v[236:239], a[196:199], v[244:247], v[236:239]
v_mfma_f32_16x16x32_bf16 v[236:239], a[200:203], v[240:243], v[236:239]
v_mfma_f32_16x16x32_bf16 v[236:239], a[204:207], v[44:47], v[236:239]
v_mfma_f32_16x16x32_bf16 v[248:251], a[192:195], v[204:207], 0
v_mfma_f32_16x16x32_bf16 v[248:251], a[196:199], v[252:255], v[248:251]
v_mfma_f32_16x16x32_bf16 v[248:251], a[200:203], v[232:235], v[248:251]
v_mfma_f32_16x16x32_bf16 v[248:251], a[204:207], v[32:35], v[248:251]
v_mfma_f32_16x16x32_bf16 v[36:39], a[208:211], v[64:67], 0
v_mfma_f32_16x16x32_bf16 v[36:39], a[212:215], v[244:247], v[36:39]
v_mfma_f32_16x16x32_bf16 v[36:39], a[216:219], v[240:243], v[36:39]
v_mfma_f32_16x16x32_bf16 v[36:39], a[220:223], v[44:47], v[36:39]
v_mfma_f32_16x16x32_bf16 v[92:95], a[208:211], v[204:207], 0
v_mfma_f32_16x16x32_bf16 v[92:95], a[212:215], v[252:255], v[92:95]
v_mfma_f32_16x16x32_bf16 v[92:95], a[216:219], v[232:235], v[92:95]
v_mfma_f32_16x16x32_bf16 v[92:95], a[220:223], v[32:35], v[92:95]
s_nop 7
s_cmp_lg_u32 s53, s66
s_cbranch_scc1 SLOW0_U
v_cndmask_b32 v236, v236, v6, s[56:57]
v_cndmask_b32 v92, v92, v6, s[56:57]
v_mov_b32 v36, v6
v_cndmask_b32 v237, v237, v6, s[58:59]
v_cndmask_b32 v93, v93, v6, s[58:59]
v_mov_b32 v37, v6
v_cndmask_b32 v238, v238, v6, s[60:61]
v_cndmask_b32 v94, v94, v6, s[60:61]
v_mov_b32 v38, v6
v_cndmask_b32 v239, v239, v6, s[62:63]
v_cndmask_b32 v95, v95, v6, s[62:63]
v_mov_b32 v39, v6
SLOW0_U:
s_cmp_lg_u32 s54, 0
s_cbranch_scc1 SLOW0_A
v_max3_f32 v16, v16, v236, v237
v_max3_f32 v16, v16, v238, v239
v_max3_f32 v18, v18, v248, v249
v_max3_f32 v18, v18, v250, v251
v_max3_f32 v16, v16, v36, v37
v_max3_f32 v16, v16, v38, v39
v_max3_f32 v18, v18, v92, v93
v_max3_f32 v18, v18, v94, v95
s_branch SLOW0_N
SLOW0_A:
v_sub_f32 v236, v236, v16
v_sub_f32 v237, v237, v16
v_sub_f32 v238, v238, v16
v_sub_f32 v239, v239, v16
v_sub_f32 v248, v248, v18
v_sub_f32 v249, v249, v18
v_sub_f32 v250, v250, v18
v_sub_f32 v251, v251, v18
v_sub_f32 v36, v36, v16
v_sub_f32 v37, v37, v16
v_sub_f32 v38, v38, v16
v_sub_f32 v39, v39, v16
v_sub_f32 v92, v92, v18
v_sub_f32 v93, v93, v18
v_sub_f32 v94, v94, v18
v_sub_f32 v95, v95, v18
v_exp_f32 v236, v236
v_exp_f32 v237, v237
v_exp_f32 v238, v238
v_exp_f32 v239, v239
v_exp_f32 v248, v248
v_exp_f32 v249, v249
v_exp_f32 v250, v250
v_exp_f32 v251, v251
v_exp_f32 v36, v36
v_exp_f32 v37, v37
v_exp_f32 v38, v38
v_exp_f32 v39, v39
v_exp_f32 v92, v92
v_exp_f32 v93, v93
v_exp_f32 v94, v94
v_exp_f32 v95, v95
s_nop 0
v_cvt_pk_bf16_f32 v228, v236, v237
v_cvt_pk_bf16_f32 v229, v238, v239
v_cvt_pk_bf16_f32 v176, v248, v249
v_cvt_pk_bf16_f32 v177, v250, v251
v_cvt_pk_bf16_f32 v230, v36, v37
v_cvt_pk_bf16_f32 v231, v38, v39
v_cvt_pk_bf16_f32 v178, v92, v93
v_cvt_pk_bf16_f32 v179, v94, v95
s_nop 1
v_mfma_f32_16x16x32_bf16 a[0:3], a[64:67], v[228:231], a[0:3]
v_mfma_f32_16x16x32_bf16 a[32:35], a[64:67], v[176:179], a[32:35]
v_mfma_f32_16x16x32_bf16 a[4:7], a[68:71], v[228:231], a[4:7]
v_mfma_f32_16x16x32_bf16 a[36:39], a[68:71], v[176:179], a[36:39]
v_mfma_f32_16x16x32_bf16 a[8:11], a[72:75], v[228:231], a[8:11]
v_mfma_f32_16x16x32_bf16 a[40:43], a[72:75], v[176:179], a[40:43]
v_mfma_f32_16x16x32_bf16 a[12:15], a[76:79], v[228:231], a[12:15]
v_mfma_f32_16x16x32_bf16 a[44:47], a[76:79], v[176:179], a[44:47]
v_mfma_f32_16x16x32_bf16 a[16:19], a[80:83], v[228:231], a[16:19]
v_mfma_f32_16x16x32_bf16 a[48:51], a[80:83], v[176:179], a[48:51]
v_mfma_f32_16x16x32_bf16 a[20:23], a[84:87], v[228:231], a[20:23]
v_mfma_f32_16x16x32_bf16 a[52:55], a[84:87], v[176:179], a[52:55]
v_mfma_f32_16x16x32_bf16 a[24:27], a[88:91], v[228:231], a[24:27]
v_mfma_f32_16x16x32_bf16 a[56:59], a[88:91], v[176:179], a[56:59]
v_mfma_f32_16x16x32_bf16 a[28:31], a[92:95], v[228:231], a[28:31]
v_mfma_f32_16x16x32_bf16 a[60:63], a[92:95], v[176:179], a[60:63]
v_mfma_f32_16x16x32_bf16 a[224:227], a[240:243], v[228:231], a[224:227]
v_mfma_f32_16x16x32_bf16 a[228:231], a[240:243], v[176:179], a[228:231]
SLOW0_N:
s_add_u32 s52, s52, 16384
s_add_u32 s53, s53, 1
s_cmp_le_u32 s53, s66
s_cbranch_scc1 SLOW0_T
s_cmp_lg_u32 s54, 0
s_cbranch_scc1 SLOW0_E
v_mov_b32 v17, v16
v_mov_b32 v19, v18
s_nop 1
v_permlane32_swap_b32 v17, v16
v_permlane32_swap_b32 v19, v18
s_nop 1
v_max_f32 v16, v16, v17
v_max_f32 v18, v18, v19
v_mov_b32 v17, v16
v_mov_b32 v19, v18
s_nop 1
v_permlane16_swap_b32 v17, v16
v_permlane16_swap_b32 v19, v18
s_nop 1
v_max_f32 v16, v16, v17
v_max_f32 v18, v18, v19
v_accvgpr_write_b32 a0, 0
v_accvgpr_write_b32 a1, 0
v_accvgpr_write_b32 a2, 0
v_accvgpr_write_b32 a3, 0
v_accvgpr_write_b32 a4, 0
v_accvgpr_write_b32 a5, 0
v_accvgpr_write_b32 a6, 0
v_accvgpr_write_b32 a7, 0
v_accvgpr_write_b32 a8, 0
v_accvgpr_write_b32 a9, 0
v_accvgpr_write_b32 a10, 0
v_accvgpr_write_b32 a11, 0
v_accvgpr_write_b32 a12, 0
v_accvgpr_write_b32 a13, 0
v_accvgpr_write_b32 a14, 0
v_accvgpr_write_b32 a15, 0
v_accvgpr_write_b32 a16, 0
v_accvgpr_write_b32 a17, 0
v_accvgpr_write_b32 a18, 0
v_accvgpr_write_b32 a19, 0
v_accvgpr_write_b32 a20, 0
v_accvgpr_write_b32 a21, 0
v_accvgpr_write_b32 a22, 0
v_accvgpr_write_b32 a23, 0
v_accvgpr_write_b32 a24, 0
v_accvgpr_write_b32 a25, 0
v_accvgpr_write_b32 a26, 0
v_accvgpr_write_b32 a27, 0
v_accvgpr_write_b32 a28, 0
v_accvgpr_write_b32 a29, 0
v_accvgpr_write_b32 a30, 0
v_accvgpr_write_b32 a31, 0
v_accvgpr_write_b32 a32, 0
v_accvgpr_write_b32 a33, 0
v_accvgpr_write_b32 a34, 0
v_accvgpr_write_b32 a35, 0
v_accvgpr_write_b32 a36, 0
v_accvgpr_write_b32 a37, 0
v_accvgpr_write_b32 a38, 0
v_accvgpr_write_b32 a39, 0
v_accvgpr_write_b32 a40, 0
v_accvgpr_write_b32 a41, 0
v_accvgpr_write_b32 a42, 0
v_accvgpr_write_b32 a43, 0
v_accvgpr_write_b32 a44, 0
v_accvgpr_write_b32 a45, 0
v_accvgpr_write_b32 a46, 0
v_accvgpr_write_b32 a47, 0
v_accvgpr_write_b32 a48, 0
v_accvgpr_write_b32 a49, 0
v_accvgpr_write_b32 a50, 0
v_accvgpr_write_b32 a51, 0
v_accvgpr_write_b32 a52, 0
v_accvgpr_write_b32 a53, 0
v_accvgpr_write_b32 a54, 0
v_accvgpr_write_b32 a55, 0
v_accvgpr_write_b32 a56, 0
v_accvgpr_write_b32 a57, 0
v_accvgpr_write_b32 a58, 0
v_accvgpr_write_b32 a59, 0
v_accvgpr_write_b32 a60, 0
v_accvgpr_write_b32 a61, 0
v_accvgpr_write_b32 a62, 0
v_accvgpr_write_b32 a63, 0
v_accvgpr_write_b32 a224, 0
v_accvgpr_write_b32 a225, 0
v_accvgpr_write_b32 a226, 0
v_accvgpr_write_b32 a227, 0
v_accvgpr_write_b32 a228, 0
v_accvgpr_write_b32 a229, 0
v_accvgpr_write_b32 a230, 0
v_accvgpr_write_b32 a231, 0
s_mov_b32 s54, 1
s_branch SLOW0_P
SLOW0_E:
s_nop 7
v_accvgpr_read_b32 v72, a224
v_accvgpr_read_b32 v74, a228
s_branch SLOW0_R
SLOW1:
v_add_u32 v20, 4096, v4
s_mov_b32 s54, 0
v_mov_b32 v16, v6
v_mov_b32 v18, v6
SLOW1_P:
s_mov_b32 s53, 0
s_mov_b32 s52, s94
SLOW1_T:
s_add_u32 s55, s52, 24576
buffer_load_dwordx4 a[192:195], v4, s[24:27], s52 offen offset:0 sc1
buffer_load_dwordx4 a[196:199], v4, s[24:27], s52 offen offset:1024 sc1
buffer_load_dwordx4 a[200:203], v4, s[24:27], s52 offen offset:2048 sc1
buffer_load_dwordx4 a[204:207], v4, s[24:27], s52 offen offset:3072 sc1
buffer_load_dwordx4 a[208:211], v20, s[24:27], s52 offen offset:0 sc1
buffer_load_dwordx4 a[212:215], v20, s[24:27], s52 offen offset:1024 sc1
buffer_load_dwordx4 a[216:219], v20, s[24:27], s52 offen offset:2048 sc1
buffer_load_dwordx4 a[220:223], v20, s[24:27], s52 offen offset:3072 sc1
buffer_load_dwordx4 a[64:67], v4, s[24:27], s55 offen offset:0 sc1
buffer_load_dwordx4 a[68:71], v4, s[24:27], s55 offen offset:1024 sc1
buffer_load_dwordx4 a[72:75], v4, s[24:27], s55 offen offset:2048 sc1
buffer_load_dwordx4 a[76:79], v4, s[24:27], s55 offen offset:3072 sc1
buffer_load_dwordx4 a[80:83], v20, s[24:27], s55 offen offset:0 sc1
buffer_load_dwordx4 a[84:87], v20, s[24:27], s55 offen offset:1024 sc1
buffer_load_dwordx4 a[88:91], v20, s[24:27], s55 offen offset:2048 sc1
buffer_load_dwordx4 a[92:95], v20, s[24:27], s55 offen offset:3072 sc1
s_waitcnt vmcnt(0)
v_mfma_f32_16x16x32_bf16 v[236:239], a[192:195], v[212:215], 0
v_mfma_f32_16x16x32_bf16 v[236:239], a[196:199], v[88:91], v[236:239]
v_mfma_f32_16x16x32_bf16 v[236:239], a[200:203], v[224:227], v[236:239]
v_mfma_f32_16x16x32_bf16 v[236:239], a[204:207], v[52:55], v[236:239]
v_mfma_f32_16x16x32_bf16 v[248:251], a[192:195], v[220:223], 0
v_mfma_f32_16x16x32_bf16 v[248:251], a[196:199], v[160:163], v[248:251]
v_mfma_f32_16x16x32_bf16 v[248:251], a[200:203], v[192:195], v[248:251]
v_mfma_f32_16x16x32_bf16 v[248:251], a[204:207], v[60:63], v[248:251]
v_mfma_f32_16x16x32_bf16 v[36:39], a[208:211], v[212:215], 0
v_mfma_f32_16x16x32_bf16 v[36:39], a[212:215], v[88:91], v[36:39]
v_mfma_f32_16x16x32_bf16 v[36:39], a[216:219], v[224:227], v[36:39]
v_mfma_f32_16x16x32_bf16 v[36:39], a[220:223], v[52:55], v[36:39]
v_mfma_f32_16x16x32_bf16 v[92:95], a[208:211], v[220:223], 0
v_mfma_f32_16x16x32_bf16 v[92:95], a[212:215], v[160:163], v[92:95]
v_mfma_f32_16x16x32_bf16 v[92:95], a[216:219], v[192:195], v[92:95]
v_mfma_f32_16x16x32_bf16 v[92:95], a[220:223], v[60:63], v[92:95]
s_nop 7
s_cmp_lg_u32 s53, s67
s_cbranch_scc1 SLOW1_U
v_cndmask_b32 v236, v236, v6, s[56:57]
v_cndmask_b32 v92, v92, v6, s[56:57]
v_mov_b32 v36, v6
v_cndmask_b32 v237, v237, v6, s[58:59]
v_cndmask_b32 v93, v93, v6, s[58:59]
v_mov_b32 v37, v6
v_cndmask_b32 v238, v238, v6, s[60:61]
v_cndmask_b32 v94, v94, v6, s[60:61]
v_mov_b32 v38, v6
v_cndmask_b32 v239, v239, v6, s[62:63]
v_cndmask_b32 v95, v95, v6, s[62:63]
v_mov_b32 v39, v6
SLOW1_U:
s_cmp_lg_u32 s54, 0
s_cbranch_scc1 SLOW1_A
v_max3_f32 v16, v16, v236, v237
v_max3_f32 v16, v16, v238, v239
v_max3_f32 v18, v18, v248, v249
v_max3_f32 v18, v18, v250, v251
v_max3_f32 v16, v16, v36, v37
v_max3_f32 v16, v16, v38, v39
v_max3_f32 v18, v18, v92, v93
v_max3_f32 v18, v18, v94, v95
s_branch SLOW1_N
SLOW1_A:
v_sub_f32 v236, v236, v16
v_sub_f32 v237, v237, v16
v_sub_f32 v238, v238, v16
v_sub_f32 v239, v239, v16
v_sub_f32 v248, v248, v18
v_sub_f32 v249, v249, v18
v_sub_f32 v250, v250, v18
v_sub_f32 v251, v251, v18
v_sub_f32 v36, v36, v16
v_sub_f32 v37, v37, v16
v_sub_f32 v38, v38, v16
v_sub_f32 v39, v39, v16
v_sub_f32 v92, v92, v18
v_sub_f32 v93, v93, v18
v_sub_f32 v94, v94, v18
v_sub_f32 v95, v95, v18
v_exp_f32 v236, v236
v_exp_f32 v237, v237
v_exp_f32 v238, v238
v_exp_f32 v239, v239
v_exp_f32 v248, v248
v_exp_f32 v249, v249
v_exp_f32 v250, v250
v_exp_f32 v251, v251
v_exp_f32 v36, v36
v_exp_f32 v37, v37
v_exp_f32 v38, v38
v_exp_f32 v39, v39
v_exp_f32 v92, v92
v_exp_f32 v93, v93
v_exp_f32 v94, v94
v_exp_f32 v95, v95
s_nop 0
v_cvt_pk_bf16_f32 v228, v236, v237
v_cvt_pk_bf16_f32 v229, v238, v239
v_cvt_pk_bf16_f32 v176, v248, v249
v_cvt_pk_bf16_f32 v177, v250, v251
v_cvt_pk_bf16_f32 v230, v36, v37
v_cvt_pk_bf16_f32 v231, v38, v39
v_cvt_pk_bf16_f32 v178, v92, v93
v_cvt_pk_bf16_f32 v179, v94, v95
s_nop 1
v_mfma_f32_16x16x32_bf16 v[100:103], a[64:67], v[228:231], v[100:103]
v_mfma_f32_16x16x32_bf16 v[116:119], a[64:67], v[176:179], v[116:119]
v_mfma_f32_16x16x32_bf16 v[148:151], a[68:71], v[228:231], v[148:151]
v_mfma_f32_16x16x32_bf16 v[132:135], a[68:71], v[176:179], v[132:135]
v_mfma_f32_16x16x32_bf16 v[156:159], a[72:75], v[228:231], v[156:159]
v_mfma_f32_16x16x32_bf16 v[164:167], a[72:75], v[176:179], v[164:167]
v_mfma_f32_16x16x32_bf16 v[56:59], a[76:79], v[228:231], v[56:59]
v_mfma_f32_16x16x32_bf16 v[188:191], a[76:79], v[176:179], v[188:191]
v_mfma_f32_16x16x32_bf16 v[108:111], a[80:83], v[228:231], v[108:111]
v_mfma_f32_16x16x32_bf16 v[40:43], a[80:83], v[176:179], v[40:43]
v_mfma_f32_16x16x32_bf16 v[140:143], a[84:87], v[228:231], v[140:143]
v_mfma_f32_16x16x32_bf16 v[124:127], a[84:87], v[176:179], v[124:127]
v_mfma_f32_16x16x32_bf16 v[48:51], a[88:91], v[228:231], v[48:51]
v_mfma_f32_16x16x32_bf16 v[172:175], a[88:91], v[176:179], v[172:175]
v_mfma_f32_16x16x32_bf16 v[196:199], a[92:95], v[228:231], v[196:199]
v_mfma_f32_16x16x32_bf16 v[180:183], a[92:95], v[176:179], v[180:183]
v_mfma_f32_16x16x32_bf16 a[232:235], a[240:243], v[228:231], a[232:235]
v_mfma_f32_16x16x32_bf16 a[236:239], a[240:243], v[176:179], a[236:239]
SLOW1_N:
s_add_u32 s52, s52, 16384
s_add_u32 s53, s53, 1
s_cmp_le_u32 s53, s67
s_cbranch_scc1 SLOW1_T
s_cmp_lg_u32 s54, 0
s_cbranch_scc1 SLOW1_E
v_mov_b32 v17, v16
v_mov_b32 v19, v18
s_nop 1
v_permlane32_swap_b32 v17, v16
v_permlane32_swap_b32 v19, v18
s_nop 1
v_max_f32 v16, v16, v17
v_max_f32 v18, v18, v19
v_mov_b32 v17, v16
v_mov_b32 v19, v18
s_nop 1
v_permlane16_swap_b32 v17, v16
v_permlane16_swap_b32 v19, v18
s_nop 1
v_max_f32 v16, v16, v17
v_max_f32 v18, v18, v19
v_mov_b32 v100, 0
v_mov_b32 v101, 0
v_mov_b32 v102, 0
v_mov_b32 v103, 0
v_mov_b32 v148, 0
v_mov_b32 v149, 0
v_mov_b32 v150, 0
v_mov_b32 v151, 0
v_mov_b32 v156, 0
v_mov_b32 v157, 0
v_mov_b32 v158, 0
v_mov_b32 v159, 0
v_mov_b32 v56, 0
v_mov_b32 v57, 0
v_mov_b32 v58, 0
v_mov_b32 v59, 0
v_mov_b32 v108, 0
v_mov_b32 v109, 0
v_mov_b32 v110, 0
v_mov_b32 v111, 0
v_mov_b32 v140, 0
v_mov_b32 v141, 0
v_mov_b32 v142, 0
v_mov_b32 v143, 0
v_mov_b32 v48, 0
v_mov_b32 v49, 0
v_mov_b32 v50, 0
v_mov_b32 v51, 0
v_mov_b32 v196, 0
v_mov_b32 v197, 0
v_mov_b32 v198, 0
v_mov_b32 v199, 0
v_mov_b32 v116, 0
v_mov_b32 v117, 0
v_mov_b32 v118, 0
v_mov_b32 v119, 0
v_mov_b32 v132, 0
v_mov_b32 v133, 0
v_mov_b32 v134, 0
v_mov_b32 v135, 0
v_mov_b32 v164, 0
v_mov_b32 v165, 0
v_mov_b32 v166, 0
v_mov_b32 v167, 0
v_mov_b32 v188, 0
v_mov_b32 v189, 0
v_mov_b32 v190, 0
v_mov_b32 v191, 0
v_mov_b32 v40, 0
v_mov_b32 v41, 0
v_mov_b32 v42, 0
v_mov_b32 v43, 0
v_mov_b32 v124, 0
v_mov_b32 v125, 0
v_mov_b32 v126, 0
v_mov_b32 v127, 0
v_mov_b32 v172, 0
v_mov_b32 v173, 0
v_mov_b32 v174, 0
v_mov_b32 v175, 0
v_mov_b32 v180, 0
v_mov_b32 v181, 0
v_mov_b32 v182, 0
v_mov_b32 v183, 0
v_accvgpr_write_b32 a232, 0
v_accvgpr_write_b32 a233, 0
v_accvgpr_write_b32 a234, 0
v_accvgpr_write_b32 a235, 0
v_accvgpr_write_b32 a236, 0
v_accvgpr_write_b32 a237, 0
v_accvgpr_write_b32 a238, 0
v_accvgpr_write_b32 a239, 0
s_mov_b32 s54, 1
s_branch SLOW1_P
SLOW1_E:
s_nop 7
v_accvgpr_read_b32 v72, a232
v_accvgpr_read_b32 v74, a236
s_branch SLOW1_R
.section .rodata,"a"
.p2align 6
.amdhsa_kernel gated_mix__sliding_local_dilated__compressed_kv_cla__prompt_kernel
  .amdhsa_next_free_vgpr 512
  .amdhsa_next_free_sgpr 102
  .amdhsa_accum_offset 256
  .amdhsa_group_segment_fixed_size 0
  .amdhsa_kernarg_size 104
  .amdhsa_user_sgpr_count 2
  .amdhsa_user_sgpr_kernarg_segment_ptr 1
  .amdhsa_system_sgpr_workgroup_id_x 1
.end_amdhsa_kernel
```

```asm
; @launch grid=(256,1,1) block=(256,1,1) lds=163840
.amdgcn_target "amdgcn-amd-amdhsa--gfx950"
.text

.globl gated_mix__sliding_local_dilated__compressed_kv_cla__prompt_kernel
.p2align 8
.type gated_mix__sliding_local_dilated__compressed_kv_cla__prompt_kernel,@function
gated_mix__sliding_local_dilated__compressed_kv_cla__prompt_kernel:
s_cmp_ge_u32 s2, 256
s_cbranch_scc1 L_END
s_load_dwordx2 s[8:9], s[0:1], 32
s_load_dwordx2 s[56:57], s[0:1], 56
s_load_dwordx2 s[16:17], s[0:1], 48
s_load_dwordx2 s[24:25], s[0:1], 96
s_load_dwordx2 s[12:13], s[0:1], 0
s_load_dwordx2 s[20:21], s[0:1], 40
s_load_dwordx2 s[28:29], s[0:1], 8
s_load_dwordx2 s[48:49], s[0:1], 16
s_load_dwordx2 s[32:33], s[0:1], 64
s_load_dwordx2 s[36:37], s[0:1], 72
s_load_dwordx2 s[40:41], s[0:1], 88
s_load_dwordx2 s[44:45], s[0:1], 80
s_getpc_b64 s[96:97]
L_PC:
s_lshr_b32 s6, s2, 3
s_lshl_b32 s98, s6, 11
s_add_u32 s98, s98, L_MAIN-L_PC
s_add_u32 s96, s96, s98
s_addc_u32 s97, s97, 0
v_lshlrev_b32 v16, 3, v0
v_mov_b32 v17, s97
v_add_co_u32 v16, vcc, s96, v16
v_lshrrev_b32 v5, 6, v0
v_and_b32 v1, 63, v0
v_addc_co_u32 v17, vcc, 0, v17, vcc
v_readfirstlane_b32 s3, v5
global_load_dwordx2 a[252:253], v[16:17], off
v_and_b32 v2, 15, v0
v_lshrrev_b32 v3, 4, v1
v_lshlrev_b32 v4, 4, v1
s_and_b32 s7, s2, 7
s_and_b32 s65, s6, 3
s_lshl2_add_u32 s4, s7, s65
s_lshr_b32 s5, s6, 2
s_lshl2_add_u32 s66, s5, s3
s_sub_u32 s67, 63, s66
v_lshrrev_b32 v16, 3, v1
v_and_b32 v17, 7, v1
v_xor_b32 v18, v17, v3
v_lshlrev_b32 v19, 10, v16
v_lshl_add_u32 v5, v18, 4, v19
v_xor_b32 v18, 4, v18
v_lshl_add_u32 v6, v18, 4, v19
v_add_u32 v6, 7168, v6
v_and_b32 v18, 1, v3
v_lshlrev_b32 v18, 1, v18
v_xor_b32 v18, v17, v18
v_lshlrev_b32 v19, 13, v16
v_lshl_add_u32 v7, v18, 4, v19
v_xor_b32 v18, 4, v18
v_lshl_add_u32 v8, v18, 4, v19
v_add_u32 v8, 64512, v8
s_add_u32 s69, s65, s5
s_and_b32 s69, s69, 1
s_mul_i32 s64, s7, 2
s_and_b32 s64, s64, 7
s_or_b32 s69, s69, s64
s_add_u32 s93, s65, s5
s_and_b32 s93, s93, 0
s_mul_i32 s64, s7, 1
s_and_b32 s64, s64, 7
s_or_b32 s93, s93, s64
s_lshl_b32 s70, s69, 7
s_lshl_b32 s75, s69, 19
s_lshr_b32 s54, s3, 1
s_and_b32 s55, s3, 1
s_lshl3_add_u32 s87, s54, s5
s_lshl_b32 s64, s55, 5
s_add_u32 s68, s87, s64
s_lshl_b32 s68, s68, 15
s_lshl_b32 s73, s3, 13
s_add_u32 s73, s73, 65536
s_lshl1_add_u32 s74, s4, s55
s_lshl_b32 s74, s74, 7
s_lshl_b32 s64, s54, 18
s_add_u32 s74, s74, s64
s_lshl_b32 s77, s3, 12
s_add_u32 s71, s68, s70
s_add_u32 s76, s74, s75
s_mov_b32 s10, 2097152
s_mov_b32 s11, 0x20000
s_mov_b32 s58, 4194304
s_mov_b32 s59, 0x20000
s_waitcnt lgkmcnt(0)
s_add_u32 m0, s73, 0
s_add_u32 s64, s71, 0
buffer_load_dwordx4 v5, s[8:11], s64 offen lds
buffer_load_dwordx4 v6, s[8:11], s64 offen offset:1024 lds
s_add_u32 m0, s73, 2048
s_add_u32 s64, s71, 16384
buffer_load_dwordx4 v5, s[8:11], s64 offen lds
buffer_load_dwordx4 v6, s[8:11], s64 offen offset:1024 lds
s_add_u32 m0, s77, 0
s_add_u32 s64, s76, 0
buffer_load_dwordx4 v7, s[56:59], s64 offen lds
buffer_load_dwordx4 v8, s[56:59], s64 offen offset:1024 lds
s_add_u32 m0, s77, 2048
s_add_u32 s64, s76, 131072
buffer_load_dwordx4 v7, s[56:59], s64 offen lds
buffer_load_dwordx4 v8, s[56:59], s64 offen offset:1024 lds
s_add_u32 m0, s73, 4096
s_add_u32 s64, s71, 524288
buffer_load_dwordx4 v5, s[8:11], s64 offen lds
buffer_load_dwordx4 v6, s[8:11], s64 offen offset:1024 lds
s_add_u32 m0, s73, 6144
s_add_u32 s64, s71, 540672
buffer_load_dwordx4 v5, s[8:11], s64 offen lds
buffer_load_dwordx4 v6, s[8:11], s64 offen offset:1024 lds
s_mov_b32 s18, 4194304
s_mov_b32 s19, 0x20000
s_mov_b32 s26, 268435456
s_mov_b32 s27, 0x20000
s_mov_b32 s14, 2359296
s_mov_b32 s15, 0x20000
s_mov_b32 s22, 4718592
s_mov_b32 s23, 0x20000
s_mov_b32 s30, 1990656
s_mov_b32 s31, 0x20000
s_mov_b32 s34, 4718592
s_mov_b32 s35, 0x20000
s_mov_b32 s38, 1152
s_mov_b32 s39, 0x20000
s_mov_b32 s42, 256
s_mov_b32 s43, 0x20000
s_mov_b32 s46, 2359296
s_mov_b32 s47, 0x20000
s_mov_b32 s50, 663552
s_mov_b32 s51, 0x20000
s_lshl_b32 s89, s4, 10
s_add_u32 s89, s89, 75497472
s_mul_i32 s94, s4, 1064960
s_cmp_eq_u32 s66, 0
s_cselect_b32 s52, s89, 2147418112
s_lshl_b32 s53, s5, 10
s_add_u32 s53, s53, s94
s_add_u32 s53, s53, 1048576
s_cmp_eq_u32 s3, 1
s_cselect_b32 s52, s53, s52
s_mul_i32 s53, s2, 74
s_add_u32 s53, s53, s55
s_lshl_b32 s53, s53, 10
s_add_u32 s53, s53, 54599680
s_cmp_ge_u32 s3, 2
s_cselect_b32 s52, s53, s52
v_mov_b32 v16, 0
v_mov_b32 v17, 0
v_mov_b32 v18, 0
v_mov_b32 v19, 0
buffer_store_dwordx4 v[16:19], v4, s[24:27], s52 offen sc1
s_add_u32 s89, s89, 512
s_cmp_eq_u32 s3, 0
s_cselect_b32 s90, s89, 2147418112
v_mov_b32 v24, 2147418112
v_cmp_eq_u32 vcc, 1, v1
s_lshl_b32 s52, s54, 7
s_lshl_b32 s53, s55, 12
v_cndmask_b32 v0, v24, 0, vcc
v_lshrrev_b32 v16, 1, v2
v_xor_b32 v16, v16, v3
v_add_u32 v17, s52, v2
v_lshlrev_b32 v17, 7, v17
v_add_u32 v17, 65536, v17
v_lshl_add_u32 v9, v16, 4, v17
v_xor_b32 v10, 64, v9
v_bfe_u32 v16, v1, 2, 2
v_lshl_add_u32 v17, v3, 3, v16
v_lshlrev_b32 v17, 7, v17
v_and_b32 v18, 3, v1
v_lshl_add_u32 v17, v18, 3, v17
v_add_u32 v17, s53, v17
v_lshrrev_b32 v16, 1, v16
v_and_b32 v18, 1, v3
v_lshl_add_u32 v16, v18, 1, v16
v_xor_b32 v18, 0, v16
v_lshl_add_u32 v11, v18, 5, v17
v_xor_b32 v18, 1, v16
v_lshl_add_u32 v12, v18, 5, v17
v_xor_b32 v18, 2, v16
v_lshl_add_u32 v13, v18, 5, v17
v_xor_b32 v18, 3, v16
v_lshl_add_u32 v14, v18, 5, v17
s_mul_i32 s87, s87, 16384
s_add_u32 s87, s87, s94
s_add_u32 s88, s87, s53
s_add_u32 s88, s88, 24576
s_lshr_b32 s53, s53, 1
s_add_u32 s87, s87, s53
s_lshl_b32 s80, s3, 10
s_mul_i32 s78, s4, 18
s_add_u32 s78, s78, s54
s_lshl2_add_u32 s78, s78, s55
s_lshl_b32 s78, s78, 10
s_add_u32 s78, s78, 35651584
s_add_u32 s80, s80, 8192
s_mov_b32 s91, 0x3e0293ee
s_mov_b32 s85, 0x05040100
s_mov_b32 s86, 0x07060302
s_lshl2_add_u32 s52, s7, s3
s_xor_b32 s92, s6, 31
s_mul_i32 s81, s92, 110592
s_mul_i32 s65, s52, 36
s_add_u32 s81, s81, s65
s_mul_i32 s82, s52, 18
s_add_u32 s82, s82, s92
s_lshl_b32 s82, s82, 12
s_add_u32 s82, s82, 35651584
s_lshl_b32 s83, s92, 6
s_lshl_b32 s84, s52, 10
s_add_u32 s84, s84, 75497984
s_cmp_lt_u32 s92, 18
s_cselect_b32 s82, s82, 2147418112
s_cselect_b32 s84, s84, 2147418112
v_lshrrev_b32 v18, 2, v2
v_and_b32 v19, 3, v2
v_mul_u32_u24 v20, 1152, v18
v_cmp_eq_u32 vcc, 2, v19
v_lshl_add_u32 v20, v19, 3, v20
v_add_u32 v21, 1, v19
v_cndmask_b32 v21, v21, 0, vcc
v_cmp_eq_u32 vcc, 3, v18
v_mul_u32_u24 v21, 1152, v21
v_add_u32 v21, 32, v21
v_cndmask_b32 v20, v20, v21, vcc
v_cmp_eq_u32 vcc, 15, v2
v_mul_u32_u24 v21, 27648, v3
v_add_u32 v20, v20, v21
v_lshlrev_b32 v21, 4, v3
v_cndmask_b32 v26, v20, v24, vcc
v_cndmask_b32 v27, v24, v21, vcc
v_and_b32 v18, 7, v1
v_cmp_gt_u32 vcc, 48, v1
v_mul_u32_u24 v18, 3456, v18
v_mul_u32_u24 v19, 1152, v3
v_bfe_u32 v20, v1, 3, 1
v_mul_u32_u24 v20, 140, v20
v_add3_u32 v18, v18, v19, v20
v_cndmask_b32 v28, v24, v18, vcc
s_mov_b64 exec, 0
s_cmp_eq_u32 s3, 0
s_cbranch_scc1 L_PAD0
s_cmp_eq_u32 s3, 1
s_cbranch_scc1 L_PAD1
s_cmp_eq_u32 s3, 2
s_cbranch_scc1 L_PAD2
s_branch L_PAD3
.p2align 12
.fill 821, 4, 0xbf800000
L_MAIN:
s_mov_b64 exec, -1
s_add_u32 m0, s77, 16384
s_add_u32 s64, s76, 0
buffer_load_dwordx4 v7, s[16:19], s64 offen lds
buffer_load_dwordx4 v8, s[16:19], s64 offen offset:1024 lds
s_add_u32 m0, s77, 18432
s_add_u32 s64, s76, 131072
buffer_load_dwordx4 v7, s[16:19], s64 offen lds
buffer_load_dwordx4 v8, s[16:19], s64 offen offset:1024 lds
s_xor_b32 s71, s70, 128
s_add_u32 s71, s68, s71
s_add_u32 m0, s73, 32768
s_add_u32 s64, s71, 0
buffer_load_dwordx4 v5, s[8:11], s64 offen lds
buffer_load_dwordx4 v6, s[8:11], s64 offen offset:1024 lds
s_add_u32 m0, s73, 34816
s_add_u32 s64, s71, 16384
buffer_load_dwordx4 v5, s[8:11], s64 offen lds
buffer_load_dwordx4 v6, s[8:11], s64 offen offset:1024 lds
s_waitcnt vmcnt(8)
s_barrier
ds_read_b128 a[64:67], v9 offset:0
ds_read_b128 a[68:71], v10 offset:0
ds_read_b64_tr_b16 a[128:129], v11 offset:0
ds_read_b64_tr_b16 a[130:131], v11 offset:512
ds_read_b64_tr_b16 a[132:133], v11 offset:8192
ds_read_b64_tr_b16 a[134:135], v11 offset:8704
ds_read_b64_tr_b16 a[136:137], v12 offset:0
ds_read_b64_tr_b16 a[138:139], v12 offset:512
ds_read_b64_tr_b16 a[140:141], v12 offset:8192
ds_read_b64_tr_b16 a[142:143], v12 offset:8704
ds_read_b64_tr_b16 a[144:145], v13 offset:0
ds_read_b64_tr_b16 a[146:147], v13 offset:512
ds_read_b64_tr_b16 a[148:149], v13 offset:8192
ds_read_b64_tr_b16 a[150:151], v13 offset:8704
ds_read_b64_tr_b16 a[152:153], v14 offset:0
ds_read_b64_tr_b16 a[154:155], v14 offset:512
ds_read_b64_tr_b16 a[156:157], v14 offset:8192
ds_read_b64_tr_b16 a[158:159], v14 offset:8704
ds_read_b128 a[72:75], v9 offset:2048
ds_read_b128 a[76:79], v10 offset:2048
ds_read_b128 a[80:83], v9 offset:4096
ds_read_b128 a[84:87], v10 offset:4096
ds_read_b128 a[88:91], v9 offset:6144
ds_read_b128 a[92:95], v10 offset:6144
s_lshl_b32 s52, s4, 2
s_cmp_eq_u32 s66, 0
s_cselect_b32 s52, s52, 2147418112
buffer_store_dword v1, v0, s[40:43], s52 offen sc1
s_waitcnt lgkmcnt(0)
v_mfma_f32_16x16x32_bf16 v[32:35], a[64:67], a[128:131], 0
s_waitcnt vmcnt(5)
v_mfma_f32_16x16x32_bf16 v[32:35], a[68:71], a[132:135], v[32:35]
s_barrier
v_mfma_f32_16x16x32_bf16 v[40:43], a[68:71], a[140:143], 0
ds_read_b128 a[96:99], v9 offset:8192
v_mfma_f32_16x16x32_bf16 v[40:43], a[64:67], a[136:139], v[40:43]
s_add_u32 m0, s73, 36864
s_add_u32 s64, s71, 524288
v_mfma_f32_16x16x32_bf16 v[48:51], a[64:67], a[144:147], 0
buffer_load_dwordx4 v5, s[8:11], s64 offen lds
v_mfma_f32_16x16x32_bf16 v[48:51], a[68:71], a[148:151], v[48:51]
ds_read_b128 a[100:103], v10 offset:8192
v_mfma_f32_16x16x32_bf16 v[56:59], a[68:71], a[156:159], 0
v_mfma_f32_16x16x32_bf16 v[56:59], a[64:67], a[152:155], v[56:59]
v_mfma_f32_16x16x32_bf16 v[60:63], a[72:75], a[152:155], 0
buffer_load_dwordx4 v6, s[8:11], s64 offen offset:1024 lds
v_mfma_f32_16x16x32_bf16 v[60:63], a[76:79], a[156:159], v[60:63]
ds_read_b128 a[104:107], v9 offset:10240
v_mfma_f32_16x16x32_bf16 v[52:55], a[76:79], a[148:151], 0
v_mfma_f32_16x16x32_bf16 v[52:55], a[72:75], a[144:147], v[52:55]
s_add_u32 m0, s73, 38912
s_add_u32 s64, s71, 540672
v_mfma_f32_16x16x32_bf16 v[44:47], a[72:75], a[136:139], 0
ds_read_b64_tr_b16 a[160:161], v11 offset:16384
ds_read_b64_tr_b16 a[162:163], v11 offset:16896
v_mfma_f32_16x16x32_bf16 v[44:47], a[76:79], a[140:143], v[44:47]
buffer_load_dwordx4 v5, s[8:11], s64 offen lds
v_mfma_f32_16x16x32_bf16 v[36:39], a[76:79], a[132:135], 0
v_mfma_f32_16x16x32_bf16 v[36:39], a[72:75], a[128:131], v[36:39]
ds_read_b128 a[108:111], v10 offset:10240
v_mfma_f32_16x16x32_bf16 v[64:67], a[80:83], a[128:131], 0
v_mfma_f32_16x16x32_bf16 v[64:67], a[84:87], a[132:135], v[64:67]
v_mfma_f32_16x16x32_bf16 v[72:75], a[84:87], a[140:143], 0
buffer_load_dwordx4 v6, s[8:11], s64 offen offset:1024 lds
v_mfma_f32_16x16x32_bf16 v[72:75], a[80:83], a[136:139], v[72:75]
s_xor_b32 s76, s75, 524288
s_add_u32 s76, s74, s76
v_mfma_f32_16x16x32_bf16 v[80:83], a[80:83], a[144:147], 0
ds_read_b64_tr_b16 a[164:165], v11 offset:24576
ds_read_b64_tr_b16 a[166:167], v11 offset:25088
v_mfma_f32_16x16x32_bf16 v[80:83], a[84:87], a[148:151], v[80:83]
s_add_u32 m0, s77, 32768
s_add_u32 s64, s76, 0
ds_read_b128 a[112:115], v9 offset:12288
v_mfma_f32_16x16x32_bf16 v[88:91], a[84:87], a[156:159], 0
v_mfma_f32_16x16x32_bf16 v[88:91], a[80:83], a[152:155], v[88:91]
buffer_load_dwordx4 v7, s[56:59], s64 offen lds
v_mfma_f32_16x16x32_bf16 v[92:95], a[88:91], a[152:155], 0
ds_read_b64_tr_b16 a[168:169], v12 offset:16384
ds_read_b64_tr_b16 a[170:171], v12 offset:16896
v_mfma_f32_16x16x32_bf16 v[92:95], a[92:95], a[156:159], v[92:95]
v_mfma_f32_16x16x32_bf16 v[84:87], a[92:95], a[148:151], 0
v_mfma_f32_16x16x32_bf16 v[84:87], a[88:91], a[144:147], v[84:87]
v_mfma_f32_16x16x32_bf16 v[76:79], a[88:91], a[136:139], 0
buffer_load_dwordx4 v8, s[56:59], s64 offen offset:1024 lds
v_mfma_f32_16x16x32_bf16 v[76:79], a[92:95], a[140:143], v[76:79]
ds_read_b128 a[116:119], v10 offset:12288
v_mfma_f32_16x16x32_bf16 v[68:71], a[92:95], a[132:135], 0
L_PAD0:
s_cbranch_execz L_PAD4
v_mfma_f32_16x16x32_bf16 v[68:71], a[88:91], a[128:131], v[68:71]
s_add_u32 m0, s77, 34816
s_add_u32 s64, s76, 131072
s_waitcnt lgkmcnt(6)
v_mfma_f32_16x16x32_bf16 v[96:99], a[96:99], a[128:131], 0
ds_read_b64_tr_b16 a[172:173], v12 offset:24576
ds_read_b64_tr_b16 a[174:175], v12 offset:25088
v_mfma_f32_16x16x32_bf16 v[96:99], a[100:103], a[132:135], v[96:99]
buffer_load_dwordx4 v7, s[56:59], s64 offen lds
v_mfma_f32_16x16x32_bf16 v[104:107], a[100:103], a[140:143], 0
ds_read_b128 a[120:123], v9 offset:14336
v_mfma_f32_16x16x32_bf16 v[104:107], a[96:99], a[136:139], v[104:107]
v_mfma_f32_16x16x32_bf16 v[112:115], a[96:99], a[144:147], 0
v_mfma_f32_16x16x32_bf16 v[112:115], a[100:103], a[148:151], v[112:115]
buffer_load_dwordx4 v8, s[56:59], s64 offen offset:1024 lds
v_mfma_f32_16x16x32_bf16 v[120:123], a[100:103], a[156:159], 0
ds_read_b64_tr_b16 a[176:177], v13 offset:16384
ds_read_b64_tr_b16 a[178:179], v13 offset:16896
v_mfma_f32_16x16x32_bf16 v[120:123], a[96:99], a[152:155], v[120:123]
v_mfma_f32_16x16x32_bf16 v[124:127], a[104:107], a[152:155], 0
s_add_u32 m0, s77, 49152
s_add_u32 s64, s76, 0
v_mfma_f32_16x16x32_bf16 v[124:127], a[108:111], a[156:159], v[124:127]
ds_read_b128 a[124:127], v10 offset:14336
v_mfma_f32_16x16x32_bf16 v[116:119], a[108:111], a[148:151], 0
buffer_load_dwordx4 v7, s[16:19], s64 offen lds
v_mfma_f32_16x16x32_bf16 v[116:119], a[104:107], a[144:147], v[116:119]
v_add_u32 v9, 32768, v9
v_add_u32 v10, 32768, v10
v_mfma_f32_16x16x32_bf16 v[108:111], a[104:107], a[136:139], 0
ds_read_b64_tr_b16 a[180:181], v13 offset:24576
ds_read_b64_tr_b16 a[182:183], v13 offset:25088
v_mfma_f32_16x16x32_bf16 v[108:111], a[108:111], a[140:143], v[108:111]
v_mfma_f32_16x16x32_bf16 v[100:103], a[108:111], a[132:135], 0
s_waitcnt lgkmcnt(2)
v_mfma_f32_16x16x32_bf16 v[100:103], a[104:107], a[128:131], v[100:103]
buffer_load_dwordx4 v8, s[16:19], s64 offen offset:1024 lds
v_mfma_f32_16x16x32_bf16 v[128:131], a[112:115], a[128:131], 0
ds_read_b64_tr_b16 a[184:185], v14 offset:16384
ds_read_b64_tr_b16 a[186:187], v14 offset:16896
v_mfma_f32_16x16x32_bf16 v[128:131], a[116:119], a[132:135], v[128:131]
v_mfma_f32_16x16x32_bf16 v[136:139], a[116:119], a[140:143], 0
s_add_u32 m0, s77, 51200
s_add_u32 s64, s76, 131072
v_mfma_f32_16x16x32_bf16 v[136:139], a[112:115], a[136:139], v[136:139]
ds_read_b64_tr_b16 a[188:189], v14 offset:24576
ds_read_b64_tr_b16 a[190:191], v14 offset:25088
v_mfma_f32_16x16x32_bf16 v[144:147], a[112:115], a[144:147], 0
buffer_load_dwordx4 v7, s[16:19], s64 offen lds
v_mfma_f32_16x16x32_bf16 v[144:147], a[116:119], a[148:151], v[144:147]
v_mfma_f32_16x16x32_bf16 v[152:155], a[116:119], a[156:159], 0
v_mfma_f32_16x16x32_bf16 v[152:155], a[112:115], a[152:155], v[152:155]
v_mfma_f32_16x16x32_bf16 v[156:159], a[120:123], a[152:155], 0
v_mfma_f32_16x16x32_bf16 v[156:159], a[124:127], a[156:159], v[156:159]
buffer_load_dwordx4 v8, s[16:19], s64 offen offset:1024 lds
v_mfma_f32_16x16x32_bf16 v[148:151], a[124:127], a[148:151], 0
v_mfma_f32_16x16x32_bf16 v[148:151], a[120:123], a[144:147], v[148:151]
v_mfma_f32_16x16x32_bf16 v[140:143], a[120:123], a[136:139], 0
v_mfma_f32_16x16x32_bf16 v[140:143], a[124:127], a[140:143], v[140:143]
v_mfma_f32_16x16x32_bf16 v[132:135], a[124:127], a[132:135], 0
v_mfma_f32_16x16x32_bf16 v[132:135], a[120:123], a[128:131], v[132:135]
s_waitcnt lgkmcnt(0)
v_mfma_f32_16x16x32_bf16 v[160:163], a[160:163], a[64:67], 0
s_waitcnt vmcnt(4)
v_mfma_f32_16x16x32_bf16 v[160:163], a[164:167], a[68:71], v[160:163]
s_barrier
v_mfma_f32_16x16x32_bf16 v[164:167], a[172:175], a[68:71], 0
ds_read_b64_tr_b16 a[128:129], v11 offset:32768
ds_read_b64_tr_b16 a[130:131], v11 offset:33280
v_mfma_f32_16x16x32_bf16 v[164:167], a[168:171], a[64:67], v[164:167]
s_xor_b32 s71, s70, 256
s_add_u32 s71, s68, s71
v_mfma_f32_16x16x32_bf16 v[168:171], a[176:179], a[64:67], 0
s_add_u32 m0, s73, 65536
s_add_u32 s64, s71, 0
v_mfma_f32_16x16x32_bf16 v[168:171], a[180:183], a[68:71], v[168:171]
buffer_load_dwordx4 v5, s[8:11], s64 offen lds
v_mfma_f32_16x16x32_bf16 v[172:175], a[188:191], a[68:71], 0
v_mfma_f32_16x16x32_bf16 v[172:175], a[184:187], a[64:67], v[172:175]
ds_read_b128 a[64:67], v9 offset:0
v_mfma_f32_16x16x32_bf16 v[188:191], a[184:187], a[72:75], 0
buffer_load_dwordx4 v6, s[8:11], s64 offen offset:1024 lds
v_mfma_f32_16x16x32_bf16 v[188:191], a[188:191], a[76:79], v[188:191]
ds_read_b64_tr_b16 a[132:133], v11 offset:40960
ds_read_b64_tr_b16 a[134:135], v11 offset:41472
v_mfma_f32_16x16x32_bf16 v[184:187], a[180:183], a[76:79], 0
v_mfma_f32_16x16x32_bf16 v[184:187], a[176:179], a[72:75], v[184:187]
s_add_u32 m0, s73, 67584
s_add_u32 s64, s71, 16384
ds_read_b128 a[68:71], v10 offset:0
v_mfma_f32_16x16x32_bf16 v[180:183], a[168:171], a[72:75], 0
v_mfma_f32_16x16x32_bf16 v[180:183], a[172:175], a[76:79], v[180:183]
buffer_load_dwordx4 v5, s[8:11], s64 offen lds
v_mfma_f32_16x16x32_bf16 v[176:179], a[164:167], a[76:79], 0
v_mfma_f32_16x16x32_bf16 v[176:179], a[160:163], a[72:75], v[176:179]
ds_read_b64_tr_b16 a[136:137], v12 offset:32768
ds_read_b64_tr_b16 a[138:139], v12 offset:33280
v_mfma_f32_16x16x32_bf16 v[192:195], a[160:163], a[80:83], 0
v_mfma_f32_16x16x32_bf16 v[192:195], a[164:167], a[84:87], v[192:195]
v_mfma_f32_16x16x32_bf16 v[196:199], a[172:175], a[84:87], 0
buffer_load_dwordx4 v6, s[8:11], s64 offen offset:1024 lds
v_mfma_f32_16x16x32_bf16 v[196:199], a[168:171], a[80:83], v[196:199]
s_xor_b32 s76, s75, 1048576
s_add_u32 s76, s74, s76
ds_read_b128 a[72:75], v9 offset:2048
v_mfma_f32_16x16x32_bf16 v[200:203], a[176:179], a[80:83], 0
v_mfma_f32_16x16x32_bf16 v[200:203], a[180:183], a[84:87], v[200:203]
s_add_u32 m0, s77, 0
s_add_u32 s64, s76, 0
v_mfma_f32_16x16x32_bf16 v[204:207], a[188:191], a[84:87], 0
ds_read_b64_tr_b16 a[140:141], v12 offset:40960
ds_read_b64_tr_b16 a[142:143], v12 offset:41472
v_mfma_f32_16x16x32_bf16 v[204:207], a[184:187], a[80:83], v[204:207]
buffer_load_dwordx4 v7, s[56:59], s64 offen lds
v_mfma_f32_16x16x32_bf16 v[220:223], a[184:187], a[88:91], 0
ds_read_b128 a[76:79], v10 offset:2048
v_mfma_f32_16x16x32_bf16 v[220:223], a[188:191], a[92:95], v[220:223]
v_mfma_f32_16x16x32_bf16 v[216:219], a[180:183], a[92:95], 0
v_mfma_f32_16x16x32_bf16 v[216:219], a[176:179], a[88:91], v[216:219]
v_mfma_f32_16x16x32_bf16 v[212:215], a[168:171], a[88:91], 0
buffer_load_dwordx4 v8, s[56:59], s64 offen offset:1024 lds
v_mfma_f32_16x16x32_bf16 v[212:215], a[172:175], a[92:95], v[212:215]
ds_read_b64_tr_b16 a[144:145], v13 offset:32768
ds_read_b64_tr_b16 a[146:147], v13 offset:33280
v_mfma_f32_16x16x32_bf16 v[208:211], a[164:167], a[92:95], 0
v_mfma_f32_16x16x32_bf16 v[208:211], a[160:163], a[88:91], v[208:211]
s_add_u32 m0, s77, 2048
s_add_u32 s64, s76, 131072
ds_read_b128 a[80:83], v9 offset:4096
v_mfma_f32_16x16x32_bf16 v[224:227], a[160:163], a[96:99], 0
v_mfma_f32_16x16x32_bf16 v[224:227], a[164:167], a[100:103], v[224:227]
buffer_load_dwordx4 v7, s[56:59], s64 offen lds
v_mfma_f32_16x16x32_bf16 v[228:231], a[172:175], a[100:103], 0
ds_read_b64_tr_b16 a[148:149], v13 offset:40960
ds_read_b64_tr_b16 a[150:151], v13 offset:41472
v_mfma_f32_16x16x32_bf16 v[228:231], a[168:171], a[96:99], v[228:231]
v_mfma_f32_16x16x32_bf16 v[232:235], a[176:179], a[96:99], 0
v_mfma_f32_16x16x32_bf16 v[232:235], a[180:183], a[100:103], v[232:235]
buffer_load_dwordx4 v8, s[56:59], s64 offen offset:1024 lds
v_mfma_f32_16x16x32_bf16 v[236:239], a[188:191], a[100:103], 0
ds_read_b128 a[84:87], v10 offset:4096
v_mfma_f32_16x16x32_bf16 v[236:239], a[184:187], a[96:99], v[236:239]
v_mfma_f32_16x16x32_bf16 v[252:255], a[184:187], a[104:107], 0
s_add_u32 m0, s73, 69632
s_add_u32 s64, s71, 524288
v_mfma_f32_16x16x32_bf16 v[252:255], a[188:191], a[108:111], v[252:255]
ds_read_b64_tr_b16 a[152:153], v14 offset:32768
ds_read_b64_tr_b16 a[154:155], v14 offset:33280
v_mfma_f32_16x16x32_bf16 v[248:251], a[180:183], a[108:111], 0
buffer_load_dwordx4 v5, s[8:11], s64 offen lds
v_mfma_f32_16x16x32_bf16 v[248:251], a[176:179], a[104:107], v[248:251]
v_mfma_f32_16x16x32_bf16 v[244:247], a[168:171], a[104:107], 0
ds_read_b128 a[88:91], v9 offset:6144
v_mfma_f32_16x16x32_bf16 v[244:247], a[172:175], a[108:111], v[244:247]
v_mfma_f32_16x16x32_bf16 v[240:243], a[164:167], a[108:111], 0
v_mfma_f32_16x16x32_bf16 v[240:243], a[160:163], a[104:107], v[240:243]
buffer_load_dwordx4 v6, s[8:11], s64 offen offset:1024 lds
v_mfma_f32_16x16x32_bf16 a[0:3], a[160:163], a[112:115], 0
ds_read_b64_tr_b16 a[156:157], v14 offset:40960
ds_read_b64_tr_b16 a[158:159], v14 offset:41472
v_mfma_f32_16x16x32_bf16 a[0:3], a[164:167], a[116:119], a[0:3]
v_mfma_f32_16x16x32_bf16 a[4:7], a[172:175], a[116:119], 0
s_add_u32 m0, s73, 71680
s_add_u32 s64, s71, 540672
ds_read_b128 a[92:95], v10 offset:6144
v_mfma_f32_16x16x32_bf16 a[4:7], a[168:171], a[112:115], a[4:7]
v_mfma_f32_16x16x32_bf16 a[8:11], a[176:179], a[112:115], 0
buffer_load_dwordx4 v5, s[8:11], s64 offen lds
v_mfma_f32_16x16x32_bf16 a[8:11], a[180:183], a[116:119], a[8:11]
v_mfma_f32_16x16x32_bf16 a[12:15], a[188:191], a[116:119], 0
v_mfma_f32_16x16x32_bf16 a[12:15], a[184:187], a[112:115], a[12:15]
v_mfma_f32_16x16x32_bf16 a[28:31], a[184:187], a[120:123], 0
v_mfma_f32_16x16x32_bf16 a[28:31], a[188:191], a[124:127], a[28:31]
buffer_load_dwordx4 v6, s[8:11], s64 offen offset:1024 lds
v_mfma_f32_16x16x32_bf16 a[24:27], a[180:183], a[124:127], 0
v_mfma_f32_16x16x32_bf16 a[24:27], a[176:179], a[120:123], a[24:27]
v_mfma_f32_16x16x32_bf16 a[20:23], a[168:171], a[120:123], 0
v_mfma_f32_16x16x32_bf16 a[20:23], a[172:175], a[124:127], a[20:23]
v_mfma_f32_16x16x32_bf16 a[16:19], a[164:167], a[124:127], 0
v_mfma_f32_16x16x32_bf16 a[16:19], a[160:163], a[120:123], a[16:19]
s_waitcnt lgkmcnt(0)
v_mfma_f32_16x16x32_bf16 v[32:35], a[64:67], a[128:131], v[32:35]
s_waitcnt vmcnt(12)
v_mfma_f32_16x16x32_bf16 v[32:35], a[68:71], a[132:135], v[32:35]
s_barrier
v_mfma_f32_16x16x32_bf16 v[40:43], a[68:71], a[140:143], v[40:43]
ds_read_b128 a[96:99], v9 offset:8192
v_mfma_f32_16x16x32_bf16 v[40:43], a[64:67], a[136:139], v[40:43]
s_add_u32 m0, s77, 16384
s_add_u32 s64, s76, 0
v_mfma_f32_16x16x32_bf16 v[48:51], a[64:67], a[144:147], v[48:51]
buffer_load_dwordx4 v7, s[16:19], s64 offen lds
v_mfma_f32_16x16x32_bf16 v[48:51], a[68:71], a[148:151], v[48:51]
ds_read_b128 a[100:103], v10 offset:8192
v_mfma_f32_16x16x32_bf16 v[56:59], a[68:71], a[156:159], v[56:59]
v_mfma_f32_16x16x32_bf16 v[56:59], a[64:67], a[152:155], v[56:59]
v_mfma_f32_16x16x32_bf16 v[60:63], a[72:75], a[152:155], v[60:63]
buffer_load_dwordx4 v8, s[16:19], s64 offen offset:1024 lds
v_mfma_f32_16x16x32_bf16 v[60:63], a[76:79], a[156:159], v[60:63]
ds_read_b128 a[104:107], v9 offset:10240
v_mfma_f32_16x16x32_bf16 v[52:55], a[76:79], a[148:151], v[52:55]
v_mfma_f32_16x16x32_bf16 v[52:55], a[72:75], a[144:147], v[52:55]
s_add_u32 m0, s77, 18432
s_add_u32 s64, s76, 131072
v_mfma_f32_16x16x32_bf16 v[44:47], a[72:75], a[136:139], v[44:47]
ds_read_b64_tr_b16 a[160:161], v11 offset:49152
ds_read_b64_tr_b16 a[162:163], v11 offset:49664
v_mfma_f32_16x16x32_bf16 v[44:47], a[76:79], a[140:143], v[44:47]
buffer_load_dwordx4 v7, s[16:19], s64 offen lds
v_mfma_f32_16x16x32_bf16 v[36:39], a[76:79], a[132:135], v[36:39]
v_mfma_f32_16x16x32_bf16 v[36:39], a[72:75], a[128:131], v[36:39]
ds_read_b128 a[108:111], v10 offset:10240
v_mfma_f32_16x16x32_bf16 v[64:67], a[80:83], a[128:131], v[64:67]
v_mfma_f32_16x16x32_bf16 v[64:67], a[84:87], a[132:135], v[64:67]
v_mfma_f32_16x16x32_bf16 v[72:75], a[84:87], a[140:143], v[72:75]
buffer_load_dwordx4 v8, s[16:19], s64 offen offset:1024 lds
v_mfma_f32_16x16x32_bf16 v[72:75], a[80:83], a[136:139], v[72:75]
s_xor_b32 s71, s70, 384
s_add_u32 s71, s68, s71
v_mfma_f32_16x16x32_bf16 v[80:83], a[80:83], a[144:147], v[80:83]
ds_read_b64_tr_b16 a[164:165], v11 offset:57344
ds_read_b64_tr_b16 a[166:167], v11 offset:57856
v_mfma_f32_16x16x32_bf16 v[80:83], a[84:87], a[148:151], v[80:83]
s_add_u32 m0, s73, 0
s_add_u32 s64, s71, 0
ds_read_b128 a[112:115], v9 offset:12288
v_mfma_f32_16x16x32_bf16 v[88:91], a[84:87], a[156:159], v[88:91]
v_mfma_f32_16x16x32_bf16 v[88:91], a[80:83], a[152:155], v[88:91]
buffer_load_dwordx4 v5, s[8:11], s64 offen lds
v_mfma_f32_16x16x32_bf16 v[92:95], a[88:91], a[152:155], v[92:95]
ds_read_b64_tr_b16 a[168:169], v12 offset:49152
ds_read_b64_tr_b16 a[170:171], v12 offset:49664
v_mfma_f32_16x16x32_bf16 v[92:95], a[92:95], a[156:159], v[92:95]
v_mfma_f32_16x16x32_bf16 v[84:87], a[92:95], a[148:151], v[84:87]
v_mfma_f32_16x16x32_bf16 v[84:87], a[88:91], a[144:147], v[84:87]
v_mfma_f32_16x16x32_bf16 v[76:79], a[88:91], a[136:139], v[76:79]
buffer_load_dwordx4 v6, s[8:11], s64 offen offset:1024 lds
v_mfma_f32_16x16x32_bf16 v[76:79], a[92:95], a[140:143], v[76:79]
ds_read_b128 a[116:119], v10 offset:12288
v_mfma_f32_16x16x32_bf16 v[68:71], a[92:95], a[132:135], v[68:71]
v_mfma_f32_16x16x32_bf16 v[68:71], a[88:91], a[128:131], v[68:71]
s_add_u32 m0, s73, 2048
s_add_u32 s64, s71, 16384
s_waitcnt lgkmcnt(6)
v_mfma_f32_16x16x32_bf16 v[96:99], a[96:99], a[128:131], v[96:99]
ds_read_b64_tr_b16 a[172:173], v12 offset:57344
ds_read_b64_tr_b16 a[174:175], v12 offset:57856
v_mfma_f32_16x16x32_bf16 v[96:99], a[100:103], a[132:135], v[96:99]
buffer_load_dwordx4 v5, s[8:11], s64 offen lds
v_mfma_f32_16x16x32_bf16 v[104:107], a[100:103], a[140:143], v[104:107]
ds_read_b128 a[120:123], v9 offset:14336
v_mfma_f32_16x16x32_bf16 v[104:107], a[96:99], a[136:139], v[104:107]
v_mfma_f32_16x16x32_bf16 v[112:115], a[96:99], a[144:147], v[112:115]
v_mfma_f32_16x16x32_bf16 v[112:115], a[100:103], a[148:151], v[112:115]
buffer_load_dwordx4 v6, s[8:11], s64 offen offset:1024 lds
v_mfma_f32_16x16x32_bf16 v[120:123], a[100:103], a[156:159], v[120:123]
s_xor_b32 s76, s75, 1572864
s_add_u32 s76, s74, s76
v_mfma_f32_16x16x32_bf16 v[120:123], a[96:99], a[152:155], v[120:123]
ds_read_b64_tr_b16 a[176:177], v13 offset:49152
ds_read_b64_tr_b16 a[178:179], v13 offset:49664
v_mfma_f32_16x16x32_bf16 v[124:127], a[104:107], a[152:155], v[124:127]
s_add_u32 m0, s77, 32768
s_add_u32 s64, s76, 0
v_mfma_f32_16x16x32_bf16 v[124:127], a[108:111], a[156:159], v[124:127]
ds_read_b128 a[124:127], v10 offset:14336
v_mfma_f32_16x16x32_bf16 v[116:119], a[108:111], a[148:151], v[116:119]
buffer_load_dwordx4 v7, s[56:59], s64 offen lds
v_mfma_f32_16x16x32_bf16 v[116:119], a[104:107], a[144:147], v[116:119]
v_add_u32 v9, 32768, v9
v_add_u32 v10, 32768, v10
v_mfma_f32_16x16x32_bf16 v[108:111], a[104:107], a[136:139], v[108:111]
ds_read_b64_tr_b16 a[180:181], v13 offset:57344
ds_read_b64_tr_b16 a[182:183], v13 offset:57856
v_mfma_f32_16x16x32_bf16 v[108:111], a[108:111], a[140:143], v[108:111]
v_mfma_f32_16x16x32_bf16 v[100:103], a[108:111], a[132:135], v[100:103]
s_waitcnt lgkmcnt(2)
v_mfma_f32_16x16x32_bf16 v[100:103], a[104:107], a[128:131], v[100:103]
buffer_load_dwordx4 v8, s[56:59], s64 offen offset:1024 lds
v_mfma_f32_16x16x32_bf16 v[128:131], a[112:115], a[128:131], v[128:131]
ds_read_b64_tr_b16 a[184:185], v14 offset:49152
ds_read_b64_tr_b16 a[186:187], v14 offset:49664
v_mfma_f32_16x16x32_bf16 v[128:131], a[116:119], a[132:135], v[128:131]
v_mfma_f32_16x16x32_bf16 v[136:139], a[116:119], a[140:143], v[136:139]
s_add_u32 m0, s77, 34816
s_add_u32 s64, s76, 131072
v_mfma_f32_16x16x32_bf16 v[136:139], a[112:115], a[136:139], v[136:139]
ds_read_b64_tr_b16 a[188:189], v14 offset:57344
ds_read_b64_tr_b16 a[190:191], v14 offset:57856
v_mfma_f32_16x16x32_bf16 v[144:147], a[112:115], a[144:147], v[144:147]
buffer_load_dwordx4 v7, s[56:59], s64 offen lds
v_mfma_f32_16x16x32_bf16 v[144:147], a[116:119], a[148:151], v[144:147]
v_mfma_f32_16x16x32_bf16 v[152:155], a[116:119], a[156:159], v[152:155]
v_mfma_f32_16x16x32_bf16 v[152:155], a[112:115], a[152:155], v[152:155]
v_mfma_f32_16x16x32_bf16 v[156:159], a[120:123], a[152:155], v[156:159]
v_mfma_f32_16x16x32_bf16 v[156:159], a[124:127], a[156:159], v[156:159]
buffer_load_dwordx4 v8, s[56:59], s64 offen offset:1024 lds
v_mfma_f32_16x16x32_bf16 v[148:151], a[124:127], a[148:151], v[148:151]
v_mfma_f32_16x16x32_bf16 v[148:151], a[120:123], a[144:147], v[148:151]
v_mfma_f32_16x16x32_bf16 v[140:143], a[120:123], a[136:139], v[140:143]
v_mfma_f32_16x16x32_bf16 v[140:143], a[124:127], a[140:143], v[140:143]
v_mfma_f32_16x16x32_bf16 v[132:135], a[124:127], a[132:135], v[132:135]
v_mfma_f32_16x16x32_bf16 v[132:135], a[120:123], a[128:131], v[132:135]
s_waitcnt lgkmcnt(0)
v_mfma_f32_16x16x32_bf16 v[160:163], a[160:163], a[64:67], v[160:163]
s_waitcnt vmcnt(12)
v_mfma_f32_16x16x32_bf16 v[160:163], a[164:167], a[68:71], v[160:163]
s_barrier
v_mfma_f32_16x16x32_bf16 v[164:167], a[172:175], a[68:71], v[164:167]
s_xor_b32 s52, s6, 31
ds_read_b64_tr_b16 a[128:129], v11 offset:0
ds_read_b64_tr_b16 a[130:131], v11 offset:512
v_mfma_f32_16x16x32_bf16 v[164:167], a[168:171], a[64:67], v[164:167]
s_add_u32 m0, s73, 4096
s_add_u32 s64, s71, 524288
s_mul_i32 s52, s52, 110592
v_mfma_f32_16x16x32_bf16 v[168:171], a[176:179], a[64:67], v[168:171]
buffer_load_dwordx4 v5, s[8:11], s64 offen lds
v_mfma_f32_16x16x32_bf16 v[168:171], a[180:183], a[68:71], v[168:171]
s_mul_i32 s53, s3, 27648
s_add_u32 s52, s52, s53
s_mul_i32 s53, s7, 144
v_mfma_f32_16x16x32_bf16 v[172:175], a[188:191], a[68:71], v[172:175]
s_add_u32 s52, s52, s53
v_mfma_f32_16x16x32_bf16 v[172:175], a[184:187], a[64:67], v[172:175]
ds_read_b128 a[64:67], v9 offset:0
v_mfma_f32_16x16x32_bf16 v[188:191], a[184:187], a[72:75], v[188:191]
buffer_load_dwordx4 v6, s[8:11], s64 offen offset:1024 lds
v_mfma_f32_16x16x32_bf16 v[188:191], a[188:191], a[76:79], v[188:191]
ds_read_b64_tr_b16 a[132:133], v11 offset:8192
ds_read_b64_tr_b16 a[134:135], v11 offset:8704
v_mfma_f32_16x16x32_bf16 v[184:187], a[180:183], a[76:79], v[184:187]
buffer_load_dword a252, v28, s[28:31], s52 offen
v_mfma_f32_16x16x32_bf16 v[184:187], a[176:179], a[72:75], v[184:187]
s_add_u32 m0, s73, 6144
s_add_u32 s64, s71, 540672
ds_read_b128 a[68:71], v10 offset:0
v_mfma_f32_16x16x32_bf16 v[180:183], a[168:171], a[72:75], v[180:183]
v_mfma_f32_16x16x32_bf16 v[180:183], a[172:175], a[76:79], v[180:183]
buffer_load_dwordx4 v5, s[8:11], s64 offen lds
v_mfma_f32_16x16x32_bf16 v[176:179], a[164:167], a[76:79], v[176:179]
v_mfma_f32_16x16x32_bf16 v[176:179], a[160:163], a[72:75], v[176:179]
ds_read_b64_tr_b16 a[136:137], v12 offset:0
ds_read_b64_tr_b16 a[138:139], v12 offset:512
v_mfma_f32_16x16x32_bf16 v[192:195], a[160:163], a[80:83], v[192:195]
v_mfma_f32_16x16x32_bf16 v[192:195], a[164:167], a[84:87], v[192:195]
v_mfma_f32_16x16x32_bf16 v[196:199], a[172:175], a[84:87], v[196:199]
buffer_load_dwordx4 v6, s[8:11], s64 offen offset:1024 lds
v_mfma_f32_16x16x32_bf16 v[196:199], a[168:171], a[80:83], v[196:199]
ds_read_b128 a[72:75], v9 offset:2048
v_mfma_f32_16x16x32_bf16 v[200:203], a[176:179], a[80:83], v[200:203]
v_mfma_f32_16x16x32_bf16 v[200:203], a[180:183], a[84:87], v[200:203]
s_add_u32 m0, s77, 49152
s_add_u32 s64, s76, 0
v_mfma_f32_16x16x32_bf16 v[204:207], a[188:191], a[84:87], v[204:207]
ds_read_b64_tr_b16 a[140:141], v12 offset:8192
ds_read_b64_tr_b16 a[142:143], v12 offset:8704
v_mfma_f32_16x16x32_bf16 v[204:207], a[184:187], a[80:83], v[204:207]
buffer_load_dwordx4 v7, s[16:19], s64 offen lds
v_mfma_f32_16x16x32_bf16 v[220:223], a[184:187], a[88:91], v[220:223]
ds_read_b128 a[76:79], v10 offset:2048
v_mfma_f32_16x16x32_bf16 v[220:223], a[188:191], a[92:95], v[220:223]
v_mfma_f32_16x16x32_bf16 v[216:219], a[180:183], a[92:95], v[216:219]
v_mfma_f32_16x16x32_bf16 v[216:219], a[176:179], a[88:91], v[216:219]
v_mfma_f32_16x16x32_bf16 v[212:215], a[168:171], a[88:91], v[212:215]
buffer_load_dwordx4 v8, s[16:19], s64 offen offset:1024 lds
v_mfma_f32_16x16x32_bf16 v[212:215], a[172:175], a[92:95], v[212:215]
ds_read_b64_tr_b16 a[144:145], v13 offset:0
ds_read_b64_tr_b16 a[146:147], v13 offset:512
v_mfma_f32_16x16x32_bf16 v[208:211], a[164:167], a[92:95], v[208:211]
v_mfma_f32_16x16x32_bf16 v[208:211], a[160:163], a[88:91], v[208:211]
s_add_u32 m0, s77, 51200
s_add_u32 s64, s76, 131072
ds_read_b128 a[80:83], v9 offset:4096
v_mfma_f32_16x16x32_bf16 v[224:227], a[160:163], a[96:99], v[224:227]
v_mfma_f32_16x16x32_bf16 v[224:227], a[164:167], a[100:103], v[224:227]
buffer_load_dwordx4 v7, s[16:19], s64 offen lds
v_mfma_f32_16x16x32_bf16 v[228:231], a[172:175], a[100:103], v[228:231]
ds_read_b64_tr_b16 a[148:149], v13 offset:8192
ds_read_b64_tr_b16 a[150:151], v13 offset:8704
v_mfma_f32_16x16x32_bf16 v[228:231], a[168:171], a[96:99], v[228:231]
v_mfma_f32_16x16x32_bf16 v[232:235], a[176:179], a[96:99], v[232:235]
v_mfma_f32_16x16x32_bf16 v[232:235], a[180:183], a[100:103], v[232:235]
buffer_load_dwordx4 v8, s[16:19], s64 offen offset:1024 lds
v_mfma_f32_16x16x32_bf16 v[236:239], a[188:191], a[100:103], v[236:239]
s_xor_b32 s71, s70, 512
s_add_u32 s71, s68, s71
ds_read_b128 a[84:87], v10 offset:4096
v_mfma_f32_16x16x32_bf16 v[236:239], a[184:187], a[96:99], v[236:239]
v_mfma_f32_16x16x32_bf16 v[252:255], a[184:187], a[104:107], v[252:255]
s_add_u32 m0, s73, 32768
s_add_u32 s64, s71, 0
v_mfma_f32_16x16x32_bf16 v[252:255], a[188:191], a[108:111], v[252:255]
ds_read_b64_tr_b16 a[152:153], v14 offset:0
ds_read_b64_tr_b16 a[154:155], v14 offset:512
v_mfma_f32_16x16x32_bf16 v[248:251], a[180:183], a[108:111], v[248:251]
buffer_load_dwordx4 v5, s[8:11], s64 offen lds
v_mfma_f32_16x16x32_bf16 v[248:251], a[176:179], a[104:107], v[248:251]
v_mfma_f32_16x16x32_bf16 v[244:247], a[168:171], a[104:107], v[244:247]
ds_read_b128 a[88:91], v9 offset:6144
v_mfma_f32_16x16x32_bf16 v[244:247], a[172:175], a[108:111], v[244:247]
v_mfma_f32_16x16x32_bf16 v[240:243], a[164:167], a[108:111], v[240:243]
v_mfma_f32_16x16x32_bf16 v[240:243], a[160:163], a[104:107], v[240:243]
buffer_load_dwordx4 v6, s[8:11], s64 offen offset:1024 lds
v_mfma_f32_16x16x32_bf16 a[0:3], a[160:163], a[112:115], a[0:3]
ds_read_b64_tr_b16 a[156:157], v14 offset:8192
ds_read_b64_tr_b16 a[158:159], v14 offset:8704
v_mfma_f32_16x16x32_bf16 a[0:3], a[164:167], a[116:119], a[0:3]
v_mfma_f32_16x16x32_bf16 a[4:7], a[172:175], a[116:119], a[4:7]
s_add_u32 m0, s73, 34816
s_add_u32 s64, s71, 16384
ds_read_b128 a[92:95], v10 offset:6144
v_mfma_f32_16x16x32_bf16 a[4:7], a[168:171], a[112:115], a[4:7]
v_mfma_f32_16x16x32_bf16 a[8:11], a[176:179], a[112:115], a[8:11]
buffer_load_dwordx4 v5, s[8:11], s64 offen lds
v_mfma_f32_16x16x32_bf16 a[8:11], a[180:183], a[116:119], a[8:11]
v_mfma_f32_16x16x32_bf16 a[12:15], a[188:191], a[116:119], a[12:15]
v_mfma_f32_16x16x32_bf16 a[12:15], a[184:187], a[112:115], a[12:15]
v_mfma_f32_16x16x32_bf16 a[28:31], a[184:187], a[120:123], a[28:31]
v_mfma_f32_16x16x32_bf16 a[28:31], a[188:191], a[124:127], a[28:31]
buffer_load_dwordx4 v6, s[8:11], s64 offen offset:1024 lds
v_mfma_f32_16x16x32_bf16 a[24:27], a[180:183], a[124:127], a[24:27]
v_mfma_f32_16x16x32_bf16 a[24:27], a[176:179], a[120:123], a[24:27]
v_mfma_f32_16x16x32_bf16 a[20:23], a[168:171], a[120:123], a[20:23]
v_mfma_f32_16x16x32_bf16 a[20:23], a[172:175], a[124:127], a[20:23]
v_mfma_f32_16x16x32_bf16 a[16:19], a[164:167], a[124:127], a[16:19]
v_mfma_f32_16x16x32_bf16 a[16:19], a[160:163], a[120:123], a[16:19]
s_waitcnt lgkmcnt(0)
v_mfma_f32_16x16x32_bf16 v[32:35], a[64:67], a[128:131], v[32:35]
s_waitcnt vmcnt(21)
v_mfma_f32_16x16x32_bf16 v[32:35], a[68:71], a[132:135], v[32:35]
s_barrier
v_mfma_f32_16x16x32_bf16 v[40:43], a[68:71], a[140:143], v[40:43]
ds_read_b128 a[96:99], v9 offset:8192
v_mfma_f32_16x16x32_bf16 v[40:43], a[64:67], a[136:139], v[40:43]
s_xor_b32 s76, s75, 2097152
s_add_u32 s76, s74, s76
v_mfma_f32_16x16x32_bf16 v[48:51], a[64:67], a[144:147], v[48:51]
s_add_u32 m0, s77, 0
s_add_u32 s64, s76, 0
v_mfma_f32_16x16x32_bf16 v[48:51], a[68:71], a[148:151], v[48:51]
buffer_load_dwordx4 v7, s[56:59], s64 offen lds
v_mfma_f32_16x16x32_bf16 v[56:59], a[68:71], a[156:159], v[56:59]
ds_read_b128 a[100:103], v10 offset:8192
v_mfma_f32_16x16x32_bf16 v[56:59], a[64:67], a[152:155], v[56:59]
v_mfma_f32_16x16x32_bf16 v[60:63], a[72:75], a[152:155], v[60:63]
ds_read_b128 a[104:107], v9 offset:10240
v_mfma_f32_16x16x32_bf16 v[60:63], a[76:79], a[156:159], v[60:63]
v_mfma_f32_16x16x32_bf16 v[52:55], a[76:79], a[148:151], v[52:55]
v_mfma_f32_16x16x32_bf16 v[52:55], a[72:75], a[144:147], v[52:55]
buffer_load_dwordx4 v8, s[56:59], s64 offen offset:1024 lds
v_mfma_f32_16x16x32_bf16 v[44:47], a[72:75], a[136:139], v[44:47]
ds_read_b64_tr_b16 a[160:161], v11 offset:16384
ds_read_b64_tr_b16 a[162:163], v11 offset:16896
v_mfma_f32_16x16x32_bf16 v[44:47], a[76:79], a[140:143], v[44:47]
v_mfma_f32_16x16x32_bf16 v[36:39], a[76:79], a[132:135], v[36:39]
v_mfma_f32_16x16x32_bf16 v[36:39], a[72:75], a[128:131], v[36:39]
ds_read_b128 a[108:111], v10 offset:10240
v_mfma_f32_16x16x32_bf16 v[64:67], a[80:83], a[128:131], v[64:67]
s_add_u32 m0, s77, 2048
s_add_u32 s64, s76, 131072
v_mfma_f32_16x16x32_bf16 v[64:67], a[84:87], a[132:135], v[64:67]
v_mfma_f32_16x16x32_bf16 v[72:75], a[84:87], a[140:143], v[72:75]
buffer_load_dwordx4 v7, s[56:59], s64 offen lds
v_mfma_f32_16x16x32_bf16 v[72:75], a[80:83], a[136:139], v[72:75]
ds_read_b64_tr_b16 a[164:165], v11 offset:24576
ds_read_b64_tr_b16 a[166:167], v11 offset:25088
v_mfma_f32_16x16x32_bf16 v[80:83], a[80:83], a[144:147], v[80:83]
v_mfma_f32_16x16x32_bf16 v[80:83], a[84:87], a[148:151], v[80:83]
ds_read_b128 a[112:115], v9 offset:12288
v_mfma_f32_16x16x32_bf16 v[88:91], a[84:87], a[156:159], v[88:91]
v_mfma_f32_16x16x32_bf16 v[88:91], a[80:83], a[152:155], v[88:91]
v_mfma_f32_16x16x32_bf16 v[92:95], a[88:91], a[152:155], v[92:95]
ds_read_b64_tr_b16 a[168:169], v12 offset:16384
ds_read_b64_tr_b16 a[170:171], v12 offset:16896
v_mfma_f32_16x16x32_bf16 v[92:95], a[92:95], a[156:159], v[92:95]
buffer_load_dwordx4 v8, s[56:59], s64 offen offset:1024 lds
v_mfma_f32_16x16x32_bf16 v[84:87], a[92:95], a[148:151], v[84:87]
v_mfma_f32_16x16x32_bf16 v[84:87], a[88:91], a[144:147], v[84:87]
v_mfma_f32_16x16x32_bf16 v[76:79], a[88:91], a[136:139], v[76:79]
ds_read_b128 a[116:119], v10 offset:12288
v_mfma_f32_16x16x32_bf16 v[76:79], a[92:95], a[140:143], v[76:79]
v_mfma_f32_16x16x32_bf16 v[68:71], a[92:95], a[132:135], v[68:71]
v_mfma_f32_16x16x32_bf16 v[68:71], a[88:91], a[128:131], v[68:71]
s_add_u32 m0, s73, 36864
s_add_u32 s64, s71, 524288
s_waitcnt lgkmcnt(6)
v_mfma_f32_16x16x32_bf16 v[96:99], a[96:99], a[128:131], v[96:99]
ds_read_b64_tr_b16 a[172:173], v12 offset:24576
ds_read_b64_tr_b16 a[174:175], v12 offset:25088
v_mfma_f32_16x16x32_bf16 v[96:99], a[100:103], a[132:135], v[96:99]
buffer_load_dwordx4 v5, s[8:11], s64 offen lds
v_mfma_f32_16x16x32_bf16 v[104:107], a[100:103], a[140:143], v[104:107]
ds_read_b128 a[120:123], v9 offset:14336
v_mfma_f32_16x16x32_bf16 v[104:107], a[96:99], a[136:139], v[104:107]
v_mfma_f32_16x16x32_bf16 v[112:115], a[96:99], a[144:147], v[112:115]
v_mfma_f32_16x16x32_bf16 v[112:115], a[100:103], a[148:151], v[112:115]
ds_read_b64_tr_b16 a[176:177], v13 offset:16384
ds_read_b64_tr_b16 a[178:179], v13 offset:16896
v_mfma_f32_16x16x32_bf16 v[120:123], a[100:103], a[156:159], v[120:123]
v_mfma_f32_16x16x32_bf16 v[120:123], a[96:99], a[152:155], v[120:123]
v_mfma_f32_16x16x32_bf16 v[124:127], a[104:107], a[152:155], v[124:127]
buffer_load_dwordx4 v6, s[8:11], s64 offen offset:1024 lds
v_mfma_f32_16x16x32_bf16 v[124:127], a[108:111], a[156:159], v[124:127]
ds_read_b128 a[124:127], v10 offset:14336
v_mfma_f32_16x16x32_bf16 v[116:119], a[108:111], a[148:151], v[116:119]
v_add_u32 v9, -65536, v9
v_add_u32 v10, -65536, v10
v_mfma_f32_16x16x32_bf16 v[116:119], a[104:107], a[144:147], v[116:119]
v_mfma_f32_16x16x32_bf16 v[108:111], a[104:107], a[136:139], v[108:111]
ds_read_b64_tr_b16 a[180:181], v13 offset:24576
ds_read_b64_tr_b16 a[182:183], v13 offset:25088
v_mfma_f32_16x16x32_bf16 v[108:111], a[108:111], a[140:143], v[108:111]
s_add_u32 m0, s73, 38912
s_add_u32 s64, s71, 540672
v_mfma_f32_16x16x32_bf16 v[100:103], a[108:111], a[132:135], v[100:103]
s_waitcnt lgkmcnt(2)
v_mfma_f32_16x16x32_bf16 v[100:103], a[104:107], a[128:131], v[100:103]
buffer_load_dwordx4 v5, s[8:11], s64 offen lds
v_mfma_f32_16x16x32_bf16 v[128:131], a[112:115], a[128:131], v[128:131]
ds_read_b64_tr_b16 a[184:185], v14 offset:16384
ds_read_b64_tr_b16 a[186:187], v14 offset:16896
v_mfma_f32_16x16x32_bf16 v[128:131], a[116:119], a[132:135], v[128:131]
v_mfma_f32_16x16x32_bf16 v[136:139], a[116:119], a[140:143], v[136:139]
ds_read_b64_tr_b16 a[188:189], v14 offset:24576
ds_read_b64_tr_b16 a[190:191], v14 offset:25088
v_mfma_f32_16x16x32_bf16 v[136:139], a[112:115], a[136:139], v[136:139]
v_mfma_f32_16x16x32_bf16 v[144:147], a[112:115], a[144:147], v[144:147]
v_mfma_f32_16x16x32_bf16 v[144:147], a[116:119], a[148:151], v[144:147]
v_mfma_f32_16x16x32_bf16 v[152:155], a[116:119], a[156:159], v[152:155]
buffer_load_dwordx4 v6, s[8:11], s64 offen offset:1024 lds
v_mfma_f32_16x16x32_bf16 v[152:155], a[112:115], a[152:155], v[152:155]
L_PAD1:
s_cbranch_execz L_PAD5
v_mfma_f32_16x16x32_bf16 v[156:159], a[120:123], a[152:155], v[156:159]
v_mfma_f32_16x16x32_bf16 v[156:159], a[124:127], a[156:159], v[156:159]
v_mfma_f32_16x16x32_bf16 v[148:151], a[124:127], a[148:151], v[148:151]
v_mfma_f32_16x16x32_bf16 v[148:151], a[120:123], a[144:147], v[148:151]
v_mfma_f32_16x16x32_bf16 v[140:143], a[120:123], a[136:139], v[140:143]
v_mfma_f32_16x16x32_bf16 v[140:143], a[124:127], a[140:143], v[140:143]
v_mfma_f32_16x16x32_bf16 v[132:135], a[124:127], a[132:135], v[132:135]
v_mfma_f32_16x16x32_bf16 v[132:135], a[120:123], a[128:131], v[132:135]
s_waitcnt lgkmcnt(0)
v_mfma_f32_16x16x32_bf16 v[160:163], a[160:163], a[64:67], v[160:163]
s_waitcnt vmcnt(16)
v_mfma_f32_16x16x32_bf16 v[160:163], a[164:167], a[68:71], v[160:163]
s_barrier
v_mfma_f32_16x16x32_bf16 v[164:167], a[172:175], a[68:71], v[164:167]
s_add_u32 s52, s81, 0
ds_read_b64_tr_b16 a[128:129], v11 offset:32768
ds_read_b64_tr_b16 a[130:131], v11 offset:33280
v_mfma_f32_16x16x32_bf16 v[164:167], a[168:171], a[64:67], v[164:167]
s_add_u32 m0, s77, 16384
s_add_u32 s64, s76, 0
v_mfma_f32_16x16x32_bf16 v[168:171], a[176:179], a[64:67], v[168:171]
buffer_load_dwordx4 v7, s[16:19], s64 offen lds
v_mfma_f32_16x16x32_bf16 v[168:171], a[180:183], a[68:71], v[168:171]
buffer_load_dwordx2 a[192:193], v26, s[28:31], s52 offen
v_mfma_f32_16x16x32_bf16 v[172:175], a[188:191], a[68:71], v[172:175]
v_mfma_f32_16x16x32_bf16 v[172:175], a[184:187], a[64:67], v[172:175]
ds_read_b128 a[64:67], v9 offset:0
v_mfma_f32_16x16x32_bf16 v[188:191], a[184:187], a[72:75], v[188:191]
ds_read_b64_tr_b16 a[132:133], v11 offset:40960
ds_read_b64_tr_b16 a[134:135], v11 offset:41472
v_mfma_f32_16x16x32_bf16 v[188:191], a[188:191], a[76:79], v[188:191]
v_mfma_f32_16x16x32_bf16 v[184:187], a[180:183], a[76:79], v[184:187]
s_add_u32 s52, s81, 3456
v_mfma_f32_16x16x32_bf16 v[184:187], a[176:179], a[72:75], v[184:187]
buffer_load_dwordx4 v8, s[16:19], s64 offen offset:1024 lds
v_mfma_f32_16x16x32_bf16 v[180:183], a[168:171], a[72:75], v[180:183]
ds_read_b128 a[68:71], v10 offset:0
v_mfma_f32_16x16x32_bf16 v[180:183], a[172:175], a[76:79], v[180:183]
buffer_load_dwordx2 a[194:195], v26, s[28:31], s52 offen
v_mfma_f32_16x16x32_bf16 v[176:179], a[164:167], a[76:79], v[176:179]
v_mfma_f32_16x16x32_bf16 v[176:179], a[160:163], a[72:75], v[176:179]
ds_read_b64_tr_b16 a[136:137], v12 offset:32768
ds_read_b64_tr_b16 a[138:139], v12 offset:33280
v_mfma_f32_16x16x32_bf16 v[192:195], a[160:163], a[80:83], v[192:195]
s_add_u32 m0, s77, 18432
s_add_u32 s64, s76, 131072
v_mfma_f32_16x16x32_bf16 v[192:195], a[164:167], a[84:87], v[192:195]
v_mfma_f32_16x16x32_bf16 v[196:199], a[172:175], a[84:87], v[196:199]
buffer_load_dwordx4 v7, s[16:19], s64 offen lds
v_mfma_f32_16x16x32_bf16 v[196:199], a[168:171], a[80:83], v[196:199]
s_add_u32 s52, s81, 6912
ds_read_b128 a[72:75], v9 offset:2048
v_mfma_f32_16x16x32_bf16 v[200:203], a[176:179], a[80:83], v[200:203]
buffer_load_dwordx2 a[196:197], v26, s[28:31], s52 offen
v_mfma_f32_16x16x32_bf16 v[200:203], a[180:183], a[84:87], v[200:203]
ds_read_b64_tr_b16 a[140:141], v12 offset:40960
ds_read_b64_tr_b16 a[142:143], v12 offset:41472
v_mfma_f32_16x16x32_bf16 v[204:207], a[188:191], a[84:87], v[204:207]
v_mfma_f32_16x16x32_bf16 v[204:207], a[184:187], a[80:83], v[204:207]
v_mfma_f32_16x16x32_bf16 v[220:223], a[184:187], a[88:91], v[220:223]
ds_read_b128 a[76:79], v10 offset:2048
v_mfma_f32_16x16x32_bf16 v[220:223], a[188:191], a[92:95], v[220:223]
buffer_load_dwordx4 v8, s[16:19], s64 offen offset:1024 lds
v_mfma_f32_16x16x32_bf16 v[216:219], a[180:183], a[92:95], v[216:219]
s_xor_b32 s71, s70, 640
s_add_u32 s71, s68, s71
s_add_u32 s52, s81, 10368
v_mfma_f32_16x16x32_bf16 v[216:219], a[176:179], a[88:91], v[216:219]
buffer_load_dwordx2 a[198:199], v26, s[28:31], s52 offen
v_mfma_f32_16x16x32_bf16 v[212:215], a[168:171], a[88:91], v[212:215]
ds_read_b64_tr_b16 a[144:145], v13 offset:32768
ds_read_b64_tr_b16 a[146:147], v13 offset:33280
v_mfma_f32_16x16x32_bf16 v[212:215], a[172:175], a[92:95], v[212:215]
v_mfma_f32_16x16x32_bf16 v[208:211], a[164:167], a[92:95], v[208:211]
v_mfma_f32_16x16x32_bf16 v[208:211], a[160:163], a[88:91], v[208:211]
s_add_u32 m0, s73, 65536
s_add_u32 s64, s71, 0
ds_read_b128 a[80:83], v9 offset:4096
v_mfma_f32_16x16x32_bf16 v[224:227], a[160:163], a[96:99], v[224:227]
s_add_u32 s52, s81, 13824
v_mfma_f32_16x16x32_bf16 v[224:227], a[164:167], a[100:103], v[224:227]
buffer_load_dwordx4 v5, s[8:11], s64 offen lds
v_mfma_f32_16x16x32_bf16 v[228:231], a[172:175], a[100:103], v[228:231]
ds_read_b64_tr_b16 a[148:149], v13 offset:40960
ds_read_b64_tr_b16 a[150:151], v13 offset:41472
v_mfma_f32_16x16x32_bf16 v[228:231], a[168:171], a[96:99], v[228:231]
buffer_load_dwordx2 a[200:201], v26, s[28:31], s52 offen
v_mfma_f32_16x16x32_bf16 v[232:235], a[176:179], a[96:99], v[232:235]
v_mfma_f32_16x16x32_bf16 v[232:235], a[180:183], a[100:103], v[232:235]
ds_read_b128 a[84:87], v10 offset:4096
v_mfma_f32_16x16x32_bf16 v[236:239], a[188:191], a[100:103], v[236:239]
v_mfma_f32_16x16x32_bf16 v[236:239], a[184:187], a[96:99], v[236:239]
v_mfma_f32_16x16x32_bf16 v[252:255], a[184:187], a[104:107], v[252:255]
buffer_load_dwordx4 v6, s[8:11], s64 offen offset:1024 lds
v_mfma_f32_16x16x32_bf16 v[252:255], a[188:191], a[108:111], v[252:255]
s_add_u32 s52, s81, 17280
ds_read_b64_tr_b16 a[152:153], v14 offset:32768
ds_read_b64_tr_b16 a[154:155], v14 offset:33280
v_mfma_f32_16x16x32_bf16 v[248:251], a[180:183], a[108:111], v[248:251]
buffer_load_dwordx2 a[202:203], v26, s[28:31], s52 offen
v_mfma_f32_16x16x32_bf16 v[248:251], a[176:179], a[104:107], v[248:251]
v_mfma_f32_16x16x32_bf16 v[244:247], a[168:171], a[104:107], v[244:247]
ds_read_b128 a[88:91], v9 offset:6144
v_mfma_f32_16x16x32_bf16 v[244:247], a[172:175], a[108:111], v[244:247]
s_add_u32 m0, s73, 67584
s_add_u32 s64, s71, 16384
v_mfma_f32_16x16x32_bf16 v[240:243], a[164:167], a[108:111], v[240:243]
v_mfma_f32_16x16x32_bf16 v[240:243], a[160:163], a[104:107], v[240:243]
buffer_load_dwordx4 v5, s[8:11], s64 offen lds
v_mfma_f32_16x16x32_bf16 a[0:3], a[160:163], a[112:115], a[0:3]
s_add_u32 s52, s81, 20736
ds_read_b64_tr_b16 a[156:157], v14 offset:40960
ds_read_b64_tr_b16 a[158:159], v14 offset:41472
v_mfma_f32_16x16x32_bf16 a[0:3], a[164:167], a[116:119], a[0:3]
buffer_load_dwordx2 a[204:205], v26, s[28:31], s52 offen
v_mfma_f32_16x16x32_bf16 a[4:7], a[172:175], a[116:119], a[4:7]
ds_read_b128 a[92:95], v10 offset:6144
v_mfma_f32_16x16x32_bf16 a[4:7], a[168:171], a[112:115], a[4:7]
v_mfma_f32_16x16x32_bf16 a[8:11], a[176:179], a[112:115], a[8:11]
v_mfma_f32_16x16x32_bf16 a[8:11], a[180:183], a[116:119], a[8:11]
v_mfma_f32_16x16x32_bf16 a[12:15], a[188:191], a[116:119], a[12:15]
buffer_load_dwordx4 v6, s[8:11], s64 offen offset:1024 lds
v_mfma_f32_16x16x32_bf16 a[12:15], a[184:187], a[112:115], a[12:15]
s_add_u32 s52, s81, 24192
v_mfma_f32_16x16x32_bf16 a[28:31], a[184:187], a[120:123], a[28:31]
buffer_load_dwordx2 a[206:207], v26, s[28:31], s52 offen
v_mfma_f32_16x16x32_bf16 a[28:31], a[188:191], a[124:127], a[28:31]
v_mfma_f32_16x16x32_bf16 a[24:27], a[180:183], a[124:127], a[24:27]
v_mfma_f32_16x16x32_bf16 a[24:27], a[176:179], a[120:123], a[24:27]
v_mfma_f32_16x16x32_bf16 a[20:23], a[168:171], a[120:123], a[20:23]
v_mfma_f32_16x16x32_bf16 a[20:23], a[172:175], a[124:127], a[20:23]
buffer_load_dwordx4 a[208:211], v27, s[36:39], s83 offen
v_mfma_f32_16x16x32_bf16 a[16:19], a[164:167], a[124:127], a[16:19]
v_mfma_f32_16x16x32_bf16 a[16:19], a[160:163], a[120:123], a[16:19]
s_waitcnt lgkmcnt(0)
v_mfma_f32_16x16x32_bf16 v[32:35], a[64:67], a[128:131], v[32:35]
s_waitcnt vmcnt(29)
v_mfma_f32_16x16x32_bf16 v[32:35], a[68:71], a[132:135], v[32:35]
s_barrier
v_mfma_f32_16x16x32_bf16 v[40:43], a[68:71], a[140:143], v[40:43]
ds_read_b128 a[96:99], v9 offset:8192
v_mfma_f32_16x16x32_bf16 v[40:43], a[64:67], a[136:139], v[40:43]
s_xor_b32 s76, s75, 2621440
s_add_u32 s76, s74, s76
v_mfma_f32_16x16x32_bf16 v[48:51], a[64:67], a[144:147], v[48:51]
s_add_u32 m0, s77, 32768
s_add_u32 s64, s76, 0
v_mfma_f32_16x16x32_bf16 v[48:51], a[68:71], a[148:151], v[48:51]
buffer_load_dwordx4 v7, s[56:59], s64 offen lds
v_mfma_f32_16x16x32_bf16 v[56:59], a[68:71], a[156:159], v[56:59]
ds_read_b128 a[100:103], v10 offset:8192
v_mfma_f32_16x16x32_bf16 v[56:59], a[64:67], a[152:155], v[56:59]
v_mfma_f32_16x16x32_bf16 v[60:63], a[72:75], a[152:155], v[60:63]
ds_read_b128 a[104:107], v9 offset:10240
v_mfma_f32_16x16x32_bf16 v[60:63], a[76:79], a[156:159], v[60:63]
v_mfma_f32_16x16x32_bf16 v[52:55], a[76:79], a[148:151], v[52:55]
v_mfma_f32_16x16x32_bf16 v[52:55], a[72:75], a[144:147], v[52:55]
buffer_load_dwordx4 v8, s[56:59], s64 offen offset:1024 lds
v_mfma_f32_16x16x32_bf16 v[44:47], a[72:75], a[136:139], v[44:47]
ds_read_b64_tr_b16 a[160:161], v11 offset:49152
ds_read_b64_tr_b16 a[162:163], v11 offset:49664
v_mfma_f32_16x16x32_bf16 v[44:47], a[76:79], a[140:143], v[44:47]
v_mfma_f32_16x16x32_bf16 v[36:39], a[76:79], a[132:135], v[36:39]
v_mfma_f32_16x16x32_bf16 v[36:39], a[72:75], a[128:131], v[36:39]
ds_read_b128 a[108:111], v10 offset:10240
v_mfma_f32_16x16x32_bf16 v[64:67], a[80:83], a[128:131], v[64:67]
s_add_u32 m0, s77, 34816
s_add_u32 s64, s76, 131072
v_mfma_f32_16x16x32_bf16 v[64:67], a[84:87], a[132:135], v[64:67]
v_mfma_f32_16x16x32_bf16 v[72:75], a[84:87], a[140:143], v[72:75]
buffer_load_dwordx4 v7, s[56:59], s64 offen lds
v_mfma_f32_16x16x32_bf16 v[72:75], a[80:83], a[136:139], v[72:75]
ds_read_b64_tr_b16 a[164:165], v11 offset:57344
ds_read_b64_tr_b16 a[166:167], v11 offset:57856
v_mfma_f32_16x16x32_bf16 v[80:83], a[80:83], a[144:147], v[80:83]
v_mfma_f32_16x16x32_bf16 v[80:83], a[84:87], a[148:151], v[80:83]
ds_read_b128 a[112:115], v9 offset:12288
v_mfma_f32_16x16x32_bf16 v[88:91], a[84:87], a[156:159], v[88:91]
v_mfma_f32_16x16x32_bf16 v[88:91], a[80:83], a[152:155], v[88:91]
v_mfma_f32_16x16x32_bf16 v[92:95], a[88:91], a[152:155], v[92:95]
ds_read_b64_tr_b16 a[168:169], v12 offset:49152
ds_read_b64_tr_b16 a[170:171], v12 offset:49664
v_mfma_f32_16x16x32_bf16 v[92:95], a[92:95], a[156:159], v[92:95]
buffer_load_dwordx4 v8, s[56:59], s64 offen offset:1024 lds
v_mfma_f32_16x16x32_bf16 v[84:87], a[92:95], a[148:151], v[84:87]
v_mfma_f32_16x16x32_bf16 v[84:87], a[88:91], a[144:147], v[84:87]
v_mfma_f32_16x16x32_bf16 v[76:79], a[88:91], a[136:139], v[76:79]
ds_read_b128 a[116:119], v10 offset:12288
v_mfma_f32_16x16x32_bf16 v[76:79], a[92:95], a[140:143], v[76:79]
v_mfma_f32_16x16x32_bf16 v[68:71], a[92:95], a[132:135], v[68:71]
v_mfma_f32_16x16x32_bf16 v[68:71], a[88:91], a[128:131], v[68:71]
s_add_u32 m0, s73, 69632
s_add_u32 s64, s71, 524288
s_waitcnt lgkmcnt(6)
v_mfma_f32_16x16x32_bf16 v[96:99], a[96:99], a[128:131], v[96:99]
ds_read_b64_tr_b16 a[172:173], v12 offset:57344
ds_read_b64_tr_b16 a[174:175], v12 offset:57856
v_mfma_f32_16x16x32_bf16 v[96:99], a[100:103], a[132:135], v[96:99]
buffer_load_dwordx4 v5, s[8:11], s64 offen lds
v_mfma_f32_16x16x32_bf16 v[104:107], a[100:103], a[140:143], v[104:107]
ds_read_b128 a[120:123], v9 offset:14336
v_mfma_f32_16x16x32_bf16 v[104:107], a[96:99], a[136:139], v[104:107]
v_mfma_f32_16x16x32_bf16 v[112:115], a[96:99], a[144:147], v[112:115]
v_mfma_f32_16x16x32_bf16 v[112:115], a[100:103], a[148:151], v[112:115]
s_waitcnt vmcnt(5)
ds_read_b64_tr_b16 a[176:177], v13 offset:49152
ds_read_b64_tr_b16 a[178:179], v13 offset:49664
v_mfma_f32_16x16x32_bf16 v[120:123], a[100:103], a[156:159], v[120:123]
v_accvgpr_read_b32 v16, a192
v_accvgpr_read_b32 v17, a194
v_mfma_f32_16x16x32_bf16 v[120:123], a[96:99], a[152:155], v[120:123]
v_accvgpr_read_b32 v18, a196
v_accvgpr_read_b32 v19, a198
v_mfma_f32_16x16x32_bf16 v[124:127], a[104:107], a[152:155], v[124:127]
buffer_load_dwordx4 v6, s[8:11], s64 offen offset:1024 lds
v_mfma_f32_16x16x32_bf16 v[124:127], a[108:111], a[156:159], v[124:127]
ds_read_b128 a[124:127], v10 offset:14336
v_accvgpr_read_b32 v20, a200
v_mfma_f32_16x16x32_bf16 v[116:119], a[108:111], a[148:151], v[116:119]
v_add_u32 v9, 32768, v9
v_add_u32 v10, 32768, v10
v_mfma_f32_16x16x32_bf16 v[116:119], a[104:107], a[144:147], v[116:119]
v_accvgpr_read_b32 v21, a202
v_accvgpr_read_b32 v22, a204
v_mfma_f32_16x16x32_bf16 v[108:111], a[104:107], a[136:139], v[108:111]
ds_read_b64_tr_b16 a[180:181], v13 offset:57344
ds_read_b64_tr_b16 a[182:183], v13 offset:57856
v_mfma_f32_16x16x32_bf16 v[108:111], a[108:111], a[140:143], v[108:111]
s_add_u32 m0, s73, 71680
s_add_u32 s64, s71, 540672
v_accvgpr_read_b32 v23, a206
v_mfma_f32_16x16x32_bf16 v[100:103], a[108:111], a[132:135], v[100:103]
s_waitcnt lgkmcnt(2)
v_mfma_f32_16x16x32_bf16 v[100:103], a[104:107], a[128:131], v[100:103]
buffer_load_dwordx4 v5, s[8:11], s64 offen lds
v_mfma_f32_16x16x32_bf16 v[128:131], a[112:115], a[128:131], v[128:131]
ds_read_b64_tr_b16 a[184:185], v14 offset:49152
ds_read_b64_tr_b16 a[186:187], v14 offset:49664
v_mfma_f32_16x16x32_bf16 v[128:131], a[116:119], a[132:135], v[128:131]
v_perm_b32 v24, v17, v16, s85
v_perm_b32 v25, v19, v18, s85
v_mfma_f32_16x16x32_bf16 v[136:139], a[116:119], a[140:143], v[136:139]
ds_read_b64_tr_b16 a[188:189], v14 offset:57344
ds_read_b64_tr_b16 a[190:191], v14 offset:57856
v_mfma_f32_16x16x32_bf16 v[136:139], a[112:115], a[136:139], v[136:139]
v_perm_b32 v26, v21, v20, s85
v_perm_b32 v27, v23, v22, s85
v_mfma_f32_16x16x32_bf16 v[144:147], a[112:115], a[144:147], v[144:147]
v_perm_b32 v28, v17, v16, s86
v_perm_b32 v29, v19, v18, s86
v_mfma_f32_16x16x32_bf16 v[144:147], a[116:119], a[148:151], v[144:147]
v_perm_b32 v30, v21, v20, s86
v_perm_b32 v31, v23, v22, s86
v_mfma_f32_16x16x32_bf16 v[152:155], a[116:119], a[156:159], v[152:155]
buffer_load_dwordx4 v6, s[8:11], s64 offen offset:1024 lds
v_mfma_f32_16x16x32_bf16 v[152:155], a[112:115], a[152:155], v[152:155]
v_accvgpr_read_b32 v16, a208
v_accvgpr_read_b32 v17, a209
v_mfma_f32_16x16x32_bf16 v[156:159], a[120:123], a[152:155], v[156:159]
v_accvgpr_read_b32 v18, a210
v_accvgpr_read_b32 v19, a211
v_mfma_f32_16x16x32_bf16 v[156:159], a[124:127], a[156:159], v[156:159]
v_or_b32 v24, v24, v16
v_or_b32 v25, v25, v17
v_mfma_f32_16x16x32_bf16 v[148:151], a[124:127], a[148:151], v[148:151]
v_or_b32 v26, v26, v18
v_or_b32 v27, v27, v19
v_mfma_f32_16x16x32_bf16 v[148:151], a[120:123], a[144:147], v[148:151]
buffer_store_dwordx4 v[24:27], v4, s[24:27], s82 offen offset:0 sc1
v_mfma_f32_16x16x32_bf16 v[140:143], a[120:123], a[136:139], v[140:143]
v_mfma_f32_16x16x32_bf16 v[140:143], a[124:127], a[140:143], v[140:143]
v_mfma_f32_16x16x32_bf16 v[132:135], a[124:127], a[132:135], v[132:135]
v_mfma_f32_16x16x32_bf16 v[132:135], a[120:123], a[128:131], v[132:135]
s_waitcnt lgkmcnt(0)
v_mfma_f32_16x16x32_bf16 v[160:163], a[160:163], a[64:67], v[160:163]
s_waitcnt vmcnt(26)
v_mfma_f32_16x16x32_bf16 v[160:163], a[164:167], a[68:71], v[160:163]
s_barrier
v_mfma_f32_16x16x32_bf16 v[164:167], a[172:175], a[68:71], v[164:167]
ds_read_b64_tr_b16 a[128:129], v11 offset:0
ds_read_b64_tr_b16 a[130:131], v11 offset:512
v_mfma_f32_16x16x32_bf16 v[164:167], a[168:171], a[64:67], v[164:167]
s_add_u32 m0, s77, 49152
s_add_u32 s64, s76, 0
v_mfma_f32_16x16x32_bf16 v[168:171], a[176:179], a[64:67], v[168:171]
buffer_load_dwordx4 v7, s[16:19], s64 offen lds
v_mfma_f32_16x16x32_bf16 v[168:171], a[180:183], a[68:71], v[168:171]
buffer_store_dwordx4 v[28:31], v4, s[24:27], s82 offen offset:1024 sc1
v_mfma_f32_16x16x32_bf16 v[172:175], a[188:191], a[68:71], v[172:175]
v_accvgpr_read_b32 v16, a193
v_accvgpr_read_b32 v17, a195
v_mfma_f32_16x16x32_bf16 v[172:175], a[184:187], a[64:67], v[172:175]
ds_read_b128 a[64:67], v9 offset:0
v_accvgpr_read_b32 v18, a197
v_mfma_f32_16x16x32_bf16 v[188:191], a[184:187], a[72:75], v[188:191]
ds_read_b64_tr_b16 a[132:133], v11 offset:8192
ds_read_b64_tr_b16 a[134:135], v11 offset:8704
v_mfma_f32_16x16x32_bf16 v[188:191], a[188:191], a[76:79], v[188:191]
v_accvgpr_read_b32 v19, a199
v_accvgpr_read_b32 v20, a201
v_mfma_f32_16x16x32_bf16 v[184:187], a[180:183], a[76:79], v[184:187]
v_accvgpr_read_b32 v21, a203
v_accvgpr_read_b32 v22, a205
v_mfma_f32_16x16x32_bf16 v[184:187], a[176:179], a[72:75], v[184:187]
buffer_load_dwordx4 v8, s[16:19], s64 offen offset:1024 lds
v_mfma_f32_16x16x32_bf16 v[180:183], a[168:171], a[72:75], v[180:183]
ds_read_b128 a[68:71], v10 offset:0
v_accvgpr_read_b32 v23, a207
v_mfma_f32_16x16x32_bf16 v[180:183], a[172:175], a[76:79], v[180:183]
v_mfma_f32_16x16x32_bf16 v[176:179], a[164:167], a[76:79], v[176:179]
v_perm_b32 v24, v17, v16, s85
v_perm_b32 v25, v19, v18, s85
v_mfma_f32_16x16x32_bf16 v[176:179], a[160:163], a[72:75], v[176:179]
ds_read_b64_tr_b16 a[136:137], v12 offset:0
ds_read_b64_tr_b16 a[138:139], v12 offset:512
v_mfma_f32_16x16x32_bf16 v[192:195], a[160:163], a[80:83], v[192:195]
s_add_u32 m0, s77, 51200
s_add_u32 s64, s76, 131072
v_perm_b32 v26, v21, v20, s85
v_mfma_f32_16x16x32_bf16 v[192:195], a[164:167], a[84:87], v[192:195]
v_perm_b32 v27, v23, v22, s85
v_perm_b32 v28, v17, v16, s86
v_mfma_f32_16x16x32_bf16 v[196:199], a[172:175], a[84:87], v[196:199]
buffer_load_dwordx4 v7, s[16:19], s64 offen lds
v_mfma_f32_16x16x32_bf16 v[196:199], a[168:171], a[80:83], v[196:199]
ds_read_b128 a[72:75], v9 offset:2048
v_perm_b32 v29, v19, v18, s86
v_mfma_f32_16x16x32_bf16 v[200:203], a[176:179], a[80:83], v[200:203]
v_perm_b32 v30, v21, v20, s86
v_perm_b32 v31, v23, v22, s86
v_mfma_f32_16x16x32_bf16 v[200:203], a[180:183], a[84:87], v[200:203]
ds_read_b64_tr_b16 a[140:141], v12 offset:8192
ds_read_b64_tr_b16 a[142:143], v12 offset:8704
v_mfma_f32_16x16x32_bf16 v[204:207], a[188:191], a[84:87], v[204:207]
buffer_store_dwordx4 v[24:27], v4, s[24:27], s82 offen offset:2048 sc1
v_mfma_f32_16x16x32_bf16 v[204:207], a[184:187], a[80:83], v[204:207]
v_mfma_f32_16x16x32_bf16 v[220:223], a[184:187], a[88:91], v[220:223]
ds_read_b128 a[76:79], v10 offset:2048
v_mfma_f32_16x16x32_bf16 v[220:223], a[188:191], a[92:95], v[220:223]
buffer_load_dwordx4 v8, s[16:19], s64 offen offset:1024 lds
v_mfma_f32_16x16x32_bf16 v[216:219], a[180:183], a[92:95], v[216:219]
s_xor_b32 s71, s70, 768
s_add_u32 s71, s68, s71
v_mfma_f32_16x16x32_bf16 v[216:219], a[176:179], a[88:91], v[216:219]
v_mfma_f32_16x16x32_bf16 v[212:215], a[168:171], a[88:91], v[212:215]
ds_read_b64_tr_b16 a[144:145], v13 offset:0
ds_read_b64_tr_b16 a[146:147], v13 offset:512
v_mfma_f32_16x16x32_bf16 v[212:215], a[172:175], a[92:95], v[212:215]
buffer_store_dwordx4 v[28:31], v4, s[24:27], s82 offen offset:3072 sc1
v_mfma_f32_16x16x32_bf16 v[208:211], a[164:167], a[92:95], v[208:211]
s_lshl_b32 s52, s7, 4
v_and_b32 v22, 3, v1
v_lshl_add_u32 v22, v22, 2, s52
v_mfma_f32_16x16x32_bf16 v[208:211], a[160:163], a[88:91], v[208:211]
s_add_u32 m0, s73, 0
s_add_u32 s64, s71, 0
ds_read_b128 a[80:83], v9 offset:4096
v_mfma_f32_16x16x32_bf16 v[224:227], a[160:163], a[96:99], v[224:227]
buffer_load_dword v23, v22, s[40:43], 0 offen sc1
v_mfma_f32_16x16x32_bf16 v[224:227], a[164:167], a[100:103], v[224:227]
buffer_load_dwordx4 v5, s[8:11], s64 offen lds
v_mfma_f32_16x16x32_bf16 v[228:231], a[172:175], a[100:103], v[228:231]
ds_read_b64_tr_b16 a[148:149], v13 offset:8192
ds_read_b64_tr_b16 a[150:151], v13 offset:8704
v_mfma_f32_16x16x32_bf16 v[228:231], a[168:171], a[96:99], v[228:231]
v_mfma_f32_16x16x32_bf16 v[232:235], a[176:179], a[96:99], v[232:235]
v_mfma_f32_16x16x32_bf16 v[232:235], a[180:183], a[100:103], v[232:235]
ds_read_b128 a[84:87], v10 offset:4096
v_mfma_f32_16x16x32_bf16 v[236:239], a[188:191], a[100:103], v[236:239]
v_mfma_f32_16x16x32_bf16 v[236:239], a[184:187], a[96:99], v[236:239]
v_mfma_f32_16x16x32_bf16 v[252:255], a[184:187], a[104:107], v[252:255]
buffer_load_dwordx4 v6, s[8:11], s64 offen offset:1024 lds
v_mfma_f32_16x16x32_bf16 v[252:255], a[188:191], a[108:111], v[252:255]
ds_read_b64_tr_b16 a[152:153], v14 offset:0
ds_read_b64_tr_b16 a[154:155], v14 offset:512
v_mfma_f32_16x16x32_bf16 v[248:251], a[180:183], a[108:111], v[248:251]
v_mfma_f32_16x16x32_bf16 v[248:251], a[176:179], a[104:107], v[248:251]
v_mfma_f32_16x16x32_bf16 v[244:247], a[168:171], a[104:107], v[244:247]
ds_read_b128 a[88:91], v9 offset:6144
v_mfma_f32_16x16x32_bf16 v[244:247], a[172:175], a[108:111], v[244:247]
s_add_u32 m0, s73, 2048
s_add_u32 s64, s71, 16384
v_mfma_f32_16x16x32_bf16 v[240:243], a[164:167], a[108:111], v[240:243]
v_mfma_f32_16x16x32_bf16 v[240:243], a[160:163], a[104:107], v[240:243]
buffer_load_dwordx4 v5, s[8:11], s64 offen lds
v_mfma_f32_16x16x32_bf16 a[0:3], a[160:163], a[112:115], a[0:3]
ds_read_b64_tr_b16 a[156:157], v14 offset:8192
ds_read_b64_tr_b16 a[158:159], v14 offset:8704
v_mfma_f32_16x16x32_bf16 a[0:3], a[164:167], a[116:119], a[0:3]
v_mfma_f32_16x16x32_bf16 a[4:7], a[172:175], a[116:119], a[4:7]
ds_read_b128 a[92:95], v10 offset:6144
v_mfma_f32_16x16x32_bf16 a[4:7], a[168:171], a[112:115], a[4:7]
v_mfma_f32_16x16x32_bf16 a[8:11], a[176:179], a[112:115], a[8:11]
v_mfma_f32_16x16x32_bf16 a[8:11], a[180:183], a[116:119], a[8:11]
v_mfma_f32_16x16x32_bf16 a[12:15], a[188:191], a[116:119], a[12:15]
buffer_load_dwordx4 v6, s[8:11], s64 offen offset:1024 lds
v_mfma_f32_16x16x32_bf16 a[12:15], a[184:187], a[112:115], a[12:15]
v_mfma_f32_16x16x32_bf16 a[28:31], a[184:187], a[120:123], a[28:31]
v_mfma_f32_16x16x32_bf16 a[28:31], a[188:191], a[124:127], a[28:31]
v_mfma_f32_16x16x32_bf16 a[24:27], a[180:183], a[124:127], a[24:27]
v_mfma_f32_16x16x32_bf16 a[24:27], a[176:179], a[120:123], a[24:27]
v_mfma_f32_16x16x32_bf16 a[20:23], a[168:171], a[120:123], a[20:23]
v_mfma_f32_16x16x32_bf16 a[20:23], a[172:175], a[124:127], a[20:23]
v_mfma_f32_16x16x32_bf16 a[16:19], a[164:167], a[124:127], a[16:19]
v_mfma_f32_16x16x32_bf16 a[16:19], a[160:163], a[120:123], a[16:19]
s_waitcnt lgkmcnt(0)
v_mfma_f32_16x16x32_bf16 v[32:35], a[64:67], a[128:131], v[32:35]
s_waitcnt vmcnt(31)
v_mfma_f32_16x16x32_bf16 v[32:35], a[68:71], a[132:135], v[32:35]
s_barrier
v_mfma_f32_16x16x32_bf16 v[40:43], a[68:71], a[140:143], v[40:43]
ds_read_b128 a[96:99], v9 offset:8192
v_mfma_f32_16x16x32_bf16 v[40:43], a[64:67], a[136:139], v[40:43]
s_xor_b32 s76, s75, 3145728
s_add_u32 s76, s74, s76
v_mfma_f32_16x16x32_bf16 v[48:51], a[64:67], a[144:147], v[48:51]
s_add_u32 m0, s77, 0
s_add_u32 s64, s76, 0
v_mfma_f32_16x16x32_bf16 v[48:51], a[68:71], a[148:151], v[48:51]
buffer_load_dwordx4 v7, s[56:59], s64 offen lds
v_mfma_f32_16x16x32_bf16 v[56:59], a[68:71], a[156:159], v[56:59]
ds_read_b128 a[100:103], v10 offset:8192
v_mfma_f32_16x16x32_bf16 v[56:59], a[64:67], a[152:155], v[56:59]
v_mfma_f32_16x16x32_bf16 v[60:63], a[72:75], a[152:155], v[60:63]
ds_read_b128 a[104:107], v9 offset:10240
v_mfma_f32_16x16x32_bf16 v[60:63], a[76:79], a[156:159], v[60:63]
v_mfma_f32_16x16x32_bf16 v[52:55], a[76:79], a[148:151], v[52:55]
v_mfma_f32_16x16x32_bf16 v[52:55], a[72:75], a[144:147], v[52:55]
buffer_load_dwordx4 v8, s[56:59], s64 offen offset:1024 lds
v_mfma_f32_16x16x32_bf16 v[44:47], a[72:75], a[136:139], v[44:47]
ds_read_b64_tr_b16 a[160:161], v11 offset:16384
ds_read_b64_tr_b16 a[162:163], v11 offset:16896
v_mfma_f32_16x16x32_bf16 v[44:47], a[76:79], a[140:143], v[44:47]
v_mfma_f32_16x16x32_bf16 v[36:39], a[76:79], a[132:135], v[36:39]
v_mfma_f32_16x16x32_bf16 v[36:39], a[72:75], a[128:131], v[36:39]
ds_read_b128 a[108:111], v10 offset:10240
v_mfma_f32_16x16x32_bf16 v[64:67], a[80:83], a[128:131], v[64:67]
s_add_u32 m0, s77, 2048
s_add_u32 s64, s76, 131072
s_waitcnt vmcnt(6)
v_mfma_f32_16x16x32_bf16 v[64:67], a[84:87], a[132:135], v[64:67]
v_cmp_gt_u32 vcc, 1, v23
v_mfma_f32_16x16x32_bf16 v[72:75], a[84:87], a[140:143], v[72:75]
buffer_load_dwordx4 v7, s[56:59], s64 offen lds
v_mfma_f32_16x16x32_bf16 v[72:75], a[80:83], a[136:139], v[72:75]
ds_read_b64_tr_b16 a[164:165], v11 offset:24576
ds_read_b64_tr_b16 a[166:167], v11 offset:25088
v_mfma_f32_16x16x32_bf16 v[80:83], a[80:83], a[144:147], v[80:83]
v_mfma_f32_16x16x32_bf16 v[80:83], a[84:87], a[148:151], v[80:83]
ds_read_b128 a[112:115], v9 offset:12288
v_mfma_f32_16x16x32_bf16 v[88:91], a[84:87], a[156:159], v[88:91]
s_cbranch_vccnz CK_Z
CK_Z_R:
v_mfma_f32_16x16x32_bf16 v[88:91], a[80:83], a[152:155], v[88:91]
buffer_atomic_add v1, v0, s[24:27], s84 offen offset:0 sc1
v_mfma_f32_16x16x32_bf16 v[92:95], a[88:91], a[152:155], v[92:95]
s_mul_i32 s52, s66, 147456
ds_read_b64_tr_b16 a[168:169], v12 offset:16384
ds_read_b64_tr_b16 a[170:171], v12 offset:16896
v_mfma_f32_16x16x32_bf16 v[92:95], a[92:95], a[156:159], v[92:95]
buffer_load_dwordx4 v8, s[56:59], s64 offen offset:1024 lds
v_mfma_f32_16x16x32_bf16 v[84:87], a[92:95], a[148:151], v[84:87]
s_lshl_b32 s53, s4, 8
s_add_u32 s52, s52, s53
s_lshl2_add_u32 s53, s2, s3
v_mfma_f32_16x16x32_bf16 v[84:87], a[88:91], a[144:147], v[84:87]
s_mul_i32 s53, s53, 2304
v_lshrrev_b32 v16, 1, v1
v_and_b32 v17, 1, v1
v_mfma_f32_16x16x32_bf16 v[76:79], a[88:91], a[136:139], v[76:79]
ds_read_b128 a[116:119], v10 offset:12288
v_lshlrev_b32 v16, 13, v16
v_mfma_f32_16x16x32_bf16 v[76:79], a[92:95], a[140:143], v[76:79]
v_lshl_add_u32 v16, v17, 7, v16
v_mov_b32 v17, 2147418112
v_mfma_f32_16x16x32_bf16 v[68:71], a[92:95], a[132:135], v[68:71]
v_cmp_gt_u32 s[96:97], 18, v1
v_lshlrev_b32 v18, 7, v1
v_mfma_f32_16x16x32_bf16 v[68:71], a[88:91], a[128:131], v[68:71]
s_add_u32 m0, s73, 4096
s_add_u32 s64, s71, 524288
s_waitcnt lgkmcnt(6)
v_mfma_f32_16x16x32_bf16 v[96:99], a[96:99], a[128:131], v[96:99]
ds_read_b64_tr_b16 a[172:173], v12 offset:24576
ds_read_b64_tr_b16 a[174:175], v12 offset:25088
v_mfma_f32_16x16x32_bf16 v[96:99], a[100:103], a[132:135], v[96:99]
buffer_load_dwordx4 v5, s[8:11], s64 offen lds
v_mfma_f32_16x16x32_bf16 v[104:107], a[100:103], a[140:143], v[104:107]
ds_read_b128 a[120:123], v9 offset:14336
v_mov_b32 v29, 0
v_mfma_f32_16x16x32_bf16 v[104:107], a[96:99], a[136:139], v[104:107]
v_mfma_f32_16x16x32_bf16 v[112:115], a[96:99], a[144:147], v[112:115]
v_cndmask_b32 v16, v17, v16, s[96:97]
v_cndmask_b32 v18, v17, v18, s[96:97]
v_mfma_f32_16x16x32_bf16 v[112:115], a[100:103], a[148:151], v[112:115]
ds_read_b64_tr_b16 a[176:177], v13 offset:16384
ds_read_b64_tr_b16 a[178:179], v13 offset:16896
v_mfma_f32_16x16x32_bf16 v[120:123], a[100:103], a[156:159], v[120:123]
buffer_load_dword a253, v18, s[12:15], s53 offen
v_mfma_f32_16x16x32_bf16 v[120:123], a[96:99], a[152:155], v[120:123]
v_mfma_f32_16x16x32_bf16 v[124:127], a[104:107], a[152:155], v[124:127]
buffer_load_dwordx4 v6, s[8:11], s64 offen offset:1024 lds
v_mfma_f32_16x16x32_bf16 v[124:127], a[108:111], a[156:159], v[124:127]
ds_read_b128 a[124:127], v10 offset:14336
v_mfma_f32_16x16x32_bf16 v[116:119], a[108:111], a[148:151], v[116:119]
v_add_u32 v9, 32768, v9
v_add_u32 v10, 32768, v10
v_mfma_f32_16x16x32_bf16 v[116:119], a[104:107], a[144:147], v[116:119]
v_mfma_f32_16x16x32_bf16 v[108:111], a[104:107], a[136:139], v[108:111]
ds_read_b64_tr_b16 a[180:181], v13 offset:24576
ds_read_b64_tr_b16 a[182:183], v13 offset:25088
v_mfma_f32_16x16x32_bf16 v[108:111], a[108:111], a[140:143], v[108:111]
s_add_u32 m0, s73, 6144
s_add_u32 s64, s71, 540672
v_mfma_f32_16x16x32_bf16 v[100:103], a[108:111], a[132:135], v[100:103]
s_waitcnt lgkmcnt(2)
v_mfma_f32_16x16x32_bf16 v[100:103], a[104:107], a[128:131], v[100:103]
buffer_load_dwordx4 v5, s[8:11], s64 offen lds
v_mfma_f32_16x16x32_bf16 v[128:131], a[112:115], a[128:131], v[128:131]
ds_read_b64_tr_b16 a[184:185], v14 offset:16384
ds_read_b64_tr_b16 a[186:187], v14 offset:16896
v_mfma_f32_16x16x32_bf16 v[128:131], a[116:119], a[132:135], v[128:131]
v_mfma_f32_16x16x32_bf16 v[136:139], a[116:119], a[140:143], v[136:139]
ds_read_b64_tr_b16 a[188:189], v14 offset:24576
ds_read_b64_tr_b16 a[190:191], v14 offset:25088
v_mfma_f32_16x16x32_bf16 v[136:139], a[112:115], a[136:139], v[136:139]
v_mfma_f32_16x16x32_bf16 v[144:147], a[112:115], a[144:147], v[144:147]
v_mfma_f32_16x16x32_bf16 v[144:147], a[116:119], a[148:151], v[144:147]
v_mfma_f32_16x16x32_bf16 v[152:155], a[116:119], a[156:159], v[152:155]
buffer_load_dwordx4 v6, s[8:11], s64 offen offset:1024 lds
v_mfma_f32_16x16x32_bf16 v[152:155], a[112:115], a[152:155], v[152:155]
v_mfma_f32_16x16x32_bf16 v[156:159], a[120:123], a[152:155], v[156:159]
v_mfma_f32_16x16x32_bf16 v[156:159], a[124:127], a[156:159], v[156:159]
v_mfma_f32_16x16x32_bf16 v[148:151], a[124:127], a[148:151], v[148:151]
L_PAD2:
s_cbranch_execz L_PAD6
v_mfma_f32_16x16x32_bf16 v[148:151], a[120:123], a[144:147], v[148:151]
v_mfma_f32_16x16x32_bf16 v[140:143], a[120:123], a[136:139], v[140:143]
v_mfma_f32_16x16x32_bf16 v[140:143], a[124:127], a[140:143], v[140:143]
v_mfma_f32_16x16x32_bf16 v[132:135], a[124:127], a[132:135], v[132:135]
v_mfma_f32_16x16x32_bf16 v[132:135], a[120:123], a[128:131], v[132:135]
s_waitcnt lgkmcnt(0)
v_mfma_f32_16x16x32_bf16 v[160:163], a[160:163], a[64:67], v[160:163]
s_waitcnt vmcnt(23)
v_mfma_f32_16x16x32_bf16 v[160:163], a[164:167], a[68:71], v[160:163]
s_barrier
v_mfma_f32_16x16x32_bf16 v[164:167], a[172:175], a[68:71], v[164:167]
ds_read_b64_tr_b16 a[128:129], v11 offset:32768
ds_read_b64_tr_b16 a[130:131], v11 offset:33280
v_mfma_f32_16x16x32_bf16 v[164:167], a[168:171], a[64:67], v[164:167]
s_add_u32 m0, s77, 16384
s_add_u32 s64, s76, 0
v_mfma_f32_16x16x32_bf16 v[168:171], a[176:179], a[64:67], v[168:171]
buffer_load_dwordx4 v7, s[16:19], s64 offen lds
v_mfma_f32_16x16x32_bf16 v[168:171], a[180:183], a[68:71], v[168:171]
buffer_load_dword a252, v16, s[20:23], s52 offen
v_mfma_f32_16x16x32_bf16 v[172:175], a[188:191], a[68:71], v[172:175]
s_add_u32 s52, s52, 73728
v_mfma_f32_16x16x32_bf16 v[172:175], a[184:187], a[64:67], v[172:175]
ds_read_b128 a[64:67], v9 offset:0
v_mfma_f32_16x16x32_bf16 v[188:191], a[184:187], a[72:75], v[188:191]
ds_read_b64_tr_b16 a[132:133], v11 offset:40960
ds_read_b64_tr_b16 a[134:135], v11 offset:41472
v_mfma_f32_16x16x32_bf16 v[188:191], a[188:191], a[76:79], v[188:191]
v_mfma_f32_16x16x32_bf16 v[184:187], a[180:183], a[76:79], v[184:187]
v_mfma_f32_16x16x32_bf16 v[184:187], a[176:179], a[72:75], v[184:187]
buffer_load_dwordx4 v8, s[16:19], s64 offen offset:1024 lds
v_mfma_f32_16x16x32_bf16 v[180:183], a[168:171], a[72:75], v[180:183]
ds_read_b128 a[68:71], v10 offset:0
v_mfma_f32_16x16x32_bf16 v[180:183], a[172:175], a[76:79], v[180:183]
v_mfma_f32_16x16x32_bf16 v[176:179], a[164:167], a[76:79], v[176:179]
v_mfma_f32_16x16x32_bf16 v[176:179], a[160:163], a[72:75], v[176:179]
ds_read_b64_tr_b16 a[136:137], v12 offset:32768
ds_read_b64_tr_b16 a[138:139], v12 offset:33280
v_mfma_f32_16x16x32_bf16 v[192:195], a[160:163], a[80:83], v[192:195]
s_add_u32 m0, s77, 18432
s_add_u32 s64, s76, 131072
v_mfma_f32_16x16x32_bf16 v[192:195], a[164:167], a[84:87], v[192:195]
v_mfma_f32_16x16x32_bf16 v[196:199], a[172:175], a[84:87], v[196:199]
buffer_load_dwordx4 v7, s[16:19], s64 offen lds
v_mfma_f32_16x16x32_bf16 v[196:199], a[168:171], a[80:83], v[196:199]
ds_read_b128 a[72:75], v9 offset:2048
v_mfma_f32_16x16x32_bf16 v[200:203], a[176:179], a[80:83], v[200:203]
v_mfma_f32_16x16x32_bf16 v[200:203], a[180:183], a[84:87], v[200:203]
ds_read_b64_tr_b16 a[140:141], v12 offset:40960
ds_read_b64_tr_b16 a[142:143], v12 offset:41472
v_mfma_f32_16x16x32_bf16 v[204:207], a[188:191], a[84:87], v[204:207]
v_mfma_f32_16x16x32_bf16 v[204:207], a[184:187], a[80:83], v[204:207]
v_mfma_f32_16x16x32_bf16 v[220:223], a[184:187], a[88:91], v[220:223]
ds_read_b128 a[76:79], v10 offset:2048
v_mfma_f32_16x16x32_bf16 v[220:223], a[188:191], a[92:95], v[220:223]
buffer_load_dwordx4 v8, s[16:19], s64 offen offset:1024 lds
v_mfma_f32_16x16x32_bf16 v[216:219], a[180:183], a[92:95], v[216:219]
s_xor_b32 s71, s70, 896
s_add_u32 s71, s68, s71
v_mfma_f32_16x16x32_bf16 v[216:219], a[176:179], a[88:91], v[216:219]
v_mfma_f32_16x16x32_bf16 v[212:215], a[168:171], a[88:91], v[212:215]
ds_read_b64_tr_b16 a[144:145], v13 offset:32768
ds_read_b64_tr_b16 a[146:147], v13 offset:33280
v_mfma_f32_16x16x32_bf16 v[212:215], a[172:175], a[92:95], v[212:215]
v_mfma_f32_16x16x32_bf16 v[208:211], a[164:167], a[92:95], v[208:211]
v_mfma_f32_16x16x32_bf16 v[208:211], a[160:163], a[88:91], v[208:211]
s_add_u32 m0, s73, 32768
s_add_u32 s64, s71, 0
ds_read_b128 a[80:83], v9 offset:4096
v_mfma_f32_16x16x32_bf16 v[224:227], a[160:163], a[96:99], v[224:227]
v_mfma_f32_16x16x32_bf16 v[224:227], a[164:167], a[100:103], v[224:227]
buffer_load_dwordx4 v5, s[8:11], s64 offen lds
v_mfma_f32_16x16x32_bf16 v[228:231], a[172:175], a[100:103], v[228:231]
ds_read_b64_tr_b16 a[148:149], v13 offset:40960
ds_read_b64_tr_b16 a[150:151], v13 offset:41472
v_mfma_f32_16x16x32_bf16 v[228:231], a[168:171], a[96:99], v[228:231]
v_mfma_f32_16x16x32_bf16 v[232:235], a[176:179], a[96:99], v[232:235]
v_mfma_f32_16x16x32_bf16 v[232:235], a[180:183], a[100:103], v[232:235]
ds_read_b128 a[84:87], v10 offset:4096
v_mfma_f32_16x16x32_bf16 v[236:239], a[188:191], a[100:103], v[236:239]
v_mfma_f32_16x16x32_bf16 v[236:239], a[184:187], a[96:99], v[236:239]
v_mfma_f32_16x16x32_bf16 v[252:255], a[184:187], a[104:107], v[252:255]
buffer_load_dwordx4 v6, s[8:11], s64 offen offset:1024 lds
v_mfma_f32_16x16x32_bf16 v[252:255], a[188:191], a[108:111], v[252:255]
ds_read_b64_tr_b16 a[152:153], v14 offset:32768
ds_read_b64_tr_b16 a[154:155], v14 offset:33280
v_mfma_f32_16x16x32_bf16 v[248:251], a[180:183], a[108:111], v[248:251]
v_mfma_f32_16x16x32_bf16 v[248:251], a[176:179], a[104:107], v[248:251]
v_mfma_f32_16x16x32_bf16 v[244:247], a[168:171], a[104:107], v[244:247]
ds_read_b128 a[88:91], v9 offset:6144
v_mfma_f32_16x16x32_bf16 v[244:247], a[172:175], a[108:111], v[244:247]
s_add_u32 m0, s73, 34816
s_add_u32 s64, s71, 16384
v_mfma_f32_16x16x32_bf16 v[240:243], a[164:167], a[108:111], v[240:243]
v_mfma_f32_16x16x32_bf16 v[240:243], a[160:163], a[104:107], v[240:243]
buffer_load_dwordx4 v5, s[8:11], s64 offen lds
v_mfma_f32_16x16x32_bf16 a[0:3], a[160:163], a[112:115], a[0:3]
ds_read_b64_tr_b16 a[156:157], v14 offset:40960
ds_read_b64_tr_b16 a[158:159], v14 offset:41472
v_mfma_f32_16x16x32_bf16 a[0:3], a[164:167], a[116:119], a[0:3]
v_mfma_f32_16x16x32_bf16 a[4:7], a[172:175], a[116:119], a[4:7]
ds_read_b128 a[92:95], v10 offset:6144
v_mfma_f32_16x16x32_bf16 a[4:7], a[168:171], a[112:115], a[4:7]
v_mfma_f32_16x16x32_bf16 a[8:11], a[176:179], a[112:115], a[8:11]
v_mfma_f32_16x16x32_bf16 a[8:11], a[180:183], a[116:119], a[8:11]
v_mfma_f32_16x16x32_bf16 a[12:15], a[188:191], a[116:119], a[12:15]
buffer_load_dwordx4 v6, s[8:11], s64 offen offset:1024 lds
v_mfma_f32_16x16x32_bf16 a[12:15], a[184:187], a[112:115], a[12:15]
v_mfma_f32_16x16x32_bf16 a[28:31], a[184:187], a[120:123], a[28:31]
v_mfma_f32_16x16x32_bf16 a[28:31], a[188:191], a[124:127], a[28:31]
v_mfma_f32_16x16x32_bf16 a[24:27], a[180:183], a[124:127], a[24:27]
v_mfma_f32_16x16x32_bf16 a[24:27], a[176:179], a[120:123], a[24:27]
v_mfma_f32_16x16x32_bf16 a[20:23], a[168:171], a[120:123], a[20:23]
v_mfma_f32_16x16x32_bf16 a[20:23], a[172:175], a[124:127], a[20:23]
v_mfma_f32_16x16x32_bf16 a[16:19], a[164:167], a[124:127], a[16:19]
v_mfma_f32_16x16x32_bf16 a[16:19], a[160:163], a[120:123], a[16:19]
s_waitcnt lgkmcnt(0)
v_mfma_f32_16x16x32_bf16 v[32:35], a[64:67], a[128:131], v[32:35]
s_waitcnt vmcnt(25)
v_mfma_f32_16x16x32_bf16 v[32:35], a[68:71], a[132:135], v[32:35]
s_barrier
v_mfma_f32_16x16x32_bf16 v[40:43], a[68:71], a[140:143], v[40:43]
ds_read_b128 a[96:99], v9 offset:8192
v_mfma_f32_16x16x32_bf16 v[40:43], a[64:67], a[136:139], v[40:43]
s_xor_b32 s76, s75, 3670016
s_add_u32 s76, s74, s76
v_mfma_f32_16x16x32_bf16 v[48:51], a[64:67], a[144:147], v[48:51]
s_add_u32 m0, s77, 32768
s_add_u32 s64, s76, 0
v_mfma_f32_16x16x32_bf16 v[48:51], a[68:71], a[148:151], v[48:51]
buffer_load_dwordx4 v7, s[56:59], s64 offen lds
v_mfma_f32_16x16x32_bf16 v[56:59], a[68:71], a[156:159], v[56:59]
ds_read_b128 a[100:103], v10 offset:8192
v_mfma_f32_16x16x32_bf16 v[56:59], a[64:67], a[152:155], v[56:59]
buffer_load_dword a252, v16, s[20:23], s52 offen
v_mfma_f32_16x16x32_bf16 v[60:63], a[72:75], a[152:155], v[60:63]
s_lshr_b32 s52, s2, 1
s_lshl2_add_u32 s52, s52, s3
ds_read_b128 a[104:107], v9 offset:10240
v_mfma_f32_16x16x32_bf16 v[60:63], a[76:79], a[156:159], v[60:63]
s_mul_i32 s52, s52, 9216
s_and_b32 s53, s2, 1
s_lshl_b32 s53, s53, 9
v_mfma_f32_16x16x32_bf16 v[52:55], a[76:79], a[148:151], v[52:55]
s_add_u32 s52, s52, s53
s_lshl2_add_u32 s53, s2, s3
s_mul_i32 s53, s53, 768
v_mfma_f32_16x16x32_bf16 v[52:55], a[72:75], a[144:147], v[52:55]
buffer_load_dwordx4 v8, s[56:59], s64 offen offset:1024 lds
v_mfma_f32_16x16x32_bf16 v[44:47], a[72:75], a[136:139], v[44:47]
ds_read_b64_tr_b16 a[160:161], v11 offset:49152
ds_read_b64_tr_b16 a[162:163], v11 offset:49664
v_mfma_f32_16x16x32_bf16 v[44:47], a[76:79], a[140:143], v[44:47]
v_cmp_gt_u32 s[96:97], 40, v1
v_and_b32 v16, 7, v1
v_mfma_f32_16x16x32_bf16 v[36:39], a[76:79], a[132:135], v[36:39]
v_mul_u32_u24 v16, 1152, v16
v_lshrrev_b32 v19, 3, v1
v_mfma_f32_16x16x32_bf16 v[36:39], a[72:75], a[128:131], v[36:39]
ds_read_b128 a[108:111], v10 offset:10240
v_lshl_add_u32 v16, v19, 7, v16
v_mfma_f32_16x16x32_bf16 v[64:67], a[80:83], a[128:131], v[64:67]
s_add_u32 m0, s77, 34816
s_add_u32 s64, s76, 131072
v_cndmask_b32 v16, v17, v16, s[96:97]
v_mfma_f32_16x16x32_bf16 v[64:67], a[84:87], a[132:135], v[64:67]
v_cmp_gt_u32 s[96:97], 6, v1
v_mfma_f32_16x16x32_bf16 v[72:75], a[84:87], a[140:143], v[72:75]
buffer_load_dwordx4 v7, s[56:59], s64 offen lds
v_mfma_f32_16x16x32_bf16 v[72:75], a[80:83], a[136:139], v[72:75]
ds_read_b64_tr_b16 a[164:165], v11 offset:57344
ds_read_b64_tr_b16 a[166:167], v11 offset:57856
v_mfma_f32_16x16x32_bf16 v[80:83], a[80:83], a[144:147], v[80:83]
v_cndmask_b32 v18, v17, v18, s[96:97]
v_mfma_f32_16x16x32_bf16 v[80:83], a[84:87], a[148:151], v[80:83]
ds_read_b128 a[112:115], v9 offset:12288
v_mfma_f32_16x16x32_bf16 v[88:91], a[84:87], a[156:159], v[88:91]
v_mfma_f32_16x16x32_bf16 v[88:91], a[80:83], a[152:155], v[88:91]
v_mfma_f32_16x16x32_bf16 v[92:95], a[88:91], a[152:155], v[92:95]
ds_read_b64_tr_b16 a[168:169], v12 offset:49152
ds_read_b64_tr_b16 a[170:171], v12 offset:49664
v_mfma_f32_16x16x32_bf16 v[92:95], a[92:95], a[156:159], v[92:95]
buffer_load_dwordx4 v8, s[56:59], s64 offen offset:1024 lds
v_mfma_f32_16x16x32_bf16 v[84:87], a[92:95], a[148:151], v[84:87]
v_mfma_f32_16x16x32_bf16 v[84:87], a[88:91], a[144:147], v[84:87]
v_mfma_f32_16x16x32_bf16 v[76:79], a[88:91], a[136:139], v[76:79]
ds_read_b128 a[116:119], v10 offset:12288
v_mfma_f32_16x16x32_bf16 v[76:79], a[92:95], a[140:143], v[76:79]
v_mfma_f32_16x16x32_bf16 v[68:71], a[92:95], a[132:135], v[68:71]
v_mfma_f32_16x16x32_bf16 v[68:71], a[88:91], a[128:131], v[68:71]
s_add_u32 m0, s73, 36864
s_add_u32 s64, s71, 524288
s_waitcnt lgkmcnt(6)
v_mfma_f32_16x16x32_bf16 v[96:99], a[96:99], a[128:131], v[96:99]
ds_read_b64_tr_b16 a[172:173], v12 offset:57344
ds_read_b64_tr_b16 a[174:175], v12 offset:57856
v_mfma_f32_16x16x32_bf16 v[96:99], a[100:103], a[132:135], v[96:99]
buffer_load_dwordx4 v5, s[8:11], s64 offen lds
v_mfma_f32_16x16x32_bf16 v[104:107], a[100:103], a[140:143], v[104:107]
ds_read_b128 a[120:123], v9 offset:14336
v_mfma_f32_16x16x32_bf16 v[104:107], a[96:99], a[136:139], v[104:107]
v_mfma_f32_16x16x32_bf16 v[112:115], a[96:99], a[144:147], v[112:115]
v_mfma_f32_16x16x32_bf16 v[112:115], a[100:103], a[148:151], v[112:115]
ds_read_b64_tr_b16 a[176:177], v13 offset:49152
ds_read_b64_tr_b16 a[178:179], v13 offset:49664
v_mfma_f32_16x16x32_bf16 v[120:123], a[100:103], a[156:159], v[120:123]
v_mfma_f32_16x16x32_bf16 v[120:123], a[96:99], a[152:155], v[120:123]
v_mfma_f32_16x16x32_bf16 v[124:127], a[104:107], a[152:155], v[124:127]
buffer_load_dwordx4 v6, s[8:11], s64 offen offset:1024 lds
v_mfma_f32_16x16x32_bf16 v[124:127], a[108:111], a[156:159], v[124:127]
ds_read_b128 a[124:127], v10 offset:14336
v_mfma_f32_16x16x32_bf16 v[116:119], a[108:111], a[148:151], v[116:119]
v_add_u32 v9, -65536, v9
v_add_u32 v10, -65536, v10
v_mfma_f32_16x16x32_bf16 v[116:119], a[104:107], a[144:147], v[116:119]
buffer_load_dword v30, v29, s[24:27], s89 offen sc1
v_mfma_f32_16x16x32_bf16 v[108:111], a[104:107], a[136:139], v[108:111]
ds_read_b64_tr_b16 a[180:181], v13 offset:57344
ds_read_b64_tr_b16 a[182:183], v13 offset:57856
v_mfma_f32_16x16x32_bf16 v[108:111], a[108:111], a[140:143], v[108:111]
s_add_u32 m0, s73, 38912
s_add_u32 s64, s71, 540672
v_mfma_f32_16x16x32_bf16 v[100:103], a[108:111], a[132:135], v[100:103]
s_waitcnt lgkmcnt(2)
v_mfma_f32_16x16x32_bf16 v[100:103], a[104:107], a[128:131], v[100:103]
buffer_load_dwordx4 v5, s[8:11], s64 offen lds
v_mfma_f32_16x16x32_bf16 v[128:131], a[112:115], a[128:131], v[128:131]
ds_read_b64_tr_b16 a[184:185], v14 offset:49152
ds_read_b64_tr_b16 a[186:187], v14 offset:49664
v_mfma_f32_16x16x32_bf16 v[128:131], a[116:119], a[132:135], v[128:131]
v_mfma_f32_16x16x32_bf16 v[136:139], a[116:119], a[140:143], v[136:139]
ds_read_b64_tr_b16 a[188:189], v14 offset:57344
ds_read_b64_tr_b16 a[190:191], v14 offset:57856
v_mfma_f32_16x16x32_bf16 v[136:139], a[112:115], a[136:139], v[136:139]
v_mfma_f32_16x16x32_bf16 v[144:147], a[112:115], a[144:147], v[144:147]
v_mfma_f32_16x16x32_bf16 v[144:147], a[116:119], a[148:151], v[144:147]
v_mfma_f32_16x16x32_bf16 v[152:155], a[116:119], a[156:159], v[152:155]
buffer_load_dwordx4 v6, s[8:11], s64 offen offset:1024 lds
v_mfma_f32_16x16x32_bf16 v[152:155], a[112:115], a[152:155], v[152:155]
v_mfma_f32_16x16x32_bf16 v[156:159], a[120:123], a[152:155], v[156:159]
v_mfma_f32_16x16x32_bf16 v[156:159], a[124:127], a[156:159], v[156:159]
v_mfma_f32_16x16x32_bf16 v[148:151], a[124:127], a[148:151], v[148:151]
v_mfma_f32_16x16x32_bf16 v[148:151], a[120:123], a[144:147], v[148:151]
v_mfma_f32_16x16x32_bf16 v[140:143], a[120:123], a[136:139], v[140:143]
v_mfma_f32_16x16x32_bf16 v[140:143], a[124:127], a[140:143], v[140:143]
v_mfma_f32_16x16x32_bf16 v[132:135], a[124:127], a[132:135], v[132:135]
v_mfma_f32_16x16x32_bf16 v[132:135], a[120:123], a[128:131], v[132:135]
s_waitcnt lgkmcnt(0)
v_mfma_f32_16x16x32_bf16 v[160:163], a[160:163], a[64:67], v[160:163]
s_waitcnt vmcnt(19)
v_mfma_f32_16x16x32_bf16 v[160:163], a[164:167], a[68:71], v[160:163]
s_barrier
v_mfma_f32_16x16x32_bf16 v[164:167], a[172:175], a[68:71], v[164:167]
ds_read_b64_tr_b16 a[128:129], v11 offset:0
ds_read_b64_tr_b16 a[130:131], v11 offset:512
v_mfma_f32_16x16x32_bf16 v[164:167], a[168:171], a[64:67], v[164:167]
s_add_u32 m0, s77, 49152
s_add_u32 s64, s76, 0
v_mfma_f32_16x16x32_bf16 v[168:171], a[176:179], a[64:67], v[168:171]
buffer_load_dwordx4 v7, s[16:19], s64 offen lds
v_mfma_f32_16x16x32_bf16 v[168:171], a[180:183], a[68:71], v[168:171]
v_mfma_f32_16x16x32_bf16 v[172:175], a[188:191], a[68:71], v[172:175]
v_mfma_f32_16x16x32_bf16 v[172:175], a[184:187], a[64:67], v[172:175]
ds_read_b128 a[64:67], v9 offset:0
v_mfma_f32_16x16x32_bf16 v[188:191], a[184:187], a[72:75], v[188:191]
ds_read_b64_tr_b16 a[132:133], v11 offset:8192
ds_read_b64_tr_b16 a[134:135], v11 offset:8704
v_mfma_f32_16x16x32_bf16 v[188:191], a[188:191], a[76:79], v[188:191]
v_mfma_f32_16x16x32_bf16 v[184:187], a[180:183], a[76:79], v[184:187]
v_mfma_f32_16x16x32_bf16 v[184:187], a[176:179], a[72:75], v[184:187]
buffer_load_dwordx4 v8, s[16:19], s64 offen offset:1024 lds
v_mfma_f32_16x16x32_bf16 v[180:183], a[168:171], a[72:75], v[180:183]
ds_read_b128 a[68:71], v10 offset:0
v_mfma_f32_16x16x32_bf16 v[180:183], a[172:175], a[76:79], v[180:183]
v_mfma_f32_16x16x32_bf16 v[176:179], a[164:167], a[76:79], v[176:179]
v_mfma_f32_16x16x32_bf16 v[176:179], a[160:163], a[72:75], v[176:179]
ds_read_b64_tr_b16 a[136:137], v12 offset:0
ds_read_b64_tr_b16 a[138:139], v12 offset:512
v_mfma_f32_16x16x32_bf16 v[192:195], a[160:163], a[80:83], v[192:195]
s_add_u32 m0, s77, 51200
s_add_u32 s64, s76, 131072
v_mfma_f32_16x16x32_bf16 v[192:195], a[164:167], a[84:87], v[192:195]
v_mfma_f32_16x16x32_bf16 v[196:199], a[172:175], a[84:87], v[196:199]
buffer_load_dwordx4 v7, s[16:19], s64 offen lds
v_mfma_f32_16x16x32_bf16 v[196:199], a[168:171], a[80:83], v[196:199]
ds_read_b128 a[72:75], v9 offset:2048
v_mfma_f32_16x16x32_bf16 v[200:203], a[176:179], a[80:83], v[200:203]
v_mfma_f32_16x16x32_bf16 v[200:203], a[180:183], a[84:87], v[200:203]
ds_read_b64_tr_b16 a[140:141], v12 offset:8192
ds_read_b64_tr_b16 a[142:143], v12 offset:8704
v_mfma_f32_16x16x32_bf16 v[204:207], a[188:191], a[84:87], v[204:207]
v_mfma_f32_16x16x32_bf16 v[204:207], a[184:187], a[80:83], v[204:207]
v_mfma_f32_16x16x32_bf16 v[220:223], a[184:187], a[88:91], v[220:223]
ds_read_b128 a[76:79], v10 offset:2048
v_mfma_f32_16x16x32_bf16 v[220:223], a[188:191], a[92:95], v[220:223]
buffer_load_dwordx4 v8, s[16:19], s64 offen offset:1024 lds
v_mfma_f32_16x16x32_bf16 v[216:219], a[180:183], a[92:95], v[216:219]
s_lshl_b32 s70, s93, 7
s_mul_i32 s68, s66, 36864
s_mul_i32 s69, s67, 36864
v_mfma_f32_16x16x32_bf16 v[216:219], a[176:179], a[88:91], v[216:219]
v_lshrrev_b32 v31, 3, v1
v_lshl_add_u32 v5, v31, 7, v5
v_mfma_f32_16x16x32_bf16 v[212:215], a[168:171], a[88:91], v[212:215]
v_lshl_add_u32 v6, v31, 7, v6
v_add_u32 v6, 1024, v6
v_mfma_f32_16x16x32_bf16 v[212:215], a[172:175], a[92:95], v[212:215]
s_mov_b32 s65, 1024
s_add_u32 s71, s68, s65
s_add_u32 s72, s69, s65
v_mfma_f32_16x16x32_bf16 v[208:211], a[164:167], a[92:95], v[208:211]
ds_read_b64_tr_b16 a[144:145], v13 offset:0
ds_read_b64_tr_b16 a[146:147], v13 offset:512
v_mfma_f32_16x16x32_bf16 v[208:211], a[160:163], a[88:91], v[208:211]
s_add_u32 m0, s73, 65536
s_add_u32 s64, s71, 0
ds_read_b128 a[80:83], v9 offset:4096
v_mfma_f32_16x16x32_bf16 v[224:227], a[160:163], a[96:99], v[224:227]
v_mfma_f32_16x16x32_bf16 v[224:227], a[164:167], a[100:103], v[224:227]
buffer_load_dwordx4 v5, s[12:15], s64 offen lds
v_mfma_f32_16x16x32_bf16 v[228:231], a[172:175], a[100:103], v[228:231]
ds_read_b64_tr_b16 a[148:149], v13 offset:8192
ds_read_b64_tr_b16 a[150:151], v13 offset:8704
v_mfma_f32_16x16x32_bf16 v[228:231], a[168:171], a[96:99], v[228:231]
v_mfma_f32_16x16x32_bf16 v[232:235], a[176:179], a[96:99], v[232:235]
v_mfma_f32_16x16x32_bf16 v[232:235], a[180:183], a[100:103], v[232:235]
ds_read_b128 a[84:87], v10 offset:4096
v_mfma_f32_16x16x32_bf16 v[236:239], a[188:191], a[100:103], v[236:239]
v_mfma_f32_16x16x32_bf16 v[236:239], a[184:187], a[96:99], v[236:239]
v_mfma_f32_16x16x32_bf16 v[252:255], a[184:187], a[104:107], v[252:255]
buffer_load_dwordx4 v6, s[12:15], s64 offen offset:1024 lds
v_mfma_f32_16x16x32_bf16 v[252:255], a[188:191], a[108:111], v[252:255]
ds_read_b64_tr_b16 a[152:153], v14 offset:0
ds_read_b64_tr_b16 a[154:155], v14 offset:512
v_mfma_f32_16x16x32_bf16 v[248:251], a[180:183], a[108:111], v[248:251]
v_mfma_f32_16x16x32_bf16 v[248:251], a[176:179], a[104:107], v[248:251]
v_mfma_f32_16x16x32_bf16 v[244:247], a[168:171], a[104:107], v[244:247]
ds_read_b128 a[88:91], v9 offset:6144
v_mfma_f32_16x16x32_bf16 v[244:247], a[172:175], a[108:111], v[244:247]
s_add_u32 m0, s73, 67584
s_add_u32 s64, s71, 18432
v_mfma_f32_16x16x32_bf16 v[240:243], a[164:167], a[108:111], v[240:243]
v_mfma_f32_16x16x32_bf16 v[240:243], a[160:163], a[104:107], v[240:243]
buffer_load_dwordx4 v5, s[12:15], s64 offen lds
v_mfma_f32_16x16x32_bf16 a[0:3], a[160:163], a[112:115], a[0:3]
ds_read_b64_tr_b16 a[156:157], v14 offset:8192
ds_read_b64_tr_b16 a[158:159], v14 offset:8704
v_mfma_f32_16x16x32_bf16 a[0:3], a[164:167], a[116:119], a[0:3]
v_mfma_f32_16x16x32_bf16 a[4:7], a[172:175], a[116:119], a[4:7]
s_waitcnt vmcnt(9)
ds_read_b128 a[92:95], v10 offset:6144
v_mfma_f32_16x16x32_bf16 a[4:7], a[168:171], a[112:115], a[4:7]
v_cmp_gt_u32 vcc, 18, v30
v_mfma_f32_16x16x32_bf16 a[8:11], a[176:179], a[112:115], a[8:11]
v_mfma_f32_16x16x32_bf16 a[8:11], a[180:183], a[116:119], a[8:11]
v_mfma_f32_16x16x32_bf16 a[12:15], a[188:191], a[116:119], a[12:15]
buffer_load_dwordx4 v6, s[12:15], s64 offen offset:1024 lds
v_mfma_f32_16x16x32_bf16 a[12:15], a[184:187], a[112:115], a[12:15]
v_mfma_f32_16x16x32_bf16 a[28:31], a[184:187], a[120:123], a[28:31]
s_cbranch_vccnz CK_WA
CK_WA_R:
v_mfma_f32_16x16x32_bf16 a[28:31], a[188:191], a[124:127], a[28:31]
v_mfma_f32_16x16x32_bf16 a[24:27], a[180:183], a[124:127], a[24:27]
v_mfma_f32_16x16x32_bf16 a[24:27], a[176:179], a[120:123], a[24:27]
v_mfma_f32_16x16x32_bf16 a[20:23], a[168:171], a[120:123], a[20:23]
v_mfma_f32_16x16x32_bf16 a[20:23], a[172:175], a[124:127], a[20:23]
v_mfma_f32_16x16x32_bf16 a[16:19], a[164:167], a[124:127], a[16:19]
v_mfma_f32_16x16x32_bf16 a[16:19], a[160:163], a[120:123], a[16:19]
s_waitcnt lgkmcnt(0)
v_mfma_f32_16x16x32_bf16 v[32:35], a[64:67], a[128:131], v[32:35]
s_waitcnt vmcnt(22)
v_mfma_f32_16x16x32_bf16 v[32:35], a[68:71], a[132:135], v[32:35]
s_barrier
v_mfma_f32_16x16x32_bf16 v[40:43], a[68:71], a[140:143], v[40:43]
ds_read_b128 a[96:99], v9 offset:8192
v_mfma_f32_16x16x32_bf16 v[40:43], a[64:67], a[136:139], v[40:43]
s_lshl_b32 s77, s3, 11
s_lshl_b32 s74, s3, 9
s_add_u32 s74, s74, s4
v_mfma_f32_16x16x32_bf16 v[48:51], a[64:67], a[144:147], v[48:51]
s_lshl_b32 s74, s74, 8
v_mfma_f32_16x16x32_bf16 v[48:51], a[68:71], a[148:151], v[48:51]
s_mov_b32 s75, 8
s_lshl_b32 s76, s75, 19
s_add_u32 s76, s76, s74
v_mfma_f32_16x16x32_bf16 v[56:59], a[68:71], a[156:159], v[56:59]
s_lshl_b32 s79, s75, 13
s_add_u32 s79, s79, s78
ds_read_b128 a[100:103], v10 offset:8192
v_mfma_f32_16x16x32_bf16 v[56:59], a[64:67], a[152:155], v[56:59]
s_add_u32 m0, s77, 0
s_add_u32 s64, s76, 0
v_mfma_f32_16x16x32_bf16 v[60:63], a[72:75], a[152:155], v[60:63]
buffer_load_dwordx4 v7, s[20:23], s64 offen lds
v_mfma_f32_16x16x32_bf16 v[60:63], a[76:79], a[156:159], v[60:63]
ds_read_b128 a[104:107], v9 offset:10240
v_mfma_f32_16x16x32_bf16 v[52:55], a[76:79], a[148:151], v[52:55]
buffer_load_dword a252, v16, s[32:35], s52 offen
v_mfma_f32_16x16x32_bf16 v[52:55], a[72:75], a[144:147], v[52:55]
ds_read_b64_tr_b16 a[160:161], v11 offset:16384
ds_read_b64_tr_b16 a[162:163], v11 offset:16896
v_mfma_f32_16x16x32_bf16 v[44:47], a[72:75], a[136:139], v[44:47]
buffer_load_dwordx4 v8, s[20:23], s64 offen offset:1024 lds
v_mfma_f32_16x16x32_bf16 v[44:47], a[76:79], a[140:143], v[44:47]
buffer_load_dword a253, v18, s[48:51], s53 offen
v_mfma_f32_16x16x32_bf16 v[36:39], a[76:79], a[132:135], v[36:39]
v_and_b32 v18, 1, v1
v_lshlrev_b32 v18, 21, v18
v_mfma_f32_16x16x32_bf16 v[36:39], a[72:75], a[128:131], v[36:39]
ds_read_b128 a[108:111], v10 offset:10240
v_mfma_f32_16x16x32_bf16 v[64:67], a[80:83], a[128:131], v[64:67]
v_mfma_f32_16x16x32_bf16 v[64:67], a[84:87], a[132:135], v[64:67]
v_mfma_f32_16x16x32_bf16 v[72:75], a[84:87], a[140:143], v[72:75]
s_add_u32 m0, s80, 0
s_add_u32 s64, s79, 0
v_mfma_f32_16x16x32_bf16 v[72:75], a[80:83], a[136:139], v[72:75]
ds_read_b64_tr_b16 a[164:165], v11 offset:24576
ds_read_b64_tr_b16 a[166:167], v11 offset:25088
v_mfma_f32_16x16x32_bf16 v[80:83], a[80:83], a[144:147], v[80:83]
buffer_load_dwordx4 v4, s[24:27], s64 offen sc1 lds
v_mfma_f32_16x16x32_bf16 v[80:83], a[84:87], a[148:151], v[80:83]
ds_read_b128 a[112:115], v9 offset:12288
v_mfma_f32_16x16x32_bf16 v[88:91], a[84:87], a[156:159], v[88:91]
v_mfma_f32_16x16x32_bf16 v[88:91], a[80:83], a[152:155], v[88:91]
v_mfma_f32_16x16x32_bf16 v[92:95], a[88:91], a[152:155], v[92:95]
ds_read_b64_tr_b16 a[168:169], v12 offset:16384
ds_read_b64_tr_b16 a[170:171], v12 offset:16896
v_mfma_f32_16x16x32_bf16 v[92:95], a[92:95], a[156:159], v[92:95]
v_mfma_f32_16x16x32_bf16 v[84:87], a[92:95], a[148:151], v[84:87]
s_add_u32 m0, s73, 69632
s_add_u32 s64, s72, 0
v_mfma_f32_16x16x32_bf16 v[84:87], a[88:91], a[144:147], v[84:87]
v_mfma_f32_16x16x32_bf16 v[76:79], a[88:91], a[136:139], v[76:79]
buffer_load_dwordx4 v5, s[12:15], s64 offen lds
v_mfma_f32_16x16x32_bf16 v[76:79], a[92:95], a[140:143], v[76:79]
ds_read_b128 a[116:119], v10 offset:12288
v_mfma_f32_16x16x32_bf16 v[68:71], a[92:95], a[132:135], v[68:71]
v_mfma_f32_16x16x32_bf16 v[68:71], a[88:91], a[128:131], v[68:71]
s_waitcnt lgkmcnt(6)
ds_read_b64_tr_b16 a[172:173], v12 offset:24576
ds_read_b64_tr_b16 a[174:175], v12 offset:25088
v_mfma_f32_16x16x32_bf16 v[96:99], a[96:99], a[128:131], v[96:99]
v_mfma_f32_16x16x32_bf16 v[96:99], a[100:103], a[132:135], v[96:99]
v_mfma_f32_16x16x32_bf16 v[104:107], a[100:103], a[140:143], v[104:107]
ds_read_b128 a[120:123], v9 offset:14336
v_mfma_f32_16x16x32_bf16 v[104:107], a[96:99], a[136:139], v[104:107]
v_mfma_f32_16x16x32_bf16 v[112:115], a[96:99], a[144:147], v[112:115]
v_mfma_f32_16x16x32_bf16 v[112:115], a[100:103], a[148:151], v[112:115]
buffer_load_dwordx4 v6, s[12:15], s64 offen offset:1024 lds
v_mfma_f32_16x16x32_bf16 v[120:123], a[100:103], a[156:159], v[120:123]
ds_read_b64_tr_b16 a[176:177], v13 offset:16384
ds_read_b64_tr_b16 a[178:179], v13 offset:16896
v_mfma_f32_16x16x32_bf16 v[120:123], a[96:99], a[152:155], v[120:123]
v_mfma_f32_16x16x32_bf16 v[124:127], a[104:107], a[152:155], v[124:127]
v_mfma_f32_16x16x32_bf16 v[124:127], a[108:111], a[156:159], v[124:127]
ds_read_b128 a[124:127], v10 offset:14336
v_mfma_f32_16x16x32_bf16 v[116:119], a[108:111], a[148:151], v[116:119]
v_add_u32 v9, 32768, v9
v_add_u32 v10, 32768, v10
v_mfma_f32_16x16x32_bf16 v[116:119], a[104:107], a[144:147], v[116:119]
s_add_u32 m0, s73, 71680
s_add_u32 s64, s72, 18432
v_mfma_f32_16x16x32_bf16 v[108:111], a[104:107], a[136:139], v[108:111]
ds_read_b64_tr_b16 a[180:181], v13 offset:24576
ds_read_b64_tr_b16 a[182:183], v13 offset:25088
v_mfma_f32_16x16x32_bf16 v[108:111], a[108:111], a[140:143], v[108:111]
buffer_load_dwordx4 v5, s[12:15], s64 offen lds
v_mfma_f32_16x16x32_bf16 v[100:103], a[108:111], a[132:135], v[100:103]
v_mfma_f32_16x16x32_bf16 v[100:103], a[104:107], a[128:131], v[100:103]
s_waitcnt lgkmcnt(2)
ds_read_b64_tr_b16 a[184:185], v14 offset:16384
ds_read_b64_tr_b16 a[186:187], v14 offset:16896
v_mfma_f32_16x16x32_bf16 v[128:131], a[112:115], a[128:131], v[128:131]
v_mfma_f32_16x16x32_bf16 v[128:131], a[116:119], a[132:135], v[128:131]
v_mfma_f32_16x16x32_bf16 v[136:139], a[116:119], a[140:143], v[136:139]
ds_read_b64_tr_b16 a[188:189], v14 offset:24576
ds_read_b64_tr_b16 a[190:191], v14 offset:25088
v_mfma_f32_16x16x32_bf16 v[136:139], a[112:115], a[136:139], v[136:139]
v_mfma_f32_16x16x32_bf16 v[144:147], a[112:115], a[144:147], v[144:147]
v_mfma_f32_16x16x32_bf16 v[144:147], a[116:119], a[148:151], v[144:147]
buffer_load_dwordx4 v6, s[12:15], s64 offen offset:1024 lds
v_mfma_f32_16x16x32_bf16 v[152:155], a[116:119], a[156:159], v[152:155]
v_mfma_f32_16x16x32_bf16 v[152:155], a[112:115], a[152:155], v[152:155]
v_mfma_f32_16x16x32_bf16 v[156:159], a[120:123], a[152:155], v[156:159]
v_mfma_f32_16x16x32_bf16 v[156:159], a[124:127], a[156:159], v[156:159]
v_mfma_f32_16x16x32_bf16 v[148:151], a[124:127], a[148:151], v[148:151]
v_mfma_f32_16x16x32_bf16 v[148:151], a[120:123], a[144:147], v[148:151]
v_mfma_f32_16x16x32_bf16 v[140:143], a[120:123], a[136:139], v[140:143]
v_mfma_f32_16x16x32_bf16 v[140:143], a[124:127], a[140:143], v[140:143]
v_mfma_f32_16x16x32_bf16 v[132:135], a[124:127], a[132:135], v[132:135]
v_mfma_f32_16x16x32_bf16 v[132:135], a[120:123], a[128:131], v[132:135]
s_waitcnt lgkmcnt(0)
v_mfma_f32_16x16x32_bf16 v[160:163], a[160:163], a[64:67], v[160:163]
s_waitcnt vmcnt(17)
v_mfma_f32_16x16x32_bf16 v[160:163], a[164:167], a[68:71], v[160:163]
s_barrier
v_mfma_f32_16x16x32_bf16 v[164:167], a[172:175], a[68:71], v[164:167]
ds_read_b64_tr_b16 a[128:129], v11 offset:32768
ds_read_b64_tr_b16 a[130:131], v11 offset:33280
v_mfma_f32_16x16x32_bf16 v[164:167], a[168:171], a[64:67], v[164:167]
s_add_u32 m0, s77, 16384
s_add_u32 s64, s76, 128
v_mfma_f32_16x16x32_bf16 v[168:171], a[176:179], a[64:67], v[168:171]
buffer_load_dwordx4 v7, s[20:23], s64 offen lds
v_mfma_f32_16x16x32_bf16 v[168:171], a[180:183], a[68:71], v[168:171]
buffer_load_dword a253, v18, s[44:47], 0 offen
v_mfma_f32_16x16x32_bf16 v[172:175], a[188:191], a[68:71], v[172:175]
v_mfma_f32_16x16x32_bf16 v[172:175], a[184:187], a[64:67], v[172:175]
ds_read_b128 a[64:67], v9 offset:0
v_mfma_f32_16x16x32_bf16 v[188:191], a[184:187], a[72:75], v[188:191]
ds_read_b64_tr_b16 a[132:133], v11 offset:40960
ds_read_b64_tr_b16 a[134:135], v11 offset:41472
v_mfma_f32_16x16x32_bf16 v[188:191], a[188:191], a[76:79], v[188:191]
v_mfma_f32_16x16x32_bf16 v[184:187], a[180:183], a[76:79], v[184:187]
v_mfma_f32_16x16x32_bf16 v[184:187], a[176:179], a[72:75], v[184:187]
ds_read_b128 a[68:71], v10 offset:0
v_mfma_f32_16x16x32_bf16 v[180:183], a[168:171], a[72:75], v[180:183]
buffer_load_dwordx4 v8, s[20:23], s64 offen offset:1024 lds
v_mfma_f32_16x16x32_bf16 v[180:183], a[172:175], a[76:79], v[180:183]
v_mfma_f32_16x16x32_bf16 v[176:179], a[164:167], a[76:79], v[176:179]
v_mfma_f32_16x16x32_bf16 v[176:179], a[160:163], a[72:75], v[176:179]
ds_read_b64_tr_b16 a[136:137], v12 offset:32768
ds_read_b64_tr_b16 a[138:139], v12 offset:33280
v_mfma_f32_16x16x32_bf16 v[192:195], a[160:163], a[80:83], v[192:195]
v_mfma_f32_16x16x32_bf16 v[192:195], a[164:167], a[84:87], v[192:195]
v_mfma_f32_16x16x32_bf16 v[196:199], a[172:175], a[84:87], v[196:199]
s_add_u32 m0, s80, 16384
s_add_u32 s64, s79, 2048
ds_read_b128 a[72:75], v9 offset:2048
v_mfma_f32_16x16x32_bf16 v[196:199], a[168:171], a[80:83], v[196:199]
v_mfma_f32_16x16x32_bf16 v[200:203], a[176:179], a[80:83], v[200:203]
buffer_load_dwordx4 v4, s[24:27], s64 offen sc1 lds
v_mfma_f32_16x16x32_bf16 v[200:203], a[180:183], a[84:87], v[200:203]
s_xor_b32 s65, s70, 0
s_add_u32 s71, s68, s65
s_add_u32 s72, s69, s65
v_mfma_f32_16x16x32_bf16 v[204:207], a[188:191], a[84:87], v[204:207]
ds_read_b64_tr_b16 a[140:141], v12 offset:40960
ds_read_b64_tr_b16 a[142:143], v12 offset:41472
v_mfma_f32_16x16x32_bf16 v[204:207], a[184:187], a[80:83], v[204:207]
v_mfma_f32_16x16x32_bf16 v[220:223], a[184:187], a[88:91], v[220:223]
ds_read_b128 a[76:79], v10 offset:2048
v_mfma_f32_16x16x32_bf16 v[220:223], a[188:191], a[92:95], v[220:223]
L_PAD3:
s_cbranch_execz L_PAD7
v_mfma_f32_16x16x32_bf16 v[216:219], a[180:183], a[92:95], v[216:219]
s_add_u32 m0, s73, 0
s_add_u32 s64, s71, 0
v_mfma_f32_16x16x32_bf16 v[216:219], a[176:179], a[88:91], v[216:219]
v_mfma_f32_16x16x32_bf16 v[212:215], a[168:171], a[88:91], v[212:215]
buffer_load_dwordx4 v5, s[12:15], s64 offen lds
v_mfma_f32_16x16x32_bf16 v[212:215], a[172:175], a[92:95], v[212:215]
ds_read_b64_tr_b16 a[144:145], v13 offset:32768
ds_read_b64_tr_b16 a[146:147], v13 offset:33280
v_mfma_f32_16x16x32_bf16 v[208:211], a[164:167], a[92:95], v[208:211]
v_mfma_f32_16x16x32_bf16 v[208:211], a[160:163], a[88:91], v[208:211]
ds_read_b128 a[80:83], v9 offset:4096
v_mfma_f32_16x16x32_bf16 v[224:227], a[160:163], a[96:99], v[224:227]
v_mfma_f32_16x16x32_bf16 v[224:227], a[164:167], a[100:103], v[224:227]
v_mfma_f32_16x16x32_bf16 v[228:231], a[172:175], a[100:103], v[228:231]
ds_read_b64_tr_b16 a[148:149], v13 offset:40960
ds_read_b64_tr_b16 a[150:151], v13 offset:41472
v_mfma_f32_16x16x32_bf16 v[228:231], a[168:171], a[96:99], v[228:231]
v_mfma_f32_16x16x32_bf16 v[232:235], a[176:179], a[96:99], v[232:235]
v_mfma_f32_16x16x32_bf16 v[232:235], a[180:183], a[100:103], v[232:235]
buffer_load_dwordx4 v6, s[12:15], s64 offen offset:1024 lds
v_mfma_f32_16x16x32_bf16 v[236:239], a[188:191], a[100:103], v[236:239]
ds_read_b128 a[84:87], v10 offset:4096
v_mfma_f32_16x16x32_bf16 v[236:239], a[184:187], a[96:99], v[236:239]
v_mfma_f32_16x16x32_bf16 v[252:255], a[184:187], a[104:107], v[252:255]
v_mfma_f32_16x16x32_bf16 v[252:255], a[188:191], a[108:111], v[252:255]
ds_read_b64_tr_b16 a[152:153], v14 offset:32768
ds_read_b64_tr_b16 a[154:155], v14 offset:33280
v_mfma_f32_16x16x32_bf16 v[248:251], a[180:183], a[108:111], v[248:251]
v_mfma_f32_16x16x32_bf16 v[248:251], a[176:179], a[104:107], v[248:251]
s_add_u32 m0, s73, 2048
s_add_u32 s64, s71, 18432
v_mfma_f32_16x16x32_bf16 v[244:247], a[168:171], a[104:107], v[244:247]
ds_read_b128 a[88:91], v9 offset:6144
v_mfma_f32_16x16x32_bf16 v[244:247], a[172:175], a[108:111], v[244:247]
buffer_load_dwordx4 v5, s[12:15], s64 offen lds
v_mfma_f32_16x16x32_bf16 v[240:243], a[164:167], a[108:111], v[240:243]
v_mfma_f32_16x16x32_bf16 v[240:243], a[160:163], a[104:107], v[240:243]
ds_read_b64_tr_b16 a[156:157], v14 offset:40960
ds_read_b64_tr_b16 a[158:159], v14 offset:41472
v_mfma_f32_16x16x32_bf16 a[0:3], a[160:163], a[112:115], a[0:3]
v_mfma_f32_16x16x32_bf16 a[0:3], a[164:167], a[116:119], a[0:3]
v_mfma_f32_16x16x32_bf16 a[4:7], a[172:175], a[116:119], a[4:7]
ds_read_b128 a[92:95], v10 offset:6144
v_mfma_f32_16x16x32_bf16 a[4:7], a[168:171], a[112:115], a[4:7]
v_mfma_f32_16x16x32_bf16 a[8:11], a[176:179], a[112:115], a[8:11]
v_mfma_f32_16x16x32_bf16 a[8:11], a[180:183], a[116:119], a[8:11]
buffer_load_dwordx4 v6, s[12:15], s64 offen offset:1024 lds
v_mfma_f32_16x16x32_bf16 a[12:15], a[188:191], a[116:119], a[12:15]
v_mfma_f32_16x16x32_bf16 a[12:15], a[184:187], a[112:115], a[12:15]
v_mfma_f32_16x16x32_bf16 a[28:31], a[184:187], a[120:123], a[28:31]
v_mfma_f32_16x16x32_bf16 a[28:31], a[188:191], a[124:127], a[28:31]
v_mfma_f32_16x16x32_bf16 a[24:27], a[180:183], a[124:127], a[24:27]
v_mfma_f32_16x16x32_bf16 a[24:27], a[176:179], a[120:123], a[24:27]
v_mfma_f32_16x16x32_bf16 a[20:23], a[168:171], a[120:123], a[20:23]
v_mfma_f32_16x16x32_bf16 a[20:23], a[172:175], a[124:127], a[20:23]
v_mfma_f32_16x16x32_bf16 a[16:19], a[164:167], a[124:127], a[16:19]
v_mfma_f32_16x16x32_bf16 a[16:19], a[160:163], a[120:123], a[16:19]
s_waitcnt lgkmcnt(0)
v_mfma_f32_16x16x32_bf16 v[32:35], a[64:67], a[128:131], v[32:35]
s_waitcnt vmcnt(21)
v_mfma_f32_16x16x32_bf16 v[32:35], a[68:71], a[132:135], v[32:35]
s_barrier
v_mfma_f32_16x16x32_bf16 v[40:43], a[68:71], a[140:143], v[40:43]
ds_read_b128 a[96:99], v9 offset:8192
v_mfma_f32_16x16x32_bf16 v[40:43], a[64:67], a[136:139], v[40:43]
s_xor_b32 s75, s93, 0
s_lshl_b32 s76, s75, 19
s_add_u32 s76, s76, s74
v_mfma_f32_16x16x32_bf16 v[48:51], a[64:67], a[144:147], v[48:51]
s_lshl_b32 s79, s75, 13
s_add_u32 s79, s79, s78
v_mfma_f32_16x16x32_bf16 v[48:51], a[68:71], a[148:151], v[48:51]
s_add_u32 m0, s77, 32768
s_add_u32 s64, s76, 0
ds_read_b128 a[100:103], v10 offset:8192
v_mfma_f32_16x16x32_bf16 v[56:59], a[68:71], a[156:159], v[56:59]
buffer_load_dwordx4 v7, s[20:23], s64 offen lds
v_mfma_f32_16x16x32_bf16 v[56:59], a[64:67], a[152:155], v[56:59]
v_mfma_f32_16x16x32_bf16 v[60:63], a[72:75], a[152:155], v[60:63]
ds_read_b128 a[104:107], v9 offset:10240
v_mfma_f32_16x16x32_bf16 v[60:63], a[76:79], a[156:159], v[60:63]
v_mfma_f32_16x16x32_bf16 v[52:55], a[76:79], a[148:151], v[52:55]
v_mfma_f32_16x16x32_bf16 v[52:55], a[72:75], a[144:147], v[52:55]
ds_read_b64_tr_b16 a[160:161], v11 offset:49152
ds_read_b64_tr_b16 a[162:163], v11 offset:49664
v_mfma_f32_16x16x32_bf16 v[44:47], a[72:75], a[136:139], v[44:47]
buffer_load_dwordx4 v8, s[20:23], s64 offen offset:1024 lds
v_mfma_f32_16x16x32_bf16 v[44:47], a[76:79], a[140:143], v[44:47]
v_mfma_f32_16x16x32_bf16 v[36:39], a[76:79], a[132:135], v[36:39]
v_mfma_f32_16x16x32_bf16 v[36:39], a[72:75], a[128:131], v[36:39]
ds_read_b128 a[108:111], v10 offset:10240
v_mfma_f32_16x16x32_bf16 v[64:67], a[80:83], a[128:131], v[64:67]
v_mfma_f32_16x16x32_bf16 v[64:67], a[84:87], a[132:135], v[64:67]
v_mfma_f32_16x16x32_bf16 v[72:75], a[84:87], a[140:143], v[72:75]
s_add_u32 m0, s80, 32768
s_add_u32 s64, s79, 0
v_mfma_f32_16x16x32_bf16 v[72:75], a[80:83], a[136:139], v[72:75]
ds_read_b64_tr_b16 a[164:165], v11 offset:57344
ds_read_b64_tr_b16 a[166:167], v11 offset:57856
v_mfma_f32_16x16x32_bf16 v[80:83], a[80:83], a[144:147], v[80:83]
buffer_load_dwordx4 v4, s[24:27], s64 offen sc1 lds
v_mfma_f32_16x16x32_bf16 v[80:83], a[84:87], a[148:151], v[80:83]
ds_read_b128 a[112:115], v9 offset:12288
v_mfma_f32_16x16x32_bf16 v[88:91], a[84:87], a[156:159], v[88:91]
v_cvt_pk_bf16_f32 v32, v32, v33
v_cvt_pk_bf16_f32 v33, v34, v35
v_mfma_f32_16x16x32_bf16 v[88:91], a[80:83], a[152:155], v[88:91]
v_cvt_pk_bf16_f32 v34, v36, v37
v_cvt_pk_bf16_f32 v35, v38, v39
v_mfma_f32_16x16x32_bf16 v[92:95], a[88:91], a[152:155], v[92:95]
ds_read_b64_tr_b16 a[168:169], v12 offset:49152
ds_read_b64_tr_b16 a[170:171], v12 offset:49664
v_mfma_f32_16x16x32_bf16 v[92:95], a[92:95], a[156:159], v[92:95]
v_cvt_pk_bf16_f32 v40, v40, v41
v_cvt_pk_bf16_f32 v41, v42, v43
v_mfma_f32_16x16x32_bf16 v[84:87], a[92:95], a[148:151], v[84:87]
s_add_u32 m0, s73, 4096
s_add_u32 s64, s72, 0
s_lshr_b32 s55, s3, 1
v_mfma_f32_16x16x32_bf16 v[84:87], a[88:91], a[144:147], v[84:87]
s_lshl_b32 s55, s55, 14
s_lshl_b32 s54, s3, 13
s_sub_u32 s55, s54, s55
v_mfma_f32_16x16x32_bf16 v[76:79], a[88:91], a[136:139], v[76:79]
buffer_load_dwordx4 v5, s[12:15], s64 offen lds
v_mfma_f32_16x16x32_bf16 v[76:79], a[92:95], a[140:143], v[76:79]
s_and_b32 s54, s3, 1
s_lshl_b32 s54, s54, 12
ds_read_b128 a[116:119], v10 offset:12288
v_mfma_f32_16x16x32_bf16 v[68:71], a[92:95], a[132:135], v[68:71]
s_add_u32 s53, s88, 0
v_cvt_pk_bf16_f32 v42, v44, v45
v_cvt_pk_bf16_f32 v43, v46, v47
v_mfma_f32_16x16x32_bf16 v[68:71], a[88:91], a[128:131], v[68:71]
s_waitcnt lgkmcnt(6)
ds_read_b64_tr_b16 a[172:173], v12 offset:57344
ds_read_b64_tr_b16 a[174:175], v12 offset:57856
v_mfma_f32_16x16x32_bf16 v[96:99], a[96:99], a[128:131], v[96:99]
buffer_store_dwordx4 v[32:35], v4, s[24:27], s53 offen offset:0 sc1
v_mfma_f32_16x16x32_bf16 v[96:99], a[100:103], a[132:135], v[96:99]
v_cvt_pk_bf16_f32 v48, v48, v49
v_cvt_pk_bf16_f32 v49, v50, v51
v_mfma_f32_16x16x32_bf16 v[104:107], a[100:103], a[140:143], v[104:107]
ds_read_b128 a[120:123], v9 offset:14336
v_cvt_pk_bf16_f32 v50, v52, v53
v_mfma_f32_16x16x32_bf16 v[104:107], a[96:99], a[136:139], v[104:107]
v_cvt_pk_bf16_f32 v51, v54, v55
v_cvt_pk_bf16_f32 v56, v56, v57
v_mfma_f32_16x16x32_bf16 v[112:115], a[96:99], a[144:147], v[112:115]
v_cvt_pk_bf16_f32 v57, v58, v59
v_cvt_pk_bf16_f32 v58, v60, v61
v_mfma_f32_16x16x32_bf16 v[112:115], a[100:103], a[148:151], v[112:115]
buffer_load_dwordx4 v6, s[12:15], s64 offen offset:1024 lds
v_mfma_f32_16x16x32_bf16 v[120:123], a[100:103], a[156:159], v[120:123]
ds_read_b64_tr_b16 a[176:177], v13 offset:49152
ds_read_b64_tr_b16 a[178:179], v13 offset:49664
v_mfma_f32_16x16x32_bf16 v[120:123], a[96:99], a[152:155], v[120:123]
v_cvt_pk_bf16_f32 v59, v62, v63
v_cvt_pk_bf16_f32 v64, v64, v65
v_mfma_f32_16x16x32_bf16 v[124:127], a[104:107], a[152:155], v[124:127]
v_cvt_pk_bf16_f32 v65, v66, v67
v_cvt_pk_bf16_f32 v66, v68, v69
v_mfma_f32_16x16x32_bf16 v[124:127], a[108:111], a[156:159], v[124:127]
ds_read_b128 a[124:127], v10 offset:14336
v_cvt_pk_bf16_f32 v67, v70, v71
v_mfma_f32_16x16x32_bf16 v[116:119], a[108:111], a[148:151], v[116:119]
v_add_u32 v9, 32768, v9
v_add_u32 v10, 32768, v10
v_mfma_f32_16x16x32_bf16 v[116:119], a[104:107], a[144:147], v[116:119]
s_add_u32 m0, s73, 6144
s_add_u32 s64, s72, 18432
v_cvt_pk_bf16_f32 v72, v72, v73
v_mfma_f32_16x16x32_bf16 v[108:111], a[104:107], a[136:139], v[108:111]
ds_read_b64_tr_b16 a[180:181], v13 offset:57344
ds_read_b64_tr_b16 a[182:183], v13 offset:57856
v_mfma_f32_16x16x32_bf16 v[108:111], a[108:111], a[140:143], v[108:111]
buffer_load_dwordx4 v5, s[12:15], s64 offen lds
v_mfma_f32_16x16x32_bf16 v[100:103], a[108:111], a[132:135], v[100:103]
v_cvt_pk_bf16_f32 v73, v74, v75
v_cvt_pk_bf16_f32 v74, v76, v77
v_mfma_f32_16x16x32_bf16 v[100:103], a[104:107], a[128:131], v[100:103]
s_waitcnt lgkmcnt(2)
ds_read_b64_tr_b16 a[184:185], v14 offset:49152
ds_read_b64_tr_b16 a[186:187], v14 offset:49664
v_mfma_f32_16x16x32_bf16 v[128:131], a[112:115], a[128:131], v[128:131]
v_cvt_pk_bf16_f32 v75, v78, v79
v_cvt_pk_bf16_f32 v80, v80, v81
v_mfma_f32_16x16x32_bf16 v[128:131], a[116:119], a[132:135], v[128:131]
v_cvt_pk_bf16_f32 v81, v82, v83
v_cvt_pk_bf16_f32 v82, v84, v85
v_mfma_f32_16x16x32_bf16 v[136:139], a[116:119], a[140:143], v[136:139]
ds_read_b64_tr_b16 a[188:189], v14 offset:57344
ds_read_b64_tr_b16 a[190:191], v14 offset:57856
v_mfma_f32_16x16x32_bf16 v[136:139], a[112:115], a[136:139], v[136:139]
v_add_u32 v9, s55, v9
v_add_u32 v10, s55, v10
v_mfma_f32_16x16x32_bf16 v[144:147], a[112:115], a[144:147], v[144:147]
v_subrev_u32 v11, s54, v11
v_subrev_u32 v12, s54, v12
v_mfma_f32_16x16x32_bf16 v[144:147], a[116:119], a[148:151], v[144:147]
buffer_load_dwordx4 v6, s[12:15], s64 offen offset:1024 lds
v_mfma_f32_16x16x32_bf16 v[152:155], a[116:119], a[156:159], v[152:155]
v_subrev_u32 v13, s54, v13
v_subrev_u32 v14, s54, v14
v_mfma_f32_16x16x32_bf16 v[152:155], a[112:115], a[152:155], v[152:155]
v_cvt_pk_bf16_f32 v83, v86, v87
v_cvt_pk_bf16_f32 v88, v88, v89
v_mfma_f32_16x16x32_bf16 v[156:159], a[120:123], a[152:155], v[156:159]
v_cvt_pk_bf16_f32 v89, v90, v91
v_cvt_pk_bf16_f32 v90, v92, v93
v_mfma_f32_16x16x32_bf16 v[156:159], a[124:127], a[156:159], v[156:159]
s_add_u32 s53, s88, 0
v_cvt_pk_bf16_f32 v91, v94, v95
v_cvt_pk_bf16_f32 v96, v96, v97
v_mfma_f32_16x16x32_bf16 v[148:151], a[124:127], a[148:151], v[148:151]
buffer_store_dwordx4 v[40:43], v4, s[24:27], s53 offen offset:1024 sc1
v_mfma_f32_16x16x32_bf16 v[148:151], a[120:123], a[144:147], v[148:151]
v_cvt_pk_bf16_f32 v97, v98, v99
v_cvt_pk_bf16_f32 v98, v100, v101
v_mfma_f32_16x16x32_bf16 v[140:143], a[120:123], a[136:139], v[140:143]
v_cvt_pk_bf16_f32 v99, v102, v103
v_cvt_pk_bf16_f32 v104, v104, v105
v_mfma_f32_16x16x32_bf16 v[140:143], a[124:127], a[140:143], v[140:143]
v_cvt_pk_bf16_f32 v105, v106, v107
v_cvt_pk_bf16_f32 v106, v108, v109
v_mfma_f32_16x16x32_bf16 v[132:135], a[124:127], a[132:135], v[132:135]
v_cvt_pk_bf16_f32 v107, v110, v111
v_cvt_pk_bf16_f32 v112, v112, v113
v_mfma_f32_16x16x32_bf16 v[132:135], a[120:123], a[128:131], v[132:135]
s_waitcnt lgkmcnt(0)
v_cvt_pk_bf16_f32 v113, v114, v115
v_cvt_pk_bf16_f32 v114, v116, v117
v_mfma_f32_16x16x32_bf16 v[160:163], a[160:163], a[64:67], v[160:163]
s_waitcnt vmcnt(17)
v_cvt_pk_bf16_f32 v115, v118, v119
v_cvt_pk_bf16_f32 v120, v120, v121
v_mfma_f32_16x16x32_bf16 v[160:163], a[164:167], a[68:71], v[160:163]
s_barrier
v_mfma_f32_16x16x32_bf16 v[164:167], a[172:175], a[68:71], v[164:167]
ds_read_b64_tr_b16 a[128:129], v11 offset:0
ds_read_b64_tr_b16 a[130:131], v11 offset:512
v_mfma_f32_16x16x32_bf16 v[164:167], a[168:171], a[64:67], v[164:167]
s_add_u32 m0, s77, 49152
s_add_u32 s64, s76, 128
v_cvt_pk_bf16_f32 v121, v122, v123
v_mfma_f32_16x16x32_bf16 v[168:171], a[176:179], a[64:67], v[168:171]
buffer_load_dwordx4 v7, s[20:23], s64 offen lds
v_mfma_f32_16x16x32_bf16 v[168:171], a[180:183], a[68:71], v[168:171]
ds_read_b64_tr_b16 a[132:133], v11 offset:4096
ds_read_b64_tr_b16 a[134:135], v11 offset:4608
v_mfma_f32_16x16x32_bf16 v[172:175], a[188:191], a[68:71], v[172:175]
v_cvt_pk_bf16_f32 v122, v124, v125
v_cvt_pk_bf16_f32 v123, v126, v127
v_mfma_f32_16x16x32_bf16 v[172:175], a[184:187], a[64:67], v[172:175]
v_cvt_pk_bf16_f32 v128, v128, v129
v_cvt_pk_bf16_f32 v129, v130, v131
v_mfma_f32_16x16x32_bf16 v[188:191], a[184:187], a[72:75], v[188:191]
ds_read_b64_tr_b16 a[136:137], v12 offset:0
ds_read_b64_tr_b16 a[138:139], v12 offset:512
v_mfma_f32_16x16x32_bf16 v[188:191], a[188:191], a[76:79], v[188:191]
v_cvt_pk_bf16_f32 v130, v132, v133
v_cvt_pk_bf16_f32 v131, v134, v135
v_mfma_f32_16x16x32_bf16 v[184:187], a[180:183], a[76:79], v[184:187]
v_cvt_pk_bf16_f32 v136, v136, v137
v_cvt_pk_bf16_f32 v137, v138, v139
v_mfma_f32_16x16x32_bf16 v[184:187], a[176:179], a[72:75], v[184:187]
ds_read_b64_tr_b16 a[140:141], v12 offset:4096
ds_read_b64_tr_b16 a[142:143], v12 offset:4608
v_mfma_f32_16x16x32_bf16 v[180:183], a[168:171], a[72:75], v[180:183]
buffer_load_dwordx4 v8, s[20:23], s64 offen offset:1024 lds
v_mfma_f32_16x16x32_bf16 v[180:183], a[172:175], a[76:79], v[180:183]
v_cvt_pk_bf16_f32 v138, v140, v141
v_cvt_pk_bf16_f32 v139, v142, v143
v_mfma_f32_16x16x32_bf16 v[176:179], a[164:167], a[76:79], v[176:179]
v_cvt_pk_bf16_f32 v144, v144, v145
v_cvt_pk_bf16_f32 v145, v146, v147
v_mfma_f32_16x16x32_bf16 v[176:179], a[160:163], a[72:75], v[176:179]
ds_read_b64_tr_b16 a[144:145], v13 offset:0
ds_read_b64_tr_b16 a[146:147], v13 offset:512
v_mfma_f32_16x16x32_bf16 v[192:195], a[160:163], a[80:83], v[192:195]
v_cvt_pk_bf16_f32 v146, v148, v149
v_cvt_pk_bf16_f32 v147, v150, v151
v_mfma_f32_16x16x32_bf16 v[192:195], a[164:167], a[84:87], v[192:195]
v_cvt_pk_bf16_f32 v152, v152, v153
v_cvt_pk_bf16_f32 v153, v154, v155
v_mfma_f32_16x16x32_bf16 v[196:199], a[172:175], a[84:87], v[196:199]
s_add_u32 m0, s80, 49152
s_add_u32 s64, s79, 2048
v_cvt_pk_bf16_f32 v154, v156, v157
v_mfma_f32_16x16x32_bf16 v[196:199], a[168:171], a[80:83], v[196:199]
ds_read_b64_tr_b16 a[148:149], v13 offset:4096
ds_read_b64_tr_b16 a[150:151], v13 offset:4608
v_mfma_f32_16x16x32_bf16 v[200:203], a[176:179], a[80:83], v[200:203]
buffer_load_dwordx4 v4, s[24:27], s64 offen sc1 lds
v_mfma_f32_16x16x32_bf16 v[200:203], a[180:183], a[84:87], v[200:203]
s_xor_b32 s65, s70, 128
s_add_u32 s71, s68, s65
s_add_u32 s72, s69, s65
v_mfma_f32_16x16x32_bf16 v[204:207], a[188:191], a[84:87], v[204:207]
s_add_u32 s53, s88, 0
ds_read_b64_tr_b16 a[152:153], v14 offset:0
ds_read_b64_tr_b16 a[154:155], v14 offset:512
v_mfma_f32_16x16x32_bf16 v[204:207], a[184:187], a[80:83], v[204:207]
buffer_store_dwordx4 v[48:51], v4, s[24:27], s53 offen offset:2048 sc1
v_mfma_f32_16x16x32_bf16 v[220:223], a[184:187], a[88:91], v[220:223]
ds_read_b64_tr_b16 a[156:157], v14 offset:4096
ds_read_b64_tr_b16 a[158:159], v14 offset:4608
v_mfma_f32_16x16x32_bf16 v[220:223], a[188:191], a[92:95], v[220:223]
v_cvt_pk_bf16_f32 v155, v158, v159
v_mul_f32 v160, s91, v160
v_mfma_f32_16x16x32_bf16 v[216:219], a[180:183], a[92:95], v[216:219]
s_add_u32 m0, s73, 32768
s_add_u32 s64, s71, 0
v_mul_f32 v161, s91, v161
v_mfma_f32_16x16x32_bf16 v[216:219], a[176:179], a[88:91], v[216:219]
v_mul_f32 v162, s91, v162
v_mul_f32 v163, s91, v163
v_mfma_f32_16x16x32_bf16 v[212:215], a[168:171], a[88:91], v[212:215]
buffer_load_dwordx4 v5, s[12:15], s64 offen lds
v_mfma_f32_16x16x32_bf16 v[212:215], a[172:175], a[92:95], v[212:215]
ds_read_b128 a[68:71], v4 offset:10240
v_mul_f32 v164, s91, v164
v_mfma_f32_16x16x32_bf16 v[208:211], a[164:167], a[92:95], v[208:211]
v_mul_f32 v165, s91, v165
v_mul_f32 v166, s91, v166
v_mfma_f32_16x16x32_bf16 v[208:211], a[160:163], a[88:91], v[208:211]
ds_read_b128 a[64:67], v4 offset:8192
v_mul_f32 v167, s91, v167
v_mfma_f32_16x16x32_bf16 v[224:227], a[160:163], a[96:99], v[224:227]
v_cvt_pk_bf16_f32 v160, v160, v161
v_cvt_pk_bf16_f32 v161, v162, v163
v_mfma_f32_16x16x32_bf16 v[224:227], a[164:167], a[100:103], v[224:227]
v_cvt_pk_bf16_f32 v162, v164, v165
v_cvt_pk_bf16_f32 v163, v166, v167
v_mfma_f32_16x16x32_bf16 v[228:231], a[172:175], a[100:103], v[228:231]
ds_read_b128 a[76:79], v4 offset:11264
v_mul_f32 v168, s91, v168
v_mfma_f32_16x16x32_bf16 v[228:231], a[168:171], a[96:99], v[228:231]
v_mul_f32 v169, s91, v169
v_mul_f32 v170, s91, v170
v_mfma_f32_16x16x32_bf16 v[232:235], a[176:179], a[96:99], v[232:235]
v_mul_f32 v171, s91, v171
v_mul_f32 v172, s91, v172
v_mfma_f32_16x16x32_bf16 v[232:235], a[180:183], a[100:103], v[232:235]
buffer_load_dwordx4 v6, s[12:15], s64 offen offset:1024 lds
v_mfma_f32_16x16x32_bf16 v[236:239], a[188:191], a[100:103], v[236:239]
ds_read_b128 a[72:75], v4 offset:9216
v_mul_f32 v173, s91, v173
v_mfma_f32_16x16x32_bf16 v[236:239], a[184:187], a[96:99], v[236:239]
v_mul_f32 v174, s91, v174
v_mul_f32 v175, s91, v175
v_mfma_f32_16x16x32_bf16 v[252:255], a[184:187], a[104:107], v[252:255]
v_cvt_pk_bf16_f32 v168, v168, v169
v_cvt_pk_bf16_f32 v169, v170, v171
v_mfma_f32_16x16x32_bf16 v[252:255], a[188:191], a[108:111], v[252:255]
ds_read_b128 a[84:87], v10 offset:0
v_cvt_pk_bf16_f32 v170, v172, v173
v_mfma_f32_16x16x32_bf16 v[248:251], a[180:183], a[108:111], v[248:251]
v_cvt_pk_bf16_f32 v171, v174, v175
v_mul_f32 v176, s91, v176
v_mfma_f32_16x16x32_bf16 v[248:251], a[176:179], a[104:107], v[248:251]
s_add_u32 m0, s73, 34816
s_add_u32 s64, s71, 18432
v_mul_f32 v177, s91, v177
v_mfma_f32_16x16x32_bf16 v[244:247], a[168:171], a[104:107], v[244:247]
ds_read_b128 a[80:83], v9 offset:0
v_mul_f32 v178, s91, v178
v_mfma_f32_16x16x32_bf16 v[244:247], a[172:175], a[108:111], v[244:247]
buffer_load_dwordx4 v5, s[12:15], s64 offen lds
v_mfma_f32_16x16x32_bf16 v[240:243], a[164:167], a[108:111], v[240:243]
v_mul_f32 v179, s91, v179
v_mul_f32 v180, s91, v180
v_mfma_f32_16x16x32_bf16 v[240:243], a[160:163], a[104:107], v[240:243]
s_add_u32 s53, s88, 0
ds_read_b128 a[92:95], v10 offset:2048
v_mul_f32 v181, s91, v181
v_mfma_f32_16x16x32_bf16 a[0:3], a[160:163], a[112:115], a[0:3]
buffer_store_dwordx4 v[56:59], v4, s[24:27], s53 offen offset:3072 sc1
v_mfma_f32_16x16x32_bf16 a[0:3], a[164:167], a[116:119], a[0:3]
v_mul_f32 v182, s91, v182
v_mul_f32 v183, s91, v183
v_mfma_f32_16x16x32_bf16 a[4:7], a[172:175], a[116:119], a[4:7]
ds_read_b128 a[88:91], v9 offset:2048
v_cvt_pk_bf16_f32 v176, v176, v177
v_mfma_f32_16x16x32_bf16 a[4:7], a[168:171], a[112:115], a[4:7]
v_cvt_pk_bf16_f32 v177, v178, v179
v_cvt_pk_bf16_f32 v178, v180, v181
v_mfma_f32_16x16x32_bf16 a[8:11], a[176:179], a[112:115], a[8:11]
v_cvt_pk_bf16_f32 v179, v182, v183
v_mul_f32 v184, s91, v184
v_mfma_f32_16x16x32_bf16 a[8:11], a[180:183], a[116:119], a[8:11]
buffer_load_dwordx4 v6, s[12:15], s64 offen offset:1024 lds
v_mfma_f32_16x16x32_bf16 a[12:15], a[188:191], a[116:119], a[12:15]
v_mul_f32 v185, s91, v185
v_mul_f32 v186, s91, v186
v_mfma_f32_16x16x32_bf16 a[12:15], a[184:187], a[112:115], a[12:15]
v_mul_f32 v187, s91, v187
v_mul_f32 v188, s91, v188
v_mfma_f32_16x16x32_bf16 a[28:31], a[184:187], a[120:123], a[28:31]
v_mul_f32 v189, s91, v189
v_mul_f32 v190, s91, v190
v_mfma_f32_16x16x32_bf16 a[28:31], a[188:191], a[124:127], a[28:31]
v_mul_f32 v191, s91, v191
v_cvt_pk_bf16_f32 v184, v184, v185
v_mfma_f32_16x16x32_bf16 a[24:27], a[180:183], a[124:127], a[24:27]
v_cvt_pk_bf16_f32 v185, v186, v187
v_cvt_pk_bf16_f32 v186, v188, v189
v_mfma_f32_16x16x32_bf16 a[24:27], a[176:179], a[120:123], a[24:27]
v_cvt_pk_bf16_f32 v187, v190, v191
v_mul_f32 v192, s91, v192
v_mfma_f32_16x16x32_bf16 a[20:23], a[168:171], a[120:123], a[20:23]
v_mul_f32 v193, s91, v193
v_mul_f32 v194, s91, v194
v_mfma_f32_16x16x32_bf16 a[20:23], a[172:175], a[124:127], a[20:23]
v_mul_f32 v195, s91, v195
v_mul_f32 v196, s91, v196
v_mfma_f32_16x16x32_bf16 a[16:19], a[164:167], a[124:127], a[16:19]
v_mul_f32 v197, s91, v197
v_mul_f32 v198, s91, v198
v_mfma_f32_16x16x32_bf16 a[16:19], a[160:163], a[120:123], a[16:19]
s_waitcnt lgkmcnt(0)
v_mul_f32 v199, s91, v199
v_cvt_pk_bf16_f32 v192, v192, v193
v_mfma_f32_16x16x32_bf16 v[36:39], a[128:131], a[80:83], 0
s_waitcnt vmcnt(22)
v_cvt_pk_bf16_f32 v193, v194, v195
v_cvt_pk_bf16_f32 v194, v196, v197
v_mfma_f32_16x16x32_bf16 v[36:39], a[132:135], a[84:87], v[36:39]
s_barrier
v_mfma_f32_16x16x32_bf16 v[44:47], a[140:143], a[84:87], 0
ds_read_b128 a[96:99], v9 offset:4096
v_cvt_pk_bf16_f32 v195, v198, v199
v_mfma_f32_16x16x32_bf16 v[44:47], a[136:139], a[80:83], v[44:47]
s_xor_b32 s75, s93, 1
s_lshl_b32 s76, s75, 19
s_add_u32 s76, s76, s74
v_mfma_f32_16x16x32_bf16 v[32:35], a[144:147], a[80:83], 0
s_lshl_b32 s79, s75, 13
s_add_u32 s79, s79, s78
ds_read_b128 a[100:103], v10 offset:4096
v_mfma_f32_16x16x32_bf16 v[32:35], a[148:151], a[84:87], v[32:35]
s_add_u32 m0, s77, 0
s_add_u32 s64, s76, 0
ds_read_b128 a[104:107], v9 offset:6144
v_mfma_f32_16x16x32_bf16 v[52:55], a[156:159], a[84:87], 0
buffer_load_dwordx4 v7, s[20:23], s64 offen lds
v_mfma_f32_16x16x32_bf16 v[52:55], a[152:155], a[80:83], v[52:55]
ds_read_b64_tr_b16 a[160:161], v11 offset:16384
ds_read_b64_tr_b16 a[162:163], v11 offset:16896
v_mfma_f32_16x16x32_bf16 v[60:63], a[64:67], a[80:83], 0
v_mul_f32 v200, s91, v200
v_mul_f32 v201, s91, v201
v_mfma_f32_16x16x32_bf16 v[60:63], a[68:71], a[84:87], v[60:63]
ds_read_b128 a[108:111], v10 offset:6144
v_mul_f32 v202, s91, v202
v_mfma_f32_16x16x32_bf16 v[68:71], a[76:79], a[84:87], 0
buffer_load_dwordx4 v8, s[20:23], s64 offen offset:1024 lds
v_mfma_f32_16x16x32_bf16 v[68:71], a[72:75], a[80:83], v[68:71]
s_add_u32 s53, s88, 262144
ds_read_b64_tr_b16 a[164:165], v11 offset:20480
ds_read_b64_tr_b16 a[166:167], v11 offset:20992
v_mfma_f32_16x16x32_bf16 v[76:79], a[72:75], a[88:91], 0
v_add_u32 v9, -65536, v9
v_add_u32 v10, -65536, v10
v_mfma_f32_16x16x32_bf16 v[76:79], a[76:79], a[92:95], v[76:79]
ds_read_b64_tr_b16 a[168:169], v12 offset:16384
ds_read_b64_tr_b16 a[170:171], v12 offset:16896
v_mfma_f32_16x16x32_bf16 v[84:87], a[68:71], a[92:95], 0
s_add_u32 m0, s80, 0
s_add_u32 s64, s79, 0
v_mul_f32 v203, s91, v203
v_mfma_f32_16x16x32_bf16 v[84:87], a[64:67], a[88:91], v[84:87]
ds_read_b64_tr_b16 a[172:173], v12 offset:20480
ds_read_b64_tr_b16 a[174:175], v12 offset:20992
v_mfma_f32_16x16x32_bf16 v[92:95], a[152:155], a[88:91], 0
buffer_load_dwordx4 v4, s[24:27], s64 offen sc1 lds
v_mfma_f32_16x16x32_bf16 v[92:95], a[156:159], a[92:95], v[92:95]
buffer_store_dwordx4 v[64:67], v4, s[24:27], s53 offen offset:0 sc1
v_mfma_f32_16x16x32_bf16 v[40:43], a[148:151], a[92:95], 0
ds_read_b64_tr_b16 a[176:177], v13 offset:16384
ds_read_b64_tr_b16 a[178:179], v13 offset:16896
v_mfma_f32_16x16x32_bf16 v[40:43], a[144:147], a[88:91], v[40:43]
v_mul_f32 v204, s91, v204
v_mul_f32 v205, s91, v205
v_mfma_f32_16x16x32_bf16 v[100:103], a[136:139], a[88:91], 0
s_add_u32 m0, s73, 36864
s_add_u32 s64, s72, 0
v_mul_f32 v206, s91, v206
v_mfma_f32_16x16x32_bf16 v[100:103], a[140:143], a[92:95], v[100:103]
ds_read_b64_tr_b16 a[180:181], v13 offset:20480
ds_read_b64_tr_b16 a[182:183], v13 offset:20992
v_mfma_f32_16x16x32_bf16 v[108:111], a[132:135], a[92:95], 0
buffer_load_dwordx4 v5, s[12:15], s64 offen lds
v_mfma_f32_16x16x32_bf16 v[108:111], a[128:131], a[88:91], v[108:111]
s_waitcnt lgkmcnt(14)
ds_read_b64_tr_b16 a[184:185], v14 offset:16384
ds_read_b64_tr_b16 a[186:187], v14 offset:16896
v_mfma_f32_16x16x32_bf16 v[116:119], a[128:131], a[96:99], 0
ds_read_b64_tr_b16 a[188:189], v14 offset:20480
ds_read_b64_tr_b16 a[190:191], v14 offset:20992
v_mfma_f32_16x16x32_bf16 v[116:119], a[132:135], a[100:103], v[116:119]
v_mul_f32 v207, s91, v207
v_cvt_pk_bf16_f32 v200, v200, v201
v_mfma_f32_16x16x32_bf16 v[124:127], a[140:143], a[100:103], 0
v_cvt_pk_bf16_f32 v201, v202, v203
v_cvt_pk_bf16_f32 v202, v204, v205
v_mfma_f32_16x16x32_bf16 v[124:127], a[136:139], a[96:99], v[124:127]
ds_read_b128 a[112:115], v4 offset:24576
v_cvt_pk_bf16_f32 v203, v206, v207
v_mfma_f32_16x16x32_bf16 v[132:135], a[144:147], a[96:99], 0
buffer_load_dwordx4 v6, s[12:15], s64 offen offset:1024 lds
v_mfma_f32_16x16x32_bf16 v[132:135], a[148:151], a[100:103], v[132:135]
ds_read_b128 a[116:119], v4 offset:26624
v_mul_f32 v208, s91, v208
v_mfma_f32_16x16x32_bf16 v[140:143], a[156:159], a[100:103], 0
v_mul_f32 v209, s91, v209
v_mul_f32 v210, s91, v210
v_mfma_f32_16x16x32_bf16 v[140:143], a[152:155], a[96:99], v[140:143]
ds_read_b128 a[120:123], v4 offset:25600
v_mul_f32 v211, s91, v211
v_mfma_f32_16x16x32_bf16 v[148:151], a[64:67], a[96:99], 0
s_add_u32 m0, s73, 38912
s_add_u32 s64, s72, 18432
v_mul_f32 v212, s91, v212
v_mfma_f32_16x16x32_bf16 v[148:151], a[68:71], a[100:103], v[148:151]
ds_read_b128 a[124:127], v4 offset:27648
v_mul_f32 v213, s91, v213
v_mfma_f32_16x16x32_bf16 v[48:51], a[76:79], a[100:103], 0
buffer_load_dwordx4 v5, s[12:15], s64 offen lds
v_mfma_f32_16x16x32_bf16 v[48:51], a[72:75], a[96:99], v[48:51]
s_waitcnt lgkmcnt(15)
v_mul_f32 v214, s91, v214
v_mul_f32 v215, s91, v215
v_mfma_f32_16x16x32_bf16 v[156:159], a[72:75], a[104:107], 0
v_cvt_pk_bf16_f32 v208, v208, v209
v_cvt_pk_bf16_f32 v209, v210, v211
v_mfma_f32_16x16x32_bf16 v[156:159], a[76:79], a[108:111], v[156:159]
s_add_u32 s53, s88, 262144
v_cvt_pk_bf16_f32 v210, v212, v213
v_cvt_pk_bf16_f32 v211, v214, v215
v_mfma_f32_16x16x32_bf16 v[164:167], a[68:71], a[108:111], 0
buffer_store_dwordx4 v[72:75], v4, s[24:27], s53 offen offset:1024 sc1
v_mfma_f32_16x16x32_bf16 v[164:167], a[64:67], a[104:107], v[164:167]
v_mul_f32 v216, s91, v216
v_mul_f32 v217, s91, v217
v_mfma_f32_16x16x32_bf16 v[172:175], a[152:155], a[104:107], 0
buffer_load_dwordx4 v6, s[12:15], s64 offen offset:1024 lds
v_mfma_f32_16x16x32_bf16 v[172:175], a[156:159], a[108:111], v[172:175]
v_mul_f32 v218, s91, v218
v_mul_f32 v219, s91, v219
v_mfma_f32_16x16x32_bf16 v[56:59], a[148:151], a[108:111], 0
v_mul_f32 v220, s91, v220
v_mul_f32 v221, s91, v221
v_mfma_f32_16x16x32_bf16 v[56:59], a[144:147], a[104:107], v[56:59]
v_mul_f32 v222, s91, v222
v_mul_f32 v223, s91, v223
v_mfma_f32_16x16x32_bf16 v[180:183], a[136:139], a[104:107], 0
v_cvt_pk_bf16_f32 v216, v216, v217
v_cvt_pk_bf16_f32 v217, v218, v219
v_mfma_f32_16x16x32_bf16 v[180:183], a[140:143], a[108:111], v[180:183]
v_cvt_pk_bf16_f32 v218, v220, v221
v_cvt_pk_bf16_f32 v219, v222, v223
v_mfma_f32_16x16x32_bf16 v[188:191], a[132:135], a[108:111], 0
v_mul_f32 v224, s91, v224
v_mul_f32 v225, s91, v225
v_mfma_f32_16x16x32_bf16 v[188:191], a[128:131], a[104:107], v[188:191]
s_waitcnt lgkmcnt(0)
v_mul_f32 v226, s91, v226
v_mul_f32 v227, s91, v227
v_mfma_f32_16x16x32_bf16 v[196:199], a[160:163], a[80:83], 0
s_waitcnt vmcnt(19)
v_mul_f32 v228, s91, v228
v_mul_f32 v229, s91, v229
v_mfma_f32_16x16x32_bf16 v[196:199], a[164:167], a[84:87], v[196:199]
s_barrier
v_mfma_f32_16x16x32_bf16 v[64:67], a[172:175], a[84:87], 0
L_PAD4:
s_cbranch_execz L_PAD8
ds_read_b64_tr_b16 a[128:129], v11 offset:32768
ds_read_b64_tr_b16 a[130:131], v11 offset:33280
v_mfma_f32_16x16x32_bf16 v[64:67], a[168:171], a[80:83], v[64:67]
s_add_u32 m0, s77, 16384
s_add_u32 s64, s76, 128
v_mul_f32 v230, s91, v230
v_mfma_f32_16x16x32_bf16 v[204:207], a[176:179], a[80:83], 0
buffer_load_dwordx4 v7, s[20:23], s64 offen lds
v_mfma_f32_16x16x32_bf16 v[204:207], a[180:183], a[84:87], v[204:207]
ds_read_b64_tr_b16 a[132:133], v11 offset:36864
ds_read_b64_tr_b16 a[134:135], v11 offset:37376
v_mfma_f32_16x16x32_bf16 v[212:215], a[188:191], a[84:87], 0
ds_read_b64_tr_b16 a[136:137], v12 offset:32768
ds_read_b64_tr_b16 a[138:139], v12 offset:33280
v_mfma_f32_16x16x32_bf16 v[212:215], a[184:187], a[80:83], v[212:215]
ds_read_b64_tr_b16 a[140:141], v12 offset:36864
ds_read_b64_tr_b16 a[142:143], v12 offset:37376
v_mfma_f32_16x16x32_bf16 v[72:75], a[112:115], a[80:83], 0
v_mul_f32 v231, s91, v231
v_cvt_pk_bf16_f32 v224, v224, v225
v_mfma_f32_16x16x32_bf16 v[72:75], a[116:119], a[84:87], v[72:75]
ds_read_b64_tr_b16 a[144:145], v13 offset:32768
ds_read_b64_tr_b16 a[146:147], v13 offset:33280
v_mfma_f32_16x16x32_bf16 v[220:223], a[124:127], a[84:87], 0
buffer_load_dwordx4 v8, s[20:23], s64 offen offset:1024 lds
v_mfma_f32_16x16x32_bf16 v[220:223], a[120:123], a[80:83], v[220:223]
ds_read_b64_tr_b16 a[148:149], v13 offset:36864
ds_read_b64_tr_b16 a[150:151], v13 offset:37376
v_mfma_f32_16x16x32_bf16 a[32:35], a[120:123], a[88:91], 0
v_cvt_pk_bf16_f32 v225, v226, v227
v_cvt_pk_bf16_f32 v226, v228, v229
v_mfma_f32_16x16x32_bf16 a[32:35], a[124:127], a[92:95], a[32:35]
ds_read_b64_tr_b16 a[152:153], v14 offset:32768
ds_read_b64_tr_b16 a[154:155], v14 offset:33280
v_mfma_f32_16x16x32_bf16 a[36:39], a[116:119], a[92:95], 0
s_add_u32 m0, s80, 16384
s_add_u32 s64, s79, 2048
v_cvt_pk_bf16_f32 v227, v230, v231
v_mfma_f32_16x16x32_bf16 a[36:39], a[112:115], a[88:91], a[36:39]
ds_read_b64_tr_b16 a[156:157], v14 offset:36864
ds_read_b64_tr_b16 a[158:159], v14 offset:37376
v_mfma_f32_16x16x32_bf16 v[228:231], a[184:187], a[88:91], 0
buffer_load_dwordx4 v4, s[24:27], s64 offen sc1 lds
v_mfma_f32_16x16x32_bf16 v[228:231], a[188:191], a[92:95], v[228:231]
s_xor_b32 s65, s70, 256
s_add_u32 s71, s68, s65
s_add_u32 s72, s69, s65
v_mfma_f32_16x16x32_bf16 a[40:43], a[180:183], a[92:95], 0
s_add_u32 s53, s88, 262144
ds_read_b128 a[64:67], v4 offset:40960
v_mul_f32 v232, s91, v232
v_mfma_f32_16x16x32_bf16 a[40:43], a[176:179], a[88:91], a[40:43]
buffer_store_dwordx4 v[80:83], v4, s[24:27], s53 offen offset:2048 sc1
v_mfma_f32_16x16x32_bf16 a[44:47], a[168:171], a[88:91], 0
s_add_u32 m0, s73, 65536
s_add_u32 s64, s71, 0
ds_read_b128 a[80:83], v9 offset:0
v_mfma_f32_16x16x32_bf16 a[44:47], a[172:175], a[92:95], a[44:47]
v_mul_f32 v233, s91, v233
v_mul_f32 v234, s91, v234
v_mfma_f32_16x16x32_bf16 v[80:83], a[164:167], a[92:95], 0
buffer_load_dwordx4 v5, s[12:15], s64 offen lds
v_mfma_f32_16x16x32_bf16 v[80:83], a[160:163], a[88:91], v[80:83]
ds_read_b128 a[68:71], v4 offset:43008
v_mul_f32 v235, s91, v235
v_mfma_f32_16x16x32_bf16 a[48:51], a[160:163], a[96:99], 0
ds_read_b128 a[84:87], v10 offset:0
v_mul_f32 v236, s91, v236
v_mfma_f32_16x16x32_bf16 a[48:51], a[164:167], a[100:103], a[48:51]
v_mul_f32 v237, s91, v237
v_mul_f32 v238, s91, v238
v_mfma_f32_16x16x32_bf16 a[52:55], a[172:175], a[100:103], 0
v_mul_f32 v239, s91, v239
v_cvt_pk_bf16_f32 v232, v232, v233
v_mfma_f32_16x16x32_bf16 a[52:55], a[168:171], a[96:99], a[52:55]
ds_read_b128 a[72:75], v4 offset:41984
v_cvt_pk_bf16_f32 v233, v234, v235
v_mfma_f32_16x16x32_bf16 a[56:59], a[176:179], a[96:99], 0
buffer_load_dwordx4 v6, s[12:15], s64 offen offset:1024 lds
v_mfma_f32_16x16x32_bf16 a[56:59], a[180:183], a[100:103], a[56:59]
ds_read_b128 a[88:91], v9 offset:2048
v_cvt_pk_bf16_f32 v234, v236, v237
v_mfma_f32_16x16x32_bf16 a[60:63], a[188:191], a[100:103], 0
v_cvt_pk_bf16_f32 v235, v238, v239
v_mul_f32 v240, s91, v240
v_mfma_f32_16x16x32_bf16 a[60:63], a[184:187], a[96:99], a[60:63]
ds_read_b128 a[76:79], v4 offset:44032
v_mul_f32 v241, s91, v241
v_mfma_f32_16x16x32_bf16 v[236:239], a[112:115], a[96:99], 0
s_add_u32 m0, s73, 67584
s_add_u32 s64, s71, 18432
v_mul_f32 v242, s91, v242
v_mfma_f32_16x16x32_bf16 v[236:239], a[116:119], a[100:103], v[236:239]
ds_read_b128 a[92:95], v10 offset:2048
v_mul_f32 v243, s91, v243
v_mfma_f32_16x16x32_bf16 a[192:195], a[124:127], a[100:103], 0
buffer_load_dwordx4 v5, s[12:15], s64 offen lds
v_mfma_f32_16x16x32_bf16 a[192:195], a[120:123], a[96:99], a[192:195]
v_mul_f32 v244, s91, v244
v_mul_f32 v245, s91, v245
v_mfma_f32_16x16x32_bf16 a[196:199], a[120:123], a[104:107], 0
v_mul_f32 v246, s91, v246
v_mul_f32 v247, s91, v247
v_mfma_f32_16x16x32_bf16 a[196:199], a[124:127], a[108:111], a[196:199]
v_cvt_pk_bf16_f32 v240, v240, v241
v_cvt_pk_bf16_f32 v241, v242, v243
v_mfma_f32_16x16x32_bf16 a[200:203], a[116:119], a[108:111], 0
v_cvt_pk_bf16_f32 v242, v244, v245
v_cvt_pk_bf16_f32 v243, v246, v247
v_mfma_f32_16x16x32_bf16 a[200:203], a[112:115], a[104:107], a[200:203]
v_mul_f32 v248, s91, v248
v_mul_f32 v249, s91, v249
v_mfma_f32_16x16x32_bf16 v[244:247], a[184:187], a[104:107], 0
buffer_load_dwordx4 v6, s[12:15], s64 offen offset:1024 lds
v_mfma_f32_16x16x32_bf16 v[244:247], a[188:191], a[108:111], v[244:247]
v_mul_f32 v250, s91, v250
v_mul_f32 v251, s91, v251
v_mfma_f32_16x16x32_bf16 a[204:207], a[180:183], a[108:111], 0
v_mul_f32 v252, s91, v252
v_mul_f32 v253, s91, v253
v_mfma_f32_16x16x32_bf16 a[204:207], a[176:179], a[104:107], a[204:207]
s_add_u32 s53, s88, 262144
v_mul_f32 v254, s91, v254
v_mul_f32 v255, s91, v255
v_mfma_f32_16x16x32_bf16 a[208:211], a[168:171], a[104:107], 0
buffer_store_dwordx4 v[88:91], v4, s[24:27], s53 offen offset:3072 sc1
v_mfma_f32_16x16x32_bf16 a[208:211], a[172:175], a[108:111], a[208:211]
v_cvt_pk_bf16_f32 v248, v248, v249
v_cvt_pk_bf16_f32 v249, v250, v251
v_mfma_f32_16x16x32_bf16 v[88:91], a[164:167], a[108:111], 0
v_cvt_pk_bf16_f32 v250, v252, v253
v_cvt_pk_bf16_f32 v251, v254, v255
v_mfma_f32_16x16x32_bf16 v[88:91], a[160:163], a[104:107], v[88:91]
s_waitcnt lgkmcnt(0)
v_accvgpr_read_b32 v16, a0
v_accvgpr_read_b32 v17, a1
v_mfma_f32_16x16x32_bf16 v[36:39], a[128:131], a[80:83], v[36:39]
s_waitcnt vmcnt(24)
v_accvgpr_read_b32 v18, a2
v_accvgpr_read_b32 v19, a3
v_mfma_f32_16x16x32_bf16 v[36:39], a[132:135], a[84:87], v[36:39]
s_barrier
v_mfma_f32_16x16x32_bf16 v[44:47], a[140:143], a[84:87], v[44:47]
ds_read_b128 a[96:99], v9 offset:4096
v_accvgpr_read_b32 v20, a4
v_mfma_f32_16x16x32_bf16 v[44:47], a[136:139], a[80:83], v[44:47]
s_xor_b32 s75, s93, 2
s_lshl_b32 s76, s75, 19
s_add_u32 s76, s76, s74
v_mfma_f32_16x16x32_bf16 v[32:35], a[144:147], a[80:83], v[32:35]
s_lshl_b32 s79, s75, 13
s_add_u32 s79, s79, s78
ds_read_b128 a[100:103], v10 offset:4096
v_mfma_f32_16x16x32_bf16 v[32:35], a[148:151], a[84:87], v[32:35]
s_add_u32 m0, s77, 32768
s_add_u32 s64, s76, 0
ds_read_b128 a[104:107], v9 offset:6144
v_mfma_f32_16x16x32_bf16 v[52:55], a[156:159], a[84:87], v[52:55]
buffer_load_dwordx4 v7, s[20:23], s64 offen lds
v_mfma_f32_16x16x32_bf16 v[52:55], a[152:155], a[80:83], v[52:55]
ds_read_b64_tr_b16 a[160:161], v11 offset:49152
ds_read_b64_tr_b16 a[162:163], v11 offset:49664
v_mfma_f32_16x16x32_bf16 v[60:63], a[64:67], a[80:83], v[60:63]
v_accvgpr_read_b32 v21, a5
v_accvgpr_read_b32 v22, a6
v_mfma_f32_16x16x32_bf16 v[60:63], a[68:71], a[84:87], v[60:63]
ds_read_b128 a[108:111], v10 offset:6144
v_accvgpr_read_b32 v23, a7
v_mfma_f32_16x16x32_bf16 v[68:71], a[76:79], a[84:87], v[68:71]
buffer_load_dwordx4 v8, s[20:23], s64 offen offset:1024 lds
v_mfma_f32_16x16x32_bf16 v[68:71], a[72:75], a[80:83], v[68:71]
ds_read_b64_tr_b16 a[164:165], v11 offset:53248
ds_read_b64_tr_b16 a[166:167], v11 offset:53760
v_mfma_f32_16x16x32_bf16 v[76:79], a[72:75], a[88:91], v[76:79]
v_add_u32 v9, 32768, v9
v_add_u32 v10, 32768, v10
v_mfma_f32_16x16x32_bf16 v[76:79], a[76:79], a[92:95], v[76:79]
ds_read_b64_tr_b16 a[168:169], v12 offset:49152
ds_read_b64_tr_b16 a[170:171], v12 offset:49664
v_mfma_f32_16x16x32_bf16 v[84:87], a[68:71], a[92:95], v[84:87]
s_add_u32 m0, s80, 32768
s_add_u32 s64, s79, 0
v_mul_f32 v16, s91, v16
v_mfma_f32_16x16x32_bf16 v[84:87], a[64:67], a[88:91], v[84:87]
ds_read_b64_tr_b16 a[172:173], v12 offset:53248
ds_read_b64_tr_b16 a[174:175], v12 offset:53760
v_mfma_f32_16x16x32_bf16 v[92:95], a[152:155], a[88:91], v[92:95]
buffer_load_dwordx4 v4, s[24:27], s64 offen sc1 lds
v_mfma_f32_16x16x32_bf16 v[92:95], a[156:159], a[92:95], v[92:95]
v_mul_f32 v17, s91, v17
v_mul_f32 v18, s91, v18
v_mfma_f32_16x16x32_bf16 v[40:43], a[148:151], a[92:95], v[40:43]
ds_read_b64_tr_b16 a[176:177], v13 offset:49152
ds_read_b64_tr_b16 a[178:179], v13 offset:49664
v_mfma_f32_16x16x32_bf16 v[40:43], a[144:147], a[88:91], v[40:43]
v_mul_f32 v19, s91, v19
v_mul_f32 v20, s91, v20
v_mfma_f32_16x16x32_bf16 v[100:103], a[136:139], a[88:91], v[100:103]
s_add_u32 m0, s73, 69632
s_add_u32 s64, s72, 0
v_mul_f32 v21, s91, v21
v_mfma_f32_16x16x32_bf16 v[100:103], a[140:143], a[92:95], v[100:103]
ds_read_b64_tr_b16 a[180:181], v13 offset:53248
ds_read_b64_tr_b16 a[182:183], v13 offset:53760
v_mfma_f32_16x16x32_bf16 v[108:111], a[132:135], a[92:95], v[108:111]
buffer_load_dwordx4 v5, s[12:15], s64 offen lds
v_mfma_f32_16x16x32_bf16 v[108:111], a[128:131], a[88:91], v[108:111]
s_waitcnt lgkmcnt(14)
ds_read_b64_tr_b16 a[184:185], v14 offset:49152
ds_read_b64_tr_b16 a[186:187], v14 offset:49664
v_mfma_f32_16x16x32_bf16 v[116:119], a[128:131], a[96:99], v[116:119]
s_add_u32 s53, s87, 0
ds_read_b64_tr_b16 a[188:189], v14 offset:53248
ds_read_b64_tr_b16 a[190:191], v14 offset:53760
v_mfma_f32_16x16x32_bf16 v[116:119], a[132:135], a[100:103], v[116:119]
buffer_store_dwordx4 v[160:163], v4, s[24:27], s53 offen offset:0 sc1
v_mfma_f32_16x16x32_bf16 v[124:127], a[140:143], a[100:103], v[124:127]
v_mul_f32 v22, s91, v22
v_mul_f32 v23, s91, v23
v_mfma_f32_16x16x32_bf16 v[124:127], a[136:139], a[96:99], v[124:127]
ds_read_b128 a[112:115], v4 offset:57344
v_cvt_pk_bf16_f32 v16, v16, v17
v_mfma_f32_16x16x32_bf16 v[132:135], a[144:147], a[96:99], v[132:135]
buffer_load_dwordx4 v6, s[12:15], s64 offen offset:1024 lds
v_mfma_f32_16x16x32_bf16 v[132:135], a[148:151], a[100:103], v[132:135]
ds_read_b128 a[116:119], v4 offset:59392
v_cvt_pk_bf16_f32 v17, v18, v19
v_mfma_f32_16x16x32_bf16 v[140:143], a[156:159], a[100:103], v[140:143]
v_cvt_pk_bf16_f32 v18, v20, v21
v_cvt_pk_bf16_f32 v19, v22, v23
v_mfma_f32_16x16x32_bf16 v[140:143], a[152:155], a[96:99], v[140:143]
ds_read_b128 a[120:123], v4 offset:58368
v_accvgpr_write_b32 a0, v16
v_mfma_f32_16x16x32_bf16 v[148:151], a[64:67], a[96:99], v[148:151]
s_add_u32 m0, s73, 71680
s_add_u32 s64, s72, 18432
v_accvgpr_write_b32 a1, v17
v_mfma_f32_16x16x32_bf16 v[148:151], a[68:71], a[100:103], v[148:151]
ds_read_b128 a[124:127], v4 offset:60416
v_accvgpr_write_b32 a2, v18
v_mfma_f32_16x16x32_bf16 v[48:51], a[76:79], a[100:103], v[48:51]
buffer_load_dwordx4 v5, s[12:15], s64 offen lds
v_mfma_f32_16x16x32_bf16 v[48:51], a[72:75], a[96:99], v[48:51]
s_waitcnt lgkmcnt(15)
v_accvgpr_write_b32 a3, v19
v_accvgpr_read_b32 v16, a8
v_mfma_f32_16x16x32_bf16 v[156:159], a[72:75], a[104:107], v[156:159]
v_accvgpr_read_b32 v17, a9
v_accvgpr_read_b32 v18, a10
v_mfma_f32_16x16x32_bf16 v[156:159], a[76:79], a[108:111], v[156:159]
v_accvgpr_read_b32 v19, a11
v_accvgpr_read_b32 v20, a12
v_mfma_f32_16x16x32_bf16 v[164:167], a[68:71], a[108:111], v[164:167]
v_accvgpr_read_b32 v21, a13
v_accvgpr_read_b32 v22, a14
v_mfma_f32_16x16x32_bf16 v[164:167], a[64:67], a[104:107], v[164:167]
v_accvgpr_read_b32 v23, a15
v_mul_f32 v16, s91, v16
v_mfma_f32_16x16x32_bf16 v[172:175], a[152:155], a[104:107], v[172:175]
buffer_load_dwordx4 v6, s[12:15], s64 offen offset:1024 lds
v_mfma_f32_16x16x32_bf16 v[172:175], a[156:159], a[108:111], v[172:175]
v_mul_f32 v17, s91, v17
v_mul_f32 v18, s91, v18
v_mfma_f32_16x16x32_bf16 v[56:59], a[148:151], a[108:111], v[56:59]
v_mul_f32 v19, s91, v19
v_mul_f32 v20, s91, v20
v_mfma_f32_16x16x32_bf16 v[56:59], a[144:147], a[104:107], v[56:59]
v_mul_f32 v21, s91, v21
v_mul_f32 v22, s91, v22
v_mfma_f32_16x16x32_bf16 v[180:183], a[136:139], a[104:107], v[180:183]
v_mul_f32 v23, s91, v23
v_cvt_pk_bf16_f32 v16, v16, v17
v_mfma_f32_16x16x32_bf16 v[180:183], a[140:143], a[108:111], v[180:183]
v_cvt_pk_bf16_f32 v17, v18, v19
v_cvt_pk_bf16_f32 v18, v20, v21
v_mfma_f32_16x16x32_bf16 v[188:191], a[132:135], a[108:111], v[188:191]
v_cvt_pk_bf16_f32 v19, v22, v23
v_accvgpr_write_b32 a8, v16
v_mfma_f32_16x16x32_bf16 v[188:191], a[128:131], a[104:107], v[188:191]
s_waitcnt lgkmcnt(0)
v_accvgpr_write_b32 a9, v17
v_accvgpr_write_b32 a10, v18
v_mfma_f32_16x16x32_bf16 v[196:199], a[160:163], a[80:83], v[196:199]
s_waitcnt vmcnt(17)
v_accvgpr_write_b32 a11, v19
v_accvgpr_read_b32 v16, a16
v_mfma_f32_16x16x32_bf16 v[196:199], a[164:167], a[84:87], v[196:199]
s_barrier
v_mfma_f32_16x16x32_bf16 v[64:67], a[172:175], a[84:87], v[64:67]
s_add_u32 s53, s87, 0
ds_read_b64_tr_b16 a[128:129], v11 offset:0
ds_read_b64_tr_b16 a[130:131], v11 offset:512
v_mfma_f32_16x16x32_bf16 v[64:67], a[168:171], a[80:83], v[64:67]
s_add_u32 m0, s77, 49152
s_add_u32 s64, s76, 128
v_accvgpr_read_b32 v17, a17
v_mfma_f32_16x16x32_bf16 v[204:207], a[176:179], a[80:83], v[204:207]
buffer_load_dwordx4 v7, s[20:23], s64 offen lds
v_mfma_f32_16x16x32_bf16 v[204:207], a[180:183], a[84:87], v[204:207]
ds_read_b64_tr_b16 a[132:133], v11 offset:4096
ds_read_b64_tr_b16 a[134:135], v11 offset:4608
v_mfma_f32_16x16x32_bf16 v[212:215], a[188:191], a[84:87], v[212:215]
ds_read_b64_tr_b16 a[136:137], v12 offset:0
ds_read_b64_tr_b16 a[138:139], v12 offset:512
v_mfma_f32_16x16x32_bf16 v[212:215], a[184:187], a[80:83], v[212:215]
ds_read_b64_tr_b16 a[140:141], v12 offset:4096
ds_read_b64_tr_b16 a[142:143], v12 offset:4608
v_mfma_f32_16x16x32_bf16 v[72:75], a[112:115], a[80:83], v[72:75]
buffer_store_dwordx4 v[168:171], v4, s[24:27], s53 offen offset:1024 sc1
v_mfma_f32_16x16x32_bf16 v[72:75], a[116:119], a[84:87], v[72:75]
ds_read_b64_tr_b16 a[144:145], v13 offset:0
ds_read_b64_tr_b16 a[146:147], v13 offset:512
v_mfma_f32_16x16x32_bf16 v[220:223], a[124:127], a[84:87], v[220:223]
buffer_load_dwordx4 v8, s[20:23], s64 offen offset:1024 lds
v_mfma_f32_16x16x32_bf16 v[220:223], a[120:123], a[80:83], v[220:223]
ds_read_b64_tr_b16 a[148:149], v13 offset:4096
ds_read_b64_tr_b16 a[150:151], v13 offset:4608
v_mfma_f32_16x16x32_bf16 a[32:35], a[120:123], a[88:91], a[32:35]
v_accvgpr_read_b32 v18, a18
v_accvgpr_read_b32 v19, a19
v_mfma_f32_16x16x32_bf16 a[32:35], a[124:127], a[92:95], a[32:35]
ds_read_b64_tr_b16 a[152:153], v14 offset:0
ds_read_b64_tr_b16 a[154:155], v14 offset:512
v_mfma_f32_16x16x32_bf16 a[36:39], a[116:119], a[92:95], a[36:39]
s_add_u32 m0, s80, 49152
s_add_u32 s64, s79, 2048
v_accvgpr_read_b32 v20, a20
v_mfma_f32_16x16x32_bf16 a[36:39], a[112:115], a[88:91], a[36:39]
ds_read_b64_tr_b16 a[156:157], v14 offset:4096
ds_read_b64_tr_b16 a[158:159], v14 offset:4608
v_mfma_f32_16x16x32_bf16 v[228:231], a[184:187], a[88:91], v[228:231]
buffer_load_dwordx4 v4, s[24:27], s64 offen sc1 lds
v_mfma_f32_16x16x32_bf16 v[228:231], a[188:191], a[92:95], v[228:231]
s_xor_b32 s65, s70, 384
s_add_u32 s71, s68, s65
s_add_u32 s72, s69, s65
v_mfma_f32_16x16x32_bf16 a[40:43], a[180:183], a[92:95], a[40:43]
ds_read_b128 a[64:67], v4 offset:8192
v_accvgpr_read_b32 v21, a21
v_mfma_f32_16x16x32_bf16 a[40:43], a[176:179], a[88:91], a[40:43]
v_accvgpr_read_b32 v22, a22
v_accvgpr_read_b32 v23, a23
v_mfma_f32_16x16x32_bf16 a[44:47], a[168:171], a[88:91], a[44:47]
s_add_u32 m0, s73, 0
s_add_u32 s64, s71, 0
ds_read_b128 a[80:83], v9 offset:0
v_mfma_f32_16x16x32_bf16 a[44:47], a[172:175], a[92:95], a[44:47]
v_mul_f32 v16, s91, v16
v_mul_f32 v17, s91, v17
v_mfma_f32_16x16x32_bf16 v[80:83], a[164:167], a[92:95], v[80:83]
buffer_load_dwordx4 v5, s[12:15], s64 offen lds
v_mfma_f32_16x16x32_bf16 v[80:83], a[160:163], a[88:91], v[80:83]
ds_read_b128 a[68:71], v4 offset:10240
v_mul_f32 v18, s91, v18
v_mfma_f32_16x16x32_bf16 a[48:51], a[160:163], a[96:99], a[48:51]
ds_read_b128 a[84:87], v10 offset:0
v_mul_f32 v19, s91, v19
v_mfma_f32_16x16x32_bf16 a[48:51], a[164:167], a[100:103], a[48:51]
v_mul_f32 v20, s91, v20
v_mul_f32 v21, s91, v21
v_mfma_f32_16x16x32_bf16 a[52:55], a[172:175], a[100:103], a[52:55]
v_mul_f32 v22, s91, v22
v_mul_f32 v23, s91, v23
v_mfma_f32_16x16x32_bf16 a[52:55], a[168:171], a[96:99], a[52:55]
ds_read_b128 a[72:75], v4 offset:9216
v_cvt_pk_bf16_f32 v16, v16, v17
v_mfma_f32_16x16x32_bf16 a[56:59], a[176:179], a[96:99], a[56:59]
buffer_load_dwordx4 v6, s[12:15], s64 offen offset:1024 lds
v_mfma_f32_16x16x32_bf16 a[56:59], a[180:183], a[100:103], a[56:59]
s_add_u32 s53, s87, 4096
ds_read_b128 a[88:91], v9 offset:2048
v_cvt_pk_bf16_f32 v17, v18, v19
v_mfma_f32_16x16x32_bf16 a[60:63], a[188:191], a[100:103], a[60:63]
buffer_store_dwordx4 v[176:179], v4, s[24:27], s53 offen offset:0 sc1
v_mfma_f32_16x16x32_bf16 a[60:63], a[184:187], a[96:99], a[60:63]
ds_read_b128 a[76:79], v4 offset:11264
v_cvt_pk_bf16_f32 v18, v20, v21
v_mfma_f32_16x16x32_bf16 v[236:239], a[112:115], a[96:99], v[236:239]
s_add_u32 m0, s73, 2048
s_add_u32 s64, s71, 18432
v_cvt_pk_bf16_f32 v19, v22, v23
v_mfma_f32_16x16x32_bf16 v[236:239], a[116:119], a[100:103], v[236:239]
ds_read_b128 a[92:95], v10 offset:2048
v_accvgpr_write_b32 a16, v16
v_mfma_f32_16x16x32_bf16 a[192:195], a[124:127], a[100:103], a[192:195]
buffer_load_dwordx4 v5, s[12:15], s64 offen lds
v_mfma_f32_16x16x32_bf16 a[192:195], a[120:123], a[96:99], a[192:195]
v_accvgpr_write_b32 a17, v17
v_accvgpr_write_b32 a18, v18
v_mfma_f32_16x16x32_bf16 a[196:199], a[120:123], a[104:107], a[196:199]
v_accvgpr_write_b32 a19, v19
v_accvgpr_read_b32 v16, a24
v_mfma_f32_16x16x32_bf16 a[196:199], a[124:127], a[108:111], a[196:199]
v_accvgpr_read_b32 v17, a25
v_accvgpr_read_b32 v18, a26
v_mfma_f32_16x16x32_bf16 a[200:203], a[116:119], a[108:111], a[200:203]
v_accvgpr_read_b32 v19, a27
v_accvgpr_read_b32 v20, a28
v_mfma_f32_16x16x32_bf16 a[200:203], a[112:115], a[104:107], a[200:203]
v_accvgpr_read_b32 v21, a29
v_accvgpr_read_b32 v22, a30
v_mfma_f32_16x16x32_bf16 v[244:247], a[184:187], a[104:107], v[244:247]
buffer_load_dwordx4 v6, s[12:15], s64 offen offset:1024 lds
v_mfma_f32_16x16x32_bf16 v[244:247], a[188:191], a[108:111], v[244:247]
v_accvgpr_read_b32 v23, a31
v_mul_f32 v16, s91, v16
v_mfma_f32_16x16x32_bf16 a[204:207], a[180:183], a[108:111], a[204:207]
v_mul_f32 v17, s91, v17
v_mul_f32 v18, s91, v18
v_mfma_f32_16x16x32_bf16 a[204:207], a[176:179], a[104:107], a[204:207]
v_mul_f32 v19, s91, v19
v_mul_f32 v20, s91, v20
v_mfma_f32_16x16x32_bf16 a[208:211], a[168:171], a[104:107], a[208:211]
v_mul_f32 v21, s91, v21
v_mul_f32 v22, s91, v22
v_mfma_f32_16x16x32_bf16 a[208:211], a[172:175], a[108:111], a[208:211]
v_mul_f32 v23, s91, v23
v_cvt_pk_bf16_f32 v16, v16, v17
v_mfma_f32_16x16x32_bf16 v[88:91], a[164:167], a[108:111], v[88:91]
v_cvt_pk_bf16_f32 v17, v18, v19
v_cvt_pk_bf16_f32 v18, v20, v21
v_mfma_f32_16x16x32_bf16 v[88:91], a[160:163], a[104:107], v[88:91]
s_waitcnt lgkmcnt(0)
v_cvt_pk_bf16_f32 v19, v22, v23
v_accvgpr_write_b32 a24, v16
v_mfma_f32_16x16x32_bf16 v[36:39], a[128:131], a[80:83], v[36:39]
s_waitcnt vmcnt(23)
v_accvgpr_write_b32 a25, v17
v_accvgpr_write_b32 a26, v18
v_mfma_f32_16x16x32_bf16 v[36:39], a[132:135], a[84:87], v[36:39]
s_barrier
v_mfma_f32_16x16x32_bf16 v[44:47], a[140:143], a[84:87], v[44:47]
ds_read_b128 a[96:99], v9 offset:4096
v_accvgpr_write_b32 a27, v19
v_mfma_f32_16x16x32_bf16 v[44:47], a[136:139], a[80:83], v[44:47]
s_xor_b32 s75, s93, 3
s_lshl_b32 s76, s75, 19
s_add_u32 s76, s76, s74
v_mfma_f32_16x16x32_bf16 v[32:35], a[144:147], a[80:83], v[32:35]
s_lshl_b32 s79, s75, 13
s_add_u32 s79, s79, s78
ds_read_b128 a[100:103], v10 offset:4096
v_mfma_f32_16x16x32_bf16 v[32:35], a[148:151], a[84:87], v[32:35]
s_add_u32 m0, s77, 0
s_add_u32 s64, s76, 0
ds_read_b128 a[104:107], v9 offset:6144
v_mfma_f32_16x16x32_bf16 v[52:55], a[156:159], a[84:87], v[52:55]
buffer_load_dwordx4 v7, s[20:23], s64 offen lds
v_mfma_f32_16x16x32_bf16 v[52:55], a[152:155], a[80:83], v[52:55]
s_add_u32 s53, s87, 4096
ds_read_b64_tr_b16 a[160:161], v11 offset:16384
ds_read_b64_tr_b16 a[162:163], v11 offset:16896
v_mfma_f32_16x16x32_bf16 v[60:63], a[64:67], a[80:83], v[60:63]
buffer_store_dwordx4 v[184:187], v4, s[24:27], s53 offen offset:1024 sc1
v_mfma_f32_16x16x32_bf16 v[60:63], a[68:71], a[84:87], v[60:63]
ds_read_b128 a[108:111], v10 offset:6144
v_accvgpr_write_b32 a4, v248
v_mfma_f32_16x16x32_bf16 v[68:71], a[76:79], a[84:87], v[68:71]
buffer_load_dwordx4 v8, s[20:23], s64 offen offset:1024 lds
v_mfma_f32_16x16x32_bf16 v[68:71], a[72:75], a[80:83], v[68:71]
ds_read_b64_tr_b16 a[164:165], v11 offset:20480
ds_read_b64_tr_b16 a[166:167], v11 offset:20992
v_mfma_f32_16x16x32_bf16 v[76:79], a[72:75], a[88:91], v[76:79]
v_add_u32 v9, 32768, v9
v_add_u32 v10, 32768, v10
v_mfma_f32_16x16x32_bf16 v[76:79], a[76:79], a[92:95], v[76:79]
ds_read_b64_tr_b16 a[168:169], v12 offset:16384
ds_read_b64_tr_b16 a[170:171], v12 offset:16896
v_mfma_f32_16x16x32_bf16 v[84:87], a[68:71], a[92:95], v[84:87]
s_add_u32 m0, s80, 0
s_add_u32 s64, s79, 0
v_accvgpr_write_b32 a5, v249
v_mfma_f32_16x16x32_bf16 v[84:87], a[64:67], a[88:91], v[84:87]
ds_read_b64_tr_b16 a[172:173], v12 offset:20480
ds_read_b64_tr_b16 a[174:175], v12 offset:20992
v_mfma_f32_16x16x32_bf16 v[92:95], a[152:155], a[88:91], v[92:95]
buffer_load_dwordx4 v4, s[24:27], s64 offen sc1 lds
v_mfma_f32_16x16x32_bf16 v[92:95], a[156:159], a[92:95], v[92:95]
v_accvgpr_write_b32 a6, v250
v_accvgpr_write_b32 a7, v251
v_mfma_f32_16x16x32_bf16 v[40:43], a[148:151], a[92:95], v[40:43]
ds_read_b64_tr_b16 a[176:177], v13 offset:16384
ds_read_b64_tr_b16 a[178:179], v13 offset:16896
v_mfma_f32_16x16x32_bf16 v[40:43], a[144:147], a[88:91], v[40:43]
v_accvgpr_write_b32 a12, v240
v_accvgpr_write_b32 a13, v241
v_mfma_f32_16x16x32_bf16 v[100:103], a[136:139], a[88:91], v[100:103]
s_add_u32 m0, s73, 4096
s_add_u32 s64, s72, 0
v_accvgpr_write_b32 a14, v242
v_mfma_f32_16x16x32_bf16 v[100:103], a[140:143], a[92:95], v[100:103]
ds_read_b64_tr_b16 a[180:181], v13 offset:20480
ds_read_b64_tr_b16 a[182:183], v13 offset:20992
v_mfma_f32_16x16x32_bf16 v[108:111], a[132:135], a[92:95], v[108:111]
buffer_load_dwordx4 v5, s[12:15], s64 offen lds
v_mfma_f32_16x16x32_bf16 v[108:111], a[128:131], a[88:91], v[108:111]
s_waitcnt lgkmcnt(14)
ds_read_b64_tr_b16 a[184:185], v14 offset:16384
ds_read_b64_tr_b16 a[186:187], v14 offset:16896
v_mfma_f32_16x16x32_bf16 v[116:119], a[128:131], a[96:99], v[116:119]
ds_read_b64_tr_b16 a[188:189], v14 offset:20480
ds_read_b64_tr_b16 a[190:191], v14 offset:20992
v_mfma_f32_16x16x32_bf16 v[116:119], a[132:135], a[100:103], v[116:119]
v_accvgpr_write_b32 a15, v243
v_accvgpr_write_b32 a20, v232
v_mfma_f32_16x16x32_bf16 v[124:127], a[140:143], a[100:103], v[124:127]
v_accvgpr_write_b32 a21, v233
v_accvgpr_write_b32 a22, v234
v_mfma_f32_16x16x32_bf16 v[124:127], a[136:139], a[96:99], v[124:127]
ds_read_b128 a[112:115], v4 offset:24576
v_accvgpr_write_b32 a23, v235
v_mfma_f32_16x16x32_bf16 v[132:135], a[144:147], a[96:99], v[132:135]
buffer_load_dwordx4 v6, s[12:15], s64 offen offset:1024 lds
v_mfma_f32_16x16x32_bf16 v[132:135], a[148:151], a[100:103], v[132:135]
ds_read_b128 a[116:119], v4 offset:26624
v_accvgpr_write_b32 a28, v224
v_mfma_f32_16x16x32_bf16 v[140:143], a[156:159], a[100:103], v[140:143]
v_accvgpr_write_b32 a29, v225
v_accvgpr_write_b32 a30, v226
v_mfma_f32_16x16x32_bf16 v[140:143], a[152:155], a[96:99], v[140:143]
ds_read_b128 a[120:123], v4 offset:25600
v_accvgpr_write_b32 a31, v227
v_mfma_f32_16x16x32_bf16 v[148:151], a[64:67], a[96:99], v[148:151]
s_add_u32 m0, s73, 6144
s_add_u32 s64, s72, 18432
v_accvgpr_read_b32 v252, a32
v_mfma_f32_16x16x32_bf16 v[148:151], a[68:71], a[100:103], v[148:151]
ds_read_b128 a[124:127], v4 offset:27648
v_accvgpr_read_b32 v253, a33
v_mfma_f32_16x16x32_bf16 v[48:51], a[76:79], a[100:103], v[48:51]
buffer_load_dwordx4 v5, s[12:15], s64 offen lds
v_mfma_f32_16x16x32_bf16 v[48:51], a[72:75], a[96:99], v[48:51]
s_waitcnt lgkmcnt(15)
s_add_u32 s53, s87, 262144
v_accvgpr_read_b32 v254, a34
v_mfma_f32_16x16x32_bf16 v[156:159], a[72:75], a[104:107], v[156:159]
buffer_store_dwordx4 v[192:195], v4, s[24:27], s53 offen offset:0 sc1
v_mfma_f32_16x16x32_bf16 v[156:159], a[76:79], a[108:111], v[156:159]
v_accvgpr_read_b32 v255, a35
v_accvgpr_read_b32 v160, a36
v_mfma_f32_16x16x32_bf16 v[164:167], a[68:71], a[108:111], v[164:167]
v_accvgpr_read_b32 v161, a37
v_accvgpr_read_b32 v162, a38
v_mfma_f32_16x16x32_bf16 v[164:167], a[64:67], a[104:107], v[164:167]
v_accvgpr_read_b32 v163, a39
v_accvgpr_read_b32 v168, a40
v_mfma_f32_16x16x32_bf16 v[172:175], a[152:155], a[104:107], v[172:175]
buffer_load_dwordx4 v6, s[12:15], s64 offen offset:1024 lds
v_mfma_f32_16x16x32_bf16 v[172:175], a[156:159], a[108:111], v[172:175]
v_accvgpr_read_b32 v169, a41
v_accvgpr_read_b32 v170, a42
v_mfma_f32_16x16x32_bf16 v[56:59], a[148:151], a[108:111], v[56:59]
v_accvgpr_read_b32 v171, a43
v_accvgpr_read_b32 v176, a44
v_mfma_f32_16x16x32_bf16 v[56:59], a[144:147], a[104:107], v[56:59]
v_accvgpr_read_b32 v177, a45
v_accvgpr_read_b32 v178, a46
v_mfma_f32_16x16x32_bf16 v[180:183], a[136:139], a[104:107], v[180:183]
L_PAD5:
s_cbranch_execz L_PAD9
v_accvgpr_read_b32 v179, a47
v_accvgpr_read_b32 v184, a48
v_mfma_f32_16x16x32_bf16 v[180:183], a[140:143], a[108:111], v[180:183]
v_accvgpr_read_b32 v185, a49
v_accvgpr_read_b32 v186, a50
v_mfma_f32_16x16x32_bf16 v[188:191], a[132:135], a[108:111], v[188:191]
v_accvgpr_read_b32 v187, a51
v_accvgpr_read_b32 v248, a52
v_mfma_f32_16x16x32_bf16 v[188:191], a[128:131], a[104:107], v[188:191]
s_waitcnt lgkmcnt(0)
v_accvgpr_read_b32 v249, a53
v_accvgpr_read_b32 v250, a54
v_mfma_f32_16x16x32_bf16 v[196:199], a[160:163], a[80:83], v[196:199]
s_waitcnt vmcnt(18)
v_accvgpr_read_b32 v251, a55
v_accvgpr_read_b32 v240, a56
v_mfma_f32_16x16x32_bf16 v[196:199], a[164:167], a[84:87], v[196:199]
s_barrier
v_mfma_f32_16x16x32_bf16 v[64:67], a[172:175], a[84:87], v[64:67]
ds_read_b64_tr_b16 a[128:129], v11 offset:32768
ds_read_b64_tr_b16 a[130:131], v11 offset:33280
v_mfma_f32_16x16x32_bf16 v[64:67], a[168:171], a[80:83], v[64:67]
s_add_u32 m0, s77, 16384
s_add_u32 s64, s76, 128
v_accvgpr_read_b32 v241, a57
v_mfma_f32_16x16x32_bf16 v[204:207], a[176:179], a[80:83], v[204:207]
buffer_load_dwordx4 v7, s[20:23], s64 offen lds
v_mfma_f32_16x16x32_bf16 v[204:207], a[180:183], a[84:87], v[204:207]
ds_read_b64_tr_b16 a[132:133], v11 offset:36864
ds_read_b64_tr_b16 a[134:135], v11 offset:37376
v_mfma_f32_16x16x32_bf16 v[212:215], a[188:191], a[84:87], v[212:215]
ds_read_b64_tr_b16 a[136:137], v12 offset:32768
ds_read_b64_tr_b16 a[138:139], v12 offset:33280
v_mfma_f32_16x16x32_bf16 v[212:215], a[184:187], a[80:83], v[212:215]
ds_read_b64_tr_b16 a[140:141], v12 offset:36864
ds_read_b64_tr_b16 a[142:143], v12 offset:37376
v_mfma_f32_16x16x32_bf16 v[72:75], a[112:115], a[80:83], v[72:75]
v_accvgpr_read_b32 v242, a58
v_accvgpr_read_b32 v243, a59
v_mfma_f32_16x16x32_bf16 v[72:75], a[116:119], a[84:87], v[72:75]
ds_read_b64_tr_b16 a[144:145], v13 offset:32768
ds_read_b64_tr_b16 a[146:147], v13 offset:33280
v_mfma_f32_16x16x32_bf16 v[220:223], a[124:127], a[84:87], v[220:223]
buffer_load_dwordx4 v8, s[20:23], s64 offen offset:1024 lds
v_mfma_f32_16x16x32_bf16 v[220:223], a[120:123], a[80:83], v[220:223]
ds_read_b64_tr_b16 a[148:149], v13 offset:36864
ds_read_b64_tr_b16 a[150:151], v13 offset:37376
v_mfma_f32_16x16x32_bf16 v[252:255], a[120:123], a[88:91], v[252:255]
v_accvgpr_read_b32 v232, a60
v_accvgpr_read_b32 v233, a61
v_mfma_f32_16x16x32_bf16 v[252:255], a[124:127], a[92:95], v[252:255]
s_add_u32 s53, s87, 262144
ds_read_b64_tr_b16 a[152:153], v14 offset:32768
ds_read_b64_tr_b16 a[154:155], v14 offset:33280
v_mfma_f32_16x16x32_bf16 v[160:163], a[116:119], a[92:95], v[160:163]
s_add_u32 m0, s80, 16384
s_add_u32 s64, s79, 2048
v_accvgpr_read_b32 v234, a62
v_mfma_f32_16x16x32_bf16 v[160:163], a[112:115], a[88:91], v[160:163]
ds_read_b64_tr_b16 a[156:157], v14 offset:36864
ds_read_b64_tr_b16 a[158:159], v14 offset:37376
v_mfma_f32_16x16x32_bf16 v[228:231], a[184:187], a[88:91], v[228:231]
buffer_load_dwordx4 v4, s[24:27], s64 offen sc1 lds
v_mfma_f32_16x16x32_bf16 v[228:231], a[188:191], a[92:95], v[228:231]
s_xor_b32 s65, s70, 512
s_add_u32 s71, s68, s65
s_add_u32 s72, s69, s65
v_mfma_f32_16x16x32_bf16 v[168:171], a[180:183], a[92:95], v[168:171]
ds_read_b128 a[64:67], v4 offset:40960
v_accvgpr_read_b32 v235, a63
v_mfma_f32_16x16x32_bf16 v[168:171], a[176:179], a[88:91], v[168:171]
buffer_store_dwordx4 v[200:203], v4, s[24:27], s53 offen offset:1024 sc1
v_mfma_f32_16x16x32_bf16 v[176:179], a[168:171], a[88:91], v[176:179]
s_add_u32 m0, s73, 32768
s_add_u32 s64, s71, 0
ds_read_b128 a[80:83], v9 offset:0
v_mfma_f32_16x16x32_bf16 v[176:179], a[172:175], a[92:95], v[176:179]
v_accvgpr_read_b32 v224, a192
v_accvgpr_read_b32 v225, a193
v_mfma_f32_16x16x32_bf16 v[80:83], a[164:167], a[92:95], v[80:83]
buffer_load_dwordx4 v5, s[12:15], s64 offen lds
v_mfma_f32_16x16x32_bf16 v[80:83], a[160:163], a[88:91], v[80:83]
ds_read_b128 a[68:71], v4 offset:43008
v_accvgpr_read_b32 v226, a194
v_mfma_f32_16x16x32_bf16 v[184:187], a[160:163], a[96:99], v[184:187]
ds_read_b128 a[84:87], v10 offset:0
v_accvgpr_read_b32 v227, a195
v_mfma_f32_16x16x32_bf16 v[184:187], a[164:167], a[100:103], v[184:187]
v_accvgpr_read_b32 v192, a204
v_accvgpr_read_b32 v193, a205
v_mfma_f32_16x16x32_bf16 v[248:251], a[172:175], a[100:103], v[248:251]
v_accvgpr_read_b32 v194, a206
v_accvgpr_read_b32 v195, a207
v_mfma_f32_16x16x32_bf16 v[248:251], a[168:171], a[96:99], v[248:251]
ds_read_b128 a[72:75], v4 offset:41984
v_accvgpr_read_b32 v200, a208
v_mfma_f32_16x16x32_bf16 v[240:243], a[176:179], a[96:99], v[240:243]
buffer_load_dwordx4 v6, s[12:15], s64 offen offset:1024 lds
v_mfma_f32_16x16x32_bf16 v[240:243], a[180:183], a[100:103], v[240:243]
ds_read_b128 a[88:91], v9 offset:2048
v_accvgpr_read_b32 v201, a209
v_mfma_f32_16x16x32_bf16 v[232:235], a[188:191], a[100:103], v[232:235]
v_accvgpr_read_b32 v202, a210
v_accvgpr_read_b32 v203, a211
v_mfma_f32_16x16x32_bf16 v[232:235], a[184:187], a[96:99], v[232:235]
ds_read_b128 a[76:79], v4 offset:44032
v_and_b32 v28, 31, v1
v_mfma_f32_16x16x32_bf16 v[236:239], a[112:115], a[96:99], v[236:239]
s_add_u32 m0, s73, 34816
s_add_u32 s64, s71, 18432
v_lshlrev_b32 v28, 2, v28
v_mfma_f32_16x16x32_bf16 v[236:239], a[116:119], a[100:103], v[236:239]
ds_read_b128 a[92:95], v10 offset:2048
v_mfma_f32_16x16x32_bf16 v[224:227], a[124:127], a[100:103], v[224:227]
buffer_load_dwordx4 v5, s[12:15], s64 offen lds
v_mfma_f32_16x16x32_bf16 v[224:227], a[120:123], a[96:99], v[224:227]
buffer_load_dword v30, v28, s[40:43], 0 offen sc1
v_mfma_f32_16x16x32_bf16 a[196:199], a[120:123], a[104:107], a[196:199]
v_mfma_f32_16x16x32_bf16 a[196:199], a[124:127], a[108:111], a[196:199]
v_mfma_f32_16x16x32_bf16 a[200:203], a[116:119], a[108:111], a[200:203]
v_mfma_f32_16x16x32_bf16 a[200:203], a[112:115], a[104:107], a[200:203]
v_mfma_f32_16x16x32_bf16 v[244:247], a[184:187], a[104:107], v[244:247]
buffer_load_dwordx4 v6, s[12:15], s64 offen offset:1024 lds
v_mfma_f32_16x16x32_bf16 v[244:247], a[188:191], a[108:111], v[244:247]
s_add_u32 s53, s87, 266240
v_mfma_f32_16x16x32_bf16 v[192:195], a[180:183], a[108:111], v[192:195]
buffer_store_dwordx4 v[208:211], v4, s[24:27], s53 offen offset:0 sc1
v_mfma_f32_16x16x32_bf16 v[192:195], a[176:179], a[104:107], v[192:195]
v_mfma_f32_16x16x32_bf16 v[200:203], a[168:171], a[104:107], v[200:203]
v_mfma_f32_16x16x32_bf16 v[200:203], a[172:175], a[108:111], v[200:203]
v_accvgpr_read_b32 v208, a196
v_accvgpr_read_b32 v209, a197
v_mfma_f32_16x16x32_bf16 v[88:91], a[164:167], a[108:111], v[88:91]
v_accvgpr_read_b32 v210, a198
v_accvgpr_read_b32 v211, a199
v_mfma_f32_16x16x32_bf16 v[88:91], a[160:163], a[104:107], v[88:91]
s_waitcnt lgkmcnt(0)
v_mfma_f32_16x16x32_bf16 v[36:39], a[128:131], a[80:83], v[36:39]
s_waitcnt vmcnt(24)
v_mfma_f32_16x16x32_bf16 v[36:39], a[132:135], a[84:87], v[36:39]
s_barrier
v_mfma_f32_16x16x32_bf16 v[44:47], a[140:143], a[84:87], v[44:47]
ds_read_b128 a[96:99], v9 offset:4096
v_mfma_f32_16x16x32_bf16 v[44:47], a[136:139], a[80:83], v[44:47]
s_xor_b32 s75, s93, 4
s_lshl_b32 s76, s75, 19
s_add_u32 s76, s76, s74
v_mfma_f32_16x16x32_bf16 v[32:35], a[144:147], a[80:83], v[32:35]
s_lshl_b32 s79, s75, 13
s_add_u32 s79, s79, s78
ds_read_b128 a[100:103], v10 offset:4096
v_mfma_f32_16x16x32_bf16 v[32:35], a[148:151], a[84:87], v[32:35]
s_add_u32 m0, s77, 32768
s_add_u32 s64, s76, 0
ds_read_b128 a[104:107], v9 offset:6144
v_mfma_f32_16x16x32_bf16 v[52:55], a[156:159], a[84:87], v[52:55]
buffer_load_dwordx4 v7, s[20:23], s64 offen lds
v_mfma_f32_16x16x32_bf16 v[52:55], a[152:155], a[80:83], v[52:55]
ds_read_b64_tr_b16 a[160:161], v11 offset:49152
ds_read_b64_tr_b16 a[162:163], v11 offset:49664
v_mfma_f32_16x16x32_bf16 v[60:63], a[64:67], a[80:83], v[60:63]
v_mfma_f32_16x16x32_bf16 v[60:63], a[68:71], a[84:87], v[60:63]
ds_read_b128 a[108:111], v10 offset:6144
v_mfma_f32_16x16x32_bf16 v[68:71], a[76:79], a[84:87], v[68:71]
buffer_load_dwordx4 v8, s[20:23], s64 offen offset:1024 lds
v_mfma_f32_16x16x32_bf16 v[68:71], a[72:75], a[80:83], v[68:71]
ds_read_b64_tr_b16 a[164:165], v11 offset:53248
ds_read_b64_tr_b16 a[166:167], v11 offset:53760
v_mfma_f32_16x16x32_bf16 v[76:79], a[72:75], a[88:91], v[76:79]
v_add_u32 v9, -65536, v9
v_add_u32 v10, -65536, v10
v_mfma_f32_16x16x32_bf16 v[76:79], a[76:79], a[92:95], v[76:79]
ds_read_b64_tr_b16 a[168:169], v12 offset:49152
ds_read_b64_tr_b16 a[170:171], v12 offset:49664
v_mfma_f32_16x16x32_bf16 v[84:87], a[68:71], a[92:95], v[84:87]
s_add_u32 m0, s80, 32768
s_add_u32 s64, s79, 0
v_mfma_f32_16x16x32_bf16 v[84:87], a[64:67], a[88:91], v[84:87]
ds_read_b64_tr_b16 a[172:173], v12 offset:53248
ds_read_b64_tr_b16 a[174:175], v12 offset:53760
v_mfma_f32_16x16x32_bf16 v[92:95], a[152:155], a[88:91], v[92:95]
buffer_load_dwordx4 v4, s[24:27], s64 offen sc1 lds
v_mfma_f32_16x16x32_bf16 v[92:95], a[156:159], a[92:95], v[92:95]
v_mfma_f32_16x16x32_bf16 v[40:43], a[148:151], a[92:95], v[40:43]
ds_read_b64_tr_b16 a[176:177], v13 offset:49152
ds_read_b64_tr_b16 a[178:179], v13 offset:49664
v_mfma_f32_16x16x32_bf16 v[40:43], a[144:147], a[88:91], v[40:43]
s_add_u32 s53, s87, 266240
v_mfma_f32_16x16x32_bf16 v[100:103], a[136:139], a[88:91], v[100:103]
s_add_u32 m0, s73, 36864
s_add_u32 s64, s72, 0
v_mfma_f32_16x16x32_bf16 v[100:103], a[140:143], a[92:95], v[100:103]
ds_read_b64_tr_b16 a[180:181], v13 offset:53248
ds_read_b64_tr_b16 a[182:183], v13 offset:53760
v_mfma_f32_16x16x32_bf16 v[108:111], a[132:135], a[92:95], v[108:111]
buffer_load_dwordx4 v5, s[12:15], s64 offen lds
v_mfma_f32_16x16x32_bf16 v[108:111], a[128:131], a[88:91], v[108:111]
s_waitcnt lgkmcnt(14)
ds_read_b64_tr_b16 a[184:185], v14 offset:49152
ds_read_b64_tr_b16 a[186:187], v14 offset:49664
v_mfma_f32_16x16x32_bf16 v[116:119], a[128:131], a[96:99], v[116:119]
s_waitcnt vmcnt(6)
ds_read_b64_tr_b16 a[188:189], v14 offset:53248
ds_read_b64_tr_b16 a[190:191], v14 offset:53760
v_mfma_f32_16x16x32_bf16 v[116:119], a[132:135], a[100:103], v[116:119]
buffer_store_dwordx4 v[216:219], v4, s[24:27], s53 offen offset:1024 sc1
v_mfma_f32_16x16x32_bf16 v[124:127], a[140:143], a[100:103], v[124:127]
v_cmp_gt_u32 vcc, 1, v30
v_mfma_f32_16x16x32_bf16 v[124:127], a[136:139], a[96:99], v[124:127]
ds_read_b128 a[112:115], v4 offset:57344
v_accvgpr_read_b32 v216, a200
v_mfma_f32_16x16x32_bf16 v[132:135], a[144:147], a[96:99], v[132:135]
buffer_load_dwordx4 v6, s[12:15], s64 offen offset:1024 lds
v_mfma_f32_16x16x32_bf16 v[132:135], a[148:151], a[100:103], v[132:135]
ds_read_b128 a[116:119], v4 offset:59392
v_accvgpr_read_b32 v217, a201
v_mfma_f32_16x16x32_bf16 v[140:143], a[156:159], a[100:103], v[140:143]
v_accvgpr_read_b32 v218, a202
v_accvgpr_read_b32 v219, a203
v_mfma_f32_16x16x32_bf16 v[140:143], a[152:155], a[96:99], v[140:143]
s_lshr_b32 s84, s7, 1
s_and_b32 s85, s7, 1
ds_read_b128 a[120:123], v4 offset:58368
v_mfma_f32_16x16x32_bf16 v[148:151], a[64:67], a[96:99], v[148:151]
s_add_u32 m0, s73, 38912
s_add_u32 s64, s72, 18432
s_xor_b32 s52, s5, 0
v_mfma_f32_16x16x32_bf16 v[148:151], a[68:71], a[100:103], v[148:151]
s_lshl1_add_u32 s85, s52, s85
s_and_b32 s86, s6, 3
ds_read_b128 a[124:127], v4 offset:60416
v_mfma_f32_16x16x32_bf16 v[48:51], a[76:79], a[100:103], v[48:51]
buffer_load_dwordx4 v5, s[12:15], s64 offen lds
v_mfma_f32_16x16x32_bf16 v[48:51], a[72:75], a[96:99], v[48:51]
s_waitcnt lgkmcnt(15)
s_lshl_b32 s83, s3, 13
s_add_u32 s83, s83, 131072
v_mfma_f32_16x16x32_bf16 v[156:159], a[72:75], a[104:107], v[156:159]
s_cbranch_vccnz CK_ZA
CK_ZA_R:
v_mfma_f32_16x16x32_bf16 v[156:159], a[76:79], a[108:111], v[156:159]
s_mul_i32 s52, s2, 5462
s_lshr_b32 s52, s52, 16
s_mul_i32 s54, s52, 12
v_mfma_f32_16x16x32_bf16 v[164:167], a[68:71], a[108:111], v[164:167]
s_sub_u32 s54, s2, s54
s_mul_i32 s54, s54, 3
s_add_u32 s54, s54, s3
v_mfma_f32_16x16x32_bf16 v[164:167], a[64:67], a[104:107], v[164:167]
s_mul_i32 s55, s52, 13108
s_lshr_b32 s55, s55, 16
s_mul_i32 s82, s55, 5
v_mfma_f32_16x16x32_bf16 v[172:175], a[152:155], a[104:107], v[172:175]
buffer_load_dwordx4 v6, s[12:15], s64 offen offset:1024 lds
v_mfma_f32_16x16x32_bf16 v[172:175], a[156:159], a[108:111], v[172:175]
s_sub_u32 s52, s52, s82
v_mfma_f32_16x16x32_bf16 v[56:59], a[148:151], a[108:111], v[56:59]
v_lshrrev_b32 v16, 1, v1
v_and_b32 v17, 1, v1
v_mfma_f32_16x16x32_bf16 v[56:59], a[144:147], a[104:107], v[56:59]
v_mul_u32_u24 v18, 1152, v16
v_lshl_add_u32 v18, v17, 4, v18
v_mfma_f32_16x16x32_bf16 v[180:183], a[136:139], a[104:107], v[180:183]
v_mov_b32 v24, v18
v_lshrrev_b32 v18, 4, v16
v_mfma_f32_16x16x32_bf16 v[180:183], a[140:143], a[108:111], v[180:183]
v_bfe_u32 v19, v16, 2, 2
v_and_b32 v16, 3, v16
v_mfma_f32_16x16x32_bf16 v[188:191], a[132:135], a[108:111], v[188:191]
s_add_u32 s53, s88, 524288
v_lshrrev_b32 v20, 1, v19
v_mul_u32_u24 v20, 18, v20
v_mfma_f32_16x16x32_bf16 v[188:191], a[128:131], a[104:107], v[188:191]
s_waitcnt lgkmcnt(0)
v_and_b32 v21, 1, v19
v_lshl_add_u32 v20, v21, 1, v20
v_mfma_f32_16x16x32_bf16 v[196:199], a[160:163], a[80:83], v[196:199]
s_waitcnt vmcnt(18)
v_lshl_add_u32 v20, v16, 2, v20
v_add_u32 v20, v20, v18
v_mfma_f32_16x16x32_bf16 v[196:199], a[164:167], a[84:87], v[196:199]
s_barrier
v_mfma_f32_16x16x32_bf16 v[64:67], a[172:175], a[84:87], v[64:67]
ds_read_b64_tr_b16 a[128:129], v11 offset:0
ds_read_b64_tr_b16 a[130:131], v11 offset:512
v_mfma_f32_16x16x32_bf16 v[64:67], a[168:171], a[80:83], v[64:67]
s_add_u32 m0, s77, 49152
s_add_u32 s64, s76, 128
v_mad_u32_u24 v20, s52, 36, v20
v_mfma_f32_16x16x32_bf16 v[204:207], a[176:179], a[80:83], v[204:207]
buffer_load_dwordx4 v7, s[20:23], s64 offen lds
v_mfma_f32_16x16x32_bf16 v[204:207], a[180:183], a[84:87], v[204:207]
ds_read_b64_tr_b16 a[132:133], v11 offset:4096
ds_read_b64_tr_b16 a[134:135], v11 offset:4608
v_mfma_f32_16x16x32_bf16 v[212:215], a[188:191], a[84:87], v[212:215]
ds_read_b64_tr_b16 a[136:137], v12 offset:0
ds_read_b64_tr_b16 a[138:139], v12 offset:512
v_mfma_f32_16x16x32_bf16 v[212:215], a[184:187], a[80:83], v[212:215]
ds_read_b64_tr_b16 a[140:141], v12 offset:4096
ds_read_b64_tr_b16 a[142:143], v12 offset:4608
v_mfma_f32_16x16x32_bf16 v[72:75], a[112:115], a[80:83], v[72:75]
buffer_store_dwordx4 v[96:99], v4, s[24:27], s53 offen offset:0 sc1
v_mfma_f32_16x16x32_bf16 v[72:75], a[116:119], a[84:87], v[72:75]
ds_read_b64_tr_b16 a[144:145], v13 offset:0
ds_read_b64_tr_b16 a[146:147], v13 offset:512
v_mfma_f32_16x16x32_bf16 v[220:223], a[124:127], a[84:87], v[220:223]
buffer_load_dwordx4 v8, s[20:23], s64 offen offset:1024 lds
v_mfma_f32_16x16x32_bf16 v[220:223], a[120:123], a[80:83], v[220:223]
ds_read_b64_tr_b16 a[148:149], v13 offset:4096
ds_read_b64_tr_b16 a[150:151], v13 offset:4608
v_mfma_f32_16x16x32_bf16 v[252:255], a[120:123], a[88:91], v[252:255]
v_lshlrev_b32 v21, 1, v18
v_lshl_add_u32 v21, v19, 2, v21
v_mfma_f32_16x16x32_bf16 v[252:255], a[124:127], a[92:95], v[252:255]
ds_read_b64_tr_b16 a[152:153], v14 offset:0
ds_read_b64_tr_b16 a[154:155], v14 offset:512
v_mfma_f32_16x16x32_bf16 v[160:163], a[116:119], a[92:95], v[160:163]
s_add_u32 m0, s80, 49152
s_add_u32 s64, s79, 2048
v_lshrrev_b32 v22, 1, v16
v_mfma_f32_16x16x32_bf16 v[160:163], a[112:115], a[88:91], v[160:163]
ds_read_b64_tr_b16 a[156:157], v14 offset:4096
ds_read_b64_tr_b16 a[158:159], v14 offset:4608
v_mfma_f32_16x16x32_bf16 v[228:231], a[184:187], a[88:91], v[228:231]
buffer_load_dwordx4 v4, s[24:27], s64 offen sc1 lds
v_mfma_f32_16x16x32_bf16 v[228:231], a[188:191], a[92:95], v[228:231]
s_xor_b32 s65, s70, 640
s_add_u32 s71, s68, s65
s_add_u32 s72, s69, s65
v_mfma_f32_16x16x32_bf16 v[168:171], a[180:183], a[92:95], v[168:171]
ds_read_b128 a[64:67], v4 offset:8192
v_add_u32 v21, v21, v22
v_mfma_f32_16x16x32_bf16 v[168:171], a[176:179], a[88:91], v[168:171]
v_mul_u32_u24 v21, 18, v21
v_and_b32 v22, 1, v16
v_mfma_f32_16x16x32_bf16 v[176:179], a[168:171], a[88:91], v[176:179]
s_add_u32 m0, s73, 65536
s_add_u32 s64, s71, 0
ds_read_b128 a[80:83], v9 offset:0
v_mfma_f32_16x16x32_bf16 v[176:179], a[172:175], a[92:95], v[176:179]
v_add3_u32 v21, v21, v22, 16
v_cmp_lt_u32 s[96:97], 1, v19
v_mfma_f32_16x16x32_bf16 v[80:83], a[164:167], a[92:95], v[80:83]
buffer_load_dwordx4 v5, s[12:15], s64 offen lds
v_mfma_f32_16x16x32_bf16 v[80:83], a[160:163], a[88:91], v[80:83]
ds_read_b128 a[68:71], v4 offset:10240
v_mov_b32 v22, 0x100000
v_mfma_f32_16x16x32_bf16 v[184:187], a[160:163], a[96:99], v[184:187]
ds_read_b128 a[84:87], v10 offset:0
v_mul_u32_u24 v23, 1, v23
v_mfma_f32_16x16x32_bf16 v[184:187], a[164:167], a[100:103], v[184:187]
s_add_u32 s53, s88, 524288
v_cndmask_b32 v21, v21, v22, s[96:97]
v_mov_b32 v22, s52
v_mfma_f32_16x16x32_bf16 v[248:251], a[172:175], a[100:103], v[248:251]
buffer_store_dwordx4 v[104:107], v4, s[24:27], s53 offen offset:1024 sc1
v_mfma_f32_16x16x32_bf16 v[248:251], a[168:171], a[96:99], v[248:251]
ds_read_b128 a[72:75], v4 offset:9216
v_cmp_eq_u32 s[96:97], 4, v22
v_mfma_f32_16x16x32_bf16 v[240:243], a[176:179], a[96:99], v[240:243]
buffer_load_dwordx4 v6, s[12:15], s64 offen offset:1024 lds
v_mfma_f32_16x16x32_bf16 v[240:243], a[180:183], a[100:103], v[240:243]
ds_read_b128 a[88:91], v9 offset:2048
v_cndmask_b32 v20, v20, v21, s[96:97]
v_mfma_f32_16x16x32_bf16 v[232:235], a[188:191], a[100:103], v[232:235]
v_mul_u32_u24 v20, 1152, v20
v_lshl_add_u32 v20, v17, 4, v20
v_mfma_f32_16x16x32_bf16 v[232:235], a[184:187], a[96:99], v[232:235]
ds_read_b128 a[76:79], v4 offset:11264
v_mov_b32 v25, v20
v_mfma_f32_16x16x32_bf16 v[236:239], a[112:115], a[96:99], v[236:239]
s_add_u32 m0, s73, 67584
s_add_u32 s64, s71, 18432
v_mov_b32 v16, s54
v_mfma_f32_16x16x32_bf16 v[236:239], a[116:119], a[100:103], v[236:239]
ds_read_b128 a[92:95], v10 offset:2048
v_mov_b32 v17, s55
v_mfma_f32_16x16x32_bf16 v[224:227], a[124:127], a[100:103], v[224:227]
buffer_load_dwordx4 v5, s[12:15], s64 offen lds
v_mfma_f32_16x16x32_bf16 v[224:227], a[120:123], a[96:99], v[224:227]
v_add_u32 v18, 32, v22
v_mfma_f32_16x16x32_bf16 v[208:211], a[120:123], a[104:107], v[208:211]
s_mul_i32 s82, s55, 165888
s_lshl_b32 s54, s54, 5
s_add_u32 s82, s82, s54
v_mfma_f32_16x16x32_bf16 v[208:211], a[124:127], a[108:111], v[208:211]
s_and_b32 s52, s2, 1
s_lshr_b32 s54, s3, 1
s_lshl1_add_u32 s52, s52, s54
v_mfma_f32_16x16x32_bf16 v[216:219], a[116:119], a[108:111], v[216:219]
s_mul_i32 s52, s52, 9
s_and_b32 s54, s3, 1
s_mul_i32 s55, s54, 5
v_mfma_f32_16x16x32_bf16 v[216:219], a[112:115], a[104:107], v[216:219]
s_add_u32 s52, s52, s55
s_lshr_b32 s55, s2, 1
s_mul_i32 s81, s55, 1152
v_mfma_f32_16x16x32_bf16 v[244:247], a[184:187], a[104:107], v[244:247]
buffer_load_dwordx4 v6, s[12:15], s64 offen offset:1024 lds
v_mfma_f32_16x16x32_bf16 v[244:247], a[188:191], a[108:111], v[244:247]
s_add_u32 s81, s81, s52
s_lshl_b32 s81, s81, 5
v_mfma_f32_16x16x32_bf16 v[192:195], a[180:183], a[108:111], v[192:195]
v_cmp_gt_u32 s[96:97], 5, v1
v_add_u32 v19, s52, v1
v_mfma_f32_16x16x32_bf16 v[192:195], a[176:179], a[104:107], v[192:195]
v_lshrrev_b32 v20, 5, s55
v_and_b32 v21, 31, s55
v_mfma_f32_16x16x32_bf16 v[200:203], a[168:171], a[104:107], v[200:203]
v_cndmask_b32 v16, v16, v19, s[96:97]
v_cndmask_b32 v17, v17, v20, s[96:97]
v_mfma_f32_16x16x32_bf16 v[200:203], a[172:175], a[108:111], v[200:203]
v_cndmask_b32 v18, v18, v21, s[96:97]
v_mul_u32_u24 v19, 7282, v16
v_mfma_f32_16x16x32_bf16 v[88:91], a[164:167], a[108:111], v[88:91]
v_lshrrev_b32 v19, 16, v19
v_mul_u32_u24 v20, 9, v19
v_mfma_f32_16x16x32_bf16 v[88:91], a[160:163], a[104:107], v[88:91]
s_waitcnt lgkmcnt(0)
v_sub_u32 v16, v16, v20
v_and_b32 v20, 1, v19
v_mfma_f32_16x16x32_bf16 v[36:39], a[128:131], a[80:83], v[36:39]
s_waitcnt vmcnt(24)
v_lshlrev_b32 v20, 2, v20
v_cndmask_b32 v20, 0, v20, s[96:97]
v_mfma_f32_16x16x32_bf16 v[36:39], a[132:135], a[84:87], v[36:39]
s_barrier
v_mfma_f32_16x16x32_bf16 v[44:47], a[140:143], a[84:87], v[44:47]
ds_read_b128 a[96:99], v9 offset:4096
v_xor_b32 v18, v18, v20
v_mfma_f32_16x16x32_bf16 v[44:47], a[136:139], a[80:83], v[44:47]
s_xor_b32 s75, s93, 5
s_lshl_b32 s76, s75, 19
s_add_u32 s76, s76, s74
v_mfma_f32_16x16x32_bf16 v[32:35], a[144:147], a[80:83], v[32:35]
s_lshl_b32 s79, s75, 13
s_add_u32 s79, s79, s78
ds_read_b128 a[100:103], v10 offset:4096
v_mfma_f32_16x16x32_bf16 v[32:35], a[148:151], a[84:87], v[32:35]
s_add_u32 m0, s77, 0
s_add_u32 s64, s76, 0
ds_read_b128 a[104:107], v9 offset:6144
v_mfma_f32_16x16x32_bf16 v[52:55], a[156:159], a[84:87], v[52:55]
buffer_load_dwordx4 v7, s[20:23], s64 offen lds
v_mfma_f32_16x16x32_bf16 v[52:55], a[152:155], a[80:83], v[52:55]
s_add_u32 s53, s88, 524288
ds_read_b64_tr_b16 a[160:161], v11 offset:16384
ds_read_b64_tr_b16 a[162:163], v11 offset:16896
v_mfma_f32_16x16x32_bf16 v[60:63], a[64:67], a[80:83], v[60:63]
buffer_store_dwordx4 v[112:115], v4, s[24:27], s53 offen offset:2048 sc1
v_mfma_f32_16x16x32_bf16 v[60:63], a[68:71], a[84:87], v[60:63]
ds_read_b128 a[108:111], v10 offset:6144
v_lshl_add_u32 v19, v19, 2, v17
v_mfma_f32_16x16x32_bf16 v[68:71], a[76:79], a[84:87], v[68:71]
buffer_load_dwordx4 v8, s[20:23], s64 offen offset:1024 lds
v_mfma_f32_16x16x32_bf16 v[68:71], a[72:75], a[80:83], v[68:71]
ds_read_b64_tr_b16 a[164:165], v11 offset:20480
ds_read_b64_tr_b16 a[166:167], v11 offset:20992
v_mfma_f32_16x16x32_bf16 v[76:79], a[72:75], a[88:91], v[76:79]
v_add_u32 v9, 32768, v9
v_add_u32 v10, 32768, v10
v_mfma_f32_16x16x32_bf16 v[76:79], a[76:79], a[92:95], v[76:79]
ds_read_b64_tr_b16 a[168:169], v12 offset:16384
ds_read_b64_tr_b16 a[170:171], v12 offset:16896
v_mfma_f32_16x16x32_bf16 v[84:87], a[68:71], a[92:95], v[84:87]
s_add_u32 m0, s80, 0
s_add_u32 s64, s79, 0
v_mul_u32_u24 v19, 344064, v19
v_mfma_f32_16x16x32_bf16 v[84:87], a[64:67], a[88:91], v[84:87]
ds_read_b64_tr_b16 a[172:173], v12 offset:20480
ds_read_b64_tr_b16 a[174:175], v12 offset:20992
v_mfma_f32_16x16x32_bf16 v[92:95], a[152:155], a[88:91], v[92:95]
buffer_load_dwordx4 v4, s[24:27], s64 offen sc1 lds
v_mfma_f32_16x16x32_bf16 v[92:95], a[156:159], a[92:95], v[92:95]
v_lshrrev_b32 v20, 1, v16
v_sub_u32 v20, v20, v17
v_mfma_f32_16x16x32_bf16 v[40:43], a[148:151], a[92:95], v[40:43]
ds_read_b64_tr_b16 a[176:177], v13 offset:16384
ds_read_b64_tr_b16 a[178:179], v13 offset:16896
v_mfma_f32_16x16x32_bf16 v[40:43], a[144:147], a[88:91], v[40:43]
v_add_u32 v20, 3, v20
v_and_b32 v20, 3, v20
v_mfma_f32_16x16x32_bf16 v[100:103], a[136:139], a[88:91], v[100:103]
s_add_u32 m0, s73, 69632
s_add_u32 s64, s72, 0
v_cmp_eq_u32 s[96:97], 8, v16
v_mfma_f32_16x16x32_bf16 v[100:103], a[140:143], a[92:95], v[100:103]
ds_read_b64_tr_b16 a[180:181], v13 offset:20480
ds_read_b64_tr_b16 a[182:183], v13 offset:20992
v_mfma_f32_16x16x32_bf16 v[108:111], a[132:135], a[92:95], v[108:111]
buffer_load_dwordx4 v5, s[12:15], s64 offen lds
v_mfma_f32_16x16x32_bf16 v[108:111], a[128:131], a[88:91], v[108:111]
s_waitcnt lgkmcnt(14)
ds_read_b64_tr_b16 a[184:185], v14 offset:16384
ds_read_b64_tr_b16 a[186:187], v14 offset:16896
v_mfma_f32_16x16x32_bf16 v[116:119], a[128:131], a[96:99], v[116:119]
ds_read_b64_tr_b16 a[188:189], v14 offset:20480
ds_read_b64_tr_b16 a[190:191], v14 offset:20992
v_mfma_f32_16x16x32_bf16 v[116:119], a[132:135], a[100:103], v[116:119]
v_and_b32 v16, 1, v16
v_lshl_add_u32 v21, v20, 1, v16
v_mfma_f32_16x16x32_bf16 v[124:127], a[140:143], a[100:103], v[124:127]
v_and_b32 v22, 1, v18
v_lshl_add_u32 v19, v22, 10, v19
v_mfma_f32_16x16x32_bf16 v[124:127], a[136:139], a[96:99], v[124:127]
ds_read_b128 a[112:115], v4 offset:24576
v_and_b32 v18, -2, v18
v_mfma_f32_16x16x32_bf16 v[132:135], a[144:147], a[96:99], v[132:135]
buffer_load_dwordx4 v6, s[12:15], s64 offen offset:1024 lds
v_mfma_f32_16x16x32_bf16 v[132:135], a[148:151], a[100:103], v[132:135]
ds_read_b128 a[116:119], v4 offset:26624
v_add_u32 v21, 1, v21
v_mfma_f32_16x16x32_bf16 v[140:143], a[156:159], a[100:103], v[140:143]
v_cndmask_b32 v21, v21, 0, s[96:97]
v_cndmask_b32 v20, v20, 0, s[96:97]
v_mfma_f32_16x16x32_bf16 v[140:143], a[152:155], a[96:99], v[140:143]
s_add_u32 s53, s88, 524288
ds_read_b128 a[120:123], v4 offset:25600
v_sub_u32 v17, 37, v18
v_mfma_f32_16x16x32_bf16 v[148:151], a[64:67], a[96:99], v[148:151]
s_add_u32 m0, s73, 71680
s_add_u32 s64, s72, 18432
v_min_u32 v17, 2, v17
v_mfma_f32_16x16x32_bf16 v[148:151], a[68:71], a[100:103], v[148:151]
ds_read_b128 a[124:127], v4 offset:27648
v_mul_u32_u24 v21, v21, v17
v_mfma_f32_16x16x32_bf16 v[48:51], a[76:79], a[100:103], v[48:51]
buffer_load_dwordx4 v5, s[12:15], s64 offen lds
v_mfma_f32_16x16x32_bf16 v[48:51], a[72:75], a[96:99], v[48:51]
s_waitcnt lgkmcnt(15)
v_mul_u32_u24 v22, v16, v17
v_min_u32 v23, 16, v18
v_mfma_f32_16x16x32_bf16 v[156:159], a[72:75], a[104:107], v[156:159]
buffer_store_dwordx4 v[120:123], v4, s[24:27], s53 offen offset:3072 sc1
v_mfma_f32_16x16x32_bf16 v[156:159], a[76:79], a[108:111], v[156:159]
v_mad_u32_u24 v21, v18, 5, v21
v_lshl_add_u32 v21, v23, 1, v21
v_mfma_f32_16x16x32_bf16 v[164:167], a[68:71], a[108:111], v[164:167]
v_lshl_add_u32 v22, v18, 1, v22
v_mad_u32_u24 v22, v20, 37, v22
v_mfma_f32_16x16x32_bf16 v[164:167], a[64:67], a[104:107], v[164:167]
v_mad_u32_u24 v22, v20, 37, v22
v_lshl_add_u32 v20, v20, 6, v18
v_mfma_f32_16x16x32_bf16 v[172:175], a[152:155], a[104:107], v[172:175]
buffer_load_dwordx4 v6, s[12:15], s64 offen offset:1024 lds
v_mfma_f32_16x16x32_bf16 v[172:175], a[156:159], a[108:111], v[172:175]
v_mov_b32 v23, 144
v_cmp_gt_u32 s[96:97], v23, v20
v_mfma_f32_16x16x32_bf16 v[56:59], a[148:151], a[108:111], v[56:59]
v_add_u32 v22, 37, v22
v_add_u32 v19, 38797312, v19
v_mfma_f32_16x16x32_bf16 v[56:59], a[144:147], a[104:107], v[56:59]
v_cndmask_b32 v21, v22, v21, s[96:97]
v_lshl_add_u32 v19, v21, 10, v19
v_mfma_f32_16x16x32_bf16 v[180:183], a[136:139], a[104:107], v[180:183]
s_cmp_eq_u32 s54, 1
s_cselect_b32 s96, 16, 0
v_mfma_f32_16x16x32_bf16 v[180:183], a[140:143], a[108:111], v[180:183]
s_cmp_eq_u32 s3, 3
s_cselect_b32 s52, 32, 0
s_or_b32 s96, s96, s52
v_mfma_f32_16x16x32_bf16 v[188:191], a[132:135], a[108:111], v[188:191]
s_cmp_ge_u32 s2, 240
s_cselect_b32 s52, 32, 0
s_or_b32 s96, s96, s52
v_mfma_f32_16x16x32_bf16 v[188:191], a[128:131], a[104:107], v[188:191]
s_waitcnt lgkmcnt(0)
s_mov_b32 s97, 0
v_mfma_f32_16x16x32_bf16 v[196:199], a[160:163], a[80:83], v[196:199]
s_waitcnt vmcnt(18)
v_mov_b32 v20, 2147418112
v_cndmask_b32 v26, v19, v20, s[96:97]
v_mfma_f32_16x16x32_bf16 v[196:199], a[164:167], a[84:87], v[196:199]
s_barrier
v_mfma_f32_16x16x32_bf16 v[64:67], a[172:175], a[84:87], v[64:67]
L_PAD6:
s_cbranch_execz L_PAD10
ds_read_b64_tr_b16 a[128:129], v11 offset:32768
ds_read_b64_tr_b16 a[130:131], v11 offset:33280
v_mfma_f32_16x16x32_bf16 v[64:67], a[168:171], a[80:83], v[64:67]
s_add_u32 m0, s77, 16384
s_add_u32 s64, s76, 128
v_lshlrev_b32 v27, 3, v1
v_mfma_f32_16x16x32_bf16 v[204:207], a[176:179], a[80:83], v[204:207]
buffer_load_dwordx4 v7, s[20:23], s64 offen lds
v_mfma_f32_16x16x32_bf16 v[204:207], a[180:183], a[84:87], v[204:207]
ds_read_b64_tr_b16 a[132:133], v11 offset:36864
ds_read_b64_tr_b16 a[134:135], v11 offset:37376
v_mfma_f32_16x16x32_bf16 v[212:215], a[188:191], a[84:87], v[212:215]
ds_read_b64_tr_b16 a[136:137], v12 offset:32768
ds_read_b64_tr_b16 a[138:139], v12 offset:33280
v_mfma_f32_16x16x32_bf16 v[212:215], a[184:187], a[80:83], v[212:215]
ds_read_b64_tr_b16 a[140:141], v12 offset:36864
ds_read_b64_tr_b16 a[142:143], v12 offset:37376
v_mfma_f32_16x16x32_bf16 v[72:75], a[112:115], a[80:83], v[72:75]
buffer_atomic_add v1, v0, s[24:27], s90 offen offset:4 sc1
v_mfma_f32_16x16x32_bf16 v[72:75], a[116:119], a[84:87], v[72:75]
ds_read_b64_tr_b16 a[144:145], v13 offset:32768
ds_read_b64_tr_b16 a[146:147], v13 offset:33280
v_mfma_f32_16x16x32_bf16 v[220:223], a[124:127], a[84:87], v[220:223]
buffer_load_dwordx4 v8, s[20:23], s64 offen offset:1024 lds
v_mfma_f32_16x16x32_bf16 v[220:223], a[120:123], a[80:83], v[220:223]
s_add_u32 s53, s88, 786432
ds_read_b64_tr_b16 a[148:149], v13 offset:36864
ds_read_b64_tr_b16 a[150:151], v13 offset:37376
v_mfma_f32_16x16x32_bf16 v[252:255], a[120:123], a[88:91], v[252:255]
buffer_store_dwordx4 v[128:131], v4, s[24:27], s53 offen offset:0 sc1
v_mfma_f32_16x16x32_bf16 v[252:255], a[124:127], a[92:95], v[252:255]
ds_read_b64_tr_b16 a[152:153], v14 offset:32768
ds_read_b64_tr_b16 a[154:155], v14 offset:33280
v_mfma_f32_16x16x32_bf16 v[160:163], a[116:119], a[92:95], v[160:163]
s_add_u32 m0, s80, 16384
s_add_u32 s64, s79, 2048
v_add_u32 v27, s83, v27
v_mfma_f32_16x16x32_bf16 v[160:163], a[112:115], a[88:91], v[160:163]
ds_read_b64_tr_b16 a[156:157], v14 offset:36864
ds_read_b64_tr_b16 a[158:159], v14 offset:37376
v_mfma_f32_16x16x32_bf16 v[228:231], a[184:187], a[88:91], v[228:231]
buffer_load_dwordx4 v4, s[24:27], s64 offen sc1 lds
v_mfma_f32_16x16x32_bf16 v[228:231], a[188:191], a[92:95], v[228:231]
s_xor_b32 s65, s70, 768
s_add_u32 s71, s68, s65
s_add_u32 s72, s69, s65
v_mfma_f32_16x16x32_bf16 v[168:171], a[180:183], a[92:95], v[168:171]
ds_read_b128 a[64:67], v4 offset:40960
v_lshrrev_b32 v22, 3, v1
v_mfma_f32_16x16x32_bf16 v[168:171], a[176:179], a[88:91], v[168:171]
v_mul_u32_u24 v22, 1152, v22
v_and_b32 v23, 7, v1
v_mfma_f32_16x16x32_bf16 v[176:179], a[168:171], a[88:91], v[176:179]
s_add_u32 m0, s73, 0
s_add_u32 s64, s71, 0
ds_read_b128 a[80:83], v9 offset:0
v_mfma_f32_16x16x32_bf16 v[176:179], a[172:175], a[92:95], v[176:179]
v_lshl_add_u32 v22, v23, 4, v22
v_lshrrev_b32 v23, 2, v1
v_mfma_f32_16x16x32_bf16 v[80:83], a[164:167], a[92:95], v[80:83]
buffer_load_dwordx4 v5, s[12:15], s64 offen lds
v_mfma_f32_16x16x32_bf16 v[80:83], a[160:163], a[88:91], v[80:83]
ds_read_b128 a[68:71], v4 offset:43008
v_mul_u32_u24 v23, 96, v23
v_mfma_f32_16x16x32_bf16 v[184:187], a[160:163], a[96:99], v[184:187]
ds_read_b128 a[84:87], v10 offset:0
v_add_u32 v23, v23, v27
v_mfma_f32_16x16x32_bf16 v[184:187], a[164:167], a[100:103], v[184:187]
v_and_b32 v16, 3, v1
v_cmp_eq_u32 s[96:97], 0, v16
v_mfma_f32_16x16x32_bf16 v[248:251], a[172:175], a[100:103], v[248:251]
v_mov_b32 v16, 0x3f803f80
v_mfma_f32_16x16x32_bf16 v[248:251], a[168:171], a[96:99], v[248:251]
ds_read_b128 a[72:75], v4 offset:41984
v_cndmask_b32 v16, 0, v16, s[96:97]
v_mfma_f32_16x16x32_bf16 v[240:243], a[176:179], a[96:99], v[240:243]
buffer_load_dwordx4 v6, s[12:15], s64 offen offset:1024 lds
v_mfma_f32_16x16x32_bf16 v[240:243], a[180:183], a[100:103], v[240:243]
ds_read_b128 a[88:91], v9 offset:2048
v_accvgpr_write_b32 a240, v16
v_mfma_f32_16x16x32_bf16 v[232:235], a[188:191], a[100:103], v[232:235]
v_accvgpr_write_b32 a241, v16
v_accvgpr_write_b32 a242, v16
v_mfma_f32_16x16x32_bf16 v[232:235], a[184:187], a[96:99], v[232:235]
ds_read_b128 a[76:79], v4 offset:44032
v_accvgpr_write_b32 a243, v16
v_mfma_f32_16x16x32_bf16 v[236:239], a[112:115], a[96:99], v[236:239]
s_add_u32 m0, s73, 2048
s_add_u32 s64, s71, 18432
v_accvgpr_write_b32 a232, 0
v_mfma_f32_16x16x32_bf16 v[236:239], a[116:119], a[100:103], v[236:239]
ds_read_b128 a[92:95], v10 offset:2048
v_accvgpr_write_b32 a233, 0
v_mfma_f32_16x16x32_bf16 v[224:227], a[124:127], a[100:103], v[224:227]
buffer_load_dwordx4 v5, s[12:15], s64 offen lds
v_mfma_f32_16x16x32_bf16 v[224:227], a[120:123], a[96:99], v[224:227]
v_accvgpr_write_b32 a234, 0
v_accvgpr_write_b32 a235, 0
v_mfma_f32_16x16x32_bf16 v[208:211], a[120:123], a[104:107], v[208:211]
v_accvgpr_write_b32 a236, 0
v_accvgpr_write_b32 a237, 0
v_mfma_f32_16x16x32_bf16 v[208:211], a[124:127], a[108:111], v[208:211]
s_add_u32 s53, s88, 786432
v_accvgpr_write_b32 a238, 0
v_accvgpr_write_b32 a239, 0
v_mfma_f32_16x16x32_bf16 v[216:219], a[116:119], a[108:111], v[216:219]
buffer_store_dwordx4 v[136:139], v4, s[24:27], s53 offen offset:1024 sc1
v_mfma_f32_16x16x32_bf16 v[216:219], a[112:115], a[104:107], v[216:219]
v_lshlrev_b32 v16, 2, v3
v_sub_u32 v16, v2, v16
v_mfma_f32_16x16x32_bf16 v[244:247], a[184:187], a[104:107], v[244:247]
buffer_load_dwordx4 v6, s[12:15], s64 offen offset:1024 lds
v_mfma_f32_16x16x32_bf16 v[244:247], a[188:191], a[108:111], v[244:247]
v_cmp_gt_i32 s[56:57], 0, v16
v_cmp_gt_i32 s[58:59], 1, v16
v_mfma_f32_16x16x32_bf16 v[192:195], a[180:183], a[108:111], v[192:195]
v_cmp_gt_i32 s[60:61], 2, v16
v_cmp_gt_i32 s[62:63], 3, v16
v_mfma_f32_16x16x32_bf16 v[192:195], a[176:179], a[104:107], v[192:195]
v_cmp_eq_u32 s[96:97], 3, v3
v_add_u32 v17, 48, v2
v_mfma_f32_16x16x32_bf16 v[200:203], a[168:171], a[104:107], v[200:203]
v_lshlrev_b32 v17, 2, v17
v_lshlrev_b32 v18, 16, v3
v_mfma_f32_16x16x32_bf16 v[200:203], a[172:175], a[108:111], v[200:203]
v_lshl_add_u32 v18, v2, 4, v18
v_add_u32 v19, 0x8000, v18
v_mfma_f32_16x16x32_bf16 v[88:91], a[164:167], a[108:111], v[88:91]
v_cndmask_b32 v19, v19, v20, s[96:97]
v_mfma_f32_16x16x32_bf16 v[88:91], a[160:163], a[104:107], v[88:91]
s_waitcnt lgkmcnt(0)
v_mfma_f32_16x16x32_bf16 v[36:39], a[128:131], a[80:83], v[36:39]
s_waitcnt vmcnt(24)
v_mfma_f32_16x16x32_bf16 v[36:39], a[132:135], a[84:87], v[36:39]
s_barrier
v_mfma_f32_16x16x32_bf16 v[44:47], a[140:143], a[84:87], v[44:47]
ds_read_b128 a[96:99], v9 offset:4096
v_mfma_f32_16x16x32_bf16 v[44:47], a[136:139], a[80:83], v[44:47]
s_xor_b32 s75, s93, 6
s_lshl_b32 s76, s75, 19
s_add_u32 s76, s76, s74
v_mfma_f32_16x16x32_bf16 v[32:35], a[144:147], a[80:83], v[32:35]
s_lshl_b32 s79, s75, 13
s_add_u32 s79, s79, s78
ds_read_b128 a[100:103], v10 offset:4096
v_mfma_f32_16x16x32_bf16 v[32:35], a[148:151], a[84:87], v[32:35]
s_add_u32 m0, s77, 32768
s_add_u32 s64, s76, 0
ds_read_b128 a[104:107], v9 offset:6144
v_mfma_f32_16x16x32_bf16 v[52:55], a[156:159], a[84:87], v[52:55]
buffer_load_dwordx4 v7, s[20:23], s64 offen lds
v_mfma_f32_16x16x32_bf16 v[52:55], a[152:155], a[80:83], v[52:55]
ds_read_b64_tr_b16 a[160:161], v11 offset:49152
ds_read_b64_tr_b16 a[162:163], v11 offset:49664
v_mfma_f32_16x16x32_bf16 v[60:63], a[64:67], a[80:83], v[60:63]
v_mfma_f32_16x16x32_bf16 v[60:63], a[68:71], a[84:87], v[60:63]
ds_read_b128 a[108:111], v10 offset:6144
v_mfma_f32_16x16x32_bf16 v[68:71], a[76:79], a[84:87], v[68:71]
buffer_load_dwordx4 v8, s[20:23], s64 offen offset:1024 lds
v_mfma_f32_16x16x32_bf16 v[68:71], a[72:75], a[80:83], v[68:71]
ds_read_b64_tr_b16 a[164:165], v11 offset:53248
ds_read_b64_tr_b16 a[166:167], v11 offset:53760
v_mfma_f32_16x16x32_bf16 v[76:79], a[72:75], a[88:91], v[76:79]
v_add_u32 v9, 32768, v9
v_add_u32 v10, 32768, v10
v_mfma_f32_16x16x32_bf16 v[76:79], a[76:79], a[92:95], v[76:79]
ds_read_b64_tr_b16 a[168:169], v12 offset:49152
ds_read_b64_tr_b16 a[170:171], v12 offset:49664
v_mfma_f32_16x16x32_bf16 v[84:87], a[68:71], a[92:95], v[84:87]
s_add_u32 m0, s80, 32768
s_add_u32 s64, s79, 0
v_mfma_f32_16x16x32_bf16 v[84:87], a[64:67], a[88:91], v[84:87]
ds_read_b64_tr_b16 a[172:173], v12 offset:53248
ds_read_b64_tr_b16 a[174:175], v12 offset:53760
v_mfma_f32_16x16x32_bf16 v[92:95], a[152:155], a[88:91], v[92:95]
buffer_load_dwordx4 v4, s[24:27], s64 offen sc1 lds
v_mfma_f32_16x16x32_bf16 v[92:95], a[156:159], a[92:95], v[92:95]
s_add_u32 s53, s88, 786432
v_mfma_f32_16x16x32_bf16 v[40:43], a[148:151], a[92:95], v[40:43]
ds_read_b64_tr_b16 a[176:177], v13 offset:49152
ds_read_b64_tr_b16 a[178:179], v13 offset:49664
v_mfma_f32_16x16x32_bf16 v[40:43], a[144:147], a[88:91], v[40:43]
buffer_store_dwordx4 v[144:147], v4, s[24:27], s53 offen offset:2048 sc1
v_mfma_f32_16x16x32_bf16 v[100:103], a[136:139], a[88:91], v[100:103]
s_add_u32 m0, s73, 4096
s_add_u32 s64, s72, 0
v_mfma_f32_16x16x32_bf16 v[100:103], a[140:143], a[92:95], v[100:103]
ds_read_b64_tr_b16 a[180:181], v13 offset:53248
ds_read_b64_tr_b16 a[182:183], v13 offset:53760
v_mfma_f32_16x16x32_bf16 v[108:111], a[132:135], a[92:95], v[108:111]
buffer_load_dwordx4 v5, s[12:15], s64 offen lds
v_mfma_f32_16x16x32_bf16 v[108:111], a[128:131], a[88:91], v[108:111]
s_waitcnt lgkmcnt(14)
ds_read_b64_tr_b16 a[184:185], v14 offset:49152
ds_read_b64_tr_b16 a[186:187], v14 offset:49664
v_mfma_f32_16x16x32_bf16 v[116:119], a[128:131], a[96:99], v[116:119]
ds_read_b64_tr_b16 a[188:189], v14 offset:53248
ds_read_b64_tr_b16 a[190:191], v14 offset:53760
v_mfma_f32_16x16x32_bf16 v[116:119], a[132:135], a[100:103], v[116:119]
v_mfma_f32_16x16x32_bf16 v[124:127], a[140:143], a[100:103], v[124:127]
v_mfma_f32_16x16x32_bf16 v[124:127], a[136:139], a[96:99], v[124:127]
ds_read_b128 a[112:115], v4 offset:57344
v_mfma_f32_16x16x32_bf16 v[132:135], a[144:147], a[96:99], v[132:135]
buffer_load_dwordx4 v6, s[12:15], s64 offen offset:1024 lds
v_mfma_f32_16x16x32_bf16 v[132:135], a[148:151], a[100:103], v[132:135]
ds_read_b128 a[116:119], v4 offset:59392
v_mfma_f32_16x16x32_bf16 v[140:143], a[156:159], a[100:103], v[140:143]
v_mfma_f32_16x16x32_bf16 v[140:143], a[152:155], a[96:99], v[140:143]
ds_read_b128 a[120:123], v4 offset:58368
v_mfma_f32_16x16x32_bf16 v[148:151], a[64:67], a[96:99], v[148:151]
s_add_u32 m0, s73, 6144
s_add_u32 s64, s72, 18432
v_mfma_f32_16x16x32_bf16 v[148:151], a[68:71], a[100:103], v[148:151]
ds_read_b128 a[124:127], v4 offset:60416
v_mfma_f32_16x16x32_bf16 v[48:51], a[76:79], a[100:103], v[48:51]
buffer_load_dwordx4 v5, s[12:15], s64 offen lds
v_mfma_f32_16x16x32_bf16 v[48:51], a[72:75], a[96:99], v[48:51]
s_waitcnt lgkmcnt(15)
v_mfma_f32_16x16x32_bf16 v[156:159], a[72:75], a[104:107], v[156:159]
v_mfma_f32_16x16x32_bf16 v[156:159], a[76:79], a[108:111], v[156:159]
v_mfma_f32_16x16x32_bf16 v[164:167], a[68:71], a[108:111], v[164:167]
v_mfma_f32_16x16x32_bf16 v[164:167], a[64:67], a[104:107], v[164:167]
v_mfma_f32_16x16x32_bf16 v[172:175], a[152:155], a[104:107], v[172:175]
buffer_load_dwordx4 v6, s[12:15], s64 offen offset:1024 lds
v_mfma_f32_16x16x32_bf16 v[172:175], a[156:159], a[108:111], v[172:175]
v_mfma_f32_16x16x32_bf16 v[56:59], a[148:151], a[108:111], v[56:59]
v_mfma_f32_16x16x32_bf16 v[56:59], a[144:147], a[104:107], v[56:59]
s_add_u32 s53, s88, 786432
v_mfma_f32_16x16x32_bf16 v[180:183], a[136:139], a[104:107], v[180:183]
buffer_store_dwordx4 v[152:155], v4, s[24:27], s53 offen offset:3072 sc1
v_mfma_f32_16x16x32_bf16 v[180:183], a[140:143], a[108:111], v[180:183]
v_mfma_f32_16x16x32_bf16 v[188:191], a[132:135], a[108:111], v[188:191]
v_mfma_f32_16x16x32_bf16 v[188:191], a[128:131], a[104:107], v[188:191]
s_waitcnt lgkmcnt(0)
v_mov_b32 v96, 0
v_mov_b32 v97, 0
v_mfma_f32_16x16x32_bf16 v[196:199], a[160:163], a[80:83], v[196:199]
s_waitcnt vmcnt(19)
v_mov_b32 v98, 0
v_mov_b32 v99, 0
v_mfma_f32_16x16x32_bf16 v[196:199], a[164:167], a[84:87], v[196:199]
s_barrier
v_mfma_f32_16x16x32_bf16 v[64:67], a[172:175], a[84:87], v[64:67]
ds_read_b64_tr_b16 a[128:129], v11 offset:0
ds_read_b64_tr_b16 a[130:131], v11 offset:512
v_mfma_f32_16x16x32_bf16 v[64:67], a[168:171], a[80:83], v[64:67]
s_add_u32 m0, s77, 49152
s_add_u32 s64, s76, 128
v_mov_b32 v104, 0
v_mfma_f32_16x16x32_bf16 v[204:207], a[176:179], a[80:83], v[204:207]
buffer_load_dwordx4 v7, s[20:23], s64 offen lds
v_mfma_f32_16x16x32_bf16 v[204:207], a[180:183], a[84:87], v[204:207]
ds_read_b64_tr_b16 a[132:133], v11 offset:4096
ds_read_b64_tr_b16 a[134:135], v11 offset:4608
v_mfma_f32_16x16x32_bf16 v[212:215], a[188:191], a[84:87], v[212:215]
ds_read_b64_tr_b16 a[136:137], v12 offset:0
ds_read_b64_tr_b16 a[138:139], v12 offset:512
v_mfma_f32_16x16x32_bf16 v[212:215], a[184:187], a[80:83], v[212:215]
ds_read_b64_tr_b16 a[140:141], v12 offset:4096
ds_read_b64_tr_b16 a[142:143], v12 offset:4608
v_mfma_f32_16x16x32_bf16 v[72:75], a[112:115], a[80:83], v[72:75]
buffer_load_dword v30, v29, s[24:27], s89 offen offset:4 sc1
v_mfma_f32_16x16x32_bf16 v[72:75], a[116:119], a[84:87], v[72:75]
ds_read_b64_tr_b16 a[144:145], v13 offset:0
ds_read_b64_tr_b16 a[146:147], v13 offset:512
v_mfma_f32_16x16x32_bf16 v[220:223], a[124:127], a[84:87], v[220:223]
buffer_load_dwordx4 v8, s[20:23], s64 offen offset:1024 lds
v_mfma_f32_16x16x32_bf16 v[220:223], a[120:123], a[80:83], v[220:223]
ds_read_b64_tr_b16 a[148:149], v13 offset:4096
ds_read_b64_tr_b16 a[150:151], v13 offset:4608
v_mfma_f32_16x16x32_bf16 v[252:255], a[120:123], a[88:91], v[252:255]
v_mov_b32 v105, 0
v_mov_b32 v106, 0
v_mfma_f32_16x16x32_bf16 v[252:255], a[124:127], a[92:95], v[252:255]
ds_read_b64_tr_b16 a[152:153], v14 offset:0
ds_read_b64_tr_b16 a[154:155], v14 offset:512
v_mfma_f32_16x16x32_bf16 v[160:163], a[116:119], a[92:95], v[160:163]
s_add_u32 m0, s80, 49152
s_add_u32 s64, s79, 2048
v_mov_b32 v107, 0
v_mfma_f32_16x16x32_bf16 v[160:163], a[112:115], a[88:91], v[160:163]
ds_read_b64_tr_b16 a[156:157], v14 offset:4096
ds_read_b64_tr_b16 a[158:159], v14 offset:4608
v_mfma_f32_16x16x32_bf16 v[228:231], a[184:187], a[88:91], v[228:231]
buffer_load_dwordx4 v4, s[24:27], s64 offen sc1 lds
v_mfma_f32_16x16x32_bf16 v[228:231], a[188:191], a[92:95], v[228:231]
s_xor_b32 s65, s70, 896
s_add_u32 s71, s68, s65
s_add_u32 s72, s69, s65
v_mfma_f32_16x16x32_bf16 v[168:171], a[180:183], a[92:95], v[168:171]
ds_read_b128 a[64:67], v4 offset:8192
v_mov_b32 v112, 0
v_mfma_f32_16x16x32_bf16 v[168:171], a[176:179], a[88:91], v[168:171]
v_mov_b32 v113, 0
v_mov_b32 v114, 0
v_mfma_f32_16x16x32_bf16 v[176:179], a[168:171], a[88:91], v[176:179]
s_add_u32 m0, s73, 32768
s_add_u32 s64, s71, 0
ds_read_b128 a[80:83], v9 offset:0
v_mfma_f32_16x16x32_bf16 v[176:179], a[172:175], a[92:95], v[176:179]
v_mov_b32 v115, 0
v_mov_b32 v120, 0
v_mfma_f32_16x16x32_bf16 v[80:83], a[164:167], a[92:95], v[80:83]
buffer_load_dwordx4 v5, s[12:15], s64 offen lds
v_mfma_f32_16x16x32_bf16 v[80:83], a[160:163], a[88:91], v[80:83]
s_add_u32 s53, s87, 524288
ds_read_b128 a[68:71], v4 offset:10240
v_mov_b32 v121, 0
v_mfma_f32_16x16x32_bf16 v[184:187], a[160:163], a[96:99], v[184:187]
ds_read_b128 a[84:87], v10 offset:0
v_mov_b32 v122, 0
v_mfma_f32_16x16x32_bf16 v[184:187], a[164:167], a[100:103], v[184:187]
buffer_store_dwordx4 a[28:31], v4, s[24:27], s53 offen offset:0 sc1
v_mfma_f32_16x16x32_bf16 v[248:251], a[172:175], a[100:103], v[248:251]
v_mov_b32 v123, 0
v_mov_b32 v128, 0
v_mfma_f32_16x16x32_bf16 v[248:251], a[168:171], a[96:99], v[248:251]
ds_read_b128 a[72:75], v4 offset:9216
v_mov_b32 v129, 0
v_mfma_f32_16x16x32_bf16 v[240:243], a[176:179], a[96:99], v[240:243]
buffer_load_dwordx4 v6, s[12:15], s64 offen offset:1024 lds
v_mfma_f32_16x16x32_bf16 v[240:243], a[180:183], a[100:103], v[240:243]
ds_read_b128 a[88:91], v9 offset:2048
v_mov_b32 v130, 0
v_mfma_f32_16x16x32_bf16 v[232:235], a[188:191], a[100:103], v[232:235]
v_mov_b32 v131, 0
v_mov_b32 v136, 0
v_mfma_f32_16x16x32_bf16 v[232:235], a[184:187], a[96:99], v[232:235]
ds_read_b128 a[76:79], v4 offset:11264
v_mov_b32 v137, 0
v_mfma_f32_16x16x32_bf16 v[236:239], a[112:115], a[96:99], v[236:239]
s_add_u32 m0, s73, 34816
s_add_u32 s64, s71, 18432
v_mov_b32 v138, 0
v_mfma_f32_16x16x32_bf16 v[236:239], a[116:119], a[100:103], v[236:239]
ds_read_b128 a[92:95], v10 offset:2048
v_mov_b32 v139, 0
v_mfma_f32_16x16x32_bf16 v[224:227], a[124:127], a[100:103], v[224:227]
buffer_load_dwordx4 v5, s[12:15], s64 offen lds
v_mfma_f32_16x16x32_bf16 v[224:227], a[120:123], a[96:99], v[224:227]
v_mov_b32 v144, 0
v_mov_b32 v145, 0
v_mfma_f32_16x16x32_bf16 v[208:211], a[120:123], a[104:107], v[208:211]
v_mov_b32 v146, 0
v_mov_b32 v147, 0
v_mfma_f32_16x16x32_bf16 v[208:211], a[124:127], a[108:111], v[208:211]
v_mov_b32 v152, 0
v_mov_b32 v153, 0
v_mfma_f32_16x16x32_bf16 v[216:219], a[116:119], a[108:111], v[216:219]
v_mov_b32 v154, 0
v_mov_b32 v155, 0
v_mfma_f32_16x16x32_bf16 v[216:219], a[112:115], a[104:107], v[216:219]
v_mfma_f32_16x16x32_bf16 v[244:247], a[184:187], a[104:107], v[244:247]
buffer_load_dwordx4 v6, s[12:15], s64 offen offset:1024 lds
v_mfma_f32_16x16x32_bf16 v[244:247], a[188:191], a[108:111], v[244:247]
v_mfma_f32_16x16x32_bf16 v[192:195], a[180:183], a[108:111], v[192:195]
v_mfma_f32_16x16x32_bf16 v[192:195], a[176:179], a[104:107], v[192:195]
v_mfma_f32_16x16x32_bf16 v[200:203], a[168:171], a[104:107], v[200:203]
v_mfma_f32_16x16x32_bf16 v[200:203], a[172:175], a[108:111], v[200:203]
v_mfma_f32_16x16x32_bf16 v[88:91], a[164:167], a[108:111], v[88:91]
v_mfma_f32_16x16x32_bf16 v[88:91], a[160:163], a[104:107], v[88:91]
s_waitcnt lgkmcnt(0)
v_mfma_f32_16x16x32_bf16 v[36:39], a[128:131], a[80:83], v[36:39]
s_waitcnt vmcnt(23)
v_mfma_f32_16x16x32_bf16 v[36:39], a[132:135], a[84:87], v[36:39]
s_barrier
v_mfma_f32_16x16x32_bf16 v[44:47], a[140:143], a[84:87], v[44:47]
s_add_u32 s53, s87, 524288
ds_read_b128 a[96:99], v9 offset:4096
v_mfma_f32_16x16x32_bf16 v[44:47], a[136:139], a[80:83], v[44:47]
s_xor_b32 s75, s93, 7
s_lshl_b32 s76, s75, 19
s_add_u32 s76, s76, s74
v_mfma_f32_16x16x32_bf16 v[32:35], a[144:147], a[80:83], v[32:35]
s_lshl_b32 s79, s75, 13
s_add_u32 s79, s79, s78
ds_read_b128 a[100:103], v10 offset:4096
v_mfma_f32_16x16x32_bf16 v[32:35], a[148:151], a[84:87], v[32:35]
s_add_u32 m0, s77, 0
s_add_u32 s64, s76, 0
ds_read_b128 a[104:107], v9 offset:6144
v_mfma_f32_16x16x32_bf16 v[52:55], a[156:159], a[84:87], v[52:55]
buffer_load_dwordx4 v7, s[20:23], s64 offen lds
v_mfma_f32_16x16x32_bf16 v[52:55], a[152:155], a[80:83], v[52:55]
ds_read_b64_tr_b16 a[160:161], v11 offset:16384
ds_read_b64_tr_b16 a[162:163], v11 offset:16896
v_mfma_f32_16x16x32_bf16 v[60:63], a[64:67], a[80:83], v[60:63]
buffer_store_dwordx4 a[20:23], v4, s[24:27], s53 offen offset:1024 sc1
v_mfma_f32_16x16x32_bf16 v[60:63], a[68:71], a[84:87], v[60:63]
ds_read_b128 a[108:111], v10 offset:6144
v_mfma_f32_16x16x32_bf16 v[68:71], a[76:79], a[84:87], v[68:71]
buffer_load_dwordx4 v8, s[20:23], s64 offen offset:1024 lds
v_mfma_f32_16x16x32_bf16 v[68:71], a[72:75], a[80:83], v[68:71]
ds_read_b64_tr_b16 a[164:165], v11 offset:20480
ds_read_b64_tr_b16 a[166:167], v11 offset:20992
v_mfma_f32_16x16x32_bf16 v[76:79], a[72:75], a[88:91], v[76:79]
v_add_u32 v9, -65536, v9
v_add_u32 v10, -65536, v10
v_mfma_f32_16x16x32_bf16 v[76:79], a[76:79], a[92:95], v[76:79]
ds_read_b64_tr_b16 a[168:169], v12 offset:16384
ds_read_b64_tr_b16 a[170:171], v12 offset:16896
v_mfma_f32_16x16x32_bf16 v[84:87], a[68:71], a[92:95], v[84:87]
s_add_u32 m0, s80, 0
s_add_u32 s64, s79, 0
v_mfma_f32_16x16x32_bf16 v[84:87], a[64:67], a[88:91], v[84:87]
ds_read_b64_tr_b16 a[172:173], v12 offset:20480
ds_read_b64_tr_b16 a[174:175], v12 offset:20992
v_mfma_f32_16x16x32_bf16 v[92:95], a[152:155], a[88:91], v[92:95]
buffer_load_dwordx4 v4, s[24:27], s64 offen sc1 lds
v_mfma_f32_16x16x32_bf16 v[92:95], a[156:159], a[92:95], v[92:95]
v_mfma_f32_16x16x32_bf16 v[40:43], a[148:151], a[92:95], v[40:43]
ds_read_b64_tr_b16 a[176:177], v13 offset:16384
ds_read_b64_tr_b16 a[178:179], v13 offset:16896
v_mfma_f32_16x16x32_bf16 v[40:43], a[144:147], a[88:91], v[40:43]
v_mfma_f32_16x16x32_bf16 v[100:103], a[136:139], a[88:91], v[100:103]
s_add_u32 m0, s73, 36864
s_add_u32 s64, s72, 0
v_mfma_f32_16x16x32_bf16 v[100:103], a[140:143], a[92:95], v[100:103]
ds_read_b64_tr_b16 a[180:181], v13 offset:20480
ds_read_b64_tr_b16 a[182:183], v13 offset:20992
v_mfma_f32_16x16x32_bf16 v[108:111], a[132:135], a[92:95], v[108:111]
buffer_load_dwordx4 v5, s[12:15], s64 offen lds
v_mfma_f32_16x16x32_bf16 v[108:111], a[128:131], a[88:91], v[108:111]
s_waitcnt lgkmcnt(14)
ds_read_b64_tr_b16 a[184:185], v14 offset:16384
ds_read_b64_tr_b16 a[186:187], v14 offset:16896
v_mfma_f32_16x16x32_bf16 v[116:119], a[128:131], a[96:99], v[116:119]
ds_read_b64_tr_b16 a[188:189], v14 offset:20480
ds_read_b64_tr_b16 a[190:191], v14 offset:20992
v_mfma_f32_16x16x32_bf16 v[116:119], a[132:135], a[100:103], v[116:119]
v_mfma_f32_16x16x32_bf16 v[124:127], a[140:143], a[100:103], v[124:127]
v_mfma_f32_16x16x32_bf16 v[124:127], a[136:139], a[96:99], v[124:127]
ds_read_b128 a[112:115], v4 offset:24576
v_mfma_f32_16x16x32_bf16 v[132:135], a[144:147], a[96:99], v[132:135]
buffer_load_dwordx4 v6, s[12:15], s64 offen offset:1024 lds
v_mfma_f32_16x16x32_bf16 v[132:135], a[148:151], a[100:103], v[132:135]
s_add_u32 s53, s87, 528384
ds_read_b128 a[116:119], v4 offset:26624
v_mfma_f32_16x16x32_bf16 v[140:143], a[156:159], a[100:103], v[140:143]
buffer_store_dwordx4 a[12:15], v4, s[24:27], s53 offen offset:0 sc1
v_mfma_f32_16x16x32_bf16 v[140:143], a[152:155], a[96:99], v[140:143]
ds_read_b128 a[120:123], v4 offset:25600
v_mfma_f32_16x16x32_bf16 v[148:151], a[64:67], a[96:99], v[148:151]
s_add_u32 m0, s73, 38912
s_add_u32 s64, s72, 18432
v_mfma_f32_16x16x32_bf16 v[148:151], a[68:71], a[100:103], v[148:151]
ds_read_b128 a[124:127], v4 offset:27648
v_mfma_f32_16x16x32_bf16 v[48:51], a[76:79], a[100:103], v[48:51]
buffer_load_dwordx4 v5, s[12:15], s64 offen lds
v_mfma_f32_16x16x32_bf16 v[48:51], a[72:75], a[96:99], v[48:51]
s_waitcnt lgkmcnt(15)
v_mfma_f32_16x16x32_bf16 v[156:159], a[72:75], a[104:107], v[156:159]
v_mfma_f32_16x16x32_bf16 v[156:159], a[76:79], a[108:111], v[156:159]
v_mfma_f32_16x16x32_bf16 v[164:167], a[68:71], a[108:111], v[164:167]
v_mfma_f32_16x16x32_bf16 v[164:167], a[64:67], a[104:107], v[164:167]
v_mfma_f32_16x16x32_bf16 v[172:175], a[152:155], a[104:107], v[172:175]
buffer_load_dwordx4 v6, s[12:15], s64 offen offset:1024 lds
v_mfma_f32_16x16x32_bf16 v[172:175], a[156:159], a[108:111], v[172:175]
v_mfma_f32_16x16x32_bf16 v[56:59], a[148:151], a[108:111], v[56:59]
v_mfma_f32_16x16x32_bf16 v[56:59], a[144:147], a[104:107], v[56:59]
v_mfma_f32_16x16x32_bf16 v[180:183], a[136:139], a[104:107], v[180:183]
v_mfma_f32_16x16x32_bf16 v[180:183], a[140:143], a[108:111], v[180:183]
v_mfma_f32_16x16x32_bf16 v[188:191], a[132:135], a[108:111], v[188:191]
v_mfma_f32_16x16x32_bf16 v[188:191], a[128:131], a[104:107], v[188:191]
s_waitcnt lgkmcnt(0)
v_mfma_f32_16x16x32_bf16 v[196:199], a[160:163], a[80:83], v[196:199]
s_waitcnt vmcnt(19)
v_mfma_f32_16x16x32_bf16 v[196:199], a[164:167], a[84:87], v[196:199]
s_barrier
v_mfma_f32_16x16x32_bf16 v[64:67], a[172:175], a[84:87], v[64:67]
ds_read_b64_tr_b16 a[128:129], v11 offset:32768
ds_read_b64_tr_b16 a[130:131], v11 offset:33280
v_mfma_f32_16x16x32_bf16 v[64:67], a[168:171], a[80:83], v[64:67]
s_add_u32 m0, s77, 16384
s_add_u32 s64, s76, 128
v_mfma_f32_16x16x32_bf16 v[204:207], a[176:179], a[80:83], v[204:207]
buffer_load_dwordx4 v7, s[20:23], s64 offen lds
v_mfma_f32_16x16x32_bf16 v[204:207], a[180:183], a[84:87], v[204:207]
ds_read_b64_tr_b16 a[132:133], v11 offset:36864
ds_read_b64_tr_b16 a[134:135], v11 offset:37376
v_mfma_f32_16x16x32_bf16 v[212:215], a[188:191], a[84:87], v[212:215]
ds_read_b64_tr_b16 a[136:137], v12 offset:32768
ds_read_b64_tr_b16 a[138:139], v12 offset:33280
v_mfma_f32_16x16x32_bf16 v[212:215], a[184:187], a[80:83], v[212:215]
s_add_u32 s53, s87, 528384
ds_read_b64_tr_b16 a[140:141], v12 offset:36864
ds_read_b64_tr_b16 a[142:143], v12 offset:37376
v_mfma_f32_16x16x32_bf16 v[72:75], a[112:115], a[80:83], v[72:75]
buffer_load_dwordx4 v8, s[20:23], s64 offen offset:1024 lds
v_mfma_f32_16x16x32_bf16 v[72:75], a[116:119], a[84:87], v[72:75]
ds_read_b64_tr_b16 a[144:145], v13 offset:32768
ds_read_b64_tr_b16 a[146:147], v13 offset:33280
v_mfma_f32_16x16x32_bf16 v[220:223], a[124:127], a[84:87], v[220:223]
buffer_store_dwordx4 a[4:7], v4, s[24:27], s53 offen offset:1024 sc1
v_mfma_f32_16x16x32_bf16 v[220:223], a[120:123], a[80:83], v[220:223]
s_add_u32 m0, s80, 16384
s_add_u32 s64, s79, 2048
v_mfma_f32_16x16x32_bf16 v[252:255], a[120:123], a[88:91], v[252:255]
ds_read_b64_tr_b16 a[148:149], v13 offset:36864
ds_read_b64_tr_b16 a[150:151], v13 offset:37376
v_mfma_f32_16x16x32_bf16 v[252:255], a[124:127], a[92:95], v[252:255]
buffer_load_dwordx4 v4, s[24:27], s64 offen sc1 lds
v_mfma_f32_16x16x32_bf16 v[160:163], a[116:119], a[92:95], v[160:163]
ds_read_b64_tr_b16 a[152:153], v14 offset:32768
ds_read_b64_tr_b16 a[154:155], v14 offset:33280
v_mfma_f32_16x16x32_bf16 v[160:163], a[112:115], a[88:91], v[160:163]
ds_read_b64_tr_b16 a[156:157], v14 offset:36864
ds_read_b64_tr_b16 a[158:159], v14 offset:37376
v_mfma_f32_16x16x32_bf16 v[228:231], a[184:187], a[88:91], v[228:231]
s_add_u32 m0, s83, 0
s_add_u32 s64, s81, 0
v_mfma_f32_16x16x32_bf16 v[228:231], a[188:191], a[92:95], v[228:231]
v_mfma_f32_16x16x32_bf16 v[168:171], a[180:183], a[92:95], v[168:171]
buffer_load_dwordx4 v22, s[32:35], s64 offen lds
v_mfma_f32_16x16x32_bf16 v[168:171], a[176:179], a[88:91], v[168:171]
ds_read_b128 a[64:67], v4 offset:40960
v_mfma_f32_16x16x32_bf16 v[176:179], a[168:171], a[88:91], v[176:179]
s_add_u32 m0, s83, 1024
s_add_u32 s64, s81, 9216
ds_read_b128 a[80:83], v9 offset:0
v_mfma_f32_16x16x32_bf16 v[176:179], a[172:175], a[92:95], v[176:179]
v_mfma_f32_16x16x32_bf16 v[80:83], a[164:167], a[92:95], v[80:83]
buffer_load_dwordx4 v22, s[32:35], s64 offen lds
v_mfma_f32_16x16x32_bf16 v[80:83], a[160:163], a[88:91], v[80:83]
ds_read_b128 a[68:71], v4 offset:43008
v_mfma_f32_16x16x32_bf16 v[184:187], a[160:163], a[96:99], v[184:187]
ds_read_b128 a[84:87], v10 offset:0
v_mfma_f32_16x16x32_bf16 v[184:187], a[164:167], a[100:103], v[184:187]
s_add_u32 m0, s83, 2048
s_add_u32 s64, s81, 18432
v_mfma_f32_16x16x32_bf16 v[248:251], a[172:175], a[100:103], v[248:251]
v_mfma_f32_16x16x32_bf16 v[248:251], a[168:171], a[96:99], v[248:251]
buffer_load_dwordx4 v22, s[32:35], s64 offen lds
v_mfma_f32_16x16x32_bf16 v[240:243], a[176:179], a[96:99], v[240:243]
ds_read_b128 a[72:75], v4 offset:41984
v_mfma_f32_16x16x32_bf16 v[240:243], a[180:183], a[100:103], v[240:243]
ds_read_b128 a[88:91], v9 offset:2048
v_mfma_f32_16x16x32_bf16 v[232:235], a[188:191], a[100:103], v[232:235]
s_add_u32 m0, s83, 3072
s_add_u32 s64, s81, 27648
v_mfma_f32_16x16x32_bf16 v[232:235], a[184:187], a[96:99], v[232:235]
ds_read_b128 a[76:79], v4 offset:44032
v_mfma_f32_16x16x32_bf16 v[236:239], a[112:115], a[96:99], v[236:239]
buffer_load_dwordx4 v22, s[32:35], s64 offen lds
v_mfma_f32_16x16x32_bf16 v[236:239], a[116:119], a[100:103], v[236:239]
ds_read_b128 a[92:95], v10 offset:2048
v_mfma_f32_16x16x32_bf16 v[224:227], a[124:127], a[100:103], v[224:227]
s_add_u32 m0, s83, 4096
s_add_u32 s64, s81, 128
s_add_u32 s53, s87, 786432
v_mfma_f32_16x16x32_bf16 v[224:227], a[120:123], a[96:99], v[224:227]
buffer_store_dwordx4 a[0:3], v4, s[24:27], s53 offen offset:0 sc1
v_mfma_f32_16x16x32_bf16 v[208:211], a[120:123], a[104:107], v[208:211]
buffer_load_dwordx4 v24, s[32:35], s64 offen lds
v_mfma_f32_16x16x32_bf16 v[208:211], a[124:127], a[108:111], v[208:211]
s_waitcnt vmcnt(26)
v_mfma_f32_16x16x32_bf16 v[216:219], a[116:119], a[108:111], v[216:219]
L_PAD7:
s_cbranch_execz L_PAD11
v_cmp_gt_u32 vcc, 8, v30
v_mfma_f32_16x16x32_bf16 v[216:219], a[112:115], a[104:107], v[216:219]
s_add_u32 m0, s83, 5120
s_add_u32 s64, s82, 0
v_mfma_f32_16x16x32_bf16 v[244:247], a[184:187], a[104:107], v[244:247]
v_mfma_f32_16x16x32_bf16 v[244:247], a[188:191], a[108:111], v[244:247]
buffer_load_dwordx4 v25, s[48:51], s64 offen lds
v_mfma_f32_16x16x32_bf16 v[192:195], a[180:183], a[108:111], v[192:195]
v_mfma_f32_16x16x32_bf16 v[192:195], a[176:179], a[104:107], v[192:195]
s_cbranch_vccnz CK_KV
CK_KV_R:
v_mfma_f32_16x16x32_bf16 v[200:203], a[168:171], a[104:107], v[200:203]
v_mfma_f32_16x16x32_bf16 v[200:203], a[172:175], a[108:111], v[200:203]
v_mfma_f32_16x16x32_bf16 v[88:91], a[164:167], a[108:111], v[88:91]
v_mfma_f32_16x16x32_bf16 v[88:91], a[160:163], a[104:107], v[88:91]
s_waitcnt lgkmcnt(0)
v_mfma_f32_16x16x32_bf16 v[36:39], a[128:131], a[80:83], v[36:39]
s_waitcnt vmcnt(25)
v_mov_b32 v6, 0xf149f2ca
v_mfma_f32_16x16x32_bf16 v[36:39], a[132:135], a[84:87], v[36:39]
s_barrier
v_mfma_f32_16x16x32_bf16 v[44:47], a[140:143], a[84:87], v[44:47]
ds_read_b128 a[96:99], v9 offset:4096
v_mfma_f32_16x16x32_bf16 v[44:47], a[136:139], a[80:83], v[44:47]
s_lshl_b32 s70, s3, 12
s_add_u32 s68, s70, s94
ds_read_b128 a[100:103], v10 offset:4096
v_mfma_f32_16x16x32_bf16 v[32:35], a[144:147], a[80:83], v[32:35]
s_add_u32 m0, s70, 32768
s_cmp_lt_u32 s3, 2
s_cselect_b32 s64, s68, 2147418112
v_mfma_f32_16x16x32_bf16 v[32:35], a[148:151], a[84:87], v[32:35]
buffer_load_dwordx4 v4, s[24:27], s64 offen offset:0 sc1 lds
v_mfma_f32_16x16x32_bf16 v[52:55], a[156:159], a[84:87], v[52:55]
ds_read_b128 a[104:107], v9 offset:6144
v_mfma_f32_16x16x32_bf16 v[52:55], a[152:155], a[80:83], v[52:55]
ds_read_b64_tr_b16 a[160:161], v11 offset:49152
ds_read_b64_tr_b16 a[162:163], v11 offset:49664
v_mfma_f32_16x16x32_bf16 v[60:63], a[64:67], a[80:83], v[60:63]
s_cmp_eq_u32 s66, 0
s_cbranch_scc1 D0
D0_R:
v_mfma_f32_16x16x32_bf16 v[60:63], a[68:71], a[84:87], v[60:63]
s_lshl_b32 s52, s4, 18
s_add_u32 s52, s52, 45088768
ds_read_b128 a[108:111], v10 offset:6144
v_mfma_f32_16x16x32_bf16 v[68:71], a[76:79], a[84:87], v[68:71]
s_lshl_b32 s54, s66, 9
v_add_u32 v9, 32768, v9
v_add_u32 v10, 32768, v10
v_mfma_f32_16x16x32_bf16 v[68:71], a[72:75], a[80:83], v[68:71]
s_add_u32 s54, s54, s52
ds_read_b64_tr_b16 a[164:165], v11 offset:53248
ds_read_b64_tr_b16 a[166:167], v11 offset:53760
v_mfma_f32_16x16x32_bf16 v[76:79], a[72:75], a[88:91], v[76:79]
s_lshl_b32 s55, s67, 9
s_add_u32 s55, s55, s52
v_mfma_f32_16x16x32_bf16 v[76:79], a[76:79], a[92:95], v[76:79]
s_add_u32 s53, s87, 786432
ds_read_b64_tr_b16 a[168:169], v12 offset:49152
ds_read_b64_tr_b16 a[170:171], v12 offset:49664
v_mfma_f32_16x16x32_bf16 v[84:87], a[68:71], a[92:95], v[84:87]
buffer_load_dwordx4 v4, s[24:27], s64 offen offset:1024 sc1 lds
v_mfma_f32_16x16x32_bf16 v[84:87], a[64:67], a[88:91], v[84:87]
ds_read_b64_tr_b16 a[172:173], v12 offset:53248
ds_read_b64_tr_b16 a[174:175], v12 offset:53760
v_mfma_f32_16x16x32_bf16 v[92:95], a[152:155], a[88:91], v[92:95]
buffer_store_dwordx4 a[8:11], v4, s[24:27], s53 offen offset:1024 sc1
v_mfma_f32_16x16x32_bf16 v[92:95], a[156:159], a[92:95], v[92:95]
v_mfma_f32_16x16x32_bf16 v[40:43], a[148:151], a[92:95], v[40:43]
ds_read_b64_tr_b16 a[176:177], v13 offset:49152
ds_read_b64_tr_b16 a[178:179], v13 offset:49664
v_mfma_f32_16x16x32_bf16 v[40:43], a[144:147], a[88:91], v[40:43]
v_mfma_f32_16x16x32_bf16 v[100:103], a[136:139], a[88:91], v[100:103]
ds_read_b64_tr_b16 a[180:181], v13 offset:53248
ds_read_b64_tr_b16 a[182:183], v13 offset:53760
v_mfma_f32_16x16x32_bf16 v[100:103], a[140:143], a[92:95], v[100:103]
v_mfma_f32_16x16x32_bf16 v[108:111], a[132:135], a[92:95], v[108:111]
ds_read_b64_tr_b16 a[184:185], v14 offset:49152
ds_read_b64_tr_b16 a[186:187], v14 offset:49664
v_mfma_f32_16x16x32_bf16 v[108:111], a[128:131], a[88:91], v[108:111]
s_waitcnt lgkmcnt(15)
v_mfma_f32_16x16x32_bf16 v[116:119], a[128:131], a[96:99], v[116:119]
ds_read_b64_tr_b16 a[188:189], v14 offset:53248
ds_read_b64_tr_b16 a[190:191], v14 offset:53760
v_mfma_f32_16x16x32_bf16 v[116:119], a[132:135], a[100:103], v[116:119]
buffer_load_dwordx4 v4, s[24:27], s64 offen offset:2048 sc1 lds
v_mfma_f32_16x16x32_bf16 v[124:127], a[140:143], a[100:103], v[124:127]
v_mfma_f32_16x16x32_bf16 v[124:127], a[136:139], a[96:99], v[124:127]
ds_read_b128 a[112:115], v4 offset:57344
v_mfma_f32_16x16x32_bf16 v[132:135], a[144:147], a[96:99], v[132:135]
v_mfma_f32_16x16x32_bf16 v[132:135], a[148:151], a[100:103], v[132:135]
ds_read_b128 a[116:119], v4 offset:59392
v_mfma_f32_16x16x32_bf16 v[140:143], a[156:159], a[100:103], v[140:143]
v_mfma_f32_16x16x32_bf16 v[140:143], a[152:155], a[96:99], v[140:143]
ds_read_b128 a[120:123], v4 offset:58368
v_mfma_f32_16x16x32_bf16 v[148:151], a[64:67], a[96:99], v[148:151]
v_mfma_f32_16x16x32_bf16 v[148:151], a[68:71], a[100:103], v[148:151]
ds_read_b128 a[124:127], v4 offset:60416
v_mfma_f32_16x16x32_bf16 v[48:51], a[76:79], a[100:103], v[48:51]
s_waitcnt lgkmcnt(15)
v_mfma_f32_16x16x32_bf16 v[48:51], a[72:75], a[96:99], v[48:51]
buffer_load_dwordx4 v4, s[24:27], s64 offen offset:3072 sc1 lds
v_mfma_f32_16x16x32_bf16 v[156:159], a[72:75], a[104:107], v[156:159]
v_mfma_f32_16x16x32_bf16 v[156:159], a[76:79], a[108:111], v[156:159]
v_mfma_f32_16x16x32_bf16 v[164:167], a[68:71], a[108:111], v[164:167]
v_mfma_f32_16x16x32_bf16 v[164:167], a[64:67], a[104:107], v[164:167]
v_mfma_f32_16x16x32_bf16 v[172:175], a[152:155], a[104:107], v[172:175]
s_add_u32 s53, s87, 790528
v_mfma_f32_16x16x32_bf16 v[172:175], a[156:159], a[108:111], v[172:175]
buffer_store_dwordx4 a[16:19], v4, s[24:27], s53 offen offset:0 sc1
v_mfma_f32_16x16x32_bf16 v[56:59], a[148:151], a[108:111], v[56:59]
v_mfma_f32_16x16x32_bf16 v[56:59], a[144:147], a[104:107], v[56:59]
v_mfma_f32_16x16x32_bf16 v[180:183], a[136:139], a[104:107], v[180:183]
v_mfma_f32_16x16x32_bf16 v[180:183], a[140:143], a[108:111], v[180:183]
v_mfma_f32_16x16x32_bf16 v[188:191], a[132:135], a[108:111], v[188:191]
v_mfma_f32_16x16x32_bf16 v[188:191], a[128:131], a[104:107], v[188:191]
s_waitcnt lgkmcnt(0)
v_mfma_f32_16x16x32_bf16 v[196:199], a[160:163], a[80:83], v[196:199]
s_waitcnt vmcnt(17)
v_mfma_f32_16x16x32_bf16 v[196:199], a[164:167], a[84:87], v[196:199]
s_barrier
v_mfma_f32_16x16x32_bf16 v[64:67], a[172:175], a[84:87], v[64:67]
ds_read_b64_tr_b16 a[128:129], v11 offset:0
ds_read_b64_tr_b16 a[130:131], v11 offset:512
v_mfma_f32_16x16x32_bf16 v[64:67], a[168:171], a[80:83], v[64:67]
s_add_u32 m0, s70, 49152
s_add_u32 s64, s68, 16384
s_waitcnt vmcnt(6)
v_mfma_f32_16x16x32_bf16 v[204:207], a[176:179], a[80:83], v[204:207]
buffer_load_dwordx4 v4, s[24:27], s64 offen offset:0 sc1 lds
v_mfma_f32_16x16x32_bf16 v[204:207], a[180:183], a[84:87], v[204:207]
ds_read_b64_tr_b16 a[132:133], v11 offset:4096
ds_read_b64_tr_b16 a[134:135], v11 offset:4608
v_mfma_f32_16x16x32_bf16 v[212:215], a[188:191], a[84:87], v[212:215]
ds_read_b64_tr_b16 a[136:137], v12 offset:0
ds_read_b64_tr_b16 a[138:139], v12 offset:512
v_mfma_f32_16x16x32_bf16 v[212:215], a[184:187], a[80:83], v[212:215]
ds_read_b64_tr_b16 a[140:141], v12 offset:4096
ds_read_b64_tr_b16 a[142:143], v12 offset:4608
v_mfma_f32_16x16x32_bf16 v[72:75], a[112:115], a[80:83], v[72:75]
ds_read_b64_tr_b16 a[192:193], v23 offset:0
ds_read_b64_tr_b16 a[194:195], v23 offset:2048
v_mfma_f32_16x16x32_bf16 v[72:75], a[116:119], a[84:87], v[72:75]
ds_read_b64_tr_b16 a[144:145], v13 offset:0
ds_read_b64_tr_b16 a[146:147], v13 offset:512
v_mfma_f32_16x16x32_bf16 v[220:223], a[124:127], a[84:87], v[220:223]
ds_read_b64_tr_b16 a[196:197], v23 offset:32
ds_read_b64_tr_b16 a[198:199], v23 offset:2080
v_mfma_f32_16x16x32_bf16 v[220:223], a[120:123], a[80:83], v[220:223]
ds_read_b64_tr_b16 a[148:149], v13 offset:4096
ds_read_b64_tr_b16 a[150:151], v13 offset:4608
v_mfma_f32_16x16x32_bf16 v[252:255], a[120:123], a[88:91], v[252:255]
ds_read_b64_tr_b16 a[200:201], v23 offset:64
ds_read_b64_tr_b16 a[202:203], v23 offset:2112
v_mfma_f32_16x16x32_bf16 v[252:255], a[124:127], a[92:95], v[252:255]
ds_read_b64_tr_b16 a[152:153], v14 offset:0
ds_read_b64_tr_b16 a[154:155], v14 offset:512
v_mfma_f32_16x16x32_bf16 v[160:163], a[116:119], a[92:95], v[160:163]
buffer_load_dwordx4 v4, s[24:27], s64 offen offset:1024 sc1 lds
v_mfma_f32_16x16x32_bf16 v[160:163], a[112:115], a[88:91], v[160:163]
ds_read_b64_tr_b16 a[156:157], v14 offset:4096
ds_read_b64_tr_b16 a[158:159], v14 offset:4608
v_mfma_f32_16x16x32_bf16 v[228:231], a[184:187], a[88:91], v[228:231]
ds_read_b64_tr_b16 a[204:205], v23 offset:96
ds_read_b64_tr_b16 a[206:207], v23 offset:2144
v_mfma_f32_16x16x32_bf16 v[228:231], a[188:191], a[92:95], v[228:231]
ds_read_b64_tr_b16 a[208:209], v27 offset:4096
ds_read_b64_tr_b16 a[210:211], v27 offset:4608
v_mfma_f32_16x16x32_bf16 v[168:171], a[180:183], a[92:95], v[168:171]
ds_read_b128 a[64:67], v4 offset:8192
v_mfma_f32_16x16x32_bf16 v[168:171], a[176:179], a[88:91], v[168:171]
s_add_u32 s53, s87, 790528
ds_read_b64_tr_b16 a[212:213], v27 offset:5120
ds_read_b64_tr_b16 a[214:215], v27 offset:5632
v_mfma_f32_16x16x32_bf16 v[176:179], a[168:171], a[88:91], v[176:179]
ds_read_b128 a[80:83], v9 offset:0
v_readlane_b32 s81, v26, 0
v_mfma_f32_16x16x32_bf16 v[176:179], a[172:175], a[92:95], v[176:179]
buffer_store_dwordx4 a[24:27], v4, s[24:27], s53 offen offset:1024 sc1
v_mfma_f32_16x16x32_bf16 v[80:83], a[164:167], a[92:95], v[80:83]
ds_read_b128 a[68:71], v4 offset:10240
v_readlane_b32 s82, v26, 1
v_mfma_f32_16x16x32_bf16 v[80:83], a[160:163], a[88:91], v[80:83]
v_readlane_b32 s71, v26, 2
v_readlane_b32 s72, v26, 3
v_mfma_f32_16x16x32_bf16 v[184:187], a[160:163], a[96:99], v[184:187]
ds_read_b128 a[84:87], v10 offset:0
v_readlane_b32 s74, v26, 4
v_mfma_f32_16x16x32_bf16 v[184:187], a[164:167], a[100:103], v[184:187]
buffer_load_dwordx4 v4, s[24:27], s64 offen offset:2048 sc1 lds
v_mfma_f32_16x16x32_bf16 v[248:251], a[172:175], a[100:103], v[248:251]
v_readlane_b32 s75, v26, 5
v_mfma_f32_16x16x32_bf16 v[248:251], a[168:171], a[96:99], v[248:251]
ds_read_b128 a[72:75], v4 offset:9216
v_mfma_f32_16x16x32_bf16 v[240:243], a[176:179], a[96:99], v[240:243]
v_mfma_f32_16x16x32_bf16 v[240:243], a[180:183], a[100:103], v[240:243]
ds_read_b128 a[88:91], v9 offset:2048
v_mfma_f32_16x16x32_bf16 v[232:235], a[188:191], a[100:103], v[232:235]
v_mfma_f32_16x16x32_bf16 v[232:235], a[184:187], a[96:99], v[232:235]
ds_read_b128 a[76:79], v4 offset:11264
v_mfma_f32_16x16x32_bf16 v[236:239], a[112:115], a[96:99], v[236:239]
v_mfma_f32_16x16x32_bf16 v[236:239], a[116:119], a[100:103], v[236:239]
ds_read_b128 a[92:95], v10 offset:2048
v_mfma_f32_16x16x32_bf16 v[224:227], a[124:127], a[100:103], v[224:227]
v_mfma_f32_16x16x32_bf16 v[224:227], a[120:123], a[96:99], v[224:227]
buffer_load_dwordx4 v4, s[24:27], s64 offen offset:3072 sc1 lds
v_mfma_f32_16x16x32_bf16 v[208:211], a[120:123], a[104:107], v[208:211]
v_mfma_f32_16x16x32_bf16 v[208:211], a[124:127], a[108:111], v[208:211]
v_mfma_f32_16x16x32_bf16 v[216:219], a[116:119], a[108:111], v[216:219]
v_mfma_f32_16x16x32_bf16 v[216:219], a[112:115], a[104:107], v[216:219]
v_mfma_f32_16x16x32_bf16 v[244:247], a[184:187], a[104:107], v[244:247]
v_mfma_f32_16x16x32_bf16 v[244:247], a[188:191], a[108:111], v[244:247]
v_mfma_f32_16x16x32_bf16 v[192:195], a[180:183], a[108:111], v[192:195]
v_mfma_f32_16x16x32_bf16 v[192:195], a[176:179], a[104:107], v[192:195]
v_mfma_f32_16x16x32_bf16 v[200:203], a[168:171], a[104:107], v[200:203]
v_mfma_f32_16x16x32_bf16 v[200:203], a[172:175], a[108:111], v[200:203]
v_mfma_f32_16x16x32_bf16 v[88:91], a[164:167], a[108:111], v[88:91]
v_mfma_f32_16x16x32_bf16 v[88:91], a[160:163], a[104:107], v[88:91]
s_waitcnt lgkmcnt(0)
v_mfma_f32_16x16x32_bf16 v[36:39], a[128:131], a[80:83], v[36:39]
s_waitcnt vmcnt(18)
v_mfma_f32_16x16x32_bf16 v[36:39], a[132:135], a[84:87], v[36:39]
s_barrier
v_mfma_f32_16x16x32_bf16 v[44:47], a[140:143], a[84:87], v[44:47]
ds_read_b128 a[96:99], v9 offset:4096
v_mfma_f32_16x16x32_bf16 v[44:47], a[136:139], a[80:83], v[44:47]
s_add_u32 m0, s70, 65536
s_add_u32 s64, s68, 32768
ds_read_b128 a[100:103], v10 offset:4096
v_mfma_f32_16x16x32_bf16 v[32:35], a[144:147], a[80:83], v[32:35]
buffer_load_dwordx4 v4, s[24:27], s64 offen offset:0 sc1 lds
v_mfma_f32_16x16x32_bf16 v[32:35], a[148:151], a[84:87], v[32:35]
ds_read_b128 a[104:107], v9 offset:6144
v_mfma_f32_16x16x32_bf16 v[52:55], a[156:159], a[84:87], v[52:55]
ds_read_b64_tr_b16 a[160:161], v11 offset:16384
ds_read_b64_tr_b16 a[162:163], v11 offset:16896
v_mfma_f32_16x16x32_bf16 v[52:55], a[152:155], a[80:83], v[52:55]
buffer_store_dwordx4 a[192:195], v4, s[24:27], s81 offen sc1
v_mfma_f32_16x16x32_bf16 v[60:63], a[64:67], a[80:83], v[60:63]
v_mfma_f32_16x16x32_bf16 v[60:63], a[68:71], a[84:87], v[60:63]
ds_read_b128 a[108:111], v10 offset:6144
v_mfma_f32_16x16x32_bf16 v[68:71], a[76:79], a[84:87], v[68:71]
v_cvt_pk_bf16_f32 v36, v36, v37
v_cvt_pk_bf16_f32 v37, v38, v39
v_mfma_f32_16x16x32_bf16 v[68:71], a[72:75], a[80:83], v[68:71]
ds_read_b64_tr_b16 a[164:165], v11 offset:20480
ds_read_b64_tr_b16 a[166:167], v11 offset:20992
v_mfma_f32_16x16x32_bf16 v[76:79], a[72:75], a[88:91], v[76:79]
buffer_store_dwordx4 a[196:199], v4, s[24:27], s82 offen sc1
v_mfma_f32_16x16x32_bf16 v[76:79], a[76:79], a[92:95], v[76:79]
ds_read_b64_tr_b16 a[168:169], v12 offset:16384
ds_read_b64_tr_b16 a[170:171], v12 offset:16896
v_mfma_f32_16x16x32_bf16 v[84:87], a[68:71], a[92:95], v[84:87]
buffer_load_dwordx4 v4, s[24:27], s64 offen offset:1024 sc1 lds
v_mfma_f32_16x16x32_bf16 v[84:87], a[64:67], a[88:91], v[84:87]
ds_read_b64_tr_b16 a[172:173], v12 offset:20480
ds_read_b64_tr_b16 a[174:175], v12 offset:20992
v_mfma_f32_16x16x32_bf16 v[92:95], a[152:155], a[88:91], v[92:95]
v_cvt_pk_bf16_f32 v38, v44, v45
v_cvt_pk_bf16_f32 v39, v46, v47
v_mfma_f32_16x16x32_bf16 v[92:95], a[156:159], a[92:95], v[92:95]
buffer_store_dwordx4 a[200:203], v4, s[24:27], s71 offen sc1
v_mfma_f32_16x16x32_bf16 v[40:43], a[148:151], a[92:95], v[40:43]
ds_read_b64_tr_b16 a[176:177], v13 offset:16384
ds_read_b64_tr_b16 a[178:179], v13 offset:16896
v_mfma_f32_16x16x32_bf16 v[40:43], a[144:147], a[88:91], v[40:43]
v_cvt_pk_bf16_f32 v32, v32, v33
v_cvt_pk_bf16_f32 v33, v34, v35
v_mfma_f32_16x16x32_bf16 v[100:103], a[136:139], a[88:91], v[100:103]
ds_read_b64_tr_b16 a[180:181], v13 offset:20480
ds_read_b64_tr_b16 a[182:183], v13 offset:20992
v_mfma_f32_16x16x32_bf16 v[100:103], a[140:143], a[92:95], v[100:103]
v_cvt_pk_bf16_f32 v34, v52, v53
v_cvt_pk_bf16_f32 v35, v54, v55
v_mfma_f32_16x16x32_bf16 v[108:111], a[132:135], a[92:95], v[108:111]
ds_read_b64_tr_b16 a[184:185], v14 offset:16384
ds_read_b64_tr_b16 a[186:187], v14 offset:16896
v_mfma_f32_16x16x32_bf16 v[108:111], a[128:131], a[88:91], v[108:111]
s_waitcnt lgkmcnt(15)
v_mfma_f32_16x16x32_bf16 v[116:119], a[128:131], a[96:99], v[116:119]
ds_read_b64_tr_b16 a[188:189], v14 offset:20480
ds_read_b64_tr_b16 a[190:191], v14 offset:20992
v_mfma_f32_16x16x32_bf16 v[116:119], a[132:135], a[100:103], v[116:119]
buffer_load_dwordx4 v4, s[24:27], s64 offen offset:2048 sc1 lds
v_mfma_f32_16x16x32_bf16 v[124:127], a[140:143], a[100:103], v[124:127]
buffer_store_dwordx4 a[204:207], v4, s[24:27], s72 offen sc1
v_mfma_f32_16x16x32_bf16 v[124:127], a[136:139], a[96:99], v[124:127]
ds_read_b128 a[112:115], v4 offset:24576
v_cvt_pk_bf16_f32 v40, v40, v41
v_mfma_f32_16x16x32_bf16 v[132:135], a[144:147], a[96:99], v[132:135]
v_cvt_pk_bf16_f32 v41, v42, v43
v_cvt_pk_bf16_f32 v42, v92, v93
v_mfma_f32_16x16x32_bf16 v[132:135], a[148:151], a[100:103], v[132:135]
ds_read_b128 a[116:119], v4 offset:26624
v_cvt_pk_bf16_f32 v43, v94, v95
v_mfma_f32_16x16x32_bf16 v[140:143], a[156:159], a[100:103], v[140:143]
v_cvt_pk_bf16_f32 v108, v108, v109
v_cvt_pk_bf16_f32 v109, v110, v111
v_mfma_f32_16x16x32_bf16 v[140:143], a[152:155], a[96:99], v[140:143]
ds_read_b128 a[120:123], v4 offset:25600
v_cvt_pk_bf16_f32 v110, v100, v101
v_mfma_f32_16x16x32_bf16 v[148:151], a[64:67], a[96:99], v[148:151]
buffer_store_dwordx4 a[208:211], v4, s[24:27], s74 offen sc1
v_mfma_f32_16x16x32_bf16 v[148:151], a[68:71], a[100:103], v[148:151]
ds_read_b128 a[124:127], v4 offset:27648
v_cvt_pk_bf16_f32 v111, v102, v103
v_mfma_f32_16x16x32_bf16 v[48:51], a[76:79], a[100:103], v[48:51]
s_waitcnt lgkmcnt(15)
v_cvt_pk_bf16_f32 v116, v116, v117
v_cvt_pk_bf16_f32 v117, v118, v119
v_mfma_f32_16x16x32_bf16 v[48:51], a[72:75], a[96:99], v[48:51]
buffer_load_dwordx4 v4, s[24:27], s64 offen offset:3072 sc1 lds
v_mfma_f32_16x16x32_bf16 v[156:159], a[72:75], a[104:107], v[156:159]
v_cvt_pk_bf16_f32 v118, v124, v125
v_cvt_pk_bf16_f32 v119, v126, v127
v_mfma_f32_16x16x32_bf16 v[156:159], a[76:79], a[108:111], v[156:159]
buffer_store_dwordx4 a[212:215], v4, s[24:27], s75 offen sc1
v_mfma_f32_16x16x32_bf16 v[164:167], a[68:71], a[108:111], v[164:167]
v_cvt_pk_bf16_f32 v132, v132, v133
v_cvt_pk_bf16_f32 v133, v134, v135
v_mfma_f32_16x16x32_bf16 v[164:167], a[64:67], a[104:107], v[164:167]
v_cvt_pk_bf16_f32 v134, v140, v141
v_cvt_pk_bf16_f32 v135, v142, v143
v_mfma_f32_16x16x32_bf16 v[172:175], a[152:155], a[104:107], v[172:175]
v_mfma_f32_16x16x32_bf16 v[172:175], a[156:159], a[108:111], v[172:175]
v_mfma_f32_16x16x32_bf16 v[56:59], a[148:151], a[108:111], v[56:59]
v_mfma_f32_16x16x32_bf16 v[56:59], a[144:147], a[104:107], v[56:59]
v_mfma_f32_16x16x32_bf16 v[180:183], a[136:139], a[104:107], v[180:183]
v_mfma_f32_16x16x32_bf16 v[180:183], a[140:143], a[108:111], v[180:183]
v_mfma_f32_16x16x32_bf16 v[188:191], a[132:135], a[108:111], v[188:191]
v_mfma_f32_16x16x32_bf16 v[188:191], a[128:131], a[104:107], v[188:191]
s_waitcnt lgkmcnt(0)
v_mfma_f32_16x16x32_bf16 v[196:199], a[160:163], a[80:83], v[196:199]
s_waitcnt vmcnt(16)
v_mfma_f32_16x16x32_bf16 v[196:199], a[164:167], a[84:87], v[196:199]
s_barrier
v_mfma_f32_16x16x32_bf16 v[64:67], a[172:175], a[84:87], v[64:67]
v_cvt_pk_bf16_f32 v56, v56, v57
v_cvt_pk_bf16_f32 v57, v58, v59
v_mfma_f32_16x16x32_bf16 v[64:67], a[168:171], a[80:83], v[64:67]
s_add_u32 m0, s70, 81920
s_add_u32 s64, s68, 49152
v_cvt_pk_bf16_f32 v58, v172, v173
v_mfma_f32_16x16x32_bf16 v[204:207], a[176:179], a[80:83], v[204:207]
buffer_load_dwordx4 v4, s[24:27], s64 offen offset:0 sc1 lds
v_mfma_f32_16x16x32_bf16 v[204:207], a[180:183], a[84:87], v[204:207]
ds_read_b128 a[192:195], v4 offset:32768
v_cvt_pk_bf16_f32 v59, v174, v175
v_mfma_f32_16x16x32_bf16 v[212:215], a[188:191], a[84:87], v[212:215]
v_cvt_pk_bf16_f32 v188, v188, v189
v_cvt_pk_bf16_f32 v189, v190, v191
v_mfma_f32_16x16x32_bf16 v[212:215], a[184:187], a[80:83], v[212:215]
v_cvt_pk_bf16_f32 v190, v180, v181
v_cvt_pk_bf16_f32 v191, v182, v183
v_mfma_f32_16x16x32_bf16 v[80:83], a[160:163], a[88:91], v[80:83]
ds_read_b128 a[196:199], v4 offset:33792
ds_read_b128 a[200:203], v4 offset:34816
v_mfma_f32_16x16x32_bf16 v[80:83], a[164:167], a[92:95], v[80:83]
ds_read_b128 a[204:207], v4 offset:35840
ds_read_b128 a[208:211], v4 offset:36864
v_mfma_f32_16x16x32_bf16 v[176:179], a[172:175], a[92:95], v[176:179]
v_cvt_pk_bf16_f32 v196, v196, v197
v_cvt_pk_bf16_f32 v197, v198, v199
v_mfma_f32_16x16x32_bf16 v[176:179], a[168:171], a[88:91], v[176:179]
v_cvt_pk_bf16_f32 v198, v64, v65
v_cvt_pk_bf16_f32 v199, v66, v67
v_mfma_f32_16x16x32_bf16 v[168:171], a[176:179], a[88:91], v[168:171]
ds_read_b128 a[212:215], v4 offset:37888
ds_read_b128 a[216:219], v4 offset:38912
v_mfma_f32_16x16x32_bf16 v[168:171], a[180:183], a[92:95], v[168:171]
ds_read_b128 a[220:223], v4 offset:39936
ds_bpermute_b32 v8, v17, v63
v_mfma_f32_16x16x32_bf16 v[228:231], a[188:191], a[92:95], v[228:231]
buffer_load_dwordx4 v4, s[24:27], s64 offen offset:1024 sc1 lds
v_mfma_f32_16x16x32_bf16 v[228:231], a[184:187], a[88:91], v[228:231]
v_cvt_pk_bf16_f32 v204, v204, v205
v_cvt_pk_bf16_f32 v205, v206, v207
v_mfma_f32_16x16x32_bf16 v[184:187], a[160:163], a[96:99], v[184:187]
v_cvt_pk_bf16_f32 v206, v212, v213
v_cvt_pk_bf16_f32 v207, v214, v215
v_mfma_f32_16x16x32_bf16 v[184:187], a[164:167], a[100:103], v[184:187]
v_cvt_pk_bf16_f32 v60, v60, v61
v_cvt_pk_bf16_f32 v61, v62, v63
v_mfma_f32_16x16x32_bf16 v[248:251], a[172:175], a[100:103], v[248:251]
v_cvt_pk_bf16_f32 v80, v80, v81
v_cvt_pk_bf16_f32 v81, v82, v83
v_mfma_f32_16x16x32_bf16 v[248:251], a[168:171], a[96:99], v[248:251]
v_cvt_pk_bf16_f32 v82, v176, v177
v_cvt_pk_bf16_f32 v83, v178, v179
v_mfma_f32_16x16x32_bf16 v[240:243], a[176:179], a[96:99], v[240:243]
v_cvt_pk_bf16_f32 v62, v68, v69
v_cvt_pk_bf16_f32 v63, v70, v71
v_mfma_f32_16x16x32_bf16 v[240:243], a[180:183], a[100:103], v[240:243]
buffer_store_dwordx4 v[60:63], v18, s[24:27], s54 offen offset:0 sc1
v_mfma_f32_16x16x32_bf16 v[232:235], a[188:191], a[100:103], v[232:235]
v_cvt_pk_bf16_f32 v168, v168, v169
v_cvt_pk_bf16_f32 v169, v170, v171
v_mfma_f32_16x16x32_bf16 v[232:235], a[184:187], a[96:99], v[232:235]
v_cvt_pk_bf16_f32 v170, v228, v229
v_cvt_pk_bf16_f32 v171, v230, v231
v_mfma_f32_16x16x32_bf16 v[88:91], a[160:163], a[104:107], v[88:91]
ds_bpermute_b32 v9, v17, v87
v_cvt_pk_bf16_f32 v84, v84, v85
v_mfma_f32_16x16x32_bf16 v[88:91], a[164:167], a[108:111], v[88:91]
buffer_load_dwordx4 v4, s[24:27], s64 offen offset:2048 sc1 lds
v_mfma_f32_16x16x32_bf16 v[200:203], a[172:175], a[108:111], v[200:203]
v_cvt_pk_bf16_f32 v184, v184, v185
v_cvt_pk_bf16_f32 v185, v186, v187
v_mfma_f32_16x16x32_bf16 v[200:203], a[168:171], a[104:107], v[200:203]
v_cvt_pk_bf16_f32 v186, v248, v249
v_cvt_pk_bf16_f32 v187, v250, v251
v_mfma_f32_16x16x32_bf16 v[192:195], a[176:179], a[104:107], v[192:195]
v_cvt_pk_bf16_f32 v85, v86, v87
v_cvt_pk_bf16_f32 v86, v76, v77
v_mfma_f32_16x16x32_bf16 v[192:195], a[180:183], a[108:111], v[192:195]
v_cvt_pk_bf16_f32 v87, v78, v79
v_mfma_f32_16x16x32_bf16 v[244:247], a[188:191], a[108:111], v[244:247]
v_cvt_pk_bf16_f32 v240, v240, v241
v_cvt_pk_bf16_f32 v241, v242, v243
v_mfma_f32_16x16x32_bf16 v[244:247], a[184:187], a[104:107], v[244:247]
v_cvt_pk_bf16_f32 v242, v232, v233
v_cvt_pk_bf16_f32 v243, v234, v235
v_mfma_f32_16x16x32_bf16 v[72:75], a[112:115], a[80:83], v[72:75]
buffer_store_dwordx4 v[84:87], v18, s[24:27], s54 offen offset:256 sc1
v_mfma_f32_16x16x32_bf16 v[72:75], a[116:119], a[84:87], v[72:75]
ds_bpermute_b32 v10, v17, v151
v_cvt_pk_bf16_f32 v148, v148, v149
v_mfma_f32_16x16x32_bf16 v[220:223], a[124:127], a[84:87], v[220:223]
v_cvt_pk_bf16_f32 v88, v88, v89
v_cvt_pk_bf16_f32 v89, v90, v91
v_mfma_f32_16x16x32_bf16 v[220:223], a[120:123], a[80:83], v[220:223]
buffer_load_dwordx4 v4, s[24:27], s64 offen offset:3072 sc1 lds
v_mfma_f32_16x16x32_bf16 v[160:163], a[112:115], a[88:91], v[160:163]
v_cvt_pk_bf16_f32 v90, v200, v201
v_cvt_pk_bf16_f32 v91, v202, v203
v_mfma_f32_16x16x32_bf16 v[160:163], a[116:119], a[92:95], v[160:163]
v_cvt_pk_bf16_f32 v149, v150, v151
v_cvt_pk_bf16_f32 v150, v48, v49
v_mfma_f32_16x16x32_bf16 v[252:255], a[124:127], a[92:95], v[252:255]
v_cvt_pk_bf16_f32 v192, v192, v193
v_cvt_pk_bf16_f32 v193, v194, v195
v_mfma_f32_16x16x32_bf16 v[252:255], a[120:123], a[88:91], v[252:255]
v_cvt_pk_bf16_f32 v194, v244, v245
v_cvt_pk_bf16_f32 v195, v246, v247
v_mfma_f32_16x16x32_bf16 v[236:239], a[112:115], a[96:99], v[236:239]
v_cvt_pk_bf16_f32 v151, v50, v51
v_mfma_f32_16x16x32_bf16 v[236:239], a[116:119], a[100:103], v[236:239]
buffer_store_dwordx4 v[148:151], v18, s[24:27], s55 offen offset:0 sc1
v_mfma_f32_16x16x32_bf16 v[224:227], a[124:127], a[100:103], v[224:227]
ds_bpermute_b32 v11, v17, v167
v_cvt_pk_bf16_f32 v164, v164, v165
v_mfma_f32_16x16x32_bf16 v[224:227], a[120:123], a[96:99], v[224:227]
v_cvt_pk_bf16_f32 v165, v166, v167
v_cvt_pk_bf16_f32 v166, v156, v157
v_mfma_f32_16x16x32_bf16 v[216:219], a[112:115], a[104:107], v[216:219]
v_cvt_pk_bf16_f32 v167, v158, v159
v_mfma_f32_16x16x32_bf16 v[216:219], a[116:119], a[108:111], v[216:219]
buffer_store_dwordx4 v[164:167], v18, s[24:27], s55 offen offset:256 sc1
v_mfma_f32_16x16x32_bf16 v[208:211], a[124:127], a[108:111], v[208:211]
v_cvt_pk_bf16_f32 v72, v72, v73
v_cvt_pk_bf16_f32 v73, v74, v75
v_mfma_f32_16x16x32_bf16 v[208:211], a[120:123], a[104:107], v[208:211]
s_waitcnt lgkmcnt(0)
v_cvt_pk_bf16_f32 v74, v220, v221
v_cvt_pk_bf16_f32 v75, v222, v223
v_mfma_f32_16x16x32_bf16 v[44:47], a[192:195], v[36:39], v[96:99]
buffer_store_dwordx4 v[72:75], v19, s[24:27], s54 offen offset:0 sc1
v_mfma_f32_16x16x32_bf16 v[44:47], a[196:199], v[32:35], v[44:47]
v_cvt_pk_bf16_f32 v160, v160, v161
v_cvt_pk_bf16_f32 v161, v162, v163
v_mfma_f32_16x16x32_bf16 v[44:47], a[200:203], v[196:199], v[44:47]
v_cvt_pk_bf16_f32 v162, v252, v253
v_cvt_pk_bf16_f32 v163, v254, v255
v_mfma_f32_16x16x32_bf16 v[44:47], a[204:207], v[204:207], v[44:47]
buffer_store_dwordx4 v[160:163], v19, s[24:27], s54 offen offset:256 sc1
v_mfma_f32_16x16x32_bf16 v[52:55], a[192:195], v[108:111], v[104:107]
v_cvt_pk_bf16_f32 v236, v236, v237
v_cvt_pk_bf16_f32 v237, v238, v239
v_mfma_f32_16x16x32_bf16 v[52:55], a[196:199], v[40:43], v[52:55]
v_cvt_pk_bf16_f32 v238, v224, v225
v_cvt_pk_bf16_f32 v239, v226, v227
v_mfma_f32_16x16x32_bf16 v[52:55], a[200:203], v[80:83], v[52:55]
buffer_store_dwordx4 v[236:239], v19, s[24:27], s55 offen offset:0 sc1
v_mfma_f32_16x16x32_bf16 v[52:55], a[204:207], v[168:171], v[52:55]
v_cvt_pk_bf16_f32 v216, v216, v217
v_cvt_pk_bf16_f32 v217, v218, v219
v_mfma_f32_16x16x32_bf16 v[64:67], a[208:211], v[36:39], v[112:115]
v_cvt_pk_bf16_f32 v218, v208, v209
v_cvt_pk_bf16_f32 v219, v210, v211
v_mfma_f32_16x16x32_bf16 v[64:67], a[212:215], v[32:35], v[64:67]
buffer_store_dwordx4 v[216:219], v19, s[24:27], s55 offen offset:256 sc1
v_mfma_f32_16x16x32_bf16 v[64:67], a[216:219], v[196:199], v[64:67]
v_mfma_f32_16x16x32_bf16 v[64:67], a[220:223], v[204:207], v[64:67]
v_mfma_f32_16x16x32_bf16 v[212:215], a[208:211], v[108:111], v[120:123]
v_mfma_f32_16x16x32_bf16 v[212:215], a[212:215], v[40:43], v[212:215]
v_mfma_f32_16x16x32_bf16 v[212:215], a[216:219], v[80:83], v[212:215]
v_mfma_f32_16x16x32_bf16 v[212:215], a[220:223], v[168:171], v[212:215]
s_waitcnt vmcnt(22)
v_mfma_f32_16x16x32_bf16 v[100:103], a[192:195], v[116:119], v[128:131]
s_barrier
v_mfma_f32_16x16x32_bf16 v[100:103], a[196:199], v[132:135], v[100:103]
v_mfma_f32_16x16x32_bf16 v[100:103], a[200:203], v[184:187], v[100:103]
v_mfma_f32_16x16x32_bf16 v[100:103], a[204:207], v[240:243], v[100:103]
v_mfma_f32_16x16x32_bf16 v[92:95], a[192:195], v[188:191], v[136:139]
v_mfma_f32_16x16x32_bf16 v[92:95], a[196:199], v[56:59], v[92:95]
v_mfma_f32_16x16x32_bf16 v[92:95], a[200:203], v[88:91], v[92:95]
v_mfma_f32_16x16x32_bf16 v[92:95], a[204:207], v[192:195], v[92:95]
v_mfma_f32_16x16x32_bf16 v[176:179], a[208:211], v[116:119], v[144:147]
v_mfma_f32_16x16x32_bf16 v[176:179], a[212:215], v[132:135], v[176:179]
v_mfma_f32_16x16x32_bf16 v[176:179], a[216:219], v[184:187], v[176:179]
v_mfma_f32_16x16x32_bf16 v[176:179], a[220:223], v[240:243], v[176:179]
v_mfma_f32_16x16x32_bf16 v[228:231], a[208:211], v[188:191], v[152:155]
v_mfma_f32_16x16x32_bf16 v[228:231], a[212:215], v[56:59], v[228:231]
v_mfma_f32_16x16x32_bf16 v[228:231], a[216:219], v[88:91], v[228:231]
v_mfma_f32_16x16x32_bf16 v[228:231], a[220:223], v[192:195], v[228:231]
ds_read_b128 a[64:67], v4 offset:57344
ds_read_b128 a[68:71], v4 offset:58368
ds_read_b128 a[72:75], v4 offset:59392
ds_read_b128 a[76:79], v4 offset:60416
ds_read_b128 a[80:83], v4 offset:61440
ds_read_b128 a[84:87], v4 offset:62464
ds_read_b128 a[88:91], v4 offset:63488
ds_read_b128 a[92:95], v4 offset:64512
s_add_u32 m0, s70, 98304
s_add_u32 s64, s68, 65536
buffer_load_dwordx4 v4, s[24:27], s64 offen offset:0 sc1 lds
v_max3_f32 v24, v44, v45, v46
v_max3_f32 v25, v47, v64, v65
v_max3_f32 v26, v52, v53, v54
v_max3_f32 v27, v55, v212, v213
v_max3_f32 v24, v24, v66, v67
L_PAD8:
s_cbranch_execz L_PAD12
v_max_f32 v24, v24, v25
buffer_load_dwordx4 v4, s[24:27], s64 offen offset:1024 sc1 lds
v_max3_f32 v26, v26, v214, v215
v_max_f32 v26, v26, v27
v_mov_b32 v25, v24
v_mov_b32 v27, v26
s_nop 1
v_permlane32_swap_b32 v25, v24
buffer_load_dwordx4 v4, s[24:27], s64 offen offset:2048 sc1 lds
v_permlane32_swap_b32 v27, v26
s_nop 0
v_max_f32 v24, v24, v25
v_max_f32 v26, v26, v27
v_mov_b32 v25, v24
v_mov_b32 v27, v26
buffer_load_dwordx4 v4, s[24:27], s64 offen offset:3072 sc1 lds
s_nop 1
v_permlane16_swap_b32 v25, v24
v_permlane16_swap_b32 v27, v26
s_nop 0
v_max_f32 v24, v24, v25
v_max_f32 v26, v26, v27
s_add_u32 m0, s70, 114688
s_add_u32 s64, s68, 81920
buffer_load_dwordx4 v4, s[24:27], s64 offen offset:0 sc1 lds
v_pk_add_f32 v[44:45], v[44:45], v[24:25] op_sel_hi:[1,0] neg_lo:[0,1] neg_hi:[0,1]
v_pk_add_f32 v[46:47], v[46:47], v[24:25] op_sel_hi:[1,0] neg_lo:[0,1] neg_hi:[0,1]
v_pk_add_f32 v[52:53], v[52:53], v[26:27] op_sel_hi:[1,0] neg_lo:[0,1] neg_hi:[0,1]
v_pk_add_f32 v[54:55], v[54:55], v[26:27] op_sel_hi:[1,0] neg_lo:[0,1] neg_hi:[0,1]
v_pk_add_f32 v[64:65], v[64:65], v[24:25] op_sel_hi:[1,0] neg_lo:[0,1] neg_hi:[0,1]
v_pk_add_f32 v[66:67], v[66:67], v[24:25] op_sel_hi:[1,0] neg_lo:[0,1] neg_hi:[0,1]
buffer_load_dwordx4 v4, s[24:27], s64 offen offset:1024 sc1 lds
v_pk_add_f32 v[212:213], v[212:213], v[26:27] op_sel_hi:[1,0] neg_lo:[0,1] neg_hi:[0,1]
v_pk_add_f32 v[214:215], v[214:215], v[26:27] op_sel_hi:[1,0] neg_lo:[0,1] neg_hi:[0,1]
v_pk_add_f32 v[96:97], v[96:97], v[24:25] op_sel_hi:[1,0] neg_lo:[0,1] neg_hi:[0,1]
v_pk_add_f32 v[98:99], v[98:99], v[24:25] op_sel_hi:[1,0] neg_lo:[0,1] neg_hi:[0,1]
v_pk_add_f32 v[104:105], v[104:105], v[26:27] op_sel_hi:[1,0] neg_lo:[0,1] neg_hi:[0,1]
v_pk_add_f32 v[106:107], v[106:107], v[26:27] op_sel_hi:[1,0] neg_lo:[0,1] neg_hi:[0,1]
buffer_load_dwordx4 v4, s[24:27], s64 offen offset:2048 sc1 lds
v_pk_add_f32 v[112:113], v[112:113], v[24:25] op_sel_hi:[1,0] neg_lo:[0,1] neg_hi:[0,1]
v_pk_add_f32 v[114:115], v[114:115], v[24:25] op_sel_hi:[1,0] neg_lo:[0,1] neg_hi:[0,1]
v_pk_add_f32 v[120:121], v[120:121], v[26:27] op_sel_hi:[1,0] neg_lo:[0,1] neg_hi:[0,1]
v_pk_add_f32 v[122:123], v[122:123], v[26:27] op_sel_hi:[1,0] neg_lo:[0,1] neg_hi:[0,1]
v_exp_f32 v44, v44
v_exp_f32 v45, v45
buffer_load_dwordx4 v4, s[24:27], s64 offen offset:3072 sc1 lds
v_exp_f32 v46, v46
v_exp_f32 v47, v47
v_cvt_pk_bf16_f32 v124, v44, v45
v_exp_f32 v52, v52
v_exp_f32 v53, v53
v_cvt_pk_bf16_f32 v125, v46, v47
s_add_u32 m0, s70, 131072
s_add_u32 s64, s68, 98304
s_cmp_ge_u32 s3, 1
s_cselect_b32 s64, s64, 2147418112
buffer_load_dwordx4 v4, s[24:27], s64 offen offset:0 sc1 lds
v_exp_f32 v54, v54
v_exp_f32 v55, v55
v_cvt_pk_bf16_f32 v140, v52, v53
v_exp_f32 v64, v64
v_exp_f32 v65, v65
v_cvt_pk_bf16_f32 v141, v54, v55
buffer_load_dwordx4 v4, s[24:27], s64 offen offset:1024 sc1 lds
v_exp_f32 v66, v66
v_exp_f32 v67, v67
v_cvt_pk_bf16_f32 v126, v64, v65
v_exp_f32 v212, v212
v_exp_f32 v213, v213
v_cvt_pk_bf16_f32 v127, v66, v67
buffer_load_dwordx4 v4, s[24:27], s64 offen offset:2048 sc1 lds
v_exp_f32 v214, v214
v_exp_f32 v215, v215
v_cvt_pk_bf16_f32 v142, v212, v213
v_max3_f32 v24, v100, v101, v102
v_cvt_pk_bf16_f32 v143, v214, v215
v_max3_f32 v25, v103, v176, v177
buffer_load_dwordx4 v4, s[24:27], s64 offen offset:3072 sc1 lds
v_max3_f32 v26, v92, v93, v94
v_max3_f32 v27, v95, v228, v229
v_max3_f32 v24, v24, v178, v179
v_max_f32 v24, v24, v25
v_max3_f32 v26, v26, v230, v231
v_max_f32 v26, v26, v27
s_add_u32 m0, s70, 147456
s_add_u32 s64, s68, 114688
s_cmp_ge_u32 s3, 2
s_cselect_b32 s64, s64, 2147418112
buffer_load_dwordx4 v4, s[24:27], s64 offen offset:0 sc1 lds
v_mov_b32 v25, v24
v_mov_b32 v27, v26
s_nop 1
v_permlane32_swap_b32 v25, v24
v_permlane32_swap_b32 v27, v26
s_nop 0
buffer_load_dwordx4 v4, s[24:27], s64 offen offset:1024 sc1 lds
v_max_f32 v24, v24, v25
v_max_f32 v26, v26, v27
v_mov_b32 v25, v24
v_mov_b32 v27, v26
s_nop 1
v_permlane16_swap_b32 v25, v24
buffer_load_dwordx4 v4, s[24:27], s64 offen offset:2048 sc1 lds
v_permlane16_swap_b32 v27, v26
s_nop 0
v_max_f32 v24, v24, v25
v_max_f32 v26, v26, v27
v_pk_add_f32 v[100:101], v[100:101], v[24:25] op_sel_hi:[1,0] neg_lo:[0,1] neg_hi:[0,1]
v_pk_add_f32 v[102:103], v[102:103], v[24:25] op_sel_hi:[1,0] neg_lo:[0,1] neg_hi:[0,1]
buffer_load_dwordx4 v4, s[24:27], s64 offen offset:3072 sc1 lds
v_pk_add_f32 v[92:93], v[92:93], v[26:27] op_sel_hi:[1,0] neg_lo:[0,1] neg_hi:[0,1]
v_pk_add_f32 v[94:95], v[94:95], v[26:27] op_sel_hi:[1,0] neg_lo:[0,1] neg_hi:[0,1]
v_pk_add_f32 v[176:177], v[176:177], v[24:25] op_sel_hi:[1,0] neg_lo:[0,1] neg_hi:[0,1]
v_pk_add_f32 v[178:179], v[178:179], v[24:25] op_sel_hi:[1,0] neg_lo:[0,1] neg_hi:[0,1]
v_pk_add_f32 v[228:229], v[228:229], v[26:27] op_sel_hi:[1,0] neg_lo:[0,1] neg_hi:[0,1]
v_pk_add_f32 v[230:231], v[230:231], v[26:27] op_sel_hi:[1,0] neg_lo:[0,1] neg_hi:[0,1]
s_add_u32 m0, s70, 0
s_add_u32 s64, s68, 131072
s_cmp_ge_u32 s3, 3
s_cselect_b32 s64, s64, 2147418112
buffer_load_dwordx4 v4, s[24:27], s64 offen offset:0 sc1 lds
v_pk_add_f32 v[128:129], v[128:129], v[24:25] op_sel_hi:[1,0] neg_lo:[0,1] neg_hi:[0,1]
v_pk_add_f32 v[130:131], v[130:131], v[24:25] op_sel_hi:[1,0] neg_lo:[0,1] neg_hi:[0,1]
v_pk_add_f32 v[136:137], v[136:137], v[26:27] op_sel_hi:[1,0] neg_lo:[0,1] neg_hi:[0,1]
v_pk_add_f32 v[138:139], v[138:139], v[26:27] op_sel_hi:[1,0] neg_lo:[0,1] neg_hi:[0,1]
v_pk_add_f32 v[144:145], v[144:145], v[24:25] op_sel_hi:[1,0] neg_lo:[0,1] neg_hi:[0,1]
v_pk_add_f32 v[146:147], v[146:147], v[24:25] op_sel_hi:[1,0] neg_lo:[0,1] neg_hi:[0,1]
buffer_load_dwordx4 v4, s[24:27], s64 offen offset:1024 sc1 lds
v_pk_add_f32 v[152:153], v[152:153], v[26:27] op_sel_hi:[1,0] neg_lo:[0,1] neg_hi:[0,1]
v_pk_add_f32 v[154:155], v[154:155], v[26:27] op_sel_hi:[1,0] neg_lo:[0,1] neg_hi:[0,1]
v_mov_b64 v[60:61], 0
v_mov_b64 v[62:63], 0
v_mov_b64 v[68:69], 0
v_mov_b64 v[70:71], 0
buffer_load_dwordx4 v4, s[24:27], s64 offen offset:2048 sc1 lds
v_mov_b64 v[72:73], 0
v_mov_b64 v[74:75], 0
v_mov_b64 v[220:221], 0
v_mov_b64 v[222:223], 0
v_mov_b64 v[84:85], 0
v_mov_b64 v[86:87], 0
buffer_load_dwordx4 v4, s[24:27], s64 offen offset:3072 sc1 lds
v_mov_b64 v[76:77], 0
v_mov_b64 v[78:79], 0
v_mov_b64 v[160:161], 0
v_mov_b64 v[162:163], 0
v_mov_b64 v[252:253], 0
v_mov_b64 v[254:255], 0
v_mov_b64 v[148:149], 0
v_mov_b64 v[150:151], 0
v_mov_b64 v[48:49], 0
v_mov_b64 v[50:51], 0
v_mov_b64 v[236:237], 0
v_mov_b64 v[238:239], 0
v_mov_b64 v[224:225], 0
v_mov_b64 v[226:227], 0
v_mov_b64 v[164:165], 0
v_mov_b64 v[166:167], 0
v_mov_b64 v[156:157], 0
v_mov_b64 v[158:159], 0
v_mov_b64 v[216:217], 0
v_mov_b64 v[218:219], 0
v_mov_b64 v[208:209], 0
v_mov_b64 v[210:211], 0
ds_read_b128 a[192:195], v4 offset:49152
ds_read_b128 a[196:199], v4 offset:50176
ds_read_b128 a[200:203], v4 offset:51200
ds_read_b128 a[204:207], v4 offset:52224
ds_read_b128 a[208:211], v4 offset:53248
ds_read_b128 a[212:215], v4 offset:54272
ds_read_b128 a[216:219], v4 offset:55296
ds_read_b128 a[220:223], v4 offset:56320
s_waitcnt lgkmcnt(8)
s_lshl2_add_u32 s77, s86, s84
s_mul_i32 s77, s77, 344064
s_mov_b32 s80, s70
s_cmp_lt_u32 s3, 2
s_cselect_b32 s53, 8, -2
s_add_u32 s53, s53, s3
v_mfma_f32_16x16x32_bf16 a[0:3], a[64:67], v[124:127], 0
s_mul_i32 s52, s5, 65536
v_exp_f32 v100, v100
v_mfma_f32_16x16x32_bf16 a[32:35], a[64:67], v[140:143], 0
s_sub_u32 s52, 1064960, s52
v_exp_f32 v101, v101
v_mfma_f32_16x16x32_bf16 a[36:39], a[68:71], v[140:143], 0
s_add_u32 s71, s68, s52
v_exp_f32 v102, v102
v_mfma_f32_16x16x32_bf16 a[4:7], a[68:71], v[124:127], 0
s_add_u32 s77, s77, s80
v_exp_f32 v103, v103
v_mfma_f32_16x16x32_bf16 a[8:11], a[72:75], v[124:127], 0
s_add_u32 s77, s77, 38797312
v_cvt_pk_bf16_f32 v248, v100, v101
v_cvt_pk_bf16_f32 v249, v102, v103
v_mfma_f32_16x16x32_bf16 a[40:43], a[72:75], v[140:143], 0
s_add_u32 s52, s3, 6
v_exp_f32 v92, v92
v_mfma_f32_16x16x32_bf16 a[44:47], a[76:79], v[140:143], 0
s_mul_i32 s52, s52, 16384
v_exp_f32 v93, v93
v_mfma_f32_16x16x32_bf16 a[12:15], a[76:79], v[124:127], 0
s_add_u32 s68, s68, s52
v_exp_f32 v94, v94
v_mfma_f32_16x16x32_bf16 a[16:19], a[80:83], v[124:127], 0
s_lshl_b32 s53, s53, 14
v_exp_f32 v95, v95
v_mfma_f32_16x16x32_bf16 a[48:51], a[80:83], v[140:143], 0
s_add_u32 s70, s70, s53
v_cvt_pk_bf16_f32 v232, v92, v93
v_cvt_pk_bf16_f32 v233, v94, v95
v_mfma_f32_16x16x32_bf16 a[52:55], a[84:87], v[140:143], 0
s_mov_b32 s75, 65536
v_exp_f32 v176, v176
v_mfma_f32_16x16x32_bf16 a[20:23], a[84:87], v[124:127], 0
s_mov_b32 s72, 1
v_exp_f32 v177, v177
v_mfma_f32_16x16x32_bf16 a[24:27], a[88:91], v[124:127], 0
s_mov_b32 s73, 3
v_exp_f32 v178, v178
v_mfma_f32_16x16x32_bf16 a[56:59], a[88:91], v[140:143], 0
s_lshl2_add_u32 s69, s5, 4
v_exp_f32 v179, v179
v_mfma_f32_16x16x32_bf16 a[60:63], a[92:95], v[140:143], 0
s_max_u32 s69, s69, 12
v_cvt_pk_bf16_f32 v250, v176, v177
v_cvt_pk_bf16_f32 v251, v178, v179
v_mfma_f32_16x16x32_bf16 a[28:31], a[92:95], v[124:127], 0
s_min_u32 s74, s73, s66
v_exp_f32 v228, v228
v_mfma_f32_16x16x32_bf16 a[224:227], a[240:243], v[124:127], 0
s_mov_b32 s93, 3
v_mfma_f32_16x16x32_bf16 a[228:231], a[240:243], v[140:143], 0
s_cmp_lt_u32 s66, 2
s_waitcnt vmcnt(26) lgkmcnt(0)
s_cbranch_scc1 L_NE
L_DUAL:
v_mfma_f32_16x16x32_bf16 v[44:47], a[192:195], v[36:39], v[96:99]
s_barrier
v_mfma_f32_16x16x32_bf16 v[44:47], a[196:199], v[32:35], v[44:47]
s_cmp_eq_u32 s68, s71
v_exp_f32 v229, v229
v_mfma_f32_16x16x32_bf16 v[44:47], a[200:203], v[196:199], v[44:47]
s_cselect_b32 s64, s77, s68
v_add_u32 v5, s75, v4
v_cvt_pk_bf16_f32 v234, v228, v229
v_mfma_f32_16x16x32_bf16 v[44:47], a[204:207], v[204:207], v[44:47]
s_mov_b32 m0, s70
v_exp_f32 v230, v230
v_mfma_f32_16x16x32_bf16 v[52:55], a[192:195], v[108:111], v[104:107]
buffer_load_dwordx4 v4, s[24:27], s64 offen offset:0 sc1 lds
v_mfma_f32_16x16x32_bf16 v[52:55], a[196:199], v[40:43], v[52:55]
s_add_u32 s75, s75, 16384
v_exp_f32 v231, v231
v_mfma_f32_16x16x32_bf16 v[52:55], a[200:203], v[80:83], v[52:55]
v_cvt_pk_bf16_f32 v235, v230, v231
v_mfma_f32_16x16x32_bf16 v[52:55], a[204:207], v[168:171], v[52:55]
s_cmp_ge_u32 s75, 163840
v_exp_f32 v44, v44
v_mfma_f32_16x16x32_bf16 v[64:67], a[208:211], v[36:39], v[112:115]
v_mfma_f32_16x16x32_bf16 v[64:67], a[212:215], v[32:35], v[64:67]
s_cselect_b32 s75, 0, s75
v_exp_f32 v45, v45
v_mfma_f32_16x16x32_bf16 v[64:67], a[216:219], v[196:199], v[64:67]
v_cvt_pk_bf16_f32 v124, v44, v45
v_mfma_f32_16x16x32_bf16 v[64:67], a[220:223], v[204:207], v[64:67]
s_add_u32 s68, s64, 16384
v_exp_f32 v46, v46
v_mfma_f32_16x16x32_bf16 v[212:215], a[208:211], v[108:111], v[120:123]
buffer_load_dwordx4 v4, s[24:27], s64 offen offset:1024 sc1 lds
v_mfma_f32_16x16x32_bf16 v[212:215], a[212:215], v[40:43], v[212:215]
s_add_u32 s70, s70, 16384
v_exp_f32 v47, v47
v_mfma_f32_16x16x32_bf16 v[212:215], a[216:219], v[80:83], v[212:215]
v_cvt_pk_bf16_f32 v125, v46, v47
v_mfma_f32_16x16x32_bf16 v[212:215], a[220:223], v[168:171], v[212:215]
v_exp_f32 v52, v52
v_mfma_f32_16x16x32_bf16 v[60:63], a[64:67], v[248:251], v[60:63]
v_mfma_f32_16x16x32_bf16 v[148:151], a[64:67], v[232:235], v[148:151]
s_cmp_ge_u32 s70, 163840
v_exp_f32 v53, v53
v_mfma_f32_16x16x32_bf16 v[48:51], a[68:71], v[232:235], v[48:51]
ds_read_b128 a[64:67], v5 offset:8192
v_cvt_pk_bf16_f32 v140, v52, v53
v_mfma_f32_16x16x32_bf16 v[68:71], a[68:71], v[248:251], v[68:71]
s_cselect_b32 s70, s80, s70
v_exp_f32 v54, v54
v_mfma_f32_16x16x32_bf16 v[72:75], a[72:75], v[248:251], v[72:75]
buffer_load_dwordx4 v4, s[24:27], s64 offen offset:2048 sc1 lds
v_mfma_f32_16x16x32_bf16 v[236:239], a[72:75], v[232:235], v[236:239]
v_exp_f32 v55, v55
v_mfma_f32_16x16x32_bf16 v[224:227], a[76:79], v[232:235], v[224:227]
ds_read_b128 a[68:71], v5 offset:9216
v_cvt_pk_bf16_f32 v141, v54, v55
v_mfma_f32_16x16x32_bf16 v[220:223], a[76:79], v[248:251], v[220:223]
v_exp_f32 v64, v64
v_mfma_f32_16x16x32_bf16 v[84:87], a[80:83], v[248:251], v[84:87]
ds_read_b128 a[72:75], v5 offset:10240
v_mfma_f32_16x16x32_bf16 v[164:167], a[80:83], v[232:235], v[164:167]
v_exp_f32 v65, v65
v_mfma_f32_16x16x32_bf16 v[156:159], a[84:87], v[232:235], v[156:159]
ds_read_b128 a[76:79], v5 offset:11264
v_cvt_pk_bf16_f32 v126, v64, v65
v_mfma_f32_16x16x32_bf16 v[76:79], a[84:87], v[248:251], v[76:79]
v_exp_f32 v66, v66
v_mfma_f32_16x16x32_bf16 v[160:163], a[88:91], v[248:251], v[160:163]
buffer_load_dwordx4 v4, s[24:27], s64 offen offset:3072 sc1 lds
v_mfma_f32_16x16x32_bf16 v[216:219], a[88:91], v[232:235], v[216:219]
v_exp_f32 v67, v67
v_mfma_f32_16x16x32_bf16 v[208:211], a[92:95], v[232:235], v[208:211]
ds_read_b128 a[80:83], v5 offset:12288
v_cvt_pk_bf16_f32 v127, v66, v67
v_mfma_f32_16x16x32_bf16 v[252:255], a[92:95], v[248:251], v[252:255]
v_exp_f32 v212, v212
v_mfma_f32_16x16x32_bf16 a[232:235], a[240:243], v[248:251], a[232:235]
ds_read_b128 a[84:87], v5 offset:13312
v_mfma_f32_16x16x32_bf16 a[236:239], a[240:243], v[232:235], a[236:239]
ds_read_b128 a[88:91], v5 offset:14336
v_mfma_f32_16x16x32_bf16 v[100:103], a[192:195], v[116:119], v[128:131]
ds_read_b128 a[92:95], v5 offset:15360
v_mfma_f32_16x16x32_bf16 v[100:103], a[196:199], v[132:135], v[100:103]
v_exp_f32 v213, v213
v_mfma_f32_16x16x32_bf16 v[100:103], a[200:203], v[184:187], v[100:103]
v_cvt_pk_bf16_f32 v142, v212, v213
v_mfma_f32_16x16x32_bf16 v[100:103], a[204:207], v[240:243], v[100:103]
v_exp_f32 v214, v214
v_mfma_f32_16x16x32_bf16 v[92:95], a[192:195], v[188:191], v[136:139]
s_nop 0
v_mfma_f32_16x16x32_bf16 v[92:95], a[196:199], v[56:59], v[92:95]
v_exp_f32 v215, v215
v_mfma_f32_16x16x32_bf16 v[92:95], a[200:203], v[88:91], v[92:95]
ds_read_b128 a[192:195], v5 offset:0
v_cvt_pk_bf16_f32 v143, v214, v215
v_mfma_f32_16x16x32_bf16 v[92:95], a[204:207], v[192:195], v[92:95]
v_exp_f32 v100, v100
v_mfma_f32_16x16x32_bf16 v[176:179], a[208:211], v[116:119], v[144:147]
ds_read_b128 a[196:199], v5 offset:1024
v_mfma_f32_16x16x32_bf16 v[176:179], a[212:215], v[132:135], v[176:179]
v_exp_f32 v101, v101
v_mfma_f32_16x16x32_bf16 v[176:179], a[216:219], v[184:187], v[176:179]
ds_read_b128 a[200:203], v5 offset:2048
v_cvt_pk_bf16_f32 v248, v100, v101
v_mfma_f32_16x16x32_bf16 v[176:179], a[220:223], v[240:243], v[176:179]
v_exp_f32 v102, v102
v_mfma_f32_16x16x32_bf16 v[228:231], a[208:211], v[188:191], v[152:155]
ds_read_b128 a[204:207], v5 offset:3072
v_mfma_f32_16x16x32_bf16 v[228:231], a[212:215], v[56:59], v[228:231]
v_exp_f32 v103, v103
v_mfma_f32_16x16x32_bf16 v[228:231], a[216:219], v[88:91], v[228:231]
ds_read_b128 a[208:211], v5 offset:4096
v_cvt_pk_bf16_f32 v249, v102, v103
v_mfma_f32_16x16x32_bf16 v[228:231], a[220:223], v[192:195], v[228:231]
s_waitcnt lgkmcnt(5)
v_exp_f32 v92, v92
v_mfma_f32_16x16x32_bf16 a[0:3], a[64:67], v[124:127], a[0:3]
ds_read_b128 a[212:215], v5 offset:5120
v_mfma_f32_16x16x32_bf16 a[32:35], a[64:67], v[140:143], a[32:35]
v_exp_f32 v93, v93
v_mfma_f32_16x16x32_bf16 a[36:39], a[68:71], v[140:143], a[36:39]
ds_read_b128 a[216:219], v5 offset:6144
v_cvt_pk_bf16_f32 v232, v92, v93
v_mfma_f32_16x16x32_bf16 a[4:7], a[68:71], v[124:127], a[4:7]
v_exp_f32 v94, v94
v_mfma_f32_16x16x32_bf16 a[8:11], a[72:75], v[124:127], a[8:11]
ds_read_b128 a[220:223], v5 offset:7168
v_mfma_f32_16x16x32_bf16 a[40:43], a[72:75], v[140:143], a[40:43]
s_add_u32 s72, s72, 1
v_exp_f32 v95, v95
v_mfma_f32_16x16x32_bf16 a[44:47], a[76:79], v[140:143], a[44:47]
v_cvt_pk_bf16_f32 v233, v94, v95
v_mfma_f32_16x16x32_bf16 a[12:15], a[76:79], v[124:127], a[12:15]
v_exp_f32 v176, v176
v_mfma_f32_16x16x32_bf16 a[16:19], a[80:83], v[124:127], a[16:19]
v_mfma_f32_16x16x32_bf16 a[48:51], a[80:83], v[140:143], a[48:51]
v_exp_f32 v177, v177
v_mfma_f32_16x16x32_bf16 a[52:55], a[84:87], v[140:143], a[52:55]
v_cvt_pk_bf16_f32 v250, v176, v177
v_mfma_f32_16x16x32_bf16 a[20:23], a[84:87], v[124:127], a[20:23]
v_exp_f32 v178, v178
v_mfma_f32_16x16x32_bf16 a[24:27], a[88:91], v[124:127], a[24:27]
v_mfma_f32_16x16x32_bf16 a[56:59], a[88:91], v[140:143], a[56:59]
s_cmp_lt_u32 s72, s74
v_exp_f32 v179, v179
v_mfma_f32_16x16x32_bf16 a[60:63], a[92:95], v[140:143], a[60:63]
v_cvt_pk_bf16_f32 v251, v178, v179
v_mfma_f32_16x16x32_bf16 a[28:31], a[92:95], v[124:127], a[28:31]
s_waitcnt vmcnt(8) lgkmcnt(0)
v_exp_f32 v228, v228
v_mfma_f32_16x16x32_bf16 a[224:227], a[240:243], v[124:127], a[224:227]
v_mfma_f32_16x16x32_bf16 a[228:231], a[240:243], v[140:143], a[228:231]
s_cbranch_scc1 L_DUAL
L_DISP:
s_cmp_eq_u32 s72, s93
s_cbranch_scc1 L_STOP
L_NE:
s_mov_b32 s74, s93
s_cmp_gt_u32 s72, s66
s_cbranch_scc1 L_SINGLE
v_cndmask_b32 v96, v96, v6, s[56:57]
v_cndmask_b32 v120, v120, v6, s[56:57]
v_mov_b32 v112, v6
v_cndmask_b32 v97, v97, v6, s[58:59]
v_cndmask_b32 v121, v121, v6, s[58:59]
v_mov_b32 v113, v6
v_cndmask_b32 v98, v98, v6, s[60:61]
v_cndmask_b32 v122, v122, v6, s[60:61]
v_mov_b32 v114, v6
v_cndmask_b32 v99, v99, v6, s[62:63]
v_cndmask_b32 v123, v123, v6, s[62:63]
v_mov_b32 v115, v6
s_mov_b32 s74, 0
s_branch L_DUAL
L_STOP:
s_cmp_eq_u32 s72, 3
s_cbranch_scc1 L_E0
s_cmp_eq_u32 s72, 9
s_cbranch_scc1 L_E1
s_cmp_lg_u32 s72, 11
s_cbranch_scc1 L_SE
v_cmp_gt_u32 vcc, 32, v172
s_mov_b32 s73, 32
s_min_u32 s93, s73, s69
s_min_u32 s74, s93, s66
s_nop 1
s_cbranch_vccnz CK_Q
CK_Q_R:
s_add_u32 s53, s77, 163840
buffer_load_dwordx4 a[96:99], v4, s[24:27], s53 offen offset:0 sc1
buffer_load_dwordx4 a[100:103], v4, s[24:27], s53 offen offset:1024 sc1
buffer_load_dwordx4 a[104:107], v4, s[24:27], s53 offen offset:2048 sc1
buffer_load_dwordx4 a[108:111], v4, s[24:27], s53 offen offset:3072 sc1
s_cmp_lt_u32 s72, s66
s_cbranch_scc1 L_DUAL
s_mov_b32 s74, s93
s_cmp_gt_u32 s72, s66
s_cbranch_scc1 L_SINGLE
s_branch L_NE
L_E0:
buffer_atomic_add v1, v0, s[24:27], s89 offen offset:8 sc1
s_mov_b32 s73, 9
s_min_u32 s93, s73, s69
s_min_u32 s74, s93, s66
s_cmp_lt_u32 s72, s66
s_cbranch_scc1 L_DUAL
s_mov_b32 s74, s93
s_cmp_gt_u32 s72, s66
s_cbranch_scc1 L_SINGLE
s_branch L_NE
L_E1:
v_and_b32 v173, 31, v1
v_lshlrev_b32 v173, 10, v173
v_add_u32 v173, 75497992, v173
buffer_load_dword v172, v173, s[24:27], 0 offen sc1
s_mov_b32 s73, 11
s_min_u32 s93, s73, s69
s_min_u32 s74, s93, s66
s_cmp_lt_u32 s72, s66
s_cbranch_scc1 L_DUAL
s_mov_b32 s74, s93
s_cmp_gt_u32 s72, s66
s_cbranch_scc1 L_SINGLE
s_branch L_NE
L_SE:
s_lshr_b32 s52, s4, 3
s_mul_i32 s52, s52, 75776
s_add_u32 s52, s52, 54525952
s_and_b32 s53, s4, 7
s_mul_i32 s53, s53, 8192
s_add_u32 s52, s52, s53
s_mul_i32 s78, s66, 303104
s_add_u32 s78, s78, s52
s_mul_i32 s79, s67, 303104
s_add_u32 s79, s79, s52
s_mov_b32 s76, 0
v_mov_b32 v7, 0x5d800000
s_mov_b32 s69, 64
v_accvgpr_read_b32 v180, a224
v_accvgpr_read_b32 v182, a228
v_cmp_nle_f32 vcc, v180, v7
v_cmp_nle_f32 s[96:97], v182, v7
s_nop 3
s_or_b64 vcc, vcc, s[96:97]
s_cbranch_vccnz L_NS
s_add_u32 s53, s77, 180224
buffer_load_dwordx4 a[112:115], v4, s[24:27], s53 offen offset:0 sc1
v_mul_f32 v8, 0x3fb8aa3b, v8
v_mul_f32 v9, 0x3fb8aa3b, v9
v_exp_f32 v8, v8
v_exp_f32 v9, v9
s_nop 0
v_fma_f32 v180, v180, v8, v180
v_fma_f32 v182, v182, v9, v182
v_rcp_f32 v180, v180
v_rcp_f32 v182, v182
s_add_u32 s52, s78, 4096
v_mov_b32 v181, v180
v_mov_b32 v183, v182
v_accvgpr_read_b32 v16, a0
v_accvgpr_read_b32 v17, a1
v_accvgpr_read_b32 v18, a2
v_accvgpr_read_b32 v19, a3
v_accvgpr_read_b32 v20, a4
v_accvgpr_read_b32 v21, a5
v_accvgpr_read_b32 v22, a6
v_accvgpr_read_b32 v23, a7
v_pk_mul_f32 v[16:17], v[16:17], v[180:181]
v_pk_mul_f32 v[18:19], v[18:19], v[180:181]
v_pk_mul_f32 v[20:21], v[20:21], v[180:181]
v_pk_mul_f32 v[22:23], v[22:23], v[180:181]
v_cvt_pk_bf16_f32 v16, v16, v17
v_cvt_pk_bf16_f32 v17, v18, v19
v_cvt_pk_bf16_f32 v18, v20, v21
v_cvt_pk_bf16_f32 v19, v22, v23
buffer_store_dwordx4 v[16:19], v4, s[24:27], s78 offen offset:0 sc1
v_accvgpr_read_b32 v24, a32
v_accvgpr_read_b32 v25, a33
v_accvgpr_read_b32 v26, a34
v_accvgpr_read_b32 v27, a35
v_accvgpr_read_b32 v28, a36
v_accvgpr_read_b32 v29, a37
v_accvgpr_read_b32 v30, a38
v_accvgpr_read_b32 v31, a39
buffer_load_dwordx4 a[116:119], v4, s[24:27], s53 offen offset:1024 sc1
v_pk_mul_f32 v[24:25], v[24:25], v[182:183]
v_pk_mul_f32 v[26:27], v[26:27], v[182:183]
v_pk_mul_f32 v[28:29], v[28:29], v[182:183]
v_pk_mul_f32 v[30:31], v[30:31], v[182:183]
v_cvt_pk_bf16_f32 v24, v24, v25
v_cvt_pk_bf16_f32 v25, v26, v27
v_cvt_pk_bf16_f32 v26, v28, v29
v_cvt_pk_bf16_f32 v27, v30, v31
buffer_store_dwordx4 v[24:27], v4, s[24:27], s78 offen offset:1024 sc1
v_accvgpr_read_b32 v16, a8
v_accvgpr_read_b32 v17, a9
v_accvgpr_read_b32 v18, a10
v_accvgpr_read_b32 v19, a11
v_accvgpr_read_b32 v20, a12
v_accvgpr_read_b32 v21, a13
v_accvgpr_read_b32 v22, a14
v_accvgpr_read_b32 v23, a15
v_pk_mul_f32 v[16:17], v[16:17], v[180:181]
v_pk_mul_f32 v[18:19], v[18:19], v[180:181]
v_pk_mul_f32 v[20:21], v[20:21], v[180:181]
v_pk_mul_f32 v[22:23], v[22:23], v[180:181]
v_cvt_pk_bf16_f32 v16, v16, v17
v_cvt_pk_bf16_f32 v17, v18, v19
v_cvt_pk_bf16_f32 v18, v20, v21
v_cvt_pk_bf16_f32 v19, v22, v23
buffer_store_dwordx4 v[16:19], v4, s[24:27], s78 offen offset:2048 sc1
v_accvgpr_read_b32 v24, a40
v_accvgpr_read_b32 v25, a41
v_accvgpr_read_b32 v26, a42
v_accvgpr_read_b32 v27, a43
v_accvgpr_read_b32 v28, a44
v_accvgpr_read_b32 v29, a45
v_accvgpr_read_b32 v30, a46
v_accvgpr_read_b32 v31, a47
v_pk_mul_f32 v[24:25], v[24:25], v[182:183]
v_pk_mul_f32 v[26:27], v[26:27], v[182:183]
v_pk_mul_f32 v[28:29], v[28:29], v[182:183]
buffer_load_dwordx4 a[120:123], v4, s[24:27], s53 offen offset:2048 sc1
v_pk_mul_f32 v[30:31], v[30:31], v[182:183]
v_cvt_pk_bf16_f32 v24, v24, v25
v_cvt_pk_bf16_f32 v25, v26, v27
v_cvt_pk_bf16_f32 v26, v28, v29
v_cvt_pk_bf16_f32 v27, v30, v31
buffer_store_dwordx4 v[24:27], v4, s[24:27], s78 offen offset:3072 sc1
v_accvgpr_read_b32 v16, a16
v_accvgpr_read_b32 v17, a17
v_accvgpr_read_b32 v18, a18
v_accvgpr_read_b32 v19, a19
v_accvgpr_read_b32 v20, a20
v_accvgpr_read_b32 v21, a21
v_accvgpr_read_b32 v22, a22
v_accvgpr_read_b32 v23, a23
v_pk_mul_f32 v[16:17], v[16:17], v[180:181]
v_pk_mul_f32 v[18:19], v[18:19], v[180:181]
v_pk_mul_f32 v[20:21], v[20:21], v[180:181]
v_pk_mul_f32 v[22:23], v[22:23], v[180:181]
v_cvt_pk_bf16_f32 v16, v16, v17
v_cvt_pk_bf16_f32 v17, v18, v19
v_cvt_pk_bf16_f32 v18, v20, v21
v_cvt_pk_bf16_f32 v19, v22, v23
buffer_store_dwordx4 v[16:19], v4, s[24:27], s52 offen offset:0 sc1
v_accvgpr_read_b32 v24, a48
v_accvgpr_read_b32 v25, a49
v_accvgpr_read_b32 v26, a50
v_accvgpr_read_b32 v27, a51
v_accvgpr_read_b32 v28, a52
v_accvgpr_read_b32 v29, a53
v_accvgpr_read_b32 v30, a54
v_accvgpr_read_b32 v31, a55
v_pk_mul_f32 v[24:25], v[24:25], v[182:183]
v_pk_mul_f32 v[26:27], v[26:27], v[182:183]
v_pk_mul_f32 v[28:29], v[28:29], v[182:183]
v_pk_mul_f32 v[30:31], v[30:31], v[182:183]
v_cvt_pk_bf16_f32 v24, v24, v25
v_cvt_pk_bf16_f32 v25, v26, v27
buffer_load_dwordx4 a[124:127], v4, s[24:27], s53 offen offset:3072 sc1
v_cvt_pk_bf16_f32 v26, v28, v29
v_cvt_pk_bf16_f32 v27, v30, v31
buffer_store_dwordx4 v[24:27], v4, s[24:27], s52 offen offset:1024 sc1
v_accvgpr_read_b32 v16, a24
v_accvgpr_read_b32 v17, a25
v_accvgpr_read_b32 v18, a26
v_accvgpr_read_b32 v19, a27
v_accvgpr_read_b32 v20, a28
v_accvgpr_read_b32 v21, a29
v_accvgpr_read_b32 v22, a30
v_accvgpr_read_b32 v23, a31
v_pk_mul_f32 v[16:17], v[16:17], v[180:181]
v_pk_mul_f32 v[18:19], v[18:19], v[180:181]
v_pk_mul_f32 v[20:21], v[20:21], v[180:181]
v_pk_mul_f32 v[22:23], v[22:23], v[180:181]
v_cvt_pk_bf16_f32 v16, v16, v17
v_cvt_pk_bf16_f32 v17, v18, v19
v_cvt_pk_bf16_f32 v18, v20, v21
v_cvt_pk_bf16_f32 v19, v22, v23
buffer_store_dwordx4 v[16:19], v4, s[24:27], s52 offen offset:2048 sc1
v_accvgpr_read_b32 v24, a56
v_accvgpr_read_b32 v25, a57
v_accvgpr_read_b32 v26, a58
v_accvgpr_read_b32 v27, a59
v_accvgpr_read_b32 v28, a60
v_accvgpr_read_b32 v29, a61
v_accvgpr_read_b32 v30, a62
v_accvgpr_read_b32 v31, a63
v_pk_mul_f32 v[24:25], v[24:25], v[182:183]
v_pk_mul_f32 v[26:27], v[26:27], v[182:183]
v_pk_mul_f32 v[28:29], v[28:29], v[182:183]
v_pk_mul_f32 v[30:31], v[30:31], v[182:183]
v_cvt_pk_bf16_f32 v24, v24, v25
v_cvt_pk_bf16_f32 v25, v26, v27
v_cvt_pk_bf16_f32 v26, v28, v29
v_cvt_pk_bf16_f32 v27, v30, v31
buffer_store_dwordx4 v[24:27], v4, s[24:27], s52 offen offset:3072 sc1
L_PAD9:
s_cbranch_execz L_PAD13
s_mov_b32 s76, 1
L_NS:
s_mov_b32 s74, s73
s_mov_b32 s93, s73
s_cmp_eq_u32 s72, 32
s_cbranch_scc1 L_FIN
L_SINGLE:
v_mfma_f32_16x16x32_bf16 v[44:47], a[192:195], v[116:119], v[128:131]
s_barrier
v_mfma_f32_16x16x32_bf16 v[44:47], a[196:199], v[132:135], v[44:47]
s_cmp_eq_u32 s68, s71
v_exp_f32 v229, v229
v_mfma_f32_16x16x32_bf16 v[44:47], a[200:203], v[184:187], v[44:47]
s_cselect_b32 s64, s77, s68
v_add_u32 v5, s75, v4
v_cvt_pk_bf16_f32 v234, v228, v229
v_mfma_f32_16x16x32_bf16 v[44:47], a[204:207], v[240:243], v[44:47]
s_mov_b32 m0, s70
v_exp_f32 v230, v230
v_mfma_f32_16x16x32_bf16 v[52:55], a[192:195], v[188:191], v[136:139]
buffer_load_dwordx4 v4, s[24:27], s64 offen offset:0 sc1 lds
v_mfma_f32_16x16x32_bf16 v[52:55], a[196:199], v[56:59], v[52:55]
s_add_u32 s75, s75, 16384
v_exp_f32 v231, v231
v_mfma_f32_16x16x32_bf16 v[52:55], a[200:203], v[88:91], v[52:55]
ds_read_b128 a[192:195], v5 offset:0
v_cvt_pk_bf16_f32 v235, v230, v231
v_mfma_f32_16x16x32_bf16 v[52:55], a[204:207], v[192:195], v[52:55]
s_cmp_ge_u32 s75, 163840
v_exp_f32 v44, v44
v_mfma_f32_16x16x32_bf16 v[64:67], a[208:211], v[116:119], v[144:147]
ds_read_b128 a[196:199], v5 offset:1024
ds_read_b128 a[200:203], v5 offset:2048
v_mfma_f32_16x16x32_bf16 v[64:67], a[212:215], v[132:135], v[64:67]
s_cselect_b32 s75, 0, s75
v_exp_f32 v45, v45
v_mfma_f32_16x16x32_bf16 v[64:67], a[216:219], v[184:187], v[64:67]
ds_read_b128 a[204:207], v5 offset:3072
v_cvt_pk_bf16_f32 v124, v44, v45
v_mfma_f32_16x16x32_bf16 v[64:67], a[220:223], v[240:243], v[64:67]
s_add_u32 s68, s64, 16384
v_exp_f32 v46, v46
v_mfma_f32_16x16x32_bf16 v[212:215], a[208:211], v[188:191], v[152:155]
buffer_load_dwordx4 v4, s[24:27], s64 offen offset:1024 sc1 lds
v_mfma_f32_16x16x32_bf16 v[212:215], a[212:215], v[56:59], v[212:215]
s_add_u32 s70, s70, 16384
v_exp_f32 v47, v47
v_mfma_f32_16x16x32_bf16 v[212:215], a[216:219], v[88:91], v[212:215]
ds_read_b128 a[208:211], v5 offset:4096
v_cvt_pk_bf16_f32 v125, v46, v47
v_mfma_f32_16x16x32_bf16 v[212:215], a[220:223], v[192:195], v[212:215]
s_waitcnt lgkmcnt(5)
v_exp_f32 v52, v52
v_mfma_f32_16x16x32_bf16 v[60:63], a[64:67], v[248:251], v[60:63]
ds_read_b128 a[212:215], v5 offset:5120
ds_read_b128 a[216:219], v5 offset:6144
v_mfma_f32_16x16x32_bf16 v[148:151], a[64:67], v[232:235], v[148:151]
s_cmp_ge_u32 s70, 163840
v_exp_f32 v53, v53
v_mfma_f32_16x16x32_bf16 v[48:51], a[68:71], v[232:235], v[48:51]
ds_read_b128 a[220:223], v5 offset:7168
v_cvt_pk_bf16_f32 v140, v52, v53
v_mfma_f32_16x16x32_bf16 v[68:71], a[68:71], v[248:251], v[68:71]
s_cselect_b32 s70, s80, s70
v_exp_f32 v54, v54
v_mfma_f32_16x16x32_bf16 v[72:75], a[72:75], v[248:251], v[72:75]
buffer_load_dwordx4 v4, s[24:27], s64 offen offset:2048 sc1 lds
v_mfma_f32_16x16x32_bf16 v[236:239], a[72:75], v[232:235], v[236:239]
v_exp_f32 v55, v55
v_mfma_f32_16x16x32_bf16 v[224:227], a[76:79], v[232:235], v[224:227]
ds_read_b128 a[64:67], v5 offset:8192
v_cvt_pk_bf16_f32 v141, v54, v55
v_mfma_f32_16x16x32_bf16 v[220:223], a[76:79], v[248:251], v[220:223]
v_exp_f32 v64, v64
v_mfma_f32_16x16x32_bf16 v[84:87], a[80:83], v[248:251], v[84:87]
ds_read_b128 a[68:71], v5 offset:9216
ds_read_b128 a[72:75], v5 offset:10240
v_mfma_f32_16x16x32_bf16 v[164:167], a[80:83], v[232:235], v[164:167]
v_exp_f32 v65, v65
v_mfma_f32_16x16x32_bf16 v[156:159], a[84:87], v[232:235], v[156:159]
ds_read_b128 a[76:79], v5 offset:11264
v_cvt_pk_bf16_f32 v126, v64, v65
v_mfma_f32_16x16x32_bf16 v[76:79], a[84:87], v[248:251], v[76:79]
s_cmp_eq_u32 s68, s71
v_exp_f32 v66, v66
v_mfma_f32_16x16x32_bf16 v[160:163], a[88:91], v[248:251], v[160:163]
buffer_load_dwordx4 v4, s[24:27], s64 offen offset:3072 sc1 lds
v_mfma_f32_16x16x32_bf16 v[216:219], a[88:91], v[232:235], v[216:219]
s_cselect_b32 s64, s77, s68
v_exp_f32 v67, v67
v_mfma_f32_16x16x32_bf16 v[208:211], a[92:95], v[232:235], v[208:211]
ds_read_b128 a[80:83], v5 offset:12288
v_cvt_pk_bf16_f32 v127, v66, v67
v_mfma_f32_16x16x32_bf16 v[252:255], a[92:95], v[248:251], v[252:255]
s_waitcnt lgkmcnt(5)
v_exp_f32 v212, v212
v_mfma_f32_16x16x32_bf16 a[232:235], a[240:243], v[248:251], a[232:235]
ds_read_b128 a[84:87], v5 offset:13312
ds_read_b128 a[88:91], v5 offset:14336
v_mfma_f32_16x16x32_bf16 a[236:239], a[240:243], v[232:235], a[236:239]
s_mov_b32 m0, s70
ds_read_b128 a[92:95], v5 offset:15360
v_mfma_f32_16x16x32_bf16 v[100:103], a[192:195], v[116:119], v[128:131]
buffer_load_dwordx4 v4, s[24:27], s64 offen offset:0 sc1 lds
v_mfma_f32_16x16x32_bf16 v[100:103], a[196:199], v[132:135], v[100:103]
v_exp_f32 v213, v213
v_mfma_f32_16x16x32_bf16 v[100:103], a[200:203], v[184:187], v[100:103]
v_add_u32 v5, s75, v4
v_cvt_pk_bf16_f32 v142, v212, v213
v_mfma_f32_16x16x32_bf16 v[100:103], a[204:207], v[240:243], v[100:103]
v_exp_f32 v214, v214
v_mfma_f32_16x16x32_bf16 v[92:95], a[192:195], v[188:191], v[136:139]
buffer_load_dwordx4 v4, s[24:27], s64 offen offset:1024 sc1 lds
v_mfma_f32_16x16x32_bf16 v[92:95], a[196:199], v[56:59], v[92:95]
s_add_u32 s75, s75, 16384
v_exp_f32 v215, v215
v_mfma_f32_16x16x32_bf16 v[92:95], a[200:203], v[88:91], v[92:95]
ds_read_b128 a[192:195], v5 offset:0
v_cvt_pk_bf16_f32 v143, v214, v215
v_mfma_f32_16x16x32_bf16 v[92:95], a[204:207], v[192:195], v[92:95]
s_cmp_ge_u32 s75, 163840
v_exp_f32 v100, v100
v_mfma_f32_16x16x32_bf16 v[176:179], a[208:211], v[116:119], v[144:147]
ds_read_b128 a[196:199], v5 offset:1024
ds_read_b128 a[200:203], v5 offset:2048
v_mfma_f32_16x16x32_bf16 v[176:179], a[212:215], v[132:135], v[176:179]
s_cselect_b32 s75, 0, s75
v_exp_f32 v101, v101
v_mfma_f32_16x16x32_bf16 v[176:179], a[216:219], v[184:187], v[176:179]
ds_read_b128 a[204:207], v5 offset:3072
v_cvt_pk_bf16_f32 v248, v100, v101
v_mfma_f32_16x16x32_bf16 v[176:179], a[220:223], v[240:243], v[176:179]
s_add_u32 s68, s64, 16384
v_exp_f32 v102, v102
v_mfma_f32_16x16x32_bf16 v[228:231], a[208:211], v[188:191], v[152:155]
buffer_load_dwordx4 v4, s[24:27], s64 offen offset:2048 sc1 lds
v_mfma_f32_16x16x32_bf16 v[228:231], a[212:215], v[56:59], v[228:231]
s_add_u32 s70, s70, 16384
v_exp_f32 v103, v103
v_mfma_f32_16x16x32_bf16 v[228:231], a[216:219], v[88:91], v[228:231]
ds_read_b128 a[208:211], v5 offset:4096
v_cvt_pk_bf16_f32 v249, v102, v103
v_mfma_f32_16x16x32_bf16 v[228:231], a[220:223], v[192:195], v[228:231]
s_waitcnt lgkmcnt(5)
v_exp_f32 v92, v92
v_mfma_f32_16x16x32_bf16 v[60:63], a[64:67], v[124:127], v[60:63]
ds_read_b128 a[212:215], v5 offset:5120
ds_read_b128 a[216:219], v5 offset:6144
v_mfma_f32_16x16x32_bf16 v[148:151], a[64:67], v[140:143], v[148:151]
s_cmp_ge_u32 s70, 163840
v_exp_f32 v93, v93
v_mfma_f32_16x16x32_bf16 v[48:51], a[68:71], v[140:143], v[48:51]
ds_read_b128 a[220:223], v5 offset:7168
v_cvt_pk_bf16_f32 v232, v92, v93
v_mfma_f32_16x16x32_bf16 v[68:71], a[68:71], v[124:127], v[68:71]
s_cselect_b32 s70, s80, s70
v_exp_f32 v94, v94
v_mfma_f32_16x16x32_bf16 v[72:75], a[72:75], v[124:127], v[72:75]
buffer_load_dwordx4 v4, s[24:27], s64 offen offset:3072 sc1 lds
v_mfma_f32_16x16x32_bf16 v[236:239], a[72:75], v[140:143], v[236:239]
s_add_u32 s72, s72, 1
v_exp_f32 v95, v95
v_mfma_f32_16x16x32_bf16 v[224:227], a[76:79], v[140:143], v[224:227]
ds_read_b128 a[64:67], v5 offset:8192
v_cvt_pk_bf16_f32 v233, v94, v95
v_mfma_f32_16x16x32_bf16 v[220:223], a[76:79], v[124:127], v[220:223]
v_exp_f32 v176, v176
v_mfma_f32_16x16x32_bf16 v[84:87], a[80:83], v[124:127], v[84:87]
ds_read_b128 a[68:71], v5 offset:9216
ds_read_b128 a[72:75], v5 offset:10240
v_mfma_f32_16x16x32_bf16 v[164:167], a[80:83], v[140:143], v[164:167]
v_exp_f32 v177, v177
v_mfma_f32_16x16x32_bf16 v[156:159], a[84:87], v[140:143], v[156:159]
ds_read_b128 a[76:79], v5 offset:11264
v_cvt_pk_bf16_f32 v250, v176, v177
v_mfma_f32_16x16x32_bf16 v[76:79], a[84:87], v[124:127], v[76:79]
v_exp_f32 v178, v178
v_mfma_f32_16x16x32_bf16 v[160:163], a[88:91], v[124:127], v[160:163]
ds_read_b128 a[80:83], v5 offset:12288
ds_read_b128 a[84:87], v5 offset:13312
v_mfma_f32_16x16x32_bf16 v[216:219], a[88:91], v[140:143], v[216:219]
s_cmp_lt_u32 s72, s74
v_exp_f32 v179, v179
v_mfma_f32_16x16x32_bf16 v[208:211], a[92:95], v[140:143], v[208:211]
ds_read_b128 a[88:91], v5 offset:14336
v_cvt_pk_bf16_f32 v251, v178, v179
v_mfma_f32_16x16x32_bf16 v[252:255], a[92:95], v[124:127], v[252:255]
s_waitcnt vmcnt(8) lgkmcnt(7)
v_exp_f32 v228, v228
v_mfma_f32_16x16x32_bf16 a[232:235], a[240:243], v[124:127], a[232:235]
ds_read_b128 a[92:95], v5 offset:15360
v_mfma_f32_16x16x32_bf16 a[236:239], a[240:243], v[140:143], a[236:239]
s_cbranch_scc1 L_SINGLE
s_cmp_eq_u32 s72, s69
s_cbranch_scc1 L_SE
s_cmp_lt_u32 s72, 32
s_cbranch_scc1 L_STOP
L_FIN:
s_add_u32 s53, s77, 196608
buffer_load_dwordx4 a[128:131], v4, s[24:27], s53 offen offset:0 sc1
v_cndmask_b32 v128, v128, v6, s[56:57]
v_cndmask_b32 v152, v152, v6, s[56:57]
v_mov_b32 v144, v6
buffer_load_dwordx4 a[132:135], v4, s[24:27], s53 offen offset:1024 sc1
v_cndmask_b32 v129, v129, v6, s[58:59]
v_cndmask_b32 v153, v153, v6, s[58:59]
v_mov_b32 v145, v6
buffer_load_dwordx4 a[136:139], v4, s[24:27], s53 offen offset:2048 sc1
v_cndmask_b32 v130, v130, v6, s[60:61]
v_cndmask_b32 v154, v154, v6, s[60:61]
v_mov_b32 v146, v6
buffer_load_dwordx4 a[140:143], v4, s[24:27], s53 offen offset:3072 sc1
v_cndmask_b32 v131, v131, v6, s[62:63]
v_cndmask_b32 v155, v155, v6, s[62:63]
v_mov_b32 v147, v6
s_sub_u32 s91, s70, s80
s_mov_b32 s83, s75
s_lshl_b32 s53, s4, 18
s_add_u32 s53, s53, 45088768
s_lshl_b32 s54, s66, 9
s_add_u32 s54, s54, s53
s_lshl_b32 s55, s67, 9
s_add_u32 s55, s55, s53
v_mfma_f32_16x16x32_bf16 v[44:47], a[192:195], v[116:119], v[128:131]
s_barrier
v_mfma_f32_16x16x32_bf16 v[44:47], a[196:199], v[132:135], v[44:47]
s_add_u32 m0, s83, 0
v_exp_f32 v229, v229
v_mfma_f32_16x16x32_bf16 v[44:47], a[200:203], v[184:187], v[44:47]
s_add_u32 s64, s54, 65280
v_add_u32 v5, s75, v4
v_cvt_pk_bf16_f32 v234, v228, v229
v_mfma_f32_16x16x32_bf16 v[44:47], a[204:207], v[240:243], v[44:47]
v_exp_f32 v230, v230
v_mfma_f32_16x16x32_bf16 v[52:55], a[192:195], v[188:191], v[136:139]
s_mov_b32 exec_hi, 0xffff
buffer_load_dwordx4 v4, s[24:27], s64 offen sc1 lds
s_mov_b32 exec_hi, -1
v_mfma_f32_16x16x32_bf16 v[52:55], a[196:199], v[56:59], v[52:55]
s_add_u32 m0, s83, 768
v_exp_f32 v231, v231
v_mfma_f32_16x16x32_bf16 v[52:55], a[200:203], v[88:91], v[52:55]
s_add_u32 s64, s54, 98048
v_cvt_pk_bf16_f32 v235, v230, v231
v_mfma_f32_16x16x32_bf16 v[52:55], a[204:207], v[192:195], v[52:55]
v_exp_f32 v44, v44
v_mfma_f32_16x16x32_bf16 v[64:67], a[208:211], v[116:119], v[144:147]
s_mov_b32 exec_hi, 0xffff
buffer_load_dwordx4 v4, s[24:27], s64 offen sc1 lds
s_mov_b32 exec_hi, -1
v_mfma_f32_16x16x32_bf16 v[64:67], a[212:215], v[132:135], v[64:67]
s_add_u32 m0, s83, 1536
v_exp_f32 v45, v45
v_mfma_f32_16x16x32_bf16 v[64:67], a[216:219], v[184:187], v[64:67]
s_add_u32 s64, s54, 130816
v_cvt_pk_bf16_f32 v124, v44, v45
v_mfma_f32_16x16x32_bf16 v[64:67], a[220:223], v[240:243], v[64:67]
v_exp_f32 v46, v46
v_mfma_f32_16x16x32_bf16 v[212:215], a[208:211], v[188:191], v[152:155]
s_mov_b32 exec_hi, 0xffff
buffer_load_dwordx4 v4, s[24:27], s64 offen sc1 lds
s_mov_b32 exec_hi, -1
v_mfma_f32_16x16x32_bf16 v[212:215], a[212:215], v[56:59], v[212:215]
s_add_u32 m0, s83, 2304
v_exp_f32 v47, v47
v_mfma_f32_16x16x32_bf16 v[212:215], a[216:219], v[88:91], v[212:215]
s_add_u32 s64, s54, 163584
v_cvt_pk_bf16_f32 v125, v46, v47
v_mfma_f32_16x16x32_bf16 v[212:215], a[220:223], v[192:195], v[212:215]
s_waitcnt lgkmcnt(0)
v_exp_f32 v52, v52
v_mfma_f32_16x16x32_bf16 v[60:63], a[64:67], v[248:251], v[60:63]
s_mov_b32 exec_hi, 0xffff
buffer_load_dwordx4 v4, s[24:27], s64 offen sc1 lds
s_mov_b32 exec_hi, -1
v_mfma_f32_16x16x32_bf16 v[148:151], a[64:67], v[232:235], v[148:151]
s_add_u32 m0, s83, 3072
v_exp_f32 v53, v53
v_mfma_f32_16x16x32_bf16 v[48:51], a[68:71], v[232:235], v[48:51]
s_add_u32 s64, s54, 196352
ds_read_b128 a[64:67], v5 offset:8192
v_cvt_pk_bf16_f32 v140, v52, v53
v_mfma_f32_16x16x32_bf16 v[68:71], a[68:71], v[248:251], v[68:71]
v_exp_f32 v54, v54
v_mfma_f32_16x16x32_bf16 v[72:75], a[72:75], v[248:251], v[72:75]
s_mov_b32 exec_hi, 0xffff
buffer_load_dwordx4 v4, s[24:27], s64 offen sc1 lds
s_mov_b32 exec_hi, -1
v_mfma_f32_16x16x32_bf16 v[236:239], a[72:75], v[232:235], v[236:239]
v_exp_f32 v55, v55
v_mfma_f32_16x16x32_bf16 v[224:227], a[76:79], v[232:235], v[224:227]
ds_read_b128 a[68:71], v5 offset:9216
v_cvt_pk_bf16_f32 v141, v54, v55
v_mfma_f32_16x16x32_bf16 v[220:223], a[76:79], v[248:251], v[220:223]
v_exp_f32 v64, v64
v_mfma_f32_16x16x32_bf16 v[84:87], a[80:83], v[248:251], v[84:87]
ds_read_b128 a[72:75], v5 offset:10240
v_mfma_f32_16x16x32_bf16 v[164:167], a[80:83], v[232:235], v[164:167]
s_add_u32 m0, s83, 3840
v_exp_f32 v65, v65
v_mfma_f32_16x16x32_bf16 v[156:159], a[84:87], v[232:235], v[156:159]
s_add_u32 s64, s55, 65280
ds_read_b128 a[76:79], v5 offset:11264
v_cvt_pk_bf16_f32 v126, v64, v65
v_mfma_f32_16x16x32_bf16 v[76:79], a[84:87], v[248:251], v[76:79]
v_exp_f32 v66, v66
v_mfma_f32_16x16x32_bf16 v[160:163], a[88:91], v[248:251], v[160:163]
s_mov_b32 exec_hi, 0xffff
buffer_load_dwordx4 v4, s[24:27], s64 offen sc1 lds
s_mov_b32 exec_hi, -1
v_mfma_f32_16x16x32_bf16 v[216:219], a[88:91], v[232:235], v[216:219]
v_exp_f32 v67, v67
v_mfma_f32_16x16x32_bf16 v[208:211], a[92:95], v[232:235], v[208:211]
ds_read_b128 a[80:83], v5 offset:12288
v_cvt_pk_bf16_f32 v127, v66, v67
v_mfma_f32_16x16x32_bf16 v[252:255], a[92:95], v[248:251], v[252:255]
v_exp_f32 v212, v212
v_mfma_f32_16x16x32_bf16 a[232:235], a[240:243], v[248:251], a[232:235]
ds_read_b128 a[84:87], v5 offset:13312
ds_read_b128 a[88:91], v5 offset:14336
v_mfma_f32_16x16x32_bf16 a[236:239], a[240:243], v[232:235], a[236:239]
ds_read_b128 a[92:95], v5 offset:15360
v_exp_f32 v213, v213
v_exp_f32 v214, v214
v_exp_f32 v215, v215
v_cmp_lt_u32 vcc, 31, v1
v_cvt_pk_bf16_f32 v142, v212, v213
v_cvt_pk_bf16_f32 v143, v214, v215
s_waitcnt lgkmcnt(0)
s_add_u32 m0, s83, 4608
v_mfma_f32_16x16x32_bf16 v[60:63], a[64:67], v[124:127], v[60:63]
s_add_u32 s64, s55, 98048
v_and_b32 v202, 31, v1
v_mov_b32 v200, s66
v_mfma_f32_16x16x32_bf16 v[148:151], a[64:67], v[140:143], v[148:151]
s_mov_b32 exec_hi, 0xffff
buffer_load_dwordx4 v4, s[24:27], s64 offen sc1 lds
s_mov_b32 exec_hi, -1
v_mfma_f32_16x16x32_bf16 v[48:51], a[68:71], v[140:143], v[48:51]
v_mov_b32 v203, s67
v_cndmask_b32 v200, v200, v203, vcc
v_mfma_f32_16x16x32_bf16 v[68:71], a[68:71], v[124:127], v[68:71]
s_add_u32 m0, s83, 5376
s_add_u32 s64, s55, 130816
v_lshl_add_u32 v200, v200, 5, v202
v_mfma_f32_16x16x32_bf16 v[72:75], a[72:75], v[124:127], v[72:75]
s_mov_b32 exec_hi, 0xffff
buffer_load_dwordx4 v4, s[24:27], s64 offen sc1 lds
s_mov_b32 exec_hi, -1
v_mfma_f32_16x16x32_bf16 v[236:239], a[72:75], v[140:143], v[236:239]
v_lshlrev_b32 v203, 4, v200
v_lshrrev_b32 v201, 5, v1
v_mfma_f32_16x16x32_bf16 v[224:227], a[76:79], v[140:143], v[224:227]
s_add_u32 m0, s83, 6144
s_add_u32 s64, s55, 163584
v_mul_u32_u24 v201, 3840, v201
v_mfma_f32_16x16x32_bf16 v[220:223], a[76:79], v[124:127], v[220:223]
s_mov_b32 exec_hi, 0xffff
buffer_load_dwordx4 v4, s[24:27], s64 offen sc1 lds
s_mov_b32 exec_hi, -1
v_mfma_f32_16x16x32_bf16 v[84:87], a[80:83], v[124:127], v[84:87]
v_lshl_add_u32 v201, v202, 4, v201
v_add_u32 v201, s83, v201
v_mfma_f32_16x16x32_bf16 v[164:167], a[80:83], v[140:143], v[164:167]
s_add_u32 m0, s83, 6912
s_add_u32 s64, s55, 196352
v_mfma_f32_16x16x32_bf16 v[156:159], a[84:87], v[140:143], v[156:159]
s_mov_b32 exec_hi, 0xffff
buffer_load_dwordx4 v4, s[24:27], s64 offen sc1 lds
s_mov_b32 exec_hi, -1
v_mfma_f32_16x16x32_bf16 v[76:79], a[84:87], v[124:127], v[76:79]
v_mfma_f32_16x16x32_bf16 v[160:163], a[88:91], v[124:127], v[160:163]
buffer_load_dwordx4 v[96:99], v203, s[24:27], s53 offen sc1
v_mfma_f32_16x16x32_bf16 v[216:219], a[88:91], v[140:143], v[216:219]
s_add_u32 s53, s53, 32768
s_lshl_b32 s74, s66, 10
s_lshr_b32 s52, s4, 3
v_mfma_f32_16x16x32_bf16 v[208:211], a[92:95], v[140:143], v[208:211]
buffer_load_dwordx4 v[104:107], v203, s[24:27], s53 offen sc1
v_mfma_f32_16x16x32_bf16 v[252:255], a[92:95], v[124:127], v[252:255]
s_lshl_b32 s52, s52, 7
s_add_u32 s74, s74, s52
s_add_u32 s74, s74, 75497472
v_mfma_f32_16x16x32_bf16 a[232:235], a[240:243], v[124:127], a[232:235]
v_mfma_f32_16x16x32_bf16 a[236:239], a[240:243], v[140:143], a[236:239]
s_lshr_b32 s52, s3, 1
s_lshl1_add_u32 s72, s85, s52
s_lshl3_add_u32 s75, s72, s84
s_lshl_b32 s75, s75, 7
s_add_u32 s75, s75, 75497472
s_and_b32 s82, s86, 1
s_lshl_b32 s82, s82, 13
v_mov_b32 v13, 0
s_nop 0
v_accvgpr_read_b32 v180, a232
v_accvgpr_read_b32 v182, a236
v_cmp_nle_f32 vcc, v180, v7
v_cmp_nle_f32 s[96:97], v182, v7
s_nop 3
s_or_b64 vcc, vcc, s[96:97]
s_cbranch_vccnz SLOW1
SLOW1_R:
s_mov_b32 m0, s70
s_mov_b32 s64, s68
s_add_u32 s68, s68, 16384
s_add_u32 s70, s70, 16384
s_cmp_ge_u32 s70, 163840
s_cselect_b32 s70, s80, s70
buffer_load_dwordx4 v4, s[24:27], s64 offen offset:0 sc1 lds
v_mul_f32 v10, 0x3fb8aa3b, v10
v_mul_f32 v11, 0x3fb8aa3b, v11
v_exp_f32 v10, v10
v_exp_f32 v11, v11
s_nop 0
v_fma_f32 v180, v180, v10, v180
v_fma_f32 v182, v182, v11, v182
v_rcp_f32 v180, v180
v_rcp_f32 v182, v182
buffer_load_dwordx4 v4, s[24:27], s64 offen offset:1024 sc1 lds
s_add_u32 s52, s79, 4096
v_mov_b32 v181, v180
v_mov_b32 v183, v182
v_pk_mul_f32 v[60:61], v[60:61], v[180:181]
v_pk_mul_f32 v[62:63], v[62:63], v[180:181]
v_pk_mul_f32 v[68:69], v[68:69], v[180:181]
v_pk_mul_f32 v[70:71], v[70:71], v[180:181]
v_cvt_pk_bf16_f32 v60, v60, v61
v_cvt_pk_bf16_f32 v61, v62, v63
buffer_load_dwordx4 v4, s[24:27], s64 offen offset:2048 sc1 lds
v_cvt_pk_bf16_f32 v62, v68, v69
v_cvt_pk_bf16_f32 v63, v70, v71
buffer_store_dwordx4 v[60:63], v4, s[24:27], s79 offen offset:0 sc1
v_pk_mul_f32 v[148:149], v[148:149], v[182:183]
v_pk_mul_f32 v[150:151], v[150:151], v[182:183]
v_pk_mul_f32 v[48:49], v[48:49], v[182:183]
v_pk_mul_f32 v[50:51], v[50:51], v[182:183]
v_cvt_pk_bf16_f32 v148, v148, v149
v_cvt_pk_bf16_f32 v149, v150, v151
buffer_load_dwordx4 v4, s[24:27], s64 offen offset:3072 sc1 lds
v_cvt_pk_bf16_f32 v150, v48, v49
v_cvt_pk_bf16_f32 v151, v50, v51
buffer_store_dwordx4 v[148:151], v4, s[24:27], s79 offen offset:1024 sc1
v_pk_mul_f32 v[72:73], v[72:73], v[180:181]
v_pk_mul_f32 v[74:75], v[74:75], v[180:181]
v_pk_mul_f32 v[220:221], v[220:221], v[180:181]
v_pk_mul_f32 v[222:223], v[222:223], v[180:181]
v_cvt_pk_bf16_f32 v72, v72, v73
v_cvt_pk_bf16_f32 v73, v74, v75
s_mov_b32 m0, s70
s_mov_b32 s64, s68
s_add_u32 s68, s68, 16384
s_add_u32 s70, s70, 16384
s_cmp_ge_u32 s70, 163840
s_cselect_b32 s70, s80, s70
buffer_load_dwordx4 v4, s[24:27], s64 offen offset:0 sc1 lds
v_cvt_pk_bf16_f32 v74, v220, v221
v_cvt_pk_bf16_f32 v75, v222, v223
buffer_store_dwordx4 v[72:75], v4, s[24:27], s79 offen offset:2048 sc1
v_pk_mul_f32 v[236:237], v[236:237], v[182:183]
v_pk_mul_f32 v[238:239], v[238:239], v[182:183]
v_pk_mul_f32 v[224:225], v[224:225], v[182:183]
v_pk_mul_f32 v[226:227], v[226:227], v[182:183]
v_cvt_pk_bf16_f32 v236, v236, v237
v_cvt_pk_bf16_f32 v237, v238, v239
buffer_load_dwordx4 v4, s[24:27], s64 offen offset:1024 sc1 lds
v_cvt_pk_bf16_f32 v238, v224, v225
v_cvt_pk_bf16_f32 v239, v226, v227
buffer_store_dwordx4 v[236:239], v4, s[24:27], s79 offen offset:3072 sc1
v_pk_mul_f32 v[84:85], v[84:85], v[180:181]
v_pk_mul_f32 v[86:87], v[86:87], v[180:181]
v_pk_mul_f32 v[76:77], v[76:77], v[180:181]
v_pk_mul_f32 v[78:79], v[78:79], v[180:181]
v_cvt_pk_bf16_f32 v84, v84, v85
v_cvt_pk_bf16_f32 v85, v86, v87
buffer_load_dwordx4 v4, s[24:27], s64 offen offset:2048 sc1 lds
v_cvt_pk_bf16_f32 v86, v76, v77
v_cvt_pk_bf16_f32 v87, v78, v79
buffer_store_dwordx4 v[84:87], v4, s[24:27], s52 offen offset:0 sc1
v_pk_mul_f32 v[164:165], v[164:165], v[182:183]
v_pk_mul_f32 v[166:167], v[166:167], v[182:183]
v_pk_mul_f32 v[156:157], v[156:157], v[182:183]
v_pk_mul_f32 v[158:159], v[158:159], v[182:183]
v_cvt_pk_bf16_f32 v164, v164, v165
v_cvt_pk_bf16_f32 v165, v166, v167
buffer_load_dwordx4 v4, s[24:27], s64 offen offset:3072 sc1 lds
v_cvt_pk_bf16_f32 v166, v156, v157
v_cvt_pk_bf16_f32 v167, v158, v159
buffer_store_dwordx4 v[164:167], v4, s[24:27], s52 offen offset:1024 sc1
v_pk_mul_f32 v[160:161], v[160:161], v[180:181]
v_pk_mul_f32 v[162:163], v[162:163], v[180:181]
v_pk_mul_f32 v[252:253], v[252:253], v[180:181]
v_pk_mul_f32 v[254:255], v[254:255], v[180:181]
v_cvt_pk_bf16_f32 v160, v160, v161
v_cvt_pk_bf16_f32 v161, v162, v163
v_cvt_pk_bf16_f32 v162, v252, v253
v_cvt_pk_bf16_f32 v163, v254, v255
buffer_store_dwordx4 v[160:163], v4, s[24:27], s52 offen offset:2048 sc1
v_pk_mul_f32 v[216:217], v[216:217], v[182:183]
v_pk_mul_f32 v[218:219], v[218:219], v[182:183]
v_pk_mul_f32 v[208:209], v[208:209], v[182:183]
v_pk_mul_f32 v[210:211], v[210:211], v[182:183]
v_cvt_pk_bf16_f32 v216, v216, v217
v_cvt_pk_bf16_f32 v217, v218, v219
v_cvt_pk_bf16_f32 v218, v208, v209
v_cvt_pk_bf16_f32 v219, v210, v211
buffer_store_dwordx4 v[216:219], v4, s[24:27], s52 offen offset:3072 sc1
s_cmp_eq_u32 s76, 0
s_cbranch_scc1 L_SE2
L_LA:
v_mov_b32 v5, v200
v_mov_b32 v6, v201
s_waitcnt vmcnt(16)
v_mov_b32 v16, v96
v_mov_b32 v17, v97
v_mov_b32 v18, v98
v_mov_b32 v19, v99
v_mov_b32 v20, v104
v_mov_b32 v21, v105
v_mov_b32 v22, v106
v_mov_b32 v23, v107
ds_read_b128 v[96:99], v6 offset:3328
ds_read_b128 v[32:35], v6 offset:256
ds_read_b128 v[36:39], v6 offset:1024
ds_read_b128 v[100:103], v6 offset:3296
ds_read_b128 v[40:43], v6 offset:224
ds_read_b128 v[44:47], v6 offset:992
ds_read_b128 v[104:107], v6 offset:3264
ds_read_b128 v[48:51], v6 offset:192
ds_read_b128 v[52:55], v6 offset:960
ds_read_b128 v[108:111], v6 offset:3232
ds_read_b128 v[56:59], v6 offset:160
ds_read_b128 v[60:63], v6 offset:928
ds_read_b128 v[112:115], v6 offset:3200
ds_read_b128 v[64:67], v6 offset:128
ds_read_b128 v[68:71], v6 offset:896
ds_read_b128 v[116:119], v6 offset:3168
ds_read_b128 v[72:75], v6 offset:96
ds_read_b128 v[76:79], v6 offset:864
ds_read_b128 v[120:123], v6 offset:3136
ds_read_b128 v[80:83], v6 offset:64
ds_read_b128 v[84:87], v6 offset:832
ds_read_b128 v[124:127], v6 offset:3104
ds_read_b128 v[88:91], v6 offset:32
ds_read_b128 v[92:95], v6 offset:800
ds_read_b128 v[128:131], v6 offset:1792
ds_read_b128 v[132:135], v6 offset:2560
ds_read_b128 v[136:139], v6 offset:1760
ds_read_b128 v[140:143], v6 offset:2528
ds_read_b128 v[144:147], v6 offset:1728
ds_read_b128 v[148:151], v6 offset:2496
ds_read_b128 v[152:155], v6 offset:1696
ds_read_b128 v[156:159], v6 offset:2464
ds_read_b128 v[160:163], v6 offset:1664
ds_read_b128 v[164:167], v6 offset:2432
ds_read_b128 v[168:171], v6 offset:1632
ds_read_b128 v[172:175], v6 offset:2400
ds_read_b128 v[176:179], v6 offset:1600
ds_read_b128 v[180:183], v6 offset:2368
ds_read_b128 v[184:187], v6 offset:1568
ds_read_b128 v[188:191], v6 offset:2336
s_lshr_b32 s53, s4, 3
s_mul_i32 s53, s53, 75776
s_add_u32 s53, s53, 54525952
s_and_b32 s52, s3, 1
s_lshl_b32 s52, s52, 10
s_add_u32 s52, s52, s53
s_sub_u32 s54, 63, s72
s_mul_i32 s77, s72, 303104
s_add_u32 s77, s77, s52
s_mul_i32 s81, s54, 303104
s_add_u32 s81, s81, s52
s_add_u32 s91, s91, 114688
s_sub_u32 s52, s91, 163840
s_cmp_ge_u32 s91, 163840
s_cselect_b32 s91, s52, s91
v_add_u32 v14, 4096, v4
v_add_u32 v7, s91, v4
s_waitcnt lgkmcnt(0)
s_barrier
s_mov_b32 m0, s70
s_mov_b32 s64, s68
s_add_u32 s68, s68, 16384
s_add_u32 s70, s70, 16384
s_cmp_ge_u32 s70, 163840
s_cselect_b32 s70, s80, s70
buffer_load_dwordx4 v4, s[24:27], s64 offen offset:0 sc1 lds
v_and_b32 v9, 0xffff, v97
v_and_b32 v11, 0xffff0000, v97
v_dot2_f32_bf16 v24, v98, v99, 0
v_dot2_f32_bf16 v25, v102, v99, 0
v_dot2_f32_bf16 v26, v106, v99, 0
v_dot2_f32_bf16 v27, v110, v99, 0
v_dot2_f32_bf16 v28, v114, v99, 0
v_dot2_f32_bf16 v29, v118, v99, 0
v_dot2_f32_bf16 v30, v122, v99, 0
v_dot2_f32_bf16 v31, v126, v99, 0
v_dot2c_f32_bf16 v24, v96, v9
v_dot2c_f32_bf16 v25, v100, v9
v_dot2c_f32_bf16 v26, v104, v9
v_dot2c_f32_bf16 v27, v108, v9
v_dot2c_f32_bf16 v28, v112, v9
v_dot2c_f32_bf16 v29, v116, v9
v_dot2c_f32_bf16 v30, v120, v9
v_dot2c_f32_bf16 v31, v124, v9
v_dot2c_f32_bf16 v24, v16, v32
v_dot2c_f32_bf16 v25, v16, v40
v_dot2c_f32_bf16 v26, v16, v48
L_PAD10:
s_cbranch_execz L_MAIN
v_dot2c_f32_bf16 v27, v16, v56
v_dot2c_f32_bf16 v28, v16, v64
v_dot2c_f32_bf16 v29, v16, v72
v_dot2c_f32_bf16 v30, v16, v80
buffer_load_dwordx4 v4, s[24:27], s64 offen offset:1024 sc1 lds
v_dot2c_f32_bf16 v31, v16, v88
v_dot2c_f32_bf16 v24, v17, v33
v_dot2c_f32_bf16 v25, v17, v41
v_dot2c_f32_bf16 v26, v17, v49
v_dot2c_f32_bf16 v27, v17, v57
v_dot2c_f32_bf16 v28, v17, v65
v_dot2c_f32_bf16 v29, v17, v73
v_dot2c_f32_bf16 v30, v17, v81
v_dot2c_f32_bf16 v31, v17, v89
v_dot2c_f32_bf16 v24, v18, v34
v_dot2c_f32_bf16 v25, v18, v42
v_dot2c_f32_bf16 v26, v18, v50
v_dot2c_f32_bf16 v27, v18, v58
v_dot2c_f32_bf16 v28, v18, v66
v_dot2c_f32_bf16 v29, v18, v74
v_dot2c_f32_bf16 v30, v18, v82
v_dot2c_f32_bf16 v31, v18, v90
v_dot2c_f32_bf16 v24, v19, v35
v_dot2c_f32_bf16 v25, v19, v43
v_dot2c_f32_bf16 v26, v19, v51
v_dot2c_f32_bf16 v27, v19, v59
v_dot2c_f32_bf16 v28, v19, v67
v_dot2c_f32_bf16 v29, v19, v75
v_dot2c_f32_bf16 v30, v19, v83
v_dot2c_f32_bf16 v31, v19, v91
buffer_load_dwordx4 v4, s[24:27], s64 offen offset:2048 sc1 lds
v_dot2c_f32_bf16 v24, v20, v36
v_dot2c_f32_bf16 v25, v20, v44
v_dot2c_f32_bf16 v26, v20, v52
v_dot2c_f32_bf16 v27, v20, v60
v_dot2c_f32_bf16 v28, v20, v68
v_dot2c_f32_bf16 v29, v20, v76
v_dot2c_f32_bf16 v30, v20, v84
v_dot2c_f32_bf16 v31, v20, v92
v_dot2c_f32_bf16 v24, v21, v37
v_dot2c_f32_bf16 v25, v21, v45
v_dot2c_f32_bf16 v26, v21, v53
v_dot2c_f32_bf16 v27, v21, v61
v_dot2c_f32_bf16 v28, v21, v69
v_dot2c_f32_bf16 v29, v21, v77
v_dot2c_f32_bf16 v30, v21, v85
v_dot2c_f32_bf16 v31, v21, v93
v_dot2c_f32_bf16 v24, v22, v38
v_dot2c_f32_bf16 v25, v22, v46
v_dot2c_f32_bf16 v26, v22, v54
v_dot2c_f32_bf16 v27, v22, v62
v_dot2c_f32_bf16 v28, v22, v70
v_dot2c_f32_bf16 v29, v22, v78
v_dot2c_f32_bf16 v30, v22, v86
v_dot2c_f32_bf16 v31, v22, v94
v_dot2c_f32_bf16 v24, v23, v39
buffer_load_dwordx4 v4, s[24:27], s64 offen offset:3072 sc1 lds
v_dot2c_f32_bf16 v25, v23, v47
v_dot2c_f32_bf16 v26, v23, v55
v_dot2c_f32_bf16 v27, v23, v63
v_dot2c_f32_bf16 v28, v23, v71
v_dot2c_f32_bf16 v29, v23, v79
v_dot2c_f32_bf16 v30, v23, v87
v_dot2c_f32_bf16 v31, v23, v95
v_mov_b32 v9, 0xf149f2ca
v_mul_f32 v11, 0xbfb8aa3b, v11
v_exp_f32 v11, v11
v_cmp_gt_u32 vcc, 2, v5
v_cmp_gt_u32 s[56:57], 4, v5
s_nop 0
v_cndmask_b32 v25, v25, v9, vcc
v_cndmask_b32 v26, v26, v9, s[56:57]
v_cmp_gt_u32 vcc, 6, v5
v_cmp_gt_u32 s[56:57], 8, v5
s_nop 0
v_cndmask_b32 v27, v27, v9, vcc
v_cndmask_b32 v28, v28, v9, s[56:57]
v_cmp_gt_u32 vcc, 10, v5
v_cmp_gt_u32 s[56:57], 12, v5
s_nop 0
v_cndmask_b32 v29, v29, v9, vcc
v_cndmask_b32 v30, v30, v9, s[56:57]
s_mov_b32 m0, s70
s_mov_b32 s64, s68
s_add_u32 s68, s68, 16384
s_add_u32 s70, s70, 16384
s_cmp_ge_u32 s70, 163840
s_cselect_b32 s70, s80, s70
buffer_load_dwordx4 v4, s[24:27], s64 offen offset:0 sc1 lds
v_cmp_gt_u32 vcc, 14, v5
s_nop 0
s_nop 0
v_cndmask_b32 v31, v31, v9, vcc
v_max3_f32 v10, v24, v25, v26
v_max3_f32 v10, v10, v27, v28
v_max3_f32 v10, v10, v29, v30
v_max_f32 v10, v10, v31
s_mov_b32 s52, 0x3eae1a93
v_sub_f32 v24, v24, v10
v_sub_f32 v25, v25, v10
v_sub_f32 v26, v26, v10
v_sub_f32 v27, v27, v10
v_sub_f32 v28, v28, v10
v_sub_f32 v29, v29, v10
v_sub_f32 v30, v30, v10
v_sub_f32 v31, v31, v10
v_mul_f32 v24, s52, v24
v_mul_f32 v25, s52, v25
v_mul_f32 v26, s52, v26
v_mul_f32 v27, s52, v27
v_mul_f32 v28, s52, v28
v_mul_f32 v29, s52, v29
v_mul_f32 v30, s52, v30
v_mul_f32 v31, s52, v31
buffer_load_dwordx4 v4, s[24:27], s64 offen offset:1024 sc1 lds
v_exp_f32 v24, v24
v_exp_f32 v25, v25
v_exp_f32 v26, v26
v_exp_f32 v27, v27
v_exp_f32 v28, v28
v_exp_f32 v29, v29
v_exp_f32 v30, v30
v_exp_f32 v31, v31
v_cvt_pk_bf16_f32 v32, v24, 0
v_cvt_pk_bf16_f32 v40, v25, 0
v_cvt_pk_bf16_f32 v48, v26, 0
v_cvt_pk_bf16_f32 v56, v27, 0
v_cvt_pk_bf16_f32 v64, v28, 0
v_cvt_pk_bf16_f32 v72, v29, 0
v_cvt_pk_bf16_f32 v80, v30, 0
v_cvt_pk_bf16_f32 v88, v31, 0
v_lshlrev_b32 v33, 16, v32
v_lshlrev_b32 v41, 16, v40
v_lshlrev_b32 v49, 16, v48
v_lshlrev_b32 v57, 16, v56
v_lshlrev_b32 v65, 16, v64
v_lshlrev_b32 v73, 16, v72
v_lshlrev_b32 v81, 16, v80
v_lshlrev_b32 v89, 16, v88
v_add_f32 v10, v33, v41
s_waitcnt vmcnt(6)
buffer_atomic_add v1, v0, s[24:27], s74 offen offset:0 sc1
buffer_load_dwordx4 v4, s[24:27], s64 offen offset:2048 sc1 lds
v_add_f32 v10, v10, v49
v_add_f32 v10, v10, v57
v_add_f32 v10, v10, v65
v_add_f32 v10, v10, v73
v_add_f32 v10, v10, v81
v_add_f32 v10, v10, v89
v_fmac_f32 v10, v10, v11
v_rcp_f32 v10, v10
v_dot2_f32_bf16 v192, v128, v32, 0
v_dot2_f32_bf16 v193, v128, v33, 0
v_dot2_f32_bf16 v194, v129, v32, 0
v_dot2_f32_bf16 v195, v129, v33, 0
buffer_load_dwordx4 v4, s[24:27], s64 offen offset:3072 sc1 lds
v_dot2_f32_bf16 v196, v130, v32, 0
v_dot2_f32_bf16 v197, v130, v33, 0
v_dot2_f32_bf16 v198, v131, v32, 0
v_dot2_f32_bf16 v199, v131, v33, 0
v_dot2_f32_bf16 v200, v132, v32, 0
v_dot2_f32_bf16 v201, v132, v33, 0
v_dot2_f32_bf16 v202, v133, v32, 0
v_dot2_f32_bf16 v203, v133, v33, 0
v_dot2_f32_bf16 v204, v134, v32, 0
v_dot2_f32_bf16 v205, v134, v33, 0
v_dot2_f32_bf16 v206, v135, v32, 0
v_dot2_f32_bf16 v207, v135, v33, 0
s_mov_b32 m0, s70
s_mov_b32 s64, s68
s_add_u32 s68, s68, 16384
s_add_u32 s70, s70, 16384
s_cmp_ge_u32 s70, 163840
s_cselect_b32 s70, s80, s70
buffer_load_dwordx4 v4, s[24:27], s64 offen offset:0 sc1 lds
v_dot2_f32_bf16 v208, v96, v33, 0
v_dot2_f32_bf16 v209, v98, v33, 0
v_dot2c_f32_bf16 v192, v136, v40
v_dot2c_f32_bf16 v193, v136, v41
v_dot2c_f32_bf16 v194, v137, v40
v_dot2c_f32_bf16 v195, v137, v41
v_dot2c_f32_bf16 v196, v138, v40
v_dot2c_f32_bf16 v197, v138, v41
v_dot2c_f32_bf16 v198, v139, v40
v_dot2c_f32_bf16 v199, v139, v41
v_dot2c_f32_bf16 v200, v140, v40
v_dot2c_f32_bf16 v201, v140, v41
buffer_load_dwordx4 v4, s[24:27], s64 offen offset:1024 sc1 lds
v_dot2c_f32_bf16 v202, v141, v40
v_dot2c_f32_bf16 v203, v141, v41
v_dot2c_f32_bf16 v204, v142, v40
v_dot2c_f32_bf16 v205, v142, v41
v_dot2c_f32_bf16 v206, v143, v40
v_dot2c_f32_bf16 v207, v143, v41
v_dot2c_f32_bf16 v208, v100, v41
v_dot2c_f32_bf16 v209, v102, v41
v_dot2c_f32_bf16 v192, v144, v48
v_dot2c_f32_bf16 v193, v144, v49
v_dot2c_f32_bf16 v194, v145, v48
v_dot2c_f32_bf16 v195, v145, v49
buffer_load_dwordx4 v4, s[24:27], s64 offen offset:2048 sc1 lds
v_dot2c_f32_bf16 v196, v146, v48
v_dot2c_f32_bf16 v197, v146, v49
v_dot2c_f32_bf16 v198, v147, v48
v_dot2c_f32_bf16 v199, v147, v49
v_dot2c_f32_bf16 v200, v148, v48
v_dot2c_f32_bf16 v201, v148, v49
v_dot2c_f32_bf16 v202, v149, v48
v_dot2c_f32_bf16 v203, v149, v49
v_dot2c_f32_bf16 v204, v150, v48
v_dot2c_f32_bf16 v205, v150, v49
v_dot2c_f32_bf16 v206, v151, v48
v_dot2c_f32_bf16 v207, v151, v49
buffer_load_dwordx4 v4, s[24:27], s64 offen offset:3072 sc1 lds
v_dot2c_f32_bf16 v208, v104, v49
v_dot2c_f32_bf16 v209, v106, v49
v_dot2c_f32_bf16 v192, v152, v56
v_dot2c_f32_bf16 v193, v152, v57
v_dot2c_f32_bf16 v194, v153, v56
v_dot2c_f32_bf16 v195, v153, v57
v_dot2c_f32_bf16 v196, v154, v56
v_dot2c_f32_bf16 v197, v154, v57
v_dot2c_f32_bf16 v198, v155, v56
v_dot2c_f32_bf16 v199, v155, v57
v_dot2c_f32_bf16 v200, v156, v56
v_dot2c_f32_bf16 v201, v156, v57
s_mov_b32 m0, s70
s_mov_b32 s64, s68
s_add_u32 s68, s68, 16384
s_add_u32 s70, s70, 16384
s_cmp_ge_u32 s70, 163840
s_cselect_b32 s70, s80, s70
buffer_load_dwordx4 v4, s[24:27], s64 offen offset:0 sc1 lds
v_dot2c_f32_bf16 v202, v157, v56
v_dot2c_f32_bf16 v203, v157, v57
v_dot2c_f32_bf16 v204, v158, v56
v_dot2c_f32_bf16 v205, v158, v57
v_dot2c_f32_bf16 v206, v159, v56
v_dot2c_f32_bf16 v207, v159, v57
v_dot2c_f32_bf16 v208, v108, v57
v_dot2c_f32_bf16 v209, v110, v57
v_dot2c_f32_bf16 v192, v160, v64
v_dot2c_f32_bf16 v193, v160, v65
v_dot2c_f32_bf16 v194, v161, v64
v_dot2c_f32_bf16 v195, v161, v65
buffer_load_dwordx4 v4, s[24:27], s64 offen offset:1024 sc1 lds
v_dot2c_f32_bf16 v196, v162, v64
v_dot2c_f32_bf16 v197, v162, v65
v_dot2c_f32_bf16 v198, v163, v64
v_dot2c_f32_bf16 v199, v163, v65
v_dot2c_f32_bf16 v200, v164, v64
v_dot2c_f32_bf16 v201, v164, v65
v_dot2c_f32_bf16 v202, v165, v64
v_dot2c_f32_bf16 v203, v165, v65
v_dot2c_f32_bf16 v204, v166, v64
v_dot2c_f32_bf16 v205, v166, v65
v_dot2c_f32_bf16 v206, v167, v64
v_dot2c_f32_bf16 v207, v167, v65
buffer_load_dwordx4 v4, s[24:27], s64 offen offset:2048 sc1 lds
v_dot2c_f32_bf16 v208, v112, v65
v_dot2c_f32_bf16 v209, v114, v65
v_dot2c_f32_bf16 v192, v168, v72
v_dot2c_f32_bf16 v193, v168, v73
v_dot2c_f32_bf16 v194, v169, v72
v_dot2c_f32_bf16 v195, v169, v73
v_dot2c_f32_bf16 v196, v170, v72
v_dot2c_f32_bf16 v197, v170, v73
v_dot2c_f32_bf16 v198, v171, v72
v_dot2c_f32_bf16 v199, v171, v73
v_dot2c_f32_bf16 v200, v172, v72
v_dot2c_f32_bf16 v201, v172, v73
buffer_load_dword v12, v13, s[24:27], s75 offen sc1
v_dot2c_f32_bf16 v202, v173, v72
v_dot2c_f32_bf16 v203, v173, v73
v_dot2c_f32_bf16 v204, v174, v72
v_dot2c_f32_bf16 v205, v174, v73
v_dot2c_f32_bf16 v206, v175, v72
v_dot2c_f32_bf16 v207, v175, v73
v_dot2c_f32_bf16 v208, v116, v73
v_dot2c_f32_bf16 v209, v118, v73
v_dot2c_f32_bf16 v192, v176, v80
v_dot2c_f32_bf16 v193, v176, v81
v_dot2c_f32_bf16 v194, v177, v80
v_dot2c_f32_bf16 v195, v177, v81
buffer_load_dwordx4 v4, s[24:27], s64 offen offset:3072 sc1 lds
v_dot2c_f32_bf16 v196, v178, v80
v_dot2c_f32_bf16 v197, v178, v81
v_dot2c_f32_bf16 v198, v179, v80
v_dot2c_f32_bf16 v199, v179, v81
v_dot2c_f32_bf16 v200, v180, v80
v_dot2c_f32_bf16 v201, v180, v81
v_dot2c_f32_bf16 v202, v181, v80
v_dot2c_f32_bf16 v203, v181, v81
v_dot2c_f32_bf16 v204, v182, v80
v_dot2c_f32_bf16 v205, v182, v81
v_dot2c_f32_bf16 v206, v183, v80
v_dot2c_f32_bf16 v207, v183, v81
s_mov_b32 m0, s70
s_mov_b32 s64, s68
s_add_u32 s68, s68, 16384
s_add_u32 s70, s70, 16384
s_cmp_ge_u32 s70, 163840
s_cselect_b32 s70, s80, s70
buffer_load_dwordx4 v4, s[24:27], s64 offen offset:0 sc1 lds
v_dot2c_f32_bf16 v208, v120, v81
v_dot2c_f32_bf16 v209, v122, v81
v_dot2c_f32_bf16 v192, v184, v88
v_dot2c_f32_bf16 v193, v184, v89
v_dot2c_f32_bf16 v194, v185, v88
v_dot2c_f32_bf16 v195, v185, v89
v_dot2c_f32_bf16 v196, v186, v88
v_dot2c_f32_bf16 v197, v186, v89
v_dot2c_f32_bf16 v198, v187, v88
v_dot2c_f32_bf16 v199, v187, v89
v_dot2c_f32_bf16 v200, v188, v88
v_dot2c_f32_bf16 v201, v188, v89
buffer_load_dwordx4 v4, s[24:27], s64 offen offset:1024 sc1 lds
v_dot2c_f32_bf16 v202, v189, v88
v_dot2c_f32_bf16 v203, v189, v89
v_dot2c_f32_bf16 v204, v190, v88
v_dot2c_f32_bf16 v205, v190, v89
v_dot2c_f32_bf16 v206, v191, v88
v_dot2c_f32_bf16 v207, v191, v89
v_dot2c_f32_bf16 v208, v124, v89
v_dot2c_f32_bf16 v209, v126, v89
v_lshrrev_b32 v9, 5, v5
v_mul_u32_u24 v9, 303104, v9
v_and_b32 v11, 1, v3
v_lshl_add_u32 v9, v11, 10, v9
buffer_load_dwordx4 v4, s[24:27], s64 offen offset:2048 sc1 lds
v_lshl_add_u32 v9, v2, 4, v9
v_mul_f32 v192, v10, v192
v_mul_f32 v193, v10, v193
v_mul_f32 v194, v10, v194
v_mul_f32 v195, v10, v195
v_mul_f32 v196, v10, v196
v_mul_f32 v197, v10, v197
v_mul_f32 v198, v10, v198
v_mul_f32 v199, v10, v199
v_mul_f32 v200, v10, v200
v_mul_f32 v201, v10, v201
v_mul_f32 v202, v10, v202
buffer_load_dwordx4 v4, s[24:27], s64 offen offset:3072 sc1 lds
v_mul_f32 v203, v10, v203
v_mul_f32 v204, v10, v204
v_mul_f32 v205, v10, v205
v_mul_f32 v206, v10, v206
v_mul_f32 v207, v10, v207
v_mul_f32 v208, v10, v208
v_mul_f32 v209, v10, v209
v_cvt_pk_bf16_f32 v192, v192, v193
v_cvt_pk_bf16_f32 v193, v194, v195
v_cvt_pk_bf16_f32 v194, v196, v197
v_cvt_pk_bf16_f32 v195, v198, v199
v_cvt_pk_bf16_f32 v196, v200, v201
v_cvt_pk_bf16_f32 v197, v202, v203
v_cvt_pk_bf16_f32 v198, v204, v205
v_cvt_pk_bf16_f32 v199, v206, v207
v_cvt_pk_bf16_f32 v200, v208, v209
s_add_u32 s53, s53, 65536
s_bfe_u32 s54, s4, 131073
s_lshl_b32 s54, s54, 11
s_add_u32 s54, s54, s53
s_and_b32 s55, s4, 1
s_lshl_b32 s55, s55, 9
s_add_u32 s54, s54, s55
s_lshl2_add_u32 s52, s85, s86
s_lshl2_add_u32 s69, s52, s3
s_mul_i32 s69, s69, 28672
s_add_u32 s69, s69, 76546048
s_lshr_b32 s73, s52, 1
s_lshl_b32 s73, s73, 10
s_and_b32 s52, s52, 1
s_lshl_b32 s52, s52, 7
s_add_u32 s73, s73, s52
s_lshl2_add_u32 s73, s3, s73
s_add_u32 s73, s73, 75498112
ds_read_b128 v[144:147], v7 offset:0
ds_read_b128 v[148:151], v7 offset:1024
ds_read_b128 v[152:155], v7 offset:2048
ds_read_b128 v[156:159], v7 offset:3072
ds_read_b128 v[160:163], v7 offset:4096
ds_read_b128 v[164:167], v7 offset:5120
ds_read_b128 v[168:171], v7 offset:6144
ds_read_b128 v[172:175], v7 offset:7168
v_mov_b32 v10, 0
s_waitcnt vmcnt(5)
v_cmp_gt_u32 vcc, 8, v12
s_mov_b32 s92, 0
s_nop 3
s_cbranch_vccz L_ZBX
L_ZB:
s_sleep 2
buffer_load_dword v12, v13, s[24:27], s75 offen sc1
s_add_u32 s92, s92, 1
s_waitcnt vmcnt(0)
v_cmp_gt_u32 vcc, 8, v12
s_cmp_gt_u32 s92, 0x20000
s_cbranch_scc1 L_ZBX
s_nop 2
s_cbranch_vccnz L_ZB
L_ZBX:
s_xor_b32 s65, s82, 0
s_add_u32 s65, s65, s77
buffer_load_dwordx4 a[0:3], v4, s[24:27], s65 offen offset:0 sc1
buffer_load_dwordx4 a[8:11], v4, s[24:27], s65 offen offset:2048 sc1
s_xor_b32 s93, s82, 0
s_add_u32 s93, s93, s81
buffer_load_dwordx4 a[4:7], v4, s[24:27], s93 offen offset:0 sc1
buffer_load_dwordx4 a[12:15], v4, s[24:27], s93 offen offset:2048 sc1
buffer_load_dwordx4 a[16:19], v14, s[24:27], s65 offen offset:0 sc1
buffer_load_dwordx4 a[24:27], v14, s[24:27], s65 offen offset:2048 sc1
buffer_load_dwordx4 a[20:23], v14, s[24:27], s93 offen offset:0 sc1
buffer_load_dwordx4 a[28:31], v14, s[24:27], s93 offen offset:2048 sc1
buffer_store_dwordx4 v[192:195], v9, s[24:27], s54 offen sc1
buffer_store_dwordx4 v[196:199], v9, s[24:27], s54 offen offset:256 sc1
s_bfe_u32 s55, s4, 65538
s_lshl_b32 s55, s55, 8
s_add_u32 s54, s53, s55
s_and_b32 s55, s4, 3
s_lshl2_add_u32 s54, s55, s54
s_add_u32 s54, s54, 8192
buffer_store_dword v200, v9, s[24:27], s54 offen sc1
s_waitcnt vmcnt(9) lgkmcnt(6)
v_mfma_f32_16x16x32_bf16 v[120:123], v[144:147], a[0:3], 0
s_waitcnt vmcnt(7)
s_add_u32 s91, s91, 16384
ds_read_b128 v[176:179], v7 offset:8192
v_mfma_f32_16x16x32_bf16 v[120:123], v[148:151], a[8:11], v[120:123]
s_xor_b32 s65, s82, 8192
s_add_u32 s65, s65, s77
ds_read_b128 v[180:183], v7 offset:9216
v_mfma_f32_16x16x32_bf16 v[124:127], v[148:151], a[12:15], 0
s_waitcnt lgkmcnt(6)
ds_read_b128 v[184:187], v7 offset:10240
v_mfma_f32_16x16x32_bf16 v[124:127], v[144:147], a[4:7], v[124:127]
buffer_load_dwordx4 a[32:35], v4, s[24:27], s65 offen offset:0 sc1
v_mfma_f32_16x16x32_bf16 v[72:75], v[152:155], a[0:3], 0
s_cmp_ge_u32 s91, 163840
s_cselect_b32 s91, 0, s91
ds_read_b128 v[188:191], v7 offset:11264
v_mfma_f32_16x16x32_bf16 v[72:75], v[156:159], a[8:11], v[72:75]
s_waitcnt lgkmcnt(6)
v_add_u32 v8, s91, v4
v_mfma_f32_16x16x32_bf16 v[76:79], v[156:159], a[12:15], 0
buffer_load_dwordx4 a[40:43], v4, s[24:27], s65 offen offset:2048 sc1
v_mfma_f32_16x16x32_bf16 v[76:79], v[152:155], a[4:7], v[76:79]
s_xor_b32 s93, s82, 8192
s_add_u32 s93, s93, s81
ds_read_b128 v[144:147], v7 offset:12288
v_mfma_f32_16x16x32_bf16 v[80:83], v[160:163], a[0:3], 0
ds_read_b128 v[148:151], v7 offset:13312
v_mfma_f32_16x16x32_bf16 v[80:83], v[164:167], a[8:11], v[80:83]
buffer_load_dwordx4 a[36:39], v4, s[24:27], s93 offen offset:0 sc1
v_mfma_f32_16x16x32_bf16 v[84:87], v[164:167], a[12:15], 0
ds_read_b128 v[152:155], v7 offset:14336
v_mfma_f32_16x16x32_bf16 v[84:87], v[160:163], a[4:7], v[84:87]
s_waitcnt lgkmcnt(7)
v_mfma_f32_16x16x32_bf16 v[88:91], v[168:171], a[0:3], 0
buffer_load_dwordx4 a[44:47], v4, s[24:27], s93 offen offset:2048 sc1
v_mfma_f32_16x16x32_bf16 v[88:91], v[172:175], a[8:11], v[88:91]
ds_read_b128 v[156:159], v7 offset:15360
v_mfma_f32_16x16x32_bf16 v[92:95], v[172:175], a[12:15], 0
s_waitcnt lgkmcnt(6)
s_add_u32 s91, s91, 16384
ds_read_b128 v[160:163], v8 offset:0
v_mfma_f32_16x16x32_bf16 v[92:95], v[168:171], a[4:7], v[92:95]
buffer_load_dwordx4 a[48:51], v14, s[24:27], s65 offen offset:0 sc1
v_mfma_f32_16x16x32_bf16 v[96:99], v[176:179], a[0:3], 0
s_cmp_ge_u32 s91, 163840
s_cselect_b32 s91, 0, s91
ds_read_b128 v[164:167], v8 offset:1024
v_mfma_f32_16x16x32_bf16 v[96:99], v[180:183], a[8:11], v[96:99]
v_add_u32 v7, s91, v4
v_mfma_f32_16x16x32_bf16 v[100:103], v[180:183], a[12:15], 0
buffer_load_dwordx4 a[56:59], v14, s[24:27], s65 offen offset:2048 sc1
v_mfma_f32_16x16x32_bf16 v[100:103], v[176:179], a[4:7], v[100:103]
s_waitcnt lgkmcnt(6)
ds_read_b128 v[168:171], v8 offset:2048
v_mfma_f32_16x16x32_bf16 v[104:107], v[184:187], a[0:3], 0
ds_read_b128 v[172:175], v8 offset:3072
v_mfma_f32_16x16x32_bf16 v[104:107], v[188:191], a[8:11], v[104:107]
v_mfma_f32_16x16x32_bf16 v[108:111], v[188:191], a[12:15], 0
buffer_load_dwordx4 a[52:55], v14, s[24:27], s93 offen offset:0 sc1
v_mfma_f32_16x16x32_bf16 v[108:111], v[184:187], a[4:7], v[108:111]
s_waitcnt lgkmcnt(6)
ds_read_b128 v[176:179], v8 offset:4096
v_mfma_f32_16x16x32_bf16 v[112:115], v[144:147], a[0:3], 0
ds_read_b128 v[180:183], v8 offset:5120
v_mfma_f32_16x16x32_bf16 v[112:115], v[148:151], a[8:11], v[112:115]
v_mfma_f32_16x16x32_bf16 v[116:119], v[148:151], a[12:15], 0
buffer_load_dwordx4 a[60:63], v14, s[24:27], s93 offen offset:2048 sc1
v_mfma_f32_16x16x32_bf16 v[116:119], v[144:147], a[4:7], v[116:119]
s_waitcnt lgkmcnt(6) vmcnt(13)
ds_read_b128 v[184:187], v8 offset:6144
v_mfma_f32_16x16x32_bf16 v[120:123], v[152:155], a[16:19], v[120:123]
ds_read_b128 v[188:191], v8 offset:7168
v_mfma_f32_16x16x32_bf16 v[120:123], v[156:159], a[24:27], v[120:123]
s_waitcnt vmcnt(11)
v_mfma_f32_16x16x32_bf16 v[124:127], v[156:159], a[28:31], v[124:127]
ds_read_b128 v[144:147], v8 offset:8192
v_mfma_f32_16x16x32_bf16 v[124:127], v[152:155], a[20:23], v[124:127]
s_waitcnt lgkmcnt(7)
v_mfma_f32_16x16x32_bf16 v[72:75], v[160:163], a[16:19], v[72:75]
ds_read_b128 v[148:151], v8 offset:9216
v_mfma_f32_16x16x32_bf16 v[72:75], v[164:167], a[24:27], v[72:75]
v_mfma_f32_16x16x32_bf16 v[76:79], v[164:167], a[28:31], v[76:79]
ds_read_b128 v[152:155], v8 offset:10240
v_mfma_f32_16x16x32_bf16 v[76:79], v[160:163], a[20:23], v[76:79]
s_waitcnt lgkmcnt(7)
v_mfma_f32_16x16x32_bf16 v[80:83], v[168:171], a[16:19], v[80:83]
ds_read_b128 v[156:159], v8 offset:11264
v_mfma_f32_16x16x32_bf16 v[80:83], v[172:175], a[24:27], v[80:83]
v_mfma_f32_16x16x32_bf16 v[84:87], v[172:175], a[28:31], v[84:87]
ds_read_b128 v[160:163], v8 offset:12288
v_mfma_f32_16x16x32_bf16 v[84:87], v[168:171], a[20:23], v[84:87]
s_waitcnt lgkmcnt(7)
v_mfma_f32_16x16x32_bf16 v[88:91], v[176:179], a[16:19], v[88:91]
s_xor_b32 s65, s82, 16384
s_add_u32 s65, s65, s77
ds_read_b128 v[164:167], v8 offset:13312
v_mfma_f32_16x16x32_bf16 v[88:91], v[180:183], a[24:27], v[88:91]
v_mfma_f32_16x16x32_bf16 v[92:95], v[180:183], a[28:31], v[92:95]
s_waitcnt lgkmcnt(6)
ds_read_b128 v[168:171], v8 offset:14336
v_add_u32 v11, s70, v4
v_mfma_f32_16x16x32_bf16 v[92:95], v[176:179], a[20:23], v[92:95]
s_add_u32 s70, s70, 16384
s_cmp_ge_u32 s70, 163840
s_cselect_b32 s70, s80, s70
v_mfma_f32_16x16x32_bf16 v[96:99], v[184:187], a[16:19], v[96:99]
buffer_load_dwordx4 a[64:67], v4, s[24:27], s65 offen offset:0 sc1
v_mfma_f32_16x16x32_bf16 v[96:99], v[188:191], a[24:27], v[96:99]
s_barrier
v_mfma_f32_16x16x32_bf16 v[100:103], v[188:191], a[28:31], v[100:103]
s_waitcnt lgkmcnt(5)
ds_read_b128 v[172:175], v8 offset:15360
v_mfma_f32_16x16x32_bf16 v[100:103], v[184:187], a[20:23], v[100:103]
buffer_load_dwordx4 a[72:75], v4, s[24:27], s65 offen offset:2048 sc1
v_mfma_f32_16x16x32_bf16 v[104:107], v[144:147], a[16:19], v[104:107]
ds_write_b64 v11, a[96:97] offset:0
v_mfma_f32_16x16x32_bf16 v[104:107], v[148:151], a[24:27], v[104:107]
s_xor_b32 s93, s82, 16384
s_add_u32 s93, s93, s81
ds_read_b128 v[176:179], v7 offset:0
v_mfma_f32_16x16x32_bf16 v[108:111], v[148:151], a[28:31], v[108:111]
buffer_load_dwordx4 a[68:71], v4, s[24:27], s93 offen offset:0 sc1
v_mfma_f32_16x16x32_bf16 v[108:111], v[144:147], a[20:23], v[108:111]
s_waitcnt lgkmcnt(6)
s_add_u32 s91, s91, 16384
ds_read_b128 v[180:183], v7 offset:1024
v_mfma_f32_16x16x32_bf16 v[112:115], v[152:155], a[16:19], v[112:115]
ds_write_b64 v11, a[98:99] offset:8
v_mfma_f32_16x16x32_bf16 v[112:115], v[156:159], a[24:27], v[112:115]
s_cmp_ge_u32 s91, 163840
s_cselect_b32 s91, 0, s91
ds_read_b128 v[184:187], v7 offset:2048
v_mfma_f32_16x16x32_bf16 v[116:119], v[156:159], a[28:31], v[116:119]
buffer_load_dwordx4 a[76:79], v4, s[24:27], s93 offen offset:2048 sc1
v_mfma_f32_16x16x32_bf16 v[116:119], v[152:155], a[20:23], v[116:119]
s_waitcnt lgkmcnt(7) vmcnt(10)
ds_read_b128 v[188:191], v7 offset:3072
v_add_u32 v8, s91, v4
v_mfma_f32_16x16x32_bf16 v[120:123], v[160:163], a[32:35], v[120:123]
s_waitcnt vmcnt(12)
s_waitcnt vmcnt(8)
ds_read_b128 v[144:147], v7 offset:4096
v_mfma_f32_16x16x32_bf16 v[120:123], v[164:167], a[40:43], v[120:123]
buffer_atomic_add v1, v0, s[24:27], s74 offen offset:4 sc1
v_mfma_f32_16x16x32_bf16 v[124:127], v[164:167], a[44:47], v[124:127]
ds_write_b64 v11, a[100:101] offset:1024
v_mfma_f32_16x16x32_bf16 v[124:127], v[160:163], a[36:39], v[124:127]
s_waitcnt lgkmcnt(8)
ds_read_b128 v[148:151], v7 offset:5120
v_mfma_f32_16x16x32_bf16 v[72:75], v[168:171], a[32:35], v[72:75]
ds_read_b128 v[152:155], v7 offset:6144
v_mfma_f32_16x16x32_bf16 v[72:75], v[172:175], a[40:43], v[72:75]
ds_read_b128 v[156:159], v7 offset:7168
v_mfma_f32_16x16x32_bf16 v[76:79], v[172:175], a[44:47], v[76:79]
ds_write_b64 v11, a[102:103] offset:1032
v_mfma_f32_16x16x32_bf16 v[76:79], v[168:171], a[36:39], v[76:79]
s_waitcnt lgkmcnt(9)
ds_read_b128 v[160:163], v7 offset:8192
v_mfma_f32_16x16x32_bf16 v[80:83], v[176:179], a[32:35], v[80:83]
ds_read_b128 v[164:167], v7 offset:9216
v_mfma_f32_16x16x32_bf16 v[80:83], v[180:183], a[40:43], v[80:83]
v_mfma_f32_16x16x32_bf16 v[84:87], v[180:183], a[44:47], v[84:87]
ds_write_b64 v11, a[104:105] offset:2048
v_mfma_f32_16x16x32_bf16 v[84:87], v[176:179], a[36:39], v[84:87]
s_waitcnt lgkmcnt(9)
ds_read_b128 v[168:171], v7 offset:10240
v_mfma_f32_16x16x32_bf16 v[88:91], v[184:187], a[32:35], v[88:91]
ds_read_b128 v[172:175], v7 offset:11264
v_mfma_f32_16x16x32_bf16 v[88:91], v[188:191], a[40:43], v[88:91]
s_waitcnt lgkmcnt(8)
v_mfma_f32_16x16x32_bf16 v[92:95], v[188:191], a[44:47], v[92:95]
ds_write_b64 v11, a[106:107] offset:2056
v_mfma_f32_16x16x32_bf16 v[92:95], v[184:187], a[36:39], v[92:95]
buffer_load_dwordx4 a[80:83], v14, s[24:27], s65 offen offset:0 sc1
v_mfma_f32_16x16x32_bf16 v[96:99], v[144:147], a[32:35], v[96:99]
ds_read_b128 v[176:179], v7 offset:12288
v_mfma_f32_16x16x32_bf16 v[96:99], v[148:151], a[40:43], v[96:99]
s_waitcnt lgkmcnt(8)
ds_read_b128 v[180:183], v7 offset:13312
v_mfma_f32_16x16x32_bf16 v[100:103], v[148:151], a[44:47], v[100:103]
ds_write_b64 v11, a[108:109] offset:3072
v_mfma_f32_16x16x32_bf16 v[100:103], v[144:147], a[36:39], v[100:103]
buffer_load_dwordx4 a[88:91], v14, s[24:27], s65 offen offset:2048 sc1
v_mfma_f32_16x16x32_bf16 v[104:107], v[152:155], a[32:35], v[104:107]
ds_read_b128 v[184:187], v7 offset:14336
v_mfma_f32_16x16x32_bf16 v[104:107], v[156:159], a[40:43], v[104:107]
s_waitcnt lgkmcnt(8)
ds_read_b128 v[188:191], v7 offset:15360
v_mfma_f32_16x16x32_bf16 v[108:111], v[156:159], a[44:47], v[108:111]
ds_write_b64 v11, a[110:111] offset:3080
v_mfma_f32_16x16x32_bf16 v[108:111], v[152:155], a[36:39], v[108:111]
buffer_load_dwordx4 a[84:87], v14, s[24:27], s93 offen offset:0 sc1
v_mfma_f32_16x16x32_bf16 v[112:115], v[160:163], a[32:35], v[112:115]
s_add_u32 s91, s91, 16384
ds_read_b128 v[144:147], v8 offset:0
v_mfma_f32_16x16x32_bf16 v[112:115], v[164:167], a[40:43], v[112:115]
s_cmp_ge_u32 s91, 163840
s_cselect_b32 s91, 0, s91
ds_read_b128 v[148:151], v8 offset:1024
v_mfma_f32_16x16x32_bf16 v[116:119], v[164:167], a[44:47], v[116:119]
buffer_load_dwordx4 a[92:95], v14, s[24:27], s93 offen offset:2048 sc1
v_mfma_f32_16x16x32_bf16 v[116:119], v[160:163], a[36:39], v[116:119]
s_waitcnt lgkmcnt(9) vmcnt(11)
ds_read_b128 v[152:155], v8 offset:2048
v_add_u32 v7, s91, v4
v_mfma_f32_16x16x32_bf16 v[120:123], v[168:171], a[48:51], v[120:123]
ds_read_b128 v[156:159], v8 offset:3072
v_mfma_f32_16x16x32_bf16 v[120:123], v[172:175], a[56:59], v[120:123]
s_waitcnt vmcnt(9)
v_mfma_f32_16x16x32_bf16 v[124:127], v[172:175], a[60:63], v[124:127]
ds_read_b128 v[160:163], v8 offset:4096
v_mfma_f32_16x16x32_bf16 v[124:127], v[168:171], a[52:55], v[124:127]
s_waitcnt lgkmcnt(9)
v_mfma_f32_16x16x32_bf16 v[72:75], v[176:179], a[48:51], v[72:75]
ds_read_b128 v[164:167], v8 offset:5120
v_mfma_f32_16x16x32_bf16 v[72:75], v[180:183], a[56:59], v[72:75]
v_mfma_f32_16x16x32_bf16 v[76:79], v[180:183], a[60:63], v[76:79]
ds_read_b128 v[168:171], v8 offset:6144
v_mfma_f32_16x16x32_bf16 v[76:79], v[176:179], a[52:55], v[76:79]
s_xor_b32 s65, s82, 24576
s_add_u32 s65, s65, s77
s_waitcnt lgkmcnt(8)
v_mfma_f32_16x16x32_bf16 v[80:83], v[184:187], a[48:51], v[80:83]
ds_read_b128 v[172:175], v8 offset:7168
v_mfma_f32_16x16x32_bf16 v[80:83], v[188:191], a[56:59], v[80:83]
buffer_load_dwordx4 a[192:195], v4, s[24:27], s65 offen offset:0 sc1
v_mfma_f32_16x16x32_bf16 v[84:87], v[188:191], a[60:63], v[84:87]
ds_read_b128 v[176:179], v8 offset:8192
v_mfma_f32_16x16x32_bf16 v[84:87], v[184:187], a[52:55], v[84:87]
s_waitcnt lgkmcnt(7)
v_mfma_f32_16x16x32_bf16 v[88:91], v[144:147], a[48:51], v[88:91]
ds_read_b128 v[180:183], v8 offset:9216
v_mfma_f32_16x16x32_bf16 v[88:91], v[148:151], a[56:59], v[88:91]
v_mfma_f32_16x16x32_bf16 v[92:95], v[148:151], a[60:63], v[92:95]
s_waitcnt lgkmcnt(6)
ds_read_b128 v[184:187], v8 offset:10240
v_mfma_f32_16x16x32_bf16 v[92:95], v[144:147], a[52:55], v[92:95]
buffer_load_dwordx4 a[200:203], v4, s[24:27], s65 offen offset:2048 sc1
v_mfma_f32_16x16x32_bf16 v[96:99], v[152:155], a[48:51], v[96:99]
s_add_u32 s52, s84, 1
ds_read_b128 v[188:191], v8 offset:11264
v_mfma_f32_16x16x32_bf16 v[96:99], v[156:159], a[56:59], v[96:99]
v_mfma_f32_16x16x32_bf16 v[100:103], v[156:159], a[60:63], v[100:103]
s_xor_b32 s93, s82, 24576
s_add_u32 s93, s93, s81
ds_read_b128 v[144:147], v8 offset:12288
v_mfma_f32_16x16x32_bf16 v[100:103], v[152:155], a[52:55], v[100:103]
s_and_b32 s52, s52, 3
s_waitcnt lgkmcnt(7)
v_mfma_f32_16x16x32_bf16 v[104:107], v[160:163], a[48:51], v[104:107]
buffer_load_dwordx4 a[196:199], v4, s[24:27], s93 offen offset:0 sc1
v_mfma_f32_16x16x32_bf16 v[104:107], v[164:167], a[56:59], v[104:107]
s_waitcnt lgkmcnt(5)
ds_read_b128 v[148:151], v8 offset:13312
v_mfma_f32_16x16x32_bf16 v[108:111], v[164:167], a[60:63], v[108:111]
s_mul_i32 s52, s52, 6144
ds_read_b128 v[152:155], v8 offset:14336
v_add_u32 v11, s70, v4
v_mfma_f32_16x16x32_bf16 v[108:111], v[160:163], a[52:55], v[108:111]
s_add_u32 s70, s70, 16384
s_cmp_ge_u32 s70, 163840
s_cselect_b32 s70, s80, s70
v_mfma_f32_16x16x32_bf16 v[112:115], v[168:171], a[48:51], v[112:115]
s_waitcnt vmcnt(49)
ds_read_b128 v[156:159], v8 offset:15360
v_mfma_f32_16x16x32_bf16 v[112:115], v[172:175], a[56:59], v[112:115]
s_barrier
v_mfma_f32_16x16x32_bf16 v[116:119], v[172:175], a[60:63], v[116:119]
s_add_u32 s52, s52, s69
s_waitcnt lgkmcnt(6) vmcnt(10)
ds_read_b128 v[160:163], v7 offset:0
v_mfma_f32_16x16x32_bf16 v[116:119], v[168:171], a[52:55], v[116:119]
buffer_load_dwordx4 a[204:207], v4, s[24:27], s93 offen offset:2048 sc1
L_PAD11:
s_cbranch_execz L_MAIN
v_mfma_f32_16x16x32_bf16 v[120:123], v[176:179], a[64:67], v[120:123]
ds_write_b64 v11, a[112:113] offset:0
v_mfma_f32_16x16x32_bf16 v[120:123], v[180:183], a[72:75], v[120:123]
s_add_u32 s52, s52, 0
s_waitcnt vmcnt(9)
ds_read_b128 v[164:167], v7 offset:1024
v_mfma_f32_16x16x32_bf16 v[124:127], v[180:183], a[76:79], v[124:127]
s_add_u32 s91, s91, 16384
ds_read_b128 v[168:171], v7 offset:2048
v_mfma_f32_16x16x32_bf16 v[124:127], v[176:179], a[68:71], v[124:127]
s_waitcnt lgkmcnt(8)
s_cmp_ge_u32 s91, 163840
s_cselect_b32 s91, 0, s91
v_mfma_f32_16x16x32_bf16 v[72:75], v[184:187], a[64:67], v[72:75]
s_add_u32 s53, s84, 2
ds_read_b128 v[172:175], v7 offset:3072
v_add_u32 v8, s91, v4
v_mfma_f32_16x16x32_bf16 v[72:75], v[188:191], a[72:75], v[72:75]
ds_write_b64 v11, a[114:115] offset:8
v_mfma_f32_16x16x32_bf16 v[76:79], v[188:191], a[76:79], v[76:79]
buffer_load_dwordx4 a[208:211], v14, s[24:27], s65 offen offset:0 sc1
v_mfma_f32_16x16x32_bf16 v[76:79], v[184:187], a[68:71], v[76:79]
s_and_b32 s53, s53, 3
s_waitcnt lgkmcnt(8)
ds_read_b128 v[176:179], v7 offset:4096
v_mfma_f32_16x16x32_bf16 v[80:83], v[144:147], a[64:67], v[80:83]
ds_read_b128 v[180:183], v7 offset:5120
v_mfma_f32_16x16x32_bf16 v[80:83], v[148:151], a[72:75], v[80:83]
ds_write_b64 v11, a[116:117] offset:1024
v_mfma_f32_16x16x32_bf16 v[84:87], v[148:151], a[76:79], v[84:87]
s_mul_i32 s53, s53, 6144
s_waitcnt lgkmcnt(9)
ds_read_b128 v[184:187], v7 offset:6144
v_mfma_f32_16x16x32_bf16 v[84:87], v[144:147], a[68:71], v[84:87]
buffer_load_dwordx4 a[216:219], v14, s[24:27], s65 offen offset:2048 sc1
v_mfma_f32_16x16x32_bf16 v[88:91], v[152:155], a[64:67], v[88:91]
ds_read_b128 v[188:191], v7 offset:7168
v_mfma_f32_16x16x32_bf16 v[88:91], v[156:159], a[72:75], v[88:91]
s_add_u32 s53, s53, s69
s_waitcnt lgkmcnt(8)
v_mfma_f32_16x16x32_bf16 v[92:95], v[156:159], a[76:79], v[92:95]
ds_write_b64 v11, a[118:119] offset:1032
v_mfma_f32_16x16x32_bf16 v[92:95], v[152:155], a[68:71], v[92:95]
buffer_load_dwordx4 a[212:215], v14, s[24:27], s93 offen offset:0 sc1
v_mfma_f32_16x16x32_bf16 v[96:99], v[160:163], a[64:67], v[96:99]
s_add_u32 s53, s53, 2048
ds_read_b128 v[144:147], v7 offset:8192
v_mfma_f32_16x16x32_bf16 v[96:99], v[164:167], a[72:75], v[96:99]
ds_read_b128 v[148:151], v7 offset:9216
v_mfma_f32_16x16x32_bf16 v[100:103], v[164:167], a[76:79], v[100:103]
ds_write_b64 v11, a[120:121] offset:2048
v_mfma_f32_16x16x32_bf16 v[100:103], v[160:163], a[68:71], v[100:103]
s_add_u32 s54, s84, 3
s_waitcnt lgkmcnt(10)
ds_read_b128 v[152:155], v7 offset:10240
v_mfma_f32_16x16x32_bf16 v[104:107], v[168:171], a[64:67], v[104:107]
ds_read_b128 v[156:159], v7 offset:11264
v_mfma_f32_16x16x32_bf16 v[104:107], v[172:175], a[72:75], v[104:107]
buffer_load_dwordx4 a[220:223], v14, s[24:27], s93 offen offset:2048 sc1
v_mfma_f32_16x16x32_bf16 v[108:111], v[172:175], a[76:79], v[108:111]
s_and_b32 s54, s54, 3
s_waitcnt lgkmcnt(9)
ds_read_b128 v[160:163], v7 offset:12288
v_mfma_f32_16x16x32_bf16 v[108:111], v[168:171], a[68:71], v[108:111]
ds_write_b64 v11, a[122:123] offset:2056
v_mfma_f32_16x16x32_bf16 v[112:115], v[176:179], a[64:67], v[112:115]
ds_read_b128 v[164:167], v7 offset:13312
v_mfma_f32_16x16x32_bf16 v[112:115], v[180:183], a[72:75], v[112:115]
s_mul_i32 s54, s54, 6144
s_xor_b32 s65, s82, 32768
s_add_u32 s65, s65, s77
v_mfma_f32_16x16x32_bf16 v[116:119], v[180:183], a[76:79], v[116:119]
s_waitcnt lgkmcnt(9) vmcnt(10)
ds_read_b128 v[168:171], v7 offset:14336
v_mfma_f32_16x16x32_bf16 v[116:119], v[176:179], a[68:71], v[116:119]
ds_write_b64 v11, a[124:125] offset:3072
v_mfma_f32_16x16x32_bf16 v[120:123], v[184:187], a[80:83], v[120:123]
s_add_u32 s54, s54, s69
s_waitcnt vmcnt(8)
ds_read_b128 v[172:175], v7 offset:15360
v_mfma_f32_16x16x32_bf16 v[120:123], v[188:191], a[88:91], v[120:123]
buffer_load_dwordx4 a[224:227], v4, s[24:27], s65 offen offset:0 sc1
v_mfma_f32_16x16x32_bf16 v[124:127], v[188:191], a[92:95], v[124:127]
s_add_u32 s91, s91, 16384
ds_read_b128 v[176:179], v8 offset:0
v_mfma_f32_16x16x32_bf16 v[124:127], v[184:187], a[84:87], v[124:127]
s_add_u32 s54, s54, 4096
s_waitcnt lgkmcnt(10)
v_mfma_f32_16x16x32_bf16 v[72:75], v[144:147], a[80:83], v[72:75]
ds_write_b64 v11, a[126:127] offset:3080
v_mfma_f32_16x16x32_bf16 v[72:75], v[148:151], a[88:91], v[72:75]
s_waitcnt lgkmcnt(5)
ds_read_b128 v[180:183], v8 offset:1024
v_add_u32 v11, s70, v4
v_mfma_f32_16x16x32_bf16 v[76:79], v[148:151], a[92:95], v[76:79]
s_sub_u32 s55, s3, s84
s_add_u32 s70, s70, 16384
ds_read_b128 v[184:187], v8 offset:2048
v_mfma_f32_16x16x32_bf16 v[76:79], v[144:147], a[84:87], v[76:79]
s_cmp_ge_u32 s70, 163840
s_cselect_b32 s70, s80, s70
s_waitcnt lgkmcnt(10)
v_mfma_f32_16x16x32_bf16 v[80:83], v[152:155], a[80:83], v[80:83]
buffer_load_dwordx4 a[232:235], v4, s[24:27], s65 offen offset:2048 sc1
v_mfma_f32_16x16x32_bf16 v[80:83], v[156:159], a[88:91], v[80:83]
s_and_b32 s55, s55, 3
s_xor_b32 s93, s82, 32768
s_add_u32 s93, s93, s81
v_mfma_f32_16x16x32_bf16 v[84:87], v[156:159], a[92:95], v[84:87]
ds_write_b64 v11, a[128:129] offset:0
v_mfma_f32_16x16x32_bf16 v[84:87], v[152:155], a[84:87], v[84:87]
buffer_load_dwordx4 a[228:231], v4, s[24:27], s93 offen offset:0 sc1
v_mfma_f32_16x16x32_bf16 v[88:91], v[160:163], a[80:83], v[88:91]
s_lshl_b32 s55, s55, 10
ds_read_b128 v[188:191], v8 offset:3072
v_mfma_f32_16x16x32_bf16 v[88:91], v[164:167], a[88:91], v[88:91]
s_cmp_ge_u32 s91, 163840
s_cselect_b32 s91, 0, s91
ds_read_b128 v[144:147], v8 offset:4096
v_mfma_f32_16x16x32_bf16 v[92:95], v[164:167], a[92:95], v[92:95]
ds_write_b64 v11, a[130:131] offset:8
v_mfma_f32_16x16x32_bf16 v[92:95], v[160:163], a[84:87], v[92:95]
s_add_u32 s55, s55, s69
s_waitcnt lgkmcnt(8)
ds_read_b128 v[148:151], v8 offset:5120
v_mfma_f32_16x16x32_bf16 v[96:99], v[168:171], a[80:83], v[96:99]
buffer_load_dwordx4 a[236:239], v4, s[24:27], s93 offen offset:2048 sc1
v_mfma_f32_16x16x32_bf16 v[96:99], v[172:175], a[88:91], v[96:99]
ds_read_b128 v[152:155], v8 offset:6144
v_add_u32 v7, s91, v4
v_mfma_f32_16x16x32_bf16 v[100:103], v[172:175], a[92:95], v[100:103]
s_add_u32 s55, s55, 23552
s_waitcnt lgkmcnt(7)
ds_read_b128 v[156:159], v8 offset:7168
v_mfma_f32_16x16x32_bf16 v[100:103], v[168:171], a[84:87], v[100:103]
ds_write_b64 v11, a[132:133] offset:1024
v_mfma_f32_16x16x32_bf16 v[104:107], v[176:179], a[80:83], v[104:107]
ds_read_b128 v[160:163], v8 offset:8192
v_mfma_f32_16x16x32_bf16 v[104:107], v[180:183], a[88:91], v[104:107]
s_add_u32 s71, s69, 24576
s_waitcnt lgkmcnt(7)
ds_read_b128 v[164:167], v8 offset:9216
v_mfma_f32_16x16x32_bf16 v[108:111], v[180:183], a[92:95], v[108:111]
buffer_load_dwordx4 a[240:243], v14, s[24:27], s65 offen offset:0 sc1
v_mfma_f32_16x16x32_bf16 v[108:111], v[176:179], a[84:87], v[108:111]
ds_write_b64 v11, a[134:135] offset:1032
v_mfma_f32_16x16x32_bf16 v[112:115], v[184:187], a[80:83], v[112:115]
s_cmp_eq_u32 s3, s84
s_cselect_b32 s55, 2147418112, s55
s_cselect_b32 s71, s71, 2147418112
v_mfma_f32_16x16x32_bf16 v[112:115], v[188:191], a[88:91], v[112:115]
ds_read_b128 v[168:171], v8 offset:10240
v_mfma_f32_16x16x32_bf16 v[116:119], v[188:191], a[92:95], v[116:119]
s_waitcnt vmcnt(9)
ds_read_b128 v[172:175], v8 offset:11264
v_mfma_f32_16x16x32_bf16 v[116:119], v[184:187], a[84:87], v[116:119]
s_mul_i32 s83, s84, 6144
s_waitcnt lgkmcnt(8) vmcnt(11)
ds_read_b128 v[176:179], v8 offset:12288
v_mfma_f32_16x16x32_bf16 v[120:123], v[144:147], a[192:195], v[120:123]
ds_write_b64 v11, a[136:137] offset:2048
v_mfma_f32_16x16x32_bf16 v[120:123], v[148:151], a[200:203], v[120:123]
buffer_load_dwordx4 a[248:251], v14, s[24:27], s65 offen offset:2048 sc1
v_mfma_f32_16x16x32_bf16 v[124:127], v[148:151], a[204:207], v[124:127]
s_add_u32 s69, s69, s83
ds_read_b128 v[180:183], v8 offset:13312
v_mfma_f32_16x16x32_bf16 v[124:127], v[144:147], a[196:199], v[124:127]
s_waitcnt lgkmcnt(9)
ds_read_b128 v[184:187], v8 offset:14336
v_mfma_f32_16x16x32_bf16 v[72:75], v[152:155], a[192:195], v[72:75]
s_waitcnt vmcnt(51)
ds_read_b128 v[188:191], v8 offset:15360
v_mfma_f32_16x16x32_bf16 v[72:75], v[156:159], a[200:203], v[72:75]
s_barrier
v_mfma_f32_16x16x32_bf16 v[76:79], v[156:159], a[204:207], v[76:79]
s_add_u32 s83, s69, 4096
s_waitcnt lgkmcnt(8)
ds_read_b128 v[144:147], v7 offset:0
v_mfma_f32_16x16x32_bf16 v[76:79], v[152:155], a[196:199], v[76:79]
ds_write_b64 v11, a[138:139] offset:2056
v_mfma_f32_16x16x32_bf16 v[80:83], v[160:163], a[192:195], v[80:83]
buffer_load_dwordx4 a[244:247], v14, s[24:27], s93 offen offset:0 sc1
v_mfma_f32_16x16x32_bf16 v[80:83], v[164:167], a[200:203], v[80:83]
s_add_u32 s91, s91, 16384
ds_read_b128 v[148:151], v7 offset:1024
v_mfma_f32_16x16x32_bf16 v[84:87], v[164:167], a[204:207], v[84:87]
s_waitcnt lgkmcnt(8)
ds_read_b128 v[152:155], v7 offset:2048
v_mfma_f32_16x16x32_bf16 v[84:87], v[160:163], a[196:199], v[84:87]
ds_write_b64 v11, a[140:141] offset:3072
v_mfma_f32_16x16x32_bf16 v[88:91], v[168:171], a[192:195], v[88:91]
buffer_load_dwordx4 a[252:255], v14, s[24:27], s93 offen offset:2048 sc1
v_mfma_f32_16x16x32_bf16 v[88:91], v[172:175], a[200:203], v[88:91]
s_waitcnt lgkmcnt(7)
ds_read_b128 v[156:159], v7 offset:3072
v_mfma_f32_16x16x32_bf16 v[92:95], v[172:175], a[204:207], v[92:95]
s_xor_b32 s65, s82, 40960
s_add_u32 s65, s65, s77
ds_read_b128 v[160:163], v7 offset:4096
v_mfma_f32_16x16x32_bf16 v[92:95], v[168:171], a[196:199], v[92:95]
ds_write_b64 v11, a[142:143] offset:3080
v_mfma_f32_16x16x32_bf16 v[96:99], v[176:179], a[192:195], v[96:99]
s_add_u32 s68, s68, 49152
ds_read_b128 v[164:167], v7 offset:5120
v_mfma_f32_16x16x32_bf16 v[96:99], v[180:183], a[200:203], v[96:99]
buffer_load_dwordx4 a[96:99], v4, s[24:27], s65 offen offset:0 sc1
v_mfma_f32_16x16x32_bf16 v[100:103], v[180:183], a[204:207], v[100:103]
s_cmp_ge_u32 s91, 163840
s_cselect_b32 s91, 0, s91
ds_read_b128 v[168:171], v7 offset:6144
v_mfma_f32_16x16x32_bf16 v[100:103], v[176:179], a[196:199], v[100:103]
s_waitcnt lgkmcnt(10)
v_add_u32 v8, s91, v4
v_mfma_f32_16x16x32_bf16 v[104:107], v[184:187], a[192:195], v[104:107]
ds_read_b128 v[172:175], v7 offset:7168
v_mfma_f32_16x16x32_bf16 v[104:107], v[188:191], a[200:203], v[104:107]
v_mfma_f32_16x16x32_bf16 v[108:111], v[188:191], a[204:207], v[108:111]
buffer_load_dwordx4 a[104:107], v4, s[24:27], s65 offen offset:2048 sc1
v_mfma_f32_16x16x32_bf16 v[108:111], v[184:187], a[196:199], v[108:111]
s_waitcnt lgkmcnt(8)
ds_read_b128 v[176:179], v7 offset:8192
v_mfma_f32_16x16x32_bf16 v[112:115], v[144:147], a[192:195], v[112:115]
ds_read_b128 v[180:183], v7 offset:9216
v_mfma_f32_16x16x32_bf16 v[112:115], v[148:151], a[200:203], v[112:115]
v_mfma_f32_16x16x32_bf16 v[116:119], v[148:151], a[204:207], v[116:119]
s_xor_b32 s93, s82, 40960
s_add_u32 s93, s93, s81
ds_read_b128 v[184:187], v7 offset:10240
v_mfma_f32_16x16x32_bf16 v[116:119], v[144:147], a[196:199], v[116:119]
s_waitcnt lgkmcnt(8) vmcnt(12)
v_mfma_f32_16x16x32_bf16 v[120:123], v[152:155], a[208:211], v[120:123]
buffer_load_dwordx4 a[100:103], v4, s[24:27], s93 offen offset:0 sc1
v_mfma_f32_16x16x32_bf16 v[120:123], v[156:159], a[216:219], v[120:123]
s_waitcnt vmcnt(11)
ds_read_b128 v[188:191], v7 offset:11264
v_mfma_f32_16x16x32_bf16 v[124:127], v[156:159], a[220:223], v[124:127]
ds_read_b128 v[144:147], v7 offset:12288
v_mfma_f32_16x16x32_bf16 v[124:127], v[152:155], a[212:215], v[124:127]
s_waitcnt lgkmcnt(7)
v_mfma_f32_16x16x32_bf16 v[72:75], v[160:163], a[208:211], v[72:75]
ds_read_b128 v[148:151], v7 offset:13312
v_mfma_f32_16x16x32_bf16 v[72:75], v[164:167], a[216:219], v[72:75]
v_mov_b32 v13, 0xffff0000
v_mul_u32_u24 v5, 1152, v2
v_mfma_f32_16x16x32_bf16 v[76:79], v[164:167], a[220:223], v[76:79]
buffer_load_dwordx4 a[108:111], v4, s[24:27], s93 offen offset:2048 sc1
v_mfma_f32_16x16x32_bf16 v[76:79], v[160:163], a[212:215], v[76:79]
s_waitcnt lgkmcnt(6)
ds_read_b128 v[152:155], v7 offset:14336
v_lshl_add_u32 v6, v3, 3, v5
v_mfma_f32_16x16x32_bf16 v[80:83], v[168:171], a[208:211], v[80:83]
ds_read_b128 v[156:159], v7 offset:15360
v_and_b32 v9, 1, v3
v_mfma_f32_16x16x32_bf16 v[80:83], v[172:175], a[216:219], v[80:83]
s_add_u32 s91, s91, 16384
s_cmp_ge_u32 s91, 163840
s_cselect_b32 s91, 0, s91
v_mfma_f32_16x16x32_bf16 v[84:87], v[172:175], a[220:223], v[84:87]
s_waitcnt lgkmcnt(6)
ds_read_b128 v[160:163], v8 offset:0
v_add_u32 v7, s91, v4
v_mfma_f32_16x16x32_bf16 v[84:87], v[168:171], a[212:215], v[84:87]
buffer_load_dwordx4 a[112:115], v14, s[24:27], s65 offen offset:0 sc1
v_mfma_f32_16x16x32_bf16 v[88:91], v[176:179], a[208:211], v[88:91]
ds_read_b128 v[164:167], v8 offset:1024
v_lshl_add_u32 v5, v9, 5, v5
v_mfma_f32_16x16x32_bf16 v[88:91], v[180:183], a[216:219], v[88:91]
v_lshrrev_b32 v9, 1, v3
v_lshl_add_u32 v5, v9, 4, v5
v_mfma_f32_16x16x32_bf16 v[92:95], v[180:183], a[220:223], v[92:95]
ds_read_b128 v[168:171], v8 offset:2048
v_mfma_f32_16x16x32_bf16 v[92:95], v[176:179], a[212:215], v[92:95]
s_waitcnt lgkmcnt(7)
v_mfma_f32_16x16x32_bf16 v[96:99], v[184:187], a[208:211], v[96:99]
ds_read_b128 v[172:175], v8 offset:3072
v_mfma_f32_16x16x32_bf16 v[96:99], v[188:191], a[216:219], v[96:99]
buffer_load_dwordx4 a[120:123], v14, s[24:27], s65 offen offset:2048 sc1
v_mfma_f32_16x16x32_bf16 v[100:103], v[188:191], a[220:223], v[100:103]
ds_read_b128 v[176:179], v8 offset:4096
v_mfma_f32_16x16x32_bf16 v[100:103], v[184:187], a[212:215], v[100:103]
s_waitcnt lgkmcnt(7)
v_mfma_f32_16x16x32_bf16 v[104:107], v[144:147], a[208:211], v[104:107]
ds_read_b128 v[180:183], v8 offset:5120
v_mfma_f32_16x16x32_bf16 v[104:107], v[148:151], a[216:219], v[104:107]
v_mfma_f32_16x16x32_bf16 v[108:111], v[148:151], a[220:223], v[108:111]
s_waitcnt lgkmcnt(6)
ds_read_b128 v[184:187], v8 offset:6144
v_mfma_f32_16x16x32_bf16 v[108:111], v[144:147], a[212:215], v[108:111]
buffer_load_dwordx4 a[116:119], v14, s[24:27], s93 offen offset:0 sc1
v_mfma_f32_16x16x32_bf16 v[112:115], v[152:155], a[208:211], v[112:115]
ds_read_b128 v[188:191], v8 offset:7168
v_mfma_f32_16x16x32_bf16 v[112:115], v[156:159], a[216:219], v[112:115]
v_mfma_f32_16x16x32_bf16 v[116:119], v[156:159], a[220:223], v[116:119]
ds_read_b128 v[144:147], v8 offset:8192
v_mfma_f32_16x16x32_bf16 v[116:119], v[152:155], a[212:215], v[116:119]
s_waitcnt lgkmcnt(7) vmcnt(13)
v_mfma_f32_16x16x32_bf16 v[120:123], v[160:163], a[224:227], v[120:123]
buffer_load_dwordx4 a[124:127], v14, s[24:27], s93 offen offset:2048 sc1
v_mfma_f32_16x16x32_bf16 v[120:123], v[164:167], a[232:235], v[120:123]
s_waitcnt vmcnt(12)
ds_read_b128 v[148:151], v8 offset:9216
v_mfma_f32_16x16x32_bf16 v[124:127], v[164:167], a[236:239], v[124:127]
ds_read_b128 v[152:155], v8 offset:10240
v_mfma_f32_16x16x32_bf16 v[124:127], v[160:163], a[228:231], v[124:127]
s_waitcnt lgkmcnt(7)
v_mfma_f32_16x16x32_bf16 v[72:75], v[168:171], a[224:227], v[72:75]
s_xor_b32 s65, s82, 49152
s_add_u32 s65, s65, s77
ds_read_b128 v[156:159], v8 offset:11264
v_mfma_f32_16x16x32_bf16 v[72:75], v[172:175], a[232:235], v[72:75]
v_mfma_f32_16x16x32_bf16 v[76:79], v[172:175], a[236:239], v[76:79]
buffer_load_dwordx4 a[128:131], v4, s[24:27], s65 offen offset:0 sc1
v_mfma_f32_16x16x32_bf16 v[76:79], v[168:171], a[228:231], v[76:79]
s_waitcnt lgkmcnt(6)
ds_read_b128 v[160:163], v8 offset:12288
v_mfma_f32_16x16x32_bf16 v[80:83], v[176:179], a[224:227], v[80:83]
ds_read_b128 v[164:167], v8 offset:13312
v_mfma_f32_16x16x32_bf16 v[80:83], v[180:183], a[232:235], v[80:83]
v_mfma_f32_16x16x32_bf16 v[84:87], v[180:183], a[236:239], v[84:87]
ds_read_b128 v[168:171], v8 offset:14336
v_mfma_f32_16x16x32_bf16 v[84:87], v[176:179], a[228:231], v[84:87]
s_waitcnt lgkmcnt(7)
v_mfma_f32_16x16x32_bf16 v[88:91], v[184:187], a[224:227], v[88:91]
s_waitcnt vmcnt(53)
ds_read_b128 v[172:175], v8 offset:15360
v_mfma_f32_16x16x32_bf16 v[88:91], v[188:191], a[232:235], v[88:91]
s_barrier
v_mfma_f32_16x16x32_bf16 v[92:95], v[188:191], a[236:239], v[92:95]
buffer_load_dwordx4 a[136:139], v4, s[24:27], s65 offen offset:2048 sc1
v_mfma_f32_16x16x32_bf16 v[92:95], v[184:187], a[228:231], v[92:95]
s_waitcnt lgkmcnt(6)
s_add_u32 s91, s91, 16384
ds_read_b128 v[176:179], v7 offset:0
v_mfma_f32_16x16x32_bf16 v[96:99], v[144:147], a[224:227], v[96:99]
s_xor_b32 s93, s82, 49152
s_add_u32 s93, s93, s81
ds_read_b128 v[180:183], v7 offset:1024
v_mfma_f32_16x16x32_bf16 v[96:99], v[148:151], a[232:235], v[96:99]
s_cmp_ge_u32 s91, 163840
s_cselect_b32 s91, 0, s91
v_add_u32 v8, s91, v4
v_mfma_f32_16x16x32_bf16 v[100:103], v[148:151], a[236:239], v[100:103]
buffer_load_dwordx4 a[132:135], v4, s[24:27], s93 offen offset:0 sc1
v_mfma_f32_16x16x32_bf16 v[100:103], v[144:147], a[228:231], v[100:103]
s_waitcnt lgkmcnt(6) vmcnt(13)
ds_read_b128 v[184:187], v7 offset:2048
v_mfma_f32_16x16x32_bf16 v[120:123], v[152:155], a[240:243], v[120:123]
ds_read_b128 v[188:191], v7 offset:3072
v_mfma_f32_16x16x32_bf16 v[120:123], v[156:159], a[248:251], v[120:123]
s_waitcnt vmcnt(11)
v_mfma_f32_16x16x32_bf16 v[124:127], v[156:159], a[252:255], v[124:127]
buffer_load_dwordx4 a[140:143], v4, s[24:27], s93 offen offset:2048 sc1
v_mfma_f32_16x16x32_bf16 v[124:127], v[152:155], a[244:247], v[124:127]
s_waitcnt lgkmcnt(6)
ds_read_b128 v[144:147], v7 offset:4096
v_mfma_f32_16x16x32_bf16 v[72:75], v[160:163], a[240:243], v[72:75]
ds_read_b128 v[148:151], v7 offset:5120
v_mfma_f32_16x16x32_bf16 v[72:75], v[164:167], a[248:251], v[72:75]
v_mfma_f32_16x16x32_bf16 v[76:79], v[164:167], a[252:255], v[76:79]
ds_read_b128 v[152:155], v7 offset:6144
v_mfma_f32_16x16x32_bf16 v[76:79], v[160:163], a[244:247], v[76:79]
s_waitcnt lgkmcnt(7)
v_mfma_f32_16x16x32_bf16 v[80:83], v[168:171], a[240:243], v[80:83]
ds_read_b128 v[156:159], v7 offset:7168
v_mfma_f32_16x16x32_bf16 v[80:83], v[172:175], a[248:251], v[80:83]
buffer_load_dwordx4 a[144:147], v14, s[24:27], s65 offen offset:0 sc1
v_mfma_f32_16x16x32_bf16 v[84:87], v[172:175], a[252:255], v[84:87]
buffer_load_dword v12, v10, s[24:27], s75 offen offset:4 sc1
v_mfma_f32_16x16x32_bf16 v[84:87], v[168:171], a[244:247], v[84:87]
s_waitcnt lgkmcnt(6)
ds_read_b128 v[160:163], v7 offset:8192
v_mfma_f32_16x16x32_bf16 v[88:91], v[176:179], a[240:243], v[88:91]
ds_read_b128 v[164:167], v7 offset:9216
v_mfma_f32_16x16x32_bf16 v[88:91], v[180:183], a[248:251], v[88:91]
v_mfma_f32_16x16x32_bf16 v[92:95], v[180:183], a[252:255], v[92:95]
buffer_load_dwordx4 a[152:155], v14, s[24:27], s65 offen offset:2048 sc1
v_mfma_f32_16x16x32_bf16 v[92:95], v[176:179], a[244:247], v[92:95]
s_waitcnt lgkmcnt(6)
ds_read_b128 v[168:171], v7 offset:10240
v_mfma_f32_16x16x32_bf16 v[96:99], v[184:187], a[240:243], v[96:99]
ds_read_b128 v[172:175], v7 offset:11264
v_mfma_f32_16x16x32_bf16 v[96:99], v[188:191], a[248:251], v[96:99]
v_mfma_f32_16x16x32_bf16 v[100:103], v[188:191], a[252:255], v[100:103]
buffer_load_dwordx4 a[148:151], v14, s[24:27], s93 offen offset:0 sc1
v_mfma_f32_16x16x32_bf16 v[100:103], v[184:187], a[244:247], v[100:103]
s_waitcnt lgkmcnt(6) vmcnt(14)
ds_read_b128 v[176:179], v7 offset:12288
v_mfma_f32_16x16x32_bf16 v[120:123], v[144:147], a[96:99], v[120:123]
ds_read_b128 v[180:183], v7 offset:13312
v_mfma_f32_16x16x32_bf16 v[120:123], v[148:151], a[104:107], v[120:123]
s_waitcnt vmcnt(12)
v_mfma_f32_16x16x32_bf16 v[124:127], v[148:151], a[108:111], v[124:127]
buffer_load_dwordx4 a[156:159], v14, s[24:27], s93 offen offset:2048 sc1
v_mfma_f32_16x16x32_bf16 v[124:127], v[144:147], a[100:103], v[124:127]
s_waitcnt lgkmcnt(6)
ds_read_b128 v[184:187], v7 offset:14336
v_mfma_f32_16x16x32_bf16 v[72:75], v[152:155], a[96:99], v[72:75]
ds_read_b128 v[188:191], v7 offset:15360
v_mfma_f32_16x16x32_bf16 v[72:75], v[156:159], a[104:107], v[72:75]
s_add_u32 s91, s91, 16384
s_cmp_ge_u32 s91, 163840
s_cselect_b32 s91, 0, s91
v_mfma_f32_16x16x32_bf16 v[76:79], v[156:159], a[108:111], v[76:79]
ds_read_b128 v[144:147], v8 offset:0
v_add_u32 v7, s91, v4
v_mfma_f32_16x16x32_bf16 v[76:79], v[152:155], a[100:103], v[76:79]
s_waitcnt lgkmcnt(7)
v_mfma_f32_16x16x32_bf16 v[80:83], v[160:163], a[96:99], v[80:83]
s_xor_b32 s65, s82, 57344
s_add_u32 s65, s65, s77
ds_read_b128 v[148:151], v8 offset:1024
v_mfma_f32_16x16x32_bf16 v[80:83], v[164:167], a[104:107], v[80:83]
v_mfma_f32_16x16x32_bf16 v[84:87], v[164:167], a[108:111], v[84:87]
buffer_load_dwordx4 a[160:163], v4, s[24:27], s65 offen offset:0 sc1
v_mfma_f32_16x16x32_bf16 v[84:87], v[160:163], a[100:103], v[84:87]
s_waitcnt lgkmcnt(6)
ds_read_b128 v[152:155], v8 offset:2048
v_mfma_f32_16x16x32_bf16 v[88:91], v[168:171], a[96:99], v[88:91]
ds_read_b128 v[156:159], v8 offset:3072
v_mfma_f32_16x16x32_bf16 v[88:91], v[172:175], a[104:107], v[88:91]
v_mfma_f32_16x16x32_bf16 v[92:95], v[172:175], a[108:111], v[92:95]
buffer_load_dwordx4 a[168:171], v4, s[24:27], s65 offen offset:2048 sc1
v_mfma_f32_16x16x32_bf16 v[92:95], v[168:171], a[100:103], v[92:95]
s_waitcnt lgkmcnt(6)
ds_read_b128 v[160:163], v8 offset:4096
v_mfma_f32_16x16x32_bf16 v[96:99], v[176:179], a[96:99], v[96:99]
s_xor_b32 s93, s82, 57344
s_add_u32 s93, s93, s81
ds_read_b128 v[164:167], v8 offset:5120
v_mfma_f32_16x16x32_bf16 v[96:99], v[180:183], a[104:107], v[96:99]
v_mfma_f32_16x16x32_bf16 v[100:103], v[180:183], a[108:111], v[100:103]
buffer_load_dwordx4 a[164:167], v4, s[24:27], s93 offen offset:0 sc1
v_mfma_f32_16x16x32_bf16 v[100:103], v[176:179], a[100:103], v[100:103]
s_waitcnt lgkmcnt(6) vmcnt(14)
ds_read_b128 v[168:171], v8 offset:6144
v_mfma_f32_16x16x32_bf16 v[120:123], v[184:187], a[112:115], v[120:123]
ds_read_b128 v[172:175], v8 offset:7168
v_mfma_f32_16x16x32_bf16 v[120:123], v[188:191], a[120:123], v[120:123]
s_waitcnt vmcnt(12)
v_mfma_f32_16x16x32_bf16 v[124:127], v[188:191], a[124:127], v[124:127]
buffer_load_dwordx4 a[172:175], v4, s[24:27], s93 offen offset:2048 sc1
v_mfma_f32_16x16x32_bf16 v[124:127], v[184:187], a[116:119], v[124:127]
s_waitcnt lgkmcnt(6)
ds_read_b128 v[176:179], v8 offset:8192
v_mfma_f32_16x16x32_bf16 v[72:75], v[144:147], a[112:115], v[72:75]
s_mov_b32 m0, s70
s_mov_b32 s64, s68
s_add_u32 s68, s68, 16384
v_mfma_f32_16x16x32_bf16 v[72:75], v[148:151], a[120:123], v[72:75]
s_waitcnt lgkmcnt(5)
ds_read_b128 v[180:183], v8 offset:9216
v_mfma_f32_16x16x32_bf16 v[76:79], v[148:151], a[124:127], v[76:79]
s_add_u32 s70, s70, 16384
s_cmp_ge_u32 s70, 163840
s_cselect_b32 s70, s80, s70
v_mfma_f32_16x16x32_bf16 v[76:79], v[144:147], a[116:119], v[76:79]
buffer_load_dwordx4 v4, s[24:27], s64 offen offset:0 sc1 lds
v_mfma_f32_16x16x32_bf16 v[80:83], v[152:155], a[112:115], v[80:83]
ds_read_b128 v[184:187], v8 offset:10240
v_mfma_f32_16x16x32_bf16 v[80:83], v[156:159], a[120:123], v[80:83]
ds_read_b128 v[188:191], v8 offset:11264
v_mfma_f32_16x16x32_bf16 v[84:87], v[156:159], a[124:127], v[84:87]
buffer_load_dwordx4 v4, s[24:27], s64 offen offset:1024 sc1 lds
v_mfma_f32_16x16x32_bf16 v[84:87], v[152:155], a[116:119], v[84:87]
s_waitcnt lgkmcnt(6)
ds_read_b128 v[144:147], v8 offset:12288
v_mfma_f32_16x16x32_bf16 v[88:91], v[160:163], a[112:115], v[88:91]
ds_read_b128 v[148:151], v8 offset:13312
v_mfma_f32_16x16x32_bf16 v[88:91], v[164:167], a[120:123], v[88:91]
buffer_load_dwordx4 a[176:179], v14, s[24:27], s65 offen offset:0 sc1
v_mfma_f32_16x16x32_bf16 v[92:95], v[164:167], a[124:127], v[92:95]
ds_read_b128 v[152:155], v8 offset:14336
v_mfma_f32_16x16x32_bf16 v[92:95], v[160:163], a[116:119], v[92:95]
s_waitcnt lgkmcnt(7)
v_mfma_f32_16x16x32_bf16 v[96:99], v[168:171], a[112:115], v[96:99]
s_waitcnt vmcnt(10)
ds_read_b128 v[156:159], v8 offset:15360
v_mfma_f32_16x16x32_bf16 v[96:99], v[172:175], a[120:123], v[96:99]
s_barrier
v_mfma_f32_16x16x32_bf16 v[100:103], v[172:175], a[124:127], v[100:103]
s_waitcnt lgkmcnt(6) vmcnt(14)
ds_read_b128 v[160:163], v7 offset:0
v_cmp_gt_u32 vcc, 8, v12
v_mfma_f32_16x16x32_bf16 v[100:103], v[168:171], a[116:119], v[100:103]
buffer_load_dwordx4 v4, s[24:27], s64 offen offset:2048 sc1 lds
v_mfma_f32_16x16x32_bf16 v[120:123], v[176:179], a[128:131], v[120:123]
s_add_u32 s91, s91, 16384
ds_read_b128 v[164:167], v7 offset:1024
v_mfma_f32_16x16x32_bf16 v[120:123], v[180:183], a[136:139], v[120:123]
s_waitcnt lgkmcnt(6) vmcnt(13)
s_cmp_ge_u32 s91, 163840
s_cselect_b32 s91, 0, s91
v_mfma_f32_16x16x32_bf16 v[124:127], v[180:183], a[140:143], v[124:127]
buffer_load_dwordx4 a[184:187], v14, s[24:27], s65 offen offset:2048 sc1
v_mfma_f32_16x16x32_bf16 v[124:127], v[176:179], a[132:135], v[124:127]
s_cbranch_vccnz CK_ZAA
CK_ZAA_R:
v_mfma_f32_16x16x32_bf16 v[72:75], v[184:187], a[128:131], v[72:75]
ds_read_b128 v[168:171], v7 offset:2048
v_add_u32 v8, s91, v4
v_mfma_f32_16x16x32_bf16 v[72:75], v[188:191], a[136:139], v[72:75]
buffer_load_dwordx4 v4, s[24:27], s64 offen offset:3072 sc1 lds
v_mfma_f32_16x16x32_bf16 v[76:79], v[188:191], a[140:143], v[76:79]
ds_read_b128 v[172:175], v7 offset:3072
v_mfma_f32_16x16x32_bf16 v[76:79], v[184:187], a[132:135], v[76:79]
s_waitcnt lgkmcnt(6)
ds_read_b128 v[176:179], v7 offset:4096
v_mfma_f32_16x16x32_bf16 v[80:83], v[144:147], a[128:131], v[80:83]
buffer_load_dwordx4 a[180:183], v14, s[24:27], s93 offen offset:0 sc1
v_mfma_f32_16x16x32_bf16 v[80:83], v[148:151], a[136:139], v[80:83]
ds_read_b128 v[180:183], v7 offset:5120
v_mfma_f32_16x16x32_bf16 v[84:87], v[148:151], a[140:143], v[84:87]
s_waitcnt lgkmcnt(6)
ds_read_b128 v[184:187], v7 offset:6144
v_mfma_f32_16x16x32_bf16 v[84:87], v[144:147], a[132:135], v[84:87]
buffer_load_dwordx4 a[188:191], v14, s[24:27], s93 offen offset:2048 sc1
v_mfma_f32_16x16x32_bf16 v[88:91], v[152:155], a[128:131], v[88:91]
s_add_u32 s65, s77, 65536
ds_read_b128 v[188:191], v7 offset:7168
v_mfma_f32_16x16x32_bf16 v[88:91], v[156:159], a[136:139], v[88:91]
v_mfma_f32_16x16x32_bf16 v[92:95], v[156:159], a[140:143], v[92:95]
buffer_load_dwordx4 v[32:35], v4, s[24:27], s65 offen offset:0 sc1
v_mfma_f32_16x16x32_bf16 v[92:95], v[152:155], a[132:135], v[92:95]
s_waitcnt lgkmcnt(6)
ds_read_b128 v[144:147], v7 offset:8192
v_mfma_f32_16x16x32_bf16 v[96:99], v[160:163], a[128:131], v[96:99]
ds_read_b128 v[148:151], v7 offset:9216
v_mfma_f32_16x16x32_bf16 v[96:99], v[164:167], a[136:139], v[96:99]
buffer_load_dwordx4 v[40:43], v4, s[24:27], s65 offen offset:2048 sc1
v_mfma_f32_16x16x32_bf16 v[100:103], v[164:167], a[140:143], v[100:103]
s_add_u32 s93, s81, 65536
ds_read_b128 v[152:155], v7 offset:10240
v_mfma_f32_16x16x32_bf16 v[100:103], v[160:163], a[132:135], v[100:103]
s_waitcnt lgkmcnt(7) vmcnt(16)
v_mfma_f32_16x16x32_bf16 v[120:123], v[168:171], a[144:147], v[120:123]
buffer_load_dwordx4 v[36:39], v4, s[24:27], s93 offen offset:0 sc1
v_mfma_f32_16x16x32_bf16 v[120:123], v[172:175], a[152:155], v[120:123]
s_waitcnt vmcnt(15)
ds_read_b128 v[156:159], v7 offset:11264
v_mfma_f32_16x16x32_bf16 v[124:127], v[172:175], a[156:159], v[124:127]
s_waitcnt lgkmcnt(6)
ds_read_b128 v[160:163], v7 offset:12288
v_mfma_f32_16x16x32_bf16 v[124:127], v[168:171], a[148:151], v[124:127]
buffer_load_dwordx4 v[44:47], v4, s[24:27], s93 offen offset:2048 sc1
v_mfma_f32_16x16x32_bf16 v[72:75], v[176:179], a[144:147], v[72:75]
ds_read_b128 v[164:167], v7 offset:13312
v_mfma_f32_16x16x32_bf16 v[72:75], v[180:183], a[152:155], v[72:75]
v_mfma_f32_16x16x32_bf16 v[76:79], v[180:183], a[156:159], v[76:79]
ds_read_b128 v[168:171], v7 offset:14336
v_mfma_f32_16x16x32_bf16 v[76:79], v[176:179], a[148:151], v[76:79]
s_waitcnt lgkmcnt(7)
v_mfma_f32_16x16x32_bf16 v[80:83], v[184:187], a[144:147], v[80:83]
ds_read_b128 v[172:175], v7 offset:15360
v_mfma_f32_16x16x32_bf16 v[80:83], v[188:191], a[152:155], v[80:83]
s_add_u32 s91, s91, 16384
s_cmp_ge_u32 s91, 163840
s_cselect_b32 s91, 0, s91
v_mfma_f32_16x16x32_bf16 v[84:87], v[188:191], a[156:159], v[84:87]
buffer_load_dwordx4 v[48:51], v14, s[24:27], s65 offen offset:0 sc1
v_mfma_f32_16x16x32_bf16 v[84:87], v[184:187], a[148:151], v[84:87]
s_waitcnt lgkmcnt(6)
ds_read_b128 v[176:179], v8 offset:0
v_add_u32 v7, s91, v4
v_mfma_f32_16x16x32_bf16 v[88:91], v[144:147], a[144:147], v[88:91]
ds_read_b128 v[180:183], v8 offset:1024
v_mfma_f32_16x16x32_bf16 v[88:91], v[148:151], a[152:155], v[88:91]
s_waitcnt lgkmcnt(6)
v_mfma_f32_16x16x32_bf16 v[92:95], v[148:151], a[156:159], v[92:95]
buffer_load_dwordx4 v[56:59], v14, s[24:27], s65 offen offset:2048 sc1
v_mfma_f32_16x16x32_bf16 v[92:95], v[144:147], a[148:151], v[92:95]
s_mov_b32 m0, s70
s_mov_b32 s64, s68
L_PAD12:
s_cbranch_execz L_MAIN
s_add_u32 s68, s68, 16384
v_mfma_f32_16x16x32_bf16 v[96:99], v[152:155], a[144:147], v[96:99]
ds_read_b128 v[184:187], v8 offset:2048
v_mfma_f32_16x16x32_bf16 v[96:99], v[156:159], a[152:155], v[96:99]
s_add_u32 s70, s70, 16384
s_cmp_ge_u32 s70, 163840
s_cselect_b32 s70, s80, s70
v_mfma_f32_16x16x32_bf16 v[100:103], v[156:159], a[156:159], v[100:103]
buffer_load_dwordx4 v4, s[24:27], s64 offen offset:0 sc1 lds
v_mfma_f32_16x16x32_bf16 v[100:103], v[152:155], a[148:151], v[100:103]
s_waitcnt lgkmcnt(5) vmcnt(17)
ds_read_b128 v[188:191], v8 offset:3072
v_mfma_f32_16x16x32_bf16 v[120:123], v[160:163], a[160:163], v[120:123]
s_waitcnt vmcnt(15)
ds_read_b128 v[144:147], v8 offset:4096
v_mfma_f32_16x16x32_bf16 v[120:123], v[164:167], a[168:171], v[120:123]
buffer_load_dwordx4 v[52:55], v14, s[24:27], s93 offen offset:0 sc1
v_mfma_f32_16x16x32_bf16 v[124:127], v[164:167], a[172:175], v[124:127]
ds_read_b128 v[148:151], v8 offset:5120
v_mfma_f32_16x16x32_bf16 v[124:127], v[160:163], a[164:167], v[124:127]
s_waitcnt lgkmcnt(6)
ds_read_b128 v[152:155], v8 offset:6144
v_mfma_f32_16x16x32_bf16 v[72:75], v[168:171], a[160:163], v[72:75]
buffer_load_dwordx4 v4, s[24:27], s64 offen offset:1024 sc1 lds
v_mfma_f32_16x16x32_bf16 v[72:75], v[172:175], a[168:171], v[72:75]
ds_read_b128 v[156:159], v8 offset:7168
v_mfma_f32_16x16x32_bf16 v[76:79], v[172:175], a[172:175], v[76:79]
s_waitcnt lgkmcnt(6)
ds_read_b128 v[160:163], v8 offset:8192
v_mfma_f32_16x16x32_bf16 v[76:79], v[168:171], a[164:167], v[76:79]
buffer_load_dwordx4 v[60:63], v14, s[24:27], s93 offen offset:2048 sc1
v_mfma_f32_16x16x32_bf16 v[80:83], v[176:179], a[160:163], v[80:83]
ds_read_b128 v[164:167], v8 offset:9216
v_mfma_f32_16x16x32_bf16 v[80:83], v[180:183], a[168:171], v[80:83]
v_mfma_f32_16x16x32_bf16 v[84:87], v[180:183], a[172:175], v[84:87]
buffer_load_dwordx4 v4, s[24:27], s64 offen offset:2048 sc1 lds
v_mfma_f32_16x16x32_bf16 v[84:87], v[176:179], a[164:167], v[84:87]
s_waitcnt lgkmcnt(6)
ds_read_b128 v[168:171], v8 offset:10240
v_mfma_f32_16x16x32_bf16 v[88:91], v[184:187], a[160:163], v[88:91]
ds_read_b128 v[172:175], v8 offset:11264
v_mfma_f32_16x16x32_bf16 v[88:91], v[188:191], a[168:171], v[88:91]
buffer_load_dwordx4 v4, s[24:27], s64 offen offset:3072 sc1 lds
v_mfma_f32_16x16x32_bf16 v[92:95], v[188:191], a[172:175], v[92:95]
s_mov_b32 m0, s70
s_mov_b32 s64, s68
s_add_u32 s68, s68, 16384
v_mfma_f32_16x16x32_bf16 v[92:95], v[184:187], a[164:167], v[92:95]
s_waitcnt lgkmcnt(6)
ds_read_b128 v[176:179], v8 offset:12288
v_mfma_f32_16x16x32_bf16 v[96:99], v[144:147], a[160:163], v[96:99]
s_add_u32 s70, s70, 16384
s_cmp_ge_u32 s70, 163840
s_cselect_b32 s70, s80, s70
v_mfma_f32_16x16x32_bf16 v[96:99], v[148:151], a[168:171], v[96:99]
buffer_load_dwordx4 v4, s[24:27], s64 offen offset:0 sc1 lds
v_mfma_f32_16x16x32_bf16 v[100:103], v[148:151], a[172:175], v[100:103]
ds_read_b128 v[180:183], v8 offset:13312
v_mfma_f32_16x16x32_bf16 v[100:103], v[144:147], a[164:167], v[100:103]
s_waitcnt lgkmcnt(6) vmcnt(16)
ds_read_b128 v[184:187], v8 offset:14336
v_mfma_f32_16x16x32_bf16 v[120:123], v[152:155], a[176:179], v[120:123]
s_waitcnt vmcnt(15)
s_waitcnt vmcnt(13)
ds_read_b128 v[188:191], v8 offset:15360
v_mfma_f32_16x16x32_bf16 v[120:123], v[156:159], a[184:187], v[120:123]
s_barrier
v_mfma_f32_16x16x32_bf16 v[124:127], v[156:159], a[188:191], v[124:127]
buffer_load_dwordx4 v4, s[24:27], s64 offen offset:1024 sc1 lds
v_mfma_f32_16x16x32_bf16 v[124:127], v[152:155], a[180:183], v[124:127]
s_add_u32 s65, s77, 73728
s_waitcnt lgkmcnt(6)
ds_read_b128 v[144:147], v7 offset:0
v_mfma_f32_16x16x32_bf16 v[72:75], v[160:163], a[176:179], v[72:75]
s_add_u32 s91, s91, 16384
ds_read_b128 v[148:151], v7 offset:1024
v_mfma_f32_16x16x32_bf16 v[72:75], v[164:167], a[184:187], v[72:75]
buffer_load_dwordx4 v[64:67], v4, s[24:27], s65 offen offset:0 sc1
v_mfma_f32_16x16x32_bf16 v[76:79], v[164:167], a[188:191], v[76:79]
s_cmp_ge_u32 s91, 163840
s_cselect_b32 s91, 0, s91
ds_read_b128 v[152:155], v7 offset:2048
v_mfma_f32_16x16x32_bf16 v[76:79], v[160:163], a[180:183], v[76:79]
s_waitcnt lgkmcnt(7)
v_add_u32 v8, s91, v4
v_mfma_f32_16x16x32_bf16 v[80:83], v[168:171], a[176:179], v[80:83]
buffer_load_dwordx4 v4, s[24:27], s64 offen offset:2048 sc1 lds
v_mfma_f32_16x16x32_bf16 v[80:83], v[172:175], a[184:187], v[80:83]
ds_read_b128 v[156:159], v7 offset:3072
v_mfma_f32_16x16x32_bf16 v[84:87], v[172:175], a[188:191], v[84:87]
s_waitcnt lgkmcnt(6)
ds_read_b128 v[160:163], v7 offset:4096
v_mfma_f32_16x16x32_bf16 v[84:87], v[168:171], a[180:183], v[84:87]
buffer_load_dwordx4 v4, s[24:27], s64 offen offset:3072 sc1 lds
v_mfma_f32_16x16x32_bf16 v[88:91], v[176:179], a[176:179], v[88:91]
s_add_u32 s93, s81, 73728
ds_read_b128 v[164:167], v7 offset:5120
v_mfma_f32_16x16x32_bf16 v[88:91], v[180:183], a[184:187], v[88:91]
v_mfma_f32_16x16x32_bf16 v[92:95], v[180:183], a[188:191], v[92:95]
buffer_load_dwordx4 v[68:71], v4, s[24:27], s93 offen offset:0 sc1
v_mfma_f32_16x16x32_bf16 v[92:95], v[176:179], a[180:183], v[92:95]
s_waitcnt lgkmcnt(6)
ds_read_b128 v[168:171], v7 offset:6144
v_mfma_f32_16x16x32_bf16 v[96:99], v[184:187], a[176:179], v[96:99]
ds_read_b128 v[172:175], v7 offset:7168
v_mfma_f32_16x16x32_bf16 v[96:99], v[188:191], a[184:187], v[96:99]
v_mfma_f32_16x16x32_bf16 v[100:103], v[188:191], a[188:191], v[100:103]
ds_read_b128 v[176:179], v7 offset:8192
v_mfma_f32_16x16x32_bf16 v[100:103], v[184:187], a[180:183], v[100:103]
s_waitcnt lgkmcnt(7) vmcnt(16)
v_mfma_f32_16x16x32_bf16 v[120:123], v[144:147], v[32:35], v[120:123]
ds_read_b128 v[180:183], v7 offset:9216
v_mfma_f32_16x16x32_bf16 v[120:123], v[148:151], v[40:43], v[120:123]
s_waitcnt vmcnt(14)
v_mfma_f32_16x16x32_bf16 v[124:127], v[148:151], v[44:47], v[124:127]
ds_read_b128 v[184:187], v7 offset:10240
v_mfma_f32_16x16x32_bf16 v[124:127], v[144:147], v[36:39], v[124:127]
s_waitcnt lgkmcnt(7)
v_mfma_f32_16x16x32_bf16 v[72:75], v[152:155], v[32:35], v[72:75]
ds_read_b128 v[188:191], v7 offset:11264
v_mfma_f32_16x16x32_bf16 v[72:75], v[156:159], v[40:43], v[72:75]
v_mfma_f32_16x16x32_bf16 v[76:79], v[156:159], v[44:47], v[76:79]
ds_read_b128 v[144:147], v7 offset:12288
v_mfma_f32_16x16x32_bf16 v[76:79], v[152:155], v[36:39], v[76:79]
s_waitcnt lgkmcnt(7)
v_mfma_f32_16x16x32_bf16 v[80:83], v[160:163], v[32:35], v[80:83]
ds_read_b128 v[148:151], v7 offset:13312
v_mfma_f32_16x16x32_bf16 v[80:83], v[164:167], v[40:43], v[80:83]
v_mfma_f32_16x16x32_bf16 v[84:87], v[164:167], v[44:47], v[84:87]
ds_read_b128 v[152:155], v7 offset:14336
v_mfma_f32_16x16x32_bf16 v[84:87], v[160:163], v[36:39], v[84:87]
s_waitcnt lgkmcnt(7)
v_mfma_f32_16x16x32_bf16 v[88:91], v[168:171], v[32:35], v[88:91]
ds_read_b128 v[156:159], v7 offset:15360
v_mfma_f32_16x16x32_bf16 v[88:91], v[172:175], v[40:43], v[88:91]
s_add_u32 s91, s91, 16384
s_cmp_ge_u32 s91, 163840
s_cselect_b32 s91, 0, s91
v_mfma_f32_16x16x32_bf16 v[92:95], v[172:175], v[44:47], v[92:95]
ds_read_b128 v[160:163], v8 offset:0
v_add_u32 v7, s91, v4
v_mfma_f32_16x16x32_bf16 v[92:95], v[168:171], v[36:39], v[92:95]
s_waitcnt lgkmcnt(7)
v_mfma_f32_16x16x32_bf16 v[96:99], v[176:179], v[32:35], v[96:99]
ds_read_b128 v[164:167], v8 offset:1024
v_mfma_f32_16x16x32_bf16 v[96:99], v[180:183], v[40:43], v[96:99]
v_mfma_f32_16x16x32_bf16 v[100:103], v[180:183], v[44:47], v[100:103]
s_mov_b32 m0, s70
s_mov_b32 s64, s68
s_add_u32 s68, s68, 16384
v_mfma_f32_16x16x32_bf16 v[100:103], v[176:179], v[36:39], v[100:103]
s_waitcnt lgkmcnt(6) vmcnt(12)
s_waitcnt vmcnt(8)
ds_read_b128 v[168:171], v8 offset:2048
v_mfma_f32_16x16x32_bf16 v[120:123], v[184:187], v[48:51], v[120:123]
s_add_u32 s70, s70, 16384
s_cmp_ge_u32 s70, 163840
s_cselect_b32 s70, s80, s70
v_mfma_f32_16x16x32_bf16 v[120:123], v[188:191], v[56:59], v[120:123]
buffer_load_dwordx4 v4, s[24:27], s64 offen offset:0 sc1 lds
v_mfma_f32_16x16x32_bf16 v[124:127], v[188:191], v[60:63], v[124:127]
ds_read_b128 v[172:175], v8 offset:3072
v_mfma_f32_16x16x32_bf16 v[124:127], v[184:187], v[52:55], v[124:127]
s_waitcnt lgkmcnt(6)
ds_read_b128 v[176:179], v8 offset:4096
v_mfma_f32_16x16x32_bf16 v[72:75], v[144:147], v[48:51], v[72:75]
buffer_load_dwordx4 v4, s[24:27], s64 offen offset:1024 sc1 lds
v_mfma_f32_16x16x32_bf16 v[72:75], v[148:151], v[56:59], v[72:75]
ds_read_b128 v[180:183], v8 offset:5120
v_mfma_f32_16x16x32_bf16 v[76:79], v[148:151], v[60:63], v[76:79]
s_waitcnt lgkmcnt(6)
ds_read_b128 v[184:187], v8 offset:6144
v_mfma_f32_16x16x32_bf16 v[76:79], v[144:147], v[52:55], v[76:79]
buffer_load_dwordx4 v4, s[24:27], s64 offen offset:2048 sc1 lds
v_mfma_f32_16x16x32_bf16 v[80:83], v[152:155], v[48:51], v[80:83]
ds_read_b128 v[188:191], v8 offset:7168
v_mfma_f32_16x16x32_bf16 v[80:83], v[156:159], v[56:59], v[80:83]
v_mfma_f32_16x16x32_bf16 v[84:87], v[156:159], v[60:63], v[84:87]
buffer_load_dwordx4 v4, s[24:27], s64 offen offset:3072 sc1 lds
v_mfma_f32_16x16x32_bf16 v[84:87], v[152:155], v[52:55], v[84:87]
s_waitcnt lgkmcnt(6)
ds_read_b128 v[144:147], v8 offset:8192
v_mfma_f32_16x16x32_bf16 v[88:91], v[160:163], v[48:51], v[88:91]
s_mov_b32 m0, s70
s_mov_b32 s64, s68
s_add_u32 s68, s68, 16384
v_mfma_f32_16x16x32_bf16 v[88:91], v[164:167], v[56:59], v[88:91]
s_waitcnt lgkmcnt(5)
ds_read_b128 v[148:151], v8 offset:9216
v_mfma_f32_16x16x32_bf16 v[92:95], v[164:167], v[60:63], v[92:95]
s_add_u32 s70, s70, 16384
s_cmp_ge_u32 s70, 163840
s_cselect_b32 s70, s80, s70
v_mfma_f32_16x16x32_bf16 v[92:95], v[160:163], v[52:55], v[92:95]
buffer_load_dwordx4 v4, s[24:27], s64 offen offset:0 sc1 lds
v_mfma_f32_16x16x32_bf16 v[96:99], v[168:171], v[48:51], v[96:99]
ds_read_b128 v[152:155], v8 offset:10240
v_mfma_f32_16x16x32_bf16 v[96:99], v[172:175], v[56:59], v[96:99]
ds_read_b128 v[156:159], v8 offset:11264
v_mfma_f32_16x16x32_bf16 v[100:103], v[172:175], v[60:63], v[100:103]
buffer_load_dwordx4 v4, s[24:27], s64 offen offset:1024 sc1 lds
v_mfma_f32_16x16x32_bf16 v[100:103], v[168:171], v[52:55], v[100:103]
s_waitcnt lgkmcnt(6) vmcnt(9)
ds_read_b128 v[160:163], v8 offset:12288
v_mfma_f32_16x16x32_bf16 v[120:123], v[176:179], v[64:67], v[120:123]
s_waitcnt vmcnt(6)
ds_read_b128 v[164:167], v8 offset:13312
v_mfma_f32_16x16x32_bf16 v[124:127], v[176:179], v[68:71], v[124:127]
buffer_load_dwordx4 v4, s[24:27], s64 offen offset:2048 sc1 lds
v_mfma_f32_16x16x32_bf16 v[72:75], v[180:183], v[64:67], v[72:75]
ds_read_b128 v[168:171], v8 offset:14336
v_mfma_f32_16x16x32_bf16 v[76:79], v[180:183], v[68:71], v[76:79]
s_waitcnt lgkmcnt(7)
v_mfma_f32_16x16x32_bf16 v[80:83], v[184:187], v[64:67], v[80:83]
s_waitcnt vmcnt(8)
ds_read_b128 v[172:175], v8 offset:15360
v_mfma_f32_16x16x32_bf16 v[84:87], v[184:187], v[68:71], v[84:87]
s_barrier
v_mfma_f32_16x16x32_bf16 v[88:91], v[188:191], v[64:67], v[88:91]
buffer_load_dwordx4 v4, s[24:27], s64 offen offset:3072 sc1 lds
v_mfma_f32_16x16x32_bf16 v[92:95], v[188:191], v[68:71], v[92:95]
s_waitcnt lgkmcnt(6)
s_add_u32 s91, s91, 16384
ds_read_b128 v[176:179], v7 offset:0
v_mfma_f32_16x16x32_bf16 v[96:99], v[144:147], v[64:67], v[96:99]
ds_read_b128 v[180:183], v7 offset:1024
v_cvt_pk_bf16_f32 v228, v120, v121
v_mfma_f32_16x16x32_bf16 v[100:103], v[144:147], v[68:71], v[100:103]
s_cmp_ge_u32 s91, 163840
s_cselect_b32 s91, 0, s91
v_cvt_pk_bf16_f32 v229, v122, v123
v_mfma_f32_16x16x32_bf16 v[104:107], v[148:151], a[224:227], v[104:107]
s_waitcnt lgkmcnt(6)
ds_read_b128 v[184:187], v7 offset:2048
v_cvt_pk_bf16_f32 v230, v124, v125
v_mfma_f32_16x16x32_bf16 v[104:107], v[152:155], a[232:235], v[104:107]
v_cvt_pk_bf16_f32 v231, v126, v127
v_add_u32 v8, s91, v4
v_mfma_f32_16x16x32_bf16 v[108:111], v[152:155], a[236:239], v[108:111]
buffer_store_dwordx4 v[228:231], v4, s[24:27], s55 offen offset:0 sc1
v_mfma_f32_16x16x32_bf16 v[108:111], v[148:151], a[228:231], v[108:111]
ds_read_b128 v[188:191], v7 offset:3072
v_cvt_pk_bf16_f32 v72, v72, v73
v_mfma_f32_16x16x32_bf16 v[112:115], v[156:159], a[224:227], v[112:115]
s_waitcnt lgkmcnt(6)
ds_read_b128 v[144:147], v7 offset:4096
v_cvt_pk_bf16_f32 v73, v74, v75
v_mfma_f32_16x16x32_bf16 v[112:115], v[160:163], a[232:235], v[112:115]
v_cvt_pk_bf16_f32 v74, v80, v81
v_mfma_f32_16x16x32_bf16 v[116:119], v[160:163], a[236:239], v[116:119]
ds_read_b128 v[148:151], v7 offset:5120
v_cvt_pk_bf16_f32 v75, v82, v83
v_mfma_f32_16x16x32_bf16 v[116:119], v[156:159], a[228:231], v[116:119]
buffer_store_dwordx4 v[72:75], v4, s[24:27], s52 offen offset:0 sc1
v_mfma_f32_16x16x32_bf16 v[104:107], v[164:167], a[240:243], v[104:107]
s_waitcnt lgkmcnt(6)
ds_read_b128 v[152:155], v7 offset:6144
v_cvt_pk_bf16_f32 v76, v76, v77
v_mfma_f32_16x16x32_bf16 v[104:107], v[168:171], a[248:251], v[104:107]
v_cvt_pk_bf16_f32 v77, v78, v79
v_mfma_f32_16x16x32_bf16 v[108:111], v[168:171], a[252:255], v[108:111]
ds_read_b128 v[156:159], v7 offset:7168
v_cvt_pk_bf16_f32 v78, v84, v85
v_mfma_f32_16x16x32_bf16 v[108:111], v[164:167], a[244:247], v[108:111]
s_waitcnt lgkmcnt(6)
v_cvt_pk_bf16_f32 v79, v86, v87
v_mfma_f32_16x16x32_bf16 v[112:115], v[172:175], a[240:243], v[112:115]
buffer_store_dwordx4 v[76:79], v4, s[24:27], s52 offen offset:1024 sc1
v_mfma_f32_16x16x32_bf16 v[112:115], v[176:179], a[248:251], v[112:115]
ds_read_b128 v[160:163], v7 offset:8192
v_cvt_pk_bf16_f32 v88, v88, v89
v_mfma_f32_16x16x32_bf16 v[116:119], v[176:179], a[252:255], v[116:119]
ds_read_b128 v[164:167], v7 offset:9216
v_cvt_pk_bf16_f32 v89, v90, v91
v_mfma_f32_16x16x32_bf16 v[116:119], v[172:175], a[244:247], v[116:119]
v_cvt_pk_bf16_f32 v90, v96, v97
v_mfma_f32_16x16x32_bf16 v[104:107], v[180:183], a[96:99], v[104:107]
s_waitcnt lgkmcnt(6)
ds_read_b128 v[168:171], v7 offset:10240
v_cvt_pk_bf16_f32 v91, v98, v99
v_mfma_f32_16x16x32_bf16 v[104:107], v[184:187], a[104:107], v[104:107]
buffer_store_dwordx4 v[88:91], v4, s[24:27], s53 offen offset:0 sc1
v_mfma_f32_16x16x32_bf16 v[108:111], v[184:187], a[108:111], v[108:111]
ds_read_b128 v[172:175], v7 offset:11264
v_cvt_pk_bf16_f32 v92, v92, v93
v_mfma_f32_16x16x32_bf16 v[108:111], v[180:183], a[100:103], v[108:111]
v_cvt_pk_bf16_f32 v93, v94, v95
v_mfma_f32_16x16x32_bf16 v[112:115], v[188:191], a[96:99], v[112:115]
s_waitcnt lgkmcnt(6)
ds_read_b128 v[176:179], v7 offset:12288
v_cvt_pk_bf16_f32 v94, v100, v101
v_mfma_f32_16x16x32_bf16 v[112:115], v[144:147], a[104:107], v[112:115]
v_cvt_pk_bf16_f32 v95, v102, v103
v_mfma_f32_16x16x32_bf16 v[116:119], v[144:147], a[108:111], v[116:119]
buffer_store_dwordx4 v[92:95], v4, s[24:27], s53 offen offset:1024 sc1
v_mfma_f32_16x16x32_bf16 v[116:119], v[188:191], a[100:103], v[116:119]
ds_read_b128 v[180:183], v7 offset:13312
v_mfma_f32_16x16x32_bf16 v[104:107], v[148:151], a[112:115], v[104:107]
s_waitcnt lgkmcnt(6)
ds_read_b128 v[184:187], v7 offset:14336
v_mfma_f32_16x16x32_bf16 v[104:107], v[152:155], a[120:123], v[104:107]
v_mfma_f32_16x16x32_bf16 v[108:111], v[152:155], a[124:127], v[108:111]
ds_read_b128 v[188:191], v7 offset:15360
v_mfma_f32_16x16x32_bf16 v[108:111], v[148:151], a[116:119], v[108:111]
s_add_u32 s91, s91, 16384
s_cmp_ge_u32 s91, 163840
s_cselect_b32 s91, 0, s91
v_mfma_f32_16x16x32_bf16 v[112:115], v[156:159], a[112:115], v[112:115]
s_waitcnt lgkmcnt(6)
ds_read_b128 v[144:147], v8 offset:0
v_add_u32 v7, s91, v4
v_mfma_f32_16x16x32_bf16 v[112:115], v[160:163], a[120:123], v[112:115]
v_mfma_f32_16x16x32_bf16 v[116:119], v[160:163], a[124:127], v[116:119]
ds_read_b128 v[148:151], v8 offset:1024
v_mfma_f32_16x16x32_bf16 v[116:119], v[156:159], a[116:119], v[116:119]
s_waitcnt lgkmcnt(6)
v_mfma_f32_16x16x32_bf16 v[104:107], v[164:167], a[128:131], v[104:107]
s_mov_b32 m0, s70
s_mov_b32 s64, s68
s_add_u32 s68, s68, 16384
v_mfma_f32_16x16x32_bf16 v[104:107], v[168:171], a[136:139], v[104:107]
ds_read_b128 v[152:155], v8 offset:2048
v_mfma_f32_16x16x32_bf16 v[108:111], v[168:171], a[140:143], v[108:111]
s_add_u32 s70, s70, 16384
s_cmp_ge_u32 s70, 163840
s_cselect_b32 s70, s80, s70
v_mfma_f32_16x16x32_bf16 v[108:111], v[164:167], a[132:135], v[108:111]
buffer_load_dwordx4 v4, s[24:27], s64 offen offset:0 sc1 lds
v_mfma_f32_16x16x32_bf16 v[112:115], v[172:175], a[128:131], v[112:115]
s_waitcnt lgkmcnt(5)
ds_read_b128 v[156:159], v8 offset:3072
v_mfma_f32_16x16x32_bf16 v[112:115], v[176:179], a[136:139], v[112:115]
ds_read_b128 v[160:163], v8 offset:4096
v_mfma_f32_16x16x32_bf16 v[116:119], v[176:179], a[140:143], v[116:119]
buffer_load_dwordx4 v4, s[24:27], s64 offen offset:1024 sc1 lds
v_mfma_f32_16x16x32_bf16 v[116:119], v[172:175], a[132:135], v[116:119]
ds_read_b128 v[164:167], v8 offset:5120
v_mfma_f32_16x16x32_bf16 v[104:107], v[180:183], a[144:147], v[104:107]
s_waitcnt lgkmcnt(6)
ds_read_b128 v[168:171], v8 offset:6144
v_mfma_f32_16x16x32_bf16 v[104:107], v[184:187], a[152:155], v[104:107]
buffer_load_dwordx4 v4, s[24:27], s64 offen offset:2048 sc1 lds
v_mfma_f32_16x16x32_bf16 v[108:111], v[184:187], a[156:159], v[108:111]
ds_read_b128 v[172:175], v8 offset:7168
v_mfma_f32_16x16x32_bf16 v[108:111], v[180:183], a[148:151], v[108:111]
s_waitcnt lgkmcnt(6)
v_mfma_f32_16x16x32_bf16 v[112:115], v[188:191], a[144:147], v[112:115]
buffer_load_dwordx4 v4, s[24:27], s64 offen offset:3072 sc1 lds
v_mfma_f32_16x16x32_bf16 v[112:115], v[144:147], a[152:155], v[112:115]
ds_read_b128 v[176:179], v8 offset:8192
v_mfma_f32_16x16x32_bf16 v[116:119], v[144:147], a[156:159], v[116:119]
s_mov_b32 m0, s70
s_mov_b32 s64, s68
s_add_u32 s68, s68, 16384
v_mfma_f32_16x16x32_bf16 v[116:119], v[188:191], a[148:151], v[116:119]
s_waitcnt lgkmcnt(5)
ds_read_b128 v[180:183], v8 offset:9216
v_mfma_f32_16x16x32_bf16 v[104:107], v[148:151], a[160:163], v[104:107]
s_add_u32 s70, s70, 16384
s_cmp_ge_u32 s70, 163840
s_cselect_b32 s70, s80, s70
v_mfma_f32_16x16x32_bf16 v[104:107], v[152:155], a[168:171], v[104:107]
buffer_load_dwordx4 v4, s[24:27], s64 offen offset:0 sc1 lds
v_mfma_f32_16x16x32_bf16 v[108:111], v[152:155], a[172:175], v[108:111]
ds_read_b128 v[184:187], v8 offset:10240
v_mfma_f32_16x16x32_bf16 v[108:111], v[148:151], a[164:167], v[108:111]
s_waitcnt lgkmcnt(5)
ds_read_b128 v[188:191], v8 offset:11264
v_mfma_f32_16x16x32_bf16 v[112:115], v[156:159], a[160:163], v[112:115]
buffer_load_dwordx4 v4, s[24:27], s64 offen offset:1024 sc1 lds
v_mfma_f32_16x16x32_bf16 v[112:115], v[160:163], a[168:171], v[112:115]
ds_read_b128 v[144:147], v8 offset:12288
v_mfma_f32_16x16x32_bf16 v[116:119], v[160:163], a[172:175], v[116:119]
ds_read_b128 v[148:151], v8 offset:13312
v_mfma_f32_16x16x32_bf16 v[116:119], v[156:159], a[164:167], v[116:119]
buffer_load_dwordx4 v4, s[24:27], s64 offen offset:2048 sc1 lds
v_mfma_f32_16x16x32_bf16 v[104:107], v[164:167], a[176:179], v[104:107]
s_waitcnt lgkmcnt(6)
ds_read_b128 v[152:155], v8 offset:14336
v_mfma_f32_16x16x32_bf16 v[104:107], v[168:171], a[184:187], v[104:107]
v_mfma_f32_16x16x32_bf16 v[108:111], v[168:171], a[188:191], v[108:111]
s_waitcnt vmcnt(12) lgkmcnt(5)
ds_read_b128 v[156:159], v8 offset:15360
v_mfma_f32_16x16x32_bf16 v[108:111], v[164:167], a[180:183], v[108:111]
s_barrier
v_mfma_f32_16x16x32_bf16 v[112:115], v[172:175], a[176:179], v[112:115]
buffer_load_dwordx4 v4, s[24:27], s64 offen offset:3072 sc1 lds
v_mfma_f32_16x16x32_bf16 v[112:115], v[176:179], a[184:187], v[112:115]
s_add_u32 s91, s91, 16384
ds_read_b128 v[160:163], v7 offset:0
v_mfma_f32_16x16x32_bf16 v[116:119], v[176:179], a[188:191], v[116:119]
s_cmp_ge_u32 s91, 163840
s_cselect_b32 s91, 0, s91
ds_read_b128 v[164:167], v7 offset:1024
v_mfma_f32_16x16x32_bf16 v[116:119], v[172:175], a[180:183], v[116:119]
v_add_u32 v8, s91, v4
v_mfma_f32_16x16x32_bf16 v[104:107], v[180:183], v[32:35], v[104:107]
s_waitcnt lgkmcnt(6)
ds_read_b128 v[168:171], v7 offset:2048
v_mfma_f32_16x16x32_bf16 v[104:107], v[184:187], v[40:43], v[104:107]
v_mfma_f32_16x16x32_bf16 v[108:111], v[184:187], v[44:47], v[108:111]
ds_read_b128 v[172:175], v7 offset:3072
v_mfma_f32_16x16x32_bf16 v[108:111], v[180:183], v[36:39], v[108:111]
v_mfma_f32_16x16x32_bf16 v[112:115], v[188:191], v[32:35], v[112:115]
s_waitcnt lgkmcnt(6)
ds_read_b128 v[176:179], v7 offset:4096
v_mfma_f32_16x16x32_bf16 v[112:115], v[144:147], v[40:43], v[112:115]
v_mfma_f32_16x16x32_bf16 v[116:119], v[144:147], v[44:47], v[116:119]
ds_read_b128 v[180:183], v7 offset:5120
v_mfma_f32_16x16x32_bf16 v[116:119], v[188:191], v[36:39], v[116:119]
v_mfma_f32_16x16x32_bf16 v[104:107], v[148:151], v[48:51], v[104:107]
s_waitcnt vmcnt(8) lgkmcnt(6)
ds_read_b128 v[184:187], v7 offset:6144
v_mfma_f32_16x16x32_bf16 v[104:107], v[152:155], v[56:59], v[104:107]
buffer_atomic_add v1, v0, s[24:27], s73 offen offset:0 sc1
v_mfma_f32_16x16x32_bf16 v[108:111], v[152:155], v[60:63], v[108:111]
ds_read_b128 v[188:191], v7 offset:7168
v_mfma_f32_16x16x32_bf16 v[108:111], v[148:151], v[52:55], v[108:111]
v_mfma_f32_16x16x32_bf16 v[112:115], v[156:159], v[48:51], v[112:115]
s_waitcnt lgkmcnt(6)
ds_read_b128 v[144:147], v7 offset:8192
v_mfma_f32_16x16x32_bf16 v[112:115], v[160:163], v[56:59], v[112:115]
v_mfma_f32_16x16x32_bf16 v[116:119], v[160:163], v[60:63], v[116:119]
ds_read_b128 v[148:151], v7 offset:9216
v_mfma_f32_16x16x32_bf16 v[116:119], v[156:159], v[52:55], v[116:119]
v_mfma_f32_16x16x32_bf16 v[104:107], v[164:167], v[64:67], v[104:107]
ds_read_b128 v[152:155], v7 offset:10240
v_mfma_f32_16x16x32_bf16 v[108:111], v[164:167], v[68:71], v[108:111]
s_waitcnt lgkmcnt(7)
v_mfma_f32_16x16x32_bf16 v[112:115], v[168:171], v[64:67], v[112:115]
ds_read_b128 v[156:159], v7 offset:11264
v_mfma_f32_16x16x32_bf16 v[116:119], v[168:171], v[68:71], v[116:119]
v_mfma_f32_16x16x32_bf16 v[128:131], v[172:175], a[0:3], 0
s_waitcnt lgkmcnt(6)
ds_read_b128 v[160:163], v7 offset:12288
v_mfma_f32_16x16x32_bf16 v[128:131], v[176:179], a[8:11], v[128:131]
v_mfma_f32_16x16x32_bf16 v[132:135], v[176:179], a[12:15], 0
ds_read_b128 v[164:167], v7 offset:13312
v_mfma_f32_16x16x32_bf16 v[132:135], v[172:175], a[4:7], v[132:135]
v_mfma_f32_16x16x32_bf16 v[136:139], v[180:183], a[0:3], 0
s_waitcnt lgkmcnt(6)
ds_read_b128 v[168:171], v7 offset:14336
v_mfma_f32_16x16x32_bf16 v[136:139], v[184:187], a[8:11], v[136:139]
v_cvt_pk_bf16_f32 v104, v104, v105
v_mfma_f32_16x16x32_bf16 v[140:143], v[184:187], a[12:15], 0
ds_read_b128 v[172:175], v7 offset:15360
v_cvt_pk_bf16_f32 v105, v106, v107
v_mfma_f32_16x16x32_bf16 v[140:143], v[180:183], a[4:7], v[140:143]
s_add_u32 s91, s91, 16384
v_cvt_pk_bf16_f32 v106, v112, v113
v_mfma_f32_16x16x32_bf16 v[128:131], v[188:191], a[16:19], v[128:131]
s_waitcnt lgkmcnt(6)
ds_read_b128 v[176:179], v8 offset:0
v_cvt_pk_bf16_f32 v107, v114, v115
v_mfma_f32_16x16x32_bf16 v[128:131], v[144:147], a[24:27], v[128:131]
buffer_store_dwordx4 v[104:107], v4, s[24:27], s54 offen offset:0 sc1
v_mfma_f32_16x16x32_bf16 v[132:135], v[144:147], a[28:31], v[132:135]
ds_read_b128 v[180:183], v8 offset:1024
v_cvt_pk_bf16_f32 v108, v108, v109
v_mfma_f32_16x16x32_bf16 v[132:135], v[188:191], a[20:23], v[132:135]
s_cmp_ge_u32 s91, 163840
s_cselect_b32 s91, 0, s91
v_cvt_pk_bf16_f32 v109, v110, v111
v_mfma_f32_16x16x32_bf16 v[136:139], v[148:151], a[16:19], v[136:139]
s_waitcnt lgkmcnt(6)
ds_read_b128 v[184:187], v8 offset:2048
v_cvt_pk_bf16_f32 v110, v116, v117
v_mfma_f32_16x16x32_bf16 v[136:139], v[152:155], a[24:27], v[136:139]
s_waitcnt lgkmcnt(5)
v_cvt_pk_bf16_f32 v111, v118, v119
v_add_u32 v7, s91, v4
v_mfma_f32_16x16x32_bf16 v[140:143], v[152:155], a[28:31], v[140:143]
buffer_store_dwordx4 v[108:111], v4, s[24:27], s54 offen offset:1024 sc1
v_mfma_f32_16x16x32_bf16 v[140:143], v[148:151], a[20:23], v[140:143]
s_mov_b32 m0, s70
s_mov_b32 s64, s68
s_add_u32 s68, s68, 16384
v_mfma_f32_16x16x32_bf16 v[128:131], v[156:159], a[32:35], v[128:131]
s_cmp_lt_u32 s3, 3
s_cselect_b32 s68, s64, 2147418112
ds_read_b128 v[188:191], v8 offset:3072
v_mfma_f32_16x16x32_bf16 v[128:131], v[160:163], a[40:43], v[128:131]
buffer_load_dwordx4 v4, s[24:27], s64 offen offset:0 sc1 lds
v_mfma_f32_16x16x32_bf16 v[132:135], v[160:163], a[44:47], v[132:135]
ds_read_b128 v[144:147], v8 offset:4096
v_mfma_f32_16x16x32_bf16 v[132:135], v[156:159], a[36:39], v[132:135]
s_waitcnt lgkmcnt(5)
ds_read_b128 v[148:151], v8 offset:5120
v_mfma_f32_16x16x32_bf16 v[136:139], v[164:167], a[32:35], v[136:139]
buffer_load_dwordx4 v4, s[24:27], s68 offen offset:1024 sc1 lds
v_mfma_f32_16x16x32_bf16 v[136:139], v[168:171], a[40:43], v[136:139]
ds_read_b128 v[152:155], v8 offset:6144
v_mfma_f32_16x16x32_bf16 v[140:143], v[168:171], a[44:47], v[140:143]
ds_read_b128 v[156:159], v8 offset:7168
v_mfma_f32_16x16x32_bf16 v[140:143], v[164:167], a[36:39], v[140:143]
buffer_load_dwordx4 v4, s[24:27], s68 offen offset:2048 sc1 lds
v_mfma_f32_16x16x32_bf16 v[128:131], v[172:175], a[48:51], v[128:131]
s_waitcnt lgkmcnt(6)
ds_read_b128 v[160:163], v8 offset:8192
v_mfma_f32_16x16x32_bf16 v[128:131], v[176:179], a[56:59], v[128:131]
v_mfma_f32_16x16x32_bf16 v[132:135], v[176:179], a[60:63], v[132:135]
buffer_load_dwordx4 v4, s[24:27], s68 offen offset:3072 sc1 lds
v_mfma_f32_16x16x32_bf16 v[132:135], v[172:175], a[52:55], v[132:135]
ds_read_b128 v[164:167], v8 offset:9216
v_mfma_f32_16x16x32_bf16 v[136:139], v[180:183], a[48:51], v[136:139]
s_waitcnt lgkmcnt(6)
ds_read_b128 v[168:171], v8 offset:10240
v_mfma_f32_16x16x32_bf16 v[136:139], v[184:187], a[56:59], v[136:139]
buffer_load_dword v12, v10, s[24:27], s73 offen sc1
v_mfma_f32_16x16x32_bf16 v[140:143], v[184:187], a[60:63], v[140:143]
ds_read_b128 v[172:175], v8 offset:11264
v_mfma_f32_16x16x32_bf16 v[140:143], v[180:183], a[52:55], v[140:143]
v_mfma_f32_16x16x32_bf16 v[128:131], v[188:191], a[64:67], v[128:131]
s_waitcnt lgkmcnt(6)
ds_read_b128 v[176:179], v8 offset:12288
v_mfma_f32_16x16x32_bf16 v[128:131], v[144:147], a[72:75], v[128:131]
v_mfma_f32_16x16x32_bf16 v[132:135], v[144:147], a[76:79], v[132:135]
ds_read_b128 v[180:183], v8 offset:13312
v_mfma_f32_16x16x32_bf16 v[132:135], v[188:191], a[68:71], v[132:135]
v_mfma_f32_16x16x32_bf16 v[136:139], v[148:151], a[64:67], v[136:139]
s_waitcnt lgkmcnt(6)
ds_read_b128 v[184:187], v8 offset:14336
v_mfma_f32_16x16x32_bf16 v[136:139], v[152:155], a[72:75], v[136:139]
v_mfma_f32_16x16x32_bf16 v[140:143], v[152:155], a[76:79], v[140:143]
s_waitcnt vmcnt(8)
ds_read_b128 v[188:191], v8 offset:15360
v_mfma_f32_16x16x32_bf16 v[140:143], v[148:151], a[68:71], v[140:143]
s_barrier
v_mfma_f32_16x16x32_bf16 v[128:131], v[156:159], a[80:83], v[128:131]
s_waitcnt lgkmcnt(6)
s_add_u32 s91, s91, 16384
ds_read_b128 v[144:147], v7 offset:0
v_mfma_f32_16x16x32_bf16 v[128:131], v[160:163], a[88:91], v[128:131]
s_cmp_ge_u32 s91, 163840
s_cselect_b32 s91, 0, s91
v_add_u32 v8, s91, v4
v_mfma_f32_16x16x32_bf16 v[132:135], v[160:163], a[92:95], v[132:135]
ds_read_b128 v[148:151], v7 offset:1024
v_mfma_f32_16x16x32_bf16 v[132:135], v[156:159], a[84:87], v[132:135]
v_mfma_f32_16x16x32_bf16 v[136:139], v[164:167], a[80:83], v[136:139]
s_waitcnt lgkmcnt(6)
ds_read_b128 v[152:155], v7 offset:2048
v_mfma_f32_16x16x32_bf16 v[136:139], v[168:171], a[88:91], v[136:139]
v_mfma_f32_16x16x32_bf16 v[140:143], v[168:171], a[92:95], v[140:143]
ds_read_b128 v[156:159], v7 offset:3072
v_mfma_f32_16x16x32_bf16 v[140:143], v[164:167], a[84:87], v[140:143]
v_mfma_f32_16x16x32_bf16 v[128:131], v[172:175], a[192:195], v[128:131]
s_waitcnt lgkmcnt(6)
ds_read_b128 v[160:163], v7 offset:4096
v_mfma_f32_16x16x32_bf16 v[128:131], v[176:179], a[200:203], v[128:131]
v_mfma_f32_16x16x32_bf16 v[132:135], v[176:179], a[204:207], v[132:135]
ds_read_b128 v[164:167], v7 offset:5120
v_mfma_f32_16x16x32_bf16 v[132:135], v[172:175], a[196:199], v[132:135]
v_mfma_f32_16x16x32_bf16 v[136:139], v[180:183], a[192:195], v[136:139]
s_waitcnt lgkmcnt(6)
ds_read_b128 v[168:171], v7 offset:6144
v_mfma_f32_16x16x32_bf16 v[136:139], v[184:187], a[200:203], v[136:139]
v_mfma_f32_16x16x32_bf16 v[140:143], v[184:187], a[204:207], v[140:143]
s_waitcnt vmcnt(5)
ds_read_b128 v[172:175], v7 offset:7168
v_mfma_f32_16x16x32_bf16 v[140:143], v[180:183], a[196:199], v[140:143]
buffer_atomic_add v1, v0, s[24:27], s73 offen offset:16 sc1
v_mfma_f32_16x16x32_bf16 v[128:131], v[188:191], a[208:211], v[128:131]
s_waitcnt lgkmcnt(6)
L_PAD13:
s_cbranch_execz L_MAIN
ds_read_b128 v[176:179], v7 offset:8192
v_mfma_f32_16x16x32_bf16 v[128:131], v[144:147], a[216:219], v[128:131]
v_mfma_f32_16x16x32_bf16 v[132:135], v[144:147], a[220:223], v[132:135]
ds_read_b128 v[180:183], v7 offset:9216
v_mfma_f32_16x16x32_bf16 v[132:135], v[188:191], a[212:215], v[132:135]
s_waitcnt vmcnt(1)
v_mfma_f32_16x16x32_bf16 v[136:139], v[148:151], a[208:211], v[136:139]
s_waitcnt lgkmcnt(6)
ds_read_b128 v[184:187], v7 offset:10240
v_cmp_gt_u32 vcc, 4, v12
v_mfma_f32_16x16x32_bf16 v[136:139], v[152:155], a[216:219], v[136:139]
v_mfma_f32_16x16x32_bf16 v[140:143], v[152:155], a[220:223], v[140:143]
ds_read_b128 v[188:191], v7 offset:11264
v_mfma_f32_16x16x32_bf16 v[140:143], v[148:151], a[212:215], v[140:143]
v_mfma_f32_16x16x32_bf16 v[128:131], v[156:159], a[224:227], v[128:131]
s_waitcnt lgkmcnt(6)
ds_read_b128 v[144:147], v7 offset:12288
v_mfma_f32_16x16x32_bf16 v[128:131], v[160:163], a[232:235], v[128:131]
s_cbranch_vccnz CK_P1
CK_P1_R:
v_mfma_f32_16x16x32_bf16 v[132:135], v[160:163], a[236:239], v[132:135]
ds_read_b128 v[148:151], v7 offset:13312
v_mfma_f32_16x16x32_bf16 v[132:135], v[156:159], a[228:231], v[132:135]
s_waitcnt lgkmcnt(6)
v_mfma_f32_16x16x32_bf16 v[136:139], v[164:167], a[224:227], v[136:139]
buffer_load_dwordx4 v[192:195], v4, s[24:27], s69 offen offset:0 sc1
v_mfma_f32_16x16x32_bf16 v[136:139], v[168:171], a[232:235], v[136:139]
ds_read_b128 v[152:155], v7 offset:14336
v_mfma_f32_16x16x32_bf16 v[140:143], v[168:171], a[236:239], v[140:143]
ds_read_b128 v[156:159], v7 offset:15360
v_mfma_f32_16x16x32_bf16 v[140:143], v[164:167], a[228:231], v[140:143]
buffer_load_dwordx4 v[196:199], v4, s[24:27], s69 offen offset:1024 sc1
v_mfma_f32_16x16x32_bf16 v[128:131], v[172:175], a[240:243], v[128:131]
s_waitcnt lgkmcnt(6)
s_add_u32 s91, s91, 16384
ds_read_b128 v[160:163], v8 offset:0
v_mfma_f32_16x16x32_bf16 v[128:131], v[176:179], a[248:251], v[128:131]
s_cmp_ge_u32 s91, 163840
s_cselect_b32 s91, 0, s91
v_add_u32 v7, s91, v4
v_mfma_f32_16x16x32_bf16 v[132:135], v[176:179], a[252:255], v[132:135]
buffer_load_dwordx4 v[200:203], v4, s[24:27], s69 offen offset:2048 sc1
v_mfma_f32_16x16x32_bf16 v[132:135], v[172:175], a[244:247], v[132:135]
ds_read_b128 v[164:167], v8 offset:1024
v_mfma_f32_16x16x32_bf16 v[136:139], v[180:183], a[240:243], v[136:139]
s_waitcnt lgkmcnt(6)
ds_read_b128 v[168:171], v8 offset:2048
v_mfma_f32_16x16x32_bf16 v[136:139], v[184:187], a[248:251], v[136:139]
buffer_load_dwordx4 v[204:207], v4, s[24:27], s69 offen offset:3072 sc1
v_mfma_f32_16x16x32_bf16 v[140:143], v[184:187], a[252:255], v[140:143]
ds_read_b128 v[172:175], v8 offset:3072
v_mfma_f32_16x16x32_bf16 v[140:143], v[180:183], a[244:247], v[140:143]
s_waitcnt lgkmcnt(6)
v_mfma_f32_16x16x32_bf16 v[128:131], v[188:191], a[96:99], v[128:131]
buffer_load_dwordx4 v[208:211], v4, s[24:27], s71 offen offset:0 sc1
v_mfma_f32_16x16x32_bf16 v[128:131], v[144:147], a[104:107], v[128:131]
ds_read_b128 v[176:179], v8 offset:4096
v_mfma_f32_16x16x32_bf16 v[132:135], v[144:147], a[108:111], v[132:135]
ds_read_b128 v[180:183], v8 offset:5120
v_mfma_f32_16x16x32_bf16 v[132:135], v[188:191], a[100:103], v[132:135]
buffer_load_dwordx4 v[212:215], v4, s[24:27], s71 offen offset:1024 sc1
v_mfma_f32_16x16x32_bf16 v[136:139], v[148:151], a[96:99], v[136:139]
s_waitcnt lgkmcnt(6)
ds_read_b128 v[184:187], v8 offset:6144
v_mfma_f32_16x16x32_bf16 v[136:139], v[152:155], a[104:107], v[136:139]
v_mfma_f32_16x16x32_bf16 v[140:143], v[152:155], a[108:111], v[140:143]
buffer_load_dwordx4 v[216:219], v4, s[24:27], s71 offen offset:2048 sc1
v_mfma_f32_16x16x32_bf16 v[140:143], v[148:151], a[100:103], v[140:143]
ds_read_b128 v[188:191], v8 offset:7168
v_mfma_f32_16x16x32_bf16 v[128:131], v[156:159], a[112:115], v[128:131]
s_waitcnt lgkmcnt(6)
ds_read_b128 v[144:147], v8 offset:8192
v_mfma_f32_16x16x32_bf16 v[128:131], v[160:163], a[120:123], v[128:131]
v_mfma_f32_16x16x32_bf16 v[132:135], v[160:163], a[124:127], v[132:135]
ds_read_b128 v[148:151], v8 offset:9216
v_mfma_f32_16x16x32_bf16 v[132:135], v[156:159], a[116:119], v[132:135]
v_mfma_f32_16x16x32_bf16 v[136:139], v[164:167], a[112:115], v[136:139]
s_waitcnt lgkmcnt(6)
ds_read_b128 v[152:155], v8 offset:10240
v_mfma_f32_16x16x32_bf16 v[136:139], v[168:171], a[120:123], v[136:139]
v_mfma_f32_16x16x32_bf16 v[140:143], v[168:171], a[124:127], v[140:143]
ds_read_b128 v[156:159], v8 offset:11264
v_mfma_f32_16x16x32_bf16 v[140:143], v[164:167], a[116:119], v[140:143]
v_mfma_f32_16x16x32_bf16 v[128:131], v[172:175], a[128:131], v[128:131]
s_waitcnt lgkmcnt(6)
ds_read_b128 v[160:163], v8 offset:12288
v_mfma_f32_16x16x32_bf16 v[128:131], v[176:179], a[136:139], v[128:131]
v_mfma_f32_16x16x32_bf16 v[132:135], v[176:179], a[140:143], v[132:135]
ds_read_b128 v[164:167], v8 offset:13312
v_mfma_f32_16x16x32_bf16 v[132:135], v[172:175], a[132:135], v[132:135]
v_mfma_f32_16x16x32_bf16 v[136:139], v[180:183], a[128:131], v[136:139]
s_waitcnt lgkmcnt(6)
ds_read_b128 v[168:171], v8 offset:14336
v_mfma_f32_16x16x32_bf16 v[136:139], v[184:187], a[136:139], v[136:139]
v_mfma_f32_16x16x32_bf16 v[140:143], v[184:187], a[140:143], v[140:143]
s_waitcnt vmcnt(9)
ds_read_b128 v[172:175], v8 offset:15360
v_mfma_f32_16x16x32_bf16 v[140:143], v[180:183], a[132:135], v[140:143]
s_barrier
v_mfma_f32_16x16x32_bf16 v[128:131], v[188:191], a[144:147], v[128:131]
s_waitcnt lgkmcnt(6)
ds_read_b128 v[176:179], v7 offset:0
v_mfma_f32_16x16x32_bf16 v[128:131], v[144:147], a[152:155], v[128:131]
v_mfma_f32_16x16x32_bf16 v[132:135], v[144:147], a[156:159], v[132:135]
ds_read_b128 v[180:183], v7 offset:1024
v_mfma_f32_16x16x32_bf16 v[132:135], v[188:191], a[148:151], v[132:135]
v_mfma_f32_16x16x32_bf16 v[136:139], v[148:151], a[144:147], v[136:139]
s_waitcnt lgkmcnt(6)
ds_read_b128 v[184:187], v7 offset:2048
v_mfma_f32_16x16x32_bf16 v[136:139], v[152:155], a[152:155], v[136:139]
v_mfma_f32_16x16x32_bf16 v[140:143], v[152:155], a[156:159], v[140:143]
ds_read_b128 v[188:191], v7 offset:3072
v_mfma_f32_16x16x32_bf16 v[140:143], v[148:151], a[148:151], v[140:143]
v_mfma_f32_16x16x32_bf16 v[128:131], v[156:159], a[160:163], v[128:131]
s_waitcnt lgkmcnt(6)
ds_read_b128 v[144:147], v7 offset:4096
v_mfma_f32_16x16x32_bf16 v[128:131], v[160:163], a[168:171], v[128:131]
v_mfma_f32_16x16x32_bf16 v[132:135], v[160:163], a[172:175], v[132:135]
ds_read_b128 v[148:151], v7 offset:5120
v_mfma_f32_16x16x32_bf16 v[132:135], v[156:159], a[164:167], v[132:135]
v_mfma_f32_16x16x32_bf16 v[136:139], v[164:167], a[160:163], v[136:139]
s_waitcnt lgkmcnt(6)
ds_read_b128 v[152:155], v7 offset:6144
v_mfma_f32_16x16x32_bf16 v[136:139], v[168:171], a[168:171], v[136:139]
v_mfma_f32_16x16x32_bf16 v[140:143], v[168:171], a[172:175], v[140:143]
ds_read_b128 v[156:159], v7 offset:7168
v_mfma_f32_16x16x32_bf16 v[140:143], v[164:167], a[164:167], v[140:143]
v_mfma_f32_16x16x32_bf16 v[128:131], v[172:175], a[176:179], v[128:131]
s_waitcnt lgkmcnt(6)
ds_read_b128 v[160:163], v7 offset:8192
v_mfma_f32_16x16x32_bf16 v[128:131], v[176:179], a[184:187], v[128:131]
v_mfma_f32_16x16x32_bf16 v[132:135], v[176:179], a[188:191], v[132:135]
ds_read_b128 v[164:167], v7 offset:9216
v_mfma_f32_16x16x32_bf16 v[132:135], v[172:175], a[180:183], v[132:135]
v_mfma_f32_16x16x32_bf16 v[136:139], v[180:183], a[176:179], v[136:139]
s_waitcnt lgkmcnt(6)
ds_read_b128 v[168:171], v7 offset:10240
v_mfma_f32_16x16x32_bf16 v[136:139], v[184:187], a[184:187], v[136:139]
v_mfma_f32_16x16x32_bf16 v[140:143], v[184:187], a[188:191], v[140:143]
ds_read_b128 v[172:175], v7 offset:11264
v_mfma_f32_16x16x32_bf16 v[140:143], v[180:183], a[180:183], v[140:143]
s_waitcnt lgkmcnt(6)
v_mfma_f32_16x16x32_bf16 v[128:131], v[188:191], v[32:35], v[128:131]
buffer_load_dword v12, v10, s[24:27], s73 offen offset:16 sc1
v_mfma_f32_16x16x32_bf16 v[128:131], v[144:147], v[40:43], v[128:131]
ds_read_b128 v[176:179], v7 offset:12288
v_mfma_f32_16x16x32_bf16 v[132:135], v[144:147], v[44:47], v[132:135]
v_mfma_f32_16x16x32_bf16 v[132:135], v[188:191], v[36:39], v[132:135]
v_mfma_f32_16x16x32_bf16 v[136:139], v[148:151], v[32:35], v[136:139]
s_waitcnt lgkmcnt(5)
v_mfma_f32_16x16x32_bf16 v[136:139], v[152:155], v[40:43], v[136:139]
v_mfma_f32_16x16x32_bf16 v[140:143], v[152:155], v[44:47], v[140:143]
v_mfma_f32_16x16x32_bf16 v[140:143], v[148:151], v[36:39], v[140:143]
v_mfma_f32_16x16x32_bf16 v[128:131], v[156:159], v[48:51], v[128:131]
s_waitcnt lgkmcnt(3)
v_mfma_f32_16x16x32_bf16 v[128:131], v[160:163], v[56:59], v[128:131]
v_mfma_f32_16x16x32_bf16 v[132:135], v[160:163], v[60:63], v[132:135]
v_mfma_f32_16x16x32_bf16 v[132:135], v[156:159], v[52:55], v[132:135]
v_mfma_f32_16x16x32_bf16 v[136:139], v[164:167], v[48:51], v[136:139]
s_waitcnt lgkmcnt(1)
v_mfma_f32_16x16x32_bf16 v[136:139], v[168:171], v[56:59], v[136:139]
v_mfma_f32_16x16x32_bf16 v[140:143], v[168:171], v[60:63], v[140:143]
v_mfma_f32_16x16x32_bf16 v[140:143], v[164:167], v[52:55], v[140:143]
v_mfma_f32_16x16x32_bf16 v[128:131], v[172:175], v[64:67], v[128:131]
v_mfma_f32_16x16x32_bf16 v[132:135], v[172:175], v[68:71], v[132:135]
s_waitcnt lgkmcnt(0)
v_mfma_f32_16x16x32_bf16 v[136:139], v[176:179], v[64:67], v[136:139]
v_mfma_f32_16x16x32_bf16 v[140:143], v[176:179], v[68:71], v[140:143]
s_waitcnt vmcnt(0)
v_cmp_gt_u32 vcc, 4, v12
s_nop 4
s_cbranch_vccnz CK_P2
CK_P2_R:
buffer_load_dwordx4 v[220:223], v4, s[24:27], s83 offen offset:0 sc1
buffer_load_dwordx4 v[224:227], v4, s[24:27], s83 offen offset:1024 sc1
s_and_b32 s54, s3, 1
s_mul_i32 s54, s54, 18432
s_mul_i32 s55, s86, 288
s_add_u32 s54, s54, s55
s_add_u32 s54, s54, 256
s_sub_u32 s55, 63, s72
s_mul_i32 s55, s55, 36864
s_add_u32 s55, s55, s54
s_mul_i32 s52, s72, 36864
s_add_u32 s54, s54, s52
s_lshl_b32 s53, s84, 6
s_sub_u32 s53, s53, 256
s_add_u32 s52, s54, s53
s_add_u32 s53, s55, s53
v_lshlrev_b32 v16, 16, v192
v_and_b32 v17, v13, v192
v_lshlrev_b32 v18, 16, v193
v_and_b32 v19, v13, v193
v_lshlrev_b32 v20, 16, v194
v_and_b32 v21, v13, v194
v_lshlrev_b32 v22, 16, v195
v_and_b32 v23, v13, v195
v_pk_add_f32 v[128:129], v[128:129], v[16:17]
v_pk_add_f32 v[130:131], v[130:131], v[18:19]
v_pk_add_f32 v[136:137], v[136:137], v[20:21]
v_pk_add_f32 v[138:139], v[138:139], v[22:23]
v_lshlrev_b32 v16, 16, v196
v_and_b32 v17, v13, v196
v_lshlrev_b32 v18, 16, v197
v_and_b32 v19, v13, v197
v_lshlrev_b32 v20, 16, v198
v_and_b32 v21, v13, v198
v_lshlrev_b32 v22, 16, v199
v_and_b32 v23, v13, v199
v_pk_add_f32 v[132:133], v[132:133], v[16:17]
v_pk_add_f32 v[134:135], v[134:135], v[18:19]
v_pk_add_f32 v[140:141], v[140:141], v[20:21]
v_pk_add_f32 v[142:143], v[142:143], v[22:23]
v_lshlrev_b32 v16, 16, v200
v_and_b32 v17, v13, v200
v_lshlrev_b32 v18, 16, v201
v_and_b32 v19, v13, v201
v_lshlrev_b32 v20, 16, v202
v_and_b32 v21, v13, v202
v_lshlrev_b32 v22, 16, v203
v_and_b32 v23, v13, v203
v_pk_add_f32 v[128:129], v[128:129], v[16:17]
v_pk_add_f32 v[130:131], v[130:131], v[18:19]
v_pk_add_f32 v[136:137], v[136:137], v[20:21]
v_pk_add_f32 v[138:139], v[138:139], v[22:23]
v_lshlrev_b32 v16, 16, v204
v_and_b32 v17, v13, v204
v_lshlrev_b32 v18, 16, v205
v_and_b32 v19, v13, v205
v_lshlrev_b32 v20, 16, v206
v_and_b32 v21, v13, v206
v_lshlrev_b32 v22, 16, v207
v_and_b32 v23, v13, v207
v_pk_add_f32 v[132:133], v[132:133], v[16:17]
v_pk_add_f32 v[134:135], v[134:135], v[18:19]
v_pk_add_f32 v[140:141], v[140:141], v[20:21]
v_pk_add_f32 v[142:143], v[142:143], v[22:23]
s_cmp_lg_u32 s3, s84
s_cbranch_scc1 L_NO9
v_lshlrev_b32 v16, 16, v208
v_and_b32 v17, v13, v208
v_lshlrev_b32 v18, 16, v209
v_and_b32 v19, v13, v209
v_lshlrev_b32 v20, 16, v210
v_and_b32 v21, v13, v210
v_lshlrev_b32 v22, 16, v211
v_and_b32 v23, v13, v211
v_pk_add_f32 v[120:121], v[120:121], v[16:17]
v_pk_add_f32 v[122:123], v[122:123], v[18:19]
v_pk_add_f32 v[124:125], v[124:125], v[20:21]
v_pk_add_f32 v[126:127], v[126:127], v[22:23]
v_lshlrev_b32 v16, 16, v212
v_and_b32 v17, v13, v212
v_lshlrev_b32 v18, 16, v213
v_and_b32 v19, v13, v213
v_lshlrev_b32 v20, 16, v214
v_and_b32 v21, v13, v214
v_lshlrev_b32 v22, 16, v215
v_and_b32 v23, v13, v215
v_pk_add_f32 v[120:121], v[120:121], v[16:17]
v_pk_add_f32 v[122:123], v[122:123], v[18:19]
v_pk_add_f32 v[124:125], v[124:125], v[20:21]
v_pk_add_f32 v[126:127], v[126:127], v[22:23]
v_lshlrev_b32 v16, 16, v216
v_and_b32 v17, v13, v216
v_lshlrev_b32 v18, 16, v217
v_and_b32 v19, v13, v217
v_lshlrev_b32 v20, 16, v218
v_and_b32 v21, v13, v218
v_lshlrev_b32 v22, 16, v219
v_and_b32 v23, v13, v219
v_pk_add_f32 v[120:121], v[120:121], v[16:17]
v_pk_add_f32 v[122:123], v[122:123], v[18:19]
v_pk_add_f32 v[124:125], v[124:125], v[20:21]
v_pk_add_f32 v[126:127], v[126:127], v[22:23]
v_cvt_pk_bf16_f32 v228, v120, v121
v_cvt_pk_bf16_f32 v229, v122, v123
v_cvt_pk_bf16_f32 v230, v124, v125
v_cvt_pk_bf16_f32 v231, v126, v127
s_waitcnt vmcnt(0)
buffer_store_dwordx2 v[228:229], v6, s[44:47], s54 offen sc1
buffer_store_dwordx2 v[230:231], v6, s[44:47], s55 offen sc1
s_branch L_9D
L_NO9:
s_waitcnt vmcnt(0)
L_9D:
v_lshlrev_b32 v16, 16, v220
v_and_b32 v17, v13, v220
v_lshlrev_b32 v18, 16, v221
v_and_b32 v19, v13, v221
v_lshlrev_b32 v20, 16, v222
v_and_b32 v21, v13, v222
v_lshlrev_b32 v22, 16, v223
v_and_b32 v23, v13, v223
v_pk_add_f32 v[128:129], v[128:129], v[16:17]
v_pk_add_f32 v[130:131], v[130:131], v[18:19]
v_pk_add_f32 v[136:137], v[136:137], v[20:21]
v_pk_add_f32 v[138:139], v[138:139], v[22:23]
v_cvt_pk_bf16_f32 v128, v128, v129
v_cvt_pk_bf16_f32 v129, v130, v131
v_cvt_pk_bf16_f32 v130, v136, v137
v_cvt_pk_bf16_f32 v131, v138, v139
s_nop 1
v_permlane16_swap_b32 v128, v130
v_permlane16_swap_b32 v129, v131
buffer_store_dwordx4 v[128:131], v5, s[44:47], s52 offen sc1
v_lshlrev_b32 v16, 16, v224
v_and_b32 v17, v13, v224
v_lshlrev_b32 v18, 16, v225
v_and_b32 v19, v13, v225
v_lshlrev_b32 v20, 16, v226
v_and_b32 v21, v13, v226
v_lshlrev_b32 v22, 16, v227
v_and_b32 v23, v13, v227
v_pk_add_f32 v[132:133], v[132:133], v[16:17]
v_pk_add_f32 v[134:135], v[134:135], v[18:19]
v_pk_add_f32 v[140:141], v[140:141], v[20:21]
v_pk_add_f32 v[142:143], v[142:143], v[22:23]
v_cvt_pk_bf16_f32 v132, v132, v133
v_cvt_pk_bf16_f32 v133, v134, v135
v_cvt_pk_bf16_f32 v134, v140, v141
v_cvt_pk_bf16_f32 v135, v142, v143
s_nop 1
v_permlane16_swap_b32 v132, v134
v_permlane16_swap_b32 v133, v135
buffer_store_dwordx4 v[132:135], v5, s[44:47], s53 offen sc1
L_END:
s_endpgm
L_SE2:
v_accvgpr_read_b32 v180, a224
v_accvgpr_read_b32 v182, a228
v_cmp_nle_f32 vcc, v180, v7
v_cmp_nle_f32 s[96:97], v182, v7
s_nop 3
s_or_b64 vcc, vcc, s[96:97]
s_cbranch_vccnz SLOW0
SLOW0_R:
s_add_u32 s53, s77, 180224
buffer_load_dwordx4 a[112:115], v4, s[24:27], s53 offen offset:0 sc1
v_mul_f32 v8, 0x3fb8aa3b, v8
v_mul_f32 v9, 0x3fb8aa3b, v9
v_exp_f32 v8, v8
v_exp_f32 v9, v9
s_nop 0
v_fma_f32 v180, v180, v8, v180
v_fma_f32 v182, v182, v9, v182
v_rcp_f32 v180, v180
v_rcp_f32 v182, v182
s_add_u32 s52, s78, 4096
v_mov_b32 v181, v180
v_mov_b32 v183, v182
v_accvgpr_read_b32 v16, a0
v_accvgpr_read_b32 v17, a1
v_accvgpr_read_b32 v18, a2
v_accvgpr_read_b32 v19, a3
v_accvgpr_read_b32 v20, a4
v_accvgpr_read_b32 v21, a5
v_accvgpr_read_b32 v22, a6
v_accvgpr_read_b32 v23, a7
v_pk_mul_f32 v[16:17], v[16:17], v[180:181]
v_pk_mul_f32 v[18:19], v[18:19], v[180:181]
v_pk_mul_f32 v[20:21], v[20:21], v[180:181]
v_pk_mul_f32 v[22:23], v[22:23], v[180:181]
v_cvt_pk_bf16_f32 v16, v16, v17
v_cvt_pk_bf16_f32 v17, v18, v19
v_cvt_pk_bf16_f32 v18, v20, v21
v_cvt_pk_bf16_f32 v19, v22, v23
buffer_store_dwordx4 v[16:19], v4, s[24:27], s78 offen offset:0 sc1
v_accvgpr_read_b32 v24, a32
v_accvgpr_read_b32 v25, a33
v_accvgpr_read_b32 v26, a34
v_accvgpr_read_b32 v27, a35
v_accvgpr_read_b32 v28, a36
v_accvgpr_read_b32 v29, a37
v_accvgpr_read_b32 v30, a38
v_accvgpr_read_b32 v31, a39
buffer_load_dwordx4 a[116:119], v4, s[24:27], s53 offen offset:1024 sc1
v_pk_mul_f32 v[24:25], v[24:25], v[182:183]
v_pk_mul_f32 v[26:27], v[26:27], v[182:183]
v_pk_mul_f32 v[28:29], v[28:29], v[182:183]
v_pk_mul_f32 v[30:31], v[30:31], v[182:183]
v_cvt_pk_bf16_f32 v24, v24, v25
v_cvt_pk_bf16_f32 v25, v26, v27
v_cvt_pk_bf16_f32 v26, v28, v29
v_cvt_pk_bf16_f32 v27, v30, v31
buffer_store_dwordx4 v[24:27], v4, s[24:27], s78 offen offset:1024 sc1
v_accvgpr_read_b32 v16, a8
v_accvgpr_read_b32 v17, a9
v_accvgpr_read_b32 v18, a10
v_accvgpr_read_b32 v19, a11
v_accvgpr_read_b32 v20, a12
v_accvgpr_read_b32 v21, a13
v_accvgpr_read_b32 v22, a14
v_accvgpr_read_b32 v23, a15
v_pk_mul_f32 v[16:17], v[16:17], v[180:181]
v_pk_mul_f32 v[18:19], v[18:19], v[180:181]
v_pk_mul_f32 v[20:21], v[20:21], v[180:181]
v_pk_mul_f32 v[22:23], v[22:23], v[180:181]
v_cvt_pk_bf16_f32 v16, v16, v17
v_cvt_pk_bf16_f32 v17, v18, v19
v_cvt_pk_bf16_f32 v18, v20, v21
v_cvt_pk_bf16_f32 v19, v22, v23
buffer_store_dwordx4 v[16:19], v4, s[24:27], s78 offen offset:2048 sc1
v_accvgpr_read_b32 v24, a40
v_accvgpr_read_b32 v25, a41
v_accvgpr_read_b32 v26, a42
v_accvgpr_read_b32 v27, a43
v_accvgpr_read_b32 v28, a44
v_accvgpr_read_b32 v29, a45
v_accvgpr_read_b32 v30, a46
v_accvgpr_read_b32 v31, a47
v_pk_mul_f32 v[24:25], v[24:25], v[182:183]
v_pk_mul_f32 v[26:27], v[26:27], v[182:183]
v_pk_mul_f32 v[28:29], v[28:29], v[182:183]
buffer_load_dwordx4 a[120:123], v4, s[24:27], s53 offen offset:2048 sc1
v_pk_mul_f32 v[30:31], v[30:31], v[182:183]
v_cvt_pk_bf16_f32 v24, v24, v25
v_cvt_pk_bf16_f32 v25, v26, v27
v_cvt_pk_bf16_f32 v26, v28, v29
v_cvt_pk_bf16_f32 v27, v30, v31
buffer_store_dwordx4 v[24:27], v4, s[24:27], s78 offen offset:3072 sc1
v_accvgpr_read_b32 v16, a16
v_accvgpr_read_b32 v17, a17
v_accvgpr_read_b32 v18, a18
v_accvgpr_read_b32 v19, a19
v_accvgpr_read_b32 v20, a20
v_accvgpr_read_b32 v21, a21
v_accvgpr_read_b32 v22, a22
v_accvgpr_read_b32 v23, a23
v_pk_mul_f32 v[16:17], v[16:17], v[180:181]
v_pk_mul_f32 v[18:19], v[18:19], v[180:181]
v_pk_mul_f32 v[20:21], v[20:21], v[180:181]
v_pk_mul_f32 v[22:23], v[22:23], v[180:181]
v_cvt_pk_bf16_f32 v16, v16, v17
v_cvt_pk_bf16_f32 v17, v18, v19
v_cvt_pk_bf16_f32 v18, v20, v21
v_cvt_pk_bf16_f32 v19, v22, v23
buffer_store_dwordx4 v[16:19], v4, s[24:27], s52 offen offset:0 sc1
v_accvgpr_read_b32 v24, a48
v_accvgpr_read_b32 v25, a49
v_accvgpr_read_b32 v26, a50
v_accvgpr_read_b32 v27, a51
v_accvgpr_read_b32 v28, a52
v_accvgpr_read_b32 v29, a53
v_accvgpr_read_b32 v30, a54
v_accvgpr_read_b32 v31, a55
v_pk_mul_f32 v[24:25], v[24:25], v[182:183]
v_pk_mul_f32 v[26:27], v[26:27], v[182:183]
v_pk_mul_f32 v[28:29], v[28:29], v[182:183]
v_pk_mul_f32 v[30:31], v[30:31], v[182:183]
v_cvt_pk_bf16_f32 v24, v24, v25
v_cvt_pk_bf16_f32 v25, v26, v27
buffer_load_dwordx4 a[124:127], v4, s[24:27], s53 offen offset:3072 sc1
v_cvt_pk_bf16_f32 v26, v28, v29
v_cvt_pk_bf16_f32 v27, v30, v31
buffer_store_dwordx4 v[24:27], v4, s[24:27], s52 offen offset:1024 sc1
v_accvgpr_read_b32 v16, a24
v_accvgpr_read_b32 v17, a25
v_accvgpr_read_b32 v18, a26
v_accvgpr_read_b32 v19, a27
v_accvgpr_read_b32 v20, a28
v_accvgpr_read_b32 v21, a29
v_accvgpr_read_b32 v22, a30
v_accvgpr_read_b32 v23, a31
v_pk_mul_f32 v[16:17], v[16:17], v[180:181]
v_pk_mul_f32 v[18:19], v[18:19], v[180:181]
v_pk_mul_f32 v[20:21], v[20:21], v[180:181]
v_pk_mul_f32 v[22:23], v[22:23], v[180:181]
v_cvt_pk_bf16_f32 v16, v16, v17
v_cvt_pk_bf16_f32 v17, v18, v19
v_cvt_pk_bf16_f32 v18, v20, v21
v_cvt_pk_bf16_f32 v19, v22, v23
buffer_store_dwordx4 v[16:19], v4, s[24:27], s52 offen offset:2048 sc1
v_accvgpr_read_b32 v24, a56
v_accvgpr_read_b32 v25, a57
v_accvgpr_read_b32 v26, a58
v_accvgpr_read_b32 v27, a59
v_accvgpr_read_b32 v28, a60
v_accvgpr_read_b32 v29, a61
v_accvgpr_read_b32 v30, a62
v_accvgpr_read_b32 v31, a63
v_pk_mul_f32 v[24:25], v[24:25], v[182:183]
v_pk_mul_f32 v[26:27], v[26:27], v[182:183]
v_pk_mul_f32 v[28:29], v[28:29], v[182:183]
v_pk_mul_f32 v[30:31], v[30:31], v[182:183]
v_cvt_pk_bf16_f32 v24, v24, v25
v_cvt_pk_bf16_f32 v25, v26, v27
v_cvt_pk_bf16_f32 v26, v28, v29
v_cvt_pk_bf16_f32 v27, v30, v31
buffer_store_dwordx4 v[24:27], v4, s[24:27], s52 offen offset:3072 sc1
s_branch L_LA
CK_Z:
s_mov_b32 s92, 0
CK_Z_L:
s_sleep 1
buffer_load_dword v23, v22, s[40:43], 0 offen sc1
s_add_u32 s92, s92, 1
s_waitcnt vmcnt(0)
v_cmp_gt_u32 vcc, 1, v23
s_cmp_gt_u32 s92, 0x20000
s_cbranch_scc1 CK_Z_R
s_nop 3
s_cbranch_vccnz CK_Z_L
s_branch CK_Z_R
CK_WA:
s_mov_b32 s92, 0
CK_WA_L:
s_sleep 1
buffer_load_dword v30, v29, s[24:27], s89 offen sc1
s_add_u32 s92, s92, 1
s_waitcnt vmcnt(0)
v_cmp_gt_u32 vcc, 18, v30
s_cmp_gt_u32 s92, 0x20000
s_cbranch_scc1 CK_WA_R
s_nop 3
s_cbranch_vccnz CK_WA_L
s_branch CK_WA_R
CK_ZA:
s_mov_b32 s92, 0
CK_ZA_L:
s_sleep 1
buffer_load_dword v30, v28, s[40:43], 0 offen sc1
s_add_u32 s92, s92, 1
s_waitcnt vmcnt(0)
v_cmp_gt_u32 vcc, 1, v30
s_cmp_gt_u32 s92, 0x20000
s_cbranch_scc1 CK_ZA_R
s_nop 3
s_cbranch_vccnz CK_ZA_L
s_branch CK_ZA_R
CK_KV:
s_mov_b32 s92, 0
CK_KV_L:
s_sleep 1
buffer_load_dword v30, v29, s[24:27], s89 offen offset:4 sc1
s_add_u32 s92, s92, 1
s_waitcnt vmcnt(0)
v_cmp_gt_u32 vcc, 8, v30
s_cmp_gt_u32 s92, 0x20000
s_cbranch_scc1 CK_KV_R
s_nop 3
s_cbranch_vccnz CK_KV_L
s_branch CK_KV_R
D0:
v_cndmask_b32 v96, v96, v6, s[56:57]
v_cndmask_b32 v120, v120, v6, s[56:57]
v_mov_b32 v112, v6
v_cndmask_b32 v97, v97, v6, s[58:59]
v_cndmask_b32 v121, v121, v6, s[58:59]
v_mov_b32 v113, v6
v_cndmask_b32 v98, v98, v6, s[60:61]
v_cndmask_b32 v122, v122, v6, s[60:61]
v_mov_b32 v114, v6
v_cndmask_b32 v99, v99, v6, s[62:63]
v_cndmask_b32 v123, v123, v6, s[62:63]
v_mov_b32 v115, v6
s_branch D0_R
CK_Q:
s_mov_b32 s92, 0
CK_Q_L:
s_sleep 1
buffer_load_dword v172, v173, s[24:27], 0 offen sc1
s_add_u32 s92, s92, 1
s_waitcnt vmcnt(0)
v_cmp_gt_u32 vcc, 32, v172
s_cmp_gt_u32 s92, 0x20000
s_cbranch_scc1 CK_Q_R
s_nop 3
s_cbranch_vccnz CK_Q_L
s_branch CK_Q_R
CK_ZAA:
s_mov_b32 s92, 0
CK_ZAA_L:
s_sleep 1
buffer_load_dword v12, v10, s[24:27], s75 offen offset:4 sc1
s_add_u32 s92, s92, 1
s_waitcnt vmcnt(0)
v_cmp_gt_u32 vcc, 8, v12
s_cmp_gt_u32 s92, 0x20000
s_cbranch_scc1 CK_ZAA_R
s_nop 3
s_cbranch_vccnz CK_ZAA_L
s_branch CK_ZAA_R
CK_P1:
s_mov_b32 s92, 0
CK_P1_L:
s_sleep 1
buffer_load_dword v12, v10, s[24:27], s73 offen sc1
s_add_u32 s92, s92, 1
s_waitcnt vmcnt(0)
v_cmp_gt_u32 vcc, 4, v12
s_cmp_gt_u32 s92, 0x20000
s_cbranch_scc1 CK_P1_R
s_nop 3
s_cbranch_vccnz CK_P1_L
s_branch CK_P1_R
CK_P2:
s_mov_b32 s92, 0
CK_P2_L:
s_sleep 1
buffer_load_dword v12, v10, s[24:27], s73 offen offset:16 sc1
s_add_u32 s92, s92, 1
s_waitcnt vmcnt(0)
v_cmp_gt_u32 vcc, 4, v12
s_cmp_gt_u32 s92, 0x20000
s_cbranch_scc1 CK_P2_R
s_nop 3
s_cbranch_vccnz CK_P2_L
s_branch CK_P2_R
SLOW0:
v_add_u32 v20, 4096, v4
s_mov_b32 s54, 0
v_mov_b32 v16, v6
v_mov_b32 v18, v6
SLOW0_P:
s_mov_b32 s53, 0
s_mov_b32 s52, s94
SLOW0_T:
s_add_u32 s55, s52, 24576
buffer_load_dwordx4 a[192:195], v4, s[24:27], s52 offen offset:0 sc1
buffer_load_dwordx4 a[196:199], v4, s[24:27], s52 offen offset:1024 sc1
buffer_load_dwordx4 a[200:203], v4, s[24:27], s52 offen offset:2048 sc1
buffer_load_dwordx4 a[204:207], v4, s[24:27], s52 offen offset:3072 sc1
buffer_load_dwordx4 a[208:211], v20, s[24:27], s52 offen offset:0 sc1
buffer_load_dwordx4 a[212:215], v20, s[24:27], s52 offen offset:1024 sc1
buffer_load_dwordx4 a[216:219], v20, s[24:27], s52 offen offset:2048 sc1
buffer_load_dwordx4 a[220:223], v20, s[24:27], s52 offen offset:3072 sc1
buffer_load_dwordx4 a[64:67], v4, s[24:27], s55 offen offset:0 sc1
buffer_load_dwordx4 a[68:71], v4, s[24:27], s55 offen offset:1024 sc1
buffer_load_dwordx4 a[72:75], v4, s[24:27], s55 offen offset:2048 sc1
buffer_load_dwordx4 a[76:79], v4, s[24:27], s55 offen offset:3072 sc1
buffer_load_dwordx4 a[80:83], v20, s[24:27], s55 offen offset:0 sc1
buffer_load_dwordx4 a[84:87], v20, s[24:27], s55 offen offset:1024 sc1
buffer_load_dwordx4 a[88:91], v20, s[24:27], s55 offen offset:2048 sc1
buffer_load_dwordx4 a[92:95], v20, s[24:27], s55 offen offset:3072 sc1
s_waitcnt vmcnt(0)
v_mfma_f32_16x16x32_bf16 v[44:47], a[192:195], v[36:39], 0
v_mfma_f32_16x16x32_bf16 v[44:47], a[196:199], v[32:35], v[44:47]
v_mfma_f32_16x16x32_bf16 v[44:47], a[200:203], v[196:199], v[44:47]
v_mfma_f32_16x16x32_bf16 v[44:47], a[204:207], v[204:207], v[44:47]
v_mfma_f32_16x16x32_bf16 v[52:55], a[192:195], v[108:111], 0
v_mfma_f32_16x16x32_bf16 v[52:55], a[196:199], v[40:43], v[52:55]
v_mfma_f32_16x16x32_bf16 v[52:55], a[200:203], v[80:83], v[52:55]
v_mfma_f32_16x16x32_bf16 v[52:55], a[204:207], v[168:171], v[52:55]
v_mfma_f32_16x16x32_bf16 v[64:67], a[208:211], v[36:39], 0
v_mfma_f32_16x16x32_bf16 v[64:67], a[212:215], v[32:35], v[64:67]
v_mfma_f32_16x16x32_bf16 v[64:67], a[216:219], v[196:199], v[64:67]
v_mfma_f32_16x16x32_bf16 v[64:67], a[220:223], v[204:207], v[64:67]
v_mfma_f32_16x16x32_bf16 v[212:215], a[208:211], v[108:111], 0
v_mfma_f32_16x16x32_bf16 v[212:215], a[212:215], v[40:43], v[212:215]
v_mfma_f32_16x16x32_bf16 v[212:215], a[216:219], v[80:83], v[212:215]
v_mfma_f32_16x16x32_bf16 v[212:215], a[220:223], v[168:171], v[212:215]
s_nop 7
s_cmp_lg_u32 s53, s66
s_cbranch_scc1 SLOW0_U
v_cndmask_b32 v44, v44, v6, s[56:57]
v_cndmask_b32 v212, v212, v6, s[56:57]
v_mov_b32 v64, v6
v_cndmask_b32 v45, v45, v6, s[58:59]
v_cndmask_b32 v213, v213, v6, s[58:59]
v_mov_b32 v65, v6
v_cndmask_b32 v46, v46, v6, s[60:61]
v_cndmask_b32 v214, v214, v6, s[60:61]
v_mov_b32 v66, v6
v_cndmask_b32 v47, v47, v6, s[62:63]
v_cndmask_b32 v215, v215, v6, s[62:63]
v_mov_b32 v67, v6
SLOW0_U:
s_cmp_lg_u32 s54, 0
s_cbranch_scc1 SLOW0_A
v_max3_f32 v16, v16, v44, v45
v_max3_f32 v16, v16, v46, v47
v_max3_f32 v18, v18, v52, v53
v_max3_f32 v18, v18, v54, v55
v_max3_f32 v16, v16, v64, v65
v_max3_f32 v16, v16, v66, v67
v_max3_f32 v18, v18, v212, v213
v_max3_f32 v18, v18, v214, v215
s_branch SLOW0_N
SLOW0_A:
v_sub_f32 v44, v44, v16
v_sub_f32 v45, v45, v16
v_sub_f32 v46, v46, v16
v_sub_f32 v47, v47, v16
v_sub_f32 v52, v52, v18
v_sub_f32 v53, v53, v18
v_sub_f32 v54, v54, v18
v_sub_f32 v55, v55, v18
v_sub_f32 v64, v64, v16
v_sub_f32 v65, v65, v16
v_sub_f32 v66, v66, v16
v_sub_f32 v67, v67, v16
v_sub_f32 v212, v212, v18
v_sub_f32 v213, v213, v18
v_sub_f32 v214, v214, v18
v_sub_f32 v215, v215, v18
v_exp_f32 v44, v44
v_exp_f32 v45, v45
v_exp_f32 v46, v46
v_exp_f32 v47, v47
v_exp_f32 v52, v52
v_exp_f32 v53, v53
v_exp_f32 v54, v54
v_exp_f32 v55, v55
v_exp_f32 v64, v64
v_exp_f32 v65, v65
v_exp_f32 v66, v66
v_exp_f32 v67, v67
v_exp_f32 v212, v212
v_exp_f32 v213, v213
v_exp_f32 v214, v214
v_exp_f32 v215, v215
s_nop 0
v_cvt_pk_bf16_f32 v124, v44, v45
v_cvt_pk_bf16_f32 v125, v46, v47
v_cvt_pk_bf16_f32 v140, v52, v53
v_cvt_pk_bf16_f32 v141, v54, v55
v_cvt_pk_bf16_f32 v126, v64, v65
v_cvt_pk_bf16_f32 v127, v66, v67
v_cvt_pk_bf16_f32 v142, v212, v213
v_cvt_pk_bf16_f32 v143, v214, v215
s_nop 1
v_mfma_f32_16x16x32_bf16 a[0:3], a[64:67], v[124:127], a[0:3]
v_mfma_f32_16x16x32_bf16 a[32:35], a[64:67], v[140:143], a[32:35]
v_mfma_f32_16x16x32_bf16 a[36:39], a[68:71], v[140:143], a[36:39]
v_mfma_f32_16x16x32_bf16 a[4:7], a[68:71], v[124:127], a[4:7]
v_mfma_f32_16x16x32_bf16 a[8:11], a[72:75], v[124:127], a[8:11]
v_mfma_f32_16x16x32_bf16 a[40:43], a[72:75], v[140:143], a[40:43]
v_mfma_f32_16x16x32_bf16 a[44:47], a[76:79], v[140:143], a[44:47]
v_mfma_f32_16x16x32_bf16 a[12:15], a[76:79], v[124:127], a[12:15]
v_mfma_f32_16x16x32_bf16 a[16:19], a[80:83], v[124:127], a[16:19]
v_mfma_f32_16x16x32_bf16 a[48:51], a[80:83], v[140:143], a[48:51]
v_mfma_f32_16x16x32_bf16 a[52:55], a[84:87], v[140:143], a[52:55]
v_mfma_f32_16x16x32_bf16 a[20:23], a[84:87], v[124:127], a[20:23]
v_mfma_f32_16x16x32_bf16 a[24:27], a[88:91], v[124:127], a[24:27]
v_mfma_f32_16x16x32_bf16 a[56:59], a[88:91], v[140:143], a[56:59]
v_mfma_f32_16x16x32_bf16 a[60:63], a[92:95], v[140:143], a[60:63]
v_mfma_f32_16x16x32_bf16 a[28:31], a[92:95], v[124:127], a[28:31]
v_mfma_f32_16x16x32_bf16 a[224:227], a[240:243], v[124:127], a[224:227]
v_mfma_f32_16x16x32_bf16 a[228:231], a[240:243], v[140:143], a[228:231]
SLOW0_N:
s_add_u32 s52, s52, 16384
s_add_u32 s53, s53, 1
s_cmp_le_u32 s53, s66
s_cbranch_scc1 SLOW0_T
s_cmp_lg_u32 s54, 0
s_cbranch_scc1 SLOW0_E
v_mov_b32 v17, v16
v_mov_b32 v19, v18
s_nop 1
v_permlane32_swap_b32 v17, v16
v_permlane32_swap_b32 v19, v18
s_nop 1
v_max_f32 v16, v16, v17
v_max_f32 v18, v18, v19
v_mov_b32 v17, v16
v_mov_b32 v19, v18
s_nop 1
v_permlane16_swap_b32 v17, v16
v_permlane16_swap_b32 v19, v18
s_nop 1
v_max_f32 v16, v16, v17
v_max_f32 v18, v18, v19
v_accvgpr_write_b32 a0, 0
v_accvgpr_write_b32 a1, 0
v_accvgpr_write_b32 a2, 0
v_accvgpr_write_b32 a3, 0
v_accvgpr_write_b32 a4, 0
v_accvgpr_write_b32 a5, 0
v_accvgpr_write_b32 a6, 0
v_accvgpr_write_b32 a7, 0
v_accvgpr_write_b32 a8, 0
v_accvgpr_write_b32 a9, 0
v_accvgpr_write_b32 a10, 0
v_accvgpr_write_b32 a11, 0
v_accvgpr_write_b32 a12, 0
v_accvgpr_write_b32 a13, 0
v_accvgpr_write_b32 a14, 0
v_accvgpr_write_b32 a15, 0
v_accvgpr_write_b32 a16, 0
v_accvgpr_write_b32 a17, 0
v_accvgpr_write_b32 a18, 0
v_accvgpr_write_b32 a19, 0
v_accvgpr_write_b32 a20, 0
v_accvgpr_write_b32 a21, 0
v_accvgpr_write_b32 a22, 0
v_accvgpr_write_b32 a23, 0
v_accvgpr_write_b32 a24, 0
v_accvgpr_write_b32 a25, 0
v_accvgpr_write_b32 a26, 0
v_accvgpr_write_b32 a27, 0
v_accvgpr_write_b32 a28, 0
v_accvgpr_write_b32 a29, 0
v_accvgpr_write_b32 a30, 0
v_accvgpr_write_b32 a31, 0
v_accvgpr_write_b32 a32, 0
v_accvgpr_write_b32 a33, 0
v_accvgpr_write_b32 a34, 0
v_accvgpr_write_b32 a35, 0
v_accvgpr_write_b32 a36, 0
v_accvgpr_write_b32 a37, 0
v_accvgpr_write_b32 a38, 0
v_accvgpr_write_b32 a39, 0
v_accvgpr_write_b32 a40, 0
v_accvgpr_write_b32 a41, 0
v_accvgpr_write_b32 a42, 0
v_accvgpr_write_b32 a43, 0
v_accvgpr_write_b32 a44, 0
v_accvgpr_write_b32 a45, 0
v_accvgpr_write_b32 a46, 0
v_accvgpr_write_b32 a47, 0
v_accvgpr_write_b32 a48, 0
v_accvgpr_write_b32 a49, 0
v_accvgpr_write_b32 a50, 0
v_accvgpr_write_b32 a51, 0
v_accvgpr_write_b32 a52, 0
v_accvgpr_write_b32 a53, 0
v_accvgpr_write_b32 a54, 0
v_accvgpr_write_b32 a55, 0
v_accvgpr_write_b32 a56, 0
v_accvgpr_write_b32 a57, 0
v_accvgpr_write_b32 a58, 0
v_accvgpr_write_b32 a59, 0
v_accvgpr_write_b32 a60, 0
v_accvgpr_write_b32 a61, 0
v_accvgpr_write_b32 a62, 0
v_accvgpr_write_b32 a63, 0
v_accvgpr_write_b32 a224, 0
v_accvgpr_write_b32 a225, 0
v_accvgpr_write_b32 a226, 0
v_accvgpr_write_b32 a227, 0
v_accvgpr_write_b32 a228, 0
v_accvgpr_write_b32 a229, 0
v_accvgpr_write_b32 a230, 0
v_accvgpr_write_b32 a231, 0
s_mov_b32 s54, 1
s_branch SLOW0_P
SLOW0_E:
s_nop 7
v_accvgpr_read_b32 v180, a224
v_accvgpr_read_b32 v182, a228
s_branch SLOW0_R
SLOW1:
v_add_u32 v20, 4096, v4
s_mov_b32 s54, 0
v_mov_b32 v16, v6
v_mov_b32 v18, v6
SLOW1_P:
s_mov_b32 s53, 0
s_mov_b32 s52, s94
SLOW1_T:
s_add_u32 s55, s52, 24576
buffer_load_dwordx4 a[192:195], v4, s[24:27], s52 offen offset:0 sc1
buffer_load_dwordx4 a[196:199], v4, s[24:27], s52 offen offset:1024 sc1
buffer_load_dwordx4 a[200:203], v4, s[24:27], s52 offen offset:2048 sc1
buffer_load_dwordx4 a[204:207], v4, s[24:27], s52 offen offset:3072 sc1
buffer_load_dwordx4 a[208:211], v20, s[24:27], s52 offen offset:0 sc1
buffer_load_dwordx4 a[212:215], v20, s[24:27], s52 offen offset:1024 sc1
buffer_load_dwordx4 a[216:219], v20, s[24:27], s52 offen offset:2048 sc1
buffer_load_dwordx4 a[220:223], v20, s[24:27], s52 offen offset:3072 sc1
buffer_load_dwordx4 a[64:67], v4, s[24:27], s55 offen offset:0 sc1
buffer_load_dwordx4 a[68:71], v4, s[24:27], s55 offen offset:1024 sc1
buffer_load_dwordx4 a[72:75], v4, s[24:27], s55 offen offset:2048 sc1
buffer_load_dwordx4 a[76:79], v4, s[24:27], s55 offen offset:3072 sc1
buffer_load_dwordx4 a[80:83], v20, s[24:27], s55 offen offset:0 sc1
buffer_load_dwordx4 a[84:87], v20, s[24:27], s55 offen offset:1024 sc1
buffer_load_dwordx4 a[88:91], v20, s[24:27], s55 offen offset:2048 sc1
buffer_load_dwordx4 a[92:95], v20, s[24:27], s55 offen offset:3072 sc1
s_waitcnt vmcnt(0)
v_mfma_f32_16x16x32_bf16 v[44:47], a[192:195], v[116:119], 0
v_mfma_f32_16x16x32_bf16 v[44:47], a[196:199], v[132:135], v[44:47]
v_mfma_f32_16x16x32_bf16 v[44:47], a[200:203], v[184:187], v[44:47]
v_mfma_f32_16x16x32_bf16 v[44:47], a[204:207], v[240:243], v[44:47]
v_mfma_f32_16x16x32_bf16 v[52:55], a[192:195], v[188:191], 0
v_mfma_f32_16x16x32_bf16 v[52:55], a[196:199], v[56:59], v[52:55]
v_mfma_f32_16x16x32_bf16 v[52:55], a[200:203], v[88:91], v[52:55]
v_mfma_f32_16x16x32_bf16 v[52:55], a[204:207], v[192:195], v[52:55]
v_mfma_f32_16x16x32_bf16 v[64:67], a[208:211], v[116:119], 0
v_mfma_f32_16x16x32_bf16 v[64:67], a[212:215], v[132:135], v[64:67]
v_mfma_f32_16x16x32_bf16 v[64:67], a[216:219], v[184:187], v[64:67]
v_mfma_f32_16x16x32_bf16 v[64:67], a[220:223], v[240:243], v[64:67]
v_mfma_f32_16x16x32_bf16 v[212:215], a[208:211], v[188:191], 0
v_mfma_f32_16x16x32_bf16 v[212:215], a[212:215], v[56:59], v[212:215]
v_mfma_f32_16x16x32_bf16 v[212:215], a[216:219], v[88:91], v[212:215]
v_mfma_f32_16x16x32_bf16 v[212:215], a[220:223], v[192:195], v[212:215]
s_nop 7
s_cmp_lg_u32 s53, s67
s_cbranch_scc1 SLOW1_U
v_cndmask_b32 v44, v44, v6, s[56:57]
v_cndmask_b32 v212, v212, v6, s[56:57]
v_mov_b32 v64, v6
v_cndmask_b32 v45, v45, v6, s[58:59]
v_cndmask_b32 v213, v213, v6, s[58:59]
v_mov_b32 v65, v6
v_cndmask_b32 v46, v46, v6, s[60:61]
v_cndmask_b32 v214, v214, v6, s[60:61]
v_mov_b32 v66, v6
v_cndmask_b32 v47, v47, v6, s[62:63]
v_cndmask_b32 v215, v215, v6, s[62:63]
v_mov_b32 v67, v6
SLOW1_U:
s_cmp_lg_u32 s54, 0
s_cbranch_scc1 SLOW1_A
v_max3_f32 v16, v16, v44, v45
v_max3_f32 v16, v16, v46, v47
v_max3_f32 v18, v18, v52, v53
v_max3_f32 v18, v18, v54, v55
v_max3_f32 v16, v16, v64, v65
v_max3_f32 v16, v16, v66, v67
v_max3_f32 v18, v18, v212, v213
v_max3_f32 v18, v18, v214, v215
s_branch SLOW1_N
SLOW1_A:
v_sub_f32 v44, v44, v16
v_sub_f32 v45, v45, v16
v_sub_f32 v46, v46, v16
v_sub_f32 v47, v47, v16
v_sub_f32 v52, v52, v18
v_sub_f32 v53, v53, v18
v_sub_f32 v54, v54, v18
v_sub_f32 v55, v55, v18
v_sub_f32 v64, v64, v16
v_sub_f32 v65, v65, v16
v_sub_f32 v66, v66, v16
v_sub_f32 v67, v67, v16
v_sub_f32 v212, v212, v18
v_sub_f32 v213, v213, v18
v_sub_f32 v214, v214, v18
v_sub_f32 v215, v215, v18
v_exp_f32 v44, v44
v_exp_f32 v45, v45
v_exp_f32 v46, v46
v_exp_f32 v47, v47
v_exp_f32 v52, v52
v_exp_f32 v53, v53
v_exp_f32 v54, v54
v_exp_f32 v55, v55
v_exp_f32 v64, v64
v_exp_f32 v65, v65
v_exp_f32 v66, v66
v_exp_f32 v67, v67
v_exp_f32 v212, v212
v_exp_f32 v213, v213
v_exp_f32 v214, v214
v_exp_f32 v215, v215
s_nop 0
v_cvt_pk_bf16_f32 v124, v44, v45
v_cvt_pk_bf16_f32 v125, v46, v47
v_cvt_pk_bf16_f32 v140, v52, v53
v_cvt_pk_bf16_f32 v141, v54, v55
v_cvt_pk_bf16_f32 v126, v64, v65
v_cvt_pk_bf16_f32 v127, v66, v67
v_cvt_pk_bf16_f32 v142, v212, v213
v_cvt_pk_bf16_f32 v143, v214, v215
s_nop 1
v_mfma_f32_16x16x32_bf16 v[60:63], a[64:67], v[124:127], v[60:63]
v_mfma_f32_16x16x32_bf16 v[148:151], a[64:67], v[140:143], v[148:151]
v_mfma_f32_16x16x32_bf16 v[48:51], a[68:71], v[140:143], v[48:51]
v_mfma_f32_16x16x32_bf16 v[68:71], a[68:71], v[124:127], v[68:71]
v_mfma_f32_16x16x32_bf16 v[72:75], a[72:75], v[124:127], v[72:75]
v_mfma_f32_16x16x32_bf16 v[236:239], a[72:75], v[140:143], v[236:239]
v_mfma_f32_16x16x32_bf16 v[224:227], a[76:79], v[140:143], v[224:227]
v_mfma_f32_16x16x32_bf16 v[220:223], a[76:79], v[124:127], v[220:223]
v_mfma_f32_16x16x32_bf16 v[84:87], a[80:83], v[124:127], v[84:87]
v_mfma_f32_16x16x32_bf16 v[164:167], a[80:83], v[140:143], v[164:167]
v_mfma_f32_16x16x32_bf16 v[156:159], a[84:87], v[140:143], v[156:159]
v_mfma_f32_16x16x32_bf16 v[76:79], a[84:87], v[124:127], v[76:79]
v_mfma_f32_16x16x32_bf16 v[160:163], a[88:91], v[124:127], v[160:163]
v_mfma_f32_16x16x32_bf16 v[216:219], a[88:91], v[140:143], v[216:219]
v_mfma_f32_16x16x32_bf16 v[208:211], a[92:95], v[140:143], v[208:211]
v_mfma_f32_16x16x32_bf16 v[252:255], a[92:95], v[124:127], v[252:255]
v_mfma_f32_16x16x32_bf16 a[232:235], a[240:243], v[124:127], a[232:235]
v_mfma_f32_16x16x32_bf16 a[236:239], a[240:243], v[140:143], a[236:239]
SLOW1_N:
s_add_u32 s52, s52, 16384
s_add_u32 s53, s53, 1
s_cmp_le_u32 s53, s67
s_cbranch_scc1 SLOW1_T
s_cmp_lg_u32 s54, 0
s_cbranch_scc1 SLOW1_E
v_mov_b32 v17, v16
v_mov_b32 v19, v18
s_nop 1
v_permlane32_swap_b32 v17, v16
v_permlane32_swap_b32 v19, v18
s_nop 1
v_max_f32 v16, v16, v17
v_max_f32 v18, v18, v19
v_mov_b32 v17, v16
v_mov_b32 v19, v18
s_nop 1
v_permlane16_swap_b32 v17, v16
v_permlane16_swap_b32 v19, v18
s_nop 1
v_max_f32 v16, v16, v17
v_max_f32 v18, v18, v19
v_mov_b32 v60, 0
v_mov_b32 v61, 0
v_mov_b32 v62, 0
v_mov_b32 v63, 0
v_mov_b32 v68, 0
v_mov_b32 v69, 0
v_mov_b32 v70, 0
v_mov_b32 v71, 0
v_mov_b32 v72, 0
v_mov_b32 v73, 0
v_mov_b32 v74, 0
v_mov_b32 v75, 0
v_mov_b32 v220, 0
v_mov_b32 v221, 0
v_mov_b32 v222, 0
v_mov_b32 v223, 0
v_mov_b32 v84, 0
v_mov_b32 v85, 0
v_mov_b32 v86, 0
v_mov_b32 v87, 0
v_mov_b32 v76, 0
v_mov_b32 v77, 0
v_mov_b32 v78, 0
v_mov_b32 v79, 0
v_mov_b32 v160, 0
v_mov_b32 v161, 0
v_mov_b32 v162, 0
v_mov_b32 v163, 0
v_mov_b32 v252, 0
v_mov_b32 v253, 0
v_mov_b32 v254, 0
v_mov_b32 v255, 0
v_mov_b32 v148, 0
v_mov_b32 v149, 0
v_mov_b32 v150, 0
v_mov_b32 v151, 0
v_mov_b32 v48, 0
v_mov_b32 v49, 0
v_mov_b32 v50, 0
v_mov_b32 v51, 0
v_mov_b32 v236, 0
v_mov_b32 v237, 0
v_mov_b32 v238, 0
v_mov_b32 v239, 0
v_mov_b32 v224, 0
v_mov_b32 v225, 0
v_mov_b32 v226, 0
v_mov_b32 v227, 0
v_mov_b32 v164, 0
v_mov_b32 v165, 0
v_mov_b32 v166, 0
v_mov_b32 v167, 0
v_mov_b32 v156, 0
v_mov_b32 v157, 0
v_mov_b32 v158, 0
v_mov_b32 v159, 0
v_mov_b32 v216, 0
v_mov_b32 v217, 0
v_mov_b32 v218, 0
v_mov_b32 v219, 0
v_mov_b32 v208, 0
v_mov_b32 v209, 0
v_mov_b32 v210, 0
v_mov_b32 v211, 0
v_accvgpr_write_b32 a232, 0
v_accvgpr_write_b32 a233, 0
v_accvgpr_write_b32 a234, 0
v_accvgpr_write_b32 a235, 0
v_accvgpr_write_b32 a236, 0
v_accvgpr_write_b32 a237, 0
v_accvgpr_write_b32 a238, 0
v_accvgpr_write_b32 a239, 0
s_mov_b32 s54, 1
s_branch SLOW1_P
SLOW1_E:
s_nop 7
v_accvgpr_read_b32 v180, a232
v_accvgpr_read_b32 v182, a236
s_branch SLOW1_R
.section .rodata,"a"
.p2align 6
.amdhsa_kernel gated_mix__sliding_local_dilated__compressed_kv_cla__prompt_kernel
  .amdhsa_next_free_vgpr 512
  .amdhsa_next_free_sgpr 102
  .amdhsa_accum_offset 256
  .amdhsa_group_segment_fixed_size 0
  .amdhsa_kernarg_size 104
  .amdhsa_user_sgpr_count 2
  .amdhsa_user_sgpr_kernarg_segment_ptr 1
  .amdhsa_system_sgpr_workgroup_id_x 1
.end_amdhsa_kernel
```

```asm
; @launch grid=(256,1,1) block=(256,1,1) lds=163840
.amdgcn_target "amdgcn-amd-amdhsa--gfx950"
.text

.globl gated_mix__sliding_local_dilated__compressed_kv_cla__prompt_kernel
.p2align 8
.type gated_mix__sliding_local_dilated__compressed_kv_cla__prompt_kernel,@function
gated_mix__sliding_local_dilated__compressed_kv_cla__prompt_kernel:
s_cmp_ge_u32 s2, 256
s_cbranch_scc1 L_END
s_load_dwordx2 s[8:9], s[0:1], 32
s_load_dwordx2 s[56:57], s[0:1], 56
s_load_dwordx2 s[16:17], s[0:1], 48
s_load_dwordx2 s[24:25], s[0:1], 96
s_load_dwordx2 s[12:13], s[0:1], 0
s_load_dwordx2 s[20:21], s[0:1], 40
s_load_dwordx2 s[28:29], s[0:1], 8
s_load_dwordx2 s[48:49], s[0:1], 16
s_load_dwordx2 s[32:33], s[0:1], 64
s_load_dwordx2 s[36:37], s[0:1], 72
s_load_dwordx2 s[40:41], s[0:1], 88
s_load_dwordx2 s[44:45], s[0:1], 80
s_getpc_b64 s[96:97]
L_PC:
s_lshr_b32 s6, s2, 3
s_lshl_b32 s98, s6, 11
s_add_u32 s98, s98, L_MAIN-L_PC
s_add_u32 s96, s96, s98
s_addc_u32 s97, s97, 0
v_lshlrev_b32 v16, 3, v0
v_mov_b32 v17, s97
v_add_co_u32 v16, vcc, s96, v16
v_lshrrev_b32 v5, 6, v0
v_and_b32 v1, 63, v0
v_addc_co_u32 v17, vcc, 0, v17, vcc
v_readfirstlane_b32 s3, v5
global_load_dwordx2 a[252:253], v[16:17], off
v_and_b32 v2, 15, v0
v_lshrrev_b32 v3, 4, v1
v_lshlrev_b32 v4, 4, v1
s_and_b32 s7, s2, 7
s_and_b32 s65, s6, 3
s_lshl2_add_u32 s4, s7, s65
s_lshr_b32 s5, s6, 2
s_lshl2_add_u32 s66, s5, s3
s_sub_u32 s67, 63, s66
v_lshrrev_b32 v16, 3, v1
v_and_b32 v17, 7, v1
v_xor_b32 v18, v17, v3
v_lshlrev_b32 v19, 10, v16
v_lshl_add_u32 v5, v18, 4, v19
v_xor_b32 v18, 4, v18
v_lshl_add_u32 v6, v18, 4, v19
v_add_u32 v6, 7168, v6
v_and_b32 v18, 1, v3
v_lshlrev_b32 v18, 1, v18
v_xor_b32 v18, v17, v18
v_lshlrev_b32 v19, 13, v16
v_lshl_add_u32 v7, v18, 4, v19
v_xor_b32 v18, 4, v18
v_lshl_add_u32 v8, v18, 4, v19
v_add_u32 v8, 64512, v8
s_add_u32 s69, s65, s5
s_and_b32 s69, s69, 1
s_mul_i32 s64, s7, 2
s_and_b32 s64, s64, 7
s_or_b32 s69, s69, s64
s_add_u32 s93, s65, s5
s_and_b32 s93, s93, 0
s_mul_i32 s64, s7, 1
s_and_b32 s64, s64, 7
s_or_b32 s93, s93, s64
s_lshl_b32 s70, s69, 7
s_lshl_b32 s75, s69, 19
s_lshr_b32 s54, s3, 1
s_and_b32 s55, s3, 1
s_lshl3_add_u32 s87, s54, s5
s_lshl_b32 s64, s55, 5
s_add_u32 s68, s87, s64
s_lshl_b32 s68, s68, 15
s_lshl_b32 s73, s3, 13
s_add_u32 s73, s73, 65536
s_lshl1_add_u32 s74, s4, s55
s_lshl_b32 s74, s74, 7
s_lshl_b32 s64, s54, 18
s_add_u32 s74, s74, s64
s_lshl_b32 s77, s3, 12
s_add_u32 s71, s68, s70
s_add_u32 s76, s74, s75
s_mov_b32 s10, 2097152
s_mov_b32 s11, 0x20000
s_mov_b32 s58, 4194304
s_mov_b32 s59, 0x20000
s_waitcnt lgkmcnt(0)
s_add_u32 m0, s73, 0
s_add_u32 s64, s71, 0
buffer_load_dwordx4 v5, s[8:11], s64 offen lds
buffer_load_dwordx4 v6, s[8:11], s64 offen offset:1024 lds
s_add_u32 m0, s73, 2048
s_add_u32 s64, s71, 16384
buffer_load_dwordx4 v5, s[8:11], s64 offen lds
buffer_load_dwordx4 v6, s[8:11], s64 offen offset:1024 lds
s_add_u32 m0, s77, 0
s_add_u32 s64, s76, 0
buffer_load_dwordx4 v7, s[56:59], s64 offen lds
buffer_load_dwordx4 v8, s[56:59], s64 offen offset:1024 lds
s_add_u32 m0, s77, 2048
s_add_u32 s64, s76, 131072
buffer_load_dwordx4 v7, s[56:59], s64 offen lds
buffer_load_dwordx4 v8, s[56:59], s64 offen offset:1024 lds
s_add_u32 m0, s73, 4096
s_add_u32 s64, s71, 524288
buffer_load_dwordx4 v5, s[8:11], s64 offen lds
buffer_load_dwordx4 v6, s[8:11], s64 offen offset:1024 lds
s_add_u32 m0, s73, 6144
s_add_u32 s64, s71, 540672
buffer_load_dwordx4 v5, s[8:11], s64 offen lds
buffer_load_dwordx4 v6, s[8:11], s64 offen offset:1024 lds
s_mov_b32 s18, 4194304
s_mov_b32 s19, 0x20000
s_lshl_b32 s65, s54, 7
s_lshl_b32 s53, s55, 12
v_lshrrev_b32 v16, 1, v2
v_xor_b32 v16, v16, v3
v_add_u32 v17, s65, v2
v_lshlrev_b32 v17, 7, v17
v_add_u32 v17, 65536, v17
v_lshl_add_u32 v9, v16, 4, v17
v_xor_b32 v10, 64, v9
v_bfe_u32 v16, v1, 2, 2
v_lshl_add_u32 v17, v3, 3, v16
v_lshlrev_b32 v17, 7, v17
v_and_b32 v18, 3, v1
v_lshl_add_u32 v17, v18, 3, v17
v_add_u32 v17, s53, v17
v_lshrrev_b32 v16, 1, v16
v_and_b32 v18, 1, v3
v_lshl_add_u32 v16, v18, 1, v16
v_xor_b32 v18, 0, v16
v_lshl_add_u32 v11, v18, 5, v17
v_xor_b32 v18, 1, v16
v_lshl_add_u32 v12, v18, 5, v17
v_xor_b32 v18, 2, v16
v_lshl_add_u32 v13, v18, 5, v17
v_xor_b32 v18, 3, v16
v_lshl_add_u32 v14, v18, 5, v17
s_add_u32 m0, s77, 16384
s_add_u32 s64, s76, 0
buffer_load_dwordx4 v7, s[16:19], s64 offen lds
buffer_load_dwordx4 v8, s[16:19], s64 offen offset:1024 lds
s_add_u32 m0, s77, 18432
s_add_u32 s64, s76, 131072
buffer_load_dwordx4 v7, s[16:19], s64 offen lds
buffer_load_dwordx4 v8, s[16:19], s64 offen offset:1024 lds
s_mov_b64 exec, 0
s_cmp_eq_u32 s3, 0
s_cbranch_scc1 L_PAD0
s_cmp_eq_u32 s3, 1
s_cbranch_scc1 L_PAD1
s_cmp_eq_u32 s3, 2
s_cbranch_scc1 L_PAD2
s_branch L_PAD3
.p2align 12
.fill 682, 4, 0xbf800000
L_MAIN:
s_mov_b64 exec, -1
s_xor_b32 s71, s70, 128
s_add_u32 s71, s68, s71
s_add_u32 m0, s73, 32768
s_add_u32 s64, s71, 0
buffer_load_dwordx4 v5, s[8:11], s64 offen lds
buffer_load_dwordx4 v6, s[8:11], s64 offen offset:1024 lds
s_add_u32 m0, s73, 34816
s_add_u32 s64, s71, 16384
buffer_load_dwordx4 v5, s[8:11], s64 offen lds
buffer_load_dwordx4 v6, s[8:11], s64 offen offset:1024 lds
s_add_u32 m0, s73, 36864
s_add_u32 s64, s71, 524288
buffer_load_dwordx4 v5, s[8:11], s64 offen lds
buffer_load_dwordx4 v6, s[8:11], s64 offen offset:1024 lds
s_add_u32 m0, s73, 38912
s_add_u32 s64, s71, 540672
buffer_load_dwordx4 v5, s[8:11], s64 offen lds
buffer_load_dwordx4 v6, s[8:11], s64 offen offset:1024 lds
s_waitcnt vmcnt(12)
s_barrier
ds_read_b128 a[64:67], v9 offset:0
ds_read_b128 a[68:71], v10 offset:0
ds_read_b64_tr_b16 a[128:129], v11 offset:0
ds_read_b64_tr_b16 a[130:131], v11 offset:512
ds_read_b64_tr_b16 a[132:133], v11 offset:8192
ds_read_b64_tr_b16 a[134:135], v11 offset:8704
ds_read_b64_tr_b16 a[136:137], v12 offset:0
ds_read_b64_tr_b16 a[138:139], v12 offset:512
ds_read_b64_tr_b16 a[140:141], v12 offset:8192
ds_read_b64_tr_b16 a[142:143], v12 offset:8704
ds_read_b64_tr_b16 a[144:145], v13 offset:0
ds_read_b64_tr_b16 a[146:147], v13 offset:512
ds_read_b64_tr_b16 a[148:149], v13 offset:8192
ds_read_b64_tr_b16 a[150:151], v13 offset:8704
ds_read_b64_tr_b16 a[152:153], v14 offset:0
ds_read_b64_tr_b16 a[154:155], v14 offset:512
ds_read_b64_tr_b16 a[156:157], v14 offset:8192
ds_read_b64_tr_b16 a[158:159], v14 offset:8704
ds_read_b128 a[72:75], v9 offset:2048
ds_read_b128 a[76:79], v10 offset:2048
ds_read_b128 a[80:83], v9 offset:4096
ds_read_b128 a[84:87], v10 offset:4096
ds_read_b128 a[88:91], v9 offset:6144
ds_read_b128 a[92:95], v10 offset:6144
s_waitcnt lgkmcnt(0)
v_mfma_f32_16x16x32_bf16 v[32:35], a[64:67], a[128:131], 0
s_waitcnt vmcnt(8)
v_mfma_f32_16x16x32_bf16 v[32:35], a[68:71], a[132:135], v[32:35]
s_barrier
v_mfma_f32_16x16x32_bf16 v[40:43], a[68:71], a[140:143], 0
s_mov_b32 s26, 268435456
s_mov_b32 s27, 0x20000
ds_read_b128 a[96:99], v9 offset:8192
v_mfma_f32_16x16x32_bf16 v[40:43], a[64:67], a[136:139], v[40:43]
s_xor_b32 s76, s75, 524288
s_add_u32 s76, s74, s76
s_mov_b32 s14, 2359296
v_mfma_f32_16x16x32_bf16 v[48:51], a[64:67], a[144:147], 0
s_add_u32 m0, s77, 32768
s_add_u32 s64, s76, 0
s_mov_b32 s15, 0x20000
v_mfma_f32_16x16x32_bf16 v[48:51], a[68:71], a[148:151], v[48:51]
buffer_load_dwordx4 v7, s[56:59], s64 offen lds
v_mfma_f32_16x16x32_bf16 v[56:59], a[68:71], a[156:159], 0
s_mov_b32 s22, 4718592
s_mov_b32 s23, 0x20000
ds_read_b128 a[100:103], v10 offset:8192
v_mfma_f32_16x16x32_bf16 v[56:59], a[64:67], a[152:155], v[56:59]
buffer_load_dwordx4 v8, s[56:59], s64 offen offset:1024 lds
v_mfma_f32_16x16x32_bf16 v[60:63], a[72:75], a[152:155], 0
s_add_u32 m0, s77, 34816
s_add_u32 s64, s76, 131072
ds_read_b128 a[104:107], v9 offset:10240
v_mfma_f32_16x16x32_bf16 v[60:63], a[76:79], a[156:159], v[60:63]
s_mov_b32 s30, 1990656
s_mov_b32 s31, 0x20000
s_mov_b32 s34, 4718592
v_mfma_f32_16x16x32_bf16 v[52:55], a[76:79], a[148:151], 0
buffer_load_dwordx4 v7, s[56:59], s64 offen lds
v_mfma_f32_16x16x32_bf16 v[52:55], a[72:75], a[144:147], v[52:55]
s_mov_b32 s35, 0x20000
ds_read_b64_tr_b16 a[160:161], v11 offset:16384
ds_read_b64_tr_b16 a[162:163], v11 offset:16896
v_mfma_f32_16x16x32_bf16 v[44:47], a[72:75], a[136:139], 0
s_mov_b32 s38, 1152
s_mov_b32 s39, 0x20000
s_mov_b32 s42, 256
v_mfma_f32_16x16x32_bf16 v[44:47], a[76:79], a[140:143], v[44:47]
buffer_load_dwordx4 v8, s[56:59], s64 offen offset:1024 lds
v_mfma_f32_16x16x32_bf16 v[36:39], a[76:79], a[132:135], 0
s_mov_b32 s43, 0x20000
s_mov_b32 s46, 2359296
s_mov_b32 s47, 0x20000
v_mfma_f32_16x16x32_bf16 v[36:39], a[72:75], a[128:131], v[36:39]
s_add_u32 m0, s77, 49152
s_add_u32 s64, s76, 0
ds_read_b128 a[108:111], v10 offset:10240
v_mfma_f32_16x16x32_bf16 v[64:67], a[80:83], a[128:131], 0
s_mov_b32 s50, 663552
s_mov_b32 s51, 0x20000
s_lshl_b32 s89, s4, 10
v_mfma_f32_16x16x32_bf16 v[64:67], a[84:87], a[132:135], v[64:67]
buffer_load_dwordx4 v7, s[16:19], s64 offen lds
v_mfma_f32_16x16x32_bf16 v[72:75], a[84:87], a[140:143], 0
s_add_u32 s89, s89, 75497472
ds_read_b64_tr_b16 a[164:165], v11 offset:24576
ds_read_b64_tr_b16 a[166:167], v11 offset:25088
v_mfma_f32_16x16x32_bf16 v[72:75], a[80:83], a[136:139], v[72:75]
s_mul_i32 s94, s4, 1064960
s_cmp_eq_u32 s66, 0
s_cselect_b32 s52, s89, 2147418112
v_mfma_f32_16x16x32_bf16 v[80:83], a[80:83], a[144:147], 0
buffer_load_dwordx4 v8, s[16:19], s64 offen offset:1024 lds
v_mfma_f32_16x16x32_bf16 v[80:83], a[84:87], a[148:151], v[80:83]
s_add_u32 m0, s77, 51200
s_add_u32 s64, s76, 131072
ds_read_b128 a[112:115], v9 offset:12288
v_mfma_f32_16x16x32_bf16 v[88:91], a[84:87], a[156:159], 0
s_lshl_b32 s53, s5, 10
s_add_u32 s53, s53, s94
s_add_u32 s53, s53, 1048576
v_mfma_f32_16x16x32_bf16 v[88:91], a[80:83], a[152:155], v[88:91]
buffer_load_dwordx4 v7, s[16:19], s64 offen lds
v_mfma_f32_16x16x32_bf16 v[92:95], a[88:91], a[152:155], 0
ds_read_b64_tr_b16 a[168:169], v12 offset:16384
ds_read_b64_tr_b16 a[170:171], v12 offset:16896
v_mfma_f32_16x16x32_bf16 v[92:95], a[92:95], a[156:159], v[92:95]
s_cmp_eq_u32 s3, 1
s_cselect_b32 s52, s53, s52
s_mul_i32 s53, s2, 74
v_mfma_f32_16x16x32_bf16 v[84:87], a[92:95], a[148:151], 0
buffer_load_dwordx4 v8, s[16:19], s64 offen offset:1024 lds
v_mfma_f32_16x16x32_bf16 v[84:87], a[88:91], a[144:147], v[84:87]
s_add_u32 s53, s53, s55
s_lshl_b32 s53, s53, 10
s_add_u32 s53, s53, 54599680
v_mfma_f32_16x16x32_bf16 v[76:79], a[88:91], a[136:139], 0
s_cmp_ge_u32 s3, 2
s_cselect_b32 s52, s53, s52
ds_read_b128 a[116:119], v10 offset:12288
v_mfma_f32_16x16x32_bf16 v[76:79], a[92:95], a[140:143], v[76:79]
v_mov_b32 v16, 0
v_mov_b32 v17, 0
v_mfma_f32_16x16x32_bf16 v[68:71], a[92:95], a[132:135], 0
v_mov_b32 v18, 0
v_mov_b32 v19, 0
v_mfma_f32_16x16x32_bf16 v[68:71], a[88:91], a[128:131], v[68:71]
s_waitcnt lgkmcnt(6)
ds_read_b64_tr_b16 a[172:173], v12 offset:24576
ds_read_b64_tr_b16 a[174:175], v12 offset:25088
v_mfma_f32_16x16x32_bf16 v[96:99], a[96:99], a[128:131], 0
v_mfma_f32_16x16x32_bf16 v[96:99], a[100:103], a[132:135], v[96:99]
v_mfma_f32_16x16x32_bf16 v[104:107], a[100:103], a[140:143], 0
ds_read_b128 a[120:123], v9 offset:14336
v_mfma_f32_16x16x32_bf16 v[104:107], a[96:99], a[136:139], v[104:107]
v_mfma_f32_16x16x32_bf16 v[112:115], a[96:99], a[144:147], 0
v_mfma_f32_16x16x32_bf16 v[112:115], a[100:103], a[148:151], v[112:115]
ds_read_b64_tr_b16 a[176:177], v13 offset:16384
ds_read_b64_tr_b16 a[178:179], v13 offset:16896
v_mfma_f32_16x16x32_bf16 v[120:123], a[100:103], a[156:159], 0
v_mfma_f32_16x16x32_bf16 v[120:123], a[96:99], a[152:155], v[120:123]
v_mfma_f32_16x16x32_bf16 v[124:127], a[104:107], a[152:155], 0
v_mfma_f32_16x16x32_bf16 v[124:127], a[108:111], a[156:159], v[124:127]
ds_read_b128 a[124:127], v10 offset:14336
v_mfma_f32_16x16x32_bf16 v[116:119], a[108:111], a[148:151], 0
v_add_u32 v9, 32768, v9
v_add_u32 v10, 32768, v10
v_mfma_f32_16x16x32_bf16 v[116:119], a[104:107], a[144:147], v[116:119]
v_mfma_f32_16x16x32_bf16 v[108:111], a[104:107], a[136:139], 0
ds_read_b64_tr_b16 a[180:181], v13 offset:24576
ds_read_b64_tr_b16 a[182:183], v13 offset:25088
v_mfma_f32_16x16x32_bf16 v[108:111], a[108:111], a[140:143], v[108:111]
v_mfma_f32_16x16x32_bf16 v[100:103], a[108:111], a[132:135], 0
v_mfma_f32_16x16x32_bf16 v[100:103], a[104:107], a[128:131], v[100:103]
s_waitcnt lgkmcnt(2)
ds_read_b64_tr_b16 a[184:185], v14 offset:16384
ds_read_b64_tr_b16 a[186:187], v14 offset:16896
v_mfma_f32_16x16x32_bf16 v[128:131], a[112:115], a[128:131], 0
v_mfma_f32_16x16x32_bf16 v[128:131], a[116:119], a[132:135], v[128:131]
v_mfma_f32_16x16x32_bf16 v[136:139], a[116:119], a[140:143], 0
ds_read_b64_tr_b16 a[188:189], v14 offset:24576
ds_read_b64_tr_b16 a[190:191], v14 offset:25088
v_mfma_f32_16x16x32_bf16 v[136:139], a[112:115], a[136:139], v[136:139]
v_mfma_f32_16x16x32_bf16 v[144:147], a[112:115], a[144:147], 0
L_PAD0:
s_cbranch_execz L_PAD4
v_mfma_f32_16x16x32_bf16 v[144:147], a[116:119], a[148:151], v[144:147]
v_mfma_f32_16x16x32_bf16 v[152:155], a[116:119], a[156:159], 0
v_mfma_f32_16x16x32_bf16 v[152:155], a[112:115], a[152:155], v[152:155]
v_mfma_f32_16x16x32_bf16 v[156:159], a[120:123], a[152:155], 0
v_mfma_f32_16x16x32_bf16 v[156:159], a[124:127], a[156:159], v[156:159]
v_mfma_f32_16x16x32_bf16 v[148:151], a[124:127], a[148:151], 0
v_mfma_f32_16x16x32_bf16 v[148:151], a[120:123], a[144:147], v[148:151]
v_mfma_f32_16x16x32_bf16 v[140:143], a[120:123], a[136:139], 0
v_mfma_f32_16x16x32_bf16 v[140:143], a[124:127], a[140:143], v[140:143]
v_mfma_f32_16x16x32_bf16 v[132:135], a[124:127], a[132:135], 0
v_mfma_f32_16x16x32_bf16 v[132:135], a[120:123], a[128:131], v[132:135]
s_waitcnt lgkmcnt(0)
v_mfma_f32_16x16x32_bf16 v[160:163], a[160:163], a[64:67], 0
s_waitcnt vmcnt(4)
v_mfma_f32_16x16x32_bf16 v[160:163], a[164:167], a[68:71], v[160:163]
s_barrier
v_mfma_f32_16x16x32_bf16 v[164:167], a[172:175], a[68:71], 0
ds_read_b64_tr_b16 a[128:129], v11 offset:32768
ds_read_b64_tr_b16 a[130:131], v11 offset:33280
v_mfma_f32_16x16x32_bf16 v[164:167], a[168:171], a[64:67], v[164:167]
s_xor_b32 s71, s70, 256
s_add_u32 s71, s68, s71
v_mfma_f32_16x16x32_bf16 v[168:171], a[176:179], a[64:67], 0
s_add_u32 m0, s73, 65536
s_add_u32 s64, s71, 0
v_mfma_f32_16x16x32_bf16 v[168:171], a[180:183], a[68:71], v[168:171]
buffer_load_dwordx4 v5, s[8:11], s64 offen lds
v_mfma_f32_16x16x32_bf16 v[172:175], a[188:191], a[68:71], 0
v_mfma_f32_16x16x32_bf16 v[172:175], a[184:187], a[64:67], v[172:175]
ds_read_b128 a[64:67], v9 offset:0
v_mfma_f32_16x16x32_bf16 v[188:191], a[184:187], a[72:75], 0
buffer_load_dwordx4 v6, s[8:11], s64 offen offset:1024 lds
v_mfma_f32_16x16x32_bf16 v[188:191], a[188:191], a[76:79], v[188:191]
ds_read_b64_tr_b16 a[132:133], v11 offset:40960
ds_read_b64_tr_b16 a[134:135], v11 offset:41472
v_mfma_f32_16x16x32_bf16 v[184:187], a[180:183], a[76:79], 0
v_mfma_f32_16x16x32_bf16 v[184:187], a[176:179], a[72:75], v[184:187]
s_add_u32 m0, s73, 67584
s_add_u32 s64, s71, 16384
ds_read_b128 a[68:71], v10 offset:0
v_mfma_f32_16x16x32_bf16 v[180:183], a[168:171], a[72:75], 0
v_mfma_f32_16x16x32_bf16 v[180:183], a[172:175], a[76:79], v[180:183]
buffer_load_dwordx4 v5, s[8:11], s64 offen lds
v_mfma_f32_16x16x32_bf16 v[176:179], a[164:167], a[76:79], 0
v_mfma_f32_16x16x32_bf16 v[176:179], a[160:163], a[72:75], v[176:179]
ds_read_b64_tr_b16 a[136:137], v12 offset:32768
ds_read_b64_tr_b16 a[138:139], v12 offset:33280
v_mfma_f32_16x16x32_bf16 v[192:195], a[160:163], a[80:83], 0
v_mfma_f32_16x16x32_bf16 v[192:195], a[164:167], a[84:87], v[192:195]
v_mfma_f32_16x16x32_bf16 v[196:199], a[172:175], a[84:87], 0
buffer_load_dwordx4 v6, s[8:11], s64 offen offset:1024 lds
v_mfma_f32_16x16x32_bf16 v[196:199], a[168:171], a[80:83], v[196:199]
s_xor_b32 s76, s75, 1048576
s_add_u32 s76, s74, s76
ds_read_b128 a[72:75], v9 offset:2048
v_mfma_f32_16x16x32_bf16 v[200:203], a[176:179], a[80:83], 0
v_mfma_f32_16x16x32_bf16 v[200:203], a[180:183], a[84:87], v[200:203]
s_add_u32 m0, s77, 0
s_add_u32 s64, s76, 0
v_mfma_f32_16x16x32_bf16 v[204:207], a[188:191], a[84:87], 0
ds_read_b64_tr_b16 a[140:141], v12 offset:40960
ds_read_b64_tr_b16 a[142:143], v12 offset:41472
v_mfma_f32_16x16x32_bf16 v[204:207], a[184:187], a[80:83], v[204:207]
buffer_load_dwordx4 v7, s[56:59], s64 offen lds
v_mfma_f32_16x16x32_bf16 v[220:223], a[184:187], a[88:91], 0
ds_read_b128 a[76:79], v10 offset:2048
v_mfma_f32_16x16x32_bf16 v[220:223], a[188:191], a[92:95], v[220:223]
v_mfma_f32_16x16x32_bf16 v[216:219], a[180:183], a[92:95], 0
v_mfma_f32_16x16x32_bf16 v[216:219], a[176:179], a[88:91], v[216:219]
v_mfma_f32_16x16x32_bf16 v[212:215], a[168:171], a[88:91], 0
buffer_load_dwordx4 v8, s[56:59], s64 offen offset:1024 lds
v_mfma_f32_16x16x32_bf16 v[212:215], a[172:175], a[92:95], v[212:215]
ds_read_b64_tr_b16 a[144:145], v13 offset:32768
ds_read_b64_tr_b16 a[146:147], v13 offset:33280
v_mfma_f32_16x16x32_bf16 v[208:211], a[164:167], a[92:95], 0
v_mfma_f32_16x16x32_bf16 v[208:211], a[160:163], a[88:91], v[208:211]
s_add_u32 m0, s77, 2048
s_add_u32 s64, s76, 131072
ds_read_b128 a[80:83], v9 offset:4096
v_mfma_f32_16x16x32_bf16 v[224:227], a[160:163], a[96:99], 0
v_mfma_f32_16x16x32_bf16 v[224:227], a[164:167], a[100:103], v[224:227]
buffer_load_dwordx4 v7, s[56:59], s64 offen lds
v_mfma_f32_16x16x32_bf16 v[228:231], a[172:175], a[100:103], 0
ds_read_b64_tr_b16 a[148:149], v13 offset:40960
ds_read_b64_tr_b16 a[150:151], v13 offset:41472
v_mfma_f32_16x16x32_bf16 v[228:231], a[168:171], a[96:99], v[228:231]
v_mfma_f32_16x16x32_bf16 v[232:235], a[176:179], a[96:99], 0
buffer_store_dwordx4 v[16:19], v4, s[24:27], s52 offen sc1
v_mfma_f32_16x16x32_bf16 v[232:235], a[180:183], a[100:103], v[232:235]
buffer_load_dwordx4 v8, s[56:59], s64 offen offset:1024 lds
v_mfma_f32_16x16x32_bf16 v[236:239], a[188:191], a[100:103], 0
s_add_u32 s89, s89, 512
ds_read_b128 a[84:87], v10 offset:4096
v_mfma_f32_16x16x32_bf16 v[236:239], a[184:187], a[96:99], v[236:239]
s_cmp_eq_u32 s3, 0
s_cselect_b32 s90, s89, 2147418112
v_mov_b32 v24, 2147418112
v_mfma_f32_16x16x32_bf16 v[252:255], a[184:187], a[104:107], 0
s_add_u32 m0, s73, 69632
s_add_u32 s64, s71, 524288
v_cmp_eq_u32 vcc, 1, v1
v_mfma_f32_16x16x32_bf16 v[252:255], a[188:191], a[108:111], v[252:255]
s_lshl_b32 s53, s55, 12
ds_read_b64_tr_b16 a[152:153], v14 offset:32768
ds_read_b64_tr_b16 a[154:155], v14 offset:33280
v_mfma_f32_16x16x32_bf16 v[248:251], a[180:183], a[108:111], 0
buffer_load_dwordx4 v5, s[8:11], s64 offen lds
v_mfma_f32_16x16x32_bf16 v[248:251], a[176:179], a[104:107], v[248:251]
v_cndmask_b32 v0, v24, 0, vcc
v_mfma_f32_16x16x32_bf16 v[244:247], a[168:171], a[104:107], 0
s_mul_i32 s87, s87, 16384
s_add_u32 s87, s87, s94
ds_read_b128 a[88:91], v9 offset:6144
v_mfma_f32_16x16x32_bf16 v[244:247], a[172:175], a[108:111], v[244:247]
s_add_u32 s88, s87, s53
s_add_u32 s88, s88, 24576
s_lshr_b32 s53, s53, 1
v_mfma_f32_16x16x32_bf16 v[240:243], a[164:167], a[108:111], 0
s_add_u32 s87, s87, s53
s_lshl_b32 s80, s3, 10
s_mul_i32 s78, s4, 18
v_mfma_f32_16x16x32_bf16 v[240:243], a[160:163], a[104:107], v[240:243]
buffer_load_dwordx4 v6, s[8:11], s64 offen offset:1024 lds
v_mfma_f32_16x16x32_bf16 a[0:3], a[160:163], a[112:115], 0
s_add_u32 s78, s78, s54
ds_read_b64_tr_b16 a[156:157], v14 offset:40960
ds_read_b64_tr_b16 a[158:159], v14 offset:41472
v_mfma_f32_16x16x32_bf16 a[0:3], a[164:167], a[116:119], a[0:3]
s_lshl2_add_u32 s78, s78, s55
s_lshl_b32 s78, s78, 10
s_add_u32 s78, s78, 35651584
v_mfma_f32_16x16x32_bf16 a[4:7], a[172:175], a[116:119], 0
s_add_u32 m0, s73, 71680
s_add_u32 s64, s71, 540672
ds_read_b128 a[92:95], v10 offset:6144
v_mfma_f32_16x16x32_bf16 a[4:7], a[168:171], a[112:115], a[4:7]
s_add_u32 s80, s80, 8192
s_mov_b32 s91, 0x3e0293ee
s_mov_b32 s85, 0x05040100
v_mfma_f32_16x16x32_bf16 a[8:11], a[176:179], a[112:115], 0
buffer_load_dwordx4 v5, s[8:11], s64 offen lds
v_mfma_f32_16x16x32_bf16 a[8:11], a[180:183], a[116:119], a[8:11]
s_mov_b32 s86, 0x07060302
s_lshl2_add_u32 s52, s7, s3
s_xor_b32 s92, s6, 31
v_mfma_f32_16x16x32_bf16 a[12:15], a[188:191], a[116:119], 0
s_mul_i32 s81, s92, 110592
s_mul_i32 s65, s52, 36
s_add_u32 s81, s81, s65
v_mfma_f32_16x16x32_bf16 a[12:15], a[184:187], a[112:115], a[12:15]
s_mul_i32 s82, s52, 18
s_add_u32 s82, s82, s92
s_lshl_b32 s82, s82, 12
v_mfma_f32_16x16x32_bf16 a[28:31], a[184:187], a[120:123], 0
s_add_u32 s82, s82, 35651584
s_lshl_b32 s83, s92, 6
s_lshl_b32 s84, s52, 10
v_mfma_f32_16x16x32_bf16 a[28:31], a[188:191], a[124:127], a[28:31]
buffer_load_dwordx4 v6, s[8:11], s64 offen offset:1024 lds
v_mfma_f32_16x16x32_bf16 a[24:27], a[180:183], a[124:127], 0
s_add_u32 s84, s84, 75497984
v_mfma_f32_16x16x32_bf16 a[24:27], a[176:179], a[120:123], a[24:27]
s_cmp_lt_u32 s92, 18
s_cselect_b32 s82, s82, 2147418112
s_cselect_b32 s84, s84, 2147418112
v_mfma_f32_16x16x32_bf16 a[20:23], a[168:171], a[120:123], 0
v_lshrrev_b32 v18, 2, v2
v_and_b32 v19, 3, v2
v_mfma_f32_16x16x32_bf16 a[20:23], a[172:175], a[124:127], a[20:23]
v_mul_u32_u24 v20, 1152, v18
v_cmp_eq_u32 vcc, 2, v19
v_mfma_f32_16x16x32_bf16 a[16:19], a[164:167], a[124:127], 0
v_lshl_add_u32 v20, v19, 3, v20
v_add_u32 v21, 1, v19
v_mfma_f32_16x16x32_bf16 a[16:19], a[160:163], a[120:123], a[16:19]
s_waitcnt lgkmcnt(0)
v_cndmask_b32 v21, v21, 0, vcc
v_cmp_eq_u32 vcc, 3, v18
v_mfma_f32_16x16x32_bf16 v[32:35], a[64:67], a[128:131], v[32:35]
s_waitcnt vmcnt(13)
v_mul_u32_u24 v21, 1152, v21
v_add_u32 v21, 32, v21
v_mfma_f32_16x16x32_bf16 v[32:35], a[68:71], a[132:135], v[32:35]
s_barrier
v_mfma_f32_16x16x32_bf16 v[40:43], a[68:71], a[140:143], v[40:43]
ds_read_b128 a[96:99], v9 offset:8192
v_cndmask_b32 v20, v20, v21, vcc
v_mfma_f32_16x16x32_bf16 v[40:43], a[64:67], a[136:139], v[40:43]
s_add_u32 m0, s77, 16384
s_add_u32 s64, s76, 0
v_cmp_eq_u32 vcc, 15, v2
v_mfma_f32_16x16x32_bf16 v[48:51], a[64:67], a[144:147], v[48:51]
buffer_load_dwordx4 v7, s[16:19], s64 offen lds
v_mfma_f32_16x16x32_bf16 v[48:51], a[68:71], a[148:151], v[48:51]
ds_read_b128 a[100:103], v10 offset:8192
v_mul_u32_u24 v21, 27648, v3
v_mfma_f32_16x16x32_bf16 v[56:59], a[68:71], a[156:159], v[56:59]
v_add_u32 v20, v20, v21
v_lshlrev_b32 v21, 4, v3
v_mfma_f32_16x16x32_bf16 v[56:59], a[64:67], a[152:155], v[56:59]
v_cndmask_b32 v26, v20, v24, vcc
v_cndmask_b32 v27, v24, v21, vcc
v_mfma_f32_16x16x32_bf16 v[60:63], a[72:75], a[152:155], v[60:63]
buffer_load_dwordx4 v8, s[16:19], s64 offen offset:1024 lds
v_mfma_f32_16x16x32_bf16 v[60:63], a[76:79], a[156:159], v[60:63]
ds_read_b128 a[104:107], v9 offset:10240
v_and_b32 v18, 7, v1
v_mfma_f32_16x16x32_bf16 v[52:55], a[76:79], a[148:151], v[52:55]
v_cmp_gt_u32 vcc, 48, v1
v_mul_u32_u24 v18, 3456, v18
v_mfma_f32_16x16x32_bf16 v[52:55], a[72:75], a[144:147], v[52:55]
s_add_u32 m0, s77, 18432
s_add_u32 s64, s76, 131072
v_mul_u32_u24 v19, 1152, v3
v_mfma_f32_16x16x32_bf16 v[44:47], a[72:75], a[136:139], v[44:47]
ds_read_b64_tr_b16 a[160:161], v11 offset:49152
ds_read_b64_tr_b16 a[162:163], v11 offset:49664
v_mfma_f32_16x16x32_bf16 v[44:47], a[76:79], a[140:143], v[44:47]
buffer_load_dwordx4 v7, s[16:19], s64 offen lds
v_mfma_f32_16x16x32_bf16 v[36:39], a[76:79], a[132:135], v[36:39]
v_bfe_u32 v20, v1, 3, 1
v_mul_u32_u24 v20, 140, v20
v_mfma_f32_16x16x32_bf16 v[36:39], a[72:75], a[128:131], v[36:39]
ds_read_b128 a[108:111], v10 offset:10240
v_add3_u32 v18, v18, v19, v20
v_mfma_f32_16x16x32_bf16 v[64:67], a[80:83], a[128:131], v[64:67]
v_cndmask_b32 v28, v24, v18, vcc
v_mfma_f32_16x16x32_bf16 v[64:67], a[84:87], a[132:135], v[64:67]
s_lshl_b32 s52, s4, 2
s_cmp_eq_u32 s66, 0
s_cselect_b32 s52, s52, 2147418112
v_mfma_f32_16x16x32_bf16 v[72:75], a[84:87], a[140:143], v[72:75]
buffer_load_dwordx4 v8, s[16:19], s64 offen offset:1024 lds
v_mfma_f32_16x16x32_bf16 v[72:75], a[80:83], a[136:139], v[72:75]
s_xor_b32 s71, s70, 384
s_add_u32 s71, s68, s71
v_mfma_f32_16x16x32_bf16 v[80:83], a[80:83], a[144:147], v[80:83]
ds_read_b64_tr_b16 a[164:165], v11 offset:57344
ds_read_b64_tr_b16 a[166:167], v11 offset:57856
v_mfma_f32_16x16x32_bf16 v[80:83], a[84:87], a[148:151], v[80:83]
s_add_u32 m0, s73, 0
s_add_u32 s64, s71, 0
ds_read_b128 a[112:115], v9 offset:12288
v_mfma_f32_16x16x32_bf16 v[88:91], a[84:87], a[156:159], v[88:91]
v_mfma_f32_16x16x32_bf16 v[88:91], a[80:83], a[152:155], v[88:91]
buffer_load_dwordx4 v5, s[8:11], s64 offen lds
v_mfma_f32_16x16x32_bf16 v[92:95], a[88:91], a[152:155], v[92:95]
ds_read_b64_tr_b16 a[168:169], v12 offset:49152
ds_read_b64_tr_b16 a[170:171], v12 offset:49664
v_mfma_f32_16x16x32_bf16 v[92:95], a[92:95], a[156:159], v[92:95]
v_mfma_f32_16x16x32_bf16 v[84:87], a[92:95], a[148:151], v[84:87]
v_mfma_f32_16x16x32_bf16 v[84:87], a[88:91], a[144:147], v[84:87]
v_mfma_f32_16x16x32_bf16 v[76:79], a[88:91], a[136:139], v[76:79]
buffer_load_dwordx4 v6, s[8:11], s64 offen offset:1024 lds
v_mfma_f32_16x16x32_bf16 v[76:79], a[92:95], a[140:143], v[76:79]
ds_read_b128 a[116:119], v10 offset:12288
v_mfma_f32_16x16x32_bf16 v[68:71], a[92:95], a[132:135], v[68:71]
v_mfma_f32_16x16x32_bf16 v[68:71], a[88:91], a[128:131], v[68:71]
s_add_u32 m0, s73, 2048
s_add_u32 s64, s71, 16384
s_waitcnt lgkmcnt(6)
v_mfma_f32_16x16x32_bf16 v[96:99], a[96:99], a[128:131], v[96:99]
ds_read_b64_tr_b16 a[172:173], v12 offset:57344
ds_read_b64_tr_b16 a[174:175], v12 offset:57856
v_mfma_f32_16x16x32_bf16 v[96:99], a[100:103], a[132:135], v[96:99]
buffer_load_dwordx4 v5, s[8:11], s64 offen lds
v_mfma_f32_16x16x32_bf16 v[104:107], a[100:103], a[140:143], v[104:107]
ds_read_b128 a[120:123], v9 offset:14336
v_mfma_f32_16x16x32_bf16 v[104:107], a[96:99], a[136:139], v[104:107]
v_mfma_f32_16x16x32_bf16 v[112:115], a[96:99], a[144:147], v[112:115]
v_mfma_f32_16x16x32_bf16 v[112:115], a[100:103], a[148:151], v[112:115]
buffer_load_dwordx4 v6, s[8:11], s64 offen offset:1024 lds
v_mfma_f32_16x16x32_bf16 v[120:123], a[100:103], a[156:159], v[120:123]
s_xor_b32 s76, s75, 1572864
s_add_u32 s76, s74, s76
v_mfma_f32_16x16x32_bf16 v[120:123], a[96:99], a[152:155], v[120:123]
ds_read_b64_tr_b16 a[176:177], v13 offset:49152
ds_read_b64_tr_b16 a[178:179], v13 offset:49664
v_mfma_f32_16x16x32_bf16 v[124:127], a[104:107], a[152:155], v[124:127]
s_add_u32 m0, s77, 32768
s_add_u32 s64, s76, 0
v_mfma_f32_16x16x32_bf16 v[124:127], a[108:111], a[156:159], v[124:127]
ds_read_b128 a[124:127], v10 offset:14336
v_mfma_f32_16x16x32_bf16 v[116:119], a[108:111], a[148:151], v[116:119]
buffer_load_dwordx4 v7, s[56:59], s64 offen lds
v_mfma_f32_16x16x32_bf16 v[116:119], a[104:107], a[144:147], v[116:119]
s_waitcnt vmcnt(14)
v_add_u32 v9, 32768, v9
v_add_u32 v10, 32768, v10
v_mfma_f32_16x16x32_bf16 v[108:111], a[104:107], a[136:139], v[108:111]
ds_read_b64_tr_b16 a[180:181], v13 offset:57344
ds_read_b64_tr_b16 a[182:183], v13 offset:57856
v_mfma_f32_16x16x32_bf16 v[108:111], a[108:111], a[140:143], v[108:111]
buffer_store_dword v1, v0, s[40:43], s52 offen sc1
v_mfma_f32_16x16x32_bf16 v[100:103], a[108:111], a[132:135], v[100:103]
s_waitcnt lgkmcnt(2)
v_mfma_f32_16x16x32_bf16 v[100:103], a[104:107], a[128:131], v[100:103]
buffer_load_dwordx4 v8, s[56:59], s64 offen offset:1024 lds
v_mfma_f32_16x16x32_bf16 v[128:131], a[112:115], a[128:131], v[128:131]
ds_read_b64_tr_b16 a[184:185], v14 offset:49152
ds_read_b64_tr_b16 a[186:187], v14 offset:49664
v_mfma_f32_16x16x32_bf16 v[128:131], a[116:119], a[132:135], v[128:131]
v_mfma_f32_16x16x32_bf16 v[136:139], a[116:119], a[140:143], v[136:139]
s_add_u32 m0, s77, 34816
s_add_u32 s64, s76, 131072
v_mfma_f32_16x16x32_bf16 v[136:139], a[112:115], a[136:139], v[136:139]
ds_read_b64_tr_b16 a[188:189], v14 offset:57344
ds_read_b64_tr_b16 a[190:191], v14 offset:57856
v_mfma_f32_16x16x32_bf16 v[144:147], a[112:115], a[144:147], v[144:147]
buffer_load_dwordx4 v7, s[56:59], s64 offen lds
v_mfma_f32_16x16x32_bf16 v[144:147], a[116:119], a[148:151], v[144:147]
v_mfma_f32_16x16x32_bf16 v[152:155], a[116:119], a[156:159], v[152:155]
v_mfma_f32_16x16x32_bf16 v[152:155], a[112:115], a[152:155], v[152:155]
v_mfma_f32_16x16x32_bf16 v[156:159], a[120:123], a[152:155], v[156:159]
v_mfma_f32_16x16x32_bf16 v[156:159], a[124:127], a[156:159], v[156:159]
buffer_load_dwordx4 v8, s[56:59], s64 offen offset:1024 lds
v_mfma_f32_16x16x32_bf16 v[148:151], a[124:127], a[148:151], v[148:151]
v_mfma_f32_16x16x32_bf16 v[148:151], a[120:123], a[144:147], v[148:151]
v_mfma_f32_16x16x32_bf16 v[140:143], a[120:123], a[136:139], v[140:143]
v_mfma_f32_16x16x32_bf16 v[140:143], a[124:127], a[140:143], v[140:143]
v_mfma_f32_16x16x32_bf16 v[132:135], a[124:127], a[132:135], v[132:135]
v_mfma_f32_16x16x32_bf16 v[132:135], a[120:123], a[128:131], v[132:135]
s_waitcnt lgkmcnt(0)
v_mfma_f32_16x16x32_bf16 v[160:163], a[160:163], a[64:67], v[160:163]
s_waitcnt vmcnt(13)
v_mfma_f32_16x16x32_bf16 v[160:163], a[164:167], a[68:71], v[160:163]
s_barrier
v_mfma_f32_16x16x32_bf16 v[164:167], a[172:175], a[68:71], v[164:167]
s_xor_b32 s52, s6, 31
ds_read_b64_tr_b16 a[128:129], v11 offset:0
ds_read_b64_tr_b16 a[130:131], v11 offset:512
v_mfma_f32_16x16x32_bf16 v[164:167], a[168:171], a[64:67], v[164:167]
s_add_u32 m0, s73, 4096
s_add_u32 s64, s71, 524288
s_mul_i32 s52, s52, 110592
v_mfma_f32_16x16x32_bf16 v[168:171], a[176:179], a[64:67], v[168:171]
buffer_load_dwordx4 v5, s[8:11], s64 offen lds
v_mfma_f32_16x16x32_bf16 v[168:171], a[180:183], a[68:71], v[168:171]
s_mul_i32 s53, s3, 27648
s_add_u32 s52, s52, s53
s_mul_i32 s53, s7, 144
v_mfma_f32_16x16x32_bf16 v[172:175], a[188:191], a[68:71], v[172:175]
s_add_u32 s52, s52, s53
v_mfma_f32_16x16x32_bf16 v[172:175], a[184:187], a[64:67], v[172:175]
ds_read_b128 a[64:67], v9 offset:0
v_mfma_f32_16x16x32_bf16 v[188:191], a[184:187], a[72:75], v[188:191]
buffer_load_dwordx4 v6, s[8:11], s64 offen offset:1024 lds
v_mfma_f32_16x16x32_bf16 v[188:191], a[188:191], a[76:79], v[188:191]
ds_read_b64_tr_b16 a[132:133], v11 offset:8192
ds_read_b64_tr_b16 a[134:135], v11 offset:8704
v_mfma_f32_16x16x32_bf16 v[184:187], a[180:183], a[76:79], v[184:187]
buffer_load_dword a252, v28, s[28:31], s52 offen
v_mfma_f32_16x16x32_bf16 v[184:187], a[176:179], a[72:75], v[184:187]
s_add_u32 m0, s73, 6144
s_add_u32 s64, s71, 540672
ds_read_b128 a[68:71], v10 offset:0
v_mfma_f32_16x16x32_bf16 v[180:183], a[168:171], a[72:75], v[180:183]
v_mfma_f32_16x16x32_bf16 v[180:183], a[172:175], a[76:79], v[180:183]
buffer_load_dwordx4 v5, s[8:11], s64 offen lds
v_mfma_f32_16x16x32_bf16 v[176:179], a[164:167], a[76:79], v[176:179]
v_mfma_f32_16x16x32_bf16 v[176:179], a[160:163], a[72:75], v[176:179]
ds_read_b64_tr_b16 a[136:137], v12 offset:0
ds_read_b64_tr_b16 a[138:139], v12 offset:512
v_mfma_f32_16x16x32_bf16 v[192:195], a[160:163], a[80:83], v[192:195]
v_mfma_f32_16x16x32_bf16 v[192:195], a[164:167], a[84:87], v[192:195]
v_mfma_f32_16x16x32_bf16 v[196:199], a[172:175], a[84:87], v[196:199]
buffer_load_dwordx4 v6, s[8:11], s64 offen offset:1024 lds
v_mfma_f32_16x16x32_bf16 v[196:199], a[168:171], a[80:83], v[196:199]
ds_read_b128 a[72:75], v9 offset:2048
v_mfma_f32_16x16x32_bf16 v[200:203], a[176:179], a[80:83], v[200:203]
v_mfma_f32_16x16x32_bf16 v[200:203], a[180:183], a[84:87], v[200:203]
s_add_u32 m0, s77, 49152
s_add_u32 s64, s76, 0
v_mfma_f32_16x16x32_bf16 v[204:207], a[188:191], a[84:87], v[204:207]
ds_read_b64_tr_b16 a[140:141], v12 offset:8192
ds_read_b64_tr_b16 a[142:143], v12 offset:8704
v_mfma_f32_16x16x32_bf16 v[204:207], a[184:187], a[80:83], v[204:207]
buffer_load_dwordx4 v7, s[16:19], s64 offen lds
v_mfma_f32_16x16x32_bf16 v[220:223], a[184:187], a[88:91], v[220:223]
ds_read_b128 a[76:79], v10 offset:2048
v_mfma_f32_16x16x32_bf16 v[220:223], a[188:191], a[92:95], v[220:223]
v_mfma_f32_16x16x32_bf16 v[216:219], a[180:183], a[92:95], v[216:219]
v_mfma_f32_16x16x32_bf16 v[216:219], a[176:179], a[88:91], v[216:219]
v_mfma_f32_16x16x32_bf16 v[212:215], a[168:171], a[88:91], v[212:215]
buffer_load_dwordx4 v8, s[16:19], s64 offen offset:1024 lds
v_mfma_f32_16x16x32_bf16 v[212:215], a[172:175], a[92:95], v[212:215]
ds_read_b64_tr_b16 a[144:145], v13 offset:0
ds_read_b64_tr_b16 a[146:147], v13 offset:512
v_mfma_f32_16x16x32_bf16 v[208:211], a[164:167], a[92:95], v[208:211]
v_mfma_f32_16x16x32_bf16 v[208:211], a[160:163], a[88:91], v[208:211]
s_add_u32 m0, s77, 51200
s_add_u32 s64, s76, 131072
ds_read_b128 a[80:83], v9 offset:4096
v_mfma_f32_16x16x32_bf16 v[224:227], a[160:163], a[96:99], v[224:227]
v_mfma_f32_16x16x32_bf16 v[224:227], a[164:167], a[100:103], v[224:227]
buffer_load_dwordx4 v7, s[16:19], s64 offen lds
v_mfma_f32_16x16x32_bf16 v[228:231], a[172:175], a[100:103], v[228:231]
ds_read_b64_tr_b16 a[148:149], v13 offset:8192
ds_read_b64_tr_b16 a[150:151], v13 offset:8704
v_mfma_f32_16x16x32_bf16 v[228:231], a[168:171], a[96:99], v[228:231]
v_mfma_f32_16x16x32_bf16 v[232:235], a[176:179], a[96:99], v[232:235]
v_mfma_f32_16x16x32_bf16 v[232:235], a[180:183], a[100:103], v[232:235]
buffer_load_dwordx4 v8, s[16:19], s64 offen offset:1024 lds
v_mfma_f32_16x16x32_bf16 v[236:239], a[188:191], a[100:103], v[236:239]
s_xor_b32 s71, s70, 512
s_add_u32 s71, s68, s71
ds_read_b128 a[84:87], v10 offset:4096
v_mfma_f32_16x16x32_bf16 v[236:239], a[184:187], a[96:99], v[236:239]
v_mfma_f32_16x16x32_bf16 v[252:255], a[184:187], a[104:107], v[252:255]
s_add_u32 m0, s73, 32768
s_add_u32 s64, s71, 0
v_mfma_f32_16x16x32_bf16 v[252:255], a[188:191], a[108:111], v[252:255]
ds_read_b64_tr_b16 a[152:153], v14 offset:0
ds_read_b64_tr_b16 a[154:155], v14 offset:512
v_mfma_f32_16x16x32_bf16 v[248:251], a[180:183], a[108:111], v[248:251]
buffer_load_dwordx4 v5, s[8:11], s64 offen lds
v_mfma_f32_16x16x32_bf16 v[248:251], a[176:179], a[104:107], v[248:251]
v_mfma_f32_16x16x32_bf16 v[244:247], a[168:171], a[104:107], v[244:247]
ds_read_b128 a[88:91], v9 offset:6144
v_mfma_f32_16x16x32_bf16 v[244:247], a[172:175], a[108:111], v[244:247]
v_mfma_f32_16x16x32_bf16 v[240:243], a[164:167], a[108:111], v[240:243]
v_mfma_f32_16x16x32_bf16 v[240:243], a[160:163], a[104:107], v[240:243]
buffer_load_dwordx4 v6, s[8:11], s64 offen offset:1024 lds
v_mfma_f32_16x16x32_bf16 a[0:3], a[160:163], a[112:115], a[0:3]
ds_read_b64_tr_b16 a[156:157], v14 offset:8192
ds_read_b64_tr_b16 a[158:159], v14 offset:8704
v_mfma_f32_16x16x32_bf16 a[0:3], a[164:167], a[116:119], a[0:3]
v_mfma_f32_16x16x32_bf16 a[4:7], a[172:175], a[116:119], a[4:7]
s_add_u32 m0, s73, 34816
s_add_u32 s64, s71, 16384
ds_read_b128 a[92:95], v10 offset:6144
v_mfma_f32_16x16x32_bf16 a[4:7], a[168:171], a[112:115], a[4:7]
v_mfma_f32_16x16x32_bf16 a[8:11], a[176:179], a[112:115], a[8:11]
buffer_load_dwordx4 v5, s[8:11], s64 offen lds
v_mfma_f32_16x16x32_bf16 a[8:11], a[180:183], a[116:119], a[8:11]
v_mfma_f32_16x16x32_bf16 a[12:15], a[188:191], a[116:119], a[12:15]
v_mfma_f32_16x16x32_bf16 a[12:15], a[184:187], a[112:115], a[12:15]
v_mfma_f32_16x16x32_bf16 a[28:31], a[184:187], a[120:123], a[28:31]
v_mfma_f32_16x16x32_bf16 a[28:31], a[188:191], a[124:127], a[28:31]
buffer_load_dwordx4 v6, s[8:11], s64 offen offset:1024 lds
v_mfma_f32_16x16x32_bf16 a[24:27], a[180:183], a[124:127], a[24:27]
v_mfma_f32_16x16x32_bf16 a[24:27], a[176:179], a[120:123], a[24:27]
v_mfma_f32_16x16x32_bf16 a[20:23], a[168:171], a[120:123], a[20:23]
v_mfma_f32_16x16x32_bf16 a[20:23], a[172:175], a[124:127], a[20:23]
v_mfma_f32_16x16x32_bf16 a[16:19], a[164:167], a[124:127], a[16:19]
v_mfma_f32_16x16x32_bf16 a[16:19], a[160:163], a[120:123], a[16:19]
s_waitcnt lgkmcnt(0)
v_mfma_f32_16x16x32_bf16 v[32:35], a[64:67], a[128:131], v[32:35]
s_waitcnt vmcnt(22)
v_mfma_f32_16x16x32_bf16 v[32:35], a[68:71], a[132:135], v[32:35]
s_barrier
v_mfma_f32_16x16x32_bf16 v[40:43], a[68:71], a[140:143], v[40:43]
ds_read_b128 a[96:99], v9 offset:8192
v_mfma_f32_16x16x32_bf16 v[40:43], a[64:67], a[136:139], v[40:43]
s_xor_b32 s76, s75, 2097152
s_add_u32 s76, s74, s76
v_mfma_f32_16x16x32_bf16 v[48:51], a[64:67], a[144:147], v[48:51]
s_add_u32 m0, s77, 0
s_add_u32 s64, s76, 0
v_mfma_f32_16x16x32_bf16 v[48:51], a[68:71], a[148:151], v[48:51]
buffer_load_dwordx4 v7, s[56:59], s64 offen lds
v_mfma_f32_16x16x32_bf16 v[56:59], a[68:71], a[156:159], v[56:59]
ds_read_b128 a[100:103], v10 offset:8192
v_mfma_f32_16x16x32_bf16 v[56:59], a[64:67], a[152:155], v[56:59]
v_mfma_f32_16x16x32_bf16 v[60:63], a[72:75], a[152:155], v[60:63]
ds_read_b128 a[104:107], v9 offset:10240
v_mfma_f32_16x16x32_bf16 v[60:63], a[76:79], a[156:159], v[60:63]
v_mfma_f32_16x16x32_bf16 v[52:55], a[76:79], a[148:151], v[52:55]
v_mfma_f32_16x16x32_bf16 v[52:55], a[72:75], a[144:147], v[52:55]
buffer_load_dwordx4 v8, s[56:59], s64 offen offset:1024 lds
v_mfma_f32_16x16x32_bf16 v[44:47], a[72:75], a[136:139], v[44:47]
ds_read_b64_tr_b16 a[160:161], v11 offset:16384
ds_read_b64_tr_b16 a[162:163], v11 offset:16896
v_mfma_f32_16x16x32_bf16 v[44:47], a[76:79], a[140:143], v[44:47]
v_mfma_f32_16x16x32_bf16 v[36:39], a[76:79], a[132:135], v[36:39]
v_mfma_f32_16x16x32_bf16 v[36:39], a[72:75], a[128:131], v[36:39]
ds_read_b128 a[108:111], v10 offset:10240
v_mfma_f32_16x16x32_bf16 v[64:67], a[80:83], a[128:131], v[64:67]
s_add_u32 m0, s77, 2048
s_add_u32 s64, s76, 131072
v_mfma_f32_16x16x32_bf16 v[64:67], a[84:87], a[132:135], v[64:67]
v_mfma_f32_16x16x32_bf16 v[72:75], a[84:87], a[140:143], v[72:75]
buffer_load_dwordx4 v7, s[56:59], s64 offen lds
v_mfma_f32_16x16x32_bf16 v[72:75], a[80:83], a[136:139], v[72:75]
ds_read_b64_tr_b16 a[164:165], v11 offset:24576
ds_read_b64_tr_b16 a[166:167], v11 offset:25088
v_mfma_f32_16x16x32_bf16 v[80:83], a[80:83], a[144:147], v[80:83]
v_mfma_f32_16x16x32_bf16 v[80:83], a[84:87], a[148:151], v[80:83]
ds_read_b128 a[112:115], v9 offset:12288
v_mfma_f32_16x16x32_bf16 v[88:91], a[84:87], a[156:159], v[88:91]
v_mfma_f32_16x16x32_bf16 v[88:91], a[80:83], a[152:155], v[88:91]
v_mfma_f32_16x16x32_bf16 v[92:95], a[88:91], a[152:155], v[92:95]
ds_read_b64_tr_b16 a[168:169], v12 offset:16384
ds_read_b64_tr_b16 a[170:171], v12 offset:16896
v_mfma_f32_16x16x32_bf16 v[92:95], a[92:95], a[156:159], v[92:95]
buffer_load_dwordx4 v8, s[56:59], s64 offen offset:1024 lds
v_mfma_f32_16x16x32_bf16 v[84:87], a[92:95], a[148:151], v[84:87]
v_mfma_f32_16x16x32_bf16 v[84:87], a[88:91], a[144:147], v[84:87]
v_mfma_f32_16x16x32_bf16 v[76:79], a[88:91], a[136:139], v[76:79]
ds_read_b128 a[116:119], v10 offset:12288
v_mfma_f32_16x16x32_bf16 v[76:79], a[92:95], a[140:143], v[76:79]
v_mfma_f32_16x16x32_bf16 v[68:71], a[92:95], a[132:135], v[68:71]
v_mfma_f32_16x16x32_bf16 v[68:71], a[88:91], a[128:131], v[68:71]
s_add_u32 m0, s73, 36864
s_add_u32 s64, s71, 524288
s_waitcnt lgkmcnt(6)
v_mfma_f32_16x16x32_bf16 v[96:99], a[96:99], a[128:131], v[96:99]
ds_read_b64_tr_b16 a[172:173], v12 offset:24576
ds_read_b64_tr_b16 a[174:175], v12 offset:25088
v_mfma_f32_16x16x32_bf16 v[96:99], a[100:103], a[132:135], v[96:99]
buffer_load_dwordx4 v5, s[8:11], s64 offen lds
v_mfma_f32_16x16x32_bf16 v[104:107], a[100:103], a[140:143], v[104:107]
ds_read_b128 a[120:123], v9 offset:14336
v_mfma_f32_16x16x32_bf16 v[104:107], a[96:99], a[136:139], v[104:107]
v_mfma_f32_16x16x32_bf16 v[112:115], a[96:99], a[144:147], v[112:115]
v_mfma_f32_16x16x32_bf16 v[112:115], a[100:103], a[148:151], v[112:115]
ds_read_b64_tr_b16 a[176:177], v13 offset:16384
ds_read_b64_tr_b16 a[178:179], v13 offset:16896
v_mfma_f32_16x16x32_bf16 v[120:123], a[100:103], a[156:159], v[120:123]
v_mfma_f32_16x16x32_bf16 v[120:123], a[96:99], a[152:155], v[120:123]
v_mfma_f32_16x16x32_bf16 v[124:127], a[104:107], a[152:155], v[124:127]
buffer_load_dwordx4 v6, s[8:11], s64 offen offset:1024 lds
v_mfma_f32_16x16x32_bf16 v[124:127], a[108:111], a[156:159], v[124:127]
ds_read_b128 a[124:127], v10 offset:14336
v_mfma_f32_16x16x32_bf16 v[116:119], a[108:111], a[148:151], v[116:119]
v_add_u32 v9, -65536, v9
v_add_u32 v10, -65536, v10
v_mfma_f32_16x16x32_bf16 v[116:119], a[104:107], a[144:147], v[116:119]
v_mfma_f32_16x16x32_bf16 v[108:111], a[104:107], a[136:139], v[108:111]
ds_read_b64_tr_b16 a[180:181], v13 offset:24576
ds_read_b64_tr_b16 a[182:183], v13 offset:25088
v_mfma_f32_16x16x32_bf16 v[108:111], a[108:111], a[140:143], v[108:111]
s_add_u32 m0, s73, 38912
s_add_u32 s64, s71, 540672
v_mfma_f32_16x16x32_bf16 v[100:103], a[108:111], a[132:135], v[100:103]
s_waitcnt lgkmcnt(2)
v_mfma_f32_16x16x32_bf16 v[100:103], a[104:107], a[128:131], v[100:103]
buffer_load_dwordx4 v5, s[8:11], s64 offen lds
v_mfma_f32_16x16x32_bf16 v[128:131], a[112:115], a[128:131], v[128:131]
ds_read_b64_tr_b16 a[184:185], v14 offset:16384
ds_read_b64_tr_b16 a[186:187], v14 offset:16896
v_mfma_f32_16x16x32_bf16 v[128:131], a[116:119], a[132:135], v[128:131]
v_mfma_f32_16x16x32_bf16 v[136:139], a[116:119], a[140:143], v[136:139]
ds_read_b64_tr_b16 a[188:189], v14 offset:24576
ds_read_b64_tr_b16 a[190:191], v14 offset:25088
v_mfma_f32_16x16x32_bf16 v[136:139], a[112:115], a[136:139], v[136:139]
v_mfma_f32_16x16x32_bf16 v[144:147], a[112:115], a[144:147], v[144:147]
v_mfma_f32_16x16x32_bf16 v[144:147], a[116:119], a[148:151], v[144:147]
v_mfma_f32_16x16x32_bf16 v[152:155], a[116:119], a[156:159], v[152:155]
buffer_load_dwordx4 v6, s[8:11], s64 offen offset:1024 lds
v_mfma_f32_16x16x32_bf16 v[152:155], a[112:115], a[152:155], v[152:155]
L_PAD1:
s_cbranch_execz L_PAD5
v_mfma_f32_16x16x32_bf16 v[156:159], a[120:123], a[152:155], v[156:159]
v_mfma_f32_16x16x32_bf16 v[156:159], a[124:127], a[156:159], v[156:159]
v_mfma_f32_16x16x32_bf16 v[148:151], a[124:127], a[148:151], v[148:151]
v_mfma_f32_16x16x32_bf16 v[148:151], a[120:123], a[144:147], v[148:151]
v_mfma_f32_16x16x32_bf16 v[140:143], a[120:123], a[136:139], v[140:143]
v_mfma_f32_16x16x32_bf16 v[140:143], a[124:127], a[140:143], v[140:143]
v_mfma_f32_16x16x32_bf16 v[132:135], a[124:127], a[132:135], v[132:135]
v_mfma_f32_16x16x32_bf16 v[132:135], a[120:123], a[128:131], v[132:135]
s_waitcnt lgkmcnt(0)
v_mfma_f32_16x16x32_bf16 v[160:163], a[160:163], a[64:67], v[160:163]
s_waitcnt vmcnt(16)
v_mfma_f32_16x16x32_bf16 v[160:163], a[164:167], a[68:71], v[160:163]
s_barrier
v_mfma_f32_16x16x32_bf16 v[164:167], a[172:175], a[68:71], v[164:167]
s_add_u32 s52, s81, 0
ds_read_b64_tr_b16 a[128:129], v11 offset:32768
ds_read_b64_tr_b16 a[130:131], v11 offset:33280
v_mfma_f32_16x16x32_bf16 v[164:167], a[168:171], a[64:67], v[164:167]
s_add_u32 m0, s77, 16384
s_add_u32 s64, s76, 0
v_mfma_f32_16x16x32_bf16 v[168:171], a[176:179], a[64:67], v[168:171]
buffer_load_dwordx4 v7, s[16:19], s64 offen lds
v_mfma_f32_16x16x32_bf16 v[168:171], a[180:183], a[68:71], v[168:171]
buffer_load_dwordx2 a[192:193], v26, s[28:31], s52 offen
v_mfma_f32_16x16x32_bf16 v[172:175], a[188:191], a[68:71], v[172:175]
v_mfma_f32_16x16x32_bf16 v[172:175], a[184:187], a[64:67], v[172:175]
ds_read_b128 a[64:67], v9 offset:0
v_mfma_f32_16x16x32_bf16 v[188:191], a[184:187], a[72:75], v[188:191]
ds_read_b64_tr_b16 a[132:133], v11 offset:40960
ds_read_b64_tr_b16 a[134:135], v11 offset:41472
v_mfma_f32_16x16x32_bf16 v[188:191], a[188:191], a[76:79], v[188:191]
v_mfma_f32_16x16x32_bf16 v[184:187], a[180:183], a[76:79], v[184:187]
s_add_u32 s52, s81, 3456
v_mfma_f32_16x16x32_bf16 v[184:187], a[176:179], a[72:75], v[184:187]
buffer_load_dwordx4 v8, s[16:19], s64 offen offset:1024 lds
v_mfma_f32_16x16x32_bf16 v[180:183], a[168:171], a[72:75], v[180:183]
ds_read_b128 a[68:71], v10 offset:0
v_mfma_f32_16x16x32_bf16 v[180:183], a[172:175], a[76:79], v[180:183]
buffer_load_dwordx2 a[194:195], v26, s[28:31], s52 offen
v_mfma_f32_16x16x32_bf16 v[176:179], a[164:167], a[76:79], v[176:179]
v_mfma_f32_16x16x32_bf16 v[176:179], a[160:163], a[72:75], v[176:179]
ds_read_b64_tr_b16 a[136:137], v12 offset:32768
ds_read_b64_tr_b16 a[138:139], v12 offset:33280
v_mfma_f32_16x16x32_bf16 v[192:195], a[160:163], a[80:83], v[192:195]
s_add_u32 m0, s77, 18432
s_add_u32 s64, s76, 131072
v_mfma_f32_16x16x32_bf16 v[192:195], a[164:167], a[84:87], v[192:195]
v_mfma_f32_16x16x32_bf16 v[196:199], a[172:175], a[84:87], v[196:199]
buffer_load_dwordx4 v7, s[16:19], s64 offen lds
v_mfma_f32_16x16x32_bf16 v[196:199], a[168:171], a[80:83], v[196:199]
s_add_u32 s52, s81, 6912
ds_read_b128 a[72:75], v9 offset:2048
v_mfma_f32_16x16x32_bf16 v[200:203], a[176:179], a[80:83], v[200:203]
buffer_load_dwordx2 a[196:197], v26, s[28:31], s52 offen
v_mfma_f32_16x16x32_bf16 v[200:203], a[180:183], a[84:87], v[200:203]
ds_read_b64_tr_b16 a[140:141], v12 offset:40960
ds_read_b64_tr_b16 a[142:143], v12 offset:41472
v_mfma_f32_16x16x32_bf16 v[204:207], a[188:191], a[84:87], v[204:207]
v_mfma_f32_16x16x32_bf16 v[204:207], a[184:187], a[80:83], v[204:207]
v_mfma_f32_16x16x32_bf16 v[220:223], a[184:187], a[88:91], v[220:223]
ds_read_b128 a[76:79], v10 offset:2048
v_mfma_f32_16x16x32_bf16 v[220:223], a[188:191], a[92:95], v[220:223]
buffer_load_dwordx4 v8, s[16:19], s64 offen offset:1024 lds
v_mfma_f32_16x16x32_bf16 v[216:219], a[180:183], a[92:95], v[216:219]
s_xor_b32 s71, s70, 640
s_add_u32 s71, s68, s71
s_add_u32 s52, s81, 10368
v_mfma_f32_16x16x32_bf16 v[216:219], a[176:179], a[88:91], v[216:219]
buffer_load_dwordx2 a[198:199], v26, s[28:31], s52 offen
v_mfma_f32_16x16x32_bf16 v[212:215], a[168:171], a[88:91], v[212:215]
ds_read_b64_tr_b16 a[144:145], v13 offset:32768
ds_read_b64_tr_b16 a[146:147], v13 offset:33280
v_mfma_f32_16x16x32_bf16 v[212:215], a[172:175], a[92:95], v[212:215]
v_mfma_f32_16x16x32_bf16 v[208:211], a[164:167], a[92:95], v[208:211]
v_mfma_f32_16x16x32_bf16 v[208:211], a[160:163], a[88:91], v[208:211]
s_add_u32 m0, s73, 65536
s_add_u32 s64, s71, 0
ds_read_b128 a[80:83], v9 offset:4096
v_mfma_f32_16x16x32_bf16 v[224:227], a[160:163], a[96:99], v[224:227]
s_add_u32 s52, s81, 13824
v_mfma_f32_16x16x32_bf16 v[224:227], a[164:167], a[100:103], v[224:227]
buffer_load_dwordx4 v5, s[8:11], s64 offen lds
v_mfma_f32_16x16x32_bf16 v[228:231], a[172:175], a[100:103], v[228:231]
ds_read_b64_tr_b16 a[148:149], v13 offset:40960
ds_read_b64_tr_b16 a[150:151], v13 offset:41472
v_mfma_f32_16x16x32_bf16 v[228:231], a[168:171], a[96:99], v[228:231]
buffer_load_dwordx2 a[200:201], v26, s[28:31], s52 offen
v_mfma_f32_16x16x32_bf16 v[232:235], a[176:179], a[96:99], v[232:235]
v_mfma_f32_16x16x32_bf16 v[232:235], a[180:183], a[100:103], v[232:235]
ds_read_b128 a[84:87], v10 offset:4096
v_mfma_f32_16x16x32_bf16 v[236:239], a[188:191], a[100:103], v[236:239]
v_mfma_f32_16x16x32_bf16 v[236:239], a[184:187], a[96:99], v[236:239]
v_mfma_f32_16x16x32_bf16 v[252:255], a[184:187], a[104:107], v[252:255]
buffer_load_dwordx4 v6, s[8:11], s64 offen offset:1024 lds
v_mfma_f32_16x16x32_bf16 v[252:255], a[188:191], a[108:111], v[252:255]
s_add_u32 s52, s81, 17280
ds_read_b64_tr_b16 a[152:153], v14 offset:32768
ds_read_b64_tr_b16 a[154:155], v14 offset:33280
v_mfma_f32_16x16x32_bf16 v[248:251], a[180:183], a[108:111], v[248:251]
buffer_load_dwordx2 a[202:203], v26, s[28:31], s52 offen
v_mfma_f32_16x16x32_bf16 v[248:251], a[176:179], a[104:107], v[248:251]
v_mfma_f32_16x16x32_bf16 v[244:247], a[168:171], a[104:107], v[244:247]
ds_read_b128 a[88:91], v9 offset:6144
v_mfma_f32_16x16x32_bf16 v[244:247], a[172:175], a[108:111], v[244:247]
s_add_u32 m0, s73, 67584
s_add_u32 s64, s71, 16384
v_mfma_f32_16x16x32_bf16 v[240:243], a[164:167], a[108:111], v[240:243]
v_mfma_f32_16x16x32_bf16 v[240:243], a[160:163], a[104:107], v[240:243]
buffer_load_dwordx4 v5, s[8:11], s64 offen lds
v_mfma_f32_16x16x32_bf16 a[0:3], a[160:163], a[112:115], a[0:3]
s_add_u32 s52, s81, 20736
ds_read_b64_tr_b16 a[156:157], v14 offset:40960
ds_read_b64_tr_b16 a[158:159], v14 offset:41472
v_mfma_f32_16x16x32_bf16 a[0:3], a[164:167], a[116:119], a[0:3]
buffer_load_dwordx2 a[204:205], v26, s[28:31], s52 offen
v_mfma_f32_16x16x32_bf16 a[4:7], a[172:175], a[116:119], a[4:7]
ds_read_b128 a[92:95], v10 offset:6144
v_mfma_f32_16x16x32_bf16 a[4:7], a[168:171], a[112:115], a[4:7]
v_mfma_f32_16x16x32_bf16 a[8:11], a[176:179], a[112:115], a[8:11]
v_mfma_f32_16x16x32_bf16 a[8:11], a[180:183], a[116:119], a[8:11]
v_mfma_f32_16x16x32_bf16 a[12:15], a[188:191], a[116:119], a[12:15]
buffer_load_dwordx4 v6, s[8:11], s64 offen offset:1024 lds
v_mfma_f32_16x16x32_bf16 a[12:15], a[184:187], a[112:115], a[12:15]
s_add_u32 s52, s81, 24192
v_mfma_f32_16x16x32_bf16 a[28:31], a[184:187], a[120:123], a[28:31]
buffer_load_dwordx2 a[206:207], v26, s[28:31], s52 offen
v_mfma_f32_16x16x32_bf16 a[28:31], a[188:191], a[124:127], a[28:31]
v_mfma_f32_16x16x32_bf16 a[24:27], a[180:183], a[124:127], a[24:27]
v_mfma_f32_16x16x32_bf16 a[24:27], a[176:179], a[120:123], a[24:27]
v_mfma_f32_16x16x32_bf16 a[20:23], a[168:171], a[120:123], a[20:23]
v_mfma_f32_16x16x32_bf16 a[20:23], a[172:175], a[124:127], a[20:23]
buffer_load_dwordx4 a[208:211], v27, s[36:39], s83 offen
v_mfma_f32_16x16x32_bf16 a[16:19], a[164:167], a[124:127], a[16:19]
v_mfma_f32_16x16x32_bf16 a[16:19], a[160:163], a[120:123], a[16:19]
s_waitcnt lgkmcnt(0)
v_mfma_f32_16x16x32_bf16 v[32:35], a[64:67], a[128:131], v[32:35]
s_waitcnt vmcnt(29)
v_mfma_f32_16x16x32_bf16 v[32:35], a[68:71], a[132:135], v[32:35]
s_barrier
v_mfma_f32_16x16x32_bf16 v[40:43], a[68:71], a[140:143], v[40:43]
ds_read_b128 a[96:99], v9 offset:8192
v_mfma_f32_16x16x32_bf16 v[40:43], a[64:67], a[136:139], v[40:43]
s_xor_b32 s76, s75, 2621440
s_add_u32 s76, s74, s76
v_mfma_f32_16x16x32_bf16 v[48:51], a[64:67], a[144:147], v[48:51]
s_add_u32 m0, s77, 32768
s_add_u32 s64, s76, 0
v_mfma_f32_16x16x32_bf16 v[48:51], a[68:71], a[148:151], v[48:51]
buffer_load_dwordx4 v7, s[56:59], s64 offen lds
v_mfma_f32_16x16x32_bf16 v[56:59], a[68:71], a[156:159], v[56:59]
ds_read_b128 a[100:103], v10 offset:8192
v_mfma_f32_16x16x32_bf16 v[56:59], a[64:67], a[152:155], v[56:59]
v_mfma_f32_16x16x32_bf16 v[60:63], a[72:75], a[152:155], v[60:63]
ds_read_b128 a[104:107], v9 offset:10240
v_mfma_f32_16x16x32_bf16 v[60:63], a[76:79], a[156:159], v[60:63]
v_mfma_f32_16x16x32_bf16 v[52:55], a[76:79], a[148:151], v[52:55]
v_mfma_f32_16x16x32_bf16 v[52:55], a[72:75], a[144:147], v[52:55]
buffer_load_dwordx4 v8, s[56:59], s64 offen offset:1024 lds
v_mfma_f32_16x16x32_bf16 v[44:47], a[72:75], a[136:139], v[44:47]
ds_read_b64_tr_b16 a[160:161], v11 offset:49152
ds_read_b64_tr_b16 a[162:163], v11 offset:49664
v_mfma_f32_16x16x32_bf16 v[44:47], a[76:79], a[140:143], v[44:47]
v_mfma_f32_16x16x32_bf16 v[36:39], a[76:79], a[132:135], v[36:39]
v_mfma_f32_16x16x32_bf16 v[36:39], a[72:75], a[128:131], v[36:39]
ds_read_b128 a[108:111], v10 offset:10240
v_mfma_f32_16x16x32_bf16 v[64:67], a[80:83], a[128:131], v[64:67]
s_add_u32 m0, s77, 34816
s_add_u32 s64, s76, 131072
v_mfma_f32_16x16x32_bf16 v[64:67], a[84:87], a[132:135], v[64:67]
v_mfma_f32_16x16x32_bf16 v[72:75], a[84:87], a[140:143], v[72:75]
buffer_load_dwordx4 v7, s[56:59], s64 offen lds
v_mfma_f32_16x16x32_bf16 v[72:75], a[80:83], a[136:139], v[72:75]
ds_read_b64_tr_b16 a[164:165], v11 offset:57344
ds_read_b64_tr_b16 a[166:167], v11 offset:57856
v_mfma_f32_16x16x32_bf16 v[80:83], a[80:83], a[144:147], v[80:83]
v_mfma_f32_16x16x32_bf16 v[80:83], a[84:87], a[148:151], v[80:83]
ds_read_b128 a[112:115], v9 offset:12288
v_mfma_f32_16x16x32_bf16 v[88:91], a[84:87], a[156:159], v[88:91]
v_mfma_f32_16x16x32_bf16 v[88:91], a[80:83], a[152:155], v[88:91]
v_mfma_f32_16x16x32_bf16 v[92:95], a[88:91], a[152:155], v[92:95]
ds_read_b64_tr_b16 a[168:169], v12 offset:49152
ds_read_b64_tr_b16 a[170:171], v12 offset:49664
v_mfma_f32_16x16x32_bf16 v[92:95], a[92:95], a[156:159], v[92:95]
buffer_load_dwordx4 v8, s[56:59], s64 offen offset:1024 lds
v_mfma_f32_16x16x32_bf16 v[84:87], a[92:95], a[148:151], v[84:87]
v_mfma_f32_16x16x32_bf16 v[84:87], a[88:91], a[144:147], v[84:87]
v_mfma_f32_16x16x32_bf16 v[76:79], a[88:91], a[136:139], v[76:79]
ds_read_b128 a[116:119], v10 offset:12288
v_mfma_f32_16x16x32_bf16 v[76:79], a[92:95], a[140:143], v[76:79]
v_mfma_f32_16x16x32_bf16 v[68:71], a[92:95], a[132:135], v[68:71]
v_mfma_f32_16x16x32_bf16 v[68:71], a[88:91], a[128:131], v[68:71]
s_add_u32 m0, s73, 69632
s_add_u32 s64, s71, 524288
s_waitcnt lgkmcnt(6)
v_mfma_f32_16x16x32_bf16 v[96:99], a[96:99], a[128:131], v[96:99]
ds_read_b64_tr_b16 a[172:173], v12 offset:57344
ds_read_b64_tr_b16 a[174:175], v12 offset:57856
v_mfma_f32_16x16x32_bf16 v[96:99], a[100:103], a[132:135], v[96:99]
buffer_load_dwordx4 v5, s[8:11], s64 offen lds
v_mfma_f32_16x16x32_bf16 v[104:107], a[100:103], a[140:143], v[104:107]
ds_read_b128 a[120:123], v9 offset:14336
v_mfma_f32_16x16x32_bf16 v[104:107], a[96:99], a[136:139], v[104:107]
v_mfma_f32_16x16x32_bf16 v[112:115], a[96:99], a[144:147], v[112:115]
v_mfma_f32_16x16x32_bf16 v[112:115], a[100:103], a[148:151], v[112:115]
s_waitcnt vmcnt(5)
ds_read_b64_tr_b16 a[176:177], v13 offset:49152
ds_read_b64_tr_b16 a[178:179], v13 offset:49664
v_mfma_f32_16x16x32_bf16 v[120:123], a[100:103], a[156:159], v[120:123]
v_accvgpr_read_b32 v16, a192
v_accvgpr_read_b32 v17, a194
v_mfma_f32_16x16x32_bf16 v[120:123], a[96:99], a[152:155], v[120:123]
v_accvgpr_read_b32 v18, a196
v_accvgpr_read_b32 v19, a198
v_mfma_f32_16x16x32_bf16 v[124:127], a[104:107], a[152:155], v[124:127]
buffer_load_dwordx4 v6, s[8:11], s64 offen offset:1024 lds
v_mfma_f32_16x16x32_bf16 v[124:127], a[108:111], a[156:159], v[124:127]
ds_read_b128 a[124:127], v10 offset:14336
v_accvgpr_read_b32 v20, a200
v_mfma_f32_16x16x32_bf16 v[116:119], a[108:111], a[148:151], v[116:119]
v_add_u32 v9, 32768, v9
v_add_u32 v10, 32768, v10
v_mfma_f32_16x16x32_bf16 v[116:119], a[104:107], a[144:147], v[116:119]
v_accvgpr_read_b32 v21, a202
v_accvgpr_read_b32 v22, a204
v_mfma_f32_16x16x32_bf16 v[108:111], a[104:107], a[136:139], v[108:111]
ds_read_b64_tr_b16 a[180:181], v13 offset:57344
ds_read_b64_tr_b16 a[182:183], v13 offset:57856
v_mfma_f32_16x16x32_bf16 v[108:111], a[108:111], a[140:143], v[108:111]
s_add_u32 m0, s73, 71680
s_add_u32 s64, s71, 540672
v_accvgpr_read_b32 v23, a206
v_mfma_f32_16x16x32_bf16 v[100:103], a[108:111], a[132:135], v[100:103]
s_waitcnt lgkmcnt(2)
v_mfma_f32_16x16x32_bf16 v[100:103], a[104:107], a[128:131], v[100:103]
buffer_load_dwordx4 v5, s[8:11], s64 offen lds
v_mfma_f32_16x16x32_bf16 v[128:131], a[112:115], a[128:131], v[128:131]
ds_read_b64_tr_b16 a[184:185], v14 offset:49152
ds_read_b64_tr_b16 a[186:187], v14 offset:49664
v_mfma_f32_16x16x32_bf16 v[128:131], a[116:119], a[132:135], v[128:131]
v_perm_b32 v24, v17, v16, s85
v_perm_b32 v25, v19, v18, s85
v_mfma_f32_16x16x32_bf16 v[136:139], a[116:119], a[140:143], v[136:139]
ds_read_b64_tr_b16 a[188:189], v14 offset:57344
ds_read_b64_tr_b16 a[190:191], v14 offset:57856
v_mfma_f32_16x16x32_bf16 v[136:139], a[112:115], a[136:139], v[136:139]
v_perm_b32 v26, v21, v20, s85
v_perm_b32 v27, v23, v22, s85
v_mfma_f32_16x16x32_bf16 v[144:147], a[112:115], a[144:147], v[144:147]
v_perm_b32 v28, v17, v16, s86
v_perm_b32 v29, v19, v18, s86
v_mfma_f32_16x16x32_bf16 v[144:147], a[116:119], a[148:151], v[144:147]
v_perm_b32 v30, v21, v20, s86
v_perm_b32 v31, v23, v22, s86
v_mfma_f32_16x16x32_bf16 v[152:155], a[116:119], a[156:159], v[152:155]
buffer_load_dwordx4 v6, s[8:11], s64 offen offset:1024 lds
v_mfma_f32_16x16x32_bf16 v[152:155], a[112:115], a[152:155], v[152:155]
v_accvgpr_read_b32 v16, a208
v_accvgpr_read_b32 v17, a209
v_mfma_f32_16x16x32_bf16 v[156:159], a[120:123], a[152:155], v[156:159]
v_accvgpr_read_b32 v18, a210
v_accvgpr_read_b32 v19, a211
v_mfma_f32_16x16x32_bf16 v[156:159], a[124:127], a[156:159], v[156:159]
v_or_b32 v24, v24, v16
v_or_b32 v25, v25, v17
v_mfma_f32_16x16x32_bf16 v[148:151], a[124:127], a[148:151], v[148:151]
v_or_b32 v26, v26, v18
v_or_b32 v27, v27, v19
v_mfma_f32_16x16x32_bf16 v[148:151], a[120:123], a[144:147], v[148:151]
buffer_store_dwordx4 v[24:27], v4, s[24:27], s82 offen offset:0 sc1
v_mfma_f32_16x16x32_bf16 v[140:143], a[120:123], a[136:139], v[140:143]
v_mfma_f32_16x16x32_bf16 v[140:143], a[124:127], a[140:143], v[140:143]
v_mfma_f32_16x16x32_bf16 v[132:135], a[124:127], a[132:135], v[132:135]
v_mfma_f32_16x16x32_bf16 v[132:135], a[120:123], a[128:131], v[132:135]
s_waitcnt lgkmcnt(0)
v_mfma_f32_16x16x32_bf16 v[160:163], a[160:163], a[64:67], v[160:163]
s_waitcnt vmcnt(26)
v_mfma_f32_16x16x32_bf16 v[160:163], a[164:167], a[68:71], v[160:163]
s_barrier
v_mfma_f32_16x16x32_bf16 v[164:167], a[172:175], a[68:71], v[164:167]
ds_read_b64_tr_b16 a[128:129], v11 offset:0
ds_read_b64_tr_b16 a[130:131], v11 offset:512
v_mfma_f32_16x16x32_bf16 v[164:167], a[168:171], a[64:67], v[164:167]
s_add_u32 m0, s77, 49152
s_add_u32 s64, s76, 0
v_mfma_f32_16x16x32_bf16 v[168:171], a[176:179], a[64:67], v[168:171]
buffer_load_dwordx4 v7, s[16:19], s64 offen lds
v_mfma_f32_16x16x32_bf16 v[168:171], a[180:183], a[68:71], v[168:171]
buffer_store_dwordx4 v[28:31], v4, s[24:27], s82 offen offset:1024 sc1
v_mfma_f32_16x16x32_bf16 v[172:175], a[188:191], a[68:71], v[172:175]
v_accvgpr_read_b32 v16, a193
v_accvgpr_read_b32 v17, a195
v_mfma_f32_16x16x32_bf16 v[172:175], a[184:187], a[64:67], v[172:175]
ds_read_b128 a[64:67], v9 offset:0
v_accvgpr_read_b32 v18, a197
v_mfma_f32_16x16x32_bf16 v[188:191], a[184:187], a[72:75], v[188:191]
ds_read_b64_tr_b16 a[132:133], v11 offset:8192
ds_read_b64_tr_b16 a[134:135], v11 offset:8704
v_mfma_f32_16x16x32_bf16 v[188:191], a[188:191], a[76:79], v[188:191]
v_accvgpr_read_b32 v19, a199
v_accvgpr_read_b32 v20, a201
v_mfma_f32_16x16x32_bf16 v[184:187], a[180:183], a[76:79], v[184:187]
v_accvgpr_read_b32 v21, a203
v_accvgpr_read_b32 v22, a205
v_mfma_f32_16x16x32_bf16 v[184:187], a[176:179], a[72:75], v[184:187]
buffer_load_dwordx4 v8, s[16:19], s64 offen offset:1024 lds
v_mfma_f32_16x16x32_bf16 v[180:183], a[168:171], a[72:75], v[180:183]
ds_read_b128 a[68:71], v10 offset:0
v_accvgpr_read_b32 v23, a207
v_mfma_f32_16x16x32_bf16 v[180:183], a[172:175], a[76:79], v[180:183]
v_mfma_f32_16x16x32_bf16 v[176:179], a[164:167], a[76:79], v[176:179]
v_perm_b32 v24, v17, v16, s85
v_perm_b32 v25, v19, v18, s85
v_mfma_f32_16x16x32_bf16 v[176:179], a[160:163], a[72:75], v[176:179]
ds_read_b64_tr_b16 a[136:137], v12 offset:0
ds_read_b64_tr_b16 a[138:139], v12 offset:512
v_mfma_f32_16x16x32_bf16 v[192:195], a[160:163], a[80:83], v[192:195]
s_add_u32 m0, s77, 51200
s_add_u32 s64, s76, 131072
v_perm_b32 v26, v21, v20, s85
v_mfma_f32_16x16x32_bf16 v[192:195], a[164:167], a[84:87], v[192:195]
v_perm_b32 v27, v23, v22, s85
v_perm_b32 v28, v17, v16, s86
v_mfma_f32_16x16x32_bf16 v[196:199], a[172:175], a[84:87], v[196:199]
buffer_load_dwordx4 v7, s[16:19], s64 offen lds
v_mfma_f32_16x16x32_bf16 v[196:199], a[168:171], a[80:83], v[196:199]
ds_read_b128 a[72:75], v9 offset:2048
v_perm_b32 v29, v19, v18, s86
v_mfma_f32_16x16x32_bf16 v[200:203], a[176:179], a[80:83], v[200:203]
v_perm_b32 v30, v21, v20, s86
v_perm_b32 v31, v23, v22, s86
v_mfma_f32_16x16x32_bf16 v[200:203], a[180:183], a[84:87], v[200:203]
ds_read_b64_tr_b16 a[140:141], v12 offset:8192
ds_read_b64_tr_b16 a[142:143], v12 offset:8704
v_mfma_f32_16x16x32_bf16 v[204:207], a[188:191], a[84:87], v[204:207]
buffer_store_dwordx4 v[24:27], v4, s[24:27], s82 offen offset:2048 sc1
v_mfma_f32_16x16x32_bf16 v[204:207], a[184:187], a[80:83], v[204:207]
v_mfma_f32_16x16x32_bf16 v[220:223], a[184:187], a[88:91], v[220:223]
ds_read_b128 a[76:79], v10 offset:2048
v_mfma_f32_16x16x32_bf16 v[220:223], a[188:191], a[92:95], v[220:223]
buffer_load_dwordx4 v8, s[16:19], s64 offen offset:1024 lds
v_mfma_f32_16x16x32_bf16 v[216:219], a[180:183], a[92:95], v[216:219]
s_xor_b32 s71, s70, 768
s_add_u32 s71, s68, s71
v_mfma_f32_16x16x32_bf16 v[216:219], a[176:179], a[88:91], v[216:219]
v_mfma_f32_16x16x32_bf16 v[212:215], a[168:171], a[88:91], v[212:215]
ds_read_b64_tr_b16 a[144:145], v13 offset:0
ds_read_b64_tr_b16 a[146:147], v13 offset:512
v_mfma_f32_16x16x32_bf16 v[212:215], a[172:175], a[92:95], v[212:215]
buffer_store_dwordx4 v[28:31], v4, s[24:27], s82 offen offset:3072 sc1
v_mfma_f32_16x16x32_bf16 v[208:211], a[164:167], a[92:95], v[208:211]
s_lshl_b32 s52, s7, 4
v_and_b32 v22, 3, v1
v_lshl_add_u32 v22, v22, 2, s52
v_mfma_f32_16x16x32_bf16 v[208:211], a[160:163], a[88:91], v[208:211]
s_add_u32 m0, s73, 0
s_add_u32 s64, s71, 0
ds_read_b128 a[80:83], v9 offset:4096
v_mfma_f32_16x16x32_bf16 v[224:227], a[160:163], a[96:99], v[224:227]
buffer_load_dword v23, v22, s[40:43], 0 offen sc1
v_mfma_f32_16x16x32_bf16 v[224:227], a[164:167], a[100:103], v[224:227]
buffer_load_dwordx4 v5, s[8:11], s64 offen lds
v_mfma_f32_16x16x32_bf16 v[228:231], a[172:175], a[100:103], v[228:231]
ds_read_b64_tr_b16 a[148:149], v13 offset:8192
ds_read_b64_tr_b16 a[150:151], v13 offset:8704
v_mfma_f32_16x16x32_bf16 v[228:231], a[168:171], a[96:99], v[228:231]
v_mfma_f32_16x16x32_bf16 v[232:235], a[176:179], a[96:99], v[232:235]
v_mfma_f32_16x16x32_bf16 v[232:235], a[180:183], a[100:103], v[232:235]
ds_read_b128 a[84:87], v10 offset:4096
v_mfma_f32_16x16x32_bf16 v[236:239], a[188:191], a[100:103], v[236:239]
v_mfma_f32_16x16x32_bf16 v[236:239], a[184:187], a[96:99], v[236:239]
v_mfma_f32_16x16x32_bf16 v[252:255], a[184:187], a[104:107], v[252:255]
buffer_load_dwordx4 v6, s[8:11], s64 offen offset:1024 lds
v_mfma_f32_16x16x32_bf16 v[252:255], a[188:191], a[108:111], v[252:255]
ds_read_b64_tr_b16 a[152:153], v14 offset:0
ds_read_b64_tr_b16 a[154:155], v14 offset:512
v_mfma_f32_16x16x32_bf16 v[248:251], a[180:183], a[108:111], v[248:251]
v_mfma_f32_16x16x32_bf16 v[248:251], a[176:179], a[104:107], v[248:251]
v_mfma_f32_16x16x32_bf16 v[244:247], a[168:171], a[104:107], v[244:247]
ds_read_b128 a[88:91], v9 offset:6144
v_mfma_f32_16x16x32_bf16 v[244:247], a[172:175], a[108:111], v[244:247]
s_add_u32 m0, s73, 2048
s_add_u32 s64, s71, 16384
v_mfma_f32_16x16x32_bf16 v[240:243], a[164:167], a[108:111], v[240:243]
v_mfma_f32_16x16x32_bf16 v[240:243], a[160:163], a[104:107], v[240:243]
buffer_load_dwordx4 v5, s[8:11], s64 offen lds
v_mfma_f32_16x16x32_bf16 a[0:3], a[160:163], a[112:115], a[0:3]
ds_read_b64_tr_b16 a[156:157], v14 offset:8192
ds_read_b64_tr_b16 a[158:159], v14 offset:8704
v_mfma_f32_16x16x32_bf16 a[0:3], a[164:167], a[116:119], a[0:3]
v_mfma_f32_16x16x32_bf16 a[4:7], a[172:175], a[116:119], a[4:7]
ds_read_b128 a[92:95], v10 offset:6144
v_mfma_f32_16x16x32_bf16 a[4:7], a[168:171], a[112:115], a[4:7]
v_mfma_f32_16x16x32_bf16 a[8:11], a[176:179], a[112:115], a[8:11]
v_mfma_f32_16x16x32_bf16 a[8:11], a[180:183], a[116:119], a[8:11]
v_mfma_f32_16x16x32_bf16 a[12:15], a[188:191], a[116:119], a[12:15]
buffer_load_dwordx4 v6, s[8:11], s64 offen offset:1024 lds
v_mfma_f32_16x16x32_bf16 a[12:15], a[184:187], a[112:115], a[12:15]
v_mfma_f32_16x16x32_bf16 a[28:31], a[184:187], a[120:123], a[28:31]
v_mfma_f32_16x16x32_bf16 a[28:31], a[188:191], a[124:127], a[28:31]
v_mfma_f32_16x16x32_bf16 a[24:27], a[180:183], a[124:127], a[24:27]
v_mfma_f32_16x16x32_bf16 a[24:27], a[176:179], a[120:123], a[24:27]
v_mfma_f32_16x16x32_bf16 a[20:23], a[168:171], a[120:123], a[20:23]
v_mfma_f32_16x16x32_bf16 a[20:23], a[172:175], a[124:127], a[20:23]
v_mfma_f32_16x16x32_bf16 a[16:19], a[164:167], a[124:127], a[16:19]
v_mfma_f32_16x16x32_bf16 a[16:19], a[160:163], a[120:123], a[16:19]
s_waitcnt lgkmcnt(0)
v_mfma_f32_16x16x32_bf16 v[32:35], a[64:67], a[128:131], v[32:35]
s_waitcnt vmcnt(31)
v_mfma_f32_16x16x32_bf16 v[32:35], a[68:71], a[132:135], v[32:35]
s_barrier
v_mfma_f32_16x16x32_bf16 v[40:43], a[68:71], a[140:143], v[40:43]
ds_read_b128 a[96:99], v9 offset:8192
v_mfma_f32_16x16x32_bf16 v[40:43], a[64:67], a[136:139], v[40:43]
s_xor_b32 s76, s75, 3145728
s_add_u32 s76, s74, s76
v_mfma_f32_16x16x32_bf16 v[48:51], a[64:67], a[144:147], v[48:51]
s_add_u32 m0, s77, 0
s_add_u32 s64, s76, 0
v_mfma_f32_16x16x32_bf16 v[48:51], a[68:71], a[148:151], v[48:51]
buffer_load_dwordx4 v7, s[56:59], s64 offen lds
v_mfma_f32_16x16x32_bf16 v[56:59], a[68:71], a[156:159], v[56:59]
ds_read_b128 a[100:103], v10 offset:8192
v_mfma_f32_16x16x32_bf16 v[56:59], a[64:67], a[152:155], v[56:59]
v_mfma_f32_16x16x32_bf16 v[60:63], a[72:75], a[152:155], v[60:63]
ds_read_b128 a[104:107], v9 offset:10240
v_mfma_f32_16x16x32_bf16 v[60:63], a[76:79], a[156:159], v[60:63]
v_mfma_f32_16x16x32_bf16 v[52:55], a[76:79], a[148:151], v[52:55]
v_mfma_f32_16x16x32_bf16 v[52:55], a[72:75], a[144:147], v[52:55]
buffer_load_dwordx4 v8, s[56:59], s64 offen offset:1024 lds
v_mfma_f32_16x16x32_bf16 v[44:47], a[72:75], a[136:139], v[44:47]
ds_read_b64_tr_b16 a[160:161], v11 offset:16384
ds_read_b64_tr_b16 a[162:163], v11 offset:16896
v_mfma_f32_16x16x32_bf16 v[44:47], a[76:79], a[140:143], v[44:47]
v_mfma_f32_16x16x32_bf16 v[36:39], a[76:79], a[132:135], v[36:39]
v_mfma_f32_16x16x32_bf16 v[36:39], a[72:75], a[128:131], v[36:39]
ds_read_b128 a[108:111], v10 offset:10240
v_mfma_f32_16x16x32_bf16 v[64:67], a[80:83], a[128:131], v[64:67]
s_add_u32 m0, s77, 2048
s_add_u32 s64, s76, 131072
s_waitcnt vmcnt(6)
v_mfma_f32_16x16x32_bf16 v[64:67], a[84:87], a[132:135], v[64:67]
v_cmp_gt_u32 vcc, 1, v23
v_mfma_f32_16x16x32_bf16 v[72:75], a[84:87], a[140:143], v[72:75]
buffer_load_dwordx4 v7, s[56:59], s64 offen lds
v_mfma_f32_16x16x32_bf16 v[72:75], a[80:83], a[136:139], v[72:75]
ds_read_b64_tr_b16 a[164:165], v11 offset:24576
ds_read_b64_tr_b16 a[166:167], v11 offset:25088
v_mfma_f32_16x16x32_bf16 v[80:83], a[80:83], a[144:147], v[80:83]
v_mfma_f32_16x16x32_bf16 v[80:83], a[84:87], a[148:151], v[80:83]
ds_read_b128 a[112:115], v9 offset:12288
v_mfma_f32_16x16x32_bf16 v[88:91], a[84:87], a[156:159], v[88:91]
s_cbranch_vccnz CK_Z
CK_Z_R:
v_mfma_f32_16x16x32_bf16 v[88:91], a[80:83], a[152:155], v[88:91]
buffer_atomic_add v1, v0, s[24:27], s84 offen offset:0 sc1
v_mfma_f32_16x16x32_bf16 v[92:95], a[88:91], a[152:155], v[92:95]
s_mul_i32 s52, s66, 147456
ds_read_b64_tr_b16 a[168:169], v12 offset:16384
ds_read_b64_tr_b16 a[170:171], v12 offset:16896
v_mfma_f32_16x16x32_bf16 v[92:95], a[92:95], a[156:159], v[92:95]
buffer_load_dwordx4 v8, s[56:59], s64 offen offset:1024 lds
v_mfma_f32_16x16x32_bf16 v[84:87], a[92:95], a[148:151], v[84:87]
s_lshl_b32 s53, s4, 8
s_add_u32 s52, s52, s53
s_lshl2_add_u32 s53, s2, s3
v_mfma_f32_16x16x32_bf16 v[84:87], a[88:91], a[144:147], v[84:87]
s_mul_i32 s53, s53, 2304
v_lshrrev_b32 v16, 1, v1
v_and_b32 v17, 1, v1
v_mfma_f32_16x16x32_bf16 v[76:79], a[88:91], a[136:139], v[76:79]
ds_read_b128 a[116:119], v10 offset:12288
v_lshlrev_b32 v16, 13, v16
v_mfma_f32_16x16x32_bf16 v[76:79], a[92:95], a[140:143], v[76:79]
v_lshl_add_u32 v16, v17, 7, v16
v_mov_b32 v17, 2147418112
v_mfma_f32_16x16x32_bf16 v[68:71], a[92:95], a[132:135], v[68:71]
v_cmp_gt_u32 s[96:97], 18, v1
v_lshlrev_b32 v18, 7, v1
v_mfma_f32_16x16x32_bf16 v[68:71], a[88:91], a[128:131], v[68:71]
s_add_u32 m0, s73, 4096
s_add_u32 s64, s71, 524288
s_waitcnt lgkmcnt(6)
v_mfma_f32_16x16x32_bf16 v[96:99], a[96:99], a[128:131], v[96:99]
ds_read_b64_tr_b16 a[172:173], v12 offset:24576
ds_read_b64_tr_b16 a[174:175], v12 offset:25088
v_mfma_f32_16x16x32_bf16 v[96:99], a[100:103], a[132:135], v[96:99]
buffer_load_dwordx4 v5, s[8:11], s64 offen lds
v_mfma_f32_16x16x32_bf16 v[104:107], a[100:103], a[140:143], v[104:107]
ds_read_b128 a[120:123], v9 offset:14336
v_mov_b32 v29, 0
v_mfma_f32_16x16x32_bf16 v[104:107], a[96:99], a[136:139], v[104:107]
v_mfma_f32_16x16x32_bf16 v[112:115], a[96:99], a[144:147], v[112:115]
v_cndmask_b32 v16, v17, v16, s[96:97]
v_cndmask_b32 v18, v17, v18, s[96:97]
v_mfma_f32_16x16x32_bf16 v[112:115], a[100:103], a[148:151], v[112:115]
ds_read_b64_tr_b16 a[176:177], v13 offset:16384
ds_read_b64_tr_b16 a[178:179], v13 offset:16896
v_mfma_f32_16x16x32_bf16 v[120:123], a[100:103], a[156:159], v[120:123]
buffer_load_dword a253, v18, s[12:15], s53 offen
v_mfma_f32_16x16x32_bf16 v[120:123], a[96:99], a[152:155], v[120:123]
v_mfma_f32_16x16x32_bf16 v[124:127], a[104:107], a[152:155], v[124:127]
buffer_load_dwordx4 v6, s[8:11], s64 offen offset:1024 lds
v_mfma_f32_16x16x32_bf16 v[124:127], a[108:111], a[156:159], v[124:127]
ds_read_b128 a[124:127], v10 offset:14336
v_mfma_f32_16x16x32_bf16 v[116:119], a[108:111], a[148:151], v[116:119]
v_add_u32 v9, 32768, v9
v_add_u32 v10, 32768, v10
v_mfma_f32_16x16x32_bf16 v[116:119], a[104:107], a[144:147], v[116:119]
v_mfma_f32_16x16x32_bf16 v[108:111], a[104:107], a[136:139], v[108:111]
ds_read_b64_tr_b16 a[180:181], v13 offset:24576
ds_read_b64_tr_b16 a[182:183], v13 offset:25088
v_mfma_f32_16x16x32_bf16 v[108:111], a[108:111], a[140:143], v[108:111]
s_add_u32 m0, s73, 6144
s_add_u32 s64, s71, 540672
v_mfma_f32_16x16x32_bf16 v[100:103], a[108:111], a[132:135], v[100:103]
s_waitcnt lgkmcnt(2)
v_mfma_f32_16x16x32_bf16 v[100:103], a[104:107], a[128:131], v[100:103]
buffer_load_dwordx4 v5, s[8:11], s64 offen lds
v_mfma_f32_16x16x32_bf16 v[128:131], a[112:115], a[128:131], v[128:131]
ds_read_b64_tr_b16 a[184:185], v14 offset:16384
ds_read_b64_tr_b16 a[186:187], v14 offset:16896
v_mfma_f32_16x16x32_bf16 v[128:131], a[116:119], a[132:135], v[128:131]
v_mfma_f32_16x16x32_bf16 v[136:139], a[116:119], a[140:143], v[136:139]
ds_read_b64_tr_b16 a[188:189], v14 offset:24576
ds_read_b64_tr_b16 a[190:191], v14 offset:25088
v_mfma_f32_16x16x32_bf16 v[136:139], a[112:115], a[136:139], v[136:139]
v_mfma_f32_16x16x32_bf16 v[144:147], a[112:115], a[144:147], v[144:147]
v_mfma_f32_16x16x32_bf16 v[144:147], a[116:119], a[148:151], v[144:147]
v_mfma_f32_16x16x32_bf16 v[152:155], a[116:119], a[156:159], v[152:155]
buffer_load_dwordx4 v6, s[8:11], s64 offen offset:1024 lds
v_mfma_f32_16x16x32_bf16 v[152:155], a[112:115], a[152:155], v[152:155]
v_mfma_f32_16x16x32_bf16 v[156:159], a[120:123], a[152:155], v[156:159]
v_mfma_f32_16x16x32_bf16 v[156:159], a[124:127], a[156:159], v[156:159]
v_mfma_f32_16x16x32_bf16 v[148:151], a[124:127], a[148:151], v[148:151]
L_PAD2:
s_cbranch_execz L_PAD6
v_mfma_f32_16x16x32_bf16 v[148:151], a[120:123], a[144:147], v[148:151]
v_mfma_f32_16x16x32_bf16 v[140:143], a[120:123], a[136:139], v[140:143]
v_mfma_f32_16x16x32_bf16 v[140:143], a[124:127], a[140:143], v[140:143]
v_mfma_f32_16x16x32_bf16 v[132:135], a[124:127], a[132:135], v[132:135]
v_mfma_f32_16x16x32_bf16 v[132:135], a[120:123], a[128:131], v[132:135]
s_waitcnt lgkmcnt(0)
v_mfma_f32_16x16x32_bf16 v[160:163], a[160:163], a[64:67], v[160:163]
s_waitcnt vmcnt(23)
v_mfma_f32_16x16x32_bf16 v[160:163], a[164:167], a[68:71], v[160:163]
s_barrier
v_mfma_f32_16x16x32_bf16 v[164:167], a[172:175], a[68:71], v[164:167]
ds_read_b64_tr_b16 a[128:129], v11 offset:32768
ds_read_b64_tr_b16 a[130:131], v11 offset:33280
v_mfma_f32_16x16x32_bf16 v[164:167], a[168:171], a[64:67], v[164:167]
s_add_u32 m0, s77, 16384
s_add_u32 s64, s76, 0
v_mfma_f32_16x16x32_bf16 v[168:171], a[176:179], a[64:67], v[168:171]
buffer_load_dwordx4 v7, s[16:19], s64 offen lds
v_mfma_f32_16x16x32_bf16 v[168:171], a[180:183], a[68:71], v[168:171]
buffer_load_dword a252, v16, s[20:23], s52 offen
v_mfma_f32_16x16x32_bf16 v[172:175], a[188:191], a[68:71], v[172:175]
s_add_u32 s52, s52, 73728
v_mfma_f32_16x16x32_bf16 v[172:175], a[184:187], a[64:67], v[172:175]
ds_read_b128 a[64:67], v9 offset:0
v_mfma_f32_16x16x32_bf16 v[188:191], a[184:187], a[72:75], v[188:191]
ds_read_b64_tr_b16 a[132:133], v11 offset:40960
ds_read_b64_tr_b16 a[134:135], v11 offset:41472
v_mfma_f32_16x16x32_bf16 v[188:191], a[188:191], a[76:79], v[188:191]
v_mfma_f32_16x16x32_bf16 v[184:187], a[180:183], a[76:79], v[184:187]
v_mfma_f32_16x16x32_bf16 v[184:187], a[176:179], a[72:75], v[184:187]
buffer_load_dwordx4 v8, s[16:19], s64 offen offset:1024 lds
v_mfma_f32_16x16x32_bf16 v[180:183], a[168:171], a[72:75], v[180:183]
ds_read_b128 a[68:71], v10 offset:0
v_mfma_f32_16x16x32_bf16 v[180:183], a[172:175], a[76:79], v[180:183]
v_mfma_f32_16x16x32_bf16 v[176:179], a[164:167], a[76:79], v[176:179]
v_mfma_f32_16x16x32_bf16 v[176:179], a[160:163], a[72:75], v[176:179]
ds_read_b64_tr_b16 a[136:137], v12 offset:32768
ds_read_b64_tr_b16 a[138:139], v12 offset:33280
v_mfma_f32_16x16x32_bf16 v[192:195], a[160:163], a[80:83], v[192:195]
s_add_u32 m0, s77, 18432
s_add_u32 s64, s76, 131072
v_mfma_f32_16x16x32_bf16 v[192:195], a[164:167], a[84:87], v[192:195]
v_mfma_f32_16x16x32_bf16 v[196:199], a[172:175], a[84:87], v[196:199]
buffer_load_dwordx4 v7, s[16:19], s64 offen lds
v_mfma_f32_16x16x32_bf16 v[196:199], a[168:171], a[80:83], v[196:199]
ds_read_b128 a[72:75], v9 offset:2048
v_mfma_f32_16x16x32_bf16 v[200:203], a[176:179], a[80:83], v[200:203]
v_mfma_f32_16x16x32_bf16 v[200:203], a[180:183], a[84:87], v[200:203]
ds_read_b64_tr_b16 a[140:141], v12 offset:40960
ds_read_b64_tr_b16 a[142:143], v12 offset:41472
v_mfma_f32_16x16x32_bf16 v[204:207], a[188:191], a[84:87], v[204:207]
v_mfma_f32_16x16x32_bf16 v[204:207], a[184:187], a[80:83], v[204:207]
v_mfma_f32_16x16x32_bf16 v[220:223], a[184:187], a[88:91], v[220:223]
ds_read_b128 a[76:79], v10 offset:2048
v_mfma_f32_16x16x32_bf16 v[220:223], a[188:191], a[92:95], v[220:223]
buffer_load_dwordx4 v8, s[16:19], s64 offen offset:1024 lds
v_mfma_f32_16x16x32_bf16 v[216:219], a[180:183], a[92:95], v[216:219]
s_xor_b32 s71, s70, 896
s_add_u32 s71, s68, s71
v_mfma_f32_16x16x32_bf16 v[216:219], a[176:179], a[88:91], v[216:219]
v_mfma_f32_16x16x32_bf16 v[212:215], a[168:171], a[88:91], v[212:215]
ds_read_b64_tr_b16 a[144:145], v13 offset:32768
ds_read_b64_tr_b16 a[146:147], v13 offset:33280
v_mfma_f32_16x16x32_bf16 v[212:215], a[172:175], a[92:95], v[212:215]
v_mfma_f32_16x16x32_bf16 v[208:211], a[164:167], a[92:95], v[208:211]
v_mfma_f32_16x16x32_bf16 v[208:211], a[160:163], a[88:91], v[208:211]
s_add_u32 m0, s73, 32768
s_add_u32 s64, s71, 0
ds_read_b128 a[80:83], v9 offset:4096
v_mfma_f32_16x16x32_bf16 v[224:227], a[160:163], a[96:99], v[224:227]
v_mfma_f32_16x16x32_bf16 v[224:227], a[164:167], a[100:103], v[224:227]
buffer_load_dwordx4 v5, s[8:11], s64 offen lds
v_mfma_f32_16x16x32_bf16 v[228:231], a[172:175], a[100:103], v[228:231]
ds_read_b64_tr_b16 a[148:149], v13 offset:40960
ds_read_b64_tr_b16 a[150:151], v13 offset:41472
v_mfma_f32_16x16x32_bf16 v[228:231], a[168:171], a[96:99], v[228:231]
v_mfma_f32_16x16x32_bf16 v[232:235], a[176:179], a[96:99], v[232:235]
v_mfma_f32_16x16x32_bf16 v[232:235], a[180:183], a[100:103], v[232:235]
ds_read_b128 a[84:87], v10 offset:4096
v_mfma_f32_16x16x32_bf16 v[236:239], a[188:191], a[100:103], v[236:239]
v_mfma_f32_16x16x32_bf16 v[236:239], a[184:187], a[96:99], v[236:239]
v_mfma_f32_16x16x32_bf16 v[252:255], a[184:187], a[104:107], v[252:255]
buffer_load_dwordx4 v6, s[8:11], s64 offen offset:1024 lds
v_mfma_f32_16x16x32_bf16 v[252:255], a[188:191], a[108:111], v[252:255]
ds_read_b64_tr_b16 a[152:153], v14 offset:32768
ds_read_b64_tr_b16 a[154:155], v14 offset:33280
v_mfma_f32_16x16x32_bf16 v[248:251], a[180:183], a[108:111], v[248:251]
v_mfma_f32_16x16x32_bf16 v[248:251], a[176:179], a[104:107], v[248:251]
v_mfma_f32_16x16x32_bf16 v[244:247], a[168:171], a[104:107], v[244:247]
ds_read_b128 a[88:91], v9 offset:6144
v_mfma_f32_16x16x32_bf16 v[244:247], a[172:175], a[108:111], v[244:247]
s_add_u32 m0, s73, 34816
s_add_u32 s64, s71, 16384
v_mfma_f32_16x16x32_bf16 v[240:243], a[164:167], a[108:111], v[240:243]
v_mfma_f32_16x16x32_bf16 v[240:243], a[160:163], a[104:107], v[240:243]
buffer_load_dwordx4 v5, s[8:11], s64 offen lds
v_mfma_f32_16x16x32_bf16 a[0:3], a[160:163], a[112:115], a[0:3]
ds_read_b64_tr_b16 a[156:157], v14 offset:40960
ds_read_b64_tr_b16 a[158:159], v14 offset:41472
v_mfma_f32_16x16x32_bf16 a[0:3], a[164:167], a[116:119], a[0:3]
v_mfma_f32_16x16x32_bf16 a[4:7], a[172:175], a[116:119], a[4:7]
ds_read_b128 a[92:95], v10 offset:6144
v_mfma_f32_16x16x32_bf16 a[4:7], a[168:171], a[112:115], a[4:7]
v_mfma_f32_16x16x32_bf16 a[8:11], a[176:179], a[112:115], a[8:11]
v_mfma_f32_16x16x32_bf16 a[8:11], a[180:183], a[116:119], a[8:11]
v_mfma_f32_16x16x32_bf16 a[12:15], a[188:191], a[116:119], a[12:15]
buffer_load_dwordx4 v6, s[8:11], s64 offen offset:1024 lds
v_mfma_f32_16x16x32_bf16 a[12:15], a[184:187], a[112:115], a[12:15]
v_mfma_f32_16x16x32_bf16 a[28:31], a[184:187], a[120:123], a[28:31]
v_mfma_f32_16x16x32_bf16 a[28:31], a[188:191], a[124:127], a[28:31]
v_mfma_f32_16x16x32_bf16 a[24:27], a[180:183], a[124:127], a[24:27]
v_mfma_f32_16x16x32_bf16 a[24:27], a[176:179], a[120:123], a[24:27]
v_mfma_f32_16x16x32_bf16 a[20:23], a[168:171], a[120:123], a[20:23]
v_mfma_f32_16x16x32_bf16 a[20:23], a[172:175], a[124:127], a[20:23]
v_mfma_f32_16x16x32_bf16 a[16:19], a[164:167], a[124:127], a[16:19]
v_mfma_f32_16x16x32_bf16 a[16:19], a[160:163], a[120:123], a[16:19]
s_waitcnt lgkmcnt(0)
v_mfma_f32_16x16x32_bf16 v[32:35], a[64:67], a[128:131], v[32:35]
s_waitcnt vmcnt(25)
v_mfma_f32_16x16x32_bf16 v[32:35], a[68:71], a[132:135], v[32:35]
s_barrier
v_mfma_f32_16x16x32_bf16 v[40:43], a[68:71], a[140:143], v[40:43]
ds_read_b128 a[96:99], v9 offset:8192
v_mfma_f32_16x16x32_bf16 v[40:43], a[64:67], a[136:139], v[40:43]
s_xor_b32 s76, s75, 3670016
s_add_u32 s76, s74, s76
v_mfma_f32_16x16x32_bf16 v[48:51], a[64:67], a[144:147], v[48:51]
s_add_u32 m0, s77, 32768
s_add_u32 s64, s76, 0
v_mfma_f32_16x16x32_bf16 v[48:51], a[68:71], a[148:151], v[48:51]
buffer_load_dwordx4 v7, s[56:59], s64 offen lds
v_mfma_f32_16x16x32_bf16 v[56:59], a[68:71], a[156:159], v[56:59]
ds_read_b128 a[100:103], v10 offset:8192
v_mfma_f32_16x16x32_bf16 v[56:59], a[64:67], a[152:155], v[56:59]
buffer_load_dword a252, v16, s[20:23], s52 offen
v_mfma_f32_16x16x32_bf16 v[60:63], a[72:75], a[152:155], v[60:63]
s_lshr_b32 s52, s2, 1
s_lshl2_add_u32 s52, s52, s3
ds_read_b128 a[104:107], v9 offset:10240
v_mfma_f32_16x16x32_bf16 v[60:63], a[76:79], a[156:159], v[60:63]
s_mul_i32 s52, s52, 9216
s_and_b32 s53, s2, 1
s_lshl_b32 s53, s53, 9
v_mfma_f32_16x16x32_bf16 v[52:55], a[76:79], a[148:151], v[52:55]
s_add_u32 s52, s52, s53
s_lshl2_add_u32 s53, s2, s3
s_mul_i32 s53, s53, 768
v_mfma_f32_16x16x32_bf16 v[52:55], a[72:75], a[144:147], v[52:55]
buffer_load_dwordx4 v8, s[56:59], s64 offen offset:1024 lds
v_mfma_f32_16x16x32_bf16 v[44:47], a[72:75], a[136:139], v[44:47]
ds_read_b64_tr_b16 a[160:161], v11 offset:49152
ds_read_b64_tr_b16 a[162:163], v11 offset:49664
v_mfma_f32_16x16x32_bf16 v[44:47], a[76:79], a[140:143], v[44:47]
v_cmp_gt_u32 s[96:97], 40, v1
v_and_b32 v16, 7, v1
v_mfma_f32_16x16x32_bf16 v[36:39], a[76:79], a[132:135], v[36:39]
v_mul_u32_u24 v16, 1152, v16
v_lshrrev_b32 v19, 3, v1
v_mfma_f32_16x16x32_bf16 v[36:39], a[72:75], a[128:131], v[36:39]
ds_read_b128 a[108:111], v10 offset:10240
v_lshl_add_u32 v16, v19, 7, v16
v_mfma_f32_16x16x32_bf16 v[64:67], a[80:83], a[128:131], v[64:67]
s_add_u32 m0, s77, 34816
s_add_u32 s64, s76, 131072
v_cndmask_b32 v16, v17, v16, s[96:97]
v_mfma_f32_16x16x32_bf16 v[64:67], a[84:87], a[132:135], v[64:67]
v_cmp_gt_u32 s[96:97], 6, v1
v_mfma_f32_16x16x32_bf16 v[72:75], a[84:87], a[140:143], v[72:75]
buffer_load_dwordx4 v7, s[56:59], s64 offen lds
v_mfma_f32_16x16x32_bf16 v[72:75], a[80:83], a[136:139], v[72:75]
ds_read_b64_tr_b16 a[164:165], v11 offset:57344
ds_read_b64_tr_b16 a[166:167], v11 offset:57856
v_mfma_f32_16x16x32_bf16 v[80:83], a[80:83], a[144:147], v[80:83]
v_cndmask_b32 v18, v17, v18, s[96:97]
v_mfma_f32_16x16x32_bf16 v[80:83], a[84:87], a[148:151], v[80:83]
ds_read_b128 a[112:115], v9 offset:12288
v_mfma_f32_16x16x32_bf16 v[88:91], a[84:87], a[156:159], v[88:91]
v_mfma_f32_16x16x32_bf16 v[88:91], a[80:83], a[152:155], v[88:91]
v_mfma_f32_16x16x32_bf16 v[92:95], a[88:91], a[152:155], v[92:95]
ds_read_b64_tr_b16 a[168:169], v12 offset:49152
ds_read_b64_tr_b16 a[170:171], v12 offset:49664
v_mfma_f32_16x16x32_bf16 v[92:95], a[92:95], a[156:159], v[92:95]
buffer_load_dwordx4 v8, s[56:59], s64 offen offset:1024 lds
v_mfma_f32_16x16x32_bf16 v[84:87], a[92:95], a[148:151], v[84:87]
v_mfma_f32_16x16x32_bf16 v[84:87], a[88:91], a[144:147], v[84:87]
v_mfma_f32_16x16x32_bf16 v[76:79], a[88:91], a[136:139], v[76:79]
ds_read_b128 a[116:119], v10 offset:12288
v_mfma_f32_16x16x32_bf16 v[76:79], a[92:95], a[140:143], v[76:79]
v_mfma_f32_16x16x32_bf16 v[68:71], a[92:95], a[132:135], v[68:71]
v_mfma_f32_16x16x32_bf16 v[68:71], a[88:91], a[128:131], v[68:71]
s_add_u32 m0, s73, 36864
s_add_u32 s64, s71, 524288
s_waitcnt lgkmcnt(6)
v_mfma_f32_16x16x32_bf16 v[96:99], a[96:99], a[128:131], v[96:99]
ds_read_b64_tr_b16 a[172:173], v12 offset:57344
ds_read_b64_tr_b16 a[174:175], v12 offset:57856
v_mfma_f32_16x16x32_bf16 v[96:99], a[100:103], a[132:135], v[96:99]
buffer_load_dwordx4 v5, s[8:11], s64 offen lds
v_mfma_f32_16x16x32_bf16 v[104:107], a[100:103], a[140:143], v[104:107]
ds_read_b128 a[120:123], v9 offset:14336
v_mfma_f32_16x16x32_bf16 v[104:107], a[96:99], a[136:139], v[104:107]
v_mfma_f32_16x16x32_bf16 v[112:115], a[96:99], a[144:147], v[112:115]
v_mfma_f32_16x16x32_bf16 v[112:115], a[100:103], a[148:151], v[112:115]
ds_read_b64_tr_b16 a[176:177], v13 offset:49152
ds_read_b64_tr_b16 a[178:179], v13 offset:49664
v_mfma_f32_16x16x32_bf16 v[120:123], a[100:103], a[156:159], v[120:123]
v_mfma_f32_16x16x32_bf16 v[120:123], a[96:99], a[152:155], v[120:123]
v_mfma_f32_16x16x32_bf16 v[124:127], a[104:107], a[152:155], v[124:127]
buffer_load_dwordx4 v6, s[8:11], s64 offen offset:1024 lds
v_mfma_f32_16x16x32_bf16 v[124:127], a[108:111], a[156:159], v[124:127]
ds_read_b128 a[124:127], v10 offset:14336
v_mfma_f32_16x16x32_bf16 v[116:119], a[108:111], a[148:151], v[116:119]
v_add_u32 v9, -65536, v9
v_add_u32 v10, -65536, v10
v_mfma_f32_16x16x32_bf16 v[116:119], a[104:107], a[144:147], v[116:119]
buffer_load_dword v30, v29, s[24:27], s89 offen sc1
v_mfma_f32_16x16x32_bf16 v[108:111], a[104:107], a[136:139], v[108:111]
ds_read_b64_tr_b16 a[180:181], v13 offset:57344
ds_read_b64_tr_b16 a[182:183], v13 offset:57856
v_mfma_f32_16x16x32_bf16 v[108:111], a[108:111], a[140:143], v[108:111]
s_add_u32 m0, s73, 38912
s_add_u32 s64, s71, 540672
v_mfma_f32_16x16x32_bf16 v[100:103], a[108:111], a[132:135], v[100:103]
s_waitcnt lgkmcnt(2)
v_mfma_f32_16x16x32_bf16 v[100:103], a[104:107], a[128:131], v[100:103]
buffer_load_dwordx4 v5, s[8:11], s64 offen lds
v_mfma_f32_16x16x32_bf16 v[128:131], a[112:115], a[128:131], v[128:131]
ds_read_b64_tr_b16 a[184:185], v14 offset:49152
ds_read_b64_tr_b16 a[186:187], v14 offset:49664
v_mfma_f32_16x16x32_bf16 v[128:131], a[116:119], a[132:135], v[128:131]
v_mfma_f32_16x16x32_bf16 v[136:139], a[116:119], a[140:143], v[136:139]
ds_read_b64_tr_b16 a[188:189], v14 offset:57344
ds_read_b64_tr_b16 a[190:191], v14 offset:57856
v_mfma_f32_16x16x32_bf16 v[136:139], a[112:115], a[136:139], v[136:139]
v_mfma_f32_16x16x32_bf16 v[144:147], a[112:115], a[144:147], v[144:147]
v_mfma_f32_16x16x32_bf16 v[144:147], a[116:119], a[148:151], v[144:147]
v_mfma_f32_16x16x32_bf16 v[152:155], a[116:119], a[156:159], v[152:155]
buffer_load_dwordx4 v6, s[8:11], s64 offen offset:1024 lds
v_mfma_f32_16x16x32_bf16 v[152:155], a[112:115], a[152:155], v[152:155]
v_mfma_f32_16x16x32_bf16 v[156:159], a[120:123], a[152:155], v[156:159]
v_mfma_f32_16x16x32_bf16 v[156:159], a[124:127], a[156:159], v[156:159]
v_mfma_f32_16x16x32_bf16 v[148:151], a[124:127], a[148:151], v[148:151]
v_mfma_f32_16x16x32_bf16 v[148:151], a[120:123], a[144:147], v[148:151]
v_mfma_f32_16x16x32_bf16 v[140:143], a[120:123], a[136:139], v[140:143]
v_mfma_f32_16x16x32_bf16 v[140:143], a[124:127], a[140:143], v[140:143]
v_mfma_f32_16x16x32_bf16 v[132:135], a[124:127], a[132:135], v[132:135]
v_mfma_f32_16x16x32_bf16 v[132:135], a[120:123], a[128:131], v[132:135]
s_waitcnt lgkmcnt(0)
v_mfma_f32_16x16x32_bf16 v[160:163], a[160:163], a[64:67], v[160:163]
s_waitcnt vmcnt(19)
v_mfma_f32_16x16x32_bf16 v[160:163], a[164:167], a[68:71], v[160:163]
s_barrier
v_mfma_f32_16x16x32_bf16 v[164:167], a[172:175], a[68:71], v[164:167]
ds_read_b64_tr_b16 a[128:129], v11 offset:0
ds_read_b64_tr_b16 a[130:131], v11 offset:512
v_mfma_f32_16x16x32_bf16 v[164:167], a[168:171], a[64:67], v[164:167]
s_add_u32 m0, s77, 49152
s_add_u32 s64, s76, 0
v_mfma_f32_16x16x32_bf16 v[168:171], a[176:179], a[64:67], v[168:171]
buffer_load_dwordx4 v7, s[16:19], s64 offen lds
v_mfma_f32_16x16x32_bf16 v[168:171], a[180:183], a[68:71], v[168:171]
v_mfma_f32_16x16x32_bf16 v[172:175], a[188:191], a[68:71], v[172:175]
v_mfma_f32_16x16x32_bf16 v[172:175], a[184:187], a[64:67], v[172:175]
ds_read_b128 a[64:67], v9 offset:0
v_mfma_f32_16x16x32_bf16 v[188:191], a[184:187], a[72:75], v[188:191]
ds_read_b64_tr_b16 a[132:133], v11 offset:8192
ds_read_b64_tr_b16 a[134:135], v11 offset:8704
v_mfma_f32_16x16x32_bf16 v[188:191], a[188:191], a[76:79], v[188:191]
v_mfma_f32_16x16x32_bf16 v[184:187], a[180:183], a[76:79], v[184:187]
v_mfma_f32_16x16x32_bf16 v[184:187], a[176:179], a[72:75], v[184:187]
buffer_load_dwordx4 v8, s[16:19], s64 offen offset:1024 lds
v_mfma_f32_16x16x32_bf16 v[180:183], a[168:171], a[72:75], v[180:183]
ds_read_b128 a[68:71], v10 offset:0
v_mfma_f32_16x16x32_bf16 v[180:183], a[172:175], a[76:79], v[180:183]
v_mfma_f32_16x16x32_bf16 v[176:179], a[164:167], a[76:79], v[176:179]
v_mfma_f32_16x16x32_bf16 v[176:179], a[160:163], a[72:75], v[176:179]
ds_read_b64_tr_b16 a[136:137], v12 offset:0
ds_read_b64_tr_b16 a[138:139], v12 offset:512
v_mfma_f32_16x16x32_bf16 v[192:195], a[160:163], a[80:83], v[192:195]
s_add_u32 m0, s77, 51200
s_add_u32 s64, s76, 131072
v_mfma_f32_16x16x32_bf16 v[192:195], a[164:167], a[84:87], v[192:195]
v_mfma_f32_16x16x32_bf16 v[196:199], a[172:175], a[84:87], v[196:199]
buffer_load_dwordx4 v7, s[16:19], s64 offen lds
v_mfma_f32_16x16x32_bf16 v[196:199], a[168:171], a[80:83], v[196:199]
ds_read_b128 a[72:75], v9 offset:2048
v_mfma_f32_16x16x32_bf16 v[200:203], a[176:179], a[80:83], v[200:203]
v_mfma_f32_16x16x32_bf16 v[200:203], a[180:183], a[84:87], v[200:203]
ds_read_b64_tr_b16 a[140:141], v12 offset:8192
ds_read_b64_tr_b16 a[142:143], v12 offset:8704
v_mfma_f32_16x16x32_bf16 v[204:207], a[188:191], a[84:87], v[204:207]
v_mfma_f32_16x16x32_bf16 v[204:207], a[184:187], a[80:83], v[204:207]
v_mfma_f32_16x16x32_bf16 v[220:223], a[184:187], a[88:91], v[220:223]
ds_read_b128 a[76:79], v10 offset:2048
v_mfma_f32_16x16x32_bf16 v[220:223], a[188:191], a[92:95], v[220:223]
buffer_load_dwordx4 v8, s[16:19], s64 offen offset:1024 lds
v_mfma_f32_16x16x32_bf16 v[216:219], a[180:183], a[92:95], v[216:219]
s_lshl_b32 s70, s93, 7
s_mul_i32 s68, s66, 36864
s_mul_i32 s69, s67, 36864
v_mfma_f32_16x16x32_bf16 v[216:219], a[176:179], a[88:91], v[216:219]
v_lshrrev_b32 v31, 3, v1
v_lshl_add_u32 v5, v31, 7, v5
v_mfma_f32_16x16x32_bf16 v[212:215], a[168:171], a[88:91], v[212:215]
v_lshl_add_u32 v6, v31, 7, v6
v_add_u32 v6, 1024, v6
v_mfma_f32_16x16x32_bf16 v[212:215], a[172:175], a[92:95], v[212:215]
s_mov_b32 s65, 1024
s_add_u32 s71, s68, s65
s_add_u32 s72, s69, s65
v_mfma_f32_16x16x32_bf16 v[208:211], a[164:167], a[92:95], v[208:211]
ds_read_b64_tr_b16 a[144:145], v13 offset:0
ds_read_b64_tr_b16 a[146:147], v13 offset:512
v_mfma_f32_16x16x32_bf16 v[208:211], a[160:163], a[88:91], v[208:211]
s_add_u32 m0, s73, 65536
s_add_u32 s64, s71, 0
ds_read_b128 a[80:83], v9 offset:4096
v_mfma_f32_16x16x32_bf16 v[224:227], a[160:163], a[96:99], v[224:227]
v_mfma_f32_16x16x32_bf16 v[224:227], a[164:167], a[100:103], v[224:227]
buffer_load_dwordx4 v5, s[12:15], s64 offen lds
v_mfma_f32_16x16x32_bf16 v[228:231], a[172:175], a[100:103], v[228:231]
ds_read_b64_tr_b16 a[148:149], v13 offset:8192
ds_read_b64_tr_b16 a[150:151], v13 offset:8704
v_mfma_f32_16x16x32_bf16 v[228:231], a[168:171], a[96:99], v[228:231]
v_mfma_f32_16x16x32_bf16 v[232:235], a[176:179], a[96:99], v[232:235]
v_mfma_f32_16x16x32_bf16 v[232:235], a[180:183], a[100:103], v[232:235]
ds_read_b128 a[84:87], v10 offset:4096
v_mfma_f32_16x16x32_bf16 v[236:239], a[188:191], a[100:103], v[236:239]
v_mfma_f32_16x16x32_bf16 v[236:239], a[184:187], a[96:99], v[236:239]
v_mfma_f32_16x16x32_bf16 v[252:255], a[184:187], a[104:107], v[252:255]
buffer_load_dwordx4 v6, s[12:15], s64 offen offset:1024 lds
v_mfma_f32_16x16x32_bf16 v[252:255], a[188:191], a[108:111], v[252:255]
ds_read_b64_tr_b16 a[152:153], v14 offset:0
ds_read_b64_tr_b16 a[154:155], v14 offset:512
v_mfma_f32_16x16x32_bf16 v[248:251], a[180:183], a[108:111], v[248:251]
v_mfma_f32_16x16x32_bf16 v[248:251], a[176:179], a[104:107], v[248:251]
v_mfma_f32_16x16x32_bf16 v[244:247], a[168:171], a[104:107], v[244:247]
ds_read_b128 a[88:91], v9 offset:6144
v_mfma_f32_16x16x32_bf16 v[244:247], a[172:175], a[108:111], v[244:247]
s_add_u32 m0, s73, 67584
s_add_u32 s64, s71, 18432
v_mfma_f32_16x16x32_bf16 v[240:243], a[164:167], a[108:111], v[240:243]
v_mfma_f32_16x16x32_bf16 v[240:243], a[160:163], a[104:107], v[240:243]
buffer_load_dwordx4 v5, s[12:15], s64 offen lds
v_mfma_f32_16x16x32_bf16 a[0:3], a[160:163], a[112:115], a[0:3]
ds_read_b64_tr_b16 a[156:157], v14 offset:8192
ds_read_b64_tr_b16 a[158:159], v14 offset:8704
v_mfma_f32_16x16x32_bf16 a[0:3], a[164:167], a[116:119], a[0:3]
v_mfma_f32_16x16x32_bf16 a[4:7], a[172:175], a[116:119], a[4:7]
s_waitcnt vmcnt(9)
ds_read_b128 a[92:95], v10 offset:6144
v_mfma_f32_16x16x32_bf16 a[4:7], a[168:171], a[112:115], a[4:7]
v_cmp_gt_u32 vcc, 18, v30
v_mfma_f32_16x16x32_bf16 a[8:11], a[176:179], a[112:115], a[8:11]
v_mfma_f32_16x16x32_bf16 a[8:11], a[180:183], a[116:119], a[8:11]
v_mfma_f32_16x16x32_bf16 a[12:15], a[188:191], a[116:119], a[12:15]
buffer_load_dwordx4 v6, s[12:15], s64 offen offset:1024 lds
v_mfma_f32_16x16x32_bf16 a[12:15], a[184:187], a[112:115], a[12:15]
v_mfma_f32_16x16x32_bf16 a[28:31], a[184:187], a[120:123], a[28:31]
s_cbranch_vccnz CK_WA
CK_WA_R:
v_mfma_f32_16x16x32_bf16 a[28:31], a[188:191], a[124:127], a[28:31]
v_mfma_f32_16x16x32_bf16 a[24:27], a[180:183], a[124:127], a[24:27]
v_mfma_f32_16x16x32_bf16 a[24:27], a[176:179], a[120:123], a[24:27]
v_mfma_f32_16x16x32_bf16 a[20:23], a[168:171], a[120:123], a[20:23]
v_mfma_f32_16x16x32_bf16 a[20:23], a[172:175], a[124:127], a[20:23]
v_mfma_f32_16x16x32_bf16 a[16:19], a[164:167], a[124:127], a[16:19]
v_mfma_f32_16x16x32_bf16 a[16:19], a[160:163], a[120:123], a[16:19]
s_waitcnt lgkmcnt(0)
v_mfma_f32_16x16x32_bf16 v[32:35], a[64:67], a[128:131], v[32:35]
s_waitcnt vmcnt(22)
v_mfma_f32_16x16x32_bf16 v[32:35], a[68:71], a[132:135], v[32:35]
s_barrier
v_mfma_f32_16x16x32_bf16 v[40:43], a[68:71], a[140:143], v[40:43]
ds_read_b128 a[96:99], v9 offset:8192
v_mfma_f32_16x16x32_bf16 v[40:43], a[64:67], a[136:139], v[40:43]
s_lshl_b32 s77, s3, 11
s_lshl_b32 s74, s3, 9
s_add_u32 s74, s74, s4
v_mfma_f32_16x16x32_bf16 v[48:51], a[64:67], a[144:147], v[48:51]
s_lshl_b32 s74, s74, 8
v_mfma_f32_16x16x32_bf16 v[48:51], a[68:71], a[148:151], v[48:51]
s_mov_b32 s75, 8
s_lshl_b32 s76, s75, 19
s_add_u32 s76, s76, s74
v_mfma_f32_16x16x32_bf16 v[56:59], a[68:71], a[156:159], v[56:59]
s_lshl_b32 s79, s75, 13
s_add_u32 s79, s79, s78
ds_read_b128 a[100:103], v10 offset:8192
v_mfma_f32_16x16x32_bf16 v[56:59], a[64:67], a[152:155], v[56:59]
s_add_u32 m0, s77, 0
s_add_u32 s64, s76, 0
v_mfma_f32_16x16x32_bf16 v[60:63], a[72:75], a[152:155], v[60:63]
buffer_load_dwordx4 v7, s[20:23], s64 offen lds
v_mfma_f32_16x16x32_bf16 v[60:63], a[76:79], a[156:159], v[60:63]
ds_read_b128 a[104:107], v9 offset:10240
v_mfma_f32_16x16x32_bf16 v[52:55], a[76:79], a[148:151], v[52:55]
buffer_load_dword a252, v16, s[32:35], s52 offen
v_mfma_f32_16x16x32_bf16 v[52:55], a[72:75], a[144:147], v[52:55]
ds_read_b64_tr_b16 a[160:161], v11 offset:16384
ds_read_b64_tr_b16 a[162:163], v11 offset:16896
v_mfma_f32_16x16x32_bf16 v[44:47], a[72:75], a[136:139], v[44:47]
buffer_load_dwordx4 v8, s[20:23], s64 offen offset:1024 lds
v_mfma_f32_16x16x32_bf16 v[44:47], a[76:79], a[140:143], v[44:47]
buffer_load_dword a253, v18, s[48:51], s53 offen
v_mfma_f32_16x16x32_bf16 v[36:39], a[76:79], a[132:135], v[36:39]
v_and_b32 v18, 1, v1
v_lshlrev_b32 v18, 21, v18
v_mfma_f32_16x16x32_bf16 v[36:39], a[72:75], a[128:131], v[36:39]
ds_read_b128 a[108:111], v10 offset:10240
v_mfma_f32_16x16x32_bf16 v[64:67], a[80:83], a[128:131], v[64:67]
v_mfma_f32_16x16x32_bf16 v[64:67], a[84:87], a[132:135], v[64:67]
v_mfma_f32_16x16x32_bf16 v[72:75], a[84:87], a[140:143], v[72:75]
s_add_u32 m0, s80, 0
s_add_u32 s64, s79, 0
v_mfma_f32_16x16x32_bf16 v[72:75], a[80:83], a[136:139], v[72:75]
ds_read_b64_tr_b16 a[164:165], v11 offset:24576
ds_read_b64_tr_b16 a[166:167], v11 offset:25088
v_mfma_f32_16x16x32_bf16 v[80:83], a[80:83], a[144:147], v[80:83]
buffer_load_dwordx4 v4, s[24:27], s64 offen sc1 lds
v_mfma_f32_16x16x32_bf16 v[80:83], a[84:87], a[148:151], v[80:83]
ds_read_b128 a[112:115], v9 offset:12288
v_mfma_f32_16x16x32_bf16 v[88:91], a[84:87], a[156:159], v[88:91]
v_mfma_f32_16x16x32_bf16 v[88:91], a[80:83], a[152:155], v[88:91]
v_mfma_f32_16x16x32_bf16 v[92:95], a[88:91], a[152:155], v[92:95]
ds_read_b64_tr_b16 a[168:169], v12 offset:16384
ds_read_b64_tr_b16 a[170:171], v12 offset:16896
v_mfma_f32_16x16x32_bf16 v[92:95], a[92:95], a[156:159], v[92:95]
v_mfma_f32_16x16x32_bf16 v[84:87], a[92:95], a[148:151], v[84:87]
s_add_u32 m0, s73, 69632
s_add_u32 s64, s72, 0
v_mfma_f32_16x16x32_bf16 v[84:87], a[88:91], a[144:147], v[84:87]
v_mfma_f32_16x16x32_bf16 v[76:79], a[88:91], a[136:139], v[76:79]
buffer_load_dwordx4 v5, s[12:15], s64 offen lds
v_mfma_f32_16x16x32_bf16 v[76:79], a[92:95], a[140:143], v[76:79]
ds_read_b128 a[116:119], v10 offset:12288
v_mfma_f32_16x16x32_bf16 v[68:71], a[92:95], a[132:135], v[68:71]
v_mfma_f32_16x16x32_bf16 v[68:71], a[88:91], a[128:131], v[68:71]
s_waitcnt lgkmcnt(6)
ds_read_b64_tr_b16 a[172:173], v12 offset:24576
ds_read_b64_tr_b16 a[174:175], v12 offset:25088
v_mfma_f32_16x16x32_bf16 v[96:99], a[96:99], a[128:131], v[96:99]
v_mfma_f32_16x16x32_bf16 v[96:99], a[100:103], a[132:135], v[96:99]
v_mfma_f32_16x16x32_bf16 v[104:107], a[100:103], a[140:143], v[104:107]
ds_read_b128 a[120:123], v9 offset:14336
v_mfma_f32_16x16x32_bf16 v[104:107], a[96:99], a[136:139], v[104:107]
v_mfma_f32_16x16x32_bf16 v[112:115], a[96:99], a[144:147], v[112:115]
v_mfma_f32_16x16x32_bf16 v[112:115], a[100:103], a[148:151], v[112:115]
buffer_load_dwordx4 v6, s[12:15], s64 offen offset:1024 lds
v_mfma_f32_16x16x32_bf16 v[120:123], a[100:103], a[156:159], v[120:123]
ds_read_b64_tr_b16 a[176:177], v13 offset:16384
ds_read_b64_tr_b16 a[178:179], v13 offset:16896
v_mfma_f32_16x16x32_bf16 v[120:123], a[96:99], a[152:155], v[120:123]
v_mfma_f32_16x16x32_bf16 v[124:127], a[104:107], a[152:155], v[124:127]
v_mfma_f32_16x16x32_bf16 v[124:127], a[108:111], a[156:159], v[124:127]
ds_read_b128 a[124:127], v10 offset:14336
v_mfma_f32_16x16x32_bf16 v[116:119], a[108:111], a[148:151], v[116:119]
v_add_u32 v9, 32768, v9
v_add_u32 v10, 32768, v10
v_mfma_f32_16x16x32_bf16 v[116:119], a[104:107], a[144:147], v[116:119]
s_add_u32 m0, s73, 71680
s_add_u32 s64, s72, 18432
v_mfma_f32_16x16x32_bf16 v[108:111], a[104:107], a[136:139], v[108:111]
ds_read_b64_tr_b16 a[180:181], v13 offset:24576
ds_read_b64_tr_b16 a[182:183], v13 offset:25088
v_mfma_f32_16x16x32_bf16 v[108:111], a[108:111], a[140:143], v[108:111]
buffer_load_dwordx4 v5, s[12:15], s64 offen lds
v_mfma_f32_16x16x32_bf16 v[100:103], a[108:111], a[132:135], v[100:103]
v_mfma_f32_16x16x32_bf16 v[100:103], a[104:107], a[128:131], v[100:103]
s_waitcnt lgkmcnt(2)
ds_read_b64_tr_b16 a[184:185], v14 offset:16384
ds_read_b64_tr_b16 a[186:187], v14 offset:16896
v_mfma_f32_16x16x32_bf16 v[128:131], a[112:115], a[128:131], v[128:131]
v_mfma_f32_16x16x32_bf16 v[128:131], a[116:119], a[132:135], v[128:131]
v_mfma_f32_16x16x32_bf16 v[136:139], a[116:119], a[140:143], v[136:139]
ds_read_b64_tr_b16 a[188:189], v14 offset:24576
ds_read_b64_tr_b16 a[190:191], v14 offset:25088
v_mfma_f32_16x16x32_bf16 v[136:139], a[112:115], a[136:139], v[136:139]
v_mfma_f32_16x16x32_bf16 v[144:147], a[112:115], a[144:147], v[144:147]
v_mfma_f32_16x16x32_bf16 v[144:147], a[116:119], a[148:151], v[144:147]
buffer_load_dwordx4 v6, s[12:15], s64 offen offset:1024 lds
v_mfma_f32_16x16x32_bf16 v[152:155], a[116:119], a[156:159], v[152:155]
v_mfma_f32_16x16x32_bf16 v[152:155], a[112:115], a[152:155], v[152:155]
v_mfma_f32_16x16x32_bf16 v[156:159], a[120:123], a[152:155], v[156:159]
v_mfma_f32_16x16x32_bf16 v[156:159], a[124:127], a[156:159], v[156:159]
v_mfma_f32_16x16x32_bf16 v[148:151], a[124:127], a[148:151], v[148:151]
v_mfma_f32_16x16x32_bf16 v[148:151], a[120:123], a[144:147], v[148:151]
v_mfma_f32_16x16x32_bf16 v[140:143], a[120:123], a[136:139], v[140:143]
v_mfma_f32_16x16x32_bf16 v[140:143], a[124:127], a[140:143], v[140:143]
v_mfma_f32_16x16x32_bf16 v[132:135], a[124:127], a[132:135], v[132:135]
v_mfma_f32_16x16x32_bf16 v[132:135], a[120:123], a[128:131], v[132:135]
s_waitcnt lgkmcnt(0)
v_mfma_f32_16x16x32_bf16 v[160:163], a[160:163], a[64:67], v[160:163]
s_waitcnt vmcnt(17)
v_mfma_f32_16x16x32_bf16 v[160:163], a[164:167], a[68:71], v[160:163]
s_barrier
v_mfma_f32_16x16x32_bf16 v[164:167], a[172:175], a[68:71], v[164:167]
ds_read_b64_tr_b16 a[128:129], v11 offset:32768
ds_read_b64_tr_b16 a[130:131], v11 offset:33280
v_mfma_f32_16x16x32_bf16 v[164:167], a[168:171], a[64:67], v[164:167]
s_add_u32 m0, s77, 16384
s_add_u32 s64, s76, 128
v_mfma_f32_16x16x32_bf16 v[168:171], a[176:179], a[64:67], v[168:171]
buffer_load_dwordx4 v7, s[20:23], s64 offen lds
v_mfma_f32_16x16x32_bf16 v[168:171], a[180:183], a[68:71], v[168:171]
buffer_load_dword a253, v18, s[44:47], 0 offen
v_mfma_f32_16x16x32_bf16 v[172:175], a[188:191], a[68:71], v[172:175]
v_mfma_f32_16x16x32_bf16 v[172:175], a[184:187], a[64:67], v[172:175]
ds_read_b128 a[64:67], v9 offset:0
v_mfma_f32_16x16x32_bf16 v[188:191], a[184:187], a[72:75], v[188:191]
ds_read_b64_tr_b16 a[132:133], v11 offset:40960
ds_read_b64_tr_b16 a[134:135], v11 offset:41472
v_mfma_f32_16x16x32_bf16 v[188:191], a[188:191], a[76:79], v[188:191]
v_mfma_f32_16x16x32_bf16 v[184:187], a[180:183], a[76:79], v[184:187]
v_mfma_f32_16x16x32_bf16 v[184:187], a[176:179], a[72:75], v[184:187]
ds_read_b128 a[68:71], v10 offset:0
v_mfma_f32_16x16x32_bf16 v[180:183], a[168:171], a[72:75], v[180:183]
buffer_load_dwordx4 v8, s[20:23], s64 offen offset:1024 lds
v_mfma_f32_16x16x32_bf16 v[180:183], a[172:175], a[76:79], v[180:183]
v_mfma_f32_16x16x32_bf16 v[176:179], a[164:167], a[76:79], v[176:179]
v_mfma_f32_16x16x32_bf16 v[176:179], a[160:163], a[72:75], v[176:179]
ds_read_b64_tr_b16 a[136:137], v12 offset:32768
ds_read_b64_tr_b16 a[138:139], v12 offset:33280
v_mfma_f32_16x16x32_bf16 v[192:195], a[160:163], a[80:83], v[192:195]
v_mfma_f32_16x16x32_bf16 v[192:195], a[164:167], a[84:87], v[192:195]
v_mfma_f32_16x16x32_bf16 v[196:199], a[172:175], a[84:87], v[196:199]
s_add_u32 m0, s80, 16384
s_add_u32 s64, s79, 2048
ds_read_b128 a[72:75], v9 offset:2048
v_mfma_f32_16x16x32_bf16 v[196:199], a[168:171], a[80:83], v[196:199]
v_mfma_f32_16x16x32_bf16 v[200:203], a[176:179], a[80:83], v[200:203]
buffer_load_dwordx4 v4, s[24:27], s64 offen sc1 lds
v_mfma_f32_16x16x32_bf16 v[200:203], a[180:183], a[84:87], v[200:203]
s_xor_b32 s65, s70, 0
s_add_u32 s71, s68, s65
s_add_u32 s72, s69, s65
v_mfma_f32_16x16x32_bf16 v[204:207], a[188:191], a[84:87], v[204:207]
ds_read_b64_tr_b16 a[140:141], v12 offset:40960
ds_read_b64_tr_b16 a[142:143], v12 offset:41472
v_mfma_f32_16x16x32_bf16 v[204:207], a[184:187], a[80:83], v[204:207]
v_mfma_f32_16x16x32_bf16 v[220:223], a[184:187], a[88:91], v[220:223]
ds_read_b128 a[76:79], v10 offset:2048
v_mfma_f32_16x16x32_bf16 v[220:223], a[188:191], a[92:95], v[220:223]
L_PAD3:
s_cbranch_execz L_PAD7
v_mfma_f32_16x16x32_bf16 v[216:219], a[180:183], a[92:95], v[216:219]
s_add_u32 m0, s73, 0
s_add_u32 s64, s71, 0
v_mfma_f32_16x16x32_bf16 v[216:219], a[176:179], a[88:91], v[216:219]
v_mfma_f32_16x16x32_bf16 v[212:215], a[168:171], a[88:91], v[212:215]
buffer_load_dwordx4 v5, s[12:15], s64 offen lds
v_mfma_f32_16x16x32_bf16 v[212:215], a[172:175], a[92:95], v[212:215]
ds_read_b64_tr_b16 a[144:145], v13 offset:32768
ds_read_b64_tr_b16 a[146:147], v13 offset:33280
v_mfma_f32_16x16x32_bf16 v[208:211], a[164:167], a[92:95], v[208:211]
v_mfma_f32_16x16x32_bf16 v[208:211], a[160:163], a[88:91], v[208:211]
ds_read_b128 a[80:83], v9 offset:4096
v_mfma_f32_16x16x32_bf16 v[224:227], a[160:163], a[96:99], v[224:227]
v_mfma_f32_16x16x32_bf16 v[224:227], a[164:167], a[100:103], v[224:227]
v_mfma_f32_16x16x32_bf16 v[228:231], a[172:175], a[100:103], v[228:231]
ds_read_b64_tr_b16 a[148:149], v13 offset:40960
ds_read_b64_tr_b16 a[150:151], v13 offset:41472
v_mfma_f32_16x16x32_bf16 v[228:231], a[168:171], a[96:99], v[228:231]
v_mfma_f32_16x16x32_bf16 v[232:235], a[176:179], a[96:99], v[232:235]
v_mfma_f32_16x16x32_bf16 v[232:235], a[180:183], a[100:103], v[232:235]
buffer_load_dwordx4 v6, s[12:15], s64 offen offset:1024 lds
v_mfma_f32_16x16x32_bf16 v[236:239], a[188:191], a[100:103], v[236:239]
ds_read_b128 a[84:87], v10 offset:4096
v_mfma_f32_16x16x32_bf16 v[236:239], a[184:187], a[96:99], v[236:239]
v_mfma_f32_16x16x32_bf16 v[252:255], a[184:187], a[104:107], v[252:255]
v_mfma_f32_16x16x32_bf16 v[252:255], a[188:191], a[108:111], v[252:255]
ds_read_b64_tr_b16 a[152:153], v14 offset:32768
ds_read_b64_tr_b16 a[154:155], v14 offset:33280
v_mfma_f32_16x16x32_bf16 v[248:251], a[180:183], a[108:111], v[248:251]
v_mfma_f32_16x16x32_bf16 v[248:251], a[176:179], a[104:107], v[248:251]
s_add_u32 m0, s73, 2048
s_add_u32 s64, s71, 18432
v_mfma_f32_16x16x32_bf16 v[244:247], a[168:171], a[104:107], v[244:247]
ds_read_b128 a[88:91], v9 offset:6144
v_mfma_f32_16x16x32_bf16 v[244:247], a[172:175], a[108:111], v[244:247]
buffer_load_dwordx4 v5, s[12:15], s64 offen lds
v_mfma_f32_16x16x32_bf16 v[240:243], a[164:167], a[108:111], v[240:243]
v_mfma_f32_16x16x32_bf16 v[240:243], a[160:163], a[104:107], v[240:243]
ds_read_b64_tr_b16 a[156:157], v14 offset:40960
ds_read_b64_tr_b16 a[158:159], v14 offset:41472
v_mfma_f32_16x16x32_bf16 a[0:3], a[160:163], a[112:115], a[0:3]
v_mfma_f32_16x16x32_bf16 a[0:3], a[164:167], a[116:119], a[0:3]
v_mfma_f32_16x16x32_bf16 a[4:7], a[172:175], a[116:119], a[4:7]
ds_read_b128 a[92:95], v10 offset:6144
v_mfma_f32_16x16x32_bf16 a[4:7], a[168:171], a[112:115], a[4:7]
v_mfma_f32_16x16x32_bf16 a[8:11], a[176:179], a[112:115], a[8:11]
v_mfma_f32_16x16x32_bf16 a[8:11], a[180:183], a[116:119], a[8:11]
buffer_load_dwordx4 v6, s[12:15], s64 offen offset:1024 lds
v_mfma_f32_16x16x32_bf16 a[12:15], a[188:191], a[116:119], a[12:15]
v_mfma_f32_16x16x32_bf16 a[12:15], a[184:187], a[112:115], a[12:15]
v_mfma_f32_16x16x32_bf16 a[28:31], a[184:187], a[120:123], a[28:31]
v_mfma_f32_16x16x32_bf16 a[28:31], a[188:191], a[124:127], a[28:31]
v_mfma_f32_16x16x32_bf16 a[24:27], a[180:183], a[124:127], a[24:27]
v_mfma_f32_16x16x32_bf16 a[24:27], a[176:179], a[120:123], a[24:27]
v_mfma_f32_16x16x32_bf16 a[20:23], a[168:171], a[120:123], a[20:23]
v_mfma_f32_16x16x32_bf16 a[20:23], a[172:175], a[124:127], a[20:23]
v_mfma_f32_16x16x32_bf16 a[16:19], a[164:167], a[124:127], a[16:19]
v_mfma_f32_16x16x32_bf16 a[16:19], a[160:163], a[120:123], a[16:19]
s_waitcnt lgkmcnt(0)
v_mfma_f32_16x16x32_bf16 v[32:35], a[64:67], a[128:131], v[32:35]
s_waitcnt vmcnt(21)
v_mfma_f32_16x16x32_bf16 v[32:35], a[68:71], a[132:135], v[32:35]
s_barrier
v_mfma_f32_16x16x32_bf16 v[40:43], a[68:71], a[140:143], v[40:43]
ds_read_b128 a[96:99], v9 offset:8192
v_mfma_f32_16x16x32_bf16 v[40:43], a[64:67], a[136:139], v[40:43]
s_xor_b32 s75, s93, 0
s_lshl_b32 s76, s75, 19
s_add_u32 s76, s76, s74
v_mfma_f32_16x16x32_bf16 v[48:51], a[64:67], a[144:147], v[48:51]
s_lshl_b32 s79, s75, 13
s_add_u32 s79, s79, s78
v_mfma_f32_16x16x32_bf16 v[48:51], a[68:71], a[148:151], v[48:51]
s_add_u32 m0, s77, 32768
s_add_u32 s64, s76, 0
ds_read_b128 a[100:103], v10 offset:8192
v_mfma_f32_16x16x32_bf16 v[56:59], a[68:71], a[156:159], v[56:59]
buffer_load_dwordx4 v7, s[20:23], s64 offen lds
v_mfma_f32_16x16x32_bf16 v[56:59], a[64:67], a[152:155], v[56:59]
v_mfma_f32_16x16x32_bf16 v[60:63], a[72:75], a[152:155], v[60:63]
ds_read_b128 a[104:107], v9 offset:10240
v_mfma_f32_16x16x32_bf16 v[60:63], a[76:79], a[156:159], v[60:63]
v_mfma_f32_16x16x32_bf16 v[52:55], a[76:79], a[148:151], v[52:55]
v_mfma_f32_16x16x32_bf16 v[52:55], a[72:75], a[144:147], v[52:55]
ds_read_b64_tr_b16 a[160:161], v11 offset:49152
ds_read_b64_tr_b16 a[162:163], v11 offset:49664
v_mfma_f32_16x16x32_bf16 v[44:47], a[72:75], a[136:139], v[44:47]
buffer_load_dwordx4 v8, s[20:23], s64 offen offset:1024 lds
v_mfma_f32_16x16x32_bf16 v[44:47], a[76:79], a[140:143], v[44:47]
v_mfma_f32_16x16x32_bf16 v[36:39], a[76:79], a[132:135], v[36:39]
v_mfma_f32_16x16x32_bf16 v[36:39], a[72:75], a[128:131], v[36:39]
ds_read_b128 a[108:111], v10 offset:10240
v_mfma_f32_16x16x32_bf16 v[64:67], a[80:83], a[128:131], v[64:67]
v_mfma_f32_16x16x32_bf16 v[64:67], a[84:87], a[132:135], v[64:67]
v_mfma_f32_16x16x32_bf16 v[72:75], a[84:87], a[140:143], v[72:75]
s_add_u32 m0, s80, 32768
s_add_u32 s64, s79, 0
v_mfma_f32_16x16x32_bf16 v[72:75], a[80:83], a[136:139], v[72:75]
ds_read_b64_tr_b16 a[164:165], v11 offset:57344
ds_read_b64_tr_b16 a[166:167], v11 offset:57856
v_mfma_f32_16x16x32_bf16 v[80:83], a[80:83], a[144:147], v[80:83]
buffer_load_dwordx4 v4, s[24:27], s64 offen sc1 lds
v_mfma_f32_16x16x32_bf16 v[80:83], a[84:87], a[148:151], v[80:83]
ds_read_b128 a[112:115], v9 offset:12288
v_mfma_f32_16x16x32_bf16 v[88:91], a[84:87], a[156:159], v[88:91]
v_cvt_pk_bf16_f32 v32, v32, v33
v_cvt_pk_bf16_f32 v33, v34, v35
v_mfma_f32_16x16x32_bf16 v[88:91], a[80:83], a[152:155], v[88:91]
v_cvt_pk_bf16_f32 v34, v36, v37
v_cvt_pk_bf16_f32 v35, v38, v39
v_mfma_f32_16x16x32_bf16 v[92:95], a[88:91], a[152:155], v[92:95]
ds_read_b64_tr_b16 a[168:169], v12 offset:49152
ds_read_b64_tr_b16 a[170:171], v12 offset:49664
v_mfma_f32_16x16x32_bf16 v[92:95], a[92:95], a[156:159], v[92:95]
v_cvt_pk_bf16_f32 v40, v40, v41
v_cvt_pk_bf16_f32 v41, v42, v43
v_mfma_f32_16x16x32_bf16 v[84:87], a[92:95], a[148:151], v[84:87]
s_add_u32 m0, s73, 4096
s_add_u32 s64, s72, 0
s_lshr_b32 s55, s3, 1
v_mfma_f32_16x16x32_bf16 v[84:87], a[88:91], a[144:147], v[84:87]
s_lshl_b32 s55, s55, 14
s_lshl_b32 s54, s3, 13
s_sub_u32 s55, s54, s55
v_mfma_f32_16x16x32_bf16 v[76:79], a[88:91], a[136:139], v[76:79]
buffer_load_dwordx4 v5, s[12:15], s64 offen lds
v_mfma_f32_16x16x32_bf16 v[76:79], a[92:95], a[140:143], v[76:79]
s_and_b32 s54, s3, 1
s_lshl_b32 s54, s54, 12
ds_read_b128 a[116:119], v10 offset:12288
v_mfma_f32_16x16x32_bf16 v[68:71], a[92:95], a[132:135], v[68:71]
s_add_u32 s53, s88, 0
v_cvt_pk_bf16_f32 v42, v44, v45
v_cvt_pk_bf16_f32 v43, v46, v47
v_mfma_f32_16x16x32_bf16 v[68:71], a[88:91], a[128:131], v[68:71]
s_waitcnt lgkmcnt(6)
ds_read_b64_tr_b16 a[172:173], v12 offset:57344
ds_read_b64_tr_b16 a[174:175], v12 offset:57856
v_mfma_f32_16x16x32_bf16 v[96:99], a[96:99], a[128:131], v[96:99]
buffer_store_dwordx4 v[32:35], v4, s[24:27], s53 offen offset:0 sc1
v_mfma_f32_16x16x32_bf16 v[96:99], a[100:103], a[132:135], v[96:99]
v_cvt_pk_bf16_f32 v48, v48, v49
v_cvt_pk_bf16_f32 v49, v50, v51
v_mfma_f32_16x16x32_bf16 v[104:107], a[100:103], a[140:143], v[104:107]
ds_read_b128 a[120:123], v9 offset:14336
v_cvt_pk_bf16_f32 v50, v52, v53
v_mfma_f32_16x16x32_bf16 v[104:107], a[96:99], a[136:139], v[104:107]
v_cvt_pk_bf16_f32 v51, v54, v55
v_cvt_pk_bf16_f32 v56, v56, v57
v_mfma_f32_16x16x32_bf16 v[112:115], a[96:99], a[144:147], v[112:115]
v_cvt_pk_bf16_f32 v57, v58, v59
v_cvt_pk_bf16_f32 v58, v60, v61
v_mfma_f32_16x16x32_bf16 v[112:115], a[100:103], a[148:151], v[112:115]
buffer_load_dwordx4 v6, s[12:15], s64 offen offset:1024 lds
v_mfma_f32_16x16x32_bf16 v[120:123], a[100:103], a[156:159], v[120:123]
ds_read_b64_tr_b16 a[176:177], v13 offset:49152
ds_read_b64_tr_b16 a[178:179], v13 offset:49664
v_mfma_f32_16x16x32_bf16 v[120:123], a[96:99], a[152:155], v[120:123]
v_cvt_pk_bf16_f32 v59, v62, v63
v_cvt_pk_bf16_f32 v64, v64, v65
v_mfma_f32_16x16x32_bf16 v[124:127], a[104:107], a[152:155], v[124:127]
v_cvt_pk_bf16_f32 v65, v66, v67
v_cvt_pk_bf16_f32 v66, v68, v69
v_mfma_f32_16x16x32_bf16 v[124:127], a[108:111], a[156:159], v[124:127]
ds_read_b128 a[124:127], v10 offset:14336
v_cvt_pk_bf16_f32 v67, v70, v71
v_mfma_f32_16x16x32_bf16 v[116:119], a[108:111], a[148:151], v[116:119]
v_add_u32 v9, 32768, v9
v_add_u32 v10, 32768, v10
v_mfma_f32_16x16x32_bf16 v[116:119], a[104:107], a[144:147], v[116:119]
s_add_u32 m0, s73, 6144
s_add_u32 s64, s72, 18432
v_cvt_pk_bf16_f32 v72, v72, v73
v_mfma_f32_16x16x32_bf16 v[108:111], a[104:107], a[136:139], v[108:111]
ds_read_b64_tr_b16 a[180:181], v13 offset:57344
ds_read_b64_tr_b16 a[182:183], v13 offset:57856
v_mfma_f32_16x16x32_bf16 v[108:111], a[108:111], a[140:143], v[108:111]
buffer_load_dwordx4 v5, s[12:15], s64 offen lds
v_mfma_f32_16x16x32_bf16 v[100:103], a[108:111], a[132:135], v[100:103]
v_cvt_pk_bf16_f32 v73, v74, v75
v_cvt_pk_bf16_f32 v74, v76, v77
v_mfma_f32_16x16x32_bf16 v[100:103], a[104:107], a[128:131], v[100:103]
s_waitcnt lgkmcnt(2)
ds_read_b64_tr_b16 a[184:185], v14 offset:49152
ds_read_b64_tr_b16 a[186:187], v14 offset:49664
v_mfma_f32_16x16x32_bf16 v[128:131], a[112:115], a[128:131], v[128:131]
v_cvt_pk_bf16_f32 v75, v78, v79
v_cvt_pk_bf16_f32 v80, v80, v81
v_mfma_f32_16x16x32_bf16 v[128:131], a[116:119], a[132:135], v[128:131]
v_cvt_pk_bf16_f32 v81, v82, v83
v_cvt_pk_bf16_f32 v82, v84, v85
v_mfma_f32_16x16x32_bf16 v[136:139], a[116:119], a[140:143], v[136:139]
ds_read_b64_tr_b16 a[188:189], v14 offset:57344
ds_read_b64_tr_b16 a[190:191], v14 offset:57856
v_mfma_f32_16x16x32_bf16 v[136:139], a[112:115], a[136:139], v[136:139]
v_add_u32 v9, s55, v9
v_add_u32 v10, s55, v10
v_mfma_f32_16x16x32_bf16 v[144:147], a[112:115], a[144:147], v[144:147]
v_subrev_u32 v11, s54, v11
v_subrev_u32 v12, s54, v12
v_mfma_f32_16x16x32_bf16 v[144:147], a[116:119], a[148:151], v[144:147]
buffer_load_dwordx4 v6, s[12:15], s64 offen offset:1024 lds
v_mfma_f32_16x16x32_bf16 v[152:155], a[116:119], a[156:159], v[152:155]
v_subrev_u32 v13, s54, v13
v_subrev_u32 v14, s54, v14
v_mfma_f32_16x16x32_bf16 v[152:155], a[112:115], a[152:155], v[152:155]
v_cvt_pk_bf16_f32 v83, v86, v87
v_cvt_pk_bf16_f32 v88, v88, v89
v_mfma_f32_16x16x32_bf16 v[156:159], a[120:123], a[152:155], v[156:159]
v_cvt_pk_bf16_f32 v89, v90, v91
v_cvt_pk_bf16_f32 v90, v92, v93
v_mfma_f32_16x16x32_bf16 v[156:159], a[124:127], a[156:159], v[156:159]
s_add_u32 s53, s88, 0
v_cvt_pk_bf16_f32 v91, v94, v95
v_cvt_pk_bf16_f32 v96, v96, v97
v_mfma_f32_16x16x32_bf16 v[148:151], a[124:127], a[148:151], v[148:151]
buffer_store_dwordx4 v[40:43], v4, s[24:27], s53 offen offset:1024 sc1
v_mfma_f32_16x16x32_bf16 v[148:151], a[120:123], a[144:147], v[148:151]
v_cvt_pk_bf16_f32 v97, v98, v99
v_cvt_pk_bf16_f32 v98, v100, v101
v_mfma_f32_16x16x32_bf16 v[140:143], a[120:123], a[136:139], v[140:143]
v_cvt_pk_bf16_f32 v99, v102, v103
v_cvt_pk_bf16_f32 v104, v104, v105
v_mfma_f32_16x16x32_bf16 v[140:143], a[124:127], a[140:143], v[140:143]
v_cvt_pk_bf16_f32 v105, v106, v107
v_cvt_pk_bf16_f32 v106, v108, v109
v_mfma_f32_16x16x32_bf16 v[132:135], a[124:127], a[132:135], v[132:135]
v_cvt_pk_bf16_f32 v107, v110, v111
v_cvt_pk_bf16_f32 v112, v112, v113
v_mfma_f32_16x16x32_bf16 v[132:135], a[120:123], a[128:131], v[132:135]
s_waitcnt lgkmcnt(0)
v_cvt_pk_bf16_f32 v113, v114, v115
v_cvt_pk_bf16_f32 v114, v116, v117
v_mfma_f32_16x16x32_bf16 v[160:163], a[160:163], a[64:67], v[160:163]
s_waitcnt vmcnt(17)
v_cvt_pk_bf16_f32 v115, v118, v119
v_cvt_pk_bf16_f32 v120, v120, v121
v_mfma_f32_16x16x32_bf16 v[160:163], a[164:167], a[68:71], v[160:163]
s_barrier
v_mfma_f32_16x16x32_bf16 v[164:167], a[172:175], a[68:71], v[164:167]
ds_read_b64_tr_b16 a[128:129], v11 offset:0
ds_read_b64_tr_b16 a[130:131], v11 offset:512
v_mfma_f32_16x16x32_bf16 v[164:167], a[168:171], a[64:67], v[164:167]
s_add_u32 m0, s77, 49152
s_add_u32 s64, s76, 128
v_cvt_pk_bf16_f32 v121, v122, v123
v_mfma_f32_16x16x32_bf16 v[168:171], a[176:179], a[64:67], v[168:171]
buffer_load_dwordx4 v7, s[20:23], s64 offen lds
v_mfma_f32_16x16x32_bf16 v[168:171], a[180:183], a[68:71], v[168:171]
ds_read_b64_tr_b16 a[132:133], v11 offset:4096
ds_read_b64_tr_b16 a[134:135], v11 offset:4608
v_mfma_f32_16x16x32_bf16 v[172:175], a[188:191], a[68:71], v[172:175]
v_cvt_pk_bf16_f32 v122, v124, v125
v_cvt_pk_bf16_f32 v123, v126, v127
v_mfma_f32_16x16x32_bf16 v[172:175], a[184:187], a[64:67], v[172:175]
v_cvt_pk_bf16_f32 v128, v128, v129
v_cvt_pk_bf16_f32 v129, v130, v131
v_mfma_f32_16x16x32_bf16 v[188:191], a[184:187], a[72:75], v[188:191]
ds_read_b64_tr_b16 a[136:137], v12 offset:0
ds_read_b64_tr_b16 a[138:139], v12 offset:512
v_mfma_f32_16x16x32_bf16 v[188:191], a[188:191], a[76:79], v[188:191]
v_cvt_pk_bf16_f32 v130, v132, v133
v_cvt_pk_bf16_f32 v131, v134, v135
v_mfma_f32_16x16x32_bf16 v[184:187], a[180:183], a[76:79], v[184:187]
v_cvt_pk_bf16_f32 v136, v136, v137
v_cvt_pk_bf16_f32 v137, v138, v139
v_mfma_f32_16x16x32_bf16 v[184:187], a[176:179], a[72:75], v[184:187]
ds_read_b64_tr_b16 a[140:141], v12 offset:4096
ds_read_b64_tr_b16 a[142:143], v12 offset:4608
v_mfma_f32_16x16x32_bf16 v[180:183], a[168:171], a[72:75], v[180:183]
buffer_load_dwordx4 v8, s[20:23], s64 offen offset:1024 lds
v_mfma_f32_16x16x32_bf16 v[180:183], a[172:175], a[76:79], v[180:183]
v_cvt_pk_bf16_f32 v138, v140, v141
v_cvt_pk_bf16_f32 v139, v142, v143
v_mfma_f32_16x16x32_bf16 v[176:179], a[164:167], a[76:79], v[176:179]
v_cvt_pk_bf16_f32 v144, v144, v145
v_cvt_pk_bf16_f32 v145, v146, v147
v_mfma_f32_16x16x32_bf16 v[176:179], a[160:163], a[72:75], v[176:179]
ds_read_b64_tr_b16 a[144:145], v13 offset:0
ds_read_b64_tr_b16 a[146:147], v13 offset:512
v_mfma_f32_16x16x32_bf16 v[192:195], a[160:163], a[80:83], v[192:195]
v_cvt_pk_bf16_f32 v146, v148, v149
v_cvt_pk_bf16_f32 v147, v150, v151
v_mfma_f32_16x16x32_bf16 v[192:195], a[164:167], a[84:87], v[192:195]
v_cvt_pk_bf16_f32 v152, v152, v153
v_cvt_pk_bf16_f32 v153, v154, v155
v_mfma_f32_16x16x32_bf16 v[196:199], a[172:175], a[84:87], v[196:199]
s_add_u32 m0, s80, 49152
s_add_u32 s64, s79, 2048
v_cvt_pk_bf16_f32 v154, v156, v157
v_mfma_f32_16x16x32_bf16 v[196:199], a[168:171], a[80:83], v[196:199]
ds_read_b64_tr_b16 a[148:149], v13 offset:4096
ds_read_b64_tr_b16 a[150:151], v13 offset:4608
v_mfma_f32_16x16x32_bf16 v[200:203], a[176:179], a[80:83], v[200:203]
buffer_load_dwordx4 v4, s[24:27], s64 offen sc1 lds
v_mfma_f32_16x16x32_bf16 v[200:203], a[180:183], a[84:87], v[200:203]
s_xor_b32 s65, s70, 128
s_add_u32 s71, s68, s65
s_add_u32 s72, s69, s65
v_mfma_f32_16x16x32_bf16 v[204:207], a[188:191], a[84:87], v[204:207]
s_add_u32 s53, s88, 0
ds_read_b64_tr_b16 a[152:153], v14 offset:0
ds_read_b64_tr_b16 a[154:155], v14 offset:512
v_mfma_f32_16x16x32_bf16 v[204:207], a[184:187], a[80:83], v[204:207]
buffer_store_dwordx4 v[48:51], v4, s[24:27], s53 offen offset:2048 sc1
v_mfma_f32_16x16x32_bf16 v[220:223], a[184:187], a[88:91], v[220:223]
ds_read_b64_tr_b16 a[156:157], v14 offset:4096
ds_read_b64_tr_b16 a[158:159], v14 offset:4608
v_mfma_f32_16x16x32_bf16 v[220:223], a[188:191], a[92:95], v[220:223]
v_cvt_pk_bf16_f32 v155, v158, v159
v_mul_f32 v160, s91, v160
v_mfma_f32_16x16x32_bf16 v[216:219], a[180:183], a[92:95], v[216:219]
s_add_u32 m0, s73, 32768
s_add_u32 s64, s71, 0
v_mul_f32 v161, s91, v161
v_mfma_f32_16x16x32_bf16 v[216:219], a[176:179], a[88:91], v[216:219]
v_mul_f32 v162, s91, v162
v_mul_f32 v163, s91, v163
v_mfma_f32_16x16x32_bf16 v[212:215], a[168:171], a[88:91], v[212:215]
buffer_load_dwordx4 v5, s[12:15], s64 offen lds
v_mfma_f32_16x16x32_bf16 v[212:215], a[172:175], a[92:95], v[212:215]
ds_read_b128 a[68:71], v4 offset:10240
v_mul_f32 v164, s91, v164
v_mfma_f32_16x16x32_bf16 v[208:211], a[164:167], a[92:95], v[208:211]
v_mul_f32 v165, s91, v165
v_mul_f32 v166, s91, v166
v_mfma_f32_16x16x32_bf16 v[208:211], a[160:163], a[88:91], v[208:211]
ds_read_b128 a[64:67], v4 offset:8192
v_mul_f32 v167, s91, v167
v_mfma_f32_16x16x32_bf16 v[224:227], a[160:163], a[96:99], v[224:227]
v_cvt_pk_bf16_f32 v160, v160, v161
v_cvt_pk_bf16_f32 v161, v162, v163
v_mfma_f32_16x16x32_bf16 v[224:227], a[164:167], a[100:103], v[224:227]
v_cvt_pk_bf16_f32 v162, v164, v165
v_cvt_pk_bf16_f32 v163, v166, v167
v_mfma_f32_16x16x32_bf16 v[228:231], a[172:175], a[100:103], v[228:231]
ds_read_b128 a[76:79], v4 offset:11264
v_mul_f32 v168, s91, v168
v_mfma_f32_16x16x32_bf16 v[228:231], a[168:171], a[96:99], v[228:231]
v_mul_f32 v169, s91, v169
v_mul_f32 v170, s91, v170
v_mfma_f32_16x16x32_bf16 v[232:235], a[176:179], a[96:99], v[232:235]
v_mul_f32 v171, s91, v171
v_mul_f32 v172, s91, v172
v_mfma_f32_16x16x32_bf16 v[232:235], a[180:183], a[100:103], v[232:235]
buffer_load_dwordx4 v6, s[12:15], s64 offen offset:1024 lds
v_mfma_f32_16x16x32_bf16 v[236:239], a[188:191], a[100:103], v[236:239]
ds_read_b128 a[72:75], v4 offset:9216
v_mul_f32 v173, s91, v173
v_mfma_f32_16x16x32_bf16 v[236:239], a[184:187], a[96:99], v[236:239]
v_mul_f32 v174, s91, v174
v_mul_f32 v175, s91, v175
v_mfma_f32_16x16x32_bf16 v[252:255], a[184:187], a[104:107], v[252:255]
v_cvt_pk_bf16_f32 v168, v168, v169
v_cvt_pk_bf16_f32 v169, v170, v171
v_mfma_f32_16x16x32_bf16 v[252:255], a[188:191], a[108:111], v[252:255]
ds_read_b128 a[84:87], v10 offset:0
v_cvt_pk_bf16_f32 v170, v172, v173
v_mfma_f32_16x16x32_bf16 v[248:251], a[180:183], a[108:111], v[248:251]
v_cvt_pk_bf16_f32 v171, v174, v175
v_mul_f32 v176, s91, v176
v_mfma_f32_16x16x32_bf16 v[248:251], a[176:179], a[104:107], v[248:251]
s_add_u32 m0, s73, 34816
s_add_u32 s64, s71, 18432
v_mul_f32 v177, s91, v177
v_mfma_f32_16x16x32_bf16 v[244:247], a[168:171], a[104:107], v[244:247]
ds_read_b128 a[80:83], v9 offset:0
v_mul_f32 v178, s91, v178
v_mfma_f32_16x16x32_bf16 v[244:247], a[172:175], a[108:111], v[244:247]
buffer_load_dwordx4 v5, s[12:15], s64 offen lds
v_mfma_f32_16x16x32_bf16 v[240:243], a[164:167], a[108:111], v[240:243]
v_mul_f32 v179, s91, v179
v_mul_f32 v180, s91, v180
v_mfma_f32_16x16x32_bf16 v[240:243], a[160:163], a[104:107], v[240:243]
s_add_u32 s53, s88, 0
ds_read_b128 a[92:95], v10 offset:2048
v_mul_f32 v181, s91, v181
v_mfma_f32_16x16x32_bf16 a[0:3], a[160:163], a[112:115], a[0:3]
buffer_store_dwordx4 v[56:59], v4, s[24:27], s53 offen offset:3072 sc1
v_mfma_f32_16x16x32_bf16 a[0:3], a[164:167], a[116:119], a[0:3]
v_mul_f32 v182, s91, v182
v_mul_f32 v183, s91, v183
v_mfma_f32_16x16x32_bf16 a[4:7], a[172:175], a[116:119], a[4:7]
ds_read_b128 a[88:91], v9 offset:2048
v_cvt_pk_bf16_f32 v176, v176, v177
v_mfma_f32_16x16x32_bf16 a[4:7], a[168:171], a[112:115], a[4:7]
v_cvt_pk_bf16_f32 v177, v178, v179
v_cvt_pk_bf16_f32 v178, v180, v181
v_mfma_f32_16x16x32_bf16 a[8:11], a[176:179], a[112:115], a[8:11]
v_cvt_pk_bf16_f32 v179, v182, v183
v_mul_f32 v184, s91, v184
v_mfma_f32_16x16x32_bf16 a[8:11], a[180:183], a[116:119], a[8:11]
buffer_load_dwordx4 v6, s[12:15], s64 offen offset:1024 lds
v_mfma_f32_16x16x32_bf16 a[12:15], a[188:191], a[116:119], a[12:15]
v_mul_f32 v185, s91, v185
v_mul_f32 v186, s91, v186
v_mfma_f32_16x16x32_bf16 a[12:15], a[184:187], a[112:115], a[12:15]
v_mul_f32 v187, s91, v187
v_mul_f32 v188, s91, v188
v_mfma_f32_16x16x32_bf16 a[28:31], a[184:187], a[120:123], a[28:31]
v_mul_f32 v189, s91, v189
v_mul_f32 v190, s91, v190
v_mfma_f32_16x16x32_bf16 a[28:31], a[188:191], a[124:127], a[28:31]
v_mul_f32 v191, s91, v191
v_cvt_pk_bf16_f32 v184, v184, v185
v_mfma_f32_16x16x32_bf16 a[24:27], a[180:183], a[124:127], a[24:27]
v_cvt_pk_bf16_f32 v185, v186, v187
v_cvt_pk_bf16_f32 v186, v188, v189
v_mfma_f32_16x16x32_bf16 a[24:27], a[176:179], a[120:123], a[24:27]
v_cvt_pk_bf16_f32 v187, v190, v191
v_mul_f32 v192, s91, v192
v_mfma_f32_16x16x32_bf16 a[20:23], a[168:171], a[120:123], a[20:23]
v_mul_f32 v193, s91, v193
v_mul_f32 v194, s91, v194
v_mfma_f32_16x16x32_bf16 a[20:23], a[172:175], a[124:127], a[20:23]
v_mul_f32 v195, s91, v195
v_mul_f32 v196, s91, v196
v_mfma_f32_16x16x32_bf16 a[16:19], a[164:167], a[124:127], a[16:19]
v_mul_f32 v197, s91, v197
v_mul_f32 v198, s91, v198
v_mfma_f32_16x16x32_bf16 a[16:19], a[160:163], a[120:123], a[16:19]
s_waitcnt lgkmcnt(0)
v_mul_f32 v199, s91, v199
v_cvt_pk_bf16_f32 v192, v192, v193
v_mfma_f32_16x16x32_bf16 v[36:39], a[128:131], a[80:83], 0
s_waitcnt vmcnt(22)
v_cvt_pk_bf16_f32 v193, v194, v195
v_cvt_pk_bf16_f32 v194, v196, v197
v_mfma_f32_16x16x32_bf16 v[36:39], a[132:135], a[84:87], v[36:39]
s_barrier
v_mfma_f32_16x16x32_bf16 v[44:47], a[140:143], a[84:87], 0
ds_read_b128 a[96:99], v9 offset:4096
v_cvt_pk_bf16_f32 v195, v198, v199
v_mfma_f32_16x16x32_bf16 v[44:47], a[136:139], a[80:83], v[44:47]
s_xor_b32 s75, s93, 1
s_lshl_b32 s76, s75, 19
s_add_u32 s76, s76, s74
v_mfma_f32_16x16x32_bf16 v[32:35], a[144:147], a[80:83], 0
s_lshl_b32 s79, s75, 13
s_add_u32 s79, s79, s78
ds_read_b128 a[100:103], v10 offset:4096
v_mfma_f32_16x16x32_bf16 v[32:35], a[148:151], a[84:87], v[32:35]
s_add_u32 m0, s77, 0
s_add_u32 s64, s76, 0
ds_read_b128 a[104:107], v9 offset:6144
v_mfma_f32_16x16x32_bf16 v[52:55], a[156:159], a[84:87], 0
buffer_load_dwordx4 v7, s[20:23], s64 offen lds
v_mfma_f32_16x16x32_bf16 v[52:55], a[152:155], a[80:83], v[52:55]
ds_read_b64_tr_b16 a[160:161], v11 offset:16384
ds_read_b64_tr_b16 a[162:163], v11 offset:16896
v_mfma_f32_16x16x32_bf16 v[60:63], a[64:67], a[80:83], 0
v_mul_f32 v200, s91, v200
v_mul_f32 v201, s91, v201
v_mfma_f32_16x16x32_bf16 v[60:63], a[68:71], a[84:87], v[60:63]
ds_read_b128 a[108:111], v10 offset:6144
v_mul_f32 v202, s91, v202
v_mfma_f32_16x16x32_bf16 v[68:71], a[76:79], a[84:87], 0
buffer_load_dwordx4 v8, s[20:23], s64 offen offset:1024 lds
v_mfma_f32_16x16x32_bf16 v[68:71], a[72:75], a[80:83], v[68:71]
s_add_u32 s53, s88, 262144
ds_read_b64_tr_b16 a[164:165], v11 offset:20480
ds_read_b64_tr_b16 a[166:167], v11 offset:20992
v_mfma_f32_16x16x32_bf16 v[76:79], a[72:75], a[88:91], 0
v_add_u32 v9, -65536, v9
v_add_u32 v10, -65536, v10
v_mfma_f32_16x16x32_bf16 v[76:79], a[76:79], a[92:95], v[76:79]
ds_read_b64_tr_b16 a[168:169], v12 offset:16384
ds_read_b64_tr_b16 a[170:171], v12 offset:16896
v_mfma_f32_16x16x32_bf16 v[84:87], a[68:71], a[92:95], 0
s_add_u32 m0, s80, 0
s_add_u32 s64, s79, 0
v_mul_f32 v203, s91, v203
v_mfma_f32_16x16x32_bf16 v[84:87], a[64:67], a[88:91], v[84:87]
ds_read_b64_tr_b16 a[172:173], v12 offset:20480
ds_read_b64_tr_b16 a[174:175], v12 offset:20992
v_mfma_f32_16x16x32_bf16 v[92:95], a[152:155], a[88:91], 0
buffer_load_dwordx4 v4, s[24:27], s64 offen sc1 lds
v_mfma_f32_16x16x32_bf16 v[92:95], a[156:159], a[92:95], v[92:95]
buffer_store_dwordx4 v[64:67], v4, s[24:27], s53 offen offset:0 sc1
v_mfma_f32_16x16x32_bf16 v[40:43], a[148:151], a[92:95], 0
ds_read_b64_tr_b16 a[176:177], v13 offset:16384
ds_read_b64_tr_b16 a[178:179], v13 offset:16896
v_mfma_f32_16x16x32_bf16 v[40:43], a[144:147], a[88:91], v[40:43]
v_mul_f32 v204, s91, v204
v_mul_f32 v205, s91, v205
v_mfma_f32_16x16x32_bf16 v[100:103], a[136:139], a[88:91], 0
s_add_u32 m0, s73, 36864
s_add_u32 s64, s72, 0
v_mul_f32 v206, s91, v206
v_mfma_f32_16x16x32_bf16 v[100:103], a[140:143], a[92:95], v[100:103]
ds_read_b64_tr_b16 a[180:181], v13 offset:20480
ds_read_b64_tr_b16 a[182:183], v13 offset:20992
v_mfma_f32_16x16x32_bf16 v[108:111], a[132:135], a[92:95], 0
buffer_load_dwordx4 v5, s[12:15], s64 offen lds
v_mfma_f32_16x16x32_bf16 v[108:111], a[128:131], a[88:91], v[108:111]
s_waitcnt lgkmcnt(14)
ds_read_b64_tr_b16 a[184:185], v14 offset:16384
ds_read_b64_tr_b16 a[186:187], v14 offset:16896
v_mfma_f32_16x16x32_bf16 v[116:119], a[128:131], a[96:99], 0
ds_read_b64_tr_b16 a[188:189], v14 offset:20480
ds_read_b64_tr_b16 a[190:191], v14 offset:20992
v_mfma_f32_16x16x32_bf16 v[116:119], a[132:135], a[100:103], v[116:119]
v_mul_f32 v207, s91, v207
v_cvt_pk_bf16_f32 v200, v200, v201
v_mfma_f32_16x16x32_bf16 v[124:127], a[140:143], a[100:103], 0
v_cvt_pk_bf16_f32 v201, v202, v203
v_cvt_pk_bf16_f32 v202, v204, v205
v_mfma_f32_16x16x32_bf16 v[124:127], a[136:139], a[96:99], v[124:127]
ds_read_b128 a[112:115], v4 offset:24576
v_cvt_pk_bf16_f32 v203, v206, v207
v_mfma_f32_16x16x32_bf16 v[132:135], a[144:147], a[96:99], 0
buffer_load_dwordx4 v6, s[12:15], s64 offen offset:1024 lds
v_mfma_f32_16x16x32_bf16 v[132:135], a[148:151], a[100:103], v[132:135]
ds_read_b128 a[116:119], v4 offset:26624
v_mul_f32 v208, s91, v208
v_mfma_f32_16x16x32_bf16 v[140:143], a[156:159], a[100:103], 0
v_mul_f32 v209, s91, v209
v_mul_f32 v210, s91, v210
v_mfma_f32_16x16x32_bf16 v[140:143], a[152:155], a[96:99], v[140:143]
ds_read_b128 a[120:123], v4 offset:25600
v_mul_f32 v211, s91, v211
v_mfma_f32_16x16x32_bf16 v[148:151], a[64:67], a[96:99], 0
s_add_u32 m0, s73, 38912
s_add_u32 s64, s72, 18432
v_mul_f32 v212, s91, v212
v_mfma_f32_16x16x32_bf16 v[148:151], a[68:71], a[100:103], v[148:151]
ds_read_b128 a[124:127], v4 offset:27648
v_mul_f32 v213, s91, v213
v_mfma_f32_16x16x32_bf16 v[48:51], a[76:79], a[100:103], 0
buffer_load_dwordx4 v5, s[12:15], s64 offen lds
v_mfma_f32_16x16x32_bf16 v[48:51], a[72:75], a[96:99], v[48:51]
s_waitcnt lgkmcnt(15)
v_mul_f32 v214, s91, v214
v_mul_f32 v215, s91, v215
v_mfma_f32_16x16x32_bf16 v[156:159], a[72:75], a[104:107], 0
v_cvt_pk_bf16_f32 v208, v208, v209
v_cvt_pk_bf16_f32 v209, v210, v211
v_mfma_f32_16x16x32_bf16 v[156:159], a[76:79], a[108:111], v[156:159]
s_add_u32 s53, s88, 262144
v_cvt_pk_bf16_f32 v210, v212, v213
v_cvt_pk_bf16_f32 v211, v214, v215
v_mfma_f32_16x16x32_bf16 v[164:167], a[68:71], a[108:111], 0
buffer_store_dwordx4 v[72:75], v4, s[24:27], s53 offen offset:1024 sc1
v_mfma_f32_16x16x32_bf16 v[164:167], a[64:67], a[104:107], v[164:167]
v_mul_f32 v216, s91, v216
v_mul_f32 v217, s91, v217
v_mfma_f32_16x16x32_bf16 v[172:175], a[152:155], a[104:107], 0
buffer_load_dwordx4 v6, s[12:15], s64 offen offset:1024 lds
v_mfma_f32_16x16x32_bf16 v[172:175], a[156:159], a[108:111], v[172:175]
v_mul_f32 v218, s91, v218
v_mul_f32 v219, s91, v219
v_mfma_f32_16x16x32_bf16 v[56:59], a[148:151], a[108:111], 0
v_mul_f32 v220, s91, v220
v_mul_f32 v221, s91, v221
v_mfma_f32_16x16x32_bf16 v[56:59], a[144:147], a[104:107], v[56:59]
v_mul_f32 v222, s91, v222
v_mul_f32 v223, s91, v223
v_mfma_f32_16x16x32_bf16 v[180:183], a[136:139], a[104:107], 0
v_cvt_pk_bf16_f32 v216, v216, v217
v_cvt_pk_bf16_f32 v217, v218, v219
v_mfma_f32_16x16x32_bf16 v[180:183], a[140:143], a[108:111], v[180:183]
v_cvt_pk_bf16_f32 v218, v220, v221
v_cvt_pk_bf16_f32 v219, v222, v223
v_mfma_f32_16x16x32_bf16 v[188:191], a[132:135], a[108:111], 0
v_mul_f32 v224, s91, v224
v_mul_f32 v225, s91, v225
v_mfma_f32_16x16x32_bf16 v[188:191], a[128:131], a[104:107], v[188:191]
s_waitcnt lgkmcnt(0)
v_mul_f32 v226, s91, v226
v_mul_f32 v227, s91, v227
v_mfma_f32_16x16x32_bf16 v[196:199], a[160:163], a[80:83], 0
s_waitcnt vmcnt(19)
v_mul_f32 v228, s91, v228
v_mul_f32 v229, s91, v229
v_mfma_f32_16x16x32_bf16 v[196:199], a[164:167], a[84:87], v[196:199]
s_barrier
v_mfma_f32_16x16x32_bf16 v[64:67], a[172:175], a[84:87], 0
L_PAD4:
s_cbranch_execz L_PAD8
ds_read_b64_tr_b16 a[128:129], v11 offset:32768
ds_read_b64_tr_b16 a[130:131], v11 offset:33280
v_mfma_f32_16x16x32_bf16 v[64:67], a[168:171], a[80:83], v[64:67]
s_add_u32 m0, s77, 16384
s_add_u32 s64, s76, 128
v_mul_f32 v230, s91, v230
v_mfma_f32_16x16x32_bf16 v[204:207], a[176:179], a[80:83], 0
buffer_load_dwordx4 v7, s[20:23], s64 offen lds
v_mfma_f32_16x16x32_bf16 v[204:207], a[180:183], a[84:87], v[204:207]
ds_read_b64_tr_b16 a[132:133], v11 offset:36864
ds_read_b64_tr_b16 a[134:135], v11 offset:37376
v_mfma_f32_16x16x32_bf16 v[212:215], a[188:191], a[84:87], 0
ds_read_b64_tr_b16 a[136:137], v12 offset:32768
ds_read_b64_tr_b16 a[138:139], v12 offset:33280
v_mfma_f32_16x16x32_bf16 v[212:215], a[184:187], a[80:83], v[212:215]
ds_read_b64_tr_b16 a[140:141], v12 offset:36864
ds_read_b64_tr_b16 a[142:143], v12 offset:37376
v_mfma_f32_16x16x32_bf16 v[72:75], a[112:115], a[80:83], 0
v_mul_f32 v231, s91, v231
v_cvt_pk_bf16_f32 v224, v224, v225
v_mfma_f32_16x16x32_bf16 v[72:75], a[116:119], a[84:87], v[72:75]
ds_read_b64_tr_b16 a[144:145], v13 offset:32768
ds_read_b64_tr_b16 a[146:147], v13 offset:33280
v_mfma_f32_16x16x32_bf16 v[220:223], a[124:127], a[84:87], 0
buffer_load_dwordx4 v8, s[20:23], s64 offen offset:1024 lds
v_mfma_f32_16x16x32_bf16 v[220:223], a[120:123], a[80:83], v[220:223]
ds_read_b64_tr_b16 a[148:149], v13 offset:36864
ds_read_b64_tr_b16 a[150:151], v13 offset:37376
v_mfma_f32_16x16x32_bf16 a[32:35], a[120:123], a[88:91], 0
v_cvt_pk_bf16_f32 v225, v226, v227
v_cvt_pk_bf16_f32 v226, v228, v229
v_mfma_f32_16x16x32_bf16 a[32:35], a[124:127], a[92:95], a[32:35]
ds_read_b64_tr_b16 a[152:153], v14 offset:32768
ds_read_b64_tr_b16 a[154:155], v14 offset:33280
v_mfma_f32_16x16x32_bf16 a[36:39], a[116:119], a[92:95], 0
s_add_u32 m0, s80, 16384
s_add_u32 s64, s79, 2048
v_cvt_pk_bf16_f32 v227, v230, v231
v_mfma_f32_16x16x32_bf16 a[36:39], a[112:115], a[88:91], a[36:39]
ds_read_b64_tr_b16 a[156:157], v14 offset:36864
ds_read_b64_tr_b16 a[158:159], v14 offset:37376
v_mfma_f32_16x16x32_bf16 v[228:231], a[184:187], a[88:91], 0
buffer_load_dwordx4 v4, s[24:27], s64 offen sc1 lds
v_mfma_f32_16x16x32_bf16 v[228:231], a[188:191], a[92:95], v[228:231]
s_xor_b32 s65, s70, 256
s_add_u32 s71, s68, s65
s_add_u32 s72, s69, s65
v_mfma_f32_16x16x32_bf16 a[40:43], a[180:183], a[92:95], 0
s_add_u32 s53, s88, 262144
ds_read_b128 a[64:67], v4 offset:40960
v_mul_f32 v232, s91, v232
v_mfma_f32_16x16x32_bf16 a[40:43], a[176:179], a[88:91], a[40:43]
buffer_store_dwordx4 v[80:83], v4, s[24:27], s53 offen offset:2048 sc1
v_mfma_f32_16x16x32_bf16 a[44:47], a[168:171], a[88:91], 0
s_add_u32 m0, s73, 65536
s_add_u32 s64, s71, 0
ds_read_b128 a[80:83], v9 offset:0
v_mfma_f32_16x16x32_bf16 a[44:47], a[172:175], a[92:95], a[44:47]
v_mul_f32 v233, s91, v233
v_mul_f32 v234, s91, v234
v_mfma_f32_16x16x32_bf16 v[80:83], a[164:167], a[92:95], 0
buffer_load_dwordx4 v5, s[12:15], s64 offen lds
v_mfma_f32_16x16x32_bf16 v[80:83], a[160:163], a[88:91], v[80:83]
ds_read_b128 a[68:71], v4 offset:43008
v_mul_f32 v235, s91, v235
v_mfma_f32_16x16x32_bf16 a[48:51], a[160:163], a[96:99], 0
ds_read_b128 a[84:87], v10 offset:0
v_mul_f32 v236, s91, v236
v_mfma_f32_16x16x32_bf16 a[48:51], a[164:167], a[100:103], a[48:51]
v_mul_f32 v237, s91, v237
v_mul_f32 v238, s91, v238
v_mfma_f32_16x16x32_bf16 a[52:55], a[172:175], a[100:103], 0
v_mul_f32 v239, s91, v239
v_cvt_pk_bf16_f32 v232, v232, v233
v_mfma_f32_16x16x32_bf16 a[52:55], a[168:171], a[96:99], a[52:55]
ds_read_b128 a[72:75], v4 offset:41984
v_cvt_pk_bf16_f32 v233, v234, v235
v_mfma_f32_16x16x32_bf16 a[56:59], a[176:179], a[96:99], 0
buffer_load_dwordx4 v6, s[12:15], s64 offen offset:1024 lds
v_mfma_f32_16x16x32_bf16 a[56:59], a[180:183], a[100:103], a[56:59]
ds_read_b128 a[88:91], v9 offset:2048
v_cvt_pk_bf16_f32 v234, v236, v237
v_mfma_f32_16x16x32_bf16 a[60:63], a[188:191], a[100:103], 0
v_cvt_pk_bf16_f32 v235, v238, v239
v_mul_f32 v240, s91, v240
v_mfma_f32_16x16x32_bf16 a[60:63], a[184:187], a[96:99], a[60:63]
ds_read_b128 a[76:79], v4 offset:44032
v_mul_f32 v241, s91, v241
v_mfma_f32_16x16x32_bf16 v[236:239], a[112:115], a[96:99], 0
s_add_u32 m0, s73, 67584
s_add_u32 s64, s71, 18432
v_mul_f32 v242, s91, v242
v_mfma_f32_16x16x32_bf16 v[236:239], a[116:119], a[100:103], v[236:239]
ds_read_b128 a[92:95], v10 offset:2048
v_mul_f32 v243, s91, v243
v_mfma_f32_16x16x32_bf16 a[192:195], a[124:127], a[100:103], 0
buffer_load_dwordx4 v5, s[12:15], s64 offen lds
v_mfma_f32_16x16x32_bf16 a[192:195], a[120:123], a[96:99], a[192:195]
v_mul_f32 v244, s91, v244
v_mul_f32 v245, s91, v245
v_mfma_f32_16x16x32_bf16 a[196:199], a[120:123], a[104:107], 0
v_mul_f32 v246, s91, v246
v_mul_f32 v247, s91, v247
v_mfma_f32_16x16x32_bf16 a[196:199], a[124:127], a[108:111], a[196:199]
v_cvt_pk_bf16_f32 v240, v240, v241
v_cvt_pk_bf16_f32 v241, v242, v243
v_mfma_f32_16x16x32_bf16 a[200:203], a[116:119], a[108:111], 0
v_cvt_pk_bf16_f32 v242, v244, v245
v_cvt_pk_bf16_f32 v243, v246, v247
v_mfma_f32_16x16x32_bf16 a[200:203], a[112:115], a[104:107], a[200:203]
v_mul_f32 v248, s91, v248
v_mul_f32 v249, s91, v249
v_mfma_f32_16x16x32_bf16 v[244:247], a[184:187], a[104:107], 0
buffer_load_dwordx4 v6, s[12:15], s64 offen offset:1024 lds
v_mfma_f32_16x16x32_bf16 v[244:247], a[188:191], a[108:111], v[244:247]
v_mul_f32 v250, s91, v250
v_mul_f32 v251, s91, v251
v_mfma_f32_16x16x32_bf16 a[204:207], a[180:183], a[108:111], 0
v_mul_f32 v252, s91, v252
v_mul_f32 v253, s91, v253
v_mfma_f32_16x16x32_bf16 a[204:207], a[176:179], a[104:107], a[204:207]
s_add_u32 s53, s88, 262144
v_mul_f32 v254, s91, v254
v_mul_f32 v255, s91, v255
v_mfma_f32_16x16x32_bf16 a[208:211], a[168:171], a[104:107], 0
buffer_store_dwordx4 v[88:91], v4, s[24:27], s53 offen offset:3072 sc1
v_mfma_f32_16x16x32_bf16 a[208:211], a[172:175], a[108:111], a[208:211]
v_cvt_pk_bf16_f32 v248, v248, v249
v_cvt_pk_bf16_f32 v249, v250, v251
v_mfma_f32_16x16x32_bf16 v[88:91], a[164:167], a[108:111], 0
v_cvt_pk_bf16_f32 v250, v252, v253
v_cvt_pk_bf16_f32 v251, v254, v255
v_mfma_f32_16x16x32_bf16 v[88:91], a[160:163], a[104:107], v[88:91]
s_waitcnt lgkmcnt(0)
v_accvgpr_read_b32 v16, a0
v_accvgpr_read_b32 v17, a1
v_mfma_f32_16x16x32_bf16 v[36:39], a[128:131], a[80:83], v[36:39]
s_waitcnt vmcnt(24)
v_accvgpr_read_b32 v18, a2
v_accvgpr_read_b32 v19, a3
v_mfma_f32_16x16x32_bf16 v[36:39], a[132:135], a[84:87], v[36:39]
s_barrier
v_mfma_f32_16x16x32_bf16 v[44:47], a[140:143], a[84:87], v[44:47]
ds_read_b128 a[96:99], v9 offset:4096
v_accvgpr_read_b32 v20, a4
v_mfma_f32_16x16x32_bf16 v[44:47], a[136:139], a[80:83], v[44:47]
s_xor_b32 s75, s93, 2
s_lshl_b32 s76, s75, 19
s_add_u32 s76, s76, s74
v_mfma_f32_16x16x32_bf16 v[32:35], a[144:147], a[80:83], v[32:35]
s_lshl_b32 s79, s75, 13
s_add_u32 s79, s79, s78
ds_read_b128 a[100:103], v10 offset:4096
v_mfma_f32_16x16x32_bf16 v[32:35], a[148:151], a[84:87], v[32:35]
s_add_u32 m0, s77, 32768
s_add_u32 s64, s76, 0
ds_read_b128 a[104:107], v9 offset:6144
v_mfma_f32_16x16x32_bf16 v[52:55], a[156:159], a[84:87], v[52:55]
buffer_load_dwordx4 v7, s[20:23], s64 offen lds
v_mfma_f32_16x16x32_bf16 v[52:55], a[152:155], a[80:83], v[52:55]
ds_read_b64_tr_b16 a[160:161], v11 offset:49152
ds_read_b64_tr_b16 a[162:163], v11 offset:49664
v_mfma_f32_16x16x32_bf16 v[60:63], a[64:67], a[80:83], v[60:63]
v_accvgpr_read_b32 v21, a5
v_accvgpr_read_b32 v22, a6
v_mfma_f32_16x16x32_bf16 v[60:63], a[68:71], a[84:87], v[60:63]
ds_read_b128 a[108:111], v10 offset:6144
v_accvgpr_read_b32 v23, a7
v_mfma_f32_16x16x32_bf16 v[68:71], a[76:79], a[84:87], v[68:71]
buffer_load_dwordx4 v8, s[20:23], s64 offen offset:1024 lds
v_mfma_f32_16x16x32_bf16 v[68:71], a[72:75], a[80:83], v[68:71]
ds_read_b64_tr_b16 a[164:165], v11 offset:53248
ds_read_b64_tr_b16 a[166:167], v11 offset:53760
v_mfma_f32_16x16x32_bf16 v[76:79], a[72:75], a[88:91], v[76:79]
v_add_u32 v9, 32768, v9
v_add_u32 v10, 32768, v10
v_mfma_f32_16x16x32_bf16 v[76:79], a[76:79], a[92:95], v[76:79]
ds_read_b64_tr_b16 a[168:169], v12 offset:49152
ds_read_b64_tr_b16 a[170:171], v12 offset:49664
v_mfma_f32_16x16x32_bf16 v[84:87], a[68:71], a[92:95], v[84:87]
s_add_u32 m0, s80, 32768
s_add_u32 s64, s79, 0
v_mul_f32 v16, s91, v16
v_mfma_f32_16x16x32_bf16 v[84:87], a[64:67], a[88:91], v[84:87]
ds_read_b64_tr_b16 a[172:173], v12 offset:53248
ds_read_b64_tr_b16 a[174:175], v12 offset:53760
v_mfma_f32_16x16x32_bf16 v[92:95], a[152:155], a[88:91], v[92:95]
buffer_load_dwordx4 v4, s[24:27], s64 offen sc1 lds
v_mfma_f32_16x16x32_bf16 v[92:95], a[156:159], a[92:95], v[92:95]
v_mul_f32 v17, s91, v17
v_mul_f32 v18, s91, v18
v_mfma_f32_16x16x32_bf16 v[40:43], a[148:151], a[92:95], v[40:43]
ds_read_b64_tr_b16 a[176:177], v13 offset:49152
ds_read_b64_tr_b16 a[178:179], v13 offset:49664
v_mfma_f32_16x16x32_bf16 v[40:43], a[144:147], a[88:91], v[40:43]
v_mul_f32 v19, s91, v19
v_mul_f32 v20, s91, v20
v_mfma_f32_16x16x32_bf16 v[100:103], a[136:139], a[88:91], v[100:103]
s_add_u32 m0, s73, 69632
s_add_u32 s64, s72, 0
v_mul_f32 v21, s91, v21
v_mfma_f32_16x16x32_bf16 v[100:103], a[140:143], a[92:95], v[100:103]
ds_read_b64_tr_b16 a[180:181], v13 offset:53248
ds_read_b64_tr_b16 a[182:183], v13 offset:53760
v_mfma_f32_16x16x32_bf16 v[108:111], a[132:135], a[92:95], v[108:111]
buffer_load_dwordx4 v5, s[12:15], s64 offen lds
v_mfma_f32_16x16x32_bf16 v[108:111], a[128:131], a[88:91], v[108:111]
s_waitcnt lgkmcnt(14)
ds_read_b64_tr_b16 a[184:185], v14 offset:49152
ds_read_b64_tr_b16 a[186:187], v14 offset:49664
v_mfma_f32_16x16x32_bf16 v[116:119], a[128:131], a[96:99], v[116:119]
s_add_u32 s53, s87, 0
ds_read_b64_tr_b16 a[188:189], v14 offset:53248
ds_read_b64_tr_b16 a[190:191], v14 offset:53760
v_mfma_f32_16x16x32_bf16 v[116:119], a[132:135], a[100:103], v[116:119]
buffer_store_dwordx4 v[160:163], v4, s[24:27], s53 offen offset:0 sc1
v_mfma_f32_16x16x32_bf16 v[124:127], a[140:143], a[100:103], v[124:127]
v_mul_f32 v22, s91, v22
v_mul_f32 v23, s91, v23
v_mfma_f32_16x16x32_bf16 v[124:127], a[136:139], a[96:99], v[124:127]
ds_read_b128 a[112:115], v4 offset:57344
v_cvt_pk_bf16_f32 v16, v16, v17
v_mfma_f32_16x16x32_bf16 v[132:135], a[144:147], a[96:99], v[132:135]
buffer_load_dwordx4 v6, s[12:15], s64 offen offset:1024 lds
v_mfma_f32_16x16x32_bf16 v[132:135], a[148:151], a[100:103], v[132:135]
ds_read_b128 a[116:119], v4 offset:59392
v_cvt_pk_bf16_f32 v17, v18, v19
v_mfma_f32_16x16x32_bf16 v[140:143], a[156:159], a[100:103], v[140:143]
v_cvt_pk_bf16_f32 v18, v20, v21
v_cvt_pk_bf16_f32 v19, v22, v23
v_mfma_f32_16x16x32_bf16 v[140:143], a[152:155], a[96:99], v[140:143]
ds_read_b128 a[120:123], v4 offset:58368
v_accvgpr_write_b32 a0, v16
v_mfma_f32_16x16x32_bf16 v[148:151], a[64:67], a[96:99], v[148:151]
s_add_u32 m0, s73, 71680
s_add_u32 s64, s72, 18432
v_accvgpr_write_b32 a1, v17
v_mfma_f32_16x16x32_bf16 v[148:151], a[68:71], a[100:103], v[148:151]
ds_read_b128 a[124:127], v4 offset:60416
v_accvgpr_write_b32 a2, v18
v_mfma_f32_16x16x32_bf16 v[48:51], a[76:79], a[100:103], v[48:51]
buffer_load_dwordx4 v5, s[12:15], s64 offen lds
v_mfma_f32_16x16x32_bf16 v[48:51], a[72:75], a[96:99], v[48:51]
s_waitcnt lgkmcnt(15)
v_accvgpr_write_b32 a3, v19
v_accvgpr_read_b32 v16, a8
v_mfma_f32_16x16x32_bf16 v[156:159], a[72:75], a[104:107], v[156:159]
v_accvgpr_read_b32 v17, a9
v_accvgpr_read_b32 v18, a10
v_mfma_f32_16x16x32_bf16 v[156:159], a[76:79], a[108:111], v[156:159]
v_accvgpr_read_b32 v19, a11
v_accvgpr_read_b32 v20, a12
v_mfma_f32_16x16x32_bf16 v[164:167], a[68:71], a[108:111], v[164:167]
v_accvgpr_read_b32 v21, a13
v_accvgpr_read_b32 v22, a14
v_mfma_f32_16x16x32_bf16 v[164:167], a[64:67], a[104:107], v[164:167]
v_accvgpr_read_b32 v23, a15
v_mul_f32 v16, s91, v16
v_mfma_f32_16x16x32_bf16 v[172:175], a[152:155], a[104:107], v[172:175]
buffer_load_dwordx4 v6, s[12:15], s64 offen offset:1024 lds
v_mfma_f32_16x16x32_bf16 v[172:175], a[156:159], a[108:111], v[172:175]
v_mul_f32 v17, s91, v17
v_mul_f32 v18, s91, v18
v_mfma_f32_16x16x32_bf16 v[56:59], a[148:151], a[108:111], v[56:59]
v_mul_f32 v19, s91, v19
v_mul_f32 v20, s91, v20
v_mfma_f32_16x16x32_bf16 v[56:59], a[144:147], a[104:107], v[56:59]
v_mul_f32 v21, s91, v21
v_mul_f32 v22, s91, v22
v_mfma_f32_16x16x32_bf16 v[180:183], a[136:139], a[104:107], v[180:183]
v_mul_f32 v23, s91, v23
v_cvt_pk_bf16_f32 v16, v16, v17
v_mfma_f32_16x16x32_bf16 v[180:183], a[140:143], a[108:111], v[180:183]
v_cvt_pk_bf16_f32 v17, v18, v19
v_cvt_pk_bf16_f32 v18, v20, v21
v_mfma_f32_16x16x32_bf16 v[188:191], a[132:135], a[108:111], v[188:191]
v_cvt_pk_bf16_f32 v19, v22, v23
v_accvgpr_write_b32 a8, v16
v_mfma_f32_16x16x32_bf16 v[188:191], a[128:131], a[104:107], v[188:191]
s_waitcnt lgkmcnt(0)
v_accvgpr_write_b32 a9, v17
v_accvgpr_write_b32 a10, v18
v_mfma_f32_16x16x32_bf16 v[196:199], a[160:163], a[80:83], v[196:199]
s_waitcnt vmcnt(17)
v_accvgpr_write_b32 a11, v19
v_accvgpr_read_b32 v16, a16
v_mfma_f32_16x16x32_bf16 v[196:199], a[164:167], a[84:87], v[196:199]
s_barrier
v_mfma_f32_16x16x32_bf16 v[64:67], a[172:175], a[84:87], v[64:67]
s_add_u32 s53, s87, 0
ds_read_b64_tr_b16 a[128:129], v11 offset:0
ds_read_b64_tr_b16 a[130:131], v11 offset:512
v_mfma_f32_16x16x32_bf16 v[64:67], a[168:171], a[80:83], v[64:67]
s_add_u32 m0, s77, 49152
s_add_u32 s64, s76, 128
v_accvgpr_read_b32 v17, a17
v_mfma_f32_16x16x32_bf16 v[204:207], a[176:179], a[80:83], v[204:207]
buffer_load_dwordx4 v7, s[20:23], s64 offen lds
v_mfma_f32_16x16x32_bf16 v[204:207], a[180:183], a[84:87], v[204:207]
ds_read_b64_tr_b16 a[132:133], v11 offset:4096
ds_read_b64_tr_b16 a[134:135], v11 offset:4608
v_mfma_f32_16x16x32_bf16 v[212:215], a[188:191], a[84:87], v[212:215]
ds_read_b64_tr_b16 a[136:137], v12 offset:0
ds_read_b64_tr_b16 a[138:139], v12 offset:512
v_mfma_f32_16x16x32_bf16 v[212:215], a[184:187], a[80:83], v[212:215]
ds_read_b64_tr_b16 a[140:141], v12 offset:4096
ds_read_b64_tr_b16 a[142:143], v12 offset:4608
v_mfma_f32_16x16x32_bf16 v[72:75], a[112:115], a[80:83], v[72:75]
buffer_store_dwordx4 v[168:171], v4, s[24:27], s53 offen offset:1024 sc1
v_mfma_f32_16x16x32_bf16 v[72:75], a[116:119], a[84:87], v[72:75]
ds_read_b64_tr_b16 a[144:145], v13 offset:0
ds_read_b64_tr_b16 a[146:147], v13 offset:512
v_mfma_f32_16x16x32_bf16 v[220:223], a[124:127], a[84:87], v[220:223]
buffer_load_dwordx4 v8, s[20:23], s64 offen offset:1024 lds
v_mfma_f32_16x16x32_bf16 v[220:223], a[120:123], a[80:83], v[220:223]
ds_read_b64_tr_b16 a[148:149], v13 offset:4096
ds_read_b64_tr_b16 a[150:151], v13 offset:4608
v_mfma_f32_16x16x32_bf16 a[32:35], a[120:123], a[88:91], a[32:35]
v_accvgpr_read_b32 v18, a18
v_accvgpr_read_b32 v19, a19
v_mfma_f32_16x16x32_bf16 a[32:35], a[124:127], a[92:95], a[32:35]
ds_read_b64_tr_b16 a[152:153], v14 offset:0
ds_read_b64_tr_b16 a[154:155], v14 offset:512
v_mfma_f32_16x16x32_bf16 a[36:39], a[116:119], a[92:95], a[36:39]
s_add_u32 m0, s80, 49152
s_add_u32 s64, s79, 2048
v_accvgpr_read_b32 v20, a20
v_mfma_f32_16x16x32_bf16 a[36:39], a[112:115], a[88:91], a[36:39]
ds_read_b64_tr_b16 a[156:157], v14 offset:4096
ds_read_b64_tr_b16 a[158:159], v14 offset:4608
v_mfma_f32_16x16x32_bf16 v[228:231], a[184:187], a[88:91], v[228:231]
buffer_load_dwordx4 v4, s[24:27], s64 offen sc1 lds
v_mfma_f32_16x16x32_bf16 v[228:231], a[188:191], a[92:95], v[228:231]
s_xor_b32 s65, s70, 384
s_add_u32 s71, s68, s65
s_add_u32 s72, s69, s65
v_mfma_f32_16x16x32_bf16 a[40:43], a[180:183], a[92:95], a[40:43]
ds_read_b128 a[64:67], v4 offset:8192
v_accvgpr_read_b32 v21, a21
v_mfma_f32_16x16x32_bf16 a[40:43], a[176:179], a[88:91], a[40:43]
v_accvgpr_read_b32 v22, a22
v_accvgpr_read_b32 v23, a23
v_mfma_f32_16x16x32_bf16 a[44:47], a[168:171], a[88:91], a[44:47]
s_add_u32 m0, s73, 0
s_add_u32 s64, s71, 0
ds_read_b128 a[80:83], v9 offset:0
v_mfma_f32_16x16x32_bf16 a[44:47], a[172:175], a[92:95], a[44:47]
v_mul_f32 v16, s91, v16
v_mul_f32 v17, s91, v17
v_mfma_f32_16x16x32_bf16 v[80:83], a[164:167], a[92:95], v[80:83]
buffer_load_dwordx4 v5, s[12:15], s64 offen lds
v_mfma_f32_16x16x32_bf16 v[80:83], a[160:163], a[88:91], v[80:83]
ds_read_b128 a[68:71], v4 offset:10240
v_mul_f32 v18, s91, v18
v_mfma_f32_16x16x32_bf16 a[48:51], a[160:163], a[96:99], a[48:51]
ds_read_b128 a[84:87], v10 offset:0
v_mul_f32 v19, s91, v19
v_mfma_f32_16x16x32_bf16 a[48:51], a[164:167], a[100:103], a[48:51]
v_mul_f32 v20, s91, v20
v_mul_f32 v21, s91, v21
v_mfma_f32_16x16x32_bf16 a[52:55], a[172:175], a[100:103], a[52:55]
v_mul_f32 v22, s91, v22
v_mul_f32 v23, s91, v23
v_mfma_f32_16x16x32_bf16 a[52:55], a[168:171], a[96:99], a[52:55]
ds_read_b128 a[72:75], v4 offset:9216
v_cvt_pk_bf16_f32 v16, v16, v17
v_mfma_f32_16x16x32_bf16 a[56:59], a[176:179], a[96:99], a[56:59]
buffer_load_dwordx4 v6, s[12:15], s64 offen offset:1024 lds
v_mfma_f32_16x16x32_bf16 a[56:59], a[180:183], a[100:103], a[56:59]
s_add_u32 s53, s87, 4096
ds_read_b128 a[88:91], v9 offset:2048
v_cvt_pk_bf16_f32 v17, v18, v19
v_mfma_f32_16x16x32_bf16 a[60:63], a[188:191], a[100:103], a[60:63]
buffer_store_dwordx4 v[176:179], v4, s[24:27], s53 offen offset:0 sc1
v_mfma_f32_16x16x32_bf16 a[60:63], a[184:187], a[96:99], a[60:63]
ds_read_b128 a[76:79], v4 offset:11264
v_cvt_pk_bf16_f32 v18, v20, v21
v_mfma_f32_16x16x32_bf16 v[236:239], a[112:115], a[96:99], v[236:239]
s_add_u32 m0, s73, 2048
s_add_u32 s64, s71, 18432
v_cvt_pk_bf16_f32 v19, v22, v23
v_mfma_f32_16x16x32_bf16 v[236:239], a[116:119], a[100:103], v[236:239]
ds_read_b128 a[92:95], v10 offset:2048
v_accvgpr_write_b32 a16, v16
v_mfma_f32_16x16x32_bf16 a[192:195], a[124:127], a[100:103], a[192:195]
buffer_load_dwordx4 v5, s[12:15], s64 offen lds
v_mfma_f32_16x16x32_bf16 a[192:195], a[120:123], a[96:99], a[192:195]
v_accvgpr_write_b32 a17, v17
v_accvgpr_write_b32 a18, v18
v_mfma_f32_16x16x32_bf16 a[196:199], a[120:123], a[104:107], a[196:199]
v_accvgpr_write_b32 a19, v19
v_accvgpr_read_b32 v16, a24
v_mfma_f32_16x16x32_bf16 a[196:199], a[124:127], a[108:111], a[196:199]
v_accvgpr_read_b32 v17, a25
v_accvgpr_read_b32 v18, a26
v_mfma_f32_16x16x32_bf16 a[200:203], a[116:119], a[108:111], a[200:203]
v_accvgpr_read_b32 v19, a27
v_accvgpr_read_b32 v20, a28
v_mfma_f32_16x16x32_bf16 a[200:203], a[112:115], a[104:107], a[200:203]
v_accvgpr_read_b32 v21, a29
v_accvgpr_read_b32 v22, a30
v_mfma_f32_16x16x32_bf16 v[244:247], a[184:187], a[104:107], v[244:247]
buffer_load_dwordx4 v6, s[12:15], s64 offen offset:1024 lds
v_mfma_f32_16x16x32_bf16 v[244:247], a[188:191], a[108:111], v[244:247]
v_accvgpr_read_b32 v23, a31
v_mul_f32 v16, s91, v16
v_mfma_f32_16x16x32_bf16 a[204:207], a[180:183], a[108:111], a[204:207]
v_mul_f32 v17, s91, v17
v_mul_f32 v18, s91, v18
v_mfma_f32_16x16x32_bf16 a[204:207], a[176:179], a[104:107], a[204:207]
v_mul_f32 v19, s91, v19
v_mul_f32 v20, s91, v20
v_mfma_f32_16x16x32_bf16 a[208:211], a[168:171], a[104:107], a[208:211]
v_mul_f32 v21, s91, v21
v_mul_f32 v22, s91, v22
v_mfma_f32_16x16x32_bf16 a[208:211], a[172:175], a[108:111], a[208:211]
v_mul_f32 v23, s91, v23
v_cvt_pk_bf16_f32 v16, v16, v17
v_mfma_f32_16x16x32_bf16 v[88:91], a[164:167], a[108:111], v[88:91]
v_cvt_pk_bf16_f32 v17, v18, v19
v_cvt_pk_bf16_f32 v18, v20, v21
v_mfma_f32_16x16x32_bf16 v[88:91], a[160:163], a[104:107], v[88:91]
s_waitcnt lgkmcnt(0)
v_cvt_pk_bf16_f32 v19, v22, v23
v_accvgpr_write_b32 a24, v16
v_mfma_f32_16x16x32_bf16 v[36:39], a[128:131], a[80:83], v[36:39]
s_waitcnt vmcnt(23)
v_accvgpr_write_b32 a25, v17
v_accvgpr_write_b32 a26, v18
v_mfma_f32_16x16x32_bf16 v[36:39], a[132:135], a[84:87], v[36:39]
s_barrier
v_mfma_f32_16x16x32_bf16 v[44:47], a[140:143], a[84:87], v[44:47]
ds_read_b128 a[96:99], v9 offset:4096
v_accvgpr_write_b32 a27, v19
v_mfma_f32_16x16x32_bf16 v[44:47], a[136:139], a[80:83], v[44:47]
s_xor_b32 s75, s93, 3
s_lshl_b32 s76, s75, 19
s_add_u32 s76, s76, s74
v_mfma_f32_16x16x32_bf16 v[32:35], a[144:147], a[80:83], v[32:35]
s_lshl_b32 s79, s75, 13
s_add_u32 s79, s79, s78
ds_read_b128 a[100:103], v10 offset:4096
v_mfma_f32_16x16x32_bf16 v[32:35], a[148:151], a[84:87], v[32:35]
s_add_u32 m0, s77, 0
s_add_u32 s64, s76, 0
ds_read_b128 a[104:107], v9 offset:6144
v_mfma_f32_16x16x32_bf16 v[52:55], a[156:159], a[84:87], v[52:55]
buffer_load_dwordx4 v7, s[20:23], s64 offen lds
v_mfma_f32_16x16x32_bf16 v[52:55], a[152:155], a[80:83], v[52:55]
s_add_u32 s53, s87, 4096
ds_read_b64_tr_b16 a[160:161], v11 offset:16384
ds_read_b64_tr_b16 a[162:163], v11 offset:16896
v_mfma_f32_16x16x32_bf16 v[60:63], a[64:67], a[80:83], v[60:63]
buffer_store_dwordx4 v[184:187], v4, s[24:27], s53 offen offset:1024 sc1
v_mfma_f32_16x16x32_bf16 v[60:63], a[68:71], a[84:87], v[60:63]
ds_read_b128 a[108:111], v10 offset:6144
v_accvgpr_write_b32 a4, v248
v_mfma_f32_16x16x32_bf16 v[68:71], a[76:79], a[84:87], v[68:71]
buffer_load_dwordx4 v8, s[20:23], s64 offen offset:1024 lds
v_mfma_f32_16x16x32_bf16 v[68:71], a[72:75], a[80:83], v[68:71]
ds_read_b64_tr_b16 a[164:165], v11 offset:20480
ds_read_b64_tr_b16 a[166:167], v11 offset:20992
v_mfma_f32_16x16x32_bf16 v[76:79], a[72:75], a[88:91], v[76:79]
v_add_u32 v9, 32768, v9
v_add_u32 v10, 32768, v10
v_mfma_f32_16x16x32_bf16 v[76:79], a[76:79], a[92:95], v[76:79]
ds_read_b64_tr_b16 a[168:169], v12 offset:16384
ds_read_b64_tr_b16 a[170:171], v12 offset:16896
v_mfma_f32_16x16x32_bf16 v[84:87], a[68:71], a[92:95], v[84:87]
s_add_u32 m0, s80, 0
s_add_u32 s64, s79, 0
v_accvgpr_write_b32 a5, v249
v_mfma_f32_16x16x32_bf16 v[84:87], a[64:67], a[88:91], v[84:87]
ds_read_b64_tr_b16 a[172:173], v12 offset:20480
ds_read_b64_tr_b16 a[174:175], v12 offset:20992
v_mfma_f32_16x16x32_bf16 v[92:95], a[152:155], a[88:91], v[92:95]
buffer_load_dwordx4 v4, s[24:27], s64 offen sc1 lds
v_mfma_f32_16x16x32_bf16 v[92:95], a[156:159], a[92:95], v[92:95]
v_accvgpr_write_b32 a6, v250
v_accvgpr_write_b32 a7, v251
v_mfma_f32_16x16x32_bf16 v[40:43], a[148:151], a[92:95], v[40:43]
ds_read_b64_tr_b16 a[176:177], v13 offset:16384
ds_read_b64_tr_b16 a[178:179], v13 offset:16896
v_mfma_f32_16x16x32_bf16 v[40:43], a[144:147], a[88:91], v[40:43]
v_accvgpr_write_b32 a12, v240
v_accvgpr_write_b32 a13, v241
v_mfma_f32_16x16x32_bf16 v[100:103], a[136:139], a[88:91], v[100:103]
s_add_u32 m0, s73, 4096
s_add_u32 s64, s72, 0
v_accvgpr_write_b32 a14, v242
v_mfma_f32_16x16x32_bf16 v[100:103], a[140:143], a[92:95], v[100:103]
ds_read_b64_tr_b16 a[180:181], v13 offset:20480
ds_read_b64_tr_b16 a[182:183], v13 offset:20992
v_mfma_f32_16x16x32_bf16 v[108:111], a[132:135], a[92:95], v[108:111]
buffer_load_dwordx4 v5, s[12:15], s64 offen lds
v_mfma_f32_16x16x32_bf16 v[108:111], a[128:131], a[88:91], v[108:111]
s_waitcnt lgkmcnt(14)
ds_read_b64_tr_b16 a[184:185], v14 offset:16384
ds_read_b64_tr_b16 a[186:187], v14 offset:16896
v_mfma_f32_16x16x32_bf16 v[116:119], a[128:131], a[96:99], v[116:119]
ds_read_b64_tr_b16 a[188:189], v14 offset:20480
ds_read_b64_tr_b16 a[190:191], v14 offset:20992
v_mfma_f32_16x16x32_bf16 v[116:119], a[132:135], a[100:103], v[116:119]
v_accvgpr_write_b32 a15, v243
v_accvgpr_write_b32 a20, v232
v_mfma_f32_16x16x32_bf16 v[124:127], a[140:143], a[100:103], v[124:127]
v_accvgpr_write_b32 a21, v233
v_accvgpr_write_b32 a22, v234
v_mfma_f32_16x16x32_bf16 v[124:127], a[136:139], a[96:99], v[124:127]
ds_read_b128 a[112:115], v4 offset:24576
v_accvgpr_write_b32 a23, v235
v_mfma_f32_16x16x32_bf16 v[132:135], a[144:147], a[96:99], v[132:135]
buffer_load_dwordx4 v6, s[12:15], s64 offen offset:1024 lds
v_mfma_f32_16x16x32_bf16 v[132:135], a[148:151], a[100:103], v[132:135]
ds_read_b128 a[116:119], v4 offset:26624
v_accvgpr_write_b32 a28, v224
v_mfma_f32_16x16x32_bf16 v[140:143], a[156:159], a[100:103], v[140:143]
v_accvgpr_write_b32 a29, v225
v_accvgpr_write_b32 a30, v226
v_mfma_f32_16x16x32_bf16 v[140:143], a[152:155], a[96:99], v[140:143]
ds_read_b128 a[120:123], v4 offset:25600
v_accvgpr_write_b32 a31, v227
v_mfma_f32_16x16x32_bf16 v[148:151], a[64:67], a[96:99], v[148:151]
s_add_u32 m0, s73, 6144
s_add_u32 s64, s72, 18432
v_accvgpr_read_b32 v252, a32
v_mfma_f32_16x16x32_bf16 v[148:151], a[68:71], a[100:103], v[148:151]
ds_read_b128 a[124:127], v4 offset:27648
v_accvgpr_read_b32 v253, a33
v_mfma_f32_16x16x32_bf16 v[48:51], a[76:79], a[100:103], v[48:51]
buffer_load_dwordx4 v5, s[12:15], s64 offen lds
v_mfma_f32_16x16x32_bf16 v[48:51], a[72:75], a[96:99], v[48:51]
s_waitcnt lgkmcnt(15)
s_add_u32 s53, s87, 262144
v_accvgpr_read_b32 v254, a34
v_mfma_f32_16x16x32_bf16 v[156:159], a[72:75], a[104:107], v[156:159]
buffer_store_dwordx4 v[192:195], v4, s[24:27], s53 offen offset:0 sc1
v_mfma_f32_16x16x32_bf16 v[156:159], a[76:79], a[108:111], v[156:159]
v_accvgpr_read_b32 v255, a35
v_accvgpr_read_b32 v160, a36
v_mfma_f32_16x16x32_bf16 v[164:167], a[68:71], a[108:111], v[164:167]
v_accvgpr_read_b32 v161, a37
v_accvgpr_read_b32 v162, a38
v_mfma_f32_16x16x32_bf16 v[164:167], a[64:67], a[104:107], v[164:167]
v_accvgpr_read_b32 v163, a39
v_accvgpr_read_b32 v168, a40
v_mfma_f32_16x16x32_bf16 v[172:175], a[152:155], a[104:107], v[172:175]
buffer_load_dwordx4 v6, s[12:15], s64 offen offset:1024 lds
v_mfma_f32_16x16x32_bf16 v[172:175], a[156:159], a[108:111], v[172:175]
v_accvgpr_read_b32 v169, a41
v_accvgpr_read_b32 v170, a42
v_mfma_f32_16x16x32_bf16 v[56:59], a[148:151], a[108:111], v[56:59]
v_accvgpr_read_b32 v171, a43
v_accvgpr_read_b32 v176, a44
v_mfma_f32_16x16x32_bf16 v[56:59], a[144:147], a[104:107], v[56:59]
v_accvgpr_read_b32 v177, a45
v_accvgpr_read_b32 v178, a46
v_mfma_f32_16x16x32_bf16 v[180:183], a[136:139], a[104:107], v[180:183]
L_PAD5:
s_cbranch_execz L_PAD9
v_accvgpr_read_b32 v179, a47
v_accvgpr_read_b32 v184, a48
v_mfma_f32_16x16x32_bf16 v[180:183], a[140:143], a[108:111], v[180:183]
v_accvgpr_read_b32 v185, a49
v_accvgpr_read_b32 v186, a50
v_mfma_f32_16x16x32_bf16 v[188:191], a[132:135], a[108:111], v[188:191]
v_accvgpr_read_b32 v187, a51
v_accvgpr_read_b32 v248, a52
v_mfma_f32_16x16x32_bf16 v[188:191], a[128:131], a[104:107], v[188:191]
s_waitcnt lgkmcnt(0)
v_accvgpr_read_b32 v249, a53
v_accvgpr_read_b32 v250, a54
v_mfma_f32_16x16x32_bf16 v[196:199], a[160:163], a[80:83], v[196:199]
s_waitcnt vmcnt(18)
v_accvgpr_read_b32 v251, a55
v_accvgpr_read_b32 v240, a56
v_mfma_f32_16x16x32_bf16 v[196:199], a[164:167], a[84:87], v[196:199]
s_barrier
v_mfma_f32_16x16x32_bf16 v[64:67], a[172:175], a[84:87], v[64:67]
ds_read_b64_tr_b16 a[128:129], v11 offset:32768
ds_read_b64_tr_b16 a[130:131], v11 offset:33280
v_mfma_f32_16x16x32_bf16 v[64:67], a[168:171], a[80:83], v[64:67]
s_add_u32 m0, s77, 16384
s_add_u32 s64, s76, 128
v_accvgpr_read_b32 v241, a57
v_mfma_f32_16x16x32_bf16 v[204:207], a[176:179], a[80:83], v[204:207]
buffer_load_dwordx4 v7, s[20:23], s64 offen lds
v_mfma_f32_16x16x32_bf16 v[204:207], a[180:183], a[84:87], v[204:207]
ds_read_b64_tr_b16 a[132:133], v11 offset:36864
ds_read_b64_tr_b16 a[134:135], v11 offset:37376
v_mfma_f32_16x16x32_bf16 v[212:215], a[188:191], a[84:87], v[212:215]
ds_read_b64_tr_b16 a[136:137], v12 offset:32768
ds_read_b64_tr_b16 a[138:139], v12 offset:33280
v_mfma_f32_16x16x32_bf16 v[212:215], a[184:187], a[80:83], v[212:215]
ds_read_b64_tr_b16 a[140:141], v12 offset:36864
ds_read_b64_tr_b16 a[142:143], v12 offset:37376
v_mfma_f32_16x16x32_bf16 v[72:75], a[112:115], a[80:83], v[72:75]
v_accvgpr_read_b32 v242, a58
v_accvgpr_read_b32 v243, a59
v_mfma_f32_16x16x32_bf16 v[72:75], a[116:119], a[84:87], v[72:75]
ds_read_b64_tr_b16 a[144:145], v13 offset:32768
ds_read_b64_tr_b16 a[146:147], v13 offset:33280
v_mfma_f32_16x16x32_bf16 v[220:223], a[124:127], a[84:87], v[220:223]
buffer_load_dwordx4 v8, s[20:23], s64 offen offset:1024 lds
v_mfma_f32_16x16x32_bf16 v[220:223], a[120:123], a[80:83], v[220:223]
ds_read_b64_tr_b16 a[148:149], v13 offset:36864
ds_read_b64_tr_b16 a[150:151], v13 offset:37376
v_mfma_f32_16x16x32_bf16 v[252:255], a[120:123], a[88:91], v[252:255]
v_accvgpr_read_b32 v232, a60
v_accvgpr_read_b32 v233, a61
v_mfma_f32_16x16x32_bf16 v[252:255], a[124:127], a[92:95], v[252:255]
s_add_u32 s53, s87, 262144
ds_read_b64_tr_b16 a[152:153], v14 offset:32768
ds_read_b64_tr_b16 a[154:155], v14 offset:33280
v_mfma_f32_16x16x32_bf16 v[160:163], a[116:119], a[92:95], v[160:163]
s_add_u32 m0, s80, 16384
s_add_u32 s64, s79, 2048
v_accvgpr_read_b32 v234, a62
v_mfma_f32_16x16x32_bf16 v[160:163], a[112:115], a[88:91], v[160:163]
ds_read_b64_tr_b16 a[156:157], v14 offset:36864
ds_read_b64_tr_b16 a[158:159], v14 offset:37376
v_mfma_f32_16x16x32_bf16 v[228:231], a[184:187], a[88:91], v[228:231]
buffer_load_dwordx4 v4, s[24:27], s64 offen sc1 lds
v_mfma_f32_16x16x32_bf16 v[228:231], a[188:191], a[92:95], v[228:231]
s_xor_b32 s65, s70, 512
s_add_u32 s71, s68, s65
s_add_u32 s72, s69, s65
v_mfma_f32_16x16x32_bf16 v[168:171], a[180:183], a[92:95], v[168:171]
ds_read_b128 a[64:67], v4 offset:40960
v_accvgpr_read_b32 v235, a63
v_mfma_f32_16x16x32_bf16 v[168:171], a[176:179], a[88:91], v[168:171]
buffer_store_dwordx4 v[200:203], v4, s[24:27], s53 offen offset:1024 sc1
v_mfma_f32_16x16x32_bf16 v[176:179], a[168:171], a[88:91], v[176:179]
s_add_u32 m0, s73, 32768
s_add_u32 s64, s71, 0
ds_read_b128 a[80:83], v9 offset:0
v_mfma_f32_16x16x32_bf16 v[176:179], a[172:175], a[92:95], v[176:179]
v_accvgpr_read_b32 v224, a192
v_accvgpr_read_b32 v225, a193
v_mfma_f32_16x16x32_bf16 v[80:83], a[164:167], a[92:95], v[80:83]
buffer_load_dwordx4 v5, s[12:15], s64 offen lds
v_mfma_f32_16x16x32_bf16 v[80:83], a[160:163], a[88:91], v[80:83]
ds_read_b128 a[68:71], v4 offset:43008
v_accvgpr_read_b32 v226, a194
v_mfma_f32_16x16x32_bf16 v[184:187], a[160:163], a[96:99], v[184:187]
ds_read_b128 a[84:87], v10 offset:0
v_accvgpr_read_b32 v227, a195
v_mfma_f32_16x16x32_bf16 v[184:187], a[164:167], a[100:103], v[184:187]
v_accvgpr_read_b32 v192, a204
v_accvgpr_read_b32 v193, a205
v_mfma_f32_16x16x32_bf16 v[248:251], a[172:175], a[100:103], v[248:251]
v_accvgpr_read_b32 v194, a206
v_accvgpr_read_b32 v195, a207
v_mfma_f32_16x16x32_bf16 v[248:251], a[168:171], a[96:99], v[248:251]
ds_read_b128 a[72:75], v4 offset:41984
v_accvgpr_read_b32 v200, a208
v_mfma_f32_16x16x32_bf16 v[240:243], a[176:179], a[96:99], v[240:243]
buffer_load_dwordx4 v6, s[12:15], s64 offen offset:1024 lds
v_mfma_f32_16x16x32_bf16 v[240:243], a[180:183], a[100:103], v[240:243]
ds_read_b128 a[88:91], v9 offset:2048
v_accvgpr_read_b32 v201, a209
v_mfma_f32_16x16x32_bf16 v[232:235], a[188:191], a[100:103], v[232:235]
v_accvgpr_read_b32 v202, a210
v_accvgpr_read_b32 v203, a211
v_mfma_f32_16x16x32_bf16 v[232:235], a[184:187], a[96:99], v[232:235]
ds_read_b128 a[76:79], v4 offset:44032
v_and_b32 v28, 31, v1
v_mfma_f32_16x16x32_bf16 v[236:239], a[112:115], a[96:99], v[236:239]
s_add_u32 m0, s73, 34816
s_add_u32 s64, s71, 18432
v_lshlrev_b32 v28, 2, v28
v_mfma_f32_16x16x32_bf16 v[236:239], a[116:119], a[100:103], v[236:239]
ds_read_b128 a[92:95], v10 offset:2048
v_mfma_f32_16x16x32_bf16 v[224:227], a[124:127], a[100:103], v[224:227]
buffer_load_dwordx4 v5, s[12:15], s64 offen lds
v_mfma_f32_16x16x32_bf16 v[224:227], a[120:123], a[96:99], v[224:227]
buffer_load_dword v30, v28, s[40:43], 0 offen sc1
v_mfma_f32_16x16x32_bf16 a[196:199], a[120:123], a[104:107], a[196:199]
v_mfma_f32_16x16x32_bf16 a[196:199], a[124:127], a[108:111], a[196:199]
v_mfma_f32_16x16x32_bf16 a[200:203], a[116:119], a[108:111], a[200:203]
v_mfma_f32_16x16x32_bf16 a[200:203], a[112:115], a[104:107], a[200:203]
v_mfma_f32_16x16x32_bf16 v[244:247], a[184:187], a[104:107], v[244:247]
buffer_load_dwordx4 v6, s[12:15], s64 offen offset:1024 lds
v_mfma_f32_16x16x32_bf16 v[244:247], a[188:191], a[108:111], v[244:247]
s_add_u32 s53, s87, 266240
v_mfma_f32_16x16x32_bf16 v[192:195], a[180:183], a[108:111], v[192:195]
buffer_store_dwordx4 v[208:211], v4, s[24:27], s53 offen offset:0 sc1
v_mfma_f32_16x16x32_bf16 v[192:195], a[176:179], a[104:107], v[192:195]
v_mfma_f32_16x16x32_bf16 v[200:203], a[168:171], a[104:107], v[200:203]
v_mfma_f32_16x16x32_bf16 v[200:203], a[172:175], a[108:111], v[200:203]
v_accvgpr_read_b32 v208, a196
v_accvgpr_read_b32 v209, a197
v_mfma_f32_16x16x32_bf16 v[88:91], a[164:167], a[108:111], v[88:91]
v_accvgpr_read_b32 v210, a198
v_accvgpr_read_b32 v211, a199
v_mfma_f32_16x16x32_bf16 v[88:91], a[160:163], a[104:107], v[88:91]
s_waitcnt lgkmcnt(0)
v_mfma_f32_16x16x32_bf16 v[36:39], a[128:131], a[80:83], v[36:39]
s_waitcnt vmcnt(24)
v_mfma_f32_16x16x32_bf16 v[36:39], a[132:135], a[84:87], v[36:39]
s_barrier
v_mfma_f32_16x16x32_bf16 v[44:47], a[140:143], a[84:87], v[44:47]
ds_read_b128 a[96:99], v9 offset:4096
v_mfma_f32_16x16x32_bf16 v[44:47], a[136:139], a[80:83], v[44:47]
s_xor_b32 s75, s93, 4
s_lshl_b32 s76, s75, 19
s_add_u32 s76, s76, s74
v_mfma_f32_16x16x32_bf16 v[32:35], a[144:147], a[80:83], v[32:35]
s_lshl_b32 s79, s75, 13
s_add_u32 s79, s79, s78
ds_read_b128 a[100:103], v10 offset:4096
v_mfma_f32_16x16x32_bf16 v[32:35], a[148:151], a[84:87], v[32:35]
s_add_u32 m0, s77, 32768
s_add_u32 s64, s76, 0
ds_read_b128 a[104:107], v9 offset:6144
v_mfma_f32_16x16x32_bf16 v[52:55], a[156:159], a[84:87], v[52:55]
buffer_load_dwordx4 v7, s[20:23], s64 offen lds
v_mfma_f32_16x16x32_bf16 v[52:55], a[152:155], a[80:83], v[52:55]
ds_read_b64_tr_b16 a[160:161], v11 offset:49152
ds_read_b64_tr_b16 a[162:163], v11 offset:49664
v_mfma_f32_16x16x32_bf16 v[60:63], a[64:67], a[80:83], v[60:63]
v_mfma_f32_16x16x32_bf16 v[60:63], a[68:71], a[84:87], v[60:63]
ds_read_b128 a[108:111], v10 offset:6144
v_mfma_f32_16x16x32_bf16 v[68:71], a[76:79], a[84:87], v[68:71]
buffer_load_dwordx4 v8, s[20:23], s64 offen offset:1024 lds
v_mfma_f32_16x16x32_bf16 v[68:71], a[72:75], a[80:83], v[68:71]
ds_read_b64_tr_b16 a[164:165], v11 offset:53248
ds_read_b64_tr_b16 a[166:167], v11 offset:53760
v_mfma_f32_16x16x32_bf16 v[76:79], a[72:75], a[88:91], v[76:79]
v_add_u32 v9, -65536, v9
v_add_u32 v10, -65536, v10
v_mfma_f32_16x16x32_bf16 v[76:79], a[76:79], a[92:95], v[76:79]
ds_read_b64_tr_b16 a[168:169], v12 offset:49152
ds_read_b64_tr_b16 a[170:171], v12 offset:49664
v_mfma_f32_16x16x32_bf16 v[84:87], a[68:71], a[92:95], v[84:87]
s_add_u32 m0, s80, 32768
s_add_u32 s64, s79, 0
v_mfma_f32_16x16x32_bf16 v[84:87], a[64:67], a[88:91], v[84:87]
ds_read_b64_tr_b16 a[172:173], v12 offset:53248
ds_read_b64_tr_b16 a[174:175], v12 offset:53760
v_mfma_f32_16x16x32_bf16 v[92:95], a[152:155], a[88:91], v[92:95]
buffer_load_dwordx4 v4, s[24:27], s64 offen sc1 lds
v_mfma_f32_16x16x32_bf16 v[92:95], a[156:159], a[92:95], v[92:95]
v_mfma_f32_16x16x32_bf16 v[40:43], a[148:151], a[92:95], v[40:43]
ds_read_b64_tr_b16 a[176:177], v13 offset:49152
ds_read_b64_tr_b16 a[178:179], v13 offset:49664
v_mfma_f32_16x16x32_bf16 v[40:43], a[144:147], a[88:91], v[40:43]
s_add_u32 s53, s87, 266240
v_mfma_f32_16x16x32_bf16 v[100:103], a[136:139], a[88:91], v[100:103]
s_add_u32 m0, s73, 36864
s_add_u32 s64, s72, 0
v_mfma_f32_16x16x32_bf16 v[100:103], a[140:143], a[92:95], v[100:103]
ds_read_b64_tr_b16 a[180:181], v13 offset:53248
ds_read_b64_tr_b16 a[182:183], v13 offset:53760
v_mfma_f32_16x16x32_bf16 v[108:111], a[132:135], a[92:95], v[108:111]
buffer_load_dwordx4 v5, s[12:15], s64 offen lds
v_mfma_f32_16x16x32_bf16 v[108:111], a[128:131], a[88:91], v[108:111]
s_waitcnt lgkmcnt(14)
ds_read_b64_tr_b16 a[184:185], v14 offset:49152
ds_read_b64_tr_b16 a[186:187], v14 offset:49664
v_mfma_f32_16x16x32_bf16 v[116:119], a[128:131], a[96:99], v[116:119]
s_waitcnt vmcnt(6)
ds_read_b64_tr_b16 a[188:189], v14 offset:53248
ds_read_b64_tr_b16 a[190:191], v14 offset:53760
v_mfma_f32_16x16x32_bf16 v[116:119], a[132:135], a[100:103], v[116:119]
buffer_store_dwordx4 v[216:219], v4, s[24:27], s53 offen offset:1024 sc1
v_mfma_f32_16x16x32_bf16 v[124:127], a[140:143], a[100:103], v[124:127]
v_cmp_gt_u32 vcc, 1, v30
v_mfma_f32_16x16x32_bf16 v[124:127], a[136:139], a[96:99], v[124:127]
ds_read_b128 a[112:115], v4 offset:57344
v_accvgpr_read_b32 v216, a200
v_mfma_f32_16x16x32_bf16 v[132:135], a[144:147], a[96:99], v[132:135]
buffer_load_dwordx4 v6, s[12:15], s64 offen offset:1024 lds
v_mfma_f32_16x16x32_bf16 v[132:135], a[148:151], a[100:103], v[132:135]
ds_read_b128 a[116:119], v4 offset:59392
v_accvgpr_read_b32 v217, a201
v_mfma_f32_16x16x32_bf16 v[140:143], a[156:159], a[100:103], v[140:143]
v_accvgpr_read_b32 v218, a202
v_accvgpr_read_b32 v219, a203
v_mfma_f32_16x16x32_bf16 v[140:143], a[152:155], a[96:99], v[140:143]
s_lshr_b32 s84, s7, 1
s_and_b32 s85, s7, 1
ds_read_b128 a[120:123], v4 offset:58368
v_mfma_f32_16x16x32_bf16 v[148:151], a[64:67], a[96:99], v[148:151]
s_add_u32 m0, s73, 38912
s_add_u32 s64, s72, 18432
s_xor_b32 s52, s5, 0
v_mfma_f32_16x16x32_bf16 v[148:151], a[68:71], a[100:103], v[148:151]
s_lshl1_add_u32 s85, s52, s85
s_and_b32 s86, s6, 3
ds_read_b128 a[124:127], v4 offset:60416
v_mfma_f32_16x16x32_bf16 v[48:51], a[76:79], a[100:103], v[48:51]
buffer_load_dwordx4 v5, s[12:15], s64 offen lds
v_mfma_f32_16x16x32_bf16 v[48:51], a[72:75], a[96:99], v[48:51]
s_waitcnt lgkmcnt(15)
s_lshl_b32 s83, s3, 13
s_add_u32 s83, s83, 131072
v_mfma_f32_16x16x32_bf16 v[156:159], a[72:75], a[104:107], v[156:159]
s_cbranch_vccnz CK_ZA
CK_ZA_R:
v_mfma_f32_16x16x32_bf16 v[156:159], a[76:79], a[108:111], v[156:159]
s_mul_i32 s52, s2, 5462
s_lshr_b32 s52, s52, 16
s_mul_i32 s54, s52, 12
v_mfma_f32_16x16x32_bf16 v[164:167], a[68:71], a[108:111], v[164:167]
s_sub_u32 s54, s2, s54
s_mul_i32 s54, s54, 3
s_add_u32 s54, s54, s3
v_mfma_f32_16x16x32_bf16 v[164:167], a[64:67], a[104:107], v[164:167]
s_mul_i32 s55, s52, 13108
s_lshr_b32 s55, s55, 16
s_mul_i32 s82, s55, 5
v_mfma_f32_16x16x32_bf16 v[172:175], a[152:155], a[104:107], v[172:175]
buffer_load_dwordx4 v6, s[12:15], s64 offen offset:1024 lds
v_mfma_f32_16x16x32_bf16 v[172:175], a[156:159], a[108:111], v[172:175]
s_sub_u32 s52, s52, s82
v_mfma_f32_16x16x32_bf16 v[56:59], a[148:151], a[108:111], v[56:59]
v_lshrrev_b32 v16, 1, v1
v_and_b32 v17, 1, v1
v_mfma_f32_16x16x32_bf16 v[56:59], a[144:147], a[104:107], v[56:59]
v_mul_u32_u24 v18, 1152, v16
v_lshl_add_u32 v18, v17, 4, v18
v_mfma_f32_16x16x32_bf16 v[180:183], a[136:139], a[104:107], v[180:183]
v_mov_b32 v24, v18
v_lshrrev_b32 v18, 4, v16
v_mfma_f32_16x16x32_bf16 v[180:183], a[140:143], a[108:111], v[180:183]
v_bfe_u32 v19, v16, 2, 2
v_and_b32 v16, 3, v16
v_mfma_f32_16x16x32_bf16 v[188:191], a[132:135], a[108:111], v[188:191]
s_add_u32 s53, s88, 524288
v_lshrrev_b32 v20, 1, v19
v_mul_u32_u24 v20, 18, v20
v_mfma_f32_16x16x32_bf16 v[188:191], a[128:131], a[104:107], v[188:191]
s_waitcnt lgkmcnt(0)
v_and_b32 v21, 1, v19
v_lshl_add_u32 v20, v21, 1, v20
v_mfma_f32_16x16x32_bf16 v[196:199], a[160:163], a[80:83], v[196:199]
s_waitcnt vmcnt(18)
v_lshl_add_u32 v20, v16, 2, v20
v_add_u32 v20, v20, v18
v_mfma_f32_16x16x32_bf16 v[196:199], a[164:167], a[84:87], v[196:199]
s_barrier
v_mfma_f32_16x16x32_bf16 v[64:67], a[172:175], a[84:87], v[64:67]
ds_read_b64_tr_b16 a[128:129], v11 offset:0
ds_read_b64_tr_b16 a[130:131], v11 offset:512
v_mfma_f32_16x16x32_bf16 v[64:67], a[168:171], a[80:83], v[64:67]
s_add_u32 m0, s77, 49152
s_add_u32 s64, s76, 128
v_mad_u32_u24 v20, s52, 36, v20
v_mfma_f32_16x16x32_bf16 v[204:207], a[176:179], a[80:83], v[204:207]
buffer_load_dwordx4 v7, s[20:23], s64 offen lds
v_mfma_f32_16x16x32_bf16 v[204:207], a[180:183], a[84:87], v[204:207]
ds_read_b64_tr_b16 a[132:133], v11 offset:4096
ds_read_b64_tr_b16 a[134:135], v11 offset:4608
v_mfma_f32_16x16x32_bf16 v[212:215], a[188:191], a[84:87], v[212:215]
ds_read_b64_tr_b16 a[136:137], v12 offset:0
ds_read_b64_tr_b16 a[138:139], v12 offset:512
v_mfma_f32_16x16x32_bf16 v[212:215], a[184:187], a[80:83], v[212:215]
ds_read_b64_tr_b16 a[140:141], v12 offset:4096
ds_read_b64_tr_b16 a[142:143], v12 offset:4608
v_mfma_f32_16x16x32_bf16 v[72:75], a[112:115], a[80:83], v[72:75]
buffer_store_dwordx4 v[96:99], v4, s[24:27], s53 offen offset:0 sc1
v_mfma_f32_16x16x32_bf16 v[72:75], a[116:119], a[84:87], v[72:75]
ds_read_b64_tr_b16 a[144:145], v13 offset:0
ds_read_b64_tr_b16 a[146:147], v13 offset:512
v_mfma_f32_16x16x32_bf16 v[220:223], a[124:127], a[84:87], v[220:223]
buffer_load_dwordx4 v8, s[20:23], s64 offen offset:1024 lds
v_mfma_f32_16x16x32_bf16 v[220:223], a[120:123], a[80:83], v[220:223]
ds_read_b64_tr_b16 a[148:149], v13 offset:4096
ds_read_b64_tr_b16 a[150:151], v13 offset:4608
v_mfma_f32_16x16x32_bf16 v[252:255], a[120:123], a[88:91], v[252:255]
v_lshlrev_b32 v21, 1, v18
v_lshl_add_u32 v21, v19, 2, v21
v_mfma_f32_16x16x32_bf16 v[252:255], a[124:127], a[92:95], v[252:255]
ds_read_b64_tr_b16 a[152:153], v14 offset:0
ds_read_b64_tr_b16 a[154:155], v14 offset:512
v_mfma_f32_16x16x32_bf16 v[160:163], a[116:119], a[92:95], v[160:163]
s_add_u32 m0, s80, 49152
s_add_u32 s64, s79, 2048
v_lshrrev_b32 v22, 1, v16
v_mfma_f32_16x16x32_bf16 v[160:163], a[112:115], a[88:91], v[160:163]
ds_read_b64_tr_b16 a[156:157], v14 offset:4096
ds_read_b64_tr_b16 a[158:159], v14 offset:4608
v_mfma_f32_16x16x32_bf16 v[228:231], a[184:187], a[88:91], v[228:231]
buffer_load_dwordx4 v4, s[24:27], s64 offen sc1 lds
v_mfma_f32_16x16x32_bf16 v[228:231], a[188:191], a[92:95], v[228:231]
s_xor_b32 s65, s70, 640
s_add_u32 s71, s68, s65
s_add_u32 s72, s69, s65
v_mfma_f32_16x16x32_bf16 v[168:171], a[180:183], a[92:95], v[168:171]
ds_read_b128 a[64:67], v4 offset:8192
v_add_u32 v21, v21, v22
v_mfma_f32_16x16x32_bf16 v[168:171], a[176:179], a[88:91], v[168:171]
v_mul_u32_u24 v21, 18, v21
v_and_b32 v22, 1, v16
v_mfma_f32_16x16x32_bf16 v[176:179], a[168:171], a[88:91], v[176:179]
s_add_u32 m0, s73, 65536
s_add_u32 s64, s71, 0
ds_read_b128 a[80:83], v9 offset:0
v_mfma_f32_16x16x32_bf16 v[176:179], a[172:175], a[92:95], v[176:179]
v_add3_u32 v21, v21, v22, 16
v_cmp_lt_u32 s[96:97], 1, v19
v_mfma_f32_16x16x32_bf16 v[80:83], a[164:167], a[92:95], v[80:83]
buffer_load_dwordx4 v5, s[12:15], s64 offen lds
v_mfma_f32_16x16x32_bf16 v[80:83], a[160:163], a[88:91], v[80:83]
ds_read_b128 a[68:71], v4 offset:10240
v_mov_b32 v22, 0x100000
v_mfma_f32_16x16x32_bf16 v[184:187], a[160:163], a[96:99], v[184:187]
ds_read_b128 a[84:87], v10 offset:0
v_mul_u32_u24 v23, 1, v23
v_mfma_f32_16x16x32_bf16 v[184:187], a[164:167], a[100:103], v[184:187]
s_add_u32 s53, s88, 524288
v_cndmask_b32 v21, v21, v22, s[96:97]
v_mov_b32 v22, s52
v_mfma_f32_16x16x32_bf16 v[248:251], a[172:175], a[100:103], v[248:251]
buffer_store_dwordx4 v[104:107], v4, s[24:27], s53 offen offset:1024 sc1
v_mfma_f32_16x16x32_bf16 v[248:251], a[168:171], a[96:99], v[248:251]
ds_read_b128 a[72:75], v4 offset:9216
v_cmp_eq_u32 s[96:97], 4, v22
v_mfma_f32_16x16x32_bf16 v[240:243], a[176:179], a[96:99], v[240:243]
buffer_load_dwordx4 v6, s[12:15], s64 offen offset:1024 lds
v_mfma_f32_16x16x32_bf16 v[240:243], a[180:183], a[100:103], v[240:243]
ds_read_b128 a[88:91], v9 offset:2048
v_cndmask_b32 v20, v20, v21, s[96:97]
v_mfma_f32_16x16x32_bf16 v[232:235], a[188:191], a[100:103], v[232:235]
v_mul_u32_u24 v20, 1152, v20
v_lshl_add_u32 v20, v17, 4, v20
v_mfma_f32_16x16x32_bf16 v[232:235], a[184:187], a[96:99], v[232:235]
ds_read_b128 a[76:79], v4 offset:11264
v_mov_b32 v25, v20
v_mfma_f32_16x16x32_bf16 v[236:239], a[112:115], a[96:99], v[236:239]
s_add_u32 m0, s73, 67584
s_add_u32 s64, s71, 18432
v_mov_b32 v16, s54
v_mfma_f32_16x16x32_bf16 v[236:239], a[116:119], a[100:103], v[236:239]
ds_read_b128 a[92:95], v10 offset:2048
v_mov_b32 v17, s55
v_mfma_f32_16x16x32_bf16 v[224:227], a[124:127], a[100:103], v[224:227]
buffer_load_dwordx4 v5, s[12:15], s64 offen lds
v_mfma_f32_16x16x32_bf16 v[224:227], a[120:123], a[96:99], v[224:227]
v_add_u32 v18, 32, v22
v_mfma_f32_16x16x32_bf16 v[208:211], a[120:123], a[104:107], v[208:211]
s_mul_i32 s82, s55, 165888
s_lshl_b32 s54, s54, 5
s_add_u32 s82, s82, s54
v_mfma_f32_16x16x32_bf16 v[208:211], a[124:127], a[108:111], v[208:211]
s_and_b32 s52, s2, 1
s_lshr_b32 s54, s3, 1
s_lshl1_add_u32 s52, s52, s54
v_mfma_f32_16x16x32_bf16 v[216:219], a[116:119], a[108:111], v[216:219]
s_mul_i32 s52, s52, 9
s_and_b32 s54, s3, 1
s_mul_i32 s55, s54, 5
v_mfma_f32_16x16x32_bf16 v[216:219], a[112:115], a[104:107], v[216:219]
s_add_u32 s52, s52, s55
s_lshr_b32 s55, s2, 1
s_mul_i32 s81, s55, 1152
v_mfma_f32_16x16x32_bf16 v[244:247], a[184:187], a[104:107], v[244:247]
buffer_load_dwordx4 v6, s[12:15], s64 offen offset:1024 lds
v_mfma_f32_16x16x32_bf16 v[244:247], a[188:191], a[108:111], v[244:247]
s_add_u32 s81, s81, s52
s_lshl_b32 s81, s81, 5
v_mfma_f32_16x16x32_bf16 v[192:195], a[180:183], a[108:111], v[192:195]
v_cmp_gt_u32 s[96:97], 5, v1
v_add_u32 v19, s52, v1
v_mfma_f32_16x16x32_bf16 v[192:195], a[176:179], a[104:107], v[192:195]
v_lshrrev_b32 v20, 5, s55
v_and_b32 v21, 31, s55
v_mfma_f32_16x16x32_bf16 v[200:203], a[168:171], a[104:107], v[200:203]
v_cndmask_b32 v16, v16, v19, s[96:97]
v_cndmask_b32 v17, v17, v20, s[96:97]
v_mfma_f32_16x16x32_bf16 v[200:203], a[172:175], a[108:111], v[200:203]
v_cndmask_b32 v18, v18, v21, s[96:97]
v_mul_u32_u24 v19, 7282, v16
v_mfma_f32_16x16x32_bf16 v[88:91], a[164:167], a[108:111], v[88:91]
v_lshrrev_b32 v19, 16, v19
v_mul_u32_u24 v20, 9, v19
v_mfma_f32_16x16x32_bf16 v[88:91], a[160:163], a[104:107], v[88:91]
s_waitcnt lgkmcnt(0)
v_sub_u32 v16, v16, v20
v_and_b32 v20, 1, v19
v_mfma_f32_16x16x32_bf16 v[36:39], a[128:131], a[80:83], v[36:39]
s_waitcnt vmcnt(24)
v_lshlrev_b32 v20, 2, v20
v_cndmask_b32 v20, 0, v20, s[96:97]
v_mfma_f32_16x16x32_bf16 v[36:39], a[132:135], a[84:87], v[36:39]
s_barrier
v_mfma_f32_16x16x32_bf16 v[44:47], a[140:143], a[84:87], v[44:47]
ds_read_b128 a[96:99], v9 offset:4096
v_xor_b32 v18, v18, v20
v_mfma_f32_16x16x32_bf16 v[44:47], a[136:139], a[80:83], v[44:47]
s_xor_b32 s75, s93, 5
s_lshl_b32 s76, s75, 19
s_add_u32 s76, s76, s74
v_mfma_f32_16x16x32_bf16 v[32:35], a[144:147], a[80:83], v[32:35]
s_lshl_b32 s79, s75, 13
s_add_u32 s79, s79, s78
ds_read_b128 a[100:103], v10 offset:4096
v_mfma_f32_16x16x32_bf16 v[32:35], a[148:151], a[84:87], v[32:35]
s_add_u32 m0, s77, 0
s_add_u32 s64, s76, 0
ds_read_b128 a[104:107], v9 offset:6144
v_mfma_f32_16x16x32_bf16 v[52:55], a[156:159], a[84:87], v[52:55]
buffer_load_dwordx4 v7, s[20:23], s64 offen lds
v_mfma_f32_16x16x32_bf16 v[52:55], a[152:155], a[80:83], v[52:55]
s_add_u32 s53, s88, 524288
ds_read_b64_tr_b16 a[160:161], v11 offset:16384
ds_read_b64_tr_b16 a[162:163], v11 offset:16896
v_mfma_f32_16x16x32_bf16 v[60:63], a[64:67], a[80:83], v[60:63]
buffer_store_dwordx4 v[112:115], v4, s[24:27], s53 offen offset:2048 sc1
v_mfma_f32_16x16x32_bf16 v[60:63], a[68:71], a[84:87], v[60:63]
ds_read_b128 a[108:111], v10 offset:6144
v_lshl_add_u32 v19, v19, 2, v17
v_mfma_f32_16x16x32_bf16 v[68:71], a[76:79], a[84:87], v[68:71]
buffer_load_dwordx4 v8, s[20:23], s64 offen offset:1024 lds
v_mfma_f32_16x16x32_bf16 v[68:71], a[72:75], a[80:83], v[68:71]
ds_read_b64_tr_b16 a[164:165], v11 offset:20480
ds_read_b64_tr_b16 a[166:167], v11 offset:20992
v_mfma_f32_16x16x32_bf16 v[76:79], a[72:75], a[88:91], v[76:79]
v_add_u32 v9, 32768, v9
v_add_u32 v10, 32768, v10
v_mfma_f32_16x16x32_bf16 v[76:79], a[76:79], a[92:95], v[76:79]
ds_read_b64_tr_b16 a[168:169], v12 offset:16384
ds_read_b64_tr_b16 a[170:171], v12 offset:16896
v_mfma_f32_16x16x32_bf16 v[84:87], a[68:71], a[92:95], v[84:87]
s_add_u32 m0, s80, 0
s_add_u32 s64, s79, 0
v_mul_u32_u24 v19, 344064, v19
v_mfma_f32_16x16x32_bf16 v[84:87], a[64:67], a[88:91], v[84:87]
ds_read_b64_tr_b16 a[172:173], v12 offset:20480
ds_read_b64_tr_b16 a[174:175], v12 offset:20992
v_mfma_f32_16x16x32_bf16 v[92:95], a[152:155], a[88:91], v[92:95]
buffer_load_dwordx4 v4, s[24:27], s64 offen sc1 lds
v_mfma_f32_16x16x32_bf16 v[92:95], a[156:159], a[92:95], v[92:95]
v_lshrrev_b32 v20, 1, v16
v_sub_u32 v20, v20, v17
v_mfma_f32_16x16x32_bf16 v[40:43], a[148:151], a[92:95], v[40:43]
ds_read_b64_tr_b16 a[176:177], v13 offset:16384
ds_read_b64_tr_b16 a[178:179], v13 offset:16896
v_mfma_f32_16x16x32_bf16 v[40:43], a[144:147], a[88:91], v[40:43]
v_add_u32 v20, 3, v20
v_and_b32 v20, 3, v20
v_mfma_f32_16x16x32_bf16 v[100:103], a[136:139], a[88:91], v[100:103]
s_add_u32 m0, s73, 69632
s_add_u32 s64, s72, 0
v_cmp_eq_u32 s[96:97], 8, v16
v_mfma_f32_16x16x32_bf16 v[100:103], a[140:143], a[92:95], v[100:103]
ds_read_b64_tr_b16 a[180:181], v13 offset:20480
ds_read_b64_tr_b16 a[182:183], v13 offset:20992
v_mfma_f32_16x16x32_bf16 v[108:111], a[132:135], a[92:95], v[108:111]
buffer_load_dwordx4 v5, s[12:15], s64 offen lds
v_mfma_f32_16x16x32_bf16 v[108:111], a[128:131], a[88:91], v[108:111]
s_waitcnt lgkmcnt(14)
ds_read_b64_tr_b16 a[184:185], v14 offset:16384
ds_read_b64_tr_b16 a[186:187], v14 offset:16896
v_mfma_f32_16x16x32_bf16 v[116:119], a[128:131], a[96:99], v[116:119]
ds_read_b64_tr_b16 a[188:189], v14 offset:20480
ds_read_b64_tr_b16 a[190:191], v14 offset:20992
v_mfma_f32_16x16x32_bf16 v[116:119], a[132:135], a[100:103], v[116:119]
v_and_b32 v16, 1, v16
v_lshl_add_u32 v21, v20, 1, v16
v_mfma_f32_16x16x32_bf16 v[124:127], a[140:143], a[100:103], v[124:127]
v_and_b32 v22, 1, v18
v_lshl_add_u32 v19, v22, 10, v19
v_mfma_f32_16x16x32_bf16 v[124:127], a[136:139], a[96:99], v[124:127]
ds_read_b128 a[112:115], v4 offset:24576
v_and_b32 v18, -2, v18
v_mfma_f32_16x16x32_bf16 v[132:135], a[144:147], a[96:99], v[132:135]
buffer_load_dwordx4 v6, s[12:15], s64 offen offset:1024 lds
v_mfma_f32_16x16x32_bf16 v[132:135], a[148:151], a[100:103], v[132:135]
ds_read_b128 a[116:119], v4 offset:26624
v_add_u32 v21, 1, v21
v_mfma_f32_16x16x32_bf16 v[140:143], a[156:159], a[100:103], v[140:143]
v_cndmask_b32 v21, v21, 0, s[96:97]
v_cndmask_b32 v20, v20, 0, s[96:97]
v_mfma_f32_16x16x32_bf16 v[140:143], a[152:155], a[96:99], v[140:143]
s_add_u32 s53, s88, 524288
ds_read_b128 a[120:123], v4 offset:25600
v_sub_u32 v17, 37, v18
v_mfma_f32_16x16x32_bf16 v[148:151], a[64:67], a[96:99], v[148:151]
s_add_u32 m0, s73, 71680
s_add_u32 s64, s72, 18432
v_min_u32 v17, 2, v17
v_mfma_f32_16x16x32_bf16 v[148:151], a[68:71], a[100:103], v[148:151]
ds_read_b128 a[124:127], v4 offset:27648
v_mul_u32_u24 v21, v21, v17
v_mfma_f32_16x16x32_bf16 v[48:51], a[76:79], a[100:103], v[48:51]
buffer_load_dwordx4 v5, s[12:15], s64 offen lds
v_mfma_f32_16x16x32_bf16 v[48:51], a[72:75], a[96:99], v[48:51]
s_waitcnt lgkmcnt(15)
v_mul_u32_u24 v22, v16, v17
v_min_u32 v23, 16, v18
v_mfma_f32_16x16x32_bf16 v[156:159], a[72:75], a[104:107], v[156:159]
buffer_store_dwordx4 v[120:123], v4, s[24:27], s53 offen offset:3072 sc1
v_mfma_f32_16x16x32_bf16 v[156:159], a[76:79], a[108:111], v[156:159]
v_mad_u32_u24 v21, v18, 5, v21
v_lshl_add_u32 v21, v23, 1, v21
v_mfma_f32_16x16x32_bf16 v[164:167], a[68:71], a[108:111], v[164:167]
v_lshl_add_u32 v22, v18, 1, v22
v_mad_u32_u24 v22, v20, 37, v22
v_mfma_f32_16x16x32_bf16 v[164:167], a[64:67], a[104:107], v[164:167]
v_mad_u32_u24 v22, v20, 37, v22
v_lshl_add_u32 v20, v20, 6, v18
v_mfma_f32_16x16x32_bf16 v[172:175], a[152:155], a[104:107], v[172:175]
buffer_load_dwordx4 v6, s[12:15], s64 offen offset:1024 lds
v_mfma_f32_16x16x32_bf16 v[172:175], a[156:159], a[108:111], v[172:175]
v_mov_b32 v23, 144
v_cmp_gt_u32 s[96:97], v23, v20
v_mfma_f32_16x16x32_bf16 v[56:59], a[148:151], a[108:111], v[56:59]
v_add_u32 v22, 37, v22
v_add_u32 v19, 38797312, v19
v_mfma_f32_16x16x32_bf16 v[56:59], a[144:147], a[104:107], v[56:59]
v_cndmask_b32 v21, v22, v21, s[96:97]
v_lshl_add_u32 v19, v21, 10, v19
v_mfma_f32_16x16x32_bf16 v[180:183], a[136:139], a[104:107], v[180:183]
s_cmp_eq_u32 s54, 1
s_cselect_b32 s96, 16, 0
v_mfma_f32_16x16x32_bf16 v[180:183], a[140:143], a[108:111], v[180:183]
s_cmp_eq_u32 s3, 3
s_cselect_b32 s52, 32, 0
s_or_b32 s96, s96, s52
v_mfma_f32_16x16x32_bf16 v[188:191], a[132:135], a[108:111], v[188:191]
s_cmp_ge_u32 s2, 240
s_cselect_b32 s52, 32, 0
s_or_b32 s96, s96, s52
v_mfma_f32_16x16x32_bf16 v[188:191], a[128:131], a[104:107], v[188:191]
s_waitcnt lgkmcnt(0)
s_mov_b32 s97, 0
v_mfma_f32_16x16x32_bf16 v[196:199], a[160:163], a[80:83], v[196:199]
s_waitcnt vmcnt(18)
v_mov_b32 v20, 2147418112
v_cndmask_b32 v26, v19, v20, s[96:97]
v_mfma_f32_16x16x32_bf16 v[196:199], a[164:167], a[84:87], v[196:199]
s_barrier
v_mfma_f32_16x16x32_bf16 v[64:67], a[172:175], a[84:87], v[64:67]
L_PAD6:
s_cbranch_execz L_PAD10
ds_read_b64_tr_b16 a[128:129], v11 offset:32768
ds_read_b64_tr_b16 a[130:131], v11 offset:33280
v_mfma_f32_16x16x32_bf16 v[64:67], a[168:171], a[80:83], v[64:67]
s_add_u32 m0, s77, 16384
s_add_u32 s64, s76, 128
v_lshlrev_b32 v27, 3, v1
v_mfma_f32_16x16x32_bf16 v[204:207], a[176:179], a[80:83], v[204:207]
buffer_load_dwordx4 v7, s[20:23], s64 offen lds
v_mfma_f32_16x16x32_bf16 v[204:207], a[180:183], a[84:87], v[204:207]
ds_read_b64_tr_b16 a[132:133], v11 offset:36864
ds_read_b64_tr_b16 a[134:135], v11 offset:37376
v_mfma_f32_16x16x32_bf16 v[212:215], a[188:191], a[84:87], v[212:215]
ds_read_b64_tr_b16 a[136:137], v12 offset:32768
ds_read_b64_tr_b16 a[138:139], v12 offset:33280
v_mfma_f32_16x16x32_bf16 v[212:215], a[184:187], a[80:83], v[212:215]
ds_read_b64_tr_b16 a[140:141], v12 offset:36864
ds_read_b64_tr_b16 a[142:143], v12 offset:37376
v_mfma_f32_16x16x32_bf16 v[72:75], a[112:115], a[80:83], v[72:75]
buffer_atomic_add v1, v0, s[24:27], s90 offen offset:4 sc1
v_mfma_f32_16x16x32_bf16 v[72:75], a[116:119], a[84:87], v[72:75]
ds_read_b64_tr_b16 a[144:145], v13 offset:32768
ds_read_b64_tr_b16 a[146:147], v13 offset:33280
v_mfma_f32_16x16x32_bf16 v[220:223], a[124:127], a[84:87], v[220:223]
buffer_load_dwordx4 v8, s[20:23], s64 offen offset:1024 lds
v_mfma_f32_16x16x32_bf16 v[220:223], a[120:123], a[80:83], v[220:223]
s_add_u32 s53, s88, 786432
ds_read_b64_tr_b16 a[148:149], v13 offset:36864
ds_read_b64_tr_b16 a[150:151], v13 offset:37376
v_mfma_f32_16x16x32_bf16 v[252:255], a[120:123], a[88:91], v[252:255]
buffer_store_dwordx4 v[128:131], v4, s[24:27], s53 offen offset:0 sc1
v_mfma_f32_16x16x32_bf16 v[252:255], a[124:127], a[92:95], v[252:255]
ds_read_b64_tr_b16 a[152:153], v14 offset:32768
ds_read_b64_tr_b16 a[154:155], v14 offset:33280
v_mfma_f32_16x16x32_bf16 v[160:163], a[116:119], a[92:95], v[160:163]
s_add_u32 m0, s80, 16384
s_add_u32 s64, s79, 2048
v_add_u32 v27, s83, v27
v_mfma_f32_16x16x32_bf16 v[160:163], a[112:115], a[88:91], v[160:163]
ds_read_b64_tr_b16 a[156:157], v14 offset:36864
ds_read_b64_tr_b16 a[158:159], v14 offset:37376
v_mfma_f32_16x16x32_bf16 v[228:231], a[184:187], a[88:91], v[228:231]
buffer_load_dwordx4 v4, s[24:27], s64 offen sc1 lds
v_mfma_f32_16x16x32_bf16 v[228:231], a[188:191], a[92:95], v[228:231]
s_xor_b32 s65, s70, 768
s_add_u32 s71, s68, s65
s_add_u32 s72, s69, s65
v_mfma_f32_16x16x32_bf16 v[168:171], a[180:183], a[92:95], v[168:171]
ds_read_b128 a[64:67], v4 offset:40960
v_lshrrev_b32 v22, 3, v1
v_mfma_f32_16x16x32_bf16 v[168:171], a[176:179], a[88:91], v[168:171]
v_mul_u32_u24 v22, 1152, v22
v_and_b32 v23, 7, v1
v_mfma_f32_16x16x32_bf16 v[176:179], a[168:171], a[88:91], v[176:179]
s_add_u32 m0, s73, 0
s_add_u32 s64, s71, 0
ds_read_b128 a[80:83], v9 offset:0
v_mfma_f32_16x16x32_bf16 v[176:179], a[172:175], a[92:95], v[176:179]
v_lshl_add_u32 v22, v23, 4, v22
v_lshrrev_b32 v23, 2, v1
v_mfma_f32_16x16x32_bf16 v[80:83], a[164:167], a[92:95], v[80:83]
buffer_load_dwordx4 v5, s[12:15], s64 offen lds
v_mfma_f32_16x16x32_bf16 v[80:83], a[160:163], a[88:91], v[80:83]
ds_read_b128 a[68:71], v4 offset:43008
v_mul_u32_u24 v23, 96, v23
v_mfma_f32_16x16x32_bf16 v[184:187], a[160:163], a[96:99], v[184:187]
ds_read_b128 a[84:87], v10 offset:0
v_add_u32 v23, v23, v27
v_mfma_f32_16x16x32_bf16 v[184:187], a[164:167], a[100:103], v[184:187]
v_and_b32 v16, 3, v1
v_cmp_eq_u32 s[96:97], 0, v16
v_mfma_f32_16x16x32_bf16 v[248:251], a[172:175], a[100:103], v[248:251]
v_mov_b32 v16, 0x3f803f80
v_mfma_f32_16x16x32_bf16 v[248:251], a[168:171], a[96:99], v[248:251]
ds_read_b128 a[72:75], v4 offset:41984
v_cndmask_b32 v16, 0, v16, s[96:97]
v_mfma_f32_16x16x32_bf16 v[240:243], a[176:179], a[96:99], v[240:243]
buffer_load_dwordx4 v6, s[12:15], s64 offen offset:1024 lds
v_mfma_f32_16x16x32_bf16 v[240:243], a[180:183], a[100:103], v[240:243]
ds_read_b128 a[88:91], v9 offset:2048
v_accvgpr_write_b32 a240, v16
v_mfma_f32_16x16x32_bf16 v[232:235], a[188:191], a[100:103], v[232:235]
v_accvgpr_write_b32 a241, v16
v_accvgpr_write_b32 a242, v16
v_mfma_f32_16x16x32_bf16 v[232:235], a[184:187], a[96:99], v[232:235]
ds_read_b128 a[76:79], v4 offset:44032
v_accvgpr_write_b32 a243, v16
v_mfma_f32_16x16x32_bf16 v[236:239], a[112:115], a[96:99], v[236:239]
s_add_u32 m0, s73, 2048
s_add_u32 s64, s71, 18432
v_accvgpr_write_b32 a232, 0
v_mfma_f32_16x16x32_bf16 v[236:239], a[116:119], a[100:103], v[236:239]
ds_read_b128 a[92:95], v10 offset:2048
v_accvgpr_write_b32 a233, 0
v_mfma_f32_16x16x32_bf16 v[224:227], a[124:127], a[100:103], v[224:227]
buffer_load_dwordx4 v5, s[12:15], s64 offen lds
v_mfma_f32_16x16x32_bf16 v[224:227], a[120:123], a[96:99], v[224:227]
v_accvgpr_write_b32 a234, 0
v_accvgpr_write_b32 a235, 0
v_mfma_f32_16x16x32_bf16 v[208:211], a[120:123], a[104:107], v[208:211]
v_accvgpr_write_b32 a236, 0
v_accvgpr_write_b32 a237, 0
v_mfma_f32_16x16x32_bf16 v[208:211], a[124:127], a[108:111], v[208:211]
s_add_u32 s53, s88, 786432
v_accvgpr_write_b32 a238, 0
v_accvgpr_write_b32 a239, 0
v_mfma_f32_16x16x32_bf16 v[216:219], a[116:119], a[108:111], v[216:219]
buffer_store_dwordx4 v[136:139], v4, s[24:27], s53 offen offset:1024 sc1
v_mfma_f32_16x16x32_bf16 v[216:219], a[112:115], a[104:107], v[216:219]
v_lshlrev_b32 v16, 2, v3
v_sub_u32 v16, v2, v16
v_mfma_f32_16x16x32_bf16 v[244:247], a[184:187], a[104:107], v[244:247]
buffer_load_dwordx4 v6, s[12:15], s64 offen offset:1024 lds
v_mfma_f32_16x16x32_bf16 v[244:247], a[188:191], a[108:111], v[244:247]
v_cmp_gt_i32 s[56:57], 0, v16
v_cmp_gt_i32 s[58:59], 1, v16
v_mfma_f32_16x16x32_bf16 v[192:195], a[180:183], a[108:111], v[192:195]
v_cmp_gt_i32 s[60:61], 2, v16
v_cmp_gt_i32 s[62:63], 3, v16
v_mfma_f32_16x16x32_bf16 v[192:195], a[176:179], a[104:107], v[192:195]
v_cmp_eq_u32 s[96:97], 3, v3
v_add_u32 v17, 48, v2
v_mfma_f32_16x16x32_bf16 v[200:203], a[168:171], a[104:107], v[200:203]
v_lshlrev_b32 v17, 2, v17
v_lshlrev_b32 v18, 16, v3
v_mfma_f32_16x16x32_bf16 v[200:203], a[172:175], a[108:111], v[200:203]
v_lshl_add_u32 v18, v2, 4, v18
v_add_u32 v19, 0x8000, v18
v_mfma_f32_16x16x32_bf16 v[88:91], a[164:167], a[108:111], v[88:91]
v_cndmask_b32 v19, v19, v20, s[96:97]
v_mfma_f32_16x16x32_bf16 v[88:91], a[160:163], a[104:107], v[88:91]
s_waitcnt lgkmcnt(0)
v_mfma_f32_16x16x32_bf16 v[36:39], a[128:131], a[80:83], v[36:39]
s_waitcnt vmcnt(24)
v_mfma_f32_16x16x32_bf16 v[36:39], a[132:135], a[84:87], v[36:39]
s_barrier
v_mfma_f32_16x16x32_bf16 v[44:47], a[140:143], a[84:87], v[44:47]
ds_read_b128 a[96:99], v9 offset:4096
v_mfma_f32_16x16x32_bf16 v[44:47], a[136:139], a[80:83], v[44:47]
s_xor_b32 s75, s93, 6
s_lshl_b32 s76, s75, 19
s_add_u32 s76, s76, s74
v_mfma_f32_16x16x32_bf16 v[32:35], a[144:147], a[80:83], v[32:35]
s_lshl_b32 s79, s75, 13
s_add_u32 s79, s79, s78
ds_read_b128 a[100:103], v10 offset:4096
v_mfma_f32_16x16x32_bf16 v[32:35], a[148:151], a[84:87], v[32:35]
s_add_u32 m0, s77, 32768
s_add_u32 s64, s76, 0
ds_read_b128 a[104:107], v9 offset:6144
v_mfma_f32_16x16x32_bf16 v[52:55], a[156:159], a[84:87], v[52:55]
buffer_load_dwordx4 v7, s[20:23], s64 offen lds
v_mfma_f32_16x16x32_bf16 v[52:55], a[152:155], a[80:83], v[52:55]
ds_read_b64_tr_b16 a[160:161], v11 offset:49152
ds_read_b64_tr_b16 a[162:163], v11 offset:49664
v_mfma_f32_16x16x32_bf16 v[60:63], a[64:67], a[80:83], v[60:63]
v_mfma_f32_16x16x32_bf16 v[60:63], a[68:71], a[84:87], v[60:63]
ds_read_b128 a[108:111], v10 offset:6144
v_mfma_f32_16x16x32_bf16 v[68:71], a[76:79], a[84:87], v[68:71]
buffer_load_dwordx4 v8, s[20:23], s64 offen offset:1024 lds
v_mfma_f32_16x16x32_bf16 v[68:71], a[72:75], a[80:83], v[68:71]
ds_read_b64_tr_b16 a[164:165], v11 offset:53248
ds_read_b64_tr_b16 a[166:167], v11 offset:53760
v_mfma_f32_16x16x32_bf16 v[76:79], a[72:75], a[88:91], v[76:79]
v_add_u32 v9, 32768, v9
v_add_u32 v10, 32768, v10
v_mfma_f32_16x16x32_bf16 v[76:79], a[76:79], a[92:95], v[76:79]
ds_read_b64_tr_b16 a[168:169], v12 offset:49152
ds_read_b64_tr_b16 a[170:171], v12 offset:49664
v_mfma_f32_16x16x32_bf16 v[84:87], a[68:71], a[92:95], v[84:87]
s_add_u32 m0, s80, 32768
s_add_u32 s64, s79, 0
v_mfma_f32_16x16x32_bf16 v[84:87], a[64:67], a[88:91], v[84:87]
ds_read_b64_tr_b16 a[172:173], v12 offset:53248
ds_read_b64_tr_b16 a[174:175], v12 offset:53760
v_mfma_f32_16x16x32_bf16 v[92:95], a[152:155], a[88:91], v[92:95]
buffer_load_dwordx4 v4, s[24:27], s64 offen sc1 lds
v_mfma_f32_16x16x32_bf16 v[92:95], a[156:159], a[92:95], v[92:95]
s_add_u32 s53, s88, 786432
v_mfma_f32_16x16x32_bf16 v[40:43], a[148:151], a[92:95], v[40:43]
ds_read_b64_tr_b16 a[176:177], v13 offset:49152
ds_read_b64_tr_b16 a[178:179], v13 offset:49664
v_mfma_f32_16x16x32_bf16 v[40:43], a[144:147], a[88:91], v[40:43]
buffer_store_dwordx4 v[144:147], v4, s[24:27], s53 offen offset:2048 sc1
v_mfma_f32_16x16x32_bf16 v[100:103], a[136:139], a[88:91], v[100:103]
s_add_u32 m0, s73, 4096
s_add_u32 s64, s72, 0
v_mfma_f32_16x16x32_bf16 v[100:103], a[140:143], a[92:95], v[100:103]
ds_read_b64_tr_b16 a[180:181], v13 offset:53248
ds_read_b64_tr_b16 a[182:183], v13 offset:53760
v_mfma_f32_16x16x32_bf16 v[108:111], a[132:135], a[92:95], v[108:111]
buffer_load_dwordx4 v5, s[12:15], s64 offen lds
v_mfma_f32_16x16x32_bf16 v[108:111], a[128:131], a[88:91], v[108:111]
s_waitcnt lgkmcnt(14)
ds_read_b64_tr_b16 a[184:185], v14 offset:49152
ds_read_b64_tr_b16 a[186:187], v14 offset:49664
v_mfma_f32_16x16x32_bf16 v[116:119], a[128:131], a[96:99], v[116:119]
ds_read_b64_tr_b16 a[188:189], v14 offset:53248
ds_read_b64_tr_b16 a[190:191], v14 offset:53760
v_mfma_f32_16x16x32_bf16 v[116:119], a[132:135], a[100:103], v[116:119]
v_mfma_f32_16x16x32_bf16 v[124:127], a[140:143], a[100:103], v[124:127]
v_mfma_f32_16x16x32_bf16 v[124:127], a[136:139], a[96:99], v[124:127]
ds_read_b128 a[112:115], v4 offset:57344
v_mfma_f32_16x16x32_bf16 v[132:135], a[144:147], a[96:99], v[132:135]
buffer_load_dwordx4 v6, s[12:15], s64 offen offset:1024 lds
v_mfma_f32_16x16x32_bf16 v[132:135], a[148:151], a[100:103], v[132:135]
ds_read_b128 a[116:119], v4 offset:59392
v_mfma_f32_16x16x32_bf16 v[140:143], a[156:159], a[100:103], v[140:143]
v_mfma_f32_16x16x32_bf16 v[140:143], a[152:155], a[96:99], v[140:143]
ds_read_b128 a[120:123], v4 offset:58368
v_mfma_f32_16x16x32_bf16 v[148:151], a[64:67], a[96:99], v[148:151]
s_add_u32 m0, s73, 6144
s_add_u32 s64, s72, 18432
v_mfma_f32_16x16x32_bf16 v[148:151], a[68:71], a[100:103], v[148:151]
ds_read_b128 a[124:127], v4 offset:60416
v_mfma_f32_16x16x32_bf16 v[48:51], a[76:79], a[100:103], v[48:51]
buffer_load_dwordx4 v5, s[12:15], s64 offen lds
v_mfma_f32_16x16x32_bf16 v[48:51], a[72:75], a[96:99], v[48:51]
s_waitcnt lgkmcnt(15)
v_mfma_f32_16x16x32_bf16 v[156:159], a[72:75], a[104:107], v[156:159]
v_mfma_f32_16x16x32_bf16 v[156:159], a[76:79], a[108:111], v[156:159]
v_mfma_f32_16x16x32_bf16 v[164:167], a[68:71], a[108:111], v[164:167]
v_mfma_f32_16x16x32_bf16 v[164:167], a[64:67], a[104:107], v[164:167]
v_mfma_f32_16x16x32_bf16 v[172:175], a[152:155], a[104:107], v[172:175]
buffer_load_dwordx4 v6, s[12:15], s64 offen offset:1024 lds
v_mfma_f32_16x16x32_bf16 v[172:175], a[156:159], a[108:111], v[172:175]
v_mfma_f32_16x16x32_bf16 v[56:59], a[148:151], a[108:111], v[56:59]
v_mfma_f32_16x16x32_bf16 v[56:59], a[144:147], a[104:107], v[56:59]
s_add_u32 s53, s88, 786432
v_mfma_f32_16x16x32_bf16 v[180:183], a[136:139], a[104:107], v[180:183]
buffer_store_dwordx4 v[152:155], v4, s[24:27], s53 offen offset:3072 sc1
v_mfma_f32_16x16x32_bf16 v[180:183], a[140:143], a[108:111], v[180:183]
v_mfma_f32_16x16x32_bf16 v[188:191], a[132:135], a[108:111], v[188:191]
v_mfma_f32_16x16x32_bf16 v[188:191], a[128:131], a[104:107], v[188:191]
s_waitcnt lgkmcnt(0)
v_mov_b32 v96, 0
v_mov_b32 v97, 0
v_mfma_f32_16x16x32_bf16 v[196:199], a[160:163], a[80:83], v[196:199]
s_waitcnt vmcnt(19)
v_mov_b32 v98, 0
v_mov_b32 v99, 0
v_mfma_f32_16x16x32_bf16 v[196:199], a[164:167], a[84:87], v[196:199]
s_barrier
v_mfma_f32_16x16x32_bf16 v[64:67], a[172:175], a[84:87], v[64:67]
ds_read_b64_tr_b16 a[128:129], v11 offset:0
ds_read_b64_tr_b16 a[130:131], v11 offset:512
v_mfma_f32_16x16x32_bf16 v[64:67], a[168:171], a[80:83], v[64:67]
s_add_u32 m0, s77, 49152
s_add_u32 s64, s76, 128
v_mov_b32 v104, 0
v_mfma_f32_16x16x32_bf16 v[204:207], a[176:179], a[80:83], v[204:207]
buffer_load_dwordx4 v7, s[20:23], s64 offen lds
v_mfma_f32_16x16x32_bf16 v[204:207], a[180:183], a[84:87], v[204:207]
ds_read_b64_tr_b16 a[132:133], v11 offset:4096
ds_read_b64_tr_b16 a[134:135], v11 offset:4608
v_mfma_f32_16x16x32_bf16 v[212:215], a[188:191], a[84:87], v[212:215]
ds_read_b64_tr_b16 a[136:137], v12 offset:0
ds_read_b64_tr_b16 a[138:139], v12 offset:512
v_mfma_f32_16x16x32_bf16 v[212:215], a[184:187], a[80:83], v[212:215]
ds_read_b64_tr_b16 a[140:141], v12 offset:4096
ds_read_b64_tr_b16 a[142:143], v12 offset:4608
v_mfma_f32_16x16x32_bf16 v[72:75], a[112:115], a[80:83], v[72:75]
buffer_load_dword v30, v29, s[24:27], s89 offen offset:4 sc1
v_mfma_f32_16x16x32_bf16 v[72:75], a[116:119], a[84:87], v[72:75]
ds_read_b64_tr_b16 a[144:145], v13 offset:0
ds_read_b64_tr_b16 a[146:147], v13 offset:512
v_mfma_f32_16x16x32_bf16 v[220:223], a[124:127], a[84:87], v[220:223]
buffer_load_dwordx4 v8, s[20:23], s64 offen offset:1024 lds
v_mfma_f32_16x16x32_bf16 v[220:223], a[120:123], a[80:83], v[220:223]
ds_read_b64_tr_b16 a[148:149], v13 offset:4096
ds_read_b64_tr_b16 a[150:151], v13 offset:4608
v_mfma_f32_16x16x32_bf16 v[252:255], a[120:123], a[88:91], v[252:255]
v_mov_b32 v105, 0
v_mov_b32 v106, 0
v_mfma_f32_16x16x32_bf16 v[252:255], a[124:127], a[92:95], v[252:255]
ds_read_b64_tr_b16 a[152:153], v14 offset:0
ds_read_b64_tr_b16 a[154:155], v14 offset:512
v_mfma_f32_16x16x32_bf16 v[160:163], a[116:119], a[92:95], v[160:163]
s_add_u32 m0, s80, 49152
s_add_u32 s64, s79, 2048
v_mov_b32 v107, 0
v_mfma_f32_16x16x32_bf16 v[160:163], a[112:115], a[88:91], v[160:163]
ds_read_b64_tr_b16 a[156:157], v14 offset:4096
ds_read_b64_tr_b16 a[158:159], v14 offset:4608
v_mfma_f32_16x16x32_bf16 v[228:231], a[184:187], a[88:91], v[228:231]
buffer_load_dwordx4 v4, s[24:27], s64 offen sc1 lds
v_mfma_f32_16x16x32_bf16 v[228:231], a[188:191], a[92:95], v[228:231]
s_xor_b32 s65, s70, 896
s_add_u32 s71, s68, s65
s_add_u32 s72, s69, s65
v_mfma_f32_16x16x32_bf16 v[168:171], a[180:183], a[92:95], v[168:171]
ds_read_b128 a[64:67], v4 offset:8192
v_mov_b32 v112, 0
v_mfma_f32_16x16x32_bf16 v[168:171], a[176:179], a[88:91], v[168:171]
v_mov_b32 v113, 0
v_mov_b32 v114, 0
v_mfma_f32_16x16x32_bf16 v[176:179], a[168:171], a[88:91], v[176:179]
s_add_u32 m0, s73, 32768
s_add_u32 s64, s71, 0
ds_read_b128 a[80:83], v9 offset:0
v_mfma_f32_16x16x32_bf16 v[176:179], a[172:175], a[92:95], v[176:179]
v_mov_b32 v115, 0
v_mov_b32 v120, 0
v_mfma_f32_16x16x32_bf16 v[80:83], a[164:167], a[92:95], v[80:83]
buffer_load_dwordx4 v5, s[12:15], s64 offen lds
v_mfma_f32_16x16x32_bf16 v[80:83], a[160:163], a[88:91], v[80:83]
s_add_u32 s53, s87, 524288
ds_read_b128 a[68:71], v4 offset:10240
v_mov_b32 v121, 0
v_mfma_f32_16x16x32_bf16 v[184:187], a[160:163], a[96:99], v[184:187]
ds_read_b128 a[84:87], v10 offset:0
v_mov_b32 v122, 0
v_mfma_f32_16x16x32_bf16 v[184:187], a[164:167], a[100:103], v[184:187]
buffer_store_dwordx4 a[28:31], v4, s[24:27], s53 offen offset:0 sc1
v_mfma_f32_16x16x32_bf16 v[248:251], a[172:175], a[100:103], v[248:251]
v_mov_b32 v123, 0
v_mov_b32 v128, 0
v_mfma_f32_16x16x32_bf16 v[248:251], a[168:171], a[96:99], v[248:251]
ds_read_b128 a[72:75], v4 offset:9216
v_mov_b32 v129, 0
v_mfma_f32_16x16x32_bf16 v[240:243], a[176:179], a[96:99], v[240:243]
buffer_load_dwordx4 v6, s[12:15], s64 offen offset:1024 lds
v_mfma_f32_16x16x32_bf16 v[240:243], a[180:183], a[100:103], v[240:243]
ds_read_b128 a[88:91], v9 offset:2048
v_mov_b32 v130, 0
v_mfma_f32_16x16x32_bf16 v[232:235], a[188:191], a[100:103], v[232:235]
v_mov_b32 v131, 0
v_mov_b32 v136, 0
v_mfma_f32_16x16x32_bf16 v[232:235], a[184:187], a[96:99], v[232:235]
ds_read_b128 a[76:79], v4 offset:11264
v_mov_b32 v137, 0
v_mfma_f32_16x16x32_bf16 v[236:239], a[112:115], a[96:99], v[236:239]
s_add_u32 m0, s73, 34816
s_add_u32 s64, s71, 18432
v_mov_b32 v138, 0
v_mfma_f32_16x16x32_bf16 v[236:239], a[116:119], a[100:103], v[236:239]
ds_read_b128 a[92:95], v10 offset:2048
v_mov_b32 v139, 0
v_mfma_f32_16x16x32_bf16 v[224:227], a[124:127], a[100:103], v[224:227]
buffer_load_dwordx4 v5, s[12:15], s64 offen lds
v_mfma_f32_16x16x32_bf16 v[224:227], a[120:123], a[96:99], v[224:227]
v_mov_b32 v144, 0
v_mov_b32 v145, 0
v_mfma_f32_16x16x32_bf16 v[208:211], a[120:123], a[104:107], v[208:211]
v_mov_b32 v146, 0
v_mov_b32 v147, 0
v_mfma_f32_16x16x32_bf16 v[208:211], a[124:127], a[108:111], v[208:211]
v_mov_b32 v152, 0
v_mov_b32 v153, 0
v_mfma_f32_16x16x32_bf16 v[216:219], a[116:119], a[108:111], v[216:219]
v_mov_b32 v154, 0
v_mov_b32 v155, 0
v_mfma_f32_16x16x32_bf16 v[216:219], a[112:115], a[104:107], v[216:219]
v_mfma_f32_16x16x32_bf16 v[244:247], a[184:187], a[104:107], v[244:247]
buffer_load_dwordx4 v6, s[12:15], s64 offen offset:1024 lds
v_mfma_f32_16x16x32_bf16 v[244:247], a[188:191], a[108:111], v[244:247]
v_mfma_f32_16x16x32_bf16 v[192:195], a[180:183], a[108:111], v[192:195]
v_mfma_f32_16x16x32_bf16 v[192:195], a[176:179], a[104:107], v[192:195]
v_mfma_f32_16x16x32_bf16 v[200:203], a[168:171], a[104:107], v[200:203]
v_mfma_f32_16x16x32_bf16 v[200:203], a[172:175], a[108:111], v[200:203]
v_mfma_f32_16x16x32_bf16 v[88:91], a[164:167], a[108:111], v[88:91]
v_mfma_f32_16x16x32_bf16 v[88:91], a[160:163], a[104:107], v[88:91]
s_waitcnt lgkmcnt(0)
v_mfma_f32_16x16x32_bf16 v[36:39], a[128:131], a[80:83], v[36:39]
s_waitcnt vmcnt(23)
v_mfma_f32_16x16x32_bf16 v[36:39], a[132:135], a[84:87], v[36:39]
s_barrier
v_mfma_f32_16x16x32_bf16 v[44:47], a[140:143], a[84:87], v[44:47]
s_add_u32 s53, s87, 524288
ds_read_b128 a[96:99], v9 offset:4096
v_mfma_f32_16x16x32_bf16 v[44:47], a[136:139], a[80:83], v[44:47]
s_xor_b32 s75, s93, 7
s_lshl_b32 s76, s75, 19
s_add_u32 s76, s76, s74
v_mfma_f32_16x16x32_bf16 v[32:35], a[144:147], a[80:83], v[32:35]
s_lshl_b32 s79, s75, 13
s_add_u32 s79, s79, s78
ds_read_b128 a[100:103], v10 offset:4096
v_mfma_f32_16x16x32_bf16 v[32:35], a[148:151], a[84:87], v[32:35]
s_add_u32 m0, s77, 0
s_add_u32 s64, s76, 0
ds_read_b128 a[104:107], v9 offset:6144
v_mfma_f32_16x16x32_bf16 v[52:55], a[156:159], a[84:87], v[52:55]
buffer_load_dwordx4 v7, s[20:23], s64 offen lds
v_mfma_f32_16x16x32_bf16 v[52:55], a[152:155], a[80:83], v[52:55]
ds_read_b64_tr_b16 a[160:161], v11 offset:16384
ds_read_b64_tr_b16 a[162:163], v11 offset:16896
v_mfma_f32_16x16x32_bf16 v[60:63], a[64:67], a[80:83], v[60:63]
buffer_store_dwordx4 a[20:23], v4, s[24:27], s53 offen offset:1024 sc1
v_mfma_f32_16x16x32_bf16 v[60:63], a[68:71], a[84:87], v[60:63]
ds_read_b128 a[108:111], v10 offset:6144
v_mfma_f32_16x16x32_bf16 v[68:71], a[76:79], a[84:87], v[68:71]
buffer_load_dwordx4 v8, s[20:23], s64 offen offset:1024 lds
v_mfma_f32_16x16x32_bf16 v[68:71], a[72:75], a[80:83], v[68:71]
ds_read_b64_tr_b16 a[164:165], v11 offset:20480
ds_read_b64_tr_b16 a[166:167], v11 offset:20992
v_mfma_f32_16x16x32_bf16 v[76:79], a[72:75], a[88:91], v[76:79]
v_add_u32 v9, -65536, v9
v_add_u32 v10, -65536, v10
v_mfma_f32_16x16x32_bf16 v[76:79], a[76:79], a[92:95], v[76:79]
ds_read_b64_tr_b16 a[168:169], v12 offset:16384
ds_read_b64_tr_b16 a[170:171], v12 offset:16896
v_mfma_f32_16x16x32_bf16 v[84:87], a[68:71], a[92:95], v[84:87]
s_add_u32 m0, s80, 0
s_add_u32 s64, s79, 0
v_mfma_f32_16x16x32_bf16 v[84:87], a[64:67], a[88:91], v[84:87]
ds_read_b64_tr_b16 a[172:173], v12 offset:20480
ds_read_b64_tr_b16 a[174:175], v12 offset:20992
v_mfma_f32_16x16x32_bf16 v[92:95], a[152:155], a[88:91], v[92:95]
buffer_load_dwordx4 v4, s[24:27], s64 offen sc1 lds
v_mfma_f32_16x16x32_bf16 v[92:95], a[156:159], a[92:95], v[92:95]
v_mfma_f32_16x16x32_bf16 v[40:43], a[148:151], a[92:95], v[40:43]
ds_read_b64_tr_b16 a[176:177], v13 offset:16384
ds_read_b64_tr_b16 a[178:179], v13 offset:16896
v_mfma_f32_16x16x32_bf16 v[40:43], a[144:147], a[88:91], v[40:43]
v_mfma_f32_16x16x32_bf16 v[100:103], a[136:139], a[88:91], v[100:103]
s_add_u32 m0, s73, 36864
s_add_u32 s64, s72, 0
v_mfma_f32_16x16x32_bf16 v[100:103], a[140:143], a[92:95], v[100:103]
ds_read_b64_tr_b16 a[180:181], v13 offset:20480
ds_read_b64_tr_b16 a[182:183], v13 offset:20992
v_mfma_f32_16x16x32_bf16 v[108:111], a[132:135], a[92:95], v[108:111]
buffer_load_dwordx4 v5, s[12:15], s64 offen lds
v_mfma_f32_16x16x32_bf16 v[108:111], a[128:131], a[88:91], v[108:111]
s_waitcnt lgkmcnt(14)
ds_read_b64_tr_b16 a[184:185], v14 offset:16384
ds_read_b64_tr_b16 a[186:187], v14 offset:16896
v_mfma_f32_16x16x32_bf16 v[116:119], a[128:131], a[96:99], v[116:119]
ds_read_b64_tr_b16 a[188:189], v14 offset:20480
ds_read_b64_tr_b16 a[190:191], v14 offset:20992
v_mfma_f32_16x16x32_bf16 v[116:119], a[132:135], a[100:103], v[116:119]
v_mfma_f32_16x16x32_bf16 v[124:127], a[140:143], a[100:103], v[124:127]
v_mfma_f32_16x16x32_bf16 v[124:127], a[136:139], a[96:99], v[124:127]
ds_read_b128 a[112:115], v4 offset:24576
v_mfma_f32_16x16x32_bf16 v[132:135], a[144:147], a[96:99], v[132:135]
buffer_load_dwordx4 v6, s[12:15], s64 offen offset:1024 lds
v_mfma_f32_16x16x32_bf16 v[132:135], a[148:151], a[100:103], v[132:135]
s_add_u32 s53, s87, 528384
ds_read_b128 a[116:119], v4 offset:26624
v_mfma_f32_16x16x32_bf16 v[140:143], a[156:159], a[100:103], v[140:143]
buffer_store_dwordx4 a[12:15], v4, s[24:27], s53 offen offset:0 sc1
v_mfma_f32_16x16x32_bf16 v[140:143], a[152:155], a[96:99], v[140:143]
ds_read_b128 a[120:123], v4 offset:25600
v_mfma_f32_16x16x32_bf16 v[148:151], a[64:67], a[96:99], v[148:151]
s_add_u32 m0, s73, 38912
s_add_u32 s64, s72, 18432
v_mfma_f32_16x16x32_bf16 v[148:151], a[68:71], a[100:103], v[148:151]
ds_read_b128 a[124:127], v4 offset:27648
v_mfma_f32_16x16x32_bf16 v[48:51], a[76:79], a[100:103], v[48:51]
buffer_load_dwordx4 v5, s[12:15], s64 offen lds
v_mfma_f32_16x16x32_bf16 v[48:51], a[72:75], a[96:99], v[48:51]
s_waitcnt lgkmcnt(15)
v_mfma_f32_16x16x32_bf16 v[156:159], a[72:75], a[104:107], v[156:159]
v_mfma_f32_16x16x32_bf16 v[156:159], a[76:79], a[108:111], v[156:159]
v_mfma_f32_16x16x32_bf16 v[164:167], a[68:71], a[108:111], v[164:167]
v_mfma_f32_16x16x32_bf16 v[164:167], a[64:67], a[104:107], v[164:167]
v_mfma_f32_16x16x32_bf16 v[172:175], a[152:155], a[104:107], v[172:175]
buffer_load_dwordx4 v6, s[12:15], s64 offen offset:1024 lds
v_mfma_f32_16x16x32_bf16 v[172:175], a[156:159], a[108:111], v[172:175]
v_mfma_f32_16x16x32_bf16 v[56:59], a[148:151], a[108:111], v[56:59]
v_mfma_f32_16x16x32_bf16 v[56:59], a[144:147], a[104:107], v[56:59]
v_mfma_f32_16x16x32_bf16 v[180:183], a[136:139], a[104:107], v[180:183]
v_mfma_f32_16x16x32_bf16 v[180:183], a[140:143], a[108:111], v[180:183]
v_mfma_f32_16x16x32_bf16 v[188:191], a[132:135], a[108:111], v[188:191]
v_mfma_f32_16x16x32_bf16 v[188:191], a[128:131], a[104:107], v[188:191]
s_waitcnt lgkmcnt(0)
v_mfma_f32_16x16x32_bf16 v[196:199], a[160:163], a[80:83], v[196:199]
s_waitcnt vmcnt(19)
v_mfma_f32_16x16x32_bf16 v[196:199], a[164:167], a[84:87], v[196:199]
s_barrier
v_mfma_f32_16x16x32_bf16 v[64:67], a[172:175], a[84:87], v[64:67]
ds_read_b64_tr_b16 a[128:129], v11 offset:32768
ds_read_b64_tr_b16 a[130:131], v11 offset:33280
v_mfma_f32_16x16x32_bf16 v[64:67], a[168:171], a[80:83], v[64:67]
s_add_u32 m0, s77, 16384
s_add_u32 s64, s76, 128
v_mfma_f32_16x16x32_bf16 v[204:207], a[176:179], a[80:83], v[204:207]
buffer_load_dwordx4 v7, s[20:23], s64 offen lds
v_mfma_f32_16x16x32_bf16 v[204:207], a[180:183], a[84:87], v[204:207]
ds_read_b64_tr_b16 a[132:133], v11 offset:36864
ds_read_b64_tr_b16 a[134:135], v11 offset:37376
v_mfma_f32_16x16x32_bf16 v[212:215], a[188:191], a[84:87], v[212:215]
ds_read_b64_tr_b16 a[136:137], v12 offset:32768
ds_read_b64_tr_b16 a[138:139], v12 offset:33280
v_mfma_f32_16x16x32_bf16 v[212:215], a[184:187], a[80:83], v[212:215]
s_add_u32 s53, s87, 528384
ds_read_b64_tr_b16 a[140:141], v12 offset:36864
ds_read_b64_tr_b16 a[142:143], v12 offset:37376
v_mfma_f32_16x16x32_bf16 v[72:75], a[112:115], a[80:83], v[72:75]
buffer_load_dwordx4 v8, s[20:23], s64 offen offset:1024 lds
v_mfma_f32_16x16x32_bf16 v[72:75], a[116:119], a[84:87], v[72:75]
ds_read_b64_tr_b16 a[144:145], v13 offset:32768
ds_read_b64_tr_b16 a[146:147], v13 offset:33280
v_mfma_f32_16x16x32_bf16 v[220:223], a[124:127], a[84:87], v[220:223]
buffer_store_dwordx4 a[4:7], v4, s[24:27], s53 offen offset:1024 sc1
v_mfma_f32_16x16x32_bf16 v[220:223], a[120:123], a[80:83], v[220:223]
s_add_u32 m0, s80, 16384
s_add_u32 s64, s79, 2048
v_mfma_f32_16x16x32_bf16 v[252:255], a[120:123], a[88:91], v[252:255]
ds_read_b64_tr_b16 a[148:149], v13 offset:36864
ds_read_b64_tr_b16 a[150:151], v13 offset:37376
v_mfma_f32_16x16x32_bf16 v[252:255], a[124:127], a[92:95], v[252:255]
buffer_load_dwordx4 v4, s[24:27], s64 offen sc1 lds
v_mfma_f32_16x16x32_bf16 v[160:163], a[116:119], a[92:95], v[160:163]
ds_read_b64_tr_b16 a[152:153], v14 offset:32768
ds_read_b64_tr_b16 a[154:155], v14 offset:33280
v_mfma_f32_16x16x32_bf16 v[160:163], a[112:115], a[88:91], v[160:163]
ds_read_b64_tr_b16 a[156:157], v14 offset:36864
ds_read_b64_tr_b16 a[158:159], v14 offset:37376
v_mfma_f32_16x16x32_bf16 v[228:231], a[184:187], a[88:91], v[228:231]
s_add_u32 m0, s83, 0
s_add_u32 s64, s81, 0
v_mfma_f32_16x16x32_bf16 v[228:231], a[188:191], a[92:95], v[228:231]
v_mfma_f32_16x16x32_bf16 v[168:171], a[180:183], a[92:95], v[168:171]
buffer_load_dwordx4 v22, s[32:35], s64 offen lds
v_mfma_f32_16x16x32_bf16 v[168:171], a[176:179], a[88:91], v[168:171]
ds_read_b128 a[64:67], v4 offset:40960
v_mfma_f32_16x16x32_bf16 v[176:179], a[168:171], a[88:91], v[176:179]
s_add_u32 m0, s83, 1024
s_add_u32 s64, s81, 9216
ds_read_b128 a[80:83], v9 offset:0
v_mfma_f32_16x16x32_bf16 v[176:179], a[172:175], a[92:95], v[176:179]
v_mfma_f32_16x16x32_bf16 v[80:83], a[164:167], a[92:95], v[80:83]
buffer_load_dwordx4 v22, s[32:35], s64 offen lds
v_mfma_f32_16x16x32_bf16 v[80:83], a[160:163], a[88:91], v[80:83]
ds_read_b128 a[68:71], v4 offset:43008
v_mfma_f32_16x16x32_bf16 v[184:187], a[160:163], a[96:99], v[184:187]
ds_read_b128 a[84:87], v10 offset:0
v_mfma_f32_16x16x32_bf16 v[184:187], a[164:167], a[100:103], v[184:187]
s_add_u32 m0, s83, 2048
s_add_u32 s64, s81, 18432
v_mfma_f32_16x16x32_bf16 v[248:251], a[172:175], a[100:103], v[248:251]
v_mfma_f32_16x16x32_bf16 v[248:251], a[168:171], a[96:99], v[248:251]
buffer_load_dwordx4 v22, s[32:35], s64 offen lds
v_mfma_f32_16x16x32_bf16 v[240:243], a[176:179], a[96:99], v[240:243]
ds_read_b128 a[72:75], v4 offset:41984
v_mfma_f32_16x16x32_bf16 v[240:243], a[180:183], a[100:103], v[240:243]
ds_read_b128 a[88:91], v9 offset:2048
v_mfma_f32_16x16x32_bf16 v[232:235], a[188:191], a[100:103], v[232:235]
s_add_u32 m0, s83, 3072
s_add_u32 s64, s81, 27648
v_mfma_f32_16x16x32_bf16 v[232:235], a[184:187], a[96:99], v[232:235]
ds_read_b128 a[76:79], v4 offset:44032
v_mfma_f32_16x16x32_bf16 v[236:239], a[112:115], a[96:99], v[236:239]
buffer_load_dwordx4 v22, s[32:35], s64 offen lds
v_mfma_f32_16x16x32_bf16 v[236:239], a[116:119], a[100:103], v[236:239]
ds_read_b128 a[92:95], v10 offset:2048
v_mfma_f32_16x16x32_bf16 v[224:227], a[124:127], a[100:103], v[224:227]
s_add_u32 m0, s83, 4096
s_add_u32 s64, s81, 128
s_add_u32 s53, s87, 786432
v_mfma_f32_16x16x32_bf16 v[224:227], a[120:123], a[96:99], v[224:227]
buffer_store_dwordx4 a[0:3], v4, s[24:27], s53 offen offset:0 sc1
v_mfma_f32_16x16x32_bf16 v[208:211], a[120:123], a[104:107], v[208:211]
buffer_load_dwordx4 v24, s[32:35], s64 offen lds
v_mfma_f32_16x16x32_bf16 v[208:211], a[124:127], a[108:111], v[208:211]
s_waitcnt vmcnt(26)
v_mfma_f32_16x16x32_bf16 v[216:219], a[116:119], a[108:111], v[216:219]
L_PAD7:
s_cbranch_execz L_PAD11
v_cmp_gt_u32 vcc, 8, v30
v_mfma_f32_16x16x32_bf16 v[216:219], a[112:115], a[104:107], v[216:219]
s_add_u32 m0, s83, 5120
s_add_u32 s64, s82, 0
v_mfma_f32_16x16x32_bf16 v[244:247], a[184:187], a[104:107], v[244:247]
v_mfma_f32_16x16x32_bf16 v[244:247], a[188:191], a[108:111], v[244:247]
buffer_load_dwordx4 v25, s[48:51], s64 offen lds
v_mfma_f32_16x16x32_bf16 v[192:195], a[180:183], a[108:111], v[192:195]
v_mfma_f32_16x16x32_bf16 v[192:195], a[176:179], a[104:107], v[192:195]
s_cbranch_vccnz CK_KV
CK_KV_R:
v_mfma_f32_16x16x32_bf16 v[200:203], a[168:171], a[104:107], v[200:203]
v_mfma_f32_16x16x32_bf16 v[200:203], a[172:175], a[108:111], v[200:203]
v_mfma_f32_16x16x32_bf16 v[88:91], a[164:167], a[108:111], v[88:91]
v_mfma_f32_16x16x32_bf16 v[88:91], a[160:163], a[104:107], v[88:91]
s_waitcnt lgkmcnt(0)
v_mfma_f32_16x16x32_bf16 v[36:39], a[128:131], a[80:83], v[36:39]
s_waitcnt vmcnt(25)
v_mov_b32 v6, 0xf149f2ca
v_mfma_f32_16x16x32_bf16 v[36:39], a[132:135], a[84:87], v[36:39]
s_barrier
v_mfma_f32_16x16x32_bf16 v[44:47], a[140:143], a[84:87], v[44:47]
ds_read_b128 a[96:99], v9 offset:4096
v_mfma_f32_16x16x32_bf16 v[44:47], a[136:139], a[80:83], v[44:47]
s_lshl_b32 s70, s3, 12
s_add_u32 s68, s70, s94
ds_read_b128 a[100:103], v10 offset:4096
v_mfma_f32_16x16x32_bf16 v[32:35], a[144:147], a[80:83], v[32:35]
s_add_u32 m0, s70, 32768
s_cmp_lt_u32 s3, 2
s_cselect_b32 s64, s68, 2147418112
v_mfma_f32_16x16x32_bf16 v[32:35], a[148:151], a[84:87], v[32:35]
buffer_load_dwordx4 v4, s[24:27], s64 offen offset:0 sc1 lds
v_mfma_f32_16x16x32_bf16 v[52:55], a[156:159], a[84:87], v[52:55]
ds_read_b128 a[104:107], v9 offset:6144
v_mfma_f32_16x16x32_bf16 v[52:55], a[152:155], a[80:83], v[52:55]
ds_read_b64_tr_b16 a[160:161], v11 offset:49152
ds_read_b64_tr_b16 a[162:163], v11 offset:49664
v_mfma_f32_16x16x32_bf16 v[60:63], a[64:67], a[80:83], v[60:63]
s_cmp_eq_u32 s66, 0
s_cbranch_scc1 D0
D0_R:
v_mfma_f32_16x16x32_bf16 v[60:63], a[68:71], a[84:87], v[60:63]
s_lshl_b32 s52, s4, 18
s_add_u32 s52, s52, 45088768
ds_read_b128 a[108:111], v10 offset:6144
v_mfma_f32_16x16x32_bf16 v[68:71], a[76:79], a[84:87], v[68:71]
s_lshl_b32 s54, s66, 9
v_add_u32 v9, 32768, v9
v_add_u32 v10, 32768, v10
v_mfma_f32_16x16x32_bf16 v[68:71], a[72:75], a[80:83], v[68:71]
s_add_u32 s54, s54, s52
ds_read_b64_tr_b16 a[164:165], v11 offset:53248
ds_read_b64_tr_b16 a[166:167], v11 offset:53760
v_mfma_f32_16x16x32_bf16 v[76:79], a[72:75], a[88:91], v[76:79]
s_lshl_b32 s55, s67, 9
s_add_u32 s55, s55, s52
v_mfma_f32_16x16x32_bf16 v[76:79], a[76:79], a[92:95], v[76:79]
s_add_u32 s53, s87, 786432
ds_read_b64_tr_b16 a[168:169], v12 offset:49152
ds_read_b64_tr_b16 a[170:171], v12 offset:49664
v_mfma_f32_16x16x32_bf16 v[84:87], a[68:71], a[92:95], v[84:87]
buffer_load_dwordx4 v4, s[24:27], s64 offen offset:1024 sc1 lds
v_mfma_f32_16x16x32_bf16 v[84:87], a[64:67], a[88:91], v[84:87]
ds_read_b64_tr_b16 a[172:173], v12 offset:53248
ds_read_b64_tr_b16 a[174:175], v12 offset:53760
v_mfma_f32_16x16x32_bf16 v[92:95], a[152:155], a[88:91], v[92:95]
buffer_store_dwordx4 a[8:11], v4, s[24:27], s53 offen offset:1024 sc1
v_mfma_f32_16x16x32_bf16 v[92:95], a[156:159], a[92:95], v[92:95]
v_mfma_f32_16x16x32_bf16 v[40:43], a[148:151], a[92:95], v[40:43]
ds_read_b64_tr_b16 a[176:177], v13 offset:49152
ds_read_b64_tr_b16 a[178:179], v13 offset:49664
v_mfma_f32_16x16x32_bf16 v[40:43], a[144:147], a[88:91], v[40:43]
v_mfma_f32_16x16x32_bf16 v[100:103], a[136:139], a[88:91], v[100:103]
ds_read_b64_tr_b16 a[180:181], v13 offset:53248
ds_read_b64_tr_b16 a[182:183], v13 offset:53760
v_mfma_f32_16x16x32_bf16 v[100:103], a[140:143], a[92:95], v[100:103]
v_mfma_f32_16x16x32_bf16 v[108:111], a[132:135], a[92:95], v[108:111]
ds_read_b64_tr_b16 a[184:185], v14 offset:49152
ds_read_b64_tr_b16 a[186:187], v14 offset:49664
v_mfma_f32_16x16x32_bf16 v[108:111], a[128:131], a[88:91], v[108:111]
s_waitcnt lgkmcnt(15)
v_mfma_f32_16x16x32_bf16 v[116:119], a[128:131], a[96:99], v[116:119]
ds_read_b64_tr_b16 a[188:189], v14 offset:53248
ds_read_b64_tr_b16 a[190:191], v14 offset:53760
v_mfma_f32_16x16x32_bf16 v[116:119], a[132:135], a[100:103], v[116:119]
buffer_load_dwordx4 v4, s[24:27], s64 offen offset:2048 sc1 lds
v_mfma_f32_16x16x32_bf16 v[124:127], a[140:143], a[100:103], v[124:127]
v_mfma_f32_16x16x32_bf16 v[124:127], a[136:139], a[96:99], v[124:127]
ds_read_b128 a[112:115], v4 offset:57344
v_mfma_f32_16x16x32_bf16 v[132:135], a[144:147], a[96:99], v[132:135]
v_mfma_f32_16x16x32_bf16 v[132:135], a[148:151], a[100:103], v[132:135]
ds_read_b128 a[116:119], v4 offset:59392
v_mfma_f32_16x16x32_bf16 v[140:143], a[156:159], a[100:103], v[140:143]
v_mfma_f32_16x16x32_bf16 v[140:143], a[152:155], a[96:99], v[140:143]
ds_read_b128 a[120:123], v4 offset:58368
v_mfma_f32_16x16x32_bf16 v[148:151], a[64:67], a[96:99], v[148:151]
v_mfma_f32_16x16x32_bf16 v[148:151], a[68:71], a[100:103], v[148:151]
ds_read_b128 a[124:127], v4 offset:60416
v_mfma_f32_16x16x32_bf16 v[48:51], a[76:79], a[100:103], v[48:51]
s_waitcnt lgkmcnt(15)
v_mfma_f32_16x16x32_bf16 v[48:51], a[72:75], a[96:99], v[48:51]
buffer_load_dwordx4 v4, s[24:27], s64 offen offset:3072 sc1 lds
v_mfma_f32_16x16x32_bf16 v[156:159], a[72:75], a[104:107], v[156:159]
v_mfma_f32_16x16x32_bf16 v[156:159], a[76:79], a[108:111], v[156:159]
v_mfma_f32_16x16x32_bf16 v[164:167], a[68:71], a[108:111], v[164:167]
v_mfma_f32_16x16x32_bf16 v[164:167], a[64:67], a[104:107], v[164:167]
v_mfma_f32_16x16x32_bf16 v[172:175], a[152:155], a[104:107], v[172:175]
s_add_u32 s53, s87, 790528
v_mfma_f32_16x16x32_bf16 v[172:175], a[156:159], a[108:111], v[172:175]
buffer_store_dwordx4 a[16:19], v4, s[24:27], s53 offen offset:0 sc1
v_mfma_f32_16x16x32_bf16 v[56:59], a[148:151], a[108:111], v[56:59]
v_mfma_f32_16x16x32_bf16 v[56:59], a[144:147], a[104:107], v[56:59]
v_mfma_f32_16x16x32_bf16 v[180:183], a[136:139], a[104:107], v[180:183]
v_mfma_f32_16x16x32_bf16 v[180:183], a[140:143], a[108:111], v[180:183]
v_mfma_f32_16x16x32_bf16 v[188:191], a[132:135], a[108:111], v[188:191]
v_mfma_f32_16x16x32_bf16 v[188:191], a[128:131], a[104:107], v[188:191]
s_waitcnt lgkmcnt(0)
v_mfma_f32_16x16x32_bf16 v[196:199], a[160:163], a[80:83], v[196:199]
s_waitcnt vmcnt(17)
v_mfma_f32_16x16x32_bf16 v[196:199], a[164:167], a[84:87], v[196:199]
s_barrier
v_mfma_f32_16x16x32_bf16 v[64:67], a[172:175], a[84:87], v[64:67]
ds_read_b64_tr_b16 a[128:129], v11 offset:0
ds_read_b64_tr_b16 a[130:131], v11 offset:512
v_mfma_f32_16x16x32_bf16 v[64:67], a[168:171], a[80:83], v[64:67]
s_add_u32 m0, s70, 49152
s_add_u32 s64, s68, 16384
s_waitcnt vmcnt(6)
v_mfma_f32_16x16x32_bf16 v[204:207], a[176:179], a[80:83], v[204:207]
buffer_load_dwordx4 v4, s[24:27], s64 offen offset:0 sc1 lds
v_mfma_f32_16x16x32_bf16 v[204:207], a[180:183], a[84:87], v[204:207]
ds_read_b64_tr_b16 a[132:133], v11 offset:4096
ds_read_b64_tr_b16 a[134:135], v11 offset:4608
v_mfma_f32_16x16x32_bf16 v[212:215], a[188:191], a[84:87], v[212:215]
ds_read_b64_tr_b16 a[136:137], v12 offset:0
ds_read_b64_tr_b16 a[138:139], v12 offset:512
v_mfma_f32_16x16x32_bf16 v[212:215], a[184:187], a[80:83], v[212:215]
ds_read_b64_tr_b16 a[140:141], v12 offset:4096
ds_read_b64_tr_b16 a[142:143], v12 offset:4608
v_mfma_f32_16x16x32_bf16 v[72:75], a[112:115], a[80:83], v[72:75]
ds_read_b64_tr_b16 a[192:193], v23 offset:0
ds_read_b64_tr_b16 a[194:195], v23 offset:2048
v_mfma_f32_16x16x32_bf16 v[72:75], a[116:119], a[84:87], v[72:75]
ds_read_b64_tr_b16 a[144:145], v13 offset:0
ds_read_b64_tr_b16 a[146:147], v13 offset:512
v_mfma_f32_16x16x32_bf16 v[220:223], a[124:127], a[84:87], v[220:223]
ds_read_b64_tr_b16 a[196:197], v23 offset:32
ds_read_b64_tr_b16 a[198:199], v23 offset:2080
v_mfma_f32_16x16x32_bf16 v[220:223], a[120:123], a[80:83], v[220:223]
ds_read_b64_tr_b16 a[148:149], v13 offset:4096
ds_read_b64_tr_b16 a[150:151], v13 offset:4608
v_mfma_f32_16x16x32_bf16 v[252:255], a[120:123], a[88:91], v[252:255]
ds_read_b64_tr_b16 a[200:201], v23 offset:64
ds_read_b64_tr_b16 a[202:203], v23 offset:2112
v_mfma_f32_16x16x32_bf16 v[252:255], a[124:127], a[92:95], v[252:255]
ds_read_b64_tr_b16 a[152:153], v14 offset:0
ds_read_b64_tr_b16 a[154:155], v14 offset:512
v_mfma_f32_16x16x32_bf16 v[160:163], a[116:119], a[92:95], v[160:163]
buffer_load_dwordx4 v4, s[24:27], s64 offen offset:1024 sc1 lds
v_mfma_f32_16x16x32_bf16 v[160:163], a[112:115], a[88:91], v[160:163]
ds_read_b64_tr_b16 a[156:157], v14 offset:4096
ds_read_b64_tr_b16 a[158:159], v14 offset:4608
v_mfma_f32_16x16x32_bf16 v[228:231], a[184:187], a[88:91], v[228:231]
ds_read_b64_tr_b16 a[204:205], v23 offset:96
ds_read_b64_tr_b16 a[206:207], v23 offset:2144
v_mfma_f32_16x16x32_bf16 v[228:231], a[188:191], a[92:95], v[228:231]
ds_read_b64_tr_b16 a[208:209], v27 offset:4096
ds_read_b64_tr_b16 a[210:211], v27 offset:4608
v_mfma_f32_16x16x32_bf16 v[168:171], a[180:183], a[92:95], v[168:171]
ds_read_b128 a[64:67], v4 offset:8192
v_mfma_f32_16x16x32_bf16 v[168:171], a[176:179], a[88:91], v[168:171]
s_add_u32 s53, s87, 790528
ds_read_b64_tr_b16 a[212:213], v27 offset:5120
ds_read_b64_tr_b16 a[214:215], v27 offset:5632
v_mfma_f32_16x16x32_bf16 v[176:179], a[168:171], a[88:91], v[176:179]
ds_read_b128 a[80:83], v9 offset:0
v_readlane_b32 s81, v26, 0
v_mfma_f32_16x16x32_bf16 v[176:179], a[172:175], a[92:95], v[176:179]
buffer_store_dwordx4 a[24:27], v4, s[24:27], s53 offen offset:1024 sc1
v_mfma_f32_16x16x32_bf16 v[80:83], a[164:167], a[92:95], v[80:83]
ds_read_b128 a[68:71], v4 offset:10240
v_readlane_b32 s82, v26, 1
v_mfma_f32_16x16x32_bf16 v[80:83], a[160:163], a[88:91], v[80:83]
v_readlane_b32 s71, v26, 2
v_readlane_b32 s72, v26, 3
v_mfma_f32_16x16x32_bf16 v[184:187], a[160:163], a[96:99], v[184:187]
ds_read_b128 a[84:87], v10 offset:0
v_readlane_b32 s74, v26, 4
v_mfma_f32_16x16x32_bf16 v[184:187], a[164:167], a[100:103], v[184:187]
buffer_load_dwordx4 v4, s[24:27], s64 offen offset:2048 sc1 lds
v_mfma_f32_16x16x32_bf16 v[248:251], a[172:175], a[100:103], v[248:251]
v_readlane_b32 s75, v26, 5
v_mfma_f32_16x16x32_bf16 v[248:251], a[168:171], a[96:99], v[248:251]
ds_read_b128 a[72:75], v4 offset:9216
v_mfma_f32_16x16x32_bf16 v[240:243], a[176:179], a[96:99], v[240:243]
v_mfma_f32_16x16x32_bf16 v[240:243], a[180:183], a[100:103], v[240:243]
ds_read_b128 a[88:91], v9 offset:2048
v_mfma_f32_16x16x32_bf16 v[232:235], a[188:191], a[100:103], v[232:235]
v_mfma_f32_16x16x32_bf16 v[232:235], a[184:187], a[96:99], v[232:235]
ds_read_b128 a[76:79], v4 offset:11264
v_mfma_f32_16x16x32_bf16 v[236:239], a[112:115], a[96:99], v[236:239]
v_mfma_f32_16x16x32_bf16 v[236:239], a[116:119], a[100:103], v[236:239]
ds_read_b128 a[92:95], v10 offset:2048
v_mfma_f32_16x16x32_bf16 v[224:227], a[124:127], a[100:103], v[224:227]
v_mfma_f32_16x16x32_bf16 v[224:227], a[120:123], a[96:99], v[224:227]
buffer_load_dwordx4 v4, s[24:27], s64 offen offset:3072 sc1 lds
v_mfma_f32_16x16x32_bf16 v[208:211], a[120:123], a[104:107], v[208:211]
v_mfma_f32_16x16x32_bf16 v[208:211], a[124:127], a[108:111], v[208:211]
v_mfma_f32_16x16x32_bf16 v[216:219], a[116:119], a[108:111], v[216:219]
v_mfma_f32_16x16x32_bf16 v[216:219], a[112:115], a[104:107], v[216:219]
v_mfma_f32_16x16x32_bf16 v[244:247], a[184:187], a[104:107], v[244:247]
v_mfma_f32_16x16x32_bf16 v[244:247], a[188:191], a[108:111], v[244:247]
v_mfma_f32_16x16x32_bf16 v[192:195], a[180:183], a[108:111], v[192:195]
v_mfma_f32_16x16x32_bf16 v[192:195], a[176:179], a[104:107], v[192:195]
v_mfma_f32_16x16x32_bf16 v[200:203], a[168:171], a[104:107], v[200:203]
v_mfma_f32_16x16x32_bf16 v[200:203], a[172:175], a[108:111], v[200:203]
v_mfma_f32_16x16x32_bf16 v[88:91], a[164:167], a[108:111], v[88:91]
v_mfma_f32_16x16x32_bf16 v[88:91], a[160:163], a[104:107], v[88:91]
s_waitcnt lgkmcnt(0)
v_mfma_f32_16x16x32_bf16 v[36:39], a[128:131], a[80:83], v[36:39]
s_waitcnt vmcnt(18)
v_mfma_f32_16x16x32_bf16 v[36:39], a[132:135], a[84:87], v[36:39]
s_barrier
v_mfma_f32_16x16x32_bf16 v[44:47], a[140:143], a[84:87], v[44:47]
ds_read_b128 a[96:99], v9 offset:4096
v_mfma_f32_16x16x32_bf16 v[44:47], a[136:139], a[80:83], v[44:47]
s_add_u32 m0, s70, 65536
s_add_u32 s64, s68, 32768
ds_read_b128 a[100:103], v10 offset:4096
v_mfma_f32_16x16x32_bf16 v[32:35], a[144:147], a[80:83], v[32:35]
buffer_load_dwordx4 v4, s[24:27], s64 offen offset:0 sc1 lds
v_mfma_f32_16x16x32_bf16 v[32:35], a[148:151], a[84:87], v[32:35]
ds_read_b128 a[104:107], v9 offset:6144
v_mfma_f32_16x16x32_bf16 v[52:55], a[156:159], a[84:87], v[52:55]
ds_read_b64_tr_b16 a[160:161], v11 offset:16384
ds_read_b64_tr_b16 a[162:163], v11 offset:16896
v_mfma_f32_16x16x32_bf16 v[52:55], a[152:155], a[80:83], v[52:55]
buffer_store_dwordx4 a[192:195], v4, s[24:27], s81 offen sc1
v_mfma_f32_16x16x32_bf16 v[60:63], a[64:67], a[80:83], v[60:63]
v_mfma_f32_16x16x32_bf16 v[60:63], a[68:71], a[84:87], v[60:63]
ds_read_b128 a[108:111], v10 offset:6144
v_mfma_f32_16x16x32_bf16 v[68:71], a[76:79], a[84:87], v[68:71]
v_cvt_pk_bf16_f32 v36, v36, v37
v_cvt_pk_bf16_f32 v37, v38, v39
v_mfma_f32_16x16x32_bf16 v[68:71], a[72:75], a[80:83], v[68:71]
ds_read_b64_tr_b16 a[164:165], v11 offset:20480
ds_read_b64_tr_b16 a[166:167], v11 offset:20992
v_mfma_f32_16x16x32_bf16 v[76:79], a[72:75], a[88:91], v[76:79]
buffer_store_dwordx4 a[196:199], v4, s[24:27], s82 offen sc1
v_mfma_f32_16x16x32_bf16 v[76:79], a[76:79], a[92:95], v[76:79]
ds_read_b64_tr_b16 a[168:169], v12 offset:16384
ds_read_b64_tr_b16 a[170:171], v12 offset:16896
v_mfma_f32_16x16x32_bf16 v[84:87], a[68:71], a[92:95], v[84:87]
buffer_load_dwordx4 v4, s[24:27], s64 offen offset:1024 sc1 lds
v_mfma_f32_16x16x32_bf16 v[84:87], a[64:67], a[88:91], v[84:87]
ds_read_b64_tr_b16 a[172:173], v12 offset:20480
ds_read_b64_tr_b16 a[174:175], v12 offset:20992
v_mfma_f32_16x16x32_bf16 v[92:95], a[152:155], a[88:91], v[92:95]
v_cvt_pk_bf16_f32 v38, v44, v45
v_cvt_pk_bf16_f32 v39, v46, v47
v_mfma_f32_16x16x32_bf16 v[92:95], a[156:159], a[92:95], v[92:95]
buffer_store_dwordx4 a[200:203], v4, s[24:27], s71 offen sc1
v_mfma_f32_16x16x32_bf16 v[40:43], a[148:151], a[92:95], v[40:43]
ds_read_b64_tr_b16 a[176:177], v13 offset:16384
ds_read_b64_tr_b16 a[178:179], v13 offset:16896
v_mfma_f32_16x16x32_bf16 v[40:43], a[144:147], a[88:91], v[40:43]
v_accvgpr_write_b32 a32, v36
v_accvgpr_write_b32 a33, v37
v_mfma_f32_16x16x32_bf16 v[100:103], a[136:139], a[88:91], v[100:103]
ds_read_b64_tr_b16 a[180:181], v13 offset:20480
ds_read_b64_tr_b16 a[182:183], v13 offset:20992
v_mfma_f32_16x16x32_bf16 v[100:103], a[140:143], a[92:95], v[100:103]
v_accvgpr_write_b32 a34, v38
v_accvgpr_write_b32 a35, v39
v_mfma_f32_16x16x32_bf16 v[108:111], a[132:135], a[92:95], v[108:111]
ds_read_b64_tr_b16 a[184:185], v14 offset:16384
ds_read_b64_tr_b16 a[186:187], v14 offset:16896
v_mfma_f32_16x16x32_bf16 v[108:111], a[128:131], a[88:91], v[108:111]
s_waitcnt lgkmcnt(15)
v_cvt_pk_bf16_f32 v32, v32, v33
v_cvt_pk_bf16_f32 v33, v34, v35
v_mfma_f32_16x16x32_bf16 v[116:119], a[128:131], a[96:99], v[116:119]
ds_read_b64_tr_b16 a[188:189], v14 offset:20480
ds_read_b64_tr_b16 a[190:191], v14 offset:20992
v_mfma_f32_16x16x32_bf16 v[116:119], a[132:135], a[100:103], v[116:119]
buffer_load_dwordx4 v4, s[24:27], s64 offen offset:2048 sc1 lds
v_mfma_f32_16x16x32_bf16 v[124:127], a[140:143], a[100:103], v[124:127]
buffer_store_dwordx4 a[204:207], v4, s[24:27], s72 offen sc1
v_mfma_f32_16x16x32_bf16 v[124:127], a[136:139], a[96:99], v[124:127]
ds_read_b128 a[112:115], v4 offset:24576
v_cvt_pk_bf16_f32 v34, v52, v53
v_mfma_f32_16x16x32_bf16 v[132:135], a[144:147], a[96:99], v[132:135]
v_cvt_pk_bf16_f32 v35, v54, v55
v_accvgpr_write_b32 a36, v32
v_mfma_f32_16x16x32_bf16 v[132:135], a[148:151], a[100:103], v[132:135]
ds_read_b128 a[116:119], v4 offset:26624
v_accvgpr_write_b32 a37, v33
v_mfma_f32_16x16x32_bf16 v[140:143], a[156:159], a[100:103], v[140:143]
v_accvgpr_write_b32 a38, v34
v_accvgpr_write_b32 a39, v35
v_mfma_f32_16x16x32_bf16 v[140:143], a[152:155], a[96:99], v[140:143]
ds_read_b128 a[120:123], v4 offset:25600
v_cvt_pk_bf16_f32 v40, v40, v41
v_mfma_f32_16x16x32_bf16 v[148:151], a[64:67], a[96:99], v[148:151]
buffer_store_dwordx4 a[208:211], v4, s[24:27], s74 offen sc1
v_mfma_f32_16x16x32_bf16 v[148:151], a[68:71], a[100:103], v[148:151]
ds_read_b128 a[124:127], v4 offset:27648
v_cvt_pk_bf16_f32 v41, v42, v43
v_mfma_f32_16x16x32_bf16 v[48:51], a[76:79], a[100:103], v[48:51]
s_waitcnt lgkmcnt(15)
v_cvt_pk_bf16_f32 v42, v92, v93
v_cvt_pk_bf16_f32 v43, v94, v95
v_mfma_f32_16x16x32_bf16 v[48:51], a[72:75], a[96:99], v[48:51]
buffer_load_dwordx4 v4, s[24:27], s64 offen offset:3072 sc1 lds
v_mfma_f32_16x16x32_bf16 v[156:159], a[72:75], a[104:107], v[156:159]
v_accvgpr_write_b32 a40, v40
v_accvgpr_write_b32 a41, v41
v_mfma_f32_16x16x32_bf16 v[156:159], a[76:79], a[108:111], v[156:159]
buffer_store_dwordx4 a[212:215], v4, s[24:27], s75 offen sc1
v_mfma_f32_16x16x32_bf16 v[164:167], a[68:71], a[108:111], v[164:167]
v_accvgpr_write_b32 a42, v42
v_accvgpr_write_b32 a43, v43
v_mfma_f32_16x16x32_bf16 v[164:167], a[64:67], a[104:107], v[164:167]
v_cvt_pk_bf16_f32 v108, v108, v109
v_cvt_pk_bf16_f32 v109, v110, v111
v_mfma_f32_16x16x32_bf16 v[172:175], a[152:155], a[104:107], v[172:175]
v_cvt_pk_bf16_f32 v110, v100, v101
v_cvt_pk_bf16_f32 v111, v102, v103
v_mfma_f32_16x16x32_bf16 v[172:175], a[156:159], a[108:111], v[172:175]
v_accvgpr_write_b32 a44, v108
v_accvgpr_write_b32 a45, v109
v_mfma_f32_16x16x32_bf16 v[56:59], a[148:151], a[108:111], v[56:59]
v_accvgpr_write_b32 a46, v110
v_accvgpr_write_b32 a47, v111
v_mfma_f32_16x16x32_bf16 v[56:59], a[144:147], a[104:107], v[56:59]
v_cvt_pk_bf16_f32 v116, v116, v117
v_cvt_pk_bf16_f32 v117, v118, v119
v_mfma_f32_16x16x32_bf16 v[180:183], a[136:139], a[104:107], v[180:183]
v_cvt_pk_bf16_f32 v118, v124, v125
v_cvt_pk_bf16_f32 v119, v126, v127
v_mfma_f32_16x16x32_bf16 v[180:183], a[140:143], a[108:111], v[180:183]
v_accvgpr_write_b32 a48, v116
v_accvgpr_write_b32 a49, v117
v_mfma_f32_16x16x32_bf16 v[188:191], a[132:135], a[108:111], v[188:191]
v_accvgpr_write_b32 a50, v118
v_accvgpr_write_b32 a51, v119
v_mfma_f32_16x16x32_bf16 v[188:191], a[128:131], a[104:107], v[188:191]
s_waitcnt lgkmcnt(0)
v_cvt_pk_bf16_f32 v132, v132, v133
v_cvt_pk_bf16_f32 v133, v134, v135
v_mfma_f32_16x16x32_bf16 v[196:199], a[160:163], a[80:83], v[196:199]
s_waitcnt vmcnt(16)
v_cvt_pk_bf16_f32 v134, v140, v141
v_cvt_pk_bf16_f32 v135, v142, v143
v_mfma_f32_16x16x32_bf16 v[196:199], a[164:167], a[84:87], v[196:199]
s_barrier
v_mfma_f32_16x16x32_bf16 v[64:67], a[172:175], a[84:87], v[64:67]
ds_read_b128 a[192:195], v4 offset:32768
v_accvgpr_write_b32 a52, v132
v_mfma_f32_16x16x32_bf16 v[64:67], a[168:171], a[80:83], v[64:67]
s_add_u32 m0, s70, 81920
s_add_u32 s64, s68, 49152
v_accvgpr_write_b32 a53, v133
v_mfma_f32_16x16x32_bf16 v[204:207], a[176:179], a[80:83], v[204:207]
buffer_load_dwordx4 v4, s[24:27], s64 offen offset:0 sc1 lds
v_mfma_f32_16x16x32_bf16 v[204:207], a[180:183], a[84:87], v[204:207]
ds_read_b128 a[196:199], v4 offset:33792
v_accvgpr_write_b32 a54, v134
v_mfma_f32_16x16x32_bf16 v[212:215], a[188:191], a[84:87], v[212:215]
v_accvgpr_write_b32 a55, v135
v_cvt_pk_bf16_f32 v56, v56, v57
v_mfma_f32_16x16x32_bf16 v[212:215], a[184:187], a[80:83], v[212:215]
ds_read_b128 a[200:203], v4 offset:34816
v_cvt_pk_bf16_f32 v57, v58, v59
v_mfma_f32_16x16x32_bf16 v[80:83], a[160:163], a[88:91], v[80:83]
v_cvt_pk_bf16_f32 v58, v172, v173
v_cvt_pk_bf16_f32 v59, v174, v175
v_mfma_f32_16x16x32_bf16 v[80:83], a[164:167], a[92:95], v[80:83]
ds_read_b128 a[204:207], v4 offset:35840
v_accvgpr_write_b32 a56, v56
v_mfma_f32_16x16x32_bf16 v[176:179], a[172:175], a[92:95], v[176:179]
v_accvgpr_write_b32 a57, v57
v_accvgpr_write_b32 a58, v58
v_mfma_f32_16x16x32_bf16 v[176:179], a[168:171], a[88:91], v[176:179]
ds_read_b128 a[208:211], v4 offset:36864
v_accvgpr_write_b32 a59, v59
v_mfma_f32_16x16x32_bf16 v[168:171], a[176:179], a[88:91], v[168:171]
v_cvt_pk_bf16_f32 v188, v188, v189
v_cvt_pk_bf16_f32 v189, v190, v191
v_mfma_f32_16x16x32_bf16 v[168:171], a[180:183], a[92:95], v[168:171]
ds_read_b128 a[212:215], v4 offset:37888
v_cvt_pk_bf16_f32 v190, v180, v181
v_mfma_f32_16x16x32_bf16 v[228:231], a[188:191], a[92:95], v[228:231]
buffer_load_dwordx4 v4, s[24:27], s64 offen offset:1024 sc1 lds
v_mfma_f32_16x16x32_bf16 v[228:231], a[184:187], a[88:91], v[228:231]
ds_read_b128 a[216:219], v4 offset:38912
v_cvt_pk_bf16_f32 v191, v182, v183
v_mfma_f32_16x16x32_bf16 v[184:187], a[160:163], a[96:99], v[184:187]
v_accvgpr_write_b32 a60, v188
v_accvgpr_write_b32 a61, v189
v_mfma_f32_16x16x32_bf16 v[184:187], a[164:167], a[100:103], v[184:187]
ds_read_b128 a[220:223], v4 offset:39936
v_accvgpr_write_b32 a62, v190
v_mfma_f32_16x16x32_bf16 v[248:251], a[172:175], a[100:103], v[248:251]
v_accvgpr_write_b32 a63, v191
v_cvt_pk_bf16_f32 v196, v196, v197
v_mfma_f32_16x16x32_bf16 v[248:251], a[168:171], a[96:99], v[248:251]
v_cvt_pk_bf16_f32 v197, v198, v199
v_cvt_pk_bf16_f32 v198, v64, v65
v_mfma_f32_16x16x32_bf16 v[240:243], a[176:179], a[96:99], v[240:243]
v_cvt_pk_bf16_f32 v199, v66, v67
v_accvgpr_write_b32 a28, v196
v_mfma_f32_16x16x32_bf16 v[240:243], a[180:183], a[100:103], v[240:243]
v_accvgpr_write_b32 a29, v197
v_accvgpr_write_b32 a30, v198
v_mfma_f32_16x16x32_bf16 v[232:235], a[188:191], a[100:103], v[232:235]
v_accvgpr_write_b32 a31, v199
v_cvt_pk_bf16_f32 v204, v204, v205
v_mfma_f32_16x16x32_bf16 v[232:235], a[184:187], a[96:99], v[232:235]
v_cvt_pk_bf16_f32 v205, v206, v207
v_cvt_pk_bf16_f32 v206, v212, v213
v_mfma_f32_16x16x32_bf16 v[88:91], a[160:163], a[104:107], v[88:91]
v_cvt_pk_bf16_f32 v207, v214, v215
v_accvgpr_write_b32 a20, v204
v_mfma_f32_16x16x32_bf16 v[88:91], a[164:167], a[108:111], v[88:91]
buffer_load_dwordx4 v4, s[24:27], s64 offen offset:2048 sc1 lds
v_mfma_f32_16x16x32_bf16 v[200:203], a[172:175], a[108:111], v[200:203]
v_accvgpr_write_b32 a21, v205
v_accvgpr_write_b32 a22, v206
v_mfma_f32_16x16x32_bf16 v[200:203], a[168:171], a[104:107], v[200:203]
v_accvgpr_write_b32 a23, v207
v_cvt_pk_bf16_f32 v80, v80, v81
v_mfma_f32_16x16x32_bf16 v[192:195], a[176:179], a[104:107], v[192:195]
v_cvt_pk_bf16_f32 v81, v82, v83
v_cvt_pk_bf16_f32 v82, v176, v177
v_mfma_f32_16x16x32_bf16 v[192:195], a[180:183], a[108:111], v[192:195]
v_cvt_pk_bf16_f32 v83, v178, v179
v_accvgpr_write_b32 a12, v80
v_mfma_f32_16x16x32_bf16 v[244:247], a[188:191], a[108:111], v[244:247]
v_accvgpr_write_b32 a13, v81
v_accvgpr_write_b32 a14, v82
v_mfma_f32_16x16x32_bf16 v[244:247], a[184:187], a[104:107], v[244:247]
v_accvgpr_write_b32 a15, v83
v_cvt_pk_bf16_f32 v168, v168, v169
v_mfma_f32_16x16x32_bf16 v[72:75], a[112:115], a[80:83], v[72:75]
v_cvt_pk_bf16_f32 v169, v170, v171
v_cvt_pk_bf16_f32 v170, v228, v229
v_mfma_f32_16x16x32_bf16 v[72:75], a[116:119], a[84:87], v[72:75]
v_cvt_pk_bf16_f32 v171, v230, v231
v_accvgpr_write_b32 a4, v168
v_mfma_f32_16x16x32_bf16 v[220:223], a[124:127], a[84:87], v[220:223]
v_accvgpr_write_b32 a5, v169
v_accvgpr_write_b32 a6, v170
v_mfma_f32_16x16x32_bf16 v[220:223], a[120:123], a[80:83], v[220:223]
buffer_load_dwordx4 v4, s[24:27], s64 offen offset:3072 sc1 lds
v_mfma_f32_16x16x32_bf16 v[160:163], a[112:115], a[88:91], v[160:163]
v_accvgpr_write_b32 a7, v171
v_cvt_pk_bf16_f32 v184, v184, v185
v_mfma_f32_16x16x32_bf16 v[160:163], a[116:119], a[92:95], v[160:163]
v_cvt_pk_bf16_f32 v185, v186, v187
v_cvt_pk_bf16_f32 v186, v248, v249
v_mfma_f32_16x16x32_bf16 v[252:255], a[124:127], a[92:95], v[252:255]
v_cvt_pk_bf16_f32 v187, v250, v251
v_accvgpr_write_b32 a0, v184
v_mfma_f32_16x16x32_bf16 v[252:255], a[120:123], a[88:91], v[252:255]
v_accvgpr_write_b32 a1, v185
v_accvgpr_write_b32 a2, v186
v_mfma_f32_16x16x32_bf16 v[236:239], a[112:115], a[96:99], v[236:239]
v_accvgpr_write_b32 a3, v187
v_cvt_pk_bf16_f32 v240, v240, v241
v_mfma_f32_16x16x32_bf16 v[236:239], a[116:119], a[100:103], v[236:239]
v_cvt_pk_bf16_f32 v241, v242, v243
v_cvt_pk_bf16_f32 v242, v232, v233
v_mfma_f32_16x16x32_bf16 v[224:227], a[124:127], a[100:103], v[224:227]
v_cvt_pk_bf16_f32 v243, v234, v235
v_accvgpr_write_b32 a8, v240
v_mfma_f32_16x16x32_bf16 v[224:227], a[120:123], a[96:99], v[224:227]
v_accvgpr_write_b32 a9, v241
v_accvgpr_write_b32 a10, v242
v_mfma_f32_16x16x32_bf16 v[216:219], a[112:115], a[104:107], v[216:219]
v_accvgpr_write_b32 a11, v243
v_cvt_pk_bf16_f32 v88, v88, v89
v_mfma_f32_16x16x32_bf16 v[216:219], a[116:119], a[108:111], v[216:219]
v_cvt_pk_bf16_f32 v89, v90, v91
v_cvt_pk_bf16_f32 v90, v200, v201
v_mfma_f32_16x16x32_bf16 v[208:211], a[124:127], a[108:111], v[208:211]
v_cvt_pk_bf16_f32 v91, v202, v203
v_accvgpr_write_b32 a16, v88
v_mfma_f32_16x16x32_bf16 v[208:211], a[120:123], a[104:107], v[208:211]
s_waitcnt lgkmcnt(0)
v_accvgpr_write_b32 a17, v89
v_accvgpr_write_b32 a18, v90
v_mfma_f32_16x16x32_bf16 v[44:47], a[192:195], a[32:35], v[96:99]
v_accvgpr_write_b32 a19, v91
v_cvt_pk_bf16_f32 v192, v192, v193
v_mfma_f32_16x16x32_bf16 v[44:47], a[196:199], a[36:39], v[44:47]
v_cvt_pk_bf16_f32 v193, v194, v195
v_cvt_pk_bf16_f32 v194, v244, v245
v_mfma_f32_16x16x32_bf16 v[44:47], a[200:203], a[28:31], v[44:47]
v_cvt_pk_bf16_f32 v195, v246, v247
v_accvgpr_write_b32 a24, v192
v_mfma_f32_16x16x32_bf16 v[44:47], a[204:207], a[20:23], v[44:47]
v_accvgpr_write_b32 a25, v193
v_accvgpr_write_b32 a26, v194
v_mfma_f32_16x16x32_bf16 v[52:55], a[192:195], a[44:47], v[104:107]
ds_bpermute_b32 v8, v17, v63
v_accvgpr_write_b32 a27, v195
v_mfma_f32_16x16x32_bf16 v[52:55], a[196:199], a[40:43], v[52:55]
v_cvt_pk_bf16_f32 v60, v60, v61
v_cvt_pk_bf16_f32 v61, v62, v63
v_mfma_f32_16x16x32_bf16 v[52:55], a[200:203], a[12:15], v[52:55]
v_cvt_pk_bf16_f32 v62, v68, v69
v_cvt_pk_bf16_f32 v63, v70, v71
v_mfma_f32_16x16x32_bf16 v[52:55], a[204:207], a[4:7], v[52:55]
buffer_store_dwordx4 v[60:63], v18, s[24:27], s54 offen offset:0 sc1
v_mfma_f32_16x16x32_bf16 v[64:67], a[208:211], a[32:35], v[112:115]
ds_bpermute_b32 v9, v17, v87
v_cvt_pk_bf16_f32 v84, v84, v85
v_mfma_f32_16x16x32_bf16 v[64:67], a[212:215], a[36:39], v[64:67]
v_cvt_pk_bf16_f32 v85, v86, v87
v_cvt_pk_bf16_f32 v86, v76, v77
v_mfma_f32_16x16x32_bf16 v[64:67], a[216:219], a[28:31], v[64:67]
v_cvt_pk_bf16_f32 v87, v78, v79
v_mfma_f32_16x16x32_bf16 v[64:67], a[220:223], a[20:23], v[64:67]
buffer_store_dwordx4 v[84:87], v18, s[24:27], s54 offen offset:256 sc1
v_mfma_f32_16x16x32_bf16 v[212:215], a[208:211], a[44:47], v[120:123]
L_PAD8:
s_cbranch_execz L_PAD12
ds_bpermute_b32 v10, v17, v151
v_cvt_pk_bf16_f32 v148, v148, v149
v_mfma_f32_16x16x32_bf16 v[212:215], a[212:215], a[40:43], v[212:215]
v_cvt_pk_bf16_f32 v149, v150, v151
v_cvt_pk_bf16_f32 v150, v48, v49
v_mfma_f32_16x16x32_bf16 v[212:215], a[216:219], a[12:15], v[212:215]
v_cvt_pk_bf16_f32 v151, v50, v51
v_mfma_f32_16x16x32_bf16 v[212:215], a[220:223], a[4:7], v[212:215]
s_waitcnt vmcnt(16)
buffer_store_dwordx4 v[148:151], v18, s[24:27], s55 offen offset:0 sc1
v_mfma_f32_16x16x32_bf16 v[100:103], a[192:195], a[48:51], v[128:131]
s_barrier
ds_bpermute_b32 v11, v17, v167
v_cvt_pk_bf16_f32 v164, v164, v165
v_mfma_f32_16x16x32_bf16 v[100:103], a[196:199], a[52:55], v[100:103]
v_cvt_pk_bf16_f32 v165, v166, v167
v_cvt_pk_bf16_f32 v166, v156, v157
v_mfma_f32_16x16x32_bf16 v[100:103], a[200:203], a[0:3], v[100:103]
v_cvt_pk_bf16_f32 v167, v158, v159
v_mfma_f32_16x16x32_bf16 v[100:103], a[204:207], a[8:11], v[100:103]
buffer_store_dwordx4 v[164:167], v18, s[24:27], s55 offen offset:256 sc1
v_mfma_f32_16x16x32_bf16 v[92:95], a[192:195], a[60:63], v[136:139]
v_cvt_pk_bf16_f32 v72, v72, v73
v_cvt_pk_bf16_f32 v73, v74, v75
v_mfma_f32_16x16x32_bf16 v[92:95], a[196:199], a[56:59], v[92:95]
v_cvt_pk_bf16_f32 v74, v220, v221
v_cvt_pk_bf16_f32 v75, v222, v223
v_mfma_f32_16x16x32_bf16 v[92:95], a[200:203], a[16:19], v[92:95]
buffer_store_dwordx4 v[72:75], v19, s[24:27], s54 offen offset:0 sc1
v_mfma_f32_16x16x32_bf16 v[92:95], a[204:207], a[24:27], v[92:95]
v_cvt_pk_bf16_f32 v160, v160, v161
v_cvt_pk_bf16_f32 v161, v162, v163
v_mfma_f32_16x16x32_bf16 v[176:179], a[208:211], a[48:51], v[144:147]
v_cvt_pk_bf16_f32 v162, v252, v253
v_cvt_pk_bf16_f32 v163, v254, v255
v_mfma_f32_16x16x32_bf16 v[176:179], a[212:215], a[52:55], v[176:179]
buffer_store_dwordx4 v[160:163], v19, s[24:27], s54 offen offset:256 sc1
v_mfma_f32_16x16x32_bf16 v[176:179], a[216:219], a[0:3], v[176:179]
v_cvt_pk_bf16_f32 v236, v236, v237
v_cvt_pk_bf16_f32 v237, v238, v239
v_mfma_f32_16x16x32_bf16 v[176:179], a[220:223], a[8:11], v[176:179]
v_cvt_pk_bf16_f32 v238, v224, v225
v_cvt_pk_bf16_f32 v239, v226, v227
v_mfma_f32_16x16x32_bf16 v[228:231], a[208:211], a[60:63], v[152:155]
buffer_store_dwordx4 v[236:239], v19, s[24:27], s55 offen offset:0 sc1
v_mfma_f32_16x16x32_bf16 v[228:231], a[212:215], a[56:59], v[228:231]
v_cvt_pk_bf16_f32 v216, v216, v217
v_cvt_pk_bf16_f32 v217, v218, v219
v_mfma_f32_16x16x32_bf16 v[228:231], a[216:219], a[16:19], v[228:231]
v_cvt_pk_bf16_f32 v218, v208, v209
v_cvt_pk_bf16_f32 v219, v210, v211
v_mfma_f32_16x16x32_bf16 v[228:231], a[220:223], a[24:27], v[228:231]
buffer_store_dwordx4 v[216:219], v19, s[24:27], s55 offen offset:256 sc1
ds_read_b128 a[64:67], v4 offset:57344
ds_read_b128 a[68:71], v4 offset:58368
ds_read_b128 a[72:75], v4 offset:59392
ds_read_b128 a[76:79], v4 offset:60416
ds_read_b128 a[80:83], v4 offset:61440
ds_read_b128 a[84:87], v4 offset:62464
ds_read_b128 a[88:91], v4 offset:63488
ds_read_b128 a[92:95], v4 offset:64512
s_add_u32 m0, s70, 98304
s_add_u32 s64, s68, 65536
buffer_load_dwordx4 v4, s[24:27], s64 offen offset:0 sc1 lds
v_max3_f32 v24, v44, v45, v46
v_max3_f32 v25, v47, v64, v65
v_max3_f32 v26, v52, v53, v54
v_max3_f32 v27, v55, v212, v213
v_max3_f32 v24, v24, v66, v67
v_max_f32 v24, v24, v25
buffer_load_dwordx4 v4, s[24:27], s64 offen offset:1024 sc1 lds
v_max3_f32 v26, v26, v214, v215
v_max_f32 v26, v26, v27
v_mov_b32 v25, v24
v_mov_b32 v27, v26
s_nop 1
v_permlane32_swap_b32 v25, v24
buffer_load_dwordx4 v4, s[24:27], s64 offen offset:2048 sc1 lds
v_permlane32_swap_b32 v27, v26
s_nop 0
v_max_f32 v24, v24, v25
v_max_f32 v26, v26, v27
v_mov_b32 v25, v24
v_mov_b32 v27, v26
buffer_load_dwordx4 v4, s[24:27], s64 offen offset:3072 sc1 lds
s_nop 1
v_permlane16_swap_b32 v25, v24
v_permlane16_swap_b32 v27, v26
s_nop 0
v_max_f32 v24, v24, v25
v_max_f32 v26, v26, v27
s_add_u32 m0, s70, 114688
s_add_u32 s64, s68, 81920
buffer_load_dwordx4 v4, s[24:27], s64 offen offset:0 sc1 lds
v_pk_add_f32 v[44:45], v[44:45], v[24:25] op_sel_hi:[1,0] neg_lo:[0,1] neg_hi:[0,1]
v_pk_add_f32 v[46:47], v[46:47], v[24:25] op_sel_hi:[1,0] neg_lo:[0,1] neg_hi:[0,1]
v_pk_add_f32 v[52:53], v[52:53], v[26:27] op_sel_hi:[1,0] neg_lo:[0,1] neg_hi:[0,1]
v_pk_add_f32 v[54:55], v[54:55], v[26:27] op_sel_hi:[1,0] neg_lo:[0,1] neg_hi:[0,1]
v_pk_add_f32 v[64:65], v[64:65], v[24:25] op_sel_hi:[1,0] neg_lo:[0,1] neg_hi:[0,1]
v_pk_add_f32 v[66:67], v[66:67], v[24:25] op_sel_hi:[1,0] neg_lo:[0,1] neg_hi:[0,1]
buffer_load_dwordx4 v4, s[24:27], s64 offen offset:1024 sc1 lds
v_pk_add_f32 v[212:213], v[212:213], v[26:27] op_sel_hi:[1,0] neg_lo:[0,1] neg_hi:[0,1]
v_pk_add_f32 v[214:215], v[214:215], v[26:27] op_sel_hi:[1,0] neg_lo:[0,1] neg_hi:[0,1]
v_pk_add_f32 v[96:97], v[96:97], v[24:25] op_sel_hi:[1,0] neg_lo:[0,1] neg_hi:[0,1]
v_pk_add_f32 v[98:99], v[98:99], v[24:25] op_sel_hi:[1,0] neg_lo:[0,1] neg_hi:[0,1]
v_pk_add_f32 v[104:105], v[104:105], v[26:27] op_sel_hi:[1,0] neg_lo:[0,1] neg_hi:[0,1]
v_pk_add_f32 v[106:107], v[106:107], v[26:27] op_sel_hi:[1,0] neg_lo:[0,1] neg_hi:[0,1]
buffer_load_dwordx4 v4, s[24:27], s64 offen offset:2048 sc1 lds
v_pk_add_f32 v[112:113], v[112:113], v[24:25] op_sel_hi:[1,0] neg_lo:[0,1] neg_hi:[0,1]
v_pk_add_f32 v[114:115], v[114:115], v[24:25] op_sel_hi:[1,0] neg_lo:[0,1] neg_hi:[0,1]
v_pk_add_f32 v[120:121], v[120:121], v[26:27] op_sel_hi:[1,0] neg_lo:[0,1] neg_hi:[0,1]
v_pk_add_f32 v[122:123], v[122:123], v[26:27] op_sel_hi:[1,0] neg_lo:[0,1] neg_hi:[0,1]
v_exp_f32 v44, v44
v_exp_f32 v45, v45
buffer_load_dwordx4 v4, s[24:27], s64 offen offset:3072 sc1 lds
v_exp_f32 v46, v46
v_exp_f32 v47, v47
v_cvt_pk_bf16_f32 v124, v44, v45
v_exp_f32 v52, v52
v_exp_f32 v53, v53
v_cvt_pk_bf16_f32 v125, v46, v47
s_add_u32 m0, s70, 131072
s_add_u32 s64, s68, 98304
s_cmp_ge_u32 s3, 1
s_cselect_b32 s64, s64, 2147418112
buffer_load_dwordx4 v4, s[24:27], s64 offen offset:0 sc1 lds
v_exp_f32 v54, v54
v_exp_f32 v55, v55
v_cvt_pk_bf16_f32 v140, v52, v53
v_exp_f32 v64, v64
v_exp_f32 v65, v65
v_cvt_pk_bf16_f32 v141, v54, v55
buffer_load_dwordx4 v4, s[24:27], s64 offen offset:1024 sc1 lds
v_exp_f32 v66, v66
v_exp_f32 v67, v67
v_cvt_pk_bf16_f32 v126, v64, v65
v_exp_f32 v212, v212
v_exp_f32 v213, v213
v_cvt_pk_bf16_f32 v127, v66, v67
buffer_load_dwordx4 v4, s[24:27], s64 offen offset:2048 sc1 lds
v_exp_f32 v214, v214
v_exp_f32 v215, v215
v_cvt_pk_bf16_f32 v142, v212, v213
v_max3_f32 v24, v100, v101, v102
v_cvt_pk_bf16_f32 v143, v214, v215
v_max3_f32 v25, v103, v176, v177
buffer_load_dwordx4 v4, s[24:27], s64 offen offset:3072 sc1 lds
v_max3_f32 v26, v92, v93, v94
v_max3_f32 v27, v95, v228, v229
v_max3_f32 v24, v24, v178, v179
v_max_f32 v24, v24, v25
v_max3_f32 v26, v26, v230, v231
v_max_f32 v26, v26, v27
s_add_u32 m0, s70, 147456
s_add_u32 s64, s68, 114688
s_cmp_ge_u32 s3, 2
s_cselect_b32 s64, s64, 2147418112
buffer_load_dwordx4 v4, s[24:27], s64 offen offset:0 sc1 lds
v_mov_b32 v25, v24
v_mov_b32 v27, v26
s_nop 1
v_permlane32_swap_b32 v25, v24
v_permlane32_swap_b32 v27, v26
s_nop 0
buffer_load_dwordx4 v4, s[24:27], s64 offen offset:1024 sc1 lds
v_max_f32 v24, v24, v25
v_max_f32 v26, v26, v27
v_mov_b32 v25, v24
v_mov_b32 v27, v26
s_nop 1
v_permlane16_swap_b32 v25, v24
buffer_load_dwordx4 v4, s[24:27], s64 offen offset:2048 sc1 lds
v_permlane16_swap_b32 v27, v26
s_nop 0
v_max_f32 v24, v24, v25
v_max_f32 v26, v26, v27
v_pk_add_f32 v[100:101], v[100:101], v[24:25] op_sel_hi:[1,0] neg_lo:[0,1] neg_hi:[0,1]
v_pk_add_f32 v[102:103], v[102:103], v[24:25] op_sel_hi:[1,0] neg_lo:[0,1] neg_hi:[0,1]
buffer_load_dwordx4 v4, s[24:27], s64 offen offset:3072 sc1 lds
v_pk_add_f32 v[92:93], v[92:93], v[26:27] op_sel_hi:[1,0] neg_lo:[0,1] neg_hi:[0,1]
v_pk_add_f32 v[94:95], v[94:95], v[26:27] op_sel_hi:[1,0] neg_lo:[0,1] neg_hi:[0,1]
v_pk_add_f32 v[176:177], v[176:177], v[24:25] op_sel_hi:[1,0] neg_lo:[0,1] neg_hi:[0,1]
v_pk_add_f32 v[178:179], v[178:179], v[24:25] op_sel_hi:[1,0] neg_lo:[0,1] neg_hi:[0,1]
v_pk_add_f32 v[228:229], v[228:229], v[26:27] op_sel_hi:[1,0] neg_lo:[0,1] neg_hi:[0,1]
v_pk_add_f32 v[230:231], v[230:231], v[26:27] op_sel_hi:[1,0] neg_lo:[0,1] neg_hi:[0,1]
s_add_u32 m0, s70, 0
s_add_u32 s64, s68, 131072
s_cmp_ge_u32 s3, 3
s_cselect_b32 s64, s64, 2147418112
buffer_load_dwordx4 v4, s[24:27], s64 offen offset:0 sc1 lds
v_pk_add_f32 v[128:129], v[128:129], v[24:25] op_sel_hi:[1,0] neg_lo:[0,1] neg_hi:[0,1]
v_pk_add_f32 v[130:131], v[130:131], v[24:25] op_sel_hi:[1,0] neg_lo:[0,1] neg_hi:[0,1]
v_pk_add_f32 v[136:137], v[136:137], v[26:27] op_sel_hi:[1,0] neg_lo:[0,1] neg_hi:[0,1]
v_pk_add_f32 v[138:139], v[138:139], v[26:27] op_sel_hi:[1,0] neg_lo:[0,1] neg_hi:[0,1]
v_pk_add_f32 v[144:145], v[144:145], v[24:25] op_sel_hi:[1,0] neg_lo:[0,1] neg_hi:[0,1]
v_pk_add_f32 v[146:147], v[146:147], v[24:25] op_sel_hi:[1,0] neg_lo:[0,1] neg_hi:[0,1]
buffer_load_dwordx4 v4, s[24:27], s64 offen offset:1024 sc1 lds
v_pk_add_f32 v[152:153], v[152:153], v[26:27] op_sel_hi:[1,0] neg_lo:[0,1] neg_hi:[0,1]
v_pk_add_f32 v[154:155], v[154:155], v[26:27] op_sel_hi:[1,0] neg_lo:[0,1] neg_hi:[0,1]
v_mov_b64 v[60:61], 0
v_mov_b64 v[62:63], 0
v_mov_b64 v[68:69], 0
v_mov_b64 v[70:71], 0
buffer_load_dwordx4 v4, s[24:27], s64 offen offset:2048 sc1 lds
v_mov_b64 v[72:73], 0
v_mov_b64 v[74:75], 0
v_mov_b64 v[220:221], 0
v_mov_b64 v[222:223], 0
v_mov_b64 v[84:85], 0
v_mov_b64 v[86:87], 0
buffer_load_dwordx4 v4, s[24:27], s64 offen offset:3072 sc1 lds
v_mov_b64 v[76:77], 0
v_mov_b64 v[78:79], 0
v_mov_b64 v[160:161], 0
v_mov_b64 v[162:163], 0
v_mov_b64 v[252:253], 0
v_mov_b64 v[254:255], 0
v_mov_b64 v[148:149], 0
v_mov_b64 v[150:151], 0
v_mov_b64 v[48:49], 0
v_mov_b64 v[50:51], 0
v_mov_b64 v[236:237], 0
v_mov_b64 v[238:239], 0
v_mov_b64 v[224:225], 0
v_mov_b64 v[226:227], 0
v_mov_b64 v[164:165], 0
v_mov_b64 v[166:167], 0
v_mov_b64 v[156:157], 0
v_mov_b64 v[158:159], 0
v_mov_b64 v[216:217], 0
v_mov_b64 v[218:219], 0
v_mov_b64 v[208:209], 0
v_mov_b64 v[210:211], 0
ds_read_b128 a[192:195], v4 offset:49152
ds_read_b128 a[196:199], v4 offset:50176
ds_read_b128 a[200:203], v4 offset:51200
ds_read_b128 a[204:207], v4 offset:52224
ds_read_b128 a[208:211], v4 offset:53248
ds_read_b128 a[212:215], v4 offset:54272
ds_read_b128 a[216:219], v4 offset:55296
ds_read_b128 a[220:223], v4 offset:56320
s_waitcnt lgkmcnt(8)
s_lshl2_add_u32 s77, s86, s84
s_mul_i32 s77, s77, 344064
s_mov_b32 s80, s70
s_cmp_lt_u32 s3, 2
s_cselect_b32 s53, 8, -2
s_add_u32 s53, s53, s3
v_mfma_f32_16x16x32_bf16 v[36:39], a[64:67], v[124:127], 0
s_mul_i32 s52, s5, 65536
v_exp_f32 v100, v100
v_mfma_f32_16x16x32_bf16 v[116:119], a[64:67], v[140:143], 0
s_sub_u32 s52, 1064960, s52
v_exp_f32 v101, v101
v_mfma_f32_16x16x32_bf16 v[132:135], a[68:71], v[140:143], 0
s_add_u32 s71, s68, s52
v_exp_f32 v102, v102
v_mfma_f32_16x16x32_bf16 v[32:35], a[68:71], v[124:127], 0
s_add_u32 s77, s77, s80
v_exp_f32 v103, v103
v_mfma_f32_16x16x32_bf16 v[196:199], a[72:75], v[124:127], 0
s_add_u32 s77, s77, 38797312
v_cvt_pk_bf16_f32 v248, v100, v101
v_cvt_pk_bf16_f32 v249, v102, v103
v_mfma_f32_16x16x32_bf16 v[184:187], a[72:75], v[140:143], 0
s_add_u32 s52, s3, 6
v_exp_f32 v92, v92
v_mfma_f32_16x16x32_bf16 v[240:243], a[76:79], v[140:143], 0
s_mul_i32 s52, s52, 16384
v_exp_f32 v93, v93
v_mfma_f32_16x16x32_bf16 v[204:207], a[76:79], v[124:127], 0
s_add_u32 s68, s68, s52
v_exp_f32 v94, v94
v_mfma_f32_16x16x32_bf16 v[108:111], a[80:83], v[124:127], 0
s_lshl_b32 s53, s53, 14
v_exp_f32 v95, v95
v_mfma_f32_16x16x32_bf16 v[188:191], a[80:83], v[140:143], 0
s_add_u32 s70, s70, s53
v_cvt_pk_bf16_f32 v232, v92, v93
v_cvt_pk_bf16_f32 v233, v94, v95
v_mfma_f32_16x16x32_bf16 v[56:59], a[84:87], v[140:143], 0
s_mov_b32 s75, 65536
v_exp_f32 v176, v176
v_mfma_f32_16x16x32_bf16 v[40:43], a[84:87], v[124:127], 0
s_mov_b32 s72, 1
v_exp_f32 v177, v177
v_mfma_f32_16x16x32_bf16 v[80:83], a[88:91], v[124:127], 0
s_mov_b32 s73, 3
v_exp_f32 v178, v178
v_mfma_f32_16x16x32_bf16 v[88:91], a[88:91], v[140:143], 0
s_lshl2_add_u32 s69, s5, 4
v_exp_f32 v179, v179
v_mfma_f32_16x16x32_bf16 v[192:195], a[92:95], v[140:143], 0
s_max_u32 s69, s69, 12
v_cvt_pk_bf16_f32 v250, v176, v177
v_cvt_pk_bf16_f32 v251, v178, v179
v_mfma_f32_16x16x32_bf16 v[168:171], a[92:95], v[124:127], 0
s_min_u32 s74, s73, s66
v_exp_f32 v228, v228
v_mfma_f32_16x16x32_bf16 a[224:227], a[240:243], v[124:127], 0
s_mov_b32 s93, 3
v_mfma_f32_16x16x32_bf16 a[228:231], a[240:243], v[140:143], 0
s_cmp_lt_u32 s66, 2
s_waitcnt vmcnt(28) lgkmcnt(0)
s_cbranch_scc1 L_NE
L_DUAL:
v_mfma_f32_16x16x32_bf16 v[44:47], a[192:195], a[32:35], v[96:99]
s_barrier
v_mfma_f32_16x16x32_bf16 v[44:47], a[196:199], a[36:39], v[44:47]
s_cmp_eq_u32 s68, s71
v_exp_f32 v229, v229
v_mfma_f32_16x16x32_bf16 v[44:47], a[200:203], a[28:31], v[44:47]
s_cselect_b32 s64, s77, s68
v_add_u32 v5, s75, v4
v_cvt_pk_bf16_f32 v234, v228, v229
v_mfma_f32_16x16x32_bf16 v[44:47], a[204:207], a[20:23], v[44:47]
s_mov_b32 m0, s70
v_exp_f32 v230, v230
v_mfma_f32_16x16x32_bf16 v[52:55], a[192:195], a[44:47], v[104:107]
buffer_load_dwordx4 v4, s[24:27], s64 offen offset:0 sc1 lds
v_mfma_f32_16x16x32_bf16 v[52:55], a[196:199], a[40:43], v[52:55]
s_add_u32 s75, s75, 16384
v_exp_f32 v231, v231
v_mfma_f32_16x16x32_bf16 v[52:55], a[200:203], a[12:15], v[52:55]
v_cvt_pk_bf16_f32 v235, v230, v231
v_mfma_f32_16x16x32_bf16 v[52:55], a[204:207], a[4:7], v[52:55]
s_cmp_ge_u32 s75, 163840
v_exp_f32 v44, v44
v_mfma_f32_16x16x32_bf16 v[64:67], a[208:211], a[32:35], v[112:115]
v_mfma_f32_16x16x32_bf16 v[64:67], a[212:215], a[36:39], v[64:67]
s_cselect_b32 s75, 0, s75
v_exp_f32 v45, v45
v_mfma_f32_16x16x32_bf16 v[64:67], a[216:219], a[28:31], v[64:67]
v_cvt_pk_bf16_f32 v124, v44, v45
v_mfma_f32_16x16x32_bf16 v[64:67], a[220:223], a[20:23], v[64:67]
s_add_u32 s68, s64, 16384
v_exp_f32 v46, v46
v_mfma_f32_16x16x32_bf16 v[212:215], a[208:211], a[44:47], v[120:123]
buffer_load_dwordx4 v4, s[24:27], s64 offen offset:1024 sc1 lds
v_mfma_f32_16x16x32_bf16 v[212:215], a[212:215], a[40:43], v[212:215]
s_add_u32 s70, s70, 16384
v_exp_f32 v47, v47
v_mfma_f32_16x16x32_bf16 v[212:215], a[216:219], a[12:15], v[212:215]
v_cvt_pk_bf16_f32 v125, v46, v47
v_mfma_f32_16x16x32_bf16 v[212:215], a[220:223], a[4:7], v[212:215]
v_exp_f32 v52, v52
v_mfma_f32_16x16x32_bf16 v[60:63], a[64:67], v[248:251], v[60:63]
v_mfma_f32_16x16x32_bf16 v[148:151], a[64:67], v[232:235], v[148:151]
s_cmp_ge_u32 s70, 163840
v_exp_f32 v53, v53
v_mfma_f32_16x16x32_bf16 v[48:51], a[68:71], v[232:235], v[48:51]
ds_read_b128 a[64:67], v5 offset:8192
v_cvt_pk_bf16_f32 v140, v52, v53
v_mfma_f32_16x16x32_bf16 v[68:71], a[68:71], v[248:251], v[68:71]
s_cselect_b32 s70, s80, s70
v_exp_f32 v54, v54
v_mfma_f32_16x16x32_bf16 v[72:75], a[72:75], v[248:251], v[72:75]
buffer_load_dwordx4 v4, s[24:27], s64 offen offset:2048 sc1 lds
v_mfma_f32_16x16x32_bf16 v[236:239], a[72:75], v[232:235], v[236:239]
v_exp_f32 v55, v55
v_mfma_f32_16x16x32_bf16 v[224:227], a[76:79], v[232:235], v[224:227]
ds_read_b128 a[68:71], v5 offset:9216
v_cvt_pk_bf16_f32 v141, v54, v55
v_mfma_f32_16x16x32_bf16 v[220:223], a[76:79], v[248:251], v[220:223]
v_exp_f32 v64, v64
v_mfma_f32_16x16x32_bf16 v[84:87], a[80:83], v[248:251], v[84:87]
ds_read_b128 a[72:75], v5 offset:10240
v_mfma_f32_16x16x32_bf16 v[164:167], a[80:83], v[232:235], v[164:167]
v_exp_f32 v65, v65
v_mfma_f32_16x16x32_bf16 v[156:159], a[84:87], v[232:235], v[156:159]
ds_read_b128 a[76:79], v5 offset:11264
v_cvt_pk_bf16_f32 v126, v64, v65
v_mfma_f32_16x16x32_bf16 v[76:79], a[84:87], v[248:251], v[76:79]
v_exp_f32 v66, v66
v_mfma_f32_16x16x32_bf16 v[160:163], a[88:91], v[248:251], v[160:163]
buffer_load_dwordx4 v4, s[24:27], s64 offen offset:3072 sc1 lds
v_mfma_f32_16x16x32_bf16 v[216:219], a[88:91], v[232:235], v[216:219]
v_exp_f32 v67, v67
v_mfma_f32_16x16x32_bf16 v[208:211], a[92:95], v[232:235], v[208:211]
ds_read_b128 a[80:83], v5 offset:12288
v_cvt_pk_bf16_f32 v127, v66, v67
v_mfma_f32_16x16x32_bf16 v[252:255], a[92:95], v[248:251], v[252:255]
v_exp_f32 v212, v212
v_mfma_f32_16x16x32_bf16 a[232:235], a[240:243], v[248:251], a[232:235]
ds_read_b128 a[84:87], v5 offset:13312
v_mfma_f32_16x16x32_bf16 a[236:239], a[240:243], v[232:235], a[236:239]
ds_read_b128 a[88:91], v5 offset:14336
v_mfma_f32_16x16x32_bf16 v[100:103], a[192:195], a[48:51], v[128:131]
ds_read_b128 a[92:95], v5 offset:15360
v_mfma_f32_16x16x32_bf16 v[100:103], a[196:199], a[52:55], v[100:103]
v_exp_f32 v213, v213
v_mfma_f32_16x16x32_bf16 v[100:103], a[200:203], a[0:3], v[100:103]
v_cvt_pk_bf16_f32 v142, v212, v213
v_mfma_f32_16x16x32_bf16 v[100:103], a[204:207], a[8:11], v[100:103]
v_exp_f32 v214, v214
v_mfma_f32_16x16x32_bf16 v[92:95], a[192:195], a[60:63], v[136:139]
s_nop 0
v_mfma_f32_16x16x32_bf16 v[92:95], a[196:199], a[56:59], v[92:95]
v_exp_f32 v215, v215
v_mfma_f32_16x16x32_bf16 v[92:95], a[200:203], a[16:19], v[92:95]
ds_read_b128 a[192:195], v5 offset:0
v_cvt_pk_bf16_f32 v143, v214, v215
v_mfma_f32_16x16x32_bf16 v[92:95], a[204:207], a[24:27], v[92:95]
v_exp_f32 v100, v100
v_mfma_f32_16x16x32_bf16 v[176:179], a[208:211], a[48:51], v[144:147]
ds_read_b128 a[196:199], v5 offset:1024
v_mfma_f32_16x16x32_bf16 v[176:179], a[212:215], a[52:55], v[176:179]
v_exp_f32 v101, v101
v_mfma_f32_16x16x32_bf16 v[176:179], a[216:219], a[0:3], v[176:179]
ds_read_b128 a[200:203], v5 offset:2048
v_cvt_pk_bf16_f32 v248, v100, v101
v_mfma_f32_16x16x32_bf16 v[176:179], a[220:223], a[8:11], v[176:179]
v_exp_f32 v102, v102
v_mfma_f32_16x16x32_bf16 v[228:231], a[208:211], a[60:63], v[152:155]
ds_read_b128 a[204:207], v5 offset:3072
v_mfma_f32_16x16x32_bf16 v[228:231], a[212:215], a[56:59], v[228:231]
v_exp_f32 v103, v103
v_mfma_f32_16x16x32_bf16 v[228:231], a[216:219], a[16:19], v[228:231]
ds_read_b128 a[208:211], v5 offset:4096
v_cvt_pk_bf16_f32 v249, v102, v103
v_mfma_f32_16x16x32_bf16 v[228:231], a[220:223], a[24:27], v[228:231]
s_waitcnt lgkmcnt(5)
v_exp_f32 v92, v92
v_mfma_f32_16x16x32_bf16 v[36:39], a[64:67], v[124:127], v[36:39]
ds_read_b128 a[212:215], v5 offset:5120
v_mfma_f32_16x16x32_bf16 v[116:119], a[64:67], v[140:143], v[116:119]
v_exp_f32 v93, v93
v_mfma_f32_16x16x32_bf16 v[132:135], a[68:71], v[140:143], v[132:135]
ds_read_b128 a[216:219], v5 offset:6144
v_cvt_pk_bf16_f32 v232, v92, v93
v_mfma_f32_16x16x32_bf16 v[32:35], a[68:71], v[124:127], v[32:35]
v_exp_f32 v94, v94
v_mfma_f32_16x16x32_bf16 v[196:199], a[72:75], v[124:127], v[196:199]
ds_read_b128 a[220:223], v5 offset:7168
v_mfma_f32_16x16x32_bf16 v[184:187], a[72:75], v[140:143], v[184:187]
s_add_u32 s72, s72, 1
v_exp_f32 v95, v95
v_mfma_f32_16x16x32_bf16 v[240:243], a[76:79], v[140:143], v[240:243]
v_cvt_pk_bf16_f32 v233, v94, v95
v_mfma_f32_16x16x32_bf16 v[204:207], a[76:79], v[124:127], v[204:207]
v_exp_f32 v176, v176
v_mfma_f32_16x16x32_bf16 v[108:111], a[80:83], v[124:127], v[108:111]
v_mfma_f32_16x16x32_bf16 v[188:191], a[80:83], v[140:143], v[188:191]
v_exp_f32 v177, v177
v_mfma_f32_16x16x32_bf16 v[56:59], a[84:87], v[140:143], v[56:59]
v_cvt_pk_bf16_f32 v250, v176, v177
v_mfma_f32_16x16x32_bf16 v[40:43], a[84:87], v[124:127], v[40:43]
v_exp_f32 v178, v178
v_mfma_f32_16x16x32_bf16 v[80:83], a[88:91], v[124:127], v[80:83]
v_mfma_f32_16x16x32_bf16 v[88:91], a[88:91], v[140:143], v[88:91]
s_cmp_lt_u32 s72, s74
v_exp_f32 v179, v179
v_mfma_f32_16x16x32_bf16 v[192:195], a[92:95], v[140:143], v[192:195]
v_cvt_pk_bf16_f32 v251, v178, v179
v_mfma_f32_16x16x32_bf16 v[168:171], a[92:95], v[124:127], v[168:171]
s_waitcnt vmcnt(8) lgkmcnt(0)
v_exp_f32 v228, v228
v_mfma_f32_16x16x32_bf16 a[224:227], a[240:243], v[124:127], a[224:227]
v_mfma_f32_16x16x32_bf16 a[228:231], a[240:243], v[140:143], a[228:231]
s_cbranch_scc1 L_DUAL
L_DISP:
s_cmp_eq_u32 s72, s93
s_cbranch_scc1 L_STOP
L_NE:
s_mov_b32 s74, s93
s_cmp_gt_u32 s72, s66
s_cbranch_scc1 L_SINGLE
v_cndmask_b32 v96, v96, v6, s[56:57]
v_cndmask_b32 v120, v120, v6, s[56:57]
v_mov_b32 v112, v6
v_cndmask_b32 v97, v97, v6, s[58:59]
v_cndmask_b32 v121, v121, v6, s[58:59]
v_mov_b32 v113, v6
v_cndmask_b32 v98, v98, v6, s[60:61]
v_cndmask_b32 v122, v122, v6, s[60:61]
v_mov_b32 v114, v6
v_cndmask_b32 v99, v99, v6, s[62:63]
v_cndmask_b32 v123, v123, v6, s[62:63]
v_mov_b32 v115, v6
s_mov_b32 s74, 0
s_branch L_DUAL
L_STOP:
s_cmp_eq_u32 s72, 3
s_cbranch_scc1 L_E0
s_cmp_eq_u32 s72, 9
s_cbranch_scc1 L_E1
s_cmp_lg_u32 s72, 11
s_cbranch_scc1 L_SE
v_cmp_gt_u32 vcc, 32, v172
s_mov_b32 s73, 32
s_min_u32 s93, s73, s69
s_min_u32 s74, s93, s66
s_nop 1
s_cbranch_vccnz CK_Q
CK_Q_R:
s_add_u32 s53, s77, 163840
buffer_load_dwordx4 a[96:99], v4, s[24:27], s53 offen offset:0 sc1
buffer_load_dwordx4 a[100:103], v4, s[24:27], s53 offen offset:1024 sc1
buffer_load_dwordx4 a[104:107], v4, s[24:27], s53 offen offset:2048 sc1
buffer_load_dwordx4 a[108:111], v4, s[24:27], s53 offen offset:3072 sc1
s_cmp_lt_u32 s72, s66
s_cbranch_scc1 L_DUAL
s_mov_b32 s74, s93
s_cmp_gt_u32 s72, s66
s_cbranch_scc1 L_SINGLE
s_branch L_NE
L_E0:
buffer_atomic_add v1, v0, s[24:27], s89 offen offset:8 sc1
s_mov_b32 s73, 9
s_min_u32 s93, s73, s69
s_min_u32 s74, s93, s66
s_cmp_lt_u32 s72, s66
s_cbranch_scc1 L_DUAL
s_mov_b32 s74, s93
s_cmp_gt_u32 s72, s66
s_cbranch_scc1 L_SINGLE
s_branch L_NE
L_E1:
v_and_b32 v173, 31, v1
v_lshlrev_b32 v173, 10, v173
v_add_u32 v173, 75497992, v173
buffer_load_dword v172, v173, s[24:27], 0 offen sc1
s_mov_b32 s73, 11
s_min_u32 s93, s73, s69
s_min_u32 s74, s93, s66
s_cmp_lt_u32 s72, s66
s_cbranch_scc1 L_DUAL
s_mov_b32 s74, s93
s_cmp_gt_u32 s72, s66
s_cbranch_scc1 L_SINGLE
s_branch L_NE
L_SE:
s_lshr_b32 s52, s4, 3
s_mul_i32 s52, s52, 75776
s_add_u32 s52, s52, 54525952
s_and_b32 s53, s4, 7
s_mul_i32 s53, s53, 8192
s_add_u32 s52, s52, s53
s_mul_i32 s78, s66, 303104
s_add_u32 s78, s78, s52
s_mul_i32 s79, s67, 303104
s_add_u32 s79, s79, s52
s_mov_b32 s76, 0
v_mov_b32 v7, 0x5d800000
s_mov_b32 s69, 64
v_accvgpr_read_b32 v180, a224
v_accvgpr_read_b32 v182, a228
v_cmp_nle_f32 vcc, v180, v7
v_cmp_nle_f32 s[96:97], v182, v7
s_nop 3
s_or_b64 vcc, vcc, s[96:97]
s_cbranch_vccnz L_NS
s_add_u32 s53, s77, 180224
buffer_load_dwordx4 a[112:115], v4, s[24:27], s53 offen offset:0 sc1
v_mul_f32 v8, 0x3fb8aa3b, v8
v_mul_f32 v9, 0x3fb8aa3b, v9
v_exp_f32 v8, v8
v_exp_f32 v9, v9
s_nop 0
v_fma_f32 v180, v180, v8, v180
v_fma_f32 v182, v182, v9, v182
v_rcp_f32 v180, v180
v_rcp_f32 v182, v182
s_add_u32 s52, s78, 4096
v_mov_b32 v181, v180
v_mov_b32 v183, v182
v_pk_mul_f32 v[36:37], v[36:37], v[180:181]
v_pk_mul_f32 v[38:39], v[38:39], v[180:181]
v_pk_mul_f32 v[32:33], v[32:33], v[180:181]
v_pk_mul_f32 v[34:35], v[34:35], v[180:181]
v_cvt_pk_bf16_f32 v36, v36, v37
v_cvt_pk_bf16_f32 v37, v38, v39
v_cvt_pk_bf16_f32 v38, v32, v33
v_cvt_pk_bf16_f32 v39, v34, v35
buffer_store_dwordx4 v[36:39], v4, s[24:27], s78 offen offset:0 sc1
buffer_load_dwordx4 a[116:119], v4, s[24:27], s53 offen offset:1024 sc1
v_pk_mul_f32 v[116:117], v[116:117], v[182:183]
v_pk_mul_f32 v[118:119], v[118:119], v[182:183]
v_pk_mul_f32 v[132:133], v[132:133], v[182:183]
v_pk_mul_f32 v[134:135], v[134:135], v[182:183]
v_cvt_pk_bf16_f32 v116, v116, v117
v_cvt_pk_bf16_f32 v117, v118, v119
v_cvt_pk_bf16_f32 v118, v132, v133
v_cvt_pk_bf16_f32 v119, v134, v135
buffer_store_dwordx4 v[116:119], v4, s[24:27], s78 offen offset:1024 sc1
v_pk_mul_f32 v[196:197], v[196:197], v[180:181]
v_pk_mul_f32 v[198:199], v[198:199], v[180:181]
v_pk_mul_f32 v[204:205], v[204:205], v[180:181]
v_pk_mul_f32 v[206:207], v[206:207], v[180:181]
v_cvt_pk_bf16_f32 v196, v196, v197
v_cvt_pk_bf16_f32 v197, v198, v199
v_cvt_pk_bf16_f32 v198, v204, v205
v_cvt_pk_bf16_f32 v199, v206, v207
buffer_store_dwordx4 v[196:199], v4, s[24:27], s78 offen offset:2048 sc1
v_pk_mul_f32 v[184:185], v[184:185], v[182:183]
v_pk_mul_f32 v[186:187], v[186:187], v[182:183]
v_pk_mul_f32 v[240:241], v[240:241], v[182:183]
buffer_load_dwordx4 a[120:123], v4, s[24:27], s53 offen offset:2048 sc1
v_pk_mul_f32 v[242:243], v[242:243], v[182:183]
v_cvt_pk_bf16_f32 v184, v184, v185
v_cvt_pk_bf16_f32 v185, v186, v187
v_cvt_pk_bf16_f32 v186, v240, v241
v_cvt_pk_bf16_f32 v187, v242, v243
buffer_store_dwordx4 v[184:187], v4, s[24:27], s78 offen offset:3072 sc1
v_pk_mul_f32 v[108:109], v[108:109], v[180:181]
v_pk_mul_f32 v[110:111], v[110:111], v[180:181]
v_pk_mul_f32 v[40:41], v[40:41], v[180:181]
v_pk_mul_f32 v[42:43], v[42:43], v[180:181]
v_cvt_pk_bf16_f32 v108, v108, v109
v_cvt_pk_bf16_f32 v109, v110, v111
v_cvt_pk_bf16_f32 v110, v40, v41
v_cvt_pk_bf16_f32 v111, v42, v43
buffer_store_dwordx4 v[108:111], v4, s[24:27], s52 offen offset:0 sc1
v_pk_mul_f32 v[188:189], v[188:189], v[182:183]
v_pk_mul_f32 v[190:191], v[190:191], v[182:183]
v_pk_mul_f32 v[56:57], v[56:57], v[182:183]
v_pk_mul_f32 v[58:59], v[58:59], v[182:183]
v_cvt_pk_bf16_f32 v188, v188, v189
v_cvt_pk_bf16_f32 v189, v190, v191
buffer_load_dwordx4 a[124:127], v4, s[24:27], s53 offen offset:3072 sc1
v_cvt_pk_bf16_f32 v190, v56, v57
v_cvt_pk_bf16_f32 v191, v58, v59
buffer_store_dwordx4 v[188:191], v4, s[24:27], s52 offen offset:1024 sc1
v_pk_mul_f32 v[80:81], v[80:81], v[180:181]
v_pk_mul_f32 v[82:83], v[82:83], v[180:181]
v_pk_mul_f32 v[168:169], v[168:169], v[180:181]
v_pk_mul_f32 v[170:171], v[170:171], v[180:181]
v_cvt_pk_bf16_f32 v80, v80, v81
v_cvt_pk_bf16_f32 v81, v82, v83
v_cvt_pk_bf16_f32 v82, v168, v169
v_cvt_pk_bf16_f32 v83, v170, v171
buffer_store_dwordx4 v[80:83], v4, s[24:27], s52 offen offset:2048 sc1
v_pk_mul_f32 v[88:89], v[88:89], v[182:183]
v_pk_mul_f32 v[90:91], v[90:91], v[182:183]
v_pk_mul_f32 v[192:193], v[192:193], v[182:183]
v_pk_mul_f32 v[194:195], v[194:195], v[182:183]
v_cvt_pk_bf16_f32 v88, v88, v89
v_cvt_pk_bf16_f32 v89, v90, v91
v_cvt_pk_bf16_f32 v90, v192, v193
v_cvt_pk_bf16_f32 v91, v194, v195
buffer_store_dwordx4 v[88:91], v4, s[24:27], s52 offen offset:3072 sc1
L_PAD9:
s_cbranch_execz L_PAD13
s_mov_b32 s76, 1
L_NS:
s_mov_b32 s74, s73
s_mov_b32 s93, s73
s_cmp_eq_u32 s72, 32
s_cbranch_scc1 L_FIN
L_SINGLE:
v_mfma_f32_16x16x32_bf16 v[44:47], a[192:195], a[48:51], v[128:131]
s_barrier
v_mfma_f32_16x16x32_bf16 v[44:47], a[196:199], a[52:55], v[44:47]
s_cmp_eq_u32 s68, s71
v_exp_f32 v229, v229
v_mfma_f32_16x16x32_bf16 v[44:47], a[200:203], a[0:3], v[44:47]
s_cselect_b32 s64, s77, s68
v_add_u32 v5, s75, v4
v_cvt_pk_bf16_f32 v234, v228, v229
v_mfma_f32_16x16x32_bf16 v[44:47], a[204:207], a[8:11], v[44:47]
s_mov_b32 m0, s70
v_exp_f32 v230, v230
v_mfma_f32_16x16x32_bf16 v[52:55], a[192:195], a[60:63], v[136:139]
buffer_load_dwordx4 v4, s[24:27], s64 offen offset:0 sc1 lds
v_mfma_f32_16x16x32_bf16 v[52:55], a[196:199], a[56:59], v[52:55]
s_add_u32 s75, s75, 16384
v_exp_f32 v231, v231
v_mfma_f32_16x16x32_bf16 v[52:55], a[200:203], a[16:19], v[52:55]
ds_read_b128 a[192:195], v5 offset:0
v_cvt_pk_bf16_f32 v235, v230, v231
v_mfma_f32_16x16x32_bf16 v[52:55], a[204:207], a[24:27], v[52:55]
s_cmp_ge_u32 s75, 163840
v_exp_f32 v44, v44
v_mfma_f32_16x16x32_bf16 v[64:67], a[208:211], a[48:51], v[144:147]
ds_read_b128 a[196:199], v5 offset:1024
ds_read_b128 a[200:203], v5 offset:2048
v_mfma_f32_16x16x32_bf16 v[64:67], a[212:215], a[52:55], v[64:67]
s_cselect_b32 s75, 0, s75
v_exp_f32 v45, v45
v_mfma_f32_16x16x32_bf16 v[64:67], a[216:219], a[0:3], v[64:67]
ds_read_b128 a[204:207], v5 offset:3072
v_cvt_pk_bf16_f32 v124, v44, v45
v_mfma_f32_16x16x32_bf16 v[64:67], a[220:223], a[8:11], v[64:67]
s_add_u32 s68, s64, 16384
v_exp_f32 v46, v46
v_mfma_f32_16x16x32_bf16 v[212:215], a[208:211], a[60:63], v[152:155]
buffer_load_dwordx4 v4, s[24:27], s64 offen offset:1024 sc1 lds
v_mfma_f32_16x16x32_bf16 v[212:215], a[212:215], a[56:59], v[212:215]
s_add_u32 s70, s70, 16384
v_exp_f32 v47, v47
v_mfma_f32_16x16x32_bf16 v[212:215], a[216:219], a[16:19], v[212:215]
ds_read_b128 a[208:211], v5 offset:4096
v_cvt_pk_bf16_f32 v125, v46, v47
v_mfma_f32_16x16x32_bf16 v[212:215], a[220:223], a[24:27], v[212:215]
s_waitcnt lgkmcnt(5)
v_exp_f32 v52, v52
v_mfma_f32_16x16x32_bf16 v[60:63], a[64:67], v[248:251], v[60:63]
ds_read_b128 a[212:215], v5 offset:5120
ds_read_b128 a[216:219], v5 offset:6144
v_mfma_f32_16x16x32_bf16 v[148:151], a[64:67], v[232:235], v[148:151]
s_cmp_ge_u32 s70, 163840
v_exp_f32 v53, v53
v_mfma_f32_16x16x32_bf16 v[48:51], a[68:71], v[232:235], v[48:51]
ds_read_b128 a[220:223], v5 offset:7168
v_cvt_pk_bf16_f32 v140, v52, v53
v_mfma_f32_16x16x32_bf16 v[68:71], a[68:71], v[248:251], v[68:71]
s_cselect_b32 s70, s80, s70
v_exp_f32 v54, v54
v_mfma_f32_16x16x32_bf16 v[72:75], a[72:75], v[248:251], v[72:75]
buffer_load_dwordx4 v4, s[24:27], s64 offen offset:2048 sc1 lds
v_mfma_f32_16x16x32_bf16 v[236:239], a[72:75], v[232:235], v[236:239]
v_exp_f32 v55, v55
v_mfma_f32_16x16x32_bf16 v[224:227], a[76:79], v[232:235], v[224:227]
ds_read_b128 a[64:67], v5 offset:8192
v_cvt_pk_bf16_f32 v141, v54, v55
v_mfma_f32_16x16x32_bf16 v[220:223], a[76:79], v[248:251], v[220:223]
v_exp_f32 v64, v64
v_mfma_f32_16x16x32_bf16 v[84:87], a[80:83], v[248:251], v[84:87]
ds_read_b128 a[68:71], v5 offset:9216
ds_read_b128 a[72:75], v5 offset:10240
v_mfma_f32_16x16x32_bf16 v[164:167], a[80:83], v[232:235], v[164:167]
v_exp_f32 v65, v65
v_mfma_f32_16x16x32_bf16 v[156:159], a[84:87], v[232:235], v[156:159]
ds_read_b128 a[76:79], v5 offset:11264
v_cvt_pk_bf16_f32 v126, v64, v65
v_mfma_f32_16x16x32_bf16 v[76:79], a[84:87], v[248:251], v[76:79]
s_cmp_eq_u32 s68, s71
v_exp_f32 v66, v66
v_mfma_f32_16x16x32_bf16 v[160:163], a[88:91], v[248:251], v[160:163]
buffer_load_dwordx4 v4, s[24:27], s64 offen offset:3072 sc1 lds
v_mfma_f32_16x16x32_bf16 v[216:219], a[88:91], v[232:235], v[216:219]
s_cselect_b32 s64, s77, s68
v_exp_f32 v67, v67
v_mfma_f32_16x16x32_bf16 v[208:211], a[92:95], v[232:235], v[208:211]
ds_read_b128 a[80:83], v5 offset:12288
v_cvt_pk_bf16_f32 v127, v66, v67
v_mfma_f32_16x16x32_bf16 v[252:255], a[92:95], v[248:251], v[252:255]
s_waitcnt lgkmcnt(5)
v_exp_f32 v212, v212
v_mfma_f32_16x16x32_bf16 a[232:235], a[240:243], v[248:251], a[232:235]
ds_read_b128 a[84:87], v5 offset:13312
ds_read_b128 a[88:91], v5 offset:14336
v_mfma_f32_16x16x32_bf16 a[236:239], a[240:243], v[232:235], a[236:239]
s_mov_b32 m0, s70
ds_read_b128 a[92:95], v5 offset:15360
v_mfma_f32_16x16x32_bf16 v[100:103], a[192:195], a[48:51], v[128:131]
buffer_load_dwordx4 v4, s[24:27], s64 offen offset:0 sc1 lds
v_mfma_f32_16x16x32_bf16 v[100:103], a[196:199], a[52:55], v[100:103]
v_exp_f32 v213, v213
v_mfma_f32_16x16x32_bf16 v[100:103], a[200:203], a[0:3], v[100:103]
v_add_u32 v5, s75, v4
v_cvt_pk_bf16_f32 v142, v212, v213
v_mfma_f32_16x16x32_bf16 v[100:103], a[204:207], a[8:11], v[100:103]
v_exp_f32 v214, v214
v_mfma_f32_16x16x32_bf16 v[92:95], a[192:195], a[60:63], v[136:139]
buffer_load_dwordx4 v4, s[24:27], s64 offen offset:1024 sc1 lds
v_mfma_f32_16x16x32_bf16 v[92:95], a[196:199], a[56:59], v[92:95]
s_add_u32 s75, s75, 16384
v_exp_f32 v215, v215
v_mfma_f32_16x16x32_bf16 v[92:95], a[200:203], a[16:19], v[92:95]
ds_read_b128 a[192:195], v5 offset:0
v_cvt_pk_bf16_f32 v143, v214, v215
v_mfma_f32_16x16x32_bf16 v[92:95], a[204:207], a[24:27], v[92:95]
s_cmp_ge_u32 s75, 163840
v_exp_f32 v100, v100
v_mfma_f32_16x16x32_bf16 v[176:179], a[208:211], a[48:51], v[144:147]
ds_read_b128 a[196:199], v5 offset:1024
ds_read_b128 a[200:203], v5 offset:2048
v_mfma_f32_16x16x32_bf16 v[176:179], a[212:215], a[52:55], v[176:179]
s_cselect_b32 s75, 0, s75
v_exp_f32 v101, v101
v_mfma_f32_16x16x32_bf16 v[176:179], a[216:219], a[0:3], v[176:179]
ds_read_b128 a[204:207], v5 offset:3072
v_cvt_pk_bf16_f32 v248, v100, v101
v_mfma_f32_16x16x32_bf16 v[176:179], a[220:223], a[8:11], v[176:179]
s_add_u32 s68, s64, 16384
v_exp_f32 v102, v102
v_mfma_f32_16x16x32_bf16 v[228:231], a[208:211], a[60:63], v[152:155]
buffer_load_dwordx4 v4, s[24:27], s64 offen offset:2048 sc1 lds
v_mfma_f32_16x16x32_bf16 v[228:231], a[212:215], a[56:59], v[228:231]
s_add_u32 s70, s70, 16384
v_exp_f32 v103, v103
v_mfma_f32_16x16x32_bf16 v[228:231], a[216:219], a[16:19], v[228:231]
ds_read_b128 a[208:211], v5 offset:4096
v_cvt_pk_bf16_f32 v249, v102, v103
v_mfma_f32_16x16x32_bf16 v[228:231], a[220:223], a[24:27], v[228:231]
s_waitcnt lgkmcnt(5)
v_exp_f32 v92, v92
v_mfma_f32_16x16x32_bf16 v[60:63], a[64:67], v[124:127], v[60:63]
ds_read_b128 a[212:215], v5 offset:5120
ds_read_b128 a[216:219], v5 offset:6144
v_mfma_f32_16x16x32_bf16 v[148:151], a[64:67], v[140:143], v[148:151]
s_cmp_ge_u32 s70, 163840
v_exp_f32 v93, v93
v_mfma_f32_16x16x32_bf16 v[48:51], a[68:71], v[140:143], v[48:51]
ds_read_b128 a[220:223], v5 offset:7168
v_cvt_pk_bf16_f32 v232, v92, v93
v_mfma_f32_16x16x32_bf16 v[68:71], a[68:71], v[124:127], v[68:71]
s_cselect_b32 s70, s80, s70
v_exp_f32 v94, v94
v_mfma_f32_16x16x32_bf16 v[72:75], a[72:75], v[124:127], v[72:75]
buffer_load_dwordx4 v4, s[24:27], s64 offen offset:3072 sc1 lds
v_mfma_f32_16x16x32_bf16 v[236:239], a[72:75], v[140:143], v[236:239]
s_add_u32 s72, s72, 1
v_exp_f32 v95, v95
v_mfma_f32_16x16x32_bf16 v[224:227], a[76:79], v[140:143], v[224:227]
ds_read_b128 a[64:67], v5 offset:8192
v_cvt_pk_bf16_f32 v233, v94, v95
v_mfma_f32_16x16x32_bf16 v[220:223], a[76:79], v[124:127], v[220:223]
v_exp_f32 v176, v176
v_mfma_f32_16x16x32_bf16 v[84:87], a[80:83], v[124:127], v[84:87]
ds_read_b128 a[68:71], v5 offset:9216
ds_read_b128 a[72:75], v5 offset:10240
v_mfma_f32_16x16x32_bf16 v[164:167], a[80:83], v[140:143], v[164:167]
v_exp_f32 v177, v177
v_mfma_f32_16x16x32_bf16 v[156:159], a[84:87], v[140:143], v[156:159]
ds_read_b128 a[76:79], v5 offset:11264
v_cvt_pk_bf16_f32 v250, v176, v177
v_mfma_f32_16x16x32_bf16 v[76:79], a[84:87], v[124:127], v[76:79]
v_exp_f32 v178, v178
v_mfma_f32_16x16x32_bf16 v[160:163], a[88:91], v[124:127], v[160:163]
ds_read_b128 a[80:83], v5 offset:12288
ds_read_b128 a[84:87], v5 offset:13312
v_mfma_f32_16x16x32_bf16 v[216:219], a[88:91], v[140:143], v[216:219]
s_cmp_lt_u32 s72, s74
v_exp_f32 v179, v179
v_mfma_f32_16x16x32_bf16 v[208:211], a[92:95], v[140:143], v[208:211]
ds_read_b128 a[88:91], v5 offset:14336
v_cvt_pk_bf16_f32 v251, v178, v179
v_mfma_f32_16x16x32_bf16 v[252:255], a[92:95], v[124:127], v[252:255]
s_waitcnt vmcnt(8) lgkmcnt(7)
v_exp_f32 v228, v228
v_mfma_f32_16x16x32_bf16 a[232:235], a[240:243], v[124:127], a[232:235]
ds_read_b128 a[92:95], v5 offset:15360
v_mfma_f32_16x16x32_bf16 a[236:239], a[240:243], v[140:143], a[236:239]
s_cbranch_scc1 L_SINGLE
s_cmp_eq_u32 s72, s69
s_cbranch_scc1 L_SE
s_cmp_lt_u32 s72, 32
s_cbranch_scc1 L_STOP
L_FIN:
s_add_u32 s53, s77, 196608
buffer_load_dwordx4 a[128:131], v4, s[24:27], s53 offen offset:0 sc1
v_cndmask_b32 v128, v128, v6, s[56:57]
v_cndmask_b32 v152, v152, v6, s[56:57]
v_mov_b32 v144, v6
buffer_load_dwordx4 a[132:135], v4, s[24:27], s53 offen offset:1024 sc1
v_cndmask_b32 v129, v129, v6, s[58:59]
v_cndmask_b32 v153, v153, v6, s[58:59]
v_mov_b32 v145, v6
buffer_load_dwordx4 a[136:139], v4, s[24:27], s53 offen offset:2048 sc1
v_cndmask_b32 v130, v130, v6, s[60:61]
v_cndmask_b32 v154, v154, v6, s[60:61]
v_mov_b32 v146, v6
buffer_load_dwordx4 a[140:143], v4, s[24:27], s53 offen offset:3072 sc1
v_cndmask_b32 v131, v131, v6, s[62:63]
v_cndmask_b32 v155, v155, v6, s[62:63]
v_mov_b32 v147, v6
s_sub_u32 s91, s70, s80
s_mov_b32 s83, s75
s_lshl_b32 s53, s4, 18
s_add_u32 s53, s53, 45088768
s_lshl_b32 s54, s66, 9
s_add_u32 s54, s54, s53
s_lshl_b32 s55, s67, 9
s_add_u32 s55, s55, s53
v_mfma_f32_16x16x32_bf16 v[44:47], a[192:195], a[48:51], v[128:131]
s_barrier
v_mfma_f32_16x16x32_bf16 v[44:47], a[196:199], a[52:55], v[44:47]
s_add_u32 m0, s83, 0
v_exp_f32 v229, v229
v_mfma_f32_16x16x32_bf16 v[44:47], a[200:203], a[0:3], v[44:47]
s_add_u32 s64, s54, 65280
v_add_u32 v5, s75, v4
v_cvt_pk_bf16_f32 v234, v228, v229
v_mfma_f32_16x16x32_bf16 v[44:47], a[204:207], a[8:11], v[44:47]
v_exp_f32 v230, v230
v_mfma_f32_16x16x32_bf16 v[52:55], a[192:195], a[60:63], v[136:139]
s_mov_b32 exec_hi, 0xffff
buffer_load_dwordx4 v4, s[24:27], s64 offen sc1 lds
s_mov_b32 exec_hi, -1
v_mfma_f32_16x16x32_bf16 v[52:55], a[196:199], a[56:59], v[52:55]
s_add_u32 m0, s83, 768
v_exp_f32 v231, v231
v_mfma_f32_16x16x32_bf16 v[52:55], a[200:203], a[16:19], v[52:55]
s_add_u32 s64, s54, 98048
v_cvt_pk_bf16_f32 v235, v230, v231
v_mfma_f32_16x16x32_bf16 v[52:55], a[204:207], a[24:27], v[52:55]
v_exp_f32 v44, v44
v_mfma_f32_16x16x32_bf16 v[64:67], a[208:211], a[48:51], v[144:147]
s_mov_b32 exec_hi, 0xffff
buffer_load_dwordx4 v4, s[24:27], s64 offen sc1 lds
s_mov_b32 exec_hi, -1
v_mfma_f32_16x16x32_bf16 v[64:67], a[212:215], a[52:55], v[64:67]
s_add_u32 m0, s83, 1536
v_exp_f32 v45, v45
v_mfma_f32_16x16x32_bf16 v[64:67], a[216:219], a[0:3], v[64:67]
s_add_u32 s64, s54, 130816
v_cvt_pk_bf16_f32 v124, v44, v45
v_mfma_f32_16x16x32_bf16 v[64:67], a[220:223], a[8:11], v[64:67]
v_exp_f32 v46, v46
v_mfma_f32_16x16x32_bf16 v[212:215], a[208:211], a[60:63], v[152:155]
s_mov_b32 exec_hi, 0xffff
buffer_load_dwordx4 v4, s[24:27], s64 offen sc1 lds
s_mov_b32 exec_hi, -1
v_mfma_f32_16x16x32_bf16 v[212:215], a[212:215], a[56:59], v[212:215]
s_add_u32 m0, s83, 2304
v_exp_f32 v47, v47
v_mfma_f32_16x16x32_bf16 v[212:215], a[216:219], a[16:19], v[212:215]
s_add_u32 s64, s54, 163584
v_cvt_pk_bf16_f32 v125, v46, v47
v_mfma_f32_16x16x32_bf16 v[212:215], a[220:223], a[24:27], v[212:215]
s_waitcnt lgkmcnt(0)
v_exp_f32 v52, v52
v_mfma_f32_16x16x32_bf16 v[60:63], a[64:67], v[248:251], v[60:63]
s_mov_b32 exec_hi, 0xffff
buffer_load_dwordx4 v4, s[24:27], s64 offen sc1 lds
s_mov_b32 exec_hi, -1
v_mfma_f32_16x16x32_bf16 v[148:151], a[64:67], v[232:235], v[148:151]
s_add_u32 m0, s83, 3072
v_exp_f32 v53, v53
v_mfma_f32_16x16x32_bf16 v[48:51], a[68:71], v[232:235], v[48:51]
s_add_u32 s64, s54, 196352
ds_read_b128 a[64:67], v5 offset:8192
v_cvt_pk_bf16_f32 v140, v52, v53
v_mfma_f32_16x16x32_bf16 v[68:71], a[68:71], v[248:251], v[68:71]
v_exp_f32 v54, v54
v_mfma_f32_16x16x32_bf16 v[72:75], a[72:75], v[248:251], v[72:75]
s_mov_b32 exec_hi, 0xffff
buffer_load_dwordx4 v4, s[24:27], s64 offen sc1 lds
s_mov_b32 exec_hi, -1
v_mfma_f32_16x16x32_bf16 v[236:239], a[72:75], v[232:235], v[236:239]
v_exp_f32 v55, v55
v_mfma_f32_16x16x32_bf16 v[224:227], a[76:79], v[232:235], v[224:227]
ds_read_b128 a[68:71], v5 offset:9216
v_cvt_pk_bf16_f32 v141, v54, v55
v_mfma_f32_16x16x32_bf16 v[220:223], a[76:79], v[248:251], v[220:223]
v_exp_f32 v64, v64
v_mfma_f32_16x16x32_bf16 v[84:87], a[80:83], v[248:251], v[84:87]
ds_read_b128 a[72:75], v5 offset:10240
v_mfma_f32_16x16x32_bf16 v[164:167], a[80:83], v[232:235], v[164:167]
s_add_u32 m0, s83, 3840
v_exp_f32 v65, v65
v_mfma_f32_16x16x32_bf16 v[156:159], a[84:87], v[232:235], v[156:159]
s_add_u32 s64, s55, 65280
ds_read_b128 a[76:79], v5 offset:11264
v_cvt_pk_bf16_f32 v126, v64, v65
v_mfma_f32_16x16x32_bf16 v[76:79], a[84:87], v[248:251], v[76:79]
v_exp_f32 v66, v66
v_mfma_f32_16x16x32_bf16 v[160:163], a[88:91], v[248:251], v[160:163]
s_mov_b32 exec_hi, 0xffff
buffer_load_dwordx4 v4, s[24:27], s64 offen sc1 lds
s_mov_b32 exec_hi, -1
v_mfma_f32_16x16x32_bf16 v[216:219], a[88:91], v[232:235], v[216:219]
v_exp_f32 v67, v67
v_mfma_f32_16x16x32_bf16 v[208:211], a[92:95], v[232:235], v[208:211]
ds_read_b128 a[80:83], v5 offset:12288
v_cvt_pk_bf16_f32 v127, v66, v67
v_mfma_f32_16x16x32_bf16 v[252:255], a[92:95], v[248:251], v[252:255]
v_exp_f32 v212, v212
v_mfma_f32_16x16x32_bf16 a[232:235], a[240:243], v[248:251], a[232:235]
ds_read_b128 a[84:87], v5 offset:13312
ds_read_b128 a[88:91], v5 offset:14336
v_mfma_f32_16x16x32_bf16 a[236:239], a[240:243], v[232:235], a[236:239]
ds_read_b128 a[92:95], v5 offset:15360
v_exp_f32 v213, v213
v_exp_f32 v214, v214
v_exp_f32 v215, v215
v_cmp_lt_u32 vcc, 31, v1
v_cvt_pk_bf16_f32 v142, v212, v213
v_cvt_pk_bf16_f32 v143, v214, v215
s_waitcnt lgkmcnt(0)
s_add_u32 m0, s83, 4608
v_mfma_f32_16x16x32_bf16 v[60:63], a[64:67], v[124:127], v[60:63]
s_add_u32 s64, s55, 98048
v_and_b32 v202, 31, v1
v_mov_b32 v200, s66
v_mfma_f32_16x16x32_bf16 v[148:151], a[64:67], v[140:143], v[148:151]
s_mov_b32 exec_hi, 0xffff
buffer_load_dwordx4 v4, s[24:27], s64 offen sc1 lds
s_mov_b32 exec_hi, -1
v_mfma_f32_16x16x32_bf16 v[48:51], a[68:71], v[140:143], v[48:51]
v_mov_b32 v203, s67
v_cndmask_b32 v200, v200, v203, vcc
v_mfma_f32_16x16x32_bf16 v[68:71], a[68:71], v[124:127], v[68:71]
s_add_u32 m0, s83, 5376
s_add_u32 s64, s55, 130816
v_lshl_add_u32 v200, v200, 5, v202
v_mfma_f32_16x16x32_bf16 v[72:75], a[72:75], v[124:127], v[72:75]
s_mov_b32 exec_hi, 0xffff
buffer_load_dwordx4 v4, s[24:27], s64 offen sc1 lds
s_mov_b32 exec_hi, -1
v_mfma_f32_16x16x32_bf16 v[236:239], a[72:75], v[140:143], v[236:239]
v_lshlrev_b32 v203, 4, v200
v_lshrrev_b32 v201, 5, v1
v_mfma_f32_16x16x32_bf16 v[224:227], a[76:79], v[140:143], v[224:227]
s_add_u32 m0, s83, 6144
s_add_u32 s64, s55, 163584
v_mul_u32_u24 v201, 3840, v201
v_mfma_f32_16x16x32_bf16 v[220:223], a[76:79], v[124:127], v[220:223]
s_mov_b32 exec_hi, 0xffff
buffer_load_dwordx4 v4, s[24:27], s64 offen sc1 lds
s_mov_b32 exec_hi, -1
v_mfma_f32_16x16x32_bf16 v[84:87], a[80:83], v[124:127], v[84:87]
v_lshl_add_u32 v201, v202, 4, v201
v_add_u32 v201, s83, v201
v_mfma_f32_16x16x32_bf16 v[164:167], a[80:83], v[140:143], v[164:167]
s_add_u32 m0, s83, 6912
s_add_u32 s64, s55, 196352
v_mfma_f32_16x16x32_bf16 v[156:159], a[84:87], v[140:143], v[156:159]
s_mov_b32 exec_hi, 0xffff
buffer_load_dwordx4 v4, s[24:27], s64 offen sc1 lds
s_mov_b32 exec_hi, -1
v_mfma_f32_16x16x32_bf16 v[76:79], a[84:87], v[124:127], v[76:79]
v_mfma_f32_16x16x32_bf16 v[160:163], a[88:91], v[124:127], v[160:163]
buffer_load_dwordx4 v[96:99], v203, s[24:27], s53 offen sc1
v_mfma_f32_16x16x32_bf16 v[216:219], a[88:91], v[140:143], v[216:219]
s_add_u32 s53, s53, 32768
s_lshl_b32 s74, s66, 10
s_lshr_b32 s52, s4, 3
v_mfma_f32_16x16x32_bf16 v[208:211], a[92:95], v[140:143], v[208:211]
buffer_load_dwordx4 v[104:107], v203, s[24:27], s53 offen sc1
v_mfma_f32_16x16x32_bf16 v[252:255], a[92:95], v[124:127], v[252:255]
s_lshl_b32 s52, s52, 7
s_add_u32 s74, s74, s52
s_add_u32 s74, s74, 75497472
v_mfma_f32_16x16x32_bf16 a[232:235], a[240:243], v[124:127], a[232:235]
v_mfma_f32_16x16x32_bf16 a[236:239], a[240:243], v[140:143], a[236:239]
s_lshr_b32 s52, s3, 1
s_lshl1_add_u32 s72, s85, s52
s_lshl3_add_u32 s75, s72, s84
s_lshl_b32 s75, s75, 7
s_add_u32 s75, s75, 75497472
s_and_b32 s82, s86, 1
s_lshl_b32 s82, s82, 13
v_mov_b32 v13, 0
s_nop 0
v_accvgpr_read_b32 v180, a232
v_accvgpr_read_b32 v182, a236
v_cmp_nle_f32 vcc, v180, v7
v_cmp_nle_f32 s[96:97], v182, v7
s_nop 3
s_or_b64 vcc, vcc, s[96:97]
s_cbranch_vccnz SLOW1
SLOW1_R:
s_mov_b32 m0, s70
s_mov_b32 s64, s68
s_add_u32 s68, s68, 16384
s_add_u32 s70, s70, 16384
s_cmp_ge_u32 s70, 163840
s_cselect_b32 s70, s80, s70
buffer_load_dwordx4 v4, s[24:27], s64 offen offset:0 sc1 lds
v_mul_f32 v10, 0x3fb8aa3b, v10
v_mul_f32 v11, 0x3fb8aa3b, v11
v_exp_f32 v10, v10
v_exp_f32 v11, v11
s_nop 0
v_fma_f32 v180, v180, v10, v180
v_fma_f32 v182, v182, v11, v182
v_rcp_f32 v180, v180
v_rcp_f32 v182, v182
buffer_load_dwordx4 v4, s[24:27], s64 offen offset:1024 sc1 lds
s_add_u32 s52, s79, 4096
v_mov_b32 v181, v180
v_mov_b32 v183, v182
v_pk_mul_f32 v[60:61], v[60:61], v[180:181]
v_pk_mul_f32 v[62:63], v[62:63], v[180:181]
v_pk_mul_f32 v[68:69], v[68:69], v[180:181]
v_pk_mul_f32 v[70:71], v[70:71], v[180:181]
v_cvt_pk_bf16_f32 v60, v60, v61
v_cvt_pk_bf16_f32 v61, v62, v63
buffer_load_dwordx4 v4, s[24:27], s64 offen offset:2048 sc1 lds
v_cvt_pk_bf16_f32 v62, v68, v69
v_cvt_pk_bf16_f32 v63, v70, v71
buffer_store_dwordx4 v[60:63], v4, s[24:27], s79 offen offset:0 sc1
v_pk_mul_f32 v[148:149], v[148:149], v[182:183]
v_pk_mul_f32 v[150:151], v[150:151], v[182:183]
v_pk_mul_f32 v[48:49], v[48:49], v[182:183]
v_pk_mul_f32 v[50:51], v[50:51], v[182:183]
v_cvt_pk_bf16_f32 v148, v148, v149
v_cvt_pk_bf16_f32 v149, v150, v151
buffer_load_dwordx4 v4, s[24:27], s64 offen offset:3072 sc1 lds
v_cvt_pk_bf16_f32 v150, v48, v49
v_cvt_pk_bf16_f32 v151, v50, v51
buffer_store_dwordx4 v[148:151], v4, s[24:27], s79 offen offset:1024 sc1
v_pk_mul_f32 v[72:73], v[72:73], v[180:181]
v_pk_mul_f32 v[74:75], v[74:75], v[180:181]
v_pk_mul_f32 v[220:221], v[220:221], v[180:181]
v_pk_mul_f32 v[222:223], v[222:223], v[180:181]
v_cvt_pk_bf16_f32 v72, v72, v73
v_cvt_pk_bf16_f32 v73, v74, v75
s_mov_b32 m0, s70
s_mov_b32 s64, s68
s_add_u32 s68, s68, 16384
s_add_u32 s70, s70, 16384
s_cmp_ge_u32 s70, 163840
s_cselect_b32 s70, s80, s70
buffer_load_dwordx4 v4, s[24:27], s64 offen offset:0 sc1 lds
v_cvt_pk_bf16_f32 v74, v220, v221
v_cvt_pk_bf16_f32 v75, v222, v223
buffer_store_dwordx4 v[72:75], v4, s[24:27], s79 offen offset:2048 sc1
v_pk_mul_f32 v[236:237], v[236:237], v[182:183]
v_pk_mul_f32 v[238:239], v[238:239], v[182:183]
v_pk_mul_f32 v[224:225], v[224:225], v[182:183]
v_pk_mul_f32 v[226:227], v[226:227], v[182:183]
v_cvt_pk_bf16_f32 v236, v236, v237
v_cvt_pk_bf16_f32 v237, v238, v239
buffer_load_dwordx4 v4, s[24:27], s64 offen offset:1024 sc1 lds
v_cvt_pk_bf16_f32 v238, v224, v225
v_cvt_pk_bf16_f32 v239, v226, v227
buffer_store_dwordx4 v[236:239], v4, s[24:27], s79 offen offset:3072 sc1
v_pk_mul_f32 v[84:85], v[84:85], v[180:181]
v_pk_mul_f32 v[86:87], v[86:87], v[180:181]
v_pk_mul_f32 v[76:77], v[76:77], v[180:181]
v_pk_mul_f32 v[78:79], v[78:79], v[180:181]
v_cvt_pk_bf16_f32 v84, v84, v85
v_cvt_pk_bf16_f32 v85, v86, v87
buffer_load_dwordx4 v4, s[24:27], s64 offen offset:2048 sc1 lds
v_cvt_pk_bf16_f32 v86, v76, v77
v_cvt_pk_bf16_f32 v87, v78, v79
buffer_store_dwordx4 v[84:87], v4, s[24:27], s52 offen offset:0 sc1
v_pk_mul_f32 v[164:165], v[164:165], v[182:183]
v_pk_mul_f32 v[166:167], v[166:167], v[182:183]
v_pk_mul_f32 v[156:157], v[156:157], v[182:183]
v_pk_mul_f32 v[158:159], v[158:159], v[182:183]
v_cvt_pk_bf16_f32 v164, v164, v165
v_cvt_pk_bf16_f32 v165, v166, v167
buffer_load_dwordx4 v4, s[24:27], s64 offen offset:3072 sc1 lds
v_cvt_pk_bf16_f32 v166, v156, v157
v_cvt_pk_bf16_f32 v167, v158, v159
buffer_store_dwordx4 v[164:167], v4, s[24:27], s52 offen offset:1024 sc1
v_pk_mul_f32 v[160:161], v[160:161], v[180:181]
v_pk_mul_f32 v[162:163], v[162:163], v[180:181]
v_pk_mul_f32 v[252:253], v[252:253], v[180:181]
v_pk_mul_f32 v[254:255], v[254:255], v[180:181]
v_cvt_pk_bf16_f32 v160, v160, v161
v_cvt_pk_bf16_f32 v161, v162, v163
v_cvt_pk_bf16_f32 v162, v252, v253
v_cvt_pk_bf16_f32 v163, v254, v255
buffer_store_dwordx4 v[160:163], v4, s[24:27], s52 offen offset:2048 sc1
v_pk_mul_f32 v[216:217], v[216:217], v[182:183]
v_pk_mul_f32 v[218:219], v[218:219], v[182:183]
v_pk_mul_f32 v[208:209], v[208:209], v[182:183]
v_pk_mul_f32 v[210:211], v[210:211], v[182:183]
v_cvt_pk_bf16_f32 v216, v216, v217
v_cvt_pk_bf16_f32 v217, v218, v219
v_cvt_pk_bf16_f32 v218, v208, v209
v_cvt_pk_bf16_f32 v219, v210, v211
buffer_store_dwordx4 v[216:219], v4, s[24:27], s52 offen offset:3072 sc1
s_cmp_eq_u32 s76, 0
s_cbranch_scc1 L_SE2
L_LA:
v_mov_b32 v5, v200
v_mov_b32 v6, v201
s_waitcnt vmcnt(16)
v_mov_b32 v16, v96
v_mov_b32 v17, v97
v_mov_b32 v18, v98
v_mov_b32 v19, v99
v_mov_b32 v20, v104
v_mov_b32 v21, v105
v_mov_b32 v22, v106
v_mov_b32 v23, v107
ds_read_b128 v[96:99], v6 offset:3328
ds_read_b128 v[32:35], v6 offset:256
ds_read_b128 v[36:39], v6 offset:1024
ds_read_b128 v[100:103], v6 offset:3296
ds_read_b128 v[40:43], v6 offset:224
ds_read_b128 v[44:47], v6 offset:992
ds_read_b128 v[104:107], v6 offset:3264
ds_read_b128 v[48:51], v6 offset:192
ds_read_b128 v[52:55], v6 offset:960
ds_read_b128 v[108:111], v6 offset:3232
ds_read_b128 v[56:59], v6 offset:160
ds_read_b128 v[60:63], v6 offset:928
ds_read_b128 v[112:115], v6 offset:3200
ds_read_b128 v[64:67], v6 offset:128
ds_read_b128 v[68:71], v6 offset:896
ds_read_b128 v[116:119], v6 offset:3168
ds_read_b128 v[72:75], v6 offset:96
ds_read_b128 v[76:79], v6 offset:864
ds_read_b128 v[120:123], v6 offset:3136
ds_read_b128 v[80:83], v6 offset:64
ds_read_b128 v[84:87], v6 offset:832
ds_read_b128 v[124:127], v6 offset:3104
ds_read_b128 v[88:91], v6 offset:32
ds_read_b128 v[92:95], v6 offset:800
ds_read_b128 v[128:131], v6 offset:1792
ds_read_b128 v[132:135], v6 offset:2560
ds_read_b128 v[136:139], v6 offset:1760
ds_read_b128 v[140:143], v6 offset:2528
ds_read_b128 v[144:147], v6 offset:1728
ds_read_b128 v[148:151], v6 offset:2496
ds_read_b128 v[152:155], v6 offset:1696
ds_read_b128 v[156:159], v6 offset:2464
ds_read_b128 v[160:163], v6 offset:1664
ds_read_b128 v[164:167], v6 offset:2432
ds_read_b128 v[168:171], v6 offset:1632
ds_read_b128 v[172:175], v6 offset:2400
ds_read_b128 v[176:179], v6 offset:1600
ds_read_b128 v[180:183], v6 offset:2368
ds_read_b128 v[184:187], v6 offset:1568
ds_read_b128 v[188:191], v6 offset:2336
s_lshr_b32 s53, s4, 3
s_mul_i32 s53, s53, 75776
s_add_u32 s53, s53, 54525952
s_and_b32 s52, s3, 1
s_lshl_b32 s52, s52, 10
s_add_u32 s52, s52, s53
s_sub_u32 s54, 63, s72
s_mul_i32 s77, s72, 303104
s_add_u32 s77, s77, s52
s_mul_i32 s81, s54, 303104
s_add_u32 s81, s81, s52
s_add_u32 s91, s91, 114688
s_sub_u32 s52, s91, 163840
s_cmp_ge_u32 s91, 163840
s_cselect_b32 s91, s52, s91
v_add_u32 v14, 4096, v4
v_add_u32 v7, s91, v4
s_waitcnt lgkmcnt(0)
s_barrier
s_mov_b32 m0, s70
s_mov_b32 s64, s68
s_add_u32 s68, s68, 16384
s_add_u32 s70, s70, 16384
s_cmp_ge_u32 s70, 163840
s_cselect_b32 s70, s80, s70
buffer_load_dwordx4 v4, s[24:27], s64 offen offset:0 sc1 lds
v_and_b32 v9, 0xffff, v97
v_and_b32 v11, 0xffff0000, v97
v_dot2_f32_bf16 v24, v98, v99, 0
v_dot2_f32_bf16 v25, v102, v99, 0
v_dot2_f32_bf16 v26, v106, v99, 0
v_dot2_f32_bf16 v27, v110, v99, 0
v_dot2_f32_bf16 v28, v114, v99, 0
v_dot2_f32_bf16 v29, v118, v99, 0
v_dot2_f32_bf16 v30, v122, v99, 0
v_dot2_f32_bf16 v31, v126, v99, 0
v_dot2c_f32_bf16 v24, v96, v9
v_dot2c_f32_bf16 v25, v100, v9
v_dot2c_f32_bf16 v26, v104, v9
v_dot2c_f32_bf16 v27, v108, v9
v_dot2c_f32_bf16 v28, v112, v9
v_dot2c_f32_bf16 v29, v116, v9
v_dot2c_f32_bf16 v30, v120, v9
v_dot2c_f32_bf16 v31, v124, v9
v_dot2c_f32_bf16 v24, v16, v32
v_dot2c_f32_bf16 v25, v16, v40
v_dot2c_f32_bf16 v26, v16, v48
L_PAD10:
s_cbranch_execz L_MAIN
v_dot2c_f32_bf16 v27, v16, v56
v_dot2c_f32_bf16 v28, v16, v64
v_dot2c_f32_bf16 v29, v16, v72
v_dot2c_f32_bf16 v30, v16, v80
buffer_load_dwordx4 v4, s[24:27], s64 offen offset:1024 sc1 lds
v_dot2c_f32_bf16 v31, v16, v88
v_dot2c_f32_bf16 v24, v17, v33
v_dot2c_f32_bf16 v25, v17, v41
v_dot2c_f32_bf16 v26, v17, v49
v_dot2c_f32_bf16 v27, v17, v57
v_dot2c_f32_bf16 v28, v17, v65
v_dot2c_f32_bf16 v29, v17, v73
v_dot2c_f32_bf16 v30, v17, v81
v_dot2c_f32_bf16 v31, v17, v89
v_dot2c_f32_bf16 v24, v18, v34
v_dot2c_f32_bf16 v25, v18, v42
v_dot2c_f32_bf16 v26, v18, v50
v_dot2c_f32_bf16 v27, v18, v58
v_dot2c_f32_bf16 v28, v18, v66
v_dot2c_f32_bf16 v29, v18, v74
v_dot2c_f32_bf16 v30, v18, v82
v_dot2c_f32_bf16 v31, v18, v90
v_dot2c_f32_bf16 v24, v19, v35
v_dot2c_f32_bf16 v25, v19, v43
v_dot2c_f32_bf16 v26, v19, v51
v_dot2c_f32_bf16 v27, v19, v59
v_dot2c_f32_bf16 v28, v19, v67
v_dot2c_f32_bf16 v29, v19, v75
v_dot2c_f32_bf16 v30, v19, v83
v_dot2c_f32_bf16 v31, v19, v91
buffer_load_dwordx4 v4, s[24:27], s64 offen offset:2048 sc1 lds
v_dot2c_f32_bf16 v24, v20, v36
v_dot2c_f32_bf16 v25, v20, v44
v_dot2c_f32_bf16 v26, v20, v52
v_dot2c_f32_bf16 v27, v20, v60
v_dot2c_f32_bf16 v28, v20, v68
v_dot2c_f32_bf16 v29, v20, v76
v_dot2c_f32_bf16 v30, v20, v84
v_dot2c_f32_bf16 v31, v20, v92
v_dot2c_f32_bf16 v24, v21, v37
v_dot2c_f32_bf16 v25, v21, v45
v_dot2c_f32_bf16 v26, v21, v53
v_dot2c_f32_bf16 v27, v21, v61
v_dot2c_f32_bf16 v28, v21, v69
v_dot2c_f32_bf16 v29, v21, v77
v_dot2c_f32_bf16 v30, v21, v85
v_dot2c_f32_bf16 v31, v21, v93
v_dot2c_f32_bf16 v24, v22, v38
v_dot2c_f32_bf16 v25, v22, v46
v_dot2c_f32_bf16 v26, v22, v54
v_dot2c_f32_bf16 v27, v22, v62
v_dot2c_f32_bf16 v28, v22, v70
v_dot2c_f32_bf16 v29, v22, v78
v_dot2c_f32_bf16 v30, v22, v86
v_dot2c_f32_bf16 v31, v22, v94
v_dot2c_f32_bf16 v24, v23, v39
buffer_load_dwordx4 v4, s[24:27], s64 offen offset:3072 sc1 lds
v_dot2c_f32_bf16 v25, v23, v47
v_dot2c_f32_bf16 v26, v23, v55
v_dot2c_f32_bf16 v27, v23, v63
v_dot2c_f32_bf16 v28, v23, v71
v_dot2c_f32_bf16 v29, v23, v79
v_dot2c_f32_bf16 v30, v23, v87
v_dot2c_f32_bf16 v31, v23, v95
v_mov_b32 v9, 0xf149f2ca
v_mul_f32 v11, 0xbfb8aa3b, v11
v_exp_f32 v11, v11
v_cmp_gt_u32 vcc, 2, v5
v_cmp_gt_u32 s[56:57], 4, v5
s_nop 0
v_cndmask_b32 v25, v25, v9, vcc
v_cndmask_b32 v26, v26, v9, s[56:57]
v_cmp_gt_u32 vcc, 6, v5
v_cmp_gt_u32 s[56:57], 8, v5
s_nop 0
v_cndmask_b32 v27, v27, v9, vcc
v_cndmask_b32 v28, v28, v9, s[56:57]
v_cmp_gt_u32 vcc, 10, v5
v_cmp_gt_u32 s[56:57], 12, v5
s_nop 0
v_cndmask_b32 v29, v29, v9, vcc
v_cndmask_b32 v30, v30, v9, s[56:57]
s_mov_b32 m0, s70
s_mov_b32 s64, s68
s_add_u32 s68, s68, 16384
s_add_u32 s70, s70, 16384
s_cmp_ge_u32 s70, 163840
s_cselect_b32 s70, s80, s70
buffer_load_dwordx4 v4, s[24:27], s64 offen offset:0 sc1 lds
v_cmp_gt_u32 vcc, 14, v5
s_nop 0
s_nop 0
v_cndmask_b32 v31, v31, v9, vcc
v_max3_f32 v10, v24, v25, v26
v_max3_f32 v10, v10, v27, v28
v_max3_f32 v10, v10, v29, v30
v_max_f32 v10, v10, v31
s_mov_b32 s52, 0x3eae1a93
v_sub_f32 v24, v24, v10
v_sub_f32 v25, v25, v10
v_sub_f32 v26, v26, v10
v_sub_f32 v27, v27, v10
v_sub_f32 v28, v28, v10
v_sub_f32 v29, v29, v10
v_sub_f32 v30, v30, v10
v_sub_f32 v31, v31, v10
v_mul_f32 v24, s52, v24
v_mul_f32 v25, s52, v25
v_mul_f32 v26, s52, v26
v_mul_f32 v27, s52, v27
v_mul_f32 v28, s52, v28
v_mul_f32 v29, s52, v29
v_mul_f32 v30, s52, v30
v_mul_f32 v31, s52, v31
buffer_load_dwordx4 v4, s[24:27], s64 offen offset:1024 sc1 lds
v_exp_f32 v24, v24
v_exp_f32 v25, v25
v_exp_f32 v26, v26
v_exp_f32 v27, v27
v_exp_f32 v28, v28
v_exp_f32 v29, v29
v_exp_f32 v30, v30
v_exp_f32 v31, v31
v_cvt_pk_bf16_f32 v32, v24, 0
v_cvt_pk_bf16_f32 v40, v25, 0
v_cvt_pk_bf16_f32 v48, v26, 0
v_cvt_pk_bf16_f32 v56, v27, 0
v_cvt_pk_bf16_f32 v64, v28, 0
v_cvt_pk_bf16_f32 v72, v29, 0
v_cvt_pk_bf16_f32 v80, v30, 0
v_cvt_pk_bf16_f32 v88, v31, 0
v_lshlrev_b32 v33, 16, v32
v_lshlrev_b32 v41, 16, v40
v_lshlrev_b32 v49, 16, v48
v_lshlrev_b32 v57, 16, v56
v_lshlrev_b32 v65, 16, v64
v_lshlrev_b32 v73, 16, v72
v_lshlrev_b32 v81, 16, v80
v_lshlrev_b32 v89, 16, v88
v_add_f32 v10, v33, v41
s_waitcnt vmcnt(6)
buffer_atomic_add v1, v0, s[24:27], s74 offen offset:0 sc1
buffer_load_dwordx4 v4, s[24:27], s64 offen offset:2048 sc1 lds
v_add_f32 v10, v10, v49
v_add_f32 v10, v10, v57
v_add_f32 v10, v10, v65
v_add_f32 v10, v10, v73
v_add_f32 v10, v10, v81
v_add_f32 v10, v10, v89
v_fmac_f32 v10, v10, v11
v_rcp_f32 v10, v10
v_dot2_f32_bf16 v192, v128, v32, 0
v_dot2_f32_bf16 v193, v128, v33, 0
v_dot2_f32_bf16 v194, v129, v32, 0
v_dot2_f32_bf16 v195, v129, v33, 0
buffer_load_dwordx4 v4, s[24:27], s64 offen offset:3072 sc1 lds
v_dot2_f32_bf16 v196, v130, v32, 0
v_dot2_f32_bf16 v197, v130, v33, 0
v_dot2_f32_bf16 v198, v131, v32, 0
v_dot2_f32_bf16 v199, v131, v33, 0
v_dot2_f32_bf16 v200, v132, v32, 0
v_dot2_f32_bf16 v201, v132, v33, 0
v_dot2_f32_bf16 v202, v133, v32, 0
v_dot2_f32_bf16 v203, v133, v33, 0
v_dot2_f32_bf16 v204, v134, v32, 0
v_dot2_f32_bf16 v205, v134, v33, 0
v_dot2_f32_bf16 v206, v135, v32, 0
v_dot2_f32_bf16 v207, v135, v33, 0
s_mov_b32 m0, s70
s_mov_b32 s64, s68
s_add_u32 s68, s68, 16384
s_add_u32 s70, s70, 16384
s_cmp_ge_u32 s70, 163840
s_cselect_b32 s70, s80, s70
buffer_load_dwordx4 v4, s[24:27], s64 offen offset:0 sc1 lds
v_dot2_f32_bf16 v208, v96, v33, 0
v_dot2_f32_bf16 v209, v98, v33, 0
v_dot2c_f32_bf16 v192, v136, v40
v_dot2c_f32_bf16 v193, v136, v41
v_dot2c_f32_bf16 v194, v137, v40
v_dot2c_f32_bf16 v195, v137, v41
v_dot2c_f32_bf16 v196, v138, v40
v_dot2c_f32_bf16 v197, v138, v41
v_dot2c_f32_bf16 v198, v139, v40
v_dot2c_f32_bf16 v199, v139, v41
v_dot2c_f32_bf16 v200, v140, v40
v_dot2c_f32_bf16 v201, v140, v41
buffer_load_dwordx4 v4, s[24:27], s64 offen offset:1024 sc1 lds
v_dot2c_f32_bf16 v202, v141, v40
v_dot2c_f32_bf16 v203, v141, v41
v_dot2c_f32_bf16 v204, v142, v40
v_dot2c_f32_bf16 v205, v142, v41
v_dot2c_f32_bf16 v206, v143, v40
v_dot2c_f32_bf16 v207, v143, v41
v_dot2c_f32_bf16 v208, v100, v41
v_dot2c_f32_bf16 v209, v102, v41
v_dot2c_f32_bf16 v192, v144, v48
v_dot2c_f32_bf16 v193, v144, v49
v_dot2c_f32_bf16 v194, v145, v48
v_dot2c_f32_bf16 v195, v145, v49
buffer_load_dwordx4 v4, s[24:27], s64 offen offset:2048 sc1 lds
v_dot2c_f32_bf16 v196, v146, v48
v_dot2c_f32_bf16 v197, v146, v49
v_dot2c_f32_bf16 v198, v147, v48
v_dot2c_f32_bf16 v199, v147, v49
v_dot2c_f32_bf16 v200, v148, v48
v_dot2c_f32_bf16 v201, v148, v49
v_dot2c_f32_bf16 v202, v149, v48
v_dot2c_f32_bf16 v203, v149, v49
v_dot2c_f32_bf16 v204, v150, v48
v_dot2c_f32_bf16 v205, v150, v49
v_dot2c_f32_bf16 v206, v151, v48
v_dot2c_f32_bf16 v207, v151, v49
buffer_load_dwordx4 v4, s[24:27], s64 offen offset:3072 sc1 lds
v_dot2c_f32_bf16 v208, v104, v49
v_dot2c_f32_bf16 v209, v106, v49
v_dot2c_f32_bf16 v192, v152, v56
v_dot2c_f32_bf16 v193, v152, v57
v_dot2c_f32_bf16 v194, v153, v56
v_dot2c_f32_bf16 v195, v153, v57
v_dot2c_f32_bf16 v196, v154, v56
v_dot2c_f32_bf16 v197, v154, v57
v_dot2c_f32_bf16 v198, v155, v56
v_dot2c_f32_bf16 v199, v155, v57
v_dot2c_f32_bf16 v200, v156, v56
v_dot2c_f32_bf16 v201, v156, v57
s_mov_b32 m0, s70
s_mov_b32 s64, s68
s_add_u32 s68, s68, 16384
s_add_u32 s70, s70, 16384
s_cmp_ge_u32 s70, 163840
s_cselect_b32 s70, s80, s70
buffer_load_dwordx4 v4, s[24:27], s64 offen offset:0 sc1 lds
v_dot2c_f32_bf16 v202, v157, v56
v_dot2c_f32_bf16 v203, v157, v57
v_dot2c_f32_bf16 v204, v158, v56
v_dot2c_f32_bf16 v205, v158, v57
v_dot2c_f32_bf16 v206, v159, v56
v_dot2c_f32_bf16 v207, v159, v57
v_dot2c_f32_bf16 v208, v108, v57
v_dot2c_f32_bf16 v209, v110, v57
v_dot2c_f32_bf16 v192, v160, v64
v_dot2c_f32_bf16 v193, v160, v65
v_dot2c_f32_bf16 v194, v161, v64
v_dot2c_f32_bf16 v195, v161, v65
buffer_load_dwordx4 v4, s[24:27], s64 offen offset:1024 sc1 lds
v_dot2c_f32_bf16 v196, v162, v64
v_dot2c_f32_bf16 v197, v162, v65
v_dot2c_f32_bf16 v198, v163, v64
v_dot2c_f32_bf16 v199, v163, v65
v_dot2c_f32_bf16 v200, v164, v64
v_dot2c_f32_bf16 v201, v164, v65
v_dot2c_f32_bf16 v202, v165, v64
v_dot2c_f32_bf16 v203, v165, v65
v_dot2c_f32_bf16 v204, v166, v64
v_dot2c_f32_bf16 v205, v166, v65
v_dot2c_f32_bf16 v206, v167, v64
v_dot2c_f32_bf16 v207, v167, v65
buffer_load_dwordx4 v4, s[24:27], s64 offen offset:2048 sc1 lds
v_dot2c_f32_bf16 v208, v112, v65
v_dot2c_f32_bf16 v209, v114, v65
v_dot2c_f32_bf16 v192, v168, v72
v_dot2c_f32_bf16 v193, v168, v73
v_dot2c_f32_bf16 v194, v169, v72
v_dot2c_f32_bf16 v195, v169, v73
v_dot2c_f32_bf16 v196, v170, v72
v_dot2c_f32_bf16 v197, v170, v73
v_dot2c_f32_bf16 v198, v171, v72
v_dot2c_f32_bf16 v199, v171, v73
v_dot2c_f32_bf16 v200, v172, v72
v_dot2c_f32_bf16 v201, v172, v73
buffer_load_dword v12, v13, s[24:27], s75 offen sc1
v_dot2c_f32_bf16 v202, v173, v72
v_dot2c_f32_bf16 v203, v173, v73
v_dot2c_f32_bf16 v204, v174, v72
v_dot2c_f32_bf16 v205, v174, v73
v_dot2c_f32_bf16 v206, v175, v72
v_dot2c_f32_bf16 v207, v175, v73
v_dot2c_f32_bf16 v208, v116, v73
v_dot2c_f32_bf16 v209, v118, v73
v_dot2c_f32_bf16 v192, v176, v80
v_dot2c_f32_bf16 v193, v176, v81
v_dot2c_f32_bf16 v194, v177, v80
v_dot2c_f32_bf16 v195, v177, v81
buffer_load_dwordx4 v4, s[24:27], s64 offen offset:3072 sc1 lds
v_dot2c_f32_bf16 v196, v178, v80
v_dot2c_f32_bf16 v197, v178, v81
v_dot2c_f32_bf16 v198, v179, v80
v_dot2c_f32_bf16 v199, v179, v81
v_dot2c_f32_bf16 v200, v180, v80
v_dot2c_f32_bf16 v201, v180, v81
v_dot2c_f32_bf16 v202, v181, v80
v_dot2c_f32_bf16 v203, v181, v81
v_dot2c_f32_bf16 v204, v182, v80
v_dot2c_f32_bf16 v205, v182, v81
v_dot2c_f32_bf16 v206, v183, v80
v_dot2c_f32_bf16 v207, v183, v81
s_mov_b32 m0, s70
s_mov_b32 s64, s68
s_add_u32 s68, s68, 16384
s_add_u32 s70, s70, 16384
s_cmp_ge_u32 s70, 163840
s_cselect_b32 s70, s80, s70
buffer_load_dwordx4 v4, s[24:27], s64 offen offset:0 sc1 lds
v_dot2c_f32_bf16 v208, v120, v81
v_dot2c_f32_bf16 v209, v122, v81
v_dot2c_f32_bf16 v192, v184, v88
v_dot2c_f32_bf16 v193, v184, v89
v_dot2c_f32_bf16 v194, v185, v88
v_dot2c_f32_bf16 v195, v185, v89
v_dot2c_f32_bf16 v196, v186, v88
v_dot2c_f32_bf16 v197, v186, v89
v_dot2c_f32_bf16 v198, v187, v88
v_dot2c_f32_bf16 v199, v187, v89
v_dot2c_f32_bf16 v200, v188, v88
v_dot2c_f32_bf16 v201, v188, v89
buffer_load_dwordx4 v4, s[24:27], s64 offen offset:1024 sc1 lds
v_dot2c_f32_bf16 v202, v189, v88
v_dot2c_f32_bf16 v203, v189, v89
v_dot2c_f32_bf16 v204, v190, v88
v_dot2c_f32_bf16 v205, v190, v89
v_dot2c_f32_bf16 v206, v191, v88
v_dot2c_f32_bf16 v207, v191, v89
v_dot2c_f32_bf16 v208, v124, v89
v_dot2c_f32_bf16 v209, v126, v89
v_lshrrev_b32 v9, 5, v5
v_mul_u32_u24 v9, 303104, v9
v_and_b32 v11, 1, v3
v_lshl_add_u32 v9, v11, 10, v9
buffer_load_dwordx4 v4, s[24:27], s64 offen offset:2048 sc1 lds
v_lshl_add_u32 v9, v2, 4, v9
v_mul_f32 v192, v10, v192
v_mul_f32 v193, v10, v193
v_mul_f32 v194, v10, v194
v_mul_f32 v195, v10, v195
v_mul_f32 v196, v10, v196
v_mul_f32 v197, v10, v197
v_mul_f32 v198, v10, v198
v_mul_f32 v199, v10, v199
v_mul_f32 v200, v10, v200
v_mul_f32 v201, v10, v201
v_mul_f32 v202, v10, v202
buffer_load_dwordx4 v4, s[24:27], s64 offen offset:3072 sc1 lds
v_mul_f32 v203, v10, v203
v_mul_f32 v204, v10, v204
v_mul_f32 v205, v10, v205
v_mul_f32 v206, v10, v206
v_mul_f32 v207, v10, v207
v_mul_f32 v208, v10, v208
v_mul_f32 v209, v10, v209
v_cvt_pk_bf16_f32 v192, v192, v193
v_cvt_pk_bf16_f32 v193, v194, v195
v_cvt_pk_bf16_f32 v194, v196, v197
v_cvt_pk_bf16_f32 v195, v198, v199
v_cvt_pk_bf16_f32 v196, v200, v201
v_cvt_pk_bf16_f32 v197, v202, v203
v_cvt_pk_bf16_f32 v198, v204, v205
v_cvt_pk_bf16_f32 v199, v206, v207
v_cvt_pk_bf16_f32 v200, v208, v209
s_add_u32 s53, s53, 65536
s_bfe_u32 s54, s4, 131073
s_lshl_b32 s54, s54, 11
s_add_u32 s54, s54, s53
s_and_b32 s55, s4, 1
s_lshl_b32 s55, s55, 9
s_add_u32 s54, s54, s55
s_lshl2_add_u32 s52, s85, s86
s_lshl2_add_u32 s69, s52, s3
s_mul_i32 s69, s69, 28672
s_add_u32 s69, s69, 76546048
s_lshr_b32 s73, s52, 1
s_lshl_b32 s73, s73, 10
s_and_b32 s52, s52, 1
s_lshl_b32 s52, s52, 7
s_add_u32 s73, s73, s52
s_lshl2_add_u32 s73, s3, s73
s_add_u32 s73, s73, 75498112
ds_read_b128 v[144:147], v7 offset:0
ds_read_b128 v[148:151], v7 offset:1024
ds_read_b128 v[152:155], v7 offset:2048
ds_read_b128 v[156:159], v7 offset:3072
ds_read_b128 v[160:163], v7 offset:4096
ds_read_b128 v[164:167], v7 offset:5120
ds_read_b128 v[168:171], v7 offset:6144
ds_read_b128 v[172:175], v7 offset:7168
v_mov_b32 v10, 0
s_waitcnt vmcnt(5)
v_cmp_gt_u32 vcc, 8, v12
s_mov_b32 s92, 0
s_nop 3
s_cbranch_vccz L_ZBX
L_ZB:
s_sleep 2
buffer_load_dword v12, v13, s[24:27], s75 offen sc1
s_add_u32 s92, s92, 1
s_waitcnt vmcnt(0)
v_cmp_gt_u32 vcc, 8, v12
s_cmp_gt_u32 s92, 1048576
s_cbranch_scc1 L_ZBX
s_nop 2
s_cbranch_vccnz L_ZB
L_ZBX:
s_xor_b32 s65, s82, 0
s_add_u32 s65, s65, s77
buffer_load_dwordx4 a[0:3], v4, s[24:27], s65 offen offset:0 sc1
buffer_load_dwordx4 a[8:11], v4, s[24:27], s65 offen offset:2048 sc1
s_xor_b32 s93, s82, 0
s_add_u32 s93, s93, s81
buffer_load_dwordx4 a[4:7], v4, s[24:27], s93 offen offset:0 sc1
buffer_load_dwordx4 a[12:15], v4, s[24:27], s93 offen offset:2048 sc1
buffer_load_dwordx4 a[16:19], v14, s[24:27], s65 offen offset:0 sc1
buffer_load_dwordx4 a[24:27], v14, s[24:27], s65 offen offset:2048 sc1
buffer_load_dwordx4 a[20:23], v14, s[24:27], s93 offen offset:0 sc1
buffer_load_dwordx4 a[28:31], v14, s[24:27], s93 offen offset:2048 sc1
buffer_store_dwordx4 v[192:195], v9, s[24:27], s54 offen sc1
buffer_store_dwordx4 v[196:199], v9, s[24:27], s54 offen offset:256 sc1
s_bfe_u32 s55, s4, 65538
s_lshl_b32 s55, s55, 8
s_add_u32 s54, s53, s55
s_and_b32 s55, s4, 3
s_lshl2_add_u32 s54, s55, s54
s_add_u32 s54, s54, 8192
buffer_store_dword v200, v9, s[24:27], s54 offen sc1
s_waitcnt vmcnt(9) lgkmcnt(6)
v_mfma_f32_16x16x32_bf16 v[120:123], v[144:147], a[0:3], 0
s_waitcnt vmcnt(7)
s_add_u32 s91, s91, 16384
ds_read_b128 v[176:179], v7 offset:8192
v_mfma_f32_16x16x32_bf16 v[120:123], v[148:151], a[8:11], v[120:123]
s_xor_b32 s65, s82, 8192
s_add_u32 s65, s65, s77
ds_read_b128 v[180:183], v7 offset:9216
v_mfma_f32_16x16x32_bf16 v[124:127], v[148:151], a[12:15], 0
s_waitcnt lgkmcnt(6)
ds_read_b128 v[184:187], v7 offset:10240
v_mfma_f32_16x16x32_bf16 v[124:127], v[144:147], a[4:7], v[124:127]
buffer_load_dwordx4 a[32:35], v4, s[24:27], s65 offen offset:0 sc1
v_mfma_f32_16x16x32_bf16 v[72:75], v[152:155], a[0:3], 0
s_cmp_ge_u32 s91, 163840
s_cselect_b32 s91, 0, s91
ds_read_b128 v[188:191], v7 offset:11264
v_mfma_f32_16x16x32_bf16 v[72:75], v[156:159], a[8:11], v[72:75]
s_waitcnt lgkmcnt(6)
v_add_u32 v8, s91, v4
v_mfma_f32_16x16x32_bf16 v[76:79], v[156:159], a[12:15], 0
buffer_load_dwordx4 a[40:43], v4, s[24:27], s65 offen offset:2048 sc1
v_mfma_f32_16x16x32_bf16 v[76:79], v[152:155], a[4:7], v[76:79]
s_xor_b32 s93, s82, 8192
s_add_u32 s93, s93, s81
ds_read_b128 v[144:147], v7 offset:12288
v_mfma_f32_16x16x32_bf16 v[80:83], v[160:163], a[0:3], 0
ds_read_b128 v[148:151], v7 offset:13312
v_mfma_f32_16x16x32_bf16 v[80:83], v[164:167], a[8:11], v[80:83]
buffer_load_dwordx4 a[36:39], v4, s[24:27], s93 offen offset:0 sc1
v_mfma_f32_16x16x32_bf16 v[84:87], v[164:167], a[12:15], 0
ds_read_b128 v[152:155], v7 offset:14336
v_mfma_f32_16x16x32_bf16 v[84:87], v[160:163], a[4:7], v[84:87]
s_waitcnt lgkmcnt(7)
v_mfma_f32_16x16x32_bf16 v[88:91], v[168:171], a[0:3], 0
buffer_load_dwordx4 a[44:47], v4, s[24:27], s93 offen offset:2048 sc1
v_mfma_f32_16x16x32_bf16 v[88:91], v[172:175], a[8:11], v[88:91]
ds_read_b128 v[156:159], v7 offset:15360
v_mfma_f32_16x16x32_bf16 v[92:95], v[172:175], a[12:15], 0
s_waitcnt lgkmcnt(6)
s_add_u32 s91, s91, 16384
ds_read_b128 v[160:163], v8 offset:0
v_mfma_f32_16x16x32_bf16 v[92:95], v[168:171], a[4:7], v[92:95]
buffer_load_dwordx4 a[48:51], v14, s[24:27], s65 offen offset:0 sc1
v_mfma_f32_16x16x32_bf16 v[96:99], v[176:179], a[0:3], 0
s_cmp_ge_u32 s91, 163840
s_cselect_b32 s91, 0, s91
ds_read_b128 v[164:167], v8 offset:1024
v_mfma_f32_16x16x32_bf16 v[96:99], v[180:183], a[8:11], v[96:99]
v_add_u32 v7, s91, v4
v_mfma_f32_16x16x32_bf16 v[100:103], v[180:183], a[12:15], 0
buffer_load_dwordx4 a[56:59], v14, s[24:27], s65 offen offset:2048 sc1
v_mfma_f32_16x16x32_bf16 v[100:103], v[176:179], a[4:7], v[100:103]
s_waitcnt lgkmcnt(6)
ds_read_b128 v[168:171], v8 offset:2048
v_mfma_f32_16x16x32_bf16 v[104:107], v[184:187], a[0:3], 0
ds_read_b128 v[172:175], v8 offset:3072
v_mfma_f32_16x16x32_bf16 v[104:107], v[188:191], a[8:11], v[104:107]
v_mfma_f32_16x16x32_bf16 v[108:111], v[188:191], a[12:15], 0
buffer_load_dwordx4 a[52:55], v14, s[24:27], s93 offen offset:0 sc1
v_mfma_f32_16x16x32_bf16 v[108:111], v[184:187], a[4:7], v[108:111]
s_waitcnt lgkmcnt(6)
ds_read_b128 v[176:179], v8 offset:4096
v_mfma_f32_16x16x32_bf16 v[112:115], v[144:147], a[0:3], 0
ds_read_b128 v[180:183], v8 offset:5120
v_mfma_f32_16x16x32_bf16 v[112:115], v[148:151], a[8:11], v[112:115]
v_mfma_f32_16x16x32_bf16 v[116:119], v[148:151], a[12:15], 0
buffer_load_dwordx4 a[60:63], v14, s[24:27], s93 offen offset:2048 sc1
v_mfma_f32_16x16x32_bf16 v[116:119], v[144:147], a[4:7], v[116:119]
s_waitcnt lgkmcnt(6) vmcnt(13)
ds_read_b128 v[184:187], v8 offset:6144
v_mfma_f32_16x16x32_bf16 v[120:123], v[152:155], a[16:19], v[120:123]
ds_read_b128 v[188:191], v8 offset:7168
v_mfma_f32_16x16x32_bf16 v[120:123], v[156:159], a[24:27], v[120:123]
s_waitcnt vmcnt(11)
v_mfma_f32_16x16x32_bf16 v[124:127], v[156:159], a[28:31], v[124:127]
ds_read_b128 v[144:147], v8 offset:8192
v_mfma_f32_16x16x32_bf16 v[124:127], v[152:155], a[20:23], v[124:127]
s_waitcnt lgkmcnt(7)
v_mfma_f32_16x16x32_bf16 v[72:75], v[160:163], a[16:19], v[72:75]
ds_read_b128 v[148:151], v8 offset:9216
v_mfma_f32_16x16x32_bf16 v[72:75], v[164:167], a[24:27], v[72:75]
v_mfma_f32_16x16x32_bf16 v[76:79], v[164:167], a[28:31], v[76:79]
ds_read_b128 v[152:155], v8 offset:10240
v_mfma_f32_16x16x32_bf16 v[76:79], v[160:163], a[20:23], v[76:79]
s_waitcnt lgkmcnt(7)
v_mfma_f32_16x16x32_bf16 v[80:83], v[168:171], a[16:19], v[80:83]
ds_read_b128 v[156:159], v8 offset:11264
v_mfma_f32_16x16x32_bf16 v[80:83], v[172:175], a[24:27], v[80:83]
v_mfma_f32_16x16x32_bf16 v[84:87], v[172:175], a[28:31], v[84:87]
ds_read_b128 v[160:163], v8 offset:12288
v_mfma_f32_16x16x32_bf16 v[84:87], v[168:171], a[20:23], v[84:87]
s_waitcnt lgkmcnt(7)
v_mfma_f32_16x16x32_bf16 v[88:91], v[176:179], a[16:19], v[88:91]
s_xor_b32 s65, s82, 16384
s_add_u32 s65, s65, s77
ds_read_b128 v[164:167], v8 offset:13312
v_mfma_f32_16x16x32_bf16 v[88:91], v[180:183], a[24:27], v[88:91]
v_mfma_f32_16x16x32_bf16 v[92:95], v[180:183], a[28:31], v[92:95]
s_waitcnt lgkmcnt(6)
ds_read_b128 v[168:171], v8 offset:14336
v_add_u32 v11, s70, v4
v_mfma_f32_16x16x32_bf16 v[92:95], v[176:179], a[20:23], v[92:95]
s_add_u32 s70, s70, 16384
s_cmp_ge_u32 s70, 163840
s_cselect_b32 s70, s80, s70
v_mfma_f32_16x16x32_bf16 v[96:99], v[184:187], a[16:19], v[96:99]
buffer_load_dwordx4 a[64:67], v4, s[24:27], s65 offen offset:0 sc1
v_mfma_f32_16x16x32_bf16 v[96:99], v[188:191], a[24:27], v[96:99]
s_barrier
v_mfma_f32_16x16x32_bf16 v[100:103], v[188:191], a[28:31], v[100:103]
s_waitcnt lgkmcnt(5)
ds_read_b128 v[172:175], v8 offset:15360
v_mfma_f32_16x16x32_bf16 v[100:103], v[184:187], a[20:23], v[100:103]
buffer_load_dwordx4 a[72:75], v4, s[24:27], s65 offen offset:2048 sc1
v_mfma_f32_16x16x32_bf16 v[104:107], v[144:147], a[16:19], v[104:107]
ds_write_b64 v11, a[96:97] offset:0
v_mfma_f32_16x16x32_bf16 v[104:107], v[148:151], a[24:27], v[104:107]
s_xor_b32 s93, s82, 16384
s_add_u32 s93, s93, s81
ds_read_b128 v[176:179], v7 offset:0
v_mfma_f32_16x16x32_bf16 v[108:111], v[148:151], a[28:31], v[108:111]
buffer_load_dwordx4 a[68:71], v4, s[24:27], s93 offen offset:0 sc1
v_mfma_f32_16x16x32_bf16 v[108:111], v[144:147], a[20:23], v[108:111]
s_waitcnt lgkmcnt(6)
s_add_u32 s91, s91, 16384
ds_read_b128 v[180:183], v7 offset:1024
v_mfma_f32_16x16x32_bf16 v[112:115], v[152:155], a[16:19], v[112:115]
ds_write_b64 v11, a[98:99] offset:8
v_mfma_f32_16x16x32_bf16 v[112:115], v[156:159], a[24:27], v[112:115]
s_cmp_ge_u32 s91, 163840
s_cselect_b32 s91, 0, s91
ds_read_b128 v[184:187], v7 offset:2048
v_mfma_f32_16x16x32_bf16 v[116:119], v[156:159], a[28:31], v[116:119]
buffer_load_dwordx4 a[76:79], v4, s[24:27], s93 offen offset:2048 sc1
v_mfma_f32_16x16x32_bf16 v[116:119], v[152:155], a[20:23], v[116:119]
s_waitcnt lgkmcnt(7) vmcnt(10)
ds_read_b128 v[188:191], v7 offset:3072
v_add_u32 v8, s91, v4
v_mfma_f32_16x16x32_bf16 v[120:123], v[160:163], a[32:35], v[120:123]
s_waitcnt vmcnt(12)
s_waitcnt vmcnt(8)
ds_read_b128 v[144:147], v7 offset:4096
v_mfma_f32_16x16x32_bf16 v[120:123], v[164:167], a[40:43], v[120:123]
buffer_atomic_add v1, v0, s[24:27], s74 offen offset:4 sc1
v_mfma_f32_16x16x32_bf16 v[124:127], v[164:167], a[44:47], v[124:127]
ds_write_b64 v11, a[100:101] offset:1024
v_mfma_f32_16x16x32_bf16 v[124:127], v[160:163], a[36:39], v[124:127]
s_waitcnt lgkmcnt(8)
ds_read_b128 v[148:151], v7 offset:5120
v_mfma_f32_16x16x32_bf16 v[72:75], v[168:171], a[32:35], v[72:75]
ds_read_b128 v[152:155], v7 offset:6144
v_mfma_f32_16x16x32_bf16 v[72:75], v[172:175], a[40:43], v[72:75]
ds_read_b128 v[156:159], v7 offset:7168
v_mfma_f32_16x16x32_bf16 v[76:79], v[172:175], a[44:47], v[76:79]
ds_write_b64 v11, a[102:103] offset:1032
v_mfma_f32_16x16x32_bf16 v[76:79], v[168:171], a[36:39], v[76:79]
s_waitcnt lgkmcnt(9)
ds_read_b128 v[160:163], v7 offset:8192
v_mfma_f32_16x16x32_bf16 v[80:83], v[176:179], a[32:35], v[80:83]
ds_read_b128 v[164:167], v7 offset:9216
v_mfma_f32_16x16x32_bf16 v[80:83], v[180:183], a[40:43], v[80:83]
v_mfma_f32_16x16x32_bf16 v[84:87], v[180:183], a[44:47], v[84:87]
ds_write_b64 v11, a[104:105] offset:2048
v_mfma_f32_16x16x32_bf16 v[84:87], v[176:179], a[36:39], v[84:87]
s_waitcnt lgkmcnt(9)
ds_read_b128 v[168:171], v7 offset:10240
v_mfma_f32_16x16x32_bf16 v[88:91], v[184:187], a[32:35], v[88:91]
ds_read_b128 v[172:175], v7 offset:11264
v_mfma_f32_16x16x32_bf16 v[88:91], v[188:191], a[40:43], v[88:91]
s_waitcnt lgkmcnt(8)
v_mfma_f32_16x16x32_bf16 v[92:95], v[188:191], a[44:47], v[92:95]
ds_write_b64 v11, a[106:107] offset:2056
v_mfma_f32_16x16x32_bf16 v[92:95], v[184:187], a[36:39], v[92:95]
buffer_load_dwordx4 a[80:83], v14, s[24:27], s65 offen offset:0 sc1
v_mfma_f32_16x16x32_bf16 v[96:99], v[144:147], a[32:35], v[96:99]
ds_read_b128 v[176:179], v7 offset:12288
v_mfma_f32_16x16x32_bf16 v[96:99], v[148:151], a[40:43], v[96:99]
s_waitcnt lgkmcnt(8)
ds_read_b128 v[180:183], v7 offset:13312
v_mfma_f32_16x16x32_bf16 v[100:103], v[148:151], a[44:47], v[100:103]
ds_write_b64 v11, a[108:109] offset:3072
v_mfma_f32_16x16x32_bf16 v[100:103], v[144:147], a[36:39], v[100:103]
buffer_load_dwordx4 a[88:91], v14, s[24:27], s65 offen offset:2048 sc1
v_mfma_f32_16x16x32_bf16 v[104:107], v[152:155], a[32:35], v[104:107]
ds_read_b128 v[184:187], v7 offset:14336
v_mfma_f32_16x16x32_bf16 v[104:107], v[156:159], a[40:43], v[104:107]
s_waitcnt lgkmcnt(8)
ds_read_b128 v[188:191], v7 offset:15360
v_mfma_f32_16x16x32_bf16 v[108:111], v[156:159], a[44:47], v[108:111]
ds_write_b64 v11, a[110:111] offset:3080
v_mfma_f32_16x16x32_bf16 v[108:111], v[152:155], a[36:39], v[108:111]
buffer_load_dwordx4 a[84:87], v14, s[24:27], s93 offen offset:0 sc1
v_mfma_f32_16x16x32_bf16 v[112:115], v[160:163], a[32:35], v[112:115]
s_add_u32 s91, s91, 16384
ds_read_b128 v[144:147], v8 offset:0
v_mfma_f32_16x16x32_bf16 v[112:115], v[164:167], a[40:43], v[112:115]
s_cmp_ge_u32 s91, 163840
s_cselect_b32 s91, 0, s91
ds_read_b128 v[148:151], v8 offset:1024
v_mfma_f32_16x16x32_bf16 v[116:119], v[164:167], a[44:47], v[116:119]
buffer_load_dwordx4 a[92:95], v14, s[24:27], s93 offen offset:2048 sc1
v_mfma_f32_16x16x32_bf16 v[116:119], v[160:163], a[36:39], v[116:119]
s_waitcnt lgkmcnt(9) vmcnt(11)
ds_read_b128 v[152:155], v8 offset:2048
v_add_u32 v7, s91, v4
v_mfma_f32_16x16x32_bf16 v[120:123], v[168:171], a[48:51], v[120:123]
ds_read_b128 v[156:159], v8 offset:3072
v_mfma_f32_16x16x32_bf16 v[120:123], v[172:175], a[56:59], v[120:123]
s_waitcnt vmcnt(9)
v_mfma_f32_16x16x32_bf16 v[124:127], v[172:175], a[60:63], v[124:127]
ds_read_b128 v[160:163], v8 offset:4096
v_mfma_f32_16x16x32_bf16 v[124:127], v[168:171], a[52:55], v[124:127]
s_waitcnt lgkmcnt(9)
v_mfma_f32_16x16x32_bf16 v[72:75], v[176:179], a[48:51], v[72:75]
ds_read_b128 v[164:167], v8 offset:5120
v_mfma_f32_16x16x32_bf16 v[72:75], v[180:183], a[56:59], v[72:75]
v_mfma_f32_16x16x32_bf16 v[76:79], v[180:183], a[60:63], v[76:79]
ds_read_b128 v[168:171], v8 offset:6144
v_mfma_f32_16x16x32_bf16 v[76:79], v[176:179], a[52:55], v[76:79]
s_xor_b32 s65, s82, 24576
s_add_u32 s65, s65, s77
s_waitcnt lgkmcnt(8)
v_mfma_f32_16x16x32_bf16 v[80:83], v[184:187], a[48:51], v[80:83]
ds_read_b128 v[172:175], v8 offset:7168
v_mfma_f32_16x16x32_bf16 v[80:83], v[188:191], a[56:59], v[80:83]
buffer_load_dwordx4 a[192:195], v4, s[24:27], s65 offen offset:0 sc1
v_mfma_f32_16x16x32_bf16 v[84:87], v[188:191], a[60:63], v[84:87]
ds_read_b128 v[176:179], v8 offset:8192
v_mfma_f32_16x16x32_bf16 v[84:87], v[184:187], a[52:55], v[84:87]
s_waitcnt lgkmcnt(7)
v_mfma_f32_16x16x32_bf16 v[88:91], v[144:147], a[48:51], v[88:91]
ds_read_b128 v[180:183], v8 offset:9216
v_mfma_f32_16x16x32_bf16 v[88:91], v[148:151], a[56:59], v[88:91]
v_mfma_f32_16x16x32_bf16 v[92:95], v[148:151], a[60:63], v[92:95]
s_waitcnt lgkmcnt(6)
ds_read_b128 v[184:187], v8 offset:10240
v_mfma_f32_16x16x32_bf16 v[92:95], v[144:147], a[52:55], v[92:95]
buffer_load_dwordx4 a[200:203], v4, s[24:27], s65 offen offset:2048 sc1
v_mfma_f32_16x16x32_bf16 v[96:99], v[152:155], a[48:51], v[96:99]
s_add_u32 s52, s84, 1
ds_read_b128 v[188:191], v8 offset:11264
v_mfma_f32_16x16x32_bf16 v[96:99], v[156:159], a[56:59], v[96:99]
v_mfma_f32_16x16x32_bf16 v[100:103], v[156:159], a[60:63], v[100:103]
s_xor_b32 s93, s82, 24576
s_add_u32 s93, s93, s81
ds_read_b128 v[144:147], v8 offset:12288
v_mfma_f32_16x16x32_bf16 v[100:103], v[152:155], a[52:55], v[100:103]
s_and_b32 s52, s52, 3
s_waitcnt lgkmcnt(7)
v_mfma_f32_16x16x32_bf16 v[104:107], v[160:163], a[48:51], v[104:107]
buffer_load_dwordx4 a[196:199], v4, s[24:27], s93 offen offset:0 sc1
v_mfma_f32_16x16x32_bf16 v[104:107], v[164:167], a[56:59], v[104:107]
s_waitcnt lgkmcnt(5)
ds_read_b128 v[148:151], v8 offset:13312
v_mfma_f32_16x16x32_bf16 v[108:111], v[164:167], a[60:63], v[108:111]
s_mul_i32 s52, s52, 6144
ds_read_b128 v[152:155], v8 offset:14336
v_add_u32 v11, s70, v4
v_mfma_f32_16x16x32_bf16 v[108:111], v[160:163], a[52:55], v[108:111]
s_add_u32 s70, s70, 16384
s_cmp_ge_u32 s70, 163840
s_cselect_b32 s70, s80, s70
v_mfma_f32_16x16x32_bf16 v[112:115], v[168:171], a[48:51], v[112:115]
s_waitcnt vmcnt(49)
ds_read_b128 v[156:159], v8 offset:15360
v_mfma_f32_16x16x32_bf16 v[112:115], v[172:175], a[56:59], v[112:115]
s_barrier
v_mfma_f32_16x16x32_bf16 v[116:119], v[172:175], a[60:63], v[116:119]
s_add_u32 s52, s52, s69
s_waitcnt lgkmcnt(6) vmcnt(10)
ds_read_b128 v[160:163], v7 offset:0
v_mfma_f32_16x16x32_bf16 v[116:119], v[168:171], a[52:55], v[116:119]
buffer_load_dwordx4 a[204:207], v4, s[24:27], s93 offen offset:2048 sc1
L_PAD11:
s_cbranch_execz L_MAIN
v_mfma_f32_16x16x32_bf16 v[120:123], v[176:179], a[64:67], v[120:123]
ds_write_b64 v11, a[112:113] offset:0
v_mfma_f32_16x16x32_bf16 v[120:123], v[180:183], a[72:75], v[120:123]
s_add_u32 s52, s52, 0
s_waitcnt vmcnt(9)
ds_read_b128 v[164:167], v7 offset:1024
v_mfma_f32_16x16x32_bf16 v[124:127], v[180:183], a[76:79], v[124:127]
s_add_u32 s91, s91, 16384
ds_read_b128 v[168:171], v7 offset:2048
v_mfma_f32_16x16x32_bf16 v[124:127], v[176:179], a[68:71], v[124:127]
s_waitcnt lgkmcnt(8)
s_cmp_ge_u32 s91, 163840
s_cselect_b32 s91, 0, s91
v_mfma_f32_16x16x32_bf16 v[72:75], v[184:187], a[64:67], v[72:75]
s_add_u32 s53, s84, 2
ds_read_b128 v[172:175], v7 offset:3072
v_add_u32 v8, s91, v4
v_mfma_f32_16x16x32_bf16 v[72:75], v[188:191], a[72:75], v[72:75]
ds_write_b64 v11, a[114:115] offset:8
v_mfma_f32_16x16x32_bf16 v[76:79], v[188:191], a[76:79], v[76:79]
buffer_load_dwordx4 a[208:211], v14, s[24:27], s65 offen offset:0 sc1
v_mfma_f32_16x16x32_bf16 v[76:79], v[184:187], a[68:71], v[76:79]
s_and_b32 s53, s53, 3
s_waitcnt lgkmcnt(8)
ds_read_b128 v[176:179], v7 offset:4096
v_mfma_f32_16x16x32_bf16 v[80:83], v[144:147], a[64:67], v[80:83]
ds_read_b128 v[180:183], v7 offset:5120
v_mfma_f32_16x16x32_bf16 v[80:83], v[148:151], a[72:75], v[80:83]
ds_write_b64 v11, a[116:117] offset:1024
v_mfma_f32_16x16x32_bf16 v[84:87], v[148:151], a[76:79], v[84:87]
s_mul_i32 s53, s53, 6144
s_waitcnt lgkmcnt(9)
ds_read_b128 v[184:187], v7 offset:6144
v_mfma_f32_16x16x32_bf16 v[84:87], v[144:147], a[68:71], v[84:87]
buffer_load_dwordx4 a[216:219], v14, s[24:27], s65 offen offset:2048 sc1
v_mfma_f32_16x16x32_bf16 v[88:91], v[152:155], a[64:67], v[88:91]
ds_read_b128 v[188:191], v7 offset:7168
v_mfma_f32_16x16x32_bf16 v[88:91], v[156:159], a[72:75], v[88:91]
s_add_u32 s53, s53, s69
s_waitcnt lgkmcnt(8)
v_mfma_f32_16x16x32_bf16 v[92:95], v[156:159], a[76:79], v[92:95]
ds_write_b64 v11, a[118:119] offset:1032
v_mfma_f32_16x16x32_bf16 v[92:95], v[152:155], a[68:71], v[92:95]
buffer_load_dwordx4 a[212:215], v14, s[24:27], s93 offen offset:0 sc1
v_mfma_f32_16x16x32_bf16 v[96:99], v[160:163], a[64:67], v[96:99]
s_add_u32 s53, s53, 2048
ds_read_b128 v[144:147], v7 offset:8192
v_mfma_f32_16x16x32_bf16 v[96:99], v[164:167], a[72:75], v[96:99]
ds_read_b128 v[148:151], v7 offset:9216
v_mfma_f32_16x16x32_bf16 v[100:103], v[164:167], a[76:79], v[100:103]
ds_write_b64 v11, a[120:121] offset:2048
v_mfma_f32_16x16x32_bf16 v[100:103], v[160:163], a[68:71], v[100:103]
s_add_u32 s54, s84, 3
s_waitcnt lgkmcnt(10)
ds_read_b128 v[152:155], v7 offset:10240
v_mfma_f32_16x16x32_bf16 v[104:107], v[168:171], a[64:67], v[104:107]
ds_read_b128 v[156:159], v7 offset:11264
v_mfma_f32_16x16x32_bf16 v[104:107], v[172:175], a[72:75], v[104:107]
buffer_load_dwordx4 a[220:223], v14, s[24:27], s93 offen offset:2048 sc1
v_mfma_f32_16x16x32_bf16 v[108:111], v[172:175], a[76:79], v[108:111]
s_and_b32 s54, s54, 3
s_waitcnt lgkmcnt(9)
ds_read_b128 v[160:163], v7 offset:12288
v_mfma_f32_16x16x32_bf16 v[108:111], v[168:171], a[68:71], v[108:111]
ds_write_b64 v11, a[122:123] offset:2056
v_mfma_f32_16x16x32_bf16 v[112:115], v[176:179], a[64:67], v[112:115]
ds_read_b128 v[164:167], v7 offset:13312
v_mfma_f32_16x16x32_bf16 v[112:115], v[180:183], a[72:75], v[112:115]
s_mul_i32 s54, s54, 6144
s_xor_b32 s65, s82, 32768
s_add_u32 s65, s65, s77
v_mfma_f32_16x16x32_bf16 v[116:119], v[180:183], a[76:79], v[116:119]
s_waitcnt lgkmcnt(9) vmcnt(10)
ds_read_b128 v[168:171], v7 offset:14336
v_mfma_f32_16x16x32_bf16 v[116:119], v[176:179], a[68:71], v[116:119]
ds_write_b64 v11, a[124:125] offset:3072
v_mfma_f32_16x16x32_bf16 v[120:123], v[184:187], a[80:83], v[120:123]
s_add_u32 s54, s54, s69
s_waitcnt vmcnt(8)
ds_read_b128 v[172:175], v7 offset:15360
v_mfma_f32_16x16x32_bf16 v[120:123], v[188:191], a[88:91], v[120:123]
buffer_load_dwordx4 a[224:227], v4, s[24:27], s65 offen offset:0 sc1
v_mfma_f32_16x16x32_bf16 v[124:127], v[188:191], a[92:95], v[124:127]
s_add_u32 s91, s91, 16384
ds_read_b128 v[176:179], v8 offset:0
v_mfma_f32_16x16x32_bf16 v[124:127], v[184:187], a[84:87], v[124:127]
s_add_u32 s54, s54, 4096
s_waitcnt lgkmcnt(10)
v_mfma_f32_16x16x32_bf16 v[72:75], v[144:147], a[80:83], v[72:75]
ds_write_b64 v11, a[126:127] offset:3080
v_mfma_f32_16x16x32_bf16 v[72:75], v[148:151], a[88:91], v[72:75]
s_waitcnt lgkmcnt(5)
ds_read_b128 v[180:183], v8 offset:1024
v_add_u32 v11, s70, v4
v_mfma_f32_16x16x32_bf16 v[76:79], v[148:151], a[92:95], v[76:79]
s_sub_u32 s55, s3, s84
s_add_u32 s70, s70, 16384
ds_read_b128 v[184:187], v8 offset:2048
v_mfma_f32_16x16x32_bf16 v[76:79], v[144:147], a[84:87], v[76:79]
s_cmp_ge_u32 s70, 163840
s_cselect_b32 s70, s80, s70
s_waitcnt lgkmcnt(10)
v_mfma_f32_16x16x32_bf16 v[80:83], v[152:155], a[80:83], v[80:83]
buffer_load_dwordx4 a[232:235], v4, s[24:27], s65 offen offset:2048 sc1
v_mfma_f32_16x16x32_bf16 v[80:83], v[156:159], a[88:91], v[80:83]
s_and_b32 s55, s55, 3
s_xor_b32 s93, s82, 32768
s_add_u32 s93, s93, s81
v_mfma_f32_16x16x32_bf16 v[84:87], v[156:159], a[92:95], v[84:87]
ds_write_b64 v11, a[128:129] offset:0
v_mfma_f32_16x16x32_bf16 v[84:87], v[152:155], a[84:87], v[84:87]
buffer_load_dwordx4 a[228:231], v4, s[24:27], s93 offen offset:0 sc1
v_mfma_f32_16x16x32_bf16 v[88:91], v[160:163], a[80:83], v[88:91]
s_lshl_b32 s55, s55, 10
ds_read_b128 v[188:191], v8 offset:3072
v_mfma_f32_16x16x32_bf16 v[88:91], v[164:167], a[88:91], v[88:91]
s_cmp_ge_u32 s91, 163840
s_cselect_b32 s91, 0, s91
ds_read_b128 v[144:147], v8 offset:4096
v_mfma_f32_16x16x32_bf16 v[92:95], v[164:167], a[92:95], v[92:95]
ds_write_b64 v11, a[130:131] offset:8
v_mfma_f32_16x16x32_bf16 v[92:95], v[160:163], a[84:87], v[92:95]
s_add_u32 s55, s55, s69
s_waitcnt lgkmcnt(8)
ds_read_b128 v[148:151], v8 offset:5120
v_mfma_f32_16x16x32_bf16 v[96:99], v[168:171], a[80:83], v[96:99]
buffer_load_dwordx4 a[236:239], v4, s[24:27], s93 offen offset:2048 sc1
v_mfma_f32_16x16x32_bf16 v[96:99], v[172:175], a[88:91], v[96:99]
ds_read_b128 v[152:155], v8 offset:6144
v_add_u32 v7, s91, v4
v_mfma_f32_16x16x32_bf16 v[100:103], v[172:175], a[92:95], v[100:103]
s_add_u32 s55, s55, 23552
s_waitcnt lgkmcnt(7)
ds_read_b128 v[156:159], v8 offset:7168
v_mfma_f32_16x16x32_bf16 v[100:103], v[168:171], a[84:87], v[100:103]
ds_write_b64 v11, a[132:133] offset:1024
v_mfma_f32_16x16x32_bf16 v[104:107], v[176:179], a[80:83], v[104:107]
ds_read_b128 v[160:163], v8 offset:8192
v_mfma_f32_16x16x32_bf16 v[104:107], v[180:183], a[88:91], v[104:107]
s_add_u32 s71, s69, 24576
s_waitcnt lgkmcnt(7)
ds_read_b128 v[164:167], v8 offset:9216
v_mfma_f32_16x16x32_bf16 v[108:111], v[180:183], a[92:95], v[108:111]
buffer_load_dwordx4 a[240:243], v14, s[24:27], s65 offen offset:0 sc1
v_mfma_f32_16x16x32_bf16 v[108:111], v[176:179], a[84:87], v[108:111]
ds_write_b64 v11, a[134:135] offset:1032
v_mfma_f32_16x16x32_bf16 v[112:115], v[184:187], a[80:83], v[112:115]
s_cmp_eq_u32 s3, s84
s_cselect_b32 s55, 2147418112, s55
s_cselect_b32 s71, s71, 2147418112
v_mfma_f32_16x16x32_bf16 v[112:115], v[188:191], a[88:91], v[112:115]
ds_read_b128 v[168:171], v8 offset:10240
v_mfma_f32_16x16x32_bf16 v[116:119], v[188:191], a[92:95], v[116:119]
s_waitcnt vmcnt(9)
ds_read_b128 v[172:175], v8 offset:11264
v_mfma_f32_16x16x32_bf16 v[116:119], v[184:187], a[84:87], v[116:119]
s_mul_i32 s83, s84, 6144
s_waitcnt lgkmcnt(8) vmcnt(11)
ds_read_b128 v[176:179], v8 offset:12288
v_mfma_f32_16x16x32_bf16 v[120:123], v[144:147], a[192:195], v[120:123]
ds_write_b64 v11, a[136:137] offset:2048
v_mfma_f32_16x16x32_bf16 v[120:123], v[148:151], a[200:203], v[120:123]
buffer_load_dwordx4 a[248:251], v14, s[24:27], s65 offen offset:2048 sc1
v_mfma_f32_16x16x32_bf16 v[124:127], v[148:151], a[204:207], v[124:127]
s_add_u32 s69, s69, s83
ds_read_b128 v[180:183], v8 offset:13312
v_mfma_f32_16x16x32_bf16 v[124:127], v[144:147], a[196:199], v[124:127]
s_waitcnt lgkmcnt(9)
ds_read_b128 v[184:187], v8 offset:14336
v_mfma_f32_16x16x32_bf16 v[72:75], v[152:155], a[192:195], v[72:75]
s_waitcnt vmcnt(51)
ds_read_b128 v[188:191], v8 offset:15360
v_mfma_f32_16x16x32_bf16 v[72:75], v[156:159], a[200:203], v[72:75]
s_barrier
v_mfma_f32_16x16x32_bf16 v[76:79], v[156:159], a[204:207], v[76:79]
s_add_u32 s83, s69, 4096
s_waitcnt lgkmcnt(8)
ds_read_b128 v[144:147], v7 offset:0
v_mfma_f32_16x16x32_bf16 v[76:79], v[152:155], a[196:199], v[76:79]
ds_write_b64 v11, a[138:139] offset:2056
v_mfma_f32_16x16x32_bf16 v[80:83], v[160:163], a[192:195], v[80:83]
buffer_load_dwordx4 a[244:247], v14, s[24:27], s93 offen offset:0 sc1
v_mfma_f32_16x16x32_bf16 v[80:83], v[164:167], a[200:203], v[80:83]
s_add_u32 s91, s91, 16384
ds_read_b128 v[148:151], v7 offset:1024
v_mfma_f32_16x16x32_bf16 v[84:87], v[164:167], a[204:207], v[84:87]
s_waitcnt lgkmcnt(8)
ds_read_b128 v[152:155], v7 offset:2048
v_mfma_f32_16x16x32_bf16 v[84:87], v[160:163], a[196:199], v[84:87]
ds_write_b64 v11, a[140:141] offset:3072
v_mfma_f32_16x16x32_bf16 v[88:91], v[168:171], a[192:195], v[88:91]
buffer_load_dwordx4 a[252:255], v14, s[24:27], s93 offen offset:2048 sc1
v_mfma_f32_16x16x32_bf16 v[88:91], v[172:175], a[200:203], v[88:91]
s_waitcnt lgkmcnt(7)
ds_read_b128 v[156:159], v7 offset:3072
v_mfma_f32_16x16x32_bf16 v[92:95], v[172:175], a[204:207], v[92:95]
s_xor_b32 s65, s82, 40960
s_add_u32 s65, s65, s77
ds_read_b128 v[160:163], v7 offset:4096
v_mfma_f32_16x16x32_bf16 v[92:95], v[168:171], a[196:199], v[92:95]
ds_write_b64 v11, a[142:143] offset:3080
v_mfma_f32_16x16x32_bf16 v[96:99], v[176:179], a[192:195], v[96:99]
s_add_u32 s68, s68, 49152
ds_read_b128 v[164:167], v7 offset:5120
v_mfma_f32_16x16x32_bf16 v[96:99], v[180:183], a[200:203], v[96:99]
buffer_load_dwordx4 a[96:99], v4, s[24:27], s65 offen offset:0 sc1
v_mfma_f32_16x16x32_bf16 v[100:103], v[180:183], a[204:207], v[100:103]
s_cmp_ge_u32 s91, 163840
s_cselect_b32 s91, 0, s91
ds_read_b128 v[168:171], v7 offset:6144
v_mfma_f32_16x16x32_bf16 v[100:103], v[176:179], a[196:199], v[100:103]
s_waitcnt lgkmcnt(10)
v_add_u32 v8, s91, v4
v_mfma_f32_16x16x32_bf16 v[104:107], v[184:187], a[192:195], v[104:107]
ds_read_b128 v[172:175], v7 offset:7168
v_mfma_f32_16x16x32_bf16 v[104:107], v[188:191], a[200:203], v[104:107]
v_mfma_f32_16x16x32_bf16 v[108:111], v[188:191], a[204:207], v[108:111]
buffer_load_dwordx4 a[104:107], v4, s[24:27], s65 offen offset:2048 sc1
v_mfma_f32_16x16x32_bf16 v[108:111], v[184:187], a[196:199], v[108:111]
s_waitcnt lgkmcnt(8)
ds_read_b128 v[176:179], v7 offset:8192
v_mfma_f32_16x16x32_bf16 v[112:115], v[144:147], a[192:195], v[112:115]
ds_read_b128 v[180:183], v7 offset:9216
v_mfma_f32_16x16x32_bf16 v[112:115], v[148:151], a[200:203], v[112:115]
v_mfma_f32_16x16x32_bf16 v[116:119], v[148:151], a[204:207], v[116:119]
s_xor_b32 s93, s82, 40960
s_add_u32 s93, s93, s81
ds_read_b128 v[184:187], v7 offset:10240
v_mfma_f32_16x16x32_bf16 v[116:119], v[144:147], a[196:199], v[116:119]
s_waitcnt lgkmcnt(8) vmcnt(12)
v_mfma_f32_16x16x32_bf16 v[120:123], v[152:155], a[208:211], v[120:123]
buffer_load_dwordx4 a[100:103], v4, s[24:27], s93 offen offset:0 sc1
v_mfma_f32_16x16x32_bf16 v[120:123], v[156:159], a[216:219], v[120:123]
s_waitcnt vmcnt(11)
ds_read_b128 v[188:191], v7 offset:11264
v_mfma_f32_16x16x32_bf16 v[124:127], v[156:159], a[220:223], v[124:127]
ds_read_b128 v[144:147], v7 offset:12288
v_mfma_f32_16x16x32_bf16 v[124:127], v[152:155], a[212:215], v[124:127]
s_waitcnt lgkmcnt(7)
v_mfma_f32_16x16x32_bf16 v[72:75], v[160:163], a[208:211], v[72:75]
ds_read_b128 v[148:151], v7 offset:13312
v_mfma_f32_16x16x32_bf16 v[72:75], v[164:167], a[216:219], v[72:75]
v_mov_b32 v13, 0xffff0000
v_mul_u32_u24 v5, 1152, v2
v_mfma_f32_16x16x32_bf16 v[76:79], v[164:167], a[220:223], v[76:79]
buffer_load_dwordx4 a[108:111], v4, s[24:27], s93 offen offset:2048 sc1
v_mfma_f32_16x16x32_bf16 v[76:79], v[160:163], a[212:215], v[76:79]
s_waitcnt lgkmcnt(6)
ds_read_b128 v[152:155], v7 offset:14336
v_lshl_add_u32 v6, v3, 3, v5
v_mfma_f32_16x16x32_bf16 v[80:83], v[168:171], a[208:211], v[80:83]
ds_read_b128 v[156:159], v7 offset:15360
v_and_b32 v9, 1, v3
v_mfma_f32_16x16x32_bf16 v[80:83], v[172:175], a[216:219], v[80:83]
s_add_u32 s91, s91, 16384
s_cmp_ge_u32 s91, 163840
s_cselect_b32 s91, 0, s91
v_mfma_f32_16x16x32_bf16 v[84:87], v[172:175], a[220:223], v[84:87]
s_waitcnt lgkmcnt(6)
ds_read_b128 v[160:163], v8 offset:0
v_add_u32 v7, s91, v4
v_mfma_f32_16x16x32_bf16 v[84:87], v[168:171], a[212:215], v[84:87]
buffer_load_dwordx4 a[112:115], v14, s[24:27], s65 offen offset:0 sc1
v_mfma_f32_16x16x32_bf16 v[88:91], v[176:179], a[208:211], v[88:91]
ds_read_b128 v[164:167], v8 offset:1024
v_lshl_add_u32 v5, v9, 5, v5
v_mfma_f32_16x16x32_bf16 v[88:91], v[180:183], a[216:219], v[88:91]
v_lshrrev_b32 v9, 1, v3
v_lshl_add_u32 v5, v9, 4, v5
v_mfma_f32_16x16x32_bf16 v[92:95], v[180:183], a[220:223], v[92:95]
ds_read_b128 v[168:171], v8 offset:2048
v_mfma_f32_16x16x32_bf16 v[92:95], v[176:179], a[212:215], v[92:95]
s_waitcnt lgkmcnt(7)
v_mfma_f32_16x16x32_bf16 v[96:99], v[184:187], a[208:211], v[96:99]
ds_read_b128 v[172:175], v8 offset:3072
v_mfma_f32_16x16x32_bf16 v[96:99], v[188:191], a[216:219], v[96:99]
buffer_load_dwordx4 a[120:123], v14, s[24:27], s65 offen offset:2048 sc1
v_mfma_f32_16x16x32_bf16 v[100:103], v[188:191], a[220:223], v[100:103]
ds_read_b128 v[176:179], v8 offset:4096
v_mfma_f32_16x16x32_bf16 v[100:103], v[184:187], a[212:215], v[100:103]
s_waitcnt lgkmcnt(7)
v_mfma_f32_16x16x32_bf16 v[104:107], v[144:147], a[208:211], v[104:107]
ds_read_b128 v[180:183], v8 offset:5120
v_mfma_f32_16x16x32_bf16 v[104:107], v[148:151], a[216:219], v[104:107]
v_mfma_f32_16x16x32_bf16 v[108:111], v[148:151], a[220:223], v[108:111]
s_waitcnt lgkmcnt(6)
ds_read_b128 v[184:187], v8 offset:6144
v_mfma_f32_16x16x32_bf16 v[108:111], v[144:147], a[212:215], v[108:111]
buffer_load_dwordx4 a[116:119], v14, s[24:27], s93 offen offset:0 sc1
v_mfma_f32_16x16x32_bf16 v[112:115], v[152:155], a[208:211], v[112:115]
ds_read_b128 v[188:191], v8 offset:7168
v_mfma_f32_16x16x32_bf16 v[112:115], v[156:159], a[216:219], v[112:115]
v_mfma_f32_16x16x32_bf16 v[116:119], v[156:159], a[220:223], v[116:119]
ds_read_b128 v[144:147], v8 offset:8192
v_mfma_f32_16x16x32_bf16 v[116:119], v[152:155], a[212:215], v[116:119]
s_waitcnt lgkmcnt(7) vmcnt(13)
v_mfma_f32_16x16x32_bf16 v[120:123], v[160:163], a[224:227], v[120:123]
buffer_load_dwordx4 a[124:127], v14, s[24:27], s93 offen offset:2048 sc1
v_mfma_f32_16x16x32_bf16 v[120:123], v[164:167], a[232:235], v[120:123]
s_waitcnt vmcnt(12)
ds_read_b128 v[148:151], v8 offset:9216
v_mfma_f32_16x16x32_bf16 v[124:127], v[164:167], a[236:239], v[124:127]
ds_read_b128 v[152:155], v8 offset:10240
v_mfma_f32_16x16x32_bf16 v[124:127], v[160:163], a[228:231], v[124:127]
s_waitcnt lgkmcnt(7)
v_mfma_f32_16x16x32_bf16 v[72:75], v[168:171], a[224:227], v[72:75]
s_xor_b32 s65, s82, 49152
s_add_u32 s65, s65, s77
ds_read_b128 v[156:159], v8 offset:11264
v_mfma_f32_16x16x32_bf16 v[72:75], v[172:175], a[232:235], v[72:75]
v_mfma_f32_16x16x32_bf16 v[76:79], v[172:175], a[236:239], v[76:79]
buffer_load_dwordx4 a[128:131], v4, s[24:27], s65 offen offset:0 sc1
v_mfma_f32_16x16x32_bf16 v[76:79], v[168:171], a[228:231], v[76:79]
s_waitcnt lgkmcnt(6)
ds_read_b128 v[160:163], v8 offset:12288
v_mfma_f32_16x16x32_bf16 v[80:83], v[176:179], a[224:227], v[80:83]
ds_read_b128 v[164:167], v8 offset:13312
v_mfma_f32_16x16x32_bf16 v[80:83], v[180:183], a[232:235], v[80:83]
v_mfma_f32_16x16x32_bf16 v[84:87], v[180:183], a[236:239], v[84:87]
ds_read_b128 v[168:171], v8 offset:14336
v_mfma_f32_16x16x32_bf16 v[84:87], v[176:179], a[228:231], v[84:87]
s_waitcnt lgkmcnt(7)
v_mfma_f32_16x16x32_bf16 v[88:91], v[184:187], a[224:227], v[88:91]
s_waitcnt vmcnt(53)
ds_read_b128 v[172:175], v8 offset:15360
v_mfma_f32_16x16x32_bf16 v[88:91], v[188:191], a[232:235], v[88:91]
s_barrier
v_mfma_f32_16x16x32_bf16 v[92:95], v[188:191], a[236:239], v[92:95]
buffer_load_dwordx4 a[136:139], v4, s[24:27], s65 offen offset:2048 sc1
v_mfma_f32_16x16x32_bf16 v[92:95], v[184:187], a[228:231], v[92:95]
s_waitcnt lgkmcnt(6)
s_add_u32 s91, s91, 16384
ds_read_b128 v[176:179], v7 offset:0
v_mfma_f32_16x16x32_bf16 v[96:99], v[144:147], a[224:227], v[96:99]
s_xor_b32 s93, s82, 49152
s_add_u32 s93, s93, s81
ds_read_b128 v[180:183], v7 offset:1024
v_mfma_f32_16x16x32_bf16 v[96:99], v[148:151], a[232:235], v[96:99]
s_cmp_ge_u32 s91, 163840
s_cselect_b32 s91, 0, s91
v_add_u32 v8, s91, v4
v_mfma_f32_16x16x32_bf16 v[100:103], v[148:151], a[236:239], v[100:103]
buffer_load_dwordx4 a[132:135], v4, s[24:27], s93 offen offset:0 sc1
v_mfma_f32_16x16x32_bf16 v[100:103], v[144:147], a[228:231], v[100:103]
s_waitcnt lgkmcnt(6) vmcnt(13)
ds_read_b128 v[184:187], v7 offset:2048
v_mfma_f32_16x16x32_bf16 v[120:123], v[152:155], a[240:243], v[120:123]
ds_read_b128 v[188:191], v7 offset:3072
v_mfma_f32_16x16x32_bf16 v[120:123], v[156:159], a[248:251], v[120:123]
s_waitcnt vmcnt(11)
v_mfma_f32_16x16x32_bf16 v[124:127], v[156:159], a[252:255], v[124:127]
buffer_load_dwordx4 a[140:143], v4, s[24:27], s93 offen offset:2048 sc1
v_mfma_f32_16x16x32_bf16 v[124:127], v[152:155], a[244:247], v[124:127]
s_waitcnt lgkmcnt(6)
ds_read_b128 v[144:147], v7 offset:4096
v_mfma_f32_16x16x32_bf16 v[72:75], v[160:163], a[240:243], v[72:75]
ds_read_b128 v[148:151], v7 offset:5120
v_mfma_f32_16x16x32_bf16 v[72:75], v[164:167], a[248:251], v[72:75]
v_mfma_f32_16x16x32_bf16 v[76:79], v[164:167], a[252:255], v[76:79]
ds_read_b128 v[152:155], v7 offset:6144
v_mfma_f32_16x16x32_bf16 v[76:79], v[160:163], a[244:247], v[76:79]
s_waitcnt lgkmcnt(7)
v_mfma_f32_16x16x32_bf16 v[80:83], v[168:171], a[240:243], v[80:83]
ds_read_b128 v[156:159], v7 offset:7168
v_mfma_f32_16x16x32_bf16 v[80:83], v[172:175], a[248:251], v[80:83]
buffer_load_dwordx4 a[144:147], v14, s[24:27], s65 offen offset:0 sc1
v_mfma_f32_16x16x32_bf16 v[84:87], v[172:175], a[252:255], v[84:87]
buffer_load_dword v12, v10, s[24:27], s75 offen offset:4 sc1
v_mfma_f32_16x16x32_bf16 v[84:87], v[168:171], a[244:247], v[84:87]
s_waitcnt lgkmcnt(6)
ds_read_b128 v[160:163], v7 offset:8192
v_mfma_f32_16x16x32_bf16 v[88:91], v[176:179], a[240:243], v[88:91]
ds_read_b128 v[164:167], v7 offset:9216
v_mfma_f32_16x16x32_bf16 v[88:91], v[180:183], a[248:251], v[88:91]
v_mfma_f32_16x16x32_bf16 v[92:95], v[180:183], a[252:255], v[92:95]
buffer_load_dwordx4 a[152:155], v14, s[24:27], s65 offen offset:2048 sc1
v_mfma_f32_16x16x32_bf16 v[92:95], v[176:179], a[244:247], v[92:95]
s_waitcnt lgkmcnt(6)
ds_read_b128 v[168:171], v7 offset:10240
v_mfma_f32_16x16x32_bf16 v[96:99], v[184:187], a[240:243], v[96:99]
ds_read_b128 v[172:175], v7 offset:11264
v_mfma_f32_16x16x32_bf16 v[96:99], v[188:191], a[248:251], v[96:99]
v_mfma_f32_16x16x32_bf16 v[100:103], v[188:191], a[252:255], v[100:103]
buffer_load_dwordx4 a[148:151], v14, s[24:27], s93 offen offset:0 sc1
v_mfma_f32_16x16x32_bf16 v[100:103], v[184:187], a[244:247], v[100:103]
s_waitcnt lgkmcnt(6) vmcnt(14)
ds_read_b128 v[176:179], v7 offset:12288
v_mfma_f32_16x16x32_bf16 v[120:123], v[144:147], a[96:99], v[120:123]
ds_read_b128 v[180:183], v7 offset:13312
v_mfma_f32_16x16x32_bf16 v[120:123], v[148:151], a[104:107], v[120:123]
s_waitcnt vmcnt(12)
v_mfma_f32_16x16x32_bf16 v[124:127], v[148:151], a[108:111], v[124:127]
buffer_load_dwordx4 a[156:159], v14, s[24:27], s93 offen offset:2048 sc1
v_mfma_f32_16x16x32_bf16 v[124:127], v[144:147], a[100:103], v[124:127]
s_waitcnt lgkmcnt(6)
ds_read_b128 v[184:187], v7 offset:14336
v_mfma_f32_16x16x32_bf16 v[72:75], v[152:155], a[96:99], v[72:75]
ds_read_b128 v[188:191], v7 offset:15360
v_mfma_f32_16x16x32_bf16 v[72:75], v[156:159], a[104:107], v[72:75]
s_add_u32 s91, s91, 16384
s_cmp_ge_u32 s91, 163840
s_cselect_b32 s91, 0, s91
v_mfma_f32_16x16x32_bf16 v[76:79], v[156:159], a[108:111], v[76:79]
ds_read_b128 v[144:147], v8 offset:0
v_add_u32 v7, s91, v4
v_mfma_f32_16x16x32_bf16 v[76:79], v[152:155], a[100:103], v[76:79]
s_waitcnt lgkmcnt(7)
v_mfma_f32_16x16x32_bf16 v[80:83], v[160:163], a[96:99], v[80:83]
s_xor_b32 s65, s82, 57344
s_add_u32 s65, s65, s77
ds_read_b128 v[148:151], v8 offset:1024
v_mfma_f32_16x16x32_bf16 v[80:83], v[164:167], a[104:107], v[80:83]
v_mfma_f32_16x16x32_bf16 v[84:87], v[164:167], a[108:111], v[84:87]
buffer_load_dwordx4 a[160:163], v4, s[24:27], s65 offen offset:0 sc1
v_mfma_f32_16x16x32_bf16 v[84:87], v[160:163], a[100:103], v[84:87]
s_waitcnt lgkmcnt(6)
ds_read_b128 v[152:155], v8 offset:2048
v_mfma_f32_16x16x32_bf16 v[88:91], v[168:171], a[96:99], v[88:91]
ds_read_b128 v[156:159], v8 offset:3072
v_mfma_f32_16x16x32_bf16 v[88:91], v[172:175], a[104:107], v[88:91]
v_mfma_f32_16x16x32_bf16 v[92:95], v[172:175], a[108:111], v[92:95]
buffer_load_dwordx4 a[168:171], v4, s[24:27], s65 offen offset:2048 sc1
v_mfma_f32_16x16x32_bf16 v[92:95], v[168:171], a[100:103], v[92:95]
s_waitcnt lgkmcnt(6)
ds_read_b128 v[160:163], v8 offset:4096
v_mfma_f32_16x16x32_bf16 v[96:99], v[176:179], a[96:99], v[96:99]
s_xor_b32 s93, s82, 57344
s_add_u32 s93, s93, s81
ds_read_b128 v[164:167], v8 offset:5120
v_mfma_f32_16x16x32_bf16 v[96:99], v[180:183], a[104:107], v[96:99]
v_mfma_f32_16x16x32_bf16 v[100:103], v[180:183], a[108:111], v[100:103]
buffer_load_dwordx4 a[164:167], v4, s[24:27], s93 offen offset:0 sc1
v_mfma_f32_16x16x32_bf16 v[100:103], v[176:179], a[100:103], v[100:103]
s_waitcnt lgkmcnt(6) vmcnt(14)
ds_read_b128 v[168:171], v8 offset:6144
v_mfma_f32_16x16x32_bf16 v[120:123], v[184:187], a[112:115], v[120:123]
ds_read_b128 v[172:175], v8 offset:7168
v_mfma_f32_16x16x32_bf16 v[120:123], v[188:191], a[120:123], v[120:123]
s_waitcnt vmcnt(12)
v_mfma_f32_16x16x32_bf16 v[124:127], v[188:191], a[124:127], v[124:127]
buffer_load_dwordx4 a[172:175], v4, s[24:27], s93 offen offset:2048 sc1
v_mfma_f32_16x16x32_bf16 v[124:127], v[184:187], a[116:119], v[124:127]
s_waitcnt lgkmcnt(6)
ds_read_b128 v[176:179], v8 offset:8192
v_mfma_f32_16x16x32_bf16 v[72:75], v[144:147], a[112:115], v[72:75]
s_mov_b32 m0, s70
s_mov_b32 s64, s68
s_add_u32 s68, s68, 16384
v_mfma_f32_16x16x32_bf16 v[72:75], v[148:151], a[120:123], v[72:75]
s_waitcnt lgkmcnt(5)
ds_read_b128 v[180:183], v8 offset:9216
v_mfma_f32_16x16x32_bf16 v[76:79], v[148:151], a[124:127], v[76:79]
s_add_u32 s70, s70, 16384
s_cmp_ge_u32 s70, 163840
s_cselect_b32 s70, s80, s70
v_mfma_f32_16x16x32_bf16 v[76:79], v[144:147], a[116:119], v[76:79]
buffer_load_dwordx4 v4, s[24:27], s64 offen offset:0 sc1 lds
v_mfma_f32_16x16x32_bf16 v[80:83], v[152:155], a[112:115], v[80:83]
ds_read_b128 v[184:187], v8 offset:10240
v_mfma_f32_16x16x32_bf16 v[80:83], v[156:159], a[120:123], v[80:83]
ds_read_b128 v[188:191], v8 offset:11264
v_mfma_f32_16x16x32_bf16 v[84:87], v[156:159], a[124:127], v[84:87]
buffer_load_dwordx4 v4, s[24:27], s64 offen offset:1024 sc1 lds
v_mfma_f32_16x16x32_bf16 v[84:87], v[152:155], a[116:119], v[84:87]
s_waitcnt lgkmcnt(6)
ds_read_b128 v[144:147], v8 offset:12288
v_mfma_f32_16x16x32_bf16 v[88:91], v[160:163], a[112:115], v[88:91]
ds_read_b128 v[148:151], v8 offset:13312
v_mfma_f32_16x16x32_bf16 v[88:91], v[164:167], a[120:123], v[88:91]
buffer_load_dwordx4 a[176:179], v14, s[24:27], s65 offen offset:0 sc1
v_mfma_f32_16x16x32_bf16 v[92:95], v[164:167], a[124:127], v[92:95]
ds_read_b128 v[152:155], v8 offset:14336
v_mfma_f32_16x16x32_bf16 v[92:95], v[160:163], a[116:119], v[92:95]
s_waitcnt lgkmcnt(7)
v_mfma_f32_16x16x32_bf16 v[96:99], v[168:171], a[112:115], v[96:99]
s_waitcnt vmcnt(10)
ds_read_b128 v[156:159], v8 offset:15360
v_mfma_f32_16x16x32_bf16 v[96:99], v[172:175], a[120:123], v[96:99]
s_barrier
v_mfma_f32_16x16x32_bf16 v[100:103], v[172:175], a[124:127], v[100:103]
s_waitcnt lgkmcnt(6) vmcnt(14)
ds_read_b128 v[160:163], v7 offset:0
v_cmp_gt_u32 vcc, 8, v12
v_mfma_f32_16x16x32_bf16 v[100:103], v[168:171], a[116:119], v[100:103]
buffer_load_dwordx4 v4, s[24:27], s64 offen offset:2048 sc1 lds
v_mfma_f32_16x16x32_bf16 v[120:123], v[176:179], a[128:131], v[120:123]
s_add_u32 s91, s91, 16384
ds_read_b128 v[164:167], v7 offset:1024
v_mfma_f32_16x16x32_bf16 v[120:123], v[180:183], a[136:139], v[120:123]
s_waitcnt lgkmcnt(6) vmcnt(13)
s_cmp_ge_u32 s91, 163840
s_cselect_b32 s91, 0, s91
v_mfma_f32_16x16x32_bf16 v[124:127], v[180:183], a[140:143], v[124:127]
buffer_load_dwordx4 a[184:187], v14, s[24:27], s65 offen offset:2048 sc1
v_mfma_f32_16x16x32_bf16 v[124:127], v[176:179], a[132:135], v[124:127]
s_cbranch_vccnz CK_ZAA
CK_ZAA_R:
v_mfma_f32_16x16x32_bf16 v[72:75], v[184:187], a[128:131], v[72:75]
ds_read_b128 v[168:171], v7 offset:2048
v_add_u32 v8, s91, v4
v_mfma_f32_16x16x32_bf16 v[72:75], v[188:191], a[136:139], v[72:75]
buffer_load_dwordx4 v4, s[24:27], s64 offen offset:3072 sc1 lds
v_mfma_f32_16x16x32_bf16 v[76:79], v[188:191], a[140:143], v[76:79]
ds_read_b128 v[172:175], v7 offset:3072
v_mfma_f32_16x16x32_bf16 v[76:79], v[184:187], a[132:135], v[76:79]
s_waitcnt lgkmcnt(6)
ds_read_b128 v[176:179], v7 offset:4096
v_mfma_f32_16x16x32_bf16 v[80:83], v[144:147], a[128:131], v[80:83]
buffer_load_dwordx4 a[180:183], v14, s[24:27], s93 offen offset:0 sc1
v_mfma_f32_16x16x32_bf16 v[80:83], v[148:151], a[136:139], v[80:83]
ds_read_b128 v[180:183], v7 offset:5120
v_mfma_f32_16x16x32_bf16 v[84:87], v[148:151], a[140:143], v[84:87]
s_waitcnt lgkmcnt(6)
ds_read_b128 v[184:187], v7 offset:6144
v_mfma_f32_16x16x32_bf16 v[84:87], v[144:147], a[132:135], v[84:87]
buffer_load_dwordx4 a[188:191], v14, s[24:27], s93 offen offset:2048 sc1
v_mfma_f32_16x16x32_bf16 v[88:91], v[152:155], a[128:131], v[88:91]
s_add_u32 s65, s77, 65536
ds_read_b128 v[188:191], v7 offset:7168
v_mfma_f32_16x16x32_bf16 v[88:91], v[156:159], a[136:139], v[88:91]
v_mfma_f32_16x16x32_bf16 v[92:95], v[156:159], a[140:143], v[92:95]
buffer_load_dwordx4 v[32:35], v4, s[24:27], s65 offen offset:0 sc1
v_mfma_f32_16x16x32_bf16 v[92:95], v[152:155], a[132:135], v[92:95]
s_waitcnt lgkmcnt(6)
ds_read_b128 v[144:147], v7 offset:8192
v_mfma_f32_16x16x32_bf16 v[96:99], v[160:163], a[128:131], v[96:99]
ds_read_b128 v[148:151], v7 offset:9216
v_mfma_f32_16x16x32_bf16 v[96:99], v[164:167], a[136:139], v[96:99]
buffer_load_dwordx4 v[40:43], v4, s[24:27], s65 offen offset:2048 sc1
v_mfma_f32_16x16x32_bf16 v[100:103], v[164:167], a[140:143], v[100:103]
s_add_u32 s93, s81, 65536
ds_read_b128 v[152:155], v7 offset:10240
v_mfma_f32_16x16x32_bf16 v[100:103], v[160:163], a[132:135], v[100:103]
s_waitcnt lgkmcnt(7) vmcnt(16)
v_mfma_f32_16x16x32_bf16 v[120:123], v[168:171], a[144:147], v[120:123]
buffer_load_dwordx4 v[36:39], v4, s[24:27], s93 offen offset:0 sc1
v_mfma_f32_16x16x32_bf16 v[120:123], v[172:175], a[152:155], v[120:123]
s_waitcnt vmcnt(15)
ds_read_b128 v[156:159], v7 offset:11264
v_mfma_f32_16x16x32_bf16 v[124:127], v[172:175], a[156:159], v[124:127]
s_waitcnt lgkmcnt(6)
ds_read_b128 v[160:163], v7 offset:12288
v_mfma_f32_16x16x32_bf16 v[124:127], v[168:171], a[148:151], v[124:127]
buffer_load_dwordx4 v[44:47], v4, s[24:27], s93 offen offset:2048 sc1
v_mfma_f32_16x16x32_bf16 v[72:75], v[176:179], a[144:147], v[72:75]
ds_read_b128 v[164:167], v7 offset:13312
v_mfma_f32_16x16x32_bf16 v[72:75], v[180:183], a[152:155], v[72:75]
v_mfma_f32_16x16x32_bf16 v[76:79], v[180:183], a[156:159], v[76:79]
ds_read_b128 v[168:171], v7 offset:14336
v_mfma_f32_16x16x32_bf16 v[76:79], v[176:179], a[148:151], v[76:79]
s_waitcnt lgkmcnt(7)
v_mfma_f32_16x16x32_bf16 v[80:83], v[184:187], a[144:147], v[80:83]
ds_read_b128 v[172:175], v7 offset:15360
v_mfma_f32_16x16x32_bf16 v[80:83], v[188:191], a[152:155], v[80:83]
s_add_u32 s91, s91, 16384
s_cmp_ge_u32 s91, 163840
s_cselect_b32 s91, 0, s91
v_mfma_f32_16x16x32_bf16 v[84:87], v[188:191], a[156:159], v[84:87]
buffer_load_dwordx4 v[48:51], v14, s[24:27], s65 offen offset:0 sc1
v_mfma_f32_16x16x32_bf16 v[84:87], v[184:187], a[148:151], v[84:87]
s_waitcnt lgkmcnt(6)
ds_read_b128 v[176:179], v8 offset:0
v_add_u32 v7, s91, v4
v_mfma_f32_16x16x32_bf16 v[88:91], v[144:147], a[144:147], v[88:91]
ds_read_b128 v[180:183], v8 offset:1024
v_mfma_f32_16x16x32_bf16 v[88:91], v[148:151], a[152:155], v[88:91]
s_waitcnt lgkmcnt(6)
v_mfma_f32_16x16x32_bf16 v[92:95], v[148:151], a[156:159], v[92:95]
buffer_load_dwordx4 v[56:59], v14, s[24:27], s65 offen offset:2048 sc1
v_mfma_f32_16x16x32_bf16 v[92:95], v[144:147], a[148:151], v[92:95]
s_mov_b32 m0, s70
s_mov_b32 s64, s68
L_PAD12:
s_cbranch_execz L_MAIN
s_add_u32 s68, s68, 16384
v_mfma_f32_16x16x32_bf16 v[96:99], v[152:155], a[144:147], v[96:99]
ds_read_b128 v[184:187], v8 offset:2048
v_mfma_f32_16x16x32_bf16 v[96:99], v[156:159], a[152:155], v[96:99]
s_add_u32 s70, s70, 16384
s_cmp_ge_u32 s70, 163840
s_cselect_b32 s70, s80, s70
v_mfma_f32_16x16x32_bf16 v[100:103], v[156:159], a[156:159], v[100:103]
buffer_load_dwordx4 v4, s[24:27], s64 offen offset:0 sc1 lds
v_mfma_f32_16x16x32_bf16 v[100:103], v[152:155], a[148:151], v[100:103]
s_waitcnt lgkmcnt(5) vmcnt(17)
ds_read_b128 v[188:191], v8 offset:3072
v_mfma_f32_16x16x32_bf16 v[120:123], v[160:163], a[160:163], v[120:123]
s_waitcnt vmcnt(15)
ds_read_b128 v[144:147], v8 offset:4096
v_mfma_f32_16x16x32_bf16 v[120:123], v[164:167], a[168:171], v[120:123]
buffer_load_dwordx4 v[52:55], v14, s[24:27], s93 offen offset:0 sc1
v_mfma_f32_16x16x32_bf16 v[124:127], v[164:167], a[172:175], v[124:127]
ds_read_b128 v[148:151], v8 offset:5120
v_mfma_f32_16x16x32_bf16 v[124:127], v[160:163], a[164:167], v[124:127]
s_waitcnt lgkmcnt(6)
ds_read_b128 v[152:155], v8 offset:6144
v_mfma_f32_16x16x32_bf16 v[72:75], v[168:171], a[160:163], v[72:75]
buffer_load_dwordx4 v4, s[24:27], s64 offen offset:1024 sc1 lds
v_mfma_f32_16x16x32_bf16 v[72:75], v[172:175], a[168:171], v[72:75]
ds_read_b128 v[156:159], v8 offset:7168
v_mfma_f32_16x16x32_bf16 v[76:79], v[172:175], a[172:175], v[76:79]
s_waitcnt lgkmcnt(6)
ds_read_b128 v[160:163], v8 offset:8192
v_mfma_f32_16x16x32_bf16 v[76:79], v[168:171], a[164:167], v[76:79]
buffer_load_dwordx4 v[60:63], v14, s[24:27], s93 offen offset:2048 sc1
v_mfma_f32_16x16x32_bf16 v[80:83], v[176:179], a[160:163], v[80:83]
ds_read_b128 v[164:167], v8 offset:9216
v_mfma_f32_16x16x32_bf16 v[80:83], v[180:183], a[168:171], v[80:83]
v_mfma_f32_16x16x32_bf16 v[84:87], v[180:183], a[172:175], v[84:87]
buffer_load_dwordx4 v4, s[24:27], s64 offen offset:2048 sc1 lds
v_mfma_f32_16x16x32_bf16 v[84:87], v[176:179], a[164:167], v[84:87]
s_waitcnt lgkmcnt(6)
ds_read_b128 v[168:171], v8 offset:10240
v_mfma_f32_16x16x32_bf16 v[88:91], v[184:187], a[160:163], v[88:91]
ds_read_b128 v[172:175], v8 offset:11264
v_mfma_f32_16x16x32_bf16 v[88:91], v[188:191], a[168:171], v[88:91]
buffer_load_dwordx4 v4, s[24:27], s64 offen offset:3072 sc1 lds
v_mfma_f32_16x16x32_bf16 v[92:95], v[188:191], a[172:175], v[92:95]
s_mov_b32 m0, s70
s_mov_b32 s64, s68
s_add_u32 s68, s68, 16384
v_mfma_f32_16x16x32_bf16 v[92:95], v[184:187], a[164:167], v[92:95]
s_waitcnt lgkmcnt(6)
ds_read_b128 v[176:179], v8 offset:12288
v_mfma_f32_16x16x32_bf16 v[96:99], v[144:147], a[160:163], v[96:99]
s_add_u32 s70, s70, 16384
s_cmp_ge_u32 s70, 163840
s_cselect_b32 s70, s80, s70
v_mfma_f32_16x16x32_bf16 v[96:99], v[148:151], a[168:171], v[96:99]
buffer_load_dwordx4 v4, s[24:27], s64 offen offset:0 sc1 lds
v_mfma_f32_16x16x32_bf16 v[100:103], v[148:151], a[172:175], v[100:103]
ds_read_b128 v[180:183], v8 offset:13312
v_mfma_f32_16x16x32_bf16 v[100:103], v[144:147], a[164:167], v[100:103]
s_waitcnt lgkmcnt(6) vmcnt(16)
ds_read_b128 v[184:187], v8 offset:14336
v_mfma_f32_16x16x32_bf16 v[120:123], v[152:155], a[176:179], v[120:123]
s_waitcnt vmcnt(15)
s_waitcnt vmcnt(13)
ds_read_b128 v[188:191], v8 offset:15360
v_mfma_f32_16x16x32_bf16 v[120:123], v[156:159], a[184:187], v[120:123]
s_barrier
v_mfma_f32_16x16x32_bf16 v[124:127], v[156:159], a[188:191], v[124:127]
buffer_load_dwordx4 v4, s[24:27], s64 offen offset:1024 sc1 lds
v_mfma_f32_16x16x32_bf16 v[124:127], v[152:155], a[180:183], v[124:127]
s_add_u32 s65, s77, 73728
s_waitcnt lgkmcnt(6)
ds_read_b128 v[144:147], v7 offset:0
v_mfma_f32_16x16x32_bf16 v[72:75], v[160:163], a[176:179], v[72:75]
s_add_u32 s91, s91, 16384
ds_read_b128 v[148:151], v7 offset:1024
v_mfma_f32_16x16x32_bf16 v[72:75], v[164:167], a[184:187], v[72:75]
buffer_load_dwordx4 v[64:67], v4, s[24:27], s65 offen offset:0 sc1
v_mfma_f32_16x16x32_bf16 v[76:79], v[164:167], a[188:191], v[76:79]
s_cmp_ge_u32 s91, 163840
s_cselect_b32 s91, 0, s91
ds_read_b128 v[152:155], v7 offset:2048
v_mfma_f32_16x16x32_bf16 v[76:79], v[160:163], a[180:183], v[76:79]
s_waitcnt lgkmcnt(7)
v_add_u32 v8, s91, v4
v_mfma_f32_16x16x32_bf16 v[80:83], v[168:171], a[176:179], v[80:83]
buffer_load_dwordx4 v4, s[24:27], s64 offen offset:2048 sc1 lds
v_mfma_f32_16x16x32_bf16 v[80:83], v[172:175], a[184:187], v[80:83]
ds_read_b128 v[156:159], v7 offset:3072
v_mfma_f32_16x16x32_bf16 v[84:87], v[172:175], a[188:191], v[84:87]
s_waitcnt lgkmcnt(6)
ds_read_b128 v[160:163], v7 offset:4096
v_mfma_f32_16x16x32_bf16 v[84:87], v[168:171], a[180:183], v[84:87]
buffer_load_dwordx4 v4, s[24:27], s64 offen offset:3072 sc1 lds
v_mfma_f32_16x16x32_bf16 v[88:91], v[176:179], a[176:179], v[88:91]
s_add_u32 s93, s81, 73728
ds_read_b128 v[164:167], v7 offset:5120
v_mfma_f32_16x16x32_bf16 v[88:91], v[180:183], a[184:187], v[88:91]
v_mfma_f32_16x16x32_bf16 v[92:95], v[180:183], a[188:191], v[92:95]
buffer_load_dwordx4 v[68:71], v4, s[24:27], s93 offen offset:0 sc1
v_mfma_f32_16x16x32_bf16 v[92:95], v[176:179], a[180:183], v[92:95]
s_waitcnt lgkmcnt(6)
ds_read_b128 v[168:171], v7 offset:6144
v_mfma_f32_16x16x32_bf16 v[96:99], v[184:187], a[176:179], v[96:99]
ds_read_b128 v[172:175], v7 offset:7168
v_mfma_f32_16x16x32_bf16 v[96:99], v[188:191], a[184:187], v[96:99]
v_mfma_f32_16x16x32_bf16 v[100:103], v[188:191], a[188:191], v[100:103]
ds_read_b128 v[176:179], v7 offset:8192
v_mfma_f32_16x16x32_bf16 v[100:103], v[184:187], a[180:183], v[100:103]
s_waitcnt lgkmcnt(7) vmcnt(16)
v_mfma_f32_16x16x32_bf16 v[120:123], v[144:147], v[32:35], v[120:123]
ds_read_b128 v[180:183], v7 offset:9216
v_mfma_f32_16x16x32_bf16 v[120:123], v[148:151], v[40:43], v[120:123]
s_waitcnt vmcnt(14)
v_mfma_f32_16x16x32_bf16 v[124:127], v[148:151], v[44:47], v[124:127]
ds_read_b128 v[184:187], v7 offset:10240
v_mfma_f32_16x16x32_bf16 v[124:127], v[144:147], v[36:39], v[124:127]
s_waitcnt lgkmcnt(7)
v_mfma_f32_16x16x32_bf16 v[72:75], v[152:155], v[32:35], v[72:75]
ds_read_b128 v[188:191], v7 offset:11264
v_mfma_f32_16x16x32_bf16 v[72:75], v[156:159], v[40:43], v[72:75]
v_mfma_f32_16x16x32_bf16 v[76:79], v[156:159], v[44:47], v[76:79]
ds_read_b128 v[144:147], v7 offset:12288
v_mfma_f32_16x16x32_bf16 v[76:79], v[152:155], v[36:39], v[76:79]
s_waitcnt lgkmcnt(7)
v_mfma_f32_16x16x32_bf16 v[80:83], v[160:163], v[32:35], v[80:83]
ds_read_b128 v[148:151], v7 offset:13312
v_mfma_f32_16x16x32_bf16 v[80:83], v[164:167], v[40:43], v[80:83]
v_mfma_f32_16x16x32_bf16 v[84:87], v[164:167], v[44:47], v[84:87]
ds_read_b128 v[152:155], v7 offset:14336
v_mfma_f32_16x16x32_bf16 v[84:87], v[160:163], v[36:39], v[84:87]
s_waitcnt lgkmcnt(7)
v_mfma_f32_16x16x32_bf16 v[88:91], v[168:171], v[32:35], v[88:91]
ds_read_b128 v[156:159], v7 offset:15360
v_mfma_f32_16x16x32_bf16 v[88:91], v[172:175], v[40:43], v[88:91]
s_add_u32 s91, s91, 16384
s_cmp_ge_u32 s91, 163840
s_cselect_b32 s91, 0, s91
v_mfma_f32_16x16x32_bf16 v[92:95], v[172:175], v[44:47], v[92:95]
ds_read_b128 v[160:163], v8 offset:0
v_add_u32 v7, s91, v4
v_mfma_f32_16x16x32_bf16 v[92:95], v[168:171], v[36:39], v[92:95]
s_waitcnt lgkmcnt(7)
v_mfma_f32_16x16x32_bf16 v[96:99], v[176:179], v[32:35], v[96:99]
ds_read_b128 v[164:167], v8 offset:1024
v_mfma_f32_16x16x32_bf16 v[96:99], v[180:183], v[40:43], v[96:99]
v_mfma_f32_16x16x32_bf16 v[100:103], v[180:183], v[44:47], v[100:103]
s_mov_b32 m0, s70
s_mov_b32 s64, s68
s_add_u32 s68, s68, 16384
v_mfma_f32_16x16x32_bf16 v[100:103], v[176:179], v[36:39], v[100:103]
s_waitcnt lgkmcnt(6) vmcnt(12)
s_waitcnt vmcnt(8)
ds_read_b128 v[168:171], v8 offset:2048
v_mfma_f32_16x16x32_bf16 v[120:123], v[184:187], v[48:51], v[120:123]
s_add_u32 s70, s70, 16384
s_cmp_ge_u32 s70, 163840
s_cselect_b32 s70, s80, s70
v_mfma_f32_16x16x32_bf16 v[120:123], v[188:191], v[56:59], v[120:123]
buffer_load_dwordx4 v4, s[24:27], s64 offen offset:0 sc1 lds
v_mfma_f32_16x16x32_bf16 v[124:127], v[188:191], v[60:63], v[124:127]
ds_read_b128 v[172:175], v8 offset:3072
v_mfma_f32_16x16x32_bf16 v[124:127], v[184:187], v[52:55], v[124:127]
s_waitcnt lgkmcnt(6)
ds_read_b128 v[176:179], v8 offset:4096
v_mfma_f32_16x16x32_bf16 v[72:75], v[144:147], v[48:51], v[72:75]
buffer_load_dwordx4 v4, s[24:27], s64 offen offset:1024 sc1 lds
v_mfma_f32_16x16x32_bf16 v[72:75], v[148:151], v[56:59], v[72:75]
ds_read_b128 v[180:183], v8 offset:5120
v_mfma_f32_16x16x32_bf16 v[76:79], v[148:151], v[60:63], v[76:79]
s_waitcnt lgkmcnt(6)
ds_read_b128 v[184:187], v8 offset:6144
v_mfma_f32_16x16x32_bf16 v[76:79], v[144:147], v[52:55], v[76:79]
buffer_load_dwordx4 v4, s[24:27], s64 offen offset:2048 sc1 lds
v_mfma_f32_16x16x32_bf16 v[80:83], v[152:155], v[48:51], v[80:83]
ds_read_b128 v[188:191], v8 offset:7168
v_mfma_f32_16x16x32_bf16 v[80:83], v[156:159], v[56:59], v[80:83]
v_mfma_f32_16x16x32_bf16 v[84:87], v[156:159], v[60:63], v[84:87]
buffer_load_dwordx4 v4, s[24:27], s64 offen offset:3072 sc1 lds
v_mfma_f32_16x16x32_bf16 v[84:87], v[152:155], v[52:55], v[84:87]
s_waitcnt lgkmcnt(6)
ds_read_b128 v[144:147], v8 offset:8192
v_mfma_f32_16x16x32_bf16 v[88:91], v[160:163], v[48:51], v[88:91]
s_mov_b32 m0, s70
s_mov_b32 s64, s68
s_add_u32 s68, s68, 16384
v_mfma_f32_16x16x32_bf16 v[88:91], v[164:167], v[56:59], v[88:91]
s_waitcnt lgkmcnt(5)
ds_read_b128 v[148:151], v8 offset:9216
v_mfma_f32_16x16x32_bf16 v[92:95], v[164:167], v[60:63], v[92:95]
s_add_u32 s70, s70, 16384
s_cmp_ge_u32 s70, 163840
s_cselect_b32 s70, s80, s70
v_mfma_f32_16x16x32_bf16 v[92:95], v[160:163], v[52:55], v[92:95]
buffer_load_dwordx4 v4, s[24:27], s64 offen offset:0 sc1 lds
v_mfma_f32_16x16x32_bf16 v[96:99], v[168:171], v[48:51], v[96:99]
ds_read_b128 v[152:155], v8 offset:10240
v_mfma_f32_16x16x32_bf16 v[96:99], v[172:175], v[56:59], v[96:99]
ds_read_b128 v[156:159], v8 offset:11264
v_mfma_f32_16x16x32_bf16 v[100:103], v[172:175], v[60:63], v[100:103]
buffer_load_dwordx4 v4, s[24:27], s64 offen offset:1024 sc1 lds
v_mfma_f32_16x16x32_bf16 v[100:103], v[168:171], v[52:55], v[100:103]
s_waitcnt lgkmcnt(6) vmcnt(9)
ds_read_b128 v[160:163], v8 offset:12288
v_mfma_f32_16x16x32_bf16 v[120:123], v[176:179], v[64:67], v[120:123]
s_waitcnt vmcnt(6)
ds_read_b128 v[164:167], v8 offset:13312
v_mfma_f32_16x16x32_bf16 v[124:127], v[176:179], v[68:71], v[124:127]
buffer_load_dwordx4 v4, s[24:27], s64 offen offset:2048 sc1 lds
v_mfma_f32_16x16x32_bf16 v[72:75], v[180:183], v[64:67], v[72:75]
ds_read_b128 v[168:171], v8 offset:14336
v_mfma_f32_16x16x32_bf16 v[76:79], v[180:183], v[68:71], v[76:79]
s_waitcnt lgkmcnt(7)
v_mfma_f32_16x16x32_bf16 v[80:83], v[184:187], v[64:67], v[80:83]
s_waitcnt vmcnt(8)
ds_read_b128 v[172:175], v8 offset:15360
v_mfma_f32_16x16x32_bf16 v[84:87], v[184:187], v[68:71], v[84:87]
s_barrier
v_mfma_f32_16x16x32_bf16 v[88:91], v[188:191], v[64:67], v[88:91]
buffer_load_dwordx4 v4, s[24:27], s64 offen offset:3072 sc1 lds
v_mfma_f32_16x16x32_bf16 v[92:95], v[188:191], v[68:71], v[92:95]
s_waitcnt lgkmcnt(6)
s_add_u32 s91, s91, 16384
ds_read_b128 v[176:179], v7 offset:0
v_mfma_f32_16x16x32_bf16 v[96:99], v[144:147], v[64:67], v[96:99]
ds_read_b128 v[180:183], v7 offset:1024
v_cvt_pk_bf16_f32 v228, v120, v121
v_mfma_f32_16x16x32_bf16 v[100:103], v[144:147], v[68:71], v[100:103]
s_cmp_ge_u32 s91, 163840
s_cselect_b32 s91, 0, s91
v_cvt_pk_bf16_f32 v229, v122, v123
v_mfma_f32_16x16x32_bf16 v[104:107], v[148:151], a[224:227], v[104:107]
s_waitcnt lgkmcnt(6)
ds_read_b128 v[184:187], v7 offset:2048
v_cvt_pk_bf16_f32 v230, v124, v125
v_mfma_f32_16x16x32_bf16 v[104:107], v[152:155], a[232:235], v[104:107]
v_cvt_pk_bf16_f32 v231, v126, v127
v_add_u32 v8, s91, v4
v_mfma_f32_16x16x32_bf16 v[108:111], v[152:155], a[236:239], v[108:111]
buffer_store_dwordx4 v[228:231], v4, s[24:27], s55 offen offset:0 sc1
v_mfma_f32_16x16x32_bf16 v[108:111], v[148:151], a[228:231], v[108:111]
ds_read_b128 v[188:191], v7 offset:3072
v_cvt_pk_bf16_f32 v72, v72, v73
v_mfma_f32_16x16x32_bf16 v[112:115], v[156:159], a[224:227], v[112:115]
s_waitcnt lgkmcnt(6)
ds_read_b128 v[144:147], v7 offset:4096
v_cvt_pk_bf16_f32 v73, v74, v75
v_mfma_f32_16x16x32_bf16 v[112:115], v[160:163], a[232:235], v[112:115]
v_cvt_pk_bf16_f32 v74, v80, v81
v_mfma_f32_16x16x32_bf16 v[116:119], v[160:163], a[236:239], v[116:119]
ds_read_b128 v[148:151], v7 offset:5120
v_cvt_pk_bf16_f32 v75, v82, v83
v_mfma_f32_16x16x32_bf16 v[116:119], v[156:159], a[228:231], v[116:119]
buffer_store_dwordx4 v[72:75], v4, s[24:27], s52 offen offset:0 sc1
v_mfma_f32_16x16x32_bf16 v[104:107], v[164:167], a[240:243], v[104:107]
s_waitcnt lgkmcnt(6)
ds_read_b128 v[152:155], v7 offset:6144
v_cvt_pk_bf16_f32 v76, v76, v77
v_mfma_f32_16x16x32_bf16 v[104:107], v[168:171], a[248:251], v[104:107]
v_cvt_pk_bf16_f32 v77, v78, v79
v_mfma_f32_16x16x32_bf16 v[108:111], v[168:171], a[252:255], v[108:111]
ds_read_b128 v[156:159], v7 offset:7168
v_cvt_pk_bf16_f32 v78, v84, v85
v_mfma_f32_16x16x32_bf16 v[108:111], v[164:167], a[244:247], v[108:111]
s_waitcnt lgkmcnt(6)
v_cvt_pk_bf16_f32 v79, v86, v87
v_mfma_f32_16x16x32_bf16 v[112:115], v[172:175], a[240:243], v[112:115]
buffer_store_dwordx4 v[76:79], v4, s[24:27], s52 offen offset:1024 sc1
v_mfma_f32_16x16x32_bf16 v[112:115], v[176:179], a[248:251], v[112:115]
ds_read_b128 v[160:163], v7 offset:8192
v_cvt_pk_bf16_f32 v88, v88, v89
v_mfma_f32_16x16x32_bf16 v[116:119], v[176:179], a[252:255], v[116:119]
ds_read_b128 v[164:167], v7 offset:9216
v_cvt_pk_bf16_f32 v89, v90, v91
v_mfma_f32_16x16x32_bf16 v[116:119], v[172:175], a[244:247], v[116:119]
v_cvt_pk_bf16_f32 v90, v96, v97
v_mfma_f32_16x16x32_bf16 v[104:107], v[180:183], a[96:99], v[104:107]
s_waitcnt lgkmcnt(6)
ds_read_b128 v[168:171], v7 offset:10240
v_cvt_pk_bf16_f32 v91, v98, v99
v_mfma_f32_16x16x32_bf16 v[104:107], v[184:187], a[104:107], v[104:107]
buffer_store_dwordx4 v[88:91], v4, s[24:27], s53 offen offset:0 sc1
v_mfma_f32_16x16x32_bf16 v[108:111], v[184:187], a[108:111], v[108:111]
ds_read_b128 v[172:175], v7 offset:11264
v_cvt_pk_bf16_f32 v92, v92, v93
v_mfma_f32_16x16x32_bf16 v[108:111], v[180:183], a[100:103], v[108:111]
v_cvt_pk_bf16_f32 v93, v94, v95
v_mfma_f32_16x16x32_bf16 v[112:115], v[188:191], a[96:99], v[112:115]
s_waitcnt lgkmcnt(6)
ds_read_b128 v[176:179], v7 offset:12288
v_cvt_pk_bf16_f32 v94, v100, v101
v_mfma_f32_16x16x32_bf16 v[112:115], v[144:147], a[104:107], v[112:115]
v_cvt_pk_bf16_f32 v95, v102, v103
v_mfma_f32_16x16x32_bf16 v[116:119], v[144:147], a[108:111], v[116:119]
buffer_store_dwordx4 v[92:95], v4, s[24:27], s53 offen offset:1024 sc1
v_mfma_f32_16x16x32_bf16 v[116:119], v[188:191], a[100:103], v[116:119]
ds_read_b128 v[180:183], v7 offset:13312
v_mfma_f32_16x16x32_bf16 v[104:107], v[148:151], a[112:115], v[104:107]
s_waitcnt lgkmcnt(6)
ds_read_b128 v[184:187], v7 offset:14336
v_mfma_f32_16x16x32_bf16 v[104:107], v[152:155], a[120:123], v[104:107]
v_mfma_f32_16x16x32_bf16 v[108:111], v[152:155], a[124:127], v[108:111]
ds_read_b128 v[188:191], v7 offset:15360
v_mfma_f32_16x16x32_bf16 v[108:111], v[148:151], a[116:119], v[108:111]
s_add_u32 s91, s91, 16384
s_cmp_ge_u32 s91, 163840
s_cselect_b32 s91, 0, s91
v_mfma_f32_16x16x32_bf16 v[112:115], v[156:159], a[112:115], v[112:115]
s_waitcnt lgkmcnt(6)
ds_read_b128 v[144:147], v8 offset:0
v_add_u32 v7, s91, v4
v_mfma_f32_16x16x32_bf16 v[112:115], v[160:163], a[120:123], v[112:115]
v_mfma_f32_16x16x32_bf16 v[116:119], v[160:163], a[124:127], v[116:119]
ds_read_b128 v[148:151], v8 offset:1024
v_mfma_f32_16x16x32_bf16 v[116:119], v[156:159], a[116:119], v[116:119]
s_waitcnt lgkmcnt(6)
v_mfma_f32_16x16x32_bf16 v[104:107], v[164:167], a[128:131], v[104:107]
s_mov_b32 m0, s70
s_mov_b32 s64, s68
s_add_u32 s68, s68, 16384
v_mfma_f32_16x16x32_bf16 v[104:107], v[168:171], a[136:139], v[104:107]
ds_read_b128 v[152:155], v8 offset:2048
v_mfma_f32_16x16x32_bf16 v[108:111], v[168:171], a[140:143], v[108:111]
s_add_u32 s70, s70, 16384
s_cmp_ge_u32 s70, 163840
s_cselect_b32 s70, s80, s70
v_mfma_f32_16x16x32_bf16 v[108:111], v[164:167], a[132:135], v[108:111]
buffer_load_dwordx4 v4, s[24:27], s64 offen offset:0 sc1 lds
v_mfma_f32_16x16x32_bf16 v[112:115], v[172:175], a[128:131], v[112:115]
s_waitcnt lgkmcnt(5)
ds_read_b128 v[156:159], v8 offset:3072
v_mfma_f32_16x16x32_bf16 v[112:115], v[176:179], a[136:139], v[112:115]
ds_read_b128 v[160:163], v8 offset:4096
v_mfma_f32_16x16x32_bf16 v[116:119], v[176:179], a[140:143], v[116:119]
buffer_load_dwordx4 v4, s[24:27], s64 offen offset:1024 sc1 lds
v_mfma_f32_16x16x32_bf16 v[116:119], v[172:175], a[132:135], v[116:119]
ds_read_b128 v[164:167], v8 offset:5120
v_mfma_f32_16x16x32_bf16 v[104:107], v[180:183], a[144:147], v[104:107]
s_waitcnt lgkmcnt(6)
ds_read_b128 v[168:171], v8 offset:6144
v_mfma_f32_16x16x32_bf16 v[104:107], v[184:187], a[152:155], v[104:107]
buffer_load_dwordx4 v4, s[24:27], s64 offen offset:2048 sc1 lds
v_mfma_f32_16x16x32_bf16 v[108:111], v[184:187], a[156:159], v[108:111]
ds_read_b128 v[172:175], v8 offset:7168
v_mfma_f32_16x16x32_bf16 v[108:111], v[180:183], a[148:151], v[108:111]
s_waitcnt lgkmcnt(6)
v_mfma_f32_16x16x32_bf16 v[112:115], v[188:191], a[144:147], v[112:115]
buffer_load_dwordx4 v4, s[24:27], s64 offen offset:3072 sc1 lds
v_mfma_f32_16x16x32_bf16 v[112:115], v[144:147], a[152:155], v[112:115]
ds_read_b128 v[176:179], v8 offset:8192
v_mfma_f32_16x16x32_bf16 v[116:119], v[144:147], a[156:159], v[116:119]
s_mov_b32 m0, s70
s_mov_b32 s64, s68
s_add_u32 s68, s68, 16384
v_mfma_f32_16x16x32_bf16 v[116:119], v[188:191], a[148:151], v[116:119]
s_waitcnt lgkmcnt(5)
ds_read_b128 v[180:183], v8 offset:9216
v_mfma_f32_16x16x32_bf16 v[104:107], v[148:151], a[160:163], v[104:107]
s_add_u32 s70, s70, 16384
s_cmp_ge_u32 s70, 163840
s_cselect_b32 s70, s80, s70
v_mfma_f32_16x16x32_bf16 v[104:107], v[152:155], a[168:171], v[104:107]
buffer_load_dwordx4 v4, s[24:27], s64 offen offset:0 sc1 lds
v_mfma_f32_16x16x32_bf16 v[108:111], v[152:155], a[172:175], v[108:111]
ds_read_b128 v[184:187], v8 offset:10240
v_mfma_f32_16x16x32_bf16 v[108:111], v[148:151], a[164:167], v[108:111]
s_waitcnt lgkmcnt(5)
ds_read_b128 v[188:191], v8 offset:11264
v_mfma_f32_16x16x32_bf16 v[112:115], v[156:159], a[160:163], v[112:115]
buffer_load_dwordx4 v4, s[24:27], s64 offen offset:1024 sc1 lds
v_mfma_f32_16x16x32_bf16 v[112:115], v[160:163], a[168:171], v[112:115]
ds_read_b128 v[144:147], v8 offset:12288
v_mfma_f32_16x16x32_bf16 v[116:119], v[160:163], a[172:175], v[116:119]
ds_read_b128 v[148:151], v8 offset:13312
v_mfma_f32_16x16x32_bf16 v[116:119], v[156:159], a[164:167], v[116:119]
buffer_load_dwordx4 v4, s[24:27], s64 offen offset:2048 sc1 lds
v_mfma_f32_16x16x32_bf16 v[104:107], v[164:167], a[176:179], v[104:107]
s_waitcnt lgkmcnt(6)
ds_read_b128 v[152:155], v8 offset:14336
v_mfma_f32_16x16x32_bf16 v[104:107], v[168:171], a[184:187], v[104:107]
v_mfma_f32_16x16x32_bf16 v[108:111], v[168:171], a[188:191], v[108:111]
s_waitcnt vmcnt(12) lgkmcnt(5)
ds_read_b128 v[156:159], v8 offset:15360
v_mfma_f32_16x16x32_bf16 v[108:111], v[164:167], a[180:183], v[108:111]
s_barrier
v_mfma_f32_16x16x32_bf16 v[112:115], v[172:175], a[176:179], v[112:115]
buffer_load_dwordx4 v4, s[24:27], s64 offen offset:3072 sc1 lds
v_mfma_f32_16x16x32_bf16 v[112:115], v[176:179], a[184:187], v[112:115]
s_add_u32 s91, s91, 16384
ds_read_b128 v[160:163], v7 offset:0
v_mfma_f32_16x16x32_bf16 v[116:119], v[176:179], a[188:191], v[116:119]
s_cmp_ge_u32 s91, 163840
s_cselect_b32 s91, 0, s91
ds_read_b128 v[164:167], v7 offset:1024
v_mfma_f32_16x16x32_bf16 v[116:119], v[172:175], a[180:183], v[116:119]
v_add_u32 v8, s91, v4
v_mfma_f32_16x16x32_bf16 v[104:107], v[180:183], v[32:35], v[104:107]
s_waitcnt lgkmcnt(6)
ds_read_b128 v[168:171], v7 offset:2048
v_mfma_f32_16x16x32_bf16 v[104:107], v[184:187], v[40:43], v[104:107]
v_mfma_f32_16x16x32_bf16 v[108:111], v[184:187], v[44:47], v[108:111]
ds_read_b128 v[172:175], v7 offset:3072
v_mfma_f32_16x16x32_bf16 v[108:111], v[180:183], v[36:39], v[108:111]
v_mfma_f32_16x16x32_bf16 v[112:115], v[188:191], v[32:35], v[112:115]
s_waitcnt lgkmcnt(6)
ds_read_b128 v[176:179], v7 offset:4096
v_mfma_f32_16x16x32_bf16 v[112:115], v[144:147], v[40:43], v[112:115]
v_mfma_f32_16x16x32_bf16 v[116:119], v[144:147], v[44:47], v[116:119]
ds_read_b128 v[180:183], v7 offset:5120
v_mfma_f32_16x16x32_bf16 v[116:119], v[188:191], v[36:39], v[116:119]
v_mfma_f32_16x16x32_bf16 v[104:107], v[148:151], v[48:51], v[104:107]
s_waitcnt vmcnt(8) lgkmcnt(6)
ds_read_b128 v[184:187], v7 offset:6144
v_mfma_f32_16x16x32_bf16 v[104:107], v[152:155], v[56:59], v[104:107]
buffer_atomic_add v1, v0, s[24:27], s73 offen offset:0 sc1
v_mfma_f32_16x16x32_bf16 v[108:111], v[152:155], v[60:63], v[108:111]
ds_read_b128 v[188:191], v7 offset:7168
v_mfma_f32_16x16x32_bf16 v[108:111], v[148:151], v[52:55], v[108:111]
v_mfma_f32_16x16x32_bf16 v[112:115], v[156:159], v[48:51], v[112:115]
s_waitcnt lgkmcnt(6)
ds_read_b128 v[144:147], v7 offset:8192
v_mfma_f32_16x16x32_bf16 v[112:115], v[160:163], v[56:59], v[112:115]
v_mfma_f32_16x16x32_bf16 v[116:119], v[160:163], v[60:63], v[116:119]
ds_read_b128 v[148:151], v7 offset:9216
v_mfma_f32_16x16x32_bf16 v[116:119], v[156:159], v[52:55], v[116:119]
v_mfma_f32_16x16x32_bf16 v[104:107], v[164:167], v[64:67], v[104:107]
ds_read_b128 v[152:155], v7 offset:10240
v_mfma_f32_16x16x32_bf16 v[108:111], v[164:167], v[68:71], v[108:111]
s_waitcnt lgkmcnt(7)
v_mfma_f32_16x16x32_bf16 v[112:115], v[168:171], v[64:67], v[112:115]
ds_read_b128 v[156:159], v7 offset:11264
v_mfma_f32_16x16x32_bf16 v[116:119], v[168:171], v[68:71], v[116:119]
v_mfma_f32_16x16x32_bf16 v[128:131], v[172:175], a[0:3], 0
s_waitcnt lgkmcnt(6)
ds_read_b128 v[160:163], v7 offset:12288
v_mfma_f32_16x16x32_bf16 v[128:131], v[176:179], a[8:11], v[128:131]
v_mfma_f32_16x16x32_bf16 v[132:135], v[176:179], a[12:15], 0
ds_read_b128 v[164:167], v7 offset:13312
v_mfma_f32_16x16x32_bf16 v[132:135], v[172:175], a[4:7], v[132:135]
v_mfma_f32_16x16x32_bf16 v[136:139], v[180:183], a[0:3], 0
s_waitcnt lgkmcnt(6)
ds_read_b128 v[168:171], v7 offset:14336
v_mfma_f32_16x16x32_bf16 v[136:139], v[184:187], a[8:11], v[136:139]
v_cvt_pk_bf16_f32 v104, v104, v105
v_mfma_f32_16x16x32_bf16 v[140:143], v[184:187], a[12:15], 0
ds_read_b128 v[172:175], v7 offset:15360
v_cvt_pk_bf16_f32 v105, v106, v107
v_mfma_f32_16x16x32_bf16 v[140:143], v[180:183], a[4:7], v[140:143]
s_add_u32 s91, s91, 16384
v_cvt_pk_bf16_f32 v106, v112, v113
v_mfma_f32_16x16x32_bf16 v[128:131], v[188:191], a[16:19], v[128:131]
s_waitcnt lgkmcnt(6)
ds_read_b128 v[176:179], v8 offset:0
v_cvt_pk_bf16_f32 v107, v114, v115
v_mfma_f32_16x16x32_bf16 v[128:131], v[144:147], a[24:27], v[128:131]
buffer_store_dwordx4 v[104:107], v4, s[24:27], s54 offen offset:0 sc1
v_mfma_f32_16x16x32_bf16 v[132:135], v[144:147], a[28:31], v[132:135]
ds_read_b128 v[180:183], v8 offset:1024
v_cvt_pk_bf16_f32 v108, v108, v109
v_mfma_f32_16x16x32_bf16 v[132:135], v[188:191], a[20:23], v[132:135]
s_cmp_ge_u32 s91, 163840
s_cselect_b32 s91, 0, s91
v_cvt_pk_bf16_f32 v109, v110, v111
v_mfma_f32_16x16x32_bf16 v[136:139], v[148:151], a[16:19], v[136:139]
s_waitcnt lgkmcnt(6)
ds_read_b128 v[184:187], v8 offset:2048
v_cvt_pk_bf16_f32 v110, v116, v117
v_mfma_f32_16x16x32_bf16 v[136:139], v[152:155], a[24:27], v[136:139]
s_waitcnt lgkmcnt(5)
v_cvt_pk_bf16_f32 v111, v118, v119
v_add_u32 v7, s91, v4
v_mfma_f32_16x16x32_bf16 v[140:143], v[152:155], a[28:31], v[140:143]
buffer_store_dwordx4 v[108:111], v4, s[24:27], s54 offen offset:1024 sc1
v_mfma_f32_16x16x32_bf16 v[140:143], v[148:151], a[20:23], v[140:143]
s_mov_b32 m0, s70
s_mov_b32 s64, s68
s_add_u32 s68, s68, 16384
v_mfma_f32_16x16x32_bf16 v[128:131], v[156:159], a[32:35], v[128:131]
s_cmp_lt_u32 s3, 3
s_cselect_b32 s68, s64, 2147418112
ds_read_b128 v[188:191], v8 offset:3072
v_mfma_f32_16x16x32_bf16 v[128:131], v[160:163], a[40:43], v[128:131]
buffer_load_dwordx4 v4, s[24:27], s64 offen offset:0 sc1 lds
v_mfma_f32_16x16x32_bf16 v[132:135], v[160:163], a[44:47], v[132:135]
ds_read_b128 v[144:147], v8 offset:4096
v_mfma_f32_16x16x32_bf16 v[132:135], v[156:159], a[36:39], v[132:135]
s_waitcnt lgkmcnt(5)
ds_read_b128 v[148:151], v8 offset:5120
v_mfma_f32_16x16x32_bf16 v[136:139], v[164:167], a[32:35], v[136:139]
buffer_load_dwordx4 v4, s[24:27], s68 offen offset:1024 sc1 lds
v_mfma_f32_16x16x32_bf16 v[136:139], v[168:171], a[40:43], v[136:139]
ds_read_b128 v[152:155], v8 offset:6144
v_mfma_f32_16x16x32_bf16 v[140:143], v[168:171], a[44:47], v[140:143]
ds_read_b128 v[156:159], v8 offset:7168
v_mfma_f32_16x16x32_bf16 v[140:143], v[164:167], a[36:39], v[140:143]
buffer_load_dwordx4 v4, s[24:27], s68 offen offset:2048 sc1 lds
v_mfma_f32_16x16x32_bf16 v[128:131], v[172:175], a[48:51], v[128:131]
s_waitcnt lgkmcnt(6)
ds_read_b128 v[160:163], v8 offset:8192
v_mfma_f32_16x16x32_bf16 v[128:131], v[176:179], a[56:59], v[128:131]
v_mfma_f32_16x16x32_bf16 v[132:135], v[176:179], a[60:63], v[132:135]
buffer_load_dwordx4 v4, s[24:27], s68 offen offset:3072 sc1 lds
v_mfma_f32_16x16x32_bf16 v[132:135], v[172:175], a[52:55], v[132:135]
ds_read_b128 v[164:167], v8 offset:9216
v_mfma_f32_16x16x32_bf16 v[136:139], v[180:183], a[48:51], v[136:139]
s_waitcnt lgkmcnt(6)
ds_read_b128 v[168:171], v8 offset:10240
v_mfma_f32_16x16x32_bf16 v[136:139], v[184:187], a[56:59], v[136:139]
buffer_load_dword v12, v10, s[24:27], s73 offen sc1
v_mfma_f32_16x16x32_bf16 v[140:143], v[184:187], a[60:63], v[140:143]
ds_read_b128 v[172:175], v8 offset:11264
v_mfma_f32_16x16x32_bf16 v[140:143], v[180:183], a[52:55], v[140:143]
v_mfma_f32_16x16x32_bf16 v[128:131], v[188:191], a[64:67], v[128:131]
s_waitcnt lgkmcnt(6)
ds_read_b128 v[176:179], v8 offset:12288
v_mfma_f32_16x16x32_bf16 v[128:131], v[144:147], a[72:75], v[128:131]
v_mfma_f32_16x16x32_bf16 v[132:135], v[144:147], a[76:79], v[132:135]
ds_read_b128 v[180:183], v8 offset:13312
v_mfma_f32_16x16x32_bf16 v[132:135], v[188:191], a[68:71], v[132:135]
v_mfma_f32_16x16x32_bf16 v[136:139], v[148:151], a[64:67], v[136:139]
s_waitcnt lgkmcnt(6)
ds_read_b128 v[184:187], v8 offset:14336
v_mfma_f32_16x16x32_bf16 v[136:139], v[152:155], a[72:75], v[136:139]
v_mfma_f32_16x16x32_bf16 v[140:143], v[152:155], a[76:79], v[140:143]
s_waitcnt vmcnt(8)
ds_read_b128 v[188:191], v8 offset:15360
v_mfma_f32_16x16x32_bf16 v[140:143], v[148:151], a[68:71], v[140:143]
s_barrier
v_mfma_f32_16x16x32_bf16 v[128:131], v[156:159], a[80:83], v[128:131]
s_waitcnt lgkmcnt(6)
s_add_u32 s91, s91, 16384
ds_read_b128 v[144:147], v7 offset:0
v_mfma_f32_16x16x32_bf16 v[128:131], v[160:163], a[88:91], v[128:131]
s_cmp_ge_u32 s91, 163840
s_cselect_b32 s91, 0, s91
v_add_u32 v8, s91, v4
v_mfma_f32_16x16x32_bf16 v[132:135], v[160:163], a[92:95], v[132:135]
ds_read_b128 v[148:151], v7 offset:1024
v_mfma_f32_16x16x32_bf16 v[132:135], v[156:159], a[84:87], v[132:135]
v_mfma_f32_16x16x32_bf16 v[136:139], v[164:167], a[80:83], v[136:139]
s_waitcnt lgkmcnt(6)
ds_read_b128 v[152:155], v7 offset:2048
v_mfma_f32_16x16x32_bf16 v[136:139], v[168:171], a[88:91], v[136:139]
v_mfma_f32_16x16x32_bf16 v[140:143], v[168:171], a[92:95], v[140:143]
ds_read_b128 v[156:159], v7 offset:3072
v_mfma_f32_16x16x32_bf16 v[140:143], v[164:167], a[84:87], v[140:143]
v_mfma_f32_16x16x32_bf16 v[128:131], v[172:175], a[192:195], v[128:131]
s_waitcnt lgkmcnt(6)
ds_read_b128 v[160:163], v7 offset:4096
v_mfma_f32_16x16x32_bf16 v[128:131], v[176:179], a[200:203], v[128:131]
v_mfma_f32_16x16x32_bf16 v[132:135], v[176:179], a[204:207], v[132:135]
ds_read_b128 v[164:167], v7 offset:5120
v_mfma_f32_16x16x32_bf16 v[132:135], v[172:175], a[196:199], v[132:135]
v_mfma_f32_16x16x32_bf16 v[136:139], v[180:183], a[192:195], v[136:139]
s_waitcnt lgkmcnt(6)
ds_read_b128 v[168:171], v7 offset:6144
v_mfma_f32_16x16x32_bf16 v[136:139], v[184:187], a[200:203], v[136:139]
v_mfma_f32_16x16x32_bf16 v[140:143], v[184:187], a[204:207], v[140:143]
s_waitcnt vmcnt(5)
ds_read_b128 v[172:175], v7 offset:7168
v_mfma_f32_16x16x32_bf16 v[140:143], v[180:183], a[196:199], v[140:143]
buffer_atomic_add v1, v0, s[24:27], s73 offen offset:16 sc1
v_mfma_f32_16x16x32_bf16 v[128:131], v[188:191], a[208:211], v[128:131]
s_waitcnt lgkmcnt(6)
L_PAD13:
s_cbranch_execz L_MAIN
ds_read_b128 v[176:179], v7 offset:8192
v_mfma_f32_16x16x32_bf16 v[128:131], v[144:147], a[216:219], v[128:131]
v_mfma_f32_16x16x32_bf16 v[132:135], v[144:147], a[220:223], v[132:135]
ds_read_b128 v[180:183], v7 offset:9216
v_mfma_f32_16x16x32_bf16 v[132:135], v[188:191], a[212:215], v[132:135]
s_waitcnt vmcnt(1)
v_mfma_f32_16x16x32_bf16 v[136:139], v[148:151], a[208:211], v[136:139]
s_waitcnt lgkmcnt(6)
ds_read_b128 v[184:187], v7 offset:10240
v_cmp_gt_u32 vcc, 4, v12
v_mfma_f32_16x16x32_bf16 v[136:139], v[152:155], a[216:219], v[136:139]
v_mfma_f32_16x16x32_bf16 v[140:143], v[152:155], a[220:223], v[140:143]
ds_read_b128 v[188:191], v7 offset:11264
v_mfma_f32_16x16x32_bf16 v[140:143], v[148:151], a[212:215], v[140:143]
v_mfma_f32_16x16x32_bf16 v[128:131], v[156:159], a[224:227], v[128:131]
s_waitcnt lgkmcnt(6)
ds_read_b128 v[144:147], v7 offset:12288
v_mfma_f32_16x16x32_bf16 v[128:131], v[160:163], a[232:235], v[128:131]
s_cbranch_vccnz CK_P1
CK_P1_R:
v_mfma_f32_16x16x32_bf16 v[132:135], v[160:163], a[236:239], v[132:135]
ds_read_b128 v[148:151], v7 offset:13312
v_mfma_f32_16x16x32_bf16 v[132:135], v[156:159], a[228:231], v[132:135]
s_waitcnt lgkmcnt(6)
v_mfma_f32_16x16x32_bf16 v[136:139], v[164:167], a[224:227], v[136:139]
buffer_load_dwordx4 v[192:195], v4, s[24:27], s69 offen offset:0 sc1
v_mfma_f32_16x16x32_bf16 v[136:139], v[168:171], a[232:235], v[136:139]
ds_read_b128 v[152:155], v7 offset:14336
v_mfma_f32_16x16x32_bf16 v[140:143], v[168:171], a[236:239], v[140:143]
ds_read_b128 v[156:159], v7 offset:15360
v_mfma_f32_16x16x32_bf16 v[140:143], v[164:167], a[228:231], v[140:143]
buffer_load_dwordx4 v[196:199], v4, s[24:27], s69 offen offset:1024 sc1
v_mfma_f32_16x16x32_bf16 v[128:131], v[172:175], a[240:243], v[128:131]
s_waitcnt lgkmcnt(6)
s_add_u32 s91, s91, 16384
ds_read_b128 v[160:163], v8 offset:0
v_mfma_f32_16x16x32_bf16 v[128:131], v[176:179], a[248:251], v[128:131]
s_cmp_ge_u32 s91, 163840
s_cselect_b32 s91, 0, s91
v_add_u32 v7, s91, v4
v_mfma_f32_16x16x32_bf16 v[132:135], v[176:179], a[252:255], v[132:135]
buffer_load_dwordx4 v[200:203], v4, s[24:27], s69 offen offset:2048 sc1
v_mfma_f32_16x16x32_bf16 v[132:135], v[172:175], a[244:247], v[132:135]
ds_read_b128 v[164:167], v8 offset:1024
v_mfma_f32_16x16x32_bf16 v[136:139], v[180:183], a[240:243], v[136:139]
s_waitcnt lgkmcnt(6)
ds_read_b128 v[168:171], v8 offset:2048
v_mfma_f32_16x16x32_bf16 v[136:139], v[184:187], a[248:251], v[136:139]
buffer_load_dwordx4 v[204:207], v4, s[24:27], s69 offen offset:3072 sc1
v_mfma_f32_16x16x32_bf16 v[140:143], v[184:187], a[252:255], v[140:143]
ds_read_b128 v[172:175], v8 offset:3072
v_mfma_f32_16x16x32_bf16 v[140:143], v[180:183], a[244:247], v[140:143]
s_waitcnt lgkmcnt(6)
v_mfma_f32_16x16x32_bf16 v[128:131], v[188:191], a[96:99], v[128:131]
buffer_load_dwordx4 v[208:211], v4, s[24:27], s71 offen offset:0 sc1
v_mfma_f32_16x16x32_bf16 v[128:131], v[144:147], a[104:107], v[128:131]
ds_read_b128 v[176:179], v8 offset:4096
v_mfma_f32_16x16x32_bf16 v[132:135], v[144:147], a[108:111], v[132:135]
ds_read_b128 v[180:183], v8 offset:5120
v_mfma_f32_16x16x32_bf16 v[132:135], v[188:191], a[100:103], v[132:135]
buffer_load_dwordx4 v[212:215], v4, s[24:27], s71 offen offset:1024 sc1
v_mfma_f32_16x16x32_bf16 v[136:139], v[148:151], a[96:99], v[136:139]
s_waitcnt lgkmcnt(6)
ds_read_b128 v[184:187], v8 offset:6144
v_mfma_f32_16x16x32_bf16 v[136:139], v[152:155], a[104:107], v[136:139]
v_mfma_f32_16x16x32_bf16 v[140:143], v[152:155], a[108:111], v[140:143]
buffer_load_dwordx4 v[216:219], v4, s[24:27], s71 offen offset:2048 sc1
v_mfma_f32_16x16x32_bf16 v[140:143], v[148:151], a[100:103], v[140:143]
ds_read_b128 v[188:191], v8 offset:7168
v_mfma_f32_16x16x32_bf16 v[128:131], v[156:159], a[112:115], v[128:131]
s_waitcnt lgkmcnt(6)
ds_read_b128 v[144:147], v8 offset:8192
v_mfma_f32_16x16x32_bf16 v[128:131], v[160:163], a[120:123], v[128:131]
v_mfma_f32_16x16x32_bf16 v[132:135], v[160:163], a[124:127], v[132:135]
ds_read_b128 v[148:151], v8 offset:9216
v_mfma_f32_16x16x32_bf16 v[132:135], v[156:159], a[116:119], v[132:135]
v_mfma_f32_16x16x32_bf16 v[136:139], v[164:167], a[112:115], v[136:139]
s_waitcnt lgkmcnt(6)
ds_read_b128 v[152:155], v8 offset:10240
v_mfma_f32_16x16x32_bf16 v[136:139], v[168:171], a[120:123], v[136:139]
v_mfma_f32_16x16x32_bf16 v[140:143], v[168:171], a[124:127], v[140:143]
ds_read_b128 v[156:159], v8 offset:11264
v_mfma_f32_16x16x32_bf16 v[140:143], v[164:167], a[116:119], v[140:143]
v_mfma_f32_16x16x32_bf16 v[128:131], v[172:175], a[128:131], v[128:131]
s_waitcnt lgkmcnt(6)
ds_read_b128 v[160:163], v8 offset:12288
v_mfma_f32_16x16x32_bf16 v[128:131], v[176:179], a[136:139], v[128:131]
v_mfma_f32_16x16x32_bf16 v[132:135], v[176:179], a[140:143], v[132:135]
ds_read_b128 v[164:167], v8 offset:13312
v_mfma_f32_16x16x32_bf16 v[132:135], v[172:175], a[132:135], v[132:135]
v_mfma_f32_16x16x32_bf16 v[136:139], v[180:183], a[128:131], v[136:139]
s_waitcnt lgkmcnt(6)
ds_read_b128 v[168:171], v8 offset:14336
v_mfma_f32_16x16x32_bf16 v[136:139], v[184:187], a[136:139], v[136:139]
v_mfma_f32_16x16x32_bf16 v[140:143], v[184:187], a[140:143], v[140:143]
s_waitcnt vmcnt(9)
ds_read_b128 v[172:175], v8 offset:15360
v_mfma_f32_16x16x32_bf16 v[140:143], v[180:183], a[132:135], v[140:143]
s_barrier
v_mfma_f32_16x16x32_bf16 v[128:131], v[188:191], a[144:147], v[128:131]
s_waitcnt lgkmcnt(6)
ds_read_b128 v[176:179], v7 offset:0
v_mfma_f32_16x16x32_bf16 v[128:131], v[144:147], a[152:155], v[128:131]
v_mfma_f32_16x16x32_bf16 v[132:135], v[144:147], a[156:159], v[132:135]
ds_read_b128 v[180:183], v7 offset:1024
v_mfma_f32_16x16x32_bf16 v[132:135], v[188:191], a[148:151], v[132:135]
v_mfma_f32_16x16x32_bf16 v[136:139], v[148:151], a[144:147], v[136:139]
s_waitcnt lgkmcnt(6)
ds_read_b128 v[184:187], v7 offset:2048
v_mfma_f32_16x16x32_bf16 v[136:139], v[152:155], a[152:155], v[136:139]
v_mfma_f32_16x16x32_bf16 v[140:143], v[152:155], a[156:159], v[140:143]
ds_read_b128 v[188:191], v7 offset:3072
v_mfma_f32_16x16x32_bf16 v[140:143], v[148:151], a[148:151], v[140:143]
v_mfma_f32_16x16x32_bf16 v[128:131], v[156:159], a[160:163], v[128:131]
s_waitcnt lgkmcnt(6)
ds_read_b128 v[144:147], v7 offset:4096
v_mfma_f32_16x16x32_bf16 v[128:131], v[160:163], a[168:171], v[128:131]
v_mfma_f32_16x16x32_bf16 v[132:135], v[160:163], a[172:175], v[132:135]
ds_read_b128 v[148:151], v7 offset:5120
v_mfma_f32_16x16x32_bf16 v[132:135], v[156:159], a[164:167], v[132:135]
v_mfma_f32_16x16x32_bf16 v[136:139], v[164:167], a[160:163], v[136:139]
s_waitcnt lgkmcnt(6)
ds_read_b128 v[152:155], v7 offset:6144
v_mfma_f32_16x16x32_bf16 v[136:139], v[168:171], a[168:171], v[136:139]
v_mfma_f32_16x16x32_bf16 v[140:143], v[168:171], a[172:175], v[140:143]
ds_read_b128 v[156:159], v7 offset:7168
v_mfma_f32_16x16x32_bf16 v[140:143], v[164:167], a[164:167], v[140:143]
v_mfma_f32_16x16x32_bf16 v[128:131], v[172:175], a[176:179], v[128:131]
s_waitcnt lgkmcnt(6)
ds_read_b128 v[160:163], v7 offset:8192
v_mfma_f32_16x16x32_bf16 v[128:131], v[176:179], a[184:187], v[128:131]
v_mfma_f32_16x16x32_bf16 v[132:135], v[176:179], a[188:191], v[132:135]
ds_read_b128 v[164:167], v7 offset:9216
v_mfma_f32_16x16x32_bf16 v[132:135], v[172:175], a[180:183], v[132:135]
v_mfma_f32_16x16x32_bf16 v[136:139], v[180:183], a[176:179], v[136:139]
s_waitcnt lgkmcnt(6)
ds_read_b128 v[168:171], v7 offset:10240
v_mfma_f32_16x16x32_bf16 v[136:139], v[184:187], a[184:187], v[136:139]
v_mfma_f32_16x16x32_bf16 v[140:143], v[184:187], a[188:191], v[140:143]
ds_read_b128 v[172:175], v7 offset:11264
v_mfma_f32_16x16x32_bf16 v[140:143], v[180:183], a[180:183], v[140:143]
s_waitcnt lgkmcnt(6)
v_mfma_f32_16x16x32_bf16 v[128:131], v[188:191], v[32:35], v[128:131]
buffer_load_dword v12, v10, s[24:27], s73 offen offset:16 sc1
v_mfma_f32_16x16x32_bf16 v[128:131], v[144:147], v[40:43], v[128:131]
ds_read_b128 v[176:179], v7 offset:12288
v_mfma_f32_16x16x32_bf16 v[132:135], v[144:147], v[44:47], v[132:135]
v_mfma_f32_16x16x32_bf16 v[132:135], v[188:191], v[36:39], v[132:135]
v_mfma_f32_16x16x32_bf16 v[136:139], v[148:151], v[32:35], v[136:139]
s_waitcnt lgkmcnt(5)
v_mfma_f32_16x16x32_bf16 v[136:139], v[152:155], v[40:43], v[136:139]
v_mfma_f32_16x16x32_bf16 v[140:143], v[152:155], v[44:47], v[140:143]
v_mfma_f32_16x16x32_bf16 v[140:143], v[148:151], v[36:39], v[140:143]
v_mfma_f32_16x16x32_bf16 v[128:131], v[156:159], v[48:51], v[128:131]
s_waitcnt lgkmcnt(3)
v_mfma_f32_16x16x32_bf16 v[128:131], v[160:163], v[56:59], v[128:131]
v_mfma_f32_16x16x32_bf16 v[132:135], v[160:163], v[60:63], v[132:135]
v_mfma_f32_16x16x32_bf16 v[132:135], v[156:159], v[52:55], v[132:135]
v_mfma_f32_16x16x32_bf16 v[136:139], v[164:167], v[48:51], v[136:139]
s_waitcnt lgkmcnt(1)
v_mfma_f32_16x16x32_bf16 v[136:139], v[168:171], v[56:59], v[136:139]
v_mfma_f32_16x16x32_bf16 v[140:143], v[168:171], v[60:63], v[140:143]
v_mfma_f32_16x16x32_bf16 v[140:143], v[164:167], v[52:55], v[140:143]
v_mfma_f32_16x16x32_bf16 v[128:131], v[172:175], v[64:67], v[128:131]
v_mfma_f32_16x16x32_bf16 v[132:135], v[172:175], v[68:71], v[132:135]
s_waitcnt lgkmcnt(0)
v_mfma_f32_16x16x32_bf16 v[136:139], v[176:179], v[64:67], v[136:139]
v_mfma_f32_16x16x32_bf16 v[140:143], v[176:179], v[68:71], v[140:143]
s_waitcnt vmcnt(0)
v_cmp_gt_u32 vcc, 4, v12
s_nop 4
s_cbranch_vccnz CK_P2
CK_P2_R:
buffer_load_dwordx4 v[220:223], v4, s[24:27], s83 offen offset:0 sc1
buffer_load_dwordx4 v[224:227], v4, s[24:27], s83 offen offset:1024 sc1
s_and_b32 s54, s3, 1
s_mul_i32 s54, s54, 18432
s_mul_i32 s55, s86, 288
s_add_u32 s54, s54, s55
s_add_u32 s54, s54, 256
s_sub_u32 s55, 63, s72
s_mul_i32 s55, s55, 36864
s_add_u32 s55, s55, s54
s_mul_i32 s52, s72, 36864
s_add_u32 s54, s54, s52
s_lshl_b32 s53, s84, 6
s_sub_u32 s53, s53, 256
s_add_u32 s52, s54, s53
s_add_u32 s53, s55, s53
v_lshlrev_b32 v16, 16, v192
v_and_b32 v17, v13, v192
v_lshlrev_b32 v18, 16, v193
v_and_b32 v19, v13, v193
v_lshlrev_b32 v20, 16, v194
v_and_b32 v21, v13, v194
v_lshlrev_b32 v22, 16, v195
v_and_b32 v23, v13, v195
v_pk_add_f32 v[128:129], v[128:129], v[16:17]
v_pk_add_f32 v[130:131], v[130:131], v[18:19]
v_pk_add_f32 v[136:137], v[136:137], v[20:21]
v_pk_add_f32 v[138:139], v[138:139], v[22:23]
v_lshlrev_b32 v16, 16, v196
v_and_b32 v17, v13, v196
v_lshlrev_b32 v18, 16, v197
v_and_b32 v19, v13, v197
v_lshlrev_b32 v20, 16, v198
v_and_b32 v21, v13, v198
v_lshlrev_b32 v22, 16, v199
v_and_b32 v23, v13, v199
v_pk_add_f32 v[132:133], v[132:133], v[16:17]
v_pk_add_f32 v[134:135], v[134:135], v[18:19]
v_pk_add_f32 v[140:141], v[140:141], v[20:21]
v_pk_add_f32 v[142:143], v[142:143], v[22:23]
v_lshlrev_b32 v16, 16, v200
v_and_b32 v17, v13, v200
v_lshlrev_b32 v18, 16, v201
v_and_b32 v19, v13, v201
v_lshlrev_b32 v20, 16, v202
v_and_b32 v21, v13, v202
v_lshlrev_b32 v22, 16, v203
v_and_b32 v23, v13, v203
v_pk_add_f32 v[128:129], v[128:129], v[16:17]
v_pk_add_f32 v[130:131], v[130:131], v[18:19]
v_pk_add_f32 v[136:137], v[136:137], v[20:21]
v_pk_add_f32 v[138:139], v[138:139], v[22:23]
v_lshlrev_b32 v16, 16, v204
v_and_b32 v17, v13, v204
v_lshlrev_b32 v18, 16, v205
v_and_b32 v19, v13, v205
v_lshlrev_b32 v20, 16, v206
v_and_b32 v21, v13, v206
v_lshlrev_b32 v22, 16, v207
v_and_b32 v23, v13, v207
v_pk_add_f32 v[132:133], v[132:133], v[16:17]
v_pk_add_f32 v[134:135], v[134:135], v[18:19]
v_pk_add_f32 v[140:141], v[140:141], v[20:21]
v_pk_add_f32 v[142:143], v[142:143], v[22:23]
s_cmp_lg_u32 s3, s84
s_cbranch_scc1 L_NO9
v_lshlrev_b32 v16, 16, v208
v_and_b32 v17, v13, v208
v_lshlrev_b32 v18, 16, v209
v_and_b32 v19, v13, v209
v_lshlrev_b32 v20, 16, v210
v_and_b32 v21, v13, v210
v_lshlrev_b32 v22, 16, v211
v_and_b32 v23, v13, v211
v_pk_add_f32 v[120:121], v[120:121], v[16:17]
v_pk_add_f32 v[122:123], v[122:123], v[18:19]
v_pk_add_f32 v[124:125], v[124:125], v[20:21]
v_pk_add_f32 v[126:127], v[126:127], v[22:23]
v_lshlrev_b32 v16, 16, v212
v_and_b32 v17, v13, v212
v_lshlrev_b32 v18, 16, v213
v_and_b32 v19, v13, v213
v_lshlrev_b32 v20, 16, v214
v_and_b32 v21, v13, v214
v_lshlrev_b32 v22, 16, v215
v_and_b32 v23, v13, v215
v_pk_add_f32 v[120:121], v[120:121], v[16:17]
v_pk_add_f32 v[122:123], v[122:123], v[18:19]
v_pk_add_f32 v[124:125], v[124:125], v[20:21]
v_pk_add_f32 v[126:127], v[126:127], v[22:23]
v_lshlrev_b32 v16, 16, v216
v_and_b32 v17, v13, v216
v_lshlrev_b32 v18, 16, v217
v_and_b32 v19, v13, v217
v_lshlrev_b32 v20, 16, v218
v_and_b32 v21, v13, v218
v_lshlrev_b32 v22, 16, v219
v_and_b32 v23, v13, v219
v_pk_add_f32 v[120:121], v[120:121], v[16:17]
v_pk_add_f32 v[122:123], v[122:123], v[18:19]
v_pk_add_f32 v[124:125], v[124:125], v[20:21]
v_pk_add_f32 v[126:127], v[126:127], v[22:23]
v_cvt_pk_bf16_f32 v228, v120, v121
v_cvt_pk_bf16_f32 v229, v122, v123
v_cvt_pk_bf16_f32 v230, v124, v125
v_cvt_pk_bf16_f32 v231, v126, v127
s_waitcnt vmcnt(0)
buffer_store_dwordx2 v[228:229], v6, s[44:47], s54 offen sc1
buffer_store_dwordx2 v[230:231], v6, s[44:47], s55 offen sc1
s_branch L_9D
L_NO9:
s_waitcnt vmcnt(0)
L_9D:
v_lshlrev_b32 v16, 16, v220
v_and_b32 v17, v13, v220
v_lshlrev_b32 v18, 16, v221
v_and_b32 v19, v13, v221
v_lshlrev_b32 v20, 16, v222
v_and_b32 v21, v13, v222
v_lshlrev_b32 v22, 16, v223
v_and_b32 v23, v13, v223
v_pk_add_f32 v[128:129], v[128:129], v[16:17]
v_pk_add_f32 v[130:131], v[130:131], v[18:19]
v_pk_add_f32 v[136:137], v[136:137], v[20:21]
v_pk_add_f32 v[138:139], v[138:139], v[22:23]
v_cvt_pk_bf16_f32 v128, v128, v129
v_cvt_pk_bf16_f32 v129, v130, v131
v_cvt_pk_bf16_f32 v130, v136, v137
v_cvt_pk_bf16_f32 v131, v138, v139
s_nop 1
v_permlane16_swap_b32 v128, v130
v_permlane16_swap_b32 v129, v131
buffer_store_dwordx4 v[128:131], v5, s[44:47], s52 offen sc1
v_lshlrev_b32 v16, 16, v224
v_and_b32 v17, v13, v224
v_lshlrev_b32 v18, 16, v225
v_and_b32 v19, v13, v225
v_lshlrev_b32 v20, 16, v226
v_and_b32 v21, v13, v226
v_lshlrev_b32 v22, 16, v227
v_and_b32 v23, v13, v227
v_pk_add_f32 v[132:133], v[132:133], v[16:17]
v_pk_add_f32 v[134:135], v[134:135], v[18:19]
v_pk_add_f32 v[140:141], v[140:141], v[20:21]
v_pk_add_f32 v[142:143], v[142:143], v[22:23]
v_cvt_pk_bf16_f32 v132, v132, v133
v_cvt_pk_bf16_f32 v133, v134, v135
v_cvt_pk_bf16_f32 v134, v140, v141
v_cvt_pk_bf16_f32 v135, v142, v143
s_nop 1
v_permlane16_swap_b32 v132, v134
v_permlane16_swap_b32 v133, v135
buffer_store_dwordx4 v[132:135], v5, s[44:47], s53 offen sc1
L_END:
s_endpgm
L_SE2:
v_accvgpr_read_b32 v180, a224
v_accvgpr_read_b32 v182, a228
v_cmp_nle_f32 vcc, v180, v7
v_cmp_nle_f32 s[96:97], v182, v7
s_nop 3
s_or_b64 vcc, vcc, s[96:97]
s_cbranch_vccnz SLOW0
SLOW0_R:
s_add_u32 s53, s77, 180224
buffer_load_dwordx4 a[112:115], v4, s[24:27], s53 offen offset:0 sc1
v_mul_f32 v8, 0x3fb8aa3b, v8
v_mul_f32 v9, 0x3fb8aa3b, v9
v_exp_f32 v8, v8
v_exp_f32 v9, v9
s_nop 0
v_fma_f32 v180, v180, v8, v180
v_fma_f32 v182, v182, v9, v182
v_rcp_f32 v180, v180
v_rcp_f32 v182, v182
s_add_u32 s52, s78, 4096
v_mov_b32 v181, v180
v_mov_b32 v183, v182
v_pk_mul_f32 v[36:37], v[36:37], v[180:181]
v_pk_mul_f32 v[38:39], v[38:39], v[180:181]
v_pk_mul_f32 v[32:33], v[32:33], v[180:181]
v_pk_mul_f32 v[34:35], v[34:35], v[180:181]
v_cvt_pk_bf16_f32 v36, v36, v37
v_cvt_pk_bf16_f32 v37, v38, v39
v_cvt_pk_bf16_f32 v38, v32, v33
v_cvt_pk_bf16_f32 v39, v34, v35
buffer_store_dwordx4 v[36:39], v4, s[24:27], s78 offen offset:0 sc1
buffer_load_dwordx4 a[116:119], v4, s[24:27], s53 offen offset:1024 sc1
v_pk_mul_f32 v[116:117], v[116:117], v[182:183]
v_pk_mul_f32 v[118:119], v[118:119], v[182:183]
v_pk_mul_f32 v[132:133], v[132:133], v[182:183]
v_pk_mul_f32 v[134:135], v[134:135], v[182:183]
v_cvt_pk_bf16_f32 v116, v116, v117
v_cvt_pk_bf16_f32 v117, v118, v119
v_cvt_pk_bf16_f32 v118, v132, v133
v_cvt_pk_bf16_f32 v119, v134, v135
buffer_store_dwordx4 v[116:119], v4, s[24:27], s78 offen offset:1024 sc1
v_pk_mul_f32 v[196:197], v[196:197], v[180:181]
v_pk_mul_f32 v[198:199], v[198:199], v[180:181]
v_pk_mul_f32 v[204:205], v[204:205], v[180:181]
v_pk_mul_f32 v[206:207], v[206:207], v[180:181]
v_cvt_pk_bf16_f32 v196, v196, v197
v_cvt_pk_bf16_f32 v197, v198, v199
v_cvt_pk_bf16_f32 v198, v204, v205
v_cvt_pk_bf16_f32 v199, v206, v207
buffer_store_dwordx4 v[196:199], v4, s[24:27], s78 offen offset:2048 sc1
v_pk_mul_f32 v[184:185], v[184:185], v[182:183]
v_pk_mul_f32 v[186:187], v[186:187], v[182:183]
v_pk_mul_f32 v[240:241], v[240:241], v[182:183]
buffer_load_dwordx4 a[120:123], v4, s[24:27], s53 offen offset:2048 sc1
v_pk_mul_f32 v[242:243], v[242:243], v[182:183]
v_cvt_pk_bf16_f32 v184, v184, v185
v_cvt_pk_bf16_f32 v185, v186, v187
v_cvt_pk_bf16_f32 v186, v240, v241
v_cvt_pk_bf16_f32 v187, v242, v243
buffer_store_dwordx4 v[184:187], v4, s[24:27], s78 offen offset:3072 sc1
v_pk_mul_f32 v[108:109], v[108:109], v[180:181]
v_pk_mul_f32 v[110:111], v[110:111], v[180:181]
v_pk_mul_f32 v[40:41], v[40:41], v[180:181]
v_pk_mul_f32 v[42:43], v[42:43], v[180:181]
v_cvt_pk_bf16_f32 v108, v108, v109
v_cvt_pk_bf16_f32 v109, v110, v111
v_cvt_pk_bf16_f32 v110, v40, v41
v_cvt_pk_bf16_f32 v111, v42, v43
buffer_store_dwordx4 v[108:111], v4, s[24:27], s52 offen offset:0 sc1
v_pk_mul_f32 v[188:189], v[188:189], v[182:183]
v_pk_mul_f32 v[190:191], v[190:191], v[182:183]
v_pk_mul_f32 v[56:57], v[56:57], v[182:183]
v_pk_mul_f32 v[58:59], v[58:59], v[182:183]
v_cvt_pk_bf16_f32 v188, v188, v189
v_cvt_pk_bf16_f32 v189, v190, v191
buffer_load_dwordx4 a[124:127], v4, s[24:27], s53 offen offset:3072 sc1
v_cvt_pk_bf16_f32 v190, v56, v57
v_cvt_pk_bf16_f32 v191, v58, v59
buffer_store_dwordx4 v[188:191], v4, s[24:27], s52 offen offset:1024 sc1
v_pk_mul_f32 v[80:81], v[80:81], v[180:181]
v_pk_mul_f32 v[82:83], v[82:83], v[180:181]
v_pk_mul_f32 v[168:169], v[168:169], v[180:181]
v_pk_mul_f32 v[170:171], v[170:171], v[180:181]
v_cvt_pk_bf16_f32 v80, v80, v81
v_cvt_pk_bf16_f32 v81, v82, v83
v_cvt_pk_bf16_f32 v82, v168, v169
v_cvt_pk_bf16_f32 v83, v170, v171
buffer_store_dwordx4 v[80:83], v4, s[24:27], s52 offen offset:2048 sc1
v_pk_mul_f32 v[88:89], v[88:89], v[182:183]
v_pk_mul_f32 v[90:91], v[90:91], v[182:183]
v_pk_mul_f32 v[192:193], v[192:193], v[182:183]
v_pk_mul_f32 v[194:195], v[194:195], v[182:183]
v_cvt_pk_bf16_f32 v88, v88, v89
v_cvt_pk_bf16_f32 v89, v90, v91
v_cvt_pk_bf16_f32 v90, v192, v193
v_cvt_pk_bf16_f32 v91, v194, v195
buffer_store_dwordx4 v[88:91], v4, s[24:27], s52 offen offset:3072 sc1
s_branch L_LA
CK_Z:
s_mov_b32 s92, 0
CK_Z_L:
s_sleep 1
buffer_load_dword v23, v22, s[40:43], 0 offen sc1
s_add_u32 s92, s92, 1
s_waitcnt vmcnt(0)
v_cmp_gt_u32 vcc, 1, v23
s_cmp_gt_u32 s92, 1048576
s_cbranch_scc1 CK_Z_R
s_nop 3
s_cbranch_vccnz CK_Z_L
s_branch CK_Z_R
CK_WA:
s_mov_b32 s92, 0
CK_WA_L:
s_sleep 1
buffer_load_dword v30, v29, s[24:27], s89 offen sc1
s_add_u32 s92, s92, 1
s_waitcnt vmcnt(0)
v_cmp_gt_u32 vcc, 18, v30
s_cmp_gt_u32 s92, 1048576
s_cbranch_scc1 CK_WA_R
s_nop 3
s_cbranch_vccnz CK_WA_L
s_branch CK_WA_R
CK_ZA:
s_mov_b32 s92, 0
CK_ZA_L:
s_sleep 1
buffer_load_dword v30, v28, s[40:43], 0 offen sc1
s_add_u32 s92, s92, 1
s_waitcnt vmcnt(0)
v_cmp_gt_u32 vcc, 1, v30
s_cmp_gt_u32 s92, 1048576
s_cbranch_scc1 CK_ZA_R
s_nop 3
s_cbranch_vccnz CK_ZA_L
s_branch CK_ZA_R
CK_KV:
s_mov_b32 s92, 0
CK_KV_L:
s_sleep 1
buffer_load_dword v30, v29, s[24:27], s89 offen offset:4 sc1
s_add_u32 s92, s92, 1
s_waitcnt vmcnt(0)
v_cmp_gt_u32 vcc, 8, v30
s_cmp_gt_u32 s92, 1048576
s_cbranch_scc1 CK_KV_R
s_nop 3
s_cbranch_vccnz CK_KV_L
s_branch CK_KV_R
D0:
v_cndmask_b32 v96, v96, v6, s[56:57]
v_cndmask_b32 v120, v120, v6, s[56:57]
v_mov_b32 v112, v6
v_cndmask_b32 v97, v97, v6, s[58:59]
v_cndmask_b32 v121, v121, v6, s[58:59]
v_mov_b32 v113, v6
v_cndmask_b32 v98, v98, v6, s[60:61]
v_cndmask_b32 v122, v122, v6, s[60:61]
v_mov_b32 v114, v6
v_cndmask_b32 v99, v99, v6, s[62:63]
v_cndmask_b32 v123, v123, v6, s[62:63]
v_mov_b32 v115, v6
s_branch D0_R
CK_Q:
s_mov_b32 s92, 0
CK_Q_L:
s_sleep 1
buffer_load_dword v172, v173, s[24:27], 0 offen sc1
s_add_u32 s92, s92, 1
s_waitcnt vmcnt(0)
v_cmp_gt_u32 vcc, 32, v172
s_cmp_gt_u32 s92, 1048576
s_cbranch_scc1 CK_Q_R
s_nop 3
s_cbranch_vccnz CK_Q_L
s_branch CK_Q_R
CK_ZAA:
s_mov_b32 s92, 0
CK_ZAA_L:
s_sleep 1
buffer_load_dword v12, v10, s[24:27], s75 offen offset:4 sc1
s_add_u32 s92, s92, 1
s_waitcnt vmcnt(0)
v_cmp_gt_u32 vcc, 8, v12
s_cmp_gt_u32 s92, 1048576
s_cbranch_scc1 CK_ZAA_R
s_nop 3
s_cbranch_vccnz CK_ZAA_L
s_branch CK_ZAA_R
CK_P1:
s_mov_b32 s92, 0
CK_P1_L:
s_sleep 1
buffer_load_dword v12, v10, s[24:27], s73 offen sc1
s_add_u32 s92, s92, 1
s_waitcnt vmcnt(0)
v_cmp_gt_u32 vcc, 4, v12
s_cmp_gt_u32 s92, 1048576
s_cbranch_scc1 CK_P1_R
s_nop 3
s_cbranch_vccnz CK_P1_L
s_branch CK_P1_R
CK_P2:
s_mov_b32 s92, 0
CK_P2_L:
s_sleep 1
buffer_load_dword v12, v10, s[24:27], s73 offen offset:16 sc1
s_add_u32 s92, s92, 1
s_waitcnt vmcnt(0)
v_cmp_gt_u32 vcc, 4, v12
s_cmp_gt_u32 s92, 1048576
s_cbranch_scc1 CK_P2_R
s_nop 3
s_cbranch_vccnz CK_P2_L
s_branch CK_P2_R
SLOW0:
v_add_u32 v20, 4096, v4
s_mov_b32 s54, 0
v_mov_b32 v16, v6
v_mov_b32 v18, v6
SLOW0_P:
s_mov_b32 s53, 0
s_mov_b32 s52, s94
SLOW0_T:
s_add_u32 s55, s52, 24576
buffer_load_dwordx4 a[192:195], v4, s[24:27], s52 offen offset:0 sc1
buffer_load_dwordx4 a[196:199], v4, s[24:27], s52 offen offset:1024 sc1
buffer_load_dwordx4 a[200:203], v4, s[24:27], s52 offen offset:2048 sc1
buffer_load_dwordx4 a[204:207], v4, s[24:27], s52 offen offset:3072 sc1
buffer_load_dwordx4 a[208:211], v20, s[24:27], s52 offen offset:0 sc1
buffer_load_dwordx4 a[212:215], v20, s[24:27], s52 offen offset:1024 sc1
buffer_load_dwordx4 a[216:219], v20, s[24:27], s52 offen offset:2048 sc1
buffer_load_dwordx4 a[220:223], v20, s[24:27], s52 offen offset:3072 sc1
buffer_load_dwordx4 a[64:67], v4, s[24:27], s55 offen offset:0 sc1
buffer_load_dwordx4 a[68:71], v4, s[24:27], s55 offen offset:1024 sc1
buffer_load_dwordx4 a[72:75], v4, s[24:27], s55 offen offset:2048 sc1
buffer_load_dwordx4 a[76:79], v4, s[24:27], s55 offen offset:3072 sc1
buffer_load_dwordx4 a[80:83], v20, s[24:27], s55 offen offset:0 sc1
buffer_load_dwordx4 a[84:87], v20, s[24:27], s55 offen offset:1024 sc1
buffer_load_dwordx4 a[88:91], v20, s[24:27], s55 offen offset:2048 sc1
buffer_load_dwordx4 a[92:95], v20, s[24:27], s55 offen offset:3072 sc1
s_waitcnt vmcnt(0)
v_mfma_f32_16x16x32_bf16 v[44:47], a[192:195], a[32:35], 0
v_mfma_f32_16x16x32_bf16 v[44:47], a[196:199], a[36:39], v[44:47]
v_mfma_f32_16x16x32_bf16 v[44:47], a[200:203], a[28:31], v[44:47]
v_mfma_f32_16x16x32_bf16 v[44:47], a[204:207], a[20:23], v[44:47]
v_mfma_f32_16x16x32_bf16 v[52:55], a[192:195], a[44:47], 0
v_mfma_f32_16x16x32_bf16 v[52:55], a[196:199], a[40:43], v[52:55]
v_mfma_f32_16x16x32_bf16 v[52:55], a[200:203], a[12:15], v[52:55]
v_mfma_f32_16x16x32_bf16 v[52:55], a[204:207], a[4:7], v[52:55]
v_mfma_f32_16x16x32_bf16 v[64:67], a[208:211], a[32:35], 0
v_mfma_f32_16x16x32_bf16 v[64:67], a[212:215], a[36:39], v[64:67]
v_mfma_f32_16x16x32_bf16 v[64:67], a[216:219], a[28:31], v[64:67]
v_mfma_f32_16x16x32_bf16 v[64:67], a[220:223], a[20:23], v[64:67]
v_mfma_f32_16x16x32_bf16 v[212:215], a[208:211], a[44:47], 0
v_mfma_f32_16x16x32_bf16 v[212:215], a[212:215], a[40:43], v[212:215]
v_mfma_f32_16x16x32_bf16 v[212:215], a[216:219], a[12:15], v[212:215]
v_mfma_f32_16x16x32_bf16 v[212:215], a[220:223], a[4:7], v[212:215]
s_nop 7
s_cmp_lg_u32 s53, s66
s_cbranch_scc1 SLOW0_U
v_cndmask_b32 v44, v44, v6, s[56:57]
v_cndmask_b32 v212, v212, v6, s[56:57]
v_mov_b32 v64, v6
v_cndmask_b32 v45, v45, v6, s[58:59]
v_cndmask_b32 v213, v213, v6, s[58:59]
v_mov_b32 v65, v6
v_cndmask_b32 v46, v46, v6, s[60:61]
v_cndmask_b32 v214, v214, v6, s[60:61]
v_mov_b32 v66, v6
v_cndmask_b32 v47, v47, v6, s[62:63]
v_cndmask_b32 v215, v215, v6, s[62:63]
v_mov_b32 v67, v6
SLOW0_U:
s_cmp_lg_u32 s54, 0
s_cbranch_scc1 SLOW0_A
v_max3_f32 v16, v16, v44, v45
v_max3_f32 v16, v16, v46, v47
v_max3_f32 v18, v18, v52, v53
v_max3_f32 v18, v18, v54, v55
v_max3_f32 v16, v16, v64, v65
v_max3_f32 v16, v16, v66, v67
v_max3_f32 v18, v18, v212, v213
v_max3_f32 v18, v18, v214, v215
s_branch SLOW0_N
SLOW0_A:
v_sub_f32 v44, v44, v16
v_sub_f32 v45, v45, v16
v_sub_f32 v46, v46, v16
v_sub_f32 v47, v47, v16
v_sub_f32 v52, v52, v18
v_sub_f32 v53, v53, v18
v_sub_f32 v54, v54, v18
v_sub_f32 v55, v55, v18
v_sub_f32 v64, v64, v16
v_sub_f32 v65, v65, v16
v_sub_f32 v66, v66, v16
v_sub_f32 v67, v67, v16
v_sub_f32 v212, v212, v18
v_sub_f32 v213, v213, v18
v_sub_f32 v214, v214, v18
v_sub_f32 v215, v215, v18
v_exp_f32 v44, v44
v_exp_f32 v45, v45
v_exp_f32 v46, v46
v_exp_f32 v47, v47
v_exp_f32 v52, v52
v_exp_f32 v53, v53
v_exp_f32 v54, v54
v_exp_f32 v55, v55
v_exp_f32 v64, v64
v_exp_f32 v65, v65
v_exp_f32 v66, v66
v_exp_f32 v67, v67
v_exp_f32 v212, v212
v_exp_f32 v213, v213
v_exp_f32 v214, v214
v_exp_f32 v215, v215
s_nop 0
v_cvt_pk_bf16_f32 v124, v44, v45
v_cvt_pk_bf16_f32 v125, v46, v47
v_cvt_pk_bf16_f32 v140, v52, v53
v_cvt_pk_bf16_f32 v141, v54, v55
v_cvt_pk_bf16_f32 v126, v64, v65
v_cvt_pk_bf16_f32 v127, v66, v67
v_cvt_pk_bf16_f32 v142, v212, v213
v_cvt_pk_bf16_f32 v143, v214, v215
s_nop 1
v_mfma_f32_16x16x32_bf16 v[36:39], a[64:67], v[124:127], v[36:39]
v_mfma_f32_16x16x32_bf16 v[116:119], a[64:67], v[140:143], v[116:119]
v_mfma_f32_16x16x32_bf16 v[132:135], a[68:71], v[140:143], v[132:135]
v_mfma_f32_16x16x32_bf16 v[32:35], a[68:71], v[124:127], v[32:35]
v_mfma_f32_16x16x32_bf16 v[196:199], a[72:75], v[124:127], v[196:199]
v_mfma_f32_16x16x32_bf16 v[184:187], a[72:75], v[140:143], v[184:187]
v_mfma_f32_16x16x32_bf16 v[240:243], a[76:79], v[140:143], v[240:243]
v_mfma_f32_16x16x32_bf16 v[204:207], a[76:79], v[124:127], v[204:207]
v_mfma_f32_16x16x32_bf16 v[108:111], a[80:83], v[124:127], v[108:111]
v_mfma_f32_16x16x32_bf16 v[188:191], a[80:83], v[140:143], v[188:191]
v_mfma_f32_16x16x32_bf16 v[56:59], a[84:87], v[140:143], v[56:59]
v_mfma_f32_16x16x32_bf16 v[40:43], a[84:87], v[124:127], v[40:43]
v_mfma_f32_16x16x32_bf16 v[80:83], a[88:91], v[124:127], v[80:83]
v_mfma_f32_16x16x32_bf16 v[88:91], a[88:91], v[140:143], v[88:91]
v_mfma_f32_16x16x32_bf16 v[192:195], a[92:95], v[140:143], v[192:195]
v_mfma_f32_16x16x32_bf16 v[168:171], a[92:95], v[124:127], v[168:171]
v_mfma_f32_16x16x32_bf16 a[224:227], a[240:243], v[124:127], a[224:227]
v_mfma_f32_16x16x32_bf16 a[228:231], a[240:243], v[140:143], a[228:231]
SLOW0_N:
s_add_u32 s52, s52, 16384
s_add_u32 s53, s53, 1
s_cmp_le_u32 s53, s66
s_cbranch_scc1 SLOW0_T
s_cmp_lg_u32 s54, 0
s_cbranch_scc1 SLOW0_E
v_mov_b32 v17, v16
v_mov_b32 v19, v18
s_nop 1
v_permlane32_swap_b32 v17, v16
v_permlane32_swap_b32 v19, v18
s_nop 1
v_max_f32 v16, v16, v17
v_max_f32 v18, v18, v19
v_mov_b32 v17, v16
v_mov_b32 v19, v18
s_nop 1
v_permlane16_swap_b32 v17, v16
v_permlane16_swap_b32 v19, v18
s_nop 1
v_max_f32 v16, v16, v17
v_max_f32 v18, v18, v19
v_mov_b32 v36, 0
v_mov_b32 v37, 0
v_mov_b32 v38, 0
v_mov_b32 v39, 0
v_mov_b32 v32, 0
v_mov_b32 v33, 0
v_mov_b32 v34, 0
v_mov_b32 v35, 0
v_mov_b32 v196, 0
v_mov_b32 v197, 0
v_mov_b32 v198, 0
v_mov_b32 v199, 0
v_mov_b32 v204, 0
v_mov_b32 v205, 0
v_mov_b32 v206, 0
v_mov_b32 v207, 0
v_mov_b32 v108, 0
v_mov_b32 v109, 0
v_mov_b32 v110, 0
v_mov_b32 v111, 0
v_mov_b32 v40, 0
v_mov_b32 v41, 0
v_mov_b32 v42, 0
v_mov_b32 v43, 0
v_mov_b32 v80, 0
v_mov_b32 v81, 0
v_mov_b32 v82, 0
v_mov_b32 v83, 0
v_mov_b32 v168, 0
v_mov_b32 v169, 0
v_mov_b32 v170, 0
v_mov_b32 v171, 0
v_mov_b32 v116, 0
v_mov_b32 v117, 0
v_mov_b32 v118, 0
v_mov_b32 v119, 0
v_mov_b32 v132, 0
v_mov_b32 v133, 0
v_mov_b32 v134, 0
v_mov_b32 v135, 0
v_mov_b32 v184, 0
v_mov_b32 v185, 0
v_mov_b32 v186, 0
v_mov_b32 v187, 0
v_mov_b32 v240, 0
v_mov_b32 v241, 0
v_mov_b32 v242, 0
v_mov_b32 v243, 0
v_mov_b32 v188, 0
v_mov_b32 v189, 0
v_mov_b32 v190, 0
v_mov_b32 v191, 0
v_mov_b32 v56, 0
v_mov_b32 v57, 0
v_mov_b32 v58, 0
v_mov_b32 v59, 0
v_mov_b32 v88, 0
v_mov_b32 v89, 0
v_mov_b32 v90, 0
v_mov_b32 v91, 0
v_mov_b32 v192, 0
v_mov_b32 v193, 0
v_mov_b32 v194, 0
v_mov_b32 v195, 0
v_accvgpr_write_b32 a224, 0
v_accvgpr_write_b32 a225, 0
v_accvgpr_write_b32 a226, 0
v_accvgpr_write_b32 a227, 0
v_accvgpr_write_b32 a228, 0
v_accvgpr_write_b32 a229, 0
v_accvgpr_write_b32 a230, 0
v_accvgpr_write_b32 a231, 0
s_mov_b32 s54, 1
s_branch SLOW0_P
SLOW0_E:
s_nop 7
v_accvgpr_read_b32 v180, a224
v_accvgpr_read_b32 v182, a228
s_branch SLOW0_R
SLOW1:
v_add_u32 v20, 4096, v4
s_mov_b32 s54, 0
v_mov_b32 v16, v6
v_mov_b32 v18, v6
SLOW1_P:
s_mov_b32 s53, 0
s_mov_b32 s52, s94
SLOW1_T:
s_add_u32 s55, s52, 24576
buffer_load_dwordx4 a[192:195], v4, s[24:27], s52 offen offset:0 sc1
buffer_load_dwordx4 a[196:199], v4, s[24:27], s52 offen offset:1024 sc1
buffer_load_dwordx4 a[200:203], v4, s[24:27], s52 offen offset:2048 sc1
buffer_load_dwordx4 a[204:207], v4, s[24:27], s52 offen offset:3072 sc1
buffer_load_dwordx4 a[208:211], v20, s[24:27], s52 offen offset:0 sc1
buffer_load_dwordx4 a[212:215], v20, s[24:27], s52 offen offset:1024 sc1
buffer_load_dwordx4 a[216:219], v20, s[24:27], s52 offen offset:2048 sc1
buffer_load_dwordx4 a[220:223], v20, s[24:27], s52 offen offset:3072 sc1
buffer_load_dwordx4 a[64:67], v4, s[24:27], s55 offen offset:0 sc1
buffer_load_dwordx4 a[68:71], v4, s[24:27], s55 offen offset:1024 sc1
buffer_load_dwordx4 a[72:75], v4, s[24:27], s55 offen offset:2048 sc1
buffer_load_dwordx4 a[76:79], v4, s[24:27], s55 offen offset:3072 sc1
buffer_load_dwordx4 a[80:83], v20, s[24:27], s55 offen offset:0 sc1
buffer_load_dwordx4 a[84:87], v20, s[24:27], s55 offen offset:1024 sc1
buffer_load_dwordx4 a[88:91], v20, s[24:27], s55 offen offset:2048 sc1
buffer_load_dwordx4 a[92:95], v20, s[24:27], s55 offen offset:3072 sc1
s_waitcnt vmcnt(0)
v_mfma_f32_16x16x32_bf16 v[44:47], a[192:195], a[48:51], 0
v_mfma_f32_16x16x32_bf16 v[44:47], a[196:199], a[52:55], v[44:47]
v_mfma_f32_16x16x32_bf16 v[44:47], a[200:203], a[0:3], v[44:47]
v_mfma_f32_16x16x32_bf16 v[44:47], a[204:207], a[8:11], v[44:47]
v_mfma_f32_16x16x32_bf16 v[52:55], a[192:195], a[60:63], 0
v_mfma_f32_16x16x32_bf16 v[52:55], a[196:199], a[56:59], v[52:55]
v_mfma_f32_16x16x32_bf16 v[52:55], a[200:203], a[16:19], v[52:55]
v_mfma_f32_16x16x32_bf16 v[52:55], a[204:207], a[24:27], v[52:55]
v_mfma_f32_16x16x32_bf16 v[64:67], a[208:211], a[48:51], 0
v_mfma_f32_16x16x32_bf16 v[64:67], a[212:215], a[52:55], v[64:67]
v_mfma_f32_16x16x32_bf16 v[64:67], a[216:219], a[0:3], v[64:67]
v_mfma_f32_16x16x32_bf16 v[64:67], a[220:223], a[8:11], v[64:67]
v_mfma_f32_16x16x32_bf16 v[212:215], a[208:211], a[60:63], 0
v_mfma_f32_16x16x32_bf16 v[212:215], a[212:215], a[56:59], v[212:215]
v_mfma_f32_16x16x32_bf16 v[212:215], a[216:219], a[16:19], v[212:215]
v_mfma_f32_16x16x32_bf16 v[212:215], a[220:223], a[24:27], v[212:215]
s_nop 7
s_cmp_lg_u32 s53, s67
s_cbranch_scc1 SLOW1_U
v_cndmask_b32 v44, v44, v6, s[56:57]
v_cndmask_b32 v212, v212, v6, s[56:57]
v_mov_b32 v64, v6
v_cndmask_b32 v45, v45, v6, s[58:59]
v_cndmask_b32 v213, v213, v6, s[58:59]
v_mov_b32 v65, v6
v_cndmask_b32 v46, v46, v6, s[60:61]
v_cndmask_b32 v214, v214, v6, s[60:61]
v_mov_b32 v66, v6
v_cndmask_b32 v47, v47, v6, s[62:63]
v_cndmask_b32 v215, v215, v6, s[62:63]
v_mov_b32 v67, v6
SLOW1_U:
s_cmp_lg_u32 s54, 0
s_cbranch_scc1 SLOW1_A
v_max3_f32 v16, v16, v44, v45
v_max3_f32 v16, v16, v46, v47
v_max3_f32 v18, v18, v52, v53
v_max3_f32 v18, v18, v54, v55
v_max3_f32 v16, v16, v64, v65
v_max3_f32 v16, v16, v66, v67
v_max3_f32 v18, v18, v212, v213
v_max3_f32 v18, v18, v214, v215
s_branch SLOW1_N
SLOW1_A:
v_sub_f32 v44, v44, v16
v_sub_f32 v45, v45, v16
v_sub_f32 v46, v46, v16
v_sub_f32 v47, v47, v16
v_sub_f32 v52, v52, v18
v_sub_f32 v53, v53, v18
v_sub_f32 v54, v54, v18
v_sub_f32 v55, v55, v18
v_sub_f32 v64, v64, v16
v_sub_f32 v65, v65, v16
v_sub_f32 v66, v66, v16
v_sub_f32 v67, v67, v16
v_sub_f32 v212, v212, v18
v_sub_f32 v213, v213, v18
v_sub_f32 v214, v214, v18
v_sub_f32 v215, v215, v18
v_exp_f32 v44, v44
v_exp_f32 v45, v45
v_exp_f32 v46, v46
v_exp_f32 v47, v47
v_exp_f32 v52, v52
v_exp_f32 v53, v53
v_exp_f32 v54, v54
v_exp_f32 v55, v55
v_exp_f32 v64, v64
v_exp_f32 v65, v65
v_exp_f32 v66, v66
v_exp_f32 v67, v67
v_exp_f32 v212, v212
v_exp_f32 v213, v213
v_exp_f32 v214, v214
v_exp_f32 v215, v215
s_nop 0
v_cvt_pk_bf16_f32 v124, v44, v45
v_cvt_pk_bf16_f32 v125, v46, v47
v_cvt_pk_bf16_f32 v140, v52, v53
v_cvt_pk_bf16_f32 v141, v54, v55
v_cvt_pk_bf16_f32 v126, v64, v65
v_cvt_pk_bf16_f32 v127, v66, v67
v_cvt_pk_bf16_f32 v142, v212, v213
v_cvt_pk_bf16_f32 v143, v214, v215
s_nop 1
v_mfma_f32_16x16x32_bf16 v[60:63], a[64:67], v[124:127], v[60:63]
v_mfma_f32_16x16x32_bf16 v[148:151], a[64:67], v[140:143], v[148:151]
v_mfma_f32_16x16x32_bf16 v[48:51], a[68:71], v[140:143], v[48:51]
v_mfma_f32_16x16x32_bf16 v[68:71], a[68:71], v[124:127], v[68:71]
v_mfma_f32_16x16x32_bf16 v[72:75], a[72:75], v[124:127], v[72:75]
v_mfma_f32_16x16x32_bf16 v[236:239], a[72:75], v[140:143], v[236:239]
v_mfma_f32_16x16x32_bf16 v[224:227], a[76:79], v[140:143], v[224:227]
v_mfma_f32_16x16x32_bf16 v[220:223], a[76:79], v[124:127], v[220:223]
v_mfma_f32_16x16x32_bf16 v[84:87], a[80:83], v[124:127], v[84:87]
v_mfma_f32_16x16x32_bf16 v[164:167], a[80:83], v[140:143], v[164:167]
v_mfma_f32_16x16x32_bf16 v[156:159], a[84:87], v[140:143], v[156:159]
v_mfma_f32_16x16x32_bf16 v[76:79], a[84:87], v[124:127], v[76:79]
v_mfma_f32_16x16x32_bf16 v[160:163], a[88:91], v[124:127], v[160:163]
v_mfma_f32_16x16x32_bf16 v[216:219], a[88:91], v[140:143], v[216:219]
v_mfma_f32_16x16x32_bf16 v[208:211], a[92:95], v[140:143], v[208:211]
v_mfma_f32_16x16x32_bf16 v[252:255], a[92:95], v[124:127], v[252:255]
v_mfma_f32_16x16x32_bf16 a[232:235], a[240:243], v[124:127], a[232:235]
v_mfma_f32_16x16x32_bf16 a[236:239], a[240:243], v[140:143], a[236:239]
SLOW1_N:
s_add_u32 s52, s52, 16384
s_add_u32 s53, s53, 1
s_cmp_le_u32 s53, s67
s_cbranch_scc1 SLOW1_T
s_cmp_lg_u32 s54, 0
s_cbranch_scc1 SLOW1_E
v_mov_b32 v17, v16
v_mov_b32 v19, v18
s_nop 1
v_permlane32_swap_b32 v17, v16
v_permlane32_swap_b32 v19, v18
s_nop 1
v_max_f32 v16, v16, v17
v_max_f32 v18, v18, v19
v_mov_b32 v17, v16
v_mov_b32 v19, v18
s_nop 1
v_permlane16_swap_b32 v17, v16
v_permlane16_swap_b32 v19, v18
s_nop 1
v_max_f32 v16, v16, v17
v_max_f32 v18, v18, v19
v_mov_b32 v60, 0
v_mov_b32 v61, 0
v_mov_b32 v62, 0
v_mov_b32 v63, 0
v_mov_b32 v68, 0
v_mov_b32 v69, 0
v_mov_b32 v70, 0
v_mov_b32 v71, 0
v_mov_b32 v72, 0
v_mov_b32 v73, 0
v_mov_b32 v74, 0
v_mov_b32 v75, 0
v_mov_b32 v220, 0
v_mov_b32 v221, 0
v_mov_b32 v222, 0
v_mov_b32 v223, 0
v_mov_b32 v84, 0
v_mov_b32 v85, 0
v_mov_b32 v86, 0
v_mov_b32 v87, 0
v_mov_b32 v76, 0
v_mov_b32 v77, 0
v_mov_b32 v78, 0
v_mov_b32 v79, 0
v_mov_b32 v160, 0
v_mov_b32 v161, 0
v_mov_b32 v162, 0
v_mov_b32 v163, 0
v_mov_b32 v252, 0
v_mov_b32 v253, 0
v_mov_b32 v254, 0
v_mov_b32 v255, 0
v_mov_b32 v148, 0
v_mov_b32 v149, 0
v_mov_b32 v150, 0
v_mov_b32 v151, 0
v_mov_b32 v48, 0
v_mov_b32 v49, 0
v_mov_b32 v50, 0
v_mov_b32 v51, 0
v_mov_b32 v236, 0
v_mov_b32 v237, 0
v_mov_b32 v238, 0
v_mov_b32 v239, 0
v_mov_b32 v224, 0
v_mov_b32 v225, 0
v_mov_b32 v226, 0
v_mov_b32 v227, 0
v_mov_b32 v164, 0
v_mov_b32 v165, 0
v_mov_b32 v166, 0
v_mov_b32 v167, 0
v_mov_b32 v156, 0
v_mov_b32 v157, 0
v_mov_b32 v158, 0
v_mov_b32 v159, 0
v_mov_b32 v216, 0
v_mov_b32 v217, 0
v_mov_b32 v218, 0
v_mov_b32 v219, 0
v_mov_b32 v208, 0
v_mov_b32 v209, 0
v_mov_b32 v210, 0
v_mov_b32 v211, 0
v_accvgpr_write_b32 a232, 0
v_accvgpr_write_b32 a233, 0
v_accvgpr_write_b32 a234, 0
v_accvgpr_write_b32 a235, 0
v_accvgpr_write_b32 a236, 0
v_accvgpr_write_b32 a237, 0
v_accvgpr_write_b32 a238, 0
v_accvgpr_write_b32 a239, 0
s_mov_b32 s54, 1
s_branch SLOW1_P
SLOW1_E:
s_nop 7
v_accvgpr_read_b32 v180, a232
v_accvgpr_read_b32 v182, a236
s_branch SLOW1_R
.section .rodata,"a"
.p2align 6
.amdhsa_kernel gated_mix__sliding_local_dilated__compressed_kv_cla__prompt_kernel
  .amdhsa_next_free_vgpr 512
  .amdhsa_next_free_sgpr 102
  .amdhsa_accum_offset 256
  .amdhsa_group_segment_fixed_size 0
  .amdhsa_kernarg_size 104
  .amdhsa_user_sgpr_count 2
  .amdhsa_user_sgpr_kernarg_segment_ptr 1
  .amdhsa_system_sgpr_workgroup_id_x 1
.end_amdhsa_kernel
```

```asm
; @launch grid=(256,1,1) block=(256,1,1) lds=163840
.amdgcn_target "amdgcn-amd-amdhsa--gfx950"
.text

.globl gated_mix__sliding_local_dilated__compressed_kv_cla__prompt_kernel
.p2align 8
.type gated_mix__sliding_local_dilated__compressed_kv_cla__prompt_kernel,@function
gated_mix__sliding_local_dilated__compressed_kv_cla__prompt_kernel:
s_cmp_ge_u32 s2, 256
s_cbranch_scc1 L_END
s_load_dwordx2 s[8:9], s[0:1], 32
s_load_dwordx2 s[56:57], s[0:1], 56
s_load_dwordx2 s[16:17], s[0:1], 48
s_load_dwordx2 s[24:25], s[0:1], 96
s_load_dwordx2 s[12:13], s[0:1], 0
s_load_dwordx2 s[20:21], s[0:1], 40
s_load_dwordx2 s[28:29], s[0:1], 8
s_load_dwordx2 s[48:49], s[0:1], 16
s_load_dwordx2 s[32:33], s[0:1], 64
s_load_dwordx2 s[36:37], s[0:1], 72
s_load_dwordx2 s[40:41], s[0:1], 88
s_load_dwordx2 s[44:45], s[0:1], 80
s_getpc_b64 s[96:97]
L_PC:
s_lshr_b32 s6, s2, 3
s_lshl_b32 s98, s6, 11
s_add_u32 s98, s98, L_MAIN-L_PC
s_add_u32 s96, s96, s98
s_addc_u32 s97, s97, 0
v_lshlrev_b32 v16, 3, v0
v_mov_b32 v17, s97
v_add_co_u32 v16, vcc, s96, v16
v_lshrrev_b32 v5, 6, v0
v_and_b32 v1, 63, v0
v_addc_co_u32 v17, vcc, 0, v17, vcc
v_readfirstlane_b32 s3, v5
global_load_dwordx2 a[252:253], v[16:17], off
v_and_b32 v2, 15, v0
v_lshrrev_b32 v3, 4, v1
v_lshlrev_b32 v4, 4, v1
s_and_b32 s7, s2, 7
s_and_b32 s65, s6, 3
s_lshl2_add_u32 s4, s7, s65
s_lshr_b32 s5, s6, 2
s_lshl2_add_u32 s66, s5, s3
s_sub_u32 s67, 63, s66
v_lshrrev_b32 v16, 3, v1
v_and_b32 v17, 7, v1
v_xor_b32 v18, v17, v3
v_lshlrev_b32 v19, 10, v16
v_lshl_add_u32 v5, v18, 4, v19
v_xor_b32 v18, 4, v18
v_lshl_add_u32 v6, v18, 4, v19
v_add_u32 v6, 7168, v6
v_and_b32 v18, 1, v3
v_lshlrev_b32 v18, 1, v18
v_xor_b32 v18, v17, v18
v_lshlrev_b32 v19, 13, v16
v_lshl_add_u32 v7, v18, 4, v19
v_xor_b32 v18, 4, v18
v_lshl_add_u32 v8, v18, 4, v19
v_add_u32 v8, 64512, v8
s_add_u32 s69, s65, s5
s_and_b32 s69, s69, 1
s_mul_i32 s64, s7, 2
s_and_b32 s64, s64, 7
s_or_b32 s69, s69, s64
s_add_u32 s93, s65, s5
s_and_b32 s93, s93, 0
s_mul_i32 s64, s7, 1
s_and_b32 s64, s64, 7
s_or_b32 s93, s93, s64
s_lshl_b32 s70, s69, 7
s_lshl_b32 s75, s69, 19
s_lshr_b32 s54, s3, 1
s_and_b32 s55, s3, 1
s_lshl3_add_u32 s87, s54, s5
s_lshl_b32 s64, s55, 5
s_add_u32 s68, s87, s64
s_lshl_b32 s68, s68, 15
s_lshl_b32 s73, s3, 13
s_add_u32 s73, s73, 65536
s_lshl1_add_u32 s74, s4, s55
s_lshl_b32 s74, s74, 7
s_lshl_b32 s64, s54, 18
s_add_u32 s74, s74, s64
s_lshl_b32 s77, s3, 12
s_add_u32 s71, s68, s70
s_add_u32 s76, s74, s75
s_mov_b32 s10, 2097152
s_mov_b32 s11, 0x20000
s_mov_b32 s58, 4194304
s_mov_b32 s59, 0x20000
s_waitcnt lgkmcnt(0)
s_add_u32 m0, s73, 0
s_add_u32 s64, s71, 0
buffer_load_dwordx4 v5, s[8:11], s64 offen lds
buffer_load_dwordx4 v6, s[8:11], s64 offen offset:1024 lds
s_add_u32 m0, s73, 2048
s_add_u32 s64, s71, 16384
buffer_load_dwordx4 v5, s[8:11], s64 offen lds
buffer_load_dwordx4 v6, s[8:11], s64 offen offset:1024 lds
s_add_u32 m0, s77, 0
s_add_u32 s64, s76, 0
buffer_load_dwordx4 v7, s[56:59], s64 offen lds
buffer_load_dwordx4 v8, s[56:59], s64 offen offset:1024 lds
s_add_u32 m0, s77, 2048
s_add_u32 s64, s76, 131072
buffer_load_dwordx4 v7, s[56:59], s64 offen lds
buffer_load_dwordx4 v8, s[56:59], s64 offen offset:1024 lds
s_add_u32 m0, s73, 4096
s_add_u32 s64, s71, 524288
buffer_load_dwordx4 v5, s[8:11], s64 offen lds
buffer_load_dwordx4 v6, s[8:11], s64 offen offset:1024 lds
s_add_u32 m0, s73, 6144
s_add_u32 s64, s71, 540672
buffer_load_dwordx4 v5, s[8:11], s64 offen lds
buffer_load_dwordx4 v6, s[8:11], s64 offen offset:1024 lds
s_mov_b32 s18, 4194304
s_mov_b32 s19, 0x20000
s_lshl_b32 s65, s54, 7
s_lshl_b32 s53, s55, 12
v_lshrrev_b32 v16, 1, v2
v_xor_b32 v16, v16, v3
v_add_u32 v17, s65, v2
v_lshlrev_b32 v17, 7, v17
v_add_u32 v17, 65536, v17
v_lshl_add_u32 v9, v16, 4, v17
v_xor_b32 v10, 64, v9
v_bfe_u32 v16, v1, 2, 2
v_lshl_add_u32 v17, v3, 3, v16
v_lshlrev_b32 v17, 7, v17
v_and_b32 v18, 3, v1
v_lshl_add_u32 v17, v18, 3, v17
v_add_u32 v17, s53, v17
v_lshrrev_b32 v16, 1, v16
v_and_b32 v18, 1, v3
v_lshl_add_u32 v16, v18, 1, v16
v_xor_b32 v18, 0, v16
v_lshl_add_u32 v11, v18, 5, v17
v_xor_b32 v18, 1, v16
v_lshl_add_u32 v12, v18, 5, v17
v_xor_b32 v18, 2, v16
v_lshl_add_u32 v13, v18, 5, v17
v_xor_b32 v18, 3, v16
v_lshl_add_u32 v14, v18, 5, v17
s_add_u32 m0, s77, 16384
s_add_u32 s64, s76, 0
buffer_load_dwordx4 v7, s[16:19], s64 offen lds
buffer_load_dwordx4 v8, s[16:19], s64 offen offset:1024 lds
s_add_u32 m0, s77, 18432
s_add_u32 s64, s76, 131072
buffer_load_dwordx4 v7, s[16:19], s64 offen lds
buffer_load_dwordx4 v8, s[16:19], s64 offen offset:1024 lds
s_mov_b64 exec, 0
s_cmp_eq_u32 s3, 0
s_cbranch_scc1 L_PAD0
s_cmp_eq_u32 s3, 1
s_cbranch_scc1 L_PAD1
s_cmp_eq_u32 s3, 2
s_cbranch_scc1 L_PAD2
s_branch L_PAD3
.p2align 12
.fill 620, 4, 0xbf800000
L_MAIN:
s_mov_b64 exec, -1
s_xor_b32 s71, s70, 128
s_add_u32 s71, s68, s71
s_add_u32 m0, s73, 32768
s_add_u32 s64, s71, 0
buffer_load_dwordx4 v5, s[8:11], s64 offen lds
buffer_load_dwordx4 v6, s[8:11], s64 offen offset:1024 lds
s_add_u32 m0, s73, 34816
s_add_u32 s64, s71, 16384
buffer_load_dwordx4 v5, s[8:11], s64 offen lds
buffer_load_dwordx4 v6, s[8:11], s64 offen offset:1024 lds
s_add_u32 m0, s73, 36864
s_add_u32 s64, s71, 524288
buffer_load_dwordx4 v5, s[8:11], s64 offen lds
buffer_load_dwordx4 v6, s[8:11], s64 offen offset:1024 lds
s_add_u32 m0, s73, 38912
s_add_u32 s64, s71, 540672
buffer_load_dwordx4 v5, s[8:11], s64 offen lds
buffer_load_dwordx4 v6, s[8:11], s64 offen offset:1024 lds
s_waitcnt vmcnt(12)
s_barrier
ds_read_b128 a[64:67], v9 offset:0
ds_read_b128 a[68:71], v10 offset:0
ds_read_b64_tr_b16 a[128:129], v11 offset:0
ds_read_b64_tr_b16 a[130:131], v11 offset:512
ds_read_b64_tr_b16 a[132:133], v11 offset:8192
ds_read_b64_tr_b16 a[134:135], v11 offset:8704
ds_read_b64_tr_b16 a[136:137], v12 offset:0
ds_read_b64_tr_b16 a[138:139], v12 offset:512
ds_read_b64_tr_b16 a[140:141], v12 offset:8192
ds_read_b64_tr_b16 a[142:143], v12 offset:8704
ds_read_b64_tr_b16 a[144:145], v13 offset:0
ds_read_b64_tr_b16 a[146:147], v13 offset:512
ds_read_b64_tr_b16 a[148:149], v13 offset:8192
ds_read_b64_tr_b16 a[150:151], v13 offset:8704
ds_read_b64_tr_b16 a[152:153], v14 offset:0
ds_read_b64_tr_b16 a[154:155], v14 offset:512
ds_read_b64_tr_b16 a[156:157], v14 offset:8192
ds_read_b64_tr_b16 a[158:159], v14 offset:8704
ds_read_b128 a[72:75], v9 offset:2048
ds_read_b128 a[76:79], v10 offset:2048
ds_read_b128 a[80:83], v9 offset:4096
ds_read_b128 a[84:87], v10 offset:4096
ds_read_b128 a[88:91], v9 offset:6144
ds_read_b128 a[92:95], v10 offset:6144
s_waitcnt lgkmcnt(0)
v_mfma_f32_16x16x32_bf16 v[32:35], a[64:67], a[128:131], 0
s_waitcnt vmcnt(8)
v_mfma_f32_16x16x32_bf16 v[32:35], a[68:71], a[132:135], v[32:35]
s_barrier
v_mfma_f32_16x16x32_bf16 v[40:43], a[68:71], a[140:143], 0
s_mov_b32 s26, 268435456
s_mov_b32 s27, 0x20000
ds_read_b128 a[96:99], v9 offset:8192
v_mfma_f32_16x16x32_bf16 v[40:43], a[64:67], a[136:139], v[40:43]
s_xor_b32 s76, s75, 524288
s_add_u32 s76, s74, s76
s_mov_b32 s14, 2359296
v_mfma_f32_16x16x32_bf16 v[48:51], a[64:67], a[144:147], 0
s_add_u32 m0, s77, 32768
s_add_u32 s64, s76, 0
s_mov_b32 s15, 0x20000
v_mfma_f32_16x16x32_bf16 v[48:51], a[68:71], a[148:151], v[48:51]
buffer_load_dwordx4 v7, s[56:59], s64 offen lds
v_mfma_f32_16x16x32_bf16 v[56:59], a[68:71], a[156:159], 0
s_mov_b32 s22, 4718592
s_mov_b32 s23, 0x20000
ds_read_b128 a[100:103], v10 offset:8192
v_mfma_f32_16x16x32_bf16 v[56:59], a[64:67], a[152:155], v[56:59]
buffer_load_dwordx4 v8, s[56:59], s64 offen offset:1024 lds
v_mfma_f32_16x16x32_bf16 v[60:63], a[72:75], a[152:155], 0
s_add_u32 m0, s77, 34816
s_add_u32 s64, s76, 131072
ds_read_b128 a[104:107], v9 offset:10240
v_mfma_f32_16x16x32_bf16 v[60:63], a[76:79], a[156:159], v[60:63]
s_mov_b32 s30, 1990656
s_mov_b32 s31, 0x20000
s_mov_b32 s34, 4718592
v_mfma_f32_16x16x32_bf16 v[52:55], a[76:79], a[148:151], 0
buffer_load_dwordx4 v7, s[56:59], s64 offen lds
v_mfma_f32_16x16x32_bf16 v[52:55], a[72:75], a[144:147], v[52:55]
s_mov_b32 s35, 0x20000
ds_read_b64_tr_b16 a[160:161], v11 offset:16384
ds_read_b64_tr_b16 a[162:163], v11 offset:16896
v_mfma_f32_16x16x32_bf16 v[44:47], a[72:75], a[136:139], 0
s_mov_b32 s38, 1152
s_mov_b32 s39, 0x20000
s_mov_b32 s42, 256
v_mfma_f32_16x16x32_bf16 v[44:47], a[76:79], a[140:143], v[44:47]
buffer_load_dwordx4 v8, s[56:59], s64 offen offset:1024 lds
v_mfma_f32_16x16x32_bf16 v[36:39], a[76:79], a[132:135], 0
s_mov_b32 s43, 0x20000
s_mov_b32 s46, 2359296
s_mov_b32 s47, 0x20000
v_mfma_f32_16x16x32_bf16 v[36:39], a[72:75], a[128:131], v[36:39]
s_add_u32 m0, s77, 49152
s_add_u32 s64, s76, 0
ds_read_b128 a[108:111], v10 offset:10240
v_mfma_f32_16x16x32_bf16 v[64:67], a[80:83], a[128:131], 0
s_mov_b32 s50, 663552
s_mov_b32 s51, 0x20000
s_lshl_b32 s89, s4, 10
v_mfma_f32_16x16x32_bf16 v[64:67], a[84:87], a[132:135], v[64:67]
buffer_load_dwordx4 v7, s[16:19], s64 offen lds
v_mfma_f32_16x16x32_bf16 v[72:75], a[84:87], a[140:143], 0
s_add_u32 s89, s89, 75497472
ds_read_b64_tr_b16 a[164:165], v11 offset:24576
ds_read_b64_tr_b16 a[166:167], v11 offset:25088
v_mfma_f32_16x16x32_bf16 v[72:75], a[80:83], a[136:139], v[72:75]
s_mul_i32 s94, s4, 1064960
s_cmp_eq_u32 s66, 0
s_cselect_b32 s52, s89, 2147418112
v_mfma_f32_16x16x32_bf16 v[80:83], a[80:83], a[144:147], 0
buffer_load_dwordx4 v8, s[16:19], s64 offen offset:1024 lds
v_mfma_f32_16x16x32_bf16 v[80:83], a[84:87], a[148:151], v[80:83]
s_add_u32 m0, s77, 51200
s_add_u32 s64, s76, 131072
ds_read_b128 a[112:115], v9 offset:12288
v_mfma_f32_16x16x32_bf16 v[88:91], a[84:87], a[156:159], 0
s_lshl_b32 s53, s5, 10
s_add_u32 s53, s53, s94
s_add_u32 s53, s53, 1048576
v_mfma_f32_16x16x32_bf16 v[88:91], a[80:83], a[152:155], v[88:91]
buffer_load_dwordx4 v7, s[16:19], s64 offen lds
v_mfma_f32_16x16x32_bf16 v[92:95], a[88:91], a[152:155], 0
ds_read_b64_tr_b16 a[168:169], v12 offset:16384
ds_read_b64_tr_b16 a[170:171], v12 offset:16896
v_mfma_f32_16x16x32_bf16 v[92:95], a[92:95], a[156:159], v[92:95]
s_cmp_eq_u32 s3, 1
s_cselect_b32 s52, s53, s52
s_mul_i32 s53, s2, 74
v_mfma_f32_16x16x32_bf16 v[84:87], a[92:95], a[148:151], 0
buffer_load_dwordx4 v8, s[16:19], s64 offen offset:1024 lds
v_mfma_f32_16x16x32_bf16 v[84:87], a[88:91], a[144:147], v[84:87]
s_add_u32 s53, s53, s55
s_lshl_b32 s53, s53, 10
s_add_u32 s53, s53, 54599680
v_mfma_f32_16x16x32_bf16 v[76:79], a[88:91], a[136:139], 0
s_cmp_ge_u32 s3, 2
s_cselect_b32 s52, s53, s52
ds_read_b128 a[116:119], v10 offset:12288
v_mfma_f32_16x16x32_bf16 v[76:79], a[92:95], a[140:143], v[76:79]
v_mov_b32 v16, 0
v_mov_b32 v17, 0
v_mfma_f32_16x16x32_bf16 v[68:71], a[92:95], a[132:135], 0
v_mov_b32 v18, 0
v_mov_b32 v19, 0
v_mfma_f32_16x16x32_bf16 v[68:71], a[88:91], a[128:131], v[68:71]
s_waitcnt lgkmcnt(6)
ds_read_b64_tr_b16 a[172:173], v12 offset:24576
ds_read_b64_tr_b16 a[174:175], v12 offset:25088
v_mfma_f32_16x16x32_bf16 v[96:99], a[96:99], a[128:131], 0
v_mfma_f32_16x16x32_bf16 v[96:99], a[100:103], a[132:135], v[96:99]
v_mfma_f32_16x16x32_bf16 v[104:107], a[100:103], a[140:143], 0
ds_read_b128 a[120:123], v9 offset:14336
v_mfma_f32_16x16x32_bf16 v[104:107], a[96:99], a[136:139], v[104:107]
v_mfma_f32_16x16x32_bf16 v[112:115], a[96:99], a[144:147], 0
v_mfma_f32_16x16x32_bf16 v[112:115], a[100:103], a[148:151], v[112:115]
ds_read_b64_tr_b16 a[176:177], v13 offset:16384
ds_read_b64_tr_b16 a[178:179], v13 offset:16896
v_mfma_f32_16x16x32_bf16 v[120:123], a[100:103], a[156:159], 0
v_mfma_f32_16x16x32_bf16 v[120:123], a[96:99], a[152:155], v[120:123]
v_mfma_f32_16x16x32_bf16 v[124:127], a[104:107], a[152:155], 0
v_mfma_f32_16x16x32_bf16 v[124:127], a[108:111], a[156:159], v[124:127]
ds_read_b128 a[124:127], v10 offset:14336
v_mfma_f32_16x16x32_bf16 v[116:119], a[108:111], a[148:151], 0
v_add_u32 v9, 32768, v9
v_add_u32 v10, 32768, v10
v_mfma_f32_16x16x32_bf16 v[116:119], a[104:107], a[144:147], v[116:119]
v_mfma_f32_16x16x32_bf16 v[108:111], a[104:107], a[136:139], 0
ds_read_b64_tr_b16 a[180:181], v13 offset:24576
ds_read_b64_tr_b16 a[182:183], v13 offset:25088
v_mfma_f32_16x16x32_bf16 v[108:111], a[108:111], a[140:143], v[108:111]
v_mfma_f32_16x16x32_bf16 v[100:103], a[108:111], a[132:135], 0
v_mfma_f32_16x16x32_bf16 v[100:103], a[104:107], a[128:131], v[100:103]
s_waitcnt lgkmcnt(2)
ds_read_b64_tr_b16 a[184:185], v14 offset:16384
ds_read_b64_tr_b16 a[186:187], v14 offset:16896
v_mfma_f32_16x16x32_bf16 v[128:131], a[112:115], a[128:131], 0
v_mfma_f32_16x16x32_bf16 v[128:131], a[116:119], a[132:135], v[128:131]
v_mfma_f32_16x16x32_bf16 v[136:139], a[116:119], a[140:143], 0
ds_read_b64_tr_b16 a[188:189], v14 offset:24576
ds_read_b64_tr_b16 a[190:191], v14 offset:25088
v_mfma_f32_16x16x32_bf16 v[136:139], a[112:115], a[136:139], v[136:139]
v_mfma_f32_16x16x32_bf16 v[144:147], a[112:115], a[144:147], 0
v_mfma_f32_16x16x32_bf16 v[144:147], a[116:119], a[148:151], v[144:147]
v_mfma_f32_16x16x32_bf16 v[152:155], a[116:119], a[156:159], 0
v_mfma_f32_16x16x32_bf16 v[152:155], a[112:115], a[152:155], v[152:155]
v_mfma_f32_16x16x32_bf16 v[156:159], a[120:123], a[152:155], 0
v_mfma_f32_16x16x32_bf16 v[156:159], a[124:127], a[156:159], v[156:159]
v_mfma_f32_16x16x32_bf16 v[148:151], a[124:127], a[148:151], 0
v_mfma_f32_16x16x32_bf16 v[148:151], a[120:123], a[144:147], v[148:151]
v_mfma_f32_16x16x32_bf16 v[140:143], a[120:123], a[136:139], 0
v_mfma_f32_16x16x32_bf16 v[140:143], a[124:127], a[140:143], v[140:143]
v_mfma_f32_16x16x32_bf16 v[132:135], a[124:127], a[132:135], 0
v_mfma_f32_16x16x32_bf16 v[132:135], a[120:123], a[128:131], v[132:135]
s_waitcnt lgkmcnt(0)
v_mfma_f32_16x16x32_bf16 v[160:163], a[160:163], a[64:67], 0
s_waitcnt vmcnt(4)
v_mfma_f32_16x16x32_bf16 v[160:163], a[164:167], a[68:71], v[160:163]
s_barrier
v_mfma_f32_16x16x32_bf16 v[164:167], a[172:175], a[68:71], 0
ds_read_b64_tr_b16 a[128:129], v11 offset:32768
ds_read_b64_tr_b16 a[130:131], v11 offset:33280
v_mfma_f32_16x16x32_bf16 v[164:167], a[168:171], a[64:67], v[164:167]
s_xor_b32 s71, s70, 256
s_add_u32 s71, s68, s71
v_mfma_f32_16x16x32_bf16 v[168:171], a[176:179], a[64:67], 0
s_add_u32 m0, s73, 65536
s_add_u32 s64, s71, 0
v_mfma_f32_16x16x32_bf16 v[168:171], a[180:183], a[68:71], v[168:171]
buffer_load_dwordx4 v5, s[8:11], s64 offen lds
v_mfma_f32_16x16x32_bf16 v[172:175], a[188:191], a[68:71], 0
v_mfma_f32_16x16x32_bf16 v[172:175], a[184:187], a[64:67], v[172:175]
ds_read_b128 a[64:67], v9 offset:0
v_mfma_f32_16x16x32_bf16 v[188:191], a[184:187], a[72:75], 0
buffer_load_dwordx4 v6, s[8:11], s64 offen offset:1024 lds
v_mfma_f32_16x16x32_bf16 v[188:191], a[188:191], a[76:79], v[188:191]
L_PAD0:
s_cbranch_execz L_PAD4
ds_read_b64_tr_b16 a[132:133], v11 offset:40960
ds_read_b64_tr_b16 a[134:135], v11 offset:41472
v_mfma_f32_16x16x32_bf16 v[184:187], a[180:183], a[76:79], 0
v_mfma_f32_16x16x32_bf16 v[184:187], a[176:179], a[72:75], v[184:187]
s_add_u32 m0, s73, 67584
s_add_u32 s64, s71, 16384
ds_read_b128 a[68:71], v10 offset:0
v_mfma_f32_16x16x32_bf16 v[180:183], a[168:171], a[72:75], 0
v_mfma_f32_16x16x32_bf16 v[180:183], a[172:175], a[76:79], v[180:183]
buffer_load_dwordx4 v5, s[8:11], s64 offen lds
v_mfma_f32_16x16x32_bf16 v[176:179], a[164:167], a[76:79], 0
v_mfma_f32_16x16x32_bf16 v[176:179], a[160:163], a[72:75], v[176:179]
ds_read_b64_tr_b16 a[136:137], v12 offset:32768
ds_read_b64_tr_b16 a[138:139], v12 offset:33280
v_mfma_f32_16x16x32_bf16 v[192:195], a[160:163], a[80:83], 0
v_mfma_f32_16x16x32_bf16 v[192:195], a[164:167], a[84:87], v[192:195]
v_mfma_f32_16x16x32_bf16 v[196:199], a[172:175], a[84:87], 0
buffer_load_dwordx4 v6, s[8:11], s64 offen offset:1024 lds
v_mfma_f32_16x16x32_bf16 v[196:199], a[168:171], a[80:83], v[196:199]
s_xor_b32 s76, s75, 1048576
s_add_u32 s76, s74, s76
ds_read_b128 a[72:75], v9 offset:2048
v_mfma_f32_16x16x32_bf16 v[200:203], a[176:179], a[80:83], 0
v_mfma_f32_16x16x32_bf16 v[200:203], a[180:183], a[84:87], v[200:203]
s_add_u32 m0, s77, 0
s_add_u32 s64, s76, 0
v_mfma_f32_16x16x32_bf16 v[204:207], a[188:191], a[84:87], 0
ds_read_b64_tr_b16 a[140:141], v12 offset:40960
ds_read_b64_tr_b16 a[142:143], v12 offset:41472
v_mfma_f32_16x16x32_bf16 v[204:207], a[184:187], a[80:83], v[204:207]
buffer_load_dwordx4 v7, s[56:59], s64 offen lds
v_mfma_f32_16x16x32_bf16 v[220:223], a[184:187], a[88:91], 0
ds_read_b128 a[76:79], v10 offset:2048
v_mfma_f32_16x16x32_bf16 v[220:223], a[188:191], a[92:95], v[220:223]
v_mfma_f32_16x16x32_bf16 v[216:219], a[180:183], a[92:95], 0
v_mfma_f32_16x16x32_bf16 v[216:219], a[176:179], a[88:91], v[216:219]
v_mfma_f32_16x16x32_bf16 v[212:215], a[168:171], a[88:91], 0
buffer_load_dwordx4 v8, s[56:59], s64 offen offset:1024 lds
v_mfma_f32_16x16x32_bf16 v[212:215], a[172:175], a[92:95], v[212:215]
ds_read_b64_tr_b16 a[144:145], v13 offset:32768
ds_read_b64_tr_b16 a[146:147], v13 offset:33280
v_mfma_f32_16x16x32_bf16 v[208:211], a[164:167], a[92:95], 0
v_mfma_f32_16x16x32_bf16 v[208:211], a[160:163], a[88:91], v[208:211]
s_add_u32 m0, s77, 2048
s_add_u32 s64, s76, 131072
ds_read_b128 a[80:83], v9 offset:4096
v_mfma_f32_16x16x32_bf16 v[224:227], a[160:163], a[96:99], 0
v_mfma_f32_16x16x32_bf16 v[224:227], a[164:167], a[100:103], v[224:227]
buffer_load_dwordx4 v7, s[56:59], s64 offen lds
v_mfma_f32_16x16x32_bf16 v[228:231], a[172:175], a[100:103], 0
ds_read_b64_tr_b16 a[148:149], v13 offset:40960
ds_read_b64_tr_b16 a[150:151], v13 offset:41472
v_mfma_f32_16x16x32_bf16 v[228:231], a[168:171], a[96:99], v[228:231]
v_mfma_f32_16x16x32_bf16 v[232:235], a[176:179], a[96:99], 0
buffer_store_dwordx4 v[16:19], v4, s[24:27], s52 offen sc1
v_mfma_f32_16x16x32_bf16 v[232:235], a[180:183], a[100:103], v[232:235]
buffer_load_dwordx4 v8, s[56:59], s64 offen offset:1024 lds
v_mfma_f32_16x16x32_bf16 v[236:239], a[188:191], a[100:103], 0
s_add_u32 s89, s89, 512
ds_read_b128 a[84:87], v10 offset:4096
v_mfma_f32_16x16x32_bf16 v[236:239], a[184:187], a[96:99], v[236:239]
s_cmp_eq_u32 s3, 0
s_cselect_b32 s90, s89, 2147418112
v_mov_b32 v24, 2147418112
v_mfma_f32_16x16x32_bf16 v[252:255], a[184:187], a[104:107], 0
s_add_u32 m0, s73, 69632
s_add_u32 s64, s71, 524288
v_cmp_eq_u32 vcc, 1, v1
v_mfma_f32_16x16x32_bf16 v[252:255], a[188:191], a[108:111], v[252:255]
s_lshl_b32 s53, s55, 12
ds_read_b64_tr_b16 a[152:153], v14 offset:32768
ds_read_b64_tr_b16 a[154:155], v14 offset:33280
v_mfma_f32_16x16x32_bf16 v[248:251], a[180:183], a[108:111], 0
buffer_load_dwordx4 v5, s[8:11], s64 offen lds
v_mfma_f32_16x16x32_bf16 v[248:251], a[176:179], a[104:107], v[248:251]
v_cndmask_b32 v0, v24, 0, vcc
v_mfma_f32_16x16x32_bf16 v[244:247], a[168:171], a[104:107], 0
s_mul_i32 s87, s87, 16384
s_add_u32 s87, s87, s94
ds_read_b128 a[88:91], v9 offset:6144
v_mfma_f32_16x16x32_bf16 v[244:247], a[172:175], a[108:111], v[244:247]
s_add_u32 s88, s87, s53
s_add_u32 s88, s88, 24576
s_lshr_b32 s53, s53, 1
v_mfma_f32_16x16x32_bf16 v[240:243], a[164:167], a[108:111], 0
s_add_u32 s87, s87, s53
s_lshl_b32 s80, s3, 10
s_mul_i32 s78, s4, 18
v_mfma_f32_16x16x32_bf16 v[240:243], a[160:163], a[104:107], v[240:243]
buffer_load_dwordx4 v6, s[8:11], s64 offen offset:1024 lds
v_mfma_f32_16x16x32_bf16 a[0:3], a[160:163], a[112:115], 0
s_add_u32 s78, s78, s54
ds_read_b64_tr_b16 a[156:157], v14 offset:40960
ds_read_b64_tr_b16 a[158:159], v14 offset:41472
v_mfma_f32_16x16x32_bf16 a[0:3], a[164:167], a[116:119], a[0:3]
s_lshl2_add_u32 s78, s78, s55
s_lshl_b32 s78, s78, 10
s_add_u32 s78, s78, 35651584
v_mfma_f32_16x16x32_bf16 a[4:7], a[172:175], a[116:119], 0
s_add_u32 m0, s73, 71680
s_add_u32 s64, s71, 540672
ds_read_b128 a[92:95], v10 offset:6144
v_mfma_f32_16x16x32_bf16 a[4:7], a[168:171], a[112:115], a[4:7]
s_add_u32 s80, s80, 8192
s_mov_b32 s91, 0x3e0293ee
s_mov_b32 s85, 0x05040100
v_mfma_f32_16x16x32_bf16 a[8:11], a[176:179], a[112:115], 0
buffer_load_dwordx4 v5, s[8:11], s64 offen lds
v_mfma_f32_16x16x32_bf16 a[8:11], a[180:183], a[116:119], a[8:11]
s_mov_b32 s86, 0x07060302
s_lshl2_add_u32 s52, s7, s3
s_xor_b32 s92, s6, 31
v_mfma_f32_16x16x32_bf16 a[12:15], a[188:191], a[116:119], 0
s_mul_i32 s81, s92, 110592
s_mul_i32 s65, s52, 36
s_add_u32 s81, s81, s65
v_mfma_f32_16x16x32_bf16 a[12:15], a[184:187], a[112:115], a[12:15]
s_mul_i32 s82, s52, 18
s_add_u32 s82, s82, s92
s_lshl_b32 s82, s82, 12
v_mfma_f32_16x16x32_bf16 a[28:31], a[184:187], a[120:123], 0
s_add_u32 s82, s82, 35651584
s_lshl_b32 s83, s92, 6
s_lshl_b32 s84, s52, 10
v_mfma_f32_16x16x32_bf16 a[28:31], a[188:191], a[124:127], a[28:31]
buffer_load_dwordx4 v6, s[8:11], s64 offen offset:1024 lds
v_mfma_f32_16x16x32_bf16 a[24:27], a[180:183], a[124:127], 0
s_add_u32 s84, s84, 75497984
v_mfma_f32_16x16x32_bf16 a[24:27], a[176:179], a[120:123], a[24:27]
s_cmp_lt_u32 s92, 18
s_cselect_b32 s82, s82, 2147418112
s_cselect_b32 s84, s84, 2147418112
v_mfma_f32_16x16x32_bf16 a[20:23], a[168:171], a[120:123], 0
v_lshrrev_b32 v18, 2, v2
v_and_b32 v19, 3, v2
v_mfma_f32_16x16x32_bf16 a[20:23], a[172:175], a[124:127], a[20:23]
v_mul_u32_u24 v20, 1152, v18
v_cmp_eq_u32 vcc, 2, v19
v_mfma_f32_16x16x32_bf16 a[16:19], a[164:167], a[124:127], 0
v_lshl_add_u32 v20, v19, 3, v20
v_add_u32 v21, 1, v19
v_mfma_f32_16x16x32_bf16 a[16:19], a[160:163], a[120:123], a[16:19]
s_waitcnt lgkmcnt(0)
v_cndmask_b32 v21, v21, 0, vcc
v_cmp_eq_u32 vcc, 3, v18
v_mfma_f32_16x16x32_bf16 v[32:35], a[64:67], a[128:131], v[32:35]
s_waitcnt vmcnt(13)
v_mul_u32_u24 v21, 1152, v21
v_add_u32 v21, 32, v21
v_mfma_f32_16x16x32_bf16 v[32:35], a[68:71], a[132:135], v[32:35]
s_barrier
v_mfma_f32_16x16x32_bf16 v[40:43], a[68:71], a[140:143], v[40:43]
ds_read_b128 a[96:99], v9 offset:8192
v_cndmask_b32 v20, v20, v21, vcc
v_mfma_f32_16x16x32_bf16 v[40:43], a[64:67], a[136:139], v[40:43]
s_add_u32 m0, s77, 16384
s_add_u32 s64, s76, 0
v_cmp_eq_u32 vcc, 15, v2
v_mfma_f32_16x16x32_bf16 v[48:51], a[64:67], a[144:147], v[48:51]
buffer_load_dwordx4 v7, s[16:19], s64 offen lds
v_mfma_f32_16x16x32_bf16 v[48:51], a[68:71], a[148:151], v[48:51]
ds_read_b128 a[100:103], v10 offset:8192
v_mul_u32_u24 v21, 27648, v3
v_mfma_f32_16x16x32_bf16 v[56:59], a[68:71], a[156:159], v[56:59]
v_add_u32 v20, v20, v21
v_lshlrev_b32 v21, 4, v3
v_mfma_f32_16x16x32_bf16 v[56:59], a[64:67], a[152:155], v[56:59]
v_cndmask_b32 v26, v20, v24, vcc
v_cndmask_b32 v27, v24, v21, vcc
v_mfma_f32_16x16x32_bf16 v[60:63], a[72:75], a[152:155], v[60:63]
buffer_load_dwordx4 v8, s[16:19], s64 offen offset:1024 lds
v_mfma_f32_16x16x32_bf16 v[60:63], a[76:79], a[156:159], v[60:63]
ds_read_b128 a[104:107], v9 offset:10240
v_and_b32 v18, 7, v1
v_mfma_f32_16x16x32_bf16 v[52:55], a[76:79], a[148:151], v[52:55]
v_cmp_gt_u32 vcc, 48, v1
v_mul_u32_u24 v18, 3456, v18
v_mfma_f32_16x16x32_bf16 v[52:55], a[72:75], a[144:147], v[52:55]
s_add_u32 m0, s77, 18432
s_add_u32 s64, s76, 131072
v_mul_u32_u24 v19, 1152, v3
v_mfma_f32_16x16x32_bf16 v[44:47], a[72:75], a[136:139], v[44:47]
ds_read_b64_tr_b16 a[160:161], v11 offset:49152
ds_read_b64_tr_b16 a[162:163], v11 offset:49664
v_mfma_f32_16x16x32_bf16 v[44:47], a[76:79], a[140:143], v[44:47]
buffer_load_dwordx4 v7, s[16:19], s64 offen lds
v_mfma_f32_16x16x32_bf16 v[36:39], a[76:79], a[132:135], v[36:39]
v_bfe_u32 v20, v1, 3, 1
v_mul_u32_u24 v20, 140, v20
v_mfma_f32_16x16x32_bf16 v[36:39], a[72:75], a[128:131], v[36:39]
ds_read_b128 a[108:111], v10 offset:10240
v_add3_u32 v18, v18, v19, v20
v_mfma_f32_16x16x32_bf16 v[64:67], a[80:83], a[128:131], v[64:67]
v_cndmask_b32 v28, v24, v18, vcc
v_mfma_f32_16x16x32_bf16 v[64:67], a[84:87], a[132:135], v[64:67]
s_lshl_b32 s52, s4, 2
s_cmp_eq_u32 s66, 0
s_cselect_b32 s52, s52, 2147418112
v_mfma_f32_16x16x32_bf16 v[72:75], a[84:87], a[140:143], v[72:75]
buffer_load_dwordx4 v8, s[16:19], s64 offen offset:1024 lds
v_mfma_f32_16x16x32_bf16 v[72:75], a[80:83], a[136:139], v[72:75]
s_xor_b32 s71, s70, 384
s_add_u32 s71, s68, s71
v_mfma_f32_16x16x32_bf16 v[80:83], a[80:83], a[144:147], v[80:83]
ds_read_b64_tr_b16 a[164:165], v11 offset:57344
ds_read_b64_tr_b16 a[166:167], v11 offset:57856
v_mfma_f32_16x16x32_bf16 v[80:83], a[84:87], a[148:151], v[80:83]
s_add_u32 m0, s73, 0
s_add_u32 s64, s71, 0
ds_read_b128 a[112:115], v9 offset:12288
v_mfma_f32_16x16x32_bf16 v[88:91], a[84:87], a[156:159], v[88:91]
v_mfma_f32_16x16x32_bf16 v[88:91], a[80:83], a[152:155], v[88:91]
buffer_load_dwordx4 v5, s[8:11], s64 offen lds
v_mfma_f32_16x16x32_bf16 v[92:95], a[88:91], a[152:155], v[92:95]
ds_read_b64_tr_b16 a[168:169], v12 offset:49152
ds_read_b64_tr_b16 a[170:171], v12 offset:49664
v_mfma_f32_16x16x32_bf16 v[92:95], a[92:95], a[156:159], v[92:95]
v_mfma_f32_16x16x32_bf16 v[84:87], a[92:95], a[148:151], v[84:87]
v_mfma_f32_16x16x32_bf16 v[84:87], a[88:91], a[144:147], v[84:87]
v_mfma_f32_16x16x32_bf16 v[76:79], a[88:91], a[136:139], v[76:79]
buffer_load_dwordx4 v6, s[8:11], s64 offen offset:1024 lds
v_mfma_f32_16x16x32_bf16 v[76:79], a[92:95], a[140:143], v[76:79]
ds_read_b128 a[116:119], v10 offset:12288
v_mfma_f32_16x16x32_bf16 v[68:71], a[92:95], a[132:135], v[68:71]
v_mfma_f32_16x16x32_bf16 v[68:71], a[88:91], a[128:131], v[68:71]
s_add_u32 m0, s73, 2048
s_add_u32 s64, s71, 16384
s_waitcnt lgkmcnt(6)
v_mfma_f32_16x16x32_bf16 v[96:99], a[96:99], a[128:131], v[96:99]
ds_read_b64_tr_b16 a[172:173], v12 offset:57344
ds_read_b64_tr_b16 a[174:175], v12 offset:57856
v_mfma_f32_16x16x32_bf16 v[96:99], a[100:103], a[132:135], v[96:99]
buffer_load_dwordx4 v5, s[8:11], s64 offen lds
v_mfma_f32_16x16x32_bf16 v[104:107], a[100:103], a[140:143], v[104:107]
ds_read_b128 a[120:123], v9 offset:14336
v_mfma_f32_16x16x32_bf16 v[104:107], a[96:99], a[136:139], v[104:107]
v_mfma_f32_16x16x32_bf16 v[112:115], a[96:99], a[144:147], v[112:115]
v_mfma_f32_16x16x32_bf16 v[112:115], a[100:103], a[148:151], v[112:115]
buffer_load_dwordx4 v6, s[8:11], s64 offen offset:1024 lds
v_mfma_f32_16x16x32_bf16 v[120:123], a[100:103], a[156:159], v[120:123]
s_xor_b32 s76, s75, 1572864
s_add_u32 s76, s74, s76
v_mfma_f32_16x16x32_bf16 v[120:123], a[96:99], a[152:155], v[120:123]
ds_read_b64_tr_b16 a[176:177], v13 offset:49152
ds_read_b64_tr_b16 a[178:179], v13 offset:49664
v_mfma_f32_16x16x32_bf16 v[124:127], a[104:107], a[152:155], v[124:127]
s_add_u32 m0, s77, 32768
s_add_u32 s64, s76, 0
v_mfma_f32_16x16x32_bf16 v[124:127], a[108:111], a[156:159], v[124:127]
ds_read_b128 a[124:127], v10 offset:14336
v_mfma_f32_16x16x32_bf16 v[116:119], a[108:111], a[148:151], v[116:119]
buffer_load_dwordx4 v7, s[56:59], s64 offen lds
v_mfma_f32_16x16x32_bf16 v[116:119], a[104:107], a[144:147], v[116:119]
s_waitcnt vmcnt(14)
v_add_u32 v9, 32768, v9
v_add_u32 v10, 32768, v10
v_mfma_f32_16x16x32_bf16 v[108:111], a[104:107], a[136:139], v[108:111]
ds_read_b64_tr_b16 a[180:181], v13 offset:57344
ds_read_b64_tr_b16 a[182:183], v13 offset:57856
v_mfma_f32_16x16x32_bf16 v[108:111], a[108:111], a[140:143], v[108:111]
buffer_store_dword v1, v0, s[40:43], s52 offen sc1
v_mfma_f32_16x16x32_bf16 v[100:103], a[108:111], a[132:135], v[100:103]
s_waitcnt lgkmcnt(2)
v_mfma_f32_16x16x32_bf16 v[100:103], a[104:107], a[128:131], v[100:103]
buffer_load_dwordx4 v8, s[56:59], s64 offen offset:1024 lds
v_mfma_f32_16x16x32_bf16 v[128:131], a[112:115], a[128:131], v[128:131]
ds_read_b64_tr_b16 a[184:185], v14 offset:49152
ds_read_b64_tr_b16 a[186:187], v14 offset:49664
v_mfma_f32_16x16x32_bf16 v[128:131], a[116:119], a[132:135], v[128:131]
v_mfma_f32_16x16x32_bf16 v[136:139], a[116:119], a[140:143], v[136:139]
s_add_u32 m0, s77, 34816
s_add_u32 s64, s76, 131072
v_mfma_f32_16x16x32_bf16 v[136:139], a[112:115], a[136:139], v[136:139]
ds_read_b64_tr_b16 a[188:189], v14 offset:57344
ds_read_b64_tr_b16 a[190:191], v14 offset:57856
v_mfma_f32_16x16x32_bf16 v[144:147], a[112:115], a[144:147], v[144:147]
buffer_load_dwordx4 v7, s[56:59], s64 offen lds
v_mfma_f32_16x16x32_bf16 v[144:147], a[116:119], a[148:151], v[144:147]
v_mfma_f32_16x16x32_bf16 v[152:155], a[116:119], a[156:159], v[152:155]
v_mfma_f32_16x16x32_bf16 v[152:155], a[112:115], a[152:155], v[152:155]
v_mfma_f32_16x16x32_bf16 v[156:159], a[120:123], a[152:155], v[156:159]
v_mfma_f32_16x16x32_bf16 v[156:159], a[124:127], a[156:159], v[156:159]
buffer_load_dwordx4 v8, s[56:59], s64 offen offset:1024 lds
v_mfma_f32_16x16x32_bf16 v[148:151], a[124:127], a[148:151], v[148:151]
v_mfma_f32_16x16x32_bf16 v[148:151], a[120:123], a[144:147], v[148:151]
v_mfma_f32_16x16x32_bf16 v[140:143], a[120:123], a[136:139], v[140:143]
v_mfma_f32_16x16x32_bf16 v[140:143], a[124:127], a[140:143], v[140:143]
v_mfma_f32_16x16x32_bf16 v[132:135], a[124:127], a[132:135], v[132:135]
v_mfma_f32_16x16x32_bf16 v[132:135], a[120:123], a[128:131], v[132:135]
s_waitcnt lgkmcnt(0)
v_mfma_f32_16x16x32_bf16 v[160:163], a[160:163], a[64:67], v[160:163]
s_waitcnt vmcnt(13)
v_mfma_f32_16x16x32_bf16 v[160:163], a[164:167], a[68:71], v[160:163]
s_barrier
v_mfma_f32_16x16x32_bf16 v[164:167], a[172:175], a[68:71], v[164:167]
s_xor_b32 s52, s6, 31
ds_read_b64_tr_b16 a[128:129], v11 offset:0
ds_read_b64_tr_b16 a[130:131], v11 offset:512
v_mfma_f32_16x16x32_bf16 v[164:167], a[168:171], a[64:67], v[164:167]
s_add_u32 m0, s73, 4096
s_add_u32 s64, s71, 524288
s_mul_i32 s52, s52, 110592
v_mfma_f32_16x16x32_bf16 v[168:171], a[176:179], a[64:67], v[168:171]
buffer_load_dwordx4 v5, s[8:11], s64 offen lds
v_mfma_f32_16x16x32_bf16 v[168:171], a[180:183], a[68:71], v[168:171]
s_mul_i32 s53, s3, 27648
s_add_u32 s52, s52, s53
s_mul_i32 s53, s7, 144
v_mfma_f32_16x16x32_bf16 v[172:175], a[188:191], a[68:71], v[172:175]
s_add_u32 s52, s52, s53
v_mfma_f32_16x16x32_bf16 v[172:175], a[184:187], a[64:67], v[172:175]
ds_read_b128 a[64:67], v9 offset:0
v_mfma_f32_16x16x32_bf16 v[188:191], a[184:187], a[72:75], v[188:191]
buffer_load_dwordx4 v6, s[8:11], s64 offen offset:1024 lds
v_mfma_f32_16x16x32_bf16 v[188:191], a[188:191], a[76:79], v[188:191]
ds_read_b64_tr_b16 a[132:133], v11 offset:8192
ds_read_b64_tr_b16 a[134:135], v11 offset:8704
v_mfma_f32_16x16x32_bf16 v[184:187], a[180:183], a[76:79], v[184:187]
buffer_load_dword a252, v28, s[28:31], s52 offen
v_mfma_f32_16x16x32_bf16 v[184:187], a[176:179], a[72:75], v[184:187]
s_add_u32 m0, s73, 6144
s_add_u32 s64, s71, 540672
ds_read_b128 a[68:71], v10 offset:0
v_mfma_f32_16x16x32_bf16 v[180:183], a[168:171], a[72:75], v[180:183]
v_mfma_f32_16x16x32_bf16 v[180:183], a[172:175], a[76:79], v[180:183]
buffer_load_dwordx4 v5, s[8:11], s64 offen lds
v_mfma_f32_16x16x32_bf16 v[176:179], a[164:167], a[76:79], v[176:179]
v_mfma_f32_16x16x32_bf16 v[176:179], a[160:163], a[72:75], v[176:179]
ds_read_b64_tr_b16 a[136:137], v12 offset:0
ds_read_b64_tr_b16 a[138:139], v12 offset:512
v_mfma_f32_16x16x32_bf16 v[192:195], a[160:163], a[80:83], v[192:195]
v_mfma_f32_16x16x32_bf16 v[192:195], a[164:167], a[84:87], v[192:195]
v_mfma_f32_16x16x32_bf16 v[196:199], a[172:175], a[84:87], v[196:199]
buffer_load_dwordx4 v6, s[8:11], s64 offen offset:1024 lds
v_mfma_f32_16x16x32_bf16 v[196:199], a[168:171], a[80:83], v[196:199]
ds_read_b128 a[72:75], v9 offset:2048
v_mfma_f32_16x16x32_bf16 v[200:203], a[176:179], a[80:83], v[200:203]
v_mfma_f32_16x16x32_bf16 v[200:203], a[180:183], a[84:87], v[200:203]
s_add_u32 m0, s77, 49152
s_add_u32 s64, s76, 0
v_mfma_f32_16x16x32_bf16 v[204:207], a[188:191], a[84:87], v[204:207]
ds_read_b64_tr_b16 a[140:141], v12 offset:8192
ds_read_b64_tr_b16 a[142:143], v12 offset:8704
v_mfma_f32_16x16x32_bf16 v[204:207], a[184:187], a[80:83], v[204:207]
buffer_load_dwordx4 v7, s[16:19], s64 offen lds
v_mfma_f32_16x16x32_bf16 v[220:223], a[184:187], a[88:91], v[220:223]
ds_read_b128 a[76:79], v10 offset:2048
v_mfma_f32_16x16x32_bf16 v[220:223], a[188:191], a[92:95], v[220:223]
v_mfma_f32_16x16x32_bf16 v[216:219], a[180:183], a[92:95], v[216:219]
v_mfma_f32_16x16x32_bf16 v[216:219], a[176:179], a[88:91], v[216:219]
v_mfma_f32_16x16x32_bf16 v[212:215], a[168:171], a[88:91], v[212:215]
buffer_load_dwordx4 v8, s[16:19], s64 offen offset:1024 lds
v_mfma_f32_16x16x32_bf16 v[212:215], a[172:175], a[92:95], v[212:215]
ds_read_b64_tr_b16 a[144:145], v13 offset:0
ds_read_b64_tr_b16 a[146:147], v13 offset:512
v_mfma_f32_16x16x32_bf16 v[208:211], a[164:167], a[92:95], v[208:211]
v_mfma_f32_16x16x32_bf16 v[208:211], a[160:163], a[88:91], v[208:211]
s_add_u32 m0, s77, 51200
s_add_u32 s64, s76, 131072
ds_read_b128 a[80:83], v9 offset:4096
v_mfma_f32_16x16x32_bf16 v[224:227], a[160:163], a[96:99], v[224:227]
v_mfma_f32_16x16x32_bf16 v[224:227], a[164:167], a[100:103], v[224:227]
buffer_load_dwordx4 v7, s[16:19], s64 offen lds
v_mfma_f32_16x16x32_bf16 v[228:231], a[172:175], a[100:103], v[228:231]
ds_read_b64_tr_b16 a[148:149], v13 offset:8192
ds_read_b64_tr_b16 a[150:151], v13 offset:8704
v_mfma_f32_16x16x32_bf16 v[228:231], a[168:171], a[96:99], v[228:231]
v_mfma_f32_16x16x32_bf16 v[232:235], a[176:179], a[96:99], v[232:235]
v_mfma_f32_16x16x32_bf16 v[232:235], a[180:183], a[100:103], v[232:235]
buffer_load_dwordx4 v8, s[16:19], s64 offen offset:1024 lds
v_mfma_f32_16x16x32_bf16 v[236:239], a[188:191], a[100:103], v[236:239]
s_xor_b32 s71, s70, 512
s_add_u32 s71, s68, s71
ds_read_b128 a[84:87], v10 offset:4096
v_mfma_f32_16x16x32_bf16 v[236:239], a[184:187], a[96:99], v[236:239]
v_mfma_f32_16x16x32_bf16 v[252:255], a[184:187], a[104:107], v[252:255]
s_add_u32 m0, s73, 32768
s_add_u32 s64, s71, 0
v_mfma_f32_16x16x32_bf16 v[252:255], a[188:191], a[108:111], v[252:255]
ds_read_b64_tr_b16 a[152:153], v14 offset:0
ds_read_b64_tr_b16 a[154:155], v14 offset:512
v_mfma_f32_16x16x32_bf16 v[248:251], a[180:183], a[108:111], v[248:251]
buffer_load_dwordx4 v5, s[8:11], s64 offen lds
v_mfma_f32_16x16x32_bf16 v[248:251], a[176:179], a[104:107], v[248:251]
v_mfma_f32_16x16x32_bf16 v[244:247], a[168:171], a[104:107], v[244:247]
ds_read_b128 a[88:91], v9 offset:6144
v_mfma_f32_16x16x32_bf16 v[244:247], a[172:175], a[108:111], v[244:247]
v_mfma_f32_16x16x32_bf16 v[240:243], a[164:167], a[108:111], v[240:243]
v_mfma_f32_16x16x32_bf16 v[240:243], a[160:163], a[104:107], v[240:243]
buffer_load_dwordx4 v6, s[8:11], s64 offen offset:1024 lds
v_mfma_f32_16x16x32_bf16 a[0:3], a[160:163], a[112:115], a[0:3]
ds_read_b64_tr_b16 a[156:157], v14 offset:8192
ds_read_b64_tr_b16 a[158:159], v14 offset:8704
v_mfma_f32_16x16x32_bf16 a[0:3], a[164:167], a[116:119], a[0:3]
v_mfma_f32_16x16x32_bf16 a[4:7], a[172:175], a[116:119], a[4:7]
s_add_u32 m0, s73, 34816
s_add_u32 s64, s71, 16384
ds_read_b128 a[92:95], v10 offset:6144
v_mfma_f32_16x16x32_bf16 a[4:7], a[168:171], a[112:115], a[4:7]
v_mfma_f32_16x16x32_bf16 a[8:11], a[176:179], a[112:115], a[8:11]
buffer_load_dwordx4 v5, s[8:11], s64 offen lds
v_mfma_f32_16x16x32_bf16 a[8:11], a[180:183], a[116:119], a[8:11]
v_mfma_f32_16x16x32_bf16 a[12:15], a[188:191], a[116:119], a[12:15]
v_mfma_f32_16x16x32_bf16 a[12:15], a[184:187], a[112:115], a[12:15]
v_mfma_f32_16x16x32_bf16 a[28:31], a[184:187], a[120:123], a[28:31]
v_mfma_f32_16x16x32_bf16 a[28:31], a[188:191], a[124:127], a[28:31]
buffer_load_dwordx4 v6, s[8:11], s64 offen offset:1024 lds
v_mfma_f32_16x16x32_bf16 a[24:27], a[180:183], a[124:127], a[24:27]
v_mfma_f32_16x16x32_bf16 a[24:27], a[176:179], a[120:123], a[24:27]
v_mfma_f32_16x16x32_bf16 a[20:23], a[168:171], a[120:123], a[20:23]
v_mfma_f32_16x16x32_bf16 a[20:23], a[172:175], a[124:127], a[20:23]
v_mfma_f32_16x16x32_bf16 a[16:19], a[164:167], a[124:127], a[16:19]
v_mfma_f32_16x16x32_bf16 a[16:19], a[160:163], a[120:123], a[16:19]
s_waitcnt lgkmcnt(0)
v_mfma_f32_16x16x32_bf16 v[32:35], a[64:67], a[128:131], v[32:35]
s_waitcnt vmcnt(22)
v_mfma_f32_16x16x32_bf16 v[32:35], a[68:71], a[132:135], v[32:35]
s_barrier
v_mfma_f32_16x16x32_bf16 v[40:43], a[68:71], a[140:143], v[40:43]
ds_read_b128 a[96:99], v9 offset:8192
v_mfma_f32_16x16x32_bf16 v[40:43], a[64:67], a[136:139], v[40:43]
s_xor_b32 s76, s75, 2097152
s_add_u32 s76, s74, s76
v_mfma_f32_16x16x32_bf16 v[48:51], a[64:67], a[144:147], v[48:51]
s_add_u32 m0, s77, 0
s_add_u32 s64, s76, 0
v_mfma_f32_16x16x32_bf16 v[48:51], a[68:71], a[148:151], v[48:51]
buffer_load_dwordx4 v7, s[56:59], s64 offen lds
v_mfma_f32_16x16x32_bf16 v[56:59], a[68:71], a[156:159], v[56:59]
ds_read_b128 a[100:103], v10 offset:8192
v_mfma_f32_16x16x32_bf16 v[56:59], a[64:67], a[152:155], v[56:59]
v_mfma_f32_16x16x32_bf16 v[60:63], a[72:75], a[152:155], v[60:63]
ds_read_b128 a[104:107], v9 offset:10240
v_mfma_f32_16x16x32_bf16 v[60:63], a[76:79], a[156:159], v[60:63]
v_mfma_f32_16x16x32_bf16 v[52:55], a[76:79], a[148:151], v[52:55]
v_mfma_f32_16x16x32_bf16 v[52:55], a[72:75], a[144:147], v[52:55]
buffer_load_dwordx4 v8, s[56:59], s64 offen offset:1024 lds
v_mfma_f32_16x16x32_bf16 v[44:47], a[72:75], a[136:139], v[44:47]
ds_read_b64_tr_b16 a[160:161], v11 offset:16384
ds_read_b64_tr_b16 a[162:163], v11 offset:16896
v_mfma_f32_16x16x32_bf16 v[44:47], a[76:79], a[140:143], v[44:47]
v_mfma_f32_16x16x32_bf16 v[36:39], a[76:79], a[132:135], v[36:39]
v_mfma_f32_16x16x32_bf16 v[36:39], a[72:75], a[128:131], v[36:39]
ds_read_b128 a[108:111], v10 offset:10240
v_mfma_f32_16x16x32_bf16 v[64:67], a[80:83], a[128:131], v[64:67]
s_add_u32 m0, s77, 2048
s_add_u32 s64, s76, 131072
v_mfma_f32_16x16x32_bf16 v[64:67], a[84:87], a[132:135], v[64:67]
v_mfma_f32_16x16x32_bf16 v[72:75], a[84:87], a[140:143], v[72:75]
buffer_load_dwordx4 v7, s[56:59], s64 offen lds
v_mfma_f32_16x16x32_bf16 v[72:75], a[80:83], a[136:139], v[72:75]
ds_read_b64_tr_b16 a[164:165], v11 offset:24576
ds_read_b64_tr_b16 a[166:167], v11 offset:25088
v_mfma_f32_16x16x32_bf16 v[80:83], a[80:83], a[144:147], v[80:83]
v_mfma_f32_16x16x32_bf16 v[80:83], a[84:87], a[148:151], v[80:83]
ds_read_b128 a[112:115], v9 offset:12288
v_mfma_f32_16x16x32_bf16 v[88:91], a[84:87], a[156:159], v[88:91]
v_mfma_f32_16x16x32_bf16 v[88:91], a[80:83], a[152:155], v[88:91]
v_mfma_f32_16x16x32_bf16 v[92:95], a[88:91], a[152:155], v[92:95]
ds_read_b64_tr_b16 a[168:169], v12 offset:16384
ds_read_b64_tr_b16 a[170:171], v12 offset:16896
v_mfma_f32_16x16x32_bf16 v[92:95], a[92:95], a[156:159], v[92:95]
buffer_load_dwordx4 v8, s[56:59], s64 offen offset:1024 lds
v_mfma_f32_16x16x32_bf16 v[84:87], a[92:95], a[148:151], v[84:87]
v_mfma_f32_16x16x32_bf16 v[84:87], a[88:91], a[144:147], v[84:87]
v_mfma_f32_16x16x32_bf16 v[76:79], a[88:91], a[136:139], v[76:79]
ds_read_b128 a[116:119], v10 offset:12288
v_mfma_f32_16x16x32_bf16 v[76:79], a[92:95], a[140:143], v[76:79]
v_mfma_f32_16x16x32_bf16 v[68:71], a[92:95], a[132:135], v[68:71]
v_mfma_f32_16x16x32_bf16 v[68:71], a[88:91], a[128:131], v[68:71]
s_add_u32 m0, s73, 36864
s_add_u32 s64, s71, 524288
s_waitcnt lgkmcnt(6)
v_mfma_f32_16x16x32_bf16 v[96:99], a[96:99], a[128:131], v[96:99]
ds_read_b64_tr_b16 a[172:173], v12 offset:24576
ds_read_b64_tr_b16 a[174:175], v12 offset:25088
v_mfma_f32_16x16x32_bf16 v[96:99], a[100:103], a[132:135], v[96:99]
buffer_load_dwordx4 v5, s[8:11], s64 offen lds
v_mfma_f32_16x16x32_bf16 v[104:107], a[100:103], a[140:143], v[104:107]
ds_read_b128 a[120:123], v9 offset:14336
v_mfma_f32_16x16x32_bf16 v[104:107], a[96:99], a[136:139], v[104:107]
v_mfma_f32_16x16x32_bf16 v[112:115], a[96:99], a[144:147], v[112:115]
v_mfma_f32_16x16x32_bf16 v[112:115], a[100:103], a[148:151], v[112:115]
ds_read_b64_tr_b16 a[176:177], v13 offset:16384
ds_read_b64_tr_b16 a[178:179], v13 offset:16896
v_mfma_f32_16x16x32_bf16 v[120:123], a[100:103], a[156:159], v[120:123]
v_mfma_f32_16x16x32_bf16 v[120:123], a[96:99], a[152:155], v[120:123]
v_mfma_f32_16x16x32_bf16 v[124:127], a[104:107], a[152:155], v[124:127]
buffer_load_dwordx4 v6, s[8:11], s64 offen offset:1024 lds
v_mfma_f32_16x16x32_bf16 v[124:127], a[108:111], a[156:159], v[124:127]
ds_read_b128 a[124:127], v10 offset:14336
v_mfma_f32_16x16x32_bf16 v[116:119], a[108:111], a[148:151], v[116:119]
v_add_u32 v9, -65536, v9
v_add_u32 v10, -65536, v10
v_mfma_f32_16x16x32_bf16 v[116:119], a[104:107], a[144:147], v[116:119]
v_mfma_f32_16x16x32_bf16 v[108:111], a[104:107], a[136:139], v[108:111]
ds_read_b64_tr_b16 a[180:181], v13 offset:24576
ds_read_b64_tr_b16 a[182:183], v13 offset:25088
v_mfma_f32_16x16x32_bf16 v[108:111], a[108:111], a[140:143], v[108:111]
s_add_u32 m0, s73, 38912
s_add_u32 s64, s71, 540672
v_mfma_f32_16x16x32_bf16 v[100:103], a[108:111], a[132:135], v[100:103]
s_waitcnt lgkmcnt(2)
v_mfma_f32_16x16x32_bf16 v[100:103], a[104:107], a[128:131], v[100:103]
buffer_load_dwordx4 v5, s[8:11], s64 offen lds
v_mfma_f32_16x16x32_bf16 v[128:131], a[112:115], a[128:131], v[128:131]
ds_read_b64_tr_b16 a[184:185], v14 offset:16384
ds_read_b64_tr_b16 a[186:187], v14 offset:16896
v_mfma_f32_16x16x32_bf16 v[128:131], a[116:119], a[132:135], v[128:131]
v_mfma_f32_16x16x32_bf16 v[136:139], a[116:119], a[140:143], v[136:139]
ds_read_b64_tr_b16 a[188:189], v14 offset:24576
ds_read_b64_tr_b16 a[190:191], v14 offset:25088
v_mfma_f32_16x16x32_bf16 v[136:139], a[112:115], a[136:139], v[136:139]
v_mfma_f32_16x16x32_bf16 v[144:147], a[112:115], a[144:147], v[144:147]
v_mfma_f32_16x16x32_bf16 v[144:147], a[116:119], a[148:151], v[144:147]
v_mfma_f32_16x16x32_bf16 v[152:155], a[116:119], a[156:159], v[152:155]
buffer_load_dwordx4 v6, s[8:11], s64 offen offset:1024 lds
v_mfma_f32_16x16x32_bf16 v[152:155], a[112:115], a[152:155], v[152:155]
v_mfma_f32_16x16x32_bf16 v[156:159], a[120:123], a[152:155], v[156:159]
v_mfma_f32_16x16x32_bf16 v[156:159], a[124:127], a[156:159], v[156:159]
v_mfma_f32_16x16x32_bf16 v[148:151], a[124:127], a[148:151], v[148:151]
v_mfma_f32_16x16x32_bf16 v[148:151], a[120:123], a[144:147], v[148:151]
v_mfma_f32_16x16x32_bf16 v[140:143], a[120:123], a[136:139], v[140:143]
v_mfma_f32_16x16x32_bf16 v[140:143], a[124:127], a[140:143], v[140:143]
v_mfma_f32_16x16x32_bf16 v[132:135], a[124:127], a[132:135], v[132:135]
v_mfma_f32_16x16x32_bf16 v[132:135], a[120:123], a[128:131], v[132:135]
s_waitcnt lgkmcnt(0)
v_mfma_f32_16x16x32_bf16 v[160:163], a[160:163], a[64:67], v[160:163]
s_waitcnt vmcnt(16)
v_mfma_f32_16x16x32_bf16 v[160:163], a[164:167], a[68:71], v[160:163]
s_barrier
v_mfma_f32_16x16x32_bf16 v[164:167], a[172:175], a[68:71], v[164:167]
s_add_u32 s52, s81, 0
ds_read_b64_tr_b16 a[128:129], v11 offset:32768
ds_read_b64_tr_b16 a[130:131], v11 offset:33280
v_mfma_f32_16x16x32_bf16 v[164:167], a[168:171], a[64:67], v[164:167]
s_add_u32 m0, s77, 16384
s_add_u32 s64, s76, 0
v_mfma_f32_16x16x32_bf16 v[168:171], a[176:179], a[64:67], v[168:171]
buffer_load_dwordx4 v7, s[16:19], s64 offen lds
v_mfma_f32_16x16x32_bf16 v[168:171], a[180:183], a[68:71], v[168:171]
buffer_load_dwordx2 a[192:193], v26, s[28:31], s52 offen
v_mfma_f32_16x16x32_bf16 v[172:175], a[188:191], a[68:71], v[172:175]
v_mfma_f32_16x16x32_bf16 v[172:175], a[184:187], a[64:67], v[172:175]
ds_read_b128 a[64:67], v9 offset:0
v_mfma_f32_16x16x32_bf16 v[188:191], a[184:187], a[72:75], v[188:191]
ds_read_b64_tr_b16 a[132:133], v11 offset:40960
ds_read_b64_tr_b16 a[134:135], v11 offset:41472
v_mfma_f32_16x16x32_bf16 v[188:191], a[188:191], a[76:79], v[188:191]
v_mfma_f32_16x16x32_bf16 v[184:187], a[180:183], a[76:79], v[184:187]
s_add_u32 s52, s81, 3456
v_mfma_f32_16x16x32_bf16 v[184:187], a[176:179], a[72:75], v[184:187]
buffer_load_dwordx4 v8, s[16:19], s64 offen offset:1024 lds
v_mfma_f32_16x16x32_bf16 v[180:183], a[168:171], a[72:75], v[180:183]
L_PAD1:
s_cbranch_execz L_PAD5
ds_read_b128 a[68:71], v10 offset:0
v_mfma_f32_16x16x32_bf16 v[180:183], a[172:175], a[76:79], v[180:183]
buffer_load_dwordx2 a[194:195], v26, s[28:31], s52 offen
v_mfma_f32_16x16x32_bf16 v[176:179], a[164:167], a[76:79], v[176:179]
v_mfma_f32_16x16x32_bf16 v[176:179], a[160:163], a[72:75], v[176:179]
ds_read_b64_tr_b16 a[136:137], v12 offset:32768
ds_read_b64_tr_b16 a[138:139], v12 offset:33280
v_mfma_f32_16x16x32_bf16 v[192:195], a[160:163], a[80:83], v[192:195]
s_add_u32 m0, s77, 18432
s_add_u32 s64, s76, 131072
v_mfma_f32_16x16x32_bf16 v[192:195], a[164:167], a[84:87], v[192:195]
v_mfma_f32_16x16x32_bf16 v[196:199], a[172:175], a[84:87], v[196:199]
buffer_load_dwordx4 v7, s[16:19], s64 offen lds
v_mfma_f32_16x16x32_bf16 v[196:199], a[168:171], a[80:83], v[196:199]
s_add_u32 s52, s81, 6912
ds_read_b128 a[72:75], v9 offset:2048
v_mfma_f32_16x16x32_bf16 v[200:203], a[176:179], a[80:83], v[200:203]
buffer_load_dwordx2 a[196:197], v26, s[28:31], s52 offen
v_mfma_f32_16x16x32_bf16 v[200:203], a[180:183], a[84:87], v[200:203]
ds_read_b64_tr_b16 a[140:141], v12 offset:40960
ds_read_b64_tr_b16 a[142:143], v12 offset:41472
v_mfma_f32_16x16x32_bf16 v[204:207], a[188:191], a[84:87], v[204:207]
v_mfma_f32_16x16x32_bf16 v[204:207], a[184:187], a[80:83], v[204:207]
v_mfma_f32_16x16x32_bf16 v[220:223], a[184:187], a[88:91], v[220:223]
ds_read_b128 a[76:79], v10 offset:2048
v_mfma_f32_16x16x32_bf16 v[220:223], a[188:191], a[92:95], v[220:223]
buffer_load_dwordx4 v8, s[16:19], s64 offen offset:1024 lds
v_mfma_f32_16x16x32_bf16 v[216:219], a[180:183], a[92:95], v[216:219]
s_xor_b32 s71, s70, 640
s_add_u32 s71, s68, s71
s_add_u32 s52, s81, 10368
v_mfma_f32_16x16x32_bf16 v[216:219], a[176:179], a[88:91], v[216:219]
buffer_load_dwordx2 a[198:199], v26, s[28:31], s52 offen
v_mfma_f32_16x16x32_bf16 v[212:215], a[168:171], a[88:91], v[212:215]
ds_read_b64_tr_b16 a[144:145], v13 offset:32768
ds_read_b64_tr_b16 a[146:147], v13 offset:33280
v_mfma_f32_16x16x32_bf16 v[212:215], a[172:175], a[92:95], v[212:215]
v_mfma_f32_16x16x32_bf16 v[208:211], a[164:167], a[92:95], v[208:211]
v_mfma_f32_16x16x32_bf16 v[208:211], a[160:163], a[88:91], v[208:211]
s_add_u32 m0, s73, 65536
s_add_u32 s64, s71, 0
ds_read_b128 a[80:83], v9 offset:4096
v_mfma_f32_16x16x32_bf16 v[224:227], a[160:163], a[96:99], v[224:227]
s_add_u32 s52, s81, 13824
v_mfma_f32_16x16x32_bf16 v[224:227], a[164:167], a[100:103], v[224:227]
buffer_load_dwordx4 v5, s[8:11], s64 offen lds
v_mfma_f32_16x16x32_bf16 v[228:231], a[172:175], a[100:103], v[228:231]
ds_read_b64_tr_b16 a[148:149], v13 offset:40960
ds_read_b64_tr_b16 a[150:151], v13 offset:41472
v_mfma_f32_16x16x32_bf16 v[228:231], a[168:171], a[96:99], v[228:231]
buffer_load_dwordx2 a[200:201], v26, s[28:31], s52 offen
v_mfma_f32_16x16x32_bf16 v[232:235], a[176:179], a[96:99], v[232:235]
v_mfma_f32_16x16x32_bf16 v[232:235], a[180:183], a[100:103], v[232:235]
ds_read_b128 a[84:87], v10 offset:4096
v_mfma_f32_16x16x32_bf16 v[236:239], a[188:191], a[100:103], v[236:239]
v_mfma_f32_16x16x32_bf16 v[236:239], a[184:187], a[96:99], v[236:239]
v_mfma_f32_16x16x32_bf16 v[252:255], a[184:187], a[104:107], v[252:255]
buffer_load_dwordx4 v6, s[8:11], s64 offen offset:1024 lds
v_mfma_f32_16x16x32_bf16 v[252:255], a[188:191], a[108:111], v[252:255]
s_add_u32 s52, s81, 17280
ds_read_b64_tr_b16 a[152:153], v14 offset:32768
ds_read_b64_tr_b16 a[154:155], v14 offset:33280
v_mfma_f32_16x16x32_bf16 v[248:251], a[180:183], a[108:111], v[248:251]
buffer_load_dwordx2 a[202:203], v26, s[28:31], s52 offen
v_mfma_f32_16x16x32_bf16 v[248:251], a[176:179], a[104:107], v[248:251]
v_mfma_f32_16x16x32_bf16 v[244:247], a[168:171], a[104:107], v[244:247]
ds_read_b128 a[88:91], v9 offset:6144
v_mfma_f32_16x16x32_bf16 v[244:247], a[172:175], a[108:111], v[244:247]
s_add_u32 m0, s73, 67584
s_add_u32 s64, s71, 16384
v_mfma_f32_16x16x32_bf16 v[240:243], a[164:167], a[108:111], v[240:243]
v_mfma_f32_16x16x32_bf16 v[240:243], a[160:163], a[104:107], v[240:243]
buffer_load_dwordx4 v5, s[8:11], s64 offen lds
v_mfma_f32_16x16x32_bf16 a[0:3], a[160:163], a[112:115], a[0:3]
s_add_u32 s52, s81, 20736
ds_read_b64_tr_b16 a[156:157], v14 offset:40960
ds_read_b64_tr_b16 a[158:159], v14 offset:41472
v_mfma_f32_16x16x32_bf16 a[0:3], a[164:167], a[116:119], a[0:3]
buffer_load_dwordx2 a[204:205], v26, s[28:31], s52 offen
v_mfma_f32_16x16x32_bf16 a[4:7], a[172:175], a[116:119], a[4:7]
ds_read_b128 a[92:95], v10 offset:6144
v_mfma_f32_16x16x32_bf16 a[4:7], a[168:171], a[112:115], a[4:7]
v_mfma_f32_16x16x32_bf16 a[8:11], a[176:179], a[112:115], a[8:11]
v_mfma_f32_16x16x32_bf16 a[8:11], a[180:183], a[116:119], a[8:11]
v_mfma_f32_16x16x32_bf16 a[12:15], a[188:191], a[116:119], a[12:15]
buffer_load_dwordx4 v6, s[8:11], s64 offen offset:1024 lds
v_mfma_f32_16x16x32_bf16 a[12:15], a[184:187], a[112:115], a[12:15]
s_add_u32 s52, s81, 24192
v_mfma_f32_16x16x32_bf16 a[28:31], a[184:187], a[120:123], a[28:31]
buffer_load_dwordx2 a[206:207], v26, s[28:31], s52 offen
v_mfma_f32_16x16x32_bf16 a[28:31], a[188:191], a[124:127], a[28:31]
v_mfma_f32_16x16x32_bf16 a[24:27], a[180:183], a[124:127], a[24:27]
v_mfma_f32_16x16x32_bf16 a[24:27], a[176:179], a[120:123], a[24:27]
v_mfma_f32_16x16x32_bf16 a[20:23], a[168:171], a[120:123], a[20:23]
v_mfma_f32_16x16x32_bf16 a[20:23], a[172:175], a[124:127], a[20:23]
buffer_load_dwordx4 a[208:211], v27, s[36:39], s83 offen
v_mfma_f32_16x16x32_bf16 a[16:19], a[164:167], a[124:127], a[16:19]
v_mfma_f32_16x16x32_bf16 a[16:19], a[160:163], a[120:123], a[16:19]
s_waitcnt lgkmcnt(0)
v_mfma_f32_16x16x32_bf16 v[32:35], a[64:67], a[128:131], v[32:35]
s_waitcnt vmcnt(29)
v_mfma_f32_16x16x32_bf16 v[32:35], a[68:71], a[132:135], v[32:35]
s_barrier
v_mfma_f32_16x16x32_bf16 v[40:43], a[68:71], a[140:143], v[40:43]
ds_read_b128 a[96:99], v9 offset:8192
v_mfma_f32_16x16x32_bf16 v[40:43], a[64:67], a[136:139], v[40:43]
s_xor_b32 s76, s75, 2621440
s_add_u32 s76, s74, s76
v_mfma_f32_16x16x32_bf16 v[48:51], a[64:67], a[144:147], v[48:51]
s_add_u32 m0, s77, 32768
s_add_u32 s64, s76, 0
v_mfma_f32_16x16x32_bf16 v[48:51], a[68:71], a[148:151], v[48:51]
buffer_load_dwordx4 v7, s[56:59], s64 offen lds
v_mfma_f32_16x16x32_bf16 v[56:59], a[68:71], a[156:159], v[56:59]
ds_read_b128 a[100:103], v10 offset:8192
v_mfma_f32_16x16x32_bf16 v[56:59], a[64:67], a[152:155], v[56:59]
v_mfma_f32_16x16x32_bf16 v[60:63], a[72:75], a[152:155], v[60:63]
ds_read_b128 a[104:107], v9 offset:10240
v_mfma_f32_16x16x32_bf16 v[60:63], a[76:79], a[156:159], v[60:63]
v_mfma_f32_16x16x32_bf16 v[52:55], a[76:79], a[148:151], v[52:55]
v_mfma_f32_16x16x32_bf16 v[52:55], a[72:75], a[144:147], v[52:55]
buffer_load_dwordx4 v8, s[56:59], s64 offen offset:1024 lds
v_mfma_f32_16x16x32_bf16 v[44:47], a[72:75], a[136:139], v[44:47]
ds_read_b64_tr_b16 a[160:161], v11 offset:49152
ds_read_b64_tr_b16 a[162:163], v11 offset:49664
v_mfma_f32_16x16x32_bf16 v[44:47], a[76:79], a[140:143], v[44:47]
v_mfma_f32_16x16x32_bf16 v[36:39], a[76:79], a[132:135], v[36:39]
v_mfma_f32_16x16x32_bf16 v[36:39], a[72:75], a[128:131], v[36:39]
ds_read_b128 a[108:111], v10 offset:10240
v_mfma_f32_16x16x32_bf16 v[64:67], a[80:83], a[128:131], v[64:67]
s_add_u32 m0, s77, 34816
s_add_u32 s64, s76, 131072
v_mfma_f32_16x16x32_bf16 v[64:67], a[84:87], a[132:135], v[64:67]
v_mfma_f32_16x16x32_bf16 v[72:75], a[84:87], a[140:143], v[72:75]
buffer_load_dwordx4 v7, s[56:59], s64 offen lds
v_mfma_f32_16x16x32_bf16 v[72:75], a[80:83], a[136:139], v[72:75]
ds_read_b64_tr_b16 a[164:165], v11 offset:57344
ds_read_b64_tr_b16 a[166:167], v11 offset:57856
v_mfma_f32_16x16x32_bf16 v[80:83], a[80:83], a[144:147], v[80:83]
v_mfma_f32_16x16x32_bf16 v[80:83], a[84:87], a[148:151], v[80:83]
ds_read_b128 a[112:115], v9 offset:12288
v_mfma_f32_16x16x32_bf16 v[88:91], a[84:87], a[156:159], v[88:91]
v_mfma_f32_16x16x32_bf16 v[88:91], a[80:83], a[152:155], v[88:91]
v_mfma_f32_16x16x32_bf16 v[92:95], a[88:91], a[152:155], v[92:95]
ds_read_b64_tr_b16 a[168:169], v12 offset:49152
ds_read_b64_tr_b16 a[170:171], v12 offset:49664
v_mfma_f32_16x16x32_bf16 v[92:95], a[92:95], a[156:159], v[92:95]
buffer_load_dwordx4 v8, s[56:59], s64 offen offset:1024 lds
v_mfma_f32_16x16x32_bf16 v[84:87], a[92:95], a[148:151], v[84:87]
v_mfma_f32_16x16x32_bf16 v[84:87], a[88:91], a[144:147], v[84:87]
v_mfma_f32_16x16x32_bf16 v[76:79], a[88:91], a[136:139], v[76:79]
ds_read_b128 a[116:119], v10 offset:12288
v_mfma_f32_16x16x32_bf16 v[76:79], a[92:95], a[140:143], v[76:79]
v_mfma_f32_16x16x32_bf16 v[68:71], a[92:95], a[132:135], v[68:71]
v_mfma_f32_16x16x32_bf16 v[68:71], a[88:91], a[128:131], v[68:71]
s_add_u32 m0, s73, 69632
s_add_u32 s64, s71, 524288
s_waitcnt lgkmcnt(6)
v_mfma_f32_16x16x32_bf16 v[96:99], a[96:99], a[128:131], v[96:99]
ds_read_b64_tr_b16 a[172:173], v12 offset:57344
ds_read_b64_tr_b16 a[174:175], v12 offset:57856
v_mfma_f32_16x16x32_bf16 v[96:99], a[100:103], a[132:135], v[96:99]
buffer_load_dwordx4 v5, s[8:11], s64 offen lds
v_mfma_f32_16x16x32_bf16 v[104:107], a[100:103], a[140:143], v[104:107]
ds_read_b128 a[120:123], v9 offset:14336
v_mfma_f32_16x16x32_bf16 v[104:107], a[96:99], a[136:139], v[104:107]
v_mfma_f32_16x16x32_bf16 v[112:115], a[96:99], a[144:147], v[112:115]
v_mfma_f32_16x16x32_bf16 v[112:115], a[100:103], a[148:151], v[112:115]
s_waitcnt vmcnt(5)
ds_read_b64_tr_b16 a[176:177], v13 offset:49152
ds_read_b64_tr_b16 a[178:179], v13 offset:49664
v_mfma_f32_16x16x32_bf16 v[120:123], a[100:103], a[156:159], v[120:123]
v_accvgpr_read_b32 v16, a192
v_accvgpr_read_b32 v17, a194
v_mfma_f32_16x16x32_bf16 v[120:123], a[96:99], a[152:155], v[120:123]
v_accvgpr_read_b32 v18, a196
v_accvgpr_read_b32 v19, a198
v_mfma_f32_16x16x32_bf16 v[124:127], a[104:107], a[152:155], v[124:127]
buffer_load_dwordx4 v6, s[8:11], s64 offen offset:1024 lds
v_mfma_f32_16x16x32_bf16 v[124:127], a[108:111], a[156:159], v[124:127]
ds_read_b128 a[124:127], v10 offset:14336
v_accvgpr_read_b32 v20, a200
v_mfma_f32_16x16x32_bf16 v[116:119], a[108:111], a[148:151], v[116:119]
v_add_u32 v9, 32768, v9
v_add_u32 v10, 32768, v10
v_mfma_f32_16x16x32_bf16 v[116:119], a[104:107], a[144:147], v[116:119]
v_accvgpr_read_b32 v21, a202
v_accvgpr_read_b32 v22, a204
v_mfma_f32_16x16x32_bf16 v[108:111], a[104:107], a[136:139], v[108:111]
ds_read_b64_tr_b16 a[180:181], v13 offset:57344
ds_read_b64_tr_b16 a[182:183], v13 offset:57856
v_mfma_f32_16x16x32_bf16 v[108:111], a[108:111], a[140:143], v[108:111]
s_add_u32 m0, s73, 71680
s_add_u32 s64, s71, 540672
v_accvgpr_read_b32 v23, a206
v_mfma_f32_16x16x32_bf16 v[100:103], a[108:111], a[132:135], v[100:103]
s_waitcnt lgkmcnt(2)
v_mfma_f32_16x16x32_bf16 v[100:103], a[104:107], a[128:131], v[100:103]
buffer_load_dwordx4 v5, s[8:11], s64 offen lds
v_mfma_f32_16x16x32_bf16 v[128:131], a[112:115], a[128:131], v[128:131]
ds_read_b64_tr_b16 a[184:185], v14 offset:49152
ds_read_b64_tr_b16 a[186:187], v14 offset:49664
v_mfma_f32_16x16x32_bf16 v[128:131], a[116:119], a[132:135], v[128:131]
v_perm_b32 v24, v17, v16, s85
v_perm_b32 v25, v19, v18, s85
v_mfma_f32_16x16x32_bf16 v[136:139], a[116:119], a[140:143], v[136:139]
ds_read_b64_tr_b16 a[188:189], v14 offset:57344
ds_read_b64_tr_b16 a[190:191], v14 offset:57856
v_mfma_f32_16x16x32_bf16 v[136:139], a[112:115], a[136:139], v[136:139]
v_perm_b32 v26, v21, v20, s85
v_perm_b32 v27, v23, v22, s85
v_mfma_f32_16x16x32_bf16 v[144:147], a[112:115], a[144:147], v[144:147]
v_perm_b32 v28, v17, v16, s86
v_perm_b32 v29, v19, v18, s86
v_mfma_f32_16x16x32_bf16 v[144:147], a[116:119], a[148:151], v[144:147]
v_perm_b32 v30, v21, v20, s86
v_perm_b32 v31, v23, v22, s86
v_mfma_f32_16x16x32_bf16 v[152:155], a[116:119], a[156:159], v[152:155]
buffer_load_dwordx4 v6, s[8:11], s64 offen offset:1024 lds
v_mfma_f32_16x16x32_bf16 v[152:155], a[112:115], a[152:155], v[152:155]
v_accvgpr_read_b32 v16, a208
v_accvgpr_read_b32 v17, a209
v_mfma_f32_16x16x32_bf16 v[156:159], a[120:123], a[152:155], v[156:159]
v_accvgpr_read_b32 v18, a210
v_accvgpr_read_b32 v19, a211
v_mfma_f32_16x16x32_bf16 v[156:159], a[124:127], a[156:159], v[156:159]
v_or_b32 v24, v24, v16
v_or_b32 v25, v25, v17
v_mfma_f32_16x16x32_bf16 v[148:151], a[124:127], a[148:151], v[148:151]
v_or_b32 v26, v26, v18
v_or_b32 v27, v27, v19
v_mfma_f32_16x16x32_bf16 v[148:151], a[120:123], a[144:147], v[148:151]
buffer_store_dwordx4 v[24:27], v4, s[24:27], s82 offen offset:0 sc1
v_mfma_f32_16x16x32_bf16 v[140:143], a[120:123], a[136:139], v[140:143]
v_mfma_f32_16x16x32_bf16 v[140:143], a[124:127], a[140:143], v[140:143]
v_mfma_f32_16x16x32_bf16 v[132:135], a[124:127], a[132:135], v[132:135]
v_mfma_f32_16x16x32_bf16 v[132:135], a[120:123], a[128:131], v[132:135]
s_waitcnt lgkmcnt(0)
v_mfma_f32_16x16x32_bf16 v[160:163], a[160:163], a[64:67], v[160:163]
s_waitcnt vmcnt(26)
v_mfma_f32_16x16x32_bf16 v[160:163], a[164:167], a[68:71], v[160:163]
s_barrier
v_mfma_f32_16x16x32_bf16 v[164:167], a[172:175], a[68:71], v[164:167]
ds_read_b64_tr_b16 a[128:129], v11 offset:0
ds_read_b64_tr_b16 a[130:131], v11 offset:512
v_mfma_f32_16x16x32_bf16 v[164:167], a[168:171], a[64:67], v[164:167]
s_add_u32 m0, s77, 49152
s_add_u32 s64, s76, 0
v_mfma_f32_16x16x32_bf16 v[168:171], a[176:179], a[64:67], v[168:171]
buffer_load_dwordx4 v7, s[16:19], s64 offen lds
v_mfma_f32_16x16x32_bf16 v[168:171], a[180:183], a[68:71], v[168:171]
buffer_store_dwordx4 v[28:31], v4, s[24:27], s82 offen offset:1024 sc1
v_mfma_f32_16x16x32_bf16 v[172:175], a[188:191], a[68:71], v[172:175]
v_accvgpr_read_b32 v16, a193
v_accvgpr_read_b32 v17, a195
v_mfma_f32_16x16x32_bf16 v[172:175], a[184:187], a[64:67], v[172:175]
ds_read_b128 a[64:67], v9 offset:0
v_accvgpr_read_b32 v18, a197
v_mfma_f32_16x16x32_bf16 v[188:191], a[184:187], a[72:75], v[188:191]
ds_read_b64_tr_b16 a[132:133], v11 offset:8192
ds_read_b64_tr_b16 a[134:135], v11 offset:8704
v_mfma_f32_16x16x32_bf16 v[188:191], a[188:191], a[76:79], v[188:191]
v_accvgpr_read_b32 v19, a199
v_accvgpr_read_b32 v20, a201
v_mfma_f32_16x16x32_bf16 v[184:187], a[180:183], a[76:79], v[184:187]
v_accvgpr_read_b32 v21, a203
v_accvgpr_read_b32 v22, a205
v_mfma_f32_16x16x32_bf16 v[184:187], a[176:179], a[72:75], v[184:187]
buffer_load_dwordx4 v8, s[16:19], s64 offen offset:1024 lds
v_mfma_f32_16x16x32_bf16 v[180:183], a[168:171], a[72:75], v[180:183]
ds_read_b128 a[68:71], v10 offset:0
v_accvgpr_read_b32 v23, a207
v_mfma_f32_16x16x32_bf16 v[180:183], a[172:175], a[76:79], v[180:183]
v_mfma_f32_16x16x32_bf16 v[176:179], a[164:167], a[76:79], v[176:179]
v_perm_b32 v24, v17, v16, s85
v_perm_b32 v25, v19, v18, s85
v_mfma_f32_16x16x32_bf16 v[176:179], a[160:163], a[72:75], v[176:179]
ds_read_b64_tr_b16 a[136:137], v12 offset:0
ds_read_b64_tr_b16 a[138:139], v12 offset:512
v_mfma_f32_16x16x32_bf16 v[192:195], a[160:163], a[80:83], v[192:195]
s_add_u32 m0, s77, 51200
s_add_u32 s64, s76, 131072
v_perm_b32 v26, v21, v20, s85
v_mfma_f32_16x16x32_bf16 v[192:195], a[164:167], a[84:87], v[192:195]
v_perm_b32 v27, v23, v22, s85
v_perm_b32 v28, v17, v16, s86
v_mfma_f32_16x16x32_bf16 v[196:199], a[172:175], a[84:87], v[196:199]
buffer_load_dwordx4 v7, s[16:19], s64 offen lds
v_mfma_f32_16x16x32_bf16 v[196:199], a[168:171], a[80:83], v[196:199]
ds_read_b128 a[72:75], v9 offset:2048
v_perm_b32 v29, v19, v18, s86
v_mfma_f32_16x16x32_bf16 v[200:203], a[176:179], a[80:83], v[200:203]
v_perm_b32 v30, v21, v20, s86
v_perm_b32 v31, v23, v22, s86
v_mfma_f32_16x16x32_bf16 v[200:203], a[180:183], a[84:87], v[200:203]
ds_read_b64_tr_b16 a[140:141], v12 offset:8192
ds_read_b64_tr_b16 a[142:143], v12 offset:8704
v_mfma_f32_16x16x32_bf16 v[204:207], a[188:191], a[84:87], v[204:207]
buffer_store_dwordx4 v[24:27], v4, s[24:27], s82 offen offset:2048 sc1
v_mfma_f32_16x16x32_bf16 v[204:207], a[184:187], a[80:83], v[204:207]
v_mfma_f32_16x16x32_bf16 v[220:223], a[184:187], a[88:91], v[220:223]
ds_read_b128 a[76:79], v10 offset:2048
v_mfma_f32_16x16x32_bf16 v[220:223], a[188:191], a[92:95], v[220:223]
buffer_load_dwordx4 v8, s[16:19], s64 offen offset:1024 lds
v_mfma_f32_16x16x32_bf16 v[216:219], a[180:183], a[92:95], v[216:219]
s_xor_b32 s71, s70, 768
s_add_u32 s71, s68, s71
v_mfma_f32_16x16x32_bf16 v[216:219], a[176:179], a[88:91], v[216:219]
v_mfma_f32_16x16x32_bf16 v[212:215], a[168:171], a[88:91], v[212:215]
ds_read_b64_tr_b16 a[144:145], v13 offset:0
ds_read_b64_tr_b16 a[146:147], v13 offset:512
v_mfma_f32_16x16x32_bf16 v[212:215], a[172:175], a[92:95], v[212:215]
buffer_store_dwordx4 v[28:31], v4, s[24:27], s82 offen offset:3072 sc1
v_mfma_f32_16x16x32_bf16 v[208:211], a[164:167], a[92:95], v[208:211]
s_lshl_b32 s52, s7, 4
v_and_b32 v22, 3, v1
v_lshl_add_u32 v22, v22, 2, s52
v_mfma_f32_16x16x32_bf16 v[208:211], a[160:163], a[88:91], v[208:211]
s_add_u32 m0, s73, 0
s_add_u32 s64, s71, 0
ds_read_b128 a[80:83], v9 offset:4096
v_mfma_f32_16x16x32_bf16 v[224:227], a[160:163], a[96:99], v[224:227]
buffer_load_dword v23, v22, s[40:43], 0 offen sc1
v_mfma_f32_16x16x32_bf16 v[224:227], a[164:167], a[100:103], v[224:227]
buffer_load_dwordx4 v5, s[8:11], s64 offen lds
v_mfma_f32_16x16x32_bf16 v[228:231], a[172:175], a[100:103], v[228:231]
ds_read_b64_tr_b16 a[148:149], v13 offset:8192
ds_read_b64_tr_b16 a[150:151], v13 offset:8704
v_mfma_f32_16x16x32_bf16 v[228:231], a[168:171], a[96:99], v[228:231]
v_mfma_f32_16x16x32_bf16 v[232:235], a[176:179], a[96:99], v[232:235]
v_mfma_f32_16x16x32_bf16 v[232:235], a[180:183], a[100:103], v[232:235]
ds_read_b128 a[84:87], v10 offset:4096
v_mfma_f32_16x16x32_bf16 v[236:239], a[188:191], a[100:103], v[236:239]
v_mfma_f32_16x16x32_bf16 v[236:239], a[184:187], a[96:99], v[236:239]
v_mfma_f32_16x16x32_bf16 v[252:255], a[184:187], a[104:107], v[252:255]
buffer_load_dwordx4 v6, s[8:11], s64 offen offset:1024 lds
v_mfma_f32_16x16x32_bf16 v[252:255], a[188:191], a[108:111], v[252:255]
ds_read_b64_tr_b16 a[152:153], v14 offset:0
ds_read_b64_tr_b16 a[154:155], v14 offset:512
v_mfma_f32_16x16x32_bf16 v[248:251], a[180:183], a[108:111], v[248:251]
v_mfma_f32_16x16x32_bf16 v[248:251], a[176:179], a[104:107], v[248:251]
v_mfma_f32_16x16x32_bf16 v[244:247], a[168:171], a[104:107], v[244:247]
ds_read_b128 a[88:91], v9 offset:6144
v_mfma_f32_16x16x32_bf16 v[244:247], a[172:175], a[108:111], v[244:247]
s_add_u32 m0, s73, 2048
s_add_u32 s64, s71, 16384
v_mfma_f32_16x16x32_bf16 v[240:243], a[164:167], a[108:111], v[240:243]
v_mfma_f32_16x16x32_bf16 v[240:243], a[160:163], a[104:107], v[240:243]
buffer_load_dwordx4 v5, s[8:11], s64 offen lds
v_mfma_f32_16x16x32_bf16 a[0:3], a[160:163], a[112:115], a[0:3]
ds_read_b64_tr_b16 a[156:157], v14 offset:8192
ds_read_b64_tr_b16 a[158:159], v14 offset:8704
v_mfma_f32_16x16x32_bf16 a[0:3], a[164:167], a[116:119], a[0:3]
v_mfma_f32_16x16x32_bf16 a[4:7], a[172:175], a[116:119], a[4:7]
ds_read_b128 a[92:95], v10 offset:6144
v_mfma_f32_16x16x32_bf16 a[4:7], a[168:171], a[112:115], a[4:7]
v_mfma_f32_16x16x32_bf16 a[8:11], a[176:179], a[112:115], a[8:11]
v_mfma_f32_16x16x32_bf16 a[8:11], a[180:183], a[116:119], a[8:11]
v_mfma_f32_16x16x32_bf16 a[12:15], a[188:191], a[116:119], a[12:15]
buffer_load_dwordx4 v6, s[8:11], s64 offen offset:1024 lds
v_mfma_f32_16x16x32_bf16 a[12:15], a[184:187], a[112:115], a[12:15]
v_mfma_f32_16x16x32_bf16 a[28:31], a[184:187], a[120:123], a[28:31]
v_mfma_f32_16x16x32_bf16 a[28:31], a[188:191], a[124:127], a[28:31]
v_mfma_f32_16x16x32_bf16 a[24:27], a[180:183], a[124:127], a[24:27]
v_mfma_f32_16x16x32_bf16 a[24:27], a[176:179], a[120:123], a[24:27]
v_mfma_f32_16x16x32_bf16 a[20:23], a[168:171], a[120:123], a[20:23]
v_mfma_f32_16x16x32_bf16 a[20:23], a[172:175], a[124:127], a[20:23]
v_mfma_f32_16x16x32_bf16 a[16:19], a[164:167], a[124:127], a[16:19]
v_mfma_f32_16x16x32_bf16 a[16:19], a[160:163], a[120:123], a[16:19]
s_waitcnt lgkmcnt(0)
v_mfma_f32_16x16x32_bf16 v[32:35], a[64:67], a[128:131], v[32:35]
s_waitcnt vmcnt(31)
v_mfma_f32_16x16x32_bf16 v[32:35], a[68:71], a[132:135], v[32:35]
s_barrier
v_mfma_f32_16x16x32_bf16 v[40:43], a[68:71], a[140:143], v[40:43]
ds_read_b128 a[96:99], v9 offset:8192
v_mfma_f32_16x16x32_bf16 v[40:43], a[64:67], a[136:139], v[40:43]
s_xor_b32 s76, s75, 3145728
s_add_u32 s76, s74, s76
v_mfma_f32_16x16x32_bf16 v[48:51], a[64:67], a[144:147], v[48:51]
s_add_u32 m0, s77, 0
s_add_u32 s64, s76, 0
v_mfma_f32_16x16x32_bf16 v[48:51], a[68:71], a[148:151], v[48:51]
buffer_load_dwordx4 v7, s[56:59], s64 offen lds
v_mfma_f32_16x16x32_bf16 v[56:59], a[68:71], a[156:159], v[56:59]
ds_read_b128 a[100:103], v10 offset:8192
v_mfma_f32_16x16x32_bf16 v[56:59], a[64:67], a[152:155], v[56:59]
v_mfma_f32_16x16x32_bf16 v[60:63], a[72:75], a[152:155], v[60:63]
ds_read_b128 a[104:107], v9 offset:10240
v_mfma_f32_16x16x32_bf16 v[60:63], a[76:79], a[156:159], v[60:63]
v_mfma_f32_16x16x32_bf16 v[52:55], a[76:79], a[148:151], v[52:55]
v_mfma_f32_16x16x32_bf16 v[52:55], a[72:75], a[144:147], v[52:55]
buffer_load_dwordx4 v8, s[56:59], s64 offen offset:1024 lds
v_mfma_f32_16x16x32_bf16 v[44:47], a[72:75], a[136:139], v[44:47]
ds_read_b64_tr_b16 a[160:161], v11 offset:16384
ds_read_b64_tr_b16 a[162:163], v11 offset:16896
v_mfma_f32_16x16x32_bf16 v[44:47], a[76:79], a[140:143], v[44:47]
v_mfma_f32_16x16x32_bf16 v[36:39], a[76:79], a[132:135], v[36:39]
v_mfma_f32_16x16x32_bf16 v[36:39], a[72:75], a[128:131], v[36:39]
ds_read_b128 a[108:111], v10 offset:10240
v_mfma_f32_16x16x32_bf16 v[64:67], a[80:83], a[128:131], v[64:67]
s_add_u32 m0, s77, 2048
s_add_u32 s64, s76, 131072
s_waitcnt vmcnt(6)
v_mfma_f32_16x16x32_bf16 v[64:67], a[84:87], a[132:135], v[64:67]
v_cmp_gt_u32 vcc, 1, v23
v_mfma_f32_16x16x32_bf16 v[72:75], a[84:87], a[140:143], v[72:75]
buffer_load_dwordx4 v7, s[56:59], s64 offen lds
v_mfma_f32_16x16x32_bf16 v[72:75], a[80:83], a[136:139], v[72:75]
ds_read_b64_tr_b16 a[164:165], v11 offset:24576
ds_read_b64_tr_b16 a[166:167], v11 offset:25088
v_mfma_f32_16x16x32_bf16 v[80:83], a[80:83], a[144:147], v[80:83]
v_mfma_f32_16x16x32_bf16 v[80:83], a[84:87], a[148:151], v[80:83]
ds_read_b128 a[112:115], v9 offset:12288
v_mfma_f32_16x16x32_bf16 v[88:91], a[84:87], a[156:159], v[88:91]
s_cbranch_vccnz CK_Z
CK_Z_R:
v_mfma_f32_16x16x32_bf16 v[88:91], a[80:83], a[152:155], v[88:91]
buffer_atomic_add v1, v0, s[24:27], s84 offen offset:0 sc1
v_mfma_f32_16x16x32_bf16 v[92:95], a[88:91], a[152:155], v[92:95]
s_mul_i32 s52, s66, 147456
ds_read_b64_tr_b16 a[168:169], v12 offset:16384
ds_read_b64_tr_b16 a[170:171], v12 offset:16896
v_mfma_f32_16x16x32_bf16 v[92:95], a[92:95], a[156:159], v[92:95]
buffer_load_dwordx4 v8, s[56:59], s64 offen offset:1024 lds
v_mfma_f32_16x16x32_bf16 v[84:87], a[92:95], a[148:151], v[84:87]
s_lshl_b32 s53, s4, 8
s_add_u32 s52, s52, s53
s_lshl2_add_u32 s53, s2, s3
v_mfma_f32_16x16x32_bf16 v[84:87], a[88:91], a[144:147], v[84:87]
s_mul_i32 s53, s53, 2304
v_lshrrev_b32 v16, 1, v1
v_and_b32 v17, 1, v1
v_mfma_f32_16x16x32_bf16 v[76:79], a[88:91], a[136:139], v[76:79]
ds_read_b128 a[116:119], v10 offset:12288
v_lshlrev_b32 v16, 13, v16
v_mfma_f32_16x16x32_bf16 v[76:79], a[92:95], a[140:143], v[76:79]
v_lshl_add_u32 v16, v17, 7, v16
v_mov_b32 v17, 2147418112
v_mfma_f32_16x16x32_bf16 v[68:71], a[92:95], a[132:135], v[68:71]
v_cmp_gt_u32 s[96:97], 18, v1
v_lshlrev_b32 v18, 7, v1
v_mfma_f32_16x16x32_bf16 v[68:71], a[88:91], a[128:131], v[68:71]
s_add_u32 m0, s73, 4096
s_add_u32 s64, s71, 524288
s_waitcnt lgkmcnt(6)
v_mfma_f32_16x16x32_bf16 v[96:99], a[96:99], a[128:131], v[96:99]
ds_read_b64_tr_b16 a[172:173], v12 offset:24576
ds_read_b64_tr_b16 a[174:175], v12 offset:25088
v_mfma_f32_16x16x32_bf16 v[96:99], a[100:103], a[132:135], v[96:99]
buffer_load_dwordx4 v5, s[8:11], s64 offen lds
v_mfma_f32_16x16x32_bf16 v[104:107], a[100:103], a[140:143], v[104:107]
ds_read_b128 a[120:123], v9 offset:14336
v_mov_b32 v29, 0
v_mfma_f32_16x16x32_bf16 v[104:107], a[96:99], a[136:139], v[104:107]
v_mfma_f32_16x16x32_bf16 v[112:115], a[96:99], a[144:147], v[112:115]
v_cndmask_b32 v16, v17, v16, s[96:97]
v_cndmask_b32 v18, v17, v18, s[96:97]
v_mfma_f32_16x16x32_bf16 v[112:115], a[100:103], a[148:151], v[112:115]
ds_read_b64_tr_b16 a[176:177], v13 offset:16384
ds_read_b64_tr_b16 a[178:179], v13 offset:16896
v_mfma_f32_16x16x32_bf16 v[120:123], a[100:103], a[156:159], v[120:123]
buffer_load_dword a253, v18, s[12:15], s53 offen
v_mfma_f32_16x16x32_bf16 v[120:123], a[96:99], a[152:155], v[120:123]
v_mfma_f32_16x16x32_bf16 v[124:127], a[104:107], a[152:155], v[124:127]
buffer_load_dwordx4 v6, s[8:11], s64 offen offset:1024 lds
v_mfma_f32_16x16x32_bf16 v[124:127], a[108:111], a[156:159], v[124:127]
ds_read_b128 a[124:127], v10 offset:14336
v_mfma_f32_16x16x32_bf16 v[116:119], a[108:111], a[148:151], v[116:119]
v_add_u32 v9, 32768, v9
v_add_u32 v10, 32768, v10
v_mfma_f32_16x16x32_bf16 v[116:119], a[104:107], a[144:147], v[116:119]
v_mfma_f32_16x16x32_bf16 v[108:111], a[104:107], a[136:139], v[108:111]
ds_read_b64_tr_b16 a[180:181], v13 offset:24576
ds_read_b64_tr_b16 a[182:183], v13 offset:25088
v_mfma_f32_16x16x32_bf16 v[108:111], a[108:111], a[140:143], v[108:111]
s_add_u32 m0, s73, 6144
s_add_u32 s64, s71, 540672
v_mfma_f32_16x16x32_bf16 v[100:103], a[108:111], a[132:135], v[100:103]
s_waitcnt lgkmcnt(2)
v_mfma_f32_16x16x32_bf16 v[100:103], a[104:107], a[128:131], v[100:103]
buffer_load_dwordx4 v5, s[8:11], s64 offen lds
v_mfma_f32_16x16x32_bf16 v[128:131], a[112:115], a[128:131], v[128:131]
ds_read_b64_tr_b16 a[184:185], v14 offset:16384
ds_read_b64_tr_b16 a[186:187], v14 offset:16896
v_mfma_f32_16x16x32_bf16 v[128:131], a[116:119], a[132:135], v[128:131]
v_mfma_f32_16x16x32_bf16 v[136:139], a[116:119], a[140:143], v[136:139]
ds_read_b64_tr_b16 a[188:189], v14 offset:24576
ds_read_b64_tr_b16 a[190:191], v14 offset:25088
v_mfma_f32_16x16x32_bf16 v[136:139], a[112:115], a[136:139], v[136:139]
v_mfma_f32_16x16x32_bf16 v[144:147], a[112:115], a[144:147], v[144:147]
v_mfma_f32_16x16x32_bf16 v[144:147], a[116:119], a[148:151], v[144:147]
v_mfma_f32_16x16x32_bf16 v[152:155], a[116:119], a[156:159], v[152:155]
buffer_load_dwordx4 v6, s[8:11], s64 offen offset:1024 lds
v_mfma_f32_16x16x32_bf16 v[152:155], a[112:115], a[152:155], v[152:155]
v_mfma_f32_16x16x32_bf16 v[156:159], a[120:123], a[152:155], v[156:159]
v_mfma_f32_16x16x32_bf16 v[156:159], a[124:127], a[156:159], v[156:159]
v_mfma_f32_16x16x32_bf16 v[148:151], a[124:127], a[148:151], v[148:151]
v_mfma_f32_16x16x32_bf16 v[148:151], a[120:123], a[144:147], v[148:151]
v_mfma_f32_16x16x32_bf16 v[140:143], a[120:123], a[136:139], v[140:143]
v_mfma_f32_16x16x32_bf16 v[140:143], a[124:127], a[140:143], v[140:143]
v_mfma_f32_16x16x32_bf16 v[132:135], a[124:127], a[132:135], v[132:135]
v_mfma_f32_16x16x32_bf16 v[132:135], a[120:123], a[128:131], v[132:135]
s_waitcnt lgkmcnt(0)
v_mfma_f32_16x16x32_bf16 v[160:163], a[160:163], a[64:67], v[160:163]
s_waitcnt vmcnt(23)
v_mfma_f32_16x16x32_bf16 v[160:163], a[164:167], a[68:71], v[160:163]
s_barrier
v_mfma_f32_16x16x32_bf16 v[164:167], a[172:175], a[68:71], v[164:167]
ds_read_b64_tr_b16 a[128:129], v11 offset:32768
ds_read_b64_tr_b16 a[130:131], v11 offset:33280
v_mfma_f32_16x16x32_bf16 v[164:167], a[168:171], a[64:67], v[164:167]
s_add_u32 m0, s77, 16384
s_add_u32 s64, s76, 0
v_mfma_f32_16x16x32_bf16 v[168:171], a[176:179], a[64:67], v[168:171]
buffer_load_dwordx4 v7, s[16:19], s64 offen lds
v_mfma_f32_16x16x32_bf16 v[168:171], a[180:183], a[68:71], v[168:171]
buffer_load_dword a252, v16, s[20:23], s52 offen
v_mfma_f32_16x16x32_bf16 v[172:175], a[188:191], a[68:71], v[172:175]
s_add_u32 s52, s52, 73728
v_mfma_f32_16x16x32_bf16 v[172:175], a[184:187], a[64:67], v[172:175]
ds_read_b128 a[64:67], v9 offset:0
v_mfma_f32_16x16x32_bf16 v[188:191], a[184:187], a[72:75], v[188:191]
ds_read_b64_tr_b16 a[132:133], v11 offset:40960
ds_read_b64_tr_b16 a[134:135], v11 offset:41472
v_mfma_f32_16x16x32_bf16 v[188:191], a[188:191], a[76:79], v[188:191]
v_mfma_f32_16x16x32_bf16 v[184:187], a[180:183], a[76:79], v[184:187]
v_mfma_f32_16x16x32_bf16 v[184:187], a[176:179], a[72:75], v[184:187]
buffer_load_dwordx4 v8, s[16:19], s64 offen offset:1024 lds
v_mfma_f32_16x16x32_bf16 v[180:183], a[168:171], a[72:75], v[180:183]
ds_read_b128 a[68:71], v10 offset:0
v_mfma_f32_16x16x32_bf16 v[180:183], a[172:175], a[76:79], v[180:183]
L_PAD2:
s_cbranch_execz L_PAD6
v_mfma_f32_16x16x32_bf16 v[176:179], a[164:167], a[76:79], v[176:179]
v_mfma_f32_16x16x32_bf16 v[176:179], a[160:163], a[72:75], v[176:179]
ds_read_b64_tr_b16 a[136:137], v12 offset:32768
ds_read_b64_tr_b16 a[138:139], v12 offset:33280
v_mfma_f32_16x16x32_bf16 v[192:195], a[160:163], a[80:83], v[192:195]
s_add_u32 m0, s77, 18432
s_add_u32 s64, s76, 131072
v_mfma_f32_16x16x32_bf16 v[192:195], a[164:167], a[84:87], v[192:195]
v_mfma_f32_16x16x32_bf16 v[196:199], a[172:175], a[84:87], v[196:199]
buffer_load_dwordx4 v7, s[16:19], s64 offen lds
v_mfma_f32_16x16x32_bf16 v[196:199], a[168:171], a[80:83], v[196:199]
ds_read_b128 a[72:75], v9 offset:2048
v_mfma_f32_16x16x32_bf16 v[200:203], a[176:179], a[80:83], v[200:203]
v_mfma_f32_16x16x32_bf16 v[200:203], a[180:183], a[84:87], v[200:203]
ds_read_b64_tr_b16 a[140:141], v12 offset:40960
ds_read_b64_tr_b16 a[142:143], v12 offset:41472
v_mfma_f32_16x16x32_bf16 v[204:207], a[188:191], a[84:87], v[204:207]
v_mfma_f32_16x16x32_bf16 v[204:207], a[184:187], a[80:83], v[204:207]
v_mfma_f32_16x16x32_bf16 v[220:223], a[184:187], a[88:91], v[220:223]
ds_read_b128 a[76:79], v10 offset:2048
v_mfma_f32_16x16x32_bf16 v[220:223], a[188:191], a[92:95], v[220:223]
buffer_load_dwordx4 v8, s[16:19], s64 offen offset:1024 lds
v_mfma_f32_16x16x32_bf16 v[216:219], a[180:183], a[92:95], v[216:219]
s_xor_b32 s71, s70, 896
s_add_u32 s71, s68, s71
v_mfma_f32_16x16x32_bf16 v[216:219], a[176:179], a[88:91], v[216:219]
v_mfma_f32_16x16x32_bf16 v[212:215], a[168:171], a[88:91], v[212:215]
ds_read_b64_tr_b16 a[144:145], v13 offset:32768
ds_read_b64_tr_b16 a[146:147], v13 offset:33280
v_mfma_f32_16x16x32_bf16 v[212:215], a[172:175], a[92:95], v[212:215]
v_mfma_f32_16x16x32_bf16 v[208:211], a[164:167], a[92:95], v[208:211]
v_mfma_f32_16x16x32_bf16 v[208:211], a[160:163], a[88:91], v[208:211]
s_add_u32 m0, s73, 32768
s_add_u32 s64, s71, 0
ds_read_b128 a[80:83], v9 offset:4096
v_mfma_f32_16x16x32_bf16 v[224:227], a[160:163], a[96:99], v[224:227]
v_mfma_f32_16x16x32_bf16 v[224:227], a[164:167], a[100:103], v[224:227]
buffer_load_dwordx4 v5, s[8:11], s64 offen lds
v_mfma_f32_16x16x32_bf16 v[228:231], a[172:175], a[100:103], v[228:231]
ds_read_b64_tr_b16 a[148:149], v13 offset:40960
ds_read_b64_tr_b16 a[150:151], v13 offset:41472
v_mfma_f32_16x16x32_bf16 v[228:231], a[168:171], a[96:99], v[228:231]
v_mfma_f32_16x16x32_bf16 v[232:235], a[176:179], a[96:99], v[232:235]
v_mfma_f32_16x16x32_bf16 v[232:235], a[180:183], a[100:103], v[232:235]
ds_read_b128 a[84:87], v10 offset:4096
v_mfma_f32_16x16x32_bf16 v[236:239], a[188:191], a[100:103], v[236:239]
v_mfma_f32_16x16x32_bf16 v[236:239], a[184:187], a[96:99], v[236:239]
v_mfma_f32_16x16x32_bf16 v[252:255], a[184:187], a[104:107], v[252:255]
buffer_load_dwordx4 v6, s[8:11], s64 offen offset:1024 lds
v_mfma_f32_16x16x32_bf16 v[252:255], a[188:191], a[108:111], v[252:255]
ds_read_b64_tr_b16 a[152:153], v14 offset:32768
ds_read_b64_tr_b16 a[154:155], v14 offset:33280
v_mfma_f32_16x16x32_bf16 v[248:251], a[180:183], a[108:111], v[248:251]
v_mfma_f32_16x16x32_bf16 v[248:251], a[176:179], a[104:107], v[248:251]
v_mfma_f32_16x16x32_bf16 v[244:247], a[168:171], a[104:107], v[244:247]
ds_read_b128 a[88:91], v9 offset:6144
v_mfma_f32_16x16x32_bf16 v[244:247], a[172:175], a[108:111], v[244:247]
s_add_u32 m0, s73, 34816
s_add_u32 s64, s71, 16384
v_mfma_f32_16x16x32_bf16 v[240:243], a[164:167], a[108:111], v[240:243]
v_mfma_f32_16x16x32_bf16 v[240:243], a[160:163], a[104:107], v[240:243]
buffer_load_dwordx4 v5, s[8:11], s64 offen lds
v_mfma_f32_16x16x32_bf16 a[0:3], a[160:163], a[112:115], a[0:3]
ds_read_b64_tr_b16 a[156:157], v14 offset:40960
ds_read_b64_tr_b16 a[158:159], v14 offset:41472
v_mfma_f32_16x16x32_bf16 a[0:3], a[164:167], a[116:119], a[0:3]
v_mfma_f32_16x16x32_bf16 a[4:7], a[172:175], a[116:119], a[4:7]
ds_read_b128 a[92:95], v10 offset:6144
v_mfma_f32_16x16x32_bf16 a[4:7], a[168:171], a[112:115], a[4:7]
v_mfma_f32_16x16x32_bf16 a[8:11], a[176:179], a[112:115], a[8:11]
v_mfma_f32_16x16x32_bf16 a[8:11], a[180:183], a[116:119], a[8:11]
v_mfma_f32_16x16x32_bf16 a[12:15], a[188:191], a[116:119], a[12:15]
buffer_load_dwordx4 v6, s[8:11], s64 offen offset:1024 lds
v_mfma_f32_16x16x32_bf16 a[12:15], a[184:187], a[112:115], a[12:15]
v_mfma_f32_16x16x32_bf16 a[28:31], a[184:187], a[120:123], a[28:31]
v_mfma_f32_16x16x32_bf16 a[28:31], a[188:191], a[124:127], a[28:31]
v_mfma_f32_16x16x32_bf16 a[24:27], a[180:183], a[124:127], a[24:27]
v_mfma_f32_16x16x32_bf16 a[24:27], a[176:179], a[120:123], a[24:27]
v_mfma_f32_16x16x32_bf16 a[20:23], a[168:171], a[120:123], a[20:23]
v_mfma_f32_16x16x32_bf16 a[20:23], a[172:175], a[124:127], a[20:23]
v_mfma_f32_16x16x32_bf16 a[16:19], a[164:167], a[124:127], a[16:19]
v_mfma_f32_16x16x32_bf16 a[16:19], a[160:163], a[120:123], a[16:19]
s_waitcnt lgkmcnt(0)
v_mfma_f32_16x16x32_bf16 v[32:35], a[64:67], a[128:131], v[32:35]
s_waitcnt vmcnt(25)
v_mfma_f32_16x16x32_bf16 v[32:35], a[68:71], a[132:135], v[32:35]
s_barrier
v_mfma_f32_16x16x32_bf16 v[40:43], a[68:71], a[140:143], v[40:43]
ds_read_b128 a[96:99], v9 offset:8192
v_mfma_f32_16x16x32_bf16 v[40:43], a[64:67], a[136:139], v[40:43]
s_xor_b32 s76, s75, 3670016
s_add_u32 s76, s74, s76
v_mfma_f32_16x16x32_bf16 v[48:51], a[64:67], a[144:147], v[48:51]
s_add_u32 m0, s77, 32768
s_add_u32 s64, s76, 0
v_mfma_f32_16x16x32_bf16 v[48:51], a[68:71], a[148:151], v[48:51]
buffer_load_dwordx4 v7, s[56:59], s64 offen lds
v_mfma_f32_16x16x32_bf16 v[56:59], a[68:71], a[156:159], v[56:59]
ds_read_b128 a[100:103], v10 offset:8192
v_mfma_f32_16x16x32_bf16 v[56:59], a[64:67], a[152:155], v[56:59]
buffer_load_dword a252, v16, s[20:23], s52 offen
v_mfma_f32_16x16x32_bf16 v[60:63], a[72:75], a[152:155], v[60:63]
s_lshr_b32 s52, s2, 1
s_lshl2_add_u32 s52, s52, s3
ds_read_b128 a[104:107], v9 offset:10240
v_mfma_f32_16x16x32_bf16 v[60:63], a[76:79], a[156:159], v[60:63]
s_mul_i32 s52, s52, 9216
s_and_b32 s53, s2, 1
s_lshl_b32 s53, s53, 9
v_mfma_f32_16x16x32_bf16 v[52:55], a[76:79], a[148:151], v[52:55]
s_add_u32 s52, s52, s53
s_lshl2_add_u32 s53, s2, s3
s_mul_i32 s53, s53, 768
v_mfma_f32_16x16x32_bf16 v[52:55], a[72:75], a[144:147], v[52:55]
buffer_load_dwordx4 v8, s[56:59], s64 offen offset:1024 lds
v_mfma_f32_16x16x32_bf16 v[44:47], a[72:75], a[136:139], v[44:47]
ds_read_b64_tr_b16 a[160:161], v11 offset:49152
ds_read_b64_tr_b16 a[162:163], v11 offset:49664
v_mfma_f32_16x16x32_bf16 v[44:47], a[76:79], a[140:143], v[44:47]
v_cmp_gt_u32 s[96:97], 40, v1
v_and_b32 v16, 7, v1
v_mfma_f32_16x16x32_bf16 v[36:39], a[76:79], a[132:135], v[36:39]
v_mul_u32_u24 v16, 1152, v16
v_lshrrev_b32 v19, 3, v1
v_mfma_f32_16x16x32_bf16 v[36:39], a[72:75], a[128:131], v[36:39]
ds_read_b128 a[108:111], v10 offset:10240
v_lshl_add_u32 v16, v19, 7, v16
v_mfma_f32_16x16x32_bf16 v[64:67], a[80:83], a[128:131], v[64:67]
s_add_u32 m0, s77, 34816
s_add_u32 s64, s76, 131072
v_cndmask_b32 v16, v17, v16, s[96:97]
v_mfma_f32_16x16x32_bf16 v[64:67], a[84:87], a[132:135], v[64:67]
v_cmp_gt_u32 s[96:97], 6, v1
v_mfma_f32_16x16x32_bf16 v[72:75], a[84:87], a[140:143], v[72:75]
buffer_load_dwordx4 v7, s[56:59], s64 offen lds
v_mfma_f32_16x16x32_bf16 v[72:75], a[80:83], a[136:139], v[72:75]
ds_read_b64_tr_b16 a[164:165], v11 offset:57344
ds_read_b64_tr_b16 a[166:167], v11 offset:57856
v_mfma_f32_16x16x32_bf16 v[80:83], a[80:83], a[144:147], v[80:83]
v_cndmask_b32 v18, v17, v18, s[96:97]
v_mfma_f32_16x16x32_bf16 v[80:83], a[84:87], a[148:151], v[80:83]
ds_read_b128 a[112:115], v9 offset:12288
v_mfma_f32_16x16x32_bf16 v[88:91], a[84:87], a[156:159], v[88:91]
v_mfma_f32_16x16x32_bf16 v[88:91], a[80:83], a[152:155], v[88:91]
v_mfma_f32_16x16x32_bf16 v[92:95], a[88:91], a[152:155], v[92:95]
ds_read_b64_tr_b16 a[168:169], v12 offset:49152
ds_read_b64_tr_b16 a[170:171], v12 offset:49664
v_mfma_f32_16x16x32_bf16 v[92:95], a[92:95], a[156:159], v[92:95]
buffer_load_dwordx4 v8, s[56:59], s64 offen offset:1024 lds
v_mfma_f32_16x16x32_bf16 v[84:87], a[92:95], a[148:151], v[84:87]
v_mfma_f32_16x16x32_bf16 v[84:87], a[88:91], a[144:147], v[84:87]
v_mfma_f32_16x16x32_bf16 v[76:79], a[88:91], a[136:139], v[76:79]
ds_read_b128 a[116:119], v10 offset:12288
v_mfma_f32_16x16x32_bf16 v[76:79], a[92:95], a[140:143], v[76:79]
v_mfma_f32_16x16x32_bf16 v[68:71], a[92:95], a[132:135], v[68:71]
v_mfma_f32_16x16x32_bf16 v[68:71], a[88:91], a[128:131], v[68:71]
s_add_u32 m0, s73, 36864
s_add_u32 s64, s71, 524288
s_waitcnt lgkmcnt(6)
v_mfma_f32_16x16x32_bf16 v[96:99], a[96:99], a[128:131], v[96:99]
ds_read_b64_tr_b16 a[172:173], v12 offset:57344
ds_read_b64_tr_b16 a[174:175], v12 offset:57856
v_mfma_f32_16x16x32_bf16 v[96:99], a[100:103], a[132:135], v[96:99]
buffer_load_dwordx4 v5, s[8:11], s64 offen lds
v_mfma_f32_16x16x32_bf16 v[104:107], a[100:103], a[140:143], v[104:107]
ds_read_b128 a[120:123], v9 offset:14336
v_mfma_f32_16x16x32_bf16 v[104:107], a[96:99], a[136:139], v[104:107]
v_mfma_f32_16x16x32_bf16 v[112:115], a[96:99], a[144:147], v[112:115]
v_mfma_f32_16x16x32_bf16 v[112:115], a[100:103], a[148:151], v[112:115]
ds_read_b64_tr_b16 a[176:177], v13 offset:49152
ds_read_b64_tr_b16 a[178:179], v13 offset:49664
v_mfma_f32_16x16x32_bf16 v[120:123], a[100:103], a[156:159], v[120:123]
v_mfma_f32_16x16x32_bf16 v[120:123], a[96:99], a[152:155], v[120:123]
v_mfma_f32_16x16x32_bf16 v[124:127], a[104:107], a[152:155], v[124:127]
buffer_load_dwordx4 v6, s[8:11], s64 offen offset:1024 lds
v_mfma_f32_16x16x32_bf16 v[124:127], a[108:111], a[156:159], v[124:127]
ds_read_b128 a[124:127], v10 offset:14336
v_mfma_f32_16x16x32_bf16 v[116:119], a[108:111], a[148:151], v[116:119]
v_add_u32 v9, -65536, v9
v_add_u32 v10, -65536, v10
v_mfma_f32_16x16x32_bf16 v[116:119], a[104:107], a[144:147], v[116:119]
buffer_load_dword v30, v29, s[24:27], s89 offen sc1
v_mfma_f32_16x16x32_bf16 v[108:111], a[104:107], a[136:139], v[108:111]
ds_read_b64_tr_b16 a[180:181], v13 offset:57344
ds_read_b64_tr_b16 a[182:183], v13 offset:57856
v_mfma_f32_16x16x32_bf16 v[108:111], a[108:111], a[140:143], v[108:111]
s_add_u32 m0, s73, 38912
s_add_u32 s64, s71, 540672
v_mfma_f32_16x16x32_bf16 v[100:103], a[108:111], a[132:135], v[100:103]
s_waitcnt lgkmcnt(2)
v_mfma_f32_16x16x32_bf16 v[100:103], a[104:107], a[128:131], v[100:103]
buffer_load_dwordx4 v5, s[8:11], s64 offen lds
v_mfma_f32_16x16x32_bf16 v[128:131], a[112:115], a[128:131], v[128:131]
ds_read_b64_tr_b16 a[184:185], v14 offset:49152
ds_read_b64_tr_b16 a[186:187], v14 offset:49664
v_mfma_f32_16x16x32_bf16 v[128:131], a[116:119], a[132:135], v[128:131]
v_mfma_f32_16x16x32_bf16 v[136:139], a[116:119], a[140:143], v[136:139]
ds_read_b64_tr_b16 a[188:189], v14 offset:57344
ds_read_b64_tr_b16 a[190:191], v14 offset:57856
v_mfma_f32_16x16x32_bf16 v[136:139], a[112:115], a[136:139], v[136:139]
v_mfma_f32_16x16x32_bf16 v[144:147], a[112:115], a[144:147], v[144:147]
v_mfma_f32_16x16x32_bf16 v[144:147], a[116:119], a[148:151], v[144:147]
v_mfma_f32_16x16x32_bf16 v[152:155], a[116:119], a[156:159], v[152:155]
buffer_load_dwordx4 v6, s[8:11], s64 offen offset:1024 lds
v_mfma_f32_16x16x32_bf16 v[152:155], a[112:115], a[152:155], v[152:155]
v_mfma_f32_16x16x32_bf16 v[156:159], a[120:123], a[152:155], v[156:159]
v_mfma_f32_16x16x32_bf16 v[156:159], a[124:127], a[156:159], v[156:159]
v_mfma_f32_16x16x32_bf16 v[148:151], a[124:127], a[148:151], v[148:151]
v_mfma_f32_16x16x32_bf16 v[148:151], a[120:123], a[144:147], v[148:151]
v_mfma_f32_16x16x32_bf16 v[140:143], a[120:123], a[136:139], v[140:143]
v_mfma_f32_16x16x32_bf16 v[140:143], a[124:127], a[140:143], v[140:143]
v_mfma_f32_16x16x32_bf16 v[132:135], a[124:127], a[132:135], v[132:135]
v_mfma_f32_16x16x32_bf16 v[132:135], a[120:123], a[128:131], v[132:135]
s_waitcnt lgkmcnt(0)
v_mfma_f32_16x16x32_bf16 v[160:163], a[160:163], a[64:67], v[160:163]
s_waitcnt vmcnt(19)
v_mfma_f32_16x16x32_bf16 v[160:163], a[164:167], a[68:71], v[160:163]
s_barrier
v_mfma_f32_16x16x32_bf16 v[164:167], a[172:175], a[68:71], v[164:167]
ds_read_b64_tr_b16 a[128:129], v11 offset:0
ds_read_b64_tr_b16 a[130:131], v11 offset:512
v_mfma_f32_16x16x32_bf16 v[164:167], a[168:171], a[64:67], v[164:167]
s_add_u32 m0, s77, 49152
s_add_u32 s64, s76, 0
v_mfma_f32_16x16x32_bf16 v[168:171], a[176:179], a[64:67], v[168:171]
buffer_load_dwordx4 v7, s[16:19], s64 offen lds
v_mfma_f32_16x16x32_bf16 v[168:171], a[180:183], a[68:71], v[168:171]
v_mfma_f32_16x16x32_bf16 v[172:175], a[188:191], a[68:71], v[172:175]
v_mfma_f32_16x16x32_bf16 v[172:175], a[184:187], a[64:67], v[172:175]
ds_read_b128 a[64:67], v9 offset:0
v_mfma_f32_16x16x32_bf16 v[188:191], a[184:187], a[72:75], v[188:191]
ds_read_b64_tr_b16 a[132:133], v11 offset:8192
ds_read_b64_tr_b16 a[134:135], v11 offset:8704
v_mfma_f32_16x16x32_bf16 v[188:191], a[188:191], a[76:79], v[188:191]
v_mfma_f32_16x16x32_bf16 v[184:187], a[180:183], a[76:79], v[184:187]
v_mfma_f32_16x16x32_bf16 v[184:187], a[176:179], a[72:75], v[184:187]
buffer_load_dwordx4 v8, s[16:19], s64 offen offset:1024 lds
v_mfma_f32_16x16x32_bf16 v[180:183], a[168:171], a[72:75], v[180:183]
ds_read_b128 a[68:71], v10 offset:0
v_mfma_f32_16x16x32_bf16 v[180:183], a[172:175], a[76:79], v[180:183]
v_mfma_f32_16x16x32_bf16 v[176:179], a[164:167], a[76:79], v[176:179]
v_mfma_f32_16x16x32_bf16 v[176:179], a[160:163], a[72:75], v[176:179]
ds_read_b64_tr_b16 a[136:137], v12 offset:0
ds_read_b64_tr_b16 a[138:139], v12 offset:512
v_mfma_f32_16x16x32_bf16 v[192:195], a[160:163], a[80:83], v[192:195]
s_add_u32 m0, s77, 51200
s_add_u32 s64, s76, 131072
v_mfma_f32_16x16x32_bf16 v[192:195], a[164:167], a[84:87], v[192:195]
v_mfma_f32_16x16x32_bf16 v[196:199], a[172:175], a[84:87], v[196:199]
buffer_load_dwordx4 v7, s[16:19], s64 offen lds
v_mfma_f32_16x16x32_bf16 v[196:199], a[168:171], a[80:83], v[196:199]
ds_read_b128 a[72:75], v9 offset:2048
v_mfma_f32_16x16x32_bf16 v[200:203], a[176:179], a[80:83], v[200:203]
v_mfma_f32_16x16x32_bf16 v[200:203], a[180:183], a[84:87], v[200:203]
ds_read_b64_tr_b16 a[140:141], v12 offset:8192
ds_read_b64_tr_b16 a[142:143], v12 offset:8704
v_mfma_f32_16x16x32_bf16 v[204:207], a[188:191], a[84:87], v[204:207]
v_mfma_f32_16x16x32_bf16 v[204:207], a[184:187], a[80:83], v[204:207]
v_mfma_f32_16x16x32_bf16 v[220:223], a[184:187], a[88:91], v[220:223]
ds_read_b128 a[76:79], v10 offset:2048
v_mfma_f32_16x16x32_bf16 v[220:223], a[188:191], a[92:95], v[220:223]
buffer_load_dwordx4 v8, s[16:19], s64 offen offset:1024 lds
v_mfma_f32_16x16x32_bf16 v[216:219], a[180:183], a[92:95], v[216:219]
s_lshl_b32 s70, s93, 7
s_mul_i32 s68, s66, 36864
s_mul_i32 s69, s67, 36864
v_mfma_f32_16x16x32_bf16 v[216:219], a[176:179], a[88:91], v[216:219]
v_lshrrev_b32 v31, 3, v1
v_lshl_add_u32 v5, v31, 7, v5
v_mfma_f32_16x16x32_bf16 v[212:215], a[168:171], a[88:91], v[212:215]
v_lshl_add_u32 v6, v31, 7, v6
v_add_u32 v6, 1024, v6
v_mfma_f32_16x16x32_bf16 v[212:215], a[172:175], a[92:95], v[212:215]
s_mov_b32 s65, 1024
s_add_u32 s71, s68, s65
s_add_u32 s72, s69, s65
v_mfma_f32_16x16x32_bf16 v[208:211], a[164:167], a[92:95], v[208:211]
ds_read_b64_tr_b16 a[144:145], v13 offset:0
ds_read_b64_tr_b16 a[146:147], v13 offset:512
v_mfma_f32_16x16x32_bf16 v[208:211], a[160:163], a[88:91], v[208:211]
s_add_u32 m0, s73, 65536
s_add_u32 s64, s71, 0
ds_read_b128 a[80:83], v9 offset:4096
v_mfma_f32_16x16x32_bf16 v[224:227], a[160:163], a[96:99], v[224:227]
v_mfma_f32_16x16x32_bf16 v[224:227], a[164:167], a[100:103], v[224:227]
buffer_load_dwordx4 v5, s[12:15], s64 offen lds
v_mfma_f32_16x16x32_bf16 v[228:231], a[172:175], a[100:103], v[228:231]
ds_read_b64_tr_b16 a[148:149], v13 offset:8192
ds_read_b64_tr_b16 a[150:151], v13 offset:8704
v_mfma_f32_16x16x32_bf16 v[228:231], a[168:171], a[96:99], v[228:231]
v_mfma_f32_16x16x32_bf16 v[232:235], a[176:179], a[96:99], v[232:235]
v_mfma_f32_16x16x32_bf16 v[232:235], a[180:183], a[100:103], v[232:235]
ds_read_b128 a[84:87], v10 offset:4096
v_mfma_f32_16x16x32_bf16 v[236:239], a[188:191], a[100:103], v[236:239]
v_mfma_f32_16x16x32_bf16 v[236:239], a[184:187], a[96:99], v[236:239]
v_mfma_f32_16x16x32_bf16 v[252:255], a[184:187], a[104:107], v[252:255]
buffer_load_dwordx4 v6, s[12:15], s64 offen offset:1024 lds
v_mfma_f32_16x16x32_bf16 v[252:255], a[188:191], a[108:111], v[252:255]
ds_read_b64_tr_b16 a[152:153], v14 offset:0
ds_read_b64_tr_b16 a[154:155], v14 offset:512
v_mfma_f32_16x16x32_bf16 v[248:251], a[180:183], a[108:111], v[248:251]
v_mfma_f32_16x16x32_bf16 v[248:251], a[176:179], a[104:107], v[248:251]
v_mfma_f32_16x16x32_bf16 v[244:247], a[168:171], a[104:107], v[244:247]
ds_read_b128 a[88:91], v9 offset:6144
v_mfma_f32_16x16x32_bf16 v[244:247], a[172:175], a[108:111], v[244:247]
s_add_u32 m0, s73, 67584
s_add_u32 s64, s71, 18432
v_mfma_f32_16x16x32_bf16 v[240:243], a[164:167], a[108:111], v[240:243]
v_mfma_f32_16x16x32_bf16 v[240:243], a[160:163], a[104:107], v[240:243]
buffer_load_dwordx4 v5, s[12:15], s64 offen lds
v_mfma_f32_16x16x32_bf16 a[0:3], a[160:163], a[112:115], a[0:3]
ds_read_b64_tr_b16 a[156:157], v14 offset:8192
ds_read_b64_tr_b16 a[158:159], v14 offset:8704
v_mfma_f32_16x16x32_bf16 a[0:3], a[164:167], a[116:119], a[0:3]
v_mfma_f32_16x16x32_bf16 a[4:7], a[172:175], a[116:119], a[4:7]
s_waitcnt vmcnt(9)
ds_read_b128 a[92:95], v10 offset:6144
v_mfma_f32_16x16x32_bf16 a[4:7], a[168:171], a[112:115], a[4:7]
v_cmp_gt_u32 vcc, 18, v30
v_mfma_f32_16x16x32_bf16 a[8:11], a[176:179], a[112:115], a[8:11]
v_mfma_f32_16x16x32_bf16 a[8:11], a[180:183], a[116:119], a[8:11]
v_mfma_f32_16x16x32_bf16 a[12:15], a[188:191], a[116:119], a[12:15]
buffer_load_dwordx4 v6, s[12:15], s64 offen offset:1024 lds
v_mfma_f32_16x16x32_bf16 a[12:15], a[184:187], a[112:115], a[12:15]
v_mfma_f32_16x16x32_bf16 a[28:31], a[184:187], a[120:123], a[28:31]
s_cbranch_vccnz CK_WA
CK_WA_R:
v_mfma_f32_16x16x32_bf16 a[28:31], a[188:191], a[124:127], a[28:31]
v_mfma_f32_16x16x32_bf16 a[24:27], a[180:183], a[124:127], a[24:27]
v_mfma_f32_16x16x32_bf16 a[24:27], a[176:179], a[120:123], a[24:27]
v_mfma_f32_16x16x32_bf16 a[20:23], a[168:171], a[120:123], a[20:23]
v_mfma_f32_16x16x32_bf16 a[20:23], a[172:175], a[124:127], a[20:23]
v_mfma_f32_16x16x32_bf16 a[16:19], a[164:167], a[124:127], a[16:19]
v_mfma_f32_16x16x32_bf16 a[16:19], a[160:163], a[120:123], a[16:19]
s_waitcnt lgkmcnt(0)
v_mfma_f32_16x16x32_bf16 v[32:35], a[64:67], a[128:131], v[32:35]
s_waitcnt vmcnt(22)
v_mfma_f32_16x16x32_bf16 v[32:35], a[68:71], a[132:135], v[32:35]
s_barrier
v_mfma_f32_16x16x32_bf16 v[40:43], a[68:71], a[140:143], v[40:43]
ds_read_b128 a[96:99], v9 offset:8192
v_mfma_f32_16x16x32_bf16 v[40:43], a[64:67], a[136:139], v[40:43]
s_lshl_b32 s77, s3, 11
s_lshl_b32 s74, s3, 9
s_add_u32 s74, s74, s4
v_mfma_f32_16x16x32_bf16 v[48:51], a[64:67], a[144:147], v[48:51]
s_lshl_b32 s74, s74, 8
v_mfma_f32_16x16x32_bf16 v[48:51], a[68:71], a[148:151], v[48:51]
s_mov_b32 s75, 8
s_lshl_b32 s76, s75, 19
s_add_u32 s76, s76, s74
v_mfma_f32_16x16x32_bf16 v[56:59], a[68:71], a[156:159], v[56:59]
s_lshl_b32 s79, s75, 13
s_add_u32 s79, s79, s78
ds_read_b128 a[100:103], v10 offset:8192
v_mfma_f32_16x16x32_bf16 v[56:59], a[64:67], a[152:155], v[56:59]
s_add_u32 m0, s77, 0
s_add_u32 s64, s76, 0
v_mfma_f32_16x16x32_bf16 v[60:63], a[72:75], a[152:155], v[60:63]
buffer_load_dwordx4 v7, s[20:23], s64 offen lds
v_mfma_f32_16x16x32_bf16 v[60:63], a[76:79], a[156:159], v[60:63]
ds_read_b128 a[104:107], v9 offset:10240
v_mfma_f32_16x16x32_bf16 v[52:55], a[76:79], a[148:151], v[52:55]
buffer_load_dword a252, v16, s[32:35], s52 offen
v_mfma_f32_16x16x32_bf16 v[52:55], a[72:75], a[144:147], v[52:55]
ds_read_b64_tr_b16 a[160:161], v11 offset:16384
ds_read_b64_tr_b16 a[162:163], v11 offset:16896
v_mfma_f32_16x16x32_bf16 v[44:47], a[72:75], a[136:139], v[44:47]
buffer_load_dwordx4 v8, s[20:23], s64 offen offset:1024 lds
v_mfma_f32_16x16x32_bf16 v[44:47], a[76:79], a[140:143], v[44:47]
buffer_load_dword a253, v18, s[48:51], s53 offen
v_mfma_f32_16x16x32_bf16 v[36:39], a[76:79], a[132:135], v[36:39]
v_and_b32 v18, 1, v1
v_lshlrev_b32 v18, 21, v18
v_mfma_f32_16x16x32_bf16 v[36:39], a[72:75], a[128:131], v[36:39]
ds_read_b128 a[108:111], v10 offset:10240
v_mfma_f32_16x16x32_bf16 v[64:67], a[80:83], a[128:131], v[64:67]
v_mfma_f32_16x16x32_bf16 v[64:67], a[84:87], a[132:135], v[64:67]
v_mfma_f32_16x16x32_bf16 v[72:75], a[84:87], a[140:143], v[72:75]
s_add_u32 m0, s80, 0
s_add_u32 s64, s79, 0
v_mfma_f32_16x16x32_bf16 v[72:75], a[80:83], a[136:139], v[72:75]
ds_read_b64_tr_b16 a[164:165], v11 offset:24576
ds_read_b64_tr_b16 a[166:167], v11 offset:25088
v_mfma_f32_16x16x32_bf16 v[80:83], a[80:83], a[144:147], v[80:83]
buffer_load_dwordx4 v4, s[24:27], s64 offen sc1 lds
v_mfma_f32_16x16x32_bf16 v[80:83], a[84:87], a[148:151], v[80:83]
ds_read_b128 a[112:115], v9 offset:12288
v_mfma_f32_16x16x32_bf16 v[88:91], a[84:87], a[156:159], v[88:91]
v_mfma_f32_16x16x32_bf16 v[88:91], a[80:83], a[152:155], v[88:91]
v_mfma_f32_16x16x32_bf16 v[92:95], a[88:91], a[152:155], v[92:95]
ds_read_b64_tr_b16 a[168:169], v12 offset:16384
ds_read_b64_tr_b16 a[170:171], v12 offset:16896
v_mfma_f32_16x16x32_bf16 v[92:95], a[92:95], a[156:159], v[92:95]
v_mfma_f32_16x16x32_bf16 v[84:87], a[92:95], a[148:151], v[84:87]
s_add_u32 m0, s73, 69632
s_add_u32 s64, s72, 0
v_mfma_f32_16x16x32_bf16 v[84:87], a[88:91], a[144:147], v[84:87]
v_mfma_f32_16x16x32_bf16 v[76:79], a[88:91], a[136:139], v[76:79]
buffer_load_dwordx4 v5, s[12:15], s64 offen lds
v_mfma_f32_16x16x32_bf16 v[76:79], a[92:95], a[140:143], v[76:79]
ds_read_b128 a[116:119], v10 offset:12288
v_mfma_f32_16x16x32_bf16 v[68:71], a[92:95], a[132:135], v[68:71]
v_mfma_f32_16x16x32_bf16 v[68:71], a[88:91], a[128:131], v[68:71]
s_waitcnt lgkmcnt(6)
ds_read_b64_tr_b16 a[172:173], v12 offset:24576
ds_read_b64_tr_b16 a[174:175], v12 offset:25088
v_mfma_f32_16x16x32_bf16 v[96:99], a[96:99], a[128:131], v[96:99]
v_mfma_f32_16x16x32_bf16 v[96:99], a[100:103], a[132:135], v[96:99]
v_mfma_f32_16x16x32_bf16 v[104:107], a[100:103], a[140:143], v[104:107]
ds_read_b128 a[120:123], v9 offset:14336
v_mfma_f32_16x16x32_bf16 v[104:107], a[96:99], a[136:139], v[104:107]
v_mfma_f32_16x16x32_bf16 v[112:115], a[96:99], a[144:147], v[112:115]
v_mfma_f32_16x16x32_bf16 v[112:115], a[100:103], a[148:151], v[112:115]
buffer_load_dwordx4 v6, s[12:15], s64 offen offset:1024 lds
v_mfma_f32_16x16x32_bf16 v[120:123], a[100:103], a[156:159], v[120:123]
ds_read_b64_tr_b16 a[176:177], v13 offset:16384
ds_read_b64_tr_b16 a[178:179], v13 offset:16896
v_mfma_f32_16x16x32_bf16 v[120:123], a[96:99], a[152:155], v[120:123]
v_mfma_f32_16x16x32_bf16 v[124:127], a[104:107], a[152:155], v[124:127]
v_mfma_f32_16x16x32_bf16 v[124:127], a[108:111], a[156:159], v[124:127]
ds_read_b128 a[124:127], v10 offset:14336
v_mfma_f32_16x16x32_bf16 v[116:119], a[108:111], a[148:151], v[116:119]
v_add_u32 v9, 32768, v9
v_add_u32 v10, 32768, v10
v_mfma_f32_16x16x32_bf16 v[116:119], a[104:107], a[144:147], v[116:119]
s_add_u32 m0, s73, 71680
s_add_u32 s64, s72, 18432
v_mfma_f32_16x16x32_bf16 v[108:111], a[104:107], a[136:139], v[108:111]
ds_read_b64_tr_b16 a[180:181], v13 offset:24576
ds_read_b64_tr_b16 a[182:183], v13 offset:25088
v_mfma_f32_16x16x32_bf16 v[108:111], a[108:111], a[140:143], v[108:111]
buffer_load_dwordx4 v5, s[12:15], s64 offen lds
v_mfma_f32_16x16x32_bf16 v[100:103], a[108:111], a[132:135], v[100:103]
v_mfma_f32_16x16x32_bf16 v[100:103], a[104:107], a[128:131], v[100:103]
s_waitcnt lgkmcnt(2)
ds_read_b64_tr_b16 a[184:185], v14 offset:16384
ds_read_b64_tr_b16 a[186:187], v14 offset:16896
v_mfma_f32_16x16x32_bf16 v[128:131], a[112:115], a[128:131], v[128:131]
v_mfma_f32_16x16x32_bf16 v[128:131], a[116:119], a[132:135], v[128:131]
v_mfma_f32_16x16x32_bf16 v[136:139], a[116:119], a[140:143], v[136:139]
ds_read_b64_tr_b16 a[188:189], v14 offset:24576
ds_read_b64_tr_b16 a[190:191], v14 offset:25088
v_mfma_f32_16x16x32_bf16 v[136:139], a[112:115], a[136:139], v[136:139]
v_mfma_f32_16x16x32_bf16 v[144:147], a[112:115], a[144:147], v[144:147]
v_mfma_f32_16x16x32_bf16 v[144:147], a[116:119], a[148:151], v[144:147]
buffer_load_dwordx4 v6, s[12:15], s64 offen offset:1024 lds
v_mfma_f32_16x16x32_bf16 v[152:155], a[116:119], a[156:159], v[152:155]
v_mfma_f32_16x16x32_bf16 v[152:155], a[112:115], a[152:155], v[152:155]
v_mfma_f32_16x16x32_bf16 v[156:159], a[120:123], a[152:155], v[156:159]
v_mfma_f32_16x16x32_bf16 v[156:159], a[124:127], a[156:159], v[156:159]
v_mfma_f32_16x16x32_bf16 v[148:151], a[124:127], a[148:151], v[148:151]
v_mfma_f32_16x16x32_bf16 v[148:151], a[120:123], a[144:147], v[148:151]
v_mfma_f32_16x16x32_bf16 v[140:143], a[120:123], a[136:139], v[140:143]
v_mfma_f32_16x16x32_bf16 v[140:143], a[124:127], a[140:143], v[140:143]
v_mfma_f32_16x16x32_bf16 v[132:135], a[124:127], a[132:135], v[132:135]
v_mfma_f32_16x16x32_bf16 v[132:135], a[120:123], a[128:131], v[132:135]
s_waitcnt lgkmcnt(0)
v_mfma_f32_16x16x32_bf16 v[160:163], a[160:163], a[64:67], v[160:163]
s_waitcnt vmcnt(17)
v_mfma_f32_16x16x32_bf16 v[160:163], a[164:167], a[68:71], v[160:163]
s_barrier
v_mfma_f32_16x16x32_bf16 v[164:167], a[172:175], a[68:71], v[164:167]
ds_read_b64_tr_b16 a[128:129], v11 offset:32768
ds_read_b64_tr_b16 a[130:131], v11 offset:33280
v_mfma_f32_16x16x32_bf16 v[164:167], a[168:171], a[64:67], v[164:167]
s_add_u32 m0, s77, 16384
s_add_u32 s64, s76, 128
v_mfma_f32_16x16x32_bf16 v[168:171], a[176:179], a[64:67], v[168:171]
buffer_load_dwordx4 v7, s[20:23], s64 offen lds
v_mfma_f32_16x16x32_bf16 v[168:171], a[180:183], a[68:71], v[168:171]
buffer_load_dword a253, v18, s[44:47], 0 offen
v_mfma_f32_16x16x32_bf16 v[172:175], a[188:191], a[68:71], v[172:175]
v_mfma_f32_16x16x32_bf16 v[172:175], a[184:187], a[64:67], v[172:175]
ds_read_b128 a[64:67], v9 offset:0
v_mfma_f32_16x16x32_bf16 v[188:191], a[184:187], a[72:75], v[188:191]
ds_read_b64_tr_b16 a[132:133], v11 offset:40960
ds_read_b64_tr_b16 a[134:135], v11 offset:41472
v_mfma_f32_16x16x32_bf16 v[188:191], a[188:191], a[76:79], v[188:191]
v_mfma_f32_16x16x32_bf16 v[184:187], a[180:183], a[76:79], v[184:187]
v_mfma_f32_16x16x32_bf16 v[184:187], a[176:179], a[72:75], v[184:187]
ds_read_b128 a[68:71], v10 offset:0
v_mfma_f32_16x16x32_bf16 v[180:183], a[168:171], a[72:75], v[180:183]
buffer_load_dwordx4 v8, s[20:23], s64 offen offset:1024 lds
v_mfma_f32_16x16x32_bf16 v[180:183], a[172:175], a[76:79], v[180:183]
v_mfma_f32_16x16x32_bf16 v[176:179], a[164:167], a[76:79], v[176:179]
v_mfma_f32_16x16x32_bf16 v[176:179], a[160:163], a[72:75], v[176:179]
ds_read_b64_tr_b16 a[136:137], v12 offset:32768
ds_read_b64_tr_b16 a[138:139], v12 offset:33280
v_mfma_f32_16x16x32_bf16 v[192:195], a[160:163], a[80:83], v[192:195]
v_mfma_f32_16x16x32_bf16 v[192:195], a[164:167], a[84:87], v[192:195]
v_mfma_f32_16x16x32_bf16 v[196:199], a[172:175], a[84:87], v[196:199]
s_add_u32 m0, s80, 16384
s_add_u32 s64, s79, 2048
ds_read_b128 a[72:75], v9 offset:2048
v_mfma_f32_16x16x32_bf16 v[196:199], a[168:171], a[80:83], v[196:199]
v_mfma_f32_16x16x32_bf16 v[200:203], a[176:179], a[80:83], v[200:203]
buffer_load_dwordx4 v4, s[24:27], s64 offen sc1 lds
v_mfma_f32_16x16x32_bf16 v[200:203], a[180:183], a[84:87], v[200:203]
s_xor_b32 s65, s70, 0
s_add_u32 s71, s68, s65
s_add_u32 s72, s69, s65
v_mfma_f32_16x16x32_bf16 v[204:207], a[188:191], a[84:87], v[204:207]
ds_read_b64_tr_b16 a[140:141], v12 offset:40960
ds_read_b64_tr_b16 a[142:143], v12 offset:41472
v_mfma_f32_16x16x32_bf16 v[204:207], a[184:187], a[80:83], v[204:207]
v_mfma_f32_16x16x32_bf16 v[220:223], a[184:187], a[88:91], v[220:223]
ds_read_b128 a[76:79], v10 offset:2048
v_mfma_f32_16x16x32_bf16 v[220:223], a[188:191], a[92:95], v[220:223]
v_mfma_f32_16x16x32_bf16 v[216:219], a[180:183], a[92:95], v[216:219]
s_add_u32 m0, s73, 0
s_add_u32 s64, s71, 0
v_mfma_f32_16x16x32_bf16 v[216:219], a[176:179], a[88:91], v[216:219]
v_mfma_f32_16x16x32_bf16 v[212:215], a[168:171], a[88:91], v[212:215]
buffer_load_dwordx4 v5, s[12:15], s64 offen lds
v_mfma_f32_16x16x32_bf16 v[212:215], a[172:175], a[92:95], v[212:215]
ds_read_b64_tr_b16 a[144:145], v13 offset:32768
ds_read_b64_tr_b16 a[146:147], v13 offset:33280
v_mfma_f32_16x16x32_bf16 v[208:211], a[164:167], a[92:95], v[208:211]
v_mfma_f32_16x16x32_bf16 v[208:211], a[160:163], a[88:91], v[208:211]
ds_read_b128 a[80:83], v9 offset:4096
v_mfma_f32_16x16x32_bf16 v[224:227], a[160:163], a[96:99], v[224:227]
v_mfma_f32_16x16x32_bf16 v[224:227], a[164:167], a[100:103], v[224:227]
v_mfma_f32_16x16x32_bf16 v[228:231], a[172:175], a[100:103], v[228:231]
ds_read_b64_tr_b16 a[148:149], v13 offset:40960
ds_read_b64_tr_b16 a[150:151], v13 offset:41472
v_mfma_f32_16x16x32_bf16 v[228:231], a[168:171], a[96:99], v[228:231]
v_mfma_f32_16x16x32_bf16 v[232:235], a[176:179], a[96:99], v[232:235]
v_mfma_f32_16x16x32_bf16 v[232:235], a[180:183], a[100:103], v[232:235]
buffer_load_dwordx4 v6, s[12:15], s64 offen offset:1024 lds
v_mfma_f32_16x16x32_bf16 v[236:239], a[188:191], a[100:103], v[236:239]
ds_read_b128 a[84:87], v10 offset:4096
v_mfma_f32_16x16x32_bf16 v[236:239], a[184:187], a[96:99], v[236:239]
v_mfma_f32_16x16x32_bf16 v[252:255], a[184:187], a[104:107], v[252:255]
v_mfma_f32_16x16x32_bf16 v[252:255], a[188:191], a[108:111], v[252:255]
ds_read_b64_tr_b16 a[152:153], v14 offset:32768
ds_read_b64_tr_b16 a[154:155], v14 offset:33280
v_mfma_f32_16x16x32_bf16 v[248:251], a[180:183], a[108:111], v[248:251]
v_mfma_f32_16x16x32_bf16 v[248:251], a[176:179], a[104:107], v[248:251]
s_add_u32 m0, s73, 2048
s_add_u32 s64, s71, 18432
v_mfma_f32_16x16x32_bf16 v[244:247], a[168:171], a[104:107], v[244:247]
L_PAD3:
s_cbranch_execz L_PAD7
ds_read_b128 a[88:91], v9 offset:6144
v_mfma_f32_16x16x32_bf16 v[244:247], a[172:175], a[108:111], v[244:247]
buffer_load_dwordx4 v5, s[12:15], s64 offen lds
v_mfma_f32_16x16x32_bf16 v[240:243], a[164:167], a[108:111], v[240:243]
v_mfma_f32_16x16x32_bf16 v[240:243], a[160:163], a[104:107], v[240:243]
ds_read_b64_tr_b16 a[156:157], v14 offset:40960
ds_read_b64_tr_b16 a[158:159], v14 offset:41472
v_mfma_f32_16x16x32_bf16 a[0:3], a[160:163], a[112:115], a[0:3]
v_mfma_f32_16x16x32_bf16 a[0:3], a[164:167], a[116:119], a[0:3]
v_mfma_f32_16x16x32_bf16 a[4:7], a[172:175], a[116:119], a[4:7]
ds_read_b128 a[92:95], v10 offset:6144
v_mfma_f32_16x16x32_bf16 a[4:7], a[168:171], a[112:115], a[4:7]
v_mfma_f32_16x16x32_bf16 a[8:11], a[176:179], a[112:115], a[8:11]
v_mfma_f32_16x16x32_bf16 a[8:11], a[180:183], a[116:119], a[8:11]
buffer_load_dwordx4 v6, s[12:15], s64 offen offset:1024 lds
v_mfma_f32_16x16x32_bf16 a[12:15], a[188:191], a[116:119], a[12:15]
v_mfma_f32_16x16x32_bf16 a[12:15], a[184:187], a[112:115], a[12:15]
v_mfma_f32_16x16x32_bf16 a[28:31], a[184:187], a[120:123], a[28:31]
v_mfma_f32_16x16x32_bf16 a[28:31], a[188:191], a[124:127], a[28:31]
v_mfma_f32_16x16x32_bf16 a[24:27], a[180:183], a[124:127], a[24:27]
v_mfma_f32_16x16x32_bf16 a[24:27], a[176:179], a[120:123], a[24:27]
v_mfma_f32_16x16x32_bf16 a[20:23], a[168:171], a[120:123], a[20:23]
v_mfma_f32_16x16x32_bf16 a[20:23], a[172:175], a[124:127], a[20:23]
v_mfma_f32_16x16x32_bf16 a[16:19], a[164:167], a[124:127], a[16:19]
v_mfma_f32_16x16x32_bf16 a[16:19], a[160:163], a[120:123], a[16:19]
s_waitcnt lgkmcnt(0)
v_mfma_f32_16x16x32_bf16 v[32:35], a[64:67], a[128:131], v[32:35]
s_waitcnt vmcnt(21)
v_mfma_f32_16x16x32_bf16 v[32:35], a[68:71], a[132:135], v[32:35]
s_barrier
v_mfma_f32_16x16x32_bf16 v[40:43], a[68:71], a[140:143], v[40:43]
ds_read_b128 a[96:99], v9 offset:8192
v_mfma_f32_16x16x32_bf16 v[40:43], a[64:67], a[136:139], v[40:43]
s_xor_b32 s75, s93, 0
s_lshl_b32 s76, s75, 19
s_add_u32 s76, s76, s74
v_mfma_f32_16x16x32_bf16 v[48:51], a[64:67], a[144:147], v[48:51]
s_lshl_b32 s79, s75, 13
s_add_u32 s79, s79, s78
v_mfma_f32_16x16x32_bf16 v[48:51], a[68:71], a[148:151], v[48:51]
s_add_u32 m0, s77, 32768
s_add_u32 s64, s76, 0
ds_read_b128 a[100:103], v10 offset:8192
v_mfma_f32_16x16x32_bf16 v[56:59], a[68:71], a[156:159], v[56:59]
buffer_load_dwordx4 v7, s[20:23], s64 offen lds
v_mfma_f32_16x16x32_bf16 v[56:59], a[64:67], a[152:155], v[56:59]
v_mfma_f32_16x16x32_bf16 v[60:63], a[72:75], a[152:155], v[60:63]
ds_read_b128 a[104:107], v9 offset:10240
v_mfma_f32_16x16x32_bf16 v[60:63], a[76:79], a[156:159], v[60:63]
v_mfma_f32_16x16x32_bf16 v[52:55], a[76:79], a[148:151], v[52:55]
v_mfma_f32_16x16x32_bf16 v[52:55], a[72:75], a[144:147], v[52:55]
ds_read_b64_tr_b16 a[160:161], v11 offset:49152
ds_read_b64_tr_b16 a[162:163], v11 offset:49664
v_mfma_f32_16x16x32_bf16 v[44:47], a[72:75], a[136:139], v[44:47]
buffer_load_dwordx4 v8, s[20:23], s64 offen offset:1024 lds
v_mfma_f32_16x16x32_bf16 v[44:47], a[76:79], a[140:143], v[44:47]
v_mfma_f32_16x16x32_bf16 v[36:39], a[76:79], a[132:135], v[36:39]
v_mfma_f32_16x16x32_bf16 v[36:39], a[72:75], a[128:131], v[36:39]
ds_read_b128 a[108:111], v10 offset:10240
v_mfma_f32_16x16x32_bf16 v[64:67], a[80:83], a[128:131], v[64:67]
v_mfma_f32_16x16x32_bf16 v[64:67], a[84:87], a[132:135], v[64:67]
v_mfma_f32_16x16x32_bf16 v[72:75], a[84:87], a[140:143], v[72:75]
s_add_u32 m0, s80, 32768
s_add_u32 s64, s79, 0
v_mfma_f32_16x16x32_bf16 v[72:75], a[80:83], a[136:139], v[72:75]
ds_read_b64_tr_b16 a[164:165], v11 offset:57344
ds_read_b64_tr_b16 a[166:167], v11 offset:57856
v_mfma_f32_16x16x32_bf16 v[80:83], a[80:83], a[144:147], v[80:83]
buffer_load_dwordx4 v4, s[24:27], s64 offen sc1 lds
v_mfma_f32_16x16x32_bf16 v[80:83], a[84:87], a[148:151], v[80:83]
ds_read_b128 a[112:115], v9 offset:12288
v_mfma_f32_16x16x32_bf16 v[88:91], a[84:87], a[156:159], v[88:91]
v_cvt_pk_bf16_f32 v32, v32, v33
v_cvt_pk_bf16_f32 v33, v34, v35
v_mfma_f32_16x16x32_bf16 v[88:91], a[80:83], a[152:155], v[88:91]
v_cvt_pk_bf16_f32 v34, v36, v37
v_cvt_pk_bf16_f32 v35, v38, v39
v_mfma_f32_16x16x32_bf16 v[92:95], a[88:91], a[152:155], v[92:95]
ds_read_b64_tr_b16 a[168:169], v12 offset:49152
ds_read_b64_tr_b16 a[170:171], v12 offset:49664
v_mfma_f32_16x16x32_bf16 v[92:95], a[92:95], a[156:159], v[92:95]
v_cvt_pk_bf16_f32 v40, v40, v41
v_cvt_pk_bf16_f32 v41, v42, v43
v_mfma_f32_16x16x32_bf16 v[84:87], a[92:95], a[148:151], v[84:87]
s_add_u32 m0, s73, 4096
s_add_u32 s64, s72, 0
s_lshr_b32 s55, s3, 1
v_mfma_f32_16x16x32_bf16 v[84:87], a[88:91], a[144:147], v[84:87]
s_lshl_b32 s55, s55, 14
s_lshl_b32 s54, s3, 13
s_sub_u32 s55, s54, s55
v_mfma_f32_16x16x32_bf16 v[76:79], a[88:91], a[136:139], v[76:79]
buffer_load_dwordx4 v5, s[12:15], s64 offen lds
v_mfma_f32_16x16x32_bf16 v[76:79], a[92:95], a[140:143], v[76:79]
s_and_b32 s54, s3, 1
s_lshl_b32 s54, s54, 12
ds_read_b128 a[116:119], v10 offset:12288
v_mfma_f32_16x16x32_bf16 v[68:71], a[92:95], a[132:135], v[68:71]
s_add_u32 s53, s88, 0
v_cvt_pk_bf16_f32 v42, v44, v45
v_cvt_pk_bf16_f32 v43, v46, v47
v_mfma_f32_16x16x32_bf16 v[68:71], a[88:91], a[128:131], v[68:71]
s_waitcnt lgkmcnt(6)
ds_read_b64_tr_b16 a[172:173], v12 offset:57344
ds_read_b64_tr_b16 a[174:175], v12 offset:57856
v_mfma_f32_16x16x32_bf16 v[96:99], a[96:99], a[128:131], v[96:99]
buffer_store_dwordx4 v[32:35], v4, s[24:27], s53 offen offset:0 sc1
v_mfma_f32_16x16x32_bf16 v[96:99], a[100:103], a[132:135], v[96:99]
v_cvt_pk_bf16_f32 v48, v48, v49
v_cvt_pk_bf16_f32 v49, v50, v51
v_mfma_f32_16x16x32_bf16 v[104:107], a[100:103], a[140:143], v[104:107]
ds_read_b128 a[120:123], v9 offset:14336
v_cvt_pk_bf16_f32 v50, v52, v53
v_mfma_f32_16x16x32_bf16 v[104:107], a[96:99], a[136:139], v[104:107]
v_cvt_pk_bf16_f32 v51, v54, v55
v_cvt_pk_bf16_f32 v56, v56, v57
v_mfma_f32_16x16x32_bf16 v[112:115], a[96:99], a[144:147], v[112:115]
v_cvt_pk_bf16_f32 v57, v58, v59
v_cvt_pk_bf16_f32 v58, v60, v61
v_mfma_f32_16x16x32_bf16 v[112:115], a[100:103], a[148:151], v[112:115]
buffer_load_dwordx4 v6, s[12:15], s64 offen offset:1024 lds
v_mfma_f32_16x16x32_bf16 v[120:123], a[100:103], a[156:159], v[120:123]
ds_read_b64_tr_b16 a[176:177], v13 offset:49152
ds_read_b64_tr_b16 a[178:179], v13 offset:49664
v_mfma_f32_16x16x32_bf16 v[120:123], a[96:99], a[152:155], v[120:123]
v_cvt_pk_bf16_f32 v59, v62, v63
v_cvt_pk_bf16_f32 v64, v64, v65
v_mfma_f32_16x16x32_bf16 v[124:127], a[104:107], a[152:155], v[124:127]
v_cvt_pk_bf16_f32 v65, v66, v67
v_cvt_pk_bf16_f32 v66, v68, v69
v_mfma_f32_16x16x32_bf16 v[124:127], a[108:111], a[156:159], v[124:127]
ds_read_b128 a[124:127], v10 offset:14336
v_cvt_pk_bf16_f32 v67, v70, v71
v_mfma_f32_16x16x32_bf16 v[116:119], a[108:111], a[148:151], v[116:119]
v_add_u32 v9, 32768, v9
v_add_u32 v10, 32768, v10
v_mfma_f32_16x16x32_bf16 v[116:119], a[104:107], a[144:147], v[116:119]
s_add_u32 m0, s73, 6144
s_add_u32 s64, s72, 18432
v_cvt_pk_bf16_f32 v72, v72, v73
v_mfma_f32_16x16x32_bf16 v[108:111], a[104:107], a[136:139], v[108:111]
ds_read_b64_tr_b16 a[180:181], v13 offset:57344
ds_read_b64_tr_b16 a[182:183], v13 offset:57856
v_mfma_f32_16x16x32_bf16 v[108:111], a[108:111], a[140:143], v[108:111]
buffer_load_dwordx4 v5, s[12:15], s64 offen lds
v_mfma_f32_16x16x32_bf16 v[100:103], a[108:111], a[132:135], v[100:103]
v_cvt_pk_bf16_f32 v73, v74, v75
v_cvt_pk_bf16_f32 v74, v76, v77
v_mfma_f32_16x16x32_bf16 v[100:103], a[104:107], a[128:131], v[100:103]
s_waitcnt lgkmcnt(2)
ds_read_b64_tr_b16 a[184:185], v14 offset:49152
ds_read_b64_tr_b16 a[186:187], v14 offset:49664
v_mfma_f32_16x16x32_bf16 v[128:131], a[112:115], a[128:131], v[128:131]
v_cvt_pk_bf16_f32 v75, v78, v79
v_cvt_pk_bf16_f32 v80, v80, v81
v_mfma_f32_16x16x32_bf16 v[128:131], a[116:119], a[132:135], v[128:131]
v_cvt_pk_bf16_f32 v81, v82, v83
v_cvt_pk_bf16_f32 v82, v84, v85
v_mfma_f32_16x16x32_bf16 v[136:139], a[116:119], a[140:143], v[136:139]
ds_read_b64_tr_b16 a[188:189], v14 offset:57344
ds_read_b64_tr_b16 a[190:191], v14 offset:57856
v_mfma_f32_16x16x32_bf16 v[136:139], a[112:115], a[136:139], v[136:139]
v_add_u32 v9, s55, v9
v_add_u32 v10, s55, v10
v_mfma_f32_16x16x32_bf16 v[144:147], a[112:115], a[144:147], v[144:147]
v_subrev_u32 v11, s54, v11
v_subrev_u32 v12, s54, v12
v_mfma_f32_16x16x32_bf16 v[144:147], a[116:119], a[148:151], v[144:147]
buffer_load_dwordx4 v6, s[12:15], s64 offen offset:1024 lds
v_mfma_f32_16x16x32_bf16 v[152:155], a[116:119], a[156:159], v[152:155]
v_subrev_u32 v13, s54, v13
v_subrev_u32 v14, s54, v14
v_mfma_f32_16x16x32_bf16 v[152:155], a[112:115], a[152:155], v[152:155]
v_cvt_pk_bf16_f32 v83, v86, v87
v_cvt_pk_bf16_f32 v88, v88, v89
v_mfma_f32_16x16x32_bf16 v[156:159], a[120:123], a[152:155], v[156:159]
v_cvt_pk_bf16_f32 v89, v90, v91
v_cvt_pk_bf16_f32 v90, v92, v93
v_mfma_f32_16x16x32_bf16 v[156:159], a[124:127], a[156:159], v[156:159]
s_add_u32 s53, s88, 0
v_cvt_pk_bf16_f32 v91, v94, v95
v_cvt_pk_bf16_f32 v96, v96, v97
v_mfma_f32_16x16x32_bf16 v[148:151], a[124:127], a[148:151], v[148:151]
buffer_store_dwordx4 v[40:43], v4, s[24:27], s53 offen offset:1024 sc1
v_mfma_f32_16x16x32_bf16 v[148:151], a[120:123], a[144:147], v[148:151]
v_cvt_pk_bf16_f32 v97, v98, v99
v_cvt_pk_bf16_f32 v98, v100, v101
v_mfma_f32_16x16x32_bf16 v[140:143], a[120:123], a[136:139], v[140:143]
v_cvt_pk_bf16_f32 v99, v102, v103
v_cvt_pk_bf16_f32 v104, v104, v105
v_mfma_f32_16x16x32_bf16 v[140:143], a[124:127], a[140:143], v[140:143]
v_cvt_pk_bf16_f32 v105, v106, v107
v_cvt_pk_bf16_f32 v106, v108, v109
v_mfma_f32_16x16x32_bf16 v[132:135], a[124:127], a[132:135], v[132:135]
v_cvt_pk_bf16_f32 v107, v110, v111
v_cvt_pk_bf16_f32 v112, v112, v113
v_mfma_f32_16x16x32_bf16 v[132:135], a[120:123], a[128:131], v[132:135]
s_waitcnt lgkmcnt(0)
v_cvt_pk_bf16_f32 v113, v114, v115
v_cvt_pk_bf16_f32 v114, v116, v117
v_mfma_f32_16x16x32_bf16 v[160:163], a[160:163], a[64:67], v[160:163]
s_waitcnt vmcnt(17)
v_cvt_pk_bf16_f32 v115, v118, v119
v_cvt_pk_bf16_f32 v120, v120, v121
v_mfma_f32_16x16x32_bf16 v[160:163], a[164:167], a[68:71], v[160:163]
s_barrier
v_mfma_f32_16x16x32_bf16 v[164:167], a[172:175], a[68:71], v[164:167]
ds_read_b64_tr_b16 a[128:129], v11 offset:0
ds_read_b64_tr_b16 a[130:131], v11 offset:512
v_mfma_f32_16x16x32_bf16 v[164:167], a[168:171], a[64:67], v[164:167]
s_add_u32 m0, s77, 49152
s_add_u32 s64, s76, 128
v_cvt_pk_bf16_f32 v121, v122, v123
v_mfma_f32_16x16x32_bf16 v[168:171], a[176:179], a[64:67], v[168:171]
buffer_load_dwordx4 v7, s[20:23], s64 offen lds
v_mfma_f32_16x16x32_bf16 v[168:171], a[180:183], a[68:71], v[168:171]
ds_read_b64_tr_b16 a[132:133], v11 offset:4096
ds_read_b64_tr_b16 a[134:135], v11 offset:4608
v_mfma_f32_16x16x32_bf16 v[172:175], a[188:191], a[68:71], v[172:175]
v_cvt_pk_bf16_f32 v122, v124, v125
v_cvt_pk_bf16_f32 v123, v126, v127
v_mfma_f32_16x16x32_bf16 v[172:175], a[184:187], a[64:67], v[172:175]
v_cvt_pk_bf16_f32 v128, v128, v129
v_cvt_pk_bf16_f32 v129, v130, v131
v_mfma_f32_16x16x32_bf16 v[188:191], a[184:187], a[72:75], v[188:191]
ds_read_b64_tr_b16 a[136:137], v12 offset:0
ds_read_b64_tr_b16 a[138:139], v12 offset:512
v_mfma_f32_16x16x32_bf16 v[188:191], a[188:191], a[76:79], v[188:191]
v_cvt_pk_bf16_f32 v130, v132, v133
v_cvt_pk_bf16_f32 v131, v134, v135
v_mfma_f32_16x16x32_bf16 v[184:187], a[180:183], a[76:79], v[184:187]
v_cvt_pk_bf16_f32 v136, v136, v137
v_cvt_pk_bf16_f32 v137, v138, v139
v_mfma_f32_16x16x32_bf16 v[184:187], a[176:179], a[72:75], v[184:187]
ds_read_b64_tr_b16 a[140:141], v12 offset:4096
ds_read_b64_tr_b16 a[142:143], v12 offset:4608
v_mfma_f32_16x16x32_bf16 v[180:183], a[168:171], a[72:75], v[180:183]
buffer_load_dwordx4 v8, s[20:23], s64 offen offset:1024 lds
v_mfma_f32_16x16x32_bf16 v[180:183], a[172:175], a[76:79], v[180:183]
v_cvt_pk_bf16_f32 v138, v140, v141
v_cvt_pk_bf16_f32 v139, v142, v143
v_mfma_f32_16x16x32_bf16 v[176:179], a[164:167], a[76:79], v[176:179]
v_cvt_pk_bf16_f32 v144, v144, v145
v_cvt_pk_bf16_f32 v145, v146, v147
v_mfma_f32_16x16x32_bf16 v[176:179], a[160:163], a[72:75], v[176:179]
ds_read_b64_tr_b16 a[144:145], v13 offset:0
ds_read_b64_tr_b16 a[146:147], v13 offset:512
v_mfma_f32_16x16x32_bf16 v[192:195], a[160:163], a[80:83], v[192:195]
v_cvt_pk_bf16_f32 v146, v148, v149
v_cvt_pk_bf16_f32 v147, v150, v151
v_mfma_f32_16x16x32_bf16 v[192:195], a[164:167], a[84:87], v[192:195]
v_cvt_pk_bf16_f32 v152, v152, v153
v_cvt_pk_bf16_f32 v153, v154, v155
v_mfma_f32_16x16x32_bf16 v[196:199], a[172:175], a[84:87], v[196:199]
s_add_u32 m0, s80, 49152
s_add_u32 s64, s79, 2048
v_cvt_pk_bf16_f32 v154, v156, v157
v_mfma_f32_16x16x32_bf16 v[196:199], a[168:171], a[80:83], v[196:199]
ds_read_b64_tr_b16 a[148:149], v13 offset:4096
ds_read_b64_tr_b16 a[150:151], v13 offset:4608
v_mfma_f32_16x16x32_bf16 v[200:203], a[176:179], a[80:83], v[200:203]
buffer_load_dwordx4 v4, s[24:27], s64 offen sc1 lds
v_mfma_f32_16x16x32_bf16 v[200:203], a[180:183], a[84:87], v[200:203]
s_xor_b32 s65, s70, 128
s_add_u32 s71, s68, s65
s_add_u32 s72, s69, s65
v_mfma_f32_16x16x32_bf16 v[204:207], a[188:191], a[84:87], v[204:207]
s_add_u32 s53, s88, 0
ds_read_b64_tr_b16 a[152:153], v14 offset:0
ds_read_b64_tr_b16 a[154:155], v14 offset:512
v_mfma_f32_16x16x32_bf16 v[204:207], a[184:187], a[80:83], v[204:207]
buffer_store_dwordx4 v[48:51], v4, s[24:27], s53 offen offset:2048 sc1
v_mfma_f32_16x16x32_bf16 v[220:223], a[184:187], a[88:91], v[220:223]
ds_read_b64_tr_b16 a[156:157], v14 offset:4096
ds_read_b64_tr_b16 a[158:159], v14 offset:4608
v_mfma_f32_16x16x32_bf16 v[220:223], a[188:191], a[92:95], v[220:223]
v_cvt_pk_bf16_f32 v155, v158, v159
v_mul_f32 v160, s91, v160
v_mfma_f32_16x16x32_bf16 v[216:219], a[180:183], a[92:95], v[216:219]
s_add_u32 m0, s73, 32768
s_add_u32 s64, s71, 0
v_mul_f32 v161, s91, v161
v_mfma_f32_16x16x32_bf16 v[216:219], a[176:179], a[88:91], v[216:219]
v_mul_f32 v162, s91, v162
v_mul_f32 v163, s91, v163
v_mfma_f32_16x16x32_bf16 v[212:215], a[168:171], a[88:91], v[212:215]
buffer_load_dwordx4 v5, s[12:15], s64 offen lds
v_mfma_f32_16x16x32_bf16 v[212:215], a[172:175], a[92:95], v[212:215]
ds_read_b128 a[68:71], v4 offset:10240
v_mul_f32 v164, s91, v164
v_mfma_f32_16x16x32_bf16 v[208:211], a[164:167], a[92:95], v[208:211]
v_mul_f32 v165, s91, v165
v_mul_f32 v166, s91, v166
v_mfma_f32_16x16x32_bf16 v[208:211], a[160:163], a[88:91], v[208:211]
ds_read_b128 a[64:67], v4 offset:8192
v_mul_f32 v167, s91, v167
v_mfma_f32_16x16x32_bf16 v[224:227], a[160:163], a[96:99], v[224:227]
v_cvt_pk_bf16_f32 v160, v160, v161
v_cvt_pk_bf16_f32 v161, v162, v163
v_mfma_f32_16x16x32_bf16 v[224:227], a[164:167], a[100:103], v[224:227]
v_cvt_pk_bf16_f32 v162, v164, v165
v_cvt_pk_bf16_f32 v163, v166, v167
v_mfma_f32_16x16x32_bf16 v[228:231], a[172:175], a[100:103], v[228:231]
ds_read_b128 a[76:79], v4 offset:11264
v_mul_f32 v168, s91, v168
v_mfma_f32_16x16x32_bf16 v[228:231], a[168:171], a[96:99], v[228:231]
v_mul_f32 v169, s91, v169
v_mul_f32 v170, s91, v170
v_mfma_f32_16x16x32_bf16 v[232:235], a[176:179], a[96:99], v[232:235]
v_mul_f32 v171, s91, v171
v_mul_f32 v172, s91, v172
v_mfma_f32_16x16x32_bf16 v[232:235], a[180:183], a[100:103], v[232:235]
buffer_load_dwordx4 v6, s[12:15], s64 offen offset:1024 lds
v_mfma_f32_16x16x32_bf16 v[236:239], a[188:191], a[100:103], v[236:239]
ds_read_b128 a[72:75], v4 offset:9216
v_mul_f32 v173, s91, v173
v_mfma_f32_16x16x32_bf16 v[236:239], a[184:187], a[96:99], v[236:239]
v_mul_f32 v174, s91, v174
v_mul_f32 v175, s91, v175
v_mfma_f32_16x16x32_bf16 v[252:255], a[184:187], a[104:107], v[252:255]
v_cvt_pk_bf16_f32 v168, v168, v169
v_cvt_pk_bf16_f32 v169, v170, v171
v_mfma_f32_16x16x32_bf16 v[252:255], a[188:191], a[108:111], v[252:255]
ds_read_b128 a[84:87], v10 offset:0
v_cvt_pk_bf16_f32 v170, v172, v173
v_mfma_f32_16x16x32_bf16 v[248:251], a[180:183], a[108:111], v[248:251]
v_cvt_pk_bf16_f32 v171, v174, v175
v_mul_f32 v176, s91, v176
v_mfma_f32_16x16x32_bf16 v[248:251], a[176:179], a[104:107], v[248:251]
s_add_u32 m0, s73, 34816
s_add_u32 s64, s71, 18432
v_mul_f32 v177, s91, v177
v_mfma_f32_16x16x32_bf16 v[244:247], a[168:171], a[104:107], v[244:247]
ds_read_b128 a[80:83], v9 offset:0
v_mul_f32 v178, s91, v178
v_mfma_f32_16x16x32_bf16 v[244:247], a[172:175], a[108:111], v[244:247]
buffer_load_dwordx4 v5, s[12:15], s64 offen lds
v_mfma_f32_16x16x32_bf16 v[240:243], a[164:167], a[108:111], v[240:243]
v_mul_f32 v179, s91, v179
v_mul_f32 v180, s91, v180
v_mfma_f32_16x16x32_bf16 v[240:243], a[160:163], a[104:107], v[240:243]
s_add_u32 s53, s88, 0
ds_read_b128 a[92:95], v10 offset:2048
v_mul_f32 v181, s91, v181
v_mfma_f32_16x16x32_bf16 a[0:3], a[160:163], a[112:115], a[0:3]
buffer_store_dwordx4 v[56:59], v4, s[24:27], s53 offen offset:3072 sc1
v_mfma_f32_16x16x32_bf16 a[0:3], a[164:167], a[116:119], a[0:3]
v_mul_f32 v182, s91, v182
v_mul_f32 v183, s91, v183
v_mfma_f32_16x16x32_bf16 a[4:7], a[172:175], a[116:119], a[4:7]
ds_read_b128 a[88:91], v9 offset:2048
v_cvt_pk_bf16_f32 v176, v176, v177
v_mfma_f32_16x16x32_bf16 a[4:7], a[168:171], a[112:115], a[4:7]
v_cvt_pk_bf16_f32 v177, v178, v179
v_cvt_pk_bf16_f32 v178, v180, v181
v_mfma_f32_16x16x32_bf16 a[8:11], a[176:179], a[112:115], a[8:11]
v_cvt_pk_bf16_f32 v179, v182, v183
v_mul_f32 v184, s91, v184
v_mfma_f32_16x16x32_bf16 a[8:11], a[180:183], a[116:119], a[8:11]
buffer_load_dwordx4 v6, s[12:15], s64 offen offset:1024 lds
v_mfma_f32_16x16x32_bf16 a[12:15], a[188:191], a[116:119], a[12:15]
v_mul_f32 v185, s91, v185
v_mul_f32 v186, s91, v186
v_mfma_f32_16x16x32_bf16 a[12:15], a[184:187], a[112:115], a[12:15]
v_mul_f32 v187, s91, v187
v_mul_f32 v188, s91, v188
v_mfma_f32_16x16x32_bf16 a[28:31], a[184:187], a[120:123], a[28:31]
v_mul_f32 v189, s91, v189
v_mul_f32 v190, s91, v190
v_mfma_f32_16x16x32_bf16 a[28:31], a[188:191], a[124:127], a[28:31]
v_mul_f32 v191, s91, v191
v_cvt_pk_bf16_f32 v184, v184, v185
v_mfma_f32_16x16x32_bf16 a[24:27], a[180:183], a[124:127], a[24:27]
v_cvt_pk_bf16_f32 v185, v186, v187
v_cvt_pk_bf16_f32 v186, v188, v189
v_mfma_f32_16x16x32_bf16 a[24:27], a[176:179], a[120:123], a[24:27]
v_cvt_pk_bf16_f32 v187, v190, v191
v_mul_f32 v192, s91, v192
v_mfma_f32_16x16x32_bf16 a[20:23], a[168:171], a[120:123], a[20:23]
v_mul_f32 v193, s91, v193
v_mul_f32 v194, s91, v194
v_mfma_f32_16x16x32_bf16 a[20:23], a[172:175], a[124:127], a[20:23]
v_mul_f32 v195, s91, v195
v_mul_f32 v196, s91, v196
v_mfma_f32_16x16x32_bf16 a[16:19], a[164:167], a[124:127], a[16:19]
v_mul_f32 v197, s91, v197
v_mul_f32 v198, s91, v198
v_mfma_f32_16x16x32_bf16 a[16:19], a[160:163], a[120:123], a[16:19]
s_waitcnt lgkmcnt(0)
v_mul_f32 v199, s91, v199
v_cvt_pk_bf16_f32 v192, v192, v193
v_mfma_f32_16x16x32_bf16 v[36:39], a[128:131], a[80:83], 0
s_waitcnt vmcnt(22)
v_cvt_pk_bf16_f32 v193, v194, v195
v_cvt_pk_bf16_f32 v194, v196, v197
v_mfma_f32_16x16x32_bf16 v[36:39], a[132:135], a[84:87], v[36:39]
s_barrier
v_mfma_f32_16x16x32_bf16 v[44:47], a[140:143], a[84:87], 0
ds_read_b128 a[96:99], v9 offset:4096
v_cvt_pk_bf16_f32 v195, v198, v199
v_mfma_f32_16x16x32_bf16 v[44:47], a[136:139], a[80:83], v[44:47]
s_xor_b32 s75, s93, 1
s_lshl_b32 s76, s75, 19
s_add_u32 s76, s76, s74
v_mfma_f32_16x16x32_bf16 v[32:35], a[144:147], a[80:83], 0
s_lshl_b32 s79, s75, 13
s_add_u32 s79, s79, s78
ds_read_b128 a[100:103], v10 offset:4096
v_mfma_f32_16x16x32_bf16 v[32:35], a[148:151], a[84:87], v[32:35]
s_add_u32 m0, s77, 0
s_add_u32 s64, s76, 0
ds_read_b128 a[104:107], v9 offset:6144
v_mfma_f32_16x16x32_bf16 v[52:55], a[156:159], a[84:87], 0
buffer_load_dwordx4 v7, s[20:23], s64 offen lds
v_mfma_f32_16x16x32_bf16 v[52:55], a[152:155], a[80:83], v[52:55]
ds_read_b64_tr_b16 a[160:161], v11 offset:16384
ds_read_b64_tr_b16 a[162:163], v11 offset:16896
v_mfma_f32_16x16x32_bf16 v[60:63], a[64:67], a[80:83], 0
v_mul_f32 v200, s91, v200
v_mul_f32 v201, s91, v201
v_mfma_f32_16x16x32_bf16 v[60:63], a[68:71], a[84:87], v[60:63]
ds_read_b128 a[108:111], v10 offset:6144
v_mul_f32 v202, s91, v202
v_mfma_f32_16x16x32_bf16 v[68:71], a[76:79], a[84:87], 0
buffer_load_dwordx4 v8, s[20:23], s64 offen offset:1024 lds
v_mfma_f32_16x16x32_bf16 v[68:71], a[72:75], a[80:83], v[68:71]
s_add_u32 s53, s88, 262144
ds_read_b64_tr_b16 a[164:165], v11 offset:20480
ds_read_b64_tr_b16 a[166:167], v11 offset:20992
v_mfma_f32_16x16x32_bf16 v[76:79], a[72:75], a[88:91], 0
v_add_u32 v9, -65536, v9
v_add_u32 v10, -65536, v10
v_mfma_f32_16x16x32_bf16 v[76:79], a[76:79], a[92:95], v[76:79]
ds_read_b64_tr_b16 a[168:169], v12 offset:16384
ds_read_b64_tr_b16 a[170:171], v12 offset:16896
v_mfma_f32_16x16x32_bf16 v[84:87], a[68:71], a[92:95], 0
s_add_u32 m0, s80, 0
s_add_u32 s64, s79, 0
v_mul_f32 v203, s91, v203
v_mfma_f32_16x16x32_bf16 v[84:87], a[64:67], a[88:91], v[84:87]
ds_read_b64_tr_b16 a[172:173], v12 offset:20480
ds_read_b64_tr_b16 a[174:175], v12 offset:20992
v_mfma_f32_16x16x32_bf16 v[92:95], a[152:155], a[88:91], 0
buffer_load_dwordx4 v4, s[24:27], s64 offen sc1 lds
v_mfma_f32_16x16x32_bf16 v[92:95], a[156:159], a[92:95], v[92:95]
buffer_store_dwordx4 v[64:67], v4, s[24:27], s53 offen offset:0 sc1
v_mfma_f32_16x16x32_bf16 v[40:43], a[148:151], a[92:95], 0
ds_read_b64_tr_b16 a[176:177], v13 offset:16384
ds_read_b64_tr_b16 a[178:179], v13 offset:16896
v_mfma_f32_16x16x32_bf16 v[40:43], a[144:147], a[88:91], v[40:43]
v_mul_f32 v204, s91, v204
v_mul_f32 v205, s91, v205
v_mfma_f32_16x16x32_bf16 v[100:103], a[136:139], a[88:91], 0
s_add_u32 m0, s73, 36864
s_add_u32 s64, s72, 0
v_mul_f32 v206, s91, v206
v_mfma_f32_16x16x32_bf16 v[100:103], a[140:143], a[92:95], v[100:103]
ds_read_b64_tr_b16 a[180:181], v13 offset:20480
ds_read_b64_tr_b16 a[182:183], v13 offset:20992
v_mfma_f32_16x16x32_bf16 v[108:111], a[132:135], a[92:95], 0
buffer_load_dwordx4 v5, s[12:15], s64 offen lds
v_mfma_f32_16x16x32_bf16 v[108:111], a[128:131], a[88:91], v[108:111]
s_waitcnt lgkmcnt(14)
ds_read_b64_tr_b16 a[184:185], v14 offset:16384
ds_read_b64_tr_b16 a[186:187], v14 offset:16896
v_mfma_f32_16x16x32_bf16 v[116:119], a[128:131], a[96:99], 0
ds_read_b64_tr_b16 a[188:189], v14 offset:20480
ds_read_b64_tr_b16 a[190:191], v14 offset:20992
v_mfma_f32_16x16x32_bf16 v[116:119], a[132:135], a[100:103], v[116:119]
v_mul_f32 v207, s91, v207
v_cvt_pk_bf16_f32 v200, v200, v201
v_mfma_f32_16x16x32_bf16 v[124:127], a[140:143], a[100:103], 0
v_cvt_pk_bf16_f32 v201, v202, v203
v_cvt_pk_bf16_f32 v202, v204, v205
v_mfma_f32_16x16x32_bf16 v[124:127], a[136:139], a[96:99], v[124:127]
ds_read_b128 a[112:115], v4 offset:24576
v_cvt_pk_bf16_f32 v203, v206, v207
v_mfma_f32_16x16x32_bf16 v[132:135], a[144:147], a[96:99], 0
buffer_load_dwordx4 v6, s[12:15], s64 offen offset:1024 lds
v_mfma_f32_16x16x32_bf16 v[132:135], a[148:151], a[100:103], v[132:135]
ds_read_b128 a[116:119], v4 offset:26624
v_mul_f32 v208, s91, v208
v_mfma_f32_16x16x32_bf16 v[140:143], a[156:159], a[100:103], 0
v_mul_f32 v209, s91, v209
v_mul_f32 v210, s91, v210
v_mfma_f32_16x16x32_bf16 v[140:143], a[152:155], a[96:99], v[140:143]
ds_read_b128 a[120:123], v4 offset:25600
v_mul_f32 v211, s91, v211
v_mfma_f32_16x16x32_bf16 v[148:151], a[64:67], a[96:99], 0
s_add_u32 m0, s73, 38912
s_add_u32 s64, s72, 18432
v_mul_f32 v212, s91, v212
v_mfma_f32_16x16x32_bf16 v[148:151], a[68:71], a[100:103], v[148:151]
ds_read_b128 a[124:127], v4 offset:27648
v_mul_f32 v213, s91, v213
v_mfma_f32_16x16x32_bf16 v[48:51], a[76:79], a[100:103], 0
buffer_load_dwordx4 v5, s[12:15], s64 offen lds
v_mfma_f32_16x16x32_bf16 v[48:51], a[72:75], a[96:99], v[48:51]
s_waitcnt lgkmcnt(15)
v_mul_f32 v214, s91, v214
v_mul_f32 v215, s91, v215
v_mfma_f32_16x16x32_bf16 v[156:159], a[72:75], a[104:107], 0
v_cvt_pk_bf16_f32 v208, v208, v209
v_cvt_pk_bf16_f32 v209, v210, v211
v_mfma_f32_16x16x32_bf16 v[156:159], a[76:79], a[108:111], v[156:159]
s_add_u32 s53, s88, 262144
v_cvt_pk_bf16_f32 v210, v212, v213
v_cvt_pk_bf16_f32 v211, v214, v215
v_mfma_f32_16x16x32_bf16 v[164:167], a[68:71], a[108:111], 0
buffer_store_dwordx4 v[72:75], v4, s[24:27], s53 offen offset:1024 sc1
v_mfma_f32_16x16x32_bf16 v[164:167], a[64:67], a[104:107], v[164:167]
v_mul_f32 v216, s91, v216
v_mul_f32 v217, s91, v217
v_mfma_f32_16x16x32_bf16 v[172:175], a[152:155], a[104:107], 0
buffer_load_dwordx4 v6, s[12:15], s64 offen offset:1024 lds
v_mfma_f32_16x16x32_bf16 v[172:175], a[156:159], a[108:111], v[172:175]
v_mul_f32 v218, s91, v218
v_mul_f32 v219, s91, v219
v_mfma_f32_16x16x32_bf16 v[56:59], a[148:151], a[108:111], 0
v_mul_f32 v220, s91, v220
v_mul_f32 v221, s91, v221
v_mfma_f32_16x16x32_bf16 v[56:59], a[144:147], a[104:107], v[56:59]
v_mul_f32 v222, s91, v222
v_mul_f32 v223, s91, v223
v_mfma_f32_16x16x32_bf16 v[180:183], a[136:139], a[104:107], 0
v_cvt_pk_bf16_f32 v216, v216, v217
v_cvt_pk_bf16_f32 v217, v218, v219
v_mfma_f32_16x16x32_bf16 v[180:183], a[140:143], a[108:111], v[180:183]
v_cvt_pk_bf16_f32 v218, v220, v221
v_cvt_pk_bf16_f32 v219, v222, v223
v_mfma_f32_16x16x32_bf16 v[188:191], a[132:135], a[108:111], 0
v_mul_f32 v224, s91, v224
v_mul_f32 v225, s91, v225
v_mfma_f32_16x16x32_bf16 v[188:191], a[128:131], a[104:107], v[188:191]
s_waitcnt lgkmcnt(0)
v_mul_f32 v226, s91, v226
v_mul_f32 v227, s91, v227
v_mfma_f32_16x16x32_bf16 v[196:199], a[160:163], a[80:83], 0
s_waitcnt vmcnt(19)
v_mul_f32 v228, s91, v228
v_mul_f32 v229, s91, v229
v_mfma_f32_16x16x32_bf16 v[196:199], a[164:167], a[84:87], v[196:199]
s_barrier
v_mfma_f32_16x16x32_bf16 v[64:67], a[172:175], a[84:87], 0
ds_read_b64_tr_b16 a[128:129], v11 offset:32768
ds_read_b64_tr_b16 a[130:131], v11 offset:33280
v_mfma_f32_16x16x32_bf16 v[64:67], a[168:171], a[80:83], v[64:67]
s_add_u32 m0, s77, 16384
s_add_u32 s64, s76, 128
v_mul_f32 v230, s91, v230
v_mfma_f32_16x16x32_bf16 v[204:207], a[176:179], a[80:83], 0
buffer_load_dwordx4 v7, s[20:23], s64 offen lds
v_mfma_f32_16x16x32_bf16 v[204:207], a[180:183], a[84:87], v[204:207]
ds_read_b64_tr_b16 a[132:133], v11 offset:36864
ds_read_b64_tr_b16 a[134:135], v11 offset:37376
v_mfma_f32_16x16x32_bf16 v[212:215], a[188:191], a[84:87], 0
ds_read_b64_tr_b16 a[136:137], v12 offset:32768
ds_read_b64_tr_b16 a[138:139], v12 offset:33280
v_mfma_f32_16x16x32_bf16 v[212:215], a[184:187], a[80:83], v[212:215]
ds_read_b64_tr_b16 a[140:141], v12 offset:36864
ds_read_b64_tr_b16 a[142:143], v12 offset:37376
v_mfma_f32_16x16x32_bf16 v[72:75], a[112:115], a[80:83], 0
v_mul_f32 v231, s91, v231
v_cvt_pk_bf16_f32 v224, v224, v225
v_mfma_f32_16x16x32_bf16 v[72:75], a[116:119], a[84:87], v[72:75]
ds_read_b64_tr_b16 a[144:145], v13 offset:32768
ds_read_b64_tr_b16 a[146:147], v13 offset:33280
v_mfma_f32_16x16x32_bf16 v[220:223], a[124:127], a[84:87], 0
buffer_load_dwordx4 v8, s[20:23], s64 offen offset:1024 lds
v_mfma_f32_16x16x32_bf16 v[220:223], a[120:123], a[80:83], v[220:223]
ds_read_b64_tr_b16 a[148:149], v13 offset:36864
ds_read_b64_tr_b16 a[150:151], v13 offset:37376
v_mfma_f32_16x16x32_bf16 a[32:35], a[120:123], a[88:91], 0
L_PAD4:
s_cbranch_execz L_PAD8
v_cvt_pk_bf16_f32 v225, v226, v227
v_cvt_pk_bf16_f32 v226, v228, v229
v_mfma_f32_16x16x32_bf16 a[32:35], a[124:127], a[92:95], a[32:35]
ds_read_b64_tr_b16 a[152:153], v14 offset:32768
ds_read_b64_tr_b16 a[154:155], v14 offset:33280
v_mfma_f32_16x16x32_bf16 a[36:39], a[116:119], a[92:95], 0
s_add_u32 m0, s80, 16384
s_add_u32 s64, s79, 2048
v_cvt_pk_bf16_f32 v227, v230, v231
v_mfma_f32_16x16x32_bf16 a[36:39], a[112:115], a[88:91], a[36:39]
ds_read_b64_tr_b16 a[156:157], v14 offset:36864
ds_read_b64_tr_b16 a[158:159], v14 offset:37376
v_mfma_f32_16x16x32_bf16 v[228:231], a[184:187], a[88:91], 0
buffer_load_dwordx4 v4, s[24:27], s64 offen sc1 lds
v_mfma_f32_16x16x32_bf16 v[228:231], a[188:191], a[92:95], v[228:231]
s_xor_b32 s65, s70, 256
s_add_u32 s71, s68, s65
s_add_u32 s72, s69, s65
v_mfma_f32_16x16x32_bf16 a[40:43], a[180:183], a[92:95], 0
s_add_u32 s53, s88, 262144
ds_read_b128 a[64:67], v4 offset:40960
v_mul_f32 v232, s91, v232
v_mfma_f32_16x16x32_bf16 a[40:43], a[176:179], a[88:91], a[40:43]
buffer_store_dwordx4 v[80:83], v4, s[24:27], s53 offen offset:2048 sc1
v_mfma_f32_16x16x32_bf16 a[44:47], a[168:171], a[88:91], 0
s_add_u32 m0, s73, 65536
s_add_u32 s64, s71, 0
ds_read_b128 a[80:83], v9 offset:0
v_mfma_f32_16x16x32_bf16 a[44:47], a[172:175], a[92:95], a[44:47]
v_mul_f32 v233, s91, v233
v_mul_f32 v234, s91, v234
v_mfma_f32_16x16x32_bf16 v[80:83], a[164:167], a[92:95], 0
buffer_load_dwordx4 v5, s[12:15], s64 offen lds
v_mfma_f32_16x16x32_bf16 v[80:83], a[160:163], a[88:91], v[80:83]
ds_read_b128 a[68:71], v4 offset:43008
v_mul_f32 v235, s91, v235
v_mfma_f32_16x16x32_bf16 a[48:51], a[160:163], a[96:99], 0
ds_read_b128 a[84:87], v10 offset:0
v_mul_f32 v236, s91, v236
v_mfma_f32_16x16x32_bf16 a[48:51], a[164:167], a[100:103], a[48:51]
v_mul_f32 v237, s91, v237
v_mul_f32 v238, s91, v238
v_mfma_f32_16x16x32_bf16 a[52:55], a[172:175], a[100:103], 0
v_mul_f32 v239, s91, v239
v_cvt_pk_bf16_f32 v232, v232, v233
v_mfma_f32_16x16x32_bf16 a[52:55], a[168:171], a[96:99], a[52:55]
ds_read_b128 a[72:75], v4 offset:41984
v_cvt_pk_bf16_f32 v233, v234, v235
v_mfma_f32_16x16x32_bf16 a[56:59], a[176:179], a[96:99], 0
buffer_load_dwordx4 v6, s[12:15], s64 offen offset:1024 lds
v_mfma_f32_16x16x32_bf16 a[56:59], a[180:183], a[100:103], a[56:59]
ds_read_b128 a[88:91], v9 offset:2048
v_cvt_pk_bf16_f32 v234, v236, v237
v_mfma_f32_16x16x32_bf16 a[60:63], a[188:191], a[100:103], 0
v_cvt_pk_bf16_f32 v235, v238, v239
v_mul_f32 v240, s91, v240
v_mfma_f32_16x16x32_bf16 a[60:63], a[184:187], a[96:99], a[60:63]
ds_read_b128 a[76:79], v4 offset:44032
v_mul_f32 v241, s91, v241
v_mfma_f32_16x16x32_bf16 v[236:239], a[112:115], a[96:99], 0
s_add_u32 m0, s73, 67584
s_add_u32 s64, s71, 18432
v_mul_f32 v242, s91, v242
v_mfma_f32_16x16x32_bf16 v[236:239], a[116:119], a[100:103], v[236:239]
ds_read_b128 a[92:95], v10 offset:2048
v_mul_f32 v243, s91, v243
v_mfma_f32_16x16x32_bf16 a[192:195], a[124:127], a[100:103], 0
buffer_load_dwordx4 v5, s[12:15], s64 offen lds
v_mfma_f32_16x16x32_bf16 a[192:195], a[120:123], a[96:99], a[192:195]
v_mul_f32 v244, s91, v244
v_mul_f32 v245, s91, v245
v_mfma_f32_16x16x32_bf16 a[196:199], a[120:123], a[104:107], 0
v_mul_f32 v246, s91, v246
v_mul_f32 v247, s91, v247
v_mfma_f32_16x16x32_bf16 a[196:199], a[124:127], a[108:111], a[196:199]
v_cvt_pk_bf16_f32 v240, v240, v241
v_cvt_pk_bf16_f32 v241, v242, v243
v_mfma_f32_16x16x32_bf16 a[200:203], a[116:119], a[108:111], 0
v_cvt_pk_bf16_f32 v242, v244, v245
v_cvt_pk_bf16_f32 v243, v246, v247
v_mfma_f32_16x16x32_bf16 a[200:203], a[112:115], a[104:107], a[200:203]
v_mul_f32 v248, s91, v248
v_mul_f32 v249, s91, v249
v_mfma_f32_16x16x32_bf16 v[244:247], a[184:187], a[104:107], 0
buffer_load_dwordx4 v6, s[12:15], s64 offen offset:1024 lds
v_mfma_f32_16x16x32_bf16 v[244:247], a[188:191], a[108:111], v[244:247]
v_mul_f32 v250, s91, v250
v_mul_f32 v251, s91, v251
v_mfma_f32_16x16x32_bf16 a[204:207], a[180:183], a[108:111], 0
v_mul_f32 v252, s91, v252
v_mul_f32 v253, s91, v253
v_mfma_f32_16x16x32_bf16 a[204:207], a[176:179], a[104:107], a[204:207]
s_add_u32 s53, s88, 262144
v_mul_f32 v254, s91, v254
v_mul_f32 v255, s91, v255
v_mfma_f32_16x16x32_bf16 a[208:211], a[168:171], a[104:107], 0
buffer_store_dwordx4 v[88:91], v4, s[24:27], s53 offen offset:3072 sc1
v_mfma_f32_16x16x32_bf16 a[208:211], a[172:175], a[108:111], a[208:211]
v_cvt_pk_bf16_f32 v248, v248, v249
v_cvt_pk_bf16_f32 v249, v250, v251
v_mfma_f32_16x16x32_bf16 v[88:91], a[164:167], a[108:111], 0
v_cvt_pk_bf16_f32 v250, v252, v253
v_cvt_pk_bf16_f32 v251, v254, v255
v_mfma_f32_16x16x32_bf16 v[88:91], a[160:163], a[104:107], v[88:91]
s_waitcnt lgkmcnt(0)
v_accvgpr_read_b32 v16, a0
v_accvgpr_read_b32 v17, a1
v_mfma_f32_16x16x32_bf16 v[36:39], a[128:131], a[80:83], v[36:39]
s_waitcnt vmcnt(24)
v_accvgpr_read_b32 v18, a2
v_accvgpr_read_b32 v19, a3
v_mfma_f32_16x16x32_bf16 v[36:39], a[132:135], a[84:87], v[36:39]
s_barrier
v_mfma_f32_16x16x32_bf16 v[44:47], a[140:143], a[84:87], v[44:47]
ds_read_b128 a[96:99], v9 offset:4096
v_accvgpr_read_b32 v20, a4
v_mfma_f32_16x16x32_bf16 v[44:47], a[136:139], a[80:83], v[44:47]
s_xor_b32 s75, s93, 2
s_lshl_b32 s76, s75, 19
s_add_u32 s76, s76, s74
v_mfma_f32_16x16x32_bf16 v[32:35], a[144:147], a[80:83], v[32:35]
s_lshl_b32 s79, s75, 13
s_add_u32 s79, s79, s78
ds_read_b128 a[100:103], v10 offset:4096
v_mfma_f32_16x16x32_bf16 v[32:35], a[148:151], a[84:87], v[32:35]
s_add_u32 m0, s77, 32768
s_add_u32 s64, s76, 0
ds_read_b128 a[104:107], v9 offset:6144
v_mfma_f32_16x16x32_bf16 v[52:55], a[156:159], a[84:87], v[52:55]
buffer_load_dwordx4 v7, s[20:23], s64 offen lds
v_mfma_f32_16x16x32_bf16 v[52:55], a[152:155], a[80:83], v[52:55]
ds_read_b64_tr_b16 a[160:161], v11 offset:49152
ds_read_b64_tr_b16 a[162:163], v11 offset:49664
v_mfma_f32_16x16x32_bf16 v[60:63], a[64:67], a[80:83], v[60:63]
v_accvgpr_read_b32 v21, a5
v_accvgpr_read_b32 v22, a6
v_mfma_f32_16x16x32_bf16 v[60:63], a[68:71], a[84:87], v[60:63]
ds_read_b128 a[108:111], v10 offset:6144
v_accvgpr_read_b32 v23, a7
v_mfma_f32_16x16x32_bf16 v[68:71], a[76:79], a[84:87], v[68:71]
buffer_load_dwordx4 v8, s[20:23], s64 offen offset:1024 lds
v_mfma_f32_16x16x32_bf16 v[68:71], a[72:75], a[80:83], v[68:71]
ds_read_b64_tr_b16 a[164:165], v11 offset:53248
ds_read_b64_tr_b16 a[166:167], v11 offset:53760
v_mfma_f32_16x16x32_bf16 v[76:79], a[72:75], a[88:91], v[76:79]
v_add_u32 v9, 32768, v9
v_add_u32 v10, 32768, v10
v_mfma_f32_16x16x32_bf16 v[76:79], a[76:79], a[92:95], v[76:79]
ds_read_b64_tr_b16 a[168:169], v12 offset:49152
ds_read_b64_tr_b16 a[170:171], v12 offset:49664
v_mfma_f32_16x16x32_bf16 v[84:87], a[68:71], a[92:95], v[84:87]
s_add_u32 m0, s80, 32768
s_add_u32 s64, s79, 0
v_mul_f32 v16, s91, v16
v_mfma_f32_16x16x32_bf16 v[84:87], a[64:67], a[88:91], v[84:87]
ds_read_b64_tr_b16 a[172:173], v12 offset:53248
ds_read_b64_tr_b16 a[174:175], v12 offset:53760
v_mfma_f32_16x16x32_bf16 v[92:95], a[152:155], a[88:91], v[92:95]
buffer_load_dwordx4 v4, s[24:27], s64 offen sc1 lds
v_mfma_f32_16x16x32_bf16 v[92:95], a[156:159], a[92:95], v[92:95]
v_mul_f32 v17, s91, v17
v_mul_f32 v18, s91, v18
v_mfma_f32_16x16x32_bf16 v[40:43], a[148:151], a[92:95], v[40:43]
ds_read_b64_tr_b16 a[176:177], v13 offset:49152
ds_read_b64_tr_b16 a[178:179], v13 offset:49664
v_mfma_f32_16x16x32_bf16 v[40:43], a[144:147], a[88:91], v[40:43]
v_mul_f32 v19, s91, v19
v_mul_f32 v20, s91, v20
v_mfma_f32_16x16x32_bf16 v[100:103], a[136:139], a[88:91], v[100:103]
s_add_u32 m0, s73, 69632
s_add_u32 s64, s72, 0
v_mul_f32 v21, s91, v21
v_mfma_f32_16x16x32_bf16 v[100:103], a[140:143], a[92:95], v[100:103]
ds_read_b64_tr_b16 a[180:181], v13 offset:53248
ds_read_b64_tr_b16 a[182:183], v13 offset:53760
v_mfma_f32_16x16x32_bf16 v[108:111], a[132:135], a[92:95], v[108:111]
buffer_load_dwordx4 v5, s[12:15], s64 offen lds
v_mfma_f32_16x16x32_bf16 v[108:111], a[128:131], a[88:91], v[108:111]
s_waitcnt lgkmcnt(14)
ds_read_b64_tr_b16 a[184:185], v14 offset:49152
ds_read_b64_tr_b16 a[186:187], v14 offset:49664
v_mfma_f32_16x16x32_bf16 v[116:119], a[128:131], a[96:99], v[116:119]
s_add_u32 s53, s87, 0
ds_read_b64_tr_b16 a[188:189], v14 offset:53248
ds_read_b64_tr_b16 a[190:191], v14 offset:53760
v_mfma_f32_16x16x32_bf16 v[116:119], a[132:135], a[100:103], v[116:119]
buffer_store_dwordx4 v[160:163], v4, s[24:27], s53 offen offset:0 sc1
v_mfma_f32_16x16x32_bf16 v[124:127], a[140:143], a[100:103], v[124:127]
v_mul_f32 v22, s91, v22
v_mul_f32 v23, s91, v23
v_mfma_f32_16x16x32_bf16 v[124:127], a[136:139], a[96:99], v[124:127]
ds_read_b128 a[112:115], v4 offset:57344
v_cvt_pk_bf16_f32 v16, v16, v17
v_mfma_f32_16x16x32_bf16 v[132:135], a[144:147], a[96:99], v[132:135]
buffer_load_dwordx4 v6, s[12:15], s64 offen offset:1024 lds
v_mfma_f32_16x16x32_bf16 v[132:135], a[148:151], a[100:103], v[132:135]
ds_read_b128 a[116:119], v4 offset:59392
v_cvt_pk_bf16_f32 v17, v18, v19
v_mfma_f32_16x16x32_bf16 v[140:143], a[156:159], a[100:103], v[140:143]
v_cvt_pk_bf16_f32 v18, v20, v21
v_cvt_pk_bf16_f32 v19, v22, v23
v_mfma_f32_16x16x32_bf16 v[140:143], a[152:155], a[96:99], v[140:143]
ds_read_b128 a[120:123], v4 offset:58368
v_accvgpr_write_b32 a0, v16
v_mfma_f32_16x16x32_bf16 v[148:151], a[64:67], a[96:99], v[148:151]
s_add_u32 m0, s73, 71680
s_add_u32 s64, s72, 18432
v_accvgpr_write_b32 a1, v17
v_mfma_f32_16x16x32_bf16 v[148:151], a[68:71], a[100:103], v[148:151]
ds_read_b128 a[124:127], v4 offset:60416
v_accvgpr_write_b32 a2, v18
v_mfma_f32_16x16x32_bf16 v[48:51], a[76:79], a[100:103], v[48:51]
buffer_load_dwordx4 v5, s[12:15], s64 offen lds
v_mfma_f32_16x16x32_bf16 v[48:51], a[72:75], a[96:99], v[48:51]
s_waitcnt lgkmcnt(15)
v_accvgpr_write_b32 a3, v19
v_accvgpr_read_b32 v16, a8
v_mfma_f32_16x16x32_bf16 v[156:159], a[72:75], a[104:107], v[156:159]
v_accvgpr_read_b32 v17, a9
v_accvgpr_read_b32 v18, a10
v_mfma_f32_16x16x32_bf16 v[156:159], a[76:79], a[108:111], v[156:159]
v_accvgpr_read_b32 v19, a11
v_accvgpr_read_b32 v20, a12
v_mfma_f32_16x16x32_bf16 v[164:167], a[68:71], a[108:111], v[164:167]
v_accvgpr_read_b32 v21, a13
v_accvgpr_read_b32 v22, a14
v_mfma_f32_16x16x32_bf16 v[164:167], a[64:67], a[104:107], v[164:167]
v_accvgpr_read_b32 v23, a15
v_mul_f32 v16, s91, v16
v_mfma_f32_16x16x32_bf16 v[172:175], a[152:155], a[104:107], v[172:175]
buffer_load_dwordx4 v6, s[12:15], s64 offen offset:1024 lds
v_mfma_f32_16x16x32_bf16 v[172:175], a[156:159], a[108:111], v[172:175]
v_mul_f32 v17, s91, v17
v_mul_f32 v18, s91, v18
v_mfma_f32_16x16x32_bf16 v[56:59], a[148:151], a[108:111], v[56:59]
v_mul_f32 v19, s91, v19
v_mul_f32 v20, s91, v20
v_mfma_f32_16x16x32_bf16 v[56:59], a[144:147], a[104:107], v[56:59]
v_mul_f32 v21, s91, v21
v_mul_f32 v22, s91, v22
v_mfma_f32_16x16x32_bf16 v[180:183], a[136:139], a[104:107], v[180:183]
v_mul_f32 v23, s91, v23
v_cvt_pk_bf16_f32 v16, v16, v17
v_mfma_f32_16x16x32_bf16 v[180:183], a[140:143], a[108:111], v[180:183]
v_cvt_pk_bf16_f32 v17, v18, v19
v_cvt_pk_bf16_f32 v18, v20, v21
v_mfma_f32_16x16x32_bf16 v[188:191], a[132:135], a[108:111], v[188:191]
v_cvt_pk_bf16_f32 v19, v22, v23
v_accvgpr_write_b32 a8, v16
v_mfma_f32_16x16x32_bf16 v[188:191], a[128:131], a[104:107], v[188:191]
s_waitcnt lgkmcnt(0)
v_accvgpr_write_b32 a9, v17
v_accvgpr_write_b32 a10, v18
v_mfma_f32_16x16x32_bf16 v[196:199], a[160:163], a[80:83], v[196:199]
s_waitcnt vmcnt(17)
v_accvgpr_write_b32 a11, v19
v_accvgpr_read_b32 v16, a16
v_mfma_f32_16x16x32_bf16 v[196:199], a[164:167], a[84:87], v[196:199]
s_barrier
v_mfma_f32_16x16x32_bf16 v[64:67], a[172:175], a[84:87], v[64:67]
s_add_u32 s53, s87, 0
ds_read_b64_tr_b16 a[128:129], v11 offset:0
ds_read_b64_tr_b16 a[130:131], v11 offset:512
v_mfma_f32_16x16x32_bf16 v[64:67], a[168:171], a[80:83], v[64:67]
s_add_u32 m0, s77, 49152
s_add_u32 s64, s76, 128
v_accvgpr_read_b32 v17, a17
v_mfma_f32_16x16x32_bf16 v[204:207], a[176:179], a[80:83], v[204:207]
buffer_load_dwordx4 v7, s[20:23], s64 offen lds
v_mfma_f32_16x16x32_bf16 v[204:207], a[180:183], a[84:87], v[204:207]
ds_read_b64_tr_b16 a[132:133], v11 offset:4096
ds_read_b64_tr_b16 a[134:135], v11 offset:4608
v_mfma_f32_16x16x32_bf16 v[212:215], a[188:191], a[84:87], v[212:215]
ds_read_b64_tr_b16 a[136:137], v12 offset:0
ds_read_b64_tr_b16 a[138:139], v12 offset:512
v_mfma_f32_16x16x32_bf16 v[212:215], a[184:187], a[80:83], v[212:215]
ds_read_b64_tr_b16 a[140:141], v12 offset:4096
ds_read_b64_tr_b16 a[142:143], v12 offset:4608
v_mfma_f32_16x16x32_bf16 v[72:75], a[112:115], a[80:83], v[72:75]
buffer_store_dwordx4 v[168:171], v4, s[24:27], s53 offen offset:1024 sc1
v_mfma_f32_16x16x32_bf16 v[72:75], a[116:119], a[84:87], v[72:75]
ds_read_b64_tr_b16 a[144:145], v13 offset:0
ds_read_b64_tr_b16 a[146:147], v13 offset:512
v_mfma_f32_16x16x32_bf16 v[220:223], a[124:127], a[84:87], v[220:223]
buffer_load_dwordx4 v8, s[20:23], s64 offen offset:1024 lds
v_mfma_f32_16x16x32_bf16 v[220:223], a[120:123], a[80:83], v[220:223]
ds_read_b64_tr_b16 a[148:149], v13 offset:4096
ds_read_b64_tr_b16 a[150:151], v13 offset:4608
v_mfma_f32_16x16x32_bf16 a[32:35], a[120:123], a[88:91], a[32:35]
v_accvgpr_read_b32 v18, a18
v_accvgpr_read_b32 v19, a19
v_mfma_f32_16x16x32_bf16 a[32:35], a[124:127], a[92:95], a[32:35]
ds_read_b64_tr_b16 a[152:153], v14 offset:0
ds_read_b64_tr_b16 a[154:155], v14 offset:512
v_mfma_f32_16x16x32_bf16 a[36:39], a[116:119], a[92:95], a[36:39]
s_add_u32 m0, s80, 49152
s_add_u32 s64, s79, 2048
v_accvgpr_read_b32 v20, a20
v_mfma_f32_16x16x32_bf16 a[36:39], a[112:115], a[88:91], a[36:39]
ds_read_b64_tr_b16 a[156:157], v14 offset:4096
ds_read_b64_tr_b16 a[158:159], v14 offset:4608
v_mfma_f32_16x16x32_bf16 v[228:231], a[184:187], a[88:91], v[228:231]
buffer_load_dwordx4 v4, s[24:27], s64 offen sc1 lds
v_mfma_f32_16x16x32_bf16 v[228:231], a[188:191], a[92:95], v[228:231]
s_xor_b32 s65, s70, 384
s_add_u32 s71, s68, s65
s_add_u32 s72, s69, s65
v_mfma_f32_16x16x32_bf16 a[40:43], a[180:183], a[92:95], a[40:43]
ds_read_b128 a[64:67], v4 offset:8192
v_accvgpr_read_b32 v21, a21
v_mfma_f32_16x16x32_bf16 a[40:43], a[176:179], a[88:91], a[40:43]
v_accvgpr_read_b32 v22, a22
v_accvgpr_read_b32 v23, a23
v_mfma_f32_16x16x32_bf16 a[44:47], a[168:171], a[88:91], a[44:47]
s_add_u32 m0, s73, 0
s_add_u32 s64, s71, 0
ds_read_b128 a[80:83], v9 offset:0
v_mfma_f32_16x16x32_bf16 a[44:47], a[172:175], a[92:95], a[44:47]
v_mul_f32 v16, s91, v16
v_mul_f32 v17, s91, v17
v_mfma_f32_16x16x32_bf16 v[80:83], a[164:167], a[92:95], v[80:83]
buffer_load_dwordx4 v5, s[12:15], s64 offen lds
v_mfma_f32_16x16x32_bf16 v[80:83], a[160:163], a[88:91], v[80:83]
ds_read_b128 a[68:71], v4 offset:10240
v_mul_f32 v18, s91, v18
v_mfma_f32_16x16x32_bf16 a[48:51], a[160:163], a[96:99], a[48:51]
ds_read_b128 a[84:87], v10 offset:0
v_mul_f32 v19, s91, v19
v_mfma_f32_16x16x32_bf16 a[48:51], a[164:167], a[100:103], a[48:51]
v_mul_f32 v20, s91, v20
v_mul_f32 v21, s91, v21
v_mfma_f32_16x16x32_bf16 a[52:55], a[172:175], a[100:103], a[52:55]
v_mul_f32 v22, s91, v22
v_mul_f32 v23, s91, v23
v_mfma_f32_16x16x32_bf16 a[52:55], a[168:171], a[96:99], a[52:55]
ds_read_b128 a[72:75], v4 offset:9216
v_cvt_pk_bf16_f32 v16, v16, v17
v_mfma_f32_16x16x32_bf16 a[56:59], a[176:179], a[96:99], a[56:59]
buffer_load_dwordx4 v6, s[12:15], s64 offen offset:1024 lds
v_mfma_f32_16x16x32_bf16 a[56:59], a[180:183], a[100:103], a[56:59]
s_add_u32 s53, s87, 4096
ds_read_b128 a[88:91], v9 offset:2048
v_cvt_pk_bf16_f32 v17, v18, v19
v_mfma_f32_16x16x32_bf16 a[60:63], a[188:191], a[100:103], a[60:63]
buffer_store_dwordx4 v[176:179], v4, s[24:27], s53 offen offset:0 sc1
v_mfma_f32_16x16x32_bf16 a[60:63], a[184:187], a[96:99], a[60:63]
ds_read_b128 a[76:79], v4 offset:11264
v_cvt_pk_bf16_f32 v18, v20, v21
v_mfma_f32_16x16x32_bf16 v[236:239], a[112:115], a[96:99], v[236:239]
s_add_u32 m0, s73, 2048
s_add_u32 s64, s71, 18432
v_cvt_pk_bf16_f32 v19, v22, v23
v_mfma_f32_16x16x32_bf16 v[236:239], a[116:119], a[100:103], v[236:239]
ds_read_b128 a[92:95], v10 offset:2048
v_accvgpr_write_b32 a16, v16
v_mfma_f32_16x16x32_bf16 a[192:195], a[124:127], a[100:103], a[192:195]
buffer_load_dwordx4 v5, s[12:15], s64 offen lds
v_mfma_f32_16x16x32_bf16 a[192:195], a[120:123], a[96:99], a[192:195]
v_accvgpr_write_b32 a17, v17
v_accvgpr_write_b32 a18, v18
v_mfma_f32_16x16x32_bf16 a[196:199], a[120:123], a[104:107], a[196:199]
v_accvgpr_write_b32 a19, v19
v_accvgpr_read_b32 v16, a24
v_mfma_f32_16x16x32_bf16 a[196:199], a[124:127], a[108:111], a[196:199]
v_accvgpr_read_b32 v17, a25
v_accvgpr_read_b32 v18, a26
v_mfma_f32_16x16x32_bf16 a[200:203], a[116:119], a[108:111], a[200:203]
v_accvgpr_read_b32 v19, a27
v_accvgpr_read_b32 v20, a28
v_mfma_f32_16x16x32_bf16 a[200:203], a[112:115], a[104:107], a[200:203]
v_accvgpr_read_b32 v21, a29
v_accvgpr_read_b32 v22, a30
v_mfma_f32_16x16x32_bf16 v[244:247], a[184:187], a[104:107], v[244:247]
buffer_load_dwordx4 v6, s[12:15], s64 offen offset:1024 lds
v_mfma_f32_16x16x32_bf16 v[244:247], a[188:191], a[108:111], v[244:247]
v_accvgpr_read_b32 v23, a31
v_mul_f32 v16, s91, v16
v_mfma_f32_16x16x32_bf16 a[204:207], a[180:183], a[108:111], a[204:207]
v_mul_f32 v17, s91, v17
v_mul_f32 v18, s91, v18
v_mfma_f32_16x16x32_bf16 a[204:207], a[176:179], a[104:107], a[204:207]
v_mul_f32 v19, s91, v19
v_mul_f32 v20, s91, v20
v_mfma_f32_16x16x32_bf16 a[208:211], a[168:171], a[104:107], a[208:211]
v_mul_f32 v21, s91, v21
v_mul_f32 v22, s91, v22
v_mfma_f32_16x16x32_bf16 a[208:211], a[172:175], a[108:111], a[208:211]
v_mul_f32 v23, s91, v23
v_cvt_pk_bf16_f32 v16, v16, v17
v_mfma_f32_16x16x32_bf16 v[88:91], a[164:167], a[108:111], v[88:91]
v_cvt_pk_bf16_f32 v17, v18, v19
v_cvt_pk_bf16_f32 v18, v20, v21
v_mfma_f32_16x16x32_bf16 v[88:91], a[160:163], a[104:107], v[88:91]
s_waitcnt lgkmcnt(0)
v_cvt_pk_bf16_f32 v19, v22, v23
v_accvgpr_write_b32 a24, v16
v_mfma_f32_16x16x32_bf16 v[36:39], a[128:131], a[80:83], v[36:39]
s_waitcnt vmcnt(23)
v_accvgpr_write_b32 a25, v17
v_accvgpr_write_b32 a26, v18
v_mfma_f32_16x16x32_bf16 v[36:39], a[132:135], a[84:87], v[36:39]
s_barrier
v_mfma_f32_16x16x32_bf16 v[44:47], a[140:143], a[84:87], v[44:47]
ds_read_b128 a[96:99], v9 offset:4096
v_accvgpr_write_b32 a27, v19
v_mfma_f32_16x16x32_bf16 v[44:47], a[136:139], a[80:83], v[44:47]
s_xor_b32 s75, s93, 3
s_lshl_b32 s76, s75, 19
s_add_u32 s76, s76, s74
v_mfma_f32_16x16x32_bf16 v[32:35], a[144:147], a[80:83], v[32:35]
s_lshl_b32 s79, s75, 13
s_add_u32 s79, s79, s78
ds_read_b128 a[100:103], v10 offset:4096
v_mfma_f32_16x16x32_bf16 v[32:35], a[148:151], a[84:87], v[32:35]
s_add_u32 m0, s77, 0
s_add_u32 s64, s76, 0
ds_read_b128 a[104:107], v9 offset:6144
v_mfma_f32_16x16x32_bf16 v[52:55], a[156:159], a[84:87], v[52:55]
buffer_load_dwordx4 v7, s[20:23], s64 offen lds
v_mfma_f32_16x16x32_bf16 v[52:55], a[152:155], a[80:83], v[52:55]
s_add_u32 s53, s87, 4096
ds_read_b64_tr_b16 a[160:161], v11 offset:16384
ds_read_b64_tr_b16 a[162:163], v11 offset:16896
v_mfma_f32_16x16x32_bf16 v[60:63], a[64:67], a[80:83], v[60:63]
buffer_store_dwordx4 v[184:187], v4, s[24:27], s53 offen offset:1024 sc1
v_mfma_f32_16x16x32_bf16 v[60:63], a[68:71], a[84:87], v[60:63]
ds_read_b128 a[108:111], v10 offset:6144
v_accvgpr_write_b32 a4, v248
v_mfma_f32_16x16x32_bf16 v[68:71], a[76:79], a[84:87], v[68:71]
buffer_load_dwordx4 v8, s[20:23], s64 offen offset:1024 lds
v_mfma_f32_16x16x32_bf16 v[68:71], a[72:75], a[80:83], v[68:71]
ds_read_b64_tr_b16 a[164:165], v11 offset:20480
ds_read_b64_tr_b16 a[166:167], v11 offset:20992
v_mfma_f32_16x16x32_bf16 v[76:79], a[72:75], a[88:91], v[76:79]
v_add_u32 v9, 32768, v9
v_add_u32 v10, 32768, v10
v_mfma_f32_16x16x32_bf16 v[76:79], a[76:79], a[92:95], v[76:79]
ds_read_b64_tr_b16 a[168:169], v12 offset:16384
ds_read_b64_tr_b16 a[170:171], v12 offset:16896
v_mfma_f32_16x16x32_bf16 v[84:87], a[68:71], a[92:95], v[84:87]
s_add_u32 m0, s80, 0
s_add_u32 s64, s79, 0
v_accvgpr_write_b32 a5, v249
v_mfma_f32_16x16x32_bf16 v[84:87], a[64:67], a[88:91], v[84:87]
ds_read_b64_tr_b16 a[172:173], v12 offset:20480
ds_read_b64_tr_b16 a[174:175], v12 offset:20992
v_mfma_f32_16x16x32_bf16 v[92:95], a[152:155], a[88:91], v[92:95]
buffer_load_dwordx4 v4, s[24:27], s64 offen sc1 lds
v_mfma_f32_16x16x32_bf16 v[92:95], a[156:159], a[92:95], v[92:95]
v_accvgpr_write_b32 a6, v250
v_accvgpr_write_b32 a7, v251
v_mfma_f32_16x16x32_bf16 v[40:43], a[148:151], a[92:95], v[40:43]
ds_read_b64_tr_b16 a[176:177], v13 offset:16384
ds_read_b64_tr_b16 a[178:179], v13 offset:16896
v_mfma_f32_16x16x32_bf16 v[40:43], a[144:147], a[88:91], v[40:43]
v_accvgpr_write_b32 a12, v240
v_accvgpr_write_b32 a13, v241
v_mfma_f32_16x16x32_bf16 v[100:103], a[136:139], a[88:91], v[100:103]
s_add_u32 m0, s73, 4096
s_add_u32 s64, s72, 0
v_accvgpr_write_b32 a14, v242
v_mfma_f32_16x16x32_bf16 v[100:103], a[140:143], a[92:95], v[100:103]
ds_read_b64_tr_b16 a[180:181], v13 offset:20480
ds_read_b64_tr_b16 a[182:183], v13 offset:20992
v_mfma_f32_16x16x32_bf16 v[108:111], a[132:135], a[92:95], v[108:111]
buffer_load_dwordx4 v5, s[12:15], s64 offen lds
v_mfma_f32_16x16x32_bf16 v[108:111], a[128:131], a[88:91], v[108:111]
s_waitcnt lgkmcnt(14)
ds_read_b64_tr_b16 a[184:185], v14 offset:16384
ds_read_b64_tr_b16 a[186:187], v14 offset:16896
v_mfma_f32_16x16x32_bf16 v[116:119], a[128:131], a[96:99], v[116:119]
ds_read_b64_tr_b16 a[188:189], v14 offset:20480
ds_read_b64_tr_b16 a[190:191], v14 offset:20992
v_mfma_f32_16x16x32_bf16 v[116:119], a[132:135], a[100:103], v[116:119]
v_accvgpr_write_b32 a15, v243
v_accvgpr_write_b32 a20, v232
v_mfma_f32_16x16x32_bf16 v[124:127], a[140:143], a[100:103], v[124:127]
v_accvgpr_write_b32 a21, v233
v_accvgpr_write_b32 a22, v234
v_mfma_f32_16x16x32_bf16 v[124:127], a[136:139], a[96:99], v[124:127]
ds_read_b128 a[112:115], v4 offset:24576
v_accvgpr_write_b32 a23, v235
v_mfma_f32_16x16x32_bf16 v[132:135], a[144:147], a[96:99], v[132:135]
buffer_load_dwordx4 v6, s[12:15], s64 offen offset:1024 lds
v_mfma_f32_16x16x32_bf16 v[132:135], a[148:151], a[100:103], v[132:135]
ds_read_b128 a[116:119], v4 offset:26624
v_accvgpr_write_b32 a28, v224
v_mfma_f32_16x16x32_bf16 v[140:143], a[156:159], a[100:103], v[140:143]
v_accvgpr_write_b32 a29, v225
v_accvgpr_write_b32 a30, v226
v_mfma_f32_16x16x32_bf16 v[140:143], a[152:155], a[96:99], v[140:143]
ds_read_b128 a[120:123], v4 offset:25600
v_accvgpr_write_b32 a31, v227
v_mfma_f32_16x16x32_bf16 v[148:151], a[64:67], a[96:99], v[148:151]
s_add_u32 m0, s73, 6144
s_add_u32 s64, s72, 18432
v_accvgpr_read_b32 v252, a32
v_mfma_f32_16x16x32_bf16 v[148:151], a[68:71], a[100:103], v[148:151]
ds_read_b128 a[124:127], v4 offset:27648
v_accvgpr_read_b32 v253, a33
v_mfma_f32_16x16x32_bf16 v[48:51], a[76:79], a[100:103], v[48:51]
buffer_load_dwordx4 v5, s[12:15], s64 offen lds
v_mfma_f32_16x16x32_bf16 v[48:51], a[72:75], a[96:99], v[48:51]
s_waitcnt lgkmcnt(15)
s_add_u32 s53, s87, 262144
v_accvgpr_read_b32 v254, a34
v_mfma_f32_16x16x32_bf16 v[156:159], a[72:75], a[104:107], v[156:159]
buffer_store_dwordx4 v[192:195], v4, s[24:27], s53 offen offset:0 sc1
v_mfma_f32_16x16x32_bf16 v[156:159], a[76:79], a[108:111], v[156:159]
v_accvgpr_read_b32 v255, a35
v_accvgpr_read_b32 v160, a36
v_mfma_f32_16x16x32_bf16 v[164:167], a[68:71], a[108:111], v[164:167]
v_accvgpr_read_b32 v161, a37
v_accvgpr_read_b32 v162, a38
v_mfma_f32_16x16x32_bf16 v[164:167], a[64:67], a[104:107], v[164:167]
v_accvgpr_read_b32 v163, a39
v_accvgpr_read_b32 v168, a40
v_mfma_f32_16x16x32_bf16 v[172:175], a[152:155], a[104:107], v[172:175]
buffer_load_dwordx4 v6, s[12:15], s64 offen offset:1024 lds
v_mfma_f32_16x16x32_bf16 v[172:175], a[156:159], a[108:111], v[172:175]
v_accvgpr_read_b32 v169, a41
v_accvgpr_read_b32 v170, a42
v_mfma_f32_16x16x32_bf16 v[56:59], a[148:151], a[108:111], v[56:59]
v_accvgpr_read_b32 v171, a43
v_accvgpr_read_b32 v176, a44
v_mfma_f32_16x16x32_bf16 v[56:59], a[144:147], a[104:107], v[56:59]
v_accvgpr_read_b32 v177, a45
v_accvgpr_read_b32 v178, a46
v_mfma_f32_16x16x32_bf16 v[180:183], a[136:139], a[104:107], v[180:183]
v_accvgpr_read_b32 v179, a47
v_accvgpr_read_b32 v184, a48
v_mfma_f32_16x16x32_bf16 v[180:183], a[140:143], a[108:111], v[180:183]
v_accvgpr_read_b32 v185, a49
v_accvgpr_read_b32 v186, a50
v_mfma_f32_16x16x32_bf16 v[188:191], a[132:135], a[108:111], v[188:191]
v_accvgpr_read_b32 v187, a51
v_accvgpr_read_b32 v248, a52
v_mfma_f32_16x16x32_bf16 v[188:191], a[128:131], a[104:107], v[188:191]
s_waitcnt lgkmcnt(0)
v_accvgpr_read_b32 v249, a53
v_accvgpr_read_b32 v250, a54
v_mfma_f32_16x16x32_bf16 v[196:199], a[160:163], a[80:83], v[196:199]
s_waitcnt vmcnt(18)
v_accvgpr_read_b32 v251, a55
v_accvgpr_read_b32 v240, a56
v_mfma_f32_16x16x32_bf16 v[196:199], a[164:167], a[84:87], v[196:199]
s_barrier
v_mfma_f32_16x16x32_bf16 v[64:67], a[172:175], a[84:87], v[64:67]
ds_read_b64_tr_b16 a[128:129], v11 offset:32768
ds_read_b64_tr_b16 a[130:131], v11 offset:33280
v_mfma_f32_16x16x32_bf16 v[64:67], a[168:171], a[80:83], v[64:67]
s_add_u32 m0, s77, 16384
s_add_u32 s64, s76, 128
v_accvgpr_read_b32 v241, a57
v_mfma_f32_16x16x32_bf16 v[204:207], a[176:179], a[80:83], v[204:207]
buffer_load_dwordx4 v7, s[20:23], s64 offen lds
v_mfma_f32_16x16x32_bf16 v[204:207], a[180:183], a[84:87], v[204:207]
ds_read_b64_tr_b16 a[132:133], v11 offset:36864
ds_read_b64_tr_b16 a[134:135], v11 offset:37376
v_mfma_f32_16x16x32_bf16 v[212:215], a[188:191], a[84:87], v[212:215]
ds_read_b64_tr_b16 a[136:137], v12 offset:32768
ds_read_b64_tr_b16 a[138:139], v12 offset:33280
v_mfma_f32_16x16x32_bf16 v[212:215], a[184:187], a[80:83], v[212:215]
L_PAD5:
s_cbranch_execz L_PAD9
ds_read_b64_tr_b16 a[140:141], v12 offset:36864
ds_read_b64_tr_b16 a[142:143], v12 offset:37376
v_mfma_f32_16x16x32_bf16 v[72:75], a[112:115], a[80:83], v[72:75]
v_accvgpr_read_b32 v242, a58
v_accvgpr_read_b32 v243, a59
v_mfma_f32_16x16x32_bf16 v[72:75], a[116:119], a[84:87], v[72:75]
ds_read_b64_tr_b16 a[144:145], v13 offset:32768
ds_read_b64_tr_b16 a[146:147], v13 offset:33280
v_mfma_f32_16x16x32_bf16 v[220:223], a[124:127], a[84:87], v[220:223]
buffer_load_dwordx4 v8, s[20:23], s64 offen offset:1024 lds
v_mfma_f32_16x16x32_bf16 v[220:223], a[120:123], a[80:83], v[220:223]
ds_read_b64_tr_b16 a[148:149], v13 offset:36864
ds_read_b64_tr_b16 a[150:151], v13 offset:37376
v_mfma_f32_16x16x32_bf16 v[252:255], a[120:123], a[88:91], v[252:255]
v_accvgpr_read_b32 v232, a60
v_accvgpr_read_b32 v233, a61
v_mfma_f32_16x16x32_bf16 v[252:255], a[124:127], a[92:95], v[252:255]
s_add_u32 s53, s87, 262144
ds_read_b64_tr_b16 a[152:153], v14 offset:32768
ds_read_b64_tr_b16 a[154:155], v14 offset:33280
v_mfma_f32_16x16x32_bf16 v[160:163], a[116:119], a[92:95], v[160:163]
s_add_u32 m0, s80, 16384
s_add_u32 s64, s79, 2048
v_accvgpr_read_b32 v234, a62
v_mfma_f32_16x16x32_bf16 v[160:163], a[112:115], a[88:91], v[160:163]
ds_read_b64_tr_b16 a[156:157], v14 offset:36864
ds_read_b64_tr_b16 a[158:159], v14 offset:37376
v_mfma_f32_16x16x32_bf16 v[228:231], a[184:187], a[88:91], v[228:231]
buffer_load_dwordx4 v4, s[24:27], s64 offen sc1 lds
v_mfma_f32_16x16x32_bf16 v[228:231], a[188:191], a[92:95], v[228:231]
s_xor_b32 s65, s70, 512
s_add_u32 s71, s68, s65
s_add_u32 s72, s69, s65
v_mfma_f32_16x16x32_bf16 v[168:171], a[180:183], a[92:95], v[168:171]
ds_read_b128 a[64:67], v4 offset:40960
v_accvgpr_read_b32 v235, a63
v_mfma_f32_16x16x32_bf16 v[168:171], a[176:179], a[88:91], v[168:171]
buffer_store_dwordx4 v[200:203], v4, s[24:27], s53 offen offset:1024 sc1
v_mfma_f32_16x16x32_bf16 v[176:179], a[168:171], a[88:91], v[176:179]
s_add_u32 m0, s73, 32768
s_add_u32 s64, s71, 0
ds_read_b128 a[80:83], v9 offset:0
v_mfma_f32_16x16x32_bf16 v[176:179], a[172:175], a[92:95], v[176:179]
v_accvgpr_read_b32 v224, a192
v_accvgpr_read_b32 v225, a193
v_mfma_f32_16x16x32_bf16 v[80:83], a[164:167], a[92:95], v[80:83]
buffer_load_dwordx4 v5, s[12:15], s64 offen lds
v_mfma_f32_16x16x32_bf16 v[80:83], a[160:163], a[88:91], v[80:83]
ds_read_b128 a[68:71], v4 offset:43008
v_accvgpr_read_b32 v226, a194
v_mfma_f32_16x16x32_bf16 v[184:187], a[160:163], a[96:99], v[184:187]
ds_read_b128 a[84:87], v10 offset:0
v_accvgpr_read_b32 v227, a195
v_mfma_f32_16x16x32_bf16 v[184:187], a[164:167], a[100:103], v[184:187]
v_accvgpr_read_b32 v192, a204
v_accvgpr_read_b32 v193, a205
v_mfma_f32_16x16x32_bf16 v[248:251], a[172:175], a[100:103], v[248:251]
v_accvgpr_read_b32 v194, a206
v_accvgpr_read_b32 v195, a207
v_mfma_f32_16x16x32_bf16 v[248:251], a[168:171], a[96:99], v[248:251]
ds_read_b128 a[72:75], v4 offset:41984
v_accvgpr_read_b32 v200, a208
v_mfma_f32_16x16x32_bf16 v[240:243], a[176:179], a[96:99], v[240:243]
buffer_load_dwordx4 v6, s[12:15], s64 offen offset:1024 lds
v_mfma_f32_16x16x32_bf16 v[240:243], a[180:183], a[100:103], v[240:243]
ds_read_b128 a[88:91], v9 offset:2048
v_accvgpr_read_b32 v201, a209
v_mfma_f32_16x16x32_bf16 v[232:235], a[188:191], a[100:103], v[232:235]
v_accvgpr_read_b32 v202, a210
v_accvgpr_read_b32 v203, a211
v_mfma_f32_16x16x32_bf16 v[232:235], a[184:187], a[96:99], v[232:235]
ds_read_b128 a[76:79], v4 offset:44032
v_and_b32 v28, 31, v1
v_mfma_f32_16x16x32_bf16 v[236:239], a[112:115], a[96:99], v[236:239]
s_add_u32 m0, s73, 34816
s_add_u32 s64, s71, 18432
v_lshlrev_b32 v28, 2, v28
v_mfma_f32_16x16x32_bf16 v[236:239], a[116:119], a[100:103], v[236:239]
ds_read_b128 a[92:95], v10 offset:2048
v_mfma_f32_16x16x32_bf16 v[224:227], a[124:127], a[100:103], v[224:227]
buffer_load_dwordx4 v5, s[12:15], s64 offen lds
v_mfma_f32_16x16x32_bf16 v[224:227], a[120:123], a[96:99], v[224:227]
buffer_load_dword v30, v28, s[40:43], 0 offen sc1
v_mfma_f32_16x16x32_bf16 a[196:199], a[120:123], a[104:107], a[196:199]
v_mfma_f32_16x16x32_bf16 a[196:199], a[124:127], a[108:111], a[196:199]
v_mfma_f32_16x16x32_bf16 a[200:203], a[116:119], a[108:111], a[200:203]
v_mfma_f32_16x16x32_bf16 a[200:203], a[112:115], a[104:107], a[200:203]
v_mfma_f32_16x16x32_bf16 v[244:247], a[184:187], a[104:107], v[244:247]
buffer_load_dwordx4 v6, s[12:15], s64 offen offset:1024 lds
v_mfma_f32_16x16x32_bf16 v[244:247], a[188:191], a[108:111], v[244:247]
s_add_u32 s53, s87, 266240
v_mfma_f32_16x16x32_bf16 v[192:195], a[180:183], a[108:111], v[192:195]
buffer_store_dwordx4 v[208:211], v4, s[24:27], s53 offen offset:0 sc1
v_mfma_f32_16x16x32_bf16 v[192:195], a[176:179], a[104:107], v[192:195]
v_mfma_f32_16x16x32_bf16 v[200:203], a[168:171], a[104:107], v[200:203]
v_mfma_f32_16x16x32_bf16 v[200:203], a[172:175], a[108:111], v[200:203]
v_accvgpr_read_b32 v208, a196
v_accvgpr_read_b32 v209, a197
v_mfma_f32_16x16x32_bf16 v[88:91], a[164:167], a[108:111], v[88:91]
v_accvgpr_read_b32 v210, a198
v_accvgpr_read_b32 v211, a199
v_mfma_f32_16x16x32_bf16 v[88:91], a[160:163], a[104:107], v[88:91]
s_waitcnt lgkmcnt(0)
v_mfma_f32_16x16x32_bf16 v[36:39], a[128:131], a[80:83], v[36:39]
s_waitcnt vmcnt(24)
v_mfma_f32_16x16x32_bf16 v[36:39], a[132:135], a[84:87], v[36:39]
s_barrier
v_mfma_f32_16x16x32_bf16 v[44:47], a[140:143], a[84:87], v[44:47]
ds_read_b128 a[96:99], v9 offset:4096
v_mfma_f32_16x16x32_bf16 v[44:47], a[136:139], a[80:83], v[44:47]
s_xor_b32 s75, s93, 4
s_lshl_b32 s76, s75, 19
s_add_u32 s76, s76, s74
v_mfma_f32_16x16x32_bf16 v[32:35], a[144:147], a[80:83], v[32:35]
s_lshl_b32 s79, s75, 13
s_add_u32 s79, s79, s78
ds_read_b128 a[100:103], v10 offset:4096
v_mfma_f32_16x16x32_bf16 v[32:35], a[148:151], a[84:87], v[32:35]
s_add_u32 m0, s77, 32768
s_add_u32 s64, s76, 0
ds_read_b128 a[104:107], v9 offset:6144
v_mfma_f32_16x16x32_bf16 v[52:55], a[156:159], a[84:87], v[52:55]
buffer_load_dwordx4 v7, s[20:23], s64 offen lds
v_mfma_f32_16x16x32_bf16 v[52:55], a[152:155], a[80:83], v[52:55]
ds_read_b64_tr_b16 a[160:161], v11 offset:49152
ds_read_b64_tr_b16 a[162:163], v11 offset:49664
v_mfma_f32_16x16x32_bf16 v[60:63], a[64:67], a[80:83], v[60:63]
v_mfma_f32_16x16x32_bf16 v[60:63], a[68:71], a[84:87], v[60:63]
ds_read_b128 a[108:111], v10 offset:6144
v_mfma_f32_16x16x32_bf16 v[68:71], a[76:79], a[84:87], v[68:71]
buffer_load_dwordx4 v8, s[20:23], s64 offen offset:1024 lds
v_mfma_f32_16x16x32_bf16 v[68:71], a[72:75], a[80:83], v[68:71]
ds_read_b64_tr_b16 a[164:165], v11 offset:53248
ds_read_b64_tr_b16 a[166:167], v11 offset:53760
v_mfma_f32_16x16x32_bf16 v[76:79], a[72:75], a[88:91], v[76:79]
v_add_u32 v9, -65536, v9
v_add_u32 v10, -65536, v10
v_mfma_f32_16x16x32_bf16 v[76:79], a[76:79], a[92:95], v[76:79]
ds_read_b64_tr_b16 a[168:169], v12 offset:49152
ds_read_b64_tr_b16 a[170:171], v12 offset:49664
v_mfma_f32_16x16x32_bf16 v[84:87], a[68:71], a[92:95], v[84:87]
s_add_u32 m0, s80, 32768
s_add_u32 s64, s79, 0
v_mfma_f32_16x16x32_bf16 v[84:87], a[64:67], a[88:91], v[84:87]
ds_read_b64_tr_b16 a[172:173], v12 offset:53248
ds_read_b64_tr_b16 a[174:175], v12 offset:53760
v_mfma_f32_16x16x32_bf16 v[92:95], a[152:155], a[88:91], v[92:95]
buffer_load_dwordx4 v4, s[24:27], s64 offen sc1 lds
v_mfma_f32_16x16x32_bf16 v[92:95], a[156:159], a[92:95], v[92:95]
v_mfma_f32_16x16x32_bf16 v[40:43], a[148:151], a[92:95], v[40:43]
ds_read_b64_tr_b16 a[176:177], v13 offset:49152
ds_read_b64_tr_b16 a[178:179], v13 offset:49664
v_mfma_f32_16x16x32_bf16 v[40:43], a[144:147], a[88:91], v[40:43]
s_add_u32 s53, s87, 266240
v_mfma_f32_16x16x32_bf16 v[100:103], a[136:139], a[88:91], v[100:103]
s_add_u32 m0, s73, 36864
s_add_u32 s64, s72, 0
v_mfma_f32_16x16x32_bf16 v[100:103], a[140:143], a[92:95], v[100:103]
ds_read_b64_tr_b16 a[180:181], v13 offset:53248
ds_read_b64_tr_b16 a[182:183], v13 offset:53760
v_mfma_f32_16x16x32_bf16 v[108:111], a[132:135], a[92:95], v[108:111]
buffer_load_dwordx4 v5, s[12:15], s64 offen lds
v_mfma_f32_16x16x32_bf16 v[108:111], a[128:131], a[88:91], v[108:111]
s_waitcnt lgkmcnt(14)
ds_read_b64_tr_b16 a[184:185], v14 offset:49152
ds_read_b64_tr_b16 a[186:187], v14 offset:49664
v_mfma_f32_16x16x32_bf16 v[116:119], a[128:131], a[96:99], v[116:119]
s_waitcnt vmcnt(6)
ds_read_b64_tr_b16 a[188:189], v14 offset:53248
ds_read_b64_tr_b16 a[190:191], v14 offset:53760
v_mfma_f32_16x16x32_bf16 v[116:119], a[132:135], a[100:103], v[116:119]
buffer_store_dwordx4 v[216:219], v4, s[24:27], s53 offen offset:1024 sc1
v_mfma_f32_16x16x32_bf16 v[124:127], a[140:143], a[100:103], v[124:127]
v_cmp_gt_u32 vcc, 1, v30
v_mfma_f32_16x16x32_bf16 v[124:127], a[136:139], a[96:99], v[124:127]
ds_read_b128 a[112:115], v4 offset:57344
v_accvgpr_read_b32 v216, a200
v_mfma_f32_16x16x32_bf16 v[132:135], a[144:147], a[96:99], v[132:135]
buffer_load_dwordx4 v6, s[12:15], s64 offen offset:1024 lds
v_mfma_f32_16x16x32_bf16 v[132:135], a[148:151], a[100:103], v[132:135]
ds_read_b128 a[116:119], v4 offset:59392
v_accvgpr_read_b32 v217, a201
v_mfma_f32_16x16x32_bf16 v[140:143], a[156:159], a[100:103], v[140:143]
v_accvgpr_read_b32 v218, a202
v_accvgpr_read_b32 v219, a203
v_mfma_f32_16x16x32_bf16 v[140:143], a[152:155], a[96:99], v[140:143]
s_lshr_b32 s84, s7, 1
s_and_b32 s85, s7, 1
ds_read_b128 a[120:123], v4 offset:58368
v_mfma_f32_16x16x32_bf16 v[148:151], a[64:67], a[96:99], v[148:151]
s_add_u32 m0, s73, 38912
s_add_u32 s64, s72, 18432
s_xor_b32 s52, s5, 0
v_mfma_f32_16x16x32_bf16 v[148:151], a[68:71], a[100:103], v[148:151]
s_lshl1_add_u32 s85, s52, s85
s_and_b32 s86, s6, 3
ds_read_b128 a[124:127], v4 offset:60416
v_mfma_f32_16x16x32_bf16 v[48:51], a[76:79], a[100:103], v[48:51]
buffer_load_dwordx4 v5, s[12:15], s64 offen lds
v_mfma_f32_16x16x32_bf16 v[48:51], a[72:75], a[96:99], v[48:51]
s_waitcnt lgkmcnt(15)
s_lshl_b32 s83, s3, 13
s_add_u32 s83, s83, 131072
v_mfma_f32_16x16x32_bf16 v[156:159], a[72:75], a[104:107], v[156:159]
s_cbranch_vccnz CK_ZA
CK_ZA_R:
v_mfma_f32_16x16x32_bf16 v[156:159], a[76:79], a[108:111], v[156:159]
s_mul_i32 s52, s2, 5462
s_lshr_b32 s52, s52, 16
s_mul_i32 s54, s52, 12
v_mfma_f32_16x16x32_bf16 v[164:167], a[68:71], a[108:111], v[164:167]
s_sub_u32 s54, s2, s54
s_mul_i32 s54, s54, 3
s_add_u32 s54, s54, s3
v_mfma_f32_16x16x32_bf16 v[164:167], a[64:67], a[104:107], v[164:167]
s_mul_i32 s55, s52, 13108
s_lshr_b32 s55, s55, 16
s_mul_i32 s82, s55, 5
v_mfma_f32_16x16x32_bf16 v[172:175], a[152:155], a[104:107], v[172:175]
buffer_load_dwordx4 v6, s[12:15], s64 offen offset:1024 lds
v_mfma_f32_16x16x32_bf16 v[172:175], a[156:159], a[108:111], v[172:175]
s_sub_u32 s52, s52, s82
v_mfma_f32_16x16x32_bf16 v[56:59], a[148:151], a[108:111], v[56:59]
v_lshrrev_b32 v16, 1, v1
v_and_b32 v17, 1, v1
v_mfma_f32_16x16x32_bf16 v[56:59], a[144:147], a[104:107], v[56:59]
v_mul_u32_u24 v18, 1152, v16
v_lshl_add_u32 v18, v17, 4, v18
v_mfma_f32_16x16x32_bf16 v[180:183], a[136:139], a[104:107], v[180:183]
v_mov_b32 v24, v18
v_lshrrev_b32 v18, 4, v16
v_mfma_f32_16x16x32_bf16 v[180:183], a[140:143], a[108:111], v[180:183]
v_bfe_u32 v19, v16, 2, 2
v_and_b32 v16, 3, v16
v_mfma_f32_16x16x32_bf16 v[188:191], a[132:135], a[108:111], v[188:191]
s_add_u32 s53, s88, 524288
v_lshrrev_b32 v20, 1, v19
v_mul_u32_u24 v20, 18, v20
v_mfma_f32_16x16x32_bf16 v[188:191], a[128:131], a[104:107], v[188:191]
s_waitcnt lgkmcnt(0)
v_and_b32 v21, 1, v19
v_lshl_add_u32 v20, v21, 1, v20
v_mfma_f32_16x16x32_bf16 v[196:199], a[160:163], a[80:83], v[196:199]
s_waitcnt vmcnt(18)
v_lshl_add_u32 v20, v16, 2, v20
v_add_u32 v20, v20, v18
v_mfma_f32_16x16x32_bf16 v[196:199], a[164:167], a[84:87], v[196:199]
s_barrier
v_mfma_f32_16x16x32_bf16 v[64:67], a[172:175], a[84:87], v[64:67]
ds_read_b64_tr_b16 a[128:129], v11 offset:0
ds_read_b64_tr_b16 a[130:131], v11 offset:512
v_mfma_f32_16x16x32_bf16 v[64:67], a[168:171], a[80:83], v[64:67]
s_add_u32 m0, s77, 49152
s_add_u32 s64, s76, 128
v_mad_u32_u24 v20, s52, 36, v20
v_mfma_f32_16x16x32_bf16 v[204:207], a[176:179], a[80:83], v[204:207]
buffer_load_dwordx4 v7, s[20:23], s64 offen lds
v_mfma_f32_16x16x32_bf16 v[204:207], a[180:183], a[84:87], v[204:207]
ds_read_b64_tr_b16 a[132:133], v11 offset:4096
ds_read_b64_tr_b16 a[134:135], v11 offset:4608
v_mfma_f32_16x16x32_bf16 v[212:215], a[188:191], a[84:87], v[212:215]
ds_read_b64_tr_b16 a[136:137], v12 offset:0
ds_read_b64_tr_b16 a[138:139], v12 offset:512
v_mfma_f32_16x16x32_bf16 v[212:215], a[184:187], a[80:83], v[212:215]
ds_read_b64_tr_b16 a[140:141], v12 offset:4096
ds_read_b64_tr_b16 a[142:143], v12 offset:4608
v_mfma_f32_16x16x32_bf16 v[72:75], a[112:115], a[80:83], v[72:75]
buffer_store_dwordx4 v[96:99], v4, s[24:27], s53 offen offset:0 sc1
v_mfma_f32_16x16x32_bf16 v[72:75], a[116:119], a[84:87], v[72:75]
ds_read_b64_tr_b16 a[144:145], v13 offset:0
ds_read_b64_tr_b16 a[146:147], v13 offset:512
v_mfma_f32_16x16x32_bf16 v[220:223], a[124:127], a[84:87], v[220:223]
buffer_load_dwordx4 v8, s[20:23], s64 offen offset:1024 lds
v_mfma_f32_16x16x32_bf16 v[220:223], a[120:123], a[80:83], v[220:223]
ds_read_b64_tr_b16 a[148:149], v13 offset:4096
ds_read_b64_tr_b16 a[150:151], v13 offset:4608
v_mfma_f32_16x16x32_bf16 v[252:255], a[120:123], a[88:91], v[252:255]
v_lshlrev_b32 v21, 1, v18
v_lshl_add_u32 v21, v19, 2, v21
v_mfma_f32_16x16x32_bf16 v[252:255], a[124:127], a[92:95], v[252:255]
ds_read_b64_tr_b16 a[152:153], v14 offset:0
ds_read_b64_tr_b16 a[154:155], v14 offset:512
v_mfma_f32_16x16x32_bf16 v[160:163], a[116:119], a[92:95], v[160:163]
s_add_u32 m0, s80, 49152
s_add_u32 s64, s79, 2048
v_lshrrev_b32 v22, 1, v16
v_mfma_f32_16x16x32_bf16 v[160:163], a[112:115], a[88:91], v[160:163]
ds_read_b64_tr_b16 a[156:157], v14 offset:4096
ds_read_b64_tr_b16 a[158:159], v14 offset:4608
v_mfma_f32_16x16x32_bf16 v[228:231], a[184:187], a[88:91], v[228:231]
buffer_load_dwordx4 v4, s[24:27], s64 offen sc1 lds
v_mfma_f32_16x16x32_bf16 v[228:231], a[188:191], a[92:95], v[228:231]
s_xor_b32 s65, s70, 640
s_add_u32 s71, s68, s65
s_add_u32 s72, s69, s65
v_mfma_f32_16x16x32_bf16 v[168:171], a[180:183], a[92:95], v[168:171]
ds_read_b128 a[64:67], v4 offset:8192
v_add_u32 v21, v21, v22
v_mfma_f32_16x16x32_bf16 v[168:171], a[176:179], a[88:91], v[168:171]
v_mul_u32_u24 v21, 18, v21
v_and_b32 v22, 1, v16
v_mfma_f32_16x16x32_bf16 v[176:179], a[168:171], a[88:91], v[176:179]
s_add_u32 m0, s73, 65536
s_add_u32 s64, s71, 0
ds_read_b128 a[80:83], v9 offset:0
v_mfma_f32_16x16x32_bf16 v[176:179], a[172:175], a[92:95], v[176:179]
v_add3_u32 v21, v21, v22, 16
v_cmp_lt_u32 s[96:97], 1, v19
v_mfma_f32_16x16x32_bf16 v[80:83], a[164:167], a[92:95], v[80:83]
buffer_load_dwordx4 v5, s[12:15], s64 offen lds
v_mfma_f32_16x16x32_bf16 v[80:83], a[160:163], a[88:91], v[80:83]
ds_read_b128 a[68:71], v4 offset:10240
v_mov_b32 v22, 0x100000
v_mfma_f32_16x16x32_bf16 v[184:187], a[160:163], a[96:99], v[184:187]
ds_read_b128 a[84:87], v10 offset:0
v_mul_u32_u24 v23, 1, v23
v_mfma_f32_16x16x32_bf16 v[184:187], a[164:167], a[100:103], v[184:187]
s_add_u32 s53, s88, 524288
v_cndmask_b32 v21, v21, v22, s[96:97]
v_mov_b32 v22, s52
v_mfma_f32_16x16x32_bf16 v[248:251], a[172:175], a[100:103], v[248:251]
buffer_store_dwordx4 v[104:107], v4, s[24:27], s53 offen offset:1024 sc1
v_mfma_f32_16x16x32_bf16 v[248:251], a[168:171], a[96:99], v[248:251]
ds_read_b128 a[72:75], v4 offset:9216
v_cmp_eq_u32 s[96:97], 4, v22
v_mfma_f32_16x16x32_bf16 v[240:243], a[176:179], a[96:99], v[240:243]
buffer_load_dwordx4 v6, s[12:15], s64 offen offset:1024 lds
v_mfma_f32_16x16x32_bf16 v[240:243], a[180:183], a[100:103], v[240:243]
ds_read_b128 a[88:91], v9 offset:2048
v_cndmask_b32 v20, v20, v21, s[96:97]
v_mfma_f32_16x16x32_bf16 v[232:235], a[188:191], a[100:103], v[232:235]
v_mul_u32_u24 v20, 1152, v20
v_lshl_add_u32 v20, v17, 4, v20
v_mfma_f32_16x16x32_bf16 v[232:235], a[184:187], a[96:99], v[232:235]
ds_read_b128 a[76:79], v4 offset:11264
v_mov_b32 v25, v20
v_mfma_f32_16x16x32_bf16 v[236:239], a[112:115], a[96:99], v[236:239]
s_add_u32 m0, s73, 67584
s_add_u32 s64, s71, 18432
v_mov_b32 v16, s54
v_mfma_f32_16x16x32_bf16 v[236:239], a[116:119], a[100:103], v[236:239]
ds_read_b128 a[92:95], v10 offset:2048
v_mov_b32 v17, s55
v_mfma_f32_16x16x32_bf16 v[224:227], a[124:127], a[100:103], v[224:227]
buffer_load_dwordx4 v5, s[12:15], s64 offen lds
v_mfma_f32_16x16x32_bf16 v[224:227], a[120:123], a[96:99], v[224:227]
v_add_u32 v18, 32, v22
v_mfma_f32_16x16x32_bf16 v[208:211], a[120:123], a[104:107], v[208:211]
s_mul_i32 s82, s55, 165888
s_lshl_b32 s54, s54, 5
s_add_u32 s82, s82, s54
v_mfma_f32_16x16x32_bf16 v[208:211], a[124:127], a[108:111], v[208:211]
s_and_b32 s52, s2, 1
s_lshr_b32 s54, s3, 1
s_lshl1_add_u32 s52, s52, s54
v_mfma_f32_16x16x32_bf16 v[216:219], a[116:119], a[108:111], v[216:219]
s_mul_i32 s52, s52, 9
s_and_b32 s54, s3, 1
s_mul_i32 s55, s54, 5
v_mfma_f32_16x16x32_bf16 v[216:219], a[112:115], a[104:107], v[216:219]
s_add_u32 s52, s52, s55
s_lshr_b32 s55, s2, 1
s_mul_i32 s81, s55, 1152
v_mfma_f32_16x16x32_bf16 v[244:247], a[184:187], a[104:107], v[244:247]
buffer_load_dwordx4 v6, s[12:15], s64 offen offset:1024 lds
v_mfma_f32_16x16x32_bf16 v[244:247], a[188:191], a[108:111], v[244:247]
s_add_u32 s81, s81, s52
s_lshl_b32 s81, s81, 5
v_mfma_f32_16x16x32_bf16 v[192:195], a[180:183], a[108:111], v[192:195]
v_cmp_gt_u32 s[96:97], 5, v1
v_add_u32 v19, s52, v1
v_mfma_f32_16x16x32_bf16 v[192:195], a[176:179], a[104:107], v[192:195]
v_lshrrev_b32 v20, 5, s55
v_and_b32 v21, 31, s55
v_mfma_f32_16x16x32_bf16 v[200:203], a[168:171], a[104:107], v[200:203]
v_cndmask_b32 v16, v16, v19, s[96:97]
v_cndmask_b32 v17, v17, v20, s[96:97]
v_mfma_f32_16x16x32_bf16 v[200:203], a[172:175], a[108:111], v[200:203]
v_cndmask_b32 v18, v18, v21, s[96:97]
v_mul_u32_u24 v19, 7282, v16
v_mfma_f32_16x16x32_bf16 v[88:91], a[164:167], a[108:111], v[88:91]
v_lshrrev_b32 v19, 16, v19
v_mul_u32_u24 v20, 9, v19
v_mfma_f32_16x16x32_bf16 v[88:91], a[160:163], a[104:107], v[88:91]
s_waitcnt lgkmcnt(0)
v_sub_u32 v16, v16, v20
v_and_b32 v20, 1, v19
v_mfma_f32_16x16x32_bf16 v[36:39], a[128:131], a[80:83], v[36:39]
s_waitcnt vmcnt(24)
v_lshlrev_b32 v20, 2, v20
v_cndmask_b32 v20, 0, v20, s[96:97]
v_mfma_f32_16x16x32_bf16 v[36:39], a[132:135], a[84:87], v[36:39]
s_barrier
v_mfma_f32_16x16x32_bf16 v[44:47], a[140:143], a[84:87], v[44:47]
ds_read_b128 a[96:99], v9 offset:4096
v_xor_b32 v18, v18, v20
v_mfma_f32_16x16x32_bf16 v[44:47], a[136:139], a[80:83], v[44:47]
s_xor_b32 s75, s93, 5
s_lshl_b32 s76, s75, 19
s_add_u32 s76, s76, s74
v_mfma_f32_16x16x32_bf16 v[32:35], a[144:147], a[80:83], v[32:35]
s_lshl_b32 s79, s75, 13
s_add_u32 s79, s79, s78
ds_read_b128 a[100:103], v10 offset:4096
v_mfma_f32_16x16x32_bf16 v[32:35], a[148:151], a[84:87], v[32:35]
s_add_u32 m0, s77, 0
s_add_u32 s64, s76, 0
ds_read_b128 a[104:107], v9 offset:6144
v_mfma_f32_16x16x32_bf16 v[52:55], a[156:159], a[84:87], v[52:55]
buffer_load_dwordx4 v7, s[20:23], s64 offen lds
v_mfma_f32_16x16x32_bf16 v[52:55], a[152:155], a[80:83], v[52:55]
s_add_u32 s53, s88, 524288
ds_read_b64_tr_b16 a[160:161], v11 offset:16384
ds_read_b64_tr_b16 a[162:163], v11 offset:16896
v_mfma_f32_16x16x32_bf16 v[60:63], a[64:67], a[80:83], v[60:63]
buffer_store_dwordx4 v[112:115], v4, s[24:27], s53 offen offset:2048 sc1
v_mfma_f32_16x16x32_bf16 v[60:63], a[68:71], a[84:87], v[60:63]
ds_read_b128 a[108:111], v10 offset:6144
v_lshl_add_u32 v19, v19, 2, v17
v_mfma_f32_16x16x32_bf16 v[68:71], a[76:79], a[84:87], v[68:71]
buffer_load_dwordx4 v8, s[20:23], s64 offen offset:1024 lds
v_mfma_f32_16x16x32_bf16 v[68:71], a[72:75], a[80:83], v[68:71]
ds_read_b64_tr_b16 a[164:165], v11 offset:20480
ds_read_b64_tr_b16 a[166:167], v11 offset:20992
v_mfma_f32_16x16x32_bf16 v[76:79], a[72:75], a[88:91], v[76:79]
v_add_u32 v9, 32768, v9
v_add_u32 v10, 32768, v10
v_mfma_f32_16x16x32_bf16 v[76:79], a[76:79], a[92:95], v[76:79]
ds_read_b64_tr_b16 a[168:169], v12 offset:16384
ds_read_b64_tr_b16 a[170:171], v12 offset:16896
v_mfma_f32_16x16x32_bf16 v[84:87], a[68:71], a[92:95], v[84:87]
s_add_u32 m0, s80, 0
s_add_u32 s64, s79, 0
v_mul_u32_u24 v19, 344064, v19
v_mfma_f32_16x16x32_bf16 v[84:87], a[64:67], a[88:91], v[84:87]
ds_read_b64_tr_b16 a[172:173], v12 offset:20480
ds_read_b64_tr_b16 a[174:175], v12 offset:20992
v_mfma_f32_16x16x32_bf16 v[92:95], a[152:155], a[88:91], v[92:95]
buffer_load_dwordx4 v4, s[24:27], s64 offen sc1 lds
v_mfma_f32_16x16x32_bf16 v[92:95], a[156:159], a[92:95], v[92:95]
v_lshrrev_b32 v20, 1, v16
v_sub_u32 v20, v20, v17
v_mfma_f32_16x16x32_bf16 v[40:43], a[148:151], a[92:95], v[40:43]
ds_read_b64_tr_b16 a[176:177], v13 offset:16384
ds_read_b64_tr_b16 a[178:179], v13 offset:16896
v_mfma_f32_16x16x32_bf16 v[40:43], a[144:147], a[88:91], v[40:43]
v_add_u32 v20, 3, v20
v_and_b32 v20, 3, v20
v_mfma_f32_16x16x32_bf16 v[100:103], a[136:139], a[88:91], v[100:103]
s_add_u32 m0, s73, 69632
s_add_u32 s64, s72, 0
v_cmp_eq_u32 s[96:97], 8, v16
v_mfma_f32_16x16x32_bf16 v[100:103], a[140:143], a[92:95], v[100:103]
ds_read_b64_tr_b16 a[180:181], v13 offset:20480
ds_read_b64_tr_b16 a[182:183], v13 offset:20992
v_mfma_f32_16x16x32_bf16 v[108:111], a[132:135], a[92:95], v[108:111]
buffer_load_dwordx4 v5, s[12:15], s64 offen lds
v_mfma_f32_16x16x32_bf16 v[108:111], a[128:131], a[88:91], v[108:111]
s_waitcnt lgkmcnt(14)
ds_read_b64_tr_b16 a[184:185], v14 offset:16384
ds_read_b64_tr_b16 a[186:187], v14 offset:16896
v_mfma_f32_16x16x32_bf16 v[116:119], a[128:131], a[96:99], v[116:119]
ds_read_b64_tr_b16 a[188:189], v14 offset:20480
ds_read_b64_tr_b16 a[190:191], v14 offset:20992
v_mfma_f32_16x16x32_bf16 v[116:119], a[132:135], a[100:103], v[116:119]
v_and_b32 v16, 1, v16
v_lshl_add_u32 v21, v20, 1, v16
v_mfma_f32_16x16x32_bf16 v[124:127], a[140:143], a[100:103], v[124:127]
v_and_b32 v22, 1, v18
v_lshl_add_u32 v19, v22, 10, v19
v_mfma_f32_16x16x32_bf16 v[124:127], a[136:139], a[96:99], v[124:127]
ds_read_b128 a[112:115], v4 offset:24576
v_and_b32 v18, -2, v18
v_mfma_f32_16x16x32_bf16 v[132:135], a[144:147], a[96:99], v[132:135]
buffer_load_dwordx4 v6, s[12:15], s64 offen offset:1024 lds
v_mfma_f32_16x16x32_bf16 v[132:135], a[148:151], a[100:103], v[132:135]
ds_read_b128 a[116:119], v4 offset:26624
v_add_u32 v21, 1, v21
v_mfma_f32_16x16x32_bf16 v[140:143], a[156:159], a[100:103], v[140:143]
v_cndmask_b32 v21, v21, 0, s[96:97]
v_cndmask_b32 v20, v20, 0, s[96:97]
v_mfma_f32_16x16x32_bf16 v[140:143], a[152:155], a[96:99], v[140:143]
s_add_u32 s53, s88, 524288
ds_read_b128 a[120:123], v4 offset:25600
v_sub_u32 v17, 37, v18
v_mfma_f32_16x16x32_bf16 v[148:151], a[64:67], a[96:99], v[148:151]
s_add_u32 m0, s73, 71680
s_add_u32 s64, s72, 18432
v_min_u32 v17, 2, v17
v_mfma_f32_16x16x32_bf16 v[148:151], a[68:71], a[100:103], v[148:151]
ds_read_b128 a[124:127], v4 offset:27648
v_mul_u32_u24 v21, v21, v17
v_mfma_f32_16x16x32_bf16 v[48:51], a[76:79], a[100:103], v[48:51]
buffer_load_dwordx4 v5, s[12:15], s64 offen lds
v_mfma_f32_16x16x32_bf16 v[48:51], a[72:75], a[96:99], v[48:51]
s_waitcnt lgkmcnt(15)
v_mul_u32_u24 v22, v16, v17
v_min_u32 v23, 16, v18
v_mfma_f32_16x16x32_bf16 v[156:159], a[72:75], a[104:107], v[156:159]
buffer_store_dwordx4 v[120:123], v4, s[24:27], s53 offen offset:3072 sc1
v_mfma_f32_16x16x32_bf16 v[156:159], a[76:79], a[108:111], v[156:159]
v_mad_u32_u24 v21, v18, 5, v21
v_lshl_add_u32 v21, v23, 1, v21
v_mfma_f32_16x16x32_bf16 v[164:167], a[68:71], a[108:111], v[164:167]
v_lshl_add_u32 v22, v18, 1, v22
v_mad_u32_u24 v22, v20, 37, v22
v_mfma_f32_16x16x32_bf16 v[164:167], a[64:67], a[104:107], v[164:167]
v_mad_u32_u24 v22, v20, 37, v22
v_lshl_add_u32 v20, v20, 6, v18
v_mfma_f32_16x16x32_bf16 v[172:175], a[152:155], a[104:107], v[172:175]
buffer_load_dwordx4 v6, s[12:15], s64 offen offset:1024 lds
v_mfma_f32_16x16x32_bf16 v[172:175], a[156:159], a[108:111], v[172:175]
v_mov_b32 v23, 144
v_cmp_gt_u32 s[96:97], v23, v20
v_mfma_f32_16x16x32_bf16 v[56:59], a[148:151], a[108:111], v[56:59]
v_add_u32 v22, 37, v22
v_add_u32 v19, 38797312, v19
v_mfma_f32_16x16x32_bf16 v[56:59], a[144:147], a[104:107], v[56:59]
v_cndmask_b32 v21, v22, v21, s[96:97]
v_lshl_add_u32 v19, v21, 10, v19
v_mfma_f32_16x16x32_bf16 v[180:183], a[136:139], a[104:107], v[180:183]
s_cmp_eq_u32 s54, 1
s_cselect_b32 s96, 16, 0
v_mfma_f32_16x16x32_bf16 v[180:183], a[140:143], a[108:111], v[180:183]
s_cmp_eq_u32 s3, 3
s_cselect_b32 s52, 32, 0
s_or_b32 s96, s96, s52
v_mfma_f32_16x16x32_bf16 v[188:191], a[132:135], a[108:111], v[188:191]
s_cmp_ge_u32 s2, 240
s_cselect_b32 s52, 32, 0
s_or_b32 s96, s96, s52
v_mfma_f32_16x16x32_bf16 v[188:191], a[128:131], a[104:107], v[188:191]
s_waitcnt lgkmcnt(0)
s_mov_b32 s97, 0
v_mfma_f32_16x16x32_bf16 v[196:199], a[160:163], a[80:83], v[196:199]
s_waitcnt vmcnt(18)
v_mov_b32 v20, 2147418112
v_cndmask_b32 v26, v19, v20, s[96:97]
v_mfma_f32_16x16x32_bf16 v[196:199], a[164:167], a[84:87], v[196:199]
s_barrier
v_mfma_f32_16x16x32_bf16 v[64:67], a[172:175], a[84:87], v[64:67]
ds_read_b64_tr_b16 a[128:129], v11 offset:32768
ds_read_b64_tr_b16 a[130:131], v11 offset:33280
v_mfma_f32_16x16x32_bf16 v[64:67], a[168:171], a[80:83], v[64:67]
s_add_u32 m0, s77, 16384
s_add_u32 s64, s76, 128
v_lshlrev_b32 v27, 3, v1
v_mfma_f32_16x16x32_bf16 v[204:207], a[176:179], a[80:83], v[204:207]
buffer_load_dwordx4 v7, s[20:23], s64 offen lds
v_mfma_f32_16x16x32_bf16 v[204:207], a[180:183], a[84:87], v[204:207]
ds_read_b64_tr_b16 a[132:133], v11 offset:36864
ds_read_b64_tr_b16 a[134:135], v11 offset:37376
v_mfma_f32_16x16x32_bf16 v[212:215], a[188:191], a[84:87], v[212:215]
ds_read_b64_tr_b16 a[136:137], v12 offset:32768
ds_read_b64_tr_b16 a[138:139], v12 offset:33280
v_mfma_f32_16x16x32_bf16 v[212:215], a[184:187], a[80:83], v[212:215]
ds_read_b64_tr_b16 a[140:141], v12 offset:36864
ds_read_b64_tr_b16 a[142:143], v12 offset:37376
v_mfma_f32_16x16x32_bf16 v[72:75], a[112:115], a[80:83], v[72:75]
buffer_atomic_add v1, v0, s[24:27], s90 offen offset:4 sc1
v_mfma_f32_16x16x32_bf16 v[72:75], a[116:119], a[84:87], v[72:75]
ds_read_b64_tr_b16 a[144:145], v13 offset:32768
ds_read_b64_tr_b16 a[146:147], v13 offset:33280
v_mfma_f32_16x16x32_bf16 v[220:223], a[124:127], a[84:87], v[220:223]
buffer_load_dwordx4 v8, s[20:23], s64 offen offset:1024 lds
v_mfma_f32_16x16x32_bf16 v[220:223], a[120:123], a[80:83], v[220:223]
s_add_u32 s53, s88, 786432
ds_read_b64_tr_b16 a[148:149], v13 offset:36864
ds_read_b64_tr_b16 a[150:151], v13 offset:37376
v_mfma_f32_16x16x32_bf16 v[252:255], a[120:123], a[88:91], v[252:255]
buffer_store_dwordx4 v[128:131], v4, s[24:27], s53 offen offset:0 sc1
v_mfma_f32_16x16x32_bf16 v[252:255], a[124:127], a[92:95], v[252:255]
L_PAD6:
s_cbranch_execz L_PAD10
ds_read_b64_tr_b16 a[152:153], v14 offset:32768
ds_read_b64_tr_b16 a[154:155], v14 offset:33280
v_mfma_f32_16x16x32_bf16 v[160:163], a[116:119], a[92:95], v[160:163]
s_add_u32 m0, s80, 16384
s_add_u32 s64, s79, 2048
v_add_u32 v27, s83, v27
v_mfma_f32_16x16x32_bf16 v[160:163], a[112:115], a[88:91], v[160:163]
ds_read_b64_tr_b16 a[156:157], v14 offset:36864
ds_read_b64_tr_b16 a[158:159], v14 offset:37376
v_mfma_f32_16x16x32_bf16 v[228:231], a[184:187], a[88:91], v[228:231]
buffer_load_dwordx4 v4, s[24:27], s64 offen sc1 lds
v_mfma_f32_16x16x32_bf16 v[228:231], a[188:191], a[92:95], v[228:231]
s_xor_b32 s65, s70, 768
s_add_u32 s71, s68, s65
s_add_u32 s72, s69, s65
v_mfma_f32_16x16x32_bf16 v[168:171], a[180:183], a[92:95], v[168:171]
ds_read_b128 a[64:67], v4 offset:40960
v_lshrrev_b32 v22, 3, v1
v_mfma_f32_16x16x32_bf16 v[168:171], a[176:179], a[88:91], v[168:171]
v_mul_u32_u24 v22, 1152, v22
v_and_b32 v23, 7, v1
v_mfma_f32_16x16x32_bf16 v[176:179], a[168:171], a[88:91], v[176:179]
s_add_u32 m0, s73, 0
s_add_u32 s64, s71, 0
ds_read_b128 a[80:83], v9 offset:0
v_mfma_f32_16x16x32_bf16 v[176:179], a[172:175], a[92:95], v[176:179]
v_lshl_add_u32 v22, v23, 4, v22
v_lshrrev_b32 v23, 2, v1
v_mfma_f32_16x16x32_bf16 v[80:83], a[164:167], a[92:95], v[80:83]
buffer_load_dwordx4 v5, s[12:15], s64 offen lds
v_mfma_f32_16x16x32_bf16 v[80:83], a[160:163], a[88:91], v[80:83]
ds_read_b128 a[68:71], v4 offset:43008
v_mul_u32_u24 v23, 96, v23
v_mfma_f32_16x16x32_bf16 v[184:187], a[160:163], a[96:99], v[184:187]
ds_read_b128 a[84:87], v10 offset:0
v_add_u32 v23, v23, v27
v_mfma_f32_16x16x32_bf16 v[184:187], a[164:167], a[100:103], v[184:187]
v_and_b32 v16, 3, v1
v_cmp_eq_u32 s[96:97], 0, v16
v_mfma_f32_16x16x32_bf16 v[248:251], a[172:175], a[100:103], v[248:251]
v_mov_b32 v16, 0x3f803f80
v_mfma_f32_16x16x32_bf16 v[248:251], a[168:171], a[96:99], v[248:251]
ds_read_b128 a[72:75], v4 offset:41984
v_cndmask_b32 v16, 0, v16, s[96:97]
v_mfma_f32_16x16x32_bf16 v[240:243], a[176:179], a[96:99], v[240:243]
buffer_load_dwordx4 v6, s[12:15], s64 offen offset:1024 lds
v_mfma_f32_16x16x32_bf16 v[240:243], a[180:183], a[100:103], v[240:243]
ds_read_b128 a[88:91], v9 offset:2048
v_accvgpr_write_b32 a240, v16
v_mfma_f32_16x16x32_bf16 v[232:235], a[188:191], a[100:103], v[232:235]
v_accvgpr_write_b32 a241, v16
v_accvgpr_write_b32 a242, v16
v_mfma_f32_16x16x32_bf16 v[232:235], a[184:187], a[96:99], v[232:235]
ds_read_b128 a[76:79], v4 offset:44032
v_accvgpr_write_b32 a243, v16
v_mfma_f32_16x16x32_bf16 v[236:239], a[112:115], a[96:99], v[236:239]
s_add_u32 m0, s73, 2048
s_add_u32 s64, s71, 18432
v_accvgpr_write_b32 a232, 0
v_mfma_f32_16x16x32_bf16 v[236:239], a[116:119], a[100:103], v[236:239]
ds_read_b128 a[92:95], v10 offset:2048
v_accvgpr_write_b32 a233, 0
v_mfma_f32_16x16x32_bf16 v[224:227], a[124:127], a[100:103], v[224:227]
buffer_load_dwordx4 v5, s[12:15], s64 offen lds
v_mfma_f32_16x16x32_bf16 v[224:227], a[120:123], a[96:99], v[224:227]
v_accvgpr_write_b32 a234, 0
v_accvgpr_write_b32 a235, 0
v_mfma_f32_16x16x32_bf16 v[208:211], a[120:123], a[104:107], v[208:211]
v_accvgpr_write_b32 a236, 0
v_accvgpr_write_b32 a237, 0
v_mfma_f32_16x16x32_bf16 v[208:211], a[124:127], a[108:111], v[208:211]
s_add_u32 s53, s88, 786432
v_accvgpr_write_b32 a238, 0
v_accvgpr_write_b32 a239, 0
v_mfma_f32_16x16x32_bf16 v[216:219], a[116:119], a[108:111], v[216:219]
buffer_store_dwordx4 v[136:139], v4, s[24:27], s53 offen offset:1024 sc1
v_mfma_f32_16x16x32_bf16 v[216:219], a[112:115], a[104:107], v[216:219]
v_lshlrev_b32 v16, 2, v3
v_sub_u32 v16, v2, v16
v_mfma_f32_16x16x32_bf16 v[244:247], a[184:187], a[104:107], v[244:247]
buffer_load_dwordx4 v6, s[12:15], s64 offen offset:1024 lds
v_mfma_f32_16x16x32_bf16 v[244:247], a[188:191], a[108:111], v[244:247]
v_cmp_gt_i32 s[56:57], 0, v16
v_cmp_gt_i32 s[58:59], 1, v16
v_mfma_f32_16x16x32_bf16 v[192:195], a[180:183], a[108:111], v[192:195]
v_cmp_gt_i32 s[60:61], 2, v16
v_cmp_gt_i32 s[62:63], 3, v16
v_mfma_f32_16x16x32_bf16 v[192:195], a[176:179], a[104:107], v[192:195]
v_cmp_eq_u32 s[96:97], 3, v3
v_add_u32 v17, 48, v2
v_mfma_f32_16x16x32_bf16 v[200:203], a[168:171], a[104:107], v[200:203]
v_lshlrev_b32 v17, 2, v17
v_lshlrev_b32 v18, 16, v3
v_mfma_f32_16x16x32_bf16 v[200:203], a[172:175], a[108:111], v[200:203]
v_lshl_add_u32 v18, v2, 4, v18
v_add_u32 v19, 0x8000, v18
v_mfma_f32_16x16x32_bf16 v[88:91], a[164:167], a[108:111], v[88:91]
v_cndmask_b32 v19, v19, v20, s[96:97]
v_cmp_eq_u32 s[96:97], 0, v3
v_mfma_f32_16x16x32_bf16 v[88:91], a[160:163], a[104:107], v[88:91]
s_waitcnt lgkmcnt(0)
v_mfma_f32_16x16x32_bf16 v[36:39], a[128:131], a[80:83], v[36:39]
s_waitcnt vmcnt(24)
v_cndmask_b32 v18, v18, v20, s[96:97]
v_cndmask_b32 v19, v19, v20, s[96:97]
v_mfma_f32_16x16x32_bf16 v[36:39], a[132:135], a[84:87], v[36:39]
s_barrier
v_mfma_f32_16x16x32_bf16 v[44:47], a[140:143], a[84:87], v[44:47]
ds_read_b128 a[96:99], v9 offset:4096
v_mfma_f32_16x16x32_bf16 v[44:47], a[136:139], a[80:83], v[44:47]
s_xor_b32 s75, s93, 6
s_lshl_b32 s76, s75, 19
s_add_u32 s76, s76, s74
v_mfma_f32_16x16x32_bf16 v[32:35], a[144:147], a[80:83], v[32:35]
s_lshl_b32 s79, s75, 13
s_add_u32 s79, s79, s78
ds_read_b128 a[100:103], v10 offset:4096
v_mfma_f32_16x16x32_bf16 v[32:35], a[148:151], a[84:87], v[32:35]
s_add_u32 m0, s77, 32768
s_add_u32 s64, s76, 0
ds_read_b128 a[104:107], v9 offset:6144
v_mfma_f32_16x16x32_bf16 v[52:55], a[156:159], a[84:87], v[52:55]
buffer_load_dwordx4 v7, s[20:23], s64 offen lds
v_mfma_f32_16x16x32_bf16 v[52:55], a[152:155], a[80:83], v[52:55]
ds_read_b64_tr_b16 a[160:161], v11 offset:49152
ds_read_b64_tr_b16 a[162:163], v11 offset:49664
v_mfma_f32_16x16x32_bf16 v[60:63], a[64:67], a[80:83], v[60:63]
v_mfma_f32_16x16x32_bf16 v[60:63], a[68:71], a[84:87], v[60:63]
ds_read_b128 a[108:111], v10 offset:6144
v_mfma_f32_16x16x32_bf16 v[68:71], a[76:79], a[84:87], v[68:71]
buffer_load_dwordx4 v8, s[20:23], s64 offen offset:1024 lds
v_mfma_f32_16x16x32_bf16 v[68:71], a[72:75], a[80:83], v[68:71]
ds_read_b64_tr_b16 a[164:165], v11 offset:53248
ds_read_b64_tr_b16 a[166:167], v11 offset:53760
v_mfma_f32_16x16x32_bf16 v[76:79], a[72:75], a[88:91], v[76:79]
v_add_u32 v9, 32768, v9
v_add_u32 v10, 32768, v10
v_mfma_f32_16x16x32_bf16 v[76:79], a[76:79], a[92:95], v[76:79]
ds_read_b64_tr_b16 a[168:169], v12 offset:49152
ds_read_b64_tr_b16 a[170:171], v12 offset:49664
v_mfma_f32_16x16x32_bf16 v[84:87], a[68:71], a[92:95], v[84:87]
s_add_u32 m0, s80, 32768
s_add_u32 s64, s79, 0
v_mfma_f32_16x16x32_bf16 v[84:87], a[64:67], a[88:91], v[84:87]
ds_read_b64_tr_b16 a[172:173], v12 offset:53248
ds_read_b64_tr_b16 a[174:175], v12 offset:53760
v_mfma_f32_16x16x32_bf16 v[92:95], a[152:155], a[88:91], v[92:95]
buffer_load_dwordx4 v4, s[24:27], s64 offen sc1 lds
v_mfma_f32_16x16x32_bf16 v[92:95], a[156:159], a[92:95], v[92:95]
s_add_u32 s53, s88, 786432
v_mfma_f32_16x16x32_bf16 v[40:43], a[148:151], a[92:95], v[40:43]
ds_read_b64_tr_b16 a[176:177], v13 offset:49152
ds_read_b64_tr_b16 a[178:179], v13 offset:49664
v_mfma_f32_16x16x32_bf16 v[40:43], a[144:147], a[88:91], v[40:43]
buffer_store_dwordx4 v[144:147], v4, s[24:27], s53 offen offset:2048 sc1
v_mfma_f32_16x16x32_bf16 v[100:103], a[136:139], a[88:91], v[100:103]
s_add_u32 m0, s73, 4096
s_add_u32 s64, s72, 0
v_mfma_f32_16x16x32_bf16 v[100:103], a[140:143], a[92:95], v[100:103]
ds_read_b64_tr_b16 a[180:181], v13 offset:53248
ds_read_b64_tr_b16 a[182:183], v13 offset:53760
v_mfma_f32_16x16x32_bf16 v[108:111], a[132:135], a[92:95], v[108:111]
buffer_load_dwordx4 v5, s[12:15], s64 offen lds
v_mfma_f32_16x16x32_bf16 v[108:111], a[128:131], a[88:91], v[108:111]
s_waitcnt lgkmcnt(14)
ds_read_b64_tr_b16 a[184:185], v14 offset:49152
ds_read_b64_tr_b16 a[186:187], v14 offset:49664
v_mfma_f32_16x16x32_bf16 v[116:119], a[128:131], a[96:99], v[116:119]
ds_read_b64_tr_b16 a[188:189], v14 offset:53248
ds_read_b64_tr_b16 a[190:191], v14 offset:53760
v_mfma_f32_16x16x32_bf16 v[116:119], a[132:135], a[100:103], v[116:119]
v_mfma_f32_16x16x32_bf16 v[124:127], a[140:143], a[100:103], v[124:127]
v_mfma_f32_16x16x32_bf16 v[124:127], a[136:139], a[96:99], v[124:127]
ds_read_b128 a[112:115], v4 offset:57344
v_mfma_f32_16x16x32_bf16 v[132:135], a[144:147], a[96:99], v[132:135]
buffer_load_dwordx4 v6, s[12:15], s64 offen offset:1024 lds
v_mfma_f32_16x16x32_bf16 v[132:135], a[148:151], a[100:103], v[132:135]
ds_read_b128 a[116:119], v4 offset:59392
v_mfma_f32_16x16x32_bf16 v[140:143], a[156:159], a[100:103], v[140:143]
v_mfma_f32_16x16x32_bf16 v[140:143], a[152:155], a[96:99], v[140:143]
ds_read_b128 a[120:123], v4 offset:58368
v_mfma_f32_16x16x32_bf16 v[148:151], a[64:67], a[96:99], v[148:151]
s_add_u32 m0, s73, 6144
s_add_u32 s64, s72, 18432
v_mfma_f32_16x16x32_bf16 v[148:151], a[68:71], a[100:103], v[148:151]
ds_read_b128 a[124:127], v4 offset:60416
v_mfma_f32_16x16x32_bf16 v[48:51], a[76:79], a[100:103], v[48:51]
buffer_load_dwordx4 v5, s[12:15], s64 offen lds
v_mfma_f32_16x16x32_bf16 v[48:51], a[72:75], a[96:99], v[48:51]
s_waitcnt lgkmcnt(15)
v_mfma_f32_16x16x32_bf16 v[156:159], a[72:75], a[104:107], v[156:159]
v_mfma_f32_16x16x32_bf16 v[156:159], a[76:79], a[108:111], v[156:159]
v_mfma_f32_16x16x32_bf16 v[164:167], a[68:71], a[108:111], v[164:167]
v_mfma_f32_16x16x32_bf16 v[164:167], a[64:67], a[104:107], v[164:167]
v_mfma_f32_16x16x32_bf16 v[172:175], a[152:155], a[104:107], v[172:175]
buffer_load_dwordx4 v6, s[12:15], s64 offen offset:1024 lds
v_mfma_f32_16x16x32_bf16 v[172:175], a[156:159], a[108:111], v[172:175]
v_mfma_f32_16x16x32_bf16 v[56:59], a[148:151], a[108:111], v[56:59]
v_mfma_f32_16x16x32_bf16 v[56:59], a[144:147], a[104:107], v[56:59]
s_add_u32 s53, s88, 786432
v_mfma_f32_16x16x32_bf16 v[180:183], a[136:139], a[104:107], v[180:183]
buffer_store_dwordx4 v[152:155], v4, s[24:27], s53 offen offset:3072 sc1
v_mfma_f32_16x16x32_bf16 v[180:183], a[140:143], a[108:111], v[180:183]
v_mfma_f32_16x16x32_bf16 v[188:191], a[132:135], a[108:111], v[188:191]
v_mfma_f32_16x16x32_bf16 v[188:191], a[128:131], a[104:107], v[188:191]
s_waitcnt lgkmcnt(0)
v_mov_b32 v96, 0
v_mov_b32 v97, 0
v_mfma_f32_16x16x32_bf16 v[196:199], a[160:163], a[80:83], v[196:199]
s_waitcnt vmcnt(19)
v_mov_b32 v98, 0
v_mov_b32 v99, 0
v_mfma_f32_16x16x32_bf16 v[196:199], a[164:167], a[84:87], v[196:199]
s_barrier
v_mfma_f32_16x16x32_bf16 v[64:67], a[172:175], a[84:87], v[64:67]
ds_read_b64_tr_b16 a[128:129], v11 offset:0
ds_read_b64_tr_b16 a[130:131], v11 offset:512
v_mfma_f32_16x16x32_bf16 v[64:67], a[168:171], a[80:83], v[64:67]
s_add_u32 m0, s77, 49152
s_add_u32 s64, s76, 128
v_mov_b32 v104, 0
v_mfma_f32_16x16x32_bf16 v[204:207], a[176:179], a[80:83], v[204:207]
buffer_load_dwordx4 v7, s[20:23], s64 offen lds
v_mfma_f32_16x16x32_bf16 v[204:207], a[180:183], a[84:87], v[204:207]
ds_read_b64_tr_b16 a[132:133], v11 offset:4096
ds_read_b64_tr_b16 a[134:135], v11 offset:4608
v_mfma_f32_16x16x32_bf16 v[212:215], a[188:191], a[84:87], v[212:215]
ds_read_b64_tr_b16 a[136:137], v12 offset:0
ds_read_b64_tr_b16 a[138:139], v12 offset:512
v_mfma_f32_16x16x32_bf16 v[212:215], a[184:187], a[80:83], v[212:215]
ds_read_b64_tr_b16 a[140:141], v12 offset:4096
ds_read_b64_tr_b16 a[142:143], v12 offset:4608
v_mfma_f32_16x16x32_bf16 v[72:75], a[112:115], a[80:83], v[72:75]
buffer_load_dword v30, v29, s[24:27], s89 offen offset:4 sc1
v_mfma_f32_16x16x32_bf16 v[72:75], a[116:119], a[84:87], v[72:75]
ds_read_b64_tr_b16 a[144:145], v13 offset:0
ds_read_b64_tr_b16 a[146:147], v13 offset:512
v_mfma_f32_16x16x32_bf16 v[220:223], a[124:127], a[84:87], v[220:223]
buffer_load_dwordx4 v8, s[20:23], s64 offen offset:1024 lds
v_mfma_f32_16x16x32_bf16 v[220:223], a[120:123], a[80:83], v[220:223]
ds_read_b64_tr_b16 a[148:149], v13 offset:4096
ds_read_b64_tr_b16 a[150:151], v13 offset:4608
v_mfma_f32_16x16x32_bf16 v[252:255], a[120:123], a[88:91], v[252:255]
v_mov_b32 v105, 0
v_mov_b32 v106, 0
v_mfma_f32_16x16x32_bf16 v[252:255], a[124:127], a[92:95], v[252:255]
ds_read_b64_tr_b16 a[152:153], v14 offset:0
ds_read_b64_tr_b16 a[154:155], v14 offset:512
v_mfma_f32_16x16x32_bf16 v[160:163], a[116:119], a[92:95], v[160:163]
s_add_u32 m0, s80, 49152
s_add_u32 s64, s79, 2048
v_mov_b32 v107, 0
v_mfma_f32_16x16x32_bf16 v[160:163], a[112:115], a[88:91], v[160:163]
ds_read_b64_tr_b16 a[156:157], v14 offset:4096
ds_read_b64_tr_b16 a[158:159], v14 offset:4608
v_mfma_f32_16x16x32_bf16 v[228:231], a[184:187], a[88:91], v[228:231]
buffer_load_dwordx4 v4, s[24:27], s64 offen sc1 lds
v_mfma_f32_16x16x32_bf16 v[228:231], a[188:191], a[92:95], v[228:231]
s_xor_b32 s65, s70, 896
s_add_u32 s71, s68, s65
s_add_u32 s72, s69, s65
v_mfma_f32_16x16x32_bf16 v[168:171], a[180:183], a[92:95], v[168:171]
ds_read_b128 a[64:67], v4 offset:8192
v_mov_b32 v112, 0
v_mfma_f32_16x16x32_bf16 v[168:171], a[176:179], a[88:91], v[168:171]
v_mov_b32 v113, 0
v_mov_b32 v114, 0
v_mfma_f32_16x16x32_bf16 v[176:179], a[168:171], a[88:91], v[176:179]
s_add_u32 m0, s73, 32768
s_add_u32 s64, s71, 0
ds_read_b128 a[80:83], v9 offset:0
v_mfma_f32_16x16x32_bf16 v[176:179], a[172:175], a[92:95], v[176:179]
v_mov_b32 v115, 0
v_mov_b32 v120, 0
v_mfma_f32_16x16x32_bf16 v[80:83], a[164:167], a[92:95], v[80:83]
buffer_load_dwordx4 v5, s[12:15], s64 offen lds
v_mfma_f32_16x16x32_bf16 v[80:83], a[160:163], a[88:91], v[80:83]
s_add_u32 s53, s87, 524288
ds_read_b128 a[68:71], v4 offset:10240
v_mov_b32 v121, 0
v_mfma_f32_16x16x32_bf16 v[184:187], a[160:163], a[96:99], v[184:187]
ds_read_b128 a[84:87], v10 offset:0
v_mov_b32 v122, 0
v_mfma_f32_16x16x32_bf16 v[184:187], a[164:167], a[100:103], v[184:187]
buffer_store_dwordx4 a[28:31], v4, s[24:27], s53 offen offset:0 sc1
v_mfma_f32_16x16x32_bf16 v[248:251], a[172:175], a[100:103], v[248:251]
v_mov_b32 v123, 0
v_mov_b32 v128, 0
v_mfma_f32_16x16x32_bf16 v[248:251], a[168:171], a[96:99], v[248:251]
ds_read_b128 a[72:75], v4 offset:9216
v_mov_b32 v129, 0
v_mfma_f32_16x16x32_bf16 v[240:243], a[176:179], a[96:99], v[240:243]
buffer_load_dwordx4 v6, s[12:15], s64 offen offset:1024 lds
v_mfma_f32_16x16x32_bf16 v[240:243], a[180:183], a[100:103], v[240:243]
ds_read_b128 a[88:91], v9 offset:2048
v_mov_b32 v130, 0
v_mfma_f32_16x16x32_bf16 v[232:235], a[188:191], a[100:103], v[232:235]
v_mov_b32 v131, 0
v_mov_b32 v136, 0
v_mfma_f32_16x16x32_bf16 v[232:235], a[184:187], a[96:99], v[232:235]
ds_read_b128 a[76:79], v4 offset:11264
v_mov_b32 v137, 0
v_mfma_f32_16x16x32_bf16 v[236:239], a[112:115], a[96:99], v[236:239]
s_add_u32 m0, s73, 34816
s_add_u32 s64, s71, 18432
v_mov_b32 v138, 0
v_mfma_f32_16x16x32_bf16 v[236:239], a[116:119], a[100:103], v[236:239]
ds_read_b128 a[92:95], v10 offset:2048
v_mov_b32 v139, 0
v_mfma_f32_16x16x32_bf16 v[224:227], a[124:127], a[100:103], v[224:227]
buffer_load_dwordx4 v5, s[12:15], s64 offen lds
v_mfma_f32_16x16x32_bf16 v[224:227], a[120:123], a[96:99], v[224:227]
v_mov_b32 v144, 0
v_mov_b32 v145, 0
v_mfma_f32_16x16x32_bf16 v[208:211], a[120:123], a[104:107], v[208:211]
v_mov_b32 v146, 0
v_mov_b32 v147, 0
v_mfma_f32_16x16x32_bf16 v[208:211], a[124:127], a[108:111], v[208:211]
v_mov_b32 v152, 0
v_mov_b32 v153, 0
v_mfma_f32_16x16x32_bf16 v[216:219], a[116:119], a[108:111], v[216:219]
v_mov_b32 v154, 0
v_mov_b32 v155, 0
v_mfma_f32_16x16x32_bf16 v[216:219], a[112:115], a[104:107], v[216:219]
v_mfma_f32_16x16x32_bf16 v[244:247], a[184:187], a[104:107], v[244:247]
buffer_load_dwordx4 v6, s[12:15], s64 offen offset:1024 lds
v_mfma_f32_16x16x32_bf16 v[244:247], a[188:191], a[108:111], v[244:247]
v_mfma_f32_16x16x32_bf16 v[192:195], a[180:183], a[108:111], v[192:195]
v_mfma_f32_16x16x32_bf16 v[192:195], a[176:179], a[104:107], v[192:195]
v_mfma_f32_16x16x32_bf16 v[200:203], a[168:171], a[104:107], v[200:203]
v_mfma_f32_16x16x32_bf16 v[200:203], a[172:175], a[108:111], v[200:203]
v_mfma_f32_16x16x32_bf16 v[88:91], a[164:167], a[108:111], v[88:91]
v_mfma_f32_16x16x32_bf16 v[88:91], a[160:163], a[104:107], v[88:91]
s_waitcnt lgkmcnt(0)
v_mfma_f32_16x16x32_bf16 v[36:39], a[128:131], a[80:83], v[36:39]
s_waitcnt vmcnt(23)
v_mfma_f32_16x16x32_bf16 v[36:39], a[132:135], a[84:87], v[36:39]
s_barrier
v_mfma_f32_16x16x32_bf16 v[44:47], a[140:143], a[84:87], v[44:47]
s_add_u32 s53, s87, 524288
ds_read_b128 a[96:99], v9 offset:4096
v_mfma_f32_16x16x32_bf16 v[44:47], a[136:139], a[80:83], v[44:47]
s_xor_b32 s75, s93, 7
s_lshl_b32 s76, s75, 19
s_add_u32 s76, s76, s74
v_mfma_f32_16x16x32_bf16 v[32:35], a[144:147], a[80:83], v[32:35]
s_lshl_b32 s79, s75, 13
s_add_u32 s79, s79, s78
ds_read_b128 a[100:103], v10 offset:4096
v_mfma_f32_16x16x32_bf16 v[32:35], a[148:151], a[84:87], v[32:35]
s_add_u32 m0, s77, 0
s_add_u32 s64, s76, 0
ds_read_b128 a[104:107], v9 offset:6144
v_mfma_f32_16x16x32_bf16 v[52:55], a[156:159], a[84:87], v[52:55]
buffer_load_dwordx4 v7, s[20:23], s64 offen lds
v_mfma_f32_16x16x32_bf16 v[52:55], a[152:155], a[80:83], v[52:55]
ds_read_b64_tr_b16 a[160:161], v11 offset:16384
ds_read_b64_tr_b16 a[162:163], v11 offset:16896
v_mfma_f32_16x16x32_bf16 v[60:63], a[64:67], a[80:83], v[60:63]
buffer_store_dwordx4 a[20:23], v4, s[24:27], s53 offen offset:1024 sc1
v_mfma_f32_16x16x32_bf16 v[60:63], a[68:71], a[84:87], v[60:63]
ds_read_b128 a[108:111], v10 offset:6144
v_mfma_f32_16x16x32_bf16 v[68:71], a[76:79], a[84:87], v[68:71]
buffer_load_dwordx4 v8, s[20:23], s64 offen offset:1024 lds
v_mfma_f32_16x16x32_bf16 v[68:71], a[72:75], a[80:83], v[68:71]
ds_read_b64_tr_b16 a[164:165], v11 offset:20480
ds_read_b64_tr_b16 a[166:167], v11 offset:20992
v_mfma_f32_16x16x32_bf16 v[76:79], a[72:75], a[88:91], v[76:79]
v_add_u32 v9, -65536, v9
v_add_u32 v10, -65536, v10
v_mfma_f32_16x16x32_bf16 v[76:79], a[76:79], a[92:95], v[76:79]
ds_read_b64_tr_b16 a[168:169], v12 offset:16384
ds_read_b64_tr_b16 a[170:171], v12 offset:16896
v_mfma_f32_16x16x32_bf16 v[84:87], a[68:71], a[92:95], v[84:87]
s_add_u32 m0, s80, 0
s_add_u32 s64, s79, 0
v_mfma_f32_16x16x32_bf16 v[84:87], a[64:67], a[88:91], v[84:87]
ds_read_b64_tr_b16 a[172:173], v12 offset:20480
ds_read_b64_tr_b16 a[174:175], v12 offset:20992
v_mfma_f32_16x16x32_bf16 v[92:95], a[152:155], a[88:91], v[92:95]
buffer_load_dwordx4 v4, s[24:27], s64 offen sc1 lds
v_mfma_f32_16x16x32_bf16 v[92:95], a[156:159], a[92:95], v[92:95]
v_mfma_f32_16x16x32_bf16 v[40:43], a[148:151], a[92:95], v[40:43]
ds_read_b64_tr_b16 a[176:177], v13 offset:16384
ds_read_b64_tr_b16 a[178:179], v13 offset:16896
v_mfma_f32_16x16x32_bf16 v[40:43], a[144:147], a[88:91], v[40:43]
v_mfma_f32_16x16x32_bf16 v[100:103], a[136:139], a[88:91], v[100:103]
s_add_u32 m0, s73, 36864
s_add_u32 s64, s72, 0
v_mfma_f32_16x16x32_bf16 v[100:103], a[140:143], a[92:95], v[100:103]
ds_read_b64_tr_b16 a[180:181], v13 offset:20480
ds_read_b64_tr_b16 a[182:183], v13 offset:20992
v_mfma_f32_16x16x32_bf16 v[108:111], a[132:135], a[92:95], v[108:111]
buffer_load_dwordx4 v5, s[12:15], s64 offen lds
v_mfma_f32_16x16x32_bf16 v[108:111], a[128:131], a[88:91], v[108:111]
s_waitcnt lgkmcnt(14)
ds_read_b64_tr_b16 a[184:185], v14 offset:16384
ds_read_b64_tr_b16 a[186:187], v14 offset:16896
v_mfma_f32_16x16x32_bf16 v[116:119], a[128:131], a[96:99], v[116:119]
ds_read_b64_tr_b16 a[188:189], v14 offset:20480
ds_read_b64_tr_b16 a[190:191], v14 offset:20992
v_mfma_f32_16x16x32_bf16 v[116:119], a[132:135], a[100:103], v[116:119]
v_mfma_f32_16x16x32_bf16 v[124:127], a[140:143], a[100:103], v[124:127]
v_mfma_f32_16x16x32_bf16 v[124:127], a[136:139], a[96:99], v[124:127]
ds_read_b128 a[112:115], v4 offset:24576
v_mfma_f32_16x16x32_bf16 v[132:135], a[144:147], a[96:99], v[132:135]
buffer_load_dwordx4 v6, s[12:15], s64 offen offset:1024 lds
v_mfma_f32_16x16x32_bf16 v[132:135], a[148:151], a[100:103], v[132:135]
s_add_u32 s53, s87, 528384
ds_read_b128 a[116:119], v4 offset:26624
v_mfma_f32_16x16x32_bf16 v[140:143], a[156:159], a[100:103], v[140:143]
buffer_store_dwordx4 a[12:15], v4, s[24:27], s53 offen offset:0 sc1
v_mfma_f32_16x16x32_bf16 v[140:143], a[152:155], a[96:99], v[140:143]
ds_read_b128 a[120:123], v4 offset:25600
v_mfma_f32_16x16x32_bf16 v[148:151], a[64:67], a[96:99], v[148:151]
s_add_u32 m0, s73, 38912
s_add_u32 s64, s72, 18432
v_mfma_f32_16x16x32_bf16 v[148:151], a[68:71], a[100:103], v[148:151]
ds_read_b128 a[124:127], v4 offset:27648
v_mfma_f32_16x16x32_bf16 v[48:51], a[76:79], a[100:103], v[48:51]
buffer_load_dwordx4 v5, s[12:15], s64 offen lds
v_mfma_f32_16x16x32_bf16 v[48:51], a[72:75], a[96:99], v[48:51]
s_waitcnt lgkmcnt(15)
v_mfma_f32_16x16x32_bf16 v[156:159], a[72:75], a[104:107], v[156:159]
v_mfma_f32_16x16x32_bf16 v[156:159], a[76:79], a[108:111], v[156:159]
v_mfma_f32_16x16x32_bf16 v[164:167], a[68:71], a[108:111], v[164:167]
v_mfma_f32_16x16x32_bf16 v[164:167], a[64:67], a[104:107], v[164:167]
v_mfma_f32_16x16x32_bf16 v[172:175], a[152:155], a[104:107], v[172:175]
buffer_load_dwordx4 v6, s[12:15], s64 offen offset:1024 lds
v_mfma_f32_16x16x32_bf16 v[172:175], a[156:159], a[108:111], v[172:175]
v_mfma_f32_16x16x32_bf16 v[56:59], a[148:151], a[108:111], v[56:59]
v_mfma_f32_16x16x32_bf16 v[56:59], a[144:147], a[104:107], v[56:59]
v_mfma_f32_16x16x32_bf16 v[180:183], a[136:139], a[104:107], v[180:183]
v_mfma_f32_16x16x32_bf16 v[180:183], a[140:143], a[108:111], v[180:183]
v_mfma_f32_16x16x32_bf16 v[188:191], a[132:135], a[108:111], v[188:191]
v_mfma_f32_16x16x32_bf16 v[188:191], a[128:131], a[104:107], v[188:191]
s_waitcnt lgkmcnt(0)
v_mfma_f32_16x16x32_bf16 v[196:199], a[160:163], a[80:83], v[196:199]
s_waitcnt vmcnt(19)
v_mfma_f32_16x16x32_bf16 v[196:199], a[164:167], a[84:87], v[196:199]
s_barrier
v_mfma_f32_16x16x32_bf16 v[64:67], a[172:175], a[84:87], v[64:67]
ds_read_b64_tr_b16 a[128:129], v11 offset:32768
ds_read_b64_tr_b16 a[130:131], v11 offset:33280
v_mfma_f32_16x16x32_bf16 v[64:67], a[168:171], a[80:83], v[64:67]
s_add_u32 m0, s77, 16384
s_add_u32 s64, s76, 128
v_mfma_f32_16x16x32_bf16 v[204:207], a[176:179], a[80:83], v[204:207]
buffer_load_dwordx4 v7, s[20:23], s64 offen lds
v_mfma_f32_16x16x32_bf16 v[204:207], a[180:183], a[84:87], v[204:207]
ds_read_b64_tr_b16 a[132:133], v11 offset:36864
ds_read_b64_tr_b16 a[134:135], v11 offset:37376
v_mfma_f32_16x16x32_bf16 v[212:215], a[188:191], a[84:87], v[212:215]
ds_read_b64_tr_b16 a[136:137], v12 offset:32768
ds_read_b64_tr_b16 a[138:139], v12 offset:33280
v_mfma_f32_16x16x32_bf16 v[212:215], a[184:187], a[80:83], v[212:215]
s_add_u32 s53, s87, 528384
ds_read_b64_tr_b16 a[140:141], v12 offset:36864
ds_read_b64_tr_b16 a[142:143], v12 offset:37376
v_mfma_f32_16x16x32_bf16 v[72:75], a[112:115], a[80:83], v[72:75]
buffer_load_dwordx4 v8, s[20:23], s64 offen offset:1024 lds
v_mfma_f32_16x16x32_bf16 v[72:75], a[116:119], a[84:87], v[72:75]
ds_read_b64_tr_b16 a[144:145], v13 offset:32768
ds_read_b64_tr_b16 a[146:147], v13 offset:33280
v_mfma_f32_16x16x32_bf16 v[220:223], a[124:127], a[84:87], v[220:223]
buffer_store_dwordx4 a[4:7], v4, s[24:27], s53 offen offset:1024 sc1
v_mfma_f32_16x16x32_bf16 v[220:223], a[120:123], a[80:83], v[220:223]
s_add_u32 m0, s80, 16384
s_add_u32 s64, s79, 2048
v_mfma_f32_16x16x32_bf16 v[252:255], a[120:123], a[88:91], v[252:255]
ds_read_b64_tr_b16 a[148:149], v13 offset:36864
ds_read_b64_tr_b16 a[150:151], v13 offset:37376
v_mfma_f32_16x16x32_bf16 v[252:255], a[124:127], a[92:95], v[252:255]
buffer_load_dwordx4 v4, s[24:27], s64 offen sc1 lds
v_mfma_f32_16x16x32_bf16 v[160:163], a[116:119], a[92:95], v[160:163]
ds_read_b64_tr_b16 a[152:153], v14 offset:32768
ds_read_b64_tr_b16 a[154:155], v14 offset:33280
v_mfma_f32_16x16x32_bf16 v[160:163], a[112:115], a[88:91], v[160:163]
ds_read_b64_tr_b16 a[156:157], v14 offset:36864
ds_read_b64_tr_b16 a[158:159], v14 offset:37376
v_mfma_f32_16x16x32_bf16 v[228:231], a[184:187], a[88:91], v[228:231]
s_add_u32 m0, s83, 0
s_add_u32 s64, s81, 0
v_mfma_f32_16x16x32_bf16 v[228:231], a[188:191], a[92:95], v[228:231]
v_mfma_f32_16x16x32_bf16 v[168:171], a[180:183], a[92:95], v[168:171]
buffer_load_dwordx4 v22, s[32:35], s64 offen lds
v_mfma_f32_16x16x32_bf16 v[168:171], a[176:179], a[88:91], v[168:171]
ds_read_b128 a[64:67], v4 offset:40960
v_mfma_f32_16x16x32_bf16 v[176:179], a[168:171], a[88:91], v[176:179]
s_add_u32 m0, s83, 1024
s_add_u32 s64, s81, 9216
ds_read_b128 a[80:83], v9 offset:0
v_mfma_f32_16x16x32_bf16 v[176:179], a[172:175], a[92:95], v[176:179]
v_mfma_f32_16x16x32_bf16 v[80:83], a[164:167], a[92:95], v[80:83]
buffer_load_dwordx4 v22, s[32:35], s64 offen lds
v_mfma_f32_16x16x32_bf16 v[80:83], a[160:163], a[88:91], v[80:83]
ds_read_b128 a[68:71], v4 offset:43008
v_mfma_f32_16x16x32_bf16 v[184:187], a[160:163], a[96:99], v[184:187]
ds_read_b128 a[84:87], v10 offset:0
v_mfma_f32_16x16x32_bf16 v[184:187], a[164:167], a[100:103], v[184:187]
s_add_u32 m0, s83, 2048
s_add_u32 s64, s81, 18432
v_mfma_f32_16x16x32_bf16 v[248:251], a[172:175], a[100:103], v[248:251]
v_mfma_f32_16x16x32_bf16 v[248:251], a[168:171], a[96:99], v[248:251]
buffer_load_dwordx4 v22, s[32:35], s64 offen lds
v_mfma_f32_16x16x32_bf16 v[240:243], a[176:179], a[96:99], v[240:243]
ds_read_b128 a[72:75], v4 offset:41984
v_mfma_f32_16x16x32_bf16 v[240:243], a[180:183], a[100:103], v[240:243]
ds_read_b128 a[88:91], v9 offset:2048
v_mfma_f32_16x16x32_bf16 v[232:235], a[188:191], a[100:103], v[232:235]
s_add_u32 m0, s83, 3072
s_add_u32 s64, s81, 27648
v_mfma_f32_16x16x32_bf16 v[232:235], a[184:187], a[96:99], v[232:235]
ds_read_b128 a[76:79], v4 offset:44032
v_mfma_f32_16x16x32_bf16 v[236:239], a[112:115], a[96:99], v[236:239]
buffer_load_dwordx4 v22, s[32:35], s64 offen lds
v_mfma_f32_16x16x32_bf16 v[236:239], a[116:119], a[100:103], v[236:239]
ds_read_b128 a[92:95], v10 offset:2048
v_mfma_f32_16x16x32_bf16 v[224:227], a[124:127], a[100:103], v[224:227]
s_add_u32 m0, s83, 4096
s_add_u32 s64, s81, 128
s_add_u32 s53, s87, 786432
v_mfma_f32_16x16x32_bf16 v[224:227], a[120:123], a[96:99], v[224:227]
buffer_store_dwordx4 a[0:3], v4, s[24:27], s53 offen offset:0 sc1
v_mfma_f32_16x16x32_bf16 v[208:211], a[120:123], a[104:107], v[208:211]
buffer_load_dwordx4 v24, s[32:35], s64 offen lds
v_mfma_f32_16x16x32_bf16 v[208:211], a[124:127], a[108:111], v[208:211]
s_waitcnt vmcnt(26)
v_mfma_f32_16x16x32_bf16 v[216:219], a[116:119], a[108:111], v[216:219]
v_cmp_gt_u32 vcc, 8, v30
v_mfma_f32_16x16x32_bf16 v[216:219], a[112:115], a[104:107], v[216:219]
s_add_u32 m0, s83, 5120
s_add_u32 s64, s82, 0
v_mfma_f32_16x16x32_bf16 v[244:247], a[184:187], a[104:107], v[244:247]
v_mfma_f32_16x16x32_bf16 v[244:247], a[188:191], a[108:111], v[244:247]
buffer_load_dwordx4 v25, s[48:51], s64 offen lds
v_mfma_f32_16x16x32_bf16 v[192:195], a[180:183], a[108:111], v[192:195]
v_mfma_f32_16x16x32_bf16 v[192:195], a[176:179], a[104:107], v[192:195]
s_cbranch_vccnz CK_KV
CK_KV_R:
v_mfma_f32_16x16x32_bf16 v[200:203], a[168:171], a[104:107], v[200:203]
v_mfma_f32_16x16x32_bf16 v[200:203], a[172:175], a[108:111], v[200:203]
v_mfma_f32_16x16x32_bf16 v[88:91], a[164:167], a[108:111], v[88:91]
v_mfma_f32_16x16x32_bf16 v[88:91], a[160:163], a[104:107], v[88:91]
s_waitcnt lgkmcnt(0)
v_mfma_f32_16x16x32_bf16 v[36:39], a[128:131], a[80:83], v[36:39]
s_waitcnt vmcnt(25)
v_mov_b32 v6, 0xf149f2ca
v_mfma_f32_16x16x32_bf16 v[36:39], a[132:135], a[84:87], v[36:39]
s_barrier
v_mfma_f32_16x16x32_bf16 v[44:47], a[140:143], a[84:87], v[44:47]
ds_read_b128 a[96:99], v9 offset:4096
v_mfma_f32_16x16x32_bf16 v[44:47], a[136:139], a[80:83], v[44:47]
s_lshl_b32 s70, s3, 12
s_add_u32 s68, s70, s94
ds_read_b128 a[100:103], v10 offset:4096
v_mfma_f32_16x16x32_bf16 v[32:35], a[144:147], a[80:83], v[32:35]
s_add_u32 m0, s70, 32768
s_cmp_lt_u32 s3, 2
s_cselect_b32 s64, s68, 2147418112
v_mfma_f32_16x16x32_bf16 v[32:35], a[148:151], a[84:87], v[32:35]
buffer_load_dwordx4 v4, s[24:27], s64 offen offset:0 sc1 lds
v_mfma_f32_16x16x32_bf16 v[52:55], a[156:159], a[84:87], v[52:55]
L_PAD7:
s_cbranch_execz L_PAD11
ds_read_b128 a[104:107], v9 offset:6144
v_mfma_f32_16x16x32_bf16 v[52:55], a[152:155], a[80:83], v[52:55]
ds_read_b64_tr_b16 a[160:161], v11 offset:49152
ds_read_b64_tr_b16 a[162:163], v11 offset:49664
v_mfma_f32_16x16x32_bf16 v[60:63], a[64:67], a[80:83], v[60:63]
s_cmp_eq_u32 s66, 0
s_cbranch_scc1 D0
D0_R:
v_mfma_f32_16x16x32_bf16 v[60:63], a[68:71], a[84:87], v[60:63]
s_lshl_b32 s52, s4, 18
s_add_u32 s52, s52, 45088768
ds_read_b128 a[108:111], v10 offset:6144
v_mfma_f32_16x16x32_bf16 v[68:71], a[76:79], a[84:87], v[68:71]
s_lshl_b32 s54, s66, 9
v_add_u32 v9, 32768, v9
v_add_u32 v10, 32768, v10
v_mfma_f32_16x16x32_bf16 v[68:71], a[72:75], a[80:83], v[68:71]
s_add_u32 s54, s54, s52
ds_read_b64_tr_b16 a[164:165], v11 offset:53248
ds_read_b64_tr_b16 a[166:167], v11 offset:53760
v_mfma_f32_16x16x32_bf16 v[76:79], a[72:75], a[88:91], v[76:79]
s_lshl_b32 s55, s67, 9
s_add_u32 s55, s55, s52
v_mfma_f32_16x16x32_bf16 v[76:79], a[76:79], a[92:95], v[76:79]
s_add_u32 s53, s87, 786432
ds_read_b64_tr_b16 a[168:169], v12 offset:49152
ds_read_b64_tr_b16 a[170:171], v12 offset:49664
v_mfma_f32_16x16x32_bf16 v[84:87], a[68:71], a[92:95], v[84:87]
buffer_load_dwordx4 v4, s[24:27], s64 offen offset:1024 sc1 lds
v_mfma_f32_16x16x32_bf16 v[84:87], a[64:67], a[88:91], v[84:87]
ds_read_b64_tr_b16 a[172:173], v12 offset:53248
ds_read_b64_tr_b16 a[174:175], v12 offset:53760
v_mfma_f32_16x16x32_bf16 v[92:95], a[152:155], a[88:91], v[92:95]
buffer_store_dwordx4 a[8:11], v4, s[24:27], s53 offen offset:1024 sc1
v_mfma_f32_16x16x32_bf16 v[92:95], a[156:159], a[92:95], v[92:95]
v_mfma_f32_16x16x32_bf16 v[40:43], a[148:151], a[92:95], v[40:43]
ds_read_b64_tr_b16 a[176:177], v13 offset:49152
ds_read_b64_tr_b16 a[178:179], v13 offset:49664
v_mfma_f32_16x16x32_bf16 v[40:43], a[144:147], a[88:91], v[40:43]
v_mfma_f32_16x16x32_bf16 v[100:103], a[136:139], a[88:91], v[100:103]
ds_read_b64_tr_b16 a[180:181], v13 offset:53248
ds_read_b64_tr_b16 a[182:183], v13 offset:53760
v_mfma_f32_16x16x32_bf16 v[100:103], a[140:143], a[92:95], v[100:103]
v_mfma_f32_16x16x32_bf16 v[108:111], a[132:135], a[92:95], v[108:111]
ds_read_b64_tr_b16 a[184:185], v14 offset:49152
ds_read_b64_tr_b16 a[186:187], v14 offset:49664
v_mfma_f32_16x16x32_bf16 v[108:111], a[128:131], a[88:91], v[108:111]
s_waitcnt lgkmcnt(15)
v_mfma_f32_16x16x32_bf16 v[116:119], a[128:131], a[96:99], v[116:119]
ds_read_b64_tr_b16 a[188:189], v14 offset:53248
ds_read_b64_tr_b16 a[190:191], v14 offset:53760
v_mfma_f32_16x16x32_bf16 v[116:119], a[132:135], a[100:103], v[116:119]
buffer_load_dwordx4 v4, s[24:27], s64 offen offset:2048 sc1 lds
v_mfma_f32_16x16x32_bf16 v[124:127], a[140:143], a[100:103], v[124:127]
v_mfma_f32_16x16x32_bf16 v[124:127], a[136:139], a[96:99], v[124:127]
ds_read_b128 a[112:115], v4 offset:57344
v_mfma_f32_16x16x32_bf16 v[132:135], a[144:147], a[96:99], v[132:135]
v_mfma_f32_16x16x32_bf16 v[132:135], a[148:151], a[100:103], v[132:135]
ds_read_b128 a[116:119], v4 offset:59392
v_mfma_f32_16x16x32_bf16 v[140:143], a[156:159], a[100:103], v[140:143]
v_mfma_f32_16x16x32_bf16 v[140:143], a[152:155], a[96:99], v[140:143]
ds_read_b128 a[120:123], v4 offset:58368
v_mfma_f32_16x16x32_bf16 v[148:151], a[64:67], a[96:99], v[148:151]
v_mfma_f32_16x16x32_bf16 v[148:151], a[68:71], a[100:103], v[148:151]
ds_read_b128 a[124:127], v4 offset:60416
v_mfma_f32_16x16x32_bf16 v[48:51], a[76:79], a[100:103], v[48:51]
s_waitcnt lgkmcnt(15)
v_mfma_f32_16x16x32_bf16 v[48:51], a[72:75], a[96:99], v[48:51]
buffer_load_dwordx4 v4, s[24:27], s64 offen offset:3072 sc1 lds
v_mfma_f32_16x16x32_bf16 v[156:159], a[72:75], a[104:107], v[156:159]
v_mfma_f32_16x16x32_bf16 v[156:159], a[76:79], a[108:111], v[156:159]
v_mfma_f32_16x16x32_bf16 v[164:167], a[68:71], a[108:111], v[164:167]
v_mfma_f32_16x16x32_bf16 v[164:167], a[64:67], a[104:107], v[164:167]
v_mfma_f32_16x16x32_bf16 v[172:175], a[152:155], a[104:107], v[172:175]
s_add_u32 s53, s87, 790528
v_mfma_f32_16x16x32_bf16 v[172:175], a[156:159], a[108:111], v[172:175]
buffer_store_dwordx4 a[16:19], v4, s[24:27], s53 offen offset:0 sc1
v_mfma_f32_16x16x32_bf16 v[56:59], a[148:151], a[108:111], v[56:59]
v_mfma_f32_16x16x32_bf16 v[56:59], a[144:147], a[104:107], v[56:59]
v_mfma_f32_16x16x32_bf16 v[180:183], a[136:139], a[104:107], v[180:183]
v_mfma_f32_16x16x32_bf16 v[180:183], a[140:143], a[108:111], v[180:183]
v_mfma_f32_16x16x32_bf16 v[188:191], a[132:135], a[108:111], v[188:191]
v_mfma_f32_16x16x32_bf16 v[188:191], a[128:131], a[104:107], v[188:191]
s_waitcnt lgkmcnt(0)
v_mfma_f32_16x16x32_bf16 v[196:199], a[160:163], a[80:83], v[196:199]
s_waitcnt vmcnt(17)
v_mfma_f32_16x16x32_bf16 v[196:199], a[164:167], a[84:87], v[196:199]
s_barrier
v_mfma_f32_16x16x32_bf16 v[64:67], a[172:175], a[84:87], v[64:67]
ds_read_b64_tr_b16 a[128:129], v11 offset:0
ds_read_b64_tr_b16 a[130:131], v11 offset:512
v_mfma_f32_16x16x32_bf16 v[64:67], a[168:171], a[80:83], v[64:67]
s_add_u32 m0, s70, 49152
s_add_u32 s64, s68, 16384
s_waitcnt vmcnt(6)
v_mfma_f32_16x16x32_bf16 v[204:207], a[176:179], a[80:83], v[204:207]
buffer_load_dwordx4 v4, s[24:27], s64 offen offset:0 sc1 lds
v_mfma_f32_16x16x32_bf16 v[204:207], a[180:183], a[84:87], v[204:207]
ds_read_b64_tr_b16 a[132:133], v11 offset:4096
ds_read_b64_tr_b16 a[134:135], v11 offset:4608
v_mfma_f32_16x16x32_bf16 v[212:215], a[188:191], a[84:87], v[212:215]
ds_read_b64_tr_b16 a[136:137], v12 offset:0
ds_read_b64_tr_b16 a[138:139], v12 offset:512
v_mfma_f32_16x16x32_bf16 v[212:215], a[184:187], a[80:83], v[212:215]
ds_read_b64_tr_b16 a[140:141], v12 offset:4096
ds_read_b64_tr_b16 a[142:143], v12 offset:4608
v_mfma_f32_16x16x32_bf16 v[72:75], a[112:115], a[80:83], v[72:75]
ds_read_b64_tr_b16 a[192:193], v23 offset:0
ds_read_b64_tr_b16 a[194:195], v23 offset:2048
v_mfma_f32_16x16x32_bf16 v[72:75], a[116:119], a[84:87], v[72:75]
ds_read_b64_tr_b16 a[144:145], v13 offset:0
ds_read_b64_tr_b16 a[146:147], v13 offset:512
v_mfma_f32_16x16x32_bf16 v[220:223], a[124:127], a[84:87], v[220:223]
ds_read_b64_tr_b16 a[196:197], v23 offset:32
ds_read_b64_tr_b16 a[198:199], v23 offset:2080
v_mfma_f32_16x16x32_bf16 v[220:223], a[120:123], a[80:83], v[220:223]
ds_read_b64_tr_b16 a[148:149], v13 offset:4096
ds_read_b64_tr_b16 a[150:151], v13 offset:4608
v_mfma_f32_16x16x32_bf16 v[252:255], a[120:123], a[88:91], v[252:255]
ds_read_b64_tr_b16 a[200:201], v23 offset:64
ds_read_b64_tr_b16 a[202:203], v23 offset:2112
v_mfma_f32_16x16x32_bf16 v[252:255], a[124:127], a[92:95], v[252:255]
ds_read_b64_tr_b16 a[152:153], v14 offset:0
ds_read_b64_tr_b16 a[154:155], v14 offset:512
v_mfma_f32_16x16x32_bf16 v[160:163], a[116:119], a[92:95], v[160:163]
buffer_load_dwordx4 v4, s[24:27], s64 offen offset:1024 sc1 lds
v_mfma_f32_16x16x32_bf16 v[160:163], a[112:115], a[88:91], v[160:163]
ds_read_b64_tr_b16 a[156:157], v14 offset:4096
ds_read_b64_tr_b16 a[158:159], v14 offset:4608
v_mfma_f32_16x16x32_bf16 v[228:231], a[184:187], a[88:91], v[228:231]
ds_read_b64_tr_b16 a[204:205], v23 offset:96
ds_read_b64_tr_b16 a[206:207], v23 offset:2144
v_mfma_f32_16x16x32_bf16 v[228:231], a[188:191], a[92:95], v[228:231]
ds_read_b64_tr_b16 a[208:209], v27 offset:4096
ds_read_b64_tr_b16 a[210:211], v27 offset:4608
v_mfma_f32_16x16x32_bf16 v[168:171], a[180:183], a[92:95], v[168:171]
ds_read_b128 a[64:67], v4 offset:8192
v_mfma_f32_16x16x32_bf16 v[168:171], a[176:179], a[88:91], v[168:171]
s_add_u32 s53, s87, 790528
ds_read_b64_tr_b16 a[212:213], v27 offset:5120
ds_read_b64_tr_b16 a[214:215], v27 offset:5632
v_mfma_f32_16x16x32_bf16 v[176:179], a[168:171], a[88:91], v[176:179]
ds_read_b128 a[80:83], v9 offset:0
v_readlane_b32 s81, v26, 0
v_mfma_f32_16x16x32_bf16 v[176:179], a[172:175], a[92:95], v[176:179]
buffer_store_dwordx4 a[24:27], v4, s[24:27], s53 offen offset:1024 sc1
v_mfma_f32_16x16x32_bf16 v[80:83], a[164:167], a[92:95], v[80:83]
ds_read_b128 a[68:71], v4 offset:10240
v_readlane_b32 s82, v26, 1
v_mfma_f32_16x16x32_bf16 v[80:83], a[160:163], a[88:91], v[80:83]
v_readlane_b32 s71, v26, 2
v_readlane_b32 s72, v26, 3
v_mfma_f32_16x16x32_bf16 v[184:187], a[160:163], a[96:99], v[184:187]
ds_read_b128 a[84:87], v10 offset:0
v_readlane_b32 s74, v26, 4
v_mfma_f32_16x16x32_bf16 v[184:187], a[164:167], a[100:103], v[184:187]
buffer_load_dwordx4 v4, s[24:27], s64 offen offset:2048 sc1 lds
v_mfma_f32_16x16x32_bf16 v[248:251], a[172:175], a[100:103], v[248:251]
v_readlane_b32 s75, v26, 5
v_mfma_f32_16x16x32_bf16 v[248:251], a[168:171], a[96:99], v[248:251]
ds_read_b128 a[72:75], v4 offset:9216
v_mfma_f32_16x16x32_bf16 v[240:243], a[176:179], a[96:99], v[240:243]
v_mfma_f32_16x16x32_bf16 v[240:243], a[180:183], a[100:103], v[240:243]
ds_read_b128 a[88:91], v9 offset:2048
v_mfma_f32_16x16x32_bf16 v[232:235], a[188:191], a[100:103], v[232:235]
v_mfma_f32_16x16x32_bf16 v[232:235], a[184:187], a[96:99], v[232:235]
ds_read_b128 a[76:79], v4 offset:11264
v_mfma_f32_16x16x32_bf16 v[236:239], a[112:115], a[96:99], v[236:239]
v_mfma_f32_16x16x32_bf16 v[236:239], a[116:119], a[100:103], v[236:239]
ds_read_b128 a[92:95], v10 offset:2048
v_mfma_f32_16x16x32_bf16 v[224:227], a[124:127], a[100:103], v[224:227]
v_mfma_f32_16x16x32_bf16 v[224:227], a[120:123], a[96:99], v[224:227]
buffer_load_dwordx4 v4, s[24:27], s64 offen offset:3072 sc1 lds
v_mfma_f32_16x16x32_bf16 v[208:211], a[120:123], a[104:107], v[208:211]
v_mfma_f32_16x16x32_bf16 v[208:211], a[124:127], a[108:111], v[208:211]
v_mfma_f32_16x16x32_bf16 v[216:219], a[116:119], a[108:111], v[216:219]
v_mfma_f32_16x16x32_bf16 v[216:219], a[112:115], a[104:107], v[216:219]
v_mfma_f32_16x16x32_bf16 v[244:247], a[184:187], a[104:107], v[244:247]
v_mfma_f32_16x16x32_bf16 v[244:247], a[188:191], a[108:111], v[244:247]
v_mfma_f32_16x16x32_bf16 v[192:195], a[180:183], a[108:111], v[192:195]
v_mfma_f32_16x16x32_bf16 v[192:195], a[176:179], a[104:107], v[192:195]
v_mfma_f32_16x16x32_bf16 v[200:203], a[168:171], a[104:107], v[200:203]
v_mfma_f32_16x16x32_bf16 v[200:203], a[172:175], a[108:111], v[200:203]
v_mfma_f32_16x16x32_bf16 v[88:91], a[164:167], a[108:111], v[88:91]
v_mfma_f32_16x16x32_bf16 v[88:91], a[160:163], a[104:107], v[88:91]
s_waitcnt lgkmcnt(0)
v_mfma_f32_16x16x32_bf16 v[36:39], a[128:131], a[80:83], v[36:39]
s_waitcnt vmcnt(18)
v_mfma_f32_16x16x32_bf16 v[36:39], a[132:135], a[84:87], v[36:39]
s_barrier
v_mfma_f32_16x16x32_bf16 v[44:47], a[140:143], a[84:87], v[44:47]
ds_read_b128 a[96:99], v9 offset:4096
v_mfma_f32_16x16x32_bf16 v[44:47], a[136:139], a[80:83], v[44:47]
s_add_u32 m0, s70, 65536
s_add_u32 s64, s68, 32768
ds_read_b128 a[100:103], v10 offset:4096
v_mfma_f32_16x16x32_bf16 v[32:35], a[144:147], a[80:83], v[32:35]
buffer_load_dwordx4 v4, s[24:27], s64 offen offset:0 sc1 lds
v_mfma_f32_16x16x32_bf16 v[32:35], a[148:151], a[84:87], v[32:35]
ds_read_b128 a[104:107], v9 offset:6144
v_mfma_f32_16x16x32_bf16 v[52:55], a[156:159], a[84:87], v[52:55]
ds_read_b64_tr_b16 a[160:161], v11 offset:16384
ds_read_b64_tr_b16 a[162:163], v11 offset:16896
v_mfma_f32_16x16x32_bf16 v[52:55], a[152:155], a[80:83], v[52:55]
buffer_store_dwordx4 a[192:195], v4, s[24:27], s81 offen sc1
v_mfma_f32_16x16x32_bf16 v[60:63], a[64:67], a[80:83], v[60:63]
v_mfma_f32_16x16x32_bf16 v[60:63], a[68:71], a[84:87], v[60:63]
ds_read_b128 a[108:111], v10 offset:6144
v_mfma_f32_16x16x32_bf16 v[68:71], a[76:79], a[84:87], v[68:71]
v_cvt_pk_bf16_f32 v36, v36, v37
v_cvt_pk_bf16_f32 v37, v38, v39
v_mfma_f32_16x16x32_bf16 v[68:71], a[72:75], a[80:83], v[68:71]
ds_read_b64_tr_b16 a[164:165], v11 offset:20480
ds_read_b64_tr_b16 a[166:167], v11 offset:20992
v_mfma_f32_16x16x32_bf16 v[76:79], a[72:75], a[88:91], v[76:79]
buffer_store_dwordx4 a[196:199], v4, s[24:27], s82 offen sc1
v_mfma_f32_16x16x32_bf16 v[76:79], a[76:79], a[92:95], v[76:79]
ds_read_b64_tr_b16 a[168:169], v12 offset:16384
ds_read_b64_tr_b16 a[170:171], v12 offset:16896
v_mfma_f32_16x16x32_bf16 v[84:87], a[68:71], a[92:95], v[84:87]
buffer_load_dwordx4 v4, s[24:27], s64 offen offset:1024 sc1 lds
v_mfma_f32_16x16x32_bf16 v[84:87], a[64:67], a[88:91], v[84:87]
ds_read_b64_tr_b16 a[172:173], v12 offset:20480
ds_read_b64_tr_b16 a[174:175], v12 offset:20992
v_mfma_f32_16x16x32_bf16 v[92:95], a[152:155], a[88:91], v[92:95]
v_cvt_pk_bf16_f32 v38, v44, v45
v_cvt_pk_bf16_f32 v39, v46, v47
v_mfma_f32_16x16x32_bf16 v[92:95], a[156:159], a[92:95], v[92:95]
buffer_store_dwordx4 a[200:203], v4, s[24:27], s71 offen sc1
v_mfma_f32_16x16x32_bf16 v[40:43], a[148:151], a[92:95], v[40:43]
ds_read_b64_tr_b16 a[176:177], v13 offset:16384
ds_read_b64_tr_b16 a[178:179], v13 offset:16896
v_mfma_f32_16x16x32_bf16 v[40:43], a[144:147], a[88:91], v[40:43]
v_accvgpr_write_b32 a32, v36
v_accvgpr_write_b32 a33, v37
v_mfma_f32_16x16x32_bf16 v[100:103], a[136:139], a[88:91], v[100:103]
ds_read_b64_tr_b16 a[180:181], v13 offset:20480
ds_read_b64_tr_b16 a[182:183], v13 offset:20992
v_mfma_f32_16x16x32_bf16 v[100:103], a[140:143], a[92:95], v[100:103]
v_accvgpr_write_b32 a34, v38
v_accvgpr_write_b32 a35, v39
v_mfma_f32_16x16x32_bf16 v[108:111], a[132:135], a[92:95], v[108:111]
ds_read_b64_tr_b16 a[184:185], v14 offset:16384
ds_read_b64_tr_b16 a[186:187], v14 offset:16896
v_mfma_f32_16x16x32_bf16 v[108:111], a[128:131], a[88:91], v[108:111]
s_waitcnt lgkmcnt(15)
v_cvt_pk_bf16_f32 v32, v32, v33
v_cvt_pk_bf16_f32 v33, v34, v35
v_mfma_f32_16x16x32_bf16 v[116:119], a[128:131], a[96:99], v[116:119]
ds_read_b64_tr_b16 a[188:189], v14 offset:20480
ds_read_b64_tr_b16 a[190:191], v14 offset:20992
v_mfma_f32_16x16x32_bf16 v[116:119], a[132:135], a[100:103], v[116:119]
buffer_load_dwordx4 v4, s[24:27], s64 offen offset:2048 sc1 lds
v_mfma_f32_16x16x32_bf16 v[124:127], a[140:143], a[100:103], v[124:127]
buffer_store_dwordx4 a[204:207], v4, s[24:27], s72 offen sc1
v_mfma_f32_16x16x32_bf16 v[124:127], a[136:139], a[96:99], v[124:127]
ds_read_b128 a[112:115], v4 offset:24576
v_cvt_pk_bf16_f32 v34, v52, v53
v_mfma_f32_16x16x32_bf16 v[132:135], a[144:147], a[96:99], v[132:135]
v_cvt_pk_bf16_f32 v35, v54, v55
v_accvgpr_write_b32 a36, v32
v_mfma_f32_16x16x32_bf16 v[132:135], a[148:151], a[100:103], v[132:135]
ds_read_b128 a[116:119], v4 offset:26624
v_accvgpr_write_b32 a37, v33
v_mfma_f32_16x16x32_bf16 v[140:143], a[156:159], a[100:103], v[140:143]
v_accvgpr_write_b32 a38, v34
v_accvgpr_write_b32 a39, v35
v_mfma_f32_16x16x32_bf16 v[140:143], a[152:155], a[96:99], v[140:143]
ds_read_b128 a[120:123], v4 offset:25600
v_cvt_pk_bf16_f32 v40, v40, v41
v_mfma_f32_16x16x32_bf16 v[148:151], a[64:67], a[96:99], v[148:151]
buffer_store_dwordx4 a[208:211], v4, s[24:27], s74 offen sc1
v_mfma_f32_16x16x32_bf16 v[148:151], a[68:71], a[100:103], v[148:151]
ds_read_b128 a[124:127], v4 offset:27648
v_cvt_pk_bf16_f32 v41, v42, v43
v_mfma_f32_16x16x32_bf16 v[48:51], a[76:79], a[100:103], v[48:51]
s_waitcnt lgkmcnt(15)
v_cvt_pk_bf16_f32 v42, v92, v93
v_cvt_pk_bf16_f32 v43, v94, v95
v_mfma_f32_16x16x32_bf16 v[48:51], a[72:75], a[96:99], v[48:51]
buffer_load_dwordx4 v4, s[24:27], s64 offen offset:3072 sc1 lds
v_mfma_f32_16x16x32_bf16 v[156:159], a[72:75], a[104:107], v[156:159]
v_accvgpr_write_b32 a40, v40
v_accvgpr_write_b32 a41, v41
v_mfma_f32_16x16x32_bf16 v[156:159], a[76:79], a[108:111], v[156:159]
buffer_store_dwordx4 a[212:215], v4, s[24:27], s75 offen sc1
v_mfma_f32_16x16x32_bf16 v[164:167], a[68:71], a[108:111], v[164:167]
v_accvgpr_write_b32 a42, v42
v_accvgpr_write_b32 a43, v43
v_mfma_f32_16x16x32_bf16 v[164:167], a[64:67], a[104:107], v[164:167]
v_cvt_pk_bf16_f32 v108, v108, v109
v_cvt_pk_bf16_f32 v109, v110, v111
v_mfma_f32_16x16x32_bf16 v[172:175], a[152:155], a[104:107], v[172:175]
v_cvt_pk_bf16_f32 v110, v100, v101
v_cvt_pk_bf16_f32 v111, v102, v103
v_mfma_f32_16x16x32_bf16 v[172:175], a[156:159], a[108:111], v[172:175]
v_accvgpr_write_b32 a44, v108
v_accvgpr_write_b32 a45, v109
v_mfma_f32_16x16x32_bf16 v[56:59], a[148:151], a[108:111], v[56:59]
v_accvgpr_write_b32 a46, v110
v_accvgpr_write_b32 a47, v111
v_mfma_f32_16x16x32_bf16 v[56:59], a[144:147], a[104:107], v[56:59]
v_cvt_pk_bf16_f32 v116, v116, v117
v_cvt_pk_bf16_f32 v117, v118, v119
v_mfma_f32_16x16x32_bf16 v[180:183], a[136:139], a[104:107], v[180:183]
v_cvt_pk_bf16_f32 v118, v124, v125
v_cvt_pk_bf16_f32 v119, v126, v127
v_mfma_f32_16x16x32_bf16 v[180:183], a[140:143], a[108:111], v[180:183]
v_accvgpr_write_b32 a48, v116
v_accvgpr_write_b32 a49, v117
v_mfma_f32_16x16x32_bf16 v[188:191], a[132:135], a[108:111], v[188:191]
v_accvgpr_write_b32 a50, v118
v_accvgpr_write_b32 a51, v119
v_mfma_f32_16x16x32_bf16 v[188:191], a[128:131], a[104:107], v[188:191]
s_waitcnt lgkmcnt(0)
v_cvt_pk_bf16_f32 v132, v132, v133
v_cvt_pk_bf16_f32 v133, v134, v135
v_mfma_f32_16x16x32_bf16 v[196:199], a[160:163], a[80:83], v[196:199]
s_waitcnt vmcnt(16)
v_cvt_pk_bf16_f32 v134, v140, v141
v_cvt_pk_bf16_f32 v135, v142, v143
v_mfma_f32_16x16x32_bf16 v[196:199], a[164:167], a[84:87], v[196:199]
s_barrier
v_mfma_f32_16x16x32_bf16 v[64:67], a[172:175], a[84:87], v[64:67]
ds_read_b128 a[192:195], v4 offset:32768
v_accvgpr_write_b32 a52, v132
v_mfma_f32_16x16x32_bf16 v[64:67], a[168:171], a[80:83], v[64:67]
s_add_u32 m0, s70, 81920
s_add_u32 s64, s68, 49152
v_accvgpr_write_b32 a53, v133
v_mfma_f32_16x16x32_bf16 v[204:207], a[176:179], a[80:83], v[204:207]
buffer_load_dwordx4 v4, s[24:27], s64 offen offset:0 sc1 lds
v_mfma_f32_16x16x32_bf16 v[204:207], a[180:183], a[84:87], v[204:207]
ds_read_b128 a[196:199], v4 offset:33792
v_accvgpr_write_b32 a54, v134
v_mfma_f32_16x16x32_bf16 v[212:215], a[188:191], a[84:87], v[212:215]
v_accvgpr_write_b32 a55, v135
v_cvt_pk_bf16_f32 v56, v56, v57
v_mfma_f32_16x16x32_bf16 v[212:215], a[184:187], a[80:83], v[212:215]
ds_read_b128 a[200:203], v4 offset:34816
v_cvt_pk_bf16_f32 v57, v58, v59
v_mfma_f32_16x16x32_bf16 v[80:83], a[160:163], a[88:91], v[80:83]
v_cvt_pk_bf16_f32 v58, v172, v173
v_cvt_pk_bf16_f32 v59, v174, v175
v_mfma_f32_16x16x32_bf16 v[80:83], a[164:167], a[92:95], v[80:83]
ds_read_b128 a[204:207], v4 offset:35840
v_accvgpr_write_b32 a56, v56
v_mfma_f32_16x16x32_bf16 v[176:179], a[172:175], a[92:95], v[176:179]
v_accvgpr_write_b32 a57, v57
v_accvgpr_write_b32 a58, v58
v_mfma_f32_16x16x32_bf16 v[176:179], a[168:171], a[88:91], v[176:179]
ds_read_b128 a[208:211], v4 offset:36864
v_accvgpr_write_b32 a59, v59
v_mfma_f32_16x16x32_bf16 v[168:171], a[176:179], a[88:91], v[168:171]
v_cvt_pk_bf16_f32 v188, v188, v189
v_cvt_pk_bf16_f32 v189, v190, v191
v_mfma_f32_16x16x32_bf16 v[168:171], a[180:183], a[92:95], v[168:171]
ds_read_b128 a[212:215], v4 offset:37888
v_cvt_pk_bf16_f32 v190, v180, v181
v_mfma_f32_16x16x32_bf16 v[228:231], a[188:191], a[92:95], v[228:231]
buffer_load_dwordx4 v4, s[24:27], s64 offen offset:1024 sc1 lds
v_mfma_f32_16x16x32_bf16 v[228:231], a[184:187], a[88:91], v[228:231]
ds_read_b128 a[216:219], v4 offset:38912
v_cvt_pk_bf16_f32 v191, v182, v183
v_mfma_f32_16x16x32_bf16 v[184:187], a[160:163], a[96:99], v[184:187]
v_accvgpr_write_b32 a60, v188
v_accvgpr_write_b32 a61, v189
v_mfma_f32_16x16x32_bf16 v[184:187], a[164:167], a[100:103], v[184:187]
ds_read_b128 a[220:223], v4 offset:39936
v_accvgpr_write_b32 a62, v190
v_mfma_f32_16x16x32_bf16 v[248:251], a[172:175], a[100:103], v[248:251]
v_accvgpr_write_b32 a63, v191
v_cvt_pk_bf16_f32 v196, v196, v197
v_mfma_f32_16x16x32_bf16 v[248:251], a[168:171], a[96:99], v[248:251]
v_cvt_pk_bf16_f32 v197, v198, v199
v_cvt_pk_bf16_f32 v198, v64, v65
v_mfma_f32_16x16x32_bf16 v[240:243], a[176:179], a[96:99], v[240:243]
v_cvt_pk_bf16_f32 v199, v66, v67
v_accvgpr_write_b32 a28, v196
v_mfma_f32_16x16x32_bf16 v[240:243], a[180:183], a[100:103], v[240:243]
v_accvgpr_write_b32 a29, v197
v_accvgpr_write_b32 a30, v198
v_mfma_f32_16x16x32_bf16 v[232:235], a[188:191], a[100:103], v[232:235]
v_accvgpr_write_b32 a31, v199
v_cvt_pk_bf16_f32 v204, v204, v205
v_mfma_f32_16x16x32_bf16 v[232:235], a[184:187], a[96:99], v[232:235]
v_cvt_pk_bf16_f32 v205, v206, v207
v_cvt_pk_bf16_f32 v206, v212, v213
v_mfma_f32_16x16x32_bf16 v[88:91], a[160:163], a[104:107], v[88:91]
v_cvt_pk_bf16_f32 v207, v214, v215
v_accvgpr_write_b32 a20, v204
v_mfma_f32_16x16x32_bf16 v[88:91], a[164:167], a[108:111], v[88:91]
buffer_load_dwordx4 v4, s[24:27], s64 offen offset:2048 sc1 lds
v_mfma_f32_16x16x32_bf16 v[200:203], a[172:175], a[108:111], v[200:203]
v_accvgpr_write_b32 a21, v205
v_accvgpr_write_b32 a22, v206
v_mfma_f32_16x16x32_bf16 v[200:203], a[168:171], a[104:107], v[200:203]
v_accvgpr_write_b32 a23, v207
v_cvt_pk_bf16_f32 v80, v80, v81
v_mfma_f32_16x16x32_bf16 v[192:195], a[176:179], a[104:107], v[192:195]
v_cvt_pk_bf16_f32 v81, v82, v83
v_cvt_pk_bf16_f32 v82, v176, v177
v_mfma_f32_16x16x32_bf16 v[192:195], a[180:183], a[108:111], v[192:195]
v_cvt_pk_bf16_f32 v83, v178, v179
v_accvgpr_write_b32 a12, v80
v_mfma_f32_16x16x32_bf16 v[244:247], a[188:191], a[108:111], v[244:247]
v_accvgpr_write_b32 a13, v81
v_accvgpr_write_b32 a14, v82
v_mfma_f32_16x16x32_bf16 v[244:247], a[184:187], a[104:107], v[244:247]
v_accvgpr_write_b32 a15, v83
v_cvt_pk_bf16_f32 v168, v168, v169
v_mfma_f32_16x16x32_bf16 v[72:75], a[112:115], a[80:83], v[72:75]
v_cvt_pk_bf16_f32 v169, v170, v171
v_cvt_pk_bf16_f32 v170, v228, v229
v_mfma_f32_16x16x32_bf16 v[72:75], a[116:119], a[84:87], v[72:75]
v_cvt_pk_bf16_f32 v171, v230, v231
v_accvgpr_write_b32 a4, v168
v_mfma_f32_16x16x32_bf16 v[220:223], a[124:127], a[84:87], v[220:223]
v_accvgpr_write_b32 a5, v169
v_accvgpr_write_b32 a6, v170
v_mfma_f32_16x16x32_bf16 v[220:223], a[120:123], a[80:83], v[220:223]
buffer_load_dwordx4 v4, s[24:27], s64 offen offset:3072 sc1 lds
v_mfma_f32_16x16x32_bf16 v[160:163], a[112:115], a[88:91], v[160:163]
v_accvgpr_write_b32 a7, v171
v_cvt_pk_bf16_f32 v184, v184, v185
v_mfma_f32_16x16x32_bf16 v[160:163], a[116:119], a[92:95], v[160:163]
v_cvt_pk_bf16_f32 v185, v186, v187
v_cvt_pk_bf16_f32 v186, v248, v249
v_mfma_f32_16x16x32_bf16 v[252:255], a[124:127], a[92:95], v[252:255]
v_cvt_pk_bf16_f32 v187, v250, v251
v_accvgpr_write_b32 a0, v184
v_mfma_f32_16x16x32_bf16 v[252:255], a[120:123], a[88:91], v[252:255]
v_accvgpr_write_b32 a1, v185
v_accvgpr_write_b32 a2, v186
v_mfma_f32_16x16x32_bf16 v[236:239], a[112:115], a[96:99], v[236:239]
v_accvgpr_write_b32 a3, v187
v_cvt_pk_bf16_f32 v240, v240, v241
v_mfma_f32_16x16x32_bf16 v[236:239], a[116:119], a[100:103], v[236:239]
v_cvt_pk_bf16_f32 v241, v242, v243
v_cvt_pk_bf16_f32 v242, v232, v233
v_mfma_f32_16x16x32_bf16 v[224:227], a[124:127], a[100:103], v[224:227]
v_cvt_pk_bf16_f32 v243, v234, v235
v_accvgpr_write_b32 a8, v240
v_mfma_f32_16x16x32_bf16 v[224:227], a[120:123], a[96:99], v[224:227]
v_accvgpr_write_b32 a9, v241
v_accvgpr_write_b32 a10, v242
v_mfma_f32_16x16x32_bf16 v[216:219], a[112:115], a[104:107], v[216:219]
v_accvgpr_write_b32 a11, v243
v_cvt_pk_bf16_f32 v88, v88, v89
v_mfma_f32_16x16x32_bf16 v[216:219], a[116:119], a[108:111], v[216:219]
v_cvt_pk_bf16_f32 v89, v90, v91
v_cvt_pk_bf16_f32 v90, v200, v201
v_mfma_f32_16x16x32_bf16 v[208:211], a[124:127], a[108:111], v[208:211]
v_cvt_pk_bf16_f32 v91, v202, v203
v_accvgpr_write_b32 a16, v88
v_mfma_f32_16x16x32_bf16 v[208:211], a[120:123], a[104:107], v[208:211]
s_waitcnt lgkmcnt(0)
v_accvgpr_write_b32 a17, v89
v_accvgpr_write_b32 a18, v90
v_mfma_f32_16x16x32_bf16 v[44:47], a[192:195], a[32:35], v[96:99]
v_accvgpr_write_b32 a19, v91
v_cvt_pk_bf16_f32 v192, v192, v193
v_mfma_f32_16x16x32_bf16 v[44:47], a[196:199], a[36:39], v[44:47]
v_cvt_pk_bf16_f32 v193, v194, v195
v_cvt_pk_bf16_f32 v194, v244, v245
v_mfma_f32_16x16x32_bf16 v[44:47], a[200:203], a[28:31], v[44:47]
v_cvt_pk_bf16_f32 v195, v246, v247
v_accvgpr_write_b32 a24, v192
v_mfma_f32_16x16x32_bf16 v[44:47], a[204:207], a[20:23], v[44:47]
v_accvgpr_write_b32 a25, v193
v_accvgpr_write_b32 a26, v194
v_mfma_f32_16x16x32_bf16 v[52:55], a[192:195], a[44:47], v[104:107]
ds_bpermute_b32 v8, v17, v63
v_accvgpr_write_b32 a27, v195
v_mfma_f32_16x16x32_bf16 v[52:55], a[196:199], a[40:43], v[52:55]
v_cvt_pk_bf16_f32 v60, v60, v61
v_cvt_pk_bf16_f32 v61, v62, v63
v_mfma_f32_16x16x32_bf16 v[52:55], a[200:203], a[12:15], v[52:55]
v_cvt_pk_bf16_f32 v62, v68, v69
v_cvt_pk_bf16_f32 v63, v70, v71
v_mfma_f32_16x16x32_bf16 v[52:55], a[204:207], a[4:7], v[52:55]
v_accvgpr_write_b32 a128, v60
v_accvgpr_write_b32 a129, v61
v_mfma_f32_16x16x32_bf16 v[64:67], a[208:211], a[32:35], v[112:115]
v_accvgpr_write_b32 a130, v62
v_accvgpr_write_b32 a131, v63
v_mfma_f32_16x16x32_bf16 v[64:67], a[212:215], a[36:39], v[64:67]
ds_bpermute_b32 v9, v17, v87
v_cvt_pk_bf16_f32 v84, v84, v85
v_mfma_f32_16x16x32_bf16 v[64:67], a[216:219], a[28:31], v[64:67]
v_cvt_pk_bf16_f32 v85, v86, v87
v_cvt_pk_bf16_f32 v86, v76, v77
v_mfma_f32_16x16x32_bf16 v[64:67], a[220:223], a[20:23], v[64:67]
v_cvt_pk_bf16_f32 v87, v78, v79
v_mfma_f32_16x16x32_bf16 v[212:215], a[208:211], a[44:47], v[120:123]
buffer_store_dwordx4 v[84:87], v18, s[24:27], s54 offen offset:256 sc1
v_mfma_f32_16x16x32_bf16 v[212:215], a[212:215], a[40:43], v[212:215]
v_accvgpr_write_b32 a136, v84
v_accvgpr_write_b32 a137, v85
v_mfma_f32_16x16x32_bf16 v[212:215], a[216:219], a[12:15], v[212:215]
v_accvgpr_write_b32 a138, v86
v_accvgpr_write_b32 a139, v87
v_mfma_f32_16x16x32_bf16 v[212:215], a[220:223], a[4:7], v[212:215]
s_waitcnt vmcnt(15)
ds_bpermute_b32 v10, v17, v151
v_cvt_pk_bf16_f32 v148, v148, v149
v_mfma_f32_16x16x32_bf16 v[100:103], a[192:195], a[48:51], v[128:131]
s_barrier
v_cvt_pk_bf16_f32 v149, v150, v151
v_cvt_pk_bf16_f32 v150, v48, v49
v_mfma_f32_16x16x32_bf16 v[100:103], a[196:199], a[52:55], v[100:103]
v_cvt_pk_bf16_f32 v151, v50, v51
v_accvgpr_write_b32 a144, v148
v_mfma_f32_16x16x32_bf16 v[100:103], a[200:203], a[0:3], v[100:103]
ds_bpermute_b32 v11, v17, v167
v_accvgpr_write_b32 a145, v149
v_mfma_f32_16x16x32_bf16 v[100:103], a[204:207], a[8:11], v[100:103]
v_cvt_pk_bf16_f32 v164, v164, v165
v_cvt_pk_bf16_f32 v165, v166, v167
v_mfma_f32_16x16x32_bf16 v[92:95], a[192:195], a[60:63], v[136:139]
v_cvt_pk_bf16_f32 v166, v156, v157
v_cvt_pk_bf16_f32 v167, v158, v159
v_mfma_f32_16x16x32_bf16 v[92:95], a[196:199], a[56:59], v[92:95]
buffer_store_dwordx4 v[164:167], v18, s[24:27], s55 offen offset:256 sc1
v_mfma_f32_16x16x32_bf16 v[92:95], a[200:203], a[16:19], v[92:95]
L_PAD8:
s_cbranch_execz L_PAD12
v_cvt_pk_bf16_f32 v72, v72, v73
v_cvt_pk_bf16_f32 v73, v74, v75
v_mfma_f32_16x16x32_bf16 v[92:95], a[204:207], a[24:27], v[92:95]
v_cvt_pk_bf16_f32 v74, v220, v221
v_cvt_pk_bf16_f32 v75, v222, v223
v_mfma_f32_16x16x32_bf16 v[176:179], a[208:211], a[48:51], v[144:147]
v_cvt_pk_bf16_f32 v160, v160, v161
v_cvt_pk_bf16_f32 v161, v162, v163
v_mfma_f32_16x16x32_bf16 v[176:179], a[212:215], a[52:55], v[176:179]
v_cvt_pk_bf16_f32 v162, v252, v253
v_cvt_pk_bf16_f32 v163, v254, v255
v_mfma_f32_16x16x32_bf16 v[176:179], a[216:219], a[0:3], v[176:179]
buffer_store_dwordx4 v[160:163], v19, s[24:27], s54 offen offset:256 sc1
v_mfma_f32_16x16x32_bf16 v[176:179], a[220:223], a[8:11], v[176:179]
v_cvt_pk_bf16_f32 v236, v236, v237
v_cvt_pk_bf16_f32 v237, v238, v239
v_mfma_f32_16x16x32_bf16 v[228:231], a[208:211], a[60:63], v[152:155]
v_cvt_pk_bf16_f32 v238, v224, v225
v_cvt_pk_bf16_f32 v239, v226, v227
v_mfma_f32_16x16x32_bf16 v[228:231], a[212:215], a[56:59], v[228:231]
v_cvt_pk_bf16_f32 v216, v216, v217
v_cvt_pk_bf16_f32 v217, v218, v219
v_mfma_f32_16x16x32_bf16 v[228:231], a[216:219], a[16:19], v[228:231]
v_cvt_pk_bf16_f32 v218, v208, v209
v_cvt_pk_bf16_f32 v219, v210, v211
v_mfma_f32_16x16x32_bf16 v[228:231], a[220:223], a[24:27], v[228:231]
buffer_store_dwordx4 v[216:219], v19, s[24:27], s55 offen offset:256 sc1
ds_read_b128 a[64:67], v4 offset:57344
ds_read_b128 a[68:71], v4 offset:58368
ds_read_b128 a[72:75], v4 offset:59392
ds_read_b128 a[76:79], v4 offset:60416
ds_read_b128 a[80:83], v4 offset:61440
ds_read_b128 a[84:87], v4 offset:62464
ds_read_b128 a[88:91], v4 offset:63488
ds_read_b128 a[92:95], v4 offset:64512
s_add_u32 m0, s70, 98304
s_add_u32 s64, s68, 65536
buffer_load_dwordx4 v4, s[24:27], s64 offen offset:0 sc1 lds
v_max3_f32 v24, v44, v45, v46
v_max3_f32 v25, v47, v64, v65
v_max3_f32 v26, v52, v53, v54
v_max3_f32 v27, v55, v212, v213
v_max3_f32 v24, v24, v66, v67
v_max_f32 v24, v24, v25
buffer_load_dwordx4 v4, s[24:27], s64 offen offset:1024 sc1 lds
v_max3_f32 v26, v26, v214, v215
v_max_f32 v26, v26, v27
v_mov_b32 v25, v24
v_mov_b32 v27, v26
s_nop 1
v_permlane32_swap_b32 v25, v24
buffer_load_dwordx4 v4, s[24:27], s64 offen offset:2048 sc1 lds
v_permlane32_swap_b32 v27, v26
s_nop 0
v_max_f32 v24, v24, v25
v_max_f32 v26, v26, v27
v_mov_b32 v25, v24
v_mov_b32 v27, v26
buffer_load_dwordx4 v4, s[24:27], s64 offen offset:3072 sc1 lds
s_nop 1
v_permlane16_swap_b32 v25, v24
v_permlane16_swap_b32 v27, v26
s_nop 0
v_max_f32 v24, v24, v25
v_max_f32 v26, v26, v27
s_add_u32 m0, s70, 114688
s_add_u32 s64, s68, 81920
buffer_load_dwordx4 v4, s[24:27], s64 offen offset:0 sc1 lds
v_pk_add_f32 v[44:45], v[44:45], v[24:25] op_sel_hi:[1,0] neg_lo:[0,1] neg_hi:[0,1]
v_pk_add_f32 v[46:47], v[46:47], v[24:25] op_sel_hi:[1,0] neg_lo:[0,1] neg_hi:[0,1]
v_pk_add_f32 v[52:53], v[52:53], v[26:27] op_sel_hi:[1,0] neg_lo:[0,1] neg_hi:[0,1]
v_pk_add_f32 v[54:55], v[54:55], v[26:27] op_sel_hi:[1,0] neg_lo:[0,1] neg_hi:[0,1]
v_pk_add_f32 v[64:65], v[64:65], v[24:25] op_sel_hi:[1,0] neg_lo:[0,1] neg_hi:[0,1]
v_pk_add_f32 v[66:67], v[66:67], v[24:25] op_sel_hi:[1,0] neg_lo:[0,1] neg_hi:[0,1]
buffer_load_dwordx4 v4, s[24:27], s64 offen offset:1024 sc1 lds
v_pk_add_f32 v[212:213], v[212:213], v[26:27] op_sel_hi:[1,0] neg_lo:[0,1] neg_hi:[0,1]
v_pk_add_f32 v[214:215], v[214:215], v[26:27] op_sel_hi:[1,0] neg_lo:[0,1] neg_hi:[0,1]
v_pk_add_f32 v[96:97], v[96:97], v[24:25] op_sel_hi:[1,0] neg_lo:[0,1] neg_hi:[0,1]
v_pk_add_f32 v[98:99], v[98:99], v[24:25] op_sel_hi:[1,0] neg_lo:[0,1] neg_hi:[0,1]
v_pk_add_f32 v[104:105], v[104:105], v[26:27] op_sel_hi:[1,0] neg_lo:[0,1] neg_hi:[0,1]
v_pk_add_f32 v[106:107], v[106:107], v[26:27] op_sel_hi:[1,0] neg_lo:[0,1] neg_hi:[0,1]
buffer_load_dwordx4 v4, s[24:27], s64 offen offset:2048 sc1 lds
v_pk_add_f32 v[112:113], v[112:113], v[24:25] op_sel_hi:[1,0] neg_lo:[0,1] neg_hi:[0,1]
v_pk_add_f32 v[114:115], v[114:115], v[24:25] op_sel_hi:[1,0] neg_lo:[0,1] neg_hi:[0,1]
v_pk_add_f32 v[120:121], v[120:121], v[26:27] op_sel_hi:[1,0] neg_lo:[0,1] neg_hi:[0,1]
v_pk_add_f32 v[122:123], v[122:123], v[26:27] op_sel_hi:[1,0] neg_lo:[0,1] neg_hi:[0,1]
v_exp_f32 v44, v44
v_exp_f32 v45, v45
buffer_load_dwordx4 v4, s[24:27], s64 offen offset:3072 sc1 lds
v_exp_f32 v46, v46
v_exp_f32 v47, v47
v_cvt_pk_bf16_f32 v124, v44, v45
v_exp_f32 v52, v52
v_exp_f32 v53, v53
v_cvt_pk_bf16_f32 v125, v46, v47
s_add_u32 m0, s70, 131072
s_add_u32 s64, s68, 98304
s_cmp_ge_u32 s3, 1
s_cselect_b32 s64, s64, 2147418112
buffer_load_dwordx4 v4, s[24:27], s64 offen offset:0 sc1 lds
v_exp_f32 v54, v54
v_exp_f32 v55, v55
v_cvt_pk_bf16_f32 v140, v52, v53
v_exp_f32 v64, v64
v_exp_f32 v65, v65
v_cvt_pk_bf16_f32 v141, v54, v55
buffer_load_dwordx4 v4, s[24:27], s64 offen offset:1024 sc1 lds
v_exp_f32 v66, v66
v_exp_f32 v67, v67
v_cvt_pk_bf16_f32 v126, v64, v65
v_exp_f32 v212, v212
v_exp_f32 v213, v213
v_cvt_pk_bf16_f32 v127, v66, v67
buffer_load_dwordx4 v4, s[24:27], s64 offen offset:2048 sc1 lds
v_exp_f32 v214, v214
v_exp_f32 v215, v215
v_cvt_pk_bf16_f32 v142, v212, v213
v_max3_f32 v24, v100, v101, v102
v_cvt_pk_bf16_f32 v143, v214, v215
v_max3_f32 v25, v103, v176, v177
buffer_load_dwordx4 v4, s[24:27], s64 offen offset:3072 sc1 lds
v_max3_f32 v26, v92, v93, v94
v_max3_f32 v27, v95, v228, v229
v_max3_f32 v24, v24, v178, v179
v_max_f32 v24, v24, v25
v_max3_f32 v26, v26, v230, v231
v_max_f32 v26, v26, v27
s_add_u32 m0, s70, 147456
s_add_u32 s64, s68, 114688
s_cmp_ge_u32 s3, 2
s_cselect_b32 s64, s64, 2147418112
buffer_load_dwordx4 v4, s[24:27], s64 offen offset:0 sc1 lds
v_mov_b32 v25, v24
v_mov_b32 v27, v26
s_nop 1
v_permlane32_swap_b32 v25, v24
v_permlane32_swap_b32 v27, v26
s_nop 0
buffer_load_dwordx4 v4, s[24:27], s64 offen offset:1024 sc1 lds
v_max_f32 v24, v24, v25
v_max_f32 v26, v26, v27
v_mov_b32 v25, v24
v_mov_b32 v27, v26
s_nop 1
v_permlane16_swap_b32 v25, v24
buffer_load_dwordx4 v4, s[24:27], s64 offen offset:2048 sc1 lds
v_permlane16_swap_b32 v27, v26
s_nop 0
v_max_f32 v24, v24, v25
v_max_f32 v26, v26, v27
v_pk_add_f32 v[100:101], v[100:101], v[24:25] op_sel_hi:[1,0] neg_lo:[0,1] neg_hi:[0,1]
v_pk_add_f32 v[102:103], v[102:103], v[24:25] op_sel_hi:[1,0] neg_lo:[0,1] neg_hi:[0,1]
buffer_load_dwordx4 v4, s[24:27], s64 offen offset:3072 sc1 lds
v_pk_add_f32 v[92:93], v[92:93], v[26:27] op_sel_hi:[1,0] neg_lo:[0,1] neg_hi:[0,1]
v_pk_add_f32 v[94:95], v[94:95], v[26:27] op_sel_hi:[1,0] neg_lo:[0,1] neg_hi:[0,1]
v_pk_add_f32 v[176:177], v[176:177], v[24:25] op_sel_hi:[1,0] neg_lo:[0,1] neg_hi:[0,1]
v_pk_add_f32 v[178:179], v[178:179], v[24:25] op_sel_hi:[1,0] neg_lo:[0,1] neg_hi:[0,1]
v_pk_add_f32 v[228:229], v[228:229], v[26:27] op_sel_hi:[1,0] neg_lo:[0,1] neg_hi:[0,1]
v_pk_add_f32 v[230:231], v[230:231], v[26:27] op_sel_hi:[1,0] neg_lo:[0,1] neg_hi:[0,1]
s_add_u32 m0, s70, 0
s_add_u32 s64, s68, 131072
s_cmp_ge_u32 s3, 3
s_cselect_b32 s64, s64, 2147418112
buffer_load_dwordx4 v4, s[24:27], s64 offen offset:0 sc1 lds
v_pk_add_f32 v[128:129], v[128:129], v[24:25] op_sel_hi:[1,0] neg_lo:[0,1] neg_hi:[0,1]
v_pk_add_f32 v[130:131], v[130:131], v[24:25] op_sel_hi:[1,0] neg_lo:[0,1] neg_hi:[0,1]
v_pk_add_f32 v[136:137], v[136:137], v[26:27] op_sel_hi:[1,0] neg_lo:[0,1] neg_hi:[0,1]
v_pk_add_f32 v[138:139], v[138:139], v[26:27] op_sel_hi:[1,0] neg_lo:[0,1] neg_hi:[0,1]
v_pk_add_f32 v[144:145], v[144:145], v[24:25] op_sel_hi:[1,0] neg_lo:[0,1] neg_hi:[0,1]
v_pk_add_f32 v[146:147], v[146:147], v[24:25] op_sel_hi:[1,0] neg_lo:[0,1] neg_hi:[0,1]
buffer_load_dwordx4 v4, s[24:27], s64 offen offset:1024 sc1 lds
v_pk_add_f32 v[152:153], v[152:153], v[26:27] op_sel_hi:[1,0] neg_lo:[0,1] neg_hi:[0,1]
v_pk_add_f32 v[154:155], v[154:155], v[26:27] op_sel_hi:[1,0] neg_lo:[0,1] neg_hi:[0,1]
v_accvgpr_write_b32 a146, v150
v_accvgpr_write_b32 a147, v151
v_accvgpr_write_b32 a152, v164
v_accvgpr_write_b32 a153, v165
buffer_load_dwordx4 v4, s[24:27], s64 offen offset:2048 sc1 lds
v_accvgpr_write_b32 a154, v166
v_accvgpr_write_b32 a155, v167
v_accvgpr_write_b32 a132, v72
v_accvgpr_write_b32 a133, v73
v_accvgpr_write_b32 a134, v74
v_accvgpr_write_b32 a135, v75
buffer_load_dwordx4 v4, s[24:27], s64 offen offset:3072 sc1 lds
v_accvgpr_write_b32 a140, v160
v_accvgpr_write_b32 a141, v161
v_accvgpr_write_b32 a142, v162
v_accvgpr_write_b32 a143, v163
v_accvgpr_write_b32 a148, v236
v_accvgpr_write_b32 a149, v237
v_accvgpr_write_b32 a150, v238
v_accvgpr_write_b32 a151, v239
v_accvgpr_write_b32 a156, v216
v_accvgpr_write_b32 a157, v217
v_accvgpr_write_b32 a158, v218
v_accvgpr_write_b32 a159, v219
v_mov_b64 v[60:61], 0
v_mov_b64 v[62:63], 0
v_mov_b64 v[68:69], 0
v_mov_b64 v[70:71], 0
v_mov_b64 v[72:73], 0
v_mov_b64 v[74:75], 0
v_mov_b64 v[220:221], 0
v_mov_b64 v[222:223], 0
v_mov_b64 v[84:85], 0
v_mov_b64 v[86:87], 0
v_mov_b64 v[76:77], 0
v_mov_b64 v[78:79], 0
v_mov_b64 v[160:161], 0
v_mov_b64 v[162:163], 0
v_mov_b64 v[252:253], 0
v_mov_b64 v[254:255], 0
v_mov_b64 v[148:149], 0
v_mov_b64 v[150:151], 0
v_mov_b64 v[48:49], 0
v_mov_b64 v[50:51], 0
v_mov_b64 v[236:237], 0
v_mov_b64 v[238:239], 0
v_mov_b64 v[224:225], 0
v_mov_b64 v[226:227], 0
v_mov_b64 v[164:165], 0
v_mov_b64 v[166:167], 0
v_mov_b64 v[156:157], 0
v_mov_b64 v[158:159], 0
v_mov_b64 v[216:217], 0
v_mov_b64 v[218:219], 0
v_mov_b64 v[208:209], 0
v_mov_b64 v[210:211], 0
ds_read_b128 a[192:195], v4 offset:49152
ds_read_b128 a[196:199], v4 offset:50176
ds_read_b128 a[200:203], v4 offset:51200
ds_read_b128 a[204:207], v4 offset:52224
ds_read_b128 a[208:211], v4 offset:53248
ds_read_b128 a[212:215], v4 offset:54272
ds_read_b128 a[216:219], v4 offset:55296
ds_read_b128 a[220:223], v4 offset:56320
s_waitcnt lgkmcnt(8)
s_lshl2_add_u32 s77, s86, s84
s_mul_i32 s77, s77, 344064
s_mov_b32 s80, s70
s_cmp_lt_u32 s3, 2
s_cselect_b32 s53, 8, -2
s_add_u32 s53, s53, s3
v_mfma_f32_16x16x32_bf16 v[36:39], a[64:67], v[124:127], 0
s_mul_i32 s52, s5, 65536
v_exp_f32 v100, v100
v_mfma_f32_16x16x32_bf16 v[116:119], a[64:67], v[140:143], 0
s_sub_u32 s52, 1064960, s52
v_exp_f32 v101, v101
v_mfma_f32_16x16x32_bf16 v[132:135], a[68:71], v[140:143], 0
s_add_u32 s71, s68, s52
v_exp_f32 v102, v102
v_mfma_f32_16x16x32_bf16 v[32:35], a[68:71], v[124:127], 0
s_add_u32 s77, s77, s80
v_exp_f32 v103, v103
v_mfma_f32_16x16x32_bf16 v[196:199], a[72:75], v[124:127], 0
s_add_u32 s77, s77, 38797312
v_cvt_pk_bf16_f32 v248, v100, v101
v_cvt_pk_bf16_f32 v249, v102, v103
v_mfma_f32_16x16x32_bf16 v[184:187], a[72:75], v[140:143], 0
s_add_u32 s52, s3, 6
v_exp_f32 v92, v92
v_mfma_f32_16x16x32_bf16 v[240:243], a[76:79], v[140:143], 0
s_mul_i32 s52, s52, 16384
v_exp_f32 v93, v93
v_mfma_f32_16x16x32_bf16 v[204:207], a[76:79], v[124:127], 0
s_add_u32 s68, s68, s52
v_exp_f32 v94, v94
v_mfma_f32_16x16x32_bf16 v[108:111], a[80:83], v[124:127], 0
s_lshl_b32 s53, s53, 14
v_exp_f32 v95, v95
v_mfma_f32_16x16x32_bf16 v[188:191], a[80:83], v[140:143], 0
s_add_u32 s70, s70, s53
v_cvt_pk_bf16_f32 v232, v92, v93
v_cvt_pk_bf16_f32 v233, v94, v95
v_mfma_f32_16x16x32_bf16 v[56:59], a[84:87], v[140:143], 0
s_mov_b32 s75, 65536
v_exp_f32 v176, v176
v_mfma_f32_16x16x32_bf16 v[40:43], a[84:87], v[124:127], 0
s_mov_b32 s72, 1
v_exp_f32 v177, v177
v_mfma_f32_16x16x32_bf16 v[80:83], a[88:91], v[124:127], 0
s_mov_b32 s73, 3
v_exp_f32 v178, v178
v_mfma_f32_16x16x32_bf16 v[88:91], a[88:91], v[140:143], 0
s_lshl2_add_u32 s69, s5, 4
v_exp_f32 v179, v179
v_mfma_f32_16x16x32_bf16 v[192:195], a[92:95], v[140:143], 0
s_max_u32 s69, s69, 12
v_cvt_pk_bf16_f32 v250, v176, v177
v_cvt_pk_bf16_f32 v251, v178, v179
v_mfma_f32_16x16x32_bf16 v[168:171], a[92:95], v[124:127], 0
s_min_u32 s74, s73, s66
v_exp_f32 v228, v228
v_mfma_f32_16x16x32_bf16 a[224:227], a[240:243], v[124:127], 0
s_mov_b32 s93, 3
v_mfma_f32_16x16x32_bf16 a[228:231], a[240:243], v[140:143], 0
s_cmp_lt_u32 s66, 2
s_waitcnt vmcnt(24) lgkmcnt(0)
s_cbranch_scc1 L_NE
L_DUAL:
v_mfma_f32_16x16x32_bf16 v[44:47], a[192:195], a[32:35], v[96:99]
s_barrier
v_mfma_f32_16x16x32_bf16 v[44:47], a[196:199], a[36:39], v[44:47]
s_cmp_eq_u32 s68, s71
v_exp_f32 v229, v229
v_mfma_f32_16x16x32_bf16 v[44:47], a[200:203], a[28:31], v[44:47]
s_cselect_b32 s64, s77, s68
v_add_u32 v5, s75, v4
v_cvt_pk_bf16_f32 v234, v228, v229
v_mfma_f32_16x16x32_bf16 v[44:47], a[204:207], a[20:23], v[44:47]
s_mov_b32 m0, s70
v_exp_f32 v230, v230
v_mfma_f32_16x16x32_bf16 v[52:55], a[192:195], a[44:47], v[104:107]
buffer_load_dwordx4 v4, s[24:27], s64 offen offset:0 sc1 lds
v_mfma_f32_16x16x32_bf16 v[52:55], a[196:199], a[40:43], v[52:55]
s_add_u32 s75, s75, 16384
v_exp_f32 v231, v231
v_mfma_f32_16x16x32_bf16 v[52:55], a[200:203], a[12:15], v[52:55]
v_cvt_pk_bf16_f32 v235, v230, v231
v_mfma_f32_16x16x32_bf16 v[52:55], a[204:207], a[4:7], v[52:55]
s_cmp_ge_u32 s75, 163840
v_exp_f32 v44, v44
v_mfma_f32_16x16x32_bf16 v[64:67], a[208:211], a[32:35], v[112:115]
v_mfma_f32_16x16x32_bf16 v[64:67], a[212:215], a[36:39], v[64:67]
s_cselect_b32 s75, 0, s75
v_exp_f32 v45, v45
v_mfma_f32_16x16x32_bf16 v[64:67], a[216:219], a[28:31], v[64:67]
v_cvt_pk_bf16_f32 v124, v44, v45
v_mfma_f32_16x16x32_bf16 v[64:67], a[220:223], a[20:23], v[64:67]
s_add_u32 s68, s64, 16384
v_exp_f32 v46, v46
v_mfma_f32_16x16x32_bf16 v[212:215], a[208:211], a[44:47], v[120:123]
buffer_load_dwordx4 v4, s[24:27], s64 offen offset:1024 sc1 lds
v_mfma_f32_16x16x32_bf16 v[212:215], a[212:215], a[40:43], v[212:215]
s_add_u32 s70, s70, 16384
v_exp_f32 v47, v47
v_mfma_f32_16x16x32_bf16 v[212:215], a[216:219], a[12:15], v[212:215]
v_cvt_pk_bf16_f32 v125, v46, v47
v_mfma_f32_16x16x32_bf16 v[212:215], a[220:223], a[4:7], v[212:215]
v_exp_f32 v52, v52
v_mfma_f32_16x16x32_bf16 v[60:63], a[64:67], v[248:251], v[60:63]
v_mfma_f32_16x16x32_bf16 v[148:151], a[64:67], v[232:235], v[148:151]
s_cmp_ge_u32 s70, 163840
v_exp_f32 v53, v53
v_mfma_f32_16x16x32_bf16 v[48:51], a[68:71], v[232:235], v[48:51]
ds_read_b128 a[64:67], v5 offset:8192
v_cvt_pk_bf16_f32 v140, v52, v53
v_mfma_f32_16x16x32_bf16 v[68:71], a[68:71], v[248:251], v[68:71]
s_cselect_b32 s70, s80, s70
v_exp_f32 v54, v54
v_mfma_f32_16x16x32_bf16 v[72:75], a[72:75], v[248:251], v[72:75]
buffer_load_dwordx4 v4, s[24:27], s64 offen offset:2048 sc1 lds
v_mfma_f32_16x16x32_bf16 v[236:239], a[72:75], v[232:235], v[236:239]
v_exp_f32 v55, v55
v_mfma_f32_16x16x32_bf16 v[224:227], a[76:79], v[232:235], v[224:227]
ds_read_b128 a[68:71], v5 offset:9216
v_cvt_pk_bf16_f32 v141, v54, v55
v_mfma_f32_16x16x32_bf16 v[220:223], a[76:79], v[248:251], v[220:223]
v_exp_f32 v64, v64
v_mfma_f32_16x16x32_bf16 v[84:87], a[80:83], v[248:251], v[84:87]
ds_read_b128 a[72:75], v5 offset:10240
v_mfma_f32_16x16x32_bf16 v[164:167], a[80:83], v[232:235], v[164:167]
v_exp_f32 v65, v65
v_mfma_f32_16x16x32_bf16 v[156:159], a[84:87], v[232:235], v[156:159]
ds_read_b128 a[76:79], v5 offset:11264
v_cvt_pk_bf16_f32 v126, v64, v65
v_mfma_f32_16x16x32_bf16 v[76:79], a[84:87], v[248:251], v[76:79]
v_exp_f32 v66, v66
v_mfma_f32_16x16x32_bf16 v[160:163], a[88:91], v[248:251], v[160:163]
buffer_load_dwordx4 v4, s[24:27], s64 offen offset:3072 sc1 lds
v_mfma_f32_16x16x32_bf16 v[216:219], a[88:91], v[232:235], v[216:219]
v_exp_f32 v67, v67
v_mfma_f32_16x16x32_bf16 v[208:211], a[92:95], v[232:235], v[208:211]
ds_read_b128 a[80:83], v5 offset:12288
v_cvt_pk_bf16_f32 v127, v66, v67
v_mfma_f32_16x16x32_bf16 v[252:255], a[92:95], v[248:251], v[252:255]
v_exp_f32 v212, v212
v_mfma_f32_16x16x32_bf16 a[232:235], a[240:243], v[248:251], a[232:235]
ds_read_b128 a[84:87], v5 offset:13312
v_mfma_f32_16x16x32_bf16 a[236:239], a[240:243], v[232:235], a[236:239]
ds_read_b128 a[88:91], v5 offset:14336
v_mfma_f32_16x16x32_bf16 v[100:103], a[192:195], a[48:51], v[128:131]
ds_read_b128 a[92:95], v5 offset:15360
v_mfma_f32_16x16x32_bf16 v[100:103], a[196:199], a[52:55], v[100:103]
v_exp_f32 v213, v213
v_mfma_f32_16x16x32_bf16 v[100:103], a[200:203], a[0:3], v[100:103]
v_cvt_pk_bf16_f32 v142, v212, v213
v_mfma_f32_16x16x32_bf16 v[100:103], a[204:207], a[8:11], v[100:103]
v_exp_f32 v214, v214
v_mfma_f32_16x16x32_bf16 v[92:95], a[192:195], a[60:63], v[136:139]
s_nop 0
v_mfma_f32_16x16x32_bf16 v[92:95], a[196:199], a[56:59], v[92:95]
v_exp_f32 v215, v215
v_mfma_f32_16x16x32_bf16 v[92:95], a[200:203], a[16:19], v[92:95]
ds_read_b128 a[192:195], v5 offset:0
v_cvt_pk_bf16_f32 v143, v214, v215
v_mfma_f32_16x16x32_bf16 v[92:95], a[204:207], a[24:27], v[92:95]
v_exp_f32 v100, v100
v_mfma_f32_16x16x32_bf16 v[176:179], a[208:211], a[48:51], v[144:147]
ds_read_b128 a[196:199], v5 offset:1024
v_mfma_f32_16x16x32_bf16 v[176:179], a[212:215], a[52:55], v[176:179]
v_exp_f32 v101, v101
v_mfma_f32_16x16x32_bf16 v[176:179], a[216:219], a[0:3], v[176:179]
ds_read_b128 a[200:203], v5 offset:2048
v_cvt_pk_bf16_f32 v248, v100, v101
v_mfma_f32_16x16x32_bf16 v[176:179], a[220:223], a[8:11], v[176:179]
v_exp_f32 v102, v102
v_mfma_f32_16x16x32_bf16 v[228:231], a[208:211], a[60:63], v[152:155]
ds_read_b128 a[204:207], v5 offset:3072
v_mfma_f32_16x16x32_bf16 v[228:231], a[212:215], a[56:59], v[228:231]
v_exp_f32 v103, v103
v_mfma_f32_16x16x32_bf16 v[228:231], a[216:219], a[16:19], v[228:231]
ds_read_b128 a[208:211], v5 offset:4096
v_cvt_pk_bf16_f32 v249, v102, v103
v_mfma_f32_16x16x32_bf16 v[228:231], a[220:223], a[24:27], v[228:231]
s_waitcnt lgkmcnt(5)
v_exp_f32 v92, v92
v_mfma_f32_16x16x32_bf16 v[36:39], a[64:67], v[124:127], v[36:39]
ds_read_b128 a[212:215], v5 offset:5120
v_mfma_f32_16x16x32_bf16 v[116:119], a[64:67], v[140:143], v[116:119]
v_exp_f32 v93, v93
v_mfma_f32_16x16x32_bf16 v[132:135], a[68:71], v[140:143], v[132:135]
ds_read_b128 a[216:219], v5 offset:6144
v_cvt_pk_bf16_f32 v232, v92, v93
v_mfma_f32_16x16x32_bf16 v[32:35], a[68:71], v[124:127], v[32:35]
v_exp_f32 v94, v94
v_mfma_f32_16x16x32_bf16 v[196:199], a[72:75], v[124:127], v[196:199]
ds_read_b128 a[220:223], v5 offset:7168
v_mfma_f32_16x16x32_bf16 v[184:187], a[72:75], v[140:143], v[184:187]
s_add_u32 s72, s72, 1
v_exp_f32 v95, v95
v_mfma_f32_16x16x32_bf16 v[240:243], a[76:79], v[140:143], v[240:243]
v_cvt_pk_bf16_f32 v233, v94, v95
v_mfma_f32_16x16x32_bf16 v[204:207], a[76:79], v[124:127], v[204:207]
v_exp_f32 v176, v176
v_mfma_f32_16x16x32_bf16 v[108:111], a[80:83], v[124:127], v[108:111]
v_mfma_f32_16x16x32_bf16 v[188:191], a[80:83], v[140:143], v[188:191]
v_exp_f32 v177, v177
v_mfma_f32_16x16x32_bf16 v[56:59], a[84:87], v[140:143], v[56:59]
v_cvt_pk_bf16_f32 v250, v176, v177
v_mfma_f32_16x16x32_bf16 v[40:43], a[84:87], v[124:127], v[40:43]
v_exp_f32 v178, v178
v_mfma_f32_16x16x32_bf16 v[80:83], a[88:91], v[124:127], v[80:83]
v_mfma_f32_16x16x32_bf16 v[88:91], a[88:91], v[140:143], v[88:91]
s_cmp_lt_u32 s72, s74
v_exp_f32 v179, v179
v_mfma_f32_16x16x32_bf16 v[192:195], a[92:95], v[140:143], v[192:195]
v_cvt_pk_bf16_f32 v251, v178, v179
v_mfma_f32_16x16x32_bf16 v[168:171], a[92:95], v[124:127], v[168:171]
s_waitcnt vmcnt(8) lgkmcnt(0)
v_exp_f32 v228, v228
v_mfma_f32_16x16x32_bf16 a[224:227], a[240:243], v[124:127], a[224:227]
v_mfma_f32_16x16x32_bf16 a[228:231], a[240:243], v[140:143], a[228:231]
s_cbranch_scc1 L_DUAL
L_DISP:
s_cmp_eq_u32 s72, s93
s_cbranch_scc1 L_STOP
L_NE:
s_mov_b32 s74, s93
s_cmp_gt_u32 s72, s66
s_cbranch_scc1 L_SINGLE
v_cndmask_b32 v96, v96, v6, s[56:57]
v_cndmask_b32 v120, v120, v6, s[56:57]
v_mov_b32 v112, v6
v_cndmask_b32 v97, v97, v6, s[58:59]
v_cndmask_b32 v121, v121, v6, s[58:59]
v_mov_b32 v113, v6
v_cndmask_b32 v98, v98, v6, s[60:61]
v_cndmask_b32 v122, v122, v6, s[60:61]
v_mov_b32 v114, v6
v_cndmask_b32 v99, v99, v6, s[62:63]
v_cndmask_b32 v123, v123, v6, s[62:63]
v_mov_b32 v115, v6
s_mov_b32 s74, 0
s_branch L_DUAL
L_STOP:
s_cmp_eq_u32 s72, 3
s_cbranch_scc1 L_E0
s_cmp_eq_u32 s72, 9
s_cbranch_scc1 L_E1
s_cmp_lg_u32 s72, 11
s_cbranch_scc1 L_SE
v_cmp_gt_u32 vcc, 32, v172
s_mov_b32 s73, 32
s_min_u32 s93, s73, s69
s_min_u32 s74, s93, s66
s_nop 1
s_cbranch_vccnz CK_Q
CK_Q_R:
s_add_u32 s53, s77, 163840
buffer_load_dwordx4 a[96:99], v4, s[24:27], s53 offen offset:0 sc1
buffer_load_dwordx4 a[100:103], v4, s[24:27], s53 offen offset:1024 sc1
buffer_load_dwordx4 a[104:107], v4, s[24:27], s53 offen offset:2048 sc1
buffer_load_dwordx4 a[108:111], v4, s[24:27], s53 offen offset:3072 sc1
s_cmp_lt_u32 s72, s66
s_cbranch_scc1 L_DUAL
s_mov_b32 s74, s93
s_cmp_gt_u32 s72, s66
s_cbranch_scc1 L_SINGLE
s_branch L_NE
L_E0:
buffer_atomic_add v1, v0, s[24:27], s89 offen offset:8 sc1
s_mov_b32 s73, 9
s_min_u32 s93, s73, s69
s_min_u32 s74, s93, s66
s_cmp_lt_u32 s72, s66
s_cbranch_scc1 L_DUAL
s_mov_b32 s74, s93
s_cmp_gt_u32 s72, s66
s_cbranch_scc1 L_SINGLE
s_branch L_NE
L_E1:
v_and_b32 v173, 31, v1
v_lshlrev_b32 v173, 10, v173
v_add_u32 v173, 75497992, v173
buffer_load_dword v172, v173, s[24:27], 0 offen sc1
s_mov_b32 s73, 11
s_min_u32 s93, s73, s69
s_min_u32 s74, s93, s66
s_cmp_lt_u32 s72, s66
s_cbranch_scc1 L_DUAL
s_mov_b32 s74, s93
s_cmp_gt_u32 s72, s66
s_cbranch_scc1 L_SINGLE
s_branch L_NE
L_SE:
s_lshr_b32 s52, s4, 3
s_mul_i32 s52, s52, 75776
s_add_u32 s52, s52, 54525952
s_and_b32 s53, s4, 7
s_mul_i32 s53, s53, 8192
s_add_u32 s52, s52, s53
s_mul_i32 s78, s66, 303104
s_add_u32 s78, s78, s52
s_mul_i32 s79, s67, 303104
s_add_u32 s79, s79, s52
s_mov_b32 s76, 0
v_mov_b32 v7, 0x5d800000
s_mov_b32 s69, 64
v_accvgpr_read_b32 v180, a224
v_accvgpr_read_b32 v182, a228
v_cmp_nle_f32 vcc, v180, v7
v_cmp_nle_f32 s[96:97], v182, v7
s_nop 3
s_or_b64 vcc, vcc, s[96:97]
s_cbranch_vccnz L_NS
s_add_u32 s53, s77, 180224
buffer_load_dwordx4 a[112:115], v4, s[24:27], s53 offen offset:0 sc1
v_mul_f32 v8, 0x3fb8aa3b, v8
v_mul_f32 v9, 0x3fb8aa3b, v9
v_exp_f32 v8, v8
v_exp_f32 v9, v9
s_nop 0
v_fma_f32 v180, v180, v8, v180
v_fma_f32 v182, v182, v9, v182
v_rcp_f32 v180, v180
v_rcp_f32 v182, v182
s_add_u32 s52, s78, 4096
v_mov_b32 v181, v180
v_mov_b32 v183, v182
v_pk_mul_f32 v[36:37], v[36:37], v[180:181]
v_pk_mul_f32 v[38:39], v[38:39], v[180:181]
v_pk_mul_f32 v[32:33], v[32:33], v[180:181]
v_pk_mul_f32 v[34:35], v[34:35], v[180:181]
v_cvt_pk_bf16_f32 v36, v36, v37
v_cvt_pk_bf16_f32 v37, v38, v39
v_cvt_pk_bf16_f32 v38, v32, v33
v_cvt_pk_bf16_f32 v39, v34, v35
buffer_store_dwordx4 v[36:39], v4, s[24:27], s78 offen offset:0 sc1
buffer_load_dwordx4 a[116:119], v4, s[24:27], s53 offen offset:1024 sc1
v_pk_mul_f32 v[116:117], v[116:117], v[182:183]
v_pk_mul_f32 v[118:119], v[118:119], v[182:183]
v_pk_mul_f32 v[132:133], v[132:133], v[182:183]
v_pk_mul_f32 v[134:135], v[134:135], v[182:183]
v_cvt_pk_bf16_f32 v116, v116, v117
v_cvt_pk_bf16_f32 v117, v118, v119
v_cvt_pk_bf16_f32 v118, v132, v133
v_cvt_pk_bf16_f32 v119, v134, v135
buffer_store_dwordx4 v[116:119], v4, s[24:27], s78 offen offset:1024 sc1
v_pk_mul_f32 v[196:197], v[196:197], v[180:181]
v_pk_mul_f32 v[198:199], v[198:199], v[180:181]
v_pk_mul_f32 v[204:205], v[204:205], v[180:181]
v_pk_mul_f32 v[206:207], v[206:207], v[180:181]
v_cvt_pk_bf16_f32 v196, v196, v197
v_cvt_pk_bf16_f32 v197, v198, v199
v_cvt_pk_bf16_f32 v198, v204, v205
v_cvt_pk_bf16_f32 v199, v206, v207
buffer_store_dwordx4 v[196:199], v4, s[24:27], s78 offen offset:2048 sc1
v_pk_mul_f32 v[184:185], v[184:185], v[182:183]
v_pk_mul_f32 v[186:187], v[186:187], v[182:183]
v_pk_mul_f32 v[240:241], v[240:241], v[182:183]
buffer_load_dwordx4 a[120:123], v4, s[24:27], s53 offen offset:2048 sc1
v_pk_mul_f32 v[242:243], v[242:243], v[182:183]
v_cvt_pk_bf16_f32 v184, v184, v185
v_cvt_pk_bf16_f32 v185, v186, v187
v_cvt_pk_bf16_f32 v186, v240, v241
v_cvt_pk_bf16_f32 v187, v242, v243
buffer_store_dwordx4 v[184:187], v4, s[24:27], s78 offen offset:3072 sc1
v_pk_mul_f32 v[108:109], v[108:109], v[180:181]
v_pk_mul_f32 v[110:111], v[110:111], v[180:181]
v_pk_mul_f32 v[40:41], v[40:41], v[180:181]
v_pk_mul_f32 v[42:43], v[42:43], v[180:181]
v_cvt_pk_bf16_f32 v108, v108, v109
v_cvt_pk_bf16_f32 v109, v110, v111
v_cvt_pk_bf16_f32 v110, v40, v41
v_cvt_pk_bf16_f32 v111, v42, v43
buffer_store_dwordx4 v[108:111], v4, s[24:27], s52 offen offset:0 sc1
v_pk_mul_f32 v[188:189], v[188:189], v[182:183]
v_pk_mul_f32 v[190:191], v[190:191], v[182:183]
v_pk_mul_f32 v[56:57], v[56:57], v[182:183]
v_pk_mul_f32 v[58:59], v[58:59], v[182:183]
v_cvt_pk_bf16_f32 v188, v188, v189
v_cvt_pk_bf16_f32 v189, v190, v191
buffer_load_dwordx4 a[124:127], v4, s[24:27], s53 offen offset:3072 sc1
v_cvt_pk_bf16_f32 v190, v56, v57
v_cvt_pk_bf16_f32 v191, v58, v59
buffer_store_dwordx4 v[188:191], v4, s[24:27], s52 offen offset:1024 sc1
v_pk_mul_f32 v[80:81], v[80:81], v[180:181]
v_pk_mul_f32 v[82:83], v[82:83], v[180:181]
v_pk_mul_f32 v[168:169], v[168:169], v[180:181]
v_pk_mul_f32 v[170:171], v[170:171], v[180:181]
v_cvt_pk_bf16_f32 v80, v80, v81
v_cvt_pk_bf16_f32 v81, v82, v83
v_cvt_pk_bf16_f32 v82, v168, v169
v_cvt_pk_bf16_f32 v83, v170, v171
buffer_store_dwordx4 v[80:83], v4, s[24:27], s52 offen offset:2048 sc1
v_pk_mul_f32 v[88:89], v[88:89], v[182:183]
v_pk_mul_f32 v[90:91], v[90:91], v[182:183]
v_pk_mul_f32 v[192:193], v[192:193], v[182:183]
v_pk_mul_f32 v[194:195], v[194:195], v[182:183]
v_cvt_pk_bf16_f32 v88, v88, v89
v_cvt_pk_bf16_f32 v89, v90, v91
v_cvt_pk_bf16_f32 v90, v192, v193
v_cvt_pk_bf16_f32 v91, v194, v195
buffer_store_dwordx4 v[88:91], v4, s[24:27], s52 offen offset:3072 sc1
L_PAD9:
s_cbranch_execz L_PAD13
s_mov_b32 s76, 1
L_NS:
s_mov_b32 s74, s73
s_mov_b32 s93, s73
s_cmp_eq_u32 s72, 32
s_cbranch_scc1 L_FIN
L_SINGLE:
v_mfma_f32_16x16x32_bf16 v[44:47], a[192:195], a[48:51], v[128:131]
s_barrier
v_mfma_f32_16x16x32_bf16 v[44:47], a[196:199], a[52:55], v[44:47]
s_cmp_eq_u32 s68, s71
v_exp_f32 v229, v229
v_mfma_f32_16x16x32_bf16 v[44:47], a[200:203], a[0:3], v[44:47]
s_cselect_b32 s64, s77, s68
v_add_u32 v5, s75, v4
v_cvt_pk_bf16_f32 v234, v228, v229
v_mfma_f32_16x16x32_bf16 v[44:47], a[204:207], a[8:11], v[44:47]
s_mov_b32 m0, s70
v_exp_f32 v230, v230
v_mfma_f32_16x16x32_bf16 v[52:55], a[192:195], a[60:63], v[136:139]
buffer_load_dwordx4 v4, s[24:27], s64 offen offset:0 sc1 lds
v_mfma_f32_16x16x32_bf16 v[52:55], a[196:199], a[56:59], v[52:55]
s_add_u32 s75, s75, 16384
v_exp_f32 v231, v231
v_mfma_f32_16x16x32_bf16 v[52:55], a[200:203], a[16:19], v[52:55]
ds_read_b128 a[192:195], v5 offset:0
v_cvt_pk_bf16_f32 v235, v230, v231
v_mfma_f32_16x16x32_bf16 v[52:55], a[204:207], a[24:27], v[52:55]
s_cmp_ge_u32 s75, 163840
v_exp_f32 v44, v44
v_mfma_f32_16x16x32_bf16 v[64:67], a[208:211], a[48:51], v[144:147]
ds_read_b128 a[196:199], v5 offset:1024
ds_read_b128 a[200:203], v5 offset:2048
v_mfma_f32_16x16x32_bf16 v[64:67], a[212:215], a[52:55], v[64:67]
s_cselect_b32 s75, 0, s75
v_exp_f32 v45, v45
v_mfma_f32_16x16x32_bf16 v[64:67], a[216:219], a[0:3], v[64:67]
ds_read_b128 a[204:207], v5 offset:3072
v_cvt_pk_bf16_f32 v124, v44, v45
v_mfma_f32_16x16x32_bf16 v[64:67], a[220:223], a[8:11], v[64:67]
s_add_u32 s68, s64, 16384
v_exp_f32 v46, v46
v_mfma_f32_16x16x32_bf16 v[212:215], a[208:211], a[60:63], v[152:155]
buffer_load_dwordx4 v4, s[24:27], s64 offen offset:1024 sc1 lds
v_mfma_f32_16x16x32_bf16 v[212:215], a[212:215], a[56:59], v[212:215]
s_add_u32 s70, s70, 16384
v_exp_f32 v47, v47
v_mfma_f32_16x16x32_bf16 v[212:215], a[216:219], a[16:19], v[212:215]
ds_read_b128 a[208:211], v5 offset:4096
v_cvt_pk_bf16_f32 v125, v46, v47
v_mfma_f32_16x16x32_bf16 v[212:215], a[220:223], a[24:27], v[212:215]
s_waitcnt lgkmcnt(5)
v_exp_f32 v52, v52
v_mfma_f32_16x16x32_bf16 v[60:63], a[64:67], v[248:251], v[60:63]
ds_read_b128 a[212:215], v5 offset:5120
ds_read_b128 a[216:219], v5 offset:6144
v_mfma_f32_16x16x32_bf16 v[148:151], a[64:67], v[232:235], v[148:151]
s_cmp_ge_u32 s70, 163840
v_exp_f32 v53, v53
v_mfma_f32_16x16x32_bf16 v[48:51], a[68:71], v[232:235], v[48:51]
ds_read_b128 a[220:223], v5 offset:7168
v_cvt_pk_bf16_f32 v140, v52, v53
v_mfma_f32_16x16x32_bf16 v[68:71], a[68:71], v[248:251], v[68:71]
s_cselect_b32 s70, s80, s70
v_exp_f32 v54, v54
v_mfma_f32_16x16x32_bf16 v[72:75], a[72:75], v[248:251], v[72:75]
buffer_load_dwordx4 v4, s[24:27], s64 offen offset:2048 sc1 lds
v_mfma_f32_16x16x32_bf16 v[236:239], a[72:75], v[232:235], v[236:239]
v_exp_f32 v55, v55
v_mfma_f32_16x16x32_bf16 v[224:227], a[76:79], v[232:235], v[224:227]
ds_read_b128 a[64:67], v5 offset:8192
v_cvt_pk_bf16_f32 v141, v54, v55
v_mfma_f32_16x16x32_bf16 v[220:223], a[76:79], v[248:251], v[220:223]
v_exp_f32 v64, v64
v_mfma_f32_16x16x32_bf16 v[84:87], a[80:83], v[248:251], v[84:87]
ds_read_b128 a[68:71], v5 offset:9216
ds_read_b128 a[72:75], v5 offset:10240
v_mfma_f32_16x16x32_bf16 v[164:167], a[80:83], v[232:235], v[164:167]
v_exp_f32 v65, v65
v_mfma_f32_16x16x32_bf16 v[156:159], a[84:87], v[232:235], v[156:159]
ds_read_b128 a[76:79], v5 offset:11264
v_cvt_pk_bf16_f32 v126, v64, v65
v_mfma_f32_16x16x32_bf16 v[76:79], a[84:87], v[248:251], v[76:79]
s_cmp_eq_u32 s68, s71
v_exp_f32 v66, v66
v_mfma_f32_16x16x32_bf16 v[160:163], a[88:91], v[248:251], v[160:163]
buffer_load_dwordx4 v4, s[24:27], s64 offen offset:3072 sc1 lds
v_mfma_f32_16x16x32_bf16 v[216:219], a[88:91], v[232:235], v[216:219]
s_cselect_b32 s64, s77, s68
v_exp_f32 v67, v67
v_mfma_f32_16x16x32_bf16 v[208:211], a[92:95], v[232:235], v[208:211]
ds_read_b128 a[80:83], v5 offset:12288
v_cvt_pk_bf16_f32 v127, v66, v67
v_mfma_f32_16x16x32_bf16 v[252:255], a[92:95], v[248:251], v[252:255]
s_waitcnt lgkmcnt(5)
v_exp_f32 v212, v212
v_mfma_f32_16x16x32_bf16 a[232:235], a[240:243], v[248:251], a[232:235]
ds_read_b128 a[84:87], v5 offset:13312
ds_read_b128 a[88:91], v5 offset:14336
v_mfma_f32_16x16x32_bf16 a[236:239], a[240:243], v[232:235], a[236:239]
s_mov_b32 m0, s70
ds_read_b128 a[92:95], v5 offset:15360
v_mfma_f32_16x16x32_bf16 v[100:103], a[192:195], a[48:51], v[128:131]
buffer_load_dwordx4 v4, s[24:27], s64 offen offset:0 sc1 lds
v_mfma_f32_16x16x32_bf16 v[100:103], a[196:199], a[52:55], v[100:103]
v_exp_f32 v213, v213
v_mfma_f32_16x16x32_bf16 v[100:103], a[200:203], a[0:3], v[100:103]
v_add_u32 v5, s75, v4
v_cvt_pk_bf16_f32 v142, v212, v213
v_mfma_f32_16x16x32_bf16 v[100:103], a[204:207], a[8:11], v[100:103]
v_exp_f32 v214, v214
v_mfma_f32_16x16x32_bf16 v[92:95], a[192:195], a[60:63], v[136:139]
buffer_load_dwordx4 v4, s[24:27], s64 offen offset:1024 sc1 lds
v_mfma_f32_16x16x32_bf16 v[92:95], a[196:199], a[56:59], v[92:95]
s_add_u32 s75, s75, 16384
v_exp_f32 v215, v215
v_mfma_f32_16x16x32_bf16 v[92:95], a[200:203], a[16:19], v[92:95]
ds_read_b128 a[192:195], v5 offset:0
v_cvt_pk_bf16_f32 v143, v214, v215
v_mfma_f32_16x16x32_bf16 v[92:95], a[204:207], a[24:27], v[92:95]
s_cmp_ge_u32 s75, 163840
v_exp_f32 v100, v100
v_mfma_f32_16x16x32_bf16 v[176:179], a[208:211], a[48:51], v[144:147]
ds_read_b128 a[196:199], v5 offset:1024
ds_read_b128 a[200:203], v5 offset:2048
v_mfma_f32_16x16x32_bf16 v[176:179], a[212:215], a[52:55], v[176:179]
s_cselect_b32 s75, 0, s75
v_exp_f32 v101, v101
v_mfma_f32_16x16x32_bf16 v[176:179], a[216:219], a[0:3], v[176:179]
ds_read_b128 a[204:207], v5 offset:3072
v_cvt_pk_bf16_f32 v248, v100, v101
v_mfma_f32_16x16x32_bf16 v[176:179], a[220:223], a[8:11], v[176:179]
s_add_u32 s68, s64, 16384
v_exp_f32 v102, v102
v_mfma_f32_16x16x32_bf16 v[228:231], a[208:211], a[60:63], v[152:155]
buffer_load_dwordx4 v4, s[24:27], s64 offen offset:2048 sc1 lds
v_mfma_f32_16x16x32_bf16 v[228:231], a[212:215], a[56:59], v[228:231]
s_add_u32 s70, s70, 16384
v_exp_f32 v103, v103
v_mfma_f32_16x16x32_bf16 v[228:231], a[216:219], a[16:19], v[228:231]
ds_read_b128 a[208:211], v5 offset:4096
v_cvt_pk_bf16_f32 v249, v102, v103
v_mfma_f32_16x16x32_bf16 v[228:231], a[220:223], a[24:27], v[228:231]
s_waitcnt lgkmcnt(5)
v_exp_f32 v92, v92
v_mfma_f32_16x16x32_bf16 v[60:63], a[64:67], v[124:127], v[60:63]
ds_read_b128 a[212:215], v5 offset:5120
ds_read_b128 a[216:219], v5 offset:6144
v_mfma_f32_16x16x32_bf16 v[148:151], a[64:67], v[140:143], v[148:151]
s_cmp_ge_u32 s70, 163840
v_exp_f32 v93, v93
v_mfma_f32_16x16x32_bf16 v[48:51], a[68:71], v[140:143], v[48:51]
ds_read_b128 a[220:223], v5 offset:7168
v_cvt_pk_bf16_f32 v232, v92, v93
v_mfma_f32_16x16x32_bf16 v[68:71], a[68:71], v[124:127], v[68:71]
s_cselect_b32 s70, s80, s70
v_exp_f32 v94, v94
v_mfma_f32_16x16x32_bf16 v[72:75], a[72:75], v[124:127], v[72:75]
buffer_load_dwordx4 v4, s[24:27], s64 offen offset:3072 sc1 lds
v_mfma_f32_16x16x32_bf16 v[236:239], a[72:75], v[140:143], v[236:239]
s_add_u32 s72, s72, 1
v_exp_f32 v95, v95
v_mfma_f32_16x16x32_bf16 v[224:227], a[76:79], v[140:143], v[224:227]
ds_read_b128 a[64:67], v5 offset:8192
v_cvt_pk_bf16_f32 v233, v94, v95
v_mfma_f32_16x16x32_bf16 v[220:223], a[76:79], v[124:127], v[220:223]
v_exp_f32 v176, v176
v_mfma_f32_16x16x32_bf16 v[84:87], a[80:83], v[124:127], v[84:87]
ds_read_b128 a[68:71], v5 offset:9216
ds_read_b128 a[72:75], v5 offset:10240
v_mfma_f32_16x16x32_bf16 v[164:167], a[80:83], v[140:143], v[164:167]
v_exp_f32 v177, v177
v_mfma_f32_16x16x32_bf16 v[156:159], a[84:87], v[140:143], v[156:159]
ds_read_b128 a[76:79], v5 offset:11264
v_cvt_pk_bf16_f32 v250, v176, v177
v_mfma_f32_16x16x32_bf16 v[76:79], a[84:87], v[124:127], v[76:79]
v_exp_f32 v178, v178
v_mfma_f32_16x16x32_bf16 v[160:163], a[88:91], v[124:127], v[160:163]
ds_read_b128 a[80:83], v5 offset:12288
ds_read_b128 a[84:87], v5 offset:13312
v_mfma_f32_16x16x32_bf16 v[216:219], a[88:91], v[140:143], v[216:219]
s_cmp_lt_u32 s72, s74
v_exp_f32 v179, v179
v_mfma_f32_16x16x32_bf16 v[208:211], a[92:95], v[140:143], v[208:211]
ds_read_b128 a[88:91], v5 offset:14336
v_cvt_pk_bf16_f32 v251, v178, v179
v_mfma_f32_16x16x32_bf16 v[252:255], a[92:95], v[124:127], v[252:255]
s_waitcnt vmcnt(8) lgkmcnt(7)
v_exp_f32 v228, v228
v_mfma_f32_16x16x32_bf16 a[232:235], a[240:243], v[124:127], a[232:235]
ds_read_b128 a[92:95], v5 offset:15360
v_mfma_f32_16x16x32_bf16 a[236:239], a[240:243], v[140:143], a[236:239]
s_cbranch_scc1 L_SINGLE
s_cmp_eq_u32 s72, s69
s_cbranch_scc1 L_SE
s_cmp_lt_u32 s72, 32
s_cbranch_scc1 L_STOP
L_FIN:
s_add_u32 s53, s77, 196608
buffer_load_dwordx4 a[160:163], v4, s[24:27], s53 offen offset:0 sc1
v_cndmask_b32 v128, v128, v6, s[56:57]
v_cndmask_b32 v152, v152, v6, s[56:57]
v_mov_b32 v144, v6
buffer_load_dwordx4 a[164:167], v4, s[24:27], s53 offen offset:1024 sc1
v_cndmask_b32 v129, v129, v6, s[58:59]
v_cndmask_b32 v153, v153, v6, s[58:59]
v_mov_b32 v145, v6
buffer_load_dwordx4 a[168:171], v4, s[24:27], s53 offen offset:2048 sc1
v_cndmask_b32 v130, v130, v6, s[60:61]
v_cndmask_b32 v154, v154, v6, s[60:61]
v_mov_b32 v146, v6
buffer_load_dwordx4 a[172:175], v4, s[24:27], s53 offen offset:3072 sc1
v_cndmask_b32 v131, v131, v6, s[62:63]
v_cndmask_b32 v155, v155, v6, s[62:63]
v_mov_b32 v147, v6
s_sub_u32 s91, s70, s80
s_mov_b32 s83, s75
s_lshl_b32 s53, s4, 18
s_add_u32 s53, s53, 45088768
s_max_u32 s54, s66, 1
s_lshl_b32 s54, s54, 9
s_add_u32 s54, s54, s53
s_lshl_b32 s55, s67, 9
s_add_u32 s55, s55, s53
v_mfma_f32_16x16x32_bf16 v[44:47], a[192:195], a[48:51], v[128:131]
s_barrier
v_mfma_f32_16x16x32_bf16 v[44:47], a[196:199], a[52:55], v[44:47]
s_add_u32 m0, s83, 0
v_exp_f32 v229, v229
v_mfma_f32_16x16x32_bf16 v[44:47], a[200:203], a[0:3], v[44:47]
s_add_u32 s64, s54, 65280
v_add_u32 v5, s75, v4
v_cvt_pk_bf16_f32 v234, v228, v229
v_mfma_f32_16x16x32_bf16 v[44:47], a[204:207], a[8:11], v[44:47]
v_exp_f32 v230, v230
v_mfma_f32_16x16x32_bf16 v[52:55], a[192:195], a[60:63], v[136:139]
s_mov_b64 exec, 0xffff
buffer_load_dwordx4 v4, s[24:27], s64 offen sc1 lds
s_mov_b64 exec, -1
v_mfma_f32_16x16x32_bf16 v[52:55], a[196:199], a[56:59], v[52:55]
s_add_u32 m0, s83, 768
v_exp_f32 v231, v231
v_mfma_f32_16x16x32_bf16 v[52:55], a[200:203], a[16:19], v[52:55]
s_add_u32 s64, s54, 98048
v_cvt_pk_bf16_f32 v235, v230, v231
v_mfma_f32_16x16x32_bf16 v[52:55], a[204:207], a[24:27], v[52:55]
v_exp_f32 v44, v44
v_mfma_f32_16x16x32_bf16 v[64:67], a[208:211], a[48:51], v[144:147]
s_mov_b64 exec, 0xffff
buffer_load_dwordx4 v4, s[24:27], s64 offen sc1 lds
s_mov_b64 exec, -1
v_mfma_f32_16x16x32_bf16 v[64:67], a[212:215], a[52:55], v[64:67]
s_add_u32 m0, s83, 1536
v_exp_f32 v45, v45
v_mfma_f32_16x16x32_bf16 v[64:67], a[216:219], a[0:3], v[64:67]
s_add_u32 s64, s54, 130816
v_cvt_pk_bf16_f32 v124, v44, v45
v_mfma_f32_16x16x32_bf16 v[64:67], a[220:223], a[8:11], v[64:67]
v_exp_f32 v46, v46
v_mfma_f32_16x16x32_bf16 v[212:215], a[208:211], a[60:63], v[152:155]
s_mov_b64 exec, 0xffff
buffer_load_dwordx4 v4, s[24:27], s64 offen sc1 lds
s_mov_b64 exec, -1
v_mfma_f32_16x16x32_bf16 v[212:215], a[212:215], a[56:59], v[212:215]
s_add_u32 m0, s83, 2304
v_exp_f32 v47, v47
v_mfma_f32_16x16x32_bf16 v[212:215], a[216:219], a[16:19], v[212:215]
s_add_u32 s64, s54, 163584
v_cvt_pk_bf16_f32 v125, v46, v47
v_mfma_f32_16x16x32_bf16 v[212:215], a[220:223], a[24:27], v[212:215]
s_waitcnt lgkmcnt(0)
v_exp_f32 v52, v52
v_mfma_f32_16x16x32_bf16 v[60:63], a[64:67], v[248:251], v[60:63]
s_mov_b64 exec, 0xffff
buffer_load_dwordx4 v4, s[24:27], s64 offen sc1 lds
s_mov_b64 exec, -1
v_mfma_f32_16x16x32_bf16 v[148:151], a[64:67], v[232:235], v[148:151]
s_add_u32 m0, s83, 3072
v_exp_f32 v53, v53
v_mfma_f32_16x16x32_bf16 v[48:51], a[68:71], v[232:235], v[48:51]
s_add_u32 s64, s54, 196352
ds_read_b128 a[64:67], v5 offset:8192
v_cvt_pk_bf16_f32 v140, v52, v53
v_mfma_f32_16x16x32_bf16 v[68:71], a[68:71], v[248:251], v[68:71]
v_exp_f32 v54, v54
v_mfma_f32_16x16x32_bf16 v[72:75], a[72:75], v[248:251], v[72:75]
s_mov_b64 exec, 0xffff
buffer_load_dwordx4 v4, s[24:27], s64 offen sc1 lds
s_mov_b64 exec, -1
v_mfma_f32_16x16x32_bf16 v[236:239], a[72:75], v[232:235], v[236:239]
v_exp_f32 v55, v55
v_mfma_f32_16x16x32_bf16 v[224:227], a[76:79], v[232:235], v[224:227]
ds_read_b128 a[68:71], v5 offset:9216
v_cvt_pk_bf16_f32 v141, v54, v55
v_mfma_f32_16x16x32_bf16 v[220:223], a[76:79], v[248:251], v[220:223]
v_exp_f32 v64, v64
v_mfma_f32_16x16x32_bf16 v[84:87], a[80:83], v[248:251], v[84:87]
ds_read_b128 a[72:75], v5 offset:10240
v_mfma_f32_16x16x32_bf16 v[164:167], a[80:83], v[232:235], v[164:167]
s_add_u32 m0, s83, 3840
v_exp_f32 v65, v65
v_mfma_f32_16x16x32_bf16 v[156:159], a[84:87], v[232:235], v[156:159]
s_add_u32 s64, s55, 65280
ds_read_b128 a[76:79], v5 offset:11264
v_cvt_pk_bf16_f32 v126, v64, v65
v_mfma_f32_16x16x32_bf16 v[76:79], a[84:87], v[248:251], v[76:79]
v_exp_f32 v66, v66
v_mfma_f32_16x16x32_bf16 v[160:163], a[88:91], v[248:251], v[160:163]
s_mov_b64 exec, 0xffff
buffer_load_dwordx4 v4, s[24:27], s64 offen sc1 lds
s_mov_b64 exec, -1
v_mfma_f32_16x16x32_bf16 v[216:219], a[88:91], v[232:235], v[216:219]
v_exp_f32 v67, v67
v_mfma_f32_16x16x32_bf16 v[208:211], a[92:95], v[232:235], v[208:211]
ds_read_b128 a[80:83], v5 offset:12288
v_cvt_pk_bf16_f32 v127, v66, v67
v_mfma_f32_16x16x32_bf16 v[252:255], a[92:95], v[248:251], v[252:255]
v_exp_f32 v212, v212
v_mfma_f32_16x16x32_bf16 a[232:235], a[240:243], v[248:251], a[232:235]
ds_read_b128 a[84:87], v5 offset:13312
ds_read_b128 a[88:91], v5 offset:14336
v_mfma_f32_16x16x32_bf16 a[236:239], a[240:243], v[232:235], a[236:239]
ds_read_b128 a[92:95], v5 offset:15360
v_exp_f32 v213, v213
v_exp_f32 v214, v214
v_exp_f32 v215, v215
v_cmp_lt_u32 vcc, 31, v1
v_cvt_pk_bf16_f32 v142, v212, v213
v_cvt_pk_bf16_f32 v143, v214, v215
s_waitcnt lgkmcnt(0)
s_add_u32 m0, s83, 4608
v_mfma_f32_16x16x32_bf16 v[60:63], a[64:67], v[124:127], v[60:63]
s_add_u32 s64, s55, 98048
v_and_b32 v202, 31, v1
v_mov_b32 v200, s66
v_mfma_f32_16x16x32_bf16 v[148:151], a[64:67], v[140:143], v[148:151]
s_mov_b64 exec, 0xffff
buffer_load_dwordx4 v4, s[24:27], s64 offen sc1 lds
s_mov_b64 exec, -1
v_mfma_f32_16x16x32_bf16 v[48:51], a[68:71], v[140:143], v[48:51]
s_add_u32 m0, s83, 5376
s_add_u32 s64, s55, 130816
v_mov_b32 v203, s67
v_mfma_f32_16x16x32_bf16 v[68:71], a[68:71], v[124:127], v[68:71]
s_mov_b64 exec, 0xffff
buffer_load_dwordx4 v4, s[24:27], s64 offen sc1 lds
s_mov_b64 exec, -1
v_mfma_f32_16x16x32_bf16 v[72:75], a[72:75], v[124:127], v[72:75]
s_add_u32 m0, s83, 6144
s_add_u32 s64, s55, 163584
v_cndmask_b32 v200, v200, v203, vcc
v_mfma_f32_16x16x32_bf16 v[236:239], a[72:75], v[140:143], v[236:239]
s_mov_b64 exec, 0xffff
buffer_load_dwordx4 v4, s[24:27], s64 offen sc1 lds
s_mov_b64 exec, -1
v_mfma_f32_16x16x32_bf16 v[224:227], a[76:79], v[140:143], v[224:227]
s_add_u32 m0, s83, 6912
s_add_u32 s64, s55, 196352
v_lshl_add_u32 v200, v200, 5, v202
v_mfma_f32_16x16x32_bf16 v[220:223], a[76:79], v[124:127], v[220:223]
s_mov_b64 exec, 0xffff
buffer_load_dwordx4 v4, s[24:27], s64 offen sc1 lds
s_mov_b64 exec, -1
v_mfma_f32_16x16x32_bf16 v[84:87], a[80:83], v[124:127], v[84:87]
s_mov_b32 m0, s70
s_mov_b32 s64, s68
s_add_u32 s68, s68, 16384
v_mfma_f32_16x16x32_bf16 v[164:167], a[80:83], v[140:143], v[164:167]
buffer_load_dwordx4 v4, s[24:27], s64 offen offset:0 sc1 lds
v_mfma_f32_16x16x32_bf16 v[156:159], a[84:87], v[140:143], v[156:159]
s_add_u32 s70, s70, 16384
s_cmp_ge_u32 s70, 163840
s_cselect_b32 s70, s80, s70
v_mfma_f32_16x16x32_bf16 v[76:79], a[84:87], v[124:127], v[76:79]
buffer_load_dwordx4 v4, s[24:27], s64 offen offset:1024 sc1 lds
v_mfma_f32_16x16x32_bf16 v[160:163], a[88:91], v[124:127], v[160:163]
v_lshrrev_b32 v201, 5, v1
v_mul_u32_u24 v201, 3840, v201
v_mfma_f32_16x16x32_bf16 v[216:219], a[88:91], v[140:143], v[216:219]
buffer_load_dwordx4 v4, s[24:27], s64 offen offset:2048 sc1 lds
v_mfma_f32_16x16x32_bf16 v[208:211], a[92:95], v[140:143], v[208:211]
v_lshl_add_u32 v201, v202, 4, v201
v_add_u32 v201, s83, v201
v_mfma_f32_16x16x32_bf16 v[252:255], a[92:95], v[124:127], v[252:255]
buffer_load_dwordx4 v4, s[24:27], s64 offen offset:3072 sc1 lds
v_mfma_f32_16x16x32_bf16 a[232:235], a[240:243], v[124:127], a[232:235]
v_cmp_eq_u32 vcc, 0, v3
v_mul_u32_u24 v244, 1536, v3
v_mfma_f32_16x16x32_bf16 a[236:239], a[240:243], v[140:143], a[236:239]
s_barrier
s_lshr_b32 s52, s3, 1
s_lshl1_add_u32 s72, s85, s52
s_lshl3_add_u32 s75, s72, s84
s_lshl_b32 s75, s75, 7
s_add_u32 s75, s75, 75497472
s_and_b32 s82, s86, 1
s_lshl_b32 s82, s82, 13
v_mov_b32 v246, 9728
v_cndmask_b32 v244, v244, v246, vcc
v_cmp_eq_u32 vcc, 3, v3
v_lshl_add_u32 v247, v2, 4, s83
v_mov_b32 v246, 10496
v_cndmask_b32 v245, v244, v246, vcc
v_add_u32 v247, -1280, v247
v_add_u32 v244, v244, v247
v_add_u32 v245, v245, v247
v_accvgpr_read_b32 v180, a232
v_accvgpr_read_b32 v182, a236
v_cmp_nle_f32 vcc, v180, v7
v_cmp_nle_f32 s[96:97], v182, v7
s_nop 3
s_or_b64 vcc, vcc, s[96:97]
s_cbranch_vccnz SLOW1
SLOW1_R:
v_mul_f32 v10, 0x3fb8aa3b, v10
v_mul_f32 v11, 0x3fb8aa3b, v11
v_exp_f32 v10, v10
v_exp_f32 v11, v11
s_nop 0
v_fma_f32 v180, v180, v10, v180
v_fma_f32 v182, v182, v11, v182
v_rcp_f32 v180, v180
v_rcp_f32 v182, v182
s_add_u32 s52, s79, 4096
v_mov_b32 v181, v180
v_mov_b32 v183, v182
v_pk_mul_f32 v[60:61], v[60:61], v[180:181]
v_pk_mul_f32 v[62:63], v[62:63], v[180:181]
v_pk_mul_f32 v[68:69], v[68:69], v[180:181]
v_pk_mul_f32 v[70:71], v[70:71], v[180:181]
v_cvt_pk_bf16_f32 v60, v60, v61
v_cvt_pk_bf16_f32 v61, v62, v63
v_cvt_pk_bf16_f32 v62, v68, v69
v_cvt_pk_bf16_f32 v63, v70, v71
buffer_store_dwordx4 v[60:63], v4, s[24:27], s79 offen offset:0 sc1
ds_write_b128 v244, a[128:131] offset:0
v_pk_mul_f32 v[148:149], v[148:149], v[182:183]
v_pk_mul_f32 v[150:151], v[150:151], v[182:183]
v_pk_mul_f32 v[48:49], v[48:49], v[182:183]
v_pk_mul_f32 v[50:51], v[50:51], v[182:183]
v_cvt_pk_bf16_f32 v148, v148, v149
v_cvt_pk_bf16_f32 v149, v150, v151
v_cvt_pk_bf16_f32 v150, v48, v49
v_cvt_pk_bf16_f32 v151, v50, v51
buffer_store_dwordx4 v[148:151], v4, s[24:27], s79 offen offset:1024 sc1
ds_write_b128 v245, a[132:135] offset:768
v_pk_mul_f32 v[72:73], v[72:73], v[180:181]
v_pk_mul_f32 v[74:75], v[74:75], v[180:181]
v_pk_mul_f32 v[220:221], v[220:221], v[180:181]
v_pk_mul_f32 v[222:223], v[222:223], v[180:181]
v_cvt_pk_bf16_f32 v72, v72, v73
v_cvt_pk_bf16_f32 v73, v74, v75
v_cvt_pk_bf16_f32 v74, v220, v221
v_cvt_pk_bf16_f32 v75, v222, v223
buffer_store_dwordx4 v[72:75], v4, s[24:27], s79 offen offset:2048 sc1
ds_write_b128 v244, a[136:139] offset:256
v_pk_mul_f32 v[236:237], v[236:237], v[182:183]
v_pk_mul_f32 v[238:239], v[238:239], v[182:183]
v_pk_mul_f32 v[224:225], v[224:225], v[182:183]
v_pk_mul_f32 v[226:227], v[226:227], v[182:183]
v_cvt_pk_bf16_f32 v236, v236, v237
v_cvt_pk_bf16_f32 v237, v238, v239
v_cvt_pk_bf16_f32 v238, v224, v225
v_cvt_pk_bf16_f32 v239, v226, v227
buffer_store_dwordx4 v[236:239], v4, s[24:27], s79 offen offset:3072 sc1
ds_write_b128 v245, a[140:143] offset:1024
v_pk_mul_f32 v[84:85], v[84:85], v[180:181]
v_pk_mul_f32 v[86:87], v[86:87], v[180:181]
v_pk_mul_f32 v[76:77], v[76:77], v[180:181]
v_pk_mul_f32 v[78:79], v[78:79], v[180:181]
v_cvt_pk_bf16_f32 v84, v84, v85
v_cvt_pk_bf16_f32 v85, v86, v87
v_cvt_pk_bf16_f32 v86, v76, v77
v_cvt_pk_bf16_f32 v87, v78, v79
buffer_store_dwordx4 v[84:87], v4, s[24:27], s52 offen offset:0 sc1
ds_write_b128 v244, a[144:147] offset:3840
v_pk_mul_f32 v[164:165], v[164:165], v[182:183]
v_pk_mul_f32 v[166:167], v[166:167], v[182:183]
v_pk_mul_f32 v[156:157], v[156:157], v[182:183]
v_pk_mul_f32 v[158:159], v[158:159], v[182:183]
v_cvt_pk_bf16_f32 v164, v164, v165
v_cvt_pk_bf16_f32 v165, v166, v167
v_cvt_pk_bf16_f32 v166, v156, v157
v_cvt_pk_bf16_f32 v167, v158, v159
buffer_store_dwordx4 v[164:167], v4, s[24:27], s52 offen offset:1024 sc1
ds_write_b128 v245, a[148:151] offset:4608
v_pk_mul_f32 v[160:161], v[160:161], v[180:181]
v_pk_mul_f32 v[162:163], v[162:163], v[180:181]
v_pk_mul_f32 v[252:253], v[252:253], v[180:181]
v_pk_mul_f32 v[254:255], v[254:255], v[180:181]
v_cvt_pk_bf16_f32 v160, v160, v161
v_cvt_pk_bf16_f32 v161, v162, v163
v_cvt_pk_bf16_f32 v162, v252, v253
v_cvt_pk_bf16_f32 v163, v254, v255
buffer_store_dwordx4 v[160:163], v4, s[24:27], s52 offen offset:2048 sc1
ds_write_b128 v244, a[152:155] offset:4096
v_pk_mul_f32 v[216:217], v[216:217], v[182:183]
v_pk_mul_f32 v[218:219], v[218:219], v[182:183]
v_pk_mul_f32 v[208:209], v[208:209], v[182:183]
v_pk_mul_f32 v[210:211], v[210:211], v[182:183]
v_cvt_pk_bf16_f32 v216, v216, v217
v_cvt_pk_bf16_f32 v217, v218, v219
v_cvt_pk_bf16_f32 v218, v208, v209
v_cvt_pk_bf16_f32 v219, v210, v211
buffer_store_dwordx4 v[216:219], v4, s[24:27], s52 offen offset:3072 sc1
ds_write_b128 v245, a[156:159] offset:4864
s_cmp_eq_u32 s76, 0
s_cbranch_scc1 L_SE2
L_LA:
v_mov_b32 v5, v200
v_mov_b32 v6, v201
v_mov_b32 v13, 0
s_waitcnt vmcnt(12)
ds_read_b128 v[16:19], v6 offset:8448
ds_read_b128 v[20:23], v6 offset:9216
ds_read_b128 v[96:99], v6 offset:3328
ds_read_b128 v[32:35], v6 offset:256
ds_read_b128 v[36:39], v6 offset:1024
ds_read_b128 v[100:103], v6 offset:3296
ds_read_b128 v[40:43], v6 offset:224
ds_read_b128 v[44:47], v6 offset:992
ds_read_b128 v[104:107], v6 offset:3264
ds_read_b128 v[48:51], v6 offset:192
ds_read_b128 v[52:55], v6 offset:960
ds_read_b128 v[108:111], v6 offset:3232
ds_read_b128 v[56:59], v6 offset:160
ds_read_b128 v[60:63], v6 offset:928
ds_read_b128 v[112:115], v6 offset:3200
ds_read_b128 v[64:67], v6 offset:128
ds_read_b128 v[68:71], v6 offset:896
ds_read_b128 v[116:119], v6 offset:3168
ds_read_b128 v[72:75], v6 offset:96
ds_read_b128 v[76:79], v6 offset:864
ds_read_b128 v[120:123], v6 offset:3136
ds_read_b128 v[80:83], v6 offset:64
ds_read_b128 v[84:87], v6 offset:832
ds_read_b128 v[124:127], v6 offset:3104
ds_read_b128 v[88:91], v6 offset:32
ds_read_b128 v[92:95], v6 offset:800
ds_read_b128 v[128:131], v6 offset:1792
ds_read_b128 v[132:135], v6 offset:2560
ds_read_b128 v[136:139], v6 offset:1760
ds_read_b128 v[140:143], v6 offset:2528
ds_read_b128 v[144:147], v6 offset:1728
ds_read_b128 v[148:151], v6 offset:2496
ds_read_b128 v[152:155], v6 offset:1696
ds_read_b128 v[156:159], v6 offset:2464
ds_read_b128 v[160:163], v6 offset:1664
ds_read_b128 v[164:167], v6 offset:2432
ds_read_b128 v[168:171], v6 offset:1632
ds_read_b128 v[172:175], v6 offset:2400
ds_read_b128 v[176:179], v6 offset:1600
ds_read_b128 v[180:183], v6 offset:2368
ds_read_b128 v[184:187], v6 offset:1568
ds_read_b128 v[188:191], v6 offset:2336
s_mov_b32 m0, s70
s_mov_b32 s64, s68
s_add_u32 s68, s68, 16384
s_add_u32 s70, s70, 16384
s_cmp_ge_u32 s70, 163840
s_cselect_b32 s70, s80, s70
buffer_load_dwordx4 v4, s[24:27], s64 offen offset:0 sc1 lds
buffer_load_dwordx4 v4, s[24:27], s64 offen offset:1024 sc1 lds
buffer_load_dwordx4 v4, s[24:27], s64 offen offset:2048 sc1 lds
buffer_load_dwordx4 v4, s[24:27], s64 offen offset:3072 sc1 lds
s_lshl_b32 s74, s66, 10
s_lshr_b32 s52, s4, 3
s_lshl_b32 s52, s52, 7
s_add_u32 s74, s74, s52
s_add_u32 s74, s74, 75497472
s_lshr_b32 s53, s4, 3
s_mul_i32 s53, s53, 75776
s_add_u32 s53, s53, 54525952
s_and_b32 s52, s3, 1
s_lshl_b32 s52, s52, 10
s_add_u32 s52, s52, s53
s_sub_u32 s54, 63, s72
s_mul_i32 s77, s72, 303104
s_add_u32 s77, s77, s52
s_mul_i32 s81, s54, 303104
s_add_u32 s81, s81, s52
s_add_u32 s91, s91, 114688
s_sub_u32 s52, s91, 163840
s_cmp_ge_u32 s91, 163840
s_cselect_b32 s91, s52, s91
v_add_u32 v14, 4096, v4
v_add_u32 v7, s91, v4
s_waitcnt lgkmcnt(0)
s_barrier
s_mov_b32 m0, s70
s_mov_b32 s64, s68
s_add_u32 s68, s68, 16384
s_add_u32 s70, s70, 16384
s_cmp_ge_u32 s70, 163840
s_cselect_b32 s70, s80, s70
buffer_load_dwordx4 v4, s[24:27], s64 offen offset:0 sc1 lds
v_and_b32 v9, 0xffff, v97
v_and_b32 v11, 0xffff0000, v97
v_dot2_f32_bf16 v24, v98, v99, 0
v_dot2_f32_bf16 v25, v102, v99, 0
v_dot2_f32_bf16 v26, v106, v99, 0
L_PAD10:
s_cbranch_execz L_MAIN
v_dot2_f32_bf16 v27, v110, v99, 0
v_dot2_f32_bf16 v28, v114, v99, 0
v_dot2_f32_bf16 v29, v118, v99, 0
v_dot2_f32_bf16 v30, v122, v99, 0
v_dot2_f32_bf16 v31, v126, v99, 0
buffer_load_dwordx4 v4, s[24:27], s64 offen offset:1024 sc1 lds
v_dot2c_f32_bf16 v24, v96, v9
v_dot2c_f32_bf16 v25, v100, v9
v_dot2c_f32_bf16 v26, v104, v9
v_dot2c_f32_bf16 v27, v108, v9
v_dot2c_f32_bf16 v28, v112, v9
v_dot2c_f32_bf16 v29, v116, v9
v_dot2c_f32_bf16 v30, v120, v9
v_dot2c_f32_bf16 v31, v124, v9
v_dot2c_f32_bf16 v24, v16, v32
v_dot2c_f32_bf16 v25, v16, v40
buffer_load_dwordx4 v4, s[24:27], s64 offen offset:2048 sc1 lds
v_dot2c_f32_bf16 v26, v16, v48
v_dot2c_f32_bf16 v27, v16, v56
v_dot2c_f32_bf16 v28, v16, v64
v_dot2c_f32_bf16 v29, v16, v72
v_dot2c_f32_bf16 v30, v16, v80
v_dot2c_f32_bf16 v31, v16, v88
v_dot2c_f32_bf16 v24, v17, v33
v_dot2c_f32_bf16 v25, v17, v41
v_dot2c_f32_bf16 v26, v17, v49
v_dot2c_f32_bf16 v27, v17, v57
s_waitcnt vmcnt(7)
buffer_atomic_add v1, v0, s[24:27], s74 offen offset:0 sc1
buffer_load_dwordx4 v4, s[24:27], s64 offen offset:3072 sc1 lds
v_dot2c_f32_bf16 v28, v17, v65
v_dot2c_f32_bf16 v29, v17, v73
v_dot2c_f32_bf16 v30, v17, v81
v_dot2c_f32_bf16 v31, v17, v89
v_dot2c_f32_bf16 v24, v18, v34
v_dot2c_f32_bf16 v25, v18, v42
v_dot2c_f32_bf16 v26, v18, v50
v_dot2c_f32_bf16 v27, v18, v58
v_dot2c_f32_bf16 v28, v18, v66
v_dot2c_f32_bf16 v29, v18, v74
v_dot2c_f32_bf16 v30, v18, v82
v_dot2c_f32_bf16 v31, v18, v90
v_dot2c_f32_bf16 v24, v19, v35
v_dot2c_f32_bf16 v25, v19, v43
v_dot2c_f32_bf16 v26, v19, v51
v_dot2c_f32_bf16 v27, v19, v59
s_mov_b32 m0, s70
s_mov_b32 s64, s68
s_add_u32 s68, s68, 16384
s_add_u32 s70, s70, 16384
s_cmp_ge_u32 s70, 163840
s_cselect_b32 s70, s80, s70
buffer_load_dwordx4 v4, s[24:27], s64 offen offset:0 sc1 lds
v_dot2c_f32_bf16 v28, v19, v67
v_dot2c_f32_bf16 v29, v19, v75
v_dot2c_f32_bf16 v30, v19, v83
v_dot2c_f32_bf16 v31, v19, v91
v_dot2c_f32_bf16 v24, v20, v36
v_dot2c_f32_bf16 v25, v20, v44
v_dot2c_f32_bf16 v26, v20, v52
v_dot2c_f32_bf16 v27, v20, v60
v_dot2c_f32_bf16 v28, v20, v68
v_dot2c_f32_bf16 v29, v20, v76
v_dot2c_f32_bf16 v30, v20, v84
v_dot2c_f32_bf16 v31, v20, v92
v_dot2c_f32_bf16 v24, v21, v37
v_dot2c_f32_bf16 v25, v21, v45
v_dot2c_f32_bf16 v26, v21, v53
v_dot2c_f32_bf16 v27, v21, v61
buffer_load_dwordx4 v4, s[24:27], s64 offen offset:1024 sc1 lds
v_dot2c_f32_bf16 v28, v21, v69
v_dot2c_f32_bf16 v29, v21, v77
v_dot2c_f32_bf16 v30, v21, v85
v_dot2c_f32_bf16 v31, v21, v93
v_dot2c_f32_bf16 v24, v22, v38
v_dot2c_f32_bf16 v25, v22, v46
v_dot2c_f32_bf16 v26, v22, v54
v_dot2c_f32_bf16 v27, v22, v62
v_dot2c_f32_bf16 v28, v22, v70
v_dot2c_f32_bf16 v29, v22, v78
v_dot2c_f32_bf16 v30, v22, v86
v_dot2c_f32_bf16 v31, v22, v94
v_dot2c_f32_bf16 v24, v23, v39
v_dot2c_f32_bf16 v25, v23, v47
v_dot2c_f32_bf16 v26, v23, v55
v_dot2c_f32_bf16 v27, v23, v63
buffer_load_dwordx4 v4, s[24:27], s64 offen offset:2048 sc1 lds
v_dot2c_f32_bf16 v28, v23, v71
v_dot2c_f32_bf16 v29, v23, v79
v_dot2c_f32_bf16 v30, v23, v87
v_dot2c_f32_bf16 v31, v23, v95
v_mov_b32 v9, 0xf149f2ca
v_mul_f32 v11, 0xbfb8aa3b, v11
v_exp_f32 v11, v11
v_cmp_gt_u32 vcc, 2, v5
v_cmp_gt_u32 s[56:57], 4, v5
s_nop 0
v_cndmask_b32 v25, v25, v9, vcc
v_cndmask_b32 v26, v26, v9, s[56:57]
v_cmp_gt_u32 vcc, 6, v5
v_cmp_gt_u32 s[56:57], 8, v5
s_nop 0
v_cndmask_b32 v27, v27, v9, vcc
buffer_load_dwordx4 v4, s[24:27], s64 offen offset:3072 sc1 lds
v_cndmask_b32 v28, v28, v9, s[56:57]
v_cmp_gt_u32 vcc, 10, v5
v_cmp_gt_u32 s[56:57], 12, v5
s_nop 0
v_cndmask_b32 v29, v29, v9, vcc
v_cndmask_b32 v30, v30, v9, s[56:57]
v_cmp_gt_u32 vcc, 14, v5
s_nop 0
s_nop 0
v_cndmask_b32 v31, v31, v9, vcc
v_max3_f32 v10, v24, v25, v26
v_max3_f32 v10, v10, v27, v28
v_max3_f32 v10, v10, v29, v30
v_max_f32 v10, v10, v31
s_mov_b32 s52, 0x3eae1a93
v_sub_f32 v24, v24, v10
s_mov_b32 m0, s70
s_mov_b32 s64, s68
s_add_u32 s68, s68, 16384
s_add_u32 s70, s70, 16384
s_cmp_ge_u32 s70, 163840
s_cselect_b32 s70, s80, s70
buffer_load_dwordx4 v4, s[24:27], s64 offen offset:0 sc1 lds
v_sub_f32 v25, v25, v10
v_sub_f32 v26, v26, v10
v_sub_f32 v27, v27, v10
v_sub_f32 v28, v28, v10
v_sub_f32 v29, v29, v10
v_sub_f32 v30, v30, v10
v_sub_f32 v31, v31, v10
v_mul_f32 v24, s52, v24
v_mul_f32 v25, s52, v25
v_mul_f32 v26, s52, v26
v_mul_f32 v27, s52, v27
v_mul_f32 v28, s52, v28
v_mul_f32 v29, s52, v29
v_mul_f32 v30, s52, v30
v_mul_f32 v31, s52, v31
v_exp_f32 v24, v24
buffer_load_dwordx4 v4, s[24:27], s64 offen offset:1024 sc1 lds
v_exp_f32 v25, v25
v_exp_f32 v26, v26
v_exp_f32 v27, v27
v_exp_f32 v28, v28
v_exp_f32 v29, v29
v_exp_f32 v30, v30
v_exp_f32 v31, v31
v_cvt_pk_bf16_f32 v32, v24, 0
v_cvt_pk_bf16_f32 v40, v25, 0
v_cvt_pk_bf16_f32 v48, v26, 0
v_cvt_pk_bf16_f32 v56, v27, 0
v_cvt_pk_bf16_f32 v64, v28, 0
v_cvt_pk_bf16_f32 v72, v29, 0
v_cvt_pk_bf16_f32 v80, v30, 0
v_cvt_pk_bf16_f32 v88, v31, 0
v_lshlrev_b32 v33, 16, v32
buffer_load_dwordx4 v4, s[24:27], s64 offen offset:2048 sc1 lds
v_lshlrev_b32 v41, 16, v40
v_lshlrev_b32 v49, 16, v48
v_lshlrev_b32 v57, 16, v56
v_lshlrev_b32 v65, 16, v64
v_lshlrev_b32 v73, 16, v72
v_lshlrev_b32 v81, 16, v80
v_lshlrev_b32 v89, 16, v88
v_add_f32 v10, v33, v41
v_add_f32 v10, v10, v49
v_add_f32 v10, v10, v57
v_add_f32 v10, v10, v65
v_add_f32 v10, v10, v73
v_add_f32 v10, v10, v81
v_add_f32 v10, v10, v89
v_fmac_f32 v10, v10, v11
v_rcp_f32 v10, v10
buffer_load_dwordx4 v4, s[24:27], s64 offen offset:3072 sc1 lds
v_dot2_f32_bf16 v192, v128, v32, 0
v_dot2_f32_bf16 v193, v128, v33, 0
v_dot2_f32_bf16 v194, v129, v32, 0
v_dot2_f32_bf16 v195, v129, v33, 0
v_dot2_f32_bf16 v196, v130, v32, 0
v_dot2_f32_bf16 v197, v130, v33, 0
v_dot2_f32_bf16 v198, v131, v32, 0
v_dot2_f32_bf16 v199, v131, v33, 0
v_dot2_f32_bf16 v200, v132, v32, 0
v_dot2_f32_bf16 v201, v132, v33, 0
v_dot2_f32_bf16 v202, v133, v32, 0
v_dot2_f32_bf16 v203, v133, v33, 0
v_dot2_f32_bf16 v204, v134, v32, 0
v_dot2_f32_bf16 v205, v134, v33, 0
v_dot2_f32_bf16 v206, v135, v32, 0
v_dot2_f32_bf16 v207, v135, v33, 0
s_mov_b32 m0, s70
s_mov_b32 s64, s68
s_add_u32 s68, s68, 16384
s_add_u32 s70, s70, 16384
s_cmp_ge_u32 s70, 163840
s_cselect_b32 s70, s80, s70
buffer_load_dwordx4 v4, s[24:27], s64 offen offset:0 sc1 lds
v_dot2_f32_bf16 v208, v96, v33, 0
v_dot2_f32_bf16 v209, v98, v33, 0
v_dot2c_f32_bf16 v192, v136, v40
v_dot2c_f32_bf16 v193, v136, v41
v_dot2c_f32_bf16 v194, v137, v40
v_dot2c_f32_bf16 v195, v137, v41
v_dot2c_f32_bf16 v196, v138, v40
v_dot2c_f32_bf16 v197, v138, v41
v_dot2c_f32_bf16 v198, v139, v40
v_dot2c_f32_bf16 v199, v139, v41
v_dot2c_f32_bf16 v200, v140, v40
v_dot2c_f32_bf16 v201, v140, v41
v_dot2c_f32_bf16 v202, v141, v40
v_dot2c_f32_bf16 v203, v141, v41
v_dot2c_f32_bf16 v204, v142, v40
v_dot2c_f32_bf16 v205, v142, v41
buffer_load_dwordx4 v4, s[24:27], s64 offen offset:1024 sc1 lds
v_dot2c_f32_bf16 v206, v143, v40
v_dot2c_f32_bf16 v207, v143, v41
v_dot2c_f32_bf16 v208, v100, v41
v_dot2c_f32_bf16 v209, v102, v41
v_dot2c_f32_bf16 v192, v144, v48
v_dot2c_f32_bf16 v193, v144, v49
v_dot2c_f32_bf16 v194, v145, v48
v_dot2c_f32_bf16 v195, v145, v49
v_dot2c_f32_bf16 v196, v146, v48
v_dot2c_f32_bf16 v197, v146, v49
v_dot2c_f32_bf16 v198, v147, v48
v_dot2c_f32_bf16 v199, v147, v49
v_dot2c_f32_bf16 v200, v148, v48
v_dot2c_f32_bf16 v201, v148, v49
v_dot2c_f32_bf16 v202, v149, v48
v_dot2c_f32_bf16 v203, v149, v49
buffer_load_dwordx4 v4, s[24:27], s64 offen offset:2048 sc1 lds
v_dot2c_f32_bf16 v204, v150, v48
v_dot2c_f32_bf16 v205, v150, v49
v_dot2c_f32_bf16 v206, v151, v48
v_dot2c_f32_bf16 v207, v151, v49
v_dot2c_f32_bf16 v208, v104, v49
v_dot2c_f32_bf16 v209, v106, v49
v_dot2c_f32_bf16 v192, v152, v56
v_dot2c_f32_bf16 v193, v152, v57
v_dot2c_f32_bf16 v194, v153, v56
v_dot2c_f32_bf16 v195, v153, v57
v_dot2c_f32_bf16 v196, v154, v56
v_dot2c_f32_bf16 v197, v154, v57
v_dot2c_f32_bf16 v198, v155, v56
v_dot2c_f32_bf16 v199, v155, v57
v_dot2c_f32_bf16 v200, v156, v56
v_dot2c_f32_bf16 v201, v156, v57
buffer_load_dword v12, v13, s[24:27], s75 offen sc1
v_dot2c_f32_bf16 v202, v157, v56
v_dot2c_f32_bf16 v203, v157, v57
v_dot2c_f32_bf16 v204, v158, v56
v_dot2c_f32_bf16 v205, v158, v57
v_dot2c_f32_bf16 v206, v159, v56
v_dot2c_f32_bf16 v207, v159, v57
v_dot2c_f32_bf16 v208, v108, v57
v_dot2c_f32_bf16 v209, v110, v57
v_dot2c_f32_bf16 v192, v160, v64
v_dot2c_f32_bf16 v193, v160, v65
v_dot2c_f32_bf16 v194, v161, v64
v_dot2c_f32_bf16 v195, v161, v65
v_dot2c_f32_bf16 v196, v162, v64
v_dot2c_f32_bf16 v197, v162, v65
v_dot2c_f32_bf16 v198, v163, v64
v_dot2c_f32_bf16 v199, v163, v65
buffer_load_dwordx4 v4, s[24:27], s64 offen offset:3072 sc1 lds
v_dot2c_f32_bf16 v200, v164, v64
v_dot2c_f32_bf16 v201, v164, v65
v_dot2c_f32_bf16 v202, v165, v64
v_dot2c_f32_bf16 v203, v165, v65
v_dot2c_f32_bf16 v204, v166, v64
v_dot2c_f32_bf16 v205, v166, v65
v_dot2c_f32_bf16 v206, v167, v64
v_dot2c_f32_bf16 v207, v167, v65
v_dot2c_f32_bf16 v208, v112, v65
v_dot2c_f32_bf16 v209, v114, v65
v_dot2c_f32_bf16 v192, v168, v72
v_dot2c_f32_bf16 v193, v168, v73
v_dot2c_f32_bf16 v194, v169, v72
v_dot2c_f32_bf16 v195, v169, v73
v_dot2c_f32_bf16 v196, v170, v72
v_dot2c_f32_bf16 v197, v170, v73
s_mov_b32 m0, s70
s_mov_b32 s64, s68
s_add_u32 s68, s68, 16384
s_add_u32 s70, s70, 16384
s_cmp_ge_u32 s70, 163840
s_cselect_b32 s70, s80, s70
buffer_load_dwordx4 v4, s[24:27], s64 offen offset:0 sc1 lds
v_dot2c_f32_bf16 v198, v171, v72
v_dot2c_f32_bf16 v199, v171, v73
v_dot2c_f32_bf16 v200, v172, v72
v_dot2c_f32_bf16 v201, v172, v73
v_dot2c_f32_bf16 v202, v173, v72
v_dot2c_f32_bf16 v203, v173, v73
v_dot2c_f32_bf16 v204, v174, v72
v_dot2c_f32_bf16 v205, v174, v73
v_dot2c_f32_bf16 v206, v175, v72
v_dot2c_f32_bf16 v207, v175, v73
v_dot2c_f32_bf16 v208, v116, v73
v_dot2c_f32_bf16 v209, v118, v73
v_dot2c_f32_bf16 v192, v176, v80
v_dot2c_f32_bf16 v193, v176, v81
v_dot2c_f32_bf16 v194, v177, v80
v_dot2c_f32_bf16 v195, v177, v81
buffer_load_dwordx4 v4, s[24:27], s64 offen offset:1024 sc1 lds
v_dot2c_f32_bf16 v196, v178, v80
v_dot2c_f32_bf16 v197, v178, v81
v_dot2c_f32_bf16 v198, v179, v80
v_dot2c_f32_bf16 v199, v179, v81
v_dot2c_f32_bf16 v200, v180, v80
v_dot2c_f32_bf16 v201, v180, v81
v_dot2c_f32_bf16 v202, v181, v80
v_dot2c_f32_bf16 v203, v181, v81
v_dot2c_f32_bf16 v204, v182, v80
v_dot2c_f32_bf16 v205, v182, v81
v_dot2c_f32_bf16 v206, v183, v80
v_dot2c_f32_bf16 v207, v183, v81
v_dot2c_f32_bf16 v208, v120, v81
v_dot2c_f32_bf16 v209, v122, v81
v_dot2c_f32_bf16 v192, v184, v88
v_dot2c_f32_bf16 v193, v184, v89
buffer_load_dwordx4 v4, s[24:27], s64 offen offset:2048 sc1 lds
v_dot2c_f32_bf16 v194, v185, v88
v_dot2c_f32_bf16 v195, v185, v89
v_dot2c_f32_bf16 v196, v186, v88
v_dot2c_f32_bf16 v197, v186, v89
v_dot2c_f32_bf16 v198, v187, v88
v_dot2c_f32_bf16 v199, v187, v89
v_dot2c_f32_bf16 v200, v188, v88
v_dot2c_f32_bf16 v201, v188, v89
v_dot2c_f32_bf16 v202, v189, v88
v_dot2c_f32_bf16 v203, v189, v89
v_dot2c_f32_bf16 v204, v190, v88
v_dot2c_f32_bf16 v205, v190, v89
v_dot2c_f32_bf16 v206, v191, v88
v_dot2c_f32_bf16 v207, v191, v89
v_dot2c_f32_bf16 v208, v124, v89
v_dot2c_f32_bf16 v209, v126, v89
buffer_load_dwordx4 v4, s[24:27], s64 offen offset:3072 sc1 lds
v_lshrrev_b32 v9, 5, v5
v_mul_u32_u24 v9, 303104, v9
v_and_b32 v11, 1, v3
v_lshl_add_u32 v9, v11, 10, v9
v_lshl_add_u32 v9, v2, 4, v9
v_mul_f32 v192, v10, v192
v_mul_f32 v193, v10, v193
v_mul_f32 v194, v10, v194
v_mul_f32 v195, v10, v195
v_mul_f32 v196, v10, v196
v_mul_f32 v197, v10, v197
v_mul_f32 v198, v10, v198
v_mul_f32 v199, v10, v199
v_mul_f32 v200, v10, v200
v_mul_f32 v201, v10, v201
v_mul_f32 v202, v10, v202
v_mul_f32 v203, v10, v203
v_mul_f32 v204, v10, v204
v_mul_f32 v205, v10, v205
v_mul_f32 v206, v10, v206
v_mul_f32 v207, v10, v207
v_mul_f32 v208, v10, v208
v_mul_f32 v209, v10, v209
v_cvt_pk_bf16_f32 v192, v192, v193
v_cvt_pk_bf16_f32 v193, v194, v195
v_cvt_pk_bf16_f32 v194, v196, v197
v_cvt_pk_bf16_f32 v195, v198, v199
v_cvt_pk_bf16_f32 v196, v200, v201
v_cvt_pk_bf16_f32 v197, v202, v203
v_cvt_pk_bf16_f32 v198, v204, v205
v_cvt_pk_bf16_f32 v199, v206, v207
v_cvt_pk_bf16_f32 v200, v208, v209
s_add_u32 s53, s53, 65536
s_bfe_u32 s54, s4, 131073
s_lshl_b32 s54, s54, 11
s_add_u32 s54, s54, s53
s_and_b32 s55, s4, 1
s_lshl_b32 s55, s55, 9
s_add_u32 s54, s54, s55
s_lshl2_add_u32 s52, s85, s86
s_lshl2_add_u32 s69, s52, s3
s_mul_i32 s69, s69, 28672
s_add_u32 s69, s69, 76546048
s_lshr_b32 s73, s52, 1
s_lshl_b32 s73, s73, 10
s_and_b32 s52, s52, 1
s_lshl_b32 s52, s52, 7
s_add_u32 s73, s73, s52
s_lshl2_add_u32 s73, s3, s73
s_add_u32 s73, s73, 75498112
ds_read_b128 v[144:147], v7 offset:0
ds_read_b128 v[148:151], v7 offset:1024
ds_read_b128 v[152:155], v7 offset:2048
ds_read_b128 v[156:159], v7 offset:3072
ds_read_b128 v[160:163], v7 offset:4096
ds_read_b128 v[164:167], v7 offset:5120
ds_read_b128 v[168:171], v7 offset:6144
ds_read_b128 v[172:175], v7 offset:7168
v_mov_b32 v10, 0
s_waitcnt vmcnt(5)
v_cmp_gt_u32 vcc, 8, v12
s_mov_b32 s92, 0
s_nop 3
s_cbranch_vccz L_ZBX
L_ZB:
s_sleep 2
buffer_load_dword v12, v13, s[24:27], s75 offen sc1
s_add_u32 s92, s92, 1
s_waitcnt vmcnt(0)
v_cmp_gt_u32 vcc, 8, v12
s_cmp_gt_u32 s92, 1048576
s_cbranch_scc1 L_ZBX
s_nop 2
s_cbranch_vccnz L_ZB
L_ZBX:
s_xor_b32 s65, s82, 0
s_add_u32 s65, s65, s77
buffer_load_dwordx4 a[0:3], v4, s[24:27], s65 offen offset:0 sc1
buffer_load_dwordx4 a[8:11], v4, s[24:27], s65 offen offset:2048 sc1
s_xor_b32 s93, s82, 0
s_add_u32 s93, s93, s81
buffer_load_dwordx4 a[4:7], v4, s[24:27], s93 offen offset:0 sc1
buffer_load_dwordx4 a[12:15], v4, s[24:27], s93 offen offset:2048 sc1
buffer_load_dwordx4 a[16:19], v14, s[24:27], s65 offen offset:0 sc1
buffer_load_dwordx4 a[24:27], v14, s[24:27], s65 offen offset:2048 sc1
buffer_load_dwordx4 a[20:23], v14, s[24:27], s93 offen offset:0 sc1
buffer_load_dwordx4 a[28:31], v14, s[24:27], s93 offen offset:2048 sc1
buffer_store_dwordx4 v[192:195], v9, s[24:27], s54 offen sc1
buffer_store_dwordx4 v[196:199], v9, s[24:27], s54 offen offset:256 sc1
s_bfe_u32 s55, s4, 65538
s_lshl_b32 s55, s55, 8
s_add_u32 s54, s53, s55
s_and_b32 s55, s4, 3
s_lshl2_add_u32 s54, s55, s54
s_add_u32 s54, s54, 8192
buffer_store_dword v200, v9, s[24:27], s54 offen sc1
s_waitcnt vmcnt(9) lgkmcnt(6)
v_mfma_f32_16x16x32_bf16 v[120:123], v[144:147], a[0:3], 0
s_waitcnt vmcnt(7)
s_add_u32 s91, s91, 16384
ds_read_b128 v[176:179], v7 offset:8192
v_mfma_f32_16x16x32_bf16 v[120:123], v[148:151], a[8:11], v[120:123]
s_xor_b32 s65, s82, 8192
s_add_u32 s65, s65, s77
ds_read_b128 v[180:183], v7 offset:9216
v_mfma_f32_16x16x32_bf16 v[124:127], v[148:151], a[12:15], 0
s_waitcnt lgkmcnt(6)
ds_read_b128 v[184:187], v7 offset:10240
v_mfma_f32_16x16x32_bf16 v[124:127], v[144:147], a[4:7], v[124:127]
buffer_load_dwordx4 a[32:35], v4, s[24:27], s65 offen offset:0 sc1
v_mfma_f32_16x16x32_bf16 v[72:75], v[152:155], a[0:3], 0
s_cmp_ge_u32 s91, 163840
s_cselect_b32 s91, 0, s91
ds_read_b128 v[188:191], v7 offset:11264
v_mfma_f32_16x16x32_bf16 v[72:75], v[156:159], a[8:11], v[72:75]
s_waitcnt lgkmcnt(6)
v_add_u32 v8, s91, v4
v_mfma_f32_16x16x32_bf16 v[76:79], v[156:159], a[12:15], 0
buffer_load_dwordx4 a[40:43], v4, s[24:27], s65 offen offset:2048 sc1
v_mfma_f32_16x16x32_bf16 v[76:79], v[152:155], a[4:7], v[76:79]
s_xor_b32 s93, s82, 8192
s_add_u32 s93, s93, s81
ds_read_b128 v[144:147], v7 offset:12288
v_mfma_f32_16x16x32_bf16 v[80:83], v[160:163], a[0:3], 0
ds_read_b128 v[148:151], v7 offset:13312
v_mfma_f32_16x16x32_bf16 v[80:83], v[164:167], a[8:11], v[80:83]
buffer_load_dwordx4 a[36:39], v4, s[24:27], s93 offen offset:0 sc1
v_mfma_f32_16x16x32_bf16 v[84:87], v[164:167], a[12:15], 0
ds_read_b128 v[152:155], v7 offset:14336
v_mfma_f32_16x16x32_bf16 v[84:87], v[160:163], a[4:7], v[84:87]
s_waitcnt lgkmcnt(7)
v_mfma_f32_16x16x32_bf16 v[88:91], v[168:171], a[0:3], 0
buffer_load_dwordx4 a[44:47], v4, s[24:27], s93 offen offset:2048 sc1
v_mfma_f32_16x16x32_bf16 v[88:91], v[172:175], a[8:11], v[88:91]
ds_read_b128 v[156:159], v7 offset:15360
v_mfma_f32_16x16x32_bf16 v[92:95], v[172:175], a[12:15], 0
s_waitcnt lgkmcnt(6)
s_add_u32 s91, s91, 16384
ds_read_b128 v[160:163], v8 offset:0
v_mfma_f32_16x16x32_bf16 v[92:95], v[168:171], a[4:7], v[92:95]
buffer_load_dwordx4 a[48:51], v14, s[24:27], s65 offen offset:0 sc1
v_mfma_f32_16x16x32_bf16 v[96:99], v[176:179], a[0:3], 0
s_cmp_ge_u32 s91, 163840
s_cselect_b32 s91, 0, s91
ds_read_b128 v[164:167], v8 offset:1024
v_mfma_f32_16x16x32_bf16 v[96:99], v[180:183], a[8:11], v[96:99]
v_add_u32 v7, s91, v4
v_mfma_f32_16x16x32_bf16 v[100:103], v[180:183], a[12:15], 0
buffer_load_dwordx4 a[56:59], v14, s[24:27], s65 offen offset:2048 sc1
v_mfma_f32_16x16x32_bf16 v[100:103], v[176:179], a[4:7], v[100:103]
s_waitcnt lgkmcnt(6)
ds_read_b128 v[168:171], v8 offset:2048
v_mfma_f32_16x16x32_bf16 v[104:107], v[184:187], a[0:3], 0
ds_read_b128 v[172:175], v8 offset:3072
v_mfma_f32_16x16x32_bf16 v[104:107], v[188:191], a[8:11], v[104:107]
v_mfma_f32_16x16x32_bf16 v[108:111], v[188:191], a[12:15], 0
buffer_load_dwordx4 a[52:55], v14, s[24:27], s93 offen offset:0 sc1
v_mfma_f32_16x16x32_bf16 v[108:111], v[184:187], a[4:7], v[108:111]
s_waitcnt lgkmcnt(6)
ds_read_b128 v[176:179], v8 offset:4096
v_mfma_f32_16x16x32_bf16 v[112:115], v[144:147], a[0:3], 0
ds_read_b128 v[180:183], v8 offset:5120
v_mfma_f32_16x16x32_bf16 v[112:115], v[148:151], a[8:11], v[112:115]
v_mfma_f32_16x16x32_bf16 v[116:119], v[148:151], a[12:15], 0
buffer_load_dwordx4 a[60:63], v14, s[24:27], s93 offen offset:2048 sc1
v_mfma_f32_16x16x32_bf16 v[116:119], v[144:147], a[4:7], v[116:119]
s_waitcnt lgkmcnt(6) vmcnt(13)
ds_read_b128 v[184:187], v8 offset:6144
v_mfma_f32_16x16x32_bf16 v[120:123], v[152:155], a[16:19], v[120:123]
ds_read_b128 v[188:191], v8 offset:7168
v_mfma_f32_16x16x32_bf16 v[120:123], v[156:159], a[24:27], v[120:123]
s_waitcnt vmcnt(11)
v_mfma_f32_16x16x32_bf16 v[124:127], v[156:159], a[28:31], v[124:127]
ds_read_b128 v[144:147], v8 offset:8192
v_mfma_f32_16x16x32_bf16 v[124:127], v[152:155], a[20:23], v[124:127]
s_waitcnt lgkmcnt(7)
v_mfma_f32_16x16x32_bf16 v[72:75], v[160:163], a[16:19], v[72:75]
ds_read_b128 v[148:151], v8 offset:9216
v_mfma_f32_16x16x32_bf16 v[72:75], v[164:167], a[24:27], v[72:75]
v_mfma_f32_16x16x32_bf16 v[76:79], v[164:167], a[28:31], v[76:79]
ds_read_b128 v[152:155], v8 offset:10240
v_mfma_f32_16x16x32_bf16 v[76:79], v[160:163], a[20:23], v[76:79]
s_waitcnt lgkmcnt(7)
v_mfma_f32_16x16x32_bf16 v[80:83], v[168:171], a[16:19], v[80:83]
ds_read_b128 v[156:159], v8 offset:11264
v_mfma_f32_16x16x32_bf16 v[80:83], v[172:175], a[24:27], v[80:83]
v_mfma_f32_16x16x32_bf16 v[84:87], v[172:175], a[28:31], v[84:87]
ds_read_b128 v[160:163], v8 offset:12288
v_mfma_f32_16x16x32_bf16 v[84:87], v[168:171], a[20:23], v[84:87]
s_waitcnt lgkmcnt(7)
v_mfma_f32_16x16x32_bf16 v[88:91], v[176:179], a[16:19], v[88:91]
s_xor_b32 s65, s82, 16384
s_add_u32 s65, s65, s77
ds_read_b128 v[164:167], v8 offset:13312
v_mfma_f32_16x16x32_bf16 v[88:91], v[180:183], a[24:27], v[88:91]
v_mfma_f32_16x16x32_bf16 v[92:95], v[180:183], a[28:31], v[92:95]
s_waitcnt lgkmcnt(6)
ds_read_b128 v[168:171], v8 offset:14336
v_add_u32 v11, s70, v4
v_mfma_f32_16x16x32_bf16 v[92:95], v[176:179], a[20:23], v[92:95]
s_add_u32 s70, s70, 16384
s_cmp_ge_u32 s70, 163840
s_cselect_b32 s70, s80, s70
v_mfma_f32_16x16x32_bf16 v[96:99], v[184:187], a[16:19], v[96:99]
buffer_load_dwordx4 a[64:67], v4, s[24:27], s65 offen offset:0 sc1
v_mfma_f32_16x16x32_bf16 v[96:99], v[188:191], a[24:27], v[96:99]
s_barrier
v_mfma_f32_16x16x32_bf16 v[100:103], v[188:191], a[28:31], v[100:103]
s_waitcnt lgkmcnt(5)
ds_read_b128 v[172:175], v8 offset:15360
v_mfma_f32_16x16x32_bf16 v[100:103], v[184:187], a[20:23], v[100:103]
buffer_load_dwordx4 a[72:75], v4, s[24:27], s65 offen offset:2048 sc1
v_mfma_f32_16x16x32_bf16 v[104:107], v[144:147], a[16:19], v[104:107]
ds_write_b64 v11, a[96:97] offset:0
v_mfma_f32_16x16x32_bf16 v[104:107], v[148:151], a[24:27], v[104:107]
s_xor_b32 s93, s82, 16384
s_add_u32 s93, s93, s81
ds_read_b128 v[176:179], v7 offset:0
v_mfma_f32_16x16x32_bf16 v[108:111], v[148:151], a[28:31], v[108:111]
buffer_load_dwordx4 a[68:71], v4, s[24:27], s93 offen offset:0 sc1
v_mfma_f32_16x16x32_bf16 v[108:111], v[144:147], a[20:23], v[108:111]
s_waitcnt lgkmcnt(6)
s_add_u32 s91, s91, 16384
ds_read_b128 v[180:183], v7 offset:1024
v_mfma_f32_16x16x32_bf16 v[112:115], v[152:155], a[16:19], v[112:115]
ds_write_b64 v11, a[98:99] offset:8
v_mfma_f32_16x16x32_bf16 v[112:115], v[156:159], a[24:27], v[112:115]
s_cmp_ge_u32 s91, 163840
s_cselect_b32 s91, 0, s91
ds_read_b128 v[184:187], v7 offset:2048
v_mfma_f32_16x16x32_bf16 v[116:119], v[156:159], a[28:31], v[116:119]
buffer_load_dwordx4 a[76:79], v4, s[24:27], s93 offen offset:2048 sc1
v_mfma_f32_16x16x32_bf16 v[116:119], v[152:155], a[20:23], v[116:119]
s_waitcnt lgkmcnt(7) vmcnt(10)
ds_read_b128 v[188:191], v7 offset:3072
v_add_u32 v8, s91, v4
v_mfma_f32_16x16x32_bf16 v[120:123], v[160:163], a[32:35], v[120:123]
s_waitcnt vmcnt(12)
s_waitcnt vmcnt(8)
ds_read_b128 v[144:147], v7 offset:4096
v_mfma_f32_16x16x32_bf16 v[120:123], v[164:167], a[40:43], v[120:123]
buffer_atomic_add v1, v0, s[24:27], s74 offen offset:4 sc1
v_mfma_f32_16x16x32_bf16 v[124:127], v[164:167], a[44:47], v[124:127]
ds_write_b64 v11, a[100:101] offset:1024
v_mfma_f32_16x16x32_bf16 v[124:127], v[160:163], a[36:39], v[124:127]
s_waitcnt lgkmcnt(8)
ds_read_b128 v[148:151], v7 offset:5120
v_mfma_f32_16x16x32_bf16 v[72:75], v[168:171], a[32:35], v[72:75]
ds_read_b128 v[152:155], v7 offset:6144
v_mfma_f32_16x16x32_bf16 v[72:75], v[172:175], a[40:43], v[72:75]
ds_read_b128 v[156:159], v7 offset:7168
v_mfma_f32_16x16x32_bf16 v[76:79], v[172:175], a[44:47], v[76:79]
ds_write_b64 v11, a[102:103] offset:1032
v_mfma_f32_16x16x32_bf16 v[76:79], v[168:171], a[36:39], v[76:79]
s_waitcnt lgkmcnt(9)
ds_read_b128 v[160:163], v7 offset:8192
v_mfma_f32_16x16x32_bf16 v[80:83], v[176:179], a[32:35], v[80:83]
ds_read_b128 v[164:167], v7 offset:9216
v_mfma_f32_16x16x32_bf16 v[80:83], v[180:183], a[40:43], v[80:83]
v_mfma_f32_16x16x32_bf16 v[84:87], v[180:183], a[44:47], v[84:87]
ds_write_b64 v11, a[104:105] offset:2048
v_mfma_f32_16x16x32_bf16 v[84:87], v[176:179], a[36:39], v[84:87]
s_waitcnt lgkmcnt(9)
ds_read_b128 v[168:171], v7 offset:10240
v_mfma_f32_16x16x32_bf16 v[88:91], v[184:187], a[32:35], v[88:91]
ds_read_b128 v[172:175], v7 offset:11264
v_mfma_f32_16x16x32_bf16 v[88:91], v[188:191], a[40:43], v[88:91]
s_waitcnt lgkmcnt(8)
v_mfma_f32_16x16x32_bf16 v[92:95], v[188:191], a[44:47], v[92:95]
ds_write_b64 v11, a[106:107] offset:2056
v_mfma_f32_16x16x32_bf16 v[92:95], v[184:187], a[36:39], v[92:95]
buffer_load_dwordx4 a[80:83], v14, s[24:27], s65 offen offset:0 sc1
v_mfma_f32_16x16x32_bf16 v[96:99], v[144:147], a[32:35], v[96:99]
ds_read_b128 v[176:179], v7 offset:12288
v_mfma_f32_16x16x32_bf16 v[96:99], v[148:151], a[40:43], v[96:99]
s_waitcnt lgkmcnt(8)
ds_read_b128 v[180:183], v7 offset:13312
v_mfma_f32_16x16x32_bf16 v[100:103], v[148:151], a[44:47], v[100:103]
ds_write_b64 v11, a[108:109] offset:3072
v_mfma_f32_16x16x32_bf16 v[100:103], v[144:147], a[36:39], v[100:103]
buffer_load_dwordx4 a[88:91], v14, s[24:27], s65 offen offset:2048 sc1
v_mfma_f32_16x16x32_bf16 v[104:107], v[152:155], a[32:35], v[104:107]
ds_read_b128 v[184:187], v7 offset:14336
v_mfma_f32_16x16x32_bf16 v[104:107], v[156:159], a[40:43], v[104:107]
s_waitcnt lgkmcnt(8)
ds_read_b128 v[188:191], v7 offset:15360
v_mfma_f32_16x16x32_bf16 v[108:111], v[156:159], a[44:47], v[108:111]
ds_write_b64 v11, a[110:111] offset:3080
v_mfma_f32_16x16x32_bf16 v[108:111], v[152:155], a[36:39], v[108:111]
buffer_load_dwordx4 a[84:87], v14, s[24:27], s93 offen offset:0 sc1
v_mfma_f32_16x16x32_bf16 v[112:115], v[160:163], a[32:35], v[112:115]
s_add_u32 s91, s91, 16384
ds_read_b128 v[144:147], v8 offset:0
v_mfma_f32_16x16x32_bf16 v[112:115], v[164:167], a[40:43], v[112:115]
s_cmp_ge_u32 s91, 163840
s_cselect_b32 s91, 0, s91
ds_read_b128 v[148:151], v8 offset:1024
v_mfma_f32_16x16x32_bf16 v[116:119], v[164:167], a[44:47], v[116:119]
buffer_load_dwordx4 a[92:95], v14, s[24:27], s93 offen offset:2048 sc1
v_mfma_f32_16x16x32_bf16 v[116:119], v[160:163], a[36:39], v[116:119]
s_waitcnt lgkmcnt(9) vmcnt(11)
ds_read_b128 v[152:155], v8 offset:2048
v_add_u32 v7, s91, v4
v_mfma_f32_16x16x32_bf16 v[120:123], v[168:171], a[48:51], v[120:123]
ds_read_b128 v[156:159], v8 offset:3072
v_mfma_f32_16x16x32_bf16 v[120:123], v[172:175], a[56:59], v[120:123]
s_waitcnt vmcnt(9)
v_mfma_f32_16x16x32_bf16 v[124:127], v[172:175], a[60:63], v[124:127]
ds_read_b128 v[160:163], v8 offset:4096
v_mfma_f32_16x16x32_bf16 v[124:127], v[168:171], a[52:55], v[124:127]
s_waitcnt lgkmcnt(9)
v_mfma_f32_16x16x32_bf16 v[72:75], v[176:179], a[48:51], v[72:75]
ds_read_b128 v[164:167], v8 offset:5120
v_mfma_f32_16x16x32_bf16 v[72:75], v[180:183], a[56:59], v[72:75]
v_mfma_f32_16x16x32_bf16 v[76:79], v[180:183], a[60:63], v[76:79]
ds_read_b128 v[168:171], v8 offset:6144
v_mfma_f32_16x16x32_bf16 v[76:79], v[176:179], a[52:55], v[76:79]
s_xor_b32 s65, s82, 24576
s_add_u32 s65, s65, s77
s_waitcnt lgkmcnt(8)
v_mfma_f32_16x16x32_bf16 v[80:83], v[184:187], a[48:51], v[80:83]
ds_read_b128 v[172:175], v8 offset:7168
v_mfma_f32_16x16x32_bf16 v[80:83], v[188:191], a[56:59], v[80:83]
buffer_load_dwordx4 a[192:195], v4, s[24:27], s65 offen offset:0 sc1
v_mfma_f32_16x16x32_bf16 v[84:87], v[188:191], a[60:63], v[84:87]
ds_read_b128 v[176:179], v8 offset:8192
v_mfma_f32_16x16x32_bf16 v[84:87], v[184:187], a[52:55], v[84:87]
s_waitcnt lgkmcnt(7)
v_mfma_f32_16x16x32_bf16 v[88:91], v[144:147], a[48:51], v[88:91]
ds_read_b128 v[180:183], v8 offset:9216
v_mfma_f32_16x16x32_bf16 v[88:91], v[148:151], a[56:59], v[88:91]
v_mfma_f32_16x16x32_bf16 v[92:95], v[148:151], a[60:63], v[92:95]
s_waitcnt lgkmcnt(6)
ds_read_b128 v[184:187], v8 offset:10240
v_mfma_f32_16x16x32_bf16 v[92:95], v[144:147], a[52:55], v[92:95]
buffer_load_dwordx4 a[200:203], v4, s[24:27], s65 offen offset:2048 sc1
v_mfma_f32_16x16x32_bf16 v[96:99], v[152:155], a[48:51], v[96:99]
s_add_u32 s52, s84, 1
ds_read_b128 v[188:191], v8 offset:11264
v_mfma_f32_16x16x32_bf16 v[96:99], v[156:159], a[56:59], v[96:99]
v_mfma_f32_16x16x32_bf16 v[100:103], v[156:159], a[60:63], v[100:103]
s_xor_b32 s93, s82, 24576
s_add_u32 s93, s93, s81
ds_read_b128 v[144:147], v8 offset:12288
v_mfma_f32_16x16x32_bf16 v[100:103], v[152:155], a[52:55], v[100:103]
s_and_b32 s52, s52, 3
s_waitcnt lgkmcnt(7)
v_mfma_f32_16x16x32_bf16 v[104:107], v[160:163], a[48:51], v[104:107]
buffer_load_dwordx4 a[196:199], v4, s[24:27], s93 offen offset:0 sc1
v_mfma_f32_16x16x32_bf16 v[104:107], v[164:167], a[56:59], v[104:107]
s_waitcnt lgkmcnt(5)
ds_read_b128 v[148:151], v8 offset:13312
v_mfma_f32_16x16x32_bf16 v[108:111], v[164:167], a[60:63], v[108:111]
s_mul_i32 s52, s52, 6144
ds_read_b128 v[152:155], v8 offset:14336
v_add_u32 v11, s70, v4
v_mfma_f32_16x16x32_bf16 v[108:111], v[160:163], a[52:55], v[108:111]
L_PAD11:
s_cbranch_execz L_MAIN
s_add_u32 s70, s70, 16384
s_cmp_ge_u32 s70, 163840
s_cselect_b32 s70, s80, s70
v_mfma_f32_16x16x32_bf16 v[112:115], v[168:171], a[48:51], v[112:115]
s_waitcnt vmcnt(48)
ds_read_b128 v[156:159], v8 offset:15360
v_mfma_f32_16x16x32_bf16 v[112:115], v[172:175], a[56:59], v[112:115]
s_barrier
v_mfma_f32_16x16x32_bf16 v[116:119], v[172:175], a[60:63], v[116:119]
s_add_u32 s52, s52, s69
s_waitcnt lgkmcnt(6) vmcnt(10)
ds_read_b128 v[160:163], v7 offset:0
v_mfma_f32_16x16x32_bf16 v[116:119], v[168:171], a[52:55], v[116:119]
buffer_load_dwordx4 a[204:207], v4, s[24:27], s93 offen offset:2048 sc1
v_mfma_f32_16x16x32_bf16 v[120:123], v[176:179], a[64:67], v[120:123]
ds_write_b64 v11, a[112:113] offset:0
v_mfma_f32_16x16x32_bf16 v[120:123], v[180:183], a[72:75], v[120:123]
s_add_u32 s52, s52, 0
s_waitcnt vmcnt(9)
ds_read_b128 v[164:167], v7 offset:1024
v_mfma_f32_16x16x32_bf16 v[124:127], v[180:183], a[76:79], v[124:127]
s_add_u32 s91, s91, 16384
ds_read_b128 v[168:171], v7 offset:2048
v_mfma_f32_16x16x32_bf16 v[124:127], v[176:179], a[68:71], v[124:127]
s_waitcnt lgkmcnt(8)
s_cmp_ge_u32 s91, 163840
s_cselect_b32 s91, 0, s91
v_mfma_f32_16x16x32_bf16 v[72:75], v[184:187], a[64:67], v[72:75]
s_add_u32 s53, s84, 2
ds_read_b128 v[172:175], v7 offset:3072
v_add_u32 v8, s91, v4
v_mfma_f32_16x16x32_bf16 v[72:75], v[188:191], a[72:75], v[72:75]
ds_write_b64 v11, a[114:115] offset:8
v_mfma_f32_16x16x32_bf16 v[76:79], v[188:191], a[76:79], v[76:79]
buffer_load_dwordx4 a[208:211], v14, s[24:27], s65 offen offset:0 sc1
v_mfma_f32_16x16x32_bf16 v[76:79], v[184:187], a[68:71], v[76:79]
s_and_b32 s53, s53, 3
s_waitcnt lgkmcnt(8)
ds_read_b128 v[176:179], v7 offset:4096
v_mfma_f32_16x16x32_bf16 v[80:83], v[144:147], a[64:67], v[80:83]
ds_read_b128 v[180:183], v7 offset:5120
v_mfma_f32_16x16x32_bf16 v[80:83], v[148:151], a[72:75], v[80:83]
ds_write_b64 v11, a[116:117] offset:1024
v_mfma_f32_16x16x32_bf16 v[84:87], v[148:151], a[76:79], v[84:87]
s_mul_i32 s53, s53, 6144
s_waitcnt lgkmcnt(9)
ds_read_b128 v[184:187], v7 offset:6144
v_mfma_f32_16x16x32_bf16 v[84:87], v[144:147], a[68:71], v[84:87]
buffer_load_dwordx4 a[216:219], v14, s[24:27], s65 offen offset:2048 sc1
v_mfma_f32_16x16x32_bf16 v[88:91], v[152:155], a[64:67], v[88:91]
ds_read_b128 v[188:191], v7 offset:7168
v_mfma_f32_16x16x32_bf16 v[88:91], v[156:159], a[72:75], v[88:91]
s_add_u32 s53, s53, s69
s_waitcnt lgkmcnt(8)
v_mfma_f32_16x16x32_bf16 v[92:95], v[156:159], a[76:79], v[92:95]
ds_write_b64 v11, a[118:119] offset:1032
v_mfma_f32_16x16x32_bf16 v[92:95], v[152:155], a[68:71], v[92:95]
buffer_load_dwordx4 a[212:215], v14, s[24:27], s93 offen offset:0 sc1
v_mfma_f32_16x16x32_bf16 v[96:99], v[160:163], a[64:67], v[96:99]
s_add_u32 s53, s53, 2048
ds_read_b128 v[144:147], v7 offset:8192
v_mfma_f32_16x16x32_bf16 v[96:99], v[164:167], a[72:75], v[96:99]
ds_read_b128 v[148:151], v7 offset:9216
v_mfma_f32_16x16x32_bf16 v[100:103], v[164:167], a[76:79], v[100:103]
ds_write_b64 v11, a[120:121] offset:2048
v_mfma_f32_16x16x32_bf16 v[100:103], v[160:163], a[68:71], v[100:103]
s_add_u32 s54, s84, 3
s_waitcnt lgkmcnt(10)
ds_read_b128 v[152:155], v7 offset:10240
v_mfma_f32_16x16x32_bf16 v[104:107], v[168:171], a[64:67], v[104:107]
ds_read_b128 v[156:159], v7 offset:11264
v_mfma_f32_16x16x32_bf16 v[104:107], v[172:175], a[72:75], v[104:107]
buffer_load_dwordx4 a[220:223], v14, s[24:27], s93 offen offset:2048 sc1
v_mfma_f32_16x16x32_bf16 v[108:111], v[172:175], a[76:79], v[108:111]
s_and_b32 s54, s54, 3
s_waitcnt lgkmcnt(9)
ds_read_b128 v[160:163], v7 offset:12288
v_mfma_f32_16x16x32_bf16 v[108:111], v[168:171], a[68:71], v[108:111]
ds_write_b64 v11, a[122:123] offset:2056
v_mfma_f32_16x16x32_bf16 v[112:115], v[176:179], a[64:67], v[112:115]
ds_read_b128 v[164:167], v7 offset:13312
v_mfma_f32_16x16x32_bf16 v[112:115], v[180:183], a[72:75], v[112:115]
s_mul_i32 s54, s54, 6144
s_xor_b32 s65, s82, 32768
s_add_u32 s65, s65, s77
v_mfma_f32_16x16x32_bf16 v[116:119], v[180:183], a[76:79], v[116:119]
s_waitcnt lgkmcnt(9) vmcnt(10)
ds_read_b128 v[168:171], v7 offset:14336
v_mfma_f32_16x16x32_bf16 v[116:119], v[176:179], a[68:71], v[116:119]
ds_write_b64 v11, a[124:125] offset:3072
v_mfma_f32_16x16x32_bf16 v[120:123], v[184:187], a[80:83], v[120:123]
s_add_u32 s54, s54, s69
s_waitcnt vmcnt(8)
ds_read_b128 v[172:175], v7 offset:15360
v_mfma_f32_16x16x32_bf16 v[120:123], v[188:191], a[88:91], v[120:123]
buffer_load_dwordx4 a[224:227], v4, s[24:27], s65 offen offset:0 sc1
v_mfma_f32_16x16x32_bf16 v[124:127], v[188:191], a[92:95], v[124:127]
s_add_u32 s91, s91, 16384
ds_read_b128 v[176:179], v8 offset:0
v_mfma_f32_16x16x32_bf16 v[124:127], v[184:187], a[84:87], v[124:127]
s_add_u32 s54, s54, 4096
s_waitcnt lgkmcnt(10)
v_mfma_f32_16x16x32_bf16 v[72:75], v[144:147], a[80:83], v[72:75]
ds_write_b64 v11, a[126:127] offset:3080
v_mfma_f32_16x16x32_bf16 v[72:75], v[148:151], a[88:91], v[72:75]
s_waitcnt lgkmcnt(5)
ds_read_b128 v[180:183], v8 offset:1024
v_add_u32 v11, s70, v4
v_mfma_f32_16x16x32_bf16 v[76:79], v[148:151], a[92:95], v[76:79]
s_sub_u32 s55, s3, s84
s_add_u32 s70, s70, 16384
ds_read_b128 v[184:187], v8 offset:2048
v_mfma_f32_16x16x32_bf16 v[76:79], v[144:147], a[84:87], v[76:79]
s_cmp_ge_u32 s70, 163840
s_cselect_b32 s70, s80, s70
s_waitcnt lgkmcnt(10)
v_mfma_f32_16x16x32_bf16 v[80:83], v[152:155], a[80:83], v[80:83]
buffer_load_dwordx4 a[232:235], v4, s[24:27], s65 offen offset:2048 sc1
v_mfma_f32_16x16x32_bf16 v[80:83], v[156:159], a[88:91], v[80:83]
s_and_b32 s55, s55, 3
s_xor_b32 s93, s82, 32768
s_add_u32 s93, s93, s81
v_mfma_f32_16x16x32_bf16 v[84:87], v[156:159], a[92:95], v[84:87]
ds_write_b64 v11, a[160:161] offset:0
v_mfma_f32_16x16x32_bf16 v[84:87], v[152:155], a[84:87], v[84:87]
buffer_load_dwordx4 a[228:231], v4, s[24:27], s93 offen offset:0 sc1
v_mfma_f32_16x16x32_bf16 v[88:91], v[160:163], a[80:83], v[88:91]
s_lshl_b32 s55, s55, 10
ds_read_b128 v[188:191], v8 offset:3072
v_mfma_f32_16x16x32_bf16 v[88:91], v[164:167], a[88:91], v[88:91]
s_cmp_ge_u32 s91, 163840
s_cselect_b32 s91, 0, s91
ds_read_b128 v[144:147], v8 offset:4096
v_mfma_f32_16x16x32_bf16 v[92:95], v[164:167], a[92:95], v[92:95]
ds_write_b64 v11, a[162:163] offset:8
v_mfma_f32_16x16x32_bf16 v[92:95], v[160:163], a[84:87], v[92:95]
s_add_u32 s55, s55, s69
s_waitcnt lgkmcnt(8)
ds_read_b128 v[148:151], v8 offset:5120
v_mfma_f32_16x16x32_bf16 v[96:99], v[168:171], a[80:83], v[96:99]
buffer_load_dwordx4 a[236:239], v4, s[24:27], s93 offen offset:2048 sc1
v_mfma_f32_16x16x32_bf16 v[96:99], v[172:175], a[88:91], v[96:99]
ds_read_b128 v[152:155], v8 offset:6144
v_add_u32 v7, s91, v4
v_mfma_f32_16x16x32_bf16 v[100:103], v[172:175], a[92:95], v[100:103]
s_add_u32 s55, s55, 23552
s_waitcnt lgkmcnt(7)
ds_read_b128 v[156:159], v8 offset:7168
v_mfma_f32_16x16x32_bf16 v[100:103], v[168:171], a[84:87], v[100:103]
ds_write_b64 v11, a[164:165] offset:1024
v_mfma_f32_16x16x32_bf16 v[104:107], v[176:179], a[80:83], v[104:107]
ds_read_b128 v[160:163], v8 offset:8192
v_mfma_f32_16x16x32_bf16 v[104:107], v[180:183], a[88:91], v[104:107]
s_add_u32 s71, s69, 24576
s_waitcnt lgkmcnt(7)
ds_read_b128 v[164:167], v8 offset:9216
v_mfma_f32_16x16x32_bf16 v[108:111], v[180:183], a[92:95], v[108:111]
buffer_load_dwordx4 a[240:243], v14, s[24:27], s65 offen offset:0 sc1
v_mfma_f32_16x16x32_bf16 v[108:111], v[176:179], a[84:87], v[108:111]
ds_write_b64 v11, a[166:167] offset:1032
v_mfma_f32_16x16x32_bf16 v[112:115], v[184:187], a[80:83], v[112:115]
s_cmp_eq_u32 s3, s84
s_cselect_b32 s55, 2147418112, s55
s_cselect_b32 s71, s71, 2147418112
v_mfma_f32_16x16x32_bf16 v[112:115], v[188:191], a[88:91], v[112:115]
ds_read_b128 v[168:171], v8 offset:10240
v_mfma_f32_16x16x32_bf16 v[116:119], v[188:191], a[92:95], v[116:119]
s_waitcnt vmcnt(9)
ds_read_b128 v[172:175], v8 offset:11264
v_mfma_f32_16x16x32_bf16 v[116:119], v[184:187], a[84:87], v[116:119]
s_mul_i32 s83, s84, 6144
s_waitcnt lgkmcnt(8) vmcnt(11)
ds_read_b128 v[176:179], v8 offset:12288
v_mfma_f32_16x16x32_bf16 v[120:123], v[144:147], a[192:195], v[120:123]
ds_write_b64 v11, a[168:169] offset:2048
v_mfma_f32_16x16x32_bf16 v[120:123], v[148:151], a[200:203], v[120:123]
buffer_load_dwordx4 a[248:251], v14, s[24:27], s65 offen offset:2048 sc1
v_mfma_f32_16x16x32_bf16 v[124:127], v[148:151], a[204:207], v[124:127]
s_add_u32 s69, s69, s83
ds_read_b128 v[180:183], v8 offset:13312
v_mfma_f32_16x16x32_bf16 v[124:127], v[144:147], a[196:199], v[124:127]
s_waitcnt lgkmcnt(9)
ds_read_b128 v[184:187], v8 offset:14336
v_mfma_f32_16x16x32_bf16 v[72:75], v[152:155], a[192:195], v[72:75]
s_waitcnt vmcnt(51)
ds_read_b128 v[188:191], v8 offset:15360
v_mfma_f32_16x16x32_bf16 v[72:75], v[156:159], a[200:203], v[72:75]
s_barrier
v_mfma_f32_16x16x32_bf16 v[76:79], v[156:159], a[204:207], v[76:79]
s_add_u32 s83, s69, 4096
s_waitcnt lgkmcnt(8)
ds_read_b128 v[144:147], v7 offset:0
v_mfma_f32_16x16x32_bf16 v[76:79], v[152:155], a[196:199], v[76:79]
ds_write_b64 v11, a[170:171] offset:2056
v_mfma_f32_16x16x32_bf16 v[80:83], v[160:163], a[192:195], v[80:83]
buffer_load_dwordx4 a[244:247], v14, s[24:27], s93 offen offset:0 sc1
v_mfma_f32_16x16x32_bf16 v[80:83], v[164:167], a[200:203], v[80:83]
s_add_u32 s91, s91, 16384
ds_read_b128 v[148:151], v7 offset:1024
v_mfma_f32_16x16x32_bf16 v[84:87], v[164:167], a[204:207], v[84:87]
s_waitcnt lgkmcnt(8)
ds_read_b128 v[152:155], v7 offset:2048
v_mfma_f32_16x16x32_bf16 v[84:87], v[160:163], a[196:199], v[84:87]
ds_write_b64 v11, a[172:173] offset:3072
v_mfma_f32_16x16x32_bf16 v[88:91], v[168:171], a[192:195], v[88:91]
buffer_load_dwordx4 a[252:255], v14, s[24:27], s93 offen offset:2048 sc1
v_mfma_f32_16x16x32_bf16 v[88:91], v[172:175], a[200:203], v[88:91]
s_waitcnt lgkmcnt(7)
ds_read_b128 v[156:159], v7 offset:3072
v_mfma_f32_16x16x32_bf16 v[92:95], v[172:175], a[204:207], v[92:95]
s_xor_b32 s65, s82, 40960
s_add_u32 s65, s65, s77
ds_read_b128 v[160:163], v7 offset:4096
v_mfma_f32_16x16x32_bf16 v[92:95], v[168:171], a[196:199], v[92:95]
ds_write_b64 v11, a[174:175] offset:3080
v_mfma_f32_16x16x32_bf16 v[96:99], v[176:179], a[192:195], v[96:99]
s_add_u32 s68, s68, 49152
ds_read_b128 v[164:167], v7 offset:5120
v_mfma_f32_16x16x32_bf16 v[96:99], v[180:183], a[200:203], v[96:99]
buffer_load_dwordx4 a[96:99], v4, s[24:27], s65 offen offset:0 sc1
v_mfma_f32_16x16x32_bf16 v[100:103], v[180:183], a[204:207], v[100:103]
s_cmp_ge_u32 s91, 163840
s_cselect_b32 s91, 0, s91
ds_read_b128 v[168:171], v7 offset:6144
v_mfma_f32_16x16x32_bf16 v[100:103], v[176:179], a[196:199], v[100:103]
s_waitcnt lgkmcnt(10)
v_add_u32 v8, s91, v4
v_mfma_f32_16x16x32_bf16 v[104:107], v[184:187], a[192:195], v[104:107]
ds_read_b128 v[172:175], v7 offset:7168
v_mfma_f32_16x16x32_bf16 v[104:107], v[188:191], a[200:203], v[104:107]
v_mfma_f32_16x16x32_bf16 v[108:111], v[188:191], a[204:207], v[108:111]
buffer_load_dwordx4 a[104:107], v4, s[24:27], s65 offen offset:2048 sc1
v_mfma_f32_16x16x32_bf16 v[108:111], v[184:187], a[196:199], v[108:111]
s_waitcnt lgkmcnt(8)
ds_read_b128 v[176:179], v7 offset:8192
v_mfma_f32_16x16x32_bf16 v[112:115], v[144:147], a[192:195], v[112:115]
ds_read_b128 v[180:183], v7 offset:9216
v_mfma_f32_16x16x32_bf16 v[112:115], v[148:151], a[200:203], v[112:115]
v_mfma_f32_16x16x32_bf16 v[116:119], v[148:151], a[204:207], v[116:119]
s_xor_b32 s93, s82, 40960
s_add_u32 s93, s93, s81
ds_read_b128 v[184:187], v7 offset:10240
v_mfma_f32_16x16x32_bf16 v[116:119], v[144:147], a[196:199], v[116:119]
s_waitcnt lgkmcnt(8) vmcnt(12)
v_mfma_f32_16x16x32_bf16 v[120:123], v[152:155], a[208:211], v[120:123]
buffer_load_dwordx4 a[100:103], v4, s[24:27], s93 offen offset:0 sc1
v_mfma_f32_16x16x32_bf16 v[120:123], v[156:159], a[216:219], v[120:123]
s_waitcnt vmcnt(11)
ds_read_b128 v[188:191], v7 offset:11264
v_mfma_f32_16x16x32_bf16 v[124:127], v[156:159], a[220:223], v[124:127]
ds_read_b128 v[144:147], v7 offset:12288
v_mfma_f32_16x16x32_bf16 v[124:127], v[152:155], a[212:215], v[124:127]
s_waitcnt lgkmcnt(7)
v_mfma_f32_16x16x32_bf16 v[72:75], v[160:163], a[208:211], v[72:75]
ds_read_b128 v[148:151], v7 offset:13312
v_mfma_f32_16x16x32_bf16 v[72:75], v[164:167], a[216:219], v[72:75]
v_mov_b32 v13, 0xffff0000
v_mul_u32_u24 v5, 1152, v2
v_mfma_f32_16x16x32_bf16 v[76:79], v[164:167], a[220:223], v[76:79]
buffer_load_dwordx4 a[108:111], v4, s[24:27], s93 offen offset:2048 sc1
v_mfma_f32_16x16x32_bf16 v[76:79], v[160:163], a[212:215], v[76:79]
s_waitcnt lgkmcnt(6)
ds_read_b128 v[152:155], v7 offset:14336
v_lshl_add_u32 v6, v3, 3, v5
v_mfma_f32_16x16x32_bf16 v[80:83], v[168:171], a[208:211], v[80:83]
ds_read_b128 v[156:159], v7 offset:15360
v_and_b32 v9, 1, v3
v_mfma_f32_16x16x32_bf16 v[80:83], v[172:175], a[216:219], v[80:83]
s_add_u32 s91, s91, 16384
s_cmp_ge_u32 s91, 163840
s_cselect_b32 s91, 0, s91
v_mfma_f32_16x16x32_bf16 v[84:87], v[172:175], a[220:223], v[84:87]
s_waitcnt lgkmcnt(6)
ds_read_b128 v[160:163], v8 offset:0
v_add_u32 v7, s91, v4
v_mfma_f32_16x16x32_bf16 v[84:87], v[168:171], a[212:215], v[84:87]
buffer_load_dwordx4 a[112:115], v14, s[24:27], s65 offen offset:0 sc1
v_mfma_f32_16x16x32_bf16 v[88:91], v[176:179], a[208:211], v[88:91]
ds_read_b128 v[164:167], v8 offset:1024
v_lshl_add_u32 v5, v9, 5, v5
v_mfma_f32_16x16x32_bf16 v[88:91], v[180:183], a[216:219], v[88:91]
v_lshrrev_b32 v9, 1, v3
v_lshl_add_u32 v5, v9, 4, v5
v_mfma_f32_16x16x32_bf16 v[92:95], v[180:183], a[220:223], v[92:95]
ds_read_b128 v[168:171], v8 offset:2048
v_mfma_f32_16x16x32_bf16 v[92:95], v[176:179], a[212:215], v[92:95]
s_waitcnt lgkmcnt(7)
v_mfma_f32_16x16x32_bf16 v[96:99], v[184:187], a[208:211], v[96:99]
ds_read_b128 v[172:175], v8 offset:3072
v_mfma_f32_16x16x32_bf16 v[96:99], v[188:191], a[216:219], v[96:99]
buffer_load_dwordx4 a[120:123], v14, s[24:27], s65 offen offset:2048 sc1
v_mfma_f32_16x16x32_bf16 v[100:103], v[188:191], a[220:223], v[100:103]
ds_read_b128 v[176:179], v8 offset:4096
v_mfma_f32_16x16x32_bf16 v[100:103], v[184:187], a[212:215], v[100:103]
s_waitcnt lgkmcnt(7)
v_mfma_f32_16x16x32_bf16 v[104:107], v[144:147], a[208:211], v[104:107]
ds_read_b128 v[180:183], v8 offset:5120
v_mfma_f32_16x16x32_bf16 v[104:107], v[148:151], a[216:219], v[104:107]
v_mfma_f32_16x16x32_bf16 v[108:111], v[148:151], a[220:223], v[108:111]
s_waitcnt lgkmcnt(6)
ds_read_b128 v[184:187], v8 offset:6144
v_mfma_f32_16x16x32_bf16 v[108:111], v[144:147], a[212:215], v[108:111]
buffer_load_dwordx4 a[116:119], v14, s[24:27], s93 offen offset:0 sc1
v_mfma_f32_16x16x32_bf16 v[112:115], v[152:155], a[208:211], v[112:115]
ds_read_b128 v[188:191], v8 offset:7168
v_mfma_f32_16x16x32_bf16 v[112:115], v[156:159], a[216:219], v[112:115]
v_mfma_f32_16x16x32_bf16 v[116:119], v[156:159], a[220:223], v[116:119]
ds_read_b128 v[144:147], v8 offset:8192
v_mfma_f32_16x16x32_bf16 v[116:119], v[152:155], a[212:215], v[116:119]
s_waitcnt lgkmcnt(7) vmcnt(13)
v_mfma_f32_16x16x32_bf16 v[120:123], v[160:163], a[224:227], v[120:123]
buffer_load_dwordx4 a[124:127], v14, s[24:27], s93 offen offset:2048 sc1
v_mfma_f32_16x16x32_bf16 v[120:123], v[164:167], a[232:235], v[120:123]
s_waitcnt vmcnt(12)
ds_read_b128 v[148:151], v8 offset:9216
v_mfma_f32_16x16x32_bf16 v[124:127], v[164:167], a[236:239], v[124:127]
ds_read_b128 v[152:155], v8 offset:10240
v_mfma_f32_16x16x32_bf16 v[124:127], v[160:163], a[228:231], v[124:127]
s_waitcnt lgkmcnt(7)
v_mfma_f32_16x16x32_bf16 v[72:75], v[168:171], a[224:227], v[72:75]
s_xor_b32 s65, s82, 49152
s_add_u32 s65, s65, s77
ds_read_b128 v[156:159], v8 offset:11264
v_mfma_f32_16x16x32_bf16 v[72:75], v[172:175], a[232:235], v[72:75]
v_mfma_f32_16x16x32_bf16 v[76:79], v[172:175], a[236:239], v[76:79]
buffer_load_dwordx4 a[128:131], v4, s[24:27], s65 offen offset:0 sc1
v_mfma_f32_16x16x32_bf16 v[76:79], v[168:171], a[228:231], v[76:79]
s_waitcnt lgkmcnt(6)
ds_read_b128 v[160:163], v8 offset:12288
v_mfma_f32_16x16x32_bf16 v[80:83], v[176:179], a[224:227], v[80:83]
ds_read_b128 v[164:167], v8 offset:13312
v_mfma_f32_16x16x32_bf16 v[80:83], v[180:183], a[232:235], v[80:83]
v_mfma_f32_16x16x32_bf16 v[84:87], v[180:183], a[236:239], v[84:87]
ds_read_b128 v[168:171], v8 offset:14336
v_mfma_f32_16x16x32_bf16 v[84:87], v[176:179], a[228:231], v[84:87]
s_waitcnt lgkmcnt(7)
v_mfma_f32_16x16x32_bf16 v[88:91], v[184:187], a[224:227], v[88:91]
s_waitcnt vmcnt(53)
ds_read_b128 v[172:175], v8 offset:15360
v_mfma_f32_16x16x32_bf16 v[88:91], v[188:191], a[232:235], v[88:91]
s_barrier
v_mfma_f32_16x16x32_bf16 v[92:95], v[188:191], a[236:239], v[92:95]
buffer_load_dwordx4 a[136:139], v4, s[24:27], s65 offen offset:2048 sc1
v_mfma_f32_16x16x32_bf16 v[92:95], v[184:187], a[228:231], v[92:95]
s_waitcnt lgkmcnt(6)
s_add_u32 s91, s91, 16384
ds_read_b128 v[176:179], v7 offset:0
v_mfma_f32_16x16x32_bf16 v[96:99], v[144:147], a[224:227], v[96:99]
s_xor_b32 s93, s82, 49152
s_add_u32 s93, s93, s81
ds_read_b128 v[180:183], v7 offset:1024
v_mfma_f32_16x16x32_bf16 v[96:99], v[148:151], a[232:235], v[96:99]
s_cmp_ge_u32 s91, 163840
s_cselect_b32 s91, 0, s91
v_add_u32 v8, s91, v4
v_mfma_f32_16x16x32_bf16 v[100:103], v[148:151], a[236:239], v[100:103]
buffer_load_dwordx4 a[132:135], v4, s[24:27], s93 offen offset:0 sc1
v_mfma_f32_16x16x32_bf16 v[100:103], v[144:147], a[228:231], v[100:103]
s_waitcnt lgkmcnt(6) vmcnt(13)
ds_read_b128 v[184:187], v7 offset:2048
v_mfma_f32_16x16x32_bf16 v[120:123], v[152:155], a[240:243], v[120:123]
ds_read_b128 v[188:191], v7 offset:3072
v_mfma_f32_16x16x32_bf16 v[120:123], v[156:159], a[248:251], v[120:123]
s_waitcnt vmcnt(11)
v_mfma_f32_16x16x32_bf16 v[124:127], v[156:159], a[252:255], v[124:127]
buffer_load_dwordx4 a[140:143], v4, s[24:27], s93 offen offset:2048 sc1
v_mfma_f32_16x16x32_bf16 v[124:127], v[152:155], a[244:247], v[124:127]
s_waitcnt lgkmcnt(6)
ds_read_b128 v[144:147], v7 offset:4096
v_mfma_f32_16x16x32_bf16 v[72:75], v[160:163], a[240:243], v[72:75]
ds_read_b128 v[148:151], v7 offset:5120
v_mfma_f32_16x16x32_bf16 v[72:75], v[164:167], a[248:251], v[72:75]
v_mfma_f32_16x16x32_bf16 v[76:79], v[164:167], a[252:255], v[76:79]
ds_read_b128 v[152:155], v7 offset:6144
v_mfma_f32_16x16x32_bf16 v[76:79], v[160:163], a[244:247], v[76:79]
s_waitcnt lgkmcnt(7)
v_mfma_f32_16x16x32_bf16 v[80:83], v[168:171], a[240:243], v[80:83]
ds_read_b128 v[156:159], v7 offset:7168
v_mfma_f32_16x16x32_bf16 v[80:83], v[172:175], a[248:251], v[80:83]
buffer_load_dwordx4 a[144:147], v14, s[24:27], s65 offen offset:0 sc1
v_mfma_f32_16x16x32_bf16 v[84:87], v[172:175], a[252:255], v[84:87]
buffer_load_dword v12, v10, s[24:27], s75 offen offset:4 sc1
v_mfma_f32_16x16x32_bf16 v[84:87], v[168:171], a[244:247], v[84:87]
s_waitcnt lgkmcnt(6)
ds_read_b128 v[160:163], v7 offset:8192
v_mfma_f32_16x16x32_bf16 v[88:91], v[176:179], a[240:243], v[88:91]
ds_read_b128 v[164:167], v7 offset:9216
v_mfma_f32_16x16x32_bf16 v[88:91], v[180:183], a[248:251], v[88:91]
v_mfma_f32_16x16x32_bf16 v[92:95], v[180:183], a[252:255], v[92:95]
buffer_load_dwordx4 a[152:155], v14, s[24:27], s65 offen offset:2048 sc1
v_mfma_f32_16x16x32_bf16 v[92:95], v[176:179], a[244:247], v[92:95]
s_waitcnt lgkmcnt(6)
ds_read_b128 v[168:171], v7 offset:10240
v_mfma_f32_16x16x32_bf16 v[96:99], v[184:187], a[240:243], v[96:99]
ds_read_b128 v[172:175], v7 offset:11264
v_mfma_f32_16x16x32_bf16 v[96:99], v[188:191], a[248:251], v[96:99]
v_mfma_f32_16x16x32_bf16 v[100:103], v[188:191], a[252:255], v[100:103]
buffer_load_dwordx4 a[148:151], v14, s[24:27], s93 offen offset:0 sc1
v_mfma_f32_16x16x32_bf16 v[100:103], v[184:187], a[244:247], v[100:103]
s_waitcnt lgkmcnt(6) vmcnt(14)
ds_read_b128 v[176:179], v7 offset:12288
v_mfma_f32_16x16x32_bf16 v[120:123], v[144:147], a[96:99], v[120:123]
ds_read_b128 v[180:183], v7 offset:13312
v_mfma_f32_16x16x32_bf16 v[120:123], v[148:151], a[104:107], v[120:123]
s_waitcnt vmcnt(12)
v_mfma_f32_16x16x32_bf16 v[124:127], v[148:151], a[108:111], v[124:127]
buffer_load_dwordx4 a[156:159], v14, s[24:27], s93 offen offset:2048 sc1
v_mfma_f32_16x16x32_bf16 v[124:127], v[144:147], a[100:103], v[124:127]
s_waitcnt lgkmcnt(6)
ds_read_b128 v[184:187], v7 offset:14336
v_mfma_f32_16x16x32_bf16 v[72:75], v[152:155], a[96:99], v[72:75]
ds_read_b128 v[188:191], v7 offset:15360
v_mfma_f32_16x16x32_bf16 v[72:75], v[156:159], a[104:107], v[72:75]
s_add_u32 s91, s91, 16384
s_cmp_ge_u32 s91, 163840
s_cselect_b32 s91, 0, s91
v_mfma_f32_16x16x32_bf16 v[76:79], v[156:159], a[108:111], v[76:79]
ds_read_b128 v[144:147], v8 offset:0
v_add_u32 v7, s91, v4
v_mfma_f32_16x16x32_bf16 v[76:79], v[152:155], a[100:103], v[76:79]
s_waitcnt lgkmcnt(7)
v_mfma_f32_16x16x32_bf16 v[80:83], v[160:163], a[96:99], v[80:83]
s_xor_b32 s65, s82, 57344
s_add_u32 s65, s65, s77
ds_read_b128 v[148:151], v8 offset:1024
v_mfma_f32_16x16x32_bf16 v[80:83], v[164:167], a[104:107], v[80:83]
v_mfma_f32_16x16x32_bf16 v[84:87], v[164:167], a[108:111], v[84:87]
buffer_load_dwordx4 a[160:163], v4, s[24:27], s65 offen offset:0 sc1
v_mfma_f32_16x16x32_bf16 v[84:87], v[160:163], a[100:103], v[84:87]
s_waitcnt lgkmcnt(6)
ds_read_b128 v[152:155], v8 offset:2048
v_mfma_f32_16x16x32_bf16 v[88:91], v[168:171], a[96:99], v[88:91]
ds_read_b128 v[156:159], v8 offset:3072
v_mfma_f32_16x16x32_bf16 v[88:91], v[172:175], a[104:107], v[88:91]
v_mfma_f32_16x16x32_bf16 v[92:95], v[172:175], a[108:111], v[92:95]
buffer_load_dwordx4 a[168:171], v4, s[24:27], s65 offen offset:2048 sc1
v_mfma_f32_16x16x32_bf16 v[92:95], v[168:171], a[100:103], v[92:95]
s_waitcnt lgkmcnt(6)
ds_read_b128 v[160:163], v8 offset:4096
v_mfma_f32_16x16x32_bf16 v[96:99], v[176:179], a[96:99], v[96:99]
s_xor_b32 s93, s82, 57344
s_add_u32 s93, s93, s81
ds_read_b128 v[164:167], v8 offset:5120
v_mfma_f32_16x16x32_bf16 v[96:99], v[180:183], a[104:107], v[96:99]
v_mfma_f32_16x16x32_bf16 v[100:103], v[180:183], a[108:111], v[100:103]
buffer_load_dwordx4 a[164:167], v4, s[24:27], s93 offen offset:0 sc1
v_mfma_f32_16x16x32_bf16 v[100:103], v[176:179], a[100:103], v[100:103]
s_waitcnt lgkmcnt(6) vmcnt(14)
ds_read_b128 v[168:171], v8 offset:6144
v_mfma_f32_16x16x32_bf16 v[120:123], v[184:187], a[112:115], v[120:123]
ds_read_b128 v[172:175], v8 offset:7168
v_mfma_f32_16x16x32_bf16 v[120:123], v[188:191], a[120:123], v[120:123]
s_waitcnt vmcnt(12)
v_mfma_f32_16x16x32_bf16 v[124:127], v[188:191], a[124:127], v[124:127]
buffer_load_dwordx4 a[172:175], v4, s[24:27], s93 offen offset:2048 sc1
v_mfma_f32_16x16x32_bf16 v[124:127], v[184:187], a[116:119], v[124:127]
s_waitcnt lgkmcnt(6)
ds_read_b128 v[176:179], v8 offset:8192
v_mfma_f32_16x16x32_bf16 v[72:75], v[144:147], a[112:115], v[72:75]
s_mov_b32 m0, s70
s_mov_b32 s64, s68
s_add_u32 s68, s68, 16384
v_mfma_f32_16x16x32_bf16 v[72:75], v[148:151], a[120:123], v[72:75]
s_waitcnt lgkmcnt(5)
ds_read_b128 v[180:183], v8 offset:9216
v_mfma_f32_16x16x32_bf16 v[76:79], v[148:151], a[124:127], v[76:79]
s_add_u32 s70, s70, 16384
s_cmp_ge_u32 s70, 163840
s_cselect_b32 s70, s80, s70
v_mfma_f32_16x16x32_bf16 v[76:79], v[144:147], a[116:119], v[76:79]
buffer_load_dwordx4 v4, s[24:27], s64 offen offset:0 sc1 lds
v_mfma_f32_16x16x32_bf16 v[80:83], v[152:155], a[112:115], v[80:83]
ds_read_b128 v[184:187], v8 offset:10240
v_mfma_f32_16x16x32_bf16 v[80:83], v[156:159], a[120:123], v[80:83]
ds_read_b128 v[188:191], v8 offset:11264
v_mfma_f32_16x16x32_bf16 v[84:87], v[156:159], a[124:127], v[84:87]
buffer_load_dwordx4 v4, s[24:27], s64 offen offset:1024 sc1 lds
v_mfma_f32_16x16x32_bf16 v[84:87], v[152:155], a[116:119], v[84:87]
s_waitcnt lgkmcnt(6)
ds_read_b128 v[144:147], v8 offset:12288
v_mfma_f32_16x16x32_bf16 v[88:91], v[160:163], a[112:115], v[88:91]
ds_read_b128 v[148:151], v8 offset:13312
v_mfma_f32_16x16x32_bf16 v[88:91], v[164:167], a[120:123], v[88:91]
buffer_load_dwordx4 a[176:179], v14, s[24:27], s65 offen offset:0 sc1
v_mfma_f32_16x16x32_bf16 v[92:95], v[164:167], a[124:127], v[92:95]
ds_read_b128 v[152:155], v8 offset:14336
v_mfma_f32_16x16x32_bf16 v[92:95], v[160:163], a[116:119], v[92:95]
s_waitcnt lgkmcnt(7)
v_mfma_f32_16x16x32_bf16 v[96:99], v[168:171], a[112:115], v[96:99]
s_waitcnt vmcnt(10)
ds_read_b128 v[156:159], v8 offset:15360
v_mfma_f32_16x16x32_bf16 v[96:99], v[172:175], a[120:123], v[96:99]
s_barrier
v_mfma_f32_16x16x32_bf16 v[100:103], v[172:175], a[124:127], v[100:103]
s_waitcnt lgkmcnt(6) vmcnt(14)
ds_read_b128 v[160:163], v7 offset:0
v_cmp_gt_u32 vcc, 8, v12
v_mfma_f32_16x16x32_bf16 v[100:103], v[168:171], a[116:119], v[100:103]
buffer_load_dwordx4 v4, s[24:27], s64 offen offset:2048 sc1 lds
v_mfma_f32_16x16x32_bf16 v[120:123], v[176:179], a[128:131], v[120:123]
s_add_u32 s91, s91, 16384
ds_read_b128 v[164:167], v7 offset:1024
v_mfma_f32_16x16x32_bf16 v[120:123], v[180:183], a[136:139], v[120:123]
s_waitcnt lgkmcnt(6) vmcnt(13)
s_cmp_ge_u32 s91, 163840
s_cselect_b32 s91, 0, s91
v_mfma_f32_16x16x32_bf16 v[124:127], v[180:183], a[140:143], v[124:127]
buffer_load_dwordx4 a[184:187], v14, s[24:27], s65 offen offset:2048 sc1
v_mfma_f32_16x16x32_bf16 v[124:127], v[176:179], a[132:135], v[124:127]
s_cbranch_vccnz CK_ZAA
CK_ZAA_R:
v_mfma_f32_16x16x32_bf16 v[72:75], v[184:187], a[128:131], v[72:75]
ds_read_b128 v[168:171], v7 offset:2048
v_add_u32 v8, s91, v4
v_mfma_f32_16x16x32_bf16 v[72:75], v[188:191], a[136:139], v[72:75]
buffer_load_dwordx4 v4, s[24:27], s64 offen offset:3072 sc1 lds
v_mfma_f32_16x16x32_bf16 v[76:79], v[188:191], a[140:143], v[76:79]
ds_read_b128 v[172:175], v7 offset:3072
v_mfma_f32_16x16x32_bf16 v[76:79], v[184:187], a[132:135], v[76:79]
s_waitcnt lgkmcnt(6)
ds_read_b128 v[176:179], v7 offset:4096
v_mfma_f32_16x16x32_bf16 v[80:83], v[144:147], a[128:131], v[80:83]
buffer_load_dwordx4 a[180:183], v14, s[24:27], s93 offen offset:0 sc1
v_mfma_f32_16x16x32_bf16 v[80:83], v[148:151], a[136:139], v[80:83]
ds_read_b128 v[180:183], v7 offset:5120
v_mfma_f32_16x16x32_bf16 v[84:87], v[148:151], a[140:143], v[84:87]
s_waitcnt lgkmcnt(6)
ds_read_b128 v[184:187], v7 offset:6144
v_mfma_f32_16x16x32_bf16 v[84:87], v[144:147], a[132:135], v[84:87]
buffer_load_dwordx4 a[188:191], v14, s[24:27], s93 offen offset:2048 sc1
v_mfma_f32_16x16x32_bf16 v[88:91], v[152:155], a[128:131], v[88:91]
s_add_u32 s65, s77, 65536
ds_read_b128 v[188:191], v7 offset:7168
v_mfma_f32_16x16x32_bf16 v[88:91], v[156:159], a[136:139], v[88:91]
v_mfma_f32_16x16x32_bf16 v[92:95], v[156:159], a[140:143], v[92:95]
buffer_load_dwordx4 v[32:35], v4, s[24:27], s65 offen offset:0 sc1
v_mfma_f32_16x16x32_bf16 v[92:95], v[152:155], a[132:135], v[92:95]
s_waitcnt lgkmcnt(6)
ds_read_b128 v[144:147], v7 offset:8192
v_mfma_f32_16x16x32_bf16 v[96:99], v[160:163], a[128:131], v[96:99]
ds_read_b128 v[148:151], v7 offset:9216
v_mfma_f32_16x16x32_bf16 v[96:99], v[164:167], a[136:139], v[96:99]
buffer_load_dwordx4 v[40:43], v4, s[24:27], s65 offen offset:2048 sc1
v_mfma_f32_16x16x32_bf16 v[100:103], v[164:167], a[140:143], v[100:103]
s_add_u32 s93, s81, 65536
ds_read_b128 v[152:155], v7 offset:10240
v_mfma_f32_16x16x32_bf16 v[100:103], v[160:163], a[132:135], v[100:103]
s_waitcnt lgkmcnt(7) vmcnt(16)
v_mfma_f32_16x16x32_bf16 v[120:123], v[168:171], a[144:147], v[120:123]
buffer_load_dwordx4 v[36:39], v4, s[24:27], s93 offen offset:0 sc1
v_mfma_f32_16x16x32_bf16 v[120:123], v[172:175], a[152:155], v[120:123]
s_waitcnt vmcnt(15)
ds_read_b128 v[156:159], v7 offset:11264
v_mfma_f32_16x16x32_bf16 v[124:127], v[172:175], a[156:159], v[124:127]
s_waitcnt lgkmcnt(6)
ds_read_b128 v[160:163], v7 offset:12288
v_mfma_f32_16x16x32_bf16 v[124:127], v[168:171], a[148:151], v[124:127]
buffer_load_dwordx4 v[44:47], v4, s[24:27], s93 offen offset:2048 sc1
v_mfma_f32_16x16x32_bf16 v[72:75], v[176:179], a[144:147], v[72:75]
ds_read_b128 v[164:167], v7 offset:13312
v_mfma_f32_16x16x32_bf16 v[72:75], v[180:183], a[152:155], v[72:75]
v_mfma_f32_16x16x32_bf16 v[76:79], v[180:183], a[156:159], v[76:79]
ds_read_b128 v[168:171], v7 offset:14336
v_mfma_f32_16x16x32_bf16 v[76:79], v[176:179], a[148:151], v[76:79]
s_waitcnt lgkmcnt(7)
v_mfma_f32_16x16x32_bf16 v[80:83], v[184:187], a[144:147], v[80:83]
ds_read_b128 v[172:175], v7 offset:15360
v_mfma_f32_16x16x32_bf16 v[80:83], v[188:191], a[152:155], v[80:83]
s_add_u32 s91, s91, 16384
s_cmp_ge_u32 s91, 163840
s_cselect_b32 s91, 0, s91
v_mfma_f32_16x16x32_bf16 v[84:87], v[188:191], a[156:159], v[84:87]
buffer_load_dwordx4 v[48:51], v14, s[24:27], s65 offen offset:0 sc1
L_PAD12:
s_cbranch_execz L_MAIN
v_mfma_f32_16x16x32_bf16 v[84:87], v[184:187], a[148:151], v[84:87]
s_waitcnt lgkmcnt(6)
ds_read_b128 v[176:179], v8 offset:0
v_add_u32 v7, s91, v4
v_mfma_f32_16x16x32_bf16 v[88:91], v[144:147], a[144:147], v[88:91]
ds_read_b128 v[180:183], v8 offset:1024
v_mfma_f32_16x16x32_bf16 v[88:91], v[148:151], a[152:155], v[88:91]
s_waitcnt lgkmcnt(6)
v_mfma_f32_16x16x32_bf16 v[92:95], v[148:151], a[156:159], v[92:95]
buffer_load_dwordx4 v[56:59], v14, s[24:27], s65 offen offset:2048 sc1
v_mfma_f32_16x16x32_bf16 v[92:95], v[144:147], a[148:151], v[92:95]
s_mov_b32 m0, s70
s_mov_b32 s64, s68
s_add_u32 s68, s68, 16384
v_mfma_f32_16x16x32_bf16 v[96:99], v[152:155], a[144:147], v[96:99]
ds_read_b128 v[184:187], v8 offset:2048
v_mfma_f32_16x16x32_bf16 v[96:99], v[156:159], a[152:155], v[96:99]
s_add_u32 s70, s70, 16384
s_cmp_ge_u32 s70, 163840
s_cselect_b32 s70, s80, s70
v_mfma_f32_16x16x32_bf16 v[100:103], v[156:159], a[156:159], v[100:103]
buffer_load_dwordx4 v4, s[24:27], s64 offen offset:0 sc1 lds
v_mfma_f32_16x16x32_bf16 v[100:103], v[152:155], a[148:151], v[100:103]
s_waitcnt lgkmcnt(5) vmcnt(17)
ds_read_b128 v[188:191], v8 offset:3072
v_mfma_f32_16x16x32_bf16 v[120:123], v[160:163], a[160:163], v[120:123]
s_waitcnt vmcnt(15)
ds_read_b128 v[144:147], v8 offset:4096
v_mfma_f32_16x16x32_bf16 v[120:123], v[164:167], a[168:171], v[120:123]
buffer_load_dwordx4 v[52:55], v14, s[24:27], s93 offen offset:0 sc1
v_mfma_f32_16x16x32_bf16 v[124:127], v[164:167], a[172:175], v[124:127]
ds_read_b128 v[148:151], v8 offset:5120
v_mfma_f32_16x16x32_bf16 v[124:127], v[160:163], a[164:167], v[124:127]
s_waitcnt lgkmcnt(6)
ds_read_b128 v[152:155], v8 offset:6144
v_mfma_f32_16x16x32_bf16 v[72:75], v[168:171], a[160:163], v[72:75]
buffer_load_dwordx4 v4, s[24:27], s64 offen offset:1024 sc1 lds
v_mfma_f32_16x16x32_bf16 v[72:75], v[172:175], a[168:171], v[72:75]
ds_read_b128 v[156:159], v8 offset:7168
v_mfma_f32_16x16x32_bf16 v[76:79], v[172:175], a[172:175], v[76:79]
s_waitcnt lgkmcnt(6)
ds_read_b128 v[160:163], v8 offset:8192
v_mfma_f32_16x16x32_bf16 v[76:79], v[168:171], a[164:167], v[76:79]
buffer_load_dwordx4 v[60:63], v14, s[24:27], s93 offen offset:2048 sc1
v_mfma_f32_16x16x32_bf16 v[80:83], v[176:179], a[160:163], v[80:83]
ds_read_b128 v[164:167], v8 offset:9216
v_mfma_f32_16x16x32_bf16 v[80:83], v[180:183], a[168:171], v[80:83]
v_mfma_f32_16x16x32_bf16 v[84:87], v[180:183], a[172:175], v[84:87]
buffer_load_dwordx4 v4, s[24:27], s64 offen offset:2048 sc1 lds
v_mfma_f32_16x16x32_bf16 v[84:87], v[176:179], a[164:167], v[84:87]
s_waitcnt lgkmcnt(6)
ds_read_b128 v[168:171], v8 offset:10240
v_mfma_f32_16x16x32_bf16 v[88:91], v[184:187], a[160:163], v[88:91]
ds_read_b128 v[172:175], v8 offset:11264
v_mfma_f32_16x16x32_bf16 v[88:91], v[188:191], a[168:171], v[88:91]
buffer_load_dwordx4 v4, s[24:27], s64 offen offset:3072 sc1 lds
v_mfma_f32_16x16x32_bf16 v[92:95], v[188:191], a[172:175], v[92:95]
s_mov_b32 m0, s70
s_mov_b32 s64, s68
s_add_u32 s68, s68, 16384
v_mfma_f32_16x16x32_bf16 v[92:95], v[184:187], a[164:167], v[92:95]
s_waitcnt lgkmcnt(6)
ds_read_b128 v[176:179], v8 offset:12288
v_mfma_f32_16x16x32_bf16 v[96:99], v[144:147], a[160:163], v[96:99]
s_add_u32 s70, s70, 16384
s_cmp_ge_u32 s70, 163840
s_cselect_b32 s70, s80, s70
v_mfma_f32_16x16x32_bf16 v[96:99], v[148:151], a[168:171], v[96:99]
buffer_load_dwordx4 v4, s[24:27], s64 offen offset:0 sc1 lds
v_mfma_f32_16x16x32_bf16 v[100:103], v[148:151], a[172:175], v[100:103]
ds_read_b128 v[180:183], v8 offset:13312
v_mfma_f32_16x16x32_bf16 v[100:103], v[144:147], a[164:167], v[100:103]
s_waitcnt lgkmcnt(6) vmcnt(16)
ds_read_b128 v[184:187], v8 offset:14336
v_mfma_f32_16x16x32_bf16 v[120:123], v[152:155], a[176:179], v[120:123]
s_waitcnt vmcnt(15)
s_waitcnt vmcnt(13)
ds_read_b128 v[188:191], v8 offset:15360
v_mfma_f32_16x16x32_bf16 v[120:123], v[156:159], a[184:187], v[120:123]
s_barrier
v_mfma_f32_16x16x32_bf16 v[124:127], v[156:159], a[188:191], v[124:127]
buffer_load_dwordx4 v4, s[24:27], s64 offen offset:1024 sc1 lds
v_mfma_f32_16x16x32_bf16 v[124:127], v[152:155], a[180:183], v[124:127]
s_add_u32 s65, s77, 73728
s_waitcnt lgkmcnt(6)
ds_read_b128 v[144:147], v7 offset:0
v_mfma_f32_16x16x32_bf16 v[72:75], v[160:163], a[176:179], v[72:75]
s_add_u32 s91, s91, 16384
ds_read_b128 v[148:151], v7 offset:1024
v_mfma_f32_16x16x32_bf16 v[72:75], v[164:167], a[184:187], v[72:75]
buffer_load_dwordx4 v[64:67], v4, s[24:27], s65 offen offset:0 sc1
v_mfma_f32_16x16x32_bf16 v[76:79], v[164:167], a[188:191], v[76:79]
s_cmp_ge_u32 s91, 163840
s_cselect_b32 s91, 0, s91
ds_read_b128 v[152:155], v7 offset:2048
v_mfma_f32_16x16x32_bf16 v[76:79], v[160:163], a[180:183], v[76:79]
s_waitcnt lgkmcnt(7)
v_add_u32 v8, s91, v4
v_mfma_f32_16x16x32_bf16 v[80:83], v[168:171], a[176:179], v[80:83]
buffer_load_dwordx4 v4, s[24:27], s64 offen offset:2048 sc1 lds
v_mfma_f32_16x16x32_bf16 v[80:83], v[172:175], a[184:187], v[80:83]
ds_read_b128 v[156:159], v7 offset:3072
v_mfma_f32_16x16x32_bf16 v[84:87], v[172:175], a[188:191], v[84:87]
s_waitcnt lgkmcnt(6)
ds_read_b128 v[160:163], v7 offset:4096
v_mfma_f32_16x16x32_bf16 v[84:87], v[168:171], a[180:183], v[84:87]
buffer_load_dwordx4 v4, s[24:27], s64 offen offset:3072 sc1 lds
v_mfma_f32_16x16x32_bf16 v[88:91], v[176:179], a[176:179], v[88:91]
s_add_u32 s93, s81, 73728
ds_read_b128 v[164:167], v7 offset:5120
v_mfma_f32_16x16x32_bf16 v[88:91], v[180:183], a[184:187], v[88:91]
v_mfma_f32_16x16x32_bf16 v[92:95], v[180:183], a[188:191], v[92:95]
buffer_load_dwordx4 v[68:71], v4, s[24:27], s93 offen offset:0 sc1
v_mfma_f32_16x16x32_bf16 v[92:95], v[176:179], a[180:183], v[92:95]
s_waitcnt lgkmcnt(6)
ds_read_b128 v[168:171], v7 offset:6144
v_mfma_f32_16x16x32_bf16 v[96:99], v[184:187], a[176:179], v[96:99]
ds_read_b128 v[172:175], v7 offset:7168
v_mfma_f32_16x16x32_bf16 v[96:99], v[188:191], a[184:187], v[96:99]
v_mfma_f32_16x16x32_bf16 v[100:103], v[188:191], a[188:191], v[100:103]
ds_read_b128 v[176:179], v7 offset:8192
v_mfma_f32_16x16x32_bf16 v[100:103], v[184:187], a[180:183], v[100:103]
s_waitcnt lgkmcnt(7) vmcnt(16)
v_mfma_f32_16x16x32_bf16 v[120:123], v[144:147], v[32:35], v[120:123]
ds_read_b128 v[180:183], v7 offset:9216
v_mfma_f32_16x16x32_bf16 v[120:123], v[148:151], v[40:43], v[120:123]
s_waitcnt vmcnt(14)
v_mfma_f32_16x16x32_bf16 v[124:127], v[148:151], v[44:47], v[124:127]
ds_read_b128 v[184:187], v7 offset:10240
v_mfma_f32_16x16x32_bf16 v[124:127], v[144:147], v[36:39], v[124:127]
s_waitcnt lgkmcnt(7)
v_mfma_f32_16x16x32_bf16 v[72:75], v[152:155], v[32:35], v[72:75]
ds_read_b128 v[188:191], v7 offset:11264
v_mfma_f32_16x16x32_bf16 v[72:75], v[156:159], v[40:43], v[72:75]
v_mfma_f32_16x16x32_bf16 v[76:79], v[156:159], v[44:47], v[76:79]
ds_read_b128 v[144:147], v7 offset:12288
v_mfma_f32_16x16x32_bf16 v[76:79], v[152:155], v[36:39], v[76:79]
s_waitcnt lgkmcnt(7)
v_mfma_f32_16x16x32_bf16 v[80:83], v[160:163], v[32:35], v[80:83]
ds_read_b128 v[148:151], v7 offset:13312
v_mfma_f32_16x16x32_bf16 v[80:83], v[164:167], v[40:43], v[80:83]
v_mfma_f32_16x16x32_bf16 v[84:87], v[164:167], v[44:47], v[84:87]
ds_read_b128 v[152:155], v7 offset:14336
v_mfma_f32_16x16x32_bf16 v[84:87], v[160:163], v[36:39], v[84:87]
s_waitcnt lgkmcnt(7)
v_mfma_f32_16x16x32_bf16 v[88:91], v[168:171], v[32:35], v[88:91]
ds_read_b128 v[156:159], v7 offset:15360
v_mfma_f32_16x16x32_bf16 v[88:91], v[172:175], v[40:43], v[88:91]
s_add_u32 s91, s91, 16384
s_cmp_ge_u32 s91, 163840
s_cselect_b32 s91, 0, s91
v_mfma_f32_16x16x32_bf16 v[92:95], v[172:175], v[44:47], v[92:95]
ds_read_b128 v[160:163], v8 offset:0
v_add_u32 v7, s91, v4
v_mfma_f32_16x16x32_bf16 v[92:95], v[168:171], v[36:39], v[92:95]
s_waitcnt lgkmcnt(7)
v_mfma_f32_16x16x32_bf16 v[96:99], v[176:179], v[32:35], v[96:99]
ds_read_b128 v[164:167], v8 offset:1024
v_mfma_f32_16x16x32_bf16 v[96:99], v[180:183], v[40:43], v[96:99]
v_mfma_f32_16x16x32_bf16 v[100:103], v[180:183], v[44:47], v[100:103]
s_mov_b32 m0, s70
s_mov_b32 s64, s68
s_add_u32 s68, s68, 16384
v_mfma_f32_16x16x32_bf16 v[100:103], v[176:179], v[36:39], v[100:103]
s_waitcnt lgkmcnt(6) vmcnt(12)
s_waitcnt vmcnt(8)
ds_read_b128 v[168:171], v8 offset:2048
v_mfma_f32_16x16x32_bf16 v[120:123], v[184:187], v[48:51], v[120:123]
s_add_u32 s70, s70, 16384
s_cmp_ge_u32 s70, 163840
s_cselect_b32 s70, s80, s70
v_mfma_f32_16x16x32_bf16 v[120:123], v[188:191], v[56:59], v[120:123]
buffer_load_dwordx4 v4, s[24:27], s64 offen offset:0 sc1 lds
v_mfma_f32_16x16x32_bf16 v[124:127], v[188:191], v[60:63], v[124:127]
ds_read_b128 v[172:175], v8 offset:3072
v_mfma_f32_16x16x32_bf16 v[124:127], v[184:187], v[52:55], v[124:127]
s_waitcnt lgkmcnt(6)
ds_read_b128 v[176:179], v8 offset:4096
v_mfma_f32_16x16x32_bf16 v[72:75], v[144:147], v[48:51], v[72:75]
buffer_load_dwordx4 v4, s[24:27], s64 offen offset:1024 sc1 lds
v_mfma_f32_16x16x32_bf16 v[72:75], v[148:151], v[56:59], v[72:75]
ds_read_b128 v[180:183], v8 offset:5120
v_mfma_f32_16x16x32_bf16 v[76:79], v[148:151], v[60:63], v[76:79]
s_waitcnt lgkmcnt(6)
ds_read_b128 v[184:187], v8 offset:6144
v_mfma_f32_16x16x32_bf16 v[76:79], v[144:147], v[52:55], v[76:79]
buffer_load_dwordx4 v4, s[24:27], s64 offen offset:2048 sc1 lds
v_mfma_f32_16x16x32_bf16 v[80:83], v[152:155], v[48:51], v[80:83]
ds_read_b128 v[188:191], v8 offset:7168
v_mfma_f32_16x16x32_bf16 v[80:83], v[156:159], v[56:59], v[80:83]
v_mfma_f32_16x16x32_bf16 v[84:87], v[156:159], v[60:63], v[84:87]
buffer_load_dwordx4 v4, s[24:27], s64 offen offset:3072 sc1 lds
v_mfma_f32_16x16x32_bf16 v[84:87], v[152:155], v[52:55], v[84:87]
s_waitcnt lgkmcnt(6)
ds_read_b128 v[144:147], v8 offset:8192
v_mfma_f32_16x16x32_bf16 v[88:91], v[160:163], v[48:51], v[88:91]
s_mov_b32 m0, s70
s_mov_b32 s64, s68
s_add_u32 s68, s68, 16384
v_mfma_f32_16x16x32_bf16 v[88:91], v[164:167], v[56:59], v[88:91]
s_waitcnt lgkmcnt(5)
ds_read_b128 v[148:151], v8 offset:9216
v_mfma_f32_16x16x32_bf16 v[92:95], v[164:167], v[60:63], v[92:95]
s_add_u32 s70, s70, 16384
s_cmp_ge_u32 s70, 163840
s_cselect_b32 s70, s80, s70
v_mfma_f32_16x16x32_bf16 v[92:95], v[160:163], v[52:55], v[92:95]
buffer_load_dwordx4 v4, s[24:27], s64 offen offset:0 sc1 lds
v_mfma_f32_16x16x32_bf16 v[96:99], v[168:171], v[48:51], v[96:99]
ds_read_b128 v[152:155], v8 offset:10240
v_mfma_f32_16x16x32_bf16 v[96:99], v[172:175], v[56:59], v[96:99]
ds_read_b128 v[156:159], v8 offset:11264
v_mfma_f32_16x16x32_bf16 v[100:103], v[172:175], v[60:63], v[100:103]
buffer_load_dwordx4 v4, s[24:27], s64 offen offset:1024 sc1 lds
v_mfma_f32_16x16x32_bf16 v[100:103], v[168:171], v[52:55], v[100:103]
s_waitcnt lgkmcnt(6) vmcnt(9)
ds_read_b128 v[160:163], v8 offset:12288
v_mfma_f32_16x16x32_bf16 v[120:123], v[176:179], v[64:67], v[120:123]
s_waitcnt vmcnt(6)
ds_read_b128 v[164:167], v8 offset:13312
v_mfma_f32_16x16x32_bf16 v[124:127], v[176:179], v[68:71], v[124:127]
buffer_load_dwordx4 v4, s[24:27], s64 offen offset:2048 sc1 lds
v_mfma_f32_16x16x32_bf16 v[72:75], v[180:183], v[64:67], v[72:75]
ds_read_b128 v[168:171], v8 offset:14336
v_mfma_f32_16x16x32_bf16 v[76:79], v[180:183], v[68:71], v[76:79]
s_waitcnt lgkmcnt(7)
v_mfma_f32_16x16x32_bf16 v[80:83], v[184:187], v[64:67], v[80:83]
s_waitcnt vmcnt(8)
ds_read_b128 v[172:175], v8 offset:15360
v_mfma_f32_16x16x32_bf16 v[84:87], v[184:187], v[68:71], v[84:87]
s_barrier
v_mfma_f32_16x16x32_bf16 v[88:91], v[188:191], v[64:67], v[88:91]
buffer_load_dwordx4 v4, s[24:27], s64 offen offset:3072 sc1 lds
v_mfma_f32_16x16x32_bf16 v[92:95], v[188:191], v[68:71], v[92:95]
s_waitcnt lgkmcnt(6)
s_add_u32 s91, s91, 16384
ds_read_b128 v[176:179], v7 offset:0
v_mfma_f32_16x16x32_bf16 v[96:99], v[144:147], v[64:67], v[96:99]
ds_read_b128 v[180:183], v7 offset:1024
v_cvt_pk_bf16_f32 v228, v120, v121
v_mfma_f32_16x16x32_bf16 v[100:103], v[144:147], v[68:71], v[100:103]
s_cmp_ge_u32 s91, 163840
s_cselect_b32 s91, 0, s91
v_cvt_pk_bf16_f32 v229, v122, v123
v_mfma_f32_16x16x32_bf16 v[104:107], v[148:151], a[224:227], v[104:107]
s_waitcnt lgkmcnt(6)
ds_read_b128 v[184:187], v7 offset:2048
v_cvt_pk_bf16_f32 v230, v124, v125
v_mfma_f32_16x16x32_bf16 v[104:107], v[152:155], a[232:235], v[104:107]
v_cvt_pk_bf16_f32 v231, v126, v127
v_add_u32 v8, s91, v4
v_mfma_f32_16x16x32_bf16 v[108:111], v[152:155], a[236:239], v[108:111]
buffer_store_dwordx4 v[228:231], v4, s[24:27], s55 offen offset:0 sc1
v_mfma_f32_16x16x32_bf16 v[108:111], v[148:151], a[228:231], v[108:111]
ds_read_b128 v[188:191], v7 offset:3072
v_cvt_pk_bf16_f32 v72, v72, v73
v_mfma_f32_16x16x32_bf16 v[112:115], v[156:159], a[224:227], v[112:115]
s_waitcnt lgkmcnt(6)
ds_read_b128 v[144:147], v7 offset:4096
v_cvt_pk_bf16_f32 v73, v74, v75
v_mfma_f32_16x16x32_bf16 v[112:115], v[160:163], a[232:235], v[112:115]
v_cvt_pk_bf16_f32 v74, v80, v81
v_mfma_f32_16x16x32_bf16 v[116:119], v[160:163], a[236:239], v[116:119]
ds_read_b128 v[148:151], v7 offset:5120
v_cvt_pk_bf16_f32 v75, v82, v83
v_mfma_f32_16x16x32_bf16 v[116:119], v[156:159], a[228:231], v[116:119]
buffer_store_dwordx4 v[72:75], v4, s[24:27], s52 offen offset:0 sc1
v_mfma_f32_16x16x32_bf16 v[104:107], v[164:167], a[240:243], v[104:107]
s_waitcnt lgkmcnt(6)
ds_read_b128 v[152:155], v7 offset:6144
v_cvt_pk_bf16_f32 v76, v76, v77
v_mfma_f32_16x16x32_bf16 v[104:107], v[168:171], a[248:251], v[104:107]
v_cvt_pk_bf16_f32 v77, v78, v79
v_mfma_f32_16x16x32_bf16 v[108:111], v[168:171], a[252:255], v[108:111]
ds_read_b128 v[156:159], v7 offset:7168
v_cvt_pk_bf16_f32 v78, v84, v85
v_mfma_f32_16x16x32_bf16 v[108:111], v[164:167], a[244:247], v[108:111]
s_waitcnt lgkmcnt(6)
v_cvt_pk_bf16_f32 v79, v86, v87
v_mfma_f32_16x16x32_bf16 v[112:115], v[172:175], a[240:243], v[112:115]
buffer_store_dwordx4 v[76:79], v4, s[24:27], s52 offen offset:1024 sc1
v_mfma_f32_16x16x32_bf16 v[112:115], v[176:179], a[248:251], v[112:115]
ds_read_b128 v[160:163], v7 offset:8192
v_cvt_pk_bf16_f32 v88, v88, v89
v_mfma_f32_16x16x32_bf16 v[116:119], v[176:179], a[252:255], v[116:119]
ds_read_b128 v[164:167], v7 offset:9216
v_cvt_pk_bf16_f32 v89, v90, v91
v_mfma_f32_16x16x32_bf16 v[116:119], v[172:175], a[244:247], v[116:119]
v_cvt_pk_bf16_f32 v90, v96, v97
v_mfma_f32_16x16x32_bf16 v[104:107], v[180:183], a[96:99], v[104:107]
s_waitcnt lgkmcnt(6)
ds_read_b128 v[168:171], v7 offset:10240
v_cvt_pk_bf16_f32 v91, v98, v99
v_mfma_f32_16x16x32_bf16 v[104:107], v[184:187], a[104:107], v[104:107]
buffer_store_dwordx4 v[88:91], v4, s[24:27], s53 offen offset:0 sc1
v_mfma_f32_16x16x32_bf16 v[108:111], v[184:187], a[108:111], v[108:111]
ds_read_b128 v[172:175], v7 offset:11264
v_cvt_pk_bf16_f32 v92, v92, v93
v_mfma_f32_16x16x32_bf16 v[108:111], v[180:183], a[100:103], v[108:111]
v_cvt_pk_bf16_f32 v93, v94, v95
v_mfma_f32_16x16x32_bf16 v[112:115], v[188:191], a[96:99], v[112:115]
s_waitcnt lgkmcnt(6)
ds_read_b128 v[176:179], v7 offset:12288
v_cvt_pk_bf16_f32 v94, v100, v101
v_mfma_f32_16x16x32_bf16 v[112:115], v[144:147], a[104:107], v[112:115]
v_cvt_pk_bf16_f32 v95, v102, v103
v_mfma_f32_16x16x32_bf16 v[116:119], v[144:147], a[108:111], v[116:119]
buffer_store_dwordx4 v[92:95], v4, s[24:27], s53 offen offset:1024 sc1
v_mfma_f32_16x16x32_bf16 v[116:119], v[188:191], a[100:103], v[116:119]
ds_read_b128 v[180:183], v7 offset:13312
v_mfma_f32_16x16x32_bf16 v[104:107], v[148:151], a[112:115], v[104:107]
s_waitcnt lgkmcnt(6)
ds_read_b128 v[184:187], v7 offset:14336
v_mfma_f32_16x16x32_bf16 v[104:107], v[152:155], a[120:123], v[104:107]
v_mfma_f32_16x16x32_bf16 v[108:111], v[152:155], a[124:127], v[108:111]
ds_read_b128 v[188:191], v7 offset:15360
v_mfma_f32_16x16x32_bf16 v[108:111], v[148:151], a[116:119], v[108:111]
s_add_u32 s91, s91, 16384
s_cmp_ge_u32 s91, 163840
s_cselect_b32 s91, 0, s91
v_mfma_f32_16x16x32_bf16 v[112:115], v[156:159], a[112:115], v[112:115]
s_waitcnt lgkmcnt(6)
ds_read_b128 v[144:147], v8 offset:0
v_add_u32 v7, s91, v4
v_mfma_f32_16x16x32_bf16 v[112:115], v[160:163], a[120:123], v[112:115]
v_mfma_f32_16x16x32_bf16 v[116:119], v[160:163], a[124:127], v[116:119]
ds_read_b128 v[148:151], v8 offset:1024
v_mfma_f32_16x16x32_bf16 v[116:119], v[156:159], a[116:119], v[116:119]
s_waitcnt lgkmcnt(6)
v_mfma_f32_16x16x32_bf16 v[104:107], v[164:167], a[128:131], v[104:107]
s_mov_b32 m0, s70
s_mov_b32 s64, s68
s_add_u32 s68, s68, 16384
v_mfma_f32_16x16x32_bf16 v[104:107], v[168:171], a[136:139], v[104:107]
ds_read_b128 v[152:155], v8 offset:2048
v_mfma_f32_16x16x32_bf16 v[108:111], v[168:171], a[140:143], v[108:111]
s_add_u32 s70, s70, 16384
s_cmp_ge_u32 s70, 163840
s_cselect_b32 s70, s80, s70
v_mfma_f32_16x16x32_bf16 v[108:111], v[164:167], a[132:135], v[108:111]
buffer_load_dwordx4 v4, s[24:27], s64 offen offset:0 sc1 lds
v_mfma_f32_16x16x32_bf16 v[112:115], v[172:175], a[128:131], v[112:115]
s_waitcnt lgkmcnt(5)
ds_read_b128 v[156:159], v8 offset:3072
v_mfma_f32_16x16x32_bf16 v[112:115], v[176:179], a[136:139], v[112:115]
ds_read_b128 v[160:163], v8 offset:4096
v_mfma_f32_16x16x32_bf16 v[116:119], v[176:179], a[140:143], v[116:119]
buffer_load_dwordx4 v4, s[24:27], s64 offen offset:1024 sc1 lds
v_mfma_f32_16x16x32_bf16 v[116:119], v[172:175], a[132:135], v[116:119]
ds_read_b128 v[164:167], v8 offset:5120
v_mfma_f32_16x16x32_bf16 v[104:107], v[180:183], a[144:147], v[104:107]
s_waitcnt lgkmcnt(6)
ds_read_b128 v[168:171], v8 offset:6144
v_mfma_f32_16x16x32_bf16 v[104:107], v[184:187], a[152:155], v[104:107]
buffer_load_dwordx4 v4, s[24:27], s64 offen offset:2048 sc1 lds
v_mfma_f32_16x16x32_bf16 v[108:111], v[184:187], a[156:159], v[108:111]
ds_read_b128 v[172:175], v8 offset:7168
v_mfma_f32_16x16x32_bf16 v[108:111], v[180:183], a[148:151], v[108:111]
s_waitcnt lgkmcnt(6)
v_mfma_f32_16x16x32_bf16 v[112:115], v[188:191], a[144:147], v[112:115]
buffer_load_dwordx4 v4, s[24:27], s64 offen offset:3072 sc1 lds
v_mfma_f32_16x16x32_bf16 v[112:115], v[144:147], a[152:155], v[112:115]
ds_read_b128 v[176:179], v8 offset:8192
v_mfma_f32_16x16x32_bf16 v[116:119], v[144:147], a[156:159], v[116:119]
s_mov_b32 m0, s70
s_mov_b32 s64, s68
s_add_u32 s68, s68, 16384
v_mfma_f32_16x16x32_bf16 v[116:119], v[188:191], a[148:151], v[116:119]
s_waitcnt lgkmcnt(5)
ds_read_b128 v[180:183], v8 offset:9216
v_mfma_f32_16x16x32_bf16 v[104:107], v[148:151], a[160:163], v[104:107]
s_add_u32 s70, s70, 16384
s_cmp_ge_u32 s70, 163840
s_cselect_b32 s70, s80, s70
v_mfma_f32_16x16x32_bf16 v[104:107], v[152:155], a[168:171], v[104:107]
buffer_load_dwordx4 v4, s[24:27], s64 offen offset:0 sc1 lds
v_mfma_f32_16x16x32_bf16 v[108:111], v[152:155], a[172:175], v[108:111]
ds_read_b128 v[184:187], v8 offset:10240
v_mfma_f32_16x16x32_bf16 v[108:111], v[148:151], a[164:167], v[108:111]
s_waitcnt lgkmcnt(5)
ds_read_b128 v[188:191], v8 offset:11264
v_mfma_f32_16x16x32_bf16 v[112:115], v[156:159], a[160:163], v[112:115]
buffer_load_dwordx4 v4, s[24:27], s64 offen offset:1024 sc1 lds
v_mfma_f32_16x16x32_bf16 v[112:115], v[160:163], a[168:171], v[112:115]
ds_read_b128 v[144:147], v8 offset:12288
v_mfma_f32_16x16x32_bf16 v[116:119], v[160:163], a[172:175], v[116:119]
ds_read_b128 v[148:151], v8 offset:13312
v_mfma_f32_16x16x32_bf16 v[116:119], v[156:159], a[164:167], v[116:119]
buffer_load_dwordx4 v4, s[24:27], s64 offen offset:2048 sc1 lds
v_mfma_f32_16x16x32_bf16 v[104:107], v[164:167], a[176:179], v[104:107]
s_waitcnt lgkmcnt(6)
ds_read_b128 v[152:155], v8 offset:14336
v_mfma_f32_16x16x32_bf16 v[104:107], v[168:171], a[184:187], v[104:107]
v_mfma_f32_16x16x32_bf16 v[108:111], v[168:171], a[188:191], v[108:111]
s_waitcnt vmcnt(12) lgkmcnt(5)
ds_read_b128 v[156:159], v8 offset:15360
v_mfma_f32_16x16x32_bf16 v[108:111], v[164:167], a[180:183], v[108:111]
s_barrier
v_mfma_f32_16x16x32_bf16 v[112:115], v[172:175], a[176:179], v[112:115]
buffer_load_dwordx4 v4, s[24:27], s64 offen offset:3072 sc1 lds
v_mfma_f32_16x16x32_bf16 v[112:115], v[176:179], a[184:187], v[112:115]
s_add_u32 s91, s91, 16384
ds_read_b128 v[160:163], v7 offset:0
v_mfma_f32_16x16x32_bf16 v[116:119], v[176:179], a[188:191], v[116:119]
s_cmp_ge_u32 s91, 163840
s_cselect_b32 s91, 0, s91
ds_read_b128 v[164:167], v7 offset:1024
v_mfma_f32_16x16x32_bf16 v[116:119], v[172:175], a[180:183], v[116:119]
v_add_u32 v8, s91, v4
v_mfma_f32_16x16x32_bf16 v[104:107], v[180:183], v[32:35], v[104:107]
s_waitcnt lgkmcnt(6)
ds_read_b128 v[168:171], v7 offset:2048
v_mfma_f32_16x16x32_bf16 v[104:107], v[184:187], v[40:43], v[104:107]
v_mfma_f32_16x16x32_bf16 v[108:111], v[184:187], v[44:47], v[108:111]
ds_read_b128 v[172:175], v7 offset:3072
v_mfma_f32_16x16x32_bf16 v[108:111], v[180:183], v[36:39], v[108:111]
v_mfma_f32_16x16x32_bf16 v[112:115], v[188:191], v[32:35], v[112:115]
s_waitcnt lgkmcnt(6)
ds_read_b128 v[176:179], v7 offset:4096
v_mfma_f32_16x16x32_bf16 v[112:115], v[144:147], v[40:43], v[112:115]
v_mfma_f32_16x16x32_bf16 v[116:119], v[144:147], v[44:47], v[116:119]
ds_read_b128 v[180:183], v7 offset:5120
v_mfma_f32_16x16x32_bf16 v[116:119], v[188:191], v[36:39], v[116:119]
v_mfma_f32_16x16x32_bf16 v[104:107], v[148:151], v[48:51], v[104:107]
s_waitcnt vmcnt(8) lgkmcnt(6)
ds_read_b128 v[184:187], v7 offset:6144
v_mfma_f32_16x16x32_bf16 v[104:107], v[152:155], v[56:59], v[104:107]
buffer_atomic_add v1, v0, s[24:27], s73 offen offset:0 sc1
v_mfma_f32_16x16x32_bf16 v[108:111], v[152:155], v[60:63], v[108:111]
ds_read_b128 v[188:191], v7 offset:7168
v_mfma_f32_16x16x32_bf16 v[108:111], v[148:151], v[52:55], v[108:111]
v_mfma_f32_16x16x32_bf16 v[112:115], v[156:159], v[48:51], v[112:115]
s_waitcnt lgkmcnt(6)
ds_read_b128 v[144:147], v7 offset:8192
v_mfma_f32_16x16x32_bf16 v[112:115], v[160:163], v[56:59], v[112:115]
v_mfma_f32_16x16x32_bf16 v[116:119], v[160:163], v[60:63], v[116:119]
ds_read_b128 v[148:151], v7 offset:9216
v_mfma_f32_16x16x32_bf16 v[116:119], v[156:159], v[52:55], v[116:119]
v_mfma_f32_16x16x32_bf16 v[104:107], v[164:167], v[64:67], v[104:107]
ds_read_b128 v[152:155], v7 offset:10240
v_mfma_f32_16x16x32_bf16 v[108:111], v[164:167], v[68:71], v[108:111]
s_waitcnt lgkmcnt(7)
v_mfma_f32_16x16x32_bf16 v[112:115], v[168:171], v[64:67], v[112:115]
ds_read_b128 v[156:159], v7 offset:11264
v_mfma_f32_16x16x32_bf16 v[116:119], v[168:171], v[68:71], v[116:119]
v_mfma_f32_16x16x32_bf16 v[128:131], v[172:175], a[0:3], 0
s_waitcnt lgkmcnt(6)
ds_read_b128 v[160:163], v7 offset:12288
v_mfma_f32_16x16x32_bf16 v[128:131], v[176:179], a[8:11], v[128:131]
v_mfma_f32_16x16x32_bf16 v[132:135], v[176:179], a[12:15], 0
ds_read_b128 v[164:167], v7 offset:13312
v_mfma_f32_16x16x32_bf16 v[132:135], v[172:175], a[4:7], v[132:135]
v_mfma_f32_16x16x32_bf16 v[136:139], v[180:183], a[0:3], 0
s_waitcnt lgkmcnt(6)
ds_read_b128 v[168:171], v7 offset:14336
v_mfma_f32_16x16x32_bf16 v[136:139], v[184:187], a[8:11], v[136:139]
v_cvt_pk_bf16_f32 v104, v104, v105
v_mfma_f32_16x16x32_bf16 v[140:143], v[184:187], a[12:15], 0
ds_read_b128 v[172:175], v7 offset:15360
v_cvt_pk_bf16_f32 v105, v106, v107
v_mfma_f32_16x16x32_bf16 v[140:143], v[180:183], a[4:7], v[140:143]
s_add_u32 s91, s91, 16384
v_cvt_pk_bf16_f32 v106, v112, v113
v_mfma_f32_16x16x32_bf16 v[128:131], v[188:191], a[16:19], v[128:131]
s_waitcnt lgkmcnt(6)
ds_read_b128 v[176:179], v8 offset:0
v_cvt_pk_bf16_f32 v107, v114, v115
v_mfma_f32_16x16x32_bf16 v[128:131], v[144:147], a[24:27], v[128:131]
buffer_store_dwordx4 v[104:107], v4, s[24:27], s54 offen offset:0 sc1
v_mfma_f32_16x16x32_bf16 v[132:135], v[144:147], a[28:31], v[132:135]
ds_read_b128 v[180:183], v8 offset:1024
v_cvt_pk_bf16_f32 v108, v108, v109
v_mfma_f32_16x16x32_bf16 v[132:135], v[188:191], a[20:23], v[132:135]
s_cmp_ge_u32 s91, 163840
s_cselect_b32 s91, 0, s91
v_cvt_pk_bf16_f32 v109, v110, v111
v_mfma_f32_16x16x32_bf16 v[136:139], v[148:151], a[16:19], v[136:139]
s_waitcnt lgkmcnt(6)
ds_read_b128 v[184:187], v8 offset:2048
v_cvt_pk_bf16_f32 v110, v116, v117
v_mfma_f32_16x16x32_bf16 v[136:139], v[152:155], a[24:27], v[136:139]
s_waitcnt lgkmcnt(5)
v_cvt_pk_bf16_f32 v111, v118, v119
v_add_u32 v7, s91, v4
v_mfma_f32_16x16x32_bf16 v[140:143], v[152:155], a[28:31], v[140:143]
buffer_store_dwordx4 v[108:111], v4, s[24:27], s54 offen offset:1024 sc1
v_mfma_f32_16x16x32_bf16 v[140:143], v[148:151], a[20:23], v[140:143]
s_mov_b32 m0, s70
s_mov_b32 s64, s68
s_add_u32 s68, s68, 16384
v_mfma_f32_16x16x32_bf16 v[128:131], v[156:159], a[32:35], v[128:131]
s_cmp_lt_u32 s3, 3
s_cselect_b32 s68, s64, 2147418112
ds_read_b128 v[188:191], v8 offset:3072
v_mfma_f32_16x16x32_bf16 v[128:131], v[160:163], a[40:43], v[128:131]
buffer_load_dwordx4 v4, s[24:27], s64 offen offset:0 sc1 lds
v_mfma_f32_16x16x32_bf16 v[132:135], v[160:163], a[44:47], v[132:135]
ds_read_b128 v[144:147], v8 offset:4096
v_mfma_f32_16x16x32_bf16 v[132:135], v[156:159], a[36:39], v[132:135]
s_waitcnt lgkmcnt(5)
ds_read_b128 v[148:151], v8 offset:5120
v_mfma_f32_16x16x32_bf16 v[136:139], v[164:167], a[32:35], v[136:139]
buffer_load_dwordx4 v4, s[24:27], s68 offen offset:1024 sc1 lds
v_mfma_f32_16x16x32_bf16 v[136:139], v[168:171], a[40:43], v[136:139]
ds_read_b128 v[152:155], v8 offset:6144
v_mfma_f32_16x16x32_bf16 v[140:143], v[168:171], a[44:47], v[140:143]
ds_read_b128 v[156:159], v8 offset:7168
v_mfma_f32_16x16x32_bf16 v[140:143], v[164:167], a[36:39], v[140:143]
buffer_load_dwordx4 v4, s[24:27], s68 offen offset:2048 sc1 lds
v_mfma_f32_16x16x32_bf16 v[128:131], v[172:175], a[48:51], v[128:131]
s_waitcnt lgkmcnt(6)
ds_read_b128 v[160:163], v8 offset:8192
v_mfma_f32_16x16x32_bf16 v[128:131], v[176:179], a[56:59], v[128:131]
v_mfma_f32_16x16x32_bf16 v[132:135], v[176:179], a[60:63], v[132:135]
buffer_load_dwordx4 v4, s[24:27], s68 offen offset:3072 sc1 lds
v_mfma_f32_16x16x32_bf16 v[132:135], v[172:175], a[52:55], v[132:135]
ds_read_b128 v[164:167], v8 offset:9216
v_mfma_f32_16x16x32_bf16 v[136:139], v[180:183], a[48:51], v[136:139]
s_waitcnt lgkmcnt(6)
ds_read_b128 v[168:171], v8 offset:10240
v_mfma_f32_16x16x32_bf16 v[136:139], v[184:187], a[56:59], v[136:139]
buffer_load_dword v12, v10, s[24:27], s73 offen sc1
v_mfma_f32_16x16x32_bf16 v[140:143], v[184:187], a[60:63], v[140:143]
ds_read_b128 v[172:175], v8 offset:11264
v_mfma_f32_16x16x32_bf16 v[140:143], v[180:183], a[52:55], v[140:143]
v_mfma_f32_16x16x32_bf16 v[128:131], v[188:191], a[64:67], v[128:131]
s_waitcnt lgkmcnt(6)
ds_read_b128 v[176:179], v8 offset:12288
v_mfma_f32_16x16x32_bf16 v[128:131], v[144:147], a[72:75], v[128:131]
v_mfma_f32_16x16x32_bf16 v[132:135], v[144:147], a[76:79], v[132:135]
ds_read_b128 v[180:183], v8 offset:13312
v_mfma_f32_16x16x32_bf16 v[132:135], v[188:191], a[68:71], v[132:135]
v_mfma_f32_16x16x32_bf16 v[136:139], v[148:151], a[64:67], v[136:139]
s_waitcnt lgkmcnt(6)
ds_read_b128 v[184:187], v8 offset:14336
v_mfma_f32_16x16x32_bf16 v[136:139], v[152:155], a[72:75], v[136:139]
v_mfma_f32_16x16x32_bf16 v[140:143], v[152:155], a[76:79], v[140:143]
s_waitcnt vmcnt(8)
ds_read_b128 v[188:191], v8 offset:15360
v_mfma_f32_16x16x32_bf16 v[140:143], v[148:151], a[68:71], v[140:143]
s_barrier
v_mfma_f32_16x16x32_bf16 v[128:131], v[156:159], a[80:83], v[128:131]
s_waitcnt lgkmcnt(6)
s_add_u32 s91, s91, 16384
ds_read_b128 v[144:147], v7 offset:0
v_mfma_f32_16x16x32_bf16 v[128:131], v[160:163], a[88:91], v[128:131]
s_cmp_ge_u32 s91, 163840
s_cselect_b32 s91, 0, s91
v_add_u32 v8, s91, v4
v_mfma_f32_16x16x32_bf16 v[132:135], v[160:163], a[92:95], v[132:135]
ds_read_b128 v[148:151], v7 offset:1024
v_mfma_f32_16x16x32_bf16 v[132:135], v[156:159], a[84:87], v[132:135]
v_mfma_f32_16x16x32_bf16 v[136:139], v[164:167], a[80:83], v[136:139]
s_waitcnt lgkmcnt(6)
ds_read_b128 v[152:155], v7 offset:2048
v_mfma_f32_16x16x32_bf16 v[136:139], v[168:171], a[88:91], v[136:139]
v_mfma_f32_16x16x32_bf16 v[140:143], v[168:171], a[92:95], v[140:143]
ds_read_b128 v[156:159], v7 offset:3072
v_mfma_f32_16x16x32_bf16 v[140:143], v[164:167], a[84:87], v[140:143]
L_PAD13:
s_cbranch_execz L_MAIN
v_mfma_f32_16x16x32_bf16 v[128:131], v[172:175], a[192:195], v[128:131]
s_waitcnt lgkmcnt(6)
ds_read_b128 v[160:163], v7 offset:4096
v_mfma_f32_16x16x32_bf16 v[128:131], v[176:179], a[200:203], v[128:131]
v_mfma_f32_16x16x32_bf16 v[132:135], v[176:179], a[204:207], v[132:135]
ds_read_b128 v[164:167], v7 offset:5120
v_mfma_f32_16x16x32_bf16 v[132:135], v[172:175], a[196:199], v[132:135]
v_mfma_f32_16x16x32_bf16 v[136:139], v[180:183], a[192:195], v[136:139]
s_waitcnt lgkmcnt(6)
ds_read_b128 v[168:171], v7 offset:6144
v_mfma_f32_16x16x32_bf16 v[136:139], v[184:187], a[200:203], v[136:139]
v_mfma_f32_16x16x32_bf16 v[140:143], v[184:187], a[204:207], v[140:143]
s_waitcnt vmcnt(5)
ds_read_b128 v[172:175], v7 offset:7168
v_mfma_f32_16x16x32_bf16 v[140:143], v[180:183], a[196:199], v[140:143]
buffer_atomic_add v1, v0, s[24:27], s73 offen offset:16 sc1
v_mfma_f32_16x16x32_bf16 v[128:131], v[188:191], a[208:211], v[128:131]
s_waitcnt lgkmcnt(6)
ds_read_b128 v[176:179], v7 offset:8192
v_mfma_f32_16x16x32_bf16 v[128:131], v[144:147], a[216:219], v[128:131]
v_mfma_f32_16x16x32_bf16 v[132:135], v[144:147], a[220:223], v[132:135]
ds_read_b128 v[180:183], v7 offset:9216
v_mfma_f32_16x16x32_bf16 v[132:135], v[188:191], a[212:215], v[132:135]
s_waitcnt vmcnt(1)
v_mfma_f32_16x16x32_bf16 v[136:139], v[148:151], a[208:211], v[136:139]
s_waitcnt lgkmcnt(6)
ds_read_b128 v[184:187], v7 offset:10240
v_cmp_gt_u32 vcc, 4, v12
v_mfma_f32_16x16x32_bf16 v[136:139], v[152:155], a[216:219], v[136:139]
v_mfma_f32_16x16x32_bf16 v[140:143], v[152:155], a[220:223], v[140:143]
ds_read_b128 v[188:191], v7 offset:11264
v_mfma_f32_16x16x32_bf16 v[140:143], v[148:151], a[212:215], v[140:143]
v_mfma_f32_16x16x32_bf16 v[128:131], v[156:159], a[224:227], v[128:131]
s_waitcnt lgkmcnt(6)
ds_read_b128 v[144:147], v7 offset:12288
v_mfma_f32_16x16x32_bf16 v[128:131], v[160:163], a[232:235], v[128:131]
s_cbranch_vccnz CK_P1
CK_P1_R:
v_mfma_f32_16x16x32_bf16 v[132:135], v[160:163], a[236:239], v[132:135]
ds_read_b128 v[148:151], v7 offset:13312
v_mfma_f32_16x16x32_bf16 v[132:135], v[156:159], a[228:231], v[132:135]
s_waitcnt lgkmcnt(6)
v_mfma_f32_16x16x32_bf16 v[136:139], v[164:167], a[224:227], v[136:139]
buffer_load_dwordx4 v[192:195], v4, s[24:27], s69 offen offset:0 sc1
v_mfma_f32_16x16x32_bf16 v[136:139], v[168:171], a[232:235], v[136:139]
ds_read_b128 v[152:155], v7 offset:14336
v_mfma_f32_16x16x32_bf16 v[140:143], v[168:171], a[236:239], v[140:143]
ds_read_b128 v[156:159], v7 offset:15360
v_mfma_f32_16x16x32_bf16 v[140:143], v[164:167], a[228:231], v[140:143]
buffer_load_dwordx4 v[196:199], v4, s[24:27], s69 offen offset:1024 sc1
v_mfma_f32_16x16x32_bf16 v[128:131], v[172:175], a[240:243], v[128:131]
s_waitcnt lgkmcnt(6)
s_add_u32 s91, s91, 16384
ds_read_b128 v[160:163], v8 offset:0
v_mfma_f32_16x16x32_bf16 v[128:131], v[176:179], a[248:251], v[128:131]
s_cmp_ge_u32 s91, 163840
s_cselect_b32 s91, 0, s91
v_add_u32 v7, s91, v4
v_mfma_f32_16x16x32_bf16 v[132:135], v[176:179], a[252:255], v[132:135]
buffer_load_dwordx4 v[200:203], v4, s[24:27], s69 offen offset:2048 sc1
v_mfma_f32_16x16x32_bf16 v[132:135], v[172:175], a[244:247], v[132:135]
ds_read_b128 v[164:167], v8 offset:1024
v_mfma_f32_16x16x32_bf16 v[136:139], v[180:183], a[240:243], v[136:139]
s_waitcnt lgkmcnt(6)
ds_read_b128 v[168:171], v8 offset:2048
v_mfma_f32_16x16x32_bf16 v[136:139], v[184:187], a[248:251], v[136:139]
buffer_load_dwordx4 v[204:207], v4, s[24:27], s69 offen offset:3072 sc1
v_mfma_f32_16x16x32_bf16 v[140:143], v[184:187], a[252:255], v[140:143]
ds_read_b128 v[172:175], v8 offset:3072
v_mfma_f32_16x16x32_bf16 v[140:143], v[180:183], a[244:247], v[140:143]
s_waitcnt lgkmcnt(6)
v_mfma_f32_16x16x32_bf16 v[128:131], v[188:191], a[96:99], v[128:131]
buffer_load_dwordx4 v[208:211], v4, s[24:27], s71 offen offset:0 sc1
v_mfma_f32_16x16x32_bf16 v[128:131], v[144:147], a[104:107], v[128:131]
ds_read_b128 v[176:179], v8 offset:4096
v_mfma_f32_16x16x32_bf16 v[132:135], v[144:147], a[108:111], v[132:135]
ds_read_b128 v[180:183], v8 offset:5120
v_mfma_f32_16x16x32_bf16 v[132:135], v[188:191], a[100:103], v[132:135]
buffer_load_dwordx4 v[212:215], v4, s[24:27], s71 offen offset:1024 sc1
v_mfma_f32_16x16x32_bf16 v[136:139], v[148:151], a[96:99], v[136:139]
s_waitcnt lgkmcnt(6)
ds_read_b128 v[184:187], v8 offset:6144
v_mfma_f32_16x16x32_bf16 v[136:139], v[152:155], a[104:107], v[136:139]
v_mfma_f32_16x16x32_bf16 v[140:143], v[152:155], a[108:111], v[140:143]
buffer_load_dwordx4 v[216:219], v4, s[24:27], s71 offen offset:2048 sc1
v_mfma_f32_16x16x32_bf16 v[140:143], v[148:151], a[100:103], v[140:143]
ds_read_b128 v[188:191], v8 offset:7168
v_mfma_f32_16x16x32_bf16 v[128:131], v[156:159], a[112:115], v[128:131]
s_waitcnt lgkmcnt(6)
ds_read_b128 v[144:147], v8 offset:8192
v_mfma_f32_16x16x32_bf16 v[128:131], v[160:163], a[120:123], v[128:131]
v_mfma_f32_16x16x32_bf16 v[132:135], v[160:163], a[124:127], v[132:135]
ds_read_b128 v[148:151], v8 offset:9216
v_mfma_f32_16x16x32_bf16 v[132:135], v[156:159], a[116:119], v[132:135]
v_mfma_f32_16x16x32_bf16 v[136:139], v[164:167], a[112:115], v[136:139]
s_waitcnt lgkmcnt(6)
ds_read_b128 v[152:155], v8 offset:10240
v_mfma_f32_16x16x32_bf16 v[136:139], v[168:171], a[120:123], v[136:139]
v_mfma_f32_16x16x32_bf16 v[140:143], v[168:171], a[124:127], v[140:143]
ds_read_b128 v[156:159], v8 offset:11264
v_mfma_f32_16x16x32_bf16 v[140:143], v[164:167], a[116:119], v[140:143]
v_mfma_f32_16x16x32_bf16 v[128:131], v[172:175], a[128:131], v[128:131]
s_waitcnt lgkmcnt(6)
ds_read_b128 v[160:163], v8 offset:12288
v_mfma_f32_16x16x32_bf16 v[128:131], v[176:179], a[136:139], v[128:131]
v_mfma_f32_16x16x32_bf16 v[132:135], v[176:179], a[140:143], v[132:135]
ds_read_b128 v[164:167], v8 offset:13312
v_mfma_f32_16x16x32_bf16 v[132:135], v[172:175], a[132:135], v[132:135]
v_mfma_f32_16x16x32_bf16 v[136:139], v[180:183], a[128:131], v[136:139]
s_waitcnt lgkmcnt(6)
ds_read_b128 v[168:171], v8 offset:14336
v_mfma_f32_16x16x32_bf16 v[136:139], v[184:187], a[136:139], v[136:139]
v_mfma_f32_16x16x32_bf16 v[140:143], v[184:187], a[140:143], v[140:143]
s_waitcnt vmcnt(9)
ds_read_b128 v[172:175], v8 offset:15360
v_mfma_f32_16x16x32_bf16 v[140:143], v[180:183], a[132:135], v[140:143]
s_barrier
v_mfma_f32_16x16x32_bf16 v[128:131], v[188:191], a[144:147], v[128:131]
s_waitcnt lgkmcnt(6)
ds_read_b128 v[176:179], v7 offset:0
v_mfma_f32_16x16x32_bf16 v[128:131], v[144:147], a[152:155], v[128:131]
v_mfma_f32_16x16x32_bf16 v[132:135], v[144:147], a[156:159], v[132:135]
ds_read_b128 v[180:183], v7 offset:1024
v_mfma_f32_16x16x32_bf16 v[132:135], v[188:191], a[148:151], v[132:135]
v_mfma_f32_16x16x32_bf16 v[136:139], v[148:151], a[144:147], v[136:139]
s_waitcnt lgkmcnt(6)
ds_read_b128 v[184:187], v7 offset:2048
v_mfma_f32_16x16x32_bf16 v[136:139], v[152:155], a[152:155], v[136:139]
v_mfma_f32_16x16x32_bf16 v[140:143], v[152:155], a[156:159], v[140:143]
ds_read_b128 v[188:191], v7 offset:3072
v_mfma_f32_16x16x32_bf16 v[140:143], v[148:151], a[148:151], v[140:143]
v_mfma_f32_16x16x32_bf16 v[128:131], v[156:159], a[160:163], v[128:131]
s_waitcnt lgkmcnt(6)
ds_read_b128 v[144:147], v7 offset:4096
v_mfma_f32_16x16x32_bf16 v[128:131], v[160:163], a[168:171], v[128:131]
v_mfma_f32_16x16x32_bf16 v[132:135], v[160:163], a[172:175], v[132:135]
ds_read_b128 v[148:151], v7 offset:5120
v_mfma_f32_16x16x32_bf16 v[132:135], v[156:159], a[164:167], v[132:135]
v_mfma_f32_16x16x32_bf16 v[136:139], v[164:167], a[160:163], v[136:139]
s_waitcnt lgkmcnt(6)
ds_read_b128 v[152:155], v7 offset:6144
v_mfma_f32_16x16x32_bf16 v[136:139], v[168:171], a[168:171], v[136:139]
v_mfma_f32_16x16x32_bf16 v[140:143], v[168:171], a[172:175], v[140:143]
ds_read_b128 v[156:159], v7 offset:7168
v_mfma_f32_16x16x32_bf16 v[140:143], v[164:167], a[164:167], v[140:143]
v_mfma_f32_16x16x32_bf16 v[128:131], v[172:175], a[176:179], v[128:131]
s_waitcnt lgkmcnt(6)
ds_read_b128 v[160:163], v7 offset:8192
v_mfma_f32_16x16x32_bf16 v[128:131], v[176:179], a[184:187], v[128:131]
v_mfma_f32_16x16x32_bf16 v[132:135], v[176:179], a[188:191], v[132:135]
ds_read_b128 v[164:167], v7 offset:9216
v_mfma_f32_16x16x32_bf16 v[132:135], v[172:175], a[180:183], v[132:135]
v_mfma_f32_16x16x32_bf16 v[136:139], v[180:183], a[176:179], v[136:139]
s_waitcnt lgkmcnt(6)
ds_read_b128 v[168:171], v7 offset:10240
v_mfma_f32_16x16x32_bf16 v[136:139], v[184:187], a[184:187], v[136:139]
v_mfma_f32_16x16x32_bf16 v[140:143], v[184:187], a[188:191], v[140:143]
ds_read_b128 v[172:175], v7 offset:11264
v_mfma_f32_16x16x32_bf16 v[140:143], v[180:183], a[180:183], v[140:143]
s_waitcnt lgkmcnt(6)
v_mfma_f32_16x16x32_bf16 v[128:131], v[188:191], v[32:35], v[128:131]
buffer_load_dword v12, v10, s[24:27], s73 offen offset:16 sc1
v_mfma_f32_16x16x32_bf16 v[128:131], v[144:147], v[40:43], v[128:131]
ds_read_b128 v[176:179], v7 offset:12288
v_mfma_f32_16x16x32_bf16 v[132:135], v[144:147], v[44:47], v[132:135]
v_mfma_f32_16x16x32_bf16 v[132:135], v[188:191], v[36:39], v[132:135]
v_mfma_f32_16x16x32_bf16 v[136:139], v[148:151], v[32:35], v[136:139]
s_waitcnt lgkmcnt(5)
v_mfma_f32_16x16x32_bf16 v[136:139], v[152:155], v[40:43], v[136:139]
v_mfma_f32_16x16x32_bf16 v[140:143], v[152:155], v[44:47], v[140:143]
v_mfma_f32_16x16x32_bf16 v[140:143], v[148:151], v[36:39], v[140:143]
v_mfma_f32_16x16x32_bf16 v[128:131], v[156:159], v[48:51], v[128:131]
s_waitcnt lgkmcnt(3)
v_mfma_f32_16x16x32_bf16 v[128:131], v[160:163], v[56:59], v[128:131]
v_mfma_f32_16x16x32_bf16 v[132:135], v[160:163], v[60:63], v[132:135]
v_mfma_f32_16x16x32_bf16 v[132:135], v[156:159], v[52:55], v[132:135]
v_mfma_f32_16x16x32_bf16 v[136:139], v[164:167], v[48:51], v[136:139]
s_waitcnt lgkmcnt(1)
v_mfma_f32_16x16x32_bf16 v[136:139], v[168:171], v[56:59], v[136:139]
v_mfma_f32_16x16x32_bf16 v[140:143], v[168:171], v[60:63], v[140:143]
v_mfma_f32_16x16x32_bf16 v[140:143], v[164:167], v[52:55], v[140:143]
v_mfma_f32_16x16x32_bf16 v[128:131], v[172:175], v[64:67], v[128:131]
v_mfma_f32_16x16x32_bf16 v[132:135], v[172:175], v[68:71], v[132:135]
s_waitcnt lgkmcnt(0)
v_mfma_f32_16x16x32_bf16 v[136:139], v[176:179], v[64:67], v[136:139]
v_mfma_f32_16x16x32_bf16 v[140:143], v[176:179], v[68:71], v[140:143]
s_waitcnt vmcnt(0)
v_cmp_gt_u32 vcc, 4, v12
s_nop 4
s_cbranch_vccnz CK_P2
CK_P2_R:
buffer_load_dwordx4 v[220:223], v4, s[24:27], s83 offen offset:0 sc1
buffer_load_dwordx4 v[224:227], v4, s[24:27], s83 offen offset:1024 sc1
s_and_b32 s54, s3, 1
s_mul_i32 s54, s54, 18432
s_mul_i32 s55, s86, 288
s_add_u32 s54, s54, s55
s_add_u32 s54, s54, 256
s_sub_u32 s55, 63, s72
s_mul_i32 s55, s55, 36864
s_add_u32 s55, s55, s54
s_mul_i32 s52, s72, 36864
s_add_u32 s54, s54, s52
s_lshl_b32 s53, s84, 6
s_sub_u32 s53, s53, 256
s_add_u32 s52, s54, s53
s_add_u32 s53, s55, s53
v_lshlrev_b32 v16, 16, v192
v_and_b32 v17, v13, v192
v_lshlrev_b32 v18, 16, v193
v_and_b32 v19, v13, v193
v_lshlrev_b32 v20, 16, v194
v_and_b32 v21, v13, v194
v_lshlrev_b32 v22, 16, v195
v_and_b32 v23, v13, v195
v_pk_add_f32 v[128:129], v[128:129], v[16:17]
v_pk_add_f32 v[130:131], v[130:131], v[18:19]
v_pk_add_f32 v[136:137], v[136:137], v[20:21]
v_pk_add_f32 v[138:139], v[138:139], v[22:23]
v_lshlrev_b32 v16, 16, v196
v_and_b32 v17, v13, v196
v_lshlrev_b32 v18, 16, v197
v_and_b32 v19, v13, v197
v_lshlrev_b32 v20, 16, v198
v_and_b32 v21, v13, v198
v_lshlrev_b32 v22, 16, v199
v_and_b32 v23, v13, v199
v_pk_add_f32 v[132:133], v[132:133], v[16:17]
v_pk_add_f32 v[134:135], v[134:135], v[18:19]
v_pk_add_f32 v[140:141], v[140:141], v[20:21]
v_pk_add_f32 v[142:143], v[142:143], v[22:23]
v_lshlrev_b32 v16, 16, v200
v_and_b32 v17, v13, v200
v_lshlrev_b32 v18, 16, v201
v_and_b32 v19, v13, v201
v_lshlrev_b32 v20, 16, v202
v_and_b32 v21, v13, v202
v_lshlrev_b32 v22, 16, v203
v_and_b32 v23, v13, v203
v_pk_add_f32 v[128:129], v[128:129], v[16:17]
v_pk_add_f32 v[130:131], v[130:131], v[18:19]
v_pk_add_f32 v[136:137], v[136:137], v[20:21]
v_pk_add_f32 v[138:139], v[138:139], v[22:23]
v_lshlrev_b32 v16, 16, v204
v_and_b32 v17, v13, v204
v_lshlrev_b32 v18, 16, v205
v_and_b32 v19, v13, v205
v_lshlrev_b32 v20, 16, v206
v_and_b32 v21, v13, v206
v_lshlrev_b32 v22, 16, v207
v_and_b32 v23, v13, v207
v_pk_add_f32 v[132:133], v[132:133], v[16:17]
v_pk_add_f32 v[134:135], v[134:135], v[18:19]
v_pk_add_f32 v[140:141], v[140:141], v[20:21]
v_pk_add_f32 v[142:143], v[142:143], v[22:23]
s_cmp_lg_u32 s3, s84
s_cbranch_scc1 L_NO9
v_lshlrev_b32 v16, 16, v208
v_and_b32 v17, v13, v208
v_lshlrev_b32 v18, 16, v209
v_and_b32 v19, v13, v209
v_lshlrev_b32 v20, 16, v210
v_and_b32 v21, v13, v210
v_lshlrev_b32 v22, 16, v211
v_and_b32 v23, v13, v211
v_pk_add_f32 v[120:121], v[120:121], v[16:17]
v_pk_add_f32 v[122:123], v[122:123], v[18:19]
v_pk_add_f32 v[124:125], v[124:125], v[20:21]
v_pk_add_f32 v[126:127], v[126:127], v[22:23]
v_lshlrev_b32 v16, 16, v212
v_and_b32 v17, v13, v212
v_lshlrev_b32 v18, 16, v213
v_and_b32 v19, v13, v213
v_lshlrev_b32 v20, 16, v214
v_and_b32 v21, v13, v214
v_lshlrev_b32 v22, 16, v215
v_and_b32 v23, v13, v215
v_pk_add_f32 v[120:121], v[120:121], v[16:17]
v_pk_add_f32 v[122:123], v[122:123], v[18:19]
v_pk_add_f32 v[124:125], v[124:125], v[20:21]
v_pk_add_f32 v[126:127], v[126:127], v[22:23]
v_lshlrev_b32 v16, 16, v216
v_and_b32 v17, v13, v216
v_lshlrev_b32 v18, 16, v217
v_and_b32 v19, v13, v217
v_lshlrev_b32 v20, 16, v218
v_and_b32 v21, v13, v218
v_lshlrev_b32 v22, 16, v219
v_and_b32 v23, v13, v219
v_pk_add_f32 v[120:121], v[120:121], v[16:17]
v_pk_add_f32 v[122:123], v[122:123], v[18:19]
v_pk_add_f32 v[124:125], v[124:125], v[20:21]
v_pk_add_f32 v[126:127], v[126:127], v[22:23]
v_cvt_pk_bf16_f32 v228, v120, v121
v_cvt_pk_bf16_f32 v229, v122, v123
v_cvt_pk_bf16_f32 v230, v124, v125
v_cvt_pk_bf16_f32 v231, v126, v127
s_waitcnt vmcnt(0)
buffer_store_dwordx2 v[228:229], v6, s[44:47], s54 offen sc1
buffer_store_dwordx2 v[230:231], v6, s[44:47], s55 offen sc1
s_branch L_9D
L_NO9:
s_waitcnt vmcnt(0)
L_9D:
v_lshlrev_b32 v16, 16, v220
v_and_b32 v17, v13, v220
v_lshlrev_b32 v18, 16, v221
v_and_b32 v19, v13, v221
v_lshlrev_b32 v20, 16, v222
v_and_b32 v21, v13, v222
v_lshlrev_b32 v22, 16, v223
v_and_b32 v23, v13, v223
v_pk_add_f32 v[128:129], v[128:129], v[16:17]
v_pk_add_f32 v[130:131], v[130:131], v[18:19]
v_pk_add_f32 v[136:137], v[136:137], v[20:21]
v_pk_add_f32 v[138:139], v[138:139], v[22:23]
v_cvt_pk_bf16_f32 v128, v128, v129
v_cvt_pk_bf16_f32 v129, v130, v131
v_cvt_pk_bf16_f32 v130, v136, v137
v_cvt_pk_bf16_f32 v131, v138, v139
s_nop 1
v_permlane16_swap_b32 v128, v130
v_permlane16_swap_b32 v129, v131
buffer_store_dwordx4 v[128:131], v5, s[44:47], s52 offen sc1
v_lshlrev_b32 v16, 16, v224
v_and_b32 v17, v13, v224
v_lshlrev_b32 v18, 16, v225
v_and_b32 v19, v13, v225
v_lshlrev_b32 v20, 16, v226
v_and_b32 v21, v13, v226
v_lshlrev_b32 v22, 16, v227
v_and_b32 v23, v13, v227
v_pk_add_f32 v[132:133], v[132:133], v[16:17]
v_pk_add_f32 v[134:135], v[134:135], v[18:19]
v_pk_add_f32 v[140:141], v[140:141], v[20:21]
v_pk_add_f32 v[142:143], v[142:143], v[22:23]
v_cvt_pk_bf16_f32 v132, v132, v133
v_cvt_pk_bf16_f32 v133, v134, v135
v_cvt_pk_bf16_f32 v134, v140, v141
v_cvt_pk_bf16_f32 v135, v142, v143
s_nop 1
v_permlane16_swap_b32 v132, v134
v_permlane16_swap_b32 v133, v135
buffer_store_dwordx4 v[132:135], v5, s[44:47], s53 offen sc1
L_END:
s_endpgm
L_SE2:
v_accvgpr_read_b32 v180, a224
v_accvgpr_read_b32 v182, a228
v_cmp_nle_f32 vcc, v180, v7
v_cmp_nle_f32 s[96:97], v182, v7
s_nop 3
s_or_b64 vcc, vcc, s[96:97]
s_cbranch_vccnz SLOW0
SLOW0_R:
s_add_u32 s53, s77, 180224
buffer_load_dwordx4 a[112:115], v4, s[24:27], s53 offen offset:0 sc1
v_mul_f32 v8, 0x3fb8aa3b, v8
v_mul_f32 v9, 0x3fb8aa3b, v9
v_exp_f32 v8, v8
v_exp_f32 v9, v9
s_nop 0
v_fma_f32 v180, v180, v8, v180
v_fma_f32 v182, v182, v9, v182
v_rcp_f32 v180, v180
v_rcp_f32 v182, v182
s_add_u32 s52, s78, 4096
v_mov_b32 v181, v180
v_mov_b32 v183, v182
v_pk_mul_f32 v[36:37], v[36:37], v[180:181]
v_pk_mul_f32 v[38:39], v[38:39], v[180:181]
v_pk_mul_f32 v[32:33], v[32:33], v[180:181]
v_pk_mul_f32 v[34:35], v[34:35], v[180:181]
v_cvt_pk_bf16_f32 v36, v36, v37
v_cvt_pk_bf16_f32 v37, v38, v39
v_cvt_pk_bf16_f32 v38, v32, v33
v_cvt_pk_bf16_f32 v39, v34, v35
buffer_store_dwordx4 v[36:39], v4, s[24:27], s78 offen offset:0 sc1
buffer_load_dwordx4 a[116:119], v4, s[24:27], s53 offen offset:1024 sc1
v_pk_mul_f32 v[116:117], v[116:117], v[182:183]
v_pk_mul_f32 v[118:119], v[118:119], v[182:183]
v_pk_mul_f32 v[132:133], v[132:133], v[182:183]
v_pk_mul_f32 v[134:135], v[134:135], v[182:183]
v_cvt_pk_bf16_f32 v116, v116, v117
v_cvt_pk_bf16_f32 v117, v118, v119
v_cvt_pk_bf16_f32 v118, v132, v133
v_cvt_pk_bf16_f32 v119, v134, v135
buffer_store_dwordx4 v[116:119], v4, s[24:27], s78 offen offset:1024 sc1
v_pk_mul_f32 v[196:197], v[196:197], v[180:181]
v_pk_mul_f32 v[198:199], v[198:199], v[180:181]
v_pk_mul_f32 v[204:205], v[204:205], v[180:181]
v_pk_mul_f32 v[206:207], v[206:207], v[180:181]
v_cvt_pk_bf16_f32 v196, v196, v197
v_cvt_pk_bf16_f32 v197, v198, v199
v_cvt_pk_bf16_f32 v198, v204, v205
v_cvt_pk_bf16_f32 v199, v206, v207
buffer_store_dwordx4 v[196:199], v4, s[24:27], s78 offen offset:2048 sc1
v_pk_mul_f32 v[184:185], v[184:185], v[182:183]
v_pk_mul_f32 v[186:187], v[186:187], v[182:183]
v_pk_mul_f32 v[240:241], v[240:241], v[182:183]
buffer_load_dwordx4 a[120:123], v4, s[24:27], s53 offen offset:2048 sc1
v_pk_mul_f32 v[242:243], v[242:243], v[182:183]
v_cvt_pk_bf16_f32 v184, v184, v185
v_cvt_pk_bf16_f32 v185, v186, v187
v_cvt_pk_bf16_f32 v186, v240, v241
v_cvt_pk_bf16_f32 v187, v242, v243
buffer_store_dwordx4 v[184:187], v4, s[24:27], s78 offen offset:3072 sc1
v_pk_mul_f32 v[108:109], v[108:109], v[180:181]
v_pk_mul_f32 v[110:111], v[110:111], v[180:181]
v_pk_mul_f32 v[40:41], v[40:41], v[180:181]
v_pk_mul_f32 v[42:43], v[42:43], v[180:181]
v_cvt_pk_bf16_f32 v108, v108, v109
v_cvt_pk_bf16_f32 v109, v110, v111
v_cvt_pk_bf16_f32 v110, v40, v41
v_cvt_pk_bf16_f32 v111, v42, v43
buffer_store_dwordx4 v[108:111], v4, s[24:27], s52 offen offset:0 sc1
v_pk_mul_f32 v[188:189], v[188:189], v[182:183]
v_pk_mul_f32 v[190:191], v[190:191], v[182:183]
v_pk_mul_f32 v[56:57], v[56:57], v[182:183]
v_pk_mul_f32 v[58:59], v[58:59], v[182:183]
v_cvt_pk_bf16_f32 v188, v188, v189
v_cvt_pk_bf16_f32 v189, v190, v191
buffer_load_dwordx4 a[124:127], v4, s[24:27], s53 offen offset:3072 sc1
v_cvt_pk_bf16_f32 v190, v56, v57
v_cvt_pk_bf16_f32 v191, v58, v59
buffer_store_dwordx4 v[188:191], v4, s[24:27], s52 offen offset:1024 sc1
v_pk_mul_f32 v[80:81], v[80:81], v[180:181]
v_pk_mul_f32 v[82:83], v[82:83], v[180:181]
v_pk_mul_f32 v[168:169], v[168:169], v[180:181]
v_pk_mul_f32 v[170:171], v[170:171], v[180:181]
v_cvt_pk_bf16_f32 v80, v80, v81
v_cvt_pk_bf16_f32 v81, v82, v83
v_cvt_pk_bf16_f32 v82, v168, v169
v_cvt_pk_bf16_f32 v83, v170, v171
buffer_store_dwordx4 v[80:83], v4, s[24:27], s52 offen offset:2048 sc1
v_pk_mul_f32 v[88:89], v[88:89], v[182:183]
v_pk_mul_f32 v[90:91], v[90:91], v[182:183]
v_pk_mul_f32 v[192:193], v[192:193], v[182:183]
v_pk_mul_f32 v[194:195], v[194:195], v[182:183]
v_cvt_pk_bf16_f32 v88, v88, v89
v_cvt_pk_bf16_f32 v89, v90, v91
v_cvt_pk_bf16_f32 v90, v192, v193
v_cvt_pk_bf16_f32 v91, v194, v195
buffer_store_dwordx4 v[88:91], v4, s[24:27], s52 offen offset:3072 sc1
s_branch L_LA
CK_Z:
s_mov_b32 s92, 0
CK_Z_L:
s_sleep 1
buffer_load_dword v23, v22, s[40:43], 0 offen sc1
s_add_u32 s92, s92, 1
s_waitcnt vmcnt(0)
v_cmp_gt_u32 vcc, 1, v23
s_cmp_gt_u32 s92, 1048576
s_cbranch_scc1 CK_Z_R
s_nop 3
s_cbranch_vccnz CK_Z_L
s_branch CK_Z_R
CK_WA:
s_mov_b32 s92, 0
CK_WA_L:
s_sleep 1
buffer_load_dword v30, v29, s[24:27], s89 offen sc1
s_add_u32 s92, s92, 1
s_waitcnt vmcnt(0)
v_cmp_gt_u32 vcc, 18, v30
s_cmp_gt_u32 s92, 1048576
s_cbranch_scc1 CK_WA_R
s_nop 3
s_cbranch_vccnz CK_WA_L
s_branch CK_WA_R
CK_ZA:
s_mov_b32 s92, 0
CK_ZA_L:
s_sleep 1
buffer_load_dword v30, v28, s[40:43], 0 offen sc1
s_add_u32 s92, s92, 1
s_waitcnt vmcnt(0)
v_cmp_gt_u32 vcc, 1, v30
s_cmp_gt_u32 s92, 1048576
s_cbranch_scc1 CK_ZA_R
s_nop 3
s_cbranch_vccnz CK_ZA_L
s_branch CK_ZA_R
CK_KV:
s_mov_b32 s92, 0
CK_KV_L:
s_sleep 1
buffer_load_dword v30, v29, s[24:27], s89 offen offset:4 sc1
s_add_u32 s92, s92, 1
s_waitcnt vmcnt(0)
v_cmp_gt_u32 vcc, 8, v30
s_cmp_gt_u32 s92, 1048576
s_cbranch_scc1 CK_KV_R
s_nop 3
s_cbranch_vccnz CK_KV_L
s_branch CK_KV_R
D0:
v_cndmask_b32 v96, v96, v6, s[56:57]
v_cndmask_b32 v120, v120, v6, s[56:57]
v_mov_b32 v112, v6
v_cndmask_b32 v97, v97, v6, s[58:59]
v_cndmask_b32 v121, v121, v6, s[58:59]
v_mov_b32 v113, v6
v_cndmask_b32 v98, v98, v6, s[60:61]
v_cndmask_b32 v122, v122, v6, s[60:61]
v_mov_b32 v114, v6
v_cndmask_b32 v99, v99, v6, s[62:63]
v_cndmask_b32 v123, v123, v6, s[62:63]
v_mov_b32 v115, v6
s_branch D0_R
CK_Q:
s_mov_b32 s92, 0
CK_Q_L:
s_sleep 1
buffer_load_dword v172, v173, s[24:27], 0 offen sc1
s_add_u32 s92, s92, 1
s_waitcnt vmcnt(0)
v_cmp_gt_u32 vcc, 32, v172
s_cmp_gt_u32 s92, 1048576
s_cbranch_scc1 CK_Q_R
s_nop 3
s_cbranch_vccnz CK_Q_L
s_branch CK_Q_R
CK_ZAA:
s_mov_b32 s92, 0
CK_ZAA_L:
s_sleep 1
buffer_load_dword v12, v10, s[24:27], s75 offen offset:4 sc1
s_add_u32 s92, s92, 1
s_waitcnt vmcnt(0)
v_cmp_gt_u32 vcc, 8, v12
s_cmp_gt_u32 s92, 1048576
s_cbranch_scc1 CK_ZAA_R
s_nop 3
s_cbranch_vccnz CK_ZAA_L
s_branch CK_ZAA_R
CK_P1:
s_mov_b32 s92, 0
CK_P1_L:
s_sleep 1
buffer_load_dword v12, v10, s[24:27], s73 offen sc1
s_add_u32 s92, s92, 1
s_waitcnt vmcnt(0)
v_cmp_gt_u32 vcc, 4, v12
s_cmp_gt_u32 s92, 1048576
s_cbranch_scc1 CK_P1_R
s_nop 3
s_cbranch_vccnz CK_P1_L
s_branch CK_P1_R
CK_P2:
s_mov_b32 s92, 0
CK_P2_L:
s_sleep 1
buffer_load_dword v12, v10, s[24:27], s73 offen offset:16 sc1
s_add_u32 s92, s92, 1
s_waitcnt vmcnt(0)
v_cmp_gt_u32 vcc, 4, v12
s_cmp_gt_u32 s92, 1048576
s_cbranch_scc1 CK_P2_R
s_nop 3
s_cbranch_vccnz CK_P2_L
s_branch CK_P2_R
SLOW0:
v_add_u32 v20, 4096, v4
s_mov_b32 s54, 0
v_mov_b32 v16, v6
v_mov_b32 v18, v6
SLOW0_P:
s_mov_b32 s53, 0
s_mov_b32 s52, s94
SLOW0_T:
s_add_u32 s55, s52, 24576
buffer_load_dwordx4 a[192:195], v4, s[24:27], s52 offen offset:0 sc1
buffer_load_dwordx4 a[196:199], v4, s[24:27], s52 offen offset:1024 sc1
buffer_load_dwordx4 a[200:203], v4, s[24:27], s52 offen offset:2048 sc1
buffer_load_dwordx4 a[204:207], v4, s[24:27], s52 offen offset:3072 sc1
buffer_load_dwordx4 a[208:211], v20, s[24:27], s52 offen offset:0 sc1
buffer_load_dwordx4 a[212:215], v20, s[24:27], s52 offen offset:1024 sc1
buffer_load_dwordx4 a[216:219], v20, s[24:27], s52 offen offset:2048 sc1
buffer_load_dwordx4 a[220:223], v20, s[24:27], s52 offen offset:3072 sc1
buffer_load_dwordx4 a[64:67], v4, s[24:27], s55 offen offset:0 sc1
buffer_load_dwordx4 a[68:71], v4, s[24:27], s55 offen offset:1024 sc1
buffer_load_dwordx4 a[72:75], v4, s[24:27], s55 offen offset:2048 sc1
buffer_load_dwordx4 a[76:79], v4, s[24:27], s55 offen offset:3072 sc1
buffer_load_dwordx4 a[80:83], v20, s[24:27], s55 offen offset:0 sc1
buffer_load_dwordx4 a[84:87], v20, s[24:27], s55 offen offset:1024 sc1
buffer_load_dwordx4 a[88:91], v20, s[24:27], s55 offen offset:2048 sc1
buffer_load_dwordx4 a[92:95], v20, s[24:27], s55 offen offset:3072 sc1
s_waitcnt vmcnt(0)
v_mfma_f32_16x16x32_bf16 v[44:47], a[192:195], a[32:35], 0
v_mfma_f32_16x16x32_bf16 v[44:47], a[196:199], a[36:39], v[44:47]
v_mfma_f32_16x16x32_bf16 v[44:47], a[200:203], a[28:31], v[44:47]
v_mfma_f32_16x16x32_bf16 v[44:47], a[204:207], a[20:23], v[44:47]
v_mfma_f32_16x16x32_bf16 v[52:55], a[192:195], a[44:47], 0
v_mfma_f32_16x16x32_bf16 v[52:55], a[196:199], a[40:43], v[52:55]
v_mfma_f32_16x16x32_bf16 v[52:55], a[200:203], a[12:15], v[52:55]
v_mfma_f32_16x16x32_bf16 v[52:55], a[204:207], a[4:7], v[52:55]
v_mfma_f32_16x16x32_bf16 v[64:67], a[208:211], a[32:35], 0
v_mfma_f32_16x16x32_bf16 v[64:67], a[212:215], a[36:39], v[64:67]
v_mfma_f32_16x16x32_bf16 v[64:67], a[216:219], a[28:31], v[64:67]
v_mfma_f32_16x16x32_bf16 v[64:67], a[220:223], a[20:23], v[64:67]
v_mfma_f32_16x16x32_bf16 v[212:215], a[208:211], a[44:47], 0
v_mfma_f32_16x16x32_bf16 v[212:215], a[212:215], a[40:43], v[212:215]
v_mfma_f32_16x16x32_bf16 v[212:215], a[216:219], a[12:15], v[212:215]
v_mfma_f32_16x16x32_bf16 v[212:215], a[220:223], a[4:7], v[212:215]
s_nop 7
s_cmp_lg_u32 s53, s66
s_cbranch_scc1 SLOW0_U
v_cndmask_b32 v44, v44, v6, s[56:57]
v_cndmask_b32 v212, v212, v6, s[56:57]
v_mov_b32 v64, v6
v_cndmask_b32 v45, v45, v6, s[58:59]
v_cndmask_b32 v213, v213, v6, s[58:59]
v_mov_b32 v65, v6
v_cndmask_b32 v46, v46, v6, s[60:61]
v_cndmask_b32 v214, v214, v6, s[60:61]
v_mov_b32 v66, v6
v_cndmask_b32 v47, v47, v6, s[62:63]
v_cndmask_b32 v215, v215, v6, s[62:63]
v_mov_b32 v67, v6
SLOW0_U:
s_cmp_lg_u32 s54, 0
s_cbranch_scc1 SLOW0_A
v_max3_f32 v16, v16, v44, v45
v_max3_f32 v16, v16, v46, v47
v_max3_f32 v18, v18, v52, v53
v_max3_f32 v18, v18, v54, v55
v_max3_f32 v16, v16, v64, v65
v_max3_f32 v16, v16, v66, v67
v_max3_f32 v18, v18, v212, v213
v_max3_f32 v18, v18, v214, v215
s_branch SLOW0_N
SLOW0_A:
v_sub_f32 v44, v44, v16
v_sub_f32 v45, v45, v16
v_sub_f32 v46, v46, v16
v_sub_f32 v47, v47, v16
v_sub_f32 v52, v52, v18
v_sub_f32 v53, v53, v18
v_sub_f32 v54, v54, v18
v_sub_f32 v55, v55, v18
v_sub_f32 v64, v64, v16
v_sub_f32 v65, v65, v16
v_sub_f32 v66, v66, v16
v_sub_f32 v67, v67, v16
v_sub_f32 v212, v212, v18
v_sub_f32 v213, v213, v18
v_sub_f32 v214, v214, v18
v_sub_f32 v215, v215, v18
v_exp_f32 v44, v44
v_exp_f32 v45, v45
v_exp_f32 v46, v46
v_exp_f32 v47, v47
v_exp_f32 v52, v52
v_exp_f32 v53, v53
v_exp_f32 v54, v54
v_exp_f32 v55, v55
v_exp_f32 v64, v64
v_exp_f32 v65, v65
v_exp_f32 v66, v66
v_exp_f32 v67, v67
v_exp_f32 v212, v212
v_exp_f32 v213, v213
v_exp_f32 v214, v214
v_exp_f32 v215, v215
s_nop 0
v_cvt_pk_bf16_f32 v124, v44, v45
v_cvt_pk_bf16_f32 v125, v46, v47
v_cvt_pk_bf16_f32 v140, v52, v53
v_cvt_pk_bf16_f32 v141, v54, v55
v_cvt_pk_bf16_f32 v126, v64, v65
v_cvt_pk_bf16_f32 v127, v66, v67
v_cvt_pk_bf16_f32 v142, v212, v213
v_cvt_pk_bf16_f32 v143, v214, v215
s_nop 1
v_mfma_f32_16x16x32_bf16 v[36:39], a[64:67], v[124:127], v[36:39]
v_mfma_f32_16x16x32_bf16 v[116:119], a[64:67], v[140:143], v[116:119]
v_mfma_f32_16x16x32_bf16 v[132:135], a[68:71], v[140:143], v[132:135]
v_mfma_f32_16x16x32_bf16 v[32:35], a[68:71], v[124:127], v[32:35]
v_mfma_f32_16x16x32_bf16 v[196:199], a[72:75], v[124:127], v[196:199]
v_mfma_f32_16x16x32_bf16 v[184:187], a[72:75], v[140:143], v[184:187]
v_mfma_f32_16x16x32_bf16 v[240:243], a[76:79], v[140:143], v[240:243]
v_mfma_f32_16x16x32_bf16 v[204:207], a[76:79], v[124:127], v[204:207]
v_mfma_f32_16x16x32_bf16 v[108:111], a[80:83], v[124:127], v[108:111]
v_mfma_f32_16x16x32_bf16 v[188:191], a[80:83], v[140:143], v[188:191]
v_mfma_f32_16x16x32_bf16 v[56:59], a[84:87], v[140:143], v[56:59]
v_mfma_f32_16x16x32_bf16 v[40:43], a[84:87], v[124:127], v[40:43]
v_mfma_f32_16x16x32_bf16 v[80:83], a[88:91], v[124:127], v[80:83]
v_mfma_f32_16x16x32_bf16 v[88:91], a[88:91], v[140:143], v[88:91]
v_mfma_f32_16x16x32_bf16 v[192:195], a[92:95], v[140:143], v[192:195]
v_mfma_f32_16x16x32_bf16 v[168:171], a[92:95], v[124:127], v[168:171]
v_mfma_f32_16x16x32_bf16 a[224:227], a[240:243], v[124:127], a[224:227]
v_mfma_f32_16x16x32_bf16 a[228:231], a[240:243], v[140:143], a[228:231]
SLOW0_N:
s_add_u32 s52, s52, 16384
s_add_u32 s53, s53, 1
s_cmp_le_u32 s53, s66
s_cbranch_scc1 SLOW0_T
s_cmp_lg_u32 s54, 0
s_cbranch_scc1 SLOW0_E
v_mov_b32 v17, v16
v_mov_b32 v19, v18
s_nop 1
v_permlane32_swap_b32 v17, v16
v_permlane32_swap_b32 v19, v18
s_nop 1
v_max_f32 v16, v16, v17
v_max_f32 v18, v18, v19
v_mov_b32 v17, v16
v_mov_b32 v19, v18
s_nop 1
v_permlane16_swap_b32 v17, v16
v_permlane16_swap_b32 v19, v18
s_nop 1
v_max_f32 v16, v16, v17
v_max_f32 v18, v18, v19
v_mov_b32 v36, 0
v_mov_b32 v37, 0
v_mov_b32 v38, 0
v_mov_b32 v39, 0
v_mov_b32 v32, 0
v_mov_b32 v33, 0
v_mov_b32 v34, 0
v_mov_b32 v35, 0
v_mov_b32 v196, 0
v_mov_b32 v197, 0
v_mov_b32 v198, 0
v_mov_b32 v199, 0
v_mov_b32 v204, 0
v_mov_b32 v205, 0
v_mov_b32 v206, 0
v_mov_b32 v207, 0
v_mov_b32 v108, 0
v_mov_b32 v109, 0
v_mov_b32 v110, 0
v_mov_b32 v111, 0
v_mov_b32 v40, 0
v_mov_b32 v41, 0
v_mov_b32 v42, 0
v_mov_b32 v43, 0
v_mov_b32 v80, 0
v_mov_b32 v81, 0
v_mov_b32 v82, 0
v_mov_b32 v83, 0
v_mov_b32 v168, 0
v_mov_b32 v169, 0
v_mov_b32 v170, 0
v_mov_b32 v171, 0
v_mov_b32 v116, 0
v_mov_b32 v117, 0
v_mov_b32 v118, 0
v_mov_b32 v119, 0
v_mov_b32 v132, 0
v_mov_b32 v133, 0
v_mov_b32 v134, 0
v_mov_b32 v135, 0
v_mov_b32 v184, 0
v_mov_b32 v185, 0
v_mov_b32 v186, 0
v_mov_b32 v187, 0
v_mov_b32 v240, 0
v_mov_b32 v241, 0
v_mov_b32 v242, 0
v_mov_b32 v243, 0
v_mov_b32 v188, 0
v_mov_b32 v189, 0
v_mov_b32 v190, 0
v_mov_b32 v191, 0
v_mov_b32 v56, 0
v_mov_b32 v57, 0
v_mov_b32 v58, 0
v_mov_b32 v59, 0
v_mov_b32 v88, 0
v_mov_b32 v89, 0
v_mov_b32 v90, 0
v_mov_b32 v91, 0
v_mov_b32 v192, 0
v_mov_b32 v193, 0
v_mov_b32 v194, 0
v_mov_b32 v195, 0
v_accvgpr_write_b32 a224, 0
v_accvgpr_write_b32 a225, 0
v_accvgpr_write_b32 a226, 0
v_accvgpr_write_b32 a227, 0
v_accvgpr_write_b32 a228, 0
v_accvgpr_write_b32 a229, 0
v_accvgpr_write_b32 a230, 0
v_accvgpr_write_b32 a231, 0
s_mov_b32 s54, 1
s_branch SLOW0_P
SLOW0_E:
s_nop 7
v_accvgpr_read_b32 v180, a224
v_accvgpr_read_b32 v182, a228
s_branch SLOW0_R
SLOW1:
v_add_u32 v20, 4096, v4
s_mov_b32 s54, 0
v_mov_b32 v16, v6
v_mov_b32 v18, v6
SLOW1_P:
s_mov_b32 s53, 0
s_mov_b32 s52, s94
SLOW1_T:
s_add_u32 s55, s52, 24576
buffer_load_dwordx4 a[192:195], v4, s[24:27], s52 offen offset:0 sc1
buffer_load_dwordx4 a[196:199], v4, s[24:27], s52 offen offset:1024 sc1
buffer_load_dwordx4 a[200:203], v4, s[24:27], s52 offen offset:2048 sc1
buffer_load_dwordx4 a[204:207], v4, s[24:27], s52 offen offset:3072 sc1
buffer_load_dwordx4 a[208:211], v20, s[24:27], s52 offen offset:0 sc1
buffer_load_dwordx4 a[212:215], v20, s[24:27], s52 offen offset:1024 sc1
buffer_load_dwordx4 a[216:219], v20, s[24:27], s52 offen offset:2048 sc1
buffer_load_dwordx4 a[220:223], v20, s[24:27], s52 offen offset:3072 sc1
buffer_load_dwordx4 a[64:67], v4, s[24:27], s55 offen offset:0 sc1
buffer_load_dwordx4 a[68:71], v4, s[24:27], s55 offen offset:1024 sc1
buffer_load_dwordx4 a[72:75], v4, s[24:27], s55 offen offset:2048 sc1
buffer_load_dwordx4 a[76:79], v4, s[24:27], s55 offen offset:3072 sc1
buffer_load_dwordx4 a[80:83], v20, s[24:27], s55 offen offset:0 sc1
buffer_load_dwordx4 a[84:87], v20, s[24:27], s55 offen offset:1024 sc1
buffer_load_dwordx4 a[88:91], v20, s[24:27], s55 offen offset:2048 sc1
buffer_load_dwordx4 a[92:95], v20, s[24:27], s55 offen offset:3072 sc1
s_waitcnt vmcnt(0)
v_mfma_f32_16x16x32_bf16 v[44:47], a[192:195], a[48:51], 0
v_mfma_f32_16x16x32_bf16 v[44:47], a[196:199], a[52:55], v[44:47]
v_mfma_f32_16x16x32_bf16 v[44:47], a[200:203], a[0:3], v[44:47]
v_mfma_f32_16x16x32_bf16 v[44:47], a[204:207], a[8:11], v[44:47]
v_mfma_f32_16x16x32_bf16 v[52:55], a[192:195], a[60:63], 0
v_mfma_f32_16x16x32_bf16 v[52:55], a[196:199], a[56:59], v[52:55]
v_mfma_f32_16x16x32_bf16 v[52:55], a[200:203], a[16:19], v[52:55]
v_mfma_f32_16x16x32_bf16 v[52:55], a[204:207], a[24:27], v[52:55]
v_mfma_f32_16x16x32_bf16 v[64:67], a[208:211], a[48:51], 0
v_mfma_f32_16x16x32_bf16 v[64:67], a[212:215], a[52:55], v[64:67]
v_mfma_f32_16x16x32_bf16 v[64:67], a[216:219], a[0:3], v[64:67]
v_mfma_f32_16x16x32_bf16 v[64:67], a[220:223], a[8:11], v[64:67]
v_mfma_f32_16x16x32_bf16 v[212:215], a[208:211], a[60:63], 0
v_mfma_f32_16x16x32_bf16 v[212:215], a[212:215], a[56:59], v[212:215]
v_mfma_f32_16x16x32_bf16 v[212:215], a[216:219], a[16:19], v[212:215]
v_mfma_f32_16x16x32_bf16 v[212:215], a[220:223], a[24:27], v[212:215]
s_nop 7
s_cmp_lg_u32 s53, s67
s_cbranch_scc1 SLOW1_U
v_cndmask_b32 v44, v44, v6, s[56:57]
v_cndmask_b32 v212, v212, v6, s[56:57]
v_mov_b32 v64, v6
v_cndmask_b32 v45, v45, v6, s[58:59]
v_cndmask_b32 v213, v213, v6, s[58:59]
v_mov_b32 v65, v6
v_cndmask_b32 v46, v46, v6, s[60:61]
v_cndmask_b32 v214, v214, v6, s[60:61]
v_mov_b32 v66, v6
v_cndmask_b32 v47, v47, v6, s[62:63]
v_cndmask_b32 v215, v215, v6, s[62:63]
v_mov_b32 v67, v6
SLOW1_U:
s_cmp_lg_u32 s54, 0
s_cbranch_scc1 SLOW1_A
v_max3_f32 v16, v16, v44, v45
v_max3_f32 v16, v16, v46, v47
v_max3_f32 v18, v18, v52, v53
v_max3_f32 v18, v18, v54, v55
v_max3_f32 v16, v16, v64, v65
v_max3_f32 v16, v16, v66, v67
v_max3_f32 v18, v18, v212, v213
v_max3_f32 v18, v18, v214, v215
s_branch SLOW1_N
SLOW1_A:
v_sub_f32 v44, v44, v16
v_sub_f32 v45, v45, v16
v_sub_f32 v46, v46, v16
v_sub_f32 v47, v47, v16
v_sub_f32 v52, v52, v18
v_sub_f32 v53, v53, v18
v_sub_f32 v54, v54, v18
v_sub_f32 v55, v55, v18
v_sub_f32 v64, v64, v16
v_sub_f32 v65, v65, v16
v_sub_f32 v66, v66, v16
v_sub_f32 v67, v67, v16
v_sub_f32 v212, v212, v18
v_sub_f32 v213, v213, v18
v_sub_f32 v214, v214, v18
v_sub_f32 v215, v215, v18
v_exp_f32 v44, v44
v_exp_f32 v45, v45
v_exp_f32 v46, v46
v_exp_f32 v47, v47
v_exp_f32 v52, v52
v_exp_f32 v53, v53
v_exp_f32 v54, v54
v_exp_f32 v55, v55
v_exp_f32 v64, v64
v_exp_f32 v65, v65
v_exp_f32 v66, v66
v_exp_f32 v67, v67
v_exp_f32 v212, v212
v_exp_f32 v213, v213
v_exp_f32 v214, v214
v_exp_f32 v215, v215
s_nop 0
v_cvt_pk_bf16_f32 v124, v44, v45
v_cvt_pk_bf16_f32 v125, v46, v47
v_cvt_pk_bf16_f32 v140, v52, v53
v_cvt_pk_bf16_f32 v141, v54, v55
v_cvt_pk_bf16_f32 v126, v64, v65
v_cvt_pk_bf16_f32 v127, v66, v67
v_cvt_pk_bf16_f32 v142, v212, v213
v_cvt_pk_bf16_f32 v143, v214, v215
s_nop 1
v_mfma_f32_16x16x32_bf16 v[60:63], a[64:67], v[124:127], v[60:63]
v_mfma_f32_16x16x32_bf16 v[148:151], a[64:67], v[140:143], v[148:151]
v_mfma_f32_16x16x32_bf16 v[48:51], a[68:71], v[140:143], v[48:51]
v_mfma_f32_16x16x32_bf16 v[68:71], a[68:71], v[124:127], v[68:71]
v_mfma_f32_16x16x32_bf16 v[72:75], a[72:75], v[124:127], v[72:75]
v_mfma_f32_16x16x32_bf16 v[236:239], a[72:75], v[140:143], v[236:239]
v_mfma_f32_16x16x32_bf16 v[224:227], a[76:79], v[140:143], v[224:227]
v_mfma_f32_16x16x32_bf16 v[220:223], a[76:79], v[124:127], v[220:223]
v_mfma_f32_16x16x32_bf16 v[84:87], a[80:83], v[124:127], v[84:87]
v_mfma_f32_16x16x32_bf16 v[164:167], a[80:83], v[140:143], v[164:167]
v_mfma_f32_16x16x32_bf16 v[156:159], a[84:87], v[140:143], v[156:159]
v_mfma_f32_16x16x32_bf16 v[76:79], a[84:87], v[124:127], v[76:79]
v_mfma_f32_16x16x32_bf16 v[160:163], a[88:91], v[124:127], v[160:163]
v_mfma_f32_16x16x32_bf16 v[216:219], a[88:91], v[140:143], v[216:219]
v_mfma_f32_16x16x32_bf16 v[208:211], a[92:95], v[140:143], v[208:211]
v_mfma_f32_16x16x32_bf16 v[252:255], a[92:95], v[124:127], v[252:255]
v_mfma_f32_16x16x32_bf16 a[232:235], a[240:243], v[124:127], a[232:235]
v_mfma_f32_16x16x32_bf16 a[236:239], a[240:243], v[140:143], a[236:239]
SLOW1_N:
s_add_u32 s52, s52, 16384
s_add_u32 s53, s53, 1
s_cmp_le_u32 s53, s67
s_cbranch_scc1 SLOW1_T
s_cmp_lg_u32 s54, 0
s_cbranch_scc1 SLOW1_E
v_mov_b32 v17, v16
v_mov_b32 v19, v18
s_nop 1
v_permlane32_swap_b32 v17, v16
v_permlane32_swap_b32 v19, v18
s_nop 1
v_max_f32 v16, v16, v17
v_max_f32 v18, v18, v19
v_mov_b32 v17, v16
v_mov_b32 v19, v18
s_nop 1
v_permlane16_swap_b32 v17, v16
v_permlane16_swap_b32 v19, v18
s_nop 1
v_max_f32 v16, v16, v17
v_max_f32 v18, v18, v19
v_mov_b32 v60, 0
v_mov_b32 v61, 0
v_mov_b32 v62, 0
v_mov_b32 v63, 0
v_mov_b32 v68, 0
v_mov_b32 v69, 0
v_mov_b32 v70, 0
v_mov_b32 v71, 0
v_mov_b32 v72, 0
v_mov_b32 v73, 0
v_mov_b32 v74, 0
v_mov_b32 v75, 0
v_mov_b32 v220, 0
v_mov_b32 v221, 0
v_mov_b32 v222, 0
v_mov_b32 v223, 0
v_mov_b32 v84, 0
v_mov_b32 v85, 0
v_mov_b32 v86, 0
v_mov_b32 v87, 0
v_mov_b32 v76, 0
v_mov_b32 v77, 0
v_mov_b32 v78, 0
v_mov_b32 v79, 0
v_mov_b32 v160, 0
v_mov_b32 v161, 0
v_mov_b32 v162, 0
v_mov_b32 v163, 0
v_mov_b32 v252, 0
v_mov_b32 v253, 0
v_mov_b32 v254, 0
v_mov_b32 v255, 0
v_mov_b32 v148, 0
v_mov_b32 v149, 0
v_mov_b32 v150, 0
v_mov_b32 v151, 0
v_mov_b32 v48, 0
v_mov_b32 v49, 0
v_mov_b32 v50, 0
v_mov_b32 v51, 0
v_mov_b32 v236, 0
v_mov_b32 v237, 0
v_mov_b32 v238, 0
v_mov_b32 v239, 0
v_mov_b32 v224, 0
v_mov_b32 v225, 0
v_mov_b32 v226, 0
v_mov_b32 v227, 0
v_mov_b32 v164, 0
v_mov_b32 v165, 0
v_mov_b32 v166, 0
v_mov_b32 v167, 0
v_mov_b32 v156, 0
v_mov_b32 v157, 0
v_mov_b32 v158, 0
v_mov_b32 v159, 0
v_mov_b32 v216, 0
v_mov_b32 v217, 0
v_mov_b32 v218, 0
v_mov_b32 v219, 0
v_mov_b32 v208, 0
v_mov_b32 v209, 0
v_mov_b32 v210, 0
v_mov_b32 v211, 0
v_accvgpr_write_b32 a232, 0
v_accvgpr_write_b32 a233, 0
v_accvgpr_write_b32 a234, 0
v_accvgpr_write_b32 a235, 0
v_accvgpr_write_b32 a236, 0
v_accvgpr_write_b32 a237, 0
v_accvgpr_write_b32 a238, 0
v_accvgpr_write_b32 a239, 0
s_mov_b32 s54, 1
s_branch SLOW1_P
SLOW1_E:
s_nop 7
v_accvgpr_read_b32 v180, a232
v_accvgpr_read_b32 v182, a236
s_branch SLOW1_R
.section .rodata,"a"
.p2align 6
.amdhsa_kernel gated_mix__sliding_local_dilated__compressed_kv_cla__prompt_kernel
  .amdhsa_next_free_vgpr 512
  .amdhsa_next_free_sgpr 102
  .amdhsa_accum_offset 256
  .amdhsa_group_segment_fixed_size 0
  .amdhsa_kernarg_size 104
  .amdhsa_user_sgpr_count 2
  .amdhsa_user_sgpr_kernarg_segment_ptr 1
  .amdhsa_system_sgpr_workgroup_id_x 1
.end_amdhsa_kernel
```

```asm
; @launch grid=(256,1,1) block=(256,1,1) lds=163840
.amdgcn_target "amdgcn-amd-amdhsa--gfx950"
.text

.globl gated_mix__sliding_local_dilated__compressed_kv_cla__prompt_kernel
.p2align 8
.type gated_mix__sliding_local_dilated__compressed_kv_cla__prompt_kernel,@function
gated_mix__sliding_local_dilated__compressed_kv_cla__prompt_kernel:
s_cmp_ge_u32 s2, 256
s_cbranch_scc1 L_END
s_load_dwordx2 s[8:9], s[0:1], 32
s_load_dwordx2 s[56:57], s[0:1], 56
s_load_dwordx2 s[16:17], s[0:1], 48
s_load_dwordx2 s[24:25], s[0:1], 96
s_load_dwordx2 s[12:13], s[0:1], 0
s_load_dwordx2 s[20:21], s[0:1], 40
s_load_dwordx2 s[28:29], s[0:1], 8
s_load_dwordx2 s[48:49], s[0:1], 16
s_load_dwordx2 s[32:33], s[0:1], 64
s_load_dwordx2 s[36:37], s[0:1], 72
s_load_dwordx2 s[40:41], s[0:1], 88
s_load_dwordx2 s[44:45], s[0:1], 80
s_getpc_b64 s[96:97]
L_PC:
s_lshr_b32 s6, s2, 3
s_lshl_b32 s98, s6, 11
s_add_u32 s98, s98, L_MAIN-L_PC
s_add_u32 s96, s96, s98
s_addc_u32 s97, s97, 0
v_lshlrev_b32 v16, 3, v0
v_mov_b32 v17, s97
v_add_co_u32 v16, vcc, s96, v16
v_lshrrev_b32 v5, 6, v0
v_and_b32 v1, 63, v0
v_addc_co_u32 v17, vcc, 0, v17, vcc
v_readfirstlane_b32 s3, v5
global_load_dwordx2 a[252:253], v[16:17], off
v_and_b32 v2, 15, v0
v_lshrrev_b32 v3, 4, v1
v_lshlrev_b32 v4, 4, v1
s_and_b32 s7, s2, 7
s_and_b32 s65, s6, 3
s_lshl2_add_u32 s4, s7, s65
s_lshr_b32 s5, s6, 2
s_lshl2_add_u32 s66, s5, s3
s_sub_u32 s67, 63, s66
v_lshrrev_b32 v16, 3, v1
v_and_b32 v17, 7, v1
v_xor_b32 v18, v17, v3
v_lshlrev_b32 v19, 10, v16
v_lshl_add_u32 v5, v18, 4, v19
v_xor_b32 v18, 4, v18
v_lshl_add_u32 v6, v18, 4, v19
v_add_u32 v6, 7168, v6
v_and_b32 v18, 1, v3
v_lshlrev_b32 v18, 1, v18
v_xor_b32 v18, v17, v18
v_lshlrev_b32 v19, 13, v16
v_lshl_add_u32 v7, v18, 4, v19
v_xor_b32 v18, 4, v18
v_lshl_add_u32 v8, v18, 4, v19
v_add_u32 v8, 64512, v8
s_add_u32 s69, s65, s5
s_and_b32 s69, s69, 1
s_mul_i32 s64, s7, 2
s_and_b32 s64, s64, 7
s_or_b32 s69, s69, s64
s_add_u32 s93, s65, s5
s_and_b32 s93, s93, 0
s_mul_i32 s64, s7, 1
s_and_b32 s64, s64, 7
s_or_b32 s93, s93, s64
s_lshl_b32 s70, s69, 7
s_lshl_b32 s75, s69, 19
s_lshr_b32 s54, s3, 1
s_and_b32 s55, s3, 1
s_lshl3_add_u32 s87, s54, s5
s_lshl_b32 s64, s55, 5
s_add_u32 s68, s87, s64
s_lshl_b32 s68, s68, 15
s_lshl_b32 s73, s3, 13
s_add_u32 s73, s73, 65536
s_lshl1_add_u32 s74, s4, s55
s_lshl_b32 s74, s74, 7
s_lshl_b32 s64, s54, 18
s_add_u32 s74, s74, s64
s_lshl_b32 s77, s3, 12
s_add_u32 s71, s68, s70
s_add_u32 s76, s74, s75
s_mov_b32 s10, 2097152
s_mov_b32 s11, 0x20000
s_mov_b32 s58, 4194304
s_mov_b32 s59, 0x20000
s_waitcnt lgkmcnt(0)
s_add_u32 m0, s73, 0
s_add_u32 s64, s71, 0
buffer_load_dwordx4 v5, s[8:11], s64 offen lds
buffer_load_dwordx4 v6, s[8:11], s64 offen offset:1024 lds
s_add_u32 m0, s73, 2048
s_add_u32 s64, s71, 16384
buffer_load_dwordx4 v5, s[8:11], s64 offen lds
buffer_load_dwordx4 v6, s[8:11], s64 offen offset:1024 lds
s_add_u32 m0, s77, 0
s_add_u32 s64, s76, 0
buffer_load_dwordx4 v7, s[56:59], s64 offen lds
buffer_load_dwordx4 v8, s[56:59], s64 offen offset:1024 lds
s_add_u32 m0, s77, 2048
s_add_u32 s64, s76, 131072
buffer_load_dwordx4 v7, s[56:59], s64 offen lds
buffer_load_dwordx4 v8, s[56:59], s64 offen offset:1024 lds
s_add_u32 m0, s73, 4096
s_add_u32 s64, s71, 524288
buffer_load_dwordx4 v5, s[8:11], s64 offen lds
buffer_load_dwordx4 v6, s[8:11], s64 offen offset:1024 lds
s_add_u32 m0, s73, 6144
s_add_u32 s64, s71, 540672
buffer_load_dwordx4 v5, s[8:11], s64 offen lds
buffer_load_dwordx4 v6, s[8:11], s64 offen offset:1024 lds
s_mov_b32 s18, 4194304
s_mov_b32 s19, 0x20000
s_lshl_b32 s65, s54, 7
s_lshl_b32 s53, s55, 12
v_lshrrev_b32 v16, 1, v2
v_xor_b32 v16, v16, v3
v_add_u32 v17, s65, v2
v_lshlrev_b32 v17, 7, v17
v_add_u32 v17, 65536, v17
v_lshl_add_u32 v9, v16, 4, v17
v_xor_b32 v10, 64, v9
v_bfe_u32 v16, v1, 2, 2
v_lshl_add_u32 v17, v3, 3, v16
v_lshlrev_b32 v17, 7, v17
v_and_b32 v18, 3, v1
v_lshl_add_u32 v17, v18, 3, v17
v_add_u32 v17, s53, v17
v_lshrrev_b32 v16, 1, v16
v_and_b32 v18, 1, v3
v_lshl_add_u32 v16, v18, 1, v16
v_xor_b32 v18, 0, v16
v_lshl_add_u32 v11, v18, 5, v17
v_xor_b32 v18, 1, v16
v_lshl_add_u32 v12, v18, 5, v17
v_xor_b32 v18, 2, v16
v_lshl_add_u32 v13, v18, 5, v17
v_xor_b32 v18, 3, v16
v_lshl_add_u32 v14, v18, 5, v17
s_add_u32 m0, s77, 16384
s_add_u32 s64, s76, 0
buffer_load_dwordx4 v7, s[16:19], s64 offen lds
buffer_load_dwordx4 v8, s[16:19], s64 offen offset:1024 lds
s_add_u32 m0, s77, 18432
s_add_u32 s64, s76, 131072
buffer_load_dwordx4 v7, s[16:19], s64 offen lds
buffer_load_dwordx4 v8, s[16:19], s64 offen offset:1024 lds
s_mov_b64 exec, 0
s_cmp_eq_u32 s3, 0
s_cbranch_scc1 L_PAD0
s_cmp_eq_u32 s3, 1
s_cbranch_scc1 L_PAD1
s_cmp_eq_u32 s3, 2
s_cbranch_scc1 L_PAD2
s_branch L_PAD3
.p2align 12
.fill 578, 4, 0xbf800000
L_MAIN:
s_mov_b64 exec, -1
s_xor_b32 s71, s70, 128
s_add_u32 s71, s68, s71
s_add_u32 m0, s73, 32768
s_add_u32 s64, s71, 0
buffer_load_dwordx4 v5, s[8:11], s64 offen lds
buffer_load_dwordx4 v6, s[8:11], s64 offen offset:1024 lds
s_add_u32 m0, s73, 34816
s_add_u32 s64, s71, 16384
buffer_load_dwordx4 v5, s[8:11], s64 offen lds
buffer_load_dwordx4 v6, s[8:11], s64 offen offset:1024 lds
s_add_u32 m0, s73, 36864
s_add_u32 s64, s71, 524288
buffer_load_dwordx4 v5, s[8:11], s64 offen lds
buffer_load_dwordx4 v6, s[8:11], s64 offen offset:1024 lds
s_add_u32 m0, s73, 38912
s_add_u32 s64, s71, 540672
buffer_load_dwordx4 v5, s[8:11], s64 offen lds
buffer_load_dwordx4 v6, s[8:11], s64 offen offset:1024 lds
s_waitcnt vmcnt(12)
s_barrier
ds_read_b128 a[64:67], v9 offset:0
ds_read_b128 a[68:71], v10 offset:0
ds_read_b64_tr_b16 a[128:129], v11 offset:0
ds_read_b64_tr_b16 a[130:131], v11 offset:512
ds_read_b64_tr_b16 a[132:133], v11 offset:8192
ds_read_b64_tr_b16 a[134:135], v11 offset:8704
ds_read_b64_tr_b16 a[136:137], v12 offset:0
ds_read_b64_tr_b16 a[138:139], v12 offset:512
ds_read_b64_tr_b16 a[140:141], v12 offset:8192
ds_read_b64_tr_b16 a[142:143], v12 offset:8704
ds_read_b64_tr_b16 a[144:145], v13 offset:0
ds_read_b64_tr_b16 a[146:147], v13 offset:512
ds_read_b64_tr_b16 a[148:149], v13 offset:8192
ds_read_b64_tr_b16 a[150:151], v13 offset:8704
ds_read_b64_tr_b16 a[152:153], v14 offset:0
ds_read_b64_tr_b16 a[154:155], v14 offset:512
ds_read_b64_tr_b16 a[156:157], v14 offset:8192
ds_read_b64_tr_b16 a[158:159], v14 offset:8704
ds_read_b128 a[72:75], v9 offset:2048
ds_read_b128 a[76:79], v10 offset:2048
ds_read_b128 a[80:83], v9 offset:4096
ds_read_b128 a[84:87], v10 offset:4096
ds_read_b128 a[88:91], v9 offset:6144
ds_read_b128 a[92:95], v10 offset:6144
s_waitcnt lgkmcnt(0)
v_mfma_f32_16x16x32_bf16 v[32:35], a[64:67], a[128:131], 0
s_waitcnt vmcnt(8)
v_mfma_f32_16x16x32_bf16 v[32:35], a[68:71], a[132:135], v[32:35]
s_barrier
v_mfma_f32_16x16x32_bf16 v[40:43], a[68:71], a[140:143], 0
s_mov_b32 s26, 268435456
s_mov_b32 s27, 0x20000
ds_read_b128 a[96:99], v9 offset:8192
v_mfma_f32_16x16x32_bf16 v[40:43], a[64:67], a[136:139], v[40:43]
s_xor_b32 s76, s75, 524288
s_add_u32 s76, s74, s76
s_mov_b32 s14, 2359296
v_mfma_f32_16x16x32_bf16 v[48:51], a[64:67], a[144:147], 0
s_add_u32 m0, s77, 32768
s_add_u32 s64, s76, 0
s_mov_b32 s15, 0x20000
v_mfma_f32_16x16x32_bf16 v[48:51], a[68:71], a[148:151], v[48:51]
buffer_load_dwordx4 v7, s[56:59], s64 offen lds
v_mfma_f32_16x16x32_bf16 v[56:59], a[68:71], a[156:159], 0
s_mov_b32 s22, 4718592
s_mov_b32 s23, 0x20000
ds_read_b128 a[100:103], v10 offset:8192
v_mfma_f32_16x16x32_bf16 v[56:59], a[64:67], a[152:155], v[56:59]
buffer_load_dwordx4 v8, s[56:59], s64 offen offset:1024 lds
v_mfma_f32_16x16x32_bf16 v[60:63], a[72:75], a[152:155], 0
s_add_u32 m0, s77, 34816
s_add_u32 s64, s76, 131072
ds_read_b128 a[104:107], v9 offset:10240
v_mfma_f32_16x16x32_bf16 v[60:63], a[76:79], a[156:159], v[60:63]
s_mov_b32 s30, 1990656
s_mov_b32 s31, 0x20000
s_mov_b32 s34, 4718592
v_mfma_f32_16x16x32_bf16 v[52:55], a[76:79], a[148:151], 0
buffer_load_dwordx4 v7, s[56:59], s64 offen lds
v_mfma_f32_16x16x32_bf16 v[52:55], a[72:75], a[144:147], v[52:55]
s_mov_b32 s35, 0x20000
ds_read_b64_tr_b16 a[160:161], v11 offset:16384
ds_read_b64_tr_b16 a[162:163], v11 offset:16896
v_mfma_f32_16x16x32_bf16 v[44:47], a[72:75], a[136:139], 0
s_mov_b32 s38, 1152
s_mov_b32 s39, 0x20000
s_mov_b32 s42, 256
v_mfma_f32_16x16x32_bf16 v[44:47], a[76:79], a[140:143], v[44:47]
buffer_load_dwordx4 v8, s[56:59], s64 offen offset:1024 lds
v_mfma_f32_16x16x32_bf16 v[36:39], a[76:79], a[132:135], 0
s_mov_b32 s43, 0x20000
s_mov_b32 s46, 2359296
s_mov_b32 s47, 0x20000
v_mfma_f32_16x16x32_bf16 v[36:39], a[72:75], a[128:131], v[36:39]
s_add_u32 m0, s77, 49152
s_add_u32 s64, s76, 0
ds_read_b128 a[108:111], v10 offset:10240
v_mfma_f32_16x16x32_bf16 v[64:67], a[80:83], a[128:131], 0
s_mov_b32 s50, 663552
s_mov_b32 s51, 0x20000
s_lshl_b32 s89, s4, 10
v_mfma_f32_16x16x32_bf16 v[64:67], a[84:87], a[132:135], v[64:67]
buffer_load_dwordx4 v7, s[16:19], s64 offen lds
v_mfma_f32_16x16x32_bf16 v[72:75], a[84:87], a[140:143], 0
s_add_u32 s89, s89, 75497472
ds_read_b64_tr_b16 a[164:165], v11 offset:24576
ds_read_b64_tr_b16 a[166:167], v11 offset:25088
v_mfma_f32_16x16x32_bf16 v[72:75], a[80:83], a[136:139], v[72:75]
s_mul_i32 s94, s4, 1064960
s_cmp_eq_u32 s66, 0
s_cselect_b32 s52, s89, 2147418112
v_mfma_f32_16x16x32_bf16 v[80:83], a[80:83], a[144:147], 0
buffer_load_dwordx4 v8, s[16:19], s64 offen offset:1024 lds
v_mfma_f32_16x16x32_bf16 v[80:83], a[84:87], a[148:151], v[80:83]
s_add_u32 m0, s77, 51200
s_add_u32 s64, s76, 131072
ds_read_b128 a[112:115], v9 offset:12288
v_mfma_f32_16x16x32_bf16 v[88:91], a[84:87], a[156:159], 0
s_lshl_b32 s53, s5, 10
s_add_u32 s53, s53, s94
s_add_u32 s53, s53, 1048576
v_mfma_f32_16x16x32_bf16 v[88:91], a[80:83], a[152:155], v[88:91]
buffer_load_dwordx4 v7, s[16:19], s64 offen lds
v_mfma_f32_16x16x32_bf16 v[92:95], a[88:91], a[152:155], 0
ds_read_b64_tr_b16 a[168:169], v12 offset:16384
ds_read_b64_tr_b16 a[170:171], v12 offset:16896
v_mfma_f32_16x16x32_bf16 v[92:95], a[92:95], a[156:159], v[92:95]
s_cmp_eq_u32 s3, 1
s_cselect_b32 s52, s53, s52
s_mul_i32 s53, s2, 74
v_mfma_f32_16x16x32_bf16 v[84:87], a[92:95], a[148:151], 0
buffer_load_dwordx4 v8, s[16:19], s64 offen offset:1024 lds
v_mfma_f32_16x16x32_bf16 v[84:87], a[88:91], a[144:147], v[84:87]
s_add_u32 s53, s53, s55
s_lshl_b32 s53, s53, 10
s_add_u32 s53, s53, 54599680
v_mfma_f32_16x16x32_bf16 v[76:79], a[88:91], a[136:139], 0
s_cmp_ge_u32 s3, 2
s_cselect_b32 s52, s53, s52
ds_read_b128 a[116:119], v10 offset:12288
v_mfma_f32_16x16x32_bf16 v[76:79], a[92:95], a[140:143], v[76:79]
v_mov_b32 v16, 0
v_mov_b32 v17, 0
v_mfma_f32_16x16x32_bf16 v[68:71], a[92:95], a[132:135], 0
v_mov_b32 v18, 0
v_mov_b32 v19, 0
v_mfma_f32_16x16x32_bf16 v[68:71], a[88:91], a[128:131], v[68:71]
s_waitcnt lgkmcnt(6)
ds_read_b64_tr_b16 a[172:173], v12 offset:24576
ds_read_b64_tr_b16 a[174:175], v12 offset:25088
v_mfma_f32_16x16x32_bf16 v[96:99], a[96:99], a[128:131], 0
v_mfma_f32_16x16x32_bf16 v[96:99], a[100:103], a[132:135], v[96:99]
v_mfma_f32_16x16x32_bf16 v[104:107], a[100:103], a[140:143], 0
ds_read_b128 a[120:123], v9 offset:14336
v_mfma_f32_16x16x32_bf16 v[104:107], a[96:99], a[136:139], v[104:107]
v_mfma_f32_16x16x32_bf16 v[112:115], a[96:99], a[144:147], 0
v_mfma_f32_16x16x32_bf16 v[112:115], a[100:103], a[148:151], v[112:115]
ds_read_b64_tr_b16 a[176:177], v13 offset:16384
ds_read_b64_tr_b16 a[178:179], v13 offset:16896
v_mfma_f32_16x16x32_bf16 v[120:123], a[100:103], a[156:159], 0
v_mfma_f32_16x16x32_bf16 v[120:123], a[96:99], a[152:155], v[120:123]
v_mfma_f32_16x16x32_bf16 v[124:127], a[104:107], a[152:155], 0
v_mfma_f32_16x16x32_bf16 v[124:127], a[108:111], a[156:159], v[124:127]
ds_read_b128 a[124:127], v10 offset:14336
v_mfma_f32_16x16x32_bf16 v[116:119], a[108:111], a[148:151], 0
v_add_u32 v9, 32768, v9
v_add_u32 v10, 32768, v10
v_mfma_f32_16x16x32_bf16 v[116:119], a[104:107], a[144:147], v[116:119]
v_mfma_f32_16x16x32_bf16 v[108:111], a[104:107], a[136:139], 0
ds_read_b64_tr_b16 a[180:181], v13 offset:24576
ds_read_b64_tr_b16 a[182:183], v13 offset:25088
v_mfma_f32_16x16x32_bf16 v[108:111], a[108:111], a[140:143], v[108:111]
v_mfma_f32_16x16x32_bf16 v[100:103], a[108:111], a[132:135], 0
v_mfma_f32_16x16x32_bf16 v[100:103], a[104:107], a[128:131], v[100:103]
s_waitcnt lgkmcnt(2)
ds_read_b64_tr_b16 a[184:185], v14 offset:16384
ds_read_b64_tr_b16 a[186:187], v14 offset:16896
v_mfma_f32_16x16x32_bf16 v[128:131], a[112:115], a[128:131], 0
v_mfma_f32_16x16x32_bf16 v[128:131], a[116:119], a[132:135], v[128:131]
v_mfma_f32_16x16x32_bf16 v[136:139], a[116:119], a[140:143], 0
ds_read_b64_tr_b16 a[188:189], v14 offset:24576
ds_read_b64_tr_b16 a[190:191], v14 offset:25088
v_mfma_f32_16x16x32_bf16 v[136:139], a[112:115], a[136:139], v[136:139]
v_mfma_f32_16x16x32_bf16 v[144:147], a[112:115], a[144:147], 0
v_mfma_f32_16x16x32_bf16 v[144:147], a[116:119], a[148:151], v[144:147]
v_mfma_f32_16x16x32_bf16 v[152:155], a[116:119], a[156:159], 0
v_mfma_f32_16x16x32_bf16 v[152:155], a[112:115], a[152:155], v[152:155]
v_mfma_f32_16x16x32_bf16 v[156:159], a[120:123], a[152:155], 0
v_mfma_f32_16x16x32_bf16 v[156:159], a[124:127], a[156:159], v[156:159]
v_mfma_f32_16x16x32_bf16 v[148:151], a[124:127], a[148:151], 0
v_mfma_f32_16x16x32_bf16 v[148:151], a[120:123], a[144:147], v[148:151]
v_mfma_f32_16x16x32_bf16 v[140:143], a[120:123], a[136:139], 0
v_mfma_f32_16x16x32_bf16 v[140:143], a[124:127], a[140:143], v[140:143]
v_mfma_f32_16x16x32_bf16 v[132:135], a[124:127], a[132:135], 0
v_mfma_f32_16x16x32_bf16 v[132:135], a[120:123], a[128:131], v[132:135]
s_waitcnt lgkmcnt(0)
v_mfma_f32_16x16x32_bf16 v[160:163], a[160:163], a[64:67], 0
s_waitcnt vmcnt(4)
v_mfma_f32_16x16x32_bf16 v[160:163], a[164:167], a[68:71], v[160:163]
s_barrier
v_mfma_f32_16x16x32_bf16 v[164:167], a[172:175], a[68:71], 0
ds_read_b64_tr_b16 a[128:129], v11 offset:32768
ds_read_b64_tr_b16 a[130:131], v11 offset:33280
v_mfma_f32_16x16x32_bf16 v[164:167], a[168:171], a[64:67], v[164:167]
s_xor_b32 s71, s70, 256
s_add_u32 s71, s68, s71
v_mfma_f32_16x16x32_bf16 v[168:171], a[176:179], a[64:67], 0
s_add_u32 m0, s73, 65536
s_add_u32 s64, s71, 0
v_mfma_f32_16x16x32_bf16 v[168:171], a[180:183], a[68:71], v[168:171]
buffer_load_dwordx4 v5, s[8:11], s64 offen lds
v_mfma_f32_16x16x32_bf16 v[172:175], a[188:191], a[68:71], 0
v_mfma_f32_16x16x32_bf16 v[172:175], a[184:187], a[64:67], v[172:175]
ds_read_b128 a[64:67], v9 offset:0
v_mfma_f32_16x16x32_bf16 v[188:191], a[184:187], a[72:75], 0
buffer_load_dwordx4 v6, s[8:11], s64 offen offset:1024 lds
v_mfma_f32_16x16x32_bf16 v[188:191], a[188:191], a[76:79], v[188:191]
ds_read_b64_tr_b16 a[132:133], v11 offset:40960
ds_read_b64_tr_b16 a[134:135], v11 offset:41472
v_mfma_f32_16x16x32_bf16 v[184:187], a[180:183], a[76:79], 0
v_mfma_f32_16x16x32_bf16 v[184:187], a[176:179], a[72:75], v[184:187]
s_add_u32 m0, s73, 67584
s_add_u32 s64, s71, 16384
ds_read_b128 a[68:71], v10 offset:0
v_mfma_f32_16x16x32_bf16 v[180:183], a[168:171], a[72:75], 0
v_mfma_f32_16x16x32_bf16 v[180:183], a[172:175], a[76:79], v[180:183]
buffer_load_dwordx4 v5, s[8:11], s64 offen lds
v_mfma_f32_16x16x32_bf16 v[176:179], a[164:167], a[76:79], 0
v_mfma_f32_16x16x32_bf16 v[176:179], a[160:163], a[72:75], v[176:179]
ds_read_b64_tr_b16 a[136:137], v12 offset:32768
ds_read_b64_tr_b16 a[138:139], v12 offset:33280
v_mfma_f32_16x16x32_bf16 v[192:195], a[160:163], a[80:83], 0
v_mfma_f32_16x16x32_bf16 v[192:195], a[164:167], a[84:87], v[192:195]
v_mfma_f32_16x16x32_bf16 v[196:199], a[172:175], a[84:87], 0
buffer_load_dwordx4 v6, s[8:11], s64 offen offset:1024 lds
v_mfma_f32_16x16x32_bf16 v[196:199], a[168:171], a[80:83], v[196:199]
s_xor_b32 s76, s75, 1048576
s_add_u32 s76, s74, s76
ds_read_b128 a[72:75], v9 offset:2048
v_mfma_f32_16x16x32_bf16 v[200:203], a[176:179], a[80:83], 0
L_PAD0:
s_cbranch_execz L_PAD4
v_mfma_f32_16x16x32_bf16 v[200:203], a[180:183], a[84:87], v[200:203]
s_add_u32 m0, s77, 0
s_add_u32 s64, s76, 0
v_mfma_f32_16x16x32_bf16 v[204:207], a[188:191], a[84:87], 0
ds_read_b64_tr_b16 a[140:141], v12 offset:40960
ds_read_b64_tr_b16 a[142:143], v12 offset:41472
v_mfma_f32_16x16x32_bf16 v[204:207], a[184:187], a[80:83], v[204:207]
buffer_load_dwordx4 v7, s[56:59], s64 offen lds
v_mfma_f32_16x16x32_bf16 v[220:223], a[184:187], a[88:91], 0
ds_read_b128 a[76:79], v10 offset:2048
v_mfma_f32_16x16x32_bf16 v[220:223], a[188:191], a[92:95], v[220:223]
v_mfma_f32_16x16x32_bf16 v[216:219], a[180:183], a[92:95], 0
v_mfma_f32_16x16x32_bf16 v[216:219], a[176:179], a[88:91], v[216:219]
v_mfma_f32_16x16x32_bf16 v[212:215], a[168:171], a[88:91], 0
buffer_load_dwordx4 v8, s[56:59], s64 offen offset:1024 lds
v_mfma_f32_16x16x32_bf16 v[212:215], a[172:175], a[92:95], v[212:215]
ds_read_b64_tr_b16 a[144:145], v13 offset:32768
ds_read_b64_tr_b16 a[146:147], v13 offset:33280
v_mfma_f32_16x16x32_bf16 v[208:211], a[164:167], a[92:95], 0
v_mfma_f32_16x16x32_bf16 v[208:211], a[160:163], a[88:91], v[208:211]
s_add_u32 m0, s77, 2048
s_add_u32 s64, s76, 131072
ds_read_b128 a[80:83], v9 offset:4096
v_mfma_f32_16x16x32_bf16 v[224:227], a[160:163], a[96:99], 0
v_mfma_f32_16x16x32_bf16 v[224:227], a[164:167], a[100:103], v[224:227]
buffer_load_dwordx4 v7, s[56:59], s64 offen lds
v_mfma_f32_16x16x32_bf16 v[228:231], a[172:175], a[100:103], 0
ds_read_b64_tr_b16 a[148:149], v13 offset:40960
ds_read_b64_tr_b16 a[150:151], v13 offset:41472
v_mfma_f32_16x16x32_bf16 v[228:231], a[168:171], a[96:99], v[228:231]
v_mfma_f32_16x16x32_bf16 v[232:235], a[176:179], a[96:99], 0
buffer_store_dwordx4 v[16:19], v4, s[24:27], s52 offen sc1
v_mfma_f32_16x16x32_bf16 v[232:235], a[180:183], a[100:103], v[232:235]
buffer_load_dwordx4 v8, s[56:59], s64 offen offset:1024 lds
v_mfma_f32_16x16x32_bf16 v[236:239], a[188:191], a[100:103], 0
s_add_u32 s89, s89, 512
ds_read_b128 a[84:87], v10 offset:4096
v_mfma_f32_16x16x32_bf16 v[236:239], a[184:187], a[96:99], v[236:239]
s_cmp_eq_u32 s3, 0
s_cselect_b32 s90, s89, 2147418112
v_mov_b32 v24, 2147418112
v_mfma_f32_16x16x32_bf16 v[252:255], a[184:187], a[104:107], 0
s_add_u32 m0, s73, 69632
s_add_u32 s64, s71, 524288
v_cmp_eq_u32 vcc, 1, v1
v_mfma_f32_16x16x32_bf16 v[252:255], a[188:191], a[108:111], v[252:255]
s_lshl_b32 s53, s55, 12
ds_read_b64_tr_b16 a[152:153], v14 offset:32768
ds_read_b64_tr_b16 a[154:155], v14 offset:33280
v_mfma_f32_16x16x32_bf16 v[248:251], a[180:183], a[108:111], 0
buffer_load_dwordx4 v5, s[8:11], s64 offen lds
v_mfma_f32_16x16x32_bf16 v[248:251], a[176:179], a[104:107], v[248:251]
v_cndmask_b32 v0, v24, 0, vcc
v_mfma_f32_16x16x32_bf16 v[244:247], a[168:171], a[104:107], 0
s_mul_i32 s87, s87, 16384
s_add_u32 s87, s87, s94
ds_read_b128 a[88:91], v9 offset:6144
v_mfma_f32_16x16x32_bf16 v[244:247], a[172:175], a[108:111], v[244:247]
s_add_u32 s88, s87, s53
s_add_u32 s88, s88, 24576
s_lshr_b32 s53, s53, 1
v_mfma_f32_16x16x32_bf16 v[240:243], a[164:167], a[108:111], 0
s_add_u32 s87, s87, s53
s_lshl_b32 s80, s3, 10
s_mul_i32 s78, s4, 18
v_mfma_f32_16x16x32_bf16 v[240:243], a[160:163], a[104:107], v[240:243]
buffer_load_dwordx4 v6, s[8:11], s64 offen offset:1024 lds
v_mfma_f32_16x16x32_bf16 a[0:3], a[160:163], a[112:115], 0
s_add_u32 s78, s78, s54
ds_read_b64_tr_b16 a[156:157], v14 offset:40960
ds_read_b64_tr_b16 a[158:159], v14 offset:41472
v_mfma_f32_16x16x32_bf16 a[0:3], a[164:167], a[116:119], a[0:3]
s_lshl2_add_u32 s78, s78, s55
s_lshl_b32 s78, s78, 10
s_add_u32 s78, s78, 35651584
v_mfma_f32_16x16x32_bf16 a[4:7], a[172:175], a[116:119], 0
s_add_u32 m0, s73, 71680
s_add_u32 s64, s71, 540672
ds_read_b128 a[92:95], v10 offset:6144
v_mfma_f32_16x16x32_bf16 a[4:7], a[168:171], a[112:115], a[4:7]
s_add_u32 s80, s80, 8192
s_mov_b32 s91, 0x3e0293ee
s_mov_b32 s85, 0x05040100
v_mfma_f32_16x16x32_bf16 a[8:11], a[176:179], a[112:115], 0
buffer_load_dwordx4 v5, s[8:11], s64 offen lds
v_mfma_f32_16x16x32_bf16 a[8:11], a[180:183], a[116:119], a[8:11]
s_mov_b32 s86, 0x07060302
s_lshl2_add_u32 s52, s7, s3
s_xor_b32 s92, s6, 31
v_mfma_f32_16x16x32_bf16 a[12:15], a[188:191], a[116:119], 0
s_mul_i32 s81, s92, 110592
s_mul_i32 s65, s52, 36
s_add_u32 s81, s81, s65
v_mfma_f32_16x16x32_bf16 a[12:15], a[184:187], a[112:115], a[12:15]
s_mul_i32 s82, s52, 18
s_add_u32 s82, s82, s92
s_lshl_b32 s82, s82, 12
v_mfma_f32_16x16x32_bf16 a[28:31], a[184:187], a[120:123], 0
s_add_u32 s82, s82, 35651584
s_lshl_b32 s83, s92, 6
s_lshl_b32 s84, s52, 10
v_mfma_f32_16x16x32_bf16 a[28:31], a[188:191], a[124:127], a[28:31]
buffer_load_dwordx4 v6, s[8:11], s64 offen offset:1024 lds
v_mfma_f32_16x16x32_bf16 a[24:27], a[180:183], a[124:127], 0
s_add_u32 s84, s84, 75497984
v_mfma_f32_16x16x32_bf16 a[24:27], a[176:179], a[120:123], a[24:27]
s_cmp_lt_u32 s92, 18
s_cselect_b32 s82, s82, 2147418112
s_cselect_b32 s84, s84, 2147418112
v_mfma_f32_16x16x32_bf16 a[20:23], a[168:171], a[120:123], 0
v_lshrrev_b32 v18, 2, v2
v_and_b32 v19, 3, v2
v_mfma_f32_16x16x32_bf16 a[20:23], a[172:175], a[124:127], a[20:23]
v_mul_u32_u24 v20, 1152, v18
v_cmp_eq_u32 vcc, 2, v19
v_mfma_f32_16x16x32_bf16 a[16:19], a[164:167], a[124:127], 0
v_lshl_add_u32 v20, v19, 3, v20
v_add_u32 v21, 1, v19
v_mfma_f32_16x16x32_bf16 a[16:19], a[160:163], a[120:123], a[16:19]
s_waitcnt lgkmcnt(0)
v_cndmask_b32 v21, v21, 0, vcc
v_cmp_eq_u32 vcc, 3, v18
v_mfma_f32_16x16x32_bf16 v[32:35], a[64:67], a[128:131], v[32:35]
s_waitcnt vmcnt(13)
v_mul_u32_u24 v21, 1152, v21
v_add_u32 v21, 32, v21
v_mfma_f32_16x16x32_bf16 v[32:35], a[68:71], a[132:135], v[32:35]
s_barrier
v_mfma_f32_16x16x32_bf16 v[40:43], a[68:71], a[140:143], v[40:43]
ds_read_b128 a[96:99], v9 offset:8192
v_cndmask_b32 v20, v20, v21, vcc
v_mfma_f32_16x16x32_bf16 v[40:43], a[64:67], a[136:139], v[40:43]
s_add_u32 m0, s77, 16384
s_add_u32 s64, s76, 0
v_cmp_eq_u32 vcc, 15, v2
v_mfma_f32_16x16x32_bf16 v[48:51], a[64:67], a[144:147], v[48:51]
buffer_load_dwordx4 v7, s[16:19], s64 offen lds
v_mfma_f32_16x16x32_bf16 v[48:51], a[68:71], a[148:151], v[48:51]
ds_read_b128 a[100:103], v10 offset:8192
v_mul_u32_u24 v21, 27648, v3
v_mfma_f32_16x16x32_bf16 v[56:59], a[68:71], a[156:159], v[56:59]
v_add_u32 v20, v20, v21
v_lshlrev_b32 v21, 4, v3
v_mfma_f32_16x16x32_bf16 v[56:59], a[64:67], a[152:155], v[56:59]
v_cndmask_b32 v26, v20, v24, vcc
v_cndmask_b32 v27, v24, v21, vcc
v_mfma_f32_16x16x32_bf16 v[60:63], a[72:75], a[152:155], v[60:63]
buffer_load_dwordx4 v8, s[16:19], s64 offen offset:1024 lds
v_mfma_f32_16x16x32_bf16 v[60:63], a[76:79], a[156:159], v[60:63]
ds_read_b128 a[104:107], v9 offset:10240
v_and_b32 v18, 7, v1
v_mfma_f32_16x16x32_bf16 v[52:55], a[76:79], a[148:151], v[52:55]
v_cmp_gt_u32 vcc, 48, v1
v_mul_u32_u24 v18, 3456, v18
v_mfma_f32_16x16x32_bf16 v[52:55], a[72:75], a[144:147], v[52:55]
s_add_u32 m0, s77, 18432
s_add_u32 s64, s76, 131072
v_mul_u32_u24 v19, 1152, v3
v_mfma_f32_16x16x32_bf16 v[44:47], a[72:75], a[136:139], v[44:47]
ds_read_b64_tr_b16 a[160:161], v11 offset:49152
ds_read_b64_tr_b16 a[162:163], v11 offset:49664
v_mfma_f32_16x16x32_bf16 v[44:47], a[76:79], a[140:143], v[44:47]
buffer_load_dwordx4 v7, s[16:19], s64 offen lds
v_mfma_f32_16x16x32_bf16 v[36:39], a[76:79], a[132:135], v[36:39]
v_bfe_u32 v20, v1, 3, 1
v_mul_u32_u24 v20, 140, v20
v_mfma_f32_16x16x32_bf16 v[36:39], a[72:75], a[128:131], v[36:39]
ds_read_b128 a[108:111], v10 offset:10240
v_add3_u32 v18, v18, v19, v20
v_mfma_f32_16x16x32_bf16 v[64:67], a[80:83], a[128:131], v[64:67]
v_cndmask_b32 v28, v24, v18, vcc
v_mfma_f32_16x16x32_bf16 v[64:67], a[84:87], a[132:135], v[64:67]
s_lshl_b32 s52, s4, 2
s_cmp_eq_u32 s66, 0
s_cselect_b32 s52, s52, 2147418112
v_mfma_f32_16x16x32_bf16 v[72:75], a[84:87], a[140:143], v[72:75]
buffer_load_dwordx4 v8, s[16:19], s64 offen offset:1024 lds
v_mfma_f32_16x16x32_bf16 v[72:75], a[80:83], a[136:139], v[72:75]
s_xor_b32 s71, s70, 384
s_add_u32 s71, s68, s71
v_mfma_f32_16x16x32_bf16 v[80:83], a[80:83], a[144:147], v[80:83]
ds_read_b64_tr_b16 a[164:165], v11 offset:57344
ds_read_b64_tr_b16 a[166:167], v11 offset:57856
v_mfma_f32_16x16x32_bf16 v[80:83], a[84:87], a[148:151], v[80:83]
s_add_u32 m0, s73, 0
s_add_u32 s64, s71, 0
ds_read_b128 a[112:115], v9 offset:12288
v_mfma_f32_16x16x32_bf16 v[88:91], a[84:87], a[156:159], v[88:91]
v_mfma_f32_16x16x32_bf16 v[88:91], a[80:83], a[152:155], v[88:91]
buffer_load_dwordx4 v5, s[8:11], s64 offen lds
v_mfma_f32_16x16x32_bf16 v[92:95], a[88:91], a[152:155], v[92:95]
ds_read_b64_tr_b16 a[168:169], v12 offset:49152
ds_read_b64_tr_b16 a[170:171], v12 offset:49664
v_mfma_f32_16x16x32_bf16 v[92:95], a[92:95], a[156:159], v[92:95]
v_mfma_f32_16x16x32_bf16 v[84:87], a[92:95], a[148:151], v[84:87]
v_mfma_f32_16x16x32_bf16 v[84:87], a[88:91], a[144:147], v[84:87]
v_mfma_f32_16x16x32_bf16 v[76:79], a[88:91], a[136:139], v[76:79]
buffer_load_dwordx4 v6, s[8:11], s64 offen offset:1024 lds
v_mfma_f32_16x16x32_bf16 v[76:79], a[92:95], a[140:143], v[76:79]
ds_read_b128 a[116:119], v10 offset:12288
v_mfma_f32_16x16x32_bf16 v[68:71], a[92:95], a[132:135], v[68:71]
v_mfma_f32_16x16x32_bf16 v[68:71], a[88:91], a[128:131], v[68:71]
s_add_u32 m0, s73, 2048
s_add_u32 s64, s71, 16384
s_waitcnt lgkmcnt(6)
v_mfma_f32_16x16x32_bf16 v[96:99], a[96:99], a[128:131], v[96:99]
ds_read_b64_tr_b16 a[172:173], v12 offset:57344
ds_read_b64_tr_b16 a[174:175], v12 offset:57856
v_mfma_f32_16x16x32_bf16 v[96:99], a[100:103], a[132:135], v[96:99]
buffer_load_dwordx4 v5, s[8:11], s64 offen lds
v_mfma_f32_16x16x32_bf16 v[104:107], a[100:103], a[140:143], v[104:107]
ds_read_b128 a[120:123], v9 offset:14336
v_mfma_f32_16x16x32_bf16 v[104:107], a[96:99], a[136:139], v[104:107]
v_mfma_f32_16x16x32_bf16 v[112:115], a[96:99], a[144:147], v[112:115]
v_mfma_f32_16x16x32_bf16 v[112:115], a[100:103], a[148:151], v[112:115]
buffer_load_dwordx4 v6, s[8:11], s64 offen offset:1024 lds
v_mfma_f32_16x16x32_bf16 v[120:123], a[100:103], a[156:159], v[120:123]
s_xor_b32 s76, s75, 1572864
s_add_u32 s76, s74, s76
v_mfma_f32_16x16x32_bf16 v[120:123], a[96:99], a[152:155], v[120:123]
ds_read_b64_tr_b16 a[176:177], v13 offset:49152
ds_read_b64_tr_b16 a[178:179], v13 offset:49664
v_mfma_f32_16x16x32_bf16 v[124:127], a[104:107], a[152:155], v[124:127]
s_add_u32 m0, s77, 32768
s_add_u32 s64, s76, 0
v_mfma_f32_16x16x32_bf16 v[124:127], a[108:111], a[156:159], v[124:127]
ds_read_b128 a[124:127], v10 offset:14336
v_mfma_f32_16x16x32_bf16 v[116:119], a[108:111], a[148:151], v[116:119]
buffer_load_dwordx4 v7, s[56:59], s64 offen lds
v_mfma_f32_16x16x32_bf16 v[116:119], a[104:107], a[144:147], v[116:119]
s_waitcnt vmcnt(14)
v_add_u32 v9, 32768, v9
v_add_u32 v10, 32768, v10
v_mfma_f32_16x16x32_bf16 v[108:111], a[104:107], a[136:139], v[108:111]
ds_read_b64_tr_b16 a[180:181], v13 offset:57344
ds_read_b64_tr_b16 a[182:183], v13 offset:57856
v_mfma_f32_16x16x32_bf16 v[108:111], a[108:111], a[140:143], v[108:111]
buffer_store_dword v1, v0, s[40:43], s52 offen sc1
v_mfma_f32_16x16x32_bf16 v[100:103], a[108:111], a[132:135], v[100:103]
s_waitcnt lgkmcnt(2)
v_mfma_f32_16x16x32_bf16 v[100:103], a[104:107], a[128:131], v[100:103]
buffer_load_dwordx4 v8, s[56:59], s64 offen offset:1024 lds
v_mfma_f32_16x16x32_bf16 v[128:131], a[112:115], a[128:131], v[128:131]
ds_read_b64_tr_b16 a[184:185], v14 offset:49152
ds_read_b64_tr_b16 a[186:187], v14 offset:49664
v_mfma_f32_16x16x32_bf16 v[128:131], a[116:119], a[132:135], v[128:131]
v_mfma_f32_16x16x32_bf16 v[136:139], a[116:119], a[140:143], v[136:139]
s_add_u32 m0, s77, 34816
s_add_u32 s64, s76, 131072
v_mfma_f32_16x16x32_bf16 v[136:139], a[112:115], a[136:139], v[136:139]
ds_read_b64_tr_b16 a[188:189], v14 offset:57344
ds_read_b64_tr_b16 a[190:191], v14 offset:57856
v_mfma_f32_16x16x32_bf16 v[144:147], a[112:115], a[144:147], v[144:147]
buffer_load_dwordx4 v7, s[56:59], s64 offen lds
v_mfma_f32_16x16x32_bf16 v[144:147], a[116:119], a[148:151], v[144:147]
v_mfma_f32_16x16x32_bf16 v[152:155], a[116:119], a[156:159], v[152:155]
v_mfma_f32_16x16x32_bf16 v[152:155], a[112:115], a[152:155], v[152:155]
v_mfma_f32_16x16x32_bf16 v[156:159], a[120:123], a[152:155], v[156:159]
v_mfma_f32_16x16x32_bf16 v[156:159], a[124:127], a[156:159], v[156:159]
buffer_load_dwordx4 v8, s[56:59], s64 offen offset:1024 lds
v_mfma_f32_16x16x32_bf16 v[148:151], a[124:127], a[148:151], v[148:151]
v_mfma_f32_16x16x32_bf16 v[148:151], a[120:123], a[144:147], v[148:151]
v_mfma_f32_16x16x32_bf16 v[140:143], a[120:123], a[136:139], v[140:143]
v_mfma_f32_16x16x32_bf16 v[140:143], a[124:127], a[140:143], v[140:143]
v_mfma_f32_16x16x32_bf16 v[132:135], a[124:127], a[132:135], v[132:135]
v_mfma_f32_16x16x32_bf16 v[132:135], a[120:123], a[128:131], v[132:135]
s_waitcnt lgkmcnt(0)
v_mfma_f32_16x16x32_bf16 v[160:163], a[160:163], a[64:67], v[160:163]
s_waitcnt vmcnt(13)
v_mfma_f32_16x16x32_bf16 v[160:163], a[164:167], a[68:71], v[160:163]
s_barrier
v_mfma_f32_16x16x32_bf16 v[164:167], a[172:175], a[68:71], v[164:167]
s_xor_b32 s52, s6, 31
ds_read_b64_tr_b16 a[128:129], v11 offset:0
ds_read_b64_tr_b16 a[130:131], v11 offset:512
v_mfma_f32_16x16x32_bf16 v[164:167], a[168:171], a[64:67], v[164:167]
s_add_u32 m0, s73, 4096
s_add_u32 s64, s71, 524288
s_mul_i32 s52, s52, 110592
v_mfma_f32_16x16x32_bf16 v[168:171], a[176:179], a[64:67], v[168:171]
buffer_load_dwordx4 v5, s[8:11], s64 offen lds
v_mfma_f32_16x16x32_bf16 v[168:171], a[180:183], a[68:71], v[168:171]
s_mul_i32 s53, s3, 27648
s_add_u32 s52, s52, s53
s_mul_i32 s53, s7, 144
v_mfma_f32_16x16x32_bf16 v[172:175], a[188:191], a[68:71], v[172:175]
s_add_u32 s52, s52, s53
v_mfma_f32_16x16x32_bf16 v[172:175], a[184:187], a[64:67], v[172:175]
ds_read_b128 a[64:67], v9 offset:0
v_mfma_f32_16x16x32_bf16 v[188:191], a[184:187], a[72:75], v[188:191]
buffer_load_dwordx4 v6, s[8:11], s64 offen offset:1024 lds
v_mfma_f32_16x16x32_bf16 v[188:191], a[188:191], a[76:79], v[188:191]
ds_read_b64_tr_b16 a[132:133], v11 offset:8192
ds_read_b64_tr_b16 a[134:135], v11 offset:8704
v_mfma_f32_16x16x32_bf16 v[184:187], a[180:183], a[76:79], v[184:187]
buffer_load_dword a252, v28, s[28:31], s52 offen
v_mfma_f32_16x16x32_bf16 v[184:187], a[176:179], a[72:75], v[184:187]
s_add_u32 m0, s73, 6144
s_add_u32 s64, s71, 540672
ds_read_b128 a[68:71], v10 offset:0
v_mfma_f32_16x16x32_bf16 v[180:183], a[168:171], a[72:75], v[180:183]
v_mfma_f32_16x16x32_bf16 v[180:183], a[172:175], a[76:79], v[180:183]
buffer_load_dwordx4 v5, s[8:11], s64 offen lds
v_mfma_f32_16x16x32_bf16 v[176:179], a[164:167], a[76:79], v[176:179]
v_mfma_f32_16x16x32_bf16 v[176:179], a[160:163], a[72:75], v[176:179]
ds_read_b64_tr_b16 a[136:137], v12 offset:0
ds_read_b64_tr_b16 a[138:139], v12 offset:512
v_mfma_f32_16x16x32_bf16 v[192:195], a[160:163], a[80:83], v[192:195]
v_mfma_f32_16x16x32_bf16 v[192:195], a[164:167], a[84:87], v[192:195]
v_mfma_f32_16x16x32_bf16 v[196:199], a[172:175], a[84:87], v[196:199]
buffer_load_dwordx4 v6, s[8:11], s64 offen offset:1024 lds
v_mfma_f32_16x16x32_bf16 v[196:199], a[168:171], a[80:83], v[196:199]
ds_read_b128 a[72:75], v9 offset:2048
v_mfma_f32_16x16x32_bf16 v[200:203], a[176:179], a[80:83], v[200:203]
v_mfma_f32_16x16x32_bf16 v[200:203], a[180:183], a[84:87], v[200:203]
s_add_u32 m0, s77, 49152
s_add_u32 s64, s76, 0
v_mfma_f32_16x16x32_bf16 v[204:207], a[188:191], a[84:87], v[204:207]
ds_read_b64_tr_b16 a[140:141], v12 offset:8192
ds_read_b64_tr_b16 a[142:143], v12 offset:8704
v_mfma_f32_16x16x32_bf16 v[204:207], a[184:187], a[80:83], v[204:207]
buffer_load_dwordx4 v7, s[16:19], s64 offen lds
v_mfma_f32_16x16x32_bf16 v[220:223], a[184:187], a[88:91], v[220:223]
ds_read_b128 a[76:79], v10 offset:2048
v_mfma_f32_16x16x32_bf16 v[220:223], a[188:191], a[92:95], v[220:223]
v_mfma_f32_16x16x32_bf16 v[216:219], a[180:183], a[92:95], v[216:219]
v_mfma_f32_16x16x32_bf16 v[216:219], a[176:179], a[88:91], v[216:219]
v_mfma_f32_16x16x32_bf16 v[212:215], a[168:171], a[88:91], v[212:215]
buffer_load_dwordx4 v8, s[16:19], s64 offen offset:1024 lds
v_mfma_f32_16x16x32_bf16 v[212:215], a[172:175], a[92:95], v[212:215]
ds_read_b64_tr_b16 a[144:145], v13 offset:0
ds_read_b64_tr_b16 a[146:147], v13 offset:512
v_mfma_f32_16x16x32_bf16 v[208:211], a[164:167], a[92:95], v[208:211]
v_mfma_f32_16x16x32_bf16 v[208:211], a[160:163], a[88:91], v[208:211]
s_add_u32 m0, s77, 51200
s_add_u32 s64, s76, 131072
ds_read_b128 a[80:83], v9 offset:4096
v_mfma_f32_16x16x32_bf16 v[224:227], a[160:163], a[96:99], v[224:227]
v_mfma_f32_16x16x32_bf16 v[224:227], a[164:167], a[100:103], v[224:227]
buffer_load_dwordx4 v7, s[16:19], s64 offen lds
v_mfma_f32_16x16x32_bf16 v[228:231], a[172:175], a[100:103], v[228:231]
ds_read_b64_tr_b16 a[148:149], v13 offset:8192
ds_read_b64_tr_b16 a[150:151], v13 offset:8704
v_mfma_f32_16x16x32_bf16 v[228:231], a[168:171], a[96:99], v[228:231]
v_mfma_f32_16x16x32_bf16 v[232:235], a[176:179], a[96:99], v[232:235]
v_mfma_f32_16x16x32_bf16 v[232:235], a[180:183], a[100:103], v[232:235]
buffer_load_dwordx4 v8, s[16:19], s64 offen offset:1024 lds
v_mfma_f32_16x16x32_bf16 v[236:239], a[188:191], a[100:103], v[236:239]
s_xor_b32 s71, s70, 512
s_add_u32 s71, s68, s71
ds_read_b128 a[84:87], v10 offset:4096
v_mfma_f32_16x16x32_bf16 v[236:239], a[184:187], a[96:99], v[236:239]
v_mfma_f32_16x16x32_bf16 v[252:255], a[184:187], a[104:107], v[252:255]
s_add_u32 m0, s73, 32768
s_add_u32 s64, s71, 0
v_mfma_f32_16x16x32_bf16 v[252:255], a[188:191], a[108:111], v[252:255]
ds_read_b64_tr_b16 a[152:153], v14 offset:0
ds_read_b64_tr_b16 a[154:155], v14 offset:512
v_mfma_f32_16x16x32_bf16 v[248:251], a[180:183], a[108:111], v[248:251]
buffer_load_dwordx4 v5, s[8:11], s64 offen lds
v_mfma_f32_16x16x32_bf16 v[248:251], a[176:179], a[104:107], v[248:251]
v_mfma_f32_16x16x32_bf16 v[244:247], a[168:171], a[104:107], v[244:247]
ds_read_b128 a[88:91], v9 offset:6144
v_mfma_f32_16x16x32_bf16 v[244:247], a[172:175], a[108:111], v[244:247]
v_mfma_f32_16x16x32_bf16 v[240:243], a[164:167], a[108:111], v[240:243]
v_mfma_f32_16x16x32_bf16 v[240:243], a[160:163], a[104:107], v[240:243]
buffer_load_dwordx4 v6, s[8:11], s64 offen offset:1024 lds
v_mfma_f32_16x16x32_bf16 a[0:3], a[160:163], a[112:115], a[0:3]
ds_read_b64_tr_b16 a[156:157], v14 offset:8192
ds_read_b64_tr_b16 a[158:159], v14 offset:8704
v_mfma_f32_16x16x32_bf16 a[0:3], a[164:167], a[116:119], a[0:3]
v_mfma_f32_16x16x32_bf16 a[4:7], a[172:175], a[116:119], a[4:7]
s_add_u32 m0, s73, 34816
s_add_u32 s64, s71, 16384
ds_read_b128 a[92:95], v10 offset:6144
v_mfma_f32_16x16x32_bf16 a[4:7], a[168:171], a[112:115], a[4:7]
v_mfma_f32_16x16x32_bf16 a[8:11], a[176:179], a[112:115], a[8:11]
buffer_load_dwordx4 v5, s[8:11], s64 offen lds
v_mfma_f32_16x16x32_bf16 a[8:11], a[180:183], a[116:119], a[8:11]
v_mfma_f32_16x16x32_bf16 a[12:15], a[188:191], a[116:119], a[12:15]
v_mfma_f32_16x16x32_bf16 a[12:15], a[184:187], a[112:115], a[12:15]
v_mfma_f32_16x16x32_bf16 a[28:31], a[184:187], a[120:123], a[28:31]
v_mfma_f32_16x16x32_bf16 a[28:31], a[188:191], a[124:127], a[28:31]
buffer_load_dwordx4 v6, s[8:11], s64 offen offset:1024 lds
v_mfma_f32_16x16x32_bf16 a[24:27], a[180:183], a[124:127], a[24:27]
v_mfma_f32_16x16x32_bf16 a[24:27], a[176:179], a[120:123], a[24:27]
v_mfma_f32_16x16x32_bf16 a[20:23], a[168:171], a[120:123], a[20:23]
v_mfma_f32_16x16x32_bf16 a[20:23], a[172:175], a[124:127], a[20:23]
v_mfma_f32_16x16x32_bf16 a[16:19], a[164:167], a[124:127], a[16:19]
v_mfma_f32_16x16x32_bf16 a[16:19], a[160:163], a[120:123], a[16:19]
s_waitcnt lgkmcnt(0)
v_mfma_f32_16x16x32_bf16 v[32:35], a[64:67], a[128:131], v[32:35]
s_waitcnt vmcnt(22)
v_mfma_f32_16x16x32_bf16 v[32:35], a[68:71], a[132:135], v[32:35]
s_barrier
v_mfma_f32_16x16x32_bf16 v[40:43], a[68:71], a[140:143], v[40:43]
ds_read_b128 a[96:99], v9 offset:8192
v_mfma_f32_16x16x32_bf16 v[40:43], a[64:67], a[136:139], v[40:43]
s_xor_b32 s76, s75, 2097152
s_add_u32 s76, s74, s76
v_mfma_f32_16x16x32_bf16 v[48:51], a[64:67], a[144:147], v[48:51]
s_add_u32 m0, s77, 0
s_add_u32 s64, s76, 0
v_mfma_f32_16x16x32_bf16 v[48:51], a[68:71], a[148:151], v[48:51]
buffer_load_dwordx4 v7, s[56:59], s64 offen lds
v_mfma_f32_16x16x32_bf16 v[56:59], a[68:71], a[156:159], v[56:59]
ds_read_b128 a[100:103], v10 offset:8192
v_mfma_f32_16x16x32_bf16 v[56:59], a[64:67], a[152:155], v[56:59]
v_mfma_f32_16x16x32_bf16 v[60:63], a[72:75], a[152:155], v[60:63]
ds_read_b128 a[104:107], v9 offset:10240
v_mfma_f32_16x16x32_bf16 v[60:63], a[76:79], a[156:159], v[60:63]
v_mfma_f32_16x16x32_bf16 v[52:55], a[76:79], a[148:151], v[52:55]
v_mfma_f32_16x16x32_bf16 v[52:55], a[72:75], a[144:147], v[52:55]
buffer_load_dwordx4 v8, s[56:59], s64 offen offset:1024 lds
v_mfma_f32_16x16x32_bf16 v[44:47], a[72:75], a[136:139], v[44:47]
ds_read_b64_tr_b16 a[160:161], v11 offset:16384
ds_read_b64_tr_b16 a[162:163], v11 offset:16896
v_mfma_f32_16x16x32_bf16 v[44:47], a[76:79], a[140:143], v[44:47]
v_mfma_f32_16x16x32_bf16 v[36:39], a[76:79], a[132:135], v[36:39]
v_mfma_f32_16x16x32_bf16 v[36:39], a[72:75], a[128:131], v[36:39]
ds_read_b128 a[108:111], v10 offset:10240
v_mfma_f32_16x16x32_bf16 v[64:67], a[80:83], a[128:131], v[64:67]
s_add_u32 m0, s77, 2048
s_add_u32 s64, s76, 131072
v_mfma_f32_16x16x32_bf16 v[64:67], a[84:87], a[132:135], v[64:67]
v_mfma_f32_16x16x32_bf16 v[72:75], a[84:87], a[140:143], v[72:75]
buffer_load_dwordx4 v7, s[56:59], s64 offen lds
v_mfma_f32_16x16x32_bf16 v[72:75], a[80:83], a[136:139], v[72:75]
ds_read_b64_tr_b16 a[164:165], v11 offset:24576
ds_read_b64_tr_b16 a[166:167], v11 offset:25088
v_mfma_f32_16x16x32_bf16 v[80:83], a[80:83], a[144:147], v[80:83]
v_mfma_f32_16x16x32_bf16 v[80:83], a[84:87], a[148:151], v[80:83]
ds_read_b128 a[112:115], v9 offset:12288
v_mfma_f32_16x16x32_bf16 v[88:91], a[84:87], a[156:159], v[88:91]
v_mfma_f32_16x16x32_bf16 v[88:91], a[80:83], a[152:155], v[88:91]
v_mfma_f32_16x16x32_bf16 v[92:95], a[88:91], a[152:155], v[92:95]
ds_read_b64_tr_b16 a[168:169], v12 offset:16384
ds_read_b64_tr_b16 a[170:171], v12 offset:16896
v_mfma_f32_16x16x32_bf16 v[92:95], a[92:95], a[156:159], v[92:95]
buffer_load_dwordx4 v8, s[56:59], s64 offen offset:1024 lds
v_mfma_f32_16x16x32_bf16 v[84:87], a[92:95], a[148:151], v[84:87]
v_mfma_f32_16x16x32_bf16 v[84:87], a[88:91], a[144:147], v[84:87]
v_mfma_f32_16x16x32_bf16 v[76:79], a[88:91], a[136:139], v[76:79]
ds_read_b128 a[116:119], v10 offset:12288
v_mfma_f32_16x16x32_bf16 v[76:79], a[92:95], a[140:143], v[76:79]
v_mfma_f32_16x16x32_bf16 v[68:71], a[92:95], a[132:135], v[68:71]
v_mfma_f32_16x16x32_bf16 v[68:71], a[88:91], a[128:131], v[68:71]
s_add_u32 m0, s73, 36864
s_add_u32 s64, s71, 524288
s_waitcnt lgkmcnt(6)
v_mfma_f32_16x16x32_bf16 v[96:99], a[96:99], a[128:131], v[96:99]
ds_read_b64_tr_b16 a[172:173], v12 offset:24576
ds_read_b64_tr_b16 a[174:175], v12 offset:25088
v_mfma_f32_16x16x32_bf16 v[96:99], a[100:103], a[132:135], v[96:99]
buffer_load_dwordx4 v5, s[8:11], s64 offen lds
v_mfma_f32_16x16x32_bf16 v[104:107], a[100:103], a[140:143], v[104:107]
ds_read_b128 a[120:123], v9 offset:14336
v_mfma_f32_16x16x32_bf16 v[104:107], a[96:99], a[136:139], v[104:107]
v_mfma_f32_16x16x32_bf16 v[112:115], a[96:99], a[144:147], v[112:115]
v_mfma_f32_16x16x32_bf16 v[112:115], a[100:103], a[148:151], v[112:115]
ds_read_b64_tr_b16 a[176:177], v13 offset:16384
ds_read_b64_tr_b16 a[178:179], v13 offset:16896
v_mfma_f32_16x16x32_bf16 v[120:123], a[100:103], a[156:159], v[120:123]
v_mfma_f32_16x16x32_bf16 v[120:123], a[96:99], a[152:155], v[120:123]
v_mfma_f32_16x16x32_bf16 v[124:127], a[104:107], a[152:155], v[124:127]
buffer_load_dwordx4 v6, s[8:11], s64 offen offset:1024 lds
v_mfma_f32_16x16x32_bf16 v[124:127], a[108:111], a[156:159], v[124:127]
ds_read_b128 a[124:127], v10 offset:14336
v_mfma_f32_16x16x32_bf16 v[116:119], a[108:111], a[148:151], v[116:119]
v_add_u32 v9, -65536, v9
v_add_u32 v10, -65536, v10
v_mfma_f32_16x16x32_bf16 v[116:119], a[104:107], a[144:147], v[116:119]
v_mfma_f32_16x16x32_bf16 v[108:111], a[104:107], a[136:139], v[108:111]
ds_read_b64_tr_b16 a[180:181], v13 offset:24576
ds_read_b64_tr_b16 a[182:183], v13 offset:25088
v_mfma_f32_16x16x32_bf16 v[108:111], a[108:111], a[140:143], v[108:111]
s_add_u32 m0, s73, 38912
s_add_u32 s64, s71, 540672
v_mfma_f32_16x16x32_bf16 v[100:103], a[108:111], a[132:135], v[100:103]
s_waitcnt lgkmcnt(2)
v_mfma_f32_16x16x32_bf16 v[100:103], a[104:107], a[128:131], v[100:103]
buffer_load_dwordx4 v5, s[8:11], s64 offen lds
v_mfma_f32_16x16x32_bf16 v[128:131], a[112:115], a[128:131], v[128:131]
ds_read_b64_tr_b16 a[184:185], v14 offset:16384
ds_read_b64_tr_b16 a[186:187], v14 offset:16896
v_mfma_f32_16x16x32_bf16 v[128:131], a[116:119], a[132:135], v[128:131]
v_mfma_f32_16x16x32_bf16 v[136:139], a[116:119], a[140:143], v[136:139]
ds_read_b64_tr_b16 a[188:189], v14 offset:24576
ds_read_b64_tr_b16 a[190:191], v14 offset:25088
v_mfma_f32_16x16x32_bf16 v[136:139], a[112:115], a[136:139], v[136:139]
v_mfma_f32_16x16x32_bf16 v[144:147], a[112:115], a[144:147], v[144:147]
v_mfma_f32_16x16x32_bf16 v[144:147], a[116:119], a[148:151], v[144:147]
v_mfma_f32_16x16x32_bf16 v[152:155], a[116:119], a[156:159], v[152:155]
buffer_load_dwordx4 v6, s[8:11], s64 offen offset:1024 lds
v_mfma_f32_16x16x32_bf16 v[152:155], a[112:115], a[152:155], v[152:155]
v_mfma_f32_16x16x32_bf16 v[156:159], a[120:123], a[152:155], v[156:159]
v_mfma_f32_16x16x32_bf16 v[156:159], a[124:127], a[156:159], v[156:159]
v_mfma_f32_16x16x32_bf16 v[148:151], a[124:127], a[148:151], v[148:151]
v_mfma_f32_16x16x32_bf16 v[148:151], a[120:123], a[144:147], v[148:151]
v_mfma_f32_16x16x32_bf16 v[140:143], a[120:123], a[136:139], v[140:143]
v_mfma_f32_16x16x32_bf16 v[140:143], a[124:127], a[140:143], v[140:143]
v_mfma_f32_16x16x32_bf16 v[132:135], a[124:127], a[132:135], v[132:135]
v_mfma_f32_16x16x32_bf16 v[132:135], a[120:123], a[128:131], v[132:135]
s_waitcnt lgkmcnt(0)
v_mfma_f32_16x16x32_bf16 v[160:163], a[160:163], a[64:67], v[160:163]
s_waitcnt vmcnt(16)
v_mfma_f32_16x16x32_bf16 v[160:163], a[164:167], a[68:71], v[160:163]
s_barrier
v_mfma_f32_16x16x32_bf16 v[164:167], a[172:175], a[68:71], v[164:167]
s_add_u32 s52, s81, 0
ds_read_b64_tr_b16 a[128:129], v11 offset:32768
ds_read_b64_tr_b16 a[130:131], v11 offset:33280
v_mfma_f32_16x16x32_bf16 v[164:167], a[168:171], a[64:67], v[164:167]
s_add_u32 m0, s77, 16384
s_add_u32 s64, s76, 0
v_mfma_f32_16x16x32_bf16 v[168:171], a[176:179], a[64:67], v[168:171]
buffer_load_dwordx4 v7, s[16:19], s64 offen lds
v_mfma_f32_16x16x32_bf16 v[168:171], a[180:183], a[68:71], v[168:171]
buffer_load_dwordx2 a[192:193], v26, s[28:31], s52 offen
v_mfma_f32_16x16x32_bf16 v[172:175], a[188:191], a[68:71], v[172:175]
v_mfma_f32_16x16x32_bf16 v[172:175], a[184:187], a[64:67], v[172:175]
ds_read_b128 a[64:67], v9 offset:0
v_mfma_f32_16x16x32_bf16 v[188:191], a[184:187], a[72:75], v[188:191]
ds_read_b64_tr_b16 a[132:133], v11 offset:40960
ds_read_b64_tr_b16 a[134:135], v11 offset:41472
v_mfma_f32_16x16x32_bf16 v[188:191], a[188:191], a[76:79], v[188:191]
v_mfma_f32_16x16x32_bf16 v[184:187], a[180:183], a[76:79], v[184:187]
s_add_u32 s52, s81, 3456
v_mfma_f32_16x16x32_bf16 v[184:187], a[176:179], a[72:75], v[184:187]
buffer_load_dwordx4 v8, s[16:19], s64 offen offset:1024 lds
v_mfma_f32_16x16x32_bf16 v[180:183], a[168:171], a[72:75], v[180:183]
ds_read_b128 a[68:71], v10 offset:0
v_mfma_f32_16x16x32_bf16 v[180:183], a[172:175], a[76:79], v[180:183]
buffer_load_dwordx2 a[194:195], v26, s[28:31], s52 offen
v_mfma_f32_16x16x32_bf16 v[176:179], a[164:167], a[76:79], v[176:179]
v_mfma_f32_16x16x32_bf16 v[176:179], a[160:163], a[72:75], v[176:179]
ds_read_b64_tr_b16 a[136:137], v12 offset:32768
ds_read_b64_tr_b16 a[138:139], v12 offset:33280
v_mfma_f32_16x16x32_bf16 v[192:195], a[160:163], a[80:83], v[192:195]
s_add_u32 m0, s77, 18432
s_add_u32 s64, s76, 131072
v_mfma_f32_16x16x32_bf16 v[192:195], a[164:167], a[84:87], v[192:195]
v_mfma_f32_16x16x32_bf16 v[196:199], a[172:175], a[84:87], v[196:199]
buffer_load_dwordx4 v7, s[16:19], s64 offen lds
v_mfma_f32_16x16x32_bf16 v[196:199], a[168:171], a[80:83], v[196:199]
s_add_u32 s52, s81, 6912
ds_read_b128 a[72:75], v9 offset:2048
v_mfma_f32_16x16x32_bf16 v[200:203], a[176:179], a[80:83], v[200:203]
buffer_load_dwordx2 a[196:197], v26, s[28:31], s52 offen
v_mfma_f32_16x16x32_bf16 v[200:203], a[180:183], a[84:87], v[200:203]
L_PAD1:
s_cbranch_execz L_PAD5
ds_read_b64_tr_b16 a[140:141], v12 offset:40960
ds_read_b64_tr_b16 a[142:143], v12 offset:41472
v_mfma_f32_16x16x32_bf16 v[204:207], a[188:191], a[84:87], v[204:207]
v_mfma_f32_16x16x32_bf16 v[204:207], a[184:187], a[80:83], v[204:207]
v_mfma_f32_16x16x32_bf16 v[220:223], a[184:187], a[88:91], v[220:223]
ds_read_b128 a[76:79], v10 offset:2048
v_mfma_f32_16x16x32_bf16 v[220:223], a[188:191], a[92:95], v[220:223]
buffer_load_dwordx4 v8, s[16:19], s64 offen offset:1024 lds
v_mfma_f32_16x16x32_bf16 v[216:219], a[180:183], a[92:95], v[216:219]
s_xor_b32 s71, s70, 640
s_add_u32 s71, s68, s71
s_add_u32 s52, s81, 10368
v_mfma_f32_16x16x32_bf16 v[216:219], a[176:179], a[88:91], v[216:219]
buffer_load_dwordx2 a[198:199], v26, s[28:31], s52 offen
v_mfma_f32_16x16x32_bf16 v[212:215], a[168:171], a[88:91], v[212:215]
ds_read_b64_tr_b16 a[144:145], v13 offset:32768
ds_read_b64_tr_b16 a[146:147], v13 offset:33280
v_mfma_f32_16x16x32_bf16 v[212:215], a[172:175], a[92:95], v[212:215]
v_mfma_f32_16x16x32_bf16 v[208:211], a[164:167], a[92:95], v[208:211]
v_mfma_f32_16x16x32_bf16 v[208:211], a[160:163], a[88:91], v[208:211]
s_add_u32 m0, s73, 65536
s_add_u32 s64, s71, 0
ds_read_b128 a[80:83], v9 offset:4096
v_mfma_f32_16x16x32_bf16 v[224:227], a[160:163], a[96:99], v[224:227]
s_add_u32 s52, s81, 13824
v_mfma_f32_16x16x32_bf16 v[224:227], a[164:167], a[100:103], v[224:227]
buffer_load_dwordx4 v5, s[8:11], s64 offen lds
v_mfma_f32_16x16x32_bf16 v[228:231], a[172:175], a[100:103], v[228:231]
ds_read_b64_tr_b16 a[148:149], v13 offset:40960
ds_read_b64_tr_b16 a[150:151], v13 offset:41472
v_mfma_f32_16x16x32_bf16 v[228:231], a[168:171], a[96:99], v[228:231]
buffer_load_dwordx2 a[200:201], v26, s[28:31], s52 offen
v_mfma_f32_16x16x32_bf16 v[232:235], a[176:179], a[96:99], v[232:235]
v_mfma_f32_16x16x32_bf16 v[232:235], a[180:183], a[100:103], v[232:235]
ds_read_b128 a[84:87], v10 offset:4096
v_mfma_f32_16x16x32_bf16 v[236:239], a[188:191], a[100:103], v[236:239]
v_mfma_f32_16x16x32_bf16 v[236:239], a[184:187], a[96:99], v[236:239]
v_mfma_f32_16x16x32_bf16 v[252:255], a[184:187], a[104:107], v[252:255]
buffer_load_dwordx4 v6, s[8:11], s64 offen offset:1024 lds
v_mfma_f32_16x16x32_bf16 v[252:255], a[188:191], a[108:111], v[252:255]
s_add_u32 s52, s81, 17280
ds_read_b64_tr_b16 a[152:153], v14 offset:32768
ds_read_b64_tr_b16 a[154:155], v14 offset:33280
v_mfma_f32_16x16x32_bf16 v[248:251], a[180:183], a[108:111], v[248:251]
buffer_load_dwordx2 a[202:203], v26, s[28:31], s52 offen
v_mfma_f32_16x16x32_bf16 v[248:251], a[176:179], a[104:107], v[248:251]
v_mfma_f32_16x16x32_bf16 v[244:247], a[168:171], a[104:107], v[244:247]
ds_read_b128 a[88:91], v9 offset:6144
v_mfma_f32_16x16x32_bf16 v[244:247], a[172:175], a[108:111], v[244:247]
s_add_u32 m0, s73, 67584
s_add_u32 s64, s71, 16384
v_mfma_f32_16x16x32_bf16 v[240:243], a[164:167], a[108:111], v[240:243]
v_mfma_f32_16x16x32_bf16 v[240:243], a[160:163], a[104:107], v[240:243]
buffer_load_dwordx4 v5, s[8:11], s64 offen lds
v_mfma_f32_16x16x32_bf16 a[0:3], a[160:163], a[112:115], a[0:3]
s_add_u32 s52, s81, 20736
ds_read_b64_tr_b16 a[156:157], v14 offset:40960
ds_read_b64_tr_b16 a[158:159], v14 offset:41472
v_mfma_f32_16x16x32_bf16 a[0:3], a[164:167], a[116:119], a[0:3]
buffer_load_dwordx2 a[204:205], v26, s[28:31], s52 offen
v_mfma_f32_16x16x32_bf16 a[4:7], a[172:175], a[116:119], a[4:7]
ds_read_b128 a[92:95], v10 offset:6144
v_mfma_f32_16x16x32_bf16 a[4:7], a[168:171], a[112:115], a[4:7]
v_mfma_f32_16x16x32_bf16 a[8:11], a[176:179], a[112:115], a[8:11]
v_mfma_f32_16x16x32_bf16 a[8:11], a[180:183], a[116:119], a[8:11]
v_mfma_f32_16x16x32_bf16 a[12:15], a[188:191], a[116:119], a[12:15]
buffer_load_dwordx4 v6, s[8:11], s64 offen offset:1024 lds
v_mfma_f32_16x16x32_bf16 a[12:15], a[184:187], a[112:115], a[12:15]
s_add_u32 s52, s81, 24192
v_mfma_f32_16x16x32_bf16 a[28:31], a[184:187], a[120:123], a[28:31]
buffer_load_dwordx2 a[206:207], v26, s[28:31], s52 offen
v_mfma_f32_16x16x32_bf16 a[28:31], a[188:191], a[124:127], a[28:31]
v_mfma_f32_16x16x32_bf16 a[24:27], a[180:183], a[124:127], a[24:27]
v_mfma_f32_16x16x32_bf16 a[24:27], a[176:179], a[120:123], a[24:27]
v_mfma_f32_16x16x32_bf16 a[20:23], a[168:171], a[120:123], a[20:23]
v_mfma_f32_16x16x32_bf16 a[20:23], a[172:175], a[124:127], a[20:23]
buffer_load_dwordx4 a[208:211], v27, s[36:39], s83 offen
v_mfma_f32_16x16x32_bf16 a[16:19], a[164:167], a[124:127], a[16:19]
v_mfma_f32_16x16x32_bf16 a[16:19], a[160:163], a[120:123], a[16:19]
s_waitcnt lgkmcnt(0)
v_mfma_f32_16x16x32_bf16 v[32:35], a[64:67], a[128:131], v[32:35]
s_waitcnt vmcnt(29)
v_mfma_f32_16x16x32_bf16 v[32:35], a[68:71], a[132:135], v[32:35]
s_barrier
v_mfma_f32_16x16x32_bf16 v[40:43], a[68:71], a[140:143], v[40:43]
ds_read_b128 a[96:99], v9 offset:8192
v_mfma_f32_16x16x32_bf16 v[40:43], a[64:67], a[136:139], v[40:43]
s_xor_b32 s76, s75, 2621440
s_add_u32 s76, s74, s76
v_mfma_f32_16x16x32_bf16 v[48:51], a[64:67], a[144:147], v[48:51]
s_add_u32 m0, s77, 32768
s_add_u32 s64, s76, 0
v_mfma_f32_16x16x32_bf16 v[48:51], a[68:71], a[148:151], v[48:51]
buffer_load_dwordx4 v7, s[56:59], s64 offen lds
v_mfma_f32_16x16x32_bf16 v[56:59], a[68:71], a[156:159], v[56:59]
ds_read_b128 a[100:103], v10 offset:8192
v_mfma_f32_16x16x32_bf16 v[56:59], a[64:67], a[152:155], v[56:59]
v_mfma_f32_16x16x32_bf16 v[60:63], a[72:75], a[152:155], v[60:63]
ds_read_b128 a[104:107], v9 offset:10240
v_mfma_f32_16x16x32_bf16 v[60:63], a[76:79], a[156:159], v[60:63]
v_mfma_f32_16x16x32_bf16 v[52:55], a[76:79], a[148:151], v[52:55]
v_mfma_f32_16x16x32_bf16 v[52:55], a[72:75], a[144:147], v[52:55]
buffer_load_dwordx4 v8, s[56:59], s64 offen offset:1024 lds
v_mfma_f32_16x16x32_bf16 v[44:47], a[72:75], a[136:139], v[44:47]
ds_read_b64_tr_b16 a[160:161], v11 offset:49152
ds_read_b64_tr_b16 a[162:163], v11 offset:49664
v_mfma_f32_16x16x32_bf16 v[44:47], a[76:79], a[140:143], v[44:47]
v_mfma_f32_16x16x32_bf16 v[36:39], a[76:79], a[132:135], v[36:39]
v_mfma_f32_16x16x32_bf16 v[36:39], a[72:75], a[128:131], v[36:39]
ds_read_b128 a[108:111], v10 offset:10240
v_mfma_f32_16x16x32_bf16 v[64:67], a[80:83], a[128:131], v[64:67]
s_add_u32 m0, s77, 34816
s_add_u32 s64, s76, 131072
v_mfma_f32_16x16x32_bf16 v[64:67], a[84:87], a[132:135], v[64:67]
v_mfma_f32_16x16x32_bf16 v[72:75], a[84:87], a[140:143], v[72:75]
buffer_load_dwordx4 v7, s[56:59], s64 offen lds
v_mfma_f32_16x16x32_bf16 v[72:75], a[80:83], a[136:139], v[72:75]
ds_read_b64_tr_b16 a[164:165], v11 offset:57344
ds_read_b64_tr_b16 a[166:167], v11 offset:57856
v_mfma_f32_16x16x32_bf16 v[80:83], a[80:83], a[144:147], v[80:83]
v_mfma_f32_16x16x32_bf16 v[80:83], a[84:87], a[148:151], v[80:83]
ds_read_b128 a[112:115], v9 offset:12288
v_mfma_f32_16x16x32_bf16 v[88:91], a[84:87], a[156:159], v[88:91]
v_mfma_f32_16x16x32_bf16 v[88:91], a[80:83], a[152:155], v[88:91]
v_mfma_f32_16x16x32_bf16 v[92:95], a[88:91], a[152:155], v[92:95]
ds_read_b64_tr_b16 a[168:169], v12 offset:49152
ds_read_b64_tr_b16 a[170:171], v12 offset:49664
v_mfma_f32_16x16x32_bf16 v[92:95], a[92:95], a[156:159], v[92:95]
buffer_load_dwordx4 v8, s[56:59], s64 offen offset:1024 lds
v_mfma_f32_16x16x32_bf16 v[84:87], a[92:95], a[148:151], v[84:87]
v_mfma_f32_16x16x32_bf16 v[84:87], a[88:91], a[144:147], v[84:87]
v_mfma_f32_16x16x32_bf16 v[76:79], a[88:91], a[136:139], v[76:79]
ds_read_b128 a[116:119], v10 offset:12288
v_mfma_f32_16x16x32_bf16 v[76:79], a[92:95], a[140:143], v[76:79]
v_mfma_f32_16x16x32_bf16 v[68:71], a[92:95], a[132:135], v[68:71]
v_mfma_f32_16x16x32_bf16 v[68:71], a[88:91], a[128:131], v[68:71]
s_add_u32 m0, s73, 69632
s_add_u32 s64, s71, 524288
s_waitcnt lgkmcnt(6)
v_mfma_f32_16x16x32_bf16 v[96:99], a[96:99], a[128:131], v[96:99]
ds_read_b64_tr_b16 a[172:173], v12 offset:57344
ds_read_b64_tr_b16 a[174:175], v12 offset:57856
v_mfma_f32_16x16x32_bf16 v[96:99], a[100:103], a[132:135], v[96:99]
buffer_load_dwordx4 v5, s[8:11], s64 offen lds
v_mfma_f32_16x16x32_bf16 v[104:107], a[100:103], a[140:143], v[104:107]
ds_read_b128 a[120:123], v9 offset:14336
v_mfma_f32_16x16x32_bf16 v[104:107], a[96:99], a[136:139], v[104:107]
v_mfma_f32_16x16x32_bf16 v[112:115], a[96:99], a[144:147], v[112:115]
v_mfma_f32_16x16x32_bf16 v[112:115], a[100:103], a[148:151], v[112:115]
s_waitcnt vmcnt(5)
ds_read_b64_tr_b16 a[176:177], v13 offset:49152
ds_read_b64_tr_b16 a[178:179], v13 offset:49664
v_mfma_f32_16x16x32_bf16 v[120:123], a[100:103], a[156:159], v[120:123]
v_accvgpr_read_b32 v16, a192
v_accvgpr_read_b32 v17, a194
v_mfma_f32_16x16x32_bf16 v[120:123], a[96:99], a[152:155], v[120:123]
v_accvgpr_read_b32 v18, a196
v_accvgpr_read_b32 v19, a198
v_mfma_f32_16x16x32_bf16 v[124:127], a[104:107], a[152:155], v[124:127]
buffer_load_dwordx4 v6, s[8:11], s64 offen offset:1024 lds
v_mfma_f32_16x16x32_bf16 v[124:127], a[108:111], a[156:159], v[124:127]
ds_read_b128 a[124:127], v10 offset:14336
v_accvgpr_read_b32 v20, a200
v_mfma_f32_16x16x32_bf16 v[116:119], a[108:111], a[148:151], v[116:119]
v_add_u32 v9, 32768, v9
v_add_u32 v10, 32768, v10
v_mfma_f32_16x16x32_bf16 v[116:119], a[104:107], a[144:147], v[116:119]
v_accvgpr_read_b32 v21, a202
v_accvgpr_read_b32 v22, a204
v_mfma_f32_16x16x32_bf16 v[108:111], a[104:107], a[136:139], v[108:111]
ds_read_b64_tr_b16 a[180:181], v13 offset:57344
ds_read_b64_tr_b16 a[182:183], v13 offset:57856
v_mfma_f32_16x16x32_bf16 v[108:111], a[108:111], a[140:143], v[108:111]
s_add_u32 m0, s73, 71680
s_add_u32 s64, s71, 540672
v_accvgpr_read_b32 v23, a206
v_mfma_f32_16x16x32_bf16 v[100:103], a[108:111], a[132:135], v[100:103]
s_waitcnt lgkmcnt(2)
v_mfma_f32_16x16x32_bf16 v[100:103], a[104:107], a[128:131], v[100:103]
buffer_load_dwordx4 v5, s[8:11], s64 offen lds
v_mfma_f32_16x16x32_bf16 v[128:131], a[112:115], a[128:131], v[128:131]
ds_read_b64_tr_b16 a[184:185], v14 offset:49152
ds_read_b64_tr_b16 a[186:187], v14 offset:49664
v_mfma_f32_16x16x32_bf16 v[128:131], a[116:119], a[132:135], v[128:131]
v_perm_b32 v24, v17, v16, s85
v_perm_b32 v25, v19, v18, s85
v_mfma_f32_16x16x32_bf16 v[136:139], a[116:119], a[140:143], v[136:139]
ds_read_b64_tr_b16 a[188:189], v14 offset:57344
ds_read_b64_tr_b16 a[190:191], v14 offset:57856
v_mfma_f32_16x16x32_bf16 v[136:139], a[112:115], a[136:139], v[136:139]
v_perm_b32 v26, v21, v20, s85
v_perm_b32 v27, v23, v22, s85
v_mfma_f32_16x16x32_bf16 v[144:147], a[112:115], a[144:147], v[144:147]
v_perm_b32 v28, v17, v16, s86
v_perm_b32 v29, v19, v18, s86
v_mfma_f32_16x16x32_bf16 v[144:147], a[116:119], a[148:151], v[144:147]
v_perm_b32 v30, v21, v20, s86
v_perm_b32 v31, v23, v22, s86
v_mfma_f32_16x16x32_bf16 v[152:155], a[116:119], a[156:159], v[152:155]
buffer_load_dwordx4 v6, s[8:11], s64 offen offset:1024 lds
v_mfma_f32_16x16x32_bf16 v[152:155], a[112:115], a[152:155], v[152:155]
v_accvgpr_read_b32 v16, a208
v_accvgpr_read_b32 v17, a209
v_mfma_f32_16x16x32_bf16 v[156:159], a[120:123], a[152:155], v[156:159]
v_accvgpr_read_b32 v18, a210
v_accvgpr_read_b32 v19, a211
v_mfma_f32_16x16x32_bf16 v[156:159], a[124:127], a[156:159], v[156:159]
v_or_b32 v24, v24, v16
v_or_b32 v25, v25, v17
v_mfma_f32_16x16x32_bf16 v[148:151], a[124:127], a[148:151], v[148:151]
v_or_b32 v26, v26, v18
v_or_b32 v27, v27, v19
v_mfma_f32_16x16x32_bf16 v[148:151], a[120:123], a[144:147], v[148:151]
buffer_store_dwordx4 v[24:27], v4, s[24:27], s82 offen offset:0 sc1
v_mfma_f32_16x16x32_bf16 v[140:143], a[120:123], a[136:139], v[140:143]
v_mfma_f32_16x16x32_bf16 v[140:143], a[124:127], a[140:143], v[140:143]
v_mfma_f32_16x16x32_bf16 v[132:135], a[124:127], a[132:135], v[132:135]
v_mfma_f32_16x16x32_bf16 v[132:135], a[120:123], a[128:131], v[132:135]
s_waitcnt lgkmcnt(0)
v_mfma_f32_16x16x32_bf16 v[160:163], a[160:163], a[64:67], v[160:163]
s_waitcnt vmcnt(26)
v_mfma_f32_16x16x32_bf16 v[160:163], a[164:167], a[68:71], v[160:163]
s_barrier
v_mfma_f32_16x16x32_bf16 v[164:167], a[172:175], a[68:71], v[164:167]
ds_read_b64_tr_b16 a[128:129], v11 offset:0
ds_read_b64_tr_b16 a[130:131], v11 offset:512
v_mfma_f32_16x16x32_bf16 v[164:167], a[168:171], a[64:67], v[164:167]
s_add_u32 m0, s77, 49152
s_add_u32 s64, s76, 0
v_mfma_f32_16x16x32_bf16 v[168:171], a[176:179], a[64:67], v[168:171]
buffer_load_dwordx4 v7, s[16:19], s64 offen lds
v_mfma_f32_16x16x32_bf16 v[168:171], a[180:183], a[68:71], v[168:171]
buffer_store_dwordx4 v[28:31], v4, s[24:27], s82 offen offset:1024 sc1
v_mfma_f32_16x16x32_bf16 v[172:175], a[188:191], a[68:71], v[172:175]
v_accvgpr_read_b32 v16, a193
v_accvgpr_read_b32 v17, a195
v_mfma_f32_16x16x32_bf16 v[172:175], a[184:187], a[64:67], v[172:175]
ds_read_b128 a[64:67], v9 offset:0
v_accvgpr_read_b32 v18, a197
v_mfma_f32_16x16x32_bf16 v[188:191], a[184:187], a[72:75], v[188:191]
ds_read_b64_tr_b16 a[132:133], v11 offset:8192
ds_read_b64_tr_b16 a[134:135], v11 offset:8704
v_mfma_f32_16x16x32_bf16 v[188:191], a[188:191], a[76:79], v[188:191]
v_accvgpr_read_b32 v19, a199
v_accvgpr_read_b32 v20, a201
v_mfma_f32_16x16x32_bf16 v[184:187], a[180:183], a[76:79], v[184:187]
v_accvgpr_read_b32 v21, a203
v_accvgpr_read_b32 v22, a205
v_mfma_f32_16x16x32_bf16 v[184:187], a[176:179], a[72:75], v[184:187]
buffer_load_dwordx4 v8, s[16:19], s64 offen offset:1024 lds
v_mfma_f32_16x16x32_bf16 v[180:183], a[168:171], a[72:75], v[180:183]
ds_read_b128 a[68:71], v10 offset:0
v_accvgpr_read_b32 v23, a207
v_mfma_f32_16x16x32_bf16 v[180:183], a[172:175], a[76:79], v[180:183]
v_mfma_f32_16x16x32_bf16 v[176:179], a[164:167], a[76:79], v[176:179]
v_perm_b32 v24, v17, v16, s85
v_perm_b32 v25, v19, v18, s85
v_mfma_f32_16x16x32_bf16 v[176:179], a[160:163], a[72:75], v[176:179]
ds_read_b64_tr_b16 a[136:137], v12 offset:0
ds_read_b64_tr_b16 a[138:139], v12 offset:512
v_mfma_f32_16x16x32_bf16 v[192:195], a[160:163], a[80:83], v[192:195]
s_add_u32 m0, s77, 51200
s_add_u32 s64, s76, 131072
v_perm_b32 v26, v21, v20, s85
v_mfma_f32_16x16x32_bf16 v[192:195], a[164:167], a[84:87], v[192:195]
v_perm_b32 v27, v23, v22, s85
v_perm_b32 v28, v17, v16, s86
v_mfma_f32_16x16x32_bf16 v[196:199], a[172:175], a[84:87], v[196:199]
buffer_load_dwordx4 v7, s[16:19], s64 offen lds
v_mfma_f32_16x16x32_bf16 v[196:199], a[168:171], a[80:83], v[196:199]
ds_read_b128 a[72:75], v9 offset:2048
v_perm_b32 v29, v19, v18, s86
v_mfma_f32_16x16x32_bf16 v[200:203], a[176:179], a[80:83], v[200:203]
v_perm_b32 v30, v21, v20, s86
v_perm_b32 v31, v23, v22, s86
v_mfma_f32_16x16x32_bf16 v[200:203], a[180:183], a[84:87], v[200:203]
ds_read_b64_tr_b16 a[140:141], v12 offset:8192
ds_read_b64_tr_b16 a[142:143], v12 offset:8704
v_mfma_f32_16x16x32_bf16 v[204:207], a[188:191], a[84:87], v[204:207]
buffer_store_dwordx4 v[24:27], v4, s[24:27], s82 offen offset:2048 sc1
v_mfma_f32_16x16x32_bf16 v[204:207], a[184:187], a[80:83], v[204:207]
v_mfma_f32_16x16x32_bf16 v[220:223], a[184:187], a[88:91], v[220:223]
ds_read_b128 a[76:79], v10 offset:2048
v_mfma_f32_16x16x32_bf16 v[220:223], a[188:191], a[92:95], v[220:223]
buffer_load_dwordx4 v8, s[16:19], s64 offen offset:1024 lds
v_mfma_f32_16x16x32_bf16 v[216:219], a[180:183], a[92:95], v[216:219]
s_xor_b32 s71, s70, 768
s_add_u32 s71, s68, s71
v_mfma_f32_16x16x32_bf16 v[216:219], a[176:179], a[88:91], v[216:219]
v_mfma_f32_16x16x32_bf16 v[212:215], a[168:171], a[88:91], v[212:215]
ds_read_b64_tr_b16 a[144:145], v13 offset:0
ds_read_b64_tr_b16 a[146:147], v13 offset:512
v_mfma_f32_16x16x32_bf16 v[212:215], a[172:175], a[92:95], v[212:215]
buffer_store_dwordx4 v[28:31], v4, s[24:27], s82 offen offset:3072 sc1
v_mfma_f32_16x16x32_bf16 v[208:211], a[164:167], a[92:95], v[208:211]
s_lshl_b32 s52, s7, 4
v_and_b32 v22, 3, v1
v_lshl_add_u32 v22, v22, 2, s52
v_mfma_f32_16x16x32_bf16 v[208:211], a[160:163], a[88:91], v[208:211]
s_add_u32 m0, s73, 0
s_add_u32 s64, s71, 0
ds_read_b128 a[80:83], v9 offset:4096
v_mfma_f32_16x16x32_bf16 v[224:227], a[160:163], a[96:99], v[224:227]
buffer_load_dword v23, v22, s[40:43], 0 offen sc1
v_mfma_f32_16x16x32_bf16 v[224:227], a[164:167], a[100:103], v[224:227]
buffer_load_dwordx4 v5, s[8:11], s64 offen lds
v_mfma_f32_16x16x32_bf16 v[228:231], a[172:175], a[100:103], v[228:231]
ds_read_b64_tr_b16 a[148:149], v13 offset:8192
ds_read_b64_tr_b16 a[150:151], v13 offset:8704
v_mfma_f32_16x16x32_bf16 v[228:231], a[168:171], a[96:99], v[228:231]
v_mfma_f32_16x16x32_bf16 v[232:235], a[176:179], a[96:99], v[232:235]
v_mfma_f32_16x16x32_bf16 v[232:235], a[180:183], a[100:103], v[232:235]
ds_read_b128 a[84:87], v10 offset:4096
v_mfma_f32_16x16x32_bf16 v[236:239], a[188:191], a[100:103], v[236:239]
v_mfma_f32_16x16x32_bf16 v[236:239], a[184:187], a[96:99], v[236:239]
v_mfma_f32_16x16x32_bf16 v[252:255], a[184:187], a[104:107], v[252:255]
buffer_load_dwordx4 v6, s[8:11], s64 offen offset:1024 lds
v_mfma_f32_16x16x32_bf16 v[252:255], a[188:191], a[108:111], v[252:255]
ds_read_b64_tr_b16 a[152:153], v14 offset:0
ds_read_b64_tr_b16 a[154:155], v14 offset:512
v_mfma_f32_16x16x32_bf16 v[248:251], a[180:183], a[108:111], v[248:251]
v_mfma_f32_16x16x32_bf16 v[248:251], a[176:179], a[104:107], v[248:251]
v_mfma_f32_16x16x32_bf16 v[244:247], a[168:171], a[104:107], v[244:247]
ds_read_b128 a[88:91], v9 offset:6144
v_mfma_f32_16x16x32_bf16 v[244:247], a[172:175], a[108:111], v[244:247]
s_add_u32 m0, s73, 2048
s_add_u32 s64, s71, 16384
v_mfma_f32_16x16x32_bf16 v[240:243], a[164:167], a[108:111], v[240:243]
v_mfma_f32_16x16x32_bf16 v[240:243], a[160:163], a[104:107], v[240:243]
buffer_load_dwordx4 v5, s[8:11], s64 offen lds
v_mfma_f32_16x16x32_bf16 a[0:3], a[160:163], a[112:115], a[0:3]
ds_read_b64_tr_b16 a[156:157], v14 offset:8192
ds_read_b64_tr_b16 a[158:159], v14 offset:8704
v_mfma_f32_16x16x32_bf16 a[0:3], a[164:167], a[116:119], a[0:3]
v_mfma_f32_16x16x32_bf16 a[4:7], a[172:175], a[116:119], a[4:7]
ds_read_b128 a[92:95], v10 offset:6144
v_mfma_f32_16x16x32_bf16 a[4:7], a[168:171], a[112:115], a[4:7]
v_mfma_f32_16x16x32_bf16 a[8:11], a[176:179], a[112:115], a[8:11]
v_mfma_f32_16x16x32_bf16 a[8:11], a[180:183], a[116:119], a[8:11]
v_mfma_f32_16x16x32_bf16 a[12:15], a[188:191], a[116:119], a[12:15]
buffer_load_dwordx4 v6, s[8:11], s64 offen offset:1024 lds
v_mfma_f32_16x16x32_bf16 a[12:15], a[184:187], a[112:115], a[12:15]
v_mfma_f32_16x16x32_bf16 a[28:31], a[184:187], a[120:123], a[28:31]
v_mfma_f32_16x16x32_bf16 a[28:31], a[188:191], a[124:127], a[28:31]
v_mfma_f32_16x16x32_bf16 a[24:27], a[180:183], a[124:127], a[24:27]
v_mfma_f32_16x16x32_bf16 a[24:27], a[176:179], a[120:123], a[24:27]
v_mfma_f32_16x16x32_bf16 a[20:23], a[168:171], a[120:123], a[20:23]
v_mfma_f32_16x16x32_bf16 a[20:23], a[172:175], a[124:127], a[20:23]
v_mfma_f32_16x16x32_bf16 a[16:19], a[164:167], a[124:127], a[16:19]
v_mfma_f32_16x16x32_bf16 a[16:19], a[160:163], a[120:123], a[16:19]
s_waitcnt lgkmcnt(0)
v_mfma_f32_16x16x32_bf16 v[32:35], a[64:67], a[128:131], v[32:35]
s_waitcnt vmcnt(31)
v_mfma_f32_16x16x32_bf16 v[32:35], a[68:71], a[132:135], v[32:35]
s_barrier
v_mfma_f32_16x16x32_bf16 v[40:43], a[68:71], a[140:143], v[40:43]
ds_read_b128 a[96:99], v9 offset:8192
v_mfma_f32_16x16x32_bf16 v[40:43], a[64:67], a[136:139], v[40:43]
s_xor_b32 s76, s75, 3145728
s_add_u32 s76, s74, s76
v_mfma_f32_16x16x32_bf16 v[48:51], a[64:67], a[144:147], v[48:51]
s_add_u32 m0, s77, 0
s_add_u32 s64, s76, 0
v_mfma_f32_16x16x32_bf16 v[48:51], a[68:71], a[148:151], v[48:51]
buffer_load_dwordx4 v7, s[56:59], s64 offen lds
v_mfma_f32_16x16x32_bf16 v[56:59], a[68:71], a[156:159], v[56:59]
ds_read_b128 a[100:103], v10 offset:8192
v_mfma_f32_16x16x32_bf16 v[56:59], a[64:67], a[152:155], v[56:59]
v_mfma_f32_16x16x32_bf16 v[60:63], a[72:75], a[152:155], v[60:63]
ds_read_b128 a[104:107], v9 offset:10240
v_mfma_f32_16x16x32_bf16 v[60:63], a[76:79], a[156:159], v[60:63]
v_mfma_f32_16x16x32_bf16 v[52:55], a[76:79], a[148:151], v[52:55]
v_mfma_f32_16x16x32_bf16 v[52:55], a[72:75], a[144:147], v[52:55]
buffer_load_dwordx4 v8, s[56:59], s64 offen offset:1024 lds
v_mfma_f32_16x16x32_bf16 v[44:47], a[72:75], a[136:139], v[44:47]
ds_read_b64_tr_b16 a[160:161], v11 offset:16384
ds_read_b64_tr_b16 a[162:163], v11 offset:16896
v_mfma_f32_16x16x32_bf16 v[44:47], a[76:79], a[140:143], v[44:47]
v_mfma_f32_16x16x32_bf16 v[36:39], a[76:79], a[132:135], v[36:39]
v_mfma_f32_16x16x32_bf16 v[36:39], a[72:75], a[128:131], v[36:39]
ds_read_b128 a[108:111], v10 offset:10240
v_mfma_f32_16x16x32_bf16 v[64:67], a[80:83], a[128:131], v[64:67]
s_add_u32 m0, s77, 2048
s_add_u32 s64, s76, 131072
s_waitcnt vmcnt(6)
v_mfma_f32_16x16x32_bf16 v[64:67], a[84:87], a[132:135], v[64:67]
v_cmp_gt_u32 vcc, 1, v23
v_mfma_f32_16x16x32_bf16 v[72:75], a[84:87], a[140:143], v[72:75]
buffer_load_dwordx4 v7, s[56:59], s64 offen lds
v_mfma_f32_16x16x32_bf16 v[72:75], a[80:83], a[136:139], v[72:75]
ds_read_b64_tr_b16 a[164:165], v11 offset:24576
ds_read_b64_tr_b16 a[166:167], v11 offset:25088
v_mfma_f32_16x16x32_bf16 v[80:83], a[80:83], a[144:147], v[80:83]
v_mfma_f32_16x16x32_bf16 v[80:83], a[84:87], a[148:151], v[80:83]
ds_read_b128 a[112:115], v9 offset:12288
v_mfma_f32_16x16x32_bf16 v[88:91], a[84:87], a[156:159], v[88:91]
s_cbranch_vccnz CK_Z
CK_Z_R:
v_mfma_f32_16x16x32_bf16 v[88:91], a[80:83], a[152:155], v[88:91]
buffer_atomic_add v1, v0, s[24:27], s84 offen offset:0 sc1
v_mfma_f32_16x16x32_bf16 v[92:95], a[88:91], a[152:155], v[92:95]
s_mul_i32 s52, s66, 147456
ds_read_b64_tr_b16 a[168:169], v12 offset:16384
ds_read_b64_tr_b16 a[170:171], v12 offset:16896
v_mfma_f32_16x16x32_bf16 v[92:95], a[92:95], a[156:159], v[92:95]
buffer_load_dwordx4 v8, s[56:59], s64 offen offset:1024 lds
v_mfma_f32_16x16x32_bf16 v[84:87], a[92:95], a[148:151], v[84:87]
s_lshl_b32 s53, s4, 8
s_add_u32 s52, s52, s53
s_lshl2_add_u32 s53, s2, s3
v_mfma_f32_16x16x32_bf16 v[84:87], a[88:91], a[144:147], v[84:87]
s_mul_i32 s53, s53, 2304
v_lshrrev_b32 v16, 1, v1
v_and_b32 v17, 1, v1
v_mfma_f32_16x16x32_bf16 v[76:79], a[88:91], a[136:139], v[76:79]
ds_read_b128 a[116:119], v10 offset:12288
v_lshlrev_b32 v16, 13, v16
v_mfma_f32_16x16x32_bf16 v[76:79], a[92:95], a[140:143], v[76:79]
v_lshl_add_u32 v16, v17, 7, v16
v_mov_b32 v17, 2147418112
v_mfma_f32_16x16x32_bf16 v[68:71], a[92:95], a[132:135], v[68:71]
v_cmp_gt_u32 s[96:97], 18, v1
v_lshlrev_b32 v18, 7, v1
v_mfma_f32_16x16x32_bf16 v[68:71], a[88:91], a[128:131], v[68:71]
s_add_u32 m0, s73, 4096
s_add_u32 s64, s71, 524288
s_waitcnt lgkmcnt(6)
v_mfma_f32_16x16x32_bf16 v[96:99], a[96:99], a[128:131], v[96:99]
ds_read_b64_tr_b16 a[172:173], v12 offset:24576
ds_read_b64_tr_b16 a[174:175], v12 offset:25088
v_mfma_f32_16x16x32_bf16 v[96:99], a[100:103], a[132:135], v[96:99]
buffer_load_dwordx4 v5, s[8:11], s64 offen lds
v_mfma_f32_16x16x32_bf16 v[104:107], a[100:103], a[140:143], v[104:107]
ds_read_b128 a[120:123], v9 offset:14336
v_mov_b32 v29, 0
v_mfma_f32_16x16x32_bf16 v[104:107], a[96:99], a[136:139], v[104:107]
v_mfma_f32_16x16x32_bf16 v[112:115], a[96:99], a[144:147], v[112:115]
v_cndmask_b32 v16, v17, v16, s[96:97]
v_cndmask_b32 v18, v17, v18, s[96:97]
v_mfma_f32_16x16x32_bf16 v[112:115], a[100:103], a[148:151], v[112:115]
ds_read_b64_tr_b16 a[176:177], v13 offset:16384
ds_read_b64_tr_b16 a[178:179], v13 offset:16896
v_mfma_f32_16x16x32_bf16 v[120:123], a[100:103], a[156:159], v[120:123]
buffer_load_dword a253, v18, s[12:15], s53 offen
v_mfma_f32_16x16x32_bf16 v[120:123], a[96:99], a[152:155], v[120:123]
v_mfma_f32_16x16x32_bf16 v[124:127], a[104:107], a[152:155], v[124:127]
buffer_load_dwordx4 v6, s[8:11], s64 offen offset:1024 lds
v_mfma_f32_16x16x32_bf16 v[124:127], a[108:111], a[156:159], v[124:127]
ds_read_b128 a[124:127], v10 offset:14336
v_mfma_f32_16x16x32_bf16 v[116:119], a[108:111], a[148:151], v[116:119]
v_add_u32 v9, 32768, v9
v_add_u32 v10, 32768, v10
v_mfma_f32_16x16x32_bf16 v[116:119], a[104:107], a[144:147], v[116:119]
v_mfma_f32_16x16x32_bf16 v[108:111], a[104:107], a[136:139], v[108:111]
ds_read_b64_tr_b16 a[180:181], v13 offset:24576
ds_read_b64_tr_b16 a[182:183], v13 offset:25088
v_mfma_f32_16x16x32_bf16 v[108:111], a[108:111], a[140:143], v[108:111]
s_add_u32 m0, s73, 6144
s_add_u32 s64, s71, 540672
v_mfma_f32_16x16x32_bf16 v[100:103], a[108:111], a[132:135], v[100:103]
s_waitcnt lgkmcnt(2)
v_mfma_f32_16x16x32_bf16 v[100:103], a[104:107], a[128:131], v[100:103]
buffer_load_dwordx4 v5, s[8:11], s64 offen lds
v_mfma_f32_16x16x32_bf16 v[128:131], a[112:115], a[128:131], v[128:131]
ds_read_b64_tr_b16 a[184:185], v14 offset:16384
ds_read_b64_tr_b16 a[186:187], v14 offset:16896
v_mfma_f32_16x16x32_bf16 v[128:131], a[116:119], a[132:135], v[128:131]
v_mfma_f32_16x16x32_bf16 v[136:139], a[116:119], a[140:143], v[136:139]
ds_read_b64_tr_b16 a[188:189], v14 offset:24576
ds_read_b64_tr_b16 a[190:191], v14 offset:25088
v_mfma_f32_16x16x32_bf16 v[136:139], a[112:115], a[136:139], v[136:139]
v_mfma_f32_16x16x32_bf16 v[144:147], a[112:115], a[144:147], v[144:147]
v_mfma_f32_16x16x32_bf16 v[144:147], a[116:119], a[148:151], v[144:147]
v_mfma_f32_16x16x32_bf16 v[152:155], a[116:119], a[156:159], v[152:155]
buffer_load_dwordx4 v6, s[8:11], s64 offen offset:1024 lds
v_mfma_f32_16x16x32_bf16 v[152:155], a[112:115], a[152:155], v[152:155]
v_mfma_f32_16x16x32_bf16 v[156:159], a[120:123], a[152:155], v[156:159]
v_mfma_f32_16x16x32_bf16 v[156:159], a[124:127], a[156:159], v[156:159]
v_mfma_f32_16x16x32_bf16 v[148:151], a[124:127], a[148:151], v[148:151]
v_mfma_f32_16x16x32_bf16 v[148:151], a[120:123], a[144:147], v[148:151]
v_mfma_f32_16x16x32_bf16 v[140:143], a[120:123], a[136:139], v[140:143]
v_mfma_f32_16x16x32_bf16 v[140:143], a[124:127], a[140:143], v[140:143]
v_mfma_f32_16x16x32_bf16 v[132:135], a[124:127], a[132:135], v[132:135]
v_mfma_f32_16x16x32_bf16 v[132:135], a[120:123], a[128:131], v[132:135]
s_waitcnt lgkmcnt(0)
v_mfma_f32_16x16x32_bf16 v[160:163], a[160:163], a[64:67], v[160:163]
s_waitcnt vmcnt(23)
v_mfma_f32_16x16x32_bf16 v[160:163], a[164:167], a[68:71], v[160:163]
s_barrier
v_mfma_f32_16x16x32_bf16 v[164:167], a[172:175], a[68:71], v[164:167]
ds_read_b64_tr_b16 a[128:129], v11 offset:32768
ds_read_b64_tr_b16 a[130:131], v11 offset:33280
v_mfma_f32_16x16x32_bf16 v[164:167], a[168:171], a[64:67], v[164:167]
s_add_u32 m0, s77, 16384
s_add_u32 s64, s76, 0
v_mfma_f32_16x16x32_bf16 v[168:171], a[176:179], a[64:67], v[168:171]
buffer_load_dwordx4 v7, s[16:19], s64 offen lds
v_mfma_f32_16x16x32_bf16 v[168:171], a[180:183], a[68:71], v[168:171]
buffer_load_dword a252, v16, s[20:23], s52 offen
v_mfma_f32_16x16x32_bf16 v[172:175], a[188:191], a[68:71], v[172:175]
s_add_u32 s52, s52, 73728
v_mfma_f32_16x16x32_bf16 v[172:175], a[184:187], a[64:67], v[172:175]
ds_read_b128 a[64:67], v9 offset:0
v_mfma_f32_16x16x32_bf16 v[188:191], a[184:187], a[72:75], v[188:191]
ds_read_b64_tr_b16 a[132:133], v11 offset:40960
ds_read_b64_tr_b16 a[134:135], v11 offset:41472
v_mfma_f32_16x16x32_bf16 v[188:191], a[188:191], a[76:79], v[188:191]
v_mfma_f32_16x16x32_bf16 v[184:187], a[180:183], a[76:79], v[184:187]
v_mfma_f32_16x16x32_bf16 v[184:187], a[176:179], a[72:75], v[184:187]
buffer_load_dwordx4 v8, s[16:19], s64 offen offset:1024 lds
v_mfma_f32_16x16x32_bf16 v[180:183], a[168:171], a[72:75], v[180:183]
ds_read_b128 a[68:71], v10 offset:0
v_mfma_f32_16x16x32_bf16 v[180:183], a[172:175], a[76:79], v[180:183]
v_mfma_f32_16x16x32_bf16 v[176:179], a[164:167], a[76:79], v[176:179]
v_mfma_f32_16x16x32_bf16 v[176:179], a[160:163], a[72:75], v[176:179]
ds_read_b64_tr_b16 a[136:137], v12 offset:32768
ds_read_b64_tr_b16 a[138:139], v12 offset:33280
v_mfma_f32_16x16x32_bf16 v[192:195], a[160:163], a[80:83], v[192:195]
s_add_u32 m0, s77, 18432
s_add_u32 s64, s76, 131072
v_mfma_f32_16x16x32_bf16 v[192:195], a[164:167], a[84:87], v[192:195]
v_mfma_f32_16x16x32_bf16 v[196:199], a[172:175], a[84:87], v[196:199]
buffer_load_dwordx4 v7, s[16:19], s64 offen lds
v_mfma_f32_16x16x32_bf16 v[196:199], a[168:171], a[80:83], v[196:199]
ds_read_b128 a[72:75], v9 offset:2048
v_mfma_f32_16x16x32_bf16 v[200:203], a[176:179], a[80:83], v[200:203]
v_mfma_f32_16x16x32_bf16 v[200:203], a[180:183], a[84:87], v[200:203]
ds_read_b64_tr_b16 a[140:141], v12 offset:40960
ds_read_b64_tr_b16 a[142:143], v12 offset:41472
v_mfma_f32_16x16x32_bf16 v[204:207], a[188:191], a[84:87], v[204:207]
v_mfma_f32_16x16x32_bf16 v[204:207], a[184:187], a[80:83], v[204:207]
v_mfma_f32_16x16x32_bf16 v[220:223], a[184:187], a[88:91], v[220:223]
ds_read_b128 a[76:79], v10 offset:2048
v_mfma_f32_16x16x32_bf16 v[220:223], a[188:191], a[92:95], v[220:223]
buffer_load_dwordx4 v8, s[16:19], s64 offen offset:1024 lds
v_mfma_f32_16x16x32_bf16 v[216:219], a[180:183], a[92:95], v[216:219]
s_xor_b32 s71, s70, 896
s_add_u32 s71, s68, s71
v_mfma_f32_16x16x32_bf16 v[216:219], a[176:179], a[88:91], v[216:219]
L_PAD2:
s_cbranch_execz L_PAD6
v_mfma_f32_16x16x32_bf16 v[212:215], a[168:171], a[88:91], v[212:215]
ds_read_b64_tr_b16 a[144:145], v13 offset:32768
ds_read_b64_tr_b16 a[146:147], v13 offset:33280
v_mfma_f32_16x16x32_bf16 v[212:215], a[172:175], a[92:95], v[212:215]
v_mfma_f32_16x16x32_bf16 v[208:211], a[164:167], a[92:95], v[208:211]
v_mfma_f32_16x16x32_bf16 v[208:211], a[160:163], a[88:91], v[208:211]
s_add_u32 m0, s73, 32768
s_add_u32 s64, s71, 0
ds_read_b128 a[80:83], v9 offset:4096
v_mfma_f32_16x16x32_bf16 v[224:227], a[160:163], a[96:99], v[224:227]
v_mfma_f32_16x16x32_bf16 v[224:227], a[164:167], a[100:103], v[224:227]
buffer_load_dwordx4 v5, s[8:11], s64 offen lds
v_mfma_f32_16x16x32_bf16 v[228:231], a[172:175], a[100:103], v[228:231]
ds_read_b64_tr_b16 a[148:149], v13 offset:40960
ds_read_b64_tr_b16 a[150:151], v13 offset:41472
v_mfma_f32_16x16x32_bf16 v[228:231], a[168:171], a[96:99], v[228:231]
v_mfma_f32_16x16x32_bf16 v[232:235], a[176:179], a[96:99], v[232:235]
v_mfma_f32_16x16x32_bf16 v[232:235], a[180:183], a[100:103], v[232:235]
ds_read_b128 a[84:87], v10 offset:4096
v_mfma_f32_16x16x32_bf16 v[236:239], a[188:191], a[100:103], v[236:239]
v_mfma_f32_16x16x32_bf16 v[236:239], a[184:187], a[96:99], v[236:239]
v_mfma_f32_16x16x32_bf16 v[252:255], a[184:187], a[104:107], v[252:255]
buffer_load_dwordx4 v6, s[8:11], s64 offen offset:1024 lds
v_mfma_f32_16x16x32_bf16 v[252:255], a[188:191], a[108:111], v[252:255]
ds_read_b64_tr_b16 a[152:153], v14 offset:32768
ds_read_b64_tr_b16 a[154:155], v14 offset:33280
v_mfma_f32_16x16x32_bf16 v[248:251], a[180:183], a[108:111], v[248:251]
v_mfma_f32_16x16x32_bf16 v[248:251], a[176:179], a[104:107], v[248:251]
v_mfma_f32_16x16x32_bf16 v[244:247], a[168:171], a[104:107], v[244:247]
ds_read_b128 a[88:91], v9 offset:6144
v_mfma_f32_16x16x32_bf16 v[244:247], a[172:175], a[108:111], v[244:247]
s_add_u32 m0, s73, 34816
s_add_u32 s64, s71, 16384
v_mfma_f32_16x16x32_bf16 v[240:243], a[164:167], a[108:111], v[240:243]
v_mfma_f32_16x16x32_bf16 v[240:243], a[160:163], a[104:107], v[240:243]
buffer_load_dwordx4 v5, s[8:11], s64 offen lds
v_mfma_f32_16x16x32_bf16 a[0:3], a[160:163], a[112:115], a[0:3]
ds_read_b64_tr_b16 a[156:157], v14 offset:40960
ds_read_b64_tr_b16 a[158:159], v14 offset:41472
v_mfma_f32_16x16x32_bf16 a[0:3], a[164:167], a[116:119], a[0:3]
v_mfma_f32_16x16x32_bf16 a[4:7], a[172:175], a[116:119], a[4:7]
ds_read_b128 a[92:95], v10 offset:6144
v_mfma_f32_16x16x32_bf16 a[4:7], a[168:171], a[112:115], a[4:7]
v_mfma_f32_16x16x32_bf16 a[8:11], a[176:179], a[112:115], a[8:11]
v_mfma_f32_16x16x32_bf16 a[8:11], a[180:183], a[116:119], a[8:11]
v_mfma_f32_16x16x32_bf16 a[12:15], a[188:191], a[116:119], a[12:15]
buffer_load_dwordx4 v6, s[8:11], s64 offen offset:1024 lds
v_mfma_f32_16x16x32_bf16 a[12:15], a[184:187], a[112:115], a[12:15]
v_mfma_f32_16x16x32_bf16 a[28:31], a[184:187], a[120:123], a[28:31]
v_mfma_f32_16x16x32_bf16 a[28:31], a[188:191], a[124:127], a[28:31]
v_mfma_f32_16x16x32_bf16 a[24:27], a[180:183], a[124:127], a[24:27]
v_mfma_f32_16x16x32_bf16 a[24:27], a[176:179], a[120:123], a[24:27]
v_mfma_f32_16x16x32_bf16 a[20:23], a[168:171], a[120:123], a[20:23]
v_mfma_f32_16x16x32_bf16 a[20:23], a[172:175], a[124:127], a[20:23]
v_mfma_f32_16x16x32_bf16 a[16:19], a[164:167], a[124:127], a[16:19]
v_mfma_f32_16x16x32_bf16 a[16:19], a[160:163], a[120:123], a[16:19]
s_waitcnt lgkmcnt(0)
v_mfma_f32_16x16x32_bf16 v[32:35], a[64:67], a[128:131], v[32:35]
s_waitcnt vmcnt(25)
v_mfma_f32_16x16x32_bf16 v[32:35], a[68:71], a[132:135], v[32:35]
s_barrier
v_mfma_f32_16x16x32_bf16 v[40:43], a[68:71], a[140:143], v[40:43]
ds_read_b128 a[96:99], v9 offset:8192
v_mfma_f32_16x16x32_bf16 v[40:43], a[64:67], a[136:139], v[40:43]
s_xor_b32 s76, s75, 3670016
s_add_u32 s76, s74, s76
v_mfma_f32_16x16x32_bf16 v[48:51], a[64:67], a[144:147], v[48:51]
s_add_u32 m0, s77, 32768
s_add_u32 s64, s76, 0
v_mfma_f32_16x16x32_bf16 v[48:51], a[68:71], a[148:151], v[48:51]
buffer_load_dwordx4 v7, s[56:59], s64 offen lds
v_mfma_f32_16x16x32_bf16 v[56:59], a[68:71], a[156:159], v[56:59]
ds_read_b128 a[100:103], v10 offset:8192
v_mfma_f32_16x16x32_bf16 v[56:59], a[64:67], a[152:155], v[56:59]
buffer_load_dword a252, v16, s[20:23], s52 offen
v_mfma_f32_16x16x32_bf16 v[60:63], a[72:75], a[152:155], v[60:63]
s_lshr_b32 s52, s2, 1
s_lshl2_add_u32 s52, s52, s3
ds_read_b128 a[104:107], v9 offset:10240
v_mfma_f32_16x16x32_bf16 v[60:63], a[76:79], a[156:159], v[60:63]
s_mul_i32 s52, s52, 9216
s_and_b32 s53, s2, 1
s_lshl_b32 s53, s53, 9
v_mfma_f32_16x16x32_bf16 v[52:55], a[76:79], a[148:151], v[52:55]
s_add_u32 s52, s52, s53
s_lshl2_add_u32 s53, s2, s3
s_mul_i32 s53, s53, 768
v_mfma_f32_16x16x32_bf16 v[52:55], a[72:75], a[144:147], v[52:55]
buffer_load_dwordx4 v8, s[56:59], s64 offen offset:1024 lds
v_mfma_f32_16x16x32_bf16 v[44:47], a[72:75], a[136:139], v[44:47]
ds_read_b64_tr_b16 a[160:161], v11 offset:49152
ds_read_b64_tr_b16 a[162:163], v11 offset:49664
v_mfma_f32_16x16x32_bf16 v[44:47], a[76:79], a[140:143], v[44:47]
v_cmp_gt_u32 s[96:97], 40, v1
v_and_b32 v16, 7, v1
v_mfma_f32_16x16x32_bf16 v[36:39], a[76:79], a[132:135], v[36:39]
v_mul_u32_u24 v16, 1152, v16
v_lshrrev_b32 v19, 3, v1
v_mfma_f32_16x16x32_bf16 v[36:39], a[72:75], a[128:131], v[36:39]
ds_read_b128 a[108:111], v10 offset:10240
v_lshl_add_u32 v16, v19, 7, v16
v_mfma_f32_16x16x32_bf16 v[64:67], a[80:83], a[128:131], v[64:67]
s_add_u32 m0, s77, 34816
s_add_u32 s64, s76, 131072
v_cndmask_b32 v16, v17, v16, s[96:97]
v_mfma_f32_16x16x32_bf16 v[64:67], a[84:87], a[132:135], v[64:67]
v_cmp_gt_u32 s[96:97], 6, v1
v_mfma_f32_16x16x32_bf16 v[72:75], a[84:87], a[140:143], v[72:75]
buffer_load_dwordx4 v7, s[56:59], s64 offen lds
v_mfma_f32_16x16x32_bf16 v[72:75], a[80:83], a[136:139], v[72:75]
ds_read_b64_tr_b16 a[164:165], v11 offset:57344
ds_read_b64_tr_b16 a[166:167], v11 offset:57856
v_mfma_f32_16x16x32_bf16 v[80:83], a[80:83], a[144:147], v[80:83]
v_cndmask_b32 v18, v17, v18, s[96:97]
v_mfma_f32_16x16x32_bf16 v[80:83], a[84:87], a[148:151], v[80:83]
ds_read_b128 a[112:115], v9 offset:12288
v_mfma_f32_16x16x32_bf16 v[88:91], a[84:87], a[156:159], v[88:91]
v_mfma_f32_16x16x32_bf16 v[88:91], a[80:83], a[152:155], v[88:91]
v_mfma_f32_16x16x32_bf16 v[92:95], a[88:91], a[152:155], v[92:95]
ds_read_b64_tr_b16 a[168:169], v12 offset:49152
ds_read_b64_tr_b16 a[170:171], v12 offset:49664
v_mfma_f32_16x16x32_bf16 v[92:95], a[92:95], a[156:159], v[92:95]
buffer_load_dwordx4 v8, s[56:59], s64 offen offset:1024 lds
v_mfma_f32_16x16x32_bf16 v[84:87], a[92:95], a[148:151], v[84:87]
v_mfma_f32_16x16x32_bf16 v[84:87], a[88:91], a[144:147], v[84:87]
v_mfma_f32_16x16x32_bf16 v[76:79], a[88:91], a[136:139], v[76:79]
ds_read_b128 a[116:119], v10 offset:12288
v_mfma_f32_16x16x32_bf16 v[76:79], a[92:95], a[140:143], v[76:79]
v_mfma_f32_16x16x32_bf16 v[68:71], a[92:95], a[132:135], v[68:71]
v_mfma_f32_16x16x32_bf16 v[68:71], a[88:91], a[128:131], v[68:71]
s_add_u32 m0, s73, 36864
s_add_u32 s64, s71, 524288
s_waitcnt lgkmcnt(6)
v_mfma_f32_16x16x32_bf16 v[96:99], a[96:99], a[128:131], v[96:99]
ds_read_b64_tr_b16 a[172:173], v12 offset:57344
ds_read_b64_tr_b16 a[174:175], v12 offset:57856
v_mfma_f32_16x16x32_bf16 v[96:99], a[100:103], a[132:135], v[96:99]
buffer_load_dwordx4 v5, s[8:11], s64 offen lds
v_mfma_f32_16x16x32_bf16 v[104:107], a[100:103], a[140:143], v[104:107]
ds_read_b128 a[120:123], v9 offset:14336
v_mfma_f32_16x16x32_bf16 v[104:107], a[96:99], a[136:139], v[104:107]
v_mfma_f32_16x16x32_bf16 v[112:115], a[96:99], a[144:147], v[112:115]
v_mfma_f32_16x16x32_bf16 v[112:115], a[100:103], a[148:151], v[112:115]
ds_read_b64_tr_b16 a[176:177], v13 offset:49152
ds_read_b64_tr_b16 a[178:179], v13 offset:49664
v_mfma_f32_16x16x32_bf16 v[120:123], a[100:103], a[156:159], v[120:123]
v_mfma_f32_16x16x32_bf16 v[120:123], a[96:99], a[152:155], v[120:123]
v_mfma_f32_16x16x32_bf16 v[124:127], a[104:107], a[152:155], v[124:127]
buffer_load_dwordx4 v6, s[8:11], s64 offen offset:1024 lds
v_mfma_f32_16x16x32_bf16 v[124:127], a[108:111], a[156:159], v[124:127]
ds_read_b128 a[124:127], v10 offset:14336
v_mfma_f32_16x16x32_bf16 v[116:119], a[108:111], a[148:151], v[116:119]
v_add_u32 v9, -65536, v9
v_add_u32 v10, -65536, v10
v_mfma_f32_16x16x32_bf16 v[116:119], a[104:107], a[144:147], v[116:119]
buffer_load_dword v30, v29, s[24:27], s89 offen sc1
v_mfma_f32_16x16x32_bf16 v[108:111], a[104:107], a[136:139], v[108:111]
ds_read_b64_tr_b16 a[180:181], v13 offset:57344
ds_read_b64_tr_b16 a[182:183], v13 offset:57856
v_mfma_f32_16x16x32_bf16 v[108:111], a[108:111], a[140:143], v[108:111]
s_add_u32 m0, s73, 38912
s_add_u32 s64, s71, 540672
v_mfma_f32_16x16x32_bf16 v[100:103], a[108:111], a[132:135], v[100:103]
s_waitcnt lgkmcnt(2)
v_mfma_f32_16x16x32_bf16 v[100:103], a[104:107], a[128:131], v[100:103]
buffer_load_dwordx4 v5, s[8:11], s64 offen lds
v_mfma_f32_16x16x32_bf16 v[128:131], a[112:115], a[128:131], v[128:131]
ds_read_b64_tr_b16 a[184:185], v14 offset:49152
ds_read_b64_tr_b16 a[186:187], v14 offset:49664
v_mfma_f32_16x16x32_bf16 v[128:131], a[116:119], a[132:135], v[128:131]
v_mfma_f32_16x16x32_bf16 v[136:139], a[116:119], a[140:143], v[136:139]
ds_read_b64_tr_b16 a[188:189], v14 offset:57344
ds_read_b64_tr_b16 a[190:191], v14 offset:57856
v_mfma_f32_16x16x32_bf16 v[136:139], a[112:115], a[136:139], v[136:139]
v_mfma_f32_16x16x32_bf16 v[144:147], a[112:115], a[144:147], v[144:147]
v_mfma_f32_16x16x32_bf16 v[144:147], a[116:119], a[148:151], v[144:147]
v_mfma_f32_16x16x32_bf16 v[152:155], a[116:119], a[156:159], v[152:155]
buffer_load_dwordx4 v6, s[8:11], s64 offen offset:1024 lds
v_mfma_f32_16x16x32_bf16 v[152:155], a[112:115], a[152:155], v[152:155]
v_mfma_f32_16x16x32_bf16 v[156:159], a[120:123], a[152:155], v[156:159]
v_mfma_f32_16x16x32_bf16 v[156:159], a[124:127], a[156:159], v[156:159]
v_mfma_f32_16x16x32_bf16 v[148:151], a[124:127], a[148:151], v[148:151]
v_mfma_f32_16x16x32_bf16 v[148:151], a[120:123], a[144:147], v[148:151]
v_mfma_f32_16x16x32_bf16 v[140:143], a[120:123], a[136:139], v[140:143]
v_mfma_f32_16x16x32_bf16 v[140:143], a[124:127], a[140:143], v[140:143]
v_mfma_f32_16x16x32_bf16 v[132:135], a[124:127], a[132:135], v[132:135]
v_mfma_f32_16x16x32_bf16 v[132:135], a[120:123], a[128:131], v[132:135]
s_waitcnt lgkmcnt(0)
v_mfma_f32_16x16x32_bf16 v[160:163], a[160:163], a[64:67], v[160:163]
s_waitcnt vmcnt(19)
v_mfma_f32_16x16x32_bf16 v[160:163], a[164:167], a[68:71], v[160:163]
s_barrier
v_mfma_f32_16x16x32_bf16 v[164:167], a[172:175], a[68:71], v[164:167]
ds_read_b64_tr_b16 a[128:129], v11 offset:0
ds_read_b64_tr_b16 a[130:131], v11 offset:512
v_mfma_f32_16x16x32_bf16 v[164:167], a[168:171], a[64:67], v[164:167]
s_add_u32 m0, s77, 49152
s_add_u32 s64, s76, 0
v_mfma_f32_16x16x32_bf16 v[168:171], a[176:179], a[64:67], v[168:171]
buffer_load_dwordx4 v7, s[16:19], s64 offen lds
v_mfma_f32_16x16x32_bf16 v[168:171], a[180:183], a[68:71], v[168:171]
v_mfma_f32_16x16x32_bf16 v[172:175], a[188:191], a[68:71], v[172:175]
v_mfma_f32_16x16x32_bf16 v[172:175], a[184:187], a[64:67], v[172:175]
ds_read_b128 a[64:67], v9 offset:0
v_mfma_f32_16x16x32_bf16 v[188:191], a[184:187], a[72:75], v[188:191]
ds_read_b64_tr_b16 a[132:133], v11 offset:8192
ds_read_b64_tr_b16 a[134:135], v11 offset:8704
v_mfma_f32_16x16x32_bf16 v[188:191], a[188:191], a[76:79], v[188:191]
v_mfma_f32_16x16x32_bf16 v[184:187], a[180:183], a[76:79], v[184:187]
v_mfma_f32_16x16x32_bf16 v[184:187], a[176:179], a[72:75], v[184:187]
buffer_load_dwordx4 v8, s[16:19], s64 offen offset:1024 lds
v_mfma_f32_16x16x32_bf16 v[180:183], a[168:171], a[72:75], v[180:183]
ds_read_b128 a[68:71], v10 offset:0
v_mfma_f32_16x16x32_bf16 v[180:183], a[172:175], a[76:79], v[180:183]
v_mfma_f32_16x16x32_bf16 v[176:179], a[164:167], a[76:79], v[176:179]
v_mfma_f32_16x16x32_bf16 v[176:179], a[160:163], a[72:75], v[176:179]
ds_read_b64_tr_b16 a[136:137], v12 offset:0
ds_read_b64_tr_b16 a[138:139], v12 offset:512
v_mfma_f32_16x16x32_bf16 v[192:195], a[160:163], a[80:83], v[192:195]
s_add_u32 m0, s77, 51200
s_add_u32 s64, s76, 131072
v_mfma_f32_16x16x32_bf16 v[192:195], a[164:167], a[84:87], v[192:195]
v_mfma_f32_16x16x32_bf16 v[196:199], a[172:175], a[84:87], v[196:199]
buffer_load_dwordx4 v7, s[16:19], s64 offen lds
v_mfma_f32_16x16x32_bf16 v[196:199], a[168:171], a[80:83], v[196:199]
ds_read_b128 a[72:75], v9 offset:2048
v_mfma_f32_16x16x32_bf16 v[200:203], a[176:179], a[80:83], v[200:203]
v_mfma_f32_16x16x32_bf16 v[200:203], a[180:183], a[84:87], v[200:203]
ds_read_b64_tr_b16 a[140:141], v12 offset:8192
ds_read_b64_tr_b16 a[142:143], v12 offset:8704
v_mfma_f32_16x16x32_bf16 v[204:207], a[188:191], a[84:87], v[204:207]
v_mfma_f32_16x16x32_bf16 v[204:207], a[184:187], a[80:83], v[204:207]
v_mfma_f32_16x16x32_bf16 v[220:223], a[184:187], a[88:91], v[220:223]
ds_read_b128 a[76:79], v10 offset:2048
v_mfma_f32_16x16x32_bf16 v[220:223], a[188:191], a[92:95], v[220:223]
buffer_load_dwordx4 v8, s[16:19], s64 offen offset:1024 lds
v_mfma_f32_16x16x32_bf16 v[216:219], a[180:183], a[92:95], v[216:219]
s_lshl_b32 s70, s93, 7
s_mul_i32 s68, s66, 36864
s_mul_i32 s69, s67, 36864
v_mfma_f32_16x16x32_bf16 v[216:219], a[176:179], a[88:91], v[216:219]
v_lshrrev_b32 v31, 3, v1
v_lshl_add_u32 v5, v31, 7, v5
v_mfma_f32_16x16x32_bf16 v[212:215], a[168:171], a[88:91], v[212:215]
v_lshl_add_u32 v6, v31, 7, v6
v_add_u32 v6, 1024, v6
v_mfma_f32_16x16x32_bf16 v[212:215], a[172:175], a[92:95], v[212:215]
s_mov_b32 s65, 1024
s_add_u32 s71, s68, s65
s_add_u32 s72, s69, s65
v_mfma_f32_16x16x32_bf16 v[208:211], a[164:167], a[92:95], v[208:211]
ds_read_b64_tr_b16 a[144:145], v13 offset:0
ds_read_b64_tr_b16 a[146:147], v13 offset:512
v_mfma_f32_16x16x32_bf16 v[208:211], a[160:163], a[88:91], v[208:211]
s_add_u32 m0, s73, 65536
s_add_u32 s64, s71, 0
ds_read_b128 a[80:83], v9 offset:4096
v_mfma_f32_16x16x32_bf16 v[224:227], a[160:163], a[96:99], v[224:227]
v_mfma_f32_16x16x32_bf16 v[224:227], a[164:167], a[100:103], v[224:227]
buffer_load_dwordx4 v5, s[12:15], s64 offen lds
v_mfma_f32_16x16x32_bf16 v[228:231], a[172:175], a[100:103], v[228:231]
ds_read_b64_tr_b16 a[148:149], v13 offset:8192
ds_read_b64_tr_b16 a[150:151], v13 offset:8704
v_mfma_f32_16x16x32_bf16 v[228:231], a[168:171], a[96:99], v[228:231]
v_mfma_f32_16x16x32_bf16 v[232:235], a[176:179], a[96:99], v[232:235]
v_mfma_f32_16x16x32_bf16 v[232:235], a[180:183], a[100:103], v[232:235]
ds_read_b128 a[84:87], v10 offset:4096
v_mfma_f32_16x16x32_bf16 v[236:239], a[188:191], a[100:103], v[236:239]
v_mfma_f32_16x16x32_bf16 v[236:239], a[184:187], a[96:99], v[236:239]
v_mfma_f32_16x16x32_bf16 v[252:255], a[184:187], a[104:107], v[252:255]
buffer_load_dwordx4 v6, s[12:15], s64 offen offset:1024 lds
v_mfma_f32_16x16x32_bf16 v[252:255], a[188:191], a[108:111], v[252:255]
ds_read_b64_tr_b16 a[152:153], v14 offset:0
ds_read_b64_tr_b16 a[154:155], v14 offset:512
v_mfma_f32_16x16x32_bf16 v[248:251], a[180:183], a[108:111], v[248:251]
v_mfma_f32_16x16x32_bf16 v[248:251], a[176:179], a[104:107], v[248:251]
v_mfma_f32_16x16x32_bf16 v[244:247], a[168:171], a[104:107], v[244:247]
ds_read_b128 a[88:91], v9 offset:6144
v_mfma_f32_16x16x32_bf16 v[244:247], a[172:175], a[108:111], v[244:247]
s_add_u32 m0, s73, 67584
s_add_u32 s64, s71, 18432
v_mfma_f32_16x16x32_bf16 v[240:243], a[164:167], a[108:111], v[240:243]
v_mfma_f32_16x16x32_bf16 v[240:243], a[160:163], a[104:107], v[240:243]
buffer_load_dwordx4 v5, s[12:15], s64 offen lds
v_mfma_f32_16x16x32_bf16 a[0:3], a[160:163], a[112:115], a[0:3]
ds_read_b64_tr_b16 a[156:157], v14 offset:8192
ds_read_b64_tr_b16 a[158:159], v14 offset:8704
v_mfma_f32_16x16x32_bf16 a[0:3], a[164:167], a[116:119], a[0:3]
v_mfma_f32_16x16x32_bf16 a[4:7], a[172:175], a[116:119], a[4:7]
s_waitcnt vmcnt(9)
ds_read_b128 a[92:95], v10 offset:6144
v_mfma_f32_16x16x32_bf16 a[4:7], a[168:171], a[112:115], a[4:7]
v_cmp_gt_u32 vcc, 18, v30
v_mfma_f32_16x16x32_bf16 a[8:11], a[176:179], a[112:115], a[8:11]
v_mfma_f32_16x16x32_bf16 a[8:11], a[180:183], a[116:119], a[8:11]
v_mfma_f32_16x16x32_bf16 a[12:15], a[188:191], a[116:119], a[12:15]
buffer_load_dwordx4 v6, s[12:15], s64 offen offset:1024 lds
v_mfma_f32_16x16x32_bf16 a[12:15], a[184:187], a[112:115], a[12:15]
v_mfma_f32_16x16x32_bf16 a[28:31], a[184:187], a[120:123], a[28:31]
s_cbranch_vccnz CK_WA
CK_WA_R:
v_mfma_f32_16x16x32_bf16 a[28:31], a[188:191], a[124:127], a[28:31]
v_mfma_f32_16x16x32_bf16 a[24:27], a[180:183], a[124:127], a[24:27]
v_mfma_f32_16x16x32_bf16 a[24:27], a[176:179], a[120:123], a[24:27]
v_mfma_f32_16x16x32_bf16 a[20:23], a[168:171], a[120:123], a[20:23]
v_mfma_f32_16x16x32_bf16 a[20:23], a[172:175], a[124:127], a[20:23]
v_mfma_f32_16x16x32_bf16 a[16:19], a[164:167], a[124:127], a[16:19]
v_mfma_f32_16x16x32_bf16 a[16:19], a[160:163], a[120:123], a[16:19]
s_waitcnt lgkmcnt(0)
v_mfma_f32_16x16x32_bf16 v[32:35], a[64:67], a[128:131], v[32:35]
s_waitcnt vmcnt(22)
v_mfma_f32_16x16x32_bf16 v[32:35], a[68:71], a[132:135], v[32:35]
s_barrier
v_mfma_f32_16x16x32_bf16 v[40:43], a[68:71], a[140:143], v[40:43]
ds_read_b128 a[96:99], v9 offset:8192
v_mfma_f32_16x16x32_bf16 v[40:43], a[64:67], a[136:139], v[40:43]
s_lshl_b32 s77, s3, 11
s_lshl_b32 s74, s3, 9
s_add_u32 s74, s74, s4
v_mfma_f32_16x16x32_bf16 v[48:51], a[64:67], a[144:147], v[48:51]
s_lshl_b32 s74, s74, 8
v_mfma_f32_16x16x32_bf16 v[48:51], a[68:71], a[148:151], v[48:51]
s_mov_b32 s75, 8
s_lshl_b32 s76, s75, 19
s_add_u32 s76, s76, s74
v_mfma_f32_16x16x32_bf16 v[56:59], a[68:71], a[156:159], v[56:59]
s_lshl_b32 s79, s75, 13
s_add_u32 s79, s79, s78
ds_read_b128 a[100:103], v10 offset:8192
v_mfma_f32_16x16x32_bf16 v[56:59], a[64:67], a[152:155], v[56:59]
s_add_u32 m0, s77, 0
s_add_u32 s64, s76, 0
v_mfma_f32_16x16x32_bf16 v[60:63], a[72:75], a[152:155], v[60:63]
buffer_load_dwordx4 v7, s[20:23], s64 offen lds
v_mfma_f32_16x16x32_bf16 v[60:63], a[76:79], a[156:159], v[60:63]
ds_read_b128 a[104:107], v9 offset:10240
v_mfma_f32_16x16x32_bf16 v[52:55], a[76:79], a[148:151], v[52:55]
buffer_load_dword a252, v16, s[32:35], s52 offen
v_mfma_f32_16x16x32_bf16 v[52:55], a[72:75], a[144:147], v[52:55]
ds_read_b64_tr_b16 a[160:161], v11 offset:16384
ds_read_b64_tr_b16 a[162:163], v11 offset:16896
v_mfma_f32_16x16x32_bf16 v[44:47], a[72:75], a[136:139], v[44:47]
buffer_load_dwordx4 v8, s[20:23], s64 offen offset:1024 lds
v_mfma_f32_16x16x32_bf16 v[44:47], a[76:79], a[140:143], v[44:47]
buffer_load_dword a253, v18, s[48:51], s53 offen
v_mfma_f32_16x16x32_bf16 v[36:39], a[76:79], a[132:135], v[36:39]
v_and_b32 v18, 1, v1
v_lshlrev_b32 v18, 21, v18
v_mfma_f32_16x16x32_bf16 v[36:39], a[72:75], a[128:131], v[36:39]
ds_read_b128 a[108:111], v10 offset:10240
v_mfma_f32_16x16x32_bf16 v[64:67], a[80:83], a[128:131], v[64:67]
v_mfma_f32_16x16x32_bf16 v[64:67], a[84:87], a[132:135], v[64:67]
v_mfma_f32_16x16x32_bf16 v[72:75], a[84:87], a[140:143], v[72:75]
s_add_u32 m0, s80, 0
s_add_u32 s64, s79, 0
v_mfma_f32_16x16x32_bf16 v[72:75], a[80:83], a[136:139], v[72:75]
ds_read_b64_tr_b16 a[164:165], v11 offset:24576
ds_read_b64_tr_b16 a[166:167], v11 offset:25088
v_mfma_f32_16x16x32_bf16 v[80:83], a[80:83], a[144:147], v[80:83]
buffer_load_dwordx4 v4, s[24:27], s64 offen sc1 lds
v_mfma_f32_16x16x32_bf16 v[80:83], a[84:87], a[148:151], v[80:83]
ds_read_b128 a[112:115], v9 offset:12288
v_mfma_f32_16x16x32_bf16 v[88:91], a[84:87], a[156:159], v[88:91]
v_mfma_f32_16x16x32_bf16 v[88:91], a[80:83], a[152:155], v[88:91]
v_mfma_f32_16x16x32_bf16 v[92:95], a[88:91], a[152:155], v[92:95]
ds_read_b64_tr_b16 a[168:169], v12 offset:16384
ds_read_b64_tr_b16 a[170:171], v12 offset:16896
v_mfma_f32_16x16x32_bf16 v[92:95], a[92:95], a[156:159], v[92:95]
v_mfma_f32_16x16x32_bf16 v[84:87], a[92:95], a[148:151], v[84:87]
s_add_u32 m0, s73, 69632
s_add_u32 s64, s72, 0
v_mfma_f32_16x16x32_bf16 v[84:87], a[88:91], a[144:147], v[84:87]
v_mfma_f32_16x16x32_bf16 v[76:79], a[88:91], a[136:139], v[76:79]
buffer_load_dwordx4 v5, s[12:15], s64 offen lds
v_mfma_f32_16x16x32_bf16 v[76:79], a[92:95], a[140:143], v[76:79]
ds_read_b128 a[116:119], v10 offset:12288
v_mfma_f32_16x16x32_bf16 v[68:71], a[92:95], a[132:135], v[68:71]
v_mfma_f32_16x16x32_bf16 v[68:71], a[88:91], a[128:131], v[68:71]
s_waitcnt lgkmcnt(6)
ds_read_b64_tr_b16 a[172:173], v12 offset:24576
ds_read_b64_tr_b16 a[174:175], v12 offset:25088
v_mfma_f32_16x16x32_bf16 v[96:99], a[96:99], a[128:131], v[96:99]
v_mfma_f32_16x16x32_bf16 v[96:99], a[100:103], a[132:135], v[96:99]
v_mfma_f32_16x16x32_bf16 v[104:107], a[100:103], a[140:143], v[104:107]
ds_read_b128 a[120:123], v9 offset:14336
v_mfma_f32_16x16x32_bf16 v[104:107], a[96:99], a[136:139], v[104:107]
v_mfma_f32_16x16x32_bf16 v[112:115], a[96:99], a[144:147], v[112:115]
v_mfma_f32_16x16x32_bf16 v[112:115], a[100:103], a[148:151], v[112:115]
buffer_load_dwordx4 v6, s[12:15], s64 offen offset:1024 lds
v_mfma_f32_16x16x32_bf16 v[120:123], a[100:103], a[156:159], v[120:123]
ds_read_b64_tr_b16 a[176:177], v13 offset:16384
ds_read_b64_tr_b16 a[178:179], v13 offset:16896
v_mfma_f32_16x16x32_bf16 v[120:123], a[96:99], a[152:155], v[120:123]
v_mfma_f32_16x16x32_bf16 v[124:127], a[104:107], a[152:155], v[124:127]
v_mfma_f32_16x16x32_bf16 v[124:127], a[108:111], a[156:159], v[124:127]
ds_read_b128 a[124:127], v10 offset:14336
v_mfma_f32_16x16x32_bf16 v[116:119], a[108:111], a[148:151], v[116:119]
v_add_u32 v9, 32768, v9
v_add_u32 v10, 32768, v10
v_mfma_f32_16x16x32_bf16 v[116:119], a[104:107], a[144:147], v[116:119]
s_add_u32 m0, s73, 71680
s_add_u32 s64, s72, 18432
v_mfma_f32_16x16x32_bf16 v[108:111], a[104:107], a[136:139], v[108:111]
ds_read_b64_tr_b16 a[180:181], v13 offset:24576
ds_read_b64_tr_b16 a[182:183], v13 offset:25088
v_mfma_f32_16x16x32_bf16 v[108:111], a[108:111], a[140:143], v[108:111]
buffer_load_dwordx4 v5, s[12:15], s64 offen lds
v_mfma_f32_16x16x32_bf16 v[100:103], a[108:111], a[132:135], v[100:103]
v_mfma_f32_16x16x32_bf16 v[100:103], a[104:107], a[128:131], v[100:103]
s_waitcnt lgkmcnt(2)
ds_read_b64_tr_b16 a[184:185], v14 offset:16384
ds_read_b64_tr_b16 a[186:187], v14 offset:16896
v_mfma_f32_16x16x32_bf16 v[128:131], a[112:115], a[128:131], v[128:131]
v_mfma_f32_16x16x32_bf16 v[128:131], a[116:119], a[132:135], v[128:131]
v_mfma_f32_16x16x32_bf16 v[136:139], a[116:119], a[140:143], v[136:139]
ds_read_b64_tr_b16 a[188:189], v14 offset:24576
ds_read_b64_tr_b16 a[190:191], v14 offset:25088
v_mfma_f32_16x16x32_bf16 v[136:139], a[112:115], a[136:139], v[136:139]
v_mfma_f32_16x16x32_bf16 v[144:147], a[112:115], a[144:147], v[144:147]
v_mfma_f32_16x16x32_bf16 v[144:147], a[116:119], a[148:151], v[144:147]
buffer_load_dwordx4 v6, s[12:15], s64 offen offset:1024 lds
v_mfma_f32_16x16x32_bf16 v[152:155], a[116:119], a[156:159], v[152:155]
v_mfma_f32_16x16x32_bf16 v[152:155], a[112:115], a[152:155], v[152:155]
v_mfma_f32_16x16x32_bf16 v[156:159], a[120:123], a[152:155], v[156:159]
v_mfma_f32_16x16x32_bf16 v[156:159], a[124:127], a[156:159], v[156:159]
v_mfma_f32_16x16x32_bf16 v[148:151], a[124:127], a[148:151], v[148:151]
v_mfma_f32_16x16x32_bf16 v[148:151], a[120:123], a[144:147], v[148:151]
v_mfma_f32_16x16x32_bf16 v[140:143], a[120:123], a[136:139], v[140:143]
v_mfma_f32_16x16x32_bf16 v[140:143], a[124:127], a[140:143], v[140:143]
v_mfma_f32_16x16x32_bf16 v[132:135], a[124:127], a[132:135], v[132:135]
v_mfma_f32_16x16x32_bf16 v[132:135], a[120:123], a[128:131], v[132:135]
s_waitcnt lgkmcnt(0)
v_mfma_f32_16x16x32_bf16 v[160:163], a[160:163], a[64:67], v[160:163]
s_waitcnt vmcnt(17)
v_mfma_f32_16x16x32_bf16 v[160:163], a[164:167], a[68:71], v[160:163]
s_barrier
v_mfma_f32_16x16x32_bf16 v[164:167], a[172:175], a[68:71], v[164:167]
ds_read_b64_tr_b16 a[128:129], v11 offset:32768
ds_read_b64_tr_b16 a[130:131], v11 offset:33280
v_mfma_f32_16x16x32_bf16 v[164:167], a[168:171], a[64:67], v[164:167]
s_add_u32 m0, s77, 16384
s_add_u32 s64, s76, 128
v_mfma_f32_16x16x32_bf16 v[168:171], a[176:179], a[64:67], v[168:171]
buffer_load_dwordx4 v7, s[20:23], s64 offen lds
v_mfma_f32_16x16x32_bf16 v[168:171], a[180:183], a[68:71], v[168:171]
buffer_load_dword a253, v18, s[44:47], 0 offen
v_mfma_f32_16x16x32_bf16 v[172:175], a[188:191], a[68:71], v[172:175]
v_mfma_f32_16x16x32_bf16 v[172:175], a[184:187], a[64:67], v[172:175]
ds_read_b128 a[64:67], v9 offset:0
v_mfma_f32_16x16x32_bf16 v[188:191], a[184:187], a[72:75], v[188:191]
ds_read_b64_tr_b16 a[132:133], v11 offset:40960
ds_read_b64_tr_b16 a[134:135], v11 offset:41472
v_mfma_f32_16x16x32_bf16 v[188:191], a[188:191], a[76:79], v[188:191]
v_mfma_f32_16x16x32_bf16 v[184:187], a[180:183], a[76:79], v[184:187]
v_mfma_f32_16x16x32_bf16 v[184:187], a[176:179], a[72:75], v[184:187]
ds_read_b128 a[68:71], v10 offset:0
v_mfma_f32_16x16x32_bf16 v[180:183], a[168:171], a[72:75], v[180:183]
buffer_load_dwordx4 v8, s[20:23], s64 offen offset:1024 lds
v_mfma_f32_16x16x32_bf16 v[180:183], a[172:175], a[76:79], v[180:183]
v_mfma_f32_16x16x32_bf16 v[176:179], a[164:167], a[76:79], v[176:179]
v_mfma_f32_16x16x32_bf16 v[176:179], a[160:163], a[72:75], v[176:179]
ds_read_b64_tr_b16 a[136:137], v12 offset:32768
ds_read_b64_tr_b16 a[138:139], v12 offset:33280
v_mfma_f32_16x16x32_bf16 v[192:195], a[160:163], a[80:83], v[192:195]
v_mfma_f32_16x16x32_bf16 v[192:195], a[164:167], a[84:87], v[192:195]
v_mfma_f32_16x16x32_bf16 v[196:199], a[172:175], a[84:87], v[196:199]
s_add_u32 m0, s80, 16384
s_add_u32 s64, s79, 2048
ds_read_b128 a[72:75], v9 offset:2048
v_mfma_f32_16x16x32_bf16 v[196:199], a[168:171], a[80:83], v[196:199]
v_mfma_f32_16x16x32_bf16 v[200:203], a[176:179], a[80:83], v[200:203]
buffer_load_dwordx4 v4, s[24:27], s64 offen sc1 lds
v_mfma_f32_16x16x32_bf16 v[200:203], a[180:183], a[84:87], v[200:203]
s_xor_b32 s65, s70, 0
s_add_u32 s71, s68, s65
s_add_u32 s72, s69, s65
v_mfma_f32_16x16x32_bf16 v[204:207], a[188:191], a[84:87], v[204:207]
ds_read_b64_tr_b16 a[140:141], v12 offset:40960
ds_read_b64_tr_b16 a[142:143], v12 offset:41472
v_mfma_f32_16x16x32_bf16 v[204:207], a[184:187], a[80:83], v[204:207]
v_mfma_f32_16x16x32_bf16 v[220:223], a[184:187], a[88:91], v[220:223]
ds_read_b128 a[76:79], v10 offset:2048
v_mfma_f32_16x16x32_bf16 v[220:223], a[188:191], a[92:95], v[220:223]
v_mfma_f32_16x16x32_bf16 v[216:219], a[180:183], a[92:95], v[216:219]
s_add_u32 m0, s73, 0
s_add_u32 s64, s71, 0
v_mfma_f32_16x16x32_bf16 v[216:219], a[176:179], a[88:91], v[216:219]
v_mfma_f32_16x16x32_bf16 v[212:215], a[168:171], a[88:91], v[212:215]
buffer_load_dwordx4 v5, s[12:15], s64 offen lds
v_mfma_f32_16x16x32_bf16 v[212:215], a[172:175], a[92:95], v[212:215]
ds_read_b64_tr_b16 a[144:145], v13 offset:32768
ds_read_b64_tr_b16 a[146:147], v13 offset:33280
v_mfma_f32_16x16x32_bf16 v[208:211], a[164:167], a[92:95], v[208:211]
v_mfma_f32_16x16x32_bf16 v[208:211], a[160:163], a[88:91], v[208:211]
ds_read_b128 a[80:83], v9 offset:4096
v_mfma_f32_16x16x32_bf16 v[224:227], a[160:163], a[96:99], v[224:227]
v_mfma_f32_16x16x32_bf16 v[224:227], a[164:167], a[100:103], v[224:227]
v_mfma_f32_16x16x32_bf16 v[228:231], a[172:175], a[100:103], v[228:231]
ds_read_b64_tr_b16 a[148:149], v13 offset:40960
ds_read_b64_tr_b16 a[150:151], v13 offset:41472
v_mfma_f32_16x16x32_bf16 v[228:231], a[168:171], a[96:99], v[228:231]
v_mfma_f32_16x16x32_bf16 v[232:235], a[176:179], a[96:99], v[232:235]
v_mfma_f32_16x16x32_bf16 v[232:235], a[180:183], a[100:103], v[232:235]
buffer_load_dwordx4 v6, s[12:15], s64 offen offset:1024 lds
v_mfma_f32_16x16x32_bf16 v[236:239], a[188:191], a[100:103], v[236:239]
ds_read_b128 a[84:87], v10 offset:4096
v_mfma_f32_16x16x32_bf16 v[236:239], a[184:187], a[96:99], v[236:239]
v_mfma_f32_16x16x32_bf16 v[252:255], a[184:187], a[104:107], v[252:255]
v_mfma_f32_16x16x32_bf16 v[252:255], a[188:191], a[108:111], v[252:255]
ds_read_b64_tr_b16 a[152:153], v14 offset:32768
ds_read_b64_tr_b16 a[154:155], v14 offset:33280
v_mfma_f32_16x16x32_bf16 v[248:251], a[180:183], a[108:111], v[248:251]
v_mfma_f32_16x16x32_bf16 v[248:251], a[176:179], a[104:107], v[248:251]
s_add_u32 m0, s73, 2048
s_add_u32 s64, s71, 18432
v_mfma_f32_16x16x32_bf16 v[244:247], a[168:171], a[104:107], v[244:247]
ds_read_b128 a[88:91], v9 offset:6144
v_mfma_f32_16x16x32_bf16 v[244:247], a[172:175], a[108:111], v[244:247]
buffer_load_dwordx4 v5, s[12:15], s64 offen lds
v_mfma_f32_16x16x32_bf16 v[240:243], a[164:167], a[108:111], v[240:243]
v_mfma_f32_16x16x32_bf16 v[240:243], a[160:163], a[104:107], v[240:243]
ds_read_b64_tr_b16 a[156:157], v14 offset:40960
ds_read_b64_tr_b16 a[158:159], v14 offset:41472
v_mfma_f32_16x16x32_bf16 a[0:3], a[160:163], a[112:115], a[0:3]
v_mfma_f32_16x16x32_bf16 a[0:3], a[164:167], a[116:119], a[0:3]
v_mfma_f32_16x16x32_bf16 a[4:7], a[172:175], a[116:119], a[4:7]
ds_read_b128 a[92:95], v10 offset:6144
v_mfma_f32_16x16x32_bf16 a[4:7], a[168:171], a[112:115], a[4:7]
v_mfma_f32_16x16x32_bf16 a[8:11], a[176:179], a[112:115], a[8:11]
v_mfma_f32_16x16x32_bf16 a[8:11], a[180:183], a[116:119], a[8:11]
buffer_load_dwordx4 v6, s[12:15], s64 offen offset:1024 lds
v_mfma_f32_16x16x32_bf16 a[12:15], a[188:191], a[116:119], a[12:15]
v_mfma_f32_16x16x32_bf16 a[12:15], a[184:187], a[112:115], a[12:15]
v_mfma_f32_16x16x32_bf16 a[28:31], a[184:187], a[120:123], a[28:31]
v_mfma_f32_16x16x32_bf16 a[28:31], a[188:191], a[124:127], a[28:31]
v_mfma_f32_16x16x32_bf16 a[24:27], a[180:183], a[124:127], a[24:27]
L_PAD3:
s_cbranch_execz L_PAD7
v_mfma_f32_16x16x32_bf16 a[24:27], a[176:179], a[120:123], a[24:27]
v_mfma_f32_16x16x32_bf16 a[20:23], a[168:171], a[120:123], a[20:23]
v_mfma_f32_16x16x32_bf16 a[20:23], a[172:175], a[124:127], a[20:23]
v_mfma_f32_16x16x32_bf16 a[16:19], a[164:167], a[124:127], a[16:19]
v_mfma_f32_16x16x32_bf16 a[16:19], a[160:163], a[120:123], a[16:19]
s_waitcnt lgkmcnt(0)
v_mfma_f32_16x16x32_bf16 v[32:35], a[64:67], a[128:131], v[32:35]
s_waitcnt vmcnt(21)
v_mfma_f32_16x16x32_bf16 v[32:35], a[68:71], a[132:135], v[32:35]
s_barrier
v_mfma_f32_16x16x32_bf16 v[40:43], a[68:71], a[140:143], v[40:43]
ds_read_b128 a[96:99], v9 offset:8192
v_mfma_f32_16x16x32_bf16 v[40:43], a[64:67], a[136:139], v[40:43]
s_xor_b32 s75, s93, 0
s_lshl_b32 s76, s75, 19
s_add_u32 s76, s76, s74
v_mfma_f32_16x16x32_bf16 v[48:51], a[64:67], a[144:147], v[48:51]
s_lshl_b32 s79, s75, 13
s_add_u32 s79, s79, s78
v_mfma_f32_16x16x32_bf16 v[48:51], a[68:71], a[148:151], v[48:51]
s_add_u32 m0, s77, 32768
s_add_u32 s64, s76, 0
ds_read_b128 a[100:103], v10 offset:8192
v_mfma_f32_16x16x32_bf16 v[56:59], a[68:71], a[156:159], v[56:59]
buffer_load_dwordx4 v7, s[20:23], s64 offen lds
v_mfma_f32_16x16x32_bf16 v[56:59], a[64:67], a[152:155], v[56:59]
v_mfma_f32_16x16x32_bf16 v[60:63], a[72:75], a[152:155], v[60:63]
ds_read_b128 a[104:107], v9 offset:10240
v_mfma_f32_16x16x32_bf16 v[60:63], a[76:79], a[156:159], v[60:63]
v_mfma_f32_16x16x32_bf16 v[52:55], a[76:79], a[148:151], v[52:55]
v_mfma_f32_16x16x32_bf16 v[52:55], a[72:75], a[144:147], v[52:55]
ds_read_b64_tr_b16 a[160:161], v11 offset:49152
ds_read_b64_tr_b16 a[162:163], v11 offset:49664
v_mfma_f32_16x16x32_bf16 v[44:47], a[72:75], a[136:139], v[44:47]
buffer_load_dwordx4 v8, s[20:23], s64 offen offset:1024 lds
v_mfma_f32_16x16x32_bf16 v[44:47], a[76:79], a[140:143], v[44:47]
v_mfma_f32_16x16x32_bf16 v[36:39], a[76:79], a[132:135], v[36:39]
v_mfma_f32_16x16x32_bf16 v[36:39], a[72:75], a[128:131], v[36:39]
ds_read_b128 a[108:111], v10 offset:10240
v_mfma_f32_16x16x32_bf16 v[64:67], a[80:83], a[128:131], v[64:67]
v_mfma_f32_16x16x32_bf16 v[64:67], a[84:87], a[132:135], v[64:67]
v_mfma_f32_16x16x32_bf16 v[72:75], a[84:87], a[140:143], v[72:75]
s_add_u32 m0, s80, 32768
s_add_u32 s64, s79, 0
v_mfma_f32_16x16x32_bf16 v[72:75], a[80:83], a[136:139], v[72:75]
ds_read_b64_tr_b16 a[164:165], v11 offset:57344
ds_read_b64_tr_b16 a[166:167], v11 offset:57856
v_mfma_f32_16x16x32_bf16 v[80:83], a[80:83], a[144:147], v[80:83]
buffer_load_dwordx4 v4, s[24:27], s64 offen sc1 lds
v_mfma_f32_16x16x32_bf16 v[80:83], a[84:87], a[148:151], v[80:83]
ds_read_b128 a[112:115], v9 offset:12288
v_mfma_f32_16x16x32_bf16 v[88:91], a[84:87], a[156:159], v[88:91]
v_cvt_pk_bf16_f32 v32, v32, v33
v_cvt_pk_bf16_f32 v33, v34, v35
v_mfma_f32_16x16x32_bf16 v[88:91], a[80:83], a[152:155], v[88:91]
v_cvt_pk_bf16_f32 v34, v36, v37
v_cvt_pk_bf16_f32 v35, v38, v39
v_mfma_f32_16x16x32_bf16 v[92:95], a[88:91], a[152:155], v[92:95]
ds_read_b64_tr_b16 a[168:169], v12 offset:49152
ds_read_b64_tr_b16 a[170:171], v12 offset:49664
v_mfma_f32_16x16x32_bf16 v[92:95], a[92:95], a[156:159], v[92:95]
v_cvt_pk_bf16_f32 v40, v40, v41
v_cvt_pk_bf16_f32 v41, v42, v43
v_mfma_f32_16x16x32_bf16 v[84:87], a[92:95], a[148:151], v[84:87]
s_add_u32 m0, s73, 4096
s_add_u32 s64, s72, 0
s_lshr_b32 s55, s3, 1
v_mfma_f32_16x16x32_bf16 v[84:87], a[88:91], a[144:147], v[84:87]
s_lshl_b32 s55, s55, 14
s_lshl_b32 s54, s3, 13
s_sub_u32 s55, s54, s55
v_mfma_f32_16x16x32_bf16 v[76:79], a[88:91], a[136:139], v[76:79]
buffer_load_dwordx4 v5, s[12:15], s64 offen lds
v_mfma_f32_16x16x32_bf16 v[76:79], a[92:95], a[140:143], v[76:79]
s_and_b32 s54, s3, 1
s_lshl_b32 s54, s54, 12
ds_read_b128 a[116:119], v10 offset:12288
v_mfma_f32_16x16x32_bf16 v[68:71], a[92:95], a[132:135], v[68:71]
s_add_u32 s53, s88, 0
v_cvt_pk_bf16_f32 v42, v44, v45
v_cvt_pk_bf16_f32 v43, v46, v47
v_mfma_f32_16x16x32_bf16 v[68:71], a[88:91], a[128:131], v[68:71]
s_waitcnt lgkmcnt(6)
ds_read_b64_tr_b16 a[172:173], v12 offset:57344
ds_read_b64_tr_b16 a[174:175], v12 offset:57856
v_mfma_f32_16x16x32_bf16 v[96:99], a[96:99], a[128:131], v[96:99]
buffer_store_dwordx4 v[32:35], v4, s[24:27], s53 offen offset:0 sc1
v_mfma_f32_16x16x32_bf16 v[96:99], a[100:103], a[132:135], v[96:99]
v_cvt_pk_bf16_f32 v48, v48, v49
v_cvt_pk_bf16_f32 v49, v50, v51
v_mfma_f32_16x16x32_bf16 v[104:107], a[100:103], a[140:143], v[104:107]
ds_read_b128 a[120:123], v9 offset:14336
v_cvt_pk_bf16_f32 v50, v52, v53
v_mfma_f32_16x16x32_bf16 v[104:107], a[96:99], a[136:139], v[104:107]
v_cvt_pk_bf16_f32 v51, v54, v55
v_cvt_pk_bf16_f32 v56, v56, v57
v_mfma_f32_16x16x32_bf16 v[112:115], a[96:99], a[144:147], v[112:115]
v_cvt_pk_bf16_f32 v57, v58, v59
v_cvt_pk_bf16_f32 v58, v60, v61
v_mfma_f32_16x16x32_bf16 v[112:115], a[100:103], a[148:151], v[112:115]
buffer_load_dwordx4 v6, s[12:15], s64 offen offset:1024 lds
v_mfma_f32_16x16x32_bf16 v[120:123], a[100:103], a[156:159], v[120:123]
ds_read_b64_tr_b16 a[176:177], v13 offset:49152
ds_read_b64_tr_b16 a[178:179], v13 offset:49664
v_mfma_f32_16x16x32_bf16 v[120:123], a[96:99], a[152:155], v[120:123]
v_cvt_pk_bf16_f32 v59, v62, v63
v_cvt_pk_bf16_f32 v64, v64, v65
v_mfma_f32_16x16x32_bf16 v[124:127], a[104:107], a[152:155], v[124:127]
v_cvt_pk_bf16_f32 v65, v66, v67
v_cvt_pk_bf16_f32 v66, v68, v69
v_mfma_f32_16x16x32_bf16 v[124:127], a[108:111], a[156:159], v[124:127]
ds_read_b128 a[124:127], v10 offset:14336
v_cvt_pk_bf16_f32 v67, v70, v71
v_mfma_f32_16x16x32_bf16 v[116:119], a[108:111], a[148:151], v[116:119]
v_add_u32 v9, 32768, v9
v_add_u32 v10, 32768, v10
v_mfma_f32_16x16x32_bf16 v[116:119], a[104:107], a[144:147], v[116:119]
s_add_u32 m0, s73, 6144
s_add_u32 s64, s72, 18432
v_cvt_pk_bf16_f32 v72, v72, v73
v_mfma_f32_16x16x32_bf16 v[108:111], a[104:107], a[136:139], v[108:111]
ds_read_b64_tr_b16 a[180:181], v13 offset:57344
ds_read_b64_tr_b16 a[182:183], v13 offset:57856
v_mfma_f32_16x16x32_bf16 v[108:111], a[108:111], a[140:143], v[108:111]
buffer_load_dwordx4 v5, s[12:15], s64 offen lds
v_mfma_f32_16x16x32_bf16 v[100:103], a[108:111], a[132:135], v[100:103]
v_cvt_pk_bf16_f32 v73, v74, v75
v_cvt_pk_bf16_f32 v74, v76, v77
v_mfma_f32_16x16x32_bf16 v[100:103], a[104:107], a[128:131], v[100:103]
s_waitcnt lgkmcnt(2)
ds_read_b64_tr_b16 a[184:185], v14 offset:49152
ds_read_b64_tr_b16 a[186:187], v14 offset:49664
v_mfma_f32_16x16x32_bf16 v[128:131], a[112:115], a[128:131], v[128:131]
v_cvt_pk_bf16_f32 v75, v78, v79
v_cvt_pk_bf16_f32 v80, v80, v81
v_mfma_f32_16x16x32_bf16 v[128:131], a[116:119], a[132:135], v[128:131]
v_cvt_pk_bf16_f32 v81, v82, v83
v_cvt_pk_bf16_f32 v82, v84, v85
v_mfma_f32_16x16x32_bf16 v[136:139], a[116:119], a[140:143], v[136:139]
ds_read_b64_tr_b16 a[188:189], v14 offset:57344
ds_read_b64_tr_b16 a[190:191], v14 offset:57856
v_mfma_f32_16x16x32_bf16 v[136:139], a[112:115], a[136:139], v[136:139]
v_add_u32 v9, s55, v9
v_add_u32 v10, s55, v10
v_mfma_f32_16x16x32_bf16 v[144:147], a[112:115], a[144:147], v[144:147]
v_subrev_u32 v11, s54, v11
v_subrev_u32 v12, s54, v12
v_mfma_f32_16x16x32_bf16 v[144:147], a[116:119], a[148:151], v[144:147]
buffer_load_dwordx4 v6, s[12:15], s64 offen offset:1024 lds
v_mfma_f32_16x16x32_bf16 v[152:155], a[116:119], a[156:159], v[152:155]
v_subrev_u32 v13, s54, v13
v_subrev_u32 v14, s54, v14
v_mfma_f32_16x16x32_bf16 v[152:155], a[112:115], a[152:155], v[152:155]
v_cvt_pk_bf16_f32 v83, v86, v87
v_cvt_pk_bf16_f32 v88, v88, v89
v_mfma_f32_16x16x32_bf16 v[156:159], a[120:123], a[152:155], v[156:159]
v_cvt_pk_bf16_f32 v89, v90, v91
v_cvt_pk_bf16_f32 v90, v92, v93
v_mfma_f32_16x16x32_bf16 v[156:159], a[124:127], a[156:159], v[156:159]
s_add_u32 s53, s88, 0
v_cvt_pk_bf16_f32 v91, v94, v95
v_cvt_pk_bf16_f32 v96, v96, v97
v_mfma_f32_16x16x32_bf16 v[148:151], a[124:127], a[148:151], v[148:151]
buffer_store_dwordx4 v[40:43], v4, s[24:27], s53 offen offset:1024 sc1
v_mfma_f32_16x16x32_bf16 v[148:151], a[120:123], a[144:147], v[148:151]
v_cvt_pk_bf16_f32 v97, v98, v99
v_cvt_pk_bf16_f32 v98, v100, v101
v_mfma_f32_16x16x32_bf16 v[140:143], a[120:123], a[136:139], v[140:143]
v_cvt_pk_bf16_f32 v99, v102, v103
v_cvt_pk_bf16_f32 v104, v104, v105
v_mfma_f32_16x16x32_bf16 v[140:143], a[124:127], a[140:143], v[140:143]
v_cvt_pk_bf16_f32 v105, v106, v107
v_cvt_pk_bf16_f32 v106, v108, v109
v_mfma_f32_16x16x32_bf16 v[132:135], a[124:127], a[132:135], v[132:135]
v_cvt_pk_bf16_f32 v107, v110, v111
v_cvt_pk_bf16_f32 v112, v112, v113
v_mfma_f32_16x16x32_bf16 v[132:135], a[120:123], a[128:131], v[132:135]
s_waitcnt lgkmcnt(0)
v_cvt_pk_bf16_f32 v113, v114, v115
v_cvt_pk_bf16_f32 v114, v116, v117
v_mfma_f32_16x16x32_bf16 v[160:163], a[160:163], a[64:67], v[160:163]
s_waitcnt vmcnt(17)
v_cvt_pk_bf16_f32 v115, v118, v119
v_cvt_pk_bf16_f32 v120, v120, v121
v_mfma_f32_16x16x32_bf16 v[160:163], a[164:167], a[68:71], v[160:163]
s_barrier
v_mfma_f32_16x16x32_bf16 v[164:167], a[172:175], a[68:71], v[164:167]
ds_read_b64_tr_b16 a[128:129], v11 offset:0
ds_read_b64_tr_b16 a[130:131], v11 offset:512
v_mfma_f32_16x16x32_bf16 v[164:167], a[168:171], a[64:67], v[164:167]
s_add_u32 m0, s77, 49152
s_add_u32 s64, s76, 128
v_cvt_pk_bf16_f32 v121, v122, v123
v_mfma_f32_16x16x32_bf16 v[168:171], a[176:179], a[64:67], v[168:171]
buffer_load_dwordx4 v7, s[20:23], s64 offen lds
v_mfma_f32_16x16x32_bf16 v[168:171], a[180:183], a[68:71], v[168:171]
ds_read_b64_tr_b16 a[132:133], v11 offset:4096
ds_read_b64_tr_b16 a[134:135], v11 offset:4608
v_mfma_f32_16x16x32_bf16 v[172:175], a[188:191], a[68:71], v[172:175]
v_cvt_pk_bf16_f32 v122, v124, v125
v_cvt_pk_bf16_f32 v123, v126, v127
v_mfma_f32_16x16x32_bf16 v[172:175], a[184:187], a[64:67], v[172:175]
v_cvt_pk_bf16_f32 v128, v128, v129
v_cvt_pk_bf16_f32 v129, v130, v131
v_mfma_f32_16x16x32_bf16 v[188:191], a[184:187], a[72:75], v[188:191]
ds_read_b64_tr_b16 a[136:137], v12 offset:0
ds_read_b64_tr_b16 a[138:139], v12 offset:512
v_mfma_f32_16x16x32_bf16 v[188:191], a[188:191], a[76:79], v[188:191]
v_cvt_pk_bf16_f32 v130, v132, v133
v_cvt_pk_bf16_f32 v131, v134, v135
v_mfma_f32_16x16x32_bf16 v[184:187], a[180:183], a[76:79], v[184:187]
v_cvt_pk_bf16_f32 v136, v136, v137
v_cvt_pk_bf16_f32 v137, v138, v139
v_mfma_f32_16x16x32_bf16 v[184:187], a[176:179], a[72:75], v[184:187]
ds_read_b64_tr_b16 a[140:141], v12 offset:4096
ds_read_b64_tr_b16 a[142:143], v12 offset:4608
v_mfma_f32_16x16x32_bf16 v[180:183], a[168:171], a[72:75], v[180:183]
buffer_load_dwordx4 v8, s[20:23], s64 offen offset:1024 lds
v_mfma_f32_16x16x32_bf16 v[180:183], a[172:175], a[76:79], v[180:183]
v_cvt_pk_bf16_f32 v138, v140, v141
v_cvt_pk_bf16_f32 v139, v142, v143
v_mfma_f32_16x16x32_bf16 v[176:179], a[164:167], a[76:79], v[176:179]
v_cvt_pk_bf16_f32 v144, v144, v145
v_cvt_pk_bf16_f32 v145, v146, v147
v_mfma_f32_16x16x32_bf16 v[176:179], a[160:163], a[72:75], v[176:179]
ds_read_b64_tr_b16 a[144:145], v13 offset:0
ds_read_b64_tr_b16 a[146:147], v13 offset:512
v_mfma_f32_16x16x32_bf16 v[192:195], a[160:163], a[80:83], v[192:195]
v_cvt_pk_bf16_f32 v146, v148, v149
v_cvt_pk_bf16_f32 v147, v150, v151
v_mfma_f32_16x16x32_bf16 v[192:195], a[164:167], a[84:87], v[192:195]
v_cvt_pk_bf16_f32 v152, v152, v153
v_cvt_pk_bf16_f32 v153, v154, v155
v_mfma_f32_16x16x32_bf16 v[196:199], a[172:175], a[84:87], v[196:199]
s_add_u32 m0, s80, 49152
s_add_u32 s64, s79, 2048
v_cvt_pk_bf16_f32 v154, v156, v157
v_mfma_f32_16x16x32_bf16 v[196:199], a[168:171], a[80:83], v[196:199]
ds_read_b64_tr_b16 a[148:149], v13 offset:4096
ds_read_b64_tr_b16 a[150:151], v13 offset:4608
v_mfma_f32_16x16x32_bf16 v[200:203], a[176:179], a[80:83], v[200:203]
buffer_load_dwordx4 v4, s[24:27], s64 offen sc1 lds
v_mfma_f32_16x16x32_bf16 v[200:203], a[180:183], a[84:87], v[200:203]
s_xor_b32 s65, s70, 128
s_add_u32 s71, s68, s65
s_add_u32 s72, s69, s65
v_mfma_f32_16x16x32_bf16 v[204:207], a[188:191], a[84:87], v[204:207]
s_add_u32 s53, s88, 0
ds_read_b64_tr_b16 a[152:153], v14 offset:0
ds_read_b64_tr_b16 a[154:155], v14 offset:512
v_mfma_f32_16x16x32_bf16 v[204:207], a[184:187], a[80:83], v[204:207]
buffer_store_dwordx4 v[48:51], v4, s[24:27], s53 offen offset:2048 sc1
v_mfma_f32_16x16x32_bf16 v[220:223], a[184:187], a[88:91], v[220:223]
ds_read_b64_tr_b16 a[156:157], v14 offset:4096
ds_read_b64_tr_b16 a[158:159], v14 offset:4608
v_mfma_f32_16x16x32_bf16 v[220:223], a[188:191], a[92:95], v[220:223]
v_cvt_pk_bf16_f32 v155, v158, v159
v_mul_f32 v160, s91, v160
v_mfma_f32_16x16x32_bf16 v[216:219], a[180:183], a[92:95], v[216:219]
s_add_u32 m0, s73, 32768
s_add_u32 s64, s71, 0
v_mul_f32 v161, s91, v161
v_mfma_f32_16x16x32_bf16 v[216:219], a[176:179], a[88:91], v[216:219]
v_mul_f32 v162, s91, v162
v_mul_f32 v163, s91, v163
v_mfma_f32_16x16x32_bf16 v[212:215], a[168:171], a[88:91], v[212:215]
buffer_load_dwordx4 v5, s[12:15], s64 offen lds
v_mfma_f32_16x16x32_bf16 v[212:215], a[172:175], a[92:95], v[212:215]
ds_read_b128 a[68:71], v4 offset:10240
v_mul_f32 v164, s91, v164
v_mfma_f32_16x16x32_bf16 v[208:211], a[164:167], a[92:95], v[208:211]
v_mul_f32 v165, s91, v165
v_mul_f32 v166, s91, v166
v_mfma_f32_16x16x32_bf16 v[208:211], a[160:163], a[88:91], v[208:211]
ds_read_b128 a[64:67], v4 offset:8192
v_mul_f32 v167, s91, v167
v_mfma_f32_16x16x32_bf16 v[224:227], a[160:163], a[96:99], v[224:227]
v_cvt_pk_bf16_f32 v160, v160, v161
v_cvt_pk_bf16_f32 v161, v162, v163
v_mfma_f32_16x16x32_bf16 v[224:227], a[164:167], a[100:103], v[224:227]
v_cvt_pk_bf16_f32 v162, v164, v165
v_cvt_pk_bf16_f32 v163, v166, v167
v_mfma_f32_16x16x32_bf16 v[228:231], a[172:175], a[100:103], v[228:231]
ds_read_b128 a[76:79], v4 offset:11264
v_mul_f32 v168, s91, v168
v_mfma_f32_16x16x32_bf16 v[228:231], a[168:171], a[96:99], v[228:231]
v_mul_f32 v169, s91, v169
v_mul_f32 v170, s91, v170
v_mfma_f32_16x16x32_bf16 v[232:235], a[176:179], a[96:99], v[232:235]
v_mul_f32 v171, s91, v171
v_mul_f32 v172, s91, v172
v_mfma_f32_16x16x32_bf16 v[232:235], a[180:183], a[100:103], v[232:235]
buffer_load_dwordx4 v6, s[12:15], s64 offen offset:1024 lds
v_mfma_f32_16x16x32_bf16 v[236:239], a[188:191], a[100:103], v[236:239]
ds_read_b128 a[72:75], v4 offset:9216
v_mul_f32 v173, s91, v173
v_mfma_f32_16x16x32_bf16 v[236:239], a[184:187], a[96:99], v[236:239]
v_mul_f32 v174, s91, v174
v_mul_f32 v175, s91, v175
v_mfma_f32_16x16x32_bf16 v[252:255], a[184:187], a[104:107], v[252:255]
v_cvt_pk_bf16_f32 v168, v168, v169
v_cvt_pk_bf16_f32 v169, v170, v171
v_mfma_f32_16x16x32_bf16 v[252:255], a[188:191], a[108:111], v[252:255]
ds_read_b128 a[84:87], v10 offset:0
v_cvt_pk_bf16_f32 v170, v172, v173
v_mfma_f32_16x16x32_bf16 v[248:251], a[180:183], a[108:111], v[248:251]
v_cvt_pk_bf16_f32 v171, v174, v175
v_mul_f32 v176, s91, v176
v_mfma_f32_16x16x32_bf16 v[248:251], a[176:179], a[104:107], v[248:251]
s_add_u32 m0, s73, 34816
s_add_u32 s64, s71, 18432
v_mul_f32 v177, s91, v177
v_mfma_f32_16x16x32_bf16 v[244:247], a[168:171], a[104:107], v[244:247]
ds_read_b128 a[80:83], v9 offset:0
v_mul_f32 v178, s91, v178
v_mfma_f32_16x16x32_bf16 v[244:247], a[172:175], a[108:111], v[244:247]
buffer_load_dwordx4 v5, s[12:15], s64 offen lds
v_mfma_f32_16x16x32_bf16 v[240:243], a[164:167], a[108:111], v[240:243]
v_mul_f32 v179, s91, v179
v_mul_f32 v180, s91, v180
v_mfma_f32_16x16x32_bf16 v[240:243], a[160:163], a[104:107], v[240:243]
s_add_u32 s53, s88, 0
ds_read_b128 a[92:95], v10 offset:2048
v_mul_f32 v181, s91, v181
v_mfma_f32_16x16x32_bf16 a[0:3], a[160:163], a[112:115], a[0:3]
buffer_store_dwordx4 v[56:59], v4, s[24:27], s53 offen offset:3072 sc1
v_mfma_f32_16x16x32_bf16 a[0:3], a[164:167], a[116:119], a[0:3]
v_mul_f32 v182, s91, v182
v_mul_f32 v183, s91, v183
v_mfma_f32_16x16x32_bf16 a[4:7], a[172:175], a[116:119], a[4:7]
ds_read_b128 a[88:91], v9 offset:2048
v_cvt_pk_bf16_f32 v176, v176, v177
v_mfma_f32_16x16x32_bf16 a[4:7], a[168:171], a[112:115], a[4:7]
v_cvt_pk_bf16_f32 v177, v178, v179
v_cvt_pk_bf16_f32 v178, v180, v181
v_mfma_f32_16x16x32_bf16 a[8:11], a[176:179], a[112:115], a[8:11]
v_cvt_pk_bf16_f32 v179, v182, v183
v_mul_f32 v184, s91, v184
v_mfma_f32_16x16x32_bf16 a[8:11], a[180:183], a[116:119], a[8:11]
buffer_load_dwordx4 v6, s[12:15], s64 offen offset:1024 lds
v_mfma_f32_16x16x32_bf16 a[12:15], a[188:191], a[116:119], a[12:15]
v_mul_f32 v185, s91, v185
v_mul_f32 v186, s91, v186
v_mfma_f32_16x16x32_bf16 a[12:15], a[184:187], a[112:115], a[12:15]
v_mul_f32 v187, s91, v187
v_mul_f32 v188, s91, v188
v_mfma_f32_16x16x32_bf16 a[28:31], a[184:187], a[120:123], a[28:31]
v_mul_f32 v189, s91, v189
v_mul_f32 v190, s91, v190
v_mfma_f32_16x16x32_bf16 a[28:31], a[188:191], a[124:127], a[28:31]
v_mul_f32 v191, s91, v191
v_cvt_pk_bf16_f32 v184, v184, v185
v_mfma_f32_16x16x32_bf16 a[24:27], a[180:183], a[124:127], a[24:27]
v_cvt_pk_bf16_f32 v185, v186, v187
v_cvt_pk_bf16_f32 v186, v188, v189
v_mfma_f32_16x16x32_bf16 a[24:27], a[176:179], a[120:123], a[24:27]
v_cvt_pk_bf16_f32 v187, v190, v191
v_mul_f32 v192, s91, v192
v_mfma_f32_16x16x32_bf16 a[20:23], a[168:171], a[120:123], a[20:23]
v_mul_f32 v193, s91, v193
v_mul_f32 v194, s91, v194
v_mfma_f32_16x16x32_bf16 a[20:23], a[172:175], a[124:127], a[20:23]
v_mul_f32 v195, s91, v195
v_mul_f32 v196, s91, v196
v_mfma_f32_16x16x32_bf16 a[16:19], a[164:167], a[124:127], a[16:19]
v_mul_f32 v197, s91, v197
v_mul_f32 v198, s91, v198
v_mfma_f32_16x16x32_bf16 a[16:19], a[160:163], a[120:123], a[16:19]
s_waitcnt lgkmcnt(0)
v_mul_f32 v199, s91, v199
v_cvt_pk_bf16_f32 v192, v192, v193
v_mfma_f32_16x16x32_bf16 v[36:39], a[128:131], a[80:83], 0
s_waitcnt vmcnt(22)
v_cvt_pk_bf16_f32 v193, v194, v195
v_cvt_pk_bf16_f32 v194, v196, v197
v_mfma_f32_16x16x32_bf16 v[36:39], a[132:135], a[84:87], v[36:39]
s_barrier
v_mfma_f32_16x16x32_bf16 v[44:47], a[140:143], a[84:87], 0
ds_read_b128 a[96:99], v9 offset:4096
v_cvt_pk_bf16_f32 v195, v198, v199
v_mfma_f32_16x16x32_bf16 v[44:47], a[136:139], a[80:83], v[44:47]
s_xor_b32 s75, s93, 1
s_lshl_b32 s76, s75, 19
s_add_u32 s76, s76, s74
v_mfma_f32_16x16x32_bf16 v[32:35], a[144:147], a[80:83], 0
s_lshl_b32 s79, s75, 13
s_add_u32 s79, s79, s78
ds_read_b128 a[100:103], v10 offset:4096
v_mfma_f32_16x16x32_bf16 v[32:35], a[148:151], a[84:87], v[32:35]
s_add_u32 m0, s77, 0
s_add_u32 s64, s76, 0
ds_read_b128 a[104:107], v9 offset:6144
v_mfma_f32_16x16x32_bf16 v[52:55], a[156:159], a[84:87], 0
buffer_load_dwordx4 v7, s[20:23], s64 offen lds
v_mfma_f32_16x16x32_bf16 v[52:55], a[152:155], a[80:83], v[52:55]
ds_read_b64_tr_b16 a[160:161], v11 offset:16384
ds_read_b64_tr_b16 a[162:163], v11 offset:16896
v_mfma_f32_16x16x32_bf16 v[60:63], a[64:67], a[80:83], 0
v_mul_f32 v200, s91, v200
v_mul_f32 v201, s91, v201
v_mfma_f32_16x16x32_bf16 v[60:63], a[68:71], a[84:87], v[60:63]
ds_read_b128 a[108:111], v10 offset:6144
v_mul_f32 v202, s91, v202
v_mfma_f32_16x16x32_bf16 v[68:71], a[76:79], a[84:87], 0
buffer_load_dwordx4 v8, s[20:23], s64 offen offset:1024 lds
v_mfma_f32_16x16x32_bf16 v[68:71], a[72:75], a[80:83], v[68:71]
s_add_u32 s53, s88, 262144
ds_read_b64_tr_b16 a[164:165], v11 offset:20480
ds_read_b64_tr_b16 a[166:167], v11 offset:20992
v_mfma_f32_16x16x32_bf16 v[76:79], a[72:75], a[88:91], 0
v_add_u32 v9, -65536, v9
v_add_u32 v10, -65536, v10
v_mfma_f32_16x16x32_bf16 v[76:79], a[76:79], a[92:95], v[76:79]
ds_read_b64_tr_b16 a[168:169], v12 offset:16384
ds_read_b64_tr_b16 a[170:171], v12 offset:16896
v_mfma_f32_16x16x32_bf16 v[84:87], a[68:71], a[92:95], 0
s_add_u32 m0, s80, 0
s_add_u32 s64, s79, 0
v_mul_f32 v203, s91, v203
v_mfma_f32_16x16x32_bf16 v[84:87], a[64:67], a[88:91], v[84:87]
ds_read_b64_tr_b16 a[172:173], v12 offset:20480
ds_read_b64_tr_b16 a[174:175], v12 offset:20992
v_mfma_f32_16x16x32_bf16 v[92:95], a[152:155], a[88:91], 0
buffer_load_dwordx4 v4, s[24:27], s64 offen sc1 lds
v_mfma_f32_16x16x32_bf16 v[92:95], a[156:159], a[92:95], v[92:95]
buffer_store_dwordx4 v[64:67], v4, s[24:27], s53 offen offset:0 sc1
v_mfma_f32_16x16x32_bf16 v[40:43], a[148:151], a[92:95], 0
ds_read_b64_tr_b16 a[176:177], v13 offset:16384
ds_read_b64_tr_b16 a[178:179], v13 offset:16896
v_mfma_f32_16x16x32_bf16 v[40:43], a[144:147], a[88:91], v[40:43]
v_mul_f32 v204, s91, v204
v_mul_f32 v205, s91, v205
v_mfma_f32_16x16x32_bf16 v[100:103], a[136:139], a[88:91], 0
s_add_u32 m0, s73, 36864
s_add_u32 s64, s72, 0
v_mul_f32 v206, s91, v206
v_mfma_f32_16x16x32_bf16 v[100:103], a[140:143], a[92:95], v[100:103]
ds_read_b64_tr_b16 a[180:181], v13 offset:20480
ds_read_b64_tr_b16 a[182:183], v13 offset:20992
v_mfma_f32_16x16x32_bf16 v[108:111], a[132:135], a[92:95], 0
buffer_load_dwordx4 v5, s[12:15], s64 offen lds
v_mfma_f32_16x16x32_bf16 v[108:111], a[128:131], a[88:91], v[108:111]
s_waitcnt lgkmcnt(14)
ds_read_b64_tr_b16 a[184:185], v14 offset:16384
ds_read_b64_tr_b16 a[186:187], v14 offset:16896
v_mfma_f32_16x16x32_bf16 v[116:119], a[128:131], a[96:99], 0
ds_read_b64_tr_b16 a[188:189], v14 offset:20480
ds_read_b64_tr_b16 a[190:191], v14 offset:20992
v_mfma_f32_16x16x32_bf16 v[116:119], a[132:135], a[100:103], v[116:119]
v_mul_f32 v207, s91, v207
v_cvt_pk_bf16_f32 v200, v200, v201
v_mfma_f32_16x16x32_bf16 v[124:127], a[140:143], a[100:103], 0
v_cvt_pk_bf16_f32 v201, v202, v203
v_cvt_pk_bf16_f32 v202, v204, v205
v_mfma_f32_16x16x32_bf16 v[124:127], a[136:139], a[96:99], v[124:127]
ds_read_b128 a[112:115], v4 offset:24576
v_cvt_pk_bf16_f32 v203, v206, v207
v_mfma_f32_16x16x32_bf16 v[132:135], a[144:147], a[96:99], 0
buffer_load_dwordx4 v6, s[12:15], s64 offen offset:1024 lds
v_mfma_f32_16x16x32_bf16 v[132:135], a[148:151], a[100:103], v[132:135]
ds_read_b128 a[116:119], v4 offset:26624
v_mul_f32 v208, s91, v208
v_mfma_f32_16x16x32_bf16 v[140:143], a[156:159], a[100:103], 0
v_mul_f32 v209, s91, v209
v_mul_f32 v210, s91, v210
v_mfma_f32_16x16x32_bf16 v[140:143], a[152:155], a[96:99], v[140:143]
ds_read_b128 a[120:123], v4 offset:25600
v_mul_f32 v211, s91, v211
v_mfma_f32_16x16x32_bf16 v[148:151], a[64:67], a[96:99], 0
s_add_u32 m0, s73, 38912
s_add_u32 s64, s72, 18432
v_mul_f32 v212, s91, v212
v_mfma_f32_16x16x32_bf16 v[148:151], a[68:71], a[100:103], v[148:151]
ds_read_b128 a[124:127], v4 offset:27648
v_mul_f32 v213, s91, v213
v_mfma_f32_16x16x32_bf16 v[48:51], a[76:79], a[100:103], 0
buffer_load_dwordx4 v5, s[12:15], s64 offen lds
v_mfma_f32_16x16x32_bf16 v[48:51], a[72:75], a[96:99], v[48:51]
s_waitcnt lgkmcnt(15)
v_mul_f32 v214, s91, v214
v_mul_f32 v215, s91, v215
v_mfma_f32_16x16x32_bf16 v[156:159], a[72:75], a[104:107], 0
v_cvt_pk_bf16_f32 v208, v208, v209
v_cvt_pk_bf16_f32 v209, v210, v211
v_mfma_f32_16x16x32_bf16 v[156:159], a[76:79], a[108:111], v[156:159]
s_add_u32 s53, s88, 262144
v_cvt_pk_bf16_f32 v210, v212, v213
v_cvt_pk_bf16_f32 v211, v214, v215
v_mfma_f32_16x16x32_bf16 v[164:167], a[68:71], a[108:111], 0
buffer_store_dwordx4 v[72:75], v4, s[24:27], s53 offen offset:1024 sc1
v_mfma_f32_16x16x32_bf16 v[164:167], a[64:67], a[104:107], v[164:167]
v_mul_f32 v216, s91, v216
v_mul_f32 v217, s91, v217
v_mfma_f32_16x16x32_bf16 v[172:175], a[152:155], a[104:107], 0
buffer_load_dwordx4 v6, s[12:15], s64 offen offset:1024 lds
v_mfma_f32_16x16x32_bf16 v[172:175], a[156:159], a[108:111], v[172:175]
v_mul_f32 v218, s91, v218
v_mul_f32 v219, s91, v219
v_mfma_f32_16x16x32_bf16 v[56:59], a[148:151], a[108:111], 0
v_mul_f32 v220, s91, v220
v_mul_f32 v221, s91, v221
v_mfma_f32_16x16x32_bf16 v[56:59], a[144:147], a[104:107], v[56:59]
v_mul_f32 v222, s91, v222
v_mul_f32 v223, s91, v223
v_mfma_f32_16x16x32_bf16 v[180:183], a[136:139], a[104:107], 0
v_cvt_pk_bf16_f32 v216, v216, v217
v_cvt_pk_bf16_f32 v217, v218, v219
v_mfma_f32_16x16x32_bf16 v[180:183], a[140:143], a[108:111], v[180:183]
v_cvt_pk_bf16_f32 v218, v220, v221
v_cvt_pk_bf16_f32 v219, v222, v223
v_mfma_f32_16x16x32_bf16 v[188:191], a[132:135], a[108:111], 0
v_mul_f32 v224, s91, v224
v_mul_f32 v225, s91, v225
v_mfma_f32_16x16x32_bf16 v[188:191], a[128:131], a[104:107], v[188:191]
s_waitcnt lgkmcnt(0)
v_mul_f32 v226, s91, v226
v_mul_f32 v227, s91, v227
v_mfma_f32_16x16x32_bf16 v[196:199], a[160:163], a[80:83], 0
s_waitcnt vmcnt(19)
v_mul_f32 v228, s91, v228
v_mul_f32 v229, s91, v229
v_mfma_f32_16x16x32_bf16 v[196:199], a[164:167], a[84:87], v[196:199]
s_barrier
v_mfma_f32_16x16x32_bf16 v[64:67], a[172:175], a[84:87], 0
ds_read_b64_tr_b16 a[128:129], v11 offset:32768
ds_read_b64_tr_b16 a[130:131], v11 offset:33280
v_mfma_f32_16x16x32_bf16 v[64:67], a[168:171], a[80:83], v[64:67]
s_add_u32 m0, s77, 16384
s_add_u32 s64, s76, 128
v_mul_f32 v230, s91, v230
v_mfma_f32_16x16x32_bf16 v[204:207], a[176:179], a[80:83], 0
buffer_load_dwordx4 v7, s[20:23], s64 offen lds
v_mfma_f32_16x16x32_bf16 v[204:207], a[180:183], a[84:87], v[204:207]
ds_read_b64_tr_b16 a[132:133], v11 offset:36864
ds_read_b64_tr_b16 a[134:135], v11 offset:37376
v_mfma_f32_16x16x32_bf16 v[212:215], a[188:191], a[84:87], 0
ds_read_b64_tr_b16 a[136:137], v12 offset:32768
ds_read_b64_tr_b16 a[138:139], v12 offset:33280
v_mfma_f32_16x16x32_bf16 v[212:215], a[184:187], a[80:83], v[212:215]
ds_read_b64_tr_b16 a[140:141], v12 offset:36864
ds_read_b64_tr_b16 a[142:143], v12 offset:37376
v_mfma_f32_16x16x32_bf16 v[72:75], a[112:115], a[80:83], 0
v_mul_f32 v231, s91, v231
v_cvt_pk_bf16_f32 v224, v224, v225
v_mfma_f32_16x16x32_bf16 v[72:75], a[116:119], a[84:87], v[72:75]
ds_read_b64_tr_b16 a[144:145], v13 offset:32768
ds_read_b64_tr_b16 a[146:147], v13 offset:33280
v_mfma_f32_16x16x32_bf16 v[220:223], a[124:127], a[84:87], 0
buffer_load_dwordx4 v8, s[20:23], s64 offen offset:1024 lds
v_mfma_f32_16x16x32_bf16 v[220:223], a[120:123], a[80:83], v[220:223]
ds_read_b64_tr_b16 a[148:149], v13 offset:36864
ds_read_b64_tr_b16 a[150:151], v13 offset:37376
v_mfma_f32_16x16x32_bf16 a[32:35], a[120:123], a[88:91], 0
v_cvt_pk_bf16_f32 v225, v226, v227
v_cvt_pk_bf16_f32 v226, v228, v229
v_mfma_f32_16x16x32_bf16 a[32:35], a[124:127], a[92:95], a[32:35]
ds_read_b64_tr_b16 a[152:153], v14 offset:32768
ds_read_b64_tr_b16 a[154:155], v14 offset:33280
v_mfma_f32_16x16x32_bf16 a[36:39], a[116:119], a[92:95], 0
s_add_u32 m0, s80, 16384
s_add_u32 s64, s79, 2048
v_cvt_pk_bf16_f32 v227, v230, v231
v_mfma_f32_16x16x32_bf16 a[36:39], a[112:115], a[88:91], a[36:39]
ds_read_b64_tr_b16 a[156:157], v14 offset:36864
ds_read_b64_tr_b16 a[158:159], v14 offset:37376
v_mfma_f32_16x16x32_bf16 v[228:231], a[184:187], a[88:91], 0
buffer_load_dwordx4 v4, s[24:27], s64 offen sc1 lds
v_mfma_f32_16x16x32_bf16 v[228:231], a[188:191], a[92:95], v[228:231]
s_xor_b32 s65, s70, 256
s_add_u32 s71, s68, s65
s_add_u32 s72, s69, s65
v_mfma_f32_16x16x32_bf16 a[40:43], a[180:183], a[92:95], 0
s_add_u32 s53, s88, 262144
ds_read_b128 a[64:67], v4 offset:40960
v_mul_f32 v232, s91, v232
v_mfma_f32_16x16x32_bf16 a[40:43], a[176:179], a[88:91], a[40:43]
buffer_store_dwordx4 v[80:83], v4, s[24:27], s53 offen offset:2048 sc1
v_mfma_f32_16x16x32_bf16 a[44:47], a[168:171], a[88:91], 0
s_add_u32 m0, s73, 65536
s_add_u32 s64, s71, 0
ds_read_b128 a[80:83], v9 offset:0
L_PAD4:
s_cbranch_execz L_PAD8
v_mfma_f32_16x16x32_bf16 a[44:47], a[172:175], a[92:95], a[44:47]
v_mul_f32 v233, s91, v233
v_mul_f32 v234, s91, v234
v_mfma_f32_16x16x32_bf16 v[80:83], a[164:167], a[92:95], 0
buffer_load_dwordx4 v5, s[12:15], s64 offen lds
v_mfma_f32_16x16x32_bf16 v[80:83], a[160:163], a[88:91], v[80:83]
ds_read_b128 a[68:71], v4 offset:43008
v_mul_f32 v235, s91, v235
v_mfma_f32_16x16x32_bf16 a[48:51], a[160:163], a[96:99], 0
ds_read_b128 a[84:87], v10 offset:0
v_mul_f32 v236, s91, v236
v_mfma_f32_16x16x32_bf16 a[48:51], a[164:167], a[100:103], a[48:51]
v_mul_f32 v237, s91, v237
v_mul_f32 v238, s91, v238
v_mfma_f32_16x16x32_bf16 a[52:55], a[172:175], a[100:103], 0
v_mul_f32 v239, s91, v239
v_cvt_pk_bf16_f32 v232, v232, v233
v_mfma_f32_16x16x32_bf16 a[52:55], a[168:171], a[96:99], a[52:55]
ds_read_b128 a[72:75], v4 offset:41984
v_cvt_pk_bf16_f32 v233, v234, v235
v_mfma_f32_16x16x32_bf16 a[56:59], a[176:179], a[96:99], 0
buffer_load_dwordx4 v6, s[12:15], s64 offen offset:1024 lds
v_mfma_f32_16x16x32_bf16 a[56:59], a[180:183], a[100:103], a[56:59]
ds_read_b128 a[88:91], v9 offset:2048
v_cvt_pk_bf16_f32 v234, v236, v237
v_mfma_f32_16x16x32_bf16 a[60:63], a[188:191], a[100:103], 0
v_cvt_pk_bf16_f32 v235, v238, v239
v_mul_f32 v240, s91, v240
v_mfma_f32_16x16x32_bf16 a[60:63], a[184:187], a[96:99], a[60:63]
ds_read_b128 a[76:79], v4 offset:44032
v_mul_f32 v241, s91, v241
v_mfma_f32_16x16x32_bf16 v[236:239], a[112:115], a[96:99], 0
s_add_u32 m0, s73, 67584
s_add_u32 s64, s71, 18432
v_mul_f32 v242, s91, v242
v_mfma_f32_16x16x32_bf16 v[236:239], a[116:119], a[100:103], v[236:239]
ds_read_b128 a[92:95], v10 offset:2048
v_mul_f32 v243, s91, v243
v_mfma_f32_16x16x32_bf16 a[192:195], a[124:127], a[100:103], 0
buffer_load_dwordx4 v5, s[12:15], s64 offen lds
v_mfma_f32_16x16x32_bf16 a[192:195], a[120:123], a[96:99], a[192:195]
v_mul_f32 v244, s91, v244
v_mul_f32 v245, s91, v245
v_mfma_f32_16x16x32_bf16 a[196:199], a[120:123], a[104:107], 0
v_mul_f32 v246, s91, v246
v_mul_f32 v247, s91, v247
v_mfma_f32_16x16x32_bf16 a[196:199], a[124:127], a[108:111], a[196:199]
v_cvt_pk_bf16_f32 v240, v240, v241
v_cvt_pk_bf16_f32 v241, v242, v243
v_mfma_f32_16x16x32_bf16 a[200:203], a[116:119], a[108:111], 0
v_cvt_pk_bf16_f32 v242, v244, v245
v_cvt_pk_bf16_f32 v243, v246, v247
v_mfma_f32_16x16x32_bf16 a[200:203], a[112:115], a[104:107], a[200:203]
v_mul_f32 v248, s91, v248
v_mul_f32 v249, s91, v249
v_mfma_f32_16x16x32_bf16 v[244:247], a[184:187], a[104:107], 0
buffer_load_dwordx4 v6, s[12:15], s64 offen offset:1024 lds
v_mfma_f32_16x16x32_bf16 v[244:247], a[188:191], a[108:111], v[244:247]
v_mul_f32 v250, s91, v250
v_mul_f32 v251, s91, v251
v_mfma_f32_16x16x32_bf16 a[204:207], a[180:183], a[108:111], 0
v_mul_f32 v252, s91, v252
v_mul_f32 v253, s91, v253
v_mfma_f32_16x16x32_bf16 a[204:207], a[176:179], a[104:107], a[204:207]
s_add_u32 s53, s88, 262144
v_mul_f32 v254, s91, v254
v_mul_f32 v255, s91, v255
v_mfma_f32_16x16x32_bf16 a[208:211], a[168:171], a[104:107], 0
buffer_store_dwordx4 v[88:91], v4, s[24:27], s53 offen offset:3072 sc1
v_mfma_f32_16x16x32_bf16 a[208:211], a[172:175], a[108:111], a[208:211]
v_cvt_pk_bf16_f32 v248, v248, v249
v_cvt_pk_bf16_f32 v249, v250, v251
v_mfma_f32_16x16x32_bf16 v[88:91], a[164:167], a[108:111], 0
v_cvt_pk_bf16_f32 v250, v252, v253
v_cvt_pk_bf16_f32 v251, v254, v255
v_mfma_f32_16x16x32_bf16 v[88:91], a[160:163], a[104:107], v[88:91]
s_waitcnt lgkmcnt(0)
v_accvgpr_read_b32 v16, a0
v_accvgpr_read_b32 v17, a1
v_mfma_f32_16x16x32_bf16 v[36:39], a[128:131], a[80:83], v[36:39]
s_waitcnt vmcnt(24)
v_accvgpr_read_b32 v18, a2
v_accvgpr_read_b32 v19, a3
v_mfma_f32_16x16x32_bf16 v[36:39], a[132:135], a[84:87], v[36:39]
s_barrier
v_mfma_f32_16x16x32_bf16 v[44:47], a[140:143], a[84:87], v[44:47]
ds_read_b128 a[96:99], v9 offset:4096
v_accvgpr_read_b32 v20, a4
v_mfma_f32_16x16x32_bf16 v[44:47], a[136:139], a[80:83], v[44:47]
s_xor_b32 s75, s93, 2
s_lshl_b32 s76, s75, 19
s_add_u32 s76, s76, s74
v_mfma_f32_16x16x32_bf16 v[32:35], a[144:147], a[80:83], v[32:35]
s_lshl_b32 s79, s75, 13
s_add_u32 s79, s79, s78
ds_read_b128 a[100:103], v10 offset:4096
v_mfma_f32_16x16x32_bf16 v[32:35], a[148:151], a[84:87], v[32:35]
s_add_u32 m0, s77, 32768
s_add_u32 s64, s76, 0
ds_read_b128 a[104:107], v9 offset:6144
v_mfma_f32_16x16x32_bf16 v[52:55], a[156:159], a[84:87], v[52:55]
buffer_load_dwordx4 v7, s[20:23], s64 offen lds
v_mfma_f32_16x16x32_bf16 v[52:55], a[152:155], a[80:83], v[52:55]
ds_read_b64_tr_b16 a[160:161], v11 offset:49152
ds_read_b64_tr_b16 a[162:163], v11 offset:49664
v_mfma_f32_16x16x32_bf16 v[60:63], a[64:67], a[80:83], v[60:63]
v_accvgpr_read_b32 v21, a5
v_accvgpr_read_b32 v22, a6
v_mfma_f32_16x16x32_bf16 v[60:63], a[68:71], a[84:87], v[60:63]
ds_read_b128 a[108:111], v10 offset:6144
v_accvgpr_read_b32 v23, a7
v_mfma_f32_16x16x32_bf16 v[68:71], a[76:79], a[84:87], v[68:71]
buffer_load_dwordx4 v8, s[20:23], s64 offen offset:1024 lds
v_mfma_f32_16x16x32_bf16 v[68:71], a[72:75], a[80:83], v[68:71]
ds_read_b64_tr_b16 a[164:165], v11 offset:53248
ds_read_b64_tr_b16 a[166:167], v11 offset:53760
v_mfma_f32_16x16x32_bf16 v[76:79], a[72:75], a[88:91], v[76:79]
v_add_u32 v9, 32768, v9
v_add_u32 v10, 32768, v10
v_mfma_f32_16x16x32_bf16 v[76:79], a[76:79], a[92:95], v[76:79]
ds_read_b64_tr_b16 a[168:169], v12 offset:49152
ds_read_b64_tr_b16 a[170:171], v12 offset:49664
v_mfma_f32_16x16x32_bf16 v[84:87], a[68:71], a[92:95], v[84:87]
s_add_u32 m0, s80, 32768
s_add_u32 s64, s79, 0
v_mul_f32 v16, s91, v16
v_mfma_f32_16x16x32_bf16 v[84:87], a[64:67], a[88:91], v[84:87]
ds_read_b64_tr_b16 a[172:173], v12 offset:53248
ds_read_b64_tr_b16 a[174:175], v12 offset:53760
v_mfma_f32_16x16x32_bf16 v[92:95], a[152:155], a[88:91], v[92:95]
buffer_load_dwordx4 v4, s[24:27], s64 offen sc1 lds
v_mfma_f32_16x16x32_bf16 v[92:95], a[156:159], a[92:95], v[92:95]
v_mul_f32 v17, s91, v17
v_mul_f32 v18, s91, v18
v_mfma_f32_16x16x32_bf16 v[40:43], a[148:151], a[92:95], v[40:43]
ds_read_b64_tr_b16 a[176:177], v13 offset:49152
ds_read_b64_tr_b16 a[178:179], v13 offset:49664
v_mfma_f32_16x16x32_bf16 v[40:43], a[144:147], a[88:91], v[40:43]
v_mul_f32 v19, s91, v19
v_mul_f32 v20, s91, v20
v_mfma_f32_16x16x32_bf16 v[100:103], a[136:139], a[88:91], v[100:103]
s_add_u32 m0, s73, 69632
s_add_u32 s64, s72, 0
v_mul_f32 v21, s91, v21
v_mfma_f32_16x16x32_bf16 v[100:103], a[140:143], a[92:95], v[100:103]
ds_read_b64_tr_b16 a[180:181], v13 offset:53248
ds_read_b64_tr_b16 a[182:183], v13 offset:53760
v_mfma_f32_16x16x32_bf16 v[108:111], a[132:135], a[92:95], v[108:111]
buffer_load_dwordx4 v5, s[12:15], s64 offen lds
v_mfma_f32_16x16x32_bf16 v[108:111], a[128:131], a[88:91], v[108:111]
s_waitcnt lgkmcnt(14)
ds_read_b64_tr_b16 a[184:185], v14 offset:49152
ds_read_b64_tr_b16 a[186:187], v14 offset:49664
v_mfma_f32_16x16x32_bf16 v[116:119], a[128:131], a[96:99], v[116:119]
s_add_u32 s53, s87, 0
ds_read_b64_tr_b16 a[188:189], v14 offset:53248
ds_read_b64_tr_b16 a[190:191], v14 offset:53760
v_mfma_f32_16x16x32_bf16 v[116:119], a[132:135], a[100:103], v[116:119]
buffer_store_dwordx4 v[160:163], v4, s[24:27], s53 offen offset:0 sc1
v_mfma_f32_16x16x32_bf16 v[124:127], a[140:143], a[100:103], v[124:127]
v_mul_f32 v22, s91, v22
v_mul_f32 v23, s91, v23
v_mfma_f32_16x16x32_bf16 v[124:127], a[136:139], a[96:99], v[124:127]
ds_read_b128 a[112:115], v4 offset:57344
v_cvt_pk_bf16_f32 v16, v16, v17
v_mfma_f32_16x16x32_bf16 v[132:135], a[144:147], a[96:99], v[132:135]
buffer_load_dwordx4 v6, s[12:15], s64 offen offset:1024 lds
v_mfma_f32_16x16x32_bf16 v[132:135], a[148:151], a[100:103], v[132:135]
ds_read_b128 a[116:119], v4 offset:59392
v_cvt_pk_bf16_f32 v17, v18, v19
v_mfma_f32_16x16x32_bf16 v[140:143], a[156:159], a[100:103], v[140:143]
v_cvt_pk_bf16_f32 v18, v20, v21
v_cvt_pk_bf16_f32 v19, v22, v23
v_mfma_f32_16x16x32_bf16 v[140:143], a[152:155], a[96:99], v[140:143]
ds_read_b128 a[120:123], v4 offset:58368
v_accvgpr_write_b32 a0, v16
v_mfma_f32_16x16x32_bf16 v[148:151], a[64:67], a[96:99], v[148:151]
s_add_u32 m0, s73, 71680
s_add_u32 s64, s72, 18432
v_accvgpr_write_b32 a1, v17
v_mfma_f32_16x16x32_bf16 v[148:151], a[68:71], a[100:103], v[148:151]
ds_read_b128 a[124:127], v4 offset:60416
v_accvgpr_write_b32 a2, v18
v_mfma_f32_16x16x32_bf16 v[48:51], a[76:79], a[100:103], v[48:51]
buffer_load_dwordx4 v5, s[12:15], s64 offen lds
v_mfma_f32_16x16x32_bf16 v[48:51], a[72:75], a[96:99], v[48:51]
s_waitcnt lgkmcnt(15)
v_accvgpr_write_b32 a3, v19
v_accvgpr_read_b32 v16, a8
v_mfma_f32_16x16x32_bf16 v[156:159], a[72:75], a[104:107], v[156:159]
v_accvgpr_read_b32 v17, a9
v_accvgpr_read_b32 v18, a10
v_mfma_f32_16x16x32_bf16 v[156:159], a[76:79], a[108:111], v[156:159]
v_accvgpr_read_b32 v19, a11
v_accvgpr_read_b32 v20, a12
v_mfma_f32_16x16x32_bf16 v[164:167], a[68:71], a[108:111], v[164:167]
v_accvgpr_read_b32 v21, a13
v_accvgpr_read_b32 v22, a14
v_mfma_f32_16x16x32_bf16 v[164:167], a[64:67], a[104:107], v[164:167]
v_accvgpr_read_b32 v23, a15
v_mul_f32 v16, s91, v16
v_mfma_f32_16x16x32_bf16 v[172:175], a[152:155], a[104:107], v[172:175]
buffer_load_dwordx4 v6, s[12:15], s64 offen offset:1024 lds
v_mfma_f32_16x16x32_bf16 v[172:175], a[156:159], a[108:111], v[172:175]
v_mul_f32 v17, s91, v17
v_mul_f32 v18, s91, v18
v_mfma_f32_16x16x32_bf16 v[56:59], a[148:151], a[108:111], v[56:59]
v_mul_f32 v19, s91, v19
v_mul_f32 v20, s91, v20
v_mfma_f32_16x16x32_bf16 v[56:59], a[144:147], a[104:107], v[56:59]
v_mul_f32 v21, s91, v21
v_mul_f32 v22, s91, v22
v_mfma_f32_16x16x32_bf16 v[180:183], a[136:139], a[104:107], v[180:183]
v_mul_f32 v23, s91, v23
v_cvt_pk_bf16_f32 v16, v16, v17
v_mfma_f32_16x16x32_bf16 v[180:183], a[140:143], a[108:111], v[180:183]
v_cvt_pk_bf16_f32 v17, v18, v19
v_cvt_pk_bf16_f32 v18, v20, v21
v_mfma_f32_16x16x32_bf16 v[188:191], a[132:135], a[108:111], v[188:191]
v_cvt_pk_bf16_f32 v19, v22, v23
v_accvgpr_write_b32 a8, v16
v_mfma_f32_16x16x32_bf16 v[188:191], a[128:131], a[104:107], v[188:191]
s_waitcnt lgkmcnt(0)
v_accvgpr_write_b32 a9, v17
v_accvgpr_write_b32 a10, v18
v_mfma_f32_16x16x32_bf16 v[196:199], a[160:163], a[80:83], v[196:199]
s_waitcnt vmcnt(17)
v_accvgpr_write_b32 a11, v19
v_accvgpr_read_b32 v16, a16
v_mfma_f32_16x16x32_bf16 v[196:199], a[164:167], a[84:87], v[196:199]
s_barrier
v_mfma_f32_16x16x32_bf16 v[64:67], a[172:175], a[84:87], v[64:67]
s_add_u32 s53, s87, 0
ds_read_b64_tr_b16 a[128:129], v11 offset:0
ds_read_b64_tr_b16 a[130:131], v11 offset:512
v_mfma_f32_16x16x32_bf16 v[64:67], a[168:171], a[80:83], v[64:67]
s_add_u32 m0, s77, 49152
s_add_u32 s64, s76, 128
v_accvgpr_read_b32 v17, a17
v_mfma_f32_16x16x32_bf16 v[204:207], a[176:179], a[80:83], v[204:207]
buffer_load_dwordx4 v7, s[20:23], s64 offen lds
v_mfma_f32_16x16x32_bf16 v[204:207], a[180:183], a[84:87], v[204:207]
ds_read_b64_tr_b16 a[132:133], v11 offset:4096
ds_read_b64_tr_b16 a[134:135], v11 offset:4608
v_mfma_f32_16x16x32_bf16 v[212:215], a[188:191], a[84:87], v[212:215]
ds_read_b64_tr_b16 a[136:137], v12 offset:0
ds_read_b64_tr_b16 a[138:139], v12 offset:512
v_mfma_f32_16x16x32_bf16 v[212:215], a[184:187], a[80:83], v[212:215]
ds_read_b64_tr_b16 a[140:141], v12 offset:4096
ds_read_b64_tr_b16 a[142:143], v12 offset:4608
v_mfma_f32_16x16x32_bf16 v[72:75], a[112:115], a[80:83], v[72:75]
buffer_store_dwordx4 v[168:171], v4, s[24:27], s53 offen offset:1024 sc1
v_mfma_f32_16x16x32_bf16 v[72:75], a[116:119], a[84:87], v[72:75]
ds_read_b64_tr_b16 a[144:145], v13 offset:0
ds_read_b64_tr_b16 a[146:147], v13 offset:512
v_mfma_f32_16x16x32_bf16 v[220:223], a[124:127], a[84:87], v[220:223]
buffer_load_dwordx4 v8, s[20:23], s64 offen offset:1024 lds
v_mfma_f32_16x16x32_bf16 v[220:223], a[120:123], a[80:83], v[220:223]
ds_read_b64_tr_b16 a[148:149], v13 offset:4096
ds_read_b64_tr_b16 a[150:151], v13 offset:4608
v_mfma_f32_16x16x32_bf16 a[32:35], a[120:123], a[88:91], a[32:35]
v_accvgpr_read_b32 v18, a18
v_accvgpr_read_b32 v19, a19
v_mfma_f32_16x16x32_bf16 a[32:35], a[124:127], a[92:95], a[32:35]
ds_read_b64_tr_b16 a[152:153], v14 offset:0
ds_read_b64_tr_b16 a[154:155], v14 offset:512
v_mfma_f32_16x16x32_bf16 a[36:39], a[116:119], a[92:95], a[36:39]
s_add_u32 m0, s80, 49152
s_add_u32 s64, s79, 2048
v_accvgpr_read_b32 v20, a20
v_mfma_f32_16x16x32_bf16 a[36:39], a[112:115], a[88:91], a[36:39]
ds_read_b64_tr_b16 a[156:157], v14 offset:4096
ds_read_b64_tr_b16 a[158:159], v14 offset:4608
v_mfma_f32_16x16x32_bf16 v[228:231], a[184:187], a[88:91], v[228:231]
buffer_load_dwordx4 v4, s[24:27], s64 offen sc1 lds
v_mfma_f32_16x16x32_bf16 v[228:231], a[188:191], a[92:95], v[228:231]
s_xor_b32 s65, s70, 384
s_add_u32 s71, s68, s65
s_add_u32 s72, s69, s65
v_mfma_f32_16x16x32_bf16 a[40:43], a[180:183], a[92:95], a[40:43]
ds_read_b128 a[64:67], v4 offset:8192
v_accvgpr_read_b32 v21, a21
v_mfma_f32_16x16x32_bf16 a[40:43], a[176:179], a[88:91], a[40:43]
v_accvgpr_read_b32 v22, a22
v_accvgpr_read_b32 v23, a23
v_mfma_f32_16x16x32_bf16 a[44:47], a[168:171], a[88:91], a[44:47]
s_add_u32 m0, s73, 0
s_add_u32 s64, s71, 0
ds_read_b128 a[80:83], v9 offset:0
v_mfma_f32_16x16x32_bf16 a[44:47], a[172:175], a[92:95], a[44:47]
v_mul_f32 v16, s91, v16
v_mul_f32 v17, s91, v17
v_mfma_f32_16x16x32_bf16 v[80:83], a[164:167], a[92:95], v[80:83]
buffer_load_dwordx4 v5, s[12:15], s64 offen lds
v_mfma_f32_16x16x32_bf16 v[80:83], a[160:163], a[88:91], v[80:83]
ds_read_b128 a[68:71], v4 offset:10240
v_mul_f32 v18, s91, v18
v_mfma_f32_16x16x32_bf16 a[48:51], a[160:163], a[96:99], a[48:51]
ds_read_b128 a[84:87], v10 offset:0
v_mul_f32 v19, s91, v19
v_mfma_f32_16x16x32_bf16 a[48:51], a[164:167], a[100:103], a[48:51]
v_mul_f32 v20, s91, v20
v_mul_f32 v21, s91, v21
v_mfma_f32_16x16x32_bf16 a[52:55], a[172:175], a[100:103], a[52:55]
v_mul_f32 v22, s91, v22
v_mul_f32 v23, s91, v23
v_mfma_f32_16x16x32_bf16 a[52:55], a[168:171], a[96:99], a[52:55]
ds_read_b128 a[72:75], v4 offset:9216
v_cvt_pk_bf16_f32 v16, v16, v17
v_mfma_f32_16x16x32_bf16 a[56:59], a[176:179], a[96:99], a[56:59]
buffer_load_dwordx4 v6, s[12:15], s64 offen offset:1024 lds
v_mfma_f32_16x16x32_bf16 a[56:59], a[180:183], a[100:103], a[56:59]
s_add_u32 s53, s87, 4096
ds_read_b128 a[88:91], v9 offset:2048
v_cvt_pk_bf16_f32 v17, v18, v19
v_mfma_f32_16x16x32_bf16 a[60:63], a[188:191], a[100:103], a[60:63]
buffer_store_dwordx4 v[176:179], v4, s[24:27], s53 offen offset:0 sc1
v_mfma_f32_16x16x32_bf16 a[60:63], a[184:187], a[96:99], a[60:63]
ds_read_b128 a[76:79], v4 offset:11264
v_cvt_pk_bf16_f32 v18, v20, v21
v_mfma_f32_16x16x32_bf16 v[236:239], a[112:115], a[96:99], v[236:239]
s_add_u32 m0, s73, 2048
s_add_u32 s64, s71, 18432
v_cvt_pk_bf16_f32 v19, v22, v23
v_mfma_f32_16x16x32_bf16 v[236:239], a[116:119], a[100:103], v[236:239]
ds_read_b128 a[92:95], v10 offset:2048
v_accvgpr_write_b32 a16, v16
v_mfma_f32_16x16x32_bf16 a[192:195], a[124:127], a[100:103], a[192:195]
buffer_load_dwordx4 v5, s[12:15], s64 offen lds
v_mfma_f32_16x16x32_bf16 a[192:195], a[120:123], a[96:99], a[192:195]
v_accvgpr_write_b32 a17, v17
v_accvgpr_write_b32 a18, v18
v_mfma_f32_16x16x32_bf16 a[196:199], a[120:123], a[104:107], a[196:199]
v_accvgpr_write_b32 a19, v19
v_accvgpr_read_b32 v16, a24
v_mfma_f32_16x16x32_bf16 a[196:199], a[124:127], a[108:111], a[196:199]
v_accvgpr_read_b32 v17, a25
v_accvgpr_read_b32 v18, a26
v_mfma_f32_16x16x32_bf16 a[200:203], a[116:119], a[108:111], a[200:203]
v_accvgpr_read_b32 v19, a27
v_accvgpr_read_b32 v20, a28
v_mfma_f32_16x16x32_bf16 a[200:203], a[112:115], a[104:107], a[200:203]
v_accvgpr_read_b32 v21, a29
v_accvgpr_read_b32 v22, a30
v_mfma_f32_16x16x32_bf16 v[244:247], a[184:187], a[104:107], v[244:247]
buffer_load_dwordx4 v6, s[12:15], s64 offen offset:1024 lds
v_mfma_f32_16x16x32_bf16 v[244:247], a[188:191], a[108:111], v[244:247]
v_accvgpr_read_b32 v23, a31
v_mul_f32 v16, s91, v16
v_mfma_f32_16x16x32_bf16 a[204:207], a[180:183], a[108:111], a[204:207]
v_mul_f32 v17, s91, v17
v_mul_f32 v18, s91, v18
v_mfma_f32_16x16x32_bf16 a[204:207], a[176:179], a[104:107], a[204:207]
v_mul_f32 v19, s91, v19
v_mul_f32 v20, s91, v20
v_mfma_f32_16x16x32_bf16 a[208:211], a[168:171], a[104:107], a[208:211]
v_mul_f32 v21, s91, v21
v_mul_f32 v22, s91, v22
v_mfma_f32_16x16x32_bf16 a[208:211], a[172:175], a[108:111], a[208:211]
v_mul_f32 v23, s91, v23
v_cvt_pk_bf16_f32 v16, v16, v17
v_mfma_f32_16x16x32_bf16 v[88:91], a[164:167], a[108:111], v[88:91]
v_cvt_pk_bf16_f32 v17, v18, v19
v_cvt_pk_bf16_f32 v18, v20, v21
v_mfma_f32_16x16x32_bf16 v[88:91], a[160:163], a[104:107], v[88:91]
s_waitcnt lgkmcnt(0)
v_cvt_pk_bf16_f32 v19, v22, v23
v_accvgpr_write_b32 a24, v16
v_mfma_f32_16x16x32_bf16 v[36:39], a[128:131], a[80:83], v[36:39]
s_waitcnt vmcnt(23)
v_accvgpr_write_b32 a25, v17
v_accvgpr_write_b32 a26, v18
v_mfma_f32_16x16x32_bf16 v[36:39], a[132:135], a[84:87], v[36:39]
s_barrier
v_mfma_f32_16x16x32_bf16 v[44:47], a[140:143], a[84:87], v[44:47]
ds_read_b128 a[96:99], v9 offset:4096
v_accvgpr_write_b32 a27, v19
v_mfma_f32_16x16x32_bf16 v[44:47], a[136:139], a[80:83], v[44:47]
s_xor_b32 s75, s93, 3
s_lshl_b32 s76, s75, 19
s_add_u32 s76, s76, s74
v_mfma_f32_16x16x32_bf16 v[32:35], a[144:147], a[80:83], v[32:35]
s_lshl_b32 s79, s75, 13
s_add_u32 s79, s79, s78
ds_read_b128 a[100:103], v10 offset:4096
v_mfma_f32_16x16x32_bf16 v[32:35], a[148:151], a[84:87], v[32:35]
s_add_u32 m0, s77, 0
s_add_u32 s64, s76, 0
ds_read_b128 a[104:107], v9 offset:6144
v_mfma_f32_16x16x32_bf16 v[52:55], a[156:159], a[84:87], v[52:55]
buffer_load_dwordx4 v7, s[20:23], s64 offen lds
v_mfma_f32_16x16x32_bf16 v[52:55], a[152:155], a[80:83], v[52:55]
s_add_u32 s53, s87, 4096
ds_read_b64_tr_b16 a[160:161], v11 offset:16384
ds_read_b64_tr_b16 a[162:163], v11 offset:16896
v_mfma_f32_16x16x32_bf16 v[60:63], a[64:67], a[80:83], v[60:63]
buffer_store_dwordx4 v[184:187], v4, s[24:27], s53 offen offset:1024 sc1
v_mfma_f32_16x16x32_bf16 v[60:63], a[68:71], a[84:87], v[60:63]
ds_read_b128 a[108:111], v10 offset:6144
v_accvgpr_write_b32 a4, v248
v_mfma_f32_16x16x32_bf16 v[68:71], a[76:79], a[84:87], v[68:71]
buffer_load_dwordx4 v8, s[20:23], s64 offen offset:1024 lds
v_mfma_f32_16x16x32_bf16 v[68:71], a[72:75], a[80:83], v[68:71]
ds_read_b64_tr_b16 a[164:165], v11 offset:20480
ds_read_b64_tr_b16 a[166:167], v11 offset:20992
v_mfma_f32_16x16x32_bf16 v[76:79], a[72:75], a[88:91], v[76:79]
v_add_u32 v9, 32768, v9
v_add_u32 v10, 32768, v10
v_mfma_f32_16x16x32_bf16 v[76:79], a[76:79], a[92:95], v[76:79]
ds_read_b64_tr_b16 a[168:169], v12 offset:16384
ds_read_b64_tr_b16 a[170:171], v12 offset:16896
v_mfma_f32_16x16x32_bf16 v[84:87], a[68:71], a[92:95], v[84:87]
s_add_u32 m0, s80, 0
s_add_u32 s64, s79, 0
v_accvgpr_write_b32 a5, v249
v_mfma_f32_16x16x32_bf16 v[84:87], a[64:67], a[88:91], v[84:87]
ds_read_b64_tr_b16 a[172:173], v12 offset:20480
ds_read_b64_tr_b16 a[174:175], v12 offset:20992
v_mfma_f32_16x16x32_bf16 v[92:95], a[152:155], a[88:91], v[92:95]
buffer_load_dwordx4 v4, s[24:27], s64 offen sc1 lds
v_mfma_f32_16x16x32_bf16 v[92:95], a[156:159], a[92:95], v[92:95]
v_accvgpr_write_b32 a6, v250
v_accvgpr_write_b32 a7, v251
v_mfma_f32_16x16x32_bf16 v[40:43], a[148:151], a[92:95], v[40:43]
ds_read_b64_tr_b16 a[176:177], v13 offset:16384
ds_read_b64_tr_b16 a[178:179], v13 offset:16896
v_mfma_f32_16x16x32_bf16 v[40:43], a[144:147], a[88:91], v[40:43]
v_accvgpr_write_b32 a12, v240
v_accvgpr_write_b32 a13, v241
v_mfma_f32_16x16x32_bf16 v[100:103], a[136:139], a[88:91], v[100:103]
s_add_u32 m0, s73, 4096
s_add_u32 s64, s72, 0
v_accvgpr_write_b32 a14, v242
v_mfma_f32_16x16x32_bf16 v[100:103], a[140:143], a[92:95], v[100:103]
ds_read_b64_tr_b16 a[180:181], v13 offset:20480
ds_read_b64_tr_b16 a[182:183], v13 offset:20992
v_mfma_f32_16x16x32_bf16 v[108:111], a[132:135], a[92:95], v[108:111]
buffer_load_dwordx4 v5, s[12:15], s64 offen lds
v_mfma_f32_16x16x32_bf16 v[108:111], a[128:131], a[88:91], v[108:111]
s_waitcnt lgkmcnt(14)
ds_read_b64_tr_b16 a[184:185], v14 offset:16384
ds_read_b64_tr_b16 a[186:187], v14 offset:16896
v_mfma_f32_16x16x32_bf16 v[116:119], a[128:131], a[96:99], v[116:119]
ds_read_b64_tr_b16 a[188:189], v14 offset:20480
ds_read_b64_tr_b16 a[190:191], v14 offset:20992
v_mfma_f32_16x16x32_bf16 v[116:119], a[132:135], a[100:103], v[116:119]
v_accvgpr_write_b32 a15, v243
v_accvgpr_write_b32 a20, v232
v_mfma_f32_16x16x32_bf16 v[124:127], a[140:143], a[100:103], v[124:127]
v_accvgpr_write_b32 a21, v233
v_accvgpr_write_b32 a22, v234
v_mfma_f32_16x16x32_bf16 v[124:127], a[136:139], a[96:99], v[124:127]
ds_read_b128 a[112:115], v4 offset:24576
v_accvgpr_write_b32 a23, v235
v_mfma_f32_16x16x32_bf16 v[132:135], a[144:147], a[96:99], v[132:135]
buffer_load_dwordx4 v6, s[12:15], s64 offen offset:1024 lds
v_mfma_f32_16x16x32_bf16 v[132:135], a[148:151], a[100:103], v[132:135]
ds_read_b128 a[116:119], v4 offset:26624
v_accvgpr_write_b32 a28, v224
v_mfma_f32_16x16x32_bf16 v[140:143], a[156:159], a[100:103], v[140:143]
v_accvgpr_write_b32 a29, v225
v_accvgpr_write_b32 a30, v226
v_mfma_f32_16x16x32_bf16 v[140:143], a[152:155], a[96:99], v[140:143]
ds_read_b128 a[120:123], v4 offset:25600
v_accvgpr_write_b32 a31, v227
v_mfma_f32_16x16x32_bf16 v[148:151], a[64:67], a[96:99], v[148:151]
s_add_u32 m0, s73, 6144
s_add_u32 s64, s72, 18432
v_accvgpr_read_b32 v252, a32
v_mfma_f32_16x16x32_bf16 v[148:151], a[68:71], a[100:103], v[148:151]
ds_read_b128 a[124:127], v4 offset:27648
v_accvgpr_read_b32 v253, a33
v_mfma_f32_16x16x32_bf16 v[48:51], a[76:79], a[100:103], v[48:51]
buffer_load_dwordx4 v5, s[12:15], s64 offen lds
v_mfma_f32_16x16x32_bf16 v[48:51], a[72:75], a[96:99], v[48:51]
s_waitcnt lgkmcnt(15)
s_add_u32 s53, s87, 262144
v_accvgpr_read_b32 v254, a34
v_mfma_f32_16x16x32_bf16 v[156:159], a[72:75], a[104:107], v[156:159]
buffer_store_dwordx4 v[192:195], v4, s[24:27], s53 offen offset:0 sc1
v_mfma_f32_16x16x32_bf16 v[156:159], a[76:79], a[108:111], v[156:159]
v_accvgpr_read_b32 v255, a35
v_accvgpr_read_b32 v160, a36
v_mfma_f32_16x16x32_bf16 v[164:167], a[68:71], a[108:111], v[164:167]
v_accvgpr_read_b32 v161, a37
v_accvgpr_read_b32 v162, a38
v_mfma_f32_16x16x32_bf16 v[164:167], a[64:67], a[104:107], v[164:167]
v_accvgpr_read_b32 v163, a39
v_accvgpr_read_b32 v168, a40
v_mfma_f32_16x16x32_bf16 v[172:175], a[152:155], a[104:107], v[172:175]
buffer_load_dwordx4 v6, s[12:15], s64 offen offset:1024 lds
v_mfma_f32_16x16x32_bf16 v[172:175], a[156:159], a[108:111], v[172:175]
v_accvgpr_read_b32 v169, a41
v_accvgpr_read_b32 v170, a42
v_mfma_f32_16x16x32_bf16 v[56:59], a[148:151], a[108:111], v[56:59]
v_accvgpr_read_b32 v171, a43
v_accvgpr_read_b32 v176, a44
v_mfma_f32_16x16x32_bf16 v[56:59], a[144:147], a[104:107], v[56:59]
v_accvgpr_read_b32 v177, a45
v_accvgpr_read_b32 v178, a46
v_mfma_f32_16x16x32_bf16 v[180:183], a[136:139], a[104:107], v[180:183]
v_accvgpr_read_b32 v179, a47
v_accvgpr_read_b32 v184, a48
v_mfma_f32_16x16x32_bf16 v[180:183], a[140:143], a[108:111], v[180:183]
v_accvgpr_read_b32 v185, a49
v_accvgpr_read_b32 v186, a50
v_mfma_f32_16x16x32_bf16 v[188:191], a[132:135], a[108:111], v[188:191]
v_accvgpr_read_b32 v187, a51
v_accvgpr_read_b32 v248, a52
v_mfma_f32_16x16x32_bf16 v[188:191], a[128:131], a[104:107], v[188:191]
s_waitcnt lgkmcnt(0)
v_accvgpr_read_b32 v249, a53
v_accvgpr_read_b32 v250, a54
v_mfma_f32_16x16x32_bf16 v[196:199], a[160:163], a[80:83], v[196:199]
s_waitcnt vmcnt(18)
v_accvgpr_read_b32 v251, a55
v_accvgpr_read_b32 v240, a56
v_mfma_f32_16x16x32_bf16 v[196:199], a[164:167], a[84:87], v[196:199]
s_barrier
v_mfma_f32_16x16x32_bf16 v[64:67], a[172:175], a[84:87], v[64:67]
ds_read_b64_tr_b16 a[128:129], v11 offset:32768
ds_read_b64_tr_b16 a[130:131], v11 offset:33280
v_mfma_f32_16x16x32_bf16 v[64:67], a[168:171], a[80:83], v[64:67]
s_add_u32 m0, s77, 16384
s_add_u32 s64, s76, 128
v_accvgpr_read_b32 v241, a57
v_mfma_f32_16x16x32_bf16 v[204:207], a[176:179], a[80:83], v[204:207]
buffer_load_dwordx4 v7, s[20:23], s64 offen lds
v_mfma_f32_16x16x32_bf16 v[204:207], a[180:183], a[84:87], v[204:207]
ds_read_b64_tr_b16 a[132:133], v11 offset:36864
ds_read_b64_tr_b16 a[134:135], v11 offset:37376
v_mfma_f32_16x16x32_bf16 v[212:215], a[188:191], a[84:87], v[212:215]
ds_read_b64_tr_b16 a[136:137], v12 offset:32768
ds_read_b64_tr_b16 a[138:139], v12 offset:33280
v_mfma_f32_16x16x32_bf16 v[212:215], a[184:187], a[80:83], v[212:215]
ds_read_b64_tr_b16 a[140:141], v12 offset:36864
ds_read_b64_tr_b16 a[142:143], v12 offset:37376
v_mfma_f32_16x16x32_bf16 v[72:75], a[112:115], a[80:83], v[72:75]
v_accvgpr_read_b32 v242, a58
v_accvgpr_read_b32 v243, a59
v_mfma_f32_16x16x32_bf16 v[72:75], a[116:119], a[84:87], v[72:75]
ds_read_b64_tr_b16 a[144:145], v13 offset:32768
ds_read_b64_tr_b16 a[146:147], v13 offset:33280
v_mfma_f32_16x16x32_bf16 v[220:223], a[124:127], a[84:87], v[220:223]
buffer_load_dwordx4 v8, s[20:23], s64 offen offset:1024 lds
v_mfma_f32_16x16x32_bf16 v[220:223], a[120:123], a[80:83], v[220:223]
ds_read_b64_tr_b16 a[148:149], v13 offset:36864
ds_read_b64_tr_b16 a[150:151], v13 offset:37376
v_mfma_f32_16x16x32_bf16 v[252:255], a[120:123], a[88:91], v[252:255]
v_accvgpr_read_b32 v232, a60
v_accvgpr_read_b32 v233, a61
v_mfma_f32_16x16x32_bf16 v[252:255], a[124:127], a[92:95], v[252:255]
s_add_u32 s53, s87, 262144
ds_read_b64_tr_b16 a[152:153], v14 offset:32768
ds_read_b64_tr_b16 a[154:155], v14 offset:33280
v_mfma_f32_16x16x32_bf16 v[160:163], a[116:119], a[92:95], v[160:163]
s_add_u32 m0, s80, 16384
s_add_u32 s64, s79, 2048
v_accvgpr_read_b32 v234, a62
L_PAD5:
s_cbranch_execz L_PAD9
v_mfma_f32_16x16x32_bf16 v[160:163], a[112:115], a[88:91], v[160:163]
ds_read_b64_tr_b16 a[156:157], v14 offset:36864
ds_read_b64_tr_b16 a[158:159], v14 offset:37376
v_mfma_f32_16x16x32_bf16 v[228:231], a[184:187], a[88:91], v[228:231]
buffer_load_dwordx4 v4, s[24:27], s64 offen sc1 lds
v_mfma_f32_16x16x32_bf16 v[228:231], a[188:191], a[92:95], v[228:231]
s_xor_b32 s65, s70, 512
s_add_u32 s71, s68, s65
s_add_u32 s72, s69, s65
v_mfma_f32_16x16x32_bf16 v[168:171], a[180:183], a[92:95], v[168:171]
ds_read_b128 a[64:67], v4 offset:40960
v_accvgpr_read_b32 v235, a63
v_mfma_f32_16x16x32_bf16 v[168:171], a[176:179], a[88:91], v[168:171]
buffer_store_dwordx4 v[200:203], v4, s[24:27], s53 offen offset:1024 sc1
v_mfma_f32_16x16x32_bf16 v[176:179], a[168:171], a[88:91], v[176:179]
s_add_u32 m0, s73, 32768
s_add_u32 s64, s71, 0
ds_read_b128 a[80:83], v9 offset:0
v_mfma_f32_16x16x32_bf16 v[176:179], a[172:175], a[92:95], v[176:179]
v_accvgpr_read_b32 v224, a192
v_accvgpr_read_b32 v225, a193
v_mfma_f32_16x16x32_bf16 v[80:83], a[164:167], a[92:95], v[80:83]
buffer_load_dwordx4 v5, s[12:15], s64 offen lds
v_mfma_f32_16x16x32_bf16 v[80:83], a[160:163], a[88:91], v[80:83]
ds_read_b128 a[68:71], v4 offset:43008
v_accvgpr_read_b32 v226, a194
v_mfma_f32_16x16x32_bf16 v[184:187], a[160:163], a[96:99], v[184:187]
ds_read_b128 a[84:87], v10 offset:0
v_accvgpr_read_b32 v227, a195
v_mfma_f32_16x16x32_bf16 v[184:187], a[164:167], a[100:103], v[184:187]
v_accvgpr_read_b32 v192, a204
v_accvgpr_read_b32 v193, a205
v_mfma_f32_16x16x32_bf16 v[248:251], a[172:175], a[100:103], v[248:251]
v_accvgpr_read_b32 v194, a206
v_accvgpr_read_b32 v195, a207
v_mfma_f32_16x16x32_bf16 v[248:251], a[168:171], a[96:99], v[248:251]
ds_read_b128 a[72:75], v4 offset:41984
v_accvgpr_read_b32 v200, a208
v_mfma_f32_16x16x32_bf16 v[240:243], a[176:179], a[96:99], v[240:243]
buffer_load_dwordx4 v6, s[12:15], s64 offen offset:1024 lds
v_mfma_f32_16x16x32_bf16 v[240:243], a[180:183], a[100:103], v[240:243]
ds_read_b128 a[88:91], v9 offset:2048
v_accvgpr_read_b32 v201, a209
v_mfma_f32_16x16x32_bf16 v[232:235], a[188:191], a[100:103], v[232:235]
v_accvgpr_read_b32 v202, a210
v_accvgpr_read_b32 v203, a211
v_mfma_f32_16x16x32_bf16 v[232:235], a[184:187], a[96:99], v[232:235]
ds_read_b128 a[76:79], v4 offset:44032
v_and_b32 v28, 31, v1
v_mfma_f32_16x16x32_bf16 v[236:239], a[112:115], a[96:99], v[236:239]
s_add_u32 m0, s73, 34816
s_add_u32 s64, s71, 18432
v_lshlrev_b32 v28, 2, v28
v_mfma_f32_16x16x32_bf16 v[236:239], a[116:119], a[100:103], v[236:239]
ds_read_b128 a[92:95], v10 offset:2048
v_mfma_f32_16x16x32_bf16 v[224:227], a[124:127], a[100:103], v[224:227]
buffer_load_dwordx4 v5, s[12:15], s64 offen lds
v_mfma_f32_16x16x32_bf16 v[224:227], a[120:123], a[96:99], v[224:227]
buffer_load_dword v30, v28, s[40:43], 0 offen sc1
v_mfma_f32_16x16x32_bf16 a[196:199], a[120:123], a[104:107], a[196:199]
v_mfma_f32_16x16x32_bf16 a[196:199], a[124:127], a[108:111], a[196:199]
v_mfma_f32_16x16x32_bf16 a[200:203], a[116:119], a[108:111], a[200:203]
v_mfma_f32_16x16x32_bf16 a[200:203], a[112:115], a[104:107], a[200:203]
v_mfma_f32_16x16x32_bf16 v[244:247], a[184:187], a[104:107], v[244:247]
buffer_load_dwordx4 v6, s[12:15], s64 offen offset:1024 lds
v_mfma_f32_16x16x32_bf16 v[244:247], a[188:191], a[108:111], v[244:247]
s_add_u32 s53, s87, 266240
v_mfma_f32_16x16x32_bf16 v[192:195], a[180:183], a[108:111], v[192:195]
buffer_store_dwordx4 v[208:211], v4, s[24:27], s53 offen offset:0 sc1
v_mfma_f32_16x16x32_bf16 v[192:195], a[176:179], a[104:107], v[192:195]
v_mfma_f32_16x16x32_bf16 v[200:203], a[168:171], a[104:107], v[200:203]
v_mfma_f32_16x16x32_bf16 v[200:203], a[172:175], a[108:111], v[200:203]
v_accvgpr_read_b32 v208, a196
v_accvgpr_read_b32 v209, a197
v_mfma_f32_16x16x32_bf16 v[88:91], a[164:167], a[108:111], v[88:91]
v_accvgpr_read_b32 v210, a198
v_accvgpr_read_b32 v211, a199
v_mfma_f32_16x16x32_bf16 v[88:91], a[160:163], a[104:107], v[88:91]
s_waitcnt lgkmcnt(0)
v_mfma_f32_16x16x32_bf16 v[36:39], a[128:131], a[80:83], v[36:39]
s_waitcnt vmcnt(24)
v_mfma_f32_16x16x32_bf16 v[36:39], a[132:135], a[84:87], v[36:39]
s_barrier
v_mfma_f32_16x16x32_bf16 v[44:47], a[140:143], a[84:87], v[44:47]
ds_read_b128 a[96:99], v9 offset:4096
v_mfma_f32_16x16x32_bf16 v[44:47], a[136:139], a[80:83], v[44:47]
s_xor_b32 s75, s93, 4
s_lshl_b32 s76, s75, 19
s_add_u32 s76, s76, s74
v_mfma_f32_16x16x32_bf16 v[32:35], a[144:147], a[80:83], v[32:35]
s_lshl_b32 s79, s75, 13
s_add_u32 s79, s79, s78
ds_read_b128 a[100:103], v10 offset:4096
v_mfma_f32_16x16x32_bf16 v[32:35], a[148:151], a[84:87], v[32:35]
s_add_u32 m0, s77, 32768
s_add_u32 s64, s76, 0
ds_read_b128 a[104:107], v9 offset:6144
v_mfma_f32_16x16x32_bf16 v[52:55], a[156:159], a[84:87], v[52:55]
buffer_load_dwordx4 v7, s[20:23], s64 offen lds
v_mfma_f32_16x16x32_bf16 v[52:55], a[152:155], a[80:83], v[52:55]
ds_read_b64_tr_b16 a[160:161], v11 offset:49152
ds_read_b64_tr_b16 a[162:163], v11 offset:49664
v_mfma_f32_16x16x32_bf16 v[60:63], a[64:67], a[80:83], v[60:63]
v_mfma_f32_16x16x32_bf16 v[60:63], a[68:71], a[84:87], v[60:63]
ds_read_b128 a[108:111], v10 offset:6144
v_mfma_f32_16x16x32_bf16 v[68:71], a[76:79], a[84:87], v[68:71]
buffer_load_dwordx4 v8, s[20:23], s64 offen offset:1024 lds
v_mfma_f32_16x16x32_bf16 v[68:71], a[72:75], a[80:83], v[68:71]
ds_read_b64_tr_b16 a[164:165], v11 offset:53248
ds_read_b64_tr_b16 a[166:167], v11 offset:53760
v_mfma_f32_16x16x32_bf16 v[76:79], a[72:75], a[88:91], v[76:79]
v_add_u32 v9, -65536, v9
v_add_u32 v10, -65536, v10
v_mfma_f32_16x16x32_bf16 v[76:79], a[76:79], a[92:95], v[76:79]
ds_read_b64_tr_b16 a[168:169], v12 offset:49152
ds_read_b64_tr_b16 a[170:171], v12 offset:49664
v_mfma_f32_16x16x32_bf16 v[84:87], a[68:71], a[92:95], v[84:87]
s_add_u32 m0, s80, 32768
s_add_u32 s64, s79, 0
v_mfma_f32_16x16x32_bf16 v[84:87], a[64:67], a[88:91], v[84:87]
ds_read_b64_tr_b16 a[172:173], v12 offset:53248
ds_read_b64_tr_b16 a[174:175], v12 offset:53760
v_mfma_f32_16x16x32_bf16 v[92:95], a[152:155], a[88:91], v[92:95]
buffer_load_dwordx4 v4, s[24:27], s64 offen sc1 lds
v_mfma_f32_16x16x32_bf16 v[92:95], a[156:159], a[92:95], v[92:95]
v_mfma_f32_16x16x32_bf16 v[40:43], a[148:151], a[92:95], v[40:43]
ds_read_b64_tr_b16 a[176:177], v13 offset:49152
ds_read_b64_tr_b16 a[178:179], v13 offset:49664
v_mfma_f32_16x16x32_bf16 v[40:43], a[144:147], a[88:91], v[40:43]
s_add_u32 s53, s87, 266240
v_mfma_f32_16x16x32_bf16 v[100:103], a[136:139], a[88:91], v[100:103]
s_add_u32 m0, s73, 36864
s_add_u32 s64, s72, 0
v_mfma_f32_16x16x32_bf16 v[100:103], a[140:143], a[92:95], v[100:103]
ds_read_b64_tr_b16 a[180:181], v13 offset:53248
ds_read_b64_tr_b16 a[182:183], v13 offset:53760
v_mfma_f32_16x16x32_bf16 v[108:111], a[132:135], a[92:95], v[108:111]
buffer_load_dwordx4 v5, s[12:15], s64 offen lds
v_mfma_f32_16x16x32_bf16 v[108:111], a[128:131], a[88:91], v[108:111]
s_waitcnt lgkmcnt(14)
ds_read_b64_tr_b16 a[184:185], v14 offset:49152
ds_read_b64_tr_b16 a[186:187], v14 offset:49664
v_mfma_f32_16x16x32_bf16 v[116:119], a[128:131], a[96:99], v[116:119]
s_waitcnt vmcnt(6)
ds_read_b64_tr_b16 a[188:189], v14 offset:53248
ds_read_b64_tr_b16 a[190:191], v14 offset:53760
v_mfma_f32_16x16x32_bf16 v[116:119], a[132:135], a[100:103], v[116:119]
buffer_store_dwordx4 v[216:219], v4, s[24:27], s53 offen offset:1024 sc1
v_mfma_f32_16x16x32_bf16 v[124:127], a[140:143], a[100:103], v[124:127]
v_cmp_gt_u32 vcc, 1, v30
v_mfma_f32_16x16x32_bf16 v[124:127], a[136:139], a[96:99], v[124:127]
ds_read_b128 a[112:115], v4 offset:57344
v_accvgpr_read_b32 v216, a200
v_mfma_f32_16x16x32_bf16 v[132:135], a[144:147], a[96:99], v[132:135]
buffer_load_dwordx4 v6, s[12:15], s64 offen offset:1024 lds
v_mfma_f32_16x16x32_bf16 v[132:135], a[148:151], a[100:103], v[132:135]
ds_read_b128 a[116:119], v4 offset:59392
v_accvgpr_read_b32 v217, a201
v_mfma_f32_16x16x32_bf16 v[140:143], a[156:159], a[100:103], v[140:143]
v_accvgpr_read_b32 v218, a202
v_accvgpr_read_b32 v219, a203
v_mfma_f32_16x16x32_bf16 v[140:143], a[152:155], a[96:99], v[140:143]
s_lshr_b32 s84, s7, 1
s_and_b32 s85, s7, 1
ds_read_b128 a[120:123], v4 offset:58368
v_mfma_f32_16x16x32_bf16 v[148:151], a[64:67], a[96:99], v[148:151]
s_add_u32 m0, s73, 38912
s_add_u32 s64, s72, 18432
s_xor_b32 s52, s5, 0
v_mfma_f32_16x16x32_bf16 v[148:151], a[68:71], a[100:103], v[148:151]
s_lshl1_add_u32 s85, s52, s85
s_and_b32 s86, s6, 3
ds_read_b128 a[124:127], v4 offset:60416
v_mfma_f32_16x16x32_bf16 v[48:51], a[76:79], a[100:103], v[48:51]
buffer_load_dwordx4 v5, s[12:15], s64 offen lds
v_mfma_f32_16x16x32_bf16 v[48:51], a[72:75], a[96:99], v[48:51]
s_waitcnt lgkmcnt(15)
s_lshl_b32 s83, s3, 13
s_add_u32 s83, s83, 131072
v_mfma_f32_16x16x32_bf16 v[156:159], a[72:75], a[104:107], v[156:159]
s_cbranch_vccnz CK_ZA
CK_ZA_R:
v_mfma_f32_16x16x32_bf16 v[156:159], a[76:79], a[108:111], v[156:159]
s_mul_i32 s52, s2, 5462
s_lshr_b32 s52, s52, 16
s_mul_i32 s54, s52, 12
v_mfma_f32_16x16x32_bf16 v[164:167], a[68:71], a[108:111], v[164:167]
s_sub_u32 s54, s2, s54
s_mul_i32 s54, s54, 3
s_add_u32 s54, s54, s3
v_mfma_f32_16x16x32_bf16 v[164:167], a[64:67], a[104:107], v[164:167]
s_mul_i32 s55, s52, 13108
s_lshr_b32 s55, s55, 16
s_mul_i32 s82, s55, 5
v_mfma_f32_16x16x32_bf16 v[172:175], a[152:155], a[104:107], v[172:175]
buffer_load_dwordx4 v6, s[12:15], s64 offen offset:1024 lds
v_mfma_f32_16x16x32_bf16 v[172:175], a[156:159], a[108:111], v[172:175]
s_sub_u32 s52, s52, s82
v_mfma_f32_16x16x32_bf16 v[56:59], a[148:151], a[108:111], v[56:59]
v_lshrrev_b32 v16, 1, v1
v_and_b32 v17, 1, v1
v_mfma_f32_16x16x32_bf16 v[56:59], a[144:147], a[104:107], v[56:59]
v_mul_u32_u24 v18, 1152, v16
v_lshl_add_u32 v18, v17, 4, v18
v_mfma_f32_16x16x32_bf16 v[180:183], a[136:139], a[104:107], v[180:183]
v_mov_b32 v24, v18
v_lshrrev_b32 v18, 4, v16
v_mfma_f32_16x16x32_bf16 v[180:183], a[140:143], a[108:111], v[180:183]
v_bfe_u32 v19, v16, 2, 2
v_and_b32 v16, 3, v16
v_mfma_f32_16x16x32_bf16 v[188:191], a[132:135], a[108:111], v[188:191]
s_add_u32 s53, s88, 524288
v_lshrrev_b32 v20, 1, v19
v_mul_u32_u24 v20, 18, v20
v_mfma_f32_16x16x32_bf16 v[188:191], a[128:131], a[104:107], v[188:191]
s_waitcnt lgkmcnt(0)
v_and_b32 v21, 1, v19
v_lshl_add_u32 v20, v21, 1, v20
v_mfma_f32_16x16x32_bf16 v[196:199], a[160:163], a[80:83], v[196:199]
s_waitcnt vmcnt(18)
v_lshl_add_u32 v20, v16, 2, v20
v_add_u32 v20, v20, v18
v_mfma_f32_16x16x32_bf16 v[196:199], a[164:167], a[84:87], v[196:199]
s_barrier
v_mfma_f32_16x16x32_bf16 v[64:67], a[172:175], a[84:87], v[64:67]
ds_read_b64_tr_b16 a[128:129], v11 offset:0
ds_read_b64_tr_b16 a[130:131], v11 offset:512
v_mfma_f32_16x16x32_bf16 v[64:67], a[168:171], a[80:83], v[64:67]
s_add_u32 m0, s77, 49152
s_add_u32 s64, s76, 128
v_mad_u32_u24 v20, s52, 36, v20
v_mfma_f32_16x16x32_bf16 v[204:207], a[176:179], a[80:83], v[204:207]
buffer_load_dwordx4 v7, s[20:23], s64 offen lds
v_mfma_f32_16x16x32_bf16 v[204:207], a[180:183], a[84:87], v[204:207]
ds_read_b64_tr_b16 a[132:133], v11 offset:4096
ds_read_b64_tr_b16 a[134:135], v11 offset:4608
v_mfma_f32_16x16x32_bf16 v[212:215], a[188:191], a[84:87], v[212:215]
ds_read_b64_tr_b16 a[136:137], v12 offset:0
ds_read_b64_tr_b16 a[138:139], v12 offset:512
v_mfma_f32_16x16x32_bf16 v[212:215], a[184:187], a[80:83], v[212:215]
ds_read_b64_tr_b16 a[140:141], v12 offset:4096
ds_read_b64_tr_b16 a[142:143], v12 offset:4608
v_mfma_f32_16x16x32_bf16 v[72:75], a[112:115], a[80:83], v[72:75]
buffer_store_dwordx4 v[96:99], v4, s[24:27], s53 offen offset:0 sc1
v_mfma_f32_16x16x32_bf16 v[72:75], a[116:119], a[84:87], v[72:75]
ds_read_b64_tr_b16 a[144:145], v13 offset:0
ds_read_b64_tr_b16 a[146:147], v13 offset:512
v_mfma_f32_16x16x32_bf16 v[220:223], a[124:127], a[84:87], v[220:223]
buffer_load_dwordx4 v8, s[20:23], s64 offen offset:1024 lds
v_mfma_f32_16x16x32_bf16 v[220:223], a[120:123], a[80:83], v[220:223]
ds_read_b64_tr_b16 a[148:149], v13 offset:4096
ds_read_b64_tr_b16 a[150:151], v13 offset:4608
v_mfma_f32_16x16x32_bf16 v[252:255], a[120:123], a[88:91], v[252:255]
v_lshlrev_b32 v21, 1, v18
v_lshl_add_u32 v21, v19, 2, v21
v_mfma_f32_16x16x32_bf16 v[252:255], a[124:127], a[92:95], v[252:255]
ds_read_b64_tr_b16 a[152:153], v14 offset:0
ds_read_b64_tr_b16 a[154:155], v14 offset:512
v_mfma_f32_16x16x32_bf16 v[160:163], a[116:119], a[92:95], v[160:163]
s_add_u32 m0, s80, 49152
s_add_u32 s64, s79, 2048
v_lshrrev_b32 v22, 1, v16
v_mfma_f32_16x16x32_bf16 v[160:163], a[112:115], a[88:91], v[160:163]
ds_read_b64_tr_b16 a[156:157], v14 offset:4096
ds_read_b64_tr_b16 a[158:159], v14 offset:4608
v_mfma_f32_16x16x32_bf16 v[228:231], a[184:187], a[88:91], v[228:231]
buffer_load_dwordx4 v4, s[24:27], s64 offen sc1 lds
v_mfma_f32_16x16x32_bf16 v[228:231], a[188:191], a[92:95], v[228:231]
s_xor_b32 s65, s70, 640
s_add_u32 s71, s68, s65
s_add_u32 s72, s69, s65
v_mfma_f32_16x16x32_bf16 v[168:171], a[180:183], a[92:95], v[168:171]
ds_read_b128 a[64:67], v4 offset:8192
v_add_u32 v21, v21, v22
v_mfma_f32_16x16x32_bf16 v[168:171], a[176:179], a[88:91], v[168:171]
v_mul_u32_u24 v21, 18, v21
v_and_b32 v22, 1, v16
v_mfma_f32_16x16x32_bf16 v[176:179], a[168:171], a[88:91], v[176:179]
s_add_u32 m0, s73, 65536
s_add_u32 s64, s71, 0
ds_read_b128 a[80:83], v9 offset:0
v_mfma_f32_16x16x32_bf16 v[176:179], a[172:175], a[92:95], v[176:179]
v_add3_u32 v21, v21, v22, 16
v_cmp_lt_u32 s[96:97], 1, v19
v_mfma_f32_16x16x32_bf16 v[80:83], a[164:167], a[92:95], v[80:83]
buffer_load_dwordx4 v5, s[12:15], s64 offen lds
v_mfma_f32_16x16x32_bf16 v[80:83], a[160:163], a[88:91], v[80:83]
ds_read_b128 a[68:71], v4 offset:10240
v_mov_b32 v22, 0x100000
v_mfma_f32_16x16x32_bf16 v[184:187], a[160:163], a[96:99], v[184:187]
ds_read_b128 a[84:87], v10 offset:0
v_mul_u32_u24 v23, 1, v23
v_mfma_f32_16x16x32_bf16 v[184:187], a[164:167], a[100:103], v[184:187]
s_add_u32 s53, s88, 524288
v_cndmask_b32 v21, v21, v22, s[96:97]
v_mov_b32 v22, s52
v_mfma_f32_16x16x32_bf16 v[248:251], a[172:175], a[100:103], v[248:251]
buffer_store_dwordx4 v[104:107], v4, s[24:27], s53 offen offset:1024 sc1
v_mfma_f32_16x16x32_bf16 v[248:251], a[168:171], a[96:99], v[248:251]
ds_read_b128 a[72:75], v4 offset:9216
v_cmp_eq_u32 s[96:97], 4, v22
v_mfma_f32_16x16x32_bf16 v[240:243], a[176:179], a[96:99], v[240:243]
buffer_load_dwordx4 v6, s[12:15], s64 offen offset:1024 lds
v_mfma_f32_16x16x32_bf16 v[240:243], a[180:183], a[100:103], v[240:243]
ds_read_b128 a[88:91], v9 offset:2048
v_cndmask_b32 v20, v20, v21, s[96:97]
v_mfma_f32_16x16x32_bf16 v[232:235], a[188:191], a[100:103], v[232:235]
v_mul_u32_u24 v20, 1152, v20
v_lshl_add_u32 v20, v17, 4, v20
v_mfma_f32_16x16x32_bf16 v[232:235], a[184:187], a[96:99], v[232:235]
ds_read_b128 a[76:79], v4 offset:11264
v_mov_b32 v25, v20
v_mfma_f32_16x16x32_bf16 v[236:239], a[112:115], a[96:99], v[236:239]
s_add_u32 m0, s73, 67584
s_add_u32 s64, s71, 18432
v_mov_b32 v16, s54
v_mfma_f32_16x16x32_bf16 v[236:239], a[116:119], a[100:103], v[236:239]
ds_read_b128 a[92:95], v10 offset:2048
v_mov_b32 v17, s55
v_mfma_f32_16x16x32_bf16 v[224:227], a[124:127], a[100:103], v[224:227]
buffer_load_dwordx4 v5, s[12:15], s64 offen lds
v_mfma_f32_16x16x32_bf16 v[224:227], a[120:123], a[96:99], v[224:227]
v_add_u32 v18, 32, v22
v_mfma_f32_16x16x32_bf16 v[208:211], a[120:123], a[104:107], v[208:211]
s_mul_i32 s82, s55, 165888
s_lshl_b32 s54, s54, 5
s_add_u32 s82, s82, s54
v_mfma_f32_16x16x32_bf16 v[208:211], a[124:127], a[108:111], v[208:211]
s_and_b32 s52, s2, 1
s_lshr_b32 s54, s3, 1
s_lshl1_add_u32 s52, s52, s54
v_mfma_f32_16x16x32_bf16 v[216:219], a[116:119], a[108:111], v[216:219]
s_mul_i32 s52, s52, 9
s_and_b32 s54, s3, 1
s_mul_i32 s55, s54, 5
v_mfma_f32_16x16x32_bf16 v[216:219], a[112:115], a[104:107], v[216:219]
s_add_u32 s52, s52, s55
s_lshr_b32 s55, s2, 1
s_mul_i32 s81, s55, 1152
v_mfma_f32_16x16x32_bf16 v[244:247], a[184:187], a[104:107], v[244:247]
buffer_load_dwordx4 v6, s[12:15], s64 offen offset:1024 lds
v_mfma_f32_16x16x32_bf16 v[244:247], a[188:191], a[108:111], v[244:247]
s_add_u32 s81, s81, s52
s_lshl_b32 s81, s81, 5
v_mfma_f32_16x16x32_bf16 v[192:195], a[180:183], a[108:111], v[192:195]
v_cmp_gt_u32 s[96:97], 5, v1
v_add_u32 v19, s52, v1
v_mfma_f32_16x16x32_bf16 v[192:195], a[176:179], a[104:107], v[192:195]
v_lshrrev_b32 v20, 5, s55
v_and_b32 v21, 31, s55
v_mfma_f32_16x16x32_bf16 v[200:203], a[168:171], a[104:107], v[200:203]
v_cndmask_b32 v16, v16, v19, s[96:97]
v_cndmask_b32 v17, v17, v20, s[96:97]
v_mfma_f32_16x16x32_bf16 v[200:203], a[172:175], a[108:111], v[200:203]
v_cndmask_b32 v18, v18, v21, s[96:97]
v_mul_u32_u24 v19, 7282, v16
v_mfma_f32_16x16x32_bf16 v[88:91], a[164:167], a[108:111], v[88:91]
v_lshrrev_b32 v19, 16, v19
v_mul_u32_u24 v20, 9, v19
v_mfma_f32_16x16x32_bf16 v[88:91], a[160:163], a[104:107], v[88:91]
s_waitcnt lgkmcnt(0)
v_sub_u32 v16, v16, v20
v_and_b32 v20, 1, v19
v_mfma_f32_16x16x32_bf16 v[36:39], a[128:131], a[80:83], v[36:39]
s_waitcnt vmcnt(24)
v_lshlrev_b32 v20, 2, v20
v_cndmask_b32 v20, 0, v20, s[96:97]
v_mfma_f32_16x16x32_bf16 v[36:39], a[132:135], a[84:87], v[36:39]
s_barrier
v_mfma_f32_16x16x32_bf16 v[44:47], a[140:143], a[84:87], v[44:47]
ds_read_b128 a[96:99], v9 offset:4096
v_xor_b32 v18, v18, v20
v_mfma_f32_16x16x32_bf16 v[44:47], a[136:139], a[80:83], v[44:47]
s_xor_b32 s75, s93, 5
s_lshl_b32 s76, s75, 19
s_add_u32 s76, s76, s74
v_mfma_f32_16x16x32_bf16 v[32:35], a[144:147], a[80:83], v[32:35]
s_lshl_b32 s79, s75, 13
s_add_u32 s79, s79, s78
ds_read_b128 a[100:103], v10 offset:4096
v_mfma_f32_16x16x32_bf16 v[32:35], a[148:151], a[84:87], v[32:35]
s_add_u32 m0, s77, 0
s_add_u32 s64, s76, 0
ds_read_b128 a[104:107], v9 offset:6144
v_mfma_f32_16x16x32_bf16 v[52:55], a[156:159], a[84:87], v[52:55]
buffer_load_dwordx4 v7, s[20:23], s64 offen lds
v_mfma_f32_16x16x32_bf16 v[52:55], a[152:155], a[80:83], v[52:55]
s_add_u32 s53, s88, 524288
ds_read_b64_tr_b16 a[160:161], v11 offset:16384
ds_read_b64_tr_b16 a[162:163], v11 offset:16896
v_mfma_f32_16x16x32_bf16 v[60:63], a[64:67], a[80:83], v[60:63]
buffer_store_dwordx4 v[112:115], v4, s[24:27], s53 offen offset:2048 sc1
v_mfma_f32_16x16x32_bf16 v[60:63], a[68:71], a[84:87], v[60:63]
ds_read_b128 a[108:111], v10 offset:6144
v_lshl_add_u32 v19, v19, 2, v17
v_mfma_f32_16x16x32_bf16 v[68:71], a[76:79], a[84:87], v[68:71]
buffer_load_dwordx4 v8, s[20:23], s64 offen offset:1024 lds
v_mfma_f32_16x16x32_bf16 v[68:71], a[72:75], a[80:83], v[68:71]
ds_read_b64_tr_b16 a[164:165], v11 offset:20480
ds_read_b64_tr_b16 a[166:167], v11 offset:20992
v_mfma_f32_16x16x32_bf16 v[76:79], a[72:75], a[88:91], v[76:79]
v_add_u32 v9, 32768, v9
v_add_u32 v10, 32768, v10
v_mfma_f32_16x16x32_bf16 v[76:79], a[76:79], a[92:95], v[76:79]
ds_read_b64_tr_b16 a[168:169], v12 offset:16384
ds_read_b64_tr_b16 a[170:171], v12 offset:16896
v_mfma_f32_16x16x32_bf16 v[84:87], a[68:71], a[92:95], v[84:87]
s_add_u32 m0, s80, 0
s_add_u32 s64, s79, 0
v_mul_u32_u24 v19, 344064, v19
v_mfma_f32_16x16x32_bf16 v[84:87], a[64:67], a[88:91], v[84:87]
ds_read_b64_tr_b16 a[172:173], v12 offset:20480
ds_read_b64_tr_b16 a[174:175], v12 offset:20992
v_mfma_f32_16x16x32_bf16 v[92:95], a[152:155], a[88:91], v[92:95]
buffer_load_dwordx4 v4, s[24:27], s64 offen sc1 lds
v_mfma_f32_16x16x32_bf16 v[92:95], a[156:159], a[92:95], v[92:95]
v_lshrrev_b32 v20, 1, v16
v_sub_u32 v20, v20, v17
v_mfma_f32_16x16x32_bf16 v[40:43], a[148:151], a[92:95], v[40:43]
ds_read_b64_tr_b16 a[176:177], v13 offset:16384
ds_read_b64_tr_b16 a[178:179], v13 offset:16896
v_mfma_f32_16x16x32_bf16 v[40:43], a[144:147], a[88:91], v[40:43]
v_add_u32 v20, 3, v20
v_and_b32 v20, 3, v20
v_mfma_f32_16x16x32_bf16 v[100:103], a[136:139], a[88:91], v[100:103]
s_add_u32 m0, s73, 69632
s_add_u32 s64, s72, 0
v_cmp_eq_u32 s[96:97], 8, v16
v_mfma_f32_16x16x32_bf16 v[100:103], a[140:143], a[92:95], v[100:103]
ds_read_b64_tr_b16 a[180:181], v13 offset:20480
ds_read_b64_tr_b16 a[182:183], v13 offset:20992
v_mfma_f32_16x16x32_bf16 v[108:111], a[132:135], a[92:95], v[108:111]
buffer_load_dwordx4 v5, s[12:15], s64 offen lds
v_mfma_f32_16x16x32_bf16 v[108:111], a[128:131], a[88:91], v[108:111]
s_waitcnt lgkmcnt(14)
ds_read_b64_tr_b16 a[184:185], v14 offset:16384
ds_read_b64_tr_b16 a[186:187], v14 offset:16896
v_mfma_f32_16x16x32_bf16 v[116:119], a[128:131], a[96:99], v[116:119]
ds_read_b64_tr_b16 a[188:189], v14 offset:20480
ds_read_b64_tr_b16 a[190:191], v14 offset:20992
v_mfma_f32_16x16x32_bf16 v[116:119], a[132:135], a[100:103], v[116:119]
v_and_b32 v16, 1, v16
v_lshl_add_u32 v21, v20, 1, v16
v_mfma_f32_16x16x32_bf16 v[124:127], a[140:143], a[100:103], v[124:127]
v_and_b32 v22, 1, v18
v_lshl_add_u32 v19, v22, 10, v19
v_mfma_f32_16x16x32_bf16 v[124:127], a[136:139], a[96:99], v[124:127]
ds_read_b128 a[112:115], v4 offset:24576
v_and_b32 v18, -2, v18
v_mfma_f32_16x16x32_bf16 v[132:135], a[144:147], a[96:99], v[132:135]
buffer_load_dwordx4 v6, s[12:15], s64 offen offset:1024 lds
v_mfma_f32_16x16x32_bf16 v[132:135], a[148:151], a[100:103], v[132:135]
ds_read_b128 a[116:119], v4 offset:26624
v_add_u32 v21, 1, v21
v_mfma_f32_16x16x32_bf16 v[140:143], a[156:159], a[100:103], v[140:143]
v_cndmask_b32 v21, v21, 0, s[96:97]
v_cndmask_b32 v20, v20, 0, s[96:97]
v_mfma_f32_16x16x32_bf16 v[140:143], a[152:155], a[96:99], v[140:143]
s_add_u32 s53, s88, 524288
ds_read_b128 a[120:123], v4 offset:25600
v_sub_u32 v17, 37, v18
v_mfma_f32_16x16x32_bf16 v[148:151], a[64:67], a[96:99], v[148:151]
s_add_u32 m0, s73, 71680
s_add_u32 s64, s72, 18432
v_min_u32 v17, 2, v17
v_mfma_f32_16x16x32_bf16 v[148:151], a[68:71], a[100:103], v[148:151]
ds_read_b128 a[124:127], v4 offset:27648
v_mul_u32_u24 v21, v21, v17
v_mfma_f32_16x16x32_bf16 v[48:51], a[76:79], a[100:103], v[48:51]
buffer_load_dwordx4 v5, s[12:15], s64 offen lds
v_mfma_f32_16x16x32_bf16 v[48:51], a[72:75], a[96:99], v[48:51]
s_waitcnt lgkmcnt(15)
v_mul_u32_u24 v22, v16, v17
v_min_u32 v23, 16, v18
v_mfma_f32_16x16x32_bf16 v[156:159], a[72:75], a[104:107], v[156:159]
buffer_store_dwordx4 v[120:123], v4, s[24:27], s53 offen offset:3072 sc1
v_mfma_f32_16x16x32_bf16 v[156:159], a[76:79], a[108:111], v[156:159]
v_mad_u32_u24 v21, v18, 5, v21
v_lshl_add_u32 v21, v23, 1, v21
v_mfma_f32_16x16x32_bf16 v[164:167], a[68:71], a[108:111], v[164:167]
v_lshl_add_u32 v22, v18, 1, v22
v_mad_u32_u24 v22, v20, 37, v22
v_mfma_f32_16x16x32_bf16 v[164:167], a[64:67], a[104:107], v[164:167]
v_mad_u32_u24 v22, v20, 37, v22
v_lshl_add_u32 v20, v20, 6, v18
v_mfma_f32_16x16x32_bf16 v[172:175], a[152:155], a[104:107], v[172:175]
buffer_load_dwordx4 v6, s[12:15], s64 offen offset:1024 lds
v_mfma_f32_16x16x32_bf16 v[172:175], a[156:159], a[108:111], v[172:175]
v_mov_b32 v23, 144
v_cmp_gt_u32 s[96:97], v23, v20
v_mfma_f32_16x16x32_bf16 v[56:59], a[148:151], a[108:111], v[56:59]
v_add_u32 v22, 37, v22
v_add_u32 v19, 38797312, v19
v_mfma_f32_16x16x32_bf16 v[56:59], a[144:147], a[104:107], v[56:59]
v_cndmask_b32 v21, v22, v21, s[96:97]
v_lshl_add_u32 v19, v21, 10, v19
v_mfma_f32_16x16x32_bf16 v[180:183], a[136:139], a[104:107], v[180:183]
s_cmp_eq_u32 s54, 1
s_cselect_b32 s96, 16, 0
v_mfma_f32_16x16x32_bf16 v[180:183], a[140:143], a[108:111], v[180:183]
s_cmp_eq_u32 s3, 3
s_cselect_b32 s52, 32, 0
s_or_b32 s96, s96, s52
v_mfma_f32_16x16x32_bf16 v[188:191], a[132:135], a[108:111], v[188:191]
s_cmp_ge_u32 s2, 240
s_cselect_b32 s52, 32, 0
s_or_b32 s96, s96, s52
v_mfma_f32_16x16x32_bf16 v[188:191], a[128:131], a[104:107], v[188:191]
s_waitcnt lgkmcnt(0)
s_mov_b32 s97, 0
v_mfma_f32_16x16x32_bf16 v[196:199], a[160:163], a[80:83], v[196:199]
s_waitcnt vmcnt(18)
v_mov_b32 v20, 2147418112
v_cndmask_b32 v26, v19, v20, s[96:97]
v_mfma_f32_16x16x32_bf16 v[196:199], a[164:167], a[84:87], v[196:199]
s_barrier
v_mfma_f32_16x16x32_bf16 v[64:67], a[172:175], a[84:87], v[64:67]
ds_read_b64_tr_b16 a[128:129], v11 offset:32768
ds_read_b64_tr_b16 a[130:131], v11 offset:33280
v_mfma_f32_16x16x32_bf16 v[64:67], a[168:171], a[80:83], v[64:67]
s_add_u32 m0, s77, 16384
s_add_u32 s64, s76, 128
v_lshlrev_b32 v27, 3, v1
v_mfma_f32_16x16x32_bf16 v[204:207], a[176:179], a[80:83], v[204:207]
buffer_load_dwordx4 v7, s[20:23], s64 offen lds
v_mfma_f32_16x16x32_bf16 v[204:207], a[180:183], a[84:87], v[204:207]
ds_read_b64_tr_b16 a[132:133], v11 offset:36864
ds_read_b64_tr_b16 a[134:135], v11 offset:37376
v_mfma_f32_16x16x32_bf16 v[212:215], a[188:191], a[84:87], v[212:215]
ds_read_b64_tr_b16 a[136:137], v12 offset:32768
ds_read_b64_tr_b16 a[138:139], v12 offset:33280
v_mfma_f32_16x16x32_bf16 v[212:215], a[184:187], a[80:83], v[212:215]
ds_read_b64_tr_b16 a[140:141], v12 offset:36864
ds_read_b64_tr_b16 a[142:143], v12 offset:37376
v_mfma_f32_16x16x32_bf16 v[72:75], a[112:115], a[80:83], v[72:75]
buffer_atomic_add v1, v0, s[24:27], s90 offen offset:4 sc1
v_mfma_f32_16x16x32_bf16 v[72:75], a[116:119], a[84:87], v[72:75]
ds_read_b64_tr_b16 a[144:145], v13 offset:32768
ds_read_b64_tr_b16 a[146:147], v13 offset:33280
v_mfma_f32_16x16x32_bf16 v[220:223], a[124:127], a[84:87], v[220:223]
buffer_load_dwordx4 v8, s[20:23], s64 offen offset:1024 lds
v_mfma_f32_16x16x32_bf16 v[220:223], a[120:123], a[80:83], v[220:223]
s_add_u32 s53, s88, 786432
ds_read_b64_tr_b16 a[148:149], v13 offset:36864
ds_read_b64_tr_b16 a[150:151], v13 offset:37376
v_mfma_f32_16x16x32_bf16 v[252:255], a[120:123], a[88:91], v[252:255]
buffer_store_dwordx4 v[128:131], v4, s[24:27], s53 offen offset:0 sc1
v_mfma_f32_16x16x32_bf16 v[252:255], a[124:127], a[92:95], v[252:255]
ds_read_b64_tr_b16 a[152:153], v14 offset:32768
ds_read_b64_tr_b16 a[154:155], v14 offset:33280
v_mfma_f32_16x16x32_bf16 v[160:163], a[116:119], a[92:95], v[160:163]
s_add_u32 m0, s80, 16384
s_add_u32 s64, s79, 2048
v_add_u32 v27, s83, v27
v_mfma_f32_16x16x32_bf16 v[160:163], a[112:115], a[88:91], v[160:163]
ds_read_b64_tr_b16 a[156:157], v14 offset:36864
ds_read_b64_tr_b16 a[158:159], v14 offset:37376
v_mfma_f32_16x16x32_bf16 v[228:231], a[184:187], a[88:91], v[228:231]
buffer_load_dwordx4 v4, s[24:27], s64 offen sc1 lds
v_mfma_f32_16x16x32_bf16 v[228:231], a[188:191], a[92:95], v[228:231]
s_xor_b32 s65, s70, 768
s_add_u32 s71, s68, s65
s_add_u32 s72, s69, s65
v_mfma_f32_16x16x32_bf16 v[168:171], a[180:183], a[92:95], v[168:171]
ds_read_b128 a[64:67], v4 offset:40960
v_lshrrev_b32 v22, 3, v1
v_mfma_f32_16x16x32_bf16 v[168:171], a[176:179], a[88:91], v[168:171]
v_mul_u32_u24 v22, 1152, v22
v_and_b32 v23, 7, v1
v_mfma_f32_16x16x32_bf16 v[176:179], a[168:171], a[88:91], v[176:179]
s_add_u32 m0, s73, 0
s_add_u32 s64, s71, 0
ds_read_b128 a[80:83], v9 offset:0
v_mfma_f32_16x16x32_bf16 v[176:179], a[172:175], a[92:95], v[176:179]
L_PAD6:
s_cbranch_execz L_PAD10
v_lshl_add_u32 v22, v23, 4, v22
v_lshrrev_b32 v23, 2, v1
v_mfma_f32_16x16x32_bf16 v[80:83], a[164:167], a[92:95], v[80:83]
buffer_load_dwordx4 v5, s[12:15], s64 offen lds
v_mfma_f32_16x16x32_bf16 v[80:83], a[160:163], a[88:91], v[80:83]
ds_read_b128 a[68:71], v4 offset:43008
v_mul_u32_u24 v23, 96, v23
v_mfma_f32_16x16x32_bf16 v[184:187], a[160:163], a[96:99], v[184:187]
ds_read_b128 a[84:87], v10 offset:0
v_add_u32 v23, v23, v27
v_mfma_f32_16x16x32_bf16 v[184:187], a[164:167], a[100:103], v[184:187]
v_and_b32 v16, 3, v1
v_cmp_eq_u32 s[96:97], 0, v16
v_mfma_f32_16x16x32_bf16 v[248:251], a[172:175], a[100:103], v[248:251]
v_mov_b32 v16, 0x3f803f80
v_mfma_f32_16x16x32_bf16 v[248:251], a[168:171], a[96:99], v[248:251]
ds_read_b128 a[72:75], v4 offset:41984
v_cndmask_b32 v16, 0, v16, s[96:97]
v_mfma_f32_16x16x32_bf16 v[240:243], a[176:179], a[96:99], v[240:243]
buffer_load_dwordx4 v6, s[12:15], s64 offen offset:1024 lds
v_mfma_f32_16x16x32_bf16 v[240:243], a[180:183], a[100:103], v[240:243]
ds_read_b128 a[88:91], v9 offset:2048
v_accvgpr_write_b32 a240, v16
v_mfma_f32_16x16x32_bf16 v[232:235], a[188:191], a[100:103], v[232:235]
v_accvgpr_write_b32 a241, v16
v_accvgpr_write_b32 a242, v16
v_mfma_f32_16x16x32_bf16 v[232:235], a[184:187], a[96:99], v[232:235]
ds_read_b128 a[76:79], v4 offset:44032
v_accvgpr_write_b32 a243, v16
v_mfma_f32_16x16x32_bf16 v[236:239], a[112:115], a[96:99], v[236:239]
s_add_u32 m0, s73, 2048
s_add_u32 s64, s71, 18432
v_accvgpr_write_b32 a232, 0
v_mfma_f32_16x16x32_bf16 v[236:239], a[116:119], a[100:103], v[236:239]
ds_read_b128 a[92:95], v10 offset:2048
v_accvgpr_write_b32 a233, 0
v_mfma_f32_16x16x32_bf16 v[224:227], a[124:127], a[100:103], v[224:227]
buffer_load_dwordx4 v5, s[12:15], s64 offen lds
v_mfma_f32_16x16x32_bf16 v[224:227], a[120:123], a[96:99], v[224:227]
v_accvgpr_write_b32 a234, 0
v_accvgpr_write_b32 a235, 0
v_mfma_f32_16x16x32_bf16 v[208:211], a[120:123], a[104:107], v[208:211]
v_accvgpr_write_b32 a236, 0
v_accvgpr_write_b32 a237, 0
v_mfma_f32_16x16x32_bf16 v[208:211], a[124:127], a[108:111], v[208:211]
s_add_u32 s53, s88, 786432
v_accvgpr_write_b32 a238, 0
v_accvgpr_write_b32 a239, 0
v_mfma_f32_16x16x32_bf16 v[216:219], a[116:119], a[108:111], v[216:219]
buffer_store_dwordx4 v[136:139], v4, s[24:27], s53 offen offset:1024 sc1
v_mfma_f32_16x16x32_bf16 v[216:219], a[112:115], a[104:107], v[216:219]
v_lshlrev_b32 v16, 2, v3
v_sub_u32 v16, v2, v16
v_mfma_f32_16x16x32_bf16 v[244:247], a[184:187], a[104:107], v[244:247]
buffer_load_dwordx4 v6, s[12:15], s64 offen offset:1024 lds
v_mfma_f32_16x16x32_bf16 v[244:247], a[188:191], a[108:111], v[244:247]
v_cmp_gt_i32 s[56:57], 0, v16
v_cmp_gt_i32 s[58:59], 1, v16
v_mfma_f32_16x16x32_bf16 v[192:195], a[180:183], a[108:111], v[192:195]
v_cmp_gt_i32 s[60:61], 2, v16
v_cmp_gt_i32 s[62:63], 3, v16
v_mfma_f32_16x16x32_bf16 v[192:195], a[176:179], a[104:107], v[192:195]
v_cmp_eq_u32 s[96:97], 3, v3
v_add_u32 v17, 48, v2
v_mfma_f32_16x16x32_bf16 v[200:203], a[168:171], a[104:107], v[200:203]
v_lshlrev_b32 v17, 2, v17
v_lshlrev_b32 v18, 16, v3
v_mfma_f32_16x16x32_bf16 v[200:203], a[172:175], a[108:111], v[200:203]
v_lshl_add_u32 v18, v2, 4, v18
v_add_u32 v19, 0x8000, v18
v_mfma_f32_16x16x32_bf16 v[88:91], a[164:167], a[108:111], v[88:91]
v_cndmask_b32 v19, v19, v20, s[96:97]
v_cmp_eq_u32 s[96:97], 0, v3
v_mfma_f32_16x16x32_bf16 v[88:91], a[160:163], a[104:107], v[88:91]
s_waitcnt lgkmcnt(0)
v_mfma_f32_16x16x32_bf16 v[36:39], a[128:131], a[80:83], v[36:39]
s_waitcnt vmcnt(24)
v_cndmask_b32 v18, v18, v20, s[96:97]
v_cndmask_b32 v19, v19, v20, s[96:97]
v_mfma_f32_16x16x32_bf16 v[36:39], a[132:135], a[84:87], v[36:39]
s_barrier
v_mfma_f32_16x16x32_bf16 v[44:47], a[140:143], a[84:87], v[44:47]
ds_read_b128 a[96:99], v9 offset:4096
v_mfma_f32_16x16x32_bf16 v[44:47], a[136:139], a[80:83], v[44:47]
s_xor_b32 s75, s93, 6
s_lshl_b32 s76, s75, 19
s_add_u32 s76, s76, s74
v_mfma_f32_16x16x32_bf16 v[32:35], a[144:147], a[80:83], v[32:35]
s_lshl_b32 s79, s75, 13
s_add_u32 s79, s79, s78
ds_read_b128 a[100:103], v10 offset:4096
v_mfma_f32_16x16x32_bf16 v[32:35], a[148:151], a[84:87], v[32:35]
s_add_u32 m0, s77, 32768
s_add_u32 s64, s76, 0
ds_read_b128 a[104:107], v9 offset:6144
v_mfma_f32_16x16x32_bf16 v[52:55], a[156:159], a[84:87], v[52:55]
buffer_load_dwordx4 v7, s[20:23], s64 offen lds
v_mfma_f32_16x16x32_bf16 v[52:55], a[152:155], a[80:83], v[52:55]
ds_read_b64_tr_b16 a[160:161], v11 offset:49152
ds_read_b64_tr_b16 a[162:163], v11 offset:49664
v_mfma_f32_16x16x32_bf16 v[60:63], a[64:67], a[80:83], v[60:63]
v_mfma_f32_16x16x32_bf16 v[60:63], a[68:71], a[84:87], v[60:63]
ds_read_b128 a[108:111], v10 offset:6144
v_mfma_f32_16x16x32_bf16 v[68:71], a[76:79], a[84:87], v[68:71]
buffer_load_dwordx4 v8, s[20:23], s64 offen offset:1024 lds
v_mfma_f32_16x16x32_bf16 v[68:71], a[72:75], a[80:83], v[68:71]
ds_read_b64_tr_b16 a[164:165], v11 offset:53248
ds_read_b64_tr_b16 a[166:167], v11 offset:53760
v_mfma_f32_16x16x32_bf16 v[76:79], a[72:75], a[88:91], v[76:79]
v_add_u32 v9, 32768, v9
v_add_u32 v10, 32768, v10
v_mfma_f32_16x16x32_bf16 v[76:79], a[76:79], a[92:95], v[76:79]
ds_read_b64_tr_b16 a[168:169], v12 offset:49152
ds_read_b64_tr_b16 a[170:171], v12 offset:49664
v_mfma_f32_16x16x32_bf16 v[84:87], a[68:71], a[92:95], v[84:87]
s_add_u32 m0, s80, 32768
s_add_u32 s64, s79, 0
v_mfma_f32_16x16x32_bf16 v[84:87], a[64:67], a[88:91], v[84:87]
ds_read_b64_tr_b16 a[172:173], v12 offset:53248
ds_read_b64_tr_b16 a[174:175], v12 offset:53760
v_mfma_f32_16x16x32_bf16 v[92:95], a[152:155], a[88:91], v[92:95]
buffer_load_dwordx4 v4, s[24:27], s64 offen sc1 lds
v_mfma_f32_16x16x32_bf16 v[92:95], a[156:159], a[92:95], v[92:95]
s_add_u32 s53, s88, 786432
v_mfma_f32_16x16x32_bf16 v[40:43], a[148:151], a[92:95], v[40:43]
ds_read_b64_tr_b16 a[176:177], v13 offset:49152
ds_read_b64_tr_b16 a[178:179], v13 offset:49664
v_mfma_f32_16x16x32_bf16 v[40:43], a[144:147], a[88:91], v[40:43]
buffer_store_dwordx4 v[144:147], v4, s[24:27], s53 offen offset:2048 sc1
v_mfma_f32_16x16x32_bf16 v[100:103], a[136:139], a[88:91], v[100:103]
s_add_u32 m0, s73, 4096
s_add_u32 s64, s72, 0
v_mfma_f32_16x16x32_bf16 v[100:103], a[140:143], a[92:95], v[100:103]
ds_read_b64_tr_b16 a[180:181], v13 offset:53248
ds_read_b64_tr_b16 a[182:183], v13 offset:53760
v_mfma_f32_16x16x32_bf16 v[108:111], a[132:135], a[92:95], v[108:111]
buffer_load_dwordx4 v5, s[12:15], s64 offen lds
v_mfma_f32_16x16x32_bf16 v[108:111], a[128:131], a[88:91], v[108:111]
s_waitcnt lgkmcnt(14)
ds_read_b64_tr_b16 a[184:185], v14 offset:49152
ds_read_b64_tr_b16 a[186:187], v14 offset:49664
v_mfma_f32_16x16x32_bf16 v[116:119], a[128:131], a[96:99], v[116:119]
ds_read_b64_tr_b16 a[188:189], v14 offset:53248
ds_read_b64_tr_b16 a[190:191], v14 offset:53760
v_mfma_f32_16x16x32_bf16 v[116:119], a[132:135], a[100:103], v[116:119]
v_mfma_f32_16x16x32_bf16 v[124:127], a[140:143], a[100:103], v[124:127]
v_mfma_f32_16x16x32_bf16 v[124:127], a[136:139], a[96:99], v[124:127]
ds_read_b128 a[112:115], v4 offset:57344
v_mfma_f32_16x16x32_bf16 v[132:135], a[144:147], a[96:99], v[132:135]
buffer_load_dwordx4 v6, s[12:15], s64 offen offset:1024 lds
v_mfma_f32_16x16x32_bf16 v[132:135], a[148:151], a[100:103], v[132:135]
ds_read_b128 a[116:119], v4 offset:59392
v_mfma_f32_16x16x32_bf16 v[140:143], a[156:159], a[100:103], v[140:143]
v_mfma_f32_16x16x32_bf16 v[140:143], a[152:155], a[96:99], v[140:143]
ds_read_b128 a[120:123], v4 offset:58368
v_mfma_f32_16x16x32_bf16 v[148:151], a[64:67], a[96:99], v[148:151]
s_add_u32 m0, s73, 6144
s_add_u32 s64, s72, 18432
v_mfma_f32_16x16x32_bf16 v[148:151], a[68:71], a[100:103], v[148:151]
ds_read_b128 a[124:127], v4 offset:60416
v_mfma_f32_16x16x32_bf16 v[48:51], a[76:79], a[100:103], v[48:51]
buffer_load_dwordx4 v5, s[12:15], s64 offen lds
v_mfma_f32_16x16x32_bf16 v[48:51], a[72:75], a[96:99], v[48:51]
s_waitcnt lgkmcnt(15)
v_mfma_f32_16x16x32_bf16 v[156:159], a[72:75], a[104:107], v[156:159]
v_mfma_f32_16x16x32_bf16 v[156:159], a[76:79], a[108:111], v[156:159]
v_mfma_f32_16x16x32_bf16 v[164:167], a[68:71], a[108:111], v[164:167]
v_mfma_f32_16x16x32_bf16 v[164:167], a[64:67], a[104:107], v[164:167]
v_mfma_f32_16x16x32_bf16 v[172:175], a[152:155], a[104:107], v[172:175]
buffer_load_dwordx4 v6, s[12:15], s64 offen offset:1024 lds
v_mfma_f32_16x16x32_bf16 v[172:175], a[156:159], a[108:111], v[172:175]
v_mfma_f32_16x16x32_bf16 v[56:59], a[148:151], a[108:111], v[56:59]
v_mfma_f32_16x16x32_bf16 v[56:59], a[144:147], a[104:107], v[56:59]
s_add_u32 s53, s88, 786432
v_mfma_f32_16x16x32_bf16 v[180:183], a[136:139], a[104:107], v[180:183]
buffer_store_dwordx4 v[152:155], v4, s[24:27], s53 offen offset:3072 sc1
v_mfma_f32_16x16x32_bf16 v[180:183], a[140:143], a[108:111], v[180:183]
v_mfma_f32_16x16x32_bf16 v[188:191], a[132:135], a[108:111], v[188:191]
v_mfma_f32_16x16x32_bf16 v[188:191], a[128:131], a[104:107], v[188:191]
s_waitcnt lgkmcnt(0)
v_mov_b32 v96, 0
v_mov_b32 v97, 0
v_mfma_f32_16x16x32_bf16 v[196:199], a[160:163], a[80:83], v[196:199]
s_waitcnt vmcnt(19)
v_mov_b32 v98, 0
v_mov_b32 v99, 0
v_mfma_f32_16x16x32_bf16 v[196:199], a[164:167], a[84:87], v[196:199]
s_barrier
v_mfma_f32_16x16x32_bf16 v[64:67], a[172:175], a[84:87], v[64:67]
ds_read_b64_tr_b16 a[128:129], v11 offset:0
ds_read_b64_tr_b16 a[130:131], v11 offset:512
v_mfma_f32_16x16x32_bf16 v[64:67], a[168:171], a[80:83], v[64:67]
s_add_u32 m0, s77, 49152
s_add_u32 s64, s76, 128
v_mov_b32 v104, 0
v_mfma_f32_16x16x32_bf16 v[204:207], a[176:179], a[80:83], v[204:207]
buffer_load_dwordx4 v7, s[20:23], s64 offen lds
v_mfma_f32_16x16x32_bf16 v[204:207], a[180:183], a[84:87], v[204:207]
ds_read_b64_tr_b16 a[132:133], v11 offset:4096
ds_read_b64_tr_b16 a[134:135], v11 offset:4608
v_mfma_f32_16x16x32_bf16 v[212:215], a[188:191], a[84:87], v[212:215]
ds_read_b64_tr_b16 a[136:137], v12 offset:0
ds_read_b64_tr_b16 a[138:139], v12 offset:512
v_mfma_f32_16x16x32_bf16 v[212:215], a[184:187], a[80:83], v[212:215]
ds_read_b64_tr_b16 a[140:141], v12 offset:4096
ds_read_b64_tr_b16 a[142:143], v12 offset:4608
v_mfma_f32_16x16x32_bf16 v[72:75], a[112:115], a[80:83], v[72:75]
buffer_load_dword v30, v29, s[24:27], s89 offen offset:4 sc1
v_mfma_f32_16x16x32_bf16 v[72:75], a[116:119], a[84:87], v[72:75]
ds_read_b64_tr_b16 a[144:145], v13 offset:0
ds_read_b64_tr_b16 a[146:147], v13 offset:512
v_mfma_f32_16x16x32_bf16 v[220:223], a[124:127], a[84:87], v[220:223]
buffer_load_dwordx4 v8, s[20:23], s64 offen offset:1024 lds
v_mfma_f32_16x16x32_bf16 v[220:223], a[120:123], a[80:83], v[220:223]
ds_read_b64_tr_b16 a[148:149], v13 offset:4096
ds_read_b64_tr_b16 a[150:151], v13 offset:4608
v_mfma_f32_16x16x32_bf16 v[252:255], a[120:123], a[88:91], v[252:255]
v_mov_b32 v105, 0
v_mov_b32 v106, 0
v_mfma_f32_16x16x32_bf16 v[252:255], a[124:127], a[92:95], v[252:255]
ds_read_b64_tr_b16 a[152:153], v14 offset:0
ds_read_b64_tr_b16 a[154:155], v14 offset:512
v_mfma_f32_16x16x32_bf16 v[160:163], a[116:119], a[92:95], v[160:163]
s_add_u32 m0, s80, 49152
s_add_u32 s64, s79, 2048
v_mov_b32 v107, 0
v_mfma_f32_16x16x32_bf16 v[160:163], a[112:115], a[88:91], v[160:163]
ds_read_b64_tr_b16 a[156:157], v14 offset:4096
ds_read_b64_tr_b16 a[158:159], v14 offset:4608
v_mfma_f32_16x16x32_bf16 v[228:231], a[184:187], a[88:91], v[228:231]
buffer_load_dwordx4 v4, s[24:27], s64 offen sc1 lds
v_mfma_f32_16x16x32_bf16 v[228:231], a[188:191], a[92:95], v[228:231]
s_xor_b32 s65, s70, 896
s_add_u32 s71, s68, s65
s_add_u32 s72, s69, s65
v_mfma_f32_16x16x32_bf16 v[168:171], a[180:183], a[92:95], v[168:171]
ds_read_b128 a[64:67], v4 offset:8192
v_mov_b32 v112, 0
v_mfma_f32_16x16x32_bf16 v[168:171], a[176:179], a[88:91], v[168:171]
v_mov_b32 v113, 0
v_mov_b32 v114, 0
v_mfma_f32_16x16x32_bf16 v[176:179], a[168:171], a[88:91], v[176:179]
s_add_u32 m0, s73, 32768
s_add_u32 s64, s71, 0
ds_read_b128 a[80:83], v9 offset:0
v_mfma_f32_16x16x32_bf16 v[176:179], a[172:175], a[92:95], v[176:179]
v_mov_b32 v115, 0
v_mov_b32 v120, 0
v_mfma_f32_16x16x32_bf16 v[80:83], a[164:167], a[92:95], v[80:83]
buffer_load_dwordx4 v5, s[12:15], s64 offen lds
v_mfma_f32_16x16x32_bf16 v[80:83], a[160:163], a[88:91], v[80:83]
s_add_u32 s53, s87, 524288
ds_read_b128 a[68:71], v4 offset:10240
v_mov_b32 v121, 0
v_mfma_f32_16x16x32_bf16 v[184:187], a[160:163], a[96:99], v[184:187]
ds_read_b128 a[84:87], v10 offset:0
v_mov_b32 v122, 0
v_mfma_f32_16x16x32_bf16 v[184:187], a[164:167], a[100:103], v[184:187]
buffer_store_dwordx4 a[28:31], v4, s[24:27], s53 offen offset:0 sc1
v_mfma_f32_16x16x32_bf16 v[248:251], a[172:175], a[100:103], v[248:251]
v_mov_b32 v123, 0
v_mov_b32 v128, 0
v_mfma_f32_16x16x32_bf16 v[248:251], a[168:171], a[96:99], v[248:251]
ds_read_b128 a[72:75], v4 offset:9216
v_mov_b32 v129, 0
v_mfma_f32_16x16x32_bf16 v[240:243], a[176:179], a[96:99], v[240:243]
buffer_load_dwordx4 v6, s[12:15], s64 offen offset:1024 lds
v_mfma_f32_16x16x32_bf16 v[240:243], a[180:183], a[100:103], v[240:243]
ds_read_b128 a[88:91], v9 offset:2048
v_mov_b32 v130, 0
v_mfma_f32_16x16x32_bf16 v[232:235], a[188:191], a[100:103], v[232:235]
v_mov_b32 v131, 0
v_mov_b32 v136, 0
v_mfma_f32_16x16x32_bf16 v[232:235], a[184:187], a[96:99], v[232:235]
ds_read_b128 a[76:79], v4 offset:11264
v_mov_b32 v137, 0
v_mfma_f32_16x16x32_bf16 v[236:239], a[112:115], a[96:99], v[236:239]
s_add_u32 m0, s73, 34816
s_add_u32 s64, s71, 18432
v_mov_b32 v138, 0
v_mfma_f32_16x16x32_bf16 v[236:239], a[116:119], a[100:103], v[236:239]
ds_read_b128 a[92:95], v10 offset:2048
v_mov_b32 v139, 0
v_mfma_f32_16x16x32_bf16 v[224:227], a[124:127], a[100:103], v[224:227]
buffer_load_dwordx4 v5, s[12:15], s64 offen lds
v_mfma_f32_16x16x32_bf16 v[224:227], a[120:123], a[96:99], v[224:227]
v_mov_b32 v144, 0
v_mov_b32 v145, 0
v_mfma_f32_16x16x32_bf16 v[208:211], a[120:123], a[104:107], v[208:211]
v_mov_b32 v146, 0
v_mov_b32 v147, 0
v_mfma_f32_16x16x32_bf16 v[208:211], a[124:127], a[108:111], v[208:211]
v_mov_b32 v152, 0
v_mov_b32 v153, 0
v_mfma_f32_16x16x32_bf16 v[216:219], a[116:119], a[108:111], v[216:219]
v_mov_b32 v154, 0
v_mov_b32 v155, 0
v_mfma_f32_16x16x32_bf16 v[216:219], a[112:115], a[104:107], v[216:219]
v_mfma_f32_16x16x32_bf16 v[244:247], a[184:187], a[104:107], v[244:247]
buffer_load_dwordx4 v6, s[12:15], s64 offen offset:1024 lds
v_mfma_f32_16x16x32_bf16 v[244:247], a[188:191], a[108:111], v[244:247]
v_mfma_f32_16x16x32_bf16 v[192:195], a[180:183], a[108:111], v[192:195]
v_mfma_f32_16x16x32_bf16 v[192:195], a[176:179], a[104:107], v[192:195]
v_mfma_f32_16x16x32_bf16 v[200:203], a[168:171], a[104:107], v[200:203]
v_mfma_f32_16x16x32_bf16 v[200:203], a[172:175], a[108:111], v[200:203]
v_mfma_f32_16x16x32_bf16 v[88:91], a[164:167], a[108:111], v[88:91]
v_mfma_f32_16x16x32_bf16 v[88:91], a[160:163], a[104:107], v[88:91]
s_waitcnt lgkmcnt(0)
v_mfma_f32_16x16x32_bf16 v[36:39], a[128:131], a[80:83], v[36:39]
s_waitcnt vmcnt(23)
v_mfma_f32_16x16x32_bf16 v[36:39], a[132:135], a[84:87], v[36:39]
s_barrier
v_mfma_f32_16x16x32_bf16 v[44:47], a[140:143], a[84:87], v[44:47]
s_add_u32 s53, s87, 524288
ds_read_b128 a[96:99], v9 offset:4096
v_mfma_f32_16x16x32_bf16 v[44:47], a[136:139], a[80:83], v[44:47]
s_xor_b32 s75, s93, 7
s_lshl_b32 s76, s75, 19
s_add_u32 s76, s76, s74
v_mfma_f32_16x16x32_bf16 v[32:35], a[144:147], a[80:83], v[32:35]
s_lshl_b32 s79, s75, 13
s_add_u32 s79, s79, s78
ds_read_b128 a[100:103], v10 offset:4096
v_mfma_f32_16x16x32_bf16 v[32:35], a[148:151], a[84:87], v[32:35]
s_add_u32 m0, s77, 0
s_add_u32 s64, s76, 0
ds_read_b128 a[104:107], v9 offset:6144
v_mfma_f32_16x16x32_bf16 v[52:55], a[156:159], a[84:87], v[52:55]
buffer_load_dwordx4 v7, s[20:23], s64 offen lds
v_mfma_f32_16x16x32_bf16 v[52:55], a[152:155], a[80:83], v[52:55]
ds_read_b64_tr_b16 a[160:161], v11 offset:16384
ds_read_b64_tr_b16 a[162:163], v11 offset:16896
v_mfma_f32_16x16x32_bf16 v[60:63], a[64:67], a[80:83], v[60:63]
buffer_store_dwordx4 a[20:23], v4, s[24:27], s53 offen offset:1024 sc1
v_mfma_f32_16x16x32_bf16 v[60:63], a[68:71], a[84:87], v[60:63]
ds_read_b128 a[108:111], v10 offset:6144
v_mfma_f32_16x16x32_bf16 v[68:71], a[76:79], a[84:87], v[68:71]
buffer_load_dwordx4 v8, s[20:23], s64 offen offset:1024 lds
v_mfma_f32_16x16x32_bf16 v[68:71], a[72:75], a[80:83], v[68:71]
ds_read_b64_tr_b16 a[164:165], v11 offset:20480
ds_read_b64_tr_b16 a[166:167], v11 offset:20992
v_mfma_f32_16x16x32_bf16 v[76:79], a[72:75], a[88:91], v[76:79]
v_add_u32 v9, -65536, v9
v_add_u32 v10, -65536, v10
v_mfma_f32_16x16x32_bf16 v[76:79], a[76:79], a[92:95], v[76:79]
ds_read_b64_tr_b16 a[168:169], v12 offset:16384
ds_read_b64_tr_b16 a[170:171], v12 offset:16896
v_mfma_f32_16x16x32_bf16 v[84:87], a[68:71], a[92:95], v[84:87]
s_add_u32 m0, s80, 0
s_add_u32 s64, s79, 0
v_mfma_f32_16x16x32_bf16 v[84:87], a[64:67], a[88:91], v[84:87]
ds_read_b64_tr_b16 a[172:173], v12 offset:20480
ds_read_b64_tr_b16 a[174:175], v12 offset:20992
v_mfma_f32_16x16x32_bf16 v[92:95], a[152:155], a[88:91], v[92:95]
buffer_load_dwordx4 v4, s[24:27], s64 offen sc1 lds
v_mfma_f32_16x16x32_bf16 v[92:95], a[156:159], a[92:95], v[92:95]
v_mfma_f32_16x16x32_bf16 v[40:43], a[148:151], a[92:95], v[40:43]
ds_read_b64_tr_b16 a[176:177], v13 offset:16384
ds_read_b64_tr_b16 a[178:179], v13 offset:16896
v_mfma_f32_16x16x32_bf16 v[40:43], a[144:147], a[88:91], v[40:43]
v_mfma_f32_16x16x32_bf16 v[100:103], a[136:139], a[88:91], v[100:103]
s_add_u32 m0, s73, 36864
s_add_u32 s64, s72, 0
v_mfma_f32_16x16x32_bf16 v[100:103], a[140:143], a[92:95], v[100:103]
ds_read_b64_tr_b16 a[180:181], v13 offset:20480
ds_read_b64_tr_b16 a[182:183], v13 offset:20992
v_mfma_f32_16x16x32_bf16 v[108:111], a[132:135], a[92:95], v[108:111]
buffer_load_dwordx4 v5, s[12:15], s64 offen lds
v_mfma_f32_16x16x32_bf16 v[108:111], a[128:131], a[88:91], v[108:111]
s_waitcnt lgkmcnt(14)
ds_read_b64_tr_b16 a[184:185], v14 offset:16384
ds_read_b64_tr_b16 a[186:187], v14 offset:16896
v_mfma_f32_16x16x32_bf16 v[116:119], a[128:131], a[96:99], v[116:119]
ds_read_b64_tr_b16 a[188:189], v14 offset:20480
ds_read_b64_tr_b16 a[190:191], v14 offset:20992
v_mfma_f32_16x16x32_bf16 v[116:119], a[132:135], a[100:103], v[116:119]
v_mfma_f32_16x16x32_bf16 v[124:127], a[140:143], a[100:103], v[124:127]
v_mfma_f32_16x16x32_bf16 v[124:127], a[136:139], a[96:99], v[124:127]
ds_read_b128 a[112:115], v4 offset:24576
v_mfma_f32_16x16x32_bf16 v[132:135], a[144:147], a[96:99], v[132:135]
buffer_load_dwordx4 v6, s[12:15], s64 offen offset:1024 lds
v_mfma_f32_16x16x32_bf16 v[132:135], a[148:151], a[100:103], v[132:135]
s_add_u32 s53, s87, 528384
ds_read_b128 a[116:119], v4 offset:26624
v_mfma_f32_16x16x32_bf16 v[140:143], a[156:159], a[100:103], v[140:143]
buffer_store_dwordx4 a[12:15], v4, s[24:27], s53 offen offset:0 sc1
v_mfma_f32_16x16x32_bf16 v[140:143], a[152:155], a[96:99], v[140:143]
ds_read_b128 a[120:123], v4 offset:25600
v_mfma_f32_16x16x32_bf16 v[148:151], a[64:67], a[96:99], v[148:151]
s_add_u32 m0, s73, 38912
s_add_u32 s64, s72, 18432
v_mfma_f32_16x16x32_bf16 v[148:151], a[68:71], a[100:103], v[148:151]
ds_read_b128 a[124:127], v4 offset:27648
v_mfma_f32_16x16x32_bf16 v[48:51], a[76:79], a[100:103], v[48:51]
buffer_load_dwordx4 v5, s[12:15], s64 offen lds
v_mfma_f32_16x16x32_bf16 v[48:51], a[72:75], a[96:99], v[48:51]
s_waitcnt lgkmcnt(15)
v_mfma_f32_16x16x32_bf16 v[156:159], a[72:75], a[104:107], v[156:159]
v_mfma_f32_16x16x32_bf16 v[156:159], a[76:79], a[108:111], v[156:159]
v_mfma_f32_16x16x32_bf16 v[164:167], a[68:71], a[108:111], v[164:167]
v_mfma_f32_16x16x32_bf16 v[164:167], a[64:67], a[104:107], v[164:167]
v_mfma_f32_16x16x32_bf16 v[172:175], a[152:155], a[104:107], v[172:175]
buffer_load_dwordx4 v6, s[12:15], s64 offen offset:1024 lds
v_mfma_f32_16x16x32_bf16 v[172:175], a[156:159], a[108:111], v[172:175]
v_mfma_f32_16x16x32_bf16 v[56:59], a[148:151], a[108:111], v[56:59]
v_mfma_f32_16x16x32_bf16 v[56:59], a[144:147], a[104:107], v[56:59]
v_mfma_f32_16x16x32_bf16 v[180:183], a[136:139], a[104:107], v[180:183]
v_mfma_f32_16x16x32_bf16 v[180:183], a[140:143], a[108:111], v[180:183]
v_mfma_f32_16x16x32_bf16 v[188:191], a[132:135], a[108:111], v[188:191]
v_mfma_f32_16x16x32_bf16 v[188:191], a[128:131], a[104:107], v[188:191]
s_waitcnt lgkmcnt(0)
v_mfma_f32_16x16x32_bf16 v[196:199], a[160:163], a[80:83], v[196:199]
s_waitcnt vmcnt(19)
v_mfma_f32_16x16x32_bf16 v[196:199], a[164:167], a[84:87], v[196:199]
s_barrier
v_mfma_f32_16x16x32_bf16 v[64:67], a[172:175], a[84:87], v[64:67]
ds_read_b64_tr_b16 a[128:129], v11 offset:32768
ds_read_b64_tr_b16 a[130:131], v11 offset:33280
v_mfma_f32_16x16x32_bf16 v[64:67], a[168:171], a[80:83], v[64:67]
s_add_u32 m0, s77, 16384
s_add_u32 s64, s76, 128
v_mfma_f32_16x16x32_bf16 v[204:207], a[176:179], a[80:83], v[204:207]
buffer_load_dwordx4 v7, s[20:23], s64 offen lds
v_mfma_f32_16x16x32_bf16 v[204:207], a[180:183], a[84:87], v[204:207]
ds_read_b64_tr_b16 a[132:133], v11 offset:36864
ds_read_b64_tr_b16 a[134:135], v11 offset:37376
v_mfma_f32_16x16x32_bf16 v[212:215], a[188:191], a[84:87], v[212:215]
ds_read_b64_tr_b16 a[136:137], v12 offset:32768
ds_read_b64_tr_b16 a[138:139], v12 offset:33280
v_mfma_f32_16x16x32_bf16 v[212:215], a[184:187], a[80:83], v[212:215]
s_add_u32 s53, s87, 528384
ds_read_b64_tr_b16 a[140:141], v12 offset:36864
ds_read_b64_tr_b16 a[142:143], v12 offset:37376
v_mfma_f32_16x16x32_bf16 v[72:75], a[112:115], a[80:83], v[72:75]
buffer_load_dwordx4 v8, s[20:23], s64 offen offset:1024 lds
v_mfma_f32_16x16x32_bf16 v[72:75], a[116:119], a[84:87], v[72:75]
ds_read_b64_tr_b16 a[144:145], v13 offset:32768
ds_read_b64_tr_b16 a[146:147], v13 offset:33280
v_mfma_f32_16x16x32_bf16 v[220:223], a[124:127], a[84:87], v[220:223]
buffer_store_dwordx4 a[4:7], v4, s[24:27], s53 offen offset:1024 sc1
v_mfma_f32_16x16x32_bf16 v[220:223], a[120:123], a[80:83], v[220:223]
s_add_u32 m0, s80, 16384
s_add_u32 s64, s79, 2048
v_mfma_f32_16x16x32_bf16 v[252:255], a[120:123], a[88:91], v[252:255]
ds_read_b64_tr_b16 a[148:149], v13 offset:36864
ds_read_b64_tr_b16 a[150:151], v13 offset:37376
v_mfma_f32_16x16x32_bf16 v[252:255], a[124:127], a[92:95], v[252:255]
buffer_load_dwordx4 v4, s[24:27], s64 offen sc1 lds
v_mfma_f32_16x16x32_bf16 v[160:163], a[116:119], a[92:95], v[160:163]
ds_read_b64_tr_b16 a[152:153], v14 offset:32768
ds_read_b64_tr_b16 a[154:155], v14 offset:33280
v_mfma_f32_16x16x32_bf16 v[160:163], a[112:115], a[88:91], v[160:163]
ds_read_b64_tr_b16 a[156:157], v14 offset:36864
ds_read_b64_tr_b16 a[158:159], v14 offset:37376
v_mfma_f32_16x16x32_bf16 v[228:231], a[184:187], a[88:91], v[228:231]
s_add_u32 m0, s83, 0
s_add_u32 s64, s81, 0
v_mfma_f32_16x16x32_bf16 v[228:231], a[188:191], a[92:95], v[228:231]
v_mfma_f32_16x16x32_bf16 v[168:171], a[180:183], a[92:95], v[168:171]
buffer_load_dwordx4 v22, s[32:35], s64 offen lds
v_mfma_f32_16x16x32_bf16 v[168:171], a[176:179], a[88:91], v[168:171]
ds_read_b128 a[64:67], v4 offset:40960
v_mfma_f32_16x16x32_bf16 v[176:179], a[168:171], a[88:91], v[176:179]
s_add_u32 m0, s83, 1024
s_add_u32 s64, s81, 9216
ds_read_b128 a[80:83], v9 offset:0
v_mfma_f32_16x16x32_bf16 v[176:179], a[172:175], a[92:95], v[176:179]
v_mfma_f32_16x16x32_bf16 v[80:83], a[164:167], a[92:95], v[80:83]
buffer_load_dwordx4 v22, s[32:35], s64 offen lds
v_mfma_f32_16x16x32_bf16 v[80:83], a[160:163], a[88:91], v[80:83]
ds_read_b128 a[68:71], v4 offset:43008
v_mfma_f32_16x16x32_bf16 v[184:187], a[160:163], a[96:99], v[184:187]
ds_read_b128 a[84:87], v10 offset:0
v_mfma_f32_16x16x32_bf16 v[184:187], a[164:167], a[100:103], v[184:187]
s_add_u32 m0, s83, 2048
s_add_u32 s64, s81, 18432
v_mfma_f32_16x16x32_bf16 v[248:251], a[172:175], a[100:103], v[248:251]
v_mfma_f32_16x16x32_bf16 v[248:251], a[168:171], a[96:99], v[248:251]
buffer_load_dwordx4 v22, s[32:35], s64 offen lds
v_mfma_f32_16x16x32_bf16 v[240:243], a[176:179], a[96:99], v[240:243]
ds_read_b128 a[72:75], v4 offset:41984
v_mfma_f32_16x16x32_bf16 v[240:243], a[180:183], a[100:103], v[240:243]
ds_read_b128 a[88:91], v9 offset:2048
v_mfma_f32_16x16x32_bf16 v[232:235], a[188:191], a[100:103], v[232:235]
s_add_u32 m0, s83, 3072
s_add_u32 s64, s81, 27648
v_mfma_f32_16x16x32_bf16 v[232:235], a[184:187], a[96:99], v[232:235]
ds_read_b128 a[76:79], v4 offset:44032
v_mfma_f32_16x16x32_bf16 v[236:239], a[112:115], a[96:99], v[236:239]
buffer_load_dwordx4 v22, s[32:35], s64 offen lds
v_mfma_f32_16x16x32_bf16 v[236:239], a[116:119], a[100:103], v[236:239]
ds_read_b128 a[92:95], v10 offset:2048
v_mfma_f32_16x16x32_bf16 v[224:227], a[124:127], a[100:103], v[224:227]
s_add_u32 m0, s83, 4096
s_add_u32 s64, s81, 128
s_add_u32 s53, s87, 786432
v_mfma_f32_16x16x32_bf16 v[224:227], a[120:123], a[96:99], v[224:227]
buffer_store_dwordx4 a[0:3], v4, s[24:27], s53 offen offset:0 sc1
v_mfma_f32_16x16x32_bf16 v[208:211], a[120:123], a[104:107], v[208:211]
buffer_load_dwordx4 v24, s[32:35], s64 offen lds
v_mfma_f32_16x16x32_bf16 v[208:211], a[124:127], a[108:111], v[208:211]
s_waitcnt vmcnt(26)
v_mfma_f32_16x16x32_bf16 v[216:219], a[116:119], a[108:111], v[216:219]
v_cmp_gt_u32 vcc, 8, v30
v_mfma_f32_16x16x32_bf16 v[216:219], a[112:115], a[104:107], v[216:219]
s_add_u32 m0, s83, 5120
s_add_u32 s64, s82, 0
v_mfma_f32_16x16x32_bf16 v[244:247], a[184:187], a[104:107], v[244:247]
v_mfma_f32_16x16x32_bf16 v[244:247], a[188:191], a[108:111], v[244:247]
buffer_load_dwordx4 v25, s[48:51], s64 offen lds
v_mfma_f32_16x16x32_bf16 v[192:195], a[180:183], a[108:111], v[192:195]
v_mfma_f32_16x16x32_bf16 v[192:195], a[176:179], a[104:107], v[192:195]
s_cbranch_vccnz CK_KV
CK_KV_R:
v_mfma_f32_16x16x32_bf16 v[200:203], a[168:171], a[104:107], v[200:203]
v_mfma_f32_16x16x32_bf16 v[200:203], a[172:175], a[108:111], v[200:203]
v_mfma_f32_16x16x32_bf16 v[88:91], a[164:167], a[108:111], v[88:91]
v_mfma_f32_16x16x32_bf16 v[88:91], a[160:163], a[104:107], v[88:91]
s_waitcnt lgkmcnt(0)
v_mfma_f32_16x16x32_bf16 v[36:39], a[128:131], a[80:83], v[36:39]
s_waitcnt vmcnt(25)
v_mov_b32 v6, 0xf149f2ca
v_mfma_f32_16x16x32_bf16 v[36:39], a[132:135], a[84:87], v[36:39]
s_barrier
v_mfma_f32_16x16x32_bf16 v[44:47], a[140:143], a[84:87], v[44:47]
ds_read_b128 a[96:99], v9 offset:4096
v_mfma_f32_16x16x32_bf16 v[44:47], a[136:139], a[80:83], v[44:47]
s_lshl_b32 s70, s3, 12
s_add_u32 s68, s70, s94
ds_read_b128 a[100:103], v10 offset:4096
v_mfma_f32_16x16x32_bf16 v[32:35], a[144:147], a[80:83], v[32:35]
s_add_u32 m0, s70, 32768
s_cmp_lt_u32 s3, 2
s_cselect_b32 s64, s68, 2147418112
v_mfma_f32_16x16x32_bf16 v[32:35], a[148:151], a[84:87], v[32:35]
buffer_load_dwordx4 v4, s[24:27], s64 offen offset:0 sc1 lds
v_mfma_f32_16x16x32_bf16 v[52:55], a[156:159], a[84:87], v[52:55]
ds_read_b128 a[104:107], v9 offset:6144
v_mfma_f32_16x16x32_bf16 v[52:55], a[152:155], a[80:83], v[52:55]
ds_read_b64_tr_b16 a[160:161], v11 offset:49152
ds_read_b64_tr_b16 a[162:163], v11 offset:49664
v_mfma_f32_16x16x32_bf16 v[60:63], a[64:67], a[80:83], v[60:63]
s_cmp_eq_u32 s66, 0
s_cbranch_scc1 D0
D0_R:
v_mfma_f32_16x16x32_bf16 v[60:63], a[68:71], a[84:87], v[60:63]
s_lshl_b32 s52, s4, 18
s_add_u32 s52, s52, 45088768
ds_read_b128 a[108:111], v10 offset:6144
v_mfma_f32_16x16x32_bf16 v[68:71], a[76:79], a[84:87], v[68:71]
s_lshl_b32 s54, s66, 9
v_add_u32 v9, 32768, v9
v_add_u32 v10, 32768, v10
v_mfma_f32_16x16x32_bf16 v[68:71], a[72:75], a[80:83], v[68:71]
s_add_u32 s54, s54, s52
ds_read_b64_tr_b16 a[164:165], v11 offset:53248
ds_read_b64_tr_b16 a[166:167], v11 offset:53760
v_mfma_f32_16x16x32_bf16 v[76:79], a[72:75], a[88:91], v[76:79]
s_lshl_b32 s55, s67, 9
s_add_u32 s55, s55, s52
v_mfma_f32_16x16x32_bf16 v[76:79], a[76:79], a[92:95], v[76:79]
s_add_u32 s53, s87, 786432
ds_read_b64_tr_b16 a[168:169], v12 offset:49152
ds_read_b64_tr_b16 a[170:171], v12 offset:49664
L_PAD7:
s_cbranch_execz L_PAD11
v_mfma_f32_16x16x32_bf16 v[84:87], a[68:71], a[92:95], v[84:87]
buffer_load_dwordx4 v4, s[24:27], s64 offen offset:1024 sc1 lds
v_mfma_f32_16x16x32_bf16 v[84:87], a[64:67], a[88:91], v[84:87]
s_max_u32 s65, s66, 1
ds_read_b64_tr_b16 a[172:173], v12 offset:53248
ds_read_b64_tr_b16 a[174:175], v12 offset:53760
v_mfma_f32_16x16x32_bf16 v[92:95], a[152:155], a[88:91], v[92:95]
buffer_store_dwordx4 a[8:11], v4, s[24:27], s53 offen offset:1024 sc1
v_mfma_f32_16x16x32_bf16 v[92:95], a[156:159], a[92:95], v[92:95]
s_lshl_b32 s65, s65, 9
s_add_u32 s52, s52, s65
s_sub_u32 s65, s55, s52
v_mfma_f32_16x16x32_bf16 v[40:43], a[148:151], a[92:95], v[40:43]
s_sub_u32 s65, s65, 163840
ds_read_b64_tr_b16 a[176:177], v13 offset:49152
ds_read_b64_tr_b16 a[178:179], v13 offset:49664
v_mfma_f32_16x16x32_bf16 v[40:43], a[144:147], a[88:91], v[40:43]
s_add_u32 s52, s52, 65280
v_mfma_f32_16x16x32_bf16 v[100:103], a[136:139], a[88:91], v[100:103]
ds_read_b64_tr_b16 a[180:181], v13 offset:53248
ds_read_b64_tr_b16 a[182:183], v13 offset:53760
v_mfma_f32_16x16x32_bf16 v[100:103], a[140:143], a[92:95], v[100:103]
v_cmp_lt_u32 s[96:97], 0, v3
v_lshlrev_b32 v16, 15, v3
v_mfma_f32_16x16x32_bf16 v[108:111], a[132:135], a[92:95], v[108:111]
ds_read_b64_tr_b16 a[184:185], v14 offset:49152
ds_read_b64_tr_b16 a[186:187], v14 offset:49664
v_mfma_f32_16x16x32_bf16 v[108:111], a[128:131], a[88:91], v[108:111]
s_waitcnt lgkmcnt(15)
v_lshl_add_u32 v16, v2, 4, v16
v_add_u32 v16, s52, v16
v_mfma_f32_16x16x32_bf16 v[116:119], a[128:131], a[96:99], v[116:119]
ds_read_b64_tr_b16 a[188:189], v14 offset:53248
ds_read_b64_tr_b16 a[190:191], v14 offset:53760
v_mfma_f32_16x16x32_bf16 v[116:119], a[132:135], a[100:103], v[116:119]
buffer_load_dwordx4 v4, s[24:27], s64 offen offset:2048 sc1 lds
v_mfma_f32_16x16x32_bf16 v[124:127], a[140:143], a[100:103], v[124:127]
v_accvgpr_write_b32 a244, v16
v_add_u32 v16, 131072, v16
v_mfma_f32_16x16x32_bf16 v[124:127], a[136:139], a[96:99], v[124:127]
ds_read_b128 a[112:115], v4 offset:57344
v_add_u32 v21, s65, v16
v_mfma_f32_16x16x32_bf16 v[132:135], a[144:147], a[96:99], v[132:135]
v_cndmask_b32 v16, v16, v21, s[96:97]
v_accvgpr_write_b32 a248, v16
v_mfma_f32_16x16x32_bf16 v[132:135], a[148:151], a[100:103], v[132:135]
ds_read_b128 a[116:119], v4 offset:59392
v_cmp_lt_u32 s[96:97], 1, v3
v_mfma_f32_16x16x32_bf16 v[140:143], a[156:159], a[100:103], v[140:143]
v_add_u32 v21, 131072, v21
v_mfma_f32_16x16x32_bf16 v[140:143], a[152:155], a[96:99], v[140:143]
ds_read_b128 a[120:123], v4 offset:58368
v_cndmask_b32 v21, v21, v20, s[96:97]
v_mfma_f32_16x16x32_bf16 v[148:151], a[64:67], a[96:99], v[148:151]
v_accvgpr_write_b32 a252, v21
v_mfma_f32_16x16x32_bf16 v[148:151], a[68:71], a[100:103], v[148:151]
ds_read_b128 a[124:127], v4 offset:60416
v_mfma_f32_16x16x32_bf16 v[48:51], a[76:79], a[100:103], v[48:51]
s_waitcnt lgkmcnt(15)
v_mfma_f32_16x16x32_bf16 v[48:51], a[72:75], a[96:99], v[48:51]
buffer_load_dwordx4 v4, s[24:27], s64 offen offset:3072 sc1 lds
v_mfma_f32_16x16x32_bf16 v[156:159], a[72:75], a[104:107], v[156:159]
v_mfma_f32_16x16x32_bf16 v[156:159], a[76:79], a[108:111], v[156:159]
v_mfma_f32_16x16x32_bf16 v[164:167], a[68:71], a[108:111], v[164:167]
v_mfma_f32_16x16x32_bf16 v[164:167], a[64:67], a[104:107], v[164:167]
v_mfma_f32_16x16x32_bf16 v[172:175], a[152:155], a[104:107], v[172:175]
s_add_u32 s53, s87, 790528
v_mfma_f32_16x16x32_bf16 v[172:175], a[156:159], a[108:111], v[172:175]
buffer_store_dwordx4 a[16:19], v4, s[24:27], s53 offen offset:0 sc1
v_mfma_f32_16x16x32_bf16 v[56:59], a[148:151], a[108:111], v[56:59]
v_mfma_f32_16x16x32_bf16 v[56:59], a[144:147], a[104:107], v[56:59]
v_mfma_f32_16x16x32_bf16 v[180:183], a[136:139], a[104:107], v[180:183]
v_mfma_f32_16x16x32_bf16 v[180:183], a[140:143], a[108:111], v[180:183]
v_mfma_f32_16x16x32_bf16 v[188:191], a[132:135], a[108:111], v[188:191]
v_mfma_f32_16x16x32_bf16 v[188:191], a[128:131], a[104:107], v[188:191]
s_waitcnt lgkmcnt(0)
v_mfma_f32_16x16x32_bf16 v[196:199], a[160:163], a[80:83], v[196:199]
s_waitcnt vmcnt(17)
v_mfma_f32_16x16x32_bf16 v[196:199], a[164:167], a[84:87], v[196:199]
s_barrier
v_mfma_f32_16x16x32_bf16 v[64:67], a[172:175], a[84:87], v[64:67]
ds_read_b64_tr_b16 a[128:129], v11 offset:0
ds_read_b64_tr_b16 a[130:131], v11 offset:512
v_mfma_f32_16x16x32_bf16 v[64:67], a[168:171], a[80:83], v[64:67]
s_add_u32 m0, s70, 49152
s_add_u32 s64, s68, 16384
s_waitcnt vmcnt(6)
v_mfma_f32_16x16x32_bf16 v[204:207], a[176:179], a[80:83], v[204:207]
buffer_load_dwordx4 v4, s[24:27], s64 offen offset:0 sc1 lds
v_mfma_f32_16x16x32_bf16 v[204:207], a[180:183], a[84:87], v[204:207]
ds_read_b64_tr_b16 a[132:133], v11 offset:4096
ds_read_b64_tr_b16 a[134:135], v11 offset:4608
v_mfma_f32_16x16x32_bf16 v[212:215], a[188:191], a[84:87], v[212:215]
ds_read_b64_tr_b16 a[136:137], v12 offset:0
ds_read_b64_tr_b16 a[138:139], v12 offset:512
v_mfma_f32_16x16x32_bf16 v[212:215], a[184:187], a[80:83], v[212:215]
ds_read_b64_tr_b16 a[140:141], v12 offset:4096
ds_read_b64_tr_b16 a[142:143], v12 offset:4608
v_mfma_f32_16x16x32_bf16 v[72:75], a[112:115], a[80:83], v[72:75]
ds_read_b64_tr_b16 a[192:193], v23 offset:0
ds_read_b64_tr_b16 a[194:195], v23 offset:2048
v_mfma_f32_16x16x32_bf16 v[72:75], a[116:119], a[84:87], v[72:75]
ds_read_b64_tr_b16 a[144:145], v13 offset:0
ds_read_b64_tr_b16 a[146:147], v13 offset:512
v_mfma_f32_16x16x32_bf16 v[220:223], a[124:127], a[84:87], v[220:223]
ds_read_b64_tr_b16 a[196:197], v23 offset:32
ds_read_b64_tr_b16 a[198:199], v23 offset:2080
v_mfma_f32_16x16x32_bf16 v[220:223], a[120:123], a[80:83], v[220:223]
ds_read_b64_tr_b16 a[148:149], v13 offset:4096
ds_read_b64_tr_b16 a[150:151], v13 offset:4608
v_mfma_f32_16x16x32_bf16 v[252:255], a[120:123], a[88:91], v[252:255]
ds_read_b64_tr_b16 a[200:201], v23 offset:64
ds_read_b64_tr_b16 a[202:203], v23 offset:2112
v_mfma_f32_16x16x32_bf16 v[252:255], a[124:127], a[92:95], v[252:255]
ds_read_b64_tr_b16 a[152:153], v14 offset:0
ds_read_b64_tr_b16 a[154:155], v14 offset:512
v_mfma_f32_16x16x32_bf16 v[160:163], a[116:119], a[92:95], v[160:163]
buffer_load_dwordx4 v4, s[24:27], s64 offen offset:1024 sc1 lds
v_mfma_f32_16x16x32_bf16 v[160:163], a[112:115], a[88:91], v[160:163]
ds_read_b64_tr_b16 a[156:157], v14 offset:4096
ds_read_b64_tr_b16 a[158:159], v14 offset:4608
v_mfma_f32_16x16x32_bf16 v[228:231], a[184:187], a[88:91], v[228:231]
ds_read_b64_tr_b16 a[204:205], v23 offset:96
ds_read_b64_tr_b16 a[206:207], v23 offset:2144
v_mfma_f32_16x16x32_bf16 v[228:231], a[188:191], a[92:95], v[228:231]
ds_read_b64_tr_b16 a[208:209], v27 offset:4096
ds_read_b64_tr_b16 a[210:211], v27 offset:4608
v_mfma_f32_16x16x32_bf16 v[168:171], a[180:183], a[92:95], v[168:171]
ds_read_b128 a[64:67], v4 offset:8192
v_mfma_f32_16x16x32_bf16 v[168:171], a[176:179], a[88:91], v[168:171]
s_add_u32 s53, s87, 790528
ds_read_b64_tr_b16 a[212:213], v27 offset:5120
ds_read_b64_tr_b16 a[214:215], v27 offset:5632
v_mfma_f32_16x16x32_bf16 v[176:179], a[168:171], a[88:91], v[176:179]
ds_read_b128 a[80:83], v9 offset:0
v_readlane_b32 s81, v26, 0
v_mfma_f32_16x16x32_bf16 v[176:179], a[172:175], a[92:95], v[176:179]
buffer_store_dwordx4 a[24:27], v4, s[24:27], s53 offen offset:1024 sc1
v_mfma_f32_16x16x32_bf16 v[80:83], a[164:167], a[92:95], v[80:83]
ds_read_b128 a[68:71], v4 offset:10240
v_readlane_b32 s82, v26, 1
v_mfma_f32_16x16x32_bf16 v[80:83], a[160:163], a[88:91], v[80:83]
v_readlane_b32 s71, v26, 2
v_readlane_b32 s72, v26, 3
v_mfma_f32_16x16x32_bf16 v[184:187], a[160:163], a[96:99], v[184:187]
ds_read_b128 a[84:87], v10 offset:0
v_readlane_b32 s74, v26, 4
v_mfma_f32_16x16x32_bf16 v[184:187], a[164:167], a[100:103], v[184:187]
buffer_load_dwordx4 v4, s[24:27], s64 offen offset:2048 sc1 lds
v_mfma_f32_16x16x32_bf16 v[248:251], a[172:175], a[100:103], v[248:251]
v_readlane_b32 s75, v26, 5
v_mfma_f32_16x16x32_bf16 v[248:251], a[168:171], a[96:99], v[248:251]
ds_read_b128 a[72:75], v4 offset:9216
v_mfma_f32_16x16x32_bf16 v[240:243], a[176:179], a[96:99], v[240:243]
v_mfma_f32_16x16x32_bf16 v[240:243], a[180:183], a[100:103], v[240:243]
ds_read_b128 a[88:91], v9 offset:2048
v_mfma_f32_16x16x32_bf16 v[232:235], a[188:191], a[100:103], v[232:235]
v_mfma_f32_16x16x32_bf16 v[232:235], a[184:187], a[96:99], v[232:235]
ds_read_b128 a[76:79], v4 offset:11264
v_mfma_f32_16x16x32_bf16 v[236:239], a[112:115], a[96:99], v[236:239]
v_mfma_f32_16x16x32_bf16 v[236:239], a[116:119], a[100:103], v[236:239]
ds_read_b128 a[92:95], v10 offset:2048
v_mfma_f32_16x16x32_bf16 v[224:227], a[124:127], a[100:103], v[224:227]
v_mfma_f32_16x16x32_bf16 v[224:227], a[120:123], a[96:99], v[224:227]
buffer_load_dwordx4 v4, s[24:27], s64 offen offset:3072 sc1 lds
v_mfma_f32_16x16x32_bf16 v[208:211], a[120:123], a[104:107], v[208:211]
v_mfma_f32_16x16x32_bf16 v[208:211], a[124:127], a[108:111], v[208:211]
v_mfma_f32_16x16x32_bf16 v[216:219], a[116:119], a[108:111], v[216:219]
v_mfma_f32_16x16x32_bf16 v[216:219], a[112:115], a[104:107], v[216:219]
v_mfma_f32_16x16x32_bf16 v[244:247], a[184:187], a[104:107], v[244:247]
v_mfma_f32_16x16x32_bf16 v[244:247], a[188:191], a[108:111], v[244:247]
v_mfma_f32_16x16x32_bf16 v[192:195], a[180:183], a[108:111], v[192:195]
v_mfma_f32_16x16x32_bf16 v[192:195], a[176:179], a[104:107], v[192:195]
v_mfma_f32_16x16x32_bf16 v[200:203], a[168:171], a[104:107], v[200:203]
v_mfma_f32_16x16x32_bf16 v[200:203], a[172:175], a[108:111], v[200:203]
v_mfma_f32_16x16x32_bf16 v[88:91], a[164:167], a[108:111], v[88:91]
v_mfma_f32_16x16x32_bf16 v[88:91], a[160:163], a[104:107], v[88:91]
s_waitcnt lgkmcnt(0)
v_mfma_f32_16x16x32_bf16 v[36:39], a[128:131], a[80:83], v[36:39]
s_waitcnt vmcnt(18)
v_mfma_f32_16x16x32_bf16 v[36:39], a[132:135], a[84:87], v[36:39]
s_barrier
v_mfma_f32_16x16x32_bf16 v[44:47], a[140:143], a[84:87], v[44:47]
ds_read_b128 a[96:99], v9 offset:4096
v_mfma_f32_16x16x32_bf16 v[44:47], a[136:139], a[80:83], v[44:47]
s_add_u32 m0, s70, 65536
s_add_u32 s64, s68, 32768
ds_read_b128 a[100:103], v10 offset:4096
v_mfma_f32_16x16x32_bf16 v[32:35], a[144:147], a[80:83], v[32:35]
buffer_load_dwordx4 v4, s[24:27], s64 offen offset:0 sc1 lds
v_mfma_f32_16x16x32_bf16 v[32:35], a[148:151], a[84:87], v[32:35]
ds_read_b128 a[104:107], v9 offset:6144
v_mfma_f32_16x16x32_bf16 v[52:55], a[156:159], a[84:87], v[52:55]
ds_read_b64_tr_b16 a[160:161], v11 offset:16384
ds_read_b64_tr_b16 a[162:163], v11 offset:16896
v_mfma_f32_16x16x32_bf16 v[52:55], a[152:155], a[80:83], v[52:55]
buffer_store_dwordx4 a[192:195], v4, s[24:27], s81 offen sc1
v_mfma_f32_16x16x32_bf16 v[60:63], a[64:67], a[80:83], v[60:63]
v_mfma_f32_16x16x32_bf16 v[60:63], a[68:71], a[84:87], v[60:63]
ds_read_b128 a[108:111], v10 offset:6144
v_mfma_f32_16x16x32_bf16 v[68:71], a[76:79], a[84:87], v[68:71]
v_cvt_pk_bf16_f32 v36, v36, v37
v_cvt_pk_bf16_f32 v37, v38, v39
v_mfma_f32_16x16x32_bf16 v[68:71], a[72:75], a[80:83], v[68:71]
ds_read_b64_tr_b16 a[164:165], v11 offset:20480
ds_read_b64_tr_b16 a[166:167], v11 offset:20992
v_mfma_f32_16x16x32_bf16 v[76:79], a[72:75], a[88:91], v[76:79]
buffer_store_dwordx4 a[196:199], v4, s[24:27], s82 offen sc1
v_mfma_f32_16x16x32_bf16 v[76:79], a[76:79], a[92:95], v[76:79]
ds_read_b64_tr_b16 a[168:169], v12 offset:16384
ds_read_b64_tr_b16 a[170:171], v12 offset:16896
v_mfma_f32_16x16x32_bf16 v[84:87], a[68:71], a[92:95], v[84:87]
buffer_load_dwordx4 v4, s[24:27], s64 offen offset:1024 sc1 lds
v_mfma_f32_16x16x32_bf16 v[84:87], a[64:67], a[88:91], v[84:87]
ds_read_b64_tr_b16 a[172:173], v12 offset:20480
ds_read_b64_tr_b16 a[174:175], v12 offset:20992
v_mfma_f32_16x16x32_bf16 v[92:95], a[152:155], a[88:91], v[92:95]
v_cvt_pk_bf16_f32 v38, v44, v45
v_cvt_pk_bf16_f32 v39, v46, v47
v_mfma_f32_16x16x32_bf16 v[92:95], a[156:159], a[92:95], v[92:95]
buffer_store_dwordx4 a[200:203], v4, s[24:27], s71 offen sc1
v_mfma_f32_16x16x32_bf16 v[40:43], a[148:151], a[92:95], v[40:43]
ds_read_b64_tr_b16 a[176:177], v13 offset:16384
ds_read_b64_tr_b16 a[178:179], v13 offset:16896
v_mfma_f32_16x16x32_bf16 v[40:43], a[144:147], a[88:91], v[40:43]
v_accvgpr_write_b32 a32, v36
v_accvgpr_write_b32 a33, v37
v_mfma_f32_16x16x32_bf16 v[100:103], a[136:139], a[88:91], v[100:103]
ds_read_b64_tr_b16 a[180:181], v13 offset:20480
ds_read_b64_tr_b16 a[182:183], v13 offset:20992
v_mfma_f32_16x16x32_bf16 v[100:103], a[140:143], a[92:95], v[100:103]
v_accvgpr_write_b32 a34, v38
v_accvgpr_write_b32 a35, v39
v_mfma_f32_16x16x32_bf16 v[108:111], a[132:135], a[92:95], v[108:111]
ds_read_b64_tr_b16 a[184:185], v14 offset:16384
ds_read_b64_tr_b16 a[186:187], v14 offset:16896
v_mfma_f32_16x16x32_bf16 v[108:111], a[128:131], a[88:91], v[108:111]
s_waitcnt lgkmcnt(15)
v_cvt_pk_bf16_f32 v32, v32, v33
v_cvt_pk_bf16_f32 v33, v34, v35
v_mfma_f32_16x16x32_bf16 v[116:119], a[128:131], a[96:99], v[116:119]
ds_read_b64_tr_b16 a[188:189], v14 offset:20480
ds_read_b64_tr_b16 a[190:191], v14 offset:20992
v_mfma_f32_16x16x32_bf16 v[116:119], a[132:135], a[100:103], v[116:119]
buffer_load_dwordx4 v4, s[24:27], s64 offen offset:2048 sc1 lds
v_mfma_f32_16x16x32_bf16 v[124:127], a[140:143], a[100:103], v[124:127]
buffer_store_dwordx4 a[204:207], v4, s[24:27], s72 offen sc1
v_mfma_f32_16x16x32_bf16 v[124:127], a[136:139], a[96:99], v[124:127]
ds_read_b128 a[112:115], v4 offset:24576
v_cvt_pk_bf16_f32 v34, v52, v53
v_mfma_f32_16x16x32_bf16 v[132:135], a[144:147], a[96:99], v[132:135]
v_cvt_pk_bf16_f32 v35, v54, v55
v_accvgpr_write_b32 a36, v32
v_mfma_f32_16x16x32_bf16 v[132:135], a[148:151], a[100:103], v[132:135]
ds_read_b128 a[116:119], v4 offset:26624
v_accvgpr_write_b32 a37, v33
v_mfma_f32_16x16x32_bf16 v[140:143], a[156:159], a[100:103], v[140:143]
v_accvgpr_write_b32 a38, v34
v_accvgpr_write_b32 a39, v35
v_mfma_f32_16x16x32_bf16 v[140:143], a[152:155], a[96:99], v[140:143]
ds_read_b128 a[120:123], v4 offset:25600
v_cvt_pk_bf16_f32 v40, v40, v41
v_mfma_f32_16x16x32_bf16 v[148:151], a[64:67], a[96:99], v[148:151]
buffer_store_dwordx4 a[208:211], v4, s[24:27], s74 offen sc1
v_mfma_f32_16x16x32_bf16 v[148:151], a[68:71], a[100:103], v[148:151]
ds_read_b128 a[124:127], v4 offset:27648
v_cvt_pk_bf16_f32 v41, v42, v43
v_mfma_f32_16x16x32_bf16 v[48:51], a[76:79], a[100:103], v[48:51]
s_waitcnt lgkmcnt(15)
v_cvt_pk_bf16_f32 v42, v92, v93
v_cvt_pk_bf16_f32 v43, v94, v95
v_mfma_f32_16x16x32_bf16 v[48:51], a[72:75], a[96:99], v[48:51]
buffer_load_dwordx4 v4, s[24:27], s64 offen offset:3072 sc1 lds
v_mfma_f32_16x16x32_bf16 v[156:159], a[72:75], a[104:107], v[156:159]
v_accvgpr_write_b32 a40, v40
v_accvgpr_write_b32 a41, v41
v_mfma_f32_16x16x32_bf16 v[156:159], a[76:79], a[108:111], v[156:159]
buffer_store_dwordx4 a[212:215], v4, s[24:27], s75 offen sc1
v_mfma_f32_16x16x32_bf16 v[164:167], a[68:71], a[108:111], v[164:167]
v_accvgpr_write_b32 a42, v42
v_accvgpr_write_b32 a43, v43
v_mfma_f32_16x16x32_bf16 v[164:167], a[64:67], a[104:107], v[164:167]
v_cvt_pk_bf16_f32 v108, v108, v109
v_cvt_pk_bf16_f32 v109, v110, v111
v_mfma_f32_16x16x32_bf16 v[172:175], a[152:155], a[104:107], v[172:175]
v_cvt_pk_bf16_f32 v110, v100, v101
v_cvt_pk_bf16_f32 v111, v102, v103
v_mfma_f32_16x16x32_bf16 v[172:175], a[156:159], a[108:111], v[172:175]
v_accvgpr_write_b32 a44, v108
v_accvgpr_write_b32 a45, v109
v_mfma_f32_16x16x32_bf16 v[56:59], a[148:151], a[108:111], v[56:59]
v_accvgpr_write_b32 a46, v110
v_accvgpr_write_b32 a47, v111
v_mfma_f32_16x16x32_bf16 v[56:59], a[144:147], a[104:107], v[56:59]
v_cvt_pk_bf16_f32 v116, v116, v117
v_cvt_pk_bf16_f32 v117, v118, v119
v_mfma_f32_16x16x32_bf16 v[180:183], a[136:139], a[104:107], v[180:183]
v_cvt_pk_bf16_f32 v118, v124, v125
v_cvt_pk_bf16_f32 v119, v126, v127
v_mfma_f32_16x16x32_bf16 v[180:183], a[140:143], a[108:111], v[180:183]
v_accvgpr_write_b32 a48, v116
v_accvgpr_write_b32 a49, v117
v_mfma_f32_16x16x32_bf16 v[188:191], a[132:135], a[108:111], v[188:191]
v_accvgpr_write_b32 a50, v118
v_accvgpr_write_b32 a51, v119
v_mfma_f32_16x16x32_bf16 v[188:191], a[128:131], a[104:107], v[188:191]
s_waitcnt lgkmcnt(0)
v_cvt_pk_bf16_f32 v132, v132, v133
v_cvt_pk_bf16_f32 v133, v134, v135
v_mfma_f32_16x16x32_bf16 v[196:199], a[160:163], a[80:83], v[196:199]
s_waitcnt vmcnt(16)
v_cvt_pk_bf16_f32 v134, v140, v141
v_cvt_pk_bf16_f32 v135, v142, v143
v_mfma_f32_16x16x32_bf16 v[196:199], a[164:167], a[84:87], v[196:199]
s_barrier
v_mfma_f32_16x16x32_bf16 v[64:67], a[172:175], a[84:87], v[64:67]
ds_read_b128 a[192:195], v4 offset:32768
v_accvgpr_write_b32 a52, v132
v_mfma_f32_16x16x32_bf16 v[64:67], a[168:171], a[80:83], v[64:67]
s_add_u32 m0, s70, 81920
s_add_u32 s64, s68, 49152
v_accvgpr_write_b32 a53, v133
v_mfma_f32_16x16x32_bf16 v[204:207], a[176:179], a[80:83], v[204:207]
buffer_load_dwordx4 v4, s[24:27], s64 offen offset:0 sc1 lds
v_mfma_f32_16x16x32_bf16 v[204:207], a[180:183], a[84:87], v[204:207]
ds_read_b128 a[196:199], v4 offset:33792
v_accvgpr_write_b32 a54, v134
v_mfma_f32_16x16x32_bf16 v[212:215], a[188:191], a[84:87], v[212:215]
v_accvgpr_write_b32 a55, v135
v_cvt_pk_bf16_f32 v56, v56, v57
v_mfma_f32_16x16x32_bf16 v[212:215], a[184:187], a[80:83], v[212:215]
ds_read_b128 a[200:203], v4 offset:34816
v_cvt_pk_bf16_f32 v57, v58, v59
v_mfma_f32_16x16x32_bf16 v[80:83], a[160:163], a[88:91], v[80:83]
v_cvt_pk_bf16_f32 v58, v172, v173
v_cvt_pk_bf16_f32 v59, v174, v175
v_mfma_f32_16x16x32_bf16 v[80:83], a[164:167], a[92:95], v[80:83]
ds_read_b128 a[204:207], v4 offset:35840
v_accvgpr_write_b32 a56, v56
v_mfma_f32_16x16x32_bf16 v[176:179], a[172:175], a[92:95], v[176:179]
v_accvgpr_write_b32 a57, v57
v_accvgpr_write_b32 a58, v58
v_mfma_f32_16x16x32_bf16 v[176:179], a[168:171], a[88:91], v[176:179]
ds_read_b128 a[208:211], v4 offset:36864
v_accvgpr_write_b32 a59, v59
v_mfma_f32_16x16x32_bf16 v[168:171], a[176:179], a[88:91], v[168:171]
v_cvt_pk_bf16_f32 v188, v188, v189
v_cvt_pk_bf16_f32 v189, v190, v191
v_mfma_f32_16x16x32_bf16 v[168:171], a[180:183], a[92:95], v[168:171]
ds_read_b128 a[212:215], v4 offset:37888
v_cvt_pk_bf16_f32 v190, v180, v181
v_mfma_f32_16x16x32_bf16 v[228:231], a[188:191], a[92:95], v[228:231]
buffer_load_dwordx4 v4, s[24:27], s64 offen offset:1024 sc1 lds
v_mfma_f32_16x16x32_bf16 v[228:231], a[184:187], a[88:91], v[228:231]
ds_read_b128 a[216:219], v4 offset:38912
v_cvt_pk_bf16_f32 v191, v182, v183
v_mfma_f32_16x16x32_bf16 v[184:187], a[160:163], a[96:99], v[184:187]
v_accvgpr_write_b32 a60, v188
v_accvgpr_write_b32 a61, v189
v_mfma_f32_16x16x32_bf16 v[184:187], a[164:167], a[100:103], v[184:187]
ds_read_b128 a[220:223], v4 offset:39936
v_accvgpr_write_b32 a62, v190
v_mfma_f32_16x16x32_bf16 v[248:251], a[172:175], a[100:103], v[248:251]
v_accvgpr_write_b32 a63, v191
v_cvt_pk_bf16_f32 v196, v196, v197
v_mfma_f32_16x16x32_bf16 v[248:251], a[168:171], a[96:99], v[248:251]
v_cvt_pk_bf16_f32 v197, v198, v199
v_cvt_pk_bf16_f32 v198, v64, v65
v_mfma_f32_16x16x32_bf16 v[240:243], a[176:179], a[96:99], v[240:243]
v_cvt_pk_bf16_f32 v199, v66, v67
v_accvgpr_write_b32 a28, v196
v_mfma_f32_16x16x32_bf16 v[240:243], a[180:183], a[100:103], v[240:243]
v_accvgpr_write_b32 a29, v197
v_accvgpr_write_b32 a30, v198
v_mfma_f32_16x16x32_bf16 v[232:235], a[188:191], a[100:103], v[232:235]
v_accvgpr_write_b32 a31, v199
v_cvt_pk_bf16_f32 v204, v204, v205
v_mfma_f32_16x16x32_bf16 v[232:235], a[184:187], a[96:99], v[232:235]
v_cvt_pk_bf16_f32 v205, v206, v207
v_cvt_pk_bf16_f32 v206, v212, v213
v_mfma_f32_16x16x32_bf16 v[88:91], a[160:163], a[104:107], v[88:91]
v_cvt_pk_bf16_f32 v207, v214, v215
v_accvgpr_write_b32 a20, v204
v_mfma_f32_16x16x32_bf16 v[88:91], a[164:167], a[108:111], v[88:91]
buffer_load_dwordx4 v4, s[24:27], s64 offen offset:2048 sc1 lds
v_mfma_f32_16x16x32_bf16 v[200:203], a[172:175], a[108:111], v[200:203]
v_accvgpr_write_b32 a21, v205
v_accvgpr_write_b32 a22, v206
v_mfma_f32_16x16x32_bf16 v[200:203], a[168:171], a[104:107], v[200:203]
v_accvgpr_write_b32 a23, v207
v_cvt_pk_bf16_f32 v80, v80, v81
v_mfma_f32_16x16x32_bf16 v[192:195], a[176:179], a[104:107], v[192:195]
v_cvt_pk_bf16_f32 v81, v82, v83
v_cvt_pk_bf16_f32 v82, v176, v177
v_mfma_f32_16x16x32_bf16 v[192:195], a[180:183], a[108:111], v[192:195]
v_cvt_pk_bf16_f32 v83, v178, v179
v_accvgpr_write_b32 a12, v80
v_mfma_f32_16x16x32_bf16 v[244:247], a[188:191], a[108:111], v[244:247]
v_accvgpr_write_b32 a13, v81
v_accvgpr_write_b32 a14, v82
v_mfma_f32_16x16x32_bf16 v[244:247], a[184:187], a[104:107], v[244:247]
v_accvgpr_write_b32 a15, v83
v_cvt_pk_bf16_f32 v168, v168, v169
v_mfma_f32_16x16x32_bf16 v[72:75], a[112:115], a[80:83], v[72:75]
v_cvt_pk_bf16_f32 v169, v170, v171
v_cvt_pk_bf16_f32 v170, v228, v229
v_mfma_f32_16x16x32_bf16 v[72:75], a[116:119], a[84:87], v[72:75]
v_cvt_pk_bf16_f32 v171, v230, v231
v_accvgpr_write_b32 a4, v168
v_mfma_f32_16x16x32_bf16 v[220:223], a[124:127], a[84:87], v[220:223]
v_accvgpr_write_b32 a5, v169
v_accvgpr_write_b32 a6, v170
v_mfma_f32_16x16x32_bf16 v[220:223], a[120:123], a[80:83], v[220:223]
buffer_load_dwordx4 v4, s[24:27], s64 offen offset:3072 sc1 lds
v_mfma_f32_16x16x32_bf16 v[160:163], a[112:115], a[88:91], v[160:163]
v_accvgpr_write_b32 a7, v171
v_cvt_pk_bf16_f32 v184, v184, v185
v_mfma_f32_16x16x32_bf16 v[160:163], a[116:119], a[92:95], v[160:163]
v_cvt_pk_bf16_f32 v185, v186, v187
v_cvt_pk_bf16_f32 v186, v248, v249
v_mfma_f32_16x16x32_bf16 v[252:255], a[124:127], a[92:95], v[252:255]
v_cvt_pk_bf16_f32 v187, v250, v251
v_accvgpr_write_b32 a0, v184
v_mfma_f32_16x16x32_bf16 v[252:255], a[120:123], a[88:91], v[252:255]
v_accvgpr_write_b32 a1, v185
v_accvgpr_write_b32 a2, v186
v_mfma_f32_16x16x32_bf16 v[236:239], a[112:115], a[96:99], v[236:239]
v_accvgpr_write_b32 a3, v187
v_cvt_pk_bf16_f32 v240, v240, v241
v_mfma_f32_16x16x32_bf16 v[236:239], a[116:119], a[100:103], v[236:239]
v_cvt_pk_bf16_f32 v241, v242, v243
v_cvt_pk_bf16_f32 v242, v232, v233
v_mfma_f32_16x16x32_bf16 v[224:227], a[124:127], a[100:103], v[224:227]
v_cvt_pk_bf16_f32 v243, v234, v235
v_accvgpr_write_b32 a8, v240
v_mfma_f32_16x16x32_bf16 v[224:227], a[120:123], a[96:99], v[224:227]
v_accvgpr_write_b32 a9, v241
v_accvgpr_write_b32 a10, v242
v_mfma_f32_16x16x32_bf16 v[216:219], a[112:115], a[104:107], v[216:219]
v_accvgpr_write_b32 a11, v243
v_cvt_pk_bf16_f32 v88, v88, v89
v_mfma_f32_16x16x32_bf16 v[216:219], a[116:119], a[108:111], v[216:219]
v_cvt_pk_bf16_f32 v89, v90, v91
v_cvt_pk_bf16_f32 v90, v200, v201
v_mfma_f32_16x16x32_bf16 v[208:211], a[124:127], a[108:111], v[208:211]
v_cvt_pk_bf16_f32 v91, v202, v203
v_accvgpr_write_b32 a16, v88
v_mfma_f32_16x16x32_bf16 v[208:211], a[120:123], a[104:107], v[208:211]
s_waitcnt lgkmcnt(0)
v_accvgpr_write_b32 a17, v89
v_accvgpr_write_b32 a18, v90
v_mfma_f32_16x16x32_bf16 v[44:47], a[192:195], a[32:35], v[96:99]
v_accvgpr_write_b32 a19, v91
v_cvt_pk_bf16_f32 v192, v192, v193
v_mfma_f32_16x16x32_bf16 v[44:47], a[196:199], a[36:39], v[44:47]
v_cvt_pk_bf16_f32 v193, v194, v195
v_cvt_pk_bf16_f32 v194, v244, v245
v_mfma_f32_16x16x32_bf16 v[44:47], a[200:203], a[28:31], v[44:47]
v_cvt_pk_bf16_f32 v195, v246, v247
v_accvgpr_write_b32 a24, v192
v_mfma_f32_16x16x32_bf16 v[44:47], a[204:207], a[20:23], v[44:47]
v_accvgpr_write_b32 a25, v193
v_accvgpr_write_b32 a26, v194
v_mfma_f32_16x16x32_bf16 v[52:55], a[192:195], a[44:47], v[104:107]
ds_bpermute_b32 v8, v17, v63
v_accvgpr_write_b32 a27, v195
v_mfma_f32_16x16x32_bf16 v[52:55], a[196:199], a[40:43], v[52:55]
v_cvt_pk_bf16_f32 v60, v60, v61
v_cvt_pk_bf16_f32 v61, v62, v63
v_mfma_f32_16x16x32_bf16 v[52:55], a[200:203], a[12:15], v[52:55]
v_cvt_pk_bf16_f32 v62, v68, v69
v_cvt_pk_bf16_f32 v63, v70, v71
v_mfma_f32_16x16x32_bf16 v[52:55], a[204:207], a[4:7], v[52:55]
v_accvgpr_write_b32 a128, v60
v_accvgpr_write_b32 a129, v61
v_mfma_f32_16x16x32_bf16 v[64:67], a[208:211], a[32:35], v[112:115]
v_accvgpr_write_b32 a130, v62
v_accvgpr_write_b32 a131, v63
v_mfma_f32_16x16x32_bf16 v[64:67], a[212:215], a[36:39], v[64:67]
ds_bpermute_b32 v9, v17, v87
v_cvt_pk_bf16_f32 v84, v84, v85
v_mfma_f32_16x16x32_bf16 v[64:67], a[216:219], a[28:31], v[64:67]
v_cvt_pk_bf16_f32 v85, v86, v87
v_cvt_pk_bf16_f32 v86, v76, v77
v_mfma_f32_16x16x32_bf16 v[64:67], a[220:223], a[20:23], v[64:67]
v_cvt_pk_bf16_f32 v87, v78, v79
v_mfma_f32_16x16x32_bf16 v[212:215], a[208:211], a[44:47], v[120:123]
buffer_store_dwordx4 v[84:87], v18, s[24:27], s54 offen offset:256 sc1
v_mfma_f32_16x16x32_bf16 v[212:215], a[212:215], a[40:43], v[212:215]
v_accvgpr_write_b32 a136, v84
v_accvgpr_write_b32 a137, v85
v_mfma_f32_16x16x32_bf16 v[212:215], a[216:219], a[12:15], v[212:215]
v_accvgpr_write_b32 a138, v86
v_accvgpr_write_b32 a139, v87
v_mfma_f32_16x16x32_bf16 v[212:215], a[220:223], a[4:7], v[212:215]
s_waitcnt vmcnt(15)
ds_bpermute_b32 v10, v17, v151
v_cvt_pk_bf16_f32 v148, v148, v149
v_mfma_f32_16x16x32_bf16 v[100:103], a[192:195], a[48:51], v[128:131]
s_barrier
v_cvt_pk_bf16_f32 v149, v150, v151
v_cvt_pk_bf16_f32 v150, v48, v49
v_mfma_f32_16x16x32_bf16 v[100:103], a[196:199], a[52:55], v[100:103]
v_cvt_pk_bf16_f32 v151, v50, v51
v_accvgpr_write_b32 a144, v148
v_mfma_f32_16x16x32_bf16 v[100:103], a[200:203], a[0:3], v[100:103]
ds_bpermute_b32 v11, v17, v167
v_accvgpr_write_b32 a145, v149
v_mfma_f32_16x16x32_bf16 v[100:103], a[204:207], a[8:11], v[100:103]
v_cvt_pk_bf16_f32 v164, v164, v165
v_cvt_pk_bf16_f32 v165, v166, v167
v_mfma_f32_16x16x32_bf16 v[92:95], a[192:195], a[60:63], v[136:139]
v_cvt_pk_bf16_f32 v166, v156, v157
v_cvt_pk_bf16_f32 v167, v158, v159
v_mfma_f32_16x16x32_bf16 v[92:95], a[196:199], a[56:59], v[92:95]
buffer_store_dwordx4 v[164:167], v18, s[24:27], s55 offen offset:256 sc1
v_mfma_f32_16x16x32_bf16 v[92:95], a[200:203], a[16:19], v[92:95]
v_cvt_pk_bf16_f32 v72, v72, v73
v_cvt_pk_bf16_f32 v73, v74, v75
v_mfma_f32_16x16x32_bf16 v[92:95], a[204:207], a[24:27], v[92:95]
L_PAD8:
s_cbranch_execz L_PAD12
v_cvt_pk_bf16_f32 v74, v220, v221
v_cvt_pk_bf16_f32 v75, v222, v223
v_mfma_f32_16x16x32_bf16 v[176:179], a[208:211], a[48:51], v[144:147]
v_cvt_pk_bf16_f32 v160, v160, v161
v_cvt_pk_bf16_f32 v161, v162, v163
v_mfma_f32_16x16x32_bf16 v[176:179], a[212:215], a[52:55], v[176:179]
v_cvt_pk_bf16_f32 v162, v252, v253
v_cvt_pk_bf16_f32 v163, v254, v255
v_mfma_f32_16x16x32_bf16 v[176:179], a[216:219], a[0:3], v[176:179]
buffer_store_dwordx4 v[160:163], v19, s[24:27], s54 offen offset:256 sc1
v_mfma_f32_16x16x32_bf16 v[176:179], a[220:223], a[8:11], v[176:179]
v_cvt_pk_bf16_f32 v236, v236, v237
v_cvt_pk_bf16_f32 v237, v238, v239
v_mfma_f32_16x16x32_bf16 v[228:231], a[208:211], a[60:63], v[152:155]
v_cvt_pk_bf16_f32 v238, v224, v225
v_cvt_pk_bf16_f32 v239, v226, v227
v_mfma_f32_16x16x32_bf16 v[228:231], a[212:215], a[56:59], v[228:231]
v_cvt_pk_bf16_f32 v216, v216, v217
v_cvt_pk_bf16_f32 v217, v218, v219
v_mfma_f32_16x16x32_bf16 v[228:231], a[216:219], a[16:19], v[228:231]
v_cvt_pk_bf16_f32 v218, v208, v209
v_cvt_pk_bf16_f32 v219, v210, v211
v_mfma_f32_16x16x32_bf16 v[228:231], a[220:223], a[24:27], v[228:231]
buffer_store_dwordx4 v[216:219], v19, s[24:27], s55 offen offset:256 sc1
ds_read_b128 a[64:67], v4 offset:57344
ds_read_b128 a[68:71], v4 offset:58368
ds_read_b128 a[72:75], v4 offset:59392
ds_read_b128 a[76:79], v4 offset:60416
ds_read_b128 a[80:83], v4 offset:61440
ds_read_b128 a[84:87], v4 offset:62464
ds_read_b128 a[88:91], v4 offset:63488
ds_read_b128 a[92:95], v4 offset:64512
s_add_u32 m0, s70, 98304
s_add_u32 s64, s68, 65536
buffer_load_dwordx4 v4, s[24:27], s64 offen offset:0 sc1 lds
v_max3_f32 v24, v44, v45, v46
v_max3_f32 v25, v47, v64, v65
v_max3_f32 v26, v52, v53, v54
v_max3_f32 v27, v55, v212, v213
v_max3_f32 v24, v24, v66, v67
v_max_f32 v24, v24, v25
buffer_load_dwordx4 v4, s[24:27], s64 offen offset:1024 sc1 lds
v_max3_f32 v26, v26, v214, v215
v_max_f32 v26, v26, v27
v_mov_b32 v25, v24
v_mov_b32 v27, v26
s_nop 1
v_permlane32_swap_b32 v25, v24
buffer_load_dwordx4 v4, s[24:27], s64 offen offset:2048 sc1 lds
v_permlane32_swap_b32 v27, v26
s_nop 0
v_max_f32 v24, v24, v25
v_max_f32 v26, v26, v27
v_mov_b32 v25, v24
v_mov_b32 v27, v26
buffer_load_dwordx4 v4, s[24:27], s64 offen offset:3072 sc1 lds
s_nop 1
v_permlane16_swap_b32 v25, v24
v_permlane16_swap_b32 v27, v26
s_nop 0
v_max_f32 v24, v24, v25
v_max_f32 v26, v26, v27
s_add_u32 m0, s70, 114688
s_add_u32 s64, s68, 81920
buffer_load_dwordx4 v4, s[24:27], s64 offen offset:0 sc1 lds
v_pk_add_f32 v[44:45], v[44:45], v[24:25] op_sel_hi:[1,0] neg_lo:[0,1] neg_hi:[0,1]
v_pk_add_f32 v[46:47], v[46:47], v[24:25] op_sel_hi:[1,0] neg_lo:[0,1] neg_hi:[0,1]
v_pk_add_f32 v[52:53], v[52:53], v[26:27] op_sel_hi:[1,0] neg_lo:[0,1] neg_hi:[0,1]
v_pk_add_f32 v[54:55], v[54:55], v[26:27] op_sel_hi:[1,0] neg_lo:[0,1] neg_hi:[0,1]
v_pk_add_f32 v[64:65], v[64:65], v[24:25] op_sel_hi:[1,0] neg_lo:[0,1] neg_hi:[0,1]
v_pk_add_f32 v[66:67], v[66:67], v[24:25] op_sel_hi:[1,0] neg_lo:[0,1] neg_hi:[0,1]
buffer_load_dwordx4 v4, s[24:27], s64 offen offset:1024 sc1 lds
v_pk_add_f32 v[212:213], v[212:213], v[26:27] op_sel_hi:[1,0] neg_lo:[0,1] neg_hi:[0,1]
v_pk_add_f32 v[214:215], v[214:215], v[26:27] op_sel_hi:[1,0] neg_lo:[0,1] neg_hi:[0,1]
v_pk_add_f32 v[96:97], v[96:97], v[24:25] op_sel_hi:[1,0] neg_lo:[0,1] neg_hi:[0,1]
v_pk_add_f32 v[98:99], v[98:99], v[24:25] op_sel_hi:[1,0] neg_lo:[0,1] neg_hi:[0,1]
v_pk_add_f32 v[104:105], v[104:105], v[26:27] op_sel_hi:[1,0] neg_lo:[0,1] neg_hi:[0,1]
v_pk_add_f32 v[106:107], v[106:107], v[26:27] op_sel_hi:[1,0] neg_lo:[0,1] neg_hi:[0,1]
buffer_load_dwordx4 v4, s[24:27], s64 offen offset:2048 sc1 lds
v_pk_add_f32 v[112:113], v[112:113], v[24:25] op_sel_hi:[1,0] neg_lo:[0,1] neg_hi:[0,1]
v_pk_add_f32 v[114:115], v[114:115], v[24:25] op_sel_hi:[1,0] neg_lo:[0,1] neg_hi:[0,1]
v_pk_add_f32 v[120:121], v[120:121], v[26:27] op_sel_hi:[1,0] neg_lo:[0,1] neg_hi:[0,1]
v_pk_add_f32 v[122:123], v[122:123], v[26:27] op_sel_hi:[1,0] neg_lo:[0,1] neg_hi:[0,1]
v_exp_f32 v44, v44
v_exp_f32 v45, v45
buffer_load_dwordx4 v4, s[24:27], s64 offen offset:3072 sc1 lds
v_exp_f32 v46, v46
v_exp_f32 v47, v47
v_cvt_pk_bf16_f32 v124, v44, v45
v_exp_f32 v52, v52
v_exp_f32 v53, v53
v_cvt_pk_bf16_f32 v125, v46, v47
s_add_u32 m0, s70, 131072
s_add_u32 s64, s68, 98304
s_cmp_ge_u32 s3, 1
s_cselect_b32 s64, s64, 2147418112
buffer_load_dwordx4 v4, s[24:27], s64 offen offset:0 sc1 lds
v_exp_f32 v54, v54
v_exp_f32 v55, v55
v_cvt_pk_bf16_f32 v140, v52, v53
v_exp_f32 v64, v64
v_exp_f32 v65, v65
v_cvt_pk_bf16_f32 v141, v54, v55
buffer_load_dwordx4 v4, s[24:27], s64 offen offset:1024 sc1 lds
v_exp_f32 v66, v66
v_exp_f32 v67, v67
v_cvt_pk_bf16_f32 v126, v64, v65
v_exp_f32 v212, v212
v_exp_f32 v213, v213
v_cvt_pk_bf16_f32 v127, v66, v67
buffer_load_dwordx4 v4, s[24:27], s64 offen offset:2048 sc1 lds
v_exp_f32 v214, v214
v_exp_f32 v215, v215
v_cvt_pk_bf16_f32 v142, v212, v213
v_max3_f32 v24, v100, v101, v102
v_cvt_pk_bf16_f32 v143, v214, v215
v_max3_f32 v25, v103, v176, v177
buffer_load_dwordx4 v4, s[24:27], s64 offen offset:3072 sc1 lds
v_max3_f32 v26, v92, v93, v94
v_max3_f32 v27, v95, v228, v229
v_max3_f32 v24, v24, v178, v179
v_max_f32 v24, v24, v25
v_max3_f32 v26, v26, v230, v231
v_max_f32 v26, v26, v27
s_add_u32 m0, s70, 147456
s_add_u32 s64, s68, 114688
s_cmp_ge_u32 s3, 2
s_cselect_b32 s64, s64, 2147418112
buffer_load_dwordx4 v4, s[24:27], s64 offen offset:0 sc1 lds
v_mov_b32 v25, v24
v_mov_b32 v27, v26
s_nop 1
v_permlane32_swap_b32 v25, v24
v_permlane32_swap_b32 v27, v26
s_nop 0
buffer_load_dwordx4 v4, s[24:27], s64 offen offset:1024 sc1 lds
v_max_f32 v24, v24, v25
v_max_f32 v26, v26, v27
v_mov_b32 v25, v24
v_mov_b32 v27, v26
s_nop 1
v_permlane16_swap_b32 v25, v24
buffer_load_dwordx4 v4, s[24:27], s64 offen offset:2048 sc1 lds
v_permlane16_swap_b32 v27, v26
s_nop 0
v_max_f32 v24, v24, v25
v_max_f32 v26, v26, v27
v_pk_add_f32 v[100:101], v[100:101], v[24:25] op_sel_hi:[1,0] neg_lo:[0,1] neg_hi:[0,1]
v_pk_add_f32 v[102:103], v[102:103], v[24:25] op_sel_hi:[1,0] neg_lo:[0,1] neg_hi:[0,1]
buffer_load_dwordx4 v4, s[24:27], s64 offen offset:3072 sc1 lds
v_pk_add_f32 v[92:93], v[92:93], v[26:27] op_sel_hi:[1,0] neg_lo:[0,1] neg_hi:[0,1]
v_pk_add_f32 v[94:95], v[94:95], v[26:27] op_sel_hi:[1,0] neg_lo:[0,1] neg_hi:[0,1]
v_pk_add_f32 v[176:177], v[176:177], v[24:25] op_sel_hi:[1,0] neg_lo:[0,1] neg_hi:[0,1]
v_pk_add_f32 v[178:179], v[178:179], v[24:25] op_sel_hi:[1,0] neg_lo:[0,1] neg_hi:[0,1]
v_pk_add_f32 v[228:229], v[228:229], v[26:27] op_sel_hi:[1,0] neg_lo:[0,1] neg_hi:[0,1]
v_pk_add_f32 v[230:231], v[230:231], v[26:27] op_sel_hi:[1,0] neg_lo:[0,1] neg_hi:[0,1]
s_add_u32 m0, s70, 0
s_add_u32 s64, s68, 131072
s_cmp_ge_u32 s3, 3
s_cselect_b32 s64, s64, 2147418112
buffer_load_dwordx4 v4, s[24:27], s64 offen offset:0 sc1 lds
v_pk_add_f32 v[128:129], v[128:129], v[24:25] op_sel_hi:[1,0] neg_lo:[0,1] neg_hi:[0,1]
v_pk_add_f32 v[130:131], v[130:131], v[24:25] op_sel_hi:[1,0] neg_lo:[0,1] neg_hi:[0,1]
v_pk_add_f32 v[136:137], v[136:137], v[26:27] op_sel_hi:[1,0] neg_lo:[0,1] neg_hi:[0,1]
v_pk_add_f32 v[138:139], v[138:139], v[26:27] op_sel_hi:[1,0] neg_lo:[0,1] neg_hi:[0,1]
v_pk_add_f32 v[144:145], v[144:145], v[24:25] op_sel_hi:[1,0] neg_lo:[0,1] neg_hi:[0,1]
v_pk_add_f32 v[146:147], v[146:147], v[24:25] op_sel_hi:[1,0] neg_lo:[0,1] neg_hi:[0,1]
buffer_load_dwordx4 v4, s[24:27], s64 offen offset:1024 sc1 lds
v_pk_add_f32 v[152:153], v[152:153], v[26:27] op_sel_hi:[1,0] neg_lo:[0,1] neg_hi:[0,1]
v_pk_add_f32 v[154:155], v[154:155], v[26:27] op_sel_hi:[1,0] neg_lo:[0,1] neg_hi:[0,1]
v_accvgpr_write_b32 a146, v150
v_accvgpr_write_b32 a147, v151
v_accvgpr_write_b32 a152, v164
v_accvgpr_write_b32 a153, v165
buffer_load_dwordx4 v4, s[24:27], s64 offen offset:2048 sc1 lds
v_accvgpr_write_b32 a154, v166
v_accvgpr_write_b32 a155, v167
v_accvgpr_write_b32 a132, v72
v_accvgpr_write_b32 a133, v73
v_accvgpr_write_b32 a134, v74
v_accvgpr_write_b32 a135, v75
buffer_load_dwordx4 v4, s[24:27], s64 offen offset:3072 sc1 lds
v_accvgpr_write_b32 a140, v160
v_accvgpr_write_b32 a141, v161
v_accvgpr_write_b32 a142, v162
v_accvgpr_write_b32 a143, v163
v_accvgpr_write_b32 a148, v236
v_accvgpr_write_b32 a149, v237
v_accvgpr_write_b32 a150, v238
v_accvgpr_write_b32 a151, v239
v_accvgpr_write_b32 a156, v216
v_accvgpr_write_b32 a157, v217
v_accvgpr_write_b32 a158, v218
v_accvgpr_write_b32 a159, v219
v_mov_b64 v[60:61], 0
v_mov_b64 v[62:63], 0
v_mov_b64 v[68:69], 0
v_mov_b64 v[70:71], 0
v_mov_b64 v[72:73], 0
v_mov_b64 v[74:75], 0
v_mov_b64 v[220:221], 0
v_mov_b64 v[222:223], 0
v_mov_b64 v[84:85], 0
v_mov_b64 v[86:87], 0
v_mov_b64 v[76:77], 0
v_mov_b64 v[78:79], 0
v_mov_b64 v[160:161], 0
v_mov_b64 v[162:163], 0
v_mov_b64 v[252:253], 0
v_mov_b64 v[254:255], 0
v_mov_b64 v[148:149], 0
v_mov_b64 v[150:151], 0
v_mov_b64 v[48:49], 0
v_mov_b64 v[50:51], 0
v_mov_b64 v[236:237], 0
v_mov_b64 v[238:239], 0
v_mov_b64 v[224:225], 0
v_mov_b64 v[226:227], 0
v_mov_b64 v[164:165], 0
v_mov_b64 v[166:167], 0
v_mov_b64 v[156:157], 0
v_mov_b64 v[158:159], 0
v_mov_b64 v[216:217], 0
v_mov_b64 v[218:219], 0
v_mov_b64 v[208:209], 0
v_mov_b64 v[210:211], 0
ds_read_b128 a[192:195], v4 offset:49152
ds_read_b128 a[196:199], v4 offset:50176
ds_read_b128 a[200:203], v4 offset:51200
ds_read_b128 a[204:207], v4 offset:52224
ds_read_b128 a[208:211], v4 offset:53248
ds_read_b128 a[212:215], v4 offset:54272
ds_read_b128 a[216:219], v4 offset:55296
ds_read_b128 a[220:223], v4 offset:56320
s_waitcnt lgkmcnt(8)
s_lshl2_add_u32 s77, s86, s84
s_mul_i32 s77, s77, 344064
s_mov_b32 s80, s70
s_cmp_lt_u32 s3, 2
s_cselect_b32 s53, 8, -2
s_add_u32 s53, s53, s3
v_mfma_f32_16x16x32_bf16 v[36:39], a[64:67], v[124:127], 0
s_mul_i32 s52, s5, 65536
v_exp_f32 v100, v100
v_mfma_f32_16x16x32_bf16 v[116:119], a[64:67], v[140:143], 0
s_sub_u32 s52, 1064960, s52
v_exp_f32 v101, v101
v_mfma_f32_16x16x32_bf16 v[132:135], a[68:71], v[140:143], 0
s_add_u32 s71, s68, s52
v_exp_f32 v102, v102
v_mfma_f32_16x16x32_bf16 v[32:35], a[68:71], v[124:127], 0
s_add_u32 s77, s77, s80
v_exp_f32 v103, v103
v_mfma_f32_16x16x32_bf16 v[196:199], a[72:75], v[124:127], 0
s_add_u32 s77, s77, 38797312
v_cvt_pk_bf16_f32 v248, v100, v101
v_cvt_pk_bf16_f32 v249, v102, v103
v_mfma_f32_16x16x32_bf16 v[184:187], a[72:75], v[140:143], 0
s_add_u32 s52, s3, 6
v_exp_f32 v92, v92
v_mfma_f32_16x16x32_bf16 v[240:243], a[76:79], v[140:143], 0
s_mul_i32 s52, s52, 16384
v_exp_f32 v93, v93
v_mfma_f32_16x16x32_bf16 v[204:207], a[76:79], v[124:127], 0
s_add_u32 s68, s68, s52
v_exp_f32 v94, v94
v_mfma_f32_16x16x32_bf16 v[108:111], a[80:83], v[124:127], 0
s_lshl_b32 s53, s53, 14
v_exp_f32 v95, v95
v_mfma_f32_16x16x32_bf16 v[188:191], a[80:83], v[140:143], 0
s_add_u32 s70, s70, s53
v_cvt_pk_bf16_f32 v232, v92, v93
v_cvt_pk_bf16_f32 v233, v94, v95
v_mfma_f32_16x16x32_bf16 v[56:59], a[84:87], v[140:143], 0
s_mov_b32 s75, 65536
v_exp_f32 v176, v176
v_mfma_f32_16x16x32_bf16 v[40:43], a[84:87], v[124:127], 0
s_mov_b32 s72, 1
v_exp_f32 v177, v177
v_mfma_f32_16x16x32_bf16 v[80:83], a[88:91], v[124:127], 0
s_mov_b32 s73, 3
v_exp_f32 v178, v178
v_mfma_f32_16x16x32_bf16 v[88:91], a[88:91], v[140:143], 0
s_lshl2_add_u32 s69, s5, 4
v_exp_f32 v179, v179
v_mfma_f32_16x16x32_bf16 v[192:195], a[92:95], v[140:143], 0
s_max_u32 s69, s69, 12
v_cvt_pk_bf16_f32 v250, v176, v177
v_cvt_pk_bf16_f32 v251, v178, v179
v_mfma_f32_16x16x32_bf16 v[168:171], a[92:95], v[124:127], 0
s_min_u32 s74, s73, s66
v_exp_f32 v228, v228
v_mfma_f32_16x16x32_bf16 a[224:227], a[240:243], v[124:127], 0
s_mov_b32 s93, 3
v_mfma_f32_16x16x32_bf16 a[228:231], a[240:243], v[140:143], 0
s_cmp_lt_u32 s66, 2
s_waitcnt vmcnt(24) lgkmcnt(0)
s_cbranch_scc1 L_NE
L_DUAL:
v_mfma_f32_16x16x32_bf16 v[44:47], a[192:195], a[32:35], v[96:99]
s_barrier
v_mfma_f32_16x16x32_bf16 v[44:47], a[196:199], a[36:39], v[44:47]
s_cmp_eq_u32 s68, s71
v_exp_f32 v229, v229
v_mfma_f32_16x16x32_bf16 v[44:47], a[200:203], a[28:31], v[44:47]
s_cselect_b32 s64, s77, s68
v_add_u32 v5, s75, v4
v_cvt_pk_bf16_f32 v234, v228, v229
v_mfma_f32_16x16x32_bf16 v[44:47], a[204:207], a[20:23], v[44:47]
s_mov_b32 m0, s70
v_exp_f32 v230, v230
v_mfma_f32_16x16x32_bf16 v[52:55], a[192:195], a[44:47], v[104:107]
buffer_load_dwordx4 v4, s[24:27], s64 offen offset:0 sc1 lds
v_mfma_f32_16x16x32_bf16 v[52:55], a[196:199], a[40:43], v[52:55]
s_add_u32 s75, s75, 16384
v_exp_f32 v231, v231
v_mfma_f32_16x16x32_bf16 v[52:55], a[200:203], a[12:15], v[52:55]
v_cvt_pk_bf16_f32 v235, v230, v231
v_mfma_f32_16x16x32_bf16 v[52:55], a[204:207], a[4:7], v[52:55]
s_cmp_ge_u32 s75, 163840
v_exp_f32 v44, v44
v_mfma_f32_16x16x32_bf16 v[64:67], a[208:211], a[32:35], v[112:115]
v_mfma_f32_16x16x32_bf16 v[64:67], a[212:215], a[36:39], v[64:67]
s_cselect_b32 s75, 0, s75
v_exp_f32 v45, v45
v_mfma_f32_16x16x32_bf16 v[64:67], a[216:219], a[28:31], v[64:67]
v_cvt_pk_bf16_f32 v124, v44, v45
v_mfma_f32_16x16x32_bf16 v[64:67], a[220:223], a[20:23], v[64:67]
s_add_u32 s68, s64, 16384
v_exp_f32 v46, v46
v_mfma_f32_16x16x32_bf16 v[212:215], a[208:211], a[44:47], v[120:123]
buffer_load_dwordx4 v4, s[24:27], s64 offen offset:1024 sc1 lds
v_mfma_f32_16x16x32_bf16 v[212:215], a[212:215], a[40:43], v[212:215]
s_add_u32 s70, s70, 16384
v_exp_f32 v47, v47
v_mfma_f32_16x16x32_bf16 v[212:215], a[216:219], a[12:15], v[212:215]
v_cvt_pk_bf16_f32 v125, v46, v47
v_mfma_f32_16x16x32_bf16 v[212:215], a[220:223], a[4:7], v[212:215]
v_exp_f32 v52, v52
v_mfma_f32_16x16x32_bf16 v[60:63], a[64:67], v[248:251], v[60:63]
v_mfma_f32_16x16x32_bf16 v[148:151], a[64:67], v[232:235], v[148:151]
s_cmp_ge_u32 s70, 163840
v_exp_f32 v53, v53
v_mfma_f32_16x16x32_bf16 v[48:51], a[68:71], v[232:235], v[48:51]
ds_read_b128 a[64:67], v5 offset:8192
v_cvt_pk_bf16_f32 v140, v52, v53
v_mfma_f32_16x16x32_bf16 v[68:71], a[68:71], v[248:251], v[68:71]
s_cselect_b32 s70, s80, s70
v_exp_f32 v54, v54
v_mfma_f32_16x16x32_bf16 v[72:75], a[72:75], v[248:251], v[72:75]
buffer_load_dwordx4 v4, s[24:27], s64 offen offset:2048 sc1 lds
v_mfma_f32_16x16x32_bf16 v[236:239], a[72:75], v[232:235], v[236:239]
v_exp_f32 v55, v55
v_mfma_f32_16x16x32_bf16 v[224:227], a[76:79], v[232:235], v[224:227]
ds_read_b128 a[68:71], v5 offset:9216
v_cvt_pk_bf16_f32 v141, v54, v55
v_mfma_f32_16x16x32_bf16 v[220:223], a[76:79], v[248:251], v[220:223]
v_exp_f32 v64, v64
v_mfma_f32_16x16x32_bf16 v[84:87], a[80:83], v[248:251], v[84:87]
ds_read_b128 a[72:75], v5 offset:10240
v_mfma_f32_16x16x32_bf16 v[164:167], a[80:83], v[232:235], v[164:167]
v_exp_f32 v65, v65
v_mfma_f32_16x16x32_bf16 v[156:159], a[84:87], v[232:235], v[156:159]
ds_read_b128 a[76:79], v5 offset:11264
v_cvt_pk_bf16_f32 v126, v64, v65
v_mfma_f32_16x16x32_bf16 v[76:79], a[84:87], v[248:251], v[76:79]
v_exp_f32 v66, v66
v_mfma_f32_16x16x32_bf16 v[160:163], a[88:91], v[248:251], v[160:163]
buffer_load_dwordx4 v4, s[24:27], s64 offen offset:3072 sc1 lds
v_mfma_f32_16x16x32_bf16 v[216:219], a[88:91], v[232:235], v[216:219]
v_exp_f32 v67, v67
v_mfma_f32_16x16x32_bf16 v[208:211], a[92:95], v[232:235], v[208:211]
ds_read_b128 a[80:83], v5 offset:12288
v_cvt_pk_bf16_f32 v127, v66, v67
v_mfma_f32_16x16x32_bf16 v[252:255], a[92:95], v[248:251], v[252:255]
v_exp_f32 v212, v212
v_mfma_f32_16x16x32_bf16 a[232:235], a[240:243], v[248:251], a[232:235]
ds_read_b128 a[84:87], v5 offset:13312
v_mfma_f32_16x16x32_bf16 a[236:239], a[240:243], v[232:235], a[236:239]
ds_read_b128 a[88:91], v5 offset:14336
v_mfma_f32_16x16x32_bf16 v[100:103], a[192:195], a[48:51], v[128:131]
ds_read_b128 a[92:95], v5 offset:15360
v_mfma_f32_16x16x32_bf16 v[100:103], a[196:199], a[52:55], v[100:103]
v_exp_f32 v213, v213
v_mfma_f32_16x16x32_bf16 v[100:103], a[200:203], a[0:3], v[100:103]
v_cvt_pk_bf16_f32 v142, v212, v213
v_mfma_f32_16x16x32_bf16 v[100:103], a[204:207], a[8:11], v[100:103]
v_exp_f32 v214, v214
v_mfma_f32_16x16x32_bf16 v[92:95], a[192:195], a[60:63], v[136:139]
s_nop 0
v_mfma_f32_16x16x32_bf16 v[92:95], a[196:199], a[56:59], v[92:95]
v_exp_f32 v215, v215
v_mfma_f32_16x16x32_bf16 v[92:95], a[200:203], a[16:19], v[92:95]
ds_read_b128 a[192:195], v5 offset:0
v_cvt_pk_bf16_f32 v143, v214, v215
v_mfma_f32_16x16x32_bf16 v[92:95], a[204:207], a[24:27], v[92:95]
v_exp_f32 v100, v100
v_mfma_f32_16x16x32_bf16 v[176:179], a[208:211], a[48:51], v[144:147]
ds_read_b128 a[196:199], v5 offset:1024
v_mfma_f32_16x16x32_bf16 v[176:179], a[212:215], a[52:55], v[176:179]
v_exp_f32 v101, v101
v_mfma_f32_16x16x32_bf16 v[176:179], a[216:219], a[0:3], v[176:179]
ds_read_b128 a[200:203], v5 offset:2048
v_cvt_pk_bf16_f32 v248, v100, v101
v_mfma_f32_16x16x32_bf16 v[176:179], a[220:223], a[8:11], v[176:179]
v_exp_f32 v102, v102
v_mfma_f32_16x16x32_bf16 v[228:231], a[208:211], a[60:63], v[152:155]
ds_read_b128 a[204:207], v5 offset:3072
v_mfma_f32_16x16x32_bf16 v[228:231], a[212:215], a[56:59], v[228:231]
v_exp_f32 v103, v103
v_mfma_f32_16x16x32_bf16 v[228:231], a[216:219], a[16:19], v[228:231]
ds_read_b128 a[208:211], v5 offset:4096
v_cvt_pk_bf16_f32 v249, v102, v103
v_mfma_f32_16x16x32_bf16 v[228:231], a[220:223], a[24:27], v[228:231]
s_waitcnt lgkmcnt(5)
v_exp_f32 v92, v92
v_mfma_f32_16x16x32_bf16 v[36:39], a[64:67], v[124:127], v[36:39]
ds_read_b128 a[212:215], v5 offset:5120
v_mfma_f32_16x16x32_bf16 v[116:119], a[64:67], v[140:143], v[116:119]
v_exp_f32 v93, v93
v_mfma_f32_16x16x32_bf16 v[132:135], a[68:71], v[140:143], v[132:135]
ds_read_b128 a[216:219], v5 offset:6144
v_cvt_pk_bf16_f32 v232, v92, v93
v_mfma_f32_16x16x32_bf16 v[32:35], a[68:71], v[124:127], v[32:35]
v_exp_f32 v94, v94
v_mfma_f32_16x16x32_bf16 v[196:199], a[72:75], v[124:127], v[196:199]
ds_read_b128 a[220:223], v5 offset:7168
v_mfma_f32_16x16x32_bf16 v[184:187], a[72:75], v[140:143], v[184:187]
s_add_u32 s72, s72, 1
v_exp_f32 v95, v95
v_mfma_f32_16x16x32_bf16 v[240:243], a[76:79], v[140:143], v[240:243]
v_cvt_pk_bf16_f32 v233, v94, v95
v_mfma_f32_16x16x32_bf16 v[204:207], a[76:79], v[124:127], v[204:207]
v_exp_f32 v176, v176
v_mfma_f32_16x16x32_bf16 v[108:111], a[80:83], v[124:127], v[108:111]
v_mfma_f32_16x16x32_bf16 v[188:191], a[80:83], v[140:143], v[188:191]
v_exp_f32 v177, v177
v_mfma_f32_16x16x32_bf16 v[56:59], a[84:87], v[140:143], v[56:59]
v_cvt_pk_bf16_f32 v250, v176, v177
v_mfma_f32_16x16x32_bf16 v[40:43], a[84:87], v[124:127], v[40:43]
v_exp_f32 v178, v178
v_mfma_f32_16x16x32_bf16 v[80:83], a[88:91], v[124:127], v[80:83]
v_mfma_f32_16x16x32_bf16 v[88:91], a[88:91], v[140:143], v[88:91]
s_cmp_lt_u32 s72, s74
v_exp_f32 v179, v179
v_mfma_f32_16x16x32_bf16 v[192:195], a[92:95], v[140:143], v[192:195]
v_cvt_pk_bf16_f32 v251, v178, v179
v_mfma_f32_16x16x32_bf16 v[168:171], a[92:95], v[124:127], v[168:171]
s_waitcnt vmcnt(8) lgkmcnt(0)
v_exp_f32 v228, v228
v_mfma_f32_16x16x32_bf16 a[224:227], a[240:243], v[124:127], a[224:227]
v_mfma_f32_16x16x32_bf16 a[228:231], a[240:243], v[140:143], a[228:231]
s_cbranch_scc1 L_DUAL
L_DISP:
s_cmp_eq_u32 s72, s93
s_cbranch_scc1 L_STOP
L_NE:
s_mov_b32 s74, s93
s_cmp_gt_u32 s72, s66
s_cbranch_scc1 L_SINGLE
v_cndmask_b32 v96, v96, v6, s[56:57]
v_cndmask_b32 v120, v120, v6, s[56:57]
v_mov_b32 v112, v6
v_cndmask_b32 v97, v97, v6, s[58:59]
v_cndmask_b32 v121, v121, v6, s[58:59]
v_mov_b32 v113, v6
v_cndmask_b32 v98, v98, v6, s[60:61]
v_cndmask_b32 v122, v122, v6, s[60:61]
v_mov_b32 v114, v6
v_cndmask_b32 v99, v99, v6, s[62:63]
v_cndmask_b32 v123, v123, v6, s[62:63]
v_mov_b32 v115, v6
s_mov_b32 s74, 0
s_branch L_DUAL
L_STOP:
s_cmp_eq_u32 s72, 3
s_cbranch_scc1 L_E0
s_cmp_eq_u32 s72, 9
s_cbranch_scc1 L_E1
s_cmp_lg_u32 s72, 11
s_cbranch_scc1 L_SE
v_cmp_gt_u32 vcc, 32, v172
s_mov_b32 s73, 32
s_min_u32 s93, s73, s69
s_min_u32 s74, s93, s66
v_accvgpr_read_b32 v16, a244
v_accvgpr_read_b32 v17, a248
v_accvgpr_read_b32 v18, a252
s_cbranch_vccnz CK_Q
CK_Q_R:
buffer_load_dwordx4 a[244:247], v16, s[24:27], 0 offen sc1
buffer_load_dwordx4 a[248:251], v17, s[24:27], 0 offen sc1
buffer_load_dwordx4 a[252:255], v18, s[24:27], 0 offen sc1
s_add_u32 s53, s77, 163840
buffer_load_dwordx4 a[96:99], v4, s[24:27], s53 offen offset:0 sc1
buffer_load_dwordx4 a[100:103], v4, s[24:27], s53 offen offset:1024 sc1
buffer_load_dwordx4 a[104:107], v4, s[24:27], s53 offen offset:2048 sc1
buffer_load_dwordx4 a[108:111], v4, s[24:27], s53 offen offset:3072 sc1
s_cmp_lt_u32 s72, s66
s_cbranch_scc1 L_DUAL
s_mov_b32 s74, s93
s_cmp_gt_u32 s72, s66
s_cbranch_scc1 L_SINGLE
s_branch L_NE
L_E0:
buffer_atomic_add v1, v0, s[24:27], s89 offen offset:8 sc1
s_mov_b32 s73, 9
s_min_u32 s93, s73, s69
s_min_u32 s74, s93, s66
s_cmp_lt_u32 s72, s66
s_cbranch_scc1 L_DUAL
s_mov_b32 s74, s93
s_cmp_gt_u32 s72, s66
s_cbranch_scc1 L_SINGLE
s_branch L_NE
L_E1:
v_and_b32 v173, 31, v1
v_lshlrev_b32 v173, 10, v173
v_add_u32 v173, 75497992, v173
buffer_load_dword v172, v173, s[24:27], 0 offen sc1
s_mov_b32 s73, 11
s_min_u32 s93, s73, s69
s_min_u32 s74, s93, s66
s_cmp_lt_u32 s72, s66
s_cbranch_scc1 L_DUAL
s_mov_b32 s74, s93
s_cmp_gt_u32 s72, s66
s_cbranch_scc1 L_SINGLE
s_branch L_NE
L_SE:
s_lshr_b32 s52, s4, 3
s_mul_i32 s52, s52, 75776
s_add_u32 s52, s52, 54525952
s_and_b32 s53, s4, 7
s_mul_i32 s53, s53, 8192
s_add_u32 s52, s52, s53
s_mul_i32 s78, s66, 303104
s_add_u32 s78, s78, s52
s_mul_i32 s79, s67, 303104
s_add_u32 s79, s79, s52
s_mov_b32 s76, 0
v_mov_b32 v7, 0x5d800000
s_mov_b32 s69, 64
v_accvgpr_read_b32 v180, a224
v_accvgpr_read_b32 v182, a228
v_cmp_nle_f32 vcc, v180, v7
v_cmp_nle_f32 s[96:97], v182, v7
s_nop 3
s_or_b64 vcc, vcc, s[96:97]
s_cbranch_vccnz L_NS
s_add_u32 s53, s77, 180224
buffer_load_dwordx4 a[112:115], v4, s[24:27], s53 offen offset:0 sc1
v_mul_f32 v8, 0x3fb8aa3b, v8
v_mul_f32 v9, 0x3fb8aa3b, v9
v_exp_f32 v8, v8
v_exp_f32 v9, v9
s_nop 0
v_fma_f32 v180, v180, v8, v180
v_fma_f32 v182, v182, v9, v182
v_rcp_f32 v180, v180
v_rcp_f32 v182, v182
s_add_u32 s52, s78, 4096
v_mov_b32 v181, v180
v_mov_b32 v183, v182
v_pk_mul_f32 v[36:37], v[36:37], v[180:181]
v_pk_mul_f32 v[38:39], v[38:39], v[180:181]
v_pk_mul_f32 v[32:33], v[32:33], v[180:181]
v_pk_mul_f32 v[34:35], v[34:35], v[180:181]
v_cvt_pk_bf16_f32 v36, v36, v37
v_cvt_pk_bf16_f32 v37, v38, v39
v_cvt_pk_bf16_f32 v38, v32, v33
v_cvt_pk_bf16_f32 v39, v34, v35
buffer_store_dwordx4 v[36:39], v4, s[24:27], s78 offen offset:0 sc1
buffer_load_dwordx4 a[116:119], v4, s[24:27], s53 offen offset:1024 sc1
v_pk_mul_f32 v[116:117], v[116:117], v[182:183]
v_pk_mul_f32 v[118:119], v[118:119], v[182:183]
v_pk_mul_f32 v[132:133], v[132:133], v[182:183]
v_pk_mul_f32 v[134:135], v[134:135], v[182:183]
v_cvt_pk_bf16_f32 v116, v116, v117
v_cvt_pk_bf16_f32 v117, v118, v119
v_cvt_pk_bf16_f32 v118, v132, v133
v_cvt_pk_bf16_f32 v119, v134, v135
buffer_store_dwordx4 v[116:119], v4, s[24:27], s78 offen offset:1024 sc1
v_pk_mul_f32 v[196:197], v[196:197], v[180:181]
v_pk_mul_f32 v[198:199], v[198:199], v[180:181]
v_pk_mul_f32 v[204:205], v[204:205], v[180:181]
v_pk_mul_f32 v[206:207], v[206:207], v[180:181]
v_cvt_pk_bf16_f32 v196, v196, v197
v_cvt_pk_bf16_f32 v197, v198, v199
v_cvt_pk_bf16_f32 v198, v204, v205
v_cvt_pk_bf16_f32 v199, v206, v207
buffer_store_dwordx4 v[196:199], v4, s[24:27], s78 offen offset:2048 sc1
v_pk_mul_f32 v[184:185], v[184:185], v[182:183]
v_pk_mul_f32 v[186:187], v[186:187], v[182:183]
v_pk_mul_f32 v[240:241], v[240:241], v[182:183]
buffer_load_dwordx4 a[120:123], v4, s[24:27], s53 offen offset:2048 sc1
v_pk_mul_f32 v[242:243], v[242:243], v[182:183]
v_cvt_pk_bf16_f32 v184, v184, v185
v_cvt_pk_bf16_f32 v185, v186, v187
v_cvt_pk_bf16_f32 v186, v240, v241
v_cvt_pk_bf16_f32 v187, v242, v243
buffer_store_dwordx4 v[184:187], v4, s[24:27], s78 offen offset:3072 sc1
v_pk_mul_f32 v[108:109], v[108:109], v[180:181]
v_pk_mul_f32 v[110:111], v[110:111], v[180:181]
v_pk_mul_f32 v[40:41], v[40:41], v[180:181]
v_pk_mul_f32 v[42:43], v[42:43], v[180:181]
v_cvt_pk_bf16_f32 v108, v108, v109
v_cvt_pk_bf16_f32 v109, v110, v111
v_cvt_pk_bf16_f32 v110, v40, v41
v_cvt_pk_bf16_f32 v111, v42, v43
buffer_store_dwordx4 v[108:111], v4, s[24:27], s52 offen offset:0 sc1
v_pk_mul_f32 v[188:189], v[188:189], v[182:183]
v_pk_mul_f32 v[190:191], v[190:191], v[182:183]
v_pk_mul_f32 v[56:57], v[56:57], v[182:183]
v_pk_mul_f32 v[58:59], v[58:59], v[182:183]
v_cvt_pk_bf16_f32 v188, v188, v189
v_cvt_pk_bf16_f32 v189, v190, v191
buffer_load_dwordx4 a[124:127], v4, s[24:27], s53 offen offset:3072 sc1
v_cvt_pk_bf16_f32 v190, v56, v57
v_cvt_pk_bf16_f32 v191, v58, v59
buffer_store_dwordx4 v[188:191], v4, s[24:27], s52 offen offset:1024 sc1
v_pk_mul_f32 v[80:81], v[80:81], v[180:181]
v_pk_mul_f32 v[82:83], v[82:83], v[180:181]
v_pk_mul_f32 v[168:169], v[168:169], v[180:181]
v_pk_mul_f32 v[170:171], v[170:171], v[180:181]
v_cvt_pk_bf16_f32 v80, v80, v81
v_cvt_pk_bf16_f32 v81, v82, v83
v_cvt_pk_bf16_f32 v82, v168, v169
v_cvt_pk_bf16_f32 v83, v170, v171
buffer_store_dwordx4 v[80:83], v4, s[24:27], s52 offen offset:2048 sc1
v_pk_mul_f32 v[88:89], v[88:89], v[182:183]
v_pk_mul_f32 v[90:91], v[90:91], v[182:183]
v_pk_mul_f32 v[192:193], v[192:193], v[182:183]
v_pk_mul_f32 v[194:195], v[194:195], v[182:183]
v_cvt_pk_bf16_f32 v88, v88, v89
v_cvt_pk_bf16_f32 v89, v90, v91
v_cvt_pk_bf16_f32 v90, v192, v193
v_cvt_pk_bf16_f32 v91, v194, v195
buffer_store_dwordx4 v[88:91], v4, s[24:27], s52 offen offset:3072 sc1
L_PAD9:
s_cbranch_execz L_PAD13
s_mov_b32 s76, 1
L_NS:
s_mov_b32 s74, s73
s_mov_b32 s93, s73
s_cmp_eq_u32 s72, 32
s_cbranch_scc1 L_FIN
L_SINGLE:
v_mfma_f32_16x16x32_bf16 v[44:47], a[192:195], a[48:51], v[128:131]
s_barrier
v_mfma_f32_16x16x32_bf16 v[44:47], a[196:199], a[52:55], v[44:47]
s_cmp_eq_u32 s68, s71
v_exp_f32 v229, v229
v_mfma_f32_16x16x32_bf16 v[44:47], a[200:203], a[0:3], v[44:47]
s_cselect_b32 s64, s77, s68
v_add_u32 v5, s75, v4
v_cvt_pk_bf16_f32 v234, v228, v229
v_mfma_f32_16x16x32_bf16 v[44:47], a[204:207], a[8:11], v[44:47]
s_mov_b32 m0, s70
v_exp_f32 v230, v230
v_mfma_f32_16x16x32_bf16 v[52:55], a[192:195], a[60:63], v[136:139]
buffer_load_dwordx4 v4, s[24:27], s64 offen offset:0 sc1 lds
v_mfma_f32_16x16x32_bf16 v[52:55], a[196:199], a[56:59], v[52:55]
s_add_u32 s75, s75, 16384
v_exp_f32 v231, v231
v_mfma_f32_16x16x32_bf16 v[52:55], a[200:203], a[16:19], v[52:55]
ds_read_b128 a[192:195], v5 offset:0
v_cvt_pk_bf16_f32 v235, v230, v231
v_mfma_f32_16x16x32_bf16 v[52:55], a[204:207], a[24:27], v[52:55]
s_cmp_ge_u32 s75, 163840
v_exp_f32 v44, v44
v_mfma_f32_16x16x32_bf16 v[64:67], a[208:211], a[48:51], v[144:147]
ds_read_b128 a[196:199], v5 offset:1024
ds_read_b128 a[200:203], v5 offset:2048
v_mfma_f32_16x16x32_bf16 v[64:67], a[212:215], a[52:55], v[64:67]
s_cselect_b32 s75, 0, s75
v_exp_f32 v45, v45
v_mfma_f32_16x16x32_bf16 v[64:67], a[216:219], a[0:3], v[64:67]
ds_read_b128 a[204:207], v5 offset:3072
v_cvt_pk_bf16_f32 v124, v44, v45
v_mfma_f32_16x16x32_bf16 v[64:67], a[220:223], a[8:11], v[64:67]
s_add_u32 s68, s64, 16384
v_exp_f32 v46, v46
v_mfma_f32_16x16x32_bf16 v[212:215], a[208:211], a[60:63], v[152:155]
buffer_load_dwordx4 v4, s[24:27], s64 offen offset:1024 sc1 lds
v_mfma_f32_16x16x32_bf16 v[212:215], a[212:215], a[56:59], v[212:215]
s_add_u32 s70, s70, 16384
v_exp_f32 v47, v47
v_mfma_f32_16x16x32_bf16 v[212:215], a[216:219], a[16:19], v[212:215]
ds_read_b128 a[208:211], v5 offset:4096
v_cvt_pk_bf16_f32 v125, v46, v47
v_mfma_f32_16x16x32_bf16 v[212:215], a[220:223], a[24:27], v[212:215]
s_waitcnt lgkmcnt(5)
v_exp_f32 v52, v52
v_mfma_f32_16x16x32_bf16 v[60:63], a[64:67], v[248:251], v[60:63]
ds_read_b128 a[212:215], v5 offset:5120
ds_read_b128 a[216:219], v5 offset:6144
v_mfma_f32_16x16x32_bf16 v[148:151], a[64:67], v[232:235], v[148:151]
s_cmp_ge_u32 s70, 163840
v_exp_f32 v53, v53
v_mfma_f32_16x16x32_bf16 v[48:51], a[68:71], v[232:235], v[48:51]
ds_read_b128 a[220:223], v5 offset:7168
v_cvt_pk_bf16_f32 v140, v52, v53
v_mfma_f32_16x16x32_bf16 v[68:71], a[68:71], v[248:251], v[68:71]
s_cselect_b32 s70, s80, s70
v_exp_f32 v54, v54
v_mfma_f32_16x16x32_bf16 v[72:75], a[72:75], v[248:251], v[72:75]
buffer_load_dwordx4 v4, s[24:27], s64 offen offset:2048 sc1 lds
v_mfma_f32_16x16x32_bf16 v[236:239], a[72:75], v[232:235], v[236:239]
v_exp_f32 v55, v55
v_mfma_f32_16x16x32_bf16 v[224:227], a[76:79], v[232:235], v[224:227]
ds_read_b128 a[64:67], v5 offset:8192
v_cvt_pk_bf16_f32 v141, v54, v55
v_mfma_f32_16x16x32_bf16 v[220:223], a[76:79], v[248:251], v[220:223]
v_exp_f32 v64, v64
v_mfma_f32_16x16x32_bf16 v[84:87], a[80:83], v[248:251], v[84:87]
ds_read_b128 a[68:71], v5 offset:9216
ds_read_b128 a[72:75], v5 offset:10240
v_mfma_f32_16x16x32_bf16 v[164:167], a[80:83], v[232:235], v[164:167]
v_exp_f32 v65, v65
v_mfma_f32_16x16x32_bf16 v[156:159], a[84:87], v[232:235], v[156:159]
ds_read_b128 a[76:79], v5 offset:11264
v_cvt_pk_bf16_f32 v126, v64, v65
v_mfma_f32_16x16x32_bf16 v[76:79], a[84:87], v[248:251], v[76:79]
s_cmp_eq_u32 s68, s71
v_exp_f32 v66, v66
v_mfma_f32_16x16x32_bf16 v[160:163], a[88:91], v[248:251], v[160:163]
buffer_load_dwordx4 v4, s[24:27], s64 offen offset:3072 sc1 lds
v_mfma_f32_16x16x32_bf16 v[216:219], a[88:91], v[232:235], v[216:219]
s_cselect_b32 s64, s77, s68
v_exp_f32 v67, v67
v_mfma_f32_16x16x32_bf16 v[208:211], a[92:95], v[232:235], v[208:211]
ds_read_b128 a[80:83], v5 offset:12288
v_cvt_pk_bf16_f32 v127, v66, v67
v_mfma_f32_16x16x32_bf16 v[252:255], a[92:95], v[248:251], v[252:255]
s_waitcnt lgkmcnt(5)
v_exp_f32 v212, v212
v_mfma_f32_16x16x32_bf16 a[232:235], a[240:243], v[248:251], a[232:235]
ds_read_b128 a[84:87], v5 offset:13312
ds_read_b128 a[88:91], v5 offset:14336
v_mfma_f32_16x16x32_bf16 a[236:239], a[240:243], v[232:235], a[236:239]
s_mov_b32 m0, s70
ds_read_b128 a[92:95], v5 offset:15360
v_mfma_f32_16x16x32_bf16 v[100:103], a[192:195], a[48:51], v[128:131]
buffer_load_dwordx4 v4, s[24:27], s64 offen offset:0 sc1 lds
v_mfma_f32_16x16x32_bf16 v[100:103], a[196:199], a[52:55], v[100:103]
v_exp_f32 v213, v213
v_mfma_f32_16x16x32_bf16 v[100:103], a[200:203], a[0:3], v[100:103]
v_add_u32 v5, s75, v4
v_cvt_pk_bf16_f32 v142, v212, v213
v_mfma_f32_16x16x32_bf16 v[100:103], a[204:207], a[8:11], v[100:103]
v_exp_f32 v214, v214
v_mfma_f32_16x16x32_bf16 v[92:95], a[192:195], a[60:63], v[136:139]
buffer_load_dwordx4 v4, s[24:27], s64 offen offset:1024 sc1 lds
v_mfma_f32_16x16x32_bf16 v[92:95], a[196:199], a[56:59], v[92:95]
s_add_u32 s75, s75, 16384
v_exp_f32 v215, v215
v_mfma_f32_16x16x32_bf16 v[92:95], a[200:203], a[16:19], v[92:95]
ds_read_b128 a[192:195], v5 offset:0
v_cvt_pk_bf16_f32 v143, v214, v215
v_mfma_f32_16x16x32_bf16 v[92:95], a[204:207], a[24:27], v[92:95]
s_cmp_ge_u32 s75, 163840
v_exp_f32 v100, v100
v_mfma_f32_16x16x32_bf16 v[176:179], a[208:211], a[48:51], v[144:147]
ds_read_b128 a[196:199], v5 offset:1024
ds_read_b128 a[200:203], v5 offset:2048
v_mfma_f32_16x16x32_bf16 v[176:179], a[212:215], a[52:55], v[176:179]
s_cselect_b32 s75, 0, s75
v_exp_f32 v101, v101
v_mfma_f32_16x16x32_bf16 v[176:179], a[216:219], a[0:3], v[176:179]
ds_read_b128 a[204:207], v5 offset:3072
v_cvt_pk_bf16_f32 v248, v100, v101
v_mfma_f32_16x16x32_bf16 v[176:179], a[220:223], a[8:11], v[176:179]
s_add_u32 s68, s64, 16384
v_exp_f32 v102, v102
v_mfma_f32_16x16x32_bf16 v[228:231], a[208:211], a[60:63], v[152:155]
buffer_load_dwordx4 v4, s[24:27], s64 offen offset:2048 sc1 lds
v_mfma_f32_16x16x32_bf16 v[228:231], a[212:215], a[56:59], v[228:231]
s_add_u32 s70, s70, 16384
v_exp_f32 v103, v103
v_mfma_f32_16x16x32_bf16 v[228:231], a[216:219], a[16:19], v[228:231]
ds_read_b128 a[208:211], v5 offset:4096
v_cvt_pk_bf16_f32 v249, v102, v103
v_mfma_f32_16x16x32_bf16 v[228:231], a[220:223], a[24:27], v[228:231]
s_waitcnt lgkmcnt(5)
v_exp_f32 v92, v92
v_mfma_f32_16x16x32_bf16 v[60:63], a[64:67], v[124:127], v[60:63]
ds_read_b128 a[212:215], v5 offset:5120
ds_read_b128 a[216:219], v5 offset:6144
v_mfma_f32_16x16x32_bf16 v[148:151], a[64:67], v[140:143], v[148:151]
s_cmp_ge_u32 s70, 163840
v_exp_f32 v93, v93
v_mfma_f32_16x16x32_bf16 v[48:51], a[68:71], v[140:143], v[48:51]
ds_read_b128 a[220:223], v5 offset:7168
v_cvt_pk_bf16_f32 v232, v92, v93
v_mfma_f32_16x16x32_bf16 v[68:71], a[68:71], v[124:127], v[68:71]
s_cselect_b32 s70, s80, s70
v_exp_f32 v94, v94
v_mfma_f32_16x16x32_bf16 v[72:75], a[72:75], v[124:127], v[72:75]
buffer_load_dwordx4 v4, s[24:27], s64 offen offset:3072 sc1 lds
v_mfma_f32_16x16x32_bf16 v[236:239], a[72:75], v[140:143], v[236:239]
s_add_u32 s72, s72, 1
v_exp_f32 v95, v95
v_mfma_f32_16x16x32_bf16 v[224:227], a[76:79], v[140:143], v[224:227]
ds_read_b128 a[64:67], v5 offset:8192
v_cvt_pk_bf16_f32 v233, v94, v95
v_mfma_f32_16x16x32_bf16 v[220:223], a[76:79], v[124:127], v[220:223]
v_exp_f32 v176, v176
v_mfma_f32_16x16x32_bf16 v[84:87], a[80:83], v[124:127], v[84:87]
ds_read_b128 a[68:71], v5 offset:9216
ds_read_b128 a[72:75], v5 offset:10240
v_mfma_f32_16x16x32_bf16 v[164:167], a[80:83], v[140:143], v[164:167]
v_exp_f32 v177, v177
v_mfma_f32_16x16x32_bf16 v[156:159], a[84:87], v[140:143], v[156:159]
ds_read_b128 a[76:79], v5 offset:11264
v_cvt_pk_bf16_f32 v250, v176, v177
v_mfma_f32_16x16x32_bf16 v[76:79], a[84:87], v[124:127], v[76:79]
v_exp_f32 v178, v178
v_mfma_f32_16x16x32_bf16 v[160:163], a[88:91], v[124:127], v[160:163]
ds_read_b128 a[80:83], v5 offset:12288
ds_read_b128 a[84:87], v5 offset:13312
v_mfma_f32_16x16x32_bf16 v[216:219], a[88:91], v[140:143], v[216:219]
s_cmp_lt_u32 s72, s74
v_exp_f32 v179, v179
v_mfma_f32_16x16x32_bf16 v[208:211], a[92:95], v[140:143], v[208:211]
ds_read_b128 a[88:91], v5 offset:14336
v_cvt_pk_bf16_f32 v251, v178, v179
v_mfma_f32_16x16x32_bf16 v[252:255], a[92:95], v[124:127], v[252:255]
s_waitcnt vmcnt(8) lgkmcnt(7)
v_exp_f32 v228, v228
v_mfma_f32_16x16x32_bf16 a[232:235], a[240:243], v[124:127], a[232:235]
ds_read_b128 a[92:95], v5 offset:15360
v_mfma_f32_16x16x32_bf16 a[236:239], a[240:243], v[140:143], a[236:239]
s_cbranch_scc1 L_SINGLE
s_cmp_eq_u32 s72, s69
s_cbranch_scc1 L_SE
s_cmp_lt_u32 s72, 32
s_cbranch_scc1 L_STOP
L_FIN:
s_add_u32 s53, s77, 196608
buffer_load_dwordx4 a[160:163], v4, s[24:27], s53 offen offset:0 sc1
v_cndmask_b32 v128, v128, v6, s[56:57]
v_cndmask_b32 v152, v152, v6, s[56:57]
v_mov_b32 v144, v6
buffer_load_dwordx4 a[164:167], v4, s[24:27], s53 offen offset:1024 sc1
v_cndmask_b32 v129, v129, v6, s[58:59]
v_cndmask_b32 v153, v153, v6, s[58:59]
v_mov_b32 v145, v6
buffer_load_dwordx4 a[168:171], v4, s[24:27], s53 offen offset:2048 sc1
v_cndmask_b32 v130, v130, v6, s[60:61]
v_cndmask_b32 v154, v154, v6, s[60:61]
v_mov_b32 v146, v6
buffer_load_dwordx4 a[172:175], v4, s[24:27], s53 offen offset:3072 sc1
v_cndmask_b32 v131, v131, v6, s[62:63]
v_cndmask_b32 v155, v155, v6, s[62:63]
v_mov_b32 v147, v6
s_mov_b32 s83, s75
s_sub_u32 s91, s70, s80
v_mfma_f32_16x16x32_bf16 v[44:47], a[192:195], a[48:51], v[128:131]
s_barrier
v_mfma_f32_16x16x32_bf16 v[44:47], a[196:199], a[52:55], v[44:47]
s_mov_b32 m0, s70
v_exp_f32 v229, v229
v_mfma_f32_16x16x32_bf16 v[44:47], a[200:203], a[0:3], v[44:47]
s_mov_b32 s64, s68
v_add_u32 v5, s75, v4
v_cvt_pk_bf16_f32 v234, v228, v229
v_mfma_f32_16x16x32_bf16 v[44:47], a[204:207], a[8:11], v[44:47]
s_add_u32 s68, s68, 16384
v_exp_f32 v230, v230
v_mfma_f32_16x16x32_bf16 v[52:55], a[192:195], a[60:63], v[136:139]
buffer_load_dwordx4 v4, s[24:27], s64 offen offset:0 sc1 lds
v_mfma_f32_16x16x32_bf16 v[52:55], a[196:199], a[56:59], v[52:55]
s_add_u32 s70, s70, 16384
v_exp_f32 v231, v231
v_mfma_f32_16x16x32_bf16 v[52:55], a[200:203], a[16:19], v[52:55]
v_cvt_pk_bf16_f32 v235, v230, v231
v_mul_f32 v10, 0x3fb8aa3b, v10
v_mfma_f32_16x16x32_bf16 v[52:55], a[204:207], a[24:27], v[52:55]
s_cmp_ge_u32 s70, 163840
v_exp_f32 v44, v44
v_mfma_f32_16x16x32_bf16 v[64:67], a[208:211], a[48:51], v[144:147]
buffer_load_dwordx4 v4, s[24:27], s64 offen offset:1024 sc1 lds
v_mfma_f32_16x16x32_bf16 v[64:67], a[212:215], a[52:55], v[64:67]
s_cselect_b32 s70, s80, s70
v_exp_f32 v45, v45
v_mfma_f32_16x16x32_bf16 v[64:67], a[216:219], a[0:3], v[64:67]
v_cvt_pk_bf16_f32 v124, v44, v45
v_mul_f32 v11, 0x3fb8aa3b, v11
v_mfma_f32_16x16x32_bf16 v[64:67], a[220:223], a[8:11], v[64:67]
v_exp_f32 v46, v46
v_mfma_f32_16x16x32_bf16 v[212:215], a[208:211], a[60:63], v[152:155]
buffer_load_dwordx4 v4, s[24:27], s64 offen offset:2048 sc1 lds
v_mfma_f32_16x16x32_bf16 v[212:215], a[212:215], a[56:59], v[212:215]
v_exp_f32 v47, v47
v_mfma_f32_16x16x32_bf16 v[212:215], a[216:219], a[16:19], v[212:215]
v_cvt_pk_bf16_f32 v125, v46, v47
v_mfma_f32_16x16x32_bf16 v[212:215], a[220:223], a[24:27], v[212:215]
s_waitcnt lgkmcnt(0)
v_exp_f32 v52, v52
v_mfma_f32_16x16x32_bf16 v[60:63], a[64:67], v[248:251], v[60:63]
buffer_load_dwordx4 v4, s[24:27], s64 offen offset:3072 sc1 lds
v_mfma_f32_16x16x32_bf16 v[148:151], a[64:67], v[232:235], v[148:151]
s_mov_b32 m0, s70
v_exp_f32 v53, v53
v_mfma_f32_16x16x32_bf16 v[48:51], a[68:71], v[232:235], v[48:51]
s_mov_b32 s64, s68
ds_read_b128 a[64:67], v5 offset:8192
v_cvt_pk_bf16_f32 v140, v52, v53
v_mfma_f32_16x16x32_bf16 v[68:71], a[68:71], v[248:251], v[68:71]
s_add_u32 s68, s68, 16384
v_exp_f32 v54, v54
v_mfma_f32_16x16x32_bf16 v[72:75], a[72:75], v[248:251], v[72:75]
buffer_load_dwordx4 v4, s[24:27], s64 offen offset:0 sc1 lds
v_mfma_f32_16x16x32_bf16 v[236:239], a[72:75], v[232:235], v[236:239]
s_add_u32 s70, s70, 16384
v_exp_f32 v55, v55
v_mfma_f32_16x16x32_bf16 v[224:227], a[76:79], v[232:235], v[224:227]
ds_read_b128 a[68:71], v5 offset:9216
v_cvt_pk_bf16_f32 v141, v54, v55
v_mfma_f32_16x16x32_bf16 v[220:223], a[76:79], v[248:251], v[220:223]
s_cmp_ge_u32 s70, 163840
v_exp_f32 v64, v64
v_mfma_f32_16x16x32_bf16 v[84:87], a[80:83], v[248:251], v[84:87]
ds_read_b128 a[72:75], v5 offset:10240
v_mfma_f32_16x16x32_bf16 v[164:167], a[80:83], v[232:235], v[164:167]
s_cselect_b32 s70, s80, s70
v_exp_f32 v65, v65
v_mfma_f32_16x16x32_bf16 v[156:159], a[84:87], v[232:235], v[156:159]
ds_read_b128 a[76:79], v5 offset:11264
v_cvt_pk_bf16_f32 v126, v64, v65
v_mfma_f32_16x16x32_bf16 v[76:79], a[84:87], v[248:251], v[76:79]
v_exp_f32 v66, v66
v_mfma_f32_16x16x32_bf16 v[160:163], a[88:91], v[248:251], v[160:163]
buffer_load_dwordx4 v4, s[24:27], s64 offen offset:1024 sc1 lds
v_mfma_f32_16x16x32_bf16 v[216:219], a[88:91], v[232:235], v[216:219]
s_add_u32 s52, s79, 4096
v_exp_f32 v67, v67
v_mfma_f32_16x16x32_bf16 v[208:211], a[92:95], v[232:235], v[208:211]
ds_read_b128 a[80:83], v5 offset:12288
v_cvt_pk_bf16_f32 v127, v66, v67
v_mfma_f32_16x16x32_bf16 v[252:255], a[92:95], v[248:251], v[252:255]
v_exp_f32 v212, v212
v_mfma_f32_16x16x32_bf16 a[232:235], a[240:243], v[248:251], a[232:235]
ds_read_b128 a[84:87], v5 offset:13312
ds_read_b128 a[88:91], v5 offset:14336
v_mfma_f32_16x16x32_bf16 a[236:239], a[240:243], v[232:235], a[236:239]
ds_read_b128 a[92:95], v5 offset:15360
v_exp_f32 v213, v213
v_exp_f32 v214, v214
v_exp_f32 v215, v215
v_exp_f32 v10, v10
v_cvt_pk_bf16_f32 v142, v212, v213
v_cvt_pk_bf16_f32 v143, v214, v215
v_exp_f32 v11, v11
s_waitcnt lgkmcnt(0)
v_mfma_f32_16x16x32_bf16 a[232:235], a[240:243], v[124:127], a[232:235]
buffer_load_dwordx4 v4, s[24:27], s64 offen offset:2048 sc1 lds
v_mfma_f32_16x16x32_bf16 a[236:239], a[240:243], v[140:143], a[236:239]
s_barrier
v_mfma_f32_16x16x32_bf16 v[60:63], a[64:67], v[124:127], v[60:63]
v_cmp_eq_u32 vcc, 0, v3
v_mul_u32_u24 v244, 1536, v3
v_mfma_f32_16x16x32_bf16 v[148:151], a[64:67], v[140:143], v[148:151]
v_mov_b32 v246, 9728
v_cndmask_b32 v244, v244, v246, vcc
v_mfma_f32_16x16x32_bf16 v[48:51], a[68:71], v[140:143], v[48:51]
buffer_load_dwordx4 v4, s[24:27], s64 offen offset:3072 sc1 lds
v_mfma_f32_16x16x32_bf16 v[68:71], a[68:71], v[124:127], v[68:71]
v_lshl_add_u32 v247, v2, 4, s83
v_mov_b32 v246, 10496
v_mfma_f32_16x16x32_bf16 v[72:75], a[72:75], v[124:127], v[72:75]
v_accvgpr_read_b32 v180, a232
v_accvgpr_read_b32 v182, a236
v_mfma_f32_16x16x32_bf16 v[236:239], a[72:75], v[140:143], v[236:239]
v_cmp_nle_f32 vcc, v180, v7
v_cmp_nle_f32 s[96:97], v182, v7
v_mfma_f32_16x16x32_bf16 v[224:227], a[76:79], v[140:143], v[224:227]
v_fma_f32 v180, v180, v10, v180
v_fma_f32 v182, v182, v11, v182
v_mfma_f32_16x16x32_bf16 v[220:223], a[76:79], v[124:127], v[220:223]
v_rcp_f32 v180, v180
v_mfma_f32_16x16x32_bf16 v[84:87], a[80:83], v[124:127], v[84:87]
s_or_b64 vcc, vcc, s[96:97]
v_rcp_f32 v182, v182
v_mfma_f32_16x16x32_bf16 v[164:167], a[80:83], v[140:143], v[164:167]
v_mul_f32 v60, v180, v60
v_mul_f32 v61, v180, v61
v_mfma_f32_16x16x32_bf16 v[156:159], a[84:87], v[140:143], v[156:159]
v_mul_f32 v62, v180, v62
v_mul_f32 v63, v180, v63
v_mfma_f32_16x16x32_bf16 v[76:79], a[84:87], v[124:127], v[76:79]
v_mul_f32 v68, v180, v68
v_mul_f32 v69, v180, v69
v_mfma_f32_16x16x32_bf16 v[160:163], a[88:91], v[124:127], v[160:163]
v_mul_f32 v70, v180, v70
v_mul_f32 v71, v180, v71
v_mfma_f32_16x16x32_bf16 v[216:219], a[88:91], v[140:143], v[216:219]
v_cvt_pk_bf16_f32 v60, v60, v61
v_cvt_pk_bf16_f32 v61, v62, v63
v_mfma_f32_16x16x32_bf16 v[208:211], a[92:95], v[140:143], v[208:211]
v_cvt_pk_bf16_f32 v62, v68, v69
v_cvt_pk_bf16_f32 v63, v70, v71
v_mfma_f32_16x16x32_bf16 v[252:255], a[92:95], v[124:127], v[252:255]
s_cbranch_vccnz SLOW1
L_EP:
buffer_store_dwordx4 v[60:63], v4, s[24:27], s79 offen offset:0 sc1
v_pk_mul_f32 v[148:149], v[148:149], v[182:183] op_sel_hi:[1,0]
v_pk_mul_f32 v[150:151], v[150:151], v[182:183] op_sel_hi:[1,0]
v_pk_mul_f32 v[48:49], v[48:49], v[182:183] op_sel_hi:[1,0]
v_pk_mul_f32 v[50:51], v[50:51], v[182:183] op_sel_hi:[1,0]
v_cvt_pk_bf16_f32 v148, v148, v149
v_cvt_pk_bf16_f32 v149, v150, v151
v_cvt_pk_bf16_f32 v150, v48, v49
v_cvt_pk_bf16_f32 v151, v50, v51
buffer_store_dwordx4 v[148:151], v4, s[24:27], s79 offen offset:1024 sc1
v_pk_mul_f32 v[72:73], v[72:73], v[180:181] op_sel_hi:[1,0]
v_pk_mul_f32 v[74:75], v[74:75], v[180:181] op_sel_hi:[1,0]
v_pk_mul_f32 v[220:221], v[220:221], v[180:181] op_sel_hi:[1,0]
v_pk_mul_f32 v[222:223], v[222:223], v[180:181] op_sel_hi:[1,0]
v_cvt_pk_bf16_f32 v72, v72, v73
v_cvt_pk_bf16_f32 v73, v74, v75
v_cvt_pk_bf16_f32 v74, v220, v221
v_cvt_pk_bf16_f32 v75, v222, v223
buffer_store_dwordx4 v[72:75], v4, s[24:27], s79 offen offset:2048 sc1
v_pk_mul_f32 v[236:237], v[236:237], v[182:183] op_sel_hi:[1,0]
v_pk_mul_f32 v[238:239], v[238:239], v[182:183] op_sel_hi:[1,0]
v_pk_mul_f32 v[224:225], v[224:225], v[182:183] op_sel_hi:[1,0]
v_pk_mul_f32 v[226:227], v[226:227], v[182:183] op_sel_hi:[1,0]
v_cvt_pk_bf16_f32 v236, v236, v237
v_cvt_pk_bf16_f32 v237, v238, v239
v_cvt_pk_bf16_f32 v238, v224, v225
v_cvt_pk_bf16_f32 v239, v226, v227
buffer_store_dwordx4 v[236:239], v4, s[24:27], s79 offen offset:3072 sc1
v_pk_mul_f32 v[84:85], v[84:85], v[180:181] op_sel_hi:[1,0]
v_pk_mul_f32 v[86:87], v[86:87], v[180:181] op_sel_hi:[1,0]
v_pk_mul_f32 v[76:77], v[76:77], v[180:181] op_sel_hi:[1,0]
v_pk_mul_f32 v[78:79], v[78:79], v[180:181] op_sel_hi:[1,0]
v_cvt_pk_bf16_f32 v84, v84, v85
v_cvt_pk_bf16_f32 v85, v86, v87
v_cvt_pk_bf16_f32 v86, v76, v77
v_cvt_pk_bf16_f32 v87, v78, v79
buffer_store_dwordx4 v[84:87], v4, s[24:27], s52 offen offset:0 sc1
v_pk_mul_f32 v[164:165], v[164:165], v[182:183] op_sel_hi:[1,0]
v_pk_mul_f32 v[166:167], v[166:167], v[182:183] op_sel_hi:[1,0]
v_pk_mul_f32 v[156:157], v[156:157], v[182:183] op_sel_hi:[1,0]
v_pk_mul_f32 v[158:159], v[158:159], v[182:183] op_sel_hi:[1,0]
v_cvt_pk_bf16_f32 v164, v164, v165
v_cvt_pk_bf16_f32 v165, v166, v167
v_cvt_pk_bf16_f32 v166, v156, v157
v_cvt_pk_bf16_f32 v167, v158, v159
buffer_store_dwordx4 v[164:167], v4, s[24:27], s52 offen offset:1024 sc1
v_pk_mul_f32 v[160:161], v[160:161], v[180:181] op_sel_hi:[1,0]
v_pk_mul_f32 v[162:163], v[162:163], v[180:181] op_sel_hi:[1,0]
v_pk_mul_f32 v[252:253], v[252:253], v[180:181] op_sel_hi:[1,0]
v_pk_mul_f32 v[254:255], v[254:255], v[180:181] op_sel_hi:[1,0]
v_cvt_pk_bf16_f32 v160, v160, v161
v_cvt_pk_bf16_f32 v161, v162, v163
v_cvt_pk_bf16_f32 v162, v252, v253
v_cvt_pk_bf16_f32 v163, v254, v255
buffer_store_dwordx4 v[160:163], v4, s[24:27], s52 offen offset:2048 sc1
v_pk_mul_f32 v[216:217], v[216:217], v[182:183] op_sel_hi:[1,0]
v_pk_mul_f32 v[218:219], v[218:219], v[182:183] op_sel_hi:[1,0]
v_pk_mul_f32 v[208:209], v[208:209], v[182:183] op_sel_hi:[1,0]
v_pk_mul_f32 v[210:211], v[210:211], v[182:183] op_sel_hi:[1,0]
v_cvt_pk_bf16_f32 v216, v216, v217
v_cvt_pk_bf16_f32 v217, v218, v219
v_cvt_pk_bf16_f32 v218, v208, v209
v_cvt_pk_bf16_f32 v219, v210, v211
buffer_store_dwordx4 v[216:219], v4, s[24:27], s52 offen offset:3072 sc1
v_cmp_eq_u32 vcc, 3, v3
v_mul_u32_u24 v200, 768, v3
v_add_u32 v200, v200, v247
ds_write_b128 v200, a[244:247] offset:0
v_cndmask_b32 v245, v244, v246, vcc
ds_write_b128 v200, a[248:251] offset:3072
v_add_u32 v247, -1280, v247
ds_write_b128 v200, a[252:255] offset:6144
v_add_u32 v244, v244, v247
v_add_u32 v245, v245, v247
ds_write_b128 v244, a[128:131] offset:0
v_cmp_lt_u32 vcc, 31, v1
ds_write_b128 v245, a[132:135] offset:768
v_and_b32 v202, 31, v1
ds_write_b128 v244, a[136:139] offset:256
v_mov_b32 v200, s66
ds_write_b128 v245, a[140:143] offset:1024
v_mov_b32 v203, s67
ds_write_b128 v244, a[144:147] offset:3840
v_cndmask_b32 v200, v200, v203, vcc
ds_write_b128 v245, a[148:151] offset:4608
v_lshl_add_u32 v200, v200, 5, v202
ds_write_b128 v244, a[152:155] offset:4096
v_lshrrev_b32 v201, 5, v1
ds_write_b128 v245, a[156:159] offset:4864
v_mul_u32_u24 v201, 3840, v201
v_lshl_add_u32 v201, v202, 4, v201
v_add_u32 v201, s83, v201
s_cmp_eq_u32 s76, 0
s_cbranch_scc1 L_SE2
L_LA:
v_mov_b32 v5, v200
v_mov_b32 v6, v201
v_mov_b32 v13, 0
s_lshl_b32 s74, s66, 10
s_lshr_b32 s52, s4, 3
s_lshl_b32 s52, s52, 7
s_add_u32 s74, s74, s52
s_add_u32 s74, s74, 75497472
ds_read_b128 v[16:19], v6 offset:8448
ds_read_b128 v[20:23], v6 offset:9216
ds_read_b128 v[96:99], v6 offset:3328
ds_read_b128 v[32:35], v6 offset:256
ds_read_b128 v[36:39], v6 offset:1024
ds_read_b128 v[100:103], v6 offset:3296
ds_read_b128 v[40:43], v6 offset:224
ds_read_b128 v[44:47], v6 offset:992
ds_read_b128 v[104:107], v6 offset:3264
ds_read_b128 v[48:51], v6 offset:192
ds_read_b128 v[52:55], v6 offset:960
ds_read_b128 v[108:111], v6 offset:3232
ds_read_b128 v[56:59], v6 offset:160
ds_read_b128 v[60:63], v6 offset:928
ds_read_b128 v[112:115], v6 offset:3200
ds_read_b128 v[64:67], v6 offset:128
ds_read_b128 v[68:71], v6 offset:896
ds_read_b128 v[116:119], v6 offset:3168
ds_read_b128 v[72:75], v6 offset:96
ds_read_b128 v[76:79], v6 offset:864
ds_read_b128 v[120:123], v6 offset:3136
ds_read_b128 v[80:83], v6 offset:64
ds_read_b128 v[84:87], v6 offset:832
ds_read_b128 v[124:127], v6 offset:3104
ds_read_b128 v[88:91], v6 offset:32
ds_read_b128 v[92:95], v6 offset:800
ds_read_b128 v[128:131], v6 offset:1792
ds_read_b128 v[132:135], v6 offset:2560
s_waitcnt vmcnt(0)
buffer_atomic_add v1, v0, s[24:27], s74 offen offset:0 sc1
ds_read_b128 v[136:139], v6 offset:1760
ds_read_b128 v[140:143], v6 offset:2528
ds_read_b128 v[144:147], v6 offset:1728
ds_read_b128 v[148:151], v6 offset:2496
ds_read_b128 v[152:155], v6 offset:1696
ds_read_b128 v[156:159], v6 offset:2464
ds_read_b128 v[160:163], v6 offset:1664
ds_read_b128 v[164:167], v6 offset:2432
ds_read_b128 v[168:171], v6 offset:1632
ds_read_b128 v[172:175], v6 offset:2400
ds_read_b128 v[176:179], v6 offset:1600
ds_read_b128 v[180:183], v6 offset:2368
ds_read_b128 v[184:187], v6 offset:1568
ds_read_b128 v[188:191], v6 offset:2336
s_lshr_b32 s52, s3, 1
s_lshl1_add_u32 s72, s85, s52
s_lshl3_add_u32 s75, s72, s84
s_lshl_b32 s75, s75, 7
s_add_u32 s75, s75, 75497472
s_and_b32 s82, s86, 1
s_lshl_b32 s82, s82, 13
s_lshr_b32 s53, s4, 3
s_mul_i32 s53, s53, 75776
s_add_u32 s53, s53, 54525952
s_and_b32 s52, s3, 1
s_lshl_b32 s52, s52, 10
s_add_u32 s52, s52, s53
s_sub_u32 s54, 63, s72
s_mul_i32 s77, s72, 303104
s_add_u32 s77, s77, s52
s_mul_i32 s81, s54, 303104
s_add_u32 s81, s81, s52
s_add_u32 s91, s91, 114688
s_sub_u32 s52, s91, 163840
s_cmp_ge_u32 s91, 163840
s_cselect_b32 s91, s52, s91
v_add_u32 v14, 4096, v4
v_add_u32 v7, s91, v4
s_waitcnt lgkmcnt(0)
s_barrier
s_mov_b32 m0, s70
s_mov_b32 s64, s68
s_add_u32 s68, s68, 16384
s_add_u32 s70, s70, 16384
s_cmp_ge_u32 s70, 163840
s_cselect_b32 s70, s80, s70
buffer_load_dwordx4 v4, s[24:27], s64 offen offset:0 sc1 lds
v_and_b32 v9, 0xffff, v97
v_and_b32 v11, 0xffff0000, v97
v_dot2_f32_bf16 v24, v98, v99, 0
v_dot2_f32_bf16 v25, v102, v99, 0
v_dot2_f32_bf16 v26, v106, v99, 0
v_dot2_f32_bf16 v27, v110, v99, 0
v_dot2_f32_bf16 v28, v114, v99, 0
v_dot2_f32_bf16 v29, v118, v99, 0
v_dot2_f32_bf16 v30, v122, v99, 0
v_dot2_f32_bf16 v31, v126, v99, 0
v_dot2c_f32_bf16 v24, v96, v9
v_dot2c_f32_bf16 v25, v100, v9
v_dot2c_f32_bf16 v26, v104, v9
v_dot2c_f32_bf16 v27, v108, v9
v_dot2c_f32_bf16 v28, v112, v9
buffer_load_dwordx4 v4, s[24:27], s64 offen offset:1024 sc1 lds
v_dot2c_f32_bf16 v29, v116, v9
v_dot2c_f32_bf16 v30, v120, v9
v_dot2c_f32_bf16 v31, v124, v9
v_dot2c_f32_bf16 v24, v16, v32
v_dot2c_f32_bf16 v25, v16, v40
v_dot2c_f32_bf16 v26, v16, v48
v_dot2c_f32_bf16 v27, v16, v56
v_dot2c_f32_bf16 v28, v16, v64
v_dot2c_f32_bf16 v29, v16, v72
v_dot2c_f32_bf16 v30, v16, v80
v_dot2c_f32_bf16 v31, v16, v88
v_dot2c_f32_bf16 v24, v17, v33
v_dot2c_f32_bf16 v25, v17, v41
v_dot2c_f32_bf16 v26, v17, v49
v_dot2c_f32_bf16 v27, v17, v57
buffer_load_dwordx4 v4, s[24:27], s64 offen offset:2048 sc1 lds
v_dot2c_f32_bf16 v28, v17, v65
v_dot2c_f32_bf16 v29, v17, v73
v_dot2c_f32_bf16 v30, v17, v81
v_dot2c_f32_bf16 v31, v17, v89
v_dot2c_f32_bf16 v24, v18, v34
v_dot2c_f32_bf16 v25, v18, v42
v_dot2c_f32_bf16 v26, v18, v50
v_dot2c_f32_bf16 v27, v18, v58
v_dot2c_f32_bf16 v28, v18, v66
v_dot2c_f32_bf16 v29, v18, v74
v_dot2c_f32_bf16 v30, v18, v82
v_dot2c_f32_bf16 v31, v18, v90
v_dot2c_f32_bf16 v24, v19, v35
v_dot2c_f32_bf16 v25, v19, v43
v_dot2c_f32_bf16 v26, v19, v51
buffer_load_dwordx4 v4, s[24:27], s64 offen offset:3072 sc1 lds
v_dot2c_f32_bf16 v27, v19, v59
v_dot2c_f32_bf16 v28, v19, v67
v_dot2c_f32_bf16 v29, v19, v75
v_dot2c_f32_bf16 v30, v19, v83
v_dot2c_f32_bf16 v31, v19, v91
v_dot2c_f32_bf16 v24, v20, v36
v_dot2c_f32_bf16 v25, v20, v44
v_dot2c_f32_bf16 v26, v20, v52
v_dot2c_f32_bf16 v27, v20, v60
v_dot2c_f32_bf16 v28, v20, v68
v_dot2c_f32_bf16 v29, v20, v76
v_dot2c_f32_bf16 v30, v20, v84
v_dot2c_f32_bf16 v31, v20, v92
v_dot2c_f32_bf16 v24, v21, v37
v_dot2c_f32_bf16 v25, v21, v45
s_mov_b32 m0, s70
s_mov_b32 s64, s68
s_add_u32 s68, s68, 16384
s_add_u32 s70, s70, 16384
s_cmp_ge_u32 s70, 163840
s_cselect_b32 s70, s80, s70
buffer_load_dwordx4 v4, s[24:27], s64 offen offset:0 sc1 lds
v_dot2c_f32_bf16 v26, v21, v53
v_dot2c_f32_bf16 v27, v21, v61
v_dot2c_f32_bf16 v28, v21, v69
v_dot2c_f32_bf16 v29, v21, v77
v_dot2c_f32_bf16 v30, v21, v85
v_dot2c_f32_bf16 v31, v21, v93
v_dot2c_f32_bf16 v24, v22, v38
v_dot2c_f32_bf16 v25, v22, v46
v_dot2c_f32_bf16 v26, v22, v54
v_dot2c_f32_bf16 v27, v22, v62
v_dot2c_f32_bf16 v28, v22, v70
v_dot2c_f32_bf16 v29, v22, v78
L_PAD10:
s_cbranch_execz L_MAIN
v_dot2c_f32_bf16 v30, v22, v86
v_dot2c_f32_bf16 v31, v22, v94
v_dot2c_f32_bf16 v24, v23, v39
buffer_load_dwordx4 v4, s[24:27], s64 offen offset:1024 sc1 lds
v_dot2c_f32_bf16 v25, v23, v47
v_dot2c_f32_bf16 v26, v23, v55
v_dot2c_f32_bf16 v27, v23, v63
v_dot2c_f32_bf16 v28, v23, v71
v_dot2c_f32_bf16 v29, v23, v79
v_dot2c_f32_bf16 v30, v23, v87
v_dot2c_f32_bf16 v31, v23, v95
v_mov_b32 v9, 0xf149f2ca
v_mul_f32 v11, 0xbfb8aa3b, v11
v_exp_f32 v11, v11
v_cmp_gt_u32 vcc, 2, v5
v_cmp_gt_u32 s[56:57], 4, v5
s_nop 0
v_cndmask_b32 v25, v25, v9, vcc
v_cndmask_b32 v26, v26, v9, s[56:57]
buffer_load_dwordx4 v4, s[24:27], s64 offen offset:2048 sc1 lds
v_cmp_gt_u32 vcc, 6, v5
v_cmp_gt_u32 s[56:57], 8, v5
s_nop 0
v_cndmask_b32 v27, v27, v9, vcc
v_cndmask_b32 v28, v28, v9, s[56:57]
v_cmp_gt_u32 vcc, 10, v5
v_cmp_gt_u32 s[56:57], 12, v5
s_nop 0
v_cndmask_b32 v29, v29, v9, vcc
v_cndmask_b32 v30, v30, v9, s[56:57]
v_cmp_gt_u32 vcc, 14, v5
s_nop 0
s_nop 0
v_cndmask_b32 v31, v31, v9, vcc
v_max3_f32 v10, v24, v25, v26
buffer_load_dwordx4 v4, s[24:27], s64 offen offset:3072 sc1 lds
v_max3_f32 v10, v10, v27, v28
v_max3_f32 v10, v10, v29, v30
v_max_f32 v10, v10, v31
s_mov_b32 s52, 0x3eae1a93
v_sub_f32 v24, v24, v10
v_sub_f32 v25, v25, v10
v_sub_f32 v26, v26, v10
v_sub_f32 v27, v27, v10
v_sub_f32 v28, v28, v10
v_sub_f32 v29, v29, v10
v_sub_f32 v30, v30, v10
v_sub_f32 v31, v31, v10
v_mul_f32 v24, s52, v24
v_mul_f32 v25, s52, v25
v_mul_f32 v26, s52, v26
s_mov_b32 m0, s70
s_mov_b32 s64, s68
s_add_u32 s68, s68, 16384
s_add_u32 s70, s70, 16384
s_cmp_ge_u32 s70, 163840
s_cselect_b32 s70, s80, s70
buffer_load_dwordx4 v4, s[24:27], s64 offen offset:0 sc1 lds
v_mul_f32 v27, s52, v27
v_mul_f32 v28, s52, v28
v_mul_f32 v29, s52, v29
v_mul_f32 v30, s52, v30
v_mul_f32 v31, s52, v31
v_exp_f32 v24, v24
v_exp_f32 v25, v25
v_exp_f32 v26, v26
v_exp_f32 v27, v27
v_exp_f32 v28, v28
v_exp_f32 v29, v29
v_exp_f32 v30, v30
v_exp_f32 v31, v31
v_cvt_pk_bf16_f32 v32, v24, 0
v_cvt_pk_bf16_f32 v40, v25, 0
buffer_load_dwordx4 v4, s[24:27], s64 offen offset:1024 sc1 lds
v_cvt_pk_bf16_f32 v48, v26, 0
v_cvt_pk_bf16_f32 v56, v27, 0
v_cvt_pk_bf16_f32 v64, v28, 0
v_cvt_pk_bf16_f32 v72, v29, 0
v_cvt_pk_bf16_f32 v80, v30, 0
v_cvt_pk_bf16_f32 v88, v31, 0
v_lshlrev_b32 v33, 16, v32
v_lshlrev_b32 v41, 16, v40
v_lshlrev_b32 v49, 16, v48
v_lshlrev_b32 v57, 16, v56
v_lshlrev_b32 v65, 16, v64
v_lshlrev_b32 v73, 16, v72
v_lshlrev_b32 v81, 16, v80
v_lshlrev_b32 v89, 16, v88
v_add_f32 v10, v33, v41
buffer_load_dwordx4 v4, s[24:27], s64 offen offset:2048 sc1 lds
v_add_f32 v10, v10, v49
v_add_f32 v10, v10, v57
v_add_f32 v10, v10, v65
v_add_f32 v10, v10, v73
v_add_f32 v10, v10, v81
v_add_f32 v10, v10, v89
v_fmac_f32 v10, v10, v11
v_rcp_f32 v10, v10
v_dot2_f32_bf16 v192, v128, v32, 0
v_dot2_f32_bf16 v193, v128, v33, 0
v_dot2_f32_bf16 v194, v129, v32, 0
v_dot2_f32_bf16 v195, v129, v33, 0
v_dot2_f32_bf16 v196, v130, v32, 0
v_dot2_f32_bf16 v197, v130, v33, 0
v_dot2_f32_bf16 v198, v131, v32, 0
buffer_load_dwordx4 v4, s[24:27], s64 offen offset:3072 sc1 lds
v_dot2_f32_bf16 v199, v131, v33, 0
v_dot2_f32_bf16 v200, v132, v32, 0
v_dot2_f32_bf16 v201, v132, v33, 0
v_dot2_f32_bf16 v202, v133, v32, 0
v_dot2_f32_bf16 v203, v133, v33, 0
v_dot2_f32_bf16 v204, v134, v32, 0
v_dot2_f32_bf16 v205, v134, v33, 0
v_dot2_f32_bf16 v206, v135, v32, 0
v_dot2_f32_bf16 v207, v135, v33, 0
v_dot2_f32_bf16 v208, v96, v33, 0
v_dot2_f32_bf16 v209, v98, v33, 0
v_dot2c_f32_bf16 v192, v136, v40
v_dot2c_f32_bf16 v193, v136, v41
v_dot2c_f32_bf16 v194, v137, v40
v_dot2c_f32_bf16 v195, v137, v41
s_mov_b32 m0, s70
s_mov_b32 s64, s68
s_add_u32 s68, s68, 16384
s_add_u32 s70, s70, 16384
s_cmp_ge_u32 s70, 163840
s_cselect_b32 s70, s80, s70
buffer_load_dwordx4 v4, s[24:27], s64 offen offset:0 sc1 lds
v_dot2c_f32_bf16 v196, v138, v40
v_dot2c_f32_bf16 v197, v138, v41
v_dot2c_f32_bf16 v198, v139, v40
v_dot2c_f32_bf16 v199, v139, v41
v_dot2c_f32_bf16 v200, v140, v40
v_dot2c_f32_bf16 v201, v140, v41
v_dot2c_f32_bf16 v202, v141, v40
v_dot2c_f32_bf16 v203, v141, v41
v_dot2c_f32_bf16 v204, v142, v40
v_dot2c_f32_bf16 v205, v142, v41
v_dot2c_f32_bf16 v206, v143, v40
v_dot2c_f32_bf16 v207, v143, v41
v_dot2c_f32_bf16 v208, v100, v41
v_dot2c_f32_bf16 v209, v102, v41
v_dot2c_f32_bf16 v192, v144, v48
buffer_load_dwordx4 v4, s[24:27], s64 offen offset:1024 sc1 lds
v_dot2c_f32_bf16 v193, v144, v49
v_dot2c_f32_bf16 v194, v145, v48
v_dot2c_f32_bf16 v195, v145, v49
v_dot2c_f32_bf16 v196, v146, v48
v_dot2c_f32_bf16 v197, v146, v49
v_dot2c_f32_bf16 v198, v147, v48
v_dot2c_f32_bf16 v199, v147, v49
v_dot2c_f32_bf16 v200, v148, v48
v_dot2c_f32_bf16 v201, v148, v49
v_dot2c_f32_bf16 v202, v149, v48
v_dot2c_f32_bf16 v203, v149, v49
v_dot2c_f32_bf16 v204, v150, v48
v_dot2c_f32_bf16 v205, v150, v49
v_dot2c_f32_bf16 v206, v151, v48
v_dot2c_f32_bf16 v207, v151, v49
buffer_load_dwordx4 v4, s[24:27], s64 offen offset:2048 sc1 lds
v_dot2c_f32_bf16 v208, v104, v49
v_dot2c_f32_bf16 v209, v106, v49
v_dot2c_f32_bf16 v192, v152, v56
v_dot2c_f32_bf16 v193, v152, v57
v_dot2c_f32_bf16 v194, v153, v56
v_dot2c_f32_bf16 v195, v153, v57
v_dot2c_f32_bf16 v196, v154, v56
v_dot2c_f32_bf16 v197, v154, v57
v_dot2c_f32_bf16 v198, v155, v56
v_dot2c_f32_bf16 v199, v155, v57
v_dot2c_f32_bf16 v200, v156, v56
v_dot2c_f32_bf16 v201, v156, v57
v_dot2c_f32_bf16 v202, v157, v56
v_dot2c_f32_bf16 v203, v157, v57
v_dot2c_f32_bf16 v204, v158, v56
buffer_load_dword v12, v13, s[24:27], s75 offen sc1
v_dot2c_f32_bf16 v205, v158, v57
v_dot2c_f32_bf16 v206, v159, v56
v_dot2c_f32_bf16 v207, v159, v57
v_dot2c_f32_bf16 v208, v108, v57
v_dot2c_f32_bf16 v209, v110, v57
v_dot2c_f32_bf16 v192, v160, v64
v_dot2c_f32_bf16 v193, v160, v65
v_dot2c_f32_bf16 v194, v161, v64
v_dot2c_f32_bf16 v195, v161, v65
v_dot2c_f32_bf16 v196, v162, v64
v_dot2c_f32_bf16 v197, v162, v65
v_dot2c_f32_bf16 v198, v163, v64
v_dot2c_f32_bf16 v199, v163, v65
v_dot2c_f32_bf16 v200, v164, v64
v_dot2c_f32_bf16 v201, v164, v65
buffer_load_dwordx4 v4, s[24:27], s64 offen offset:3072 sc1 lds
v_dot2c_f32_bf16 v202, v165, v64
v_dot2c_f32_bf16 v203, v165, v65
v_dot2c_f32_bf16 v204, v166, v64
v_dot2c_f32_bf16 v205, v166, v65
v_dot2c_f32_bf16 v206, v167, v64
v_dot2c_f32_bf16 v207, v167, v65
v_dot2c_f32_bf16 v208, v112, v65
v_dot2c_f32_bf16 v209, v114, v65
v_dot2c_f32_bf16 v192, v168, v72
v_dot2c_f32_bf16 v193, v168, v73
v_dot2c_f32_bf16 v194, v169, v72
v_dot2c_f32_bf16 v195, v169, v73
v_dot2c_f32_bf16 v196, v170, v72
v_dot2c_f32_bf16 v197, v170, v73
v_dot2c_f32_bf16 v198, v171, v72
s_mov_b32 m0, s70
s_mov_b32 s64, s68
s_add_u32 s68, s68, 16384
s_add_u32 s70, s70, 16384
s_cmp_ge_u32 s70, 163840
s_cselect_b32 s70, s80, s70
buffer_load_dwordx4 v4, s[24:27], s64 offen offset:0 sc1 lds
v_dot2c_f32_bf16 v199, v171, v73
v_dot2c_f32_bf16 v200, v172, v72
v_dot2c_f32_bf16 v201, v172, v73
v_dot2c_f32_bf16 v202, v173, v72
v_dot2c_f32_bf16 v203, v173, v73
v_dot2c_f32_bf16 v204, v174, v72
v_dot2c_f32_bf16 v205, v174, v73
v_dot2c_f32_bf16 v206, v175, v72
v_dot2c_f32_bf16 v207, v175, v73
v_dot2c_f32_bf16 v208, v116, v73
v_dot2c_f32_bf16 v209, v118, v73
v_dot2c_f32_bf16 v192, v176, v80
v_dot2c_f32_bf16 v193, v176, v81
v_dot2c_f32_bf16 v194, v177, v80
v_dot2c_f32_bf16 v195, v177, v81
buffer_load_dwordx4 v4, s[24:27], s64 offen offset:1024 sc1 lds
v_dot2c_f32_bf16 v196, v178, v80
v_dot2c_f32_bf16 v197, v178, v81
v_dot2c_f32_bf16 v198, v179, v80
v_dot2c_f32_bf16 v199, v179, v81
v_dot2c_f32_bf16 v200, v180, v80
v_dot2c_f32_bf16 v201, v180, v81
v_dot2c_f32_bf16 v202, v181, v80
v_dot2c_f32_bf16 v203, v181, v81
v_dot2c_f32_bf16 v204, v182, v80
v_dot2c_f32_bf16 v205, v182, v81
v_dot2c_f32_bf16 v206, v183, v80
v_dot2c_f32_bf16 v207, v183, v81
v_dot2c_f32_bf16 v208, v120, v81
v_dot2c_f32_bf16 v209, v122, v81
v_dot2c_f32_bf16 v192, v184, v88
buffer_load_dwordx4 v4, s[24:27], s64 offen offset:2048 sc1 lds
v_dot2c_f32_bf16 v193, v184, v89
v_dot2c_f32_bf16 v194, v185, v88
v_dot2c_f32_bf16 v195, v185, v89
v_dot2c_f32_bf16 v196, v186, v88
v_dot2c_f32_bf16 v197, v186, v89
v_dot2c_f32_bf16 v198, v187, v88
v_dot2c_f32_bf16 v199, v187, v89
v_dot2c_f32_bf16 v200, v188, v88
v_dot2c_f32_bf16 v201, v188, v89
v_dot2c_f32_bf16 v202, v189, v88
v_dot2c_f32_bf16 v203, v189, v89
v_dot2c_f32_bf16 v204, v190, v88
v_dot2c_f32_bf16 v205, v190, v89
v_dot2c_f32_bf16 v206, v191, v88
v_dot2c_f32_bf16 v207, v191, v89
buffer_load_dwordx4 v4, s[24:27], s64 offen offset:3072 sc1 lds
v_dot2c_f32_bf16 v208, v124, v89
v_dot2c_f32_bf16 v209, v126, v89
v_lshrrev_b32 v9, 5, v5
v_mul_u32_u24 v9, 303104, v9
v_and_b32 v11, 1, v3
v_lshl_add_u32 v9, v11, 10, v9
v_lshl_add_u32 v9, v2, 4, v9
v_mul_f32 v192, v10, v192
v_mul_f32 v193, v10, v193
v_mul_f32 v194, v10, v194
v_mul_f32 v195, v10, v195
v_mul_f32 v196, v10, v196
v_mul_f32 v197, v10, v197
v_mul_f32 v198, v10, v198
v_mul_f32 v199, v10, v199
v_mul_f32 v200, v10, v200
v_mul_f32 v201, v10, v201
v_mul_f32 v202, v10, v202
v_mul_f32 v203, v10, v203
v_mul_f32 v204, v10, v204
v_mul_f32 v205, v10, v205
v_mul_f32 v206, v10, v206
v_mul_f32 v207, v10, v207
v_mul_f32 v208, v10, v208
v_mul_f32 v209, v10, v209
v_cvt_pk_bf16_f32 v192, v192, v193
v_cvt_pk_bf16_f32 v193, v194, v195
v_cvt_pk_bf16_f32 v194, v196, v197
v_cvt_pk_bf16_f32 v195, v198, v199
v_cvt_pk_bf16_f32 v196, v200, v201
v_cvt_pk_bf16_f32 v197, v202, v203
v_cvt_pk_bf16_f32 v198, v204, v205
v_cvt_pk_bf16_f32 v199, v206, v207
v_cvt_pk_bf16_f32 v200, v208, v209
s_add_u32 s53, s53, 65536
s_bfe_u32 s54, s4, 131073
s_lshl_b32 s54, s54, 11
s_add_u32 s54, s54, s53
s_and_b32 s55, s4, 1
s_lshl_b32 s55, s55, 9
s_add_u32 s54, s54, s55
s_lshl2_add_u32 s52, s85, s86
s_lshl2_add_u32 s69, s52, s3
s_mul_i32 s69, s69, 28672
s_add_u32 s69, s69, 76546048
s_lshr_b32 s73, s52, 1
s_lshl_b32 s73, s73, 10
s_and_b32 s52, s52, 1
s_lshl_b32 s52, s52, 7
s_add_u32 s73, s73, s52
s_lshl2_add_u32 s73, s3, s73
s_add_u32 s73, s73, 75498112
ds_read_b128 v[144:147], v7 offset:0
ds_read_b128 v[148:151], v7 offset:1024
ds_read_b128 v[152:155], v7 offset:2048
ds_read_b128 v[156:159], v7 offset:3072
ds_read_b128 v[160:163], v7 offset:4096
ds_read_b128 v[164:167], v7 offset:5120
ds_read_b128 v[168:171], v7 offset:6144
ds_read_b128 v[172:175], v7 offset:7168
v_mov_b32 v10, 0
s_waitcnt vmcnt(5)
v_cmp_gt_u32 vcc, 8, v12
s_mov_b32 s92, 0
s_nop 3
s_cbranch_vccz L_ZBX
L_ZB:
s_sleep 2
buffer_load_dword v12, v13, s[24:27], s75 offen sc1
s_add_u32 s92, s92, 1
s_waitcnt vmcnt(0)
v_cmp_gt_u32 vcc, 8, v12
s_cmp_gt_u32 s92, 1048576
s_cbranch_scc1 L_ZBX
s_nop 2
s_cbranch_vccnz L_ZB
L_ZBX:
s_xor_b32 s65, s82, 0
s_add_u32 s65, s65, s77
buffer_load_dwordx4 a[0:3], v4, s[24:27], s65 offen offset:0 sc1
buffer_load_dwordx4 a[8:11], v4, s[24:27], s65 offen offset:2048 sc1
s_xor_b32 s93, s82, 0
s_add_u32 s93, s93, s81
buffer_load_dwordx4 a[4:7], v4, s[24:27], s93 offen offset:0 sc1
buffer_load_dwordx4 a[12:15], v4, s[24:27], s93 offen offset:2048 sc1
buffer_load_dwordx4 a[16:19], v14, s[24:27], s65 offen offset:0 sc1
buffer_load_dwordx4 a[24:27], v14, s[24:27], s65 offen offset:2048 sc1
buffer_load_dwordx4 a[20:23], v14, s[24:27], s93 offen offset:0 sc1
buffer_load_dwordx4 a[28:31], v14, s[24:27], s93 offen offset:2048 sc1
buffer_store_dwordx4 v[192:195], v9, s[24:27], s54 offen sc1
buffer_store_dwordx4 v[196:199], v9, s[24:27], s54 offen offset:256 sc1
s_bfe_u32 s55, s4, 65538
s_lshl_b32 s55, s55, 8
s_add_u32 s54, s53, s55
s_and_b32 s55, s4, 3
s_lshl2_add_u32 s54, s55, s54
s_add_u32 s54, s54, 8192
buffer_store_dword v200, v9, s[24:27], s54 offen sc1
s_waitcnt vmcnt(9) lgkmcnt(6)
v_mfma_f32_16x16x32_bf16 v[120:123], v[144:147], a[0:3], 0
s_waitcnt vmcnt(7)
s_add_u32 s91, s91, 16384
ds_read_b128 v[176:179], v7 offset:8192
v_mfma_f32_16x16x32_bf16 v[120:123], v[148:151], a[8:11], v[120:123]
s_xor_b32 s65, s82, 8192
s_add_u32 s65, s65, s77
ds_read_b128 v[180:183], v7 offset:9216
v_mfma_f32_16x16x32_bf16 v[124:127], v[148:151], a[12:15], 0
s_waitcnt lgkmcnt(6)
ds_read_b128 v[184:187], v7 offset:10240
v_mfma_f32_16x16x32_bf16 v[124:127], v[144:147], a[4:7], v[124:127]
buffer_load_dwordx4 a[32:35], v4, s[24:27], s65 offen offset:0 sc1
v_mfma_f32_16x16x32_bf16 v[72:75], v[152:155], a[0:3], 0
s_cmp_ge_u32 s91, 163840
s_cselect_b32 s91, 0, s91
ds_read_b128 v[188:191], v7 offset:11264
v_mfma_f32_16x16x32_bf16 v[72:75], v[156:159], a[8:11], v[72:75]
s_waitcnt lgkmcnt(6)
v_add_u32 v8, s91, v4
v_mfma_f32_16x16x32_bf16 v[76:79], v[156:159], a[12:15], 0
buffer_load_dwordx4 a[40:43], v4, s[24:27], s65 offen offset:2048 sc1
v_mfma_f32_16x16x32_bf16 v[76:79], v[152:155], a[4:7], v[76:79]
s_xor_b32 s93, s82, 8192
s_add_u32 s93, s93, s81
ds_read_b128 v[144:147], v7 offset:12288
v_mfma_f32_16x16x32_bf16 v[80:83], v[160:163], a[0:3], 0
ds_read_b128 v[148:151], v7 offset:13312
v_mfma_f32_16x16x32_bf16 v[80:83], v[164:167], a[8:11], v[80:83]
buffer_load_dwordx4 a[36:39], v4, s[24:27], s93 offen offset:0 sc1
v_mfma_f32_16x16x32_bf16 v[84:87], v[164:167], a[12:15], 0
ds_read_b128 v[152:155], v7 offset:14336
v_mfma_f32_16x16x32_bf16 v[84:87], v[160:163], a[4:7], v[84:87]
s_waitcnt lgkmcnt(7)
v_mfma_f32_16x16x32_bf16 v[88:91], v[168:171], a[0:3], 0
buffer_load_dwordx4 a[44:47], v4, s[24:27], s93 offen offset:2048 sc1
v_mfma_f32_16x16x32_bf16 v[88:91], v[172:175], a[8:11], v[88:91]
ds_read_b128 v[156:159], v7 offset:15360
v_mfma_f32_16x16x32_bf16 v[92:95], v[172:175], a[12:15], 0
s_waitcnt lgkmcnt(6)
s_add_u32 s91, s91, 16384
ds_read_b128 v[160:163], v8 offset:0
v_mfma_f32_16x16x32_bf16 v[92:95], v[168:171], a[4:7], v[92:95]
buffer_load_dwordx4 a[48:51], v14, s[24:27], s65 offen offset:0 sc1
v_mfma_f32_16x16x32_bf16 v[96:99], v[176:179], a[0:3], 0
s_cmp_ge_u32 s91, 163840
s_cselect_b32 s91, 0, s91
ds_read_b128 v[164:167], v8 offset:1024
v_mfma_f32_16x16x32_bf16 v[96:99], v[180:183], a[8:11], v[96:99]
v_add_u32 v7, s91, v4
v_mfma_f32_16x16x32_bf16 v[100:103], v[180:183], a[12:15], 0
buffer_load_dwordx4 a[56:59], v14, s[24:27], s65 offen offset:2048 sc1
v_mfma_f32_16x16x32_bf16 v[100:103], v[176:179], a[4:7], v[100:103]
s_waitcnt lgkmcnt(6)
ds_read_b128 v[168:171], v8 offset:2048
v_mfma_f32_16x16x32_bf16 v[104:107], v[184:187], a[0:3], 0
ds_read_b128 v[172:175], v8 offset:3072
v_mfma_f32_16x16x32_bf16 v[104:107], v[188:191], a[8:11], v[104:107]
v_mfma_f32_16x16x32_bf16 v[108:111], v[188:191], a[12:15], 0
buffer_load_dwordx4 a[52:55], v14, s[24:27], s93 offen offset:0 sc1
v_mfma_f32_16x16x32_bf16 v[108:111], v[184:187], a[4:7], v[108:111]
s_waitcnt lgkmcnt(6)
ds_read_b128 v[176:179], v8 offset:4096
v_mfma_f32_16x16x32_bf16 v[112:115], v[144:147], a[0:3], 0
ds_read_b128 v[180:183], v8 offset:5120
v_mfma_f32_16x16x32_bf16 v[112:115], v[148:151], a[8:11], v[112:115]
v_mfma_f32_16x16x32_bf16 v[116:119], v[148:151], a[12:15], 0
buffer_load_dwordx4 a[60:63], v14, s[24:27], s93 offen offset:2048 sc1
v_mfma_f32_16x16x32_bf16 v[116:119], v[144:147], a[4:7], v[116:119]
s_waitcnt lgkmcnt(6) vmcnt(13)
ds_read_b128 v[184:187], v8 offset:6144
v_mfma_f32_16x16x32_bf16 v[120:123], v[152:155], a[16:19], v[120:123]
ds_read_b128 v[188:191], v8 offset:7168
v_mfma_f32_16x16x32_bf16 v[120:123], v[156:159], a[24:27], v[120:123]
s_waitcnt vmcnt(11)
v_mfma_f32_16x16x32_bf16 v[124:127], v[156:159], a[28:31], v[124:127]
ds_read_b128 v[144:147], v8 offset:8192
v_mfma_f32_16x16x32_bf16 v[124:127], v[152:155], a[20:23], v[124:127]
s_waitcnt lgkmcnt(7)
v_mfma_f32_16x16x32_bf16 v[72:75], v[160:163], a[16:19], v[72:75]
ds_read_b128 v[148:151], v8 offset:9216
v_mfma_f32_16x16x32_bf16 v[72:75], v[164:167], a[24:27], v[72:75]
v_mfma_f32_16x16x32_bf16 v[76:79], v[164:167], a[28:31], v[76:79]
ds_read_b128 v[152:155], v8 offset:10240
v_mfma_f32_16x16x32_bf16 v[76:79], v[160:163], a[20:23], v[76:79]
s_waitcnt lgkmcnt(7)
v_mfma_f32_16x16x32_bf16 v[80:83], v[168:171], a[16:19], v[80:83]
ds_read_b128 v[156:159], v8 offset:11264
v_mfma_f32_16x16x32_bf16 v[80:83], v[172:175], a[24:27], v[80:83]
v_mfma_f32_16x16x32_bf16 v[84:87], v[172:175], a[28:31], v[84:87]
ds_read_b128 v[160:163], v8 offset:12288
v_mfma_f32_16x16x32_bf16 v[84:87], v[168:171], a[20:23], v[84:87]
s_waitcnt lgkmcnt(7)
v_mfma_f32_16x16x32_bf16 v[88:91], v[176:179], a[16:19], v[88:91]
s_xor_b32 s65, s82, 16384
s_add_u32 s65, s65, s77
ds_read_b128 v[164:167], v8 offset:13312
v_mfma_f32_16x16x32_bf16 v[88:91], v[180:183], a[24:27], v[88:91]
v_mfma_f32_16x16x32_bf16 v[92:95], v[180:183], a[28:31], v[92:95]
s_waitcnt lgkmcnt(6)
ds_read_b128 v[168:171], v8 offset:14336
v_add_u32 v11, s70, v4
v_mfma_f32_16x16x32_bf16 v[92:95], v[176:179], a[20:23], v[92:95]
s_add_u32 s70, s70, 16384
s_cmp_ge_u32 s70, 163840
s_cselect_b32 s70, s80, s70
v_mfma_f32_16x16x32_bf16 v[96:99], v[184:187], a[16:19], v[96:99]
buffer_load_dwordx4 a[64:67], v4, s[24:27], s65 offen offset:0 sc1
v_mfma_f32_16x16x32_bf16 v[96:99], v[188:191], a[24:27], v[96:99]
s_barrier
v_mfma_f32_16x16x32_bf16 v[100:103], v[188:191], a[28:31], v[100:103]
s_waitcnt lgkmcnt(5)
ds_read_b128 v[172:175], v8 offset:15360
v_mfma_f32_16x16x32_bf16 v[100:103], v[184:187], a[20:23], v[100:103]
buffer_load_dwordx4 a[72:75], v4, s[24:27], s65 offen offset:2048 sc1
v_mfma_f32_16x16x32_bf16 v[104:107], v[144:147], a[16:19], v[104:107]
ds_write_b64 v11, a[96:97] offset:0
v_mfma_f32_16x16x32_bf16 v[104:107], v[148:151], a[24:27], v[104:107]
s_xor_b32 s93, s82, 16384
s_add_u32 s93, s93, s81
ds_read_b128 v[176:179], v7 offset:0
v_mfma_f32_16x16x32_bf16 v[108:111], v[148:151], a[28:31], v[108:111]
buffer_load_dwordx4 a[68:71], v4, s[24:27], s93 offen offset:0 sc1
v_mfma_f32_16x16x32_bf16 v[108:111], v[144:147], a[20:23], v[108:111]
s_waitcnt lgkmcnt(6)
s_add_u32 s91, s91, 16384
ds_read_b128 v[180:183], v7 offset:1024
v_mfma_f32_16x16x32_bf16 v[112:115], v[152:155], a[16:19], v[112:115]
ds_write_b64 v11, a[98:99] offset:8
v_mfma_f32_16x16x32_bf16 v[112:115], v[156:159], a[24:27], v[112:115]
s_cmp_ge_u32 s91, 163840
s_cselect_b32 s91, 0, s91
ds_read_b128 v[184:187], v7 offset:2048
v_mfma_f32_16x16x32_bf16 v[116:119], v[156:159], a[28:31], v[116:119]
buffer_load_dwordx4 a[76:79], v4, s[24:27], s93 offen offset:2048 sc1
v_mfma_f32_16x16x32_bf16 v[116:119], v[152:155], a[20:23], v[116:119]
s_waitcnt lgkmcnt(7) vmcnt(10)
ds_read_b128 v[188:191], v7 offset:3072
v_add_u32 v8, s91, v4
v_mfma_f32_16x16x32_bf16 v[120:123], v[160:163], a[32:35], v[120:123]
s_waitcnt vmcnt(12)
s_waitcnt vmcnt(8)
ds_read_b128 v[144:147], v7 offset:4096
v_mfma_f32_16x16x32_bf16 v[120:123], v[164:167], a[40:43], v[120:123]
buffer_atomic_add v1, v0, s[24:27], s74 offen offset:4 sc1
v_mfma_f32_16x16x32_bf16 v[124:127], v[164:167], a[44:47], v[124:127]
ds_write_b64 v11, a[100:101] offset:1024
v_mfma_f32_16x16x32_bf16 v[124:127], v[160:163], a[36:39], v[124:127]
s_waitcnt lgkmcnt(8)
ds_read_b128 v[148:151], v7 offset:5120
v_mfma_f32_16x16x32_bf16 v[72:75], v[168:171], a[32:35], v[72:75]
ds_read_b128 v[152:155], v7 offset:6144
v_mfma_f32_16x16x32_bf16 v[72:75], v[172:175], a[40:43], v[72:75]
ds_read_b128 v[156:159], v7 offset:7168
v_mfma_f32_16x16x32_bf16 v[76:79], v[172:175], a[44:47], v[76:79]
ds_write_b64 v11, a[102:103] offset:1032
v_mfma_f32_16x16x32_bf16 v[76:79], v[168:171], a[36:39], v[76:79]
s_waitcnt lgkmcnt(9)
ds_read_b128 v[160:163], v7 offset:8192
v_mfma_f32_16x16x32_bf16 v[80:83], v[176:179], a[32:35], v[80:83]
ds_read_b128 v[164:167], v7 offset:9216
v_mfma_f32_16x16x32_bf16 v[80:83], v[180:183], a[40:43], v[80:83]
v_mfma_f32_16x16x32_bf16 v[84:87], v[180:183], a[44:47], v[84:87]
ds_write_b64 v11, a[104:105] offset:2048
v_mfma_f32_16x16x32_bf16 v[84:87], v[176:179], a[36:39], v[84:87]
s_waitcnt lgkmcnt(9)
ds_read_b128 v[168:171], v7 offset:10240
v_mfma_f32_16x16x32_bf16 v[88:91], v[184:187], a[32:35], v[88:91]
ds_read_b128 v[172:175], v7 offset:11264
v_mfma_f32_16x16x32_bf16 v[88:91], v[188:191], a[40:43], v[88:91]
s_waitcnt lgkmcnt(8)
v_mfma_f32_16x16x32_bf16 v[92:95], v[188:191], a[44:47], v[92:95]
ds_write_b64 v11, a[106:107] offset:2056
v_mfma_f32_16x16x32_bf16 v[92:95], v[184:187], a[36:39], v[92:95]
buffer_load_dwordx4 a[80:83], v14, s[24:27], s65 offen offset:0 sc1
v_mfma_f32_16x16x32_bf16 v[96:99], v[144:147], a[32:35], v[96:99]
ds_read_b128 v[176:179], v7 offset:12288
v_mfma_f32_16x16x32_bf16 v[96:99], v[148:151], a[40:43], v[96:99]
s_waitcnt lgkmcnt(8)
ds_read_b128 v[180:183], v7 offset:13312
v_mfma_f32_16x16x32_bf16 v[100:103], v[148:151], a[44:47], v[100:103]
ds_write_b64 v11, a[108:109] offset:3072
v_mfma_f32_16x16x32_bf16 v[100:103], v[144:147], a[36:39], v[100:103]
buffer_load_dwordx4 a[88:91], v14, s[24:27], s65 offen offset:2048 sc1
v_mfma_f32_16x16x32_bf16 v[104:107], v[152:155], a[32:35], v[104:107]
ds_read_b128 v[184:187], v7 offset:14336
v_mfma_f32_16x16x32_bf16 v[104:107], v[156:159], a[40:43], v[104:107]
s_waitcnt lgkmcnt(8)
ds_read_b128 v[188:191], v7 offset:15360
v_mfma_f32_16x16x32_bf16 v[108:111], v[156:159], a[44:47], v[108:111]
ds_write_b64 v11, a[110:111] offset:3080
v_mfma_f32_16x16x32_bf16 v[108:111], v[152:155], a[36:39], v[108:111]
buffer_load_dwordx4 a[84:87], v14, s[24:27], s93 offen offset:0 sc1
v_mfma_f32_16x16x32_bf16 v[112:115], v[160:163], a[32:35], v[112:115]
s_add_u32 s91, s91, 16384
ds_read_b128 v[144:147], v8 offset:0
v_mfma_f32_16x16x32_bf16 v[112:115], v[164:167], a[40:43], v[112:115]
s_cmp_ge_u32 s91, 163840
s_cselect_b32 s91, 0, s91
ds_read_b128 v[148:151], v8 offset:1024
v_mfma_f32_16x16x32_bf16 v[116:119], v[164:167], a[44:47], v[116:119]
buffer_load_dwordx4 a[92:95], v14, s[24:27], s93 offen offset:2048 sc1
v_mfma_f32_16x16x32_bf16 v[116:119], v[160:163], a[36:39], v[116:119]
s_waitcnt lgkmcnt(9) vmcnt(11)
ds_read_b128 v[152:155], v8 offset:2048
v_add_u32 v7, s91, v4
v_mfma_f32_16x16x32_bf16 v[120:123], v[168:171], a[48:51], v[120:123]
ds_read_b128 v[156:159], v8 offset:3072
v_mfma_f32_16x16x32_bf16 v[120:123], v[172:175], a[56:59], v[120:123]
s_waitcnt vmcnt(9)
v_mfma_f32_16x16x32_bf16 v[124:127], v[172:175], a[60:63], v[124:127]
ds_read_b128 v[160:163], v8 offset:4096
v_mfma_f32_16x16x32_bf16 v[124:127], v[168:171], a[52:55], v[124:127]
s_waitcnt lgkmcnt(9)
v_mfma_f32_16x16x32_bf16 v[72:75], v[176:179], a[48:51], v[72:75]
ds_read_b128 v[164:167], v8 offset:5120
v_mfma_f32_16x16x32_bf16 v[72:75], v[180:183], a[56:59], v[72:75]
v_mfma_f32_16x16x32_bf16 v[76:79], v[180:183], a[60:63], v[76:79]
ds_read_b128 v[168:171], v8 offset:6144
v_mfma_f32_16x16x32_bf16 v[76:79], v[176:179], a[52:55], v[76:79]
s_xor_b32 s65, s82, 24576
s_add_u32 s65, s65, s77
s_waitcnt lgkmcnt(8)
v_mfma_f32_16x16x32_bf16 v[80:83], v[184:187], a[48:51], v[80:83]
ds_read_b128 v[172:175], v8 offset:7168
v_mfma_f32_16x16x32_bf16 v[80:83], v[188:191], a[56:59], v[80:83]
buffer_load_dwordx4 a[192:195], v4, s[24:27], s65 offen offset:0 sc1
v_mfma_f32_16x16x32_bf16 v[84:87], v[188:191], a[60:63], v[84:87]
ds_read_b128 v[176:179], v8 offset:8192
v_mfma_f32_16x16x32_bf16 v[84:87], v[184:187], a[52:55], v[84:87]
s_waitcnt lgkmcnt(7)
v_mfma_f32_16x16x32_bf16 v[88:91], v[144:147], a[48:51], v[88:91]
ds_read_b128 v[180:183], v8 offset:9216
v_mfma_f32_16x16x32_bf16 v[88:91], v[148:151], a[56:59], v[88:91]
v_mfma_f32_16x16x32_bf16 v[92:95], v[148:151], a[60:63], v[92:95]
s_waitcnt lgkmcnt(6)
ds_read_b128 v[184:187], v8 offset:10240
v_mfma_f32_16x16x32_bf16 v[92:95], v[144:147], a[52:55], v[92:95]
buffer_load_dwordx4 a[200:203], v4, s[24:27], s65 offen offset:2048 sc1
v_mfma_f32_16x16x32_bf16 v[96:99], v[152:155], a[48:51], v[96:99]
s_add_u32 s52, s84, 1
ds_read_b128 v[188:191], v8 offset:11264
v_mfma_f32_16x16x32_bf16 v[96:99], v[156:159], a[56:59], v[96:99]
v_mfma_f32_16x16x32_bf16 v[100:103], v[156:159], a[60:63], v[100:103]
s_xor_b32 s93, s82, 24576
s_add_u32 s93, s93, s81
ds_read_b128 v[144:147], v8 offset:12288
v_mfma_f32_16x16x32_bf16 v[100:103], v[152:155], a[52:55], v[100:103]
s_and_b32 s52, s52, 3
s_waitcnt lgkmcnt(7)
v_mfma_f32_16x16x32_bf16 v[104:107], v[160:163], a[48:51], v[104:107]
buffer_load_dwordx4 a[196:199], v4, s[24:27], s93 offen offset:0 sc1
v_mfma_f32_16x16x32_bf16 v[104:107], v[164:167], a[56:59], v[104:107]
s_waitcnt lgkmcnt(5)
ds_read_b128 v[148:151], v8 offset:13312
v_mfma_f32_16x16x32_bf16 v[108:111], v[164:167], a[60:63], v[108:111]
s_mul_i32 s52, s52, 6144
ds_read_b128 v[152:155], v8 offset:14336
v_add_u32 v11, s70, v4
v_mfma_f32_16x16x32_bf16 v[108:111], v[160:163], a[52:55], v[108:111]
s_add_u32 s70, s70, 16384
s_cmp_ge_u32 s70, 163840
s_cselect_b32 s70, s80, s70
v_mfma_f32_16x16x32_bf16 v[112:115], v[168:171], a[48:51], v[112:115]
s_waitcnt vmcnt(48)
ds_read_b128 v[156:159], v8 offset:15360
v_mfma_f32_16x16x32_bf16 v[112:115], v[172:175], a[56:59], v[112:115]
s_barrier
v_mfma_f32_16x16x32_bf16 v[116:119], v[172:175], a[60:63], v[116:119]
s_add_u32 s52, s52, s69
s_waitcnt lgkmcnt(6) vmcnt(10)
ds_read_b128 v[160:163], v7 offset:0
v_mfma_f32_16x16x32_bf16 v[116:119], v[168:171], a[52:55], v[116:119]
buffer_load_dwordx4 a[204:207], v4, s[24:27], s93 offen offset:2048 sc1
v_mfma_f32_16x16x32_bf16 v[120:123], v[176:179], a[64:67], v[120:123]
ds_write_b64 v11, a[112:113] offset:0
v_mfma_f32_16x16x32_bf16 v[120:123], v[180:183], a[72:75], v[120:123]
s_add_u32 s52, s52, 0
s_waitcnt vmcnt(9)
ds_read_b128 v[164:167], v7 offset:1024
v_mfma_f32_16x16x32_bf16 v[124:127], v[180:183], a[76:79], v[124:127]
s_add_u32 s91, s91, 16384
ds_read_b128 v[168:171], v7 offset:2048
v_mfma_f32_16x16x32_bf16 v[124:127], v[176:179], a[68:71], v[124:127]
s_waitcnt lgkmcnt(8)
s_cmp_ge_u32 s91, 163840
s_cselect_b32 s91, 0, s91
v_mfma_f32_16x16x32_bf16 v[72:75], v[184:187], a[64:67], v[72:75]
s_add_u32 s53, s84, 2
ds_read_b128 v[172:175], v7 offset:3072
v_add_u32 v8, s91, v4
v_mfma_f32_16x16x32_bf16 v[72:75], v[188:191], a[72:75], v[72:75]
ds_write_b64 v11, a[114:115] offset:8
v_mfma_f32_16x16x32_bf16 v[76:79], v[188:191], a[76:79], v[76:79]
buffer_load_dwordx4 a[208:211], v14, s[24:27], s65 offen offset:0 sc1
v_mfma_f32_16x16x32_bf16 v[76:79], v[184:187], a[68:71], v[76:79]
s_and_b32 s53, s53, 3
s_waitcnt lgkmcnt(8)
ds_read_b128 v[176:179], v7 offset:4096
v_mfma_f32_16x16x32_bf16 v[80:83], v[144:147], a[64:67], v[80:83]
ds_read_b128 v[180:183], v7 offset:5120
v_mfma_f32_16x16x32_bf16 v[80:83], v[148:151], a[72:75], v[80:83]
ds_write_b64 v11, a[116:117] offset:1024
v_mfma_f32_16x16x32_bf16 v[84:87], v[148:151], a[76:79], v[84:87]
s_mul_i32 s53, s53, 6144
s_waitcnt lgkmcnt(9)
ds_read_b128 v[184:187], v7 offset:6144
v_mfma_f32_16x16x32_bf16 v[84:87], v[144:147], a[68:71], v[84:87]
buffer_load_dwordx4 a[216:219], v14, s[24:27], s65 offen offset:2048 sc1
v_mfma_f32_16x16x32_bf16 v[88:91], v[152:155], a[64:67], v[88:91]
L_PAD11:
s_cbranch_execz L_MAIN
ds_read_b128 v[188:191], v7 offset:7168
v_mfma_f32_16x16x32_bf16 v[88:91], v[156:159], a[72:75], v[88:91]
s_add_u32 s53, s53, s69
s_waitcnt lgkmcnt(8)
v_mfma_f32_16x16x32_bf16 v[92:95], v[156:159], a[76:79], v[92:95]
ds_write_b64 v11, a[118:119] offset:1032
v_mfma_f32_16x16x32_bf16 v[92:95], v[152:155], a[68:71], v[92:95]
buffer_load_dwordx4 a[212:215], v14, s[24:27], s93 offen offset:0 sc1
v_mfma_f32_16x16x32_bf16 v[96:99], v[160:163], a[64:67], v[96:99]
s_add_u32 s53, s53, 2048
ds_read_b128 v[144:147], v7 offset:8192
v_mfma_f32_16x16x32_bf16 v[96:99], v[164:167], a[72:75], v[96:99]
ds_read_b128 v[148:151], v7 offset:9216
v_mfma_f32_16x16x32_bf16 v[100:103], v[164:167], a[76:79], v[100:103]
ds_write_b64 v11, a[120:121] offset:2048
v_mfma_f32_16x16x32_bf16 v[100:103], v[160:163], a[68:71], v[100:103]
s_add_u32 s54, s84, 3
s_waitcnt lgkmcnt(10)
ds_read_b128 v[152:155], v7 offset:10240
v_mfma_f32_16x16x32_bf16 v[104:107], v[168:171], a[64:67], v[104:107]
ds_read_b128 v[156:159], v7 offset:11264
v_mfma_f32_16x16x32_bf16 v[104:107], v[172:175], a[72:75], v[104:107]
buffer_load_dwordx4 a[220:223], v14, s[24:27], s93 offen offset:2048 sc1
v_mfma_f32_16x16x32_bf16 v[108:111], v[172:175], a[76:79], v[108:111]
s_and_b32 s54, s54, 3
s_waitcnt lgkmcnt(9)
ds_read_b128 v[160:163], v7 offset:12288
v_mfma_f32_16x16x32_bf16 v[108:111], v[168:171], a[68:71], v[108:111]
ds_write_b64 v11, a[122:123] offset:2056
v_mfma_f32_16x16x32_bf16 v[112:115], v[176:179], a[64:67], v[112:115]
ds_read_b128 v[164:167], v7 offset:13312
v_mfma_f32_16x16x32_bf16 v[112:115], v[180:183], a[72:75], v[112:115]
s_mul_i32 s54, s54, 6144
s_xor_b32 s65, s82, 32768
s_add_u32 s65, s65, s77
v_mfma_f32_16x16x32_bf16 v[116:119], v[180:183], a[76:79], v[116:119]
s_waitcnt lgkmcnt(9) vmcnt(10)
ds_read_b128 v[168:171], v7 offset:14336
v_mfma_f32_16x16x32_bf16 v[116:119], v[176:179], a[68:71], v[116:119]
ds_write_b64 v11, a[124:125] offset:3072
v_mfma_f32_16x16x32_bf16 v[120:123], v[184:187], a[80:83], v[120:123]
s_add_u32 s54, s54, s69
s_waitcnt vmcnt(8)
ds_read_b128 v[172:175], v7 offset:15360
v_mfma_f32_16x16x32_bf16 v[120:123], v[188:191], a[88:91], v[120:123]
buffer_load_dwordx4 a[224:227], v4, s[24:27], s65 offen offset:0 sc1
v_mfma_f32_16x16x32_bf16 v[124:127], v[188:191], a[92:95], v[124:127]
s_add_u32 s91, s91, 16384
ds_read_b128 v[176:179], v8 offset:0
v_mfma_f32_16x16x32_bf16 v[124:127], v[184:187], a[84:87], v[124:127]
s_add_u32 s54, s54, 4096
s_waitcnt lgkmcnt(10)
v_mfma_f32_16x16x32_bf16 v[72:75], v[144:147], a[80:83], v[72:75]
ds_write_b64 v11, a[126:127] offset:3080
v_mfma_f32_16x16x32_bf16 v[72:75], v[148:151], a[88:91], v[72:75]
s_waitcnt lgkmcnt(5)
ds_read_b128 v[180:183], v8 offset:1024
v_add_u32 v11, s70, v4
v_mfma_f32_16x16x32_bf16 v[76:79], v[148:151], a[92:95], v[76:79]
s_sub_u32 s55, s3, s84
s_add_u32 s70, s70, 16384
ds_read_b128 v[184:187], v8 offset:2048
v_mfma_f32_16x16x32_bf16 v[76:79], v[144:147], a[84:87], v[76:79]
s_cmp_ge_u32 s70, 163840
s_cselect_b32 s70, s80, s70
s_waitcnt lgkmcnt(10)
v_mfma_f32_16x16x32_bf16 v[80:83], v[152:155], a[80:83], v[80:83]
buffer_load_dwordx4 a[232:235], v4, s[24:27], s65 offen offset:2048 sc1
v_mfma_f32_16x16x32_bf16 v[80:83], v[156:159], a[88:91], v[80:83]
s_and_b32 s55, s55, 3
s_xor_b32 s93, s82, 32768
s_add_u32 s93, s93, s81
v_mfma_f32_16x16x32_bf16 v[84:87], v[156:159], a[92:95], v[84:87]
ds_write_b64 v11, a[160:161] offset:0
v_mfma_f32_16x16x32_bf16 v[84:87], v[152:155], a[84:87], v[84:87]
buffer_load_dwordx4 a[228:231], v4, s[24:27], s93 offen offset:0 sc1
v_mfma_f32_16x16x32_bf16 v[88:91], v[160:163], a[80:83], v[88:91]
s_lshl_b32 s55, s55, 10
ds_read_b128 v[188:191], v8 offset:3072
v_mfma_f32_16x16x32_bf16 v[88:91], v[164:167], a[88:91], v[88:91]
s_cmp_ge_u32 s91, 163840
s_cselect_b32 s91, 0, s91
ds_read_b128 v[144:147], v8 offset:4096
v_mfma_f32_16x16x32_bf16 v[92:95], v[164:167], a[92:95], v[92:95]
ds_write_b64 v11, a[162:163] offset:8
v_mfma_f32_16x16x32_bf16 v[92:95], v[160:163], a[84:87], v[92:95]
s_add_u32 s55, s55, s69
s_waitcnt lgkmcnt(8)
ds_read_b128 v[148:151], v8 offset:5120
v_mfma_f32_16x16x32_bf16 v[96:99], v[168:171], a[80:83], v[96:99]
buffer_load_dwordx4 a[236:239], v4, s[24:27], s93 offen offset:2048 sc1
v_mfma_f32_16x16x32_bf16 v[96:99], v[172:175], a[88:91], v[96:99]
ds_read_b128 v[152:155], v8 offset:6144
v_add_u32 v7, s91, v4
v_mfma_f32_16x16x32_bf16 v[100:103], v[172:175], a[92:95], v[100:103]
s_add_u32 s55, s55, 23552
s_waitcnt lgkmcnt(7)
ds_read_b128 v[156:159], v8 offset:7168
v_mfma_f32_16x16x32_bf16 v[100:103], v[168:171], a[84:87], v[100:103]
ds_write_b64 v11, a[164:165] offset:1024
v_mfma_f32_16x16x32_bf16 v[104:107], v[176:179], a[80:83], v[104:107]
ds_read_b128 v[160:163], v8 offset:8192
v_mfma_f32_16x16x32_bf16 v[104:107], v[180:183], a[88:91], v[104:107]
s_add_u32 s71, s69, 24576
s_waitcnt lgkmcnt(7)
ds_read_b128 v[164:167], v8 offset:9216
v_mfma_f32_16x16x32_bf16 v[108:111], v[180:183], a[92:95], v[108:111]
buffer_load_dwordx4 a[240:243], v14, s[24:27], s65 offen offset:0 sc1
v_mfma_f32_16x16x32_bf16 v[108:111], v[176:179], a[84:87], v[108:111]
ds_write_b64 v11, a[166:167] offset:1032
v_mfma_f32_16x16x32_bf16 v[112:115], v[184:187], a[80:83], v[112:115]
s_cmp_eq_u32 s3, s84
s_cselect_b32 s55, 2147418112, s55
s_cselect_b32 s71, s71, 2147418112
v_mfma_f32_16x16x32_bf16 v[112:115], v[188:191], a[88:91], v[112:115]
ds_read_b128 v[168:171], v8 offset:10240
v_mfma_f32_16x16x32_bf16 v[116:119], v[188:191], a[92:95], v[116:119]
s_waitcnt vmcnt(9)
ds_read_b128 v[172:175], v8 offset:11264
v_mfma_f32_16x16x32_bf16 v[116:119], v[184:187], a[84:87], v[116:119]
s_mul_i32 s83, s84, 6144
s_waitcnt lgkmcnt(8) vmcnt(11)
ds_read_b128 v[176:179], v8 offset:12288
v_mfma_f32_16x16x32_bf16 v[120:123], v[144:147], a[192:195], v[120:123]
ds_write_b64 v11, a[168:169] offset:2048
v_mfma_f32_16x16x32_bf16 v[120:123], v[148:151], a[200:203], v[120:123]
buffer_load_dwordx4 a[248:251], v14, s[24:27], s65 offen offset:2048 sc1
v_mfma_f32_16x16x32_bf16 v[124:127], v[148:151], a[204:207], v[124:127]
s_add_u32 s69, s69, s83
ds_read_b128 v[180:183], v8 offset:13312
v_mfma_f32_16x16x32_bf16 v[124:127], v[144:147], a[196:199], v[124:127]
s_waitcnt lgkmcnt(9)
ds_read_b128 v[184:187], v8 offset:14336
v_mfma_f32_16x16x32_bf16 v[72:75], v[152:155], a[192:195], v[72:75]
s_waitcnt vmcnt(51)
ds_read_b128 v[188:191], v8 offset:15360
v_mfma_f32_16x16x32_bf16 v[72:75], v[156:159], a[200:203], v[72:75]
s_barrier
v_mfma_f32_16x16x32_bf16 v[76:79], v[156:159], a[204:207], v[76:79]
s_add_u32 s83, s69, 4096
s_waitcnt lgkmcnt(8)
ds_read_b128 v[144:147], v7 offset:0
v_mfma_f32_16x16x32_bf16 v[76:79], v[152:155], a[196:199], v[76:79]
ds_write_b64 v11, a[170:171] offset:2056
v_mfma_f32_16x16x32_bf16 v[80:83], v[160:163], a[192:195], v[80:83]
buffer_load_dwordx4 a[244:247], v14, s[24:27], s93 offen offset:0 sc1
v_mfma_f32_16x16x32_bf16 v[80:83], v[164:167], a[200:203], v[80:83]
s_add_u32 s91, s91, 16384
ds_read_b128 v[148:151], v7 offset:1024
v_mfma_f32_16x16x32_bf16 v[84:87], v[164:167], a[204:207], v[84:87]
s_waitcnt lgkmcnt(8)
ds_read_b128 v[152:155], v7 offset:2048
v_mfma_f32_16x16x32_bf16 v[84:87], v[160:163], a[196:199], v[84:87]
ds_write_b64 v11, a[172:173] offset:3072
v_mfma_f32_16x16x32_bf16 v[88:91], v[168:171], a[192:195], v[88:91]
buffer_load_dwordx4 a[252:255], v14, s[24:27], s93 offen offset:2048 sc1
v_mfma_f32_16x16x32_bf16 v[88:91], v[172:175], a[200:203], v[88:91]
s_waitcnt lgkmcnt(7)
ds_read_b128 v[156:159], v7 offset:3072
v_mfma_f32_16x16x32_bf16 v[92:95], v[172:175], a[204:207], v[92:95]
s_xor_b32 s65, s82, 40960
s_add_u32 s65, s65, s77
ds_read_b128 v[160:163], v7 offset:4096
v_mfma_f32_16x16x32_bf16 v[92:95], v[168:171], a[196:199], v[92:95]
ds_write_b64 v11, a[174:175] offset:3080
v_mfma_f32_16x16x32_bf16 v[96:99], v[176:179], a[192:195], v[96:99]
s_add_u32 s68, s68, 49152
ds_read_b128 v[164:167], v7 offset:5120
v_mfma_f32_16x16x32_bf16 v[96:99], v[180:183], a[200:203], v[96:99]
buffer_load_dwordx4 a[96:99], v4, s[24:27], s65 offen offset:0 sc1
v_mfma_f32_16x16x32_bf16 v[100:103], v[180:183], a[204:207], v[100:103]
s_cmp_ge_u32 s91, 163840
s_cselect_b32 s91, 0, s91
ds_read_b128 v[168:171], v7 offset:6144
v_mfma_f32_16x16x32_bf16 v[100:103], v[176:179], a[196:199], v[100:103]
s_waitcnt lgkmcnt(10)
v_add_u32 v8, s91, v4
v_mfma_f32_16x16x32_bf16 v[104:107], v[184:187], a[192:195], v[104:107]
ds_read_b128 v[172:175], v7 offset:7168
v_mfma_f32_16x16x32_bf16 v[104:107], v[188:191], a[200:203], v[104:107]
v_mfma_f32_16x16x32_bf16 v[108:111], v[188:191], a[204:207], v[108:111]
buffer_load_dwordx4 a[104:107], v4, s[24:27], s65 offen offset:2048 sc1
v_mfma_f32_16x16x32_bf16 v[108:111], v[184:187], a[196:199], v[108:111]
s_waitcnt lgkmcnt(8)
ds_read_b128 v[176:179], v7 offset:8192
v_mfma_f32_16x16x32_bf16 v[112:115], v[144:147], a[192:195], v[112:115]
ds_read_b128 v[180:183], v7 offset:9216
v_mfma_f32_16x16x32_bf16 v[112:115], v[148:151], a[200:203], v[112:115]
v_mfma_f32_16x16x32_bf16 v[116:119], v[148:151], a[204:207], v[116:119]
s_xor_b32 s93, s82, 40960
s_add_u32 s93, s93, s81
ds_read_b128 v[184:187], v7 offset:10240
v_mfma_f32_16x16x32_bf16 v[116:119], v[144:147], a[196:199], v[116:119]
s_waitcnt lgkmcnt(8) vmcnt(12)
v_mfma_f32_16x16x32_bf16 v[120:123], v[152:155], a[208:211], v[120:123]
buffer_load_dwordx4 a[100:103], v4, s[24:27], s93 offen offset:0 sc1
v_mfma_f32_16x16x32_bf16 v[120:123], v[156:159], a[216:219], v[120:123]
s_waitcnt vmcnt(11)
ds_read_b128 v[188:191], v7 offset:11264
v_mfma_f32_16x16x32_bf16 v[124:127], v[156:159], a[220:223], v[124:127]
ds_read_b128 v[144:147], v7 offset:12288
v_mfma_f32_16x16x32_bf16 v[124:127], v[152:155], a[212:215], v[124:127]
s_waitcnt lgkmcnt(7)
v_mfma_f32_16x16x32_bf16 v[72:75], v[160:163], a[208:211], v[72:75]
ds_read_b128 v[148:151], v7 offset:13312
v_mfma_f32_16x16x32_bf16 v[72:75], v[164:167], a[216:219], v[72:75]
v_mov_b32 v13, 0xffff0000
v_mul_u32_u24 v5, 1152, v2
v_mfma_f32_16x16x32_bf16 v[76:79], v[164:167], a[220:223], v[76:79]
buffer_load_dwordx4 a[108:111], v4, s[24:27], s93 offen offset:2048 sc1
v_mfma_f32_16x16x32_bf16 v[76:79], v[160:163], a[212:215], v[76:79]
s_waitcnt lgkmcnt(6)
ds_read_b128 v[152:155], v7 offset:14336
v_lshl_add_u32 v6, v3, 3, v5
v_mfma_f32_16x16x32_bf16 v[80:83], v[168:171], a[208:211], v[80:83]
ds_read_b128 v[156:159], v7 offset:15360
v_and_b32 v9, 1, v3
v_mfma_f32_16x16x32_bf16 v[80:83], v[172:175], a[216:219], v[80:83]
s_add_u32 s91, s91, 16384
s_cmp_ge_u32 s91, 163840
s_cselect_b32 s91, 0, s91
v_mfma_f32_16x16x32_bf16 v[84:87], v[172:175], a[220:223], v[84:87]
s_waitcnt lgkmcnt(6)
ds_read_b128 v[160:163], v8 offset:0
v_add_u32 v7, s91, v4
v_mfma_f32_16x16x32_bf16 v[84:87], v[168:171], a[212:215], v[84:87]
buffer_load_dwordx4 a[112:115], v14, s[24:27], s65 offen offset:0 sc1
v_mfma_f32_16x16x32_bf16 v[88:91], v[176:179], a[208:211], v[88:91]
ds_read_b128 v[164:167], v8 offset:1024
v_lshl_add_u32 v5, v9, 5, v5
v_mfma_f32_16x16x32_bf16 v[88:91], v[180:183], a[216:219], v[88:91]
v_lshrrev_b32 v9, 1, v3
v_lshl_add_u32 v5, v9, 4, v5
v_mfma_f32_16x16x32_bf16 v[92:95], v[180:183], a[220:223], v[92:95]
ds_read_b128 v[168:171], v8 offset:2048
v_mfma_f32_16x16x32_bf16 v[92:95], v[176:179], a[212:215], v[92:95]
s_waitcnt lgkmcnt(7)
v_mfma_f32_16x16x32_bf16 v[96:99], v[184:187], a[208:211], v[96:99]
ds_read_b128 v[172:175], v8 offset:3072
v_mfma_f32_16x16x32_bf16 v[96:99], v[188:191], a[216:219], v[96:99]
buffer_load_dwordx4 a[120:123], v14, s[24:27], s65 offen offset:2048 sc1
v_mfma_f32_16x16x32_bf16 v[100:103], v[188:191], a[220:223], v[100:103]
ds_read_b128 v[176:179], v8 offset:4096
v_mfma_f32_16x16x32_bf16 v[100:103], v[184:187], a[212:215], v[100:103]
s_waitcnt lgkmcnt(7)
v_mfma_f32_16x16x32_bf16 v[104:107], v[144:147], a[208:211], v[104:107]
ds_read_b128 v[180:183], v8 offset:5120
v_mfma_f32_16x16x32_bf16 v[104:107], v[148:151], a[216:219], v[104:107]
v_mfma_f32_16x16x32_bf16 v[108:111], v[148:151], a[220:223], v[108:111]
s_waitcnt lgkmcnt(6)
ds_read_b128 v[184:187], v8 offset:6144
v_mfma_f32_16x16x32_bf16 v[108:111], v[144:147], a[212:215], v[108:111]
buffer_load_dwordx4 a[116:119], v14, s[24:27], s93 offen offset:0 sc1
v_mfma_f32_16x16x32_bf16 v[112:115], v[152:155], a[208:211], v[112:115]
ds_read_b128 v[188:191], v8 offset:7168
v_mfma_f32_16x16x32_bf16 v[112:115], v[156:159], a[216:219], v[112:115]
v_mfma_f32_16x16x32_bf16 v[116:119], v[156:159], a[220:223], v[116:119]
ds_read_b128 v[144:147], v8 offset:8192
v_mfma_f32_16x16x32_bf16 v[116:119], v[152:155], a[212:215], v[116:119]
s_waitcnt lgkmcnt(7) vmcnt(13)
v_mfma_f32_16x16x32_bf16 v[120:123], v[160:163], a[224:227], v[120:123]
buffer_load_dwordx4 a[124:127], v14, s[24:27], s93 offen offset:2048 sc1
v_mfma_f32_16x16x32_bf16 v[120:123], v[164:167], a[232:235], v[120:123]
s_waitcnt vmcnt(12)
ds_read_b128 v[148:151], v8 offset:9216
v_mfma_f32_16x16x32_bf16 v[124:127], v[164:167], a[236:239], v[124:127]
ds_read_b128 v[152:155], v8 offset:10240
v_mfma_f32_16x16x32_bf16 v[124:127], v[160:163], a[228:231], v[124:127]
s_waitcnt lgkmcnt(7)
v_mfma_f32_16x16x32_bf16 v[72:75], v[168:171], a[224:227], v[72:75]
s_xor_b32 s65, s82, 49152
s_add_u32 s65, s65, s77
ds_read_b128 v[156:159], v8 offset:11264
v_mfma_f32_16x16x32_bf16 v[72:75], v[172:175], a[232:235], v[72:75]
v_mfma_f32_16x16x32_bf16 v[76:79], v[172:175], a[236:239], v[76:79]
buffer_load_dwordx4 a[128:131], v4, s[24:27], s65 offen offset:0 sc1
v_mfma_f32_16x16x32_bf16 v[76:79], v[168:171], a[228:231], v[76:79]
s_waitcnt lgkmcnt(6)
ds_read_b128 v[160:163], v8 offset:12288
v_mfma_f32_16x16x32_bf16 v[80:83], v[176:179], a[224:227], v[80:83]
ds_read_b128 v[164:167], v8 offset:13312
v_mfma_f32_16x16x32_bf16 v[80:83], v[180:183], a[232:235], v[80:83]
v_mfma_f32_16x16x32_bf16 v[84:87], v[180:183], a[236:239], v[84:87]
ds_read_b128 v[168:171], v8 offset:14336
v_mfma_f32_16x16x32_bf16 v[84:87], v[176:179], a[228:231], v[84:87]
s_waitcnt lgkmcnt(7)
v_mfma_f32_16x16x32_bf16 v[88:91], v[184:187], a[224:227], v[88:91]
s_waitcnt vmcnt(53)
ds_read_b128 v[172:175], v8 offset:15360
v_mfma_f32_16x16x32_bf16 v[88:91], v[188:191], a[232:235], v[88:91]
s_barrier
v_mfma_f32_16x16x32_bf16 v[92:95], v[188:191], a[236:239], v[92:95]
buffer_load_dwordx4 a[136:139], v4, s[24:27], s65 offen offset:2048 sc1
v_mfma_f32_16x16x32_bf16 v[92:95], v[184:187], a[228:231], v[92:95]
s_waitcnt lgkmcnt(6)
s_add_u32 s91, s91, 16384
ds_read_b128 v[176:179], v7 offset:0
v_mfma_f32_16x16x32_bf16 v[96:99], v[144:147], a[224:227], v[96:99]
s_xor_b32 s93, s82, 49152
s_add_u32 s93, s93, s81
ds_read_b128 v[180:183], v7 offset:1024
v_mfma_f32_16x16x32_bf16 v[96:99], v[148:151], a[232:235], v[96:99]
s_cmp_ge_u32 s91, 163840
s_cselect_b32 s91, 0, s91
v_add_u32 v8, s91, v4
v_mfma_f32_16x16x32_bf16 v[100:103], v[148:151], a[236:239], v[100:103]
buffer_load_dwordx4 a[132:135], v4, s[24:27], s93 offen offset:0 sc1
v_mfma_f32_16x16x32_bf16 v[100:103], v[144:147], a[228:231], v[100:103]
s_waitcnt lgkmcnt(6) vmcnt(13)
ds_read_b128 v[184:187], v7 offset:2048
v_mfma_f32_16x16x32_bf16 v[120:123], v[152:155], a[240:243], v[120:123]
ds_read_b128 v[188:191], v7 offset:3072
v_mfma_f32_16x16x32_bf16 v[120:123], v[156:159], a[248:251], v[120:123]
s_waitcnt vmcnt(11)
v_mfma_f32_16x16x32_bf16 v[124:127], v[156:159], a[252:255], v[124:127]
buffer_load_dwordx4 a[140:143], v4, s[24:27], s93 offen offset:2048 sc1
v_mfma_f32_16x16x32_bf16 v[124:127], v[152:155], a[244:247], v[124:127]
s_waitcnt lgkmcnt(6)
ds_read_b128 v[144:147], v7 offset:4096
v_mfma_f32_16x16x32_bf16 v[72:75], v[160:163], a[240:243], v[72:75]
ds_read_b128 v[148:151], v7 offset:5120
v_mfma_f32_16x16x32_bf16 v[72:75], v[164:167], a[248:251], v[72:75]
v_mfma_f32_16x16x32_bf16 v[76:79], v[164:167], a[252:255], v[76:79]
ds_read_b128 v[152:155], v7 offset:6144
v_mfma_f32_16x16x32_bf16 v[76:79], v[160:163], a[244:247], v[76:79]
s_waitcnt lgkmcnt(7)
v_mfma_f32_16x16x32_bf16 v[80:83], v[168:171], a[240:243], v[80:83]
ds_read_b128 v[156:159], v7 offset:7168
v_mfma_f32_16x16x32_bf16 v[80:83], v[172:175], a[248:251], v[80:83]
buffer_load_dwordx4 a[144:147], v14, s[24:27], s65 offen offset:0 sc1
v_mfma_f32_16x16x32_bf16 v[84:87], v[172:175], a[252:255], v[84:87]
buffer_load_dword v12, v10, s[24:27], s75 offen offset:4 sc1
v_mfma_f32_16x16x32_bf16 v[84:87], v[168:171], a[244:247], v[84:87]
s_waitcnt lgkmcnt(6)
ds_read_b128 v[160:163], v7 offset:8192
v_mfma_f32_16x16x32_bf16 v[88:91], v[176:179], a[240:243], v[88:91]
ds_read_b128 v[164:167], v7 offset:9216
v_mfma_f32_16x16x32_bf16 v[88:91], v[180:183], a[248:251], v[88:91]
v_mfma_f32_16x16x32_bf16 v[92:95], v[180:183], a[252:255], v[92:95]
buffer_load_dwordx4 a[152:155], v14, s[24:27], s65 offen offset:2048 sc1
v_mfma_f32_16x16x32_bf16 v[92:95], v[176:179], a[244:247], v[92:95]
s_waitcnt lgkmcnt(6)
ds_read_b128 v[168:171], v7 offset:10240
v_mfma_f32_16x16x32_bf16 v[96:99], v[184:187], a[240:243], v[96:99]
ds_read_b128 v[172:175], v7 offset:11264
v_mfma_f32_16x16x32_bf16 v[96:99], v[188:191], a[248:251], v[96:99]
v_mfma_f32_16x16x32_bf16 v[100:103], v[188:191], a[252:255], v[100:103]
buffer_load_dwordx4 a[148:151], v14, s[24:27], s93 offen offset:0 sc1
v_mfma_f32_16x16x32_bf16 v[100:103], v[184:187], a[244:247], v[100:103]
s_waitcnt lgkmcnt(6) vmcnt(14)
ds_read_b128 v[176:179], v7 offset:12288
v_mfma_f32_16x16x32_bf16 v[120:123], v[144:147], a[96:99], v[120:123]
ds_read_b128 v[180:183], v7 offset:13312
v_mfma_f32_16x16x32_bf16 v[120:123], v[148:151], a[104:107], v[120:123]
s_waitcnt vmcnt(12)
v_mfma_f32_16x16x32_bf16 v[124:127], v[148:151], a[108:111], v[124:127]
buffer_load_dwordx4 a[156:159], v14, s[24:27], s93 offen offset:2048 sc1
v_mfma_f32_16x16x32_bf16 v[124:127], v[144:147], a[100:103], v[124:127]
s_waitcnt lgkmcnt(6)
ds_read_b128 v[184:187], v7 offset:14336
v_mfma_f32_16x16x32_bf16 v[72:75], v[152:155], a[96:99], v[72:75]
ds_read_b128 v[188:191], v7 offset:15360
v_mfma_f32_16x16x32_bf16 v[72:75], v[156:159], a[104:107], v[72:75]
s_add_u32 s91, s91, 16384
s_cmp_ge_u32 s91, 163840
s_cselect_b32 s91, 0, s91
v_mfma_f32_16x16x32_bf16 v[76:79], v[156:159], a[108:111], v[76:79]
ds_read_b128 v[144:147], v8 offset:0
v_add_u32 v7, s91, v4
v_mfma_f32_16x16x32_bf16 v[76:79], v[152:155], a[100:103], v[76:79]
s_waitcnt lgkmcnt(7)
v_mfma_f32_16x16x32_bf16 v[80:83], v[160:163], a[96:99], v[80:83]
s_xor_b32 s65, s82, 57344
s_add_u32 s65, s65, s77
ds_read_b128 v[148:151], v8 offset:1024
v_mfma_f32_16x16x32_bf16 v[80:83], v[164:167], a[104:107], v[80:83]
v_mfma_f32_16x16x32_bf16 v[84:87], v[164:167], a[108:111], v[84:87]
buffer_load_dwordx4 a[160:163], v4, s[24:27], s65 offen offset:0 sc1
v_mfma_f32_16x16x32_bf16 v[84:87], v[160:163], a[100:103], v[84:87]
s_waitcnt lgkmcnt(6)
ds_read_b128 v[152:155], v8 offset:2048
v_mfma_f32_16x16x32_bf16 v[88:91], v[168:171], a[96:99], v[88:91]
ds_read_b128 v[156:159], v8 offset:3072
v_mfma_f32_16x16x32_bf16 v[88:91], v[172:175], a[104:107], v[88:91]
v_mfma_f32_16x16x32_bf16 v[92:95], v[172:175], a[108:111], v[92:95]
buffer_load_dwordx4 a[168:171], v4, s[24:27], s65 offen offset:2048 sc1
v_mfma_f32_16x16x32_bf16 v[92:95], v[168:171], a[100:103], v[92:95]
s_waitcnt lgkmcnt(6)
ds_read_b128 v[160:163], v8 offset:4096
v_mfma_f32_16x16x32_bf16 v[96:99], v[176:179], a[96:99], v[96:99]
s_xor_b32 s93, s82, 57344
s_add_u32 s93, s93, s81
ds_read_b128 v[164:167], v8 offset:5120
v_mfma_f32_16x16x32_bf16 v[96:99], v[180:183], a[104:107], v[96:99]
v_mfma_f32_16x16x32_bf16 v[100:103], v[180:183], a[108:111], v[100:103]
buffer_load_dwordx4 a[164:167], v4, s[24:27], s93 offen offset:0 sc1
v_mfma_f32_16x16x32_bf16 v[100:103], v[176:179], a[100:103], v[100:103]
s_waitcnt lgkmcnt(6) vmcnt(14)
ds_read_b128 v[168:171], v8 offset:6144
v_mfma_f32_16x16x32_bf16 v[120:123], v[184:187], a[112:115], v[120:123]
ds_read_b128 v[172:175], v8 offset:7168
v_mfma_f32_16x16x32_bf16 v[120:123], v[188:191], a[120:123], v[120:123]
s_waitcnt vmcnt(12)
v_mfma_f32_16x16x32_bf16 v[124:127], v[188:191], a[124:127], v[124:127]
buffer_load_dwordx4 a[172:175], v4, s[24:27], s93 offen offset:2048 sc1
v_mfma_f32_16x16x32_bf16 v[124:127], v[184:187], a[116:119], v[124:127]
s_waitcnt lgkmcnt(6)
ds_read_b128 v[176:179], v8 offset:8192
v_mfma_f32_16x16x32_bf16 v[72:75], v[144:147], a[112:115], v[72:75]
s_mov_b32 m0, s70
s_mov_b32 s64, s68
s_add_u32 s68, s68, 16384
v_mfma_f32_16x16x32_bf16 v[72:75], v[148:151], a[120:123], v[72:75]
s_waitcnt lgkmcnt(5)
ds_read_b128 v[180:183], v8 offset:9216
v_mfma_f32_16x16x32_bf16 v[76:79], v[148:151], a[124:127], v[76:79]
s_add_u32 s70, s70, 16384
s_cmp_ge_u32 s70, 163840
s_cselect_b32 s70, s80, s70
v_mfma_f32_16x16x32_bf16 v[76:79], v[144:147], a[116:119], v[76:79]
buffer_load_dwordx4 v4, s[24:27], s64 offen offset:0 sc1 lds
v_mfma_f32_16x16x32_bf16 v[80:83], v[152:155], a[112:115], v[80:83]
ds_read_b128 v[184:187], v8 offset:10240
v_mfma_f32_16x16x32_bf16 v[80:83], v[156:159], a[120:123], v[80:83]
ds_read_b128 v[188:191], v8 offset:11264
v_mfma_f32_16x16x32_bf16 v[84:87], v[156:159], a[124:127], v[84:87]
buffer_load_dwordx4 v4, s[24:27], s64 offen offset:1024 sc1 lds
v_mfma_f32_16x16x32_bf16 v[84:87], v[152:155], a[116:119], v[84:87]
s_waitcnt lgkmcnt(6)
ds_read_b128 v[144:147], v8 offset:12288
v_mfma_f32_16x16x32_bf16 v[88:91], v[160:163], a[112:115], v[88:91]
ds_read_b128 v[148:151], v8 offset:13312
v_mfma_f32_16x16x32_bf16 v[88:91], v[164:167], a[120:123], v[88:91]
buffer_load_dwordx4 a[176:179], v14, s[24:27], s65 offen offset:0 sc1
v_mfma_f32_16x16x32_bf16 v[92:95], v[164:167], a[124:127], v[92:95]
ds_read_b128 v[152:155], v8 offset:14336
v_mfma_f32_16x16x32_bf16 v[92:95], v[160:163], a[116:119], v[92:95]
s_waitcnt lgkmcnt(7)
v_mfma_f32_16x16x32_bf16 v[96:99], v[168:171], a[112:115], v[96:99]
s_waitcnt vmcnt(10)
ds_read_b128 v[156:159], v8 offset:15360
v_mfma_f32_16x16x32_bf16 v[96:99], v[172:175], a[120:123], v[96:99]
s_barrier
v_mfma_f32_16x16x32_bf16 v[100:103], v[172:175], a[124:127], v[100:103]
s_waitcnt lgkmcnt(6) vmcnt(14)
ds_read_b128 v[160:163], v7 offset:0
v_cmp_gt_u32 vcc, 8, v12
v_mfma_f32_16x16x32_bf16 v[100:103], v[168:171], a[116:119], v[100:103]
buffer_load_dwordx4 v4, s[24:27], s64 offen offset:2048 sc1 lds
v_mfma_f32_16x16x32_bf16 v[120:123], v[176:179], a[128:131], v[120:123]
s_add_u32 s91, s91, 16384
ds_read_b128 v[164:167], v7 offset:1024
v_mfma_f32_16x16x32_bf16 v[120:123], v[180:183], a[136:139], v[120:123]
s_waitcnt lgkmcnt(6) vmcnt(13)
s_cmp_ge_u32 s91, 163840
s_cselect_b32 s91, 0, s91
v_mfma_f32_16x16x32_bf16 v[124:127], v[180:183], a[140:143], v[124:127]
buffer_load_dwordx4 a[184:187], v14, s[24:27], s65 offen offset:2048 sc1
v_mfma_f32_16x16x32_bf16 v[124:127], v[176:179], a[132:135], v[124:127]
s_cbranch_vccnz CK_ZAA
CK_ZAA_R:
v_mfma_f32_16x16x32_bf16 v[72:75], v[184:187], a[128:131], v[72:75]
ds_read_b128 v[168:171], v7 offset:2048
v_add_u32 v8, s91, v4
v_mfma_f32_16x16x32_bf16 v[72:75], v[188:191], a[136:139], v[72:75]
buffer_load_dwordx4 v4, s[24:27], s64 offen offset:3072 sc1 lds
v_mfma_f32_16x16x32_bf16 v[76:79], v[188:191], a[140:143], v[76:79]
ds_read_b128 v[172:175], v7 offset:3072
v_mfma_f32_16x16x32_bf16 v[76:79], v[184:187], a[132:135], v[76:79]
s_waitcnt lgkmcnt(6)
ds_read_b128 v[176:179], v7 offset:4096
v_mfma_f32_16x16x32_bf16 v[80:83], v[144:147], a[128:131], v[80:83]
buffer_load_dwordx4 a[180:183], v14, s[24:27], s93 offen offset:0 sc1
v_mfma_f32_16x16x32_bf16 v[80:83], v[148:151], a[136:139], v[80:83]
ds_read_b128 v[180:183], v7 offset:5120
v_mfma_f32_16x16x32_bf16 v[84:87], v[148:151], a[140:143], v[84:87]
s_waitcnt lgkmcnt(6)
ds_read_b128 v[184:187], v7 offset:6144
v_mfma_f32_16x16x32_bf16 v[84:87], v[144:147], a[132:135], v[84:87]
buffer_load_dwordx4 a[188:191], v14, s[24:27], s93 offen offset:2048 sc1
v_mfma_f32_16x16x32_bf16 v[88:91], v[152:155], a[128:131], v[88:91]
s_add_u32 s65, s77, 65536
ds_read_b128 v[188:191], v7 offset:7168
v_mfma_f32_16x16x32_bf16 v[88:91], v[156:159], a[136:139], v[88:91]
v_mfma_f32_16x16x32_bf16 v[92:95], v[156:159], a[140:143], v[92:95]
buffer_load_dwordx4 v[32:35], v4, s[24:27], s65 offen offset:0 sc1
v_mfma_f32_16x16x32_bf16 v[92:95], v[152:155], a[132:135], v[92:95]
s_waitcnt lgkmcnt(6)
ds_read_b128 v[144:147], v7 offset:8192
v_mfma_f32_16x16x32_bf16 v[96:99], v[160:163], a[128:131], v[96:99]
ds_read_b128 v[148:151], v7 offset:9216
v_mfma_f32_16x16x32_bf16 v[96:99], v[164:167], a[136:139], v[96:99]
buffer_load_dwordx4 v[40:43], v4, s[24:27], s65 offen offset:2048 sc1
v_mfma_f32_16x16x32_bf16 v[100:103], v[164:167], a[140:143], v[100:103]
s_add_u32 s93, s81, 65536
ds_read_b128 v[152:155], v7 offset:10240
v_mfma_f32_16x16x32_bf16 v[100:103], v[160:163], a[132:135], v[100:103]
s_waitcnt lgkmcnt(7) vmcnt(16)
v_mfma_f32_16x16x32_bf16 v[120:123], v[168:171], a[144:147], v[120:123]
buffer_load_dwordx4 v[36:39], v4, s[24:27], s93 offen offset:0 sc1
v_mfma_f32_16x16x32_bf16 v[120:123], v[172:175], a[152:155], v[120:123]
s_waitcnt vmcnt(15)
ds_read_b128 v[156:159], v7 offset:11264
v_mfma_f32_16x16x32_bf16 v[124:127], v[172:175], a[156:159], v[124:127]
s_waitcnt lgkmcnt(6)
ds_read_b128 v[160:163], v7 offset:12288
v_mfma_f32_16x16x32_bf16 v[124:127], v[168:171], a[148:151], v[124:127]
buffer_load_dwordx4 v[44:47], v4, s[24:27], s93 offen offset:2048 sc1
v_mfma_f32_16x16x32_bf16 v[72:75], v[176:179], a[144:147], v[72:75]
ds_read_b128 v[164:167], v7 offset:13312
v_mfma_f32_16x16x32_bf16 v[72:75], v[180:183], a[152:155], v[72:75]
v_mfma_f32_16x16x32_bf16 v[76:79], v[180:183], a[156:159], v[76:79]
ds_read_b128 v[168:171], v7 offset:14336
v_mfma_f32_16x16x32_bf16 v[76:79], v[176:179], a[148:151], v[76:79]
s_waitcnt lgkmcnt(7)
v_mfma_f32_16x16x32_bf16 v[80:83], v[184:187], a[144:147], v[80:83]
ds_read_b128 v[172:175], v7 offset:15360
v_mfma_f32_16x16x32_bf16 v[80:83], v[188:191], a[152:155], v[80:83]
s_add_u32 s91, s91, 16384
s_cmp_ge_u32 s91, 163840
s_cselect_b32 s91, 0, s91
v_mfma_f32_16x16x32_bf16 v[84:87], v[188:191], a[156:159], v[84:87]
buffer_load_dwordx4 v[48:51], v14, s[24:27], s65 offen offset:0 sc1
v_mfma_f32_16x16x32_bf16 v[84:87], v[184:187], a[148:151], v[84:87]
s_waitcnt lgkmcnt(6)
ds_read_b128 v[176:179], v8 offset:0
v_add_u32 v7, s91, v4
v_mfma_f32_16x16x32_bf16 v[88:91], v[144:147], a[144:147], v[88:91]
ds_read_b128 v[180:183], v8 offset:1024
v_mfma_f32_16x16x32_bf16 v[88:91], v[148:151], a[152:155], v[88:91]
s_waitcnt lgkmcnt(6)
v_mfma_f32_16x16x32_bf16 v[92:95], v[148:151], a[156:159], v[92:95]
buffer_load_dwordx4 v[56:59], v14, s[24:27], s65 offen offset:2048 sc1
v_mfma_f32_16x16x32_bf16 v[92:95], v[144:147], a[148:151], v[92:95]
s_mov_b32 m0, s70
s_mov_b32 s64, s68
s_add_u32 s68, s68, 16384
v_mfma_f32_16x16x32_bf16 v[96:99], v[152:155], a[144:147], v[96:99]
ds_read_b128 v[184:187], v8 offset:2048
v_mfma_f32_16x16x32_bf16 v[96:99], v[156:159], a[152:155], v[96:99]
s_add_u32 s70, s70, 16384
s_cmp_ge_u32 s70, 163840
s_cselect_b32 s70, s80, s70
v_mfma_f32_16x16x32_bf16 v[100:103], v[156:159], a[156:159], v[100:103]
buffer_load_dwordx4 v4, s[24:27], s64 offen offset:0 sc1 lds
v_mfma_f32_16x16x32_bf16 v[100:103], v[152:155], a[148:151], v[100:103]
s_waitcnt lgkmcnt(5) vmcnt(17)
ds_read_b128 v[188:191], v8 offset:3072
v_mfma_f32_16x16x32_bf16 v[120:123], v[160:163], a[160:163], v[120:123]
s_waitcnt vmcnt(15)
ds_read_b128 v[144:147], v8 offset:4096
v_mfma_f32_16x16x32_bf16 v[120:123], v[164:167], a[168:171], v[120:123]
buffer_load_dwordx4 v[52:55], v14, s[24:27], s93 offen offset:0 sc1
v_mfma_f32_16x16x32_bf16 v[124:127], v[164:167], a[172:175], v[124:127]
ds_read_b128 v[148:151], v8 offset:5120
v_mfma_f32_16x16x32_bf16 v[124:127], v[160:163], a[164:167], v[124:127]
s_waitcnt lgkmcnt(6)
ds_read_b128 v[152:155], v8 offset:6144
v_mfma_f32_16x16x32_bf16 v[72:75], v[168:171], a[160:163], v[72:75]
buffer_load_dwordx4 v4, s[24:27], s64 offen offset:1024 sc1 lds
v_mfma_f32_16x16x32_bf16 v[72:75], v[172:175], a[168:171], v[72:75]
ds_read_b128 v[156:159], v8 offset:7168
v_mfma_f32_16x16x32_bf16 v[76:79], v[172:175], a[172:175], v[76:79]
s_waitcnt lgkmcnt(6)
ds_read_b128 v[160:163], v8 offset:8192
v_mfma_f32_16x16x32_bf16 v[76:79], v[168:171], a[164:167], v[76:79]
buffer_load_dwordx4 v[60:63], v14, s[24:27], s93 offen offset:2048 sc1
v_mfma_f32_16x16x32_bf16 v[80:83], v[176:179], a[160:163], v[80:83]
ds_read_b128 v[164:167], v8 offset:9216
v_mfma_f32_16x16x32_bf16 v[80:83], v[180:183], a[168:171], v[80:83]
L_PAD12:
s_cbranch_execz L_MAIN
v_mfma_f32_16x16x32_bf16 v[84:87], v[180:183], a[172:175], v[84:87]
buffer_load_dwordx4 v4, s[24:27], s64 offen offset:2048 sc1 lds
v_mfma_f32_16x16x32_bf16 v[84:87], v[176:179], a[164:167], v[84:87]
s_waitcnt lgkmcnt(6)
ds_read_b128 v[168:171], v8 offset:10240
v_mfma_f32_16x16x32_bf16 v[88:91], v[184:187], a[160:163], v[88:91]
ds_read_b128 v[172:175], v8 offset:11264
v_mfma_f32_16x16x32_bf16 v[88:91], v[188:191], a[168:171], v[88:91]
buffer_load_dwordx4 v4, s[24:27], s64 offen offset:3072 sc1 lds
v_mfma_f32_16x16x32_bf16 v[92:95], v[188:191], a[172:175], v[92:95]
s_mov_b32 m0, s70
s_mov_b32 s64, s68
s_add_u32 s68, s68, 16384
v_mfma_f32_16x16x32_bf16 v[92:95], v[184:187], a[164:167], v[92:95]
s_waitcnt lgkmcnt(6)
ds_read_b128 v[176:179], v8 offset:12288
v_mfma_f32_16x16x32_bf16 v[96:99], v[144:147], a[160:163], v[96:99]
s_add_u32 s70, s70, 16384
s_cmp_ge_u32 s70, 163840
s_cselect_b32 s70, s80, s70
v_mfma_f32_16x16x32_bf16 v[96:99], v[148:151], a[168:171], v[96:99]
buffer_load_dwordx4 v4, s[24:27], s64 offen offset:0 sc1 lds
v_mfma_f32_16x16x32_bf16 v[100:103], v[148:151], a[172:175], v[100:103]
ds_read_b128 v[180:183], v8 offset:13312
v_mfma_f32_16x16x32_bf16 v[100:103], v[144:147], a[164:167], v[100:103]
s_waitcnt lgkmcnt(6) vmcnt(16)
ds_read_b128 v[184:187], v8 offset:14336
v_mfma_f32_16x16x32_bf16 v[120:123], v[152:155], a[176:179], v[120:123]
s_waitcnt vmcnt(15)
s_waitcnt vmcnt(13)
ds_read_b128 v[188:191], v8 offset:15360
v_mfma_f32_16x16x32_bf16 v[120:123], v[156:159], a[184:187], v[120:123]
s_barrier
v_mfma_f32_16x16x32_bf16 v[124:127], v[156:159], a[188:191], v[124:127]
buffer_load_dwordx4 v4, s[24:27], s64 offen offset:1024 sc1 lds
v_mfma_f32_16x16x32_bf16 v[124:127], v[152:155], a[180:183], v[124:127]
s_add_u32 s65, s77, 73728
s_waitcnt lgkmcnt(6)
ds_read_b128 v[144:147], v7 offset:0
v_mfma_f32_16x16x32_bf16 v[72:75], v[160:163], a[176:179], v[72:75]
s_add_u32 s91, s91, 16384
ds_read_b128 v[148:151], v7 offset:1024
v_mfma_f32_16x16x32_bf16 v[72:75], v[164:167], a[184:187], v[72:75]
buffer_load_dwordx4 v[64:67], v4, s[24:27], s65 offen offset:0 sc1
v_mfma_f32_16x16x32_bf16 v[76:79], v[164:167], a[188:191], v[76:79]
s_cmp_ge_u32 s91, 163840
s_cselect_b32 s91, 0, s91
ds_read_b128 v[152:155], v7 offset:2048
v_mfma_f32_16x16x32_bf16 v[76:79], v[160:163], a[180:183], v[76:79]
s_waitcnt lgkmcnt(7)
v_add_u32 v8, s91, v4
v_mfma_f32_16x16x32_bf16 v[80:83], v[168:171], a[176:179], v[80:83]
buffer_load_dwordx4 v4, s[24:27], s64 offen offset:2048 sc1 lds
v_mfma_f32_16x16x32_bf16 v[80:83], v[172:175], a[184:187], v[80:83]
ds_read_b128 v[156:159], v7 offset:3072
v_mfma_f32_16x16x32_bf16 v[84:87], v[172:175], a[188:191], v[84:87]
s_waitcnt lgkmcnt(6)
ds_read_b128 v[160:163], v7 offset:4096
v_mfma_f32_16x16x32_bf16 v[84:87], v[168:171], a[180:183], v[84:87]
buffer_load_dwordx4 v4, s[24:27], s64 offen offset:3072 sc1 lds
v_mfma_f32_16x16x32_bf16 v[88:91], v[176:179], a[176:179], v[88:91]
s_add_u32 s93, s81, 73728
ds_read_b128 v[164:167], v7 offset:5120
v_mfma_f32_16x16x32_bf16 v[88:91], v[180:183], a[184:187], v[88:91]
v_mfma_f32_16x16x32_bf16 v[92:95], v[180:183], a[188:191], v[92:95]
buffer_load_dwordx4 v[68:71], v4, s[24:27], s93 offen offset:0 sc1
v_mfma_f32_16x16x32_bf16 v[92:95], v[176:179], a[180:183], v[92:95]
s_waitcnt lgkmcnt(6)
ds_read_b128 v[168:171], v7 offset:6144
v_mfma_f32_16x16x32_bf16 v[96:99], v[184:187], a[176:179], v[96:99]
ds_read_b128 v[172:175], v7 offset:7168
v_mfma_f32_16x16x32_bf16 v[96:99], v[188:191], a[184:187], v[96:99]
v_mfma_f32_16x16x32_bf16 v[100:103], v[188:191], a[188:191], v[100:103]
ds_read_b128 v[176:179], v7 offset:8192
v_mfma_f32_16x16x32_bf16 v[100:103], v[184:187], a[180:183], v[100:103]
s_waitcnt lgkmcnt(7) vmcnt(16)
v_mfma_f32_16x16x32_bf16 v[120:123], v[144:147], v[32:35], v[120:123]
ds_read_b128 v[180:183], v7 offset:9216
v_mfma_f32_16x16x32_bf16 v[120:123], v[148:151], v[40:43], v[120:123]
s_waitcnt vmcnt(14)
v_mfma_f32_16x16x32_bf16 v[124:127], v[148:151], v[44:47], v[124:127]
ds_read_b128 v[184:187], v7 offset:10240
v_mfma_f32_16x16x32_bf16 v[124:127], v[144:147], v[36:39], v[124:127]
s_waitcnt lgkmcnt(7)
v_mfma_f32_16x16x32_bf16 v[72:75], v[152:155], v[32:35], v[72:75]
ds_read_b128 v[188:191], v7 offset:11264
v_mfma_f32_16x16x32_bf16 v[72:75], v[156:159], v[40:43], v[72:75]
v_mfma_f32_16x16x32_bf16 v[76:79], v[156:159], v[44:47], v[76:79]
ds_read_b128 v[144:147], v7 offset:12288
v_mfma_f32_16x16x32_bf16 v[76:79], v[152:155], v[36:39], v[76:79]
s_waitcnt lgkmcnt(7)
v_mfma_f32_16x16x32_bf16 v[80:83], v[160:163], v[32:35], v[80:83]
ds_read_b128 v[148:151], v7 offset:13312
v_mfma_f32_16x16x32_bf16 v[80:83], v[164:167], v[40:43], v[80:83]
v_mfma_f32_16x16x32_bf16 v[84:87], v[164:167], v[44:47], v[84:87]
ds_read_b128 v[152:155], v7 offset:14336
v_mfma_f32_16x16x32_bf16 v[84:87], v[160:163], v[36:39], v[84:87]
s_waitcnt lgkmcnt(7)
v_mfma_f32_16x16x32_bf16 v[88:91], v[168:171], v[32:35], v[88:91]
ds_read_b128 v[156:159], v7 offset:15360
v_mfma_f32_16x16x32_bf16 v[88:91], v[172:175], v[40:43], v[88:91]
s_add_u32 s91, s91, 16384
s_cmp_ge_u32 s91, 163840
s_cselect_b32 s91, 0, s91
v_mfma_f32_16x16x32_bf16 v[92:95], v[172:175], v[44:47], v[92:95]
ds_read_b128 v[160:163], v8 offset:0
v_add_u32 v7, s91, v4
v_mfma_f32_16x16x32_bf16 v[92:95], v[168:171], v[36:39], v[92:95]
s_waitcnt lgkmcnt(7)
v_mfma_f32_16x16x32_bf16 v[96:99], v[176:179], v[32:35], v[96:99]
ds_read_b128 v[164:167], v8 offset:1024
v_mfma_f32_16x16x32_bf16 v[96:99], v[180:183], v[40:43], v[96:99]
v_mfma_f32_16x16x32_bf16 v[100:103], v[180:183], v[44:47], v[100:103]
s_mov_b32 m0, s70
s_mov_b32 s64, s68
s_add_u32 s68, s68, 16384
v_mfma_f32_16x16x32_bf16 v[100:103], v[176:179], v[36:39], v[100:103]
s_waitcnt lgkmcnt(6) vmcnt(12)
s_waitcnt vmcnt(8)
ds_read_b128 v[168:171], v8 offset:2048
v_mfma_f32_16x16x32_bf16 v[120:123], v[184:187], v[48:51], v[120:123]
s_add_u32 s70, s70, 16384
s_cmp_ge_u32 s70, 163840
s_cselect_b32 s70, s80, s70
v_mfma_f32_16x16x32_bf16 v[120:123], v[188:191], v[56:59], v[120:123]
buffer_load_dwordx4 v4, s[24:27], s64 offen offset:0 sc1 lds
v_mfma_f32_16x16x32_bf16 v[124:127], v[188:191], v[60:63], v[124:127]
ds_read_b128 v[172:175], v8 offset:3072
v_mfma_f32_16x16x32_bf16 v[124:127], v[184:187], v[52:55], v[124:127]
s_waitcnt lgkmcnt(6)
ds_read_b128 v[176:179], v8 offset:4096
v_mfma_f32_16x16x32_bf16 v[72:75], v[144:147], v[48:51], v[72:75]
buffer_load_dwordx4 v4, s[24:27], s64 offen offset:1024 sc1 lds
v_mfma_f32_16x16x32_bf16 v[72:75], v[148:151], v[56:59], v[72:75]
ds_read_b128 v[180:183], v8 offset:5120
v_mfma_f32_16x16x32_bf16 v[76:79], v[148:151], v[60:63], v[76:79]
s_waitcnt lgkmcnt(6)
ds_read_b128 v[184:187], v8 offset:6144
v_mfma_f32_16x16x32_bf16 v[76:79], v[144:147], v[52:55], v[76:79]
buffer_load_dwordx4 v4, s[24:27], s64 offen offset:2048 sc1 lds
v_mfma_f32_16x16x32_bf16 v[80:83], v[152:155], v[48:51], v[80:83]
ds_read_b128 v[188:191], v8 offset:7168
v_mfma_f32_16x16x32_bf16 v[80:83], v[156:159], v[56:59], v[80:83]
v_mfma_f32_16x16x32_bf16 v[84:87], v[156:159], v[60:63], v[84:87]
buffer_load_dwordx4 v4, s[24:27], s64 offen offset:3072 sc1 lds
v_mfma_f32_16x16x32_bf16 v[84:87], v[152:155], v[52:55], v[84:87]
s_waitcnt lgkmcnt(6)
ds_read_b128 v[144:147], v8 offset:8192
v_mfma_f32_16x16x32_bf16 v[88:91], v[160:163], v[48:51], v[88:91]
s_mov_b32 m0, s70
s_mov_b32 s64, s68
s_add_u32 s68, s68, 16384
v_mfma_f32_16x16x32_bf16 v[88:91], v[164:167], v[56:59], v[88:91]
s_waitcnt lgkmcnt(5)
ds_read_b128 v[148:151], v8 offset:9216
v_mfma_f32_16x16x32_bf16 v[92:95], v[164:167], v[60:63], v[92:95]
s_add_u32 s70, s70, 16384
s_cmp_ge_u32 s70, 163840
s_cselect_b32 s70, s80, s70
v_mfma_f32_16x16x32_bf16 v[92:95], v[160:163], v[52:55], v[92:95]
buffer_load_dwordx4 v4, s[24:27], s64 offen offset:0 sc1 lds
v_mfma_f32_16x16x32_bf16 v[96:99], v[168:171], v[48:51], v[96:99]
ds_read_b128 v[152:155], v8 offset:10240
v_mfma_f32_16x16x32_bf16 v[96:99], v[172:175], v[56:59], v[96:99]
ds_read_b128 v[156:159], v8 offset:11264
v_mfma_f32_16x16x32_bf16 v[100:103], v[172:175], v[60:63], v[100:103]
buffer_load_dwordx4 v4, s[24:27], s64 offen offset:1024 sc1 lds
v_mfma_f32_16x16x32_bf16 v[100:103], v[168:171], v[52:55], v[100:103]
s_waitcnt lgkmcnt(6) vmcnt(9)
ds_read_b128 v[160:163], v8 offset:12288
v_mfma_f32_16x16x32_bf16 v[120:123], v[176:179], v[64:67], v[120:123]
s_waitcnt vmcnt(6)
ds_read_b128 v[164:167], v8 offset:13312
v_mfma_f32_16x16x32_bf16 v[124:127], v[176:179], v[68:71], v[124:127]
buffer_load_dwordx4 v4, s[24:27], s64 offen offset:2048 sc1 lds
v_mfma_f32_16x16x32_bf16 v[72:75], v[180:183], v[64:67], v[72:75]
ds_read_b128 v[168:171], v8 offset:14336
v_mfma_f32_16x16x32_bf16 v[76:79], v[180:183], v[68:71], v[76:79]
s_waitcnt lgkmcnt(7)
v_mfma_f32_16x16x32_bf16 v[80:83], v[184:187], v[64:67], v[80:83]
s_waitcnt vmcnt(8)
ds_read_b128 v[172:175], v8 offset:15360
v_mfma_f32_16x16x32_bf16 v[84:87], v[184:187], v[68:71], v[84:87]
s_barrier
v_mfma_f32_16x16x32_bf16 v[88:91], v[188:191], v[64:67], v[88:91]
buffer_load_dwordx4 v4, s[24:27], s64 offen offset:3072 sc1 lds
v_mfma_f32_16x16x32_bf16 v[92:95], v[188:191], v[68:71], v[92:95]
s_waitcnt lgkmcnt(6)
s_add_u32 s91, s91, 16384
ds_read_b128 v[176:179], v7 offset:0
v_mfma_f32_16x16x32_bf16 v[96:99], v[144:147], v[64:67], v[96:99]
ds_read_b128 v[180:183], v7 offset:1024
v_cvt_pk_bf16_f32 v228, v120, v121
v_mfma_f32_16x16x32_bf16 v[100:103], v[144:147], v[68:71], v[100:103]
s_cmp_ge_u32 s91, 163840
s_cselect_b32 s91, 0, s91
v_cvt_pk_bf16_f32 v229, v122, v123
v_mfma_f32_16x16x32_bf16 v[104:107], v[148:151], a[224:227], v[104:107]
s_waitcnt lgkmcnt(6)
ds_read_b128 v[184:187], v7 offset:2048
v_cvt_pk_bf16_f32 v230, v124, v125
v_mfma_f32_16x16x32_bf16 v[104:107], v[152:155], a[232:235], v[104:107]
v_cvt_pk_bf16_f32 v231, v126, v127
v_add_u32 v8, s91, v4
v_mfma_f32_16x16x32_bf16 v[108:111], v[152:155], a[236:239], v[108:111]
buffer_store_dwordx4 v[228:231], v4, s[24:27], s55 offen offset:0 sc1
v_mfma_f32_16x16x32_bf16 v[108:111], v[148:151], a[228:231], v[108:111]
ds_read_b128 v[188:191], v7 offset:3072
v_cvt_pk_bf16_f32 v72, v72, v73
v_mfma_f32_16x16x32_bf16 v[112:115], v[156:159], a[224:227], v[112:115]
s_waitcnt lgkmcnt(6)
ds_read_b128 v[144:147], v7 offset:4096
v_cvt_pk_bf16_f32 v73, v74, v75
v_mfma_f32_16x16x32_bf16 v[112:115], v[160:163], a[232:235], v[112:115]
v_cvt_pk_bf16_f32 v74, v80, v81
v_mfma_f32_16x16x32_bf16 v[116:119], v[160:163], a[236:239], v[116:119]
ds_read_b128 v[148:151], v7 offset:5120
v_cvt_pk_bf16_f32 v75, v82, v83
v_mfma_f32_16x16x32_bf16 v[116:119], v[156:159], a[228:231], v[116:119]
buffer_store_dwordx4 v[72:75], v4, s[24:27], s52 offen offset:0 sc1
v_mfma_f32_16x16x32_bf16 v[104:107], v[164:167], a[240:243], v[104:107]
s_waitcnt lgkmcnt(6)
ds_read_b128 v[152:155], v7 offset:6144
v_cvt_pk_bf16_f32 v76, v76, v77
v_mfma_f32_16x16x32_bf16 v[104:107], v[168:171], a[248:251], v[104:107]
v_cvt_pk_bf16_f32 v77, v78, v79
v_mfma_f32_16x16x32_bf16 v[108:111], v[168:171], a[252:255], v[108:111]
ds_read_b128 v[156:159], v7 offset:7168
v_cvt_pk_bf16_f32 v78, v84, v85
v_mfma_f32_16x16x32_bf16 v[108:111], v[164:167], a[244:247], v[108:111]
s_waitcnt lgkmcnt(6)
v_cvt_pk_bf16_f32 v79, v86, v87
v_mfma_f32_16x16x32_bf16 v[112:115], v[172:175], a[240:243], v[112:115]
buffer_store_dwordx4 v[76:79], v4, s[24:27], s52 offen offset:1024 sc1
v_mfma_f32_16x16x32_bf16 v[112:115], v[176:179], a[248:251], v[112:115]
ds_read_b128 v[160:163], v7 offset:8192
v_cvt_pk_bf16_f32 v88, v88, v89
v_mfma_f32_16x16x32_bf16 v[116:119], v[176:179], a[252:255], v[116:119]
ds_read_b128 v[164:167], v7 offset:9216
v_cvt_pk_bf16_f32 v89, v90, v91
v_mfma_f32_16x16x32_bf16 v[116:119], v[172:175], a[244:247], v[116:119]
v_cvt_pk_bf16_f32 v90, v96, v97
v_mfma_f32_16x16x32_bf16 v[104:107], v[180:183], a[96:99], v[104:107]
s_waitcnt lgkmcnt(6)
ds_read_b128 v[168:171], v7 offset:10240
v_cvt_pk_bf16_f32 v91, v98, v99
v_mfma_f32_16x16x32_bf16 v[104:107], v[184:187], a[104:107], v[104:107]
buffer_store_dwordx4 v[88:91], v4, s[24:27], s53 offen offset:0 sc1
v_mfma_f32_16x16x32_bf16 v[108:111], v[184:187], a[108:111], v[108:111]
ds_read_b128 v[172:175], v7 offset:11264
v_cvt_pk_bf16_f32 v92, v92, v93
v_mfma_f32_16x16x32_bf16 v[108:111], v[180:183], a[100:103], v[108:111]
v_cvt_pk_bf16_f32 v93, v94, v95
v_mfma_f32_16x16x32_bf16 v[112:115], v[188:191], a[96:99], v[112:115]
s_waitcnt lgkmcnt(6)
ds_read_b128 v[176:179], v7 offset:12288
v_cvt_pk_bf16_f32 v94, v100, v101
v_mfma_f32_16x16x32_bf16 v[112:115], v[144:147], a[104:107], v[112:115]
v_cvt_pk_bf16_f32 v95, v102, v103
v_mfma_f32_16x16x32_bf16 v[116:119], v[144:147], a[108:111], v[116:119]
buffer_store_dwordx4 v[92:95], v4, s[24:27], s53 offen offset:1024 sc1
v_mfma_f32_16x16x32_bf16 v[116:119], v[188:191], a[100:103], v[116:119]
ds_read_b128 v[180:183], v7 offset:13312
v_mfma_f32_16x16x32_bf16 v[104:107], v[148:151], a[112:115], v[104:107]
s_waitcnt lgkmcnt(6)
ds_read_b128 v[184:187], v7 offset:14336
v_mfma_f32_16x16x32_bf16 v[104:107], v[152:155], a[120:123], v[104:107]
v_mfma_f32_16x16x32_bf16 v[108:111], v[152:155], a[124:127], v[108:111]
ds_read_b128 v[188:191], v7 offset:15360
v_mfma_f32_16x16x32_bf16 v[108:111], v[148:151], a[116:119], v[108:111]
s_add_u32 s91, s91, 16384
s_cmp_ge_u32 s91, 163840
s_cselect_b32 s91, 0, s91
v_mfma_f32_16x16x32_bf16 v[112:115], v[156:159], a[112:115], v[112:115]
s_waitcnt lgkmcnt(6)
ds_read_b128 v[144:147], v8 offset:0
v_add_u32 v7, s91, v4
v_mfma_f32_16x16x32_bf16 v[112:115], v[160:163], a[120:123], v[112:115]
v_mfma_f32_16x16x32_bf16 v[116:119], v[160:163], a[124:127], v[116:119]
ds_read_b128 v[148:151], v8 offset:1024
v_mfma_f32_16x16x32_bf16 v[116:119], v[156:159], a[116:119], v[116:119]
s_waitcnt lgkmcnt(6)
v_mfma_f32_16x16x32_bf16 v[104:107], v[164:167], a[128:131], v[104:107]
s_mov_b32 m0, s70
s_mov_b32 s64, s68
s_add_u32 s68, s68, 16384
v_mfma_f32_16x16x32_bf16 v[104:107], v[168:171], a[136:139], v[104:107]
ds_read_b128 v[152:155], v8 offset:2048
v_mfma_f32_16x16x32_bf16 v[108:111], v[168:171], a[140:143], v[108:111]
s_add_u32 s70, s70, 16384
s_cmp_ge_u32 s70, 163840
s_cselect_b32 s70, s80, s70
v_mfma_f32_16x16x32_bf16 v[108:111], v[164:167], a[132:135], v[108:111]
buffer_load_dwordx4 v4, s[24:27], s64 offen offset:0 sc1 lds
v_mfma_f32_16x16x32_bf16 v[112:115], v[172:175], a[128:131], v[112:115]
s_waitcnt lgkmcnt(5)
ds_read_b128 v[156:159], v8 offset:3072
v_mfma_f32_16x16x32_bf16 v[112:115], v[176:179], a[136:139], v[112:115]
ds_read_b128 v[160:163], v8 offset:4096
v_mfma_f32_16x16x32_bf16 v[116:119], v[176:179], a[140:143], v[116:119]
buffer_load_dwordx4 v4, s[24:27], s64 offen offset:1024 sc1 lds
v_mfma_f32_16x16x32_bf16 v[116:119], v[172:175], a[132:135], v[116:119]
ds_read_b128 v[164:167], v8 offset:5120
v_mfma_f32_16x16x32_bf16 v[104:107], v[180:183], a[144:147], v[104:107]
s_waitcnt lgkmcnt(6)
ds_read_b128 v[168:171], v8 offset:6144
v_mfma_f32_16x16x32_bf16 v[104:107], v[184:187], a[152:155], v[104:107]
buffer_load_dwordx4 v4, s[24:27], s64 offen offset:2048 sc1 lds
v_mfma_f32_16x16x32_bf16 v[108:111], v[184:187], a[156:159], v[108:111]
ds_read_b128 v[172:175], v8 offset:7168
v_mfma_f32_16x16x32_bf16 v[108:111], v[180:183], a[148:151], v[108:111]
s_waitcnt lgkmcnt(6)
v_mfma_f32_16x16x32_bf16 v[112:115], v[188:191], a[144:147], v[112:115]
buffer_load_dwordx4 v4, s[24:27], s64 offen offset:3072 sc1 lds
v_mfma_f32_16x16x32_bf16 v[112:115], v[144:147], a[152:155], v[112:115]
ds_read_b128 v[176:179], v8 offset:8192
v_mfma_f32_16x16x32_bf16 v[116:119], v[144:147], a[156:159], v[116:119]
s_mov_b32 m0, s70
s_mov_b32 s64, s68
s_add_u32 s68, s68, 16384
v_mfma_f32_16x16x32_bf16 v[116:119], v[188:191], a[148:151], v[116:119]
s_waitcnt lgkmcnt(5)
ds_read_b128 v[180:183], v8 offset:9216
v_mfma_f32_16x16x32_bf16 v[104:107], v[148:151], a[160:163], v[104:107]
s_add_u32 s70, s70, 16384
s_cmp_ge_u32 s70, 163840
s_cselect_b32 s70, s80, s70
v_mfma_f32_16x16x32_bf16 v[104:107], v[152:155], a[168:171], v[104:107]
buffer_load_dwordx4 v4, s[24:27], s64 offen offset:0 sc1 lds
v_mfma_f32_16x16x32_bf16 v[108:111], v[152:155], a[172:175], v[108:111]
ds_read_b128 v[184:187], v8 offset:10240
v_mfma_f32_16x16x32_bf16 v[108:111], v[148:151], a[164:167], v[108:111]
s_waitcnt lgkmcnt(5)
ds_read_b128 v[188:191], v8 offset:11264
v_mfma_f32_16x16x32_bf16 v[112:115], v[156:159], a[160:163], v[112:115]
buffer_load_dwordx4 v4, s[24:27], s64 offen offset:1024 sc1 lds
v_mfma_f32_16x16x32_bf16 v[112:115], v[160:163], a[168:171], v[112:115]
ds_read_b128 v[144:147], v8 offset:12288
v_mfma_f32_16x16x32_bf16 v[116:119], v[160:163], a[172:175], v[116:119]
ds_read_b128 v[148:151], v8 offset:13312
v_mfma_f32_16x16x32_bf16 v[116:119], v[156:159], a[164:167], v[116:119]
buffer_load_dwordx4 v4, s[24:27], s64 offen offset:2048 sc1 lds
v_mfma_f32_16x16x32_bf16 v[104:107], v[164:167], a[176:179], v[104:107]
s_waitcnt lgkmcnt(6)
ds_read_b128 v[152:155], v8 offset:14336
v_mfma_f32_16x16x32_bf16 v[104:107], v[168:171], a[184:187], v[104:107]
v_mfma_f32_16x16x32_bf16 v[108:111], v[168:171], a[188:191], v[108:111]
s_waitcnt vmcnt(12) lgkmcnt(5)
ds_read_b128 v[156:159], v8 offset:15360
v_mfma_f32_16x16x32_bf16 v[108:111], v[164:167], a[180:183], v[108:111]
s_barrier
v_mfma_f32_16x16x32_bf16 v[112:115], v[172:175], a[176:179], v[112:115]
buffer_load_dwordx4 v4, s[24:27], s64 offen offset:3072 sc1 lds
v_mfma_f32_16x16x32_bf16 v[112:115], v[176:179], a[184:187], v[112:115]
s_add_u32 s91, s91, 16384
ds_read_b128 v[160:163], v7 offset:0
v_mfma_f32_16x16x32_bf16 v[116:119], v[176:179], a[188:191], v[116:119]
s_cmp_ge_u32 s91, 163840
s_cselect_b32 s91, 0, s91
ds_read_b128 v[164:167], v7 offset:1024
v_mfma_f32_16x16x32_bf16 v[116:119], v[172:175], a[180:183], v[116:119]
v_add_u32 v8, s91, v4
v_mfma_f32_16x16x32_bf16 v[104:107], v[180:183], v[32:35], v[104:107]
s_waitcnt lgkmcnt(6)
ds_read_b128 v[168:171], v7 offset:2048
v_mfma_f32_16x16x32_bf16 v[104:107], v[184:187], v[40:43], v[104:107]
v_mfma_f32_16x16x32_bf16 v[108:111], v[184:187], v[44:47], v[108:111]
ds_read_b128 v[172:175], v7 offset:3072
v_mfma_f32_16x16x32_bf16 v[108:111], v[180:183], v[36:39], v[108:111]
v_mfma_f32_16x16x32_bf16 v[112:115], v[188:191], v[32:35], v[112:115]
s_waitcnt lgkmcnt(6)
ds_read_b128 v[176:179], v7 offset:4096
v_mfma_f32_16x16x32_bf16 v[112:115], v[144:147], v[40:43], v[112:115]
v_mfma_f32_16x16x32_bf16 v[116:119], v[144:147], v[44:47], v[116:119]
ds_read_b128 v[180:183], v7 offset:5120
v_mfma_f32_16x16x32_bf16 v[116:119], v[188:191], v[36:39], v[116:119]
v_mfma_f32_16x16x32_bf16 v[104:107], v[148:151], v[48:51], v[104:107]
s_waitcnt vmcnt(8) lgkmcnt(6)
ds_read_b128 v[184:187], v7 offset:6144
v_mfma_f32_16x16x32_bf16 v[104:107], v[152:155], v[56:59], v[104:107]
buffer_atomic_add v1, v0, s[24:27], s73 offen offset:0 sc1
v_mfma_f32_16x16x32_bf16 v[108:111], v[152:155], v[60:63], v[108:111]
ds_read_b128 v[188:191], v7 offset:7168
v_mfma_f32_16x16x32_bf16 v[108:111], v[148:151], v[52:55], v[108:111]
v_mfma_f32_16x16x32_bf16 v[112:115], v[156:159], v[48:51], v[112:115]
s_waitcnt lgkmcnt(6)
ds_read_b128 v[144:147], v7 offset:8192
v_mfma_f32_16x16x32_bf16 v[112:115], v[160:163], v[56:59], v[112:115]
v_mfma_f32_16x16x32_bf16 v[116:119], v[160:163], v[60:63], v[116:119]
ds_read_b128 v[148:151], v7 offset:9216
v_mfma_f32_16x16x32_bf16 v[116:119], v[156:159], v[52:55], v[116:119]
v_mfma_f32_16x16x32_bf16 v[104:107], v[164:167], v[64:67], v[104:107]
ds_read_b128 v[152:155], v7 offset:10240
v_mfma_f32_16x16x32_bf16 v[108:111], v[164:167], v[68:71], v[108:111]
s_waitcnt lgkmcnt(7)
v_mfma_f32_16x16x32_bf16 v[112:115], v[168:171], v[64:67], v[112:115]
ds_read_b128 v[156:159], v7 offset:11264
v_mfma_f32_16x16x32_bf16 v[116:119], v[168:171], v[68:71], v[116:119]
v_mfma_f32_16x16x32_bf16 v[128:131], v[172:175], a[0:3], 0
s_waitcnt lgkmcnt(6)
ds_read_b128 v[160:163], v7 offset:12288
v_mfma_f32_16x16x32_bf16 v[128:131], v[176:179], a[8:11], v[128:131]
v_mfma_f32_16x16x32_bf16 v[132:135], v[176:179], a[12:15], 0
ds_read_b128 v[164:167], v7 offset:13312
v_mfma_f32_16x16x32_bf16 v[132:135], v[172:175], a[4:7], v[132:135]
v_mfma_f32_16x16x32_bf16 v[136:139], v[180:183], a[0:3], 0
s_waitcnt lgkmcnt(6)
ds_read_b128 v[168:171], v7 offset:14336
v_mfma_f32_16x16x32_bf16 v[136:139], v[184:187], a[8:11], v[136:139]
v_cvt_pk_bf16_f32 v104, v104, v105
v_mfma_f32_16x16x32_bf16 v[140:143], v[184:187], a[12:15], 0
ds_read_b128 v[172:175], v7 offset:15360
v_cvt_pk_bf16_f32 v105, v106, v107
v_mfma_f32_16x16x32_bf16 v[140:143], v[180:183], a[4:7], v[140:143]
s_add_u32 s91, s91, 16384
v_cvt_pk_bf16_f32 v106, v112, v113
v_mfma_f32_16x16x32_bf16 v[128:131], v[188:191], a[16:19], v[128:131]
s_waitcnt lgkmcnt(6)
ds_read_b128 v[176:179], v8 offset:0
v_cvt_pk_bf16_f32 v107, v114, v115
v_mfma_f32_16x16x32_bf16 v[128:131], v[144:147], a[24:27], v[128:131]
buffer_store_dwordx4 v[104:107], v4, s[24:27], s54 offen offset:0 sc1
v_mfma_f32_16x16x32_bf16 v[132:135], v[144:147], a[28:31], v[132:135]
ds_read_b128 v[180:183], v8 offset:1024
v_cvt_pk_bf16_f32 v108, v108, v109
v_mfma_f32_16x16x32_bf16 v[132:135], v[188:191], a[20:23], v[132:135]
s_cmp_ge_u32 s91, 163840
s_cselect_b32 s91, 0, s91
v_cvt_pk_bf16_f32 v109, v110, v111
v_mfma_f32_16x16x32_bf16 v[136:139], v[148:151], a[16:19], v[136:139]
s_waitcnt lgkmcnt(6)
ds_read_b128 v[184:187], v8 offset:2048
v_cvt_pk_bf16_f32 v110, v116, v117
v_mfma_f32_16x16x32_bf16 v[136:139], v[152:155], a[24:27], v[136:139]
s_waitcnt lgkmcnt(5)
v_cvt_pk_bf16_f32 v111, v118, v119
v_add_u32 v7, s91, v4
v_mfma_f32_16x16x32_bf16 v[140:143], v[152:155], a[28:31], v[140:143]
buffer_store_dwordx4 v[108:111], v4, s[24:27], s54 offen offset:1024 sc1
v_mfma_f32_16x16x32_bf16 v[140:143], v[148:151], a[20:23], v[140:143]
s_mov_b32 m0, s70
s_mov_b32 s64, s68
s_add_u32 s68, s68, 16384
v_mfma_f32_16x16x32_bf16 v[128:131], v[156:159], a[32:35], v[128:131]
s_cmp_lt_u32 s3, 3
s_cselect_b32 s68, s64, 2147418112
ds_read_b128 v[188:191], v8 offset:3072
v_mfma_f32_16x16x32_bf16 v[128:131], v[160:163], a[40:43], v[128:131]
buffer_load_dwordx4 v4, s[24:27], s64 offen offset:0 sc1 lds
v_mfma_f32_16x16x32_bf16 v[132:135], v[160:163], a[44:47], v[132:135]
ds_read_b128 v[144:147], v8 offset:4096
v_mfma_f32_16x16x32_bf16 v[132:135], v[156:159], a[36:39], v[132:135]
s_waitcnt lgkmcnt(5)
ds_read_b128 v[148:151], v8 offset:5120
v_mfma_f32_16x16x32_bf16 v[136:139], v[164:167], a[32:35], v[136:139]
buffer_load_dwordx4 v4, s[24:27], s68 offen offset:1024 sc1 lds
v_mfma_f32_16x16x32_bf16 v[136:139], v[168:171], a[40:43], v[136:139]
ds_read_b128 v[152:155], v8 offset:6144
v_mfma_f32_16x16x32_bf16 v[140:143], v[168:171], a[44:47], v[140:143]
ds_read_b128 v[156:159], v8 offset:7168
v_mfma_f32_16x16x32_bf16 v[140:143], v[164:167], a[36:39], v[140:143]
buffer_load_dwordx4 v4, s[24:27], s68 offen offset:2048 sc1 lds
v_mfma_f32_16x16x32_bf16 v[128:131], v[172:175], a[48:51], v[128:131]
s_waitcnt lgkmcnt(6)
ds_read_b128 v[160:163], v8 offset:8192
v_mfma_f32_16x16x32_bf16 v[128:131], v[176:179], a[56:59], v[128:131]
v_mfma_f32_16x16x32_bf16 v[132:135], v[176:179], a[60:63], v[132:135]
buffer_load_dwordx4 v4, s[24:27], s68 offen offset:3072 sc1 lds
v_mfma_f32_16x16x32_bf16 v[132:135], v[172:175], a[52:55], v[132:135]
ds_read_b128 v[164:167], v8 offset:9216
v_mfma_f32_16x16x32_bf16 v[136:139], v[180:183], a[48:51], v[136:139]
s_waitcnt lgkmcnt(6)
ds_read_b128 v[168:171], v8 offset:10240
v_mfma_f32_16x16x32_bf16 v[136:139], v[184:187], a[56:59], v[136:139]
buffer_load_dword v12, v10, s[24:27], s73 offen sc1
v_mfma_f32_16x16x32_bf16 v[140:143], v[184:187], a[60:63], v[140:143]
ds_read_b128 v[172:175], v8 offset:11264
v_mfma_f32_16x16x32_bf16 v[140:143], v[180:183], a[52:55], v[140:143]
v_mfma_f32_16x16x32_bf16 v[128:131], v[188:191], a[64:67], v[128:131]
s_waitcnt lgkmcnt(6)
ds_read_b128 v[176:179], v8 offset:12288
v_mfma_f32_16x16x32_bf16 v[128:131], v[144:147], a[72:75], v[128:131]
v_mfma_f32_16x16x32_bf16 v[132:135], v[144:147], a[76:79], v[132:135]
ds_read_b128 v[180:183], v8 offset:13312
v_mfma_f32_16x16x32_bf16 v[132:135], v[188:191], a[68:71], v[132:135]
v_mfma_f32_16x16x32_bf16 v[136:139], v[148:151], a[64:67], v[136:139]
s_waitcnt lgkmcnt(6)
ds_read_b128 v[184:187], v8 offset:14336
v_mfma_f32_16x16x32_bf16 v[136:139], v[152:155], a[72:75], v[136:139]
v_mfma_f32_16x16x32_bf16 v[140:143], v[152:155], a[76:79], v[140:143]
s_waitcnt vmcnt(8)
ds_read_b128 v[188:191], v8 offset:15360
v_mfma_f32_16x16x32_bf16 v[140:143], v[148:151], a[68:71], v[140:143]
s_barrier
v_mfma_f32_16x16x32_bf16 v[128:131], v[156:159], a[80:83], v[128:131]
s_waitcnt lgkmcnt(6)
s_add_u32 s91, s91, 16384
ds_read_b128 v[144:147], v7 offset:0
v_mfma_f32_16x16x32_bf16 v[128:131], v[160:163], a[88:91], v[128:131]
s_cmp_ge_u32 s91, 163840
s_cselect_b32 s91, 0, s91
v_add_u32 v8, s91, v4
v_mfma_f32_16x16x32_bf16 v[132:135], v[160:163], a[92:95], v[132:135]
ds_read_b128 v[148:151], v7 offset:1024
v_mfma_f32_16x16x32_bf16 v[132:135], v[156:159], a[84:87], v[132:135]
v_mfma_f32_16x16x32_bf16 v[136:139], v[164:167], a[80:83], v[136:139]
s_waitcnt lgkmcnt(6)
ds_read_b128 v[152:155], v7 offset:2048
v_mfma_f32_16x16x32_bf16 v[136:139], v[168:171], a[88:91], v[136:139]
v_mfma_f32_16x16x32_bf16 v[140:143], v[168:171], a[92:95], v[140:143]
ds_read_b128 v[156:159], v7 offset:3072
v_mfma_f32_16x16x32_bf16 v[140:143], v[164:167], a[84:87], v[140:143]
v_mfma_f32_16x16x32_bf16 v[128:131], v[172:175], a[192:195], v[128:131]
s_waitcnt lgkmcnt(6)
ds_read_b128 v[160:163], v7 offset:4096
v_mfma_f32_16x16x32_bf16 v[128:131], v[176:179], a[200:203], v[128:131]
v_mfma_f32_16x16x32_bf16 v[132:135], v[176:179], a[204:207], v[132:135]
ds_read_b128 v[164:167], v7 offset:5120
v_mfma_f32_16x16x32_bf16 v[132:135], v[172:175], a[196:199], v[132:135]
v_mfma_f32_16x16x32_bf16 v[136:139], v[180:183], a[192:195], v[136:139]
s_waitcnt lgkmcnt(6)
ds_read_b128 v[168:171], v7 offset:6144
v_mfma_f32_16x16x32_bf16 v[136:139], v[184:187], a[200:203], v[136:139]
v_mfma_f32_16x16x32_bf16 v[140:143], v[184:187], a[204:207], v[140:143]
s_waitcnt vmcnt(5)
ds_read_b128 v[172:175], v7 offset:7168
v_mfma_f32_16x16x32_bf16 v[140:143], v[180:183], a[196:199], v[140:143]
buffer_atomic_add v1, v0, s[24:27], s73 offen offset:16 sc1
v_mfma_f32_16x16x32_bf16 v[128:131], v[188:191], a[208:211], v[128:131]
s_waitcnt lgkmcnt(6)
ds_read_b128 v[176:179], v7 offset:8192
v_mfma_f32_16x16x32_bf16 v[128:131], v[144:147], a[216:219], v[128:131]
v_mfma_f32_16x16x32_bf16 v[132:135], v[144:147], a[220:223], v[132:135]
ds_read_b128 v[180:183], v7 offset:9216
v_mfma_f32_16x16x32_bf16 v[132:135], v[188:191], a[212:215], v[132:135]
s_waitcnt vmcnt(1)
v_mfma_f32_16x16x32_bf16 v[136:139], v[148:151], a[208:211], v[136:139]
s_waitcnt lgkmcnt(6)
ds_read_b128 v[184:187], v7 offset:10240
v_cmp_gt_u32 vcc, 4, v12
v_mfma_f32_16x16x32_bf16 v[136:139], v[152:155], a[216:219], v[136:139]
v_mfma_f32_16x16x32_bf16 v[140:143], v[152:155], a[220:223], v[140:143]
ds_read_b128 v[188:191], v7 offset:11264
v_mfma_f32_16x16x32_bf16 v[140:143], v[148:151], a[212:215], v[140:143]
v_mfma_f32_16x16x32_bf16 v[128:131], v[156:159], a[224:227], v[128:131]
s_waitcnt lgkmcnt(6)
ds_read_b128 v[144:147], v7 offset:12288
v_mfma_f32_16x16x32_bf16 v[128:131], v[160:163], a[232:235], v[128:131]
s_cbranch_vccnz CK_P1
CK_P1_R:
v_mfma_f32_16x16x32_bf16 v[132:135], v[160:163], a[236:239], v[132:135]
ds_read_b128 v[148:151], v7 offset:13312
v_mfma_f32_16x16x32_bf16 v[132:135], v[156:159], a[228:231], v[132:135]
s_waitcnt lgkmcnt(6)
v_mfma_f32_16x16x32_bf16 v[136:139], v[164:167], a[224:227], v[136:139]
buffer_load_dwordx4 v[192:195], v4, s[24:27], s69 offen offset:0 sc1
v_mfma_f32_16x16x32_bf16 v[136:139], v[168:171], a[232:235], v[136:139]
ds_read_b128 v[152:155], v7 offset:14336
v_mfma_f32_16x16x32_bf16 v[140:143], v[168:171], a[236:239], v[140:143]
ds_read_b128 v[156:159], v7 offset:15360
v_mfma_f32_16x16x32_bf16 v[140:143], v[164:167], a[228:231], v[140:143]
buffer_load_dwordx4 v[196:199], v4, s[24:27], s69 offen offset:1024 sc1
v_mfma_f32_16x16x32_bf16 v[128:131], v[172:175], a[240:243], v[128:131]
s_waitcnt lgkmcnt(6)
s_add_u32 s91, s91, 16384
ds_read_b128 v[160:163], v8 offset:0
v_mfma_f32_16x16x32_bf16 v[128:131], v[176:179], a[248:251], v[128:131]
s_cmp_ge_u32 s91, 163840
s_cselect_b32 s91, 0, s91
v_add_u32 v7, s91, v4
v_mfma_f32_16x16x32_bf16 v[132:135], v[176:179], a[252:255], v[132:135]
L_PAD13:
s_cbranch_execz L_MAIN
buffer_load_dwordx4 v[200:203], v4, s[24:27], s69 offen offset:2048 sc1
v_mfma_f32_16x16x32_bf16 v[132:135], v[172:175], a[244:247], v[132:135]
ds_read_b128 v[164:167], v8 offset:1024
v_mfma_f32_16x16x32_bf16 v[136:139], v[180:183], a[240:243], v[136:139]
s_waitcnt lgkmcnt(6)
ds_read_b128 v[168:171], v8 offset:2048
v_mfma_f32_16x16x32_bf16 v[136:139], v[184:187], a[248:251], v[136:139]
buffer_load_dwordx4 v[204:207], v4, s[24:27], s69 offen offset:3072 sc1
v_mfma_f32_16x16x32_bf16 v[140:143], v[184:187], a[252:255], v[140:143]
ds_read_b128 v[172:175], v8 offset:3072
v_mfma_f32_16x16x32_bf16 v[140:143], v[180:183], a[244:247], v[140:143]
s_waitcnt lgkmcnt(6)
v_mfma_f32_16x16x32_bf16 v[128:131], v[188:191], a[96:99], v[128:131]
buffer_load_dwordx4 v[208:211], v4, s[24:27], s71 offen offset:0 sc1
v_mfma_f32_16x16x32_bf16 v[128:131], v[144:147], a[104:107], v[128:131]
ds_read_b128 v[176:179], v8 offset:4096
v_mfma_f32_16x16x32_bf16 v[132:135], v[144:147], a[108:111], v[132:135]
ds_read_b128 v[180:183], v8 offset:5120
v_mfma_f32_16x16x32_bf16 v[132:135], v[188:191], a[100:103], v[132:135]
buffer_load_dwordx4 v[212:215], v4, s[24:27], s71 offen offset:1024 sc1
v_mfma_f32_16x16x32_bf16 v[136:139], v[148:151], a[96:99], v[136:139]
s_waitcnt lgkmcnt(6)
ds_read_b128 v[184:187], v8 offset:6144
v_mfma_f32_16x16x32_bf16 v[136:139], v[152:155], a[104:107], v[136:139]
v_mfma_f32_16x16x32_bf16 v[140:143], v[152:155], a[108:111], v[140:143]
buffer_load_dwordx4 v[216:219], v4, s[24:27], s71 offen offset:2048 sc1
v_mfma_f32_16x16x32_bf16 v[140:143], v[148:151], a[100:103], v[140:143]
ds_read_b128 v[188:191], v8 offset:7168
v_mfma_f32_16x16x32_bf16 v[128:131], v[156:159], a[112:115], v[128:131]
s_waitcnt lgkmcnt(6)
ds_read_b128 v[144:147], v8 offset:8192
v_mfma_f32_16x16x32_bf16 v[128:131], v[160:163], a[120:123], v[128:131]
v_mfma_f32_16x16x32_bf16 v[132:135], v[160:163], a[124:127], v[132:135]
ds_read_b128 v[148:151], v8 offset:9216
v_mfma_f32_16x16x32_bf16 v[132:135], v[156:159], a[116:119], v[132:135]
v_mfma_f32_16x16x32_bf16 v[136:139], v[164:167], a[112:115], v[136:139]
s_waitcnt lgkmcnt(6)
ds_read_b128 v[152:155], v8 offset:10240
v_mfma_f32_16x16x32_bf16 v[136:139], v[168:171], a[120:123], v[136:139]
v_mfma_f32_16x16x32_bf16 v[140:143], v[168:171], a[124:127], v[140:143]
ds_read_b128 v[156:159], v8 offset:11264
v_mfma_f32_16x16x32_bf16 v[140:143], v[164:167], a[116:119], v[140:143]
v_mfma_f32_16x16x32_bf16 v[128:131], v[172:175], a[128:131], v[128:131]
s_waitcnt lgkmcnt(6)
ds_read_b128 v[160:163], v8 offset:12288
v_mfma_f32_16x16x32_bf16 v[128:131], v[176:179], a[136:139], v[128:131]
v_mfma_f32_16x16x32_bf16 v[132:135], v[176:179], a[140:143], v[132:135]
ds_read_b128 v[164:167], v8 offset:13312
v_mfma_f32_16x16x32_bf16 v[132:135], v[172:175], a[132:135], v[132:135]
v_mfma_f32_16x16x32_bf16 v[136:139], v[180:183], a[128:131], v[136:139]
s_waitcnt lgkmcnt(6)
ds_read_b128 v[168:171], v8 offset:14336
v_mfma_f32_16x16x32_bf16 v[136:139], v[184:187], a[136:139], v[136:139]
v_mfma_f32_16x16x32_bf16 v[140:143], v[184:187], a[140:143], v[140:143]
s_waitcnt vmcnt(9)
ds_read_b128 v[172:175], v8 offset:15360
v_mfma_f32_16x16x32_bf16 v[140:143], v[180:183], a[132:135], v[140:143]
s_barrier
v_mfma_f32_16x16x32_bf16 v[128:131], v[188:191], a[144:147], v[128:131]
s_waitcnt lgkmcnt(6)
ds_read_b128 v[176:179], v7 offset:0
v_mfma_f32_16x16x32_bf16 v[128:131], v[144:147], a[152:155], v[128:131]
v_mfma_f32_16x16x32_bf16 v[132:135], v[144:147], a[156:159], v[132:135]
ds_read_b128 v[180:183], v7 offset:1024
v_mfma_f32_16x16x32_bf16 v[132:135], v[188:191], a[148:151], v[132:135]
v_mfma_f32_16x16x32_bf16 v[136:139], v[148:151], a[144:147], v[136:139]
s_waitcnt lgkmcnt(6)
ds_read_b128 v[184:187], v7 offset:2048
v_mfma_f32_16x16x32_bf16 v[136:139], v[152:155], a[152:155], v[136:139]
v_mfma_f32_16x16x32_bf16 v[140:143], v[152:155], a[156:159], v[140:143]
ds_read_b128 v[188:191], v7 offset:3072
v_mfma_f32_16x16x32_bf16 v[140:143], v[148:151], a[148:151], v[140:143]
v_mfma_f32_16x16x32_bf16 v[128:131], v[156:159], a[160:163], v[128:131]
s_waitcnt lgkmcnt(6)
ds_read_b128 v[144:147], v7 offset:4096
v_mfma_f32_16x16x32_bf16 v[128:131], v[160:163], a[168:171], v[128:131]
v_mfma_f32_16x16x32_bf16 v[132:135], v[160:163], a[172:175], v[132:135]
ds_read_b128 v[148:151], v7 offset:5120
v_mfma_f32_16x16x32_bf16 v[132:135], v[156:159], a[164:167], v[132:135]
v_mfma_f32_16x16x32_bf16 v[136:139], v[164:167], a[160:163], v[136:139]
s_waitcnt lgkmcnt(6)
ds_read_b128 v[152:155], v7 offset:6144
v_mfma_f32_16x16x32_bf16 v[136:139], v[168:171], a[168:171], v[136:139]
v_mfma_f32_16x16x32_bf16 v[140:143], v[168:171], a[172:175], v[140:143]
ds_read_b128 v[156:159], v7 offset:7168
v_mfma_f32_16x16x32_bf16 v[140:143], v[164:167], a[164:167], v[140:143]
v_mfma_f32_16x16x32_bf16 v[128:131], v[172:175], a[176:179], v[128:131]
s_waitcnt lgkmcnt(6)
ds_read_b128 v[160:163], v7 offset:8192
v_mfma_f32_16x16x32_bf16 v[128:131], v[176:179], a[184:187], v[128:131]
v_mfma_f32_16x16x32_bf16 v[132:135], v[176:179], a[188:191], v[132:135]
ds_read_b128 v[164:167], v7 offset:9216
v_mfma_f32_16x16x32_bf16 v[132:135], v[172:175], a[180:183], v[132:135]
v_mfma_f32_16x16x32_bf16 v[136:139], v[180:183], a[176:179], v[136:139]
s_waitcnt lgkmcnt(6)
ds_read_b128 v[168:171], v7 offset:10240
v_mfma_f32_16x16x32_bf16 v[136:139], v[184:187], a[184:187], v[136:139]
v_mfma_f32_16x16x32_bf16 v[140:143], v[184:187], a[188:191], v[140:143]
ds_read_b128 v[172:175], v7 offset:11264
v_mfma_f32_16x16x32_bf16 v[140:143], v[180:183], a[180:183], v[140:143]
s_waitcnt lgkmcnt(6)
v_mfma_f32_16x16x32_bf16 v[128:131], v[188:191], v[32:35], v[128:131]
buffer_load_dword v12, v10, s[24:27], s73 offen offset:16 sc1
v_mfma_f32_16x16x32_bf16 v[128:131], v[144:147], v[40:43], v[128:131]
ds_read_b128 v[176:179], v7 offset:12288
v_mfma_f32_16x16x32_bf16 v[132:135], v[144:147], v[44:47], v[132:135]
v_mfma_f32_16x16x32_bf16 v[132:135], v[188:191], v[36:39], v[132:135]
v_mfma_f32_16x16x32_bf16 v[136:139], v[148:151], v[32:35], v[136:139]
s_waitcnt lgkmcnt(5)
v_mfma_f32_16x16x32_bf16 v[136:139], v[152:155], v[40:43], v[136:139]
v_mfma_f32_16x16x32_bf16 v[140:143], v[152:155], v[44:47], v[140:143]
v_mfma_f32_16x16x32_bf16 v[140:143], v[148:151], v[36:39], v[140:143]
v_mfma_f32_16x16x32_bf16 v[128:131], v[156:159], v[48:51], v[128:131]
s_waitcnt lgkmcnt(3)
v_mfma_f32_16x16x32_bf16 v[128:131], v[160:163], v[56:59], v[128:131]
v_mfma_f32_16x16x32_bf16 v[132:135], v[160:163], v[60:63], v[132:135]
v_mfma_f32_16x16x32_bf16 v[132:135], v[156:159], v[52:55], v[132:135]
v_mfma_f32_16x16x32_bf16 v[136:139], v[164:167], v[48:51], v[136:139]
s_waitcnt lgkmcnt(1)
v_mfma_f32_16x16x32_bf16 v[136:139], v[168:171], v[56:59], v[136:139]
v_mfma_f32_16x16x32_bf16 v[140:143], v[168:171], v[60:63], v[140:143]
v_mfma_f32_16x16x32_bf16 v[140:143], v[164:167], v[52:55], v[140:143]
v_mfma_f32_16x16x32_bf16 v[128:131], v[172:175], v[64:67], v[128:131]
v_mfma_f32_16x16x32_bf16 v[132:135], v[172:175], v[68:71], v[132:135]
s_waitcnt lgkmcnt(0)
v_mfma_f32_16x16x32_bf16 v[136:139], v[176:179], v[64:67], v[136:139]
v_mfma_f32_16x16x32_bf16 v[140:143], v[176:179], v[68:71], v[140:143]
s_waitcnt vmcnt(0)
v_cmp_gt_u32 vcc, 4, v12
s_nop 4
s_cbranch_vccnz CK_P2
CK_P2_R:
buffer_load_dwordx4 v[220:223], v4, s[24:27], s83 offen offset:0 sc1
buffer_load_dwordx4 v[224:227], v4, s[24:27], s83 offen offset:1024 sc1
s_and_b32 s54, s3, 1
s_mul_i32 s54, s54, 18432
s_mul_i32 s55, s86, 288
s_add_u32 s54, s54, s55
s_add_u32 s54, s54, 256
s_sub_u32 s55, 63, s72
s_mul_i32 s55, s55, 36864
s_add_u32 s55, s55, s54
s_mul_i32 s52, s72, 36864
s_add_u32 s54, s54, s52
s_lshl_b32 s53, s84, 6
s_sub_u32 s53, s53, 256
s_add_u32 s52, s54, s53
s_add_u32 s53, s55, s53
v_lshlrev_b32 v16, 16, v192
v_and_b32 v17, v13, v192
v_lshlrev_b32 v18, 16, v193
v_and_b32 v19, v13, v193
v_lshlrev_b32 v20, 16, v194
v_and_b32 v21, v13, v194
v_lshlrev_b32 v22, 16, v195
v_and_b32 v23, v13, v195
v_pk_add_f32 v[128:129], v[128:129], v[16:17]
v_pk_add_f32 v[130:131], v[130:131], v[18:19]
v_pk_add_f32 v[136:137], v[136:137], v[20:21]
v_pk_add_f32 v[138:139], v[138:139], v[22:23]
v_lshlrev_b32 v16, 16, v196
v_and_b32 v17, v13, v196
v_lshlrev_b32 v18, 16, v197
v_and_b32 v19, v13, v197
v_lshlrev_b32 v20, 16, v198
v_and_b32 v21, v13, v198
v_lshlrev_b32 v22, 16, v199
v_and_b32 v23, v13, v199
v_pk_add_f32 v[132:133], v[132:133], v[16:17]
v_pk_add_f32 v[134:135], v[134:135], v[18:19]
v_pk_add_f32 v[140:141], v[140:141], v[20:21]
v_pk_add_f32 v[142:143], v[142:143], v[22:23]
v_lshlrev_b32 v16, 16, v200
v_and_b32 v17, v13, v200
v_lshlrev_b32 v18, 16, v201
v_and_b32 v19, v13, v201
v_lshlrev_b32 v20, 16, v202
v_and_b32 v21, v13, v202
v_lshlrev_b32 v22, 16, v203
v_and_b32 v23, v13, v203
v_pk_add_f32 v[128:129], v[128:129], v[16:17]
v_pk_add_f32 v[130:131], v[130:131], v[18:19]
v_pk_add_f32 v[136:137], v[136:137], v[20:21]
v_pk_add_f32 v[138:139], v[138:139], v[22:23]
v_lshlrev_b32 v16, 16, v204
v_and_b32 v17, v13, v204
v_lshlrev_b32 v18, 16, v205
v_and_b32 v19, v13, v205
v_lshlrev_b32 v20, 16, v206
v_and_b32 v21, v13, v206
v_lshlrev_b32 v22, 16, v207
v_and_b32 v23, v13, v207
v_pk_add_f32 v[132:133], v[132:133], v[16:17]
v_pk_add_f32 v[134:135], v[134:135], v[18:19]
v_pk_add_f32 v[140:141], v[140:141], v[20:21]
v_pk_add_f32 v[142:143], v[142:143], v[22:23]
s_cmp_lg_u32 s3, s84
s_cbranch_scc1 L_NO9
v_lshlrev_b32 v16, 16, v208
v_and_b32 v17, v13, v208
v_lshlrev_b32 v18, 16, v209
v_and_b32 v19, v13, v209
v_lshlrev_b32 v20, 16, v210
v_and_b32 v21, v13, v210
v_lshlrev_b32 v22, 16, v211
v_and_b32 v23, v13, v211
v_pk_add_f32 v[120:121], v[120:121], v[16:17]
v_pk_add_f32 v[122:123], v[122:123], v[18:19]
v_pk_add_f32 v[124:125], v[124:125], v[20:21]
v_pk_add_f32 v[126:127], v[126:127], v[22:23]
v_lshlrev_b32 v16, 16, v212
v_and_b32 v17, v13, v212
v_lshlrev_b32 v18, 16, v213
v_and_b32 v19, v13, v213
v_lshlrev_b32 v20, 16, v214
v_and_b32 v21, v13, v214
v_lshlrev_b32 v22, 16, v215
v_and_b32 v23, v13, v215
v_pk_add_f32 v[120:121], v[120:121], v[16:17]
v_pk_add_f32 v[122:123], v[122:123], v[18:19]
v_pk_add_f32 v[124:125], v[124:125], v[20:21]
v_pk_add_f32 v[126:127], v[126:127], v[22:23]
v_lshlrev_b32 v16, 16, v216
v_and_b32 v17, v13, v216
v_lshlrev_b32 v18, 16, v217
v_and_b32 v19, v13, v217
v_lshlrev_b32 v20, 16, v218
v_and_b32 v21, v13, v218
v_lshlrev_b32 v22, 16, v219
v_and_b32 v23, v13, v219
v_pk_add_f32 v[120:121], v[120:121], v[16:17]
v_pk_add_f32 v[122:123], v[122:123], v[18:19]
v_pk_add_f32 v[124:125], v[124:125], v[20:21]
v_pk_add_f32 v[126:127], v[126:127], v[22:23]
v_cvt_pk_bf16_f32 v228, v120, v121
v_cvt_pk_bf16_f32 v229, v122, v123
v_cvt_pk_bf16_f32 v230, v124, v125
v_cvt_pk_bf16_f32 v231, v126, v127
s_waitcnt vmcnt(0)
buffer_store_dwordx2 v[228:229], v6, s[44:47], s54 offen sc1
buffer_store_dwordx2 v[230:231], v6, s[44:47], s55 offen sc1
s_branch L_9D
L_NO9:
s_waitcnt vmcnt(0)
L_9D:
v_lshlrev_b32 v16, 16, v220
v_and_b32 v17, v13, v220
v_lshlrev_b32 v18, 16, v221
v_and_b32 v19, v13, v221
v_lshlrev_b32 v20, 16, v222
v_and_b32 v21, v13, v222
v_lshlrev_b32 v22, 16, v223
v_and_b32 v23, v13, v223
v_pk_add_f32 v[128:129], v[128:129], v[16:17]
v_pk_add_f32 v[130:131], v[130:131], v[18:19]
v_pk_add_f32 v[136:137], v[136:137], v[20:21]
v_pk_add_f32 v[138:139], v[138:139], v[22:23]
v_cvt_pk_bf16_f32 v128, v128, v129
v_cvt_pk_bf16_f32 v129, v130, v131
v_cvt_pk_bf16_f32 v130, v136, v137
v_cvt_pk_bf16_f32 v131, v138, v139
s_nop 1
v_permlane16_swap_b32 v128, v130
v_permlane16_swap_b32 v129, v131
buffer_store_dwordx4 v[128:131], v5, s[44:47], s52 offen sc1
v_lshlrev_b32 v16, 16, v224
v_and_b32 v17, v13, v224
v_lshlrev_b32 v18, 16, v225
v_and_b32 v19, v13, v225
v_lshlrev_b32 v20, 16, v226
v_and_b32 v21, v13, v226
v_lshlrev_b32 v22, 16, v227
v_and_b32 v23, v13, v227
v_pk_add_f32 v[132:133], v[132:133], v[16:17]
v_pk_add_f32 v[134:135], v[134:135], v[18:19]
v_pk_add_f32 v[140:141], v[140:141], v[20:21]
v_pk_add_f32 v[142:143], v[142:143], v[22:23]
v_cvt_pk_bf16_f32 v132, v132, v133
v_cvt_pk_bf16_f32 v133, v134, v135
v_cvt_pk_bf16_f32 v134, v140, v141
v_cvt_pk_bf16_f32 v135, v142, v143
s_nop 1
v_permlane16_swap_b32 v132, v134
v_permlane16_swap_b32 v133, v135
buffer_store_dwordx4 v[132:135], v5, s[44:47], s53 offen sc1
L_END:
s_endpgm
L_SE2:
v_accvgpr_read_b32 v180, a224
v_accvgpr_read_b32 v182, a228
v_cmp_nle_f32 vcc, v180, v7
v_cmp_nle_f32 s[96:97], v182, v7
s_nop 3
s_or_b64 vcc, vcc, s[96:97]
s_cbranch_vccnz SLOW0
SLOW0_R:
s_add_u32 s53, s77, 180224
buffer_load_dwordx4 a[112:115], v4, s[24:27], s53 offen offset:0 sc1
v_mul_f32 v8, 0x3fb8aa3b, v8
v_mul_f32 v9, 0x3fb8aa3b, v9
v_exp_f32 v8, v8
v_exp_f32 v9, v9
s_nop 0
v_fma_f32 v180, v180, v8, v180
v_fma_f32 v182, v182, v9, v182
v_rcp_f32 v180, v180
v_rcp_f32 v182, v182
s_add_u32 s52, s78, 4096
v_mov_b32 v181, v180
v_mov_b32 v183, v182
v_pk_mul_f32 v[36:37], v[36:37], v[180:181]
v_pk_mul_f32 v[38:39], v[38:39], v[180:181]
v_pk_mul_f32 v[32:33], v[32:33], v[180:181]
v_pk_mul_f32 v[34:35], v[34:35], v[180:181]
v_cvt_pk_bf16_f32 v36, v36, v37
v_cvt_pk_bf16_f32 v37, v38, v39
v_cvt_pk_bf16_f32 v38, v32, v33
v_cvt_pk_bf16_f32 v39, v34, v35
buffer_store_dwordx4 v[36:39], v4, s[24:27], s78 offen offset:0 sc1
buffer_load_dwordx4 a[116:119], v4, s[24:27], s53 offen offset:1024 sc1
v_pk_mul_f32 v[116:117], v[116:117], v[182:183]
v_pk_mul_f32 v[118:119], v[118:119], v[182:183]
v_pk_mul_f32 v[132:133], v[132:133], v[182:183]
v_pk_mul_f32 v[134:135], v[134:135], v[182:183]
v_cvt_pk_bf16_f32 v116, v116, v117
v_cvt_pk_bf16_f32 v117, v118, v119
v_cvt_pk_bf16_f32 v118, v132, v133
v_cvt_pk_bf16_f32 v119, v134, v135
buffer_store_dwordx4 v[116:119], v4, s[24:27], s78 offen offset:1024 sc1
v_pk_mul_f32 v[196:197], v[196:197], v[180:181]
v_pk_mul_f32 v[198:199], v[198:199], v[180:181]
v_pk_mul_f32 v[204:205], v[204:205], v[180:181]
v_pk_mul_f32 v[206:207], v[206:207], v[180:181]
v_cvt_pk_bf16_f32 v196, v196, v197
v_cvt_pk_bf16_f32 v197, v198, v199
v_cvt_pk_bf16_f32 v198, v204, v205
v_cvt_pk_bf16_f32 v199, v206, v207
buffer_store_dwordx4 v[196:199], v4, s[24:27], s78 offen offset:2048 sc1
v_pk_mul_f32 v[184:185], v[184:185], v[182:183]
v_pk_mul_f32 v[186:187], v[186:187], v[182:183]
v_pk_mul_f32 v[240:241], v[240:241], v[182:183]
buffer_load_dwordx4 a[120:123], v4, s[24:27], s53 offen offset:2048 sc1
v_pk_mul_f32 v[242:243], v[242:243], v[182:183]
v_cvt_pk_bf16_f32 v184, v184, v185
v_cvt_pk_bf16_f32 v185, v186, v187
v_cvt_pk_bf16_f32 v186, v240, v241
v_cvt_pk_bf16_f32 v187, v242, v243
buffer_store_dwordx4 v[184:187], v4, s[24:27], s78 offen offset:3072 sc1
v_pk_mul_f32 v[108:109], v[108:109], v[180:181]
v_pk_mul_f32 v[110:111], v[110:111], v[180:181]
v_pk_mul_f32 v[40:41], v[40:41], v[180:181]
v_pk_mul_f32 v[42:43], v[42:43], v[180:181]
v_cvt_pk_bf16_f32 v108, v108, v109
v_cvt_pk_bf16_f32 v109, v110, v111
v_cvt_pk_bf16_f32 v110, v40, v41
v_cvt_pk_bf16_f32 v111, v42, v43
buffer_store_dwordx4 v[108:111], v4, s[24:27], s52 offen offset:0 sc1
v_pk_mul_f32 v[188:189], v[188:189], v[182:183]
v_pk_mul_f32 v[190:191], v[190:191], v[182:183]
v_pk_mul_f32 v[56:57], v[56:57], v[182:183]
v_pk_mul_f32 v[58:59], v[58:59], v[182:183]
v_cvt_pk_bf16_f32 v188, v188, v189
v_cvt_pk_bf16_f32 v189, v190, v191
buffer_load_dwordx4 a[124:127], v4, s[24:27], s53 offen offset:3072 sc1
v_cvt_pk_bf16_f32 v190, v56, v57
v_cvt_pk_bf16_f32 v191, v58, v59
buffer_store_dwordx4 v[188:191], v4, s[24:27], s52 offen offset:1024 sc1
v_pk_mul_f32 v[80:81], v[80:81], v[180:181]
v_pk_mul_f32 v[82:83], v[82:83], v[180:181]
v_pk_mul_f32 v[168:169], v[168:169], v[180:181]
v_pk_mul_f32 v[170:171], v[170:171], v[180:181]
v_cvt_pk_bf16_f32 v80, v80, v81
v_cvt_pk_bf16_f32 v81, v82, v83
v_cvt_pk_bf16_f32 v82, v168, v169
v_cvt_pk_bf16_f32 v83, v170, v171
buffer_store_dwordx4 v[80:83], v4, s[24:27], s52 offen offset:2048 sc1
v_pk_mul_f32 v[88:89], v[88:89], v[182:183]
v_pk_mul_f32 v[90:91], v[90:91], v[182:183]
v_pk_mul_f32 v[192:193], v[192:193], v[182:183]
v_pk_mul_f32 v[194:195], v[194:195], v[182:183]
v_cvt_pk_bf16_f32 v88, v88, v89
v_cvt_pk_bf16_f32 v89, v90, v91
v_cvt_pk_bf16_f32 v90, v192, v193
v_cvt_pk_bf16_f32 v91, v194, v195
buffer_store_dwordx4 v[88:91], v4, s[24:27], s52 offen offset:3072 sc1
s_branch L_LA
CK_Z:
s_mov_b32 s92, 0
CK_Z_L:
s_sleep 1
buffer_load_dword v23, v22, s[40:43], 0 offen sc1
s_add_u32 s92, s92, 1
s_waitcnt vmcnt(0)
v_cmp_gt_u32 vcc, 1, v23
s_cmp_gt_u32 s92, 1048576
s_cbranch_scc1 CK_Z_R
s_nop 3
s_cbranch_vccnz CK_Z_L
s_branch CK_Z_R
CK_WA:
s_mov_b32 s92, 0
CK_WA_L:
s_sleep 1
buffer_load_dword v30, v29, s[24:27], s89 offen sc1
s_add_u32 s92, s92, 1
s_waitcnt vmcnt(0)
v_cmp_gt_u32 vcc, 18, v30
s_cmp_gt_u32 s92, 1048576
s_cbranch_scc1 CK_WA_R
s_nop 3
s_cbranch_vccnz CK_WA_L
s_branch CK_WA_R
CK_ZA:
s_mov_b32 s92, 0
CK_ZA_L:
s_sleep 1
buffer_load_dword v30, v28, s[40:43], 0 offen sc1
s_add_u32 s92, s92, 1
s_waitcnt vmcnt(0)
v_cmp_gt_u32 vcc, 1, v30
s_cmp_gt_u32 s92, 1048576
s_cbranch_scc1 CK_ZA_R
s_nop 3
s_cbranch_vccnz CK_ZA_L
s_branch CK_ZA_R
CK_KV:
s_mov_b32 s92, 0
CK_KV_L:
s_sleep 1
buffer_load_dword v30, v29, s[24:27], s89 offen offset:4 sc1
s_add_u32 s92, s92, 1
s_waitcnt vmcnt(0)
v_cmp_gt_u32 vcc, 8, v30
s_cmp_gt_u32 s92, 1048576
s_cbranch_scc1 CK_KV_R
s_nop 3
s_cbranch_vccnz CK_KV_L
s_branch CK_KV_R
D0:
v_cndmask_b32 v96, v96, v6, s[56:57]
v_cndmask_b32 v120, v120, v6, s[56:57]
v_mov_b32 v112, v6
v_cndmask_b32 v97, v97, v6, s[58:59]
v_cndmask_b32 v121, v121, v6, s[58:59]
v_mov_b32 v113, v6
v_cndmask_b32 v98, v98, v6, s[60:61]
v_cndmask_b32 v122, v122, v6, s[60:61]
v_mov_b32 v114, v6
v_cndmask_b32 v99, v99, v6, s[62:63]
v_cndmask_b32 v123, v123, v6, s[62:63]
v_mov_b32 v115, v6
s_branch D0_R
CK_Q:
s_mov_b32 s92, 0
CK_Q_L:
s_sleep 1
buffer_load_dword v172, v173, s[24:27], 0 offen sc1
s_add_u32 s92, s92, 1
s_waitcnt vmcnt(0)
v_cmp_gt_u32 vcc, 32, v172
s_cmp_gt_u32 s92, 1048576
s_cbranch_scc1 CK_Q_R
s_nop 3
s_cbranch_vccnz CK_Q_L
s_branch CK_Q_R
CK_ZAA:
s_mov_b32 s92, 0
CK_ZAA_L:
s_sleep 1
buffer_load_dword v12, v10, s[24:27], s75 offen offset:4 sc1
s_add_u32 s92, s92, 1
s_waitcnt vmcnt(0)
v_cmp_gt_u32 vcc, 8, v12
s_cmp_gt_u32 s92, 1048576
s_cbranch_scc1 CK_ZAA_R
s_nop 3
s_cbranch_vccnz CK_ZAA_L
s_branch CK_ZAA_R
CK_P1:
s_mov_b32 s92, 0
CK_P1_L:
s_sleep 1
buffer_load_dword v12, v10, s[24:27], s73 offen sc1
s_add_u32 s92, s92, 1
s_waitcnt vmcnt(0)
v_cmp_gt_u32 vcc, 4, v12
s_cmp_gt_u32 s92, 1048576
s_cbranch_scc1 CK_P1_R
s_nop 3
s_cbranch_vccnz CK_P1_L
s_branch CK_P1_R
CK_P2:
s_mov_b32 s92, 0
CK_P2_L:
s_sleep 1
buffer_load_dword v12, v10, s[24:27], s73 offen offset:16 sc1
s_add_u32 s92, s92, 1
s_waitcnt vmcnt(0)
v_cmp_gt_u32 vcc, 4, v12
s_cmp_gt_u32 s92, 1048576
s_cbranch_scc1 CK_P2_R
s_nop 3
s_cbranch_vccnz CK_P2_L
s_branch CK_P2_R
SLOW0:
v_add_u32 v20, 4096, v4
s_mov_b32 s54, 0
v_mov_b32 v16, v6
v_mov_b32 v18, v6
SLOW0_P:
s_mov_b32 s53, 0
s_mov_b32 s52, s94
SLOW0_T:
s_add_u32 s55, s52, 24576
buffer_load_dwordx4 a[192:195], v4, s[24:27], s52 offen offset:0 sc1
buffer_load_dwordx4 a[196:199], v4, s[24:27], s52 offen offset:1024 sc1
buffer_load_dwordx4 a[200:203], v4, s[24:27], s52 offen offset:2048 sc1
buffer_load_dwordx4 a[204:207], v4, s[24:27], s52 offen offset:3072 sc1
buffer_load_dwordx4 a[208:211], v20, s[24:27], s52 offen offset:0 sc1
buffer_load_dwordx4 a[212:215], v20, s[24:27], s52 offen offset:1024 sc1
buffer_load_dwordx4 a[216:219], v20, s[24:27], s52 offen offset:2048 sc1
buffer_load_dwordx4 a[220:223], v20, s[24:27], s52 offen offset:3072 sc1
buffer_load_dwordx4 a[64:67], v4, s[24:27], s55 offen offset:0 sc1
buffer_load_dwordx4 a[68:71], v4, s[24:27], s55 offen offset:1024 sc1
buffer_load_dwordx4 a[72:75], v4, s[24:27], s55 offen offset:2048 sc1
buffer_load_dwordx4 a[76:79], v4, s[24:27], s55 offen offset:3072 sc1
buffer_load_dwordx4 a[80:83], v20, s[24:27], s55 offen offset:0 sc1
buffer_load_dwordx4 a[84:87], v20, s[24:27], s55 offen offset:1024 sc1
buffer_load_dwordx4 a[88:91], v20, s[24:27], s55 offen offset:2048 sc1
buffer_load_dwordx4 a[92:95], v20, s[24:27], s55 offen offset:3072 sc1
s_waitcnt vmcnt(0)
v_mfma_f32_16x16x32_bf16 v[44:47], a[192:195], a[32:35], 0
v_mfma_f32_16x16x32_bf16 v[44:47], a[196:199], a[36:39], v[44:47]
v_mfma_f32_16x16x32_bf16 v[44:47], a[200:203], a[28:31], v[44:47]
v_mfma_f32_16x16x32_bf16 v[44:47], a[204:207], a[20:23], v[44:47]
v_mfma_f32_16x16x32_bf16 v[52:55], a[192:195], a[44:47], 0
v_mfma_f32_16x16x32_bf16 v[52:55], a[196:199], a[40:43], v[52:55]
v_mfma_f32_16x16x32_bf16 v[52:55], a[200:203], a[12:15], v[52:55]
v_mfma_f32_16x16x32_bf16 v[52:55], a[204:207], a[4:7], v[52:55]
v_mfma_f32_16x16x32_bf16 v[64:67], a[208:211], a[32:35], 0
v_mfma_f32_16x16x32_bf16 v[64:67], a[212:215], a[36:39], v[64:67]
v_mfma_f32_16x16x32_bf16 v[64:67], a[216:219], a[28:31], v[64:67]
v_mfma_f32_16x16x32_bf16 v[64:67], a[220:223], a[20:23], v[64:67]
v_mfma_f32_16x16x32_bf16 v[212:215], a[208:211], a[44:47], 0
v_mfma_f32_16x16x32_bf16 v[212:215], a[212:215], a[40:43], v[212:215]
v_mfma_f32_16x16x32_bf16 v[212:215], a[216:219], a[12:15], v[212:215]
v_mfma_f32_16x16x32_bf16 v[212:215], a[220:223], a[4:7], v[212:215]
s_nop 7
s_cmp_lg_u32 s53, s66
s_cbranch_scc1 SLOW0_U
v_cndmask_b32 v44, v44, v6, s[56:57]
v_cndmask_b32 v212, v212, v6, s[56:57]
v_mov_b32 v64, v6
v_cndmask_b32 v45, v45, v6, s[58:59]
v_cndmask_b32 v213, v213, v6, s[58:59]
v_mov_b32 v65, v6
v_cndmask_b32 v46, v46, v6, s[60:61]
v_cndmask_b32 v214, v214, v6, s[60:61]
v_mov_b32 v66, v6
v_cndmask_b32 v47, v47, v6, s[62:63]
v_cndmask_b32 v215, v215, v6, s[62:63]
v_mov_b32 v67, v6
SLOW0_U:
s_cmp_lg_u32 s54, 0
s_cbranch_scc1 SLOW0_A
v_max3_f32 v16, v16, v44, v45
v_max3_f32 v16, v16, v46, v47
v_max3_f32 v18, v18, v52, v53
v_max3_f32 v18, v18, v54, v55
v_max3_f32 v16, v16, v64, v65
v_max3_f32 v16, v16, v66, v67
v_max3_f32 v18, v18, v212, v213
v_max3_f32 v18, v18, v214, v215
s_branch SLOW0_N
SLOW0_A:
v_sub_f32 v44, v44, v16
v_sub_f32 v45, v45, v16
v_sub_f32 v46, v46, v16
v_sub_f32 v47, v47, v16
v_sub_f32 v52, v52, v18
v_sub_f32 v53, v53, v18
v_sub_f32 v54, v54, v18
v_sub_f32 v55, v55, v18
v_sub_f32 v64, v64, v16
v_sub_f32 v65, v65, v16
v_sub_f32 v66, v66, v16
v_sub_f32 v67, v67, v16
v_sub_f32 v212, v212, v18
v_sub_f32 v213, v213, v18
v_sub_f32 v214, v214, v18
v_sub_f32 v215, v215, v18
v_exp_f32 v44, v44
v_exp_f32 v45, v45
v_exp_f32 v46, v46
v_exp_f32 v47, v47
v_exp_f32 v52, v52
v_exp_f32 v53, v53
v_exp_f32 v54, v54
v_exp_f32 v55, v55
v_exp_f32 v64, v64
v_exp_f32 v65, v65
v_exp_f32 v66, v66
v_exp_f32 v67, v67
v_exp_f32 v212, v212
v_exp_f32 v213, v213
v_exp_f32 v214, v214
v_exp_f32 v215, v215
s_nop 0
v_cvt_pk_bf16_f32 v124, v44, v45
v_cvt_pk_bf16_f32 v125, v46, v47
v_cvt_pk_bf16_f32 v140, v52, v53
v_cvt_pk_bf16_f32 v141, v54, v55
v_cvt_pk_bf16_f32 v126, v64, v65
v_cvt_pk_bf16_f32 v127, v66, v67
v_cvt_pk_bf16_f32 v142, v212, v213
v_cvt_pk_bf16_f32 v143, v214, v215
s_nop 1
v_mfma_f32_16x16x32_bf16 v[36:39], a[64:67], v[124:127], v[36:39]
v_mfma_f32_16x16x32_bf16 v[116:119], a[64:67], v[140:143], v[116:119]
v_mfma_f32_16x16x32_bf16 v[132:135], a[68:71], v[140:143], v[132:135]
v_mfma_f32_16x16x32_bf16 v[32:35], a[68:71], v[124:127], v[32:35]
v_mfma_f32_16x16x32_bf16 v[196:199], a[72:75], v[124:127], v[196:199]
v_mfma_f32_16x16x32_bf16 v[184:187], a[72:75], v[140:143], v[184:187]
v_mfma_f32_16x16x32_bf16 v[240:243], a[76:79], v[140:143], v[240:243]
v_mfma_f32_16x16x32_bf16 v[204:207], a[76:79], v[124:127], v[204:207]
v_mfma_f32_16x16x32_bf16 v[108:111], a[80:83], v[124:127], v[108:111]
v_mfma_f32_16x16x32_bf16 v[188:191], a[80:83], v[140:143], v[188:191]
v_mfma_f32_16x16x32_bf16 v[56:59], a[84:87], v[140:143], v[56:59]
v_mfma_f32_16x16x32_bf16 v[40:43], a[84:87], v[124:127], v[40:43]
v_mfma_f32_16x16x32_bf16 v[80:83], a[88:91], v[124:127], v[80:83]
v_mfma_f32_16x16x32_bf16 v[88:91], a[88:91], v[140:143], v[88:91]
v_mfma_f32_16x16x32_bf16 v[192:195], a[92:95], v[140:143], v[192:195]
v_mfma_f32_16x16x32_bf16 v[168:171], a[92:95], v[124:127], v[168:171]
v_mfma_f32_16x16x32_bf16 a[224:227], a[240:243], v[124:127], a[224:227]
v_mfma_f32_16x16x32_bf16 a[228:231], a[240:243], v[140:143], a[228:231]
SLOW0_N:
s_add_u32 s52, s52, 16384
s_add_u32 s53, s53, 1
s_cmp_le_u32 s53, s66
s_cbranch_scc1 SLOW0_T
s_cmp_lg_u32 s54, 0
s_cbranch_scc1 SLOW0_E
v_mov_b32 v17, v16
v_mov_b32 v19, v18
s_nop 1
v_permlane32_swap_b32 v17, v16
v_permlane32_swap_b32 v19, v18
s_nop 1
v_max_f32 v16, v16, v17
v_max_f32 v18, v18, v19
v_mov_b32 v17, v16
v_mov_b32 v19, v18
s_nop 1
v_permlane16_swap_b32 v17, v16
v_permlane16_swap_b32 v19, v18
s_nop 1
v_max_f32 v16, v16, v17
v_max_f32 v18, v18, v19
v_mov_b32 v36, 0
v_mov_b32 v37, 0
v_mov_b32 v38, 0
v_mov_b32 v39, 0
v_mov_b32 v32, 0
v_mov_b32 v33, 0
v_mov_b32 v34, 0
v_mov_b32 v35, 0
v_mov_b32 v196, 0
v_mov_b32 v197, 0
v_mov_b32 v198, 0
v_mov_b32 v199, 0
v_mov_b32 v204, 0
v_mov_b32 v205, 0
v_mov_b32 v206, 0
v_mov_b32 v207, 0
v_mov_b32 v108, 0
v_mov_b32 v109, 0
v_mov_b32 v110, 0
v_mov_b32 v111, 0
v_mov_b32 v40, 0
v_mov_b32 v41, 0
v_mov_b32 v42, 0
v_mov_b32 v43, 0
v_mov_b32 v80, 0
v_mov_b32 v81, 0
v_mov_b32 v82, 0
v_mov_b32 v83, 0
v_mov_b32 v168, 0
v_mov_b32 v169, 0
v_mov_b32 v170, 0
v_mov_b32 v171, 0
v_mov_b32 v116, 0
v_mov_b32 v117, 0
v_mov_b32 v118, 0
v_mov_b32 v119, 0
v_mov_b32 v132, 0
v_mov_b32 v133, 0
v_mov_b32 v134, 0
v_mov_b32 v135, 0
v_mov_b32 v184, 0
v_mov_b32 v185, 0
v_mov_b32 v186, 0
v_mov_b32 v187, 0
v_mov_b32 v240, 0
v_mov_b32 v241, 0
v_mov_b32 v242, 0
v_mov_b32 v243, 0
v_mov_b32 v188, 0
v_mov_b32 v189, 0
v_mov_b32 v190, 0
v_mov_b32 v191, 0
v_mov_b32 v56, 0
v_mov_b32 v57, 0
v_mov_b32 v58, 0
v_mov_b32 v59, 0
v_mov_b32 v88, 0
v_mov_b32 v89, 0
v_mov_b32 v90, 0
v_mov_b32 v91, 0
v_mov_b32 v192, 0
v_mov_b32 v193, 0
v_mov_b32 v194, 0
v_mov_b32 v195, 0
v_accvgpr_write_b32 a224, 0
v_accvgpr_write_b32 a225, 0
v_accvgpr_write_b32 a226, 0
v_accvgpr_write_b32 a227, 0
v_accvgpr_write_b32 a228, 0
v_accvgpr_write_b32 a229, 0
v_accvgpr_write_b32 a230, 0
v_accvgpr_write_b32 a231, 0
s_mov_b32 s54, 1
s_branch SLOW0_P
SLOW0_E:
s_nop 7
v_accvgpr_read_b32 v180, a224
v_accvgpr_read_b32 v182, a228
s_branch SLOW0_R
SLOW1:
v_add_u32 v20, 4096, v4
s_mov_b32 s54, 0
v_mov_b32 v16, v6
v_mov_b32 v18, v6
SLOW1_P:
s_mov_b32 s53, 0
s_mov_b32 s52, s94
SLOW1_T:
s_add_u32 s55, s52, 24576
buffer_load_dwordx4 a[192:195], v4, s[24:27], s52 offen offset:0 sc1
buffer_load_dwordx4 a[196:199], v4, s[24:27], s52 offen offset:1024 sc1
buffer_load_dwordx4 a[200:203], v4, s[24:27], s52 offen offset:2048 sc1
buffer_load_dwordx4 a[204:207], v4, s[24:27], s52 offen offset:3072 sc1
buffer_load_dwordx4 a[208:211], v20, s[24:27], s52 offen offset:0 sc1
buffer_load_dwordx4 a[212:215], v20, s[24:27], s52 offen offset:1024 sc1
buffer_load_dwordx4 a[216:219], v20, s[24:27], s52 offen offset:2048 sc1
buffer_load_dwordx4 a[220:223], v20, s[24:27], s52 offen offset:3072 sc1
buffer_load_dwordx4 a[64:67], v4, s[24:27], s55 offen offset:0 sc1
buffer_load_dwordx4 a[68:71], v4, s[24:27], s55 offen offset:1024 sc1
buffer_load_dwordx4 a[72:75], v4, s[24:27], s55 offen offset:2048 sc1
buffer_load_dwordx4 a[76:79], v4, s[24:27], s55 offen offset:3072 sc1
buffer_load_dwordx4 a[80:83], v20, s[24:27], s55 offen offset:0 sc1
buffer_load_dwordx4 a[84:87], v20, s[24:27], s55 offen offset:1024 sc1
buffer_load_dwordx4 a[88:91], v20, s[24:27], s55 offen offset:2048 sc1
buffer_load_dwordx4 a[92:95], v20, s[24:27], s55 offen offset:3072 sc1
s_waitcnt vmcnt(0)
v_mfma_f32_16x16x32_bf16 v[44:47], a[192:195], a[48:51], 0
v_mfma_f32_16x16x32_bf16 v[44:47], a[196:199], a[52:55], v[44:47]
v_mfma_f32_16x16x32_bf16 v[44:47], a[200:203], a[0:3], v[44:47]
v_mfma_f32_16x16x32_bf16 v[44:47], a[204:207], a[8:11], v[44:47]
v_mfma_f32_16x16x32_bf16 v[52:55], a[192:195], a[60:63], 0
v_mfma_f32_16x16x32_bf16 v[52:55], a[196:199], a[56:59], v[52:55]
v_mfma_f32_16x16x32_bf16 v[52:55], a[200:203], a[16:19], v[52:55]
v_mfma_f32_16x16x32_bf16 v[52:55], a[204:207], a[24:27], v[52:55]
v_mfma_f32_16x16x32_bf16 v[64:67], a[208:211], a[48:51], 0
v_mfma_f32_16x16x32_bf16 v[64:67], a[212:215], a[52:55], v[64:67]
v_mfma_f32_16x16x32_bf16 v[64:67], a[216:219], a[0:3], v[64:67]
v_mfma_f32_16x16x32_bf16 v[64:67], a[220:223], a[8:11], v[64:67]
v_mfma_f32_16x16x32_bf16 v[212:215], a[208:211], a[60:63], 0
v_mfma_f32_16x16x32_bf16 v[212:215], a[212:215], a[56:59], v[212:215]
v_mfma_f32_16x16x32_bf16 v[212:215], a[216:219], a[16:19], v[212:215]
v_mfma_f32_16x16x32_bf16 v[212:215], a[220:223], a[24:27], v[212:215]
s_nop 7
s_cmp_lg_u32 s53, s67
s_cbranch_scc1 SLOW1_U
v_cndmask_b32 v44, v44, v6, s[56:57]
v_cndmask_b32 v212, v212, v6, s[56:57]
v_mov_b32 v64, v6
v_cndmask_b32 v45, v45, v6, s[58:59]
v_cndmask_b32 v213, v213, v6, s[58:59]
v_mov_b32 v65, v6
v_cndmask_b32 v46, v46, v6, s[60:61]
v_cndmask_b32 v214, v214, v6, s[60:61]
v_mov_b32 v66, v6
v_cndmask_b32 v47, v47, v6, s[62:63]
v_cndmask_b32 v215, v215, v6, s[62:63]
v_mov_b32 v67, v6
SLOW1_U:
s_cmp_lg_u32 s54, 0
s_cbranch_scc1 SLOW1_A
v_max3_f32 v16, v16, v44, v45
v_max3_f32 v16, v16, v46, v47
v_max3_f32 v18, v18, v52, v53
v_max3_f32 v18, v18, v54, v55
v_max3_f32 v16, v16, v64, v65
v_max3_f32 v16, v16, v66, v67
v_max3_f32 v18, v18, v212, v213
v_max3_f32 v18, v18, v214, v215
s_branch SLOW1_N
SLOW1_A:
v_sub_f32 v44, v44, v16
v_sub_f32 v45, v45, v16
v_sub_f32 v46, v46, v16
v_sub_f32 v47, v47, v16
v_sub_f32 v52, v52, v18
v_sub_f32 v53, v53, v18
v_sub_f32 v54, v54, v18
v_sub_f32 v55, v55, v18
v_sub_f32 v64, v64, v16
v_sub_f32 v65, v65, v16
v_sub_f32 v66, v66, v16
v_sub_f32 v67, v67, v16
v_sub_f32 v212, v212, v18
v_sub_f32 v213, v213, v18
v_sub_f32 v214, v214, v18
v_sub_f32 v215, v215, v18
v_exp_f32 v44, v44
v_exp_f32 v45, v45
v_exp_f32 v46, v46
v_exp_f32 v47, v47
v_exp_f32 v52, v52
v_exp_f32 v53, v53
v_exp_f32 v54, v54
v_exp_f32 v55, v55
v_exp_f32 v64, v64
v_exp_f32 v65, v65
v_exp_f32 v66, v66
v_exp_f32 v67, v67
v_exp_f32 v212, v212
v_exp_f32 v213, v213
v_exp_f32 v214, v214
v_exp_f32 v215, v215
s_nop 0
v_cvt_pk_bf16_f32 v124, v44, v45
v_cvt_pk_bf16_f32 v125, v46, v47
v_cvt_pk_bf16_f32 v140, v52, v53
v_cvt_pk_bf16_f32 v141, v54, v55
v_cvt_pk_bf16_f32 v126, v64, v65
v_cvt_pk_bf16_f32 v127, v66, v67
v_cvt_pk_bf16_f32 v142, v212, v213
v_cvt_pk_bf16_f32 v143, v214, v215
s_nop 1
v_mfma_f32_16x16x32_bf16 v[60:63], a[64:67], v[124:127], v[60:63]
v_mfma_f32_16x16x32_bf16 v[148:151], a[64:67], v[140:143], v[148:151]
v_mfma_f32_16x16x32_bf16 v[48:51], a[68:71], v[140:143], v[48:51]
v_mfma_f32_16x16x32_bf16 v[68:71], a[68:71], v[124:127], v[68:71]
v_mfma_f32_16x16x32_bf16 v[72:75], a[72:75], v[124:127], v[72:75]
v_mfma_f32_16x16x32_bf16 v[236:239], a[72:75], v[140:143], v[236:239]
v_mfma_f32_16x16x32_bf16 v[224:227], a[76:79], v[140:143], v[224:227]
v_mfma_f32_16x16x32_bf16 v[220:223], a[76:79], v[124:127], v[220:223]
v_mfma_f32_16x16x32_bf16 v[84:87], a[80:83], v[124:127], v[84:87]
v_mfma_f32_16x16x32_bf16 v[164:167], a[80:83], v[140:143], v[164:167]
v_mfma_f32_16x16x32_bf16 v[156:159], a[84:87], v[140:143], v[156:159]
v_mfma_f32_16x16x32_bf16 v[76:79], a[84:87], v[124:127], v[76:79]
v_mfma_f32_16x16x32_bf16 v[160:163], a[88:91], v[124:127], v[160:163]
v_mfma_f32_16x16x32_bf16 v[216:219], a[88:91], v[140:143], v[216:219]
v_mfma_f32_16x16x32_bf16 v[208:211], a[92:95], v[140:143], v[208:211]
v_mfma_f32_16x16x32_bf16 v[252:255], a[92:95], v[124:127], v[252:255]
v_mfma_f32_16x16x32_bf16 a[232:235], a[240:243], v[124:127], a[232:235]
v_mfma_f32_16x16x32_bf16 a[236:239], a[240:243], v[140:143], a[236:239]
SLOW1_N:
s_add_u32 s52, s52, 16384
s_add_u32 s53, s53, 1
s_cmp_le_u32 s53, s67
s_cbranch_scc1 SLOW1_T
s_cmp_lg_u32 s54, 0
s_cbranch_scc1 SLOW1_E
v_mov_b32 v17, v16
v_mov_b32 v19, v18
s_nop 1
v_permlane32_swap_b32 v17, v16
v_permlane32_swap_b32 v19, v18
s_nop 1
v_max_f32 v16, v16, v17
v_max_f32 v18, v18, v19
v_mov_b32 v17, v16
v_mov_b32 v19, v18
s_nop 1
v_permlane16_swap_b32 v17, v16
v_permlane16_swap_b32 v19, v18
s_nop 1
v_max_f32 v16, v16, v17
v_max_f32 v18, v18, v19
v_mov_b32 v60, 0
v_mov_b32 v61, 0
v_mov_b32 v62, 0
v_mov_b32 v63, 0
v_mov_b32 v68, 0
v_mov_b32 v69, 0
v_mov_b32 v70, 0
v_mov_b32 v71, 0
v_mov_b32 v72, 0
v_mov_b32 v73, 0
v_mov_b32 v74, 0
v_mov_b32 v75, 0
v_mov_b32 v220, 0
v_mov_b32 v221, 0
v_mov_b32 v222, 0
v_mov_b32 v223, 0
v_mov_b32 v84, 0
v_mov_b32 v85, 0
v_mov_b32 v86, 0
v_mov_b32 v87, 0
v_mov_b32 v76, 0
v_mov_b32 v77, 0
v_mov_b32 v78, 0
v_mov_b32 v79, 0
v_mov_b32 v160, 0
v_mov_b32 v161, 0
v_mov_b32 v162, 0
v_mov_b32 v163, 0
v_mov_b32 v252, 0
v_mov_b32 v253, 0
v_mov_b32 v254, 0
v_mov_b32 v255, 0
v_mov_b32 v148, 0
v_mov_b32 v149, 0
v_mov_b32 v150, 0
v_mov_b32 v151, 0
v_mov_b32 v48, 0
v_mov_b32 v49, 0
v_mov_b32 v50, 0
v_mov_b32 v51, 0
v_mov_b32 v236, 0
v_mov_b32 v237, 0
v_mov_b32 v238, 0
v_mov_b32 v239, 0
v_mov_b32 v224, 0
v_mov_b32 v225, 0
v_mov_b32 v226, 0
v_mov_b32 v227, 0
v_mov_b32 v164, 0
v_mov_b32 v165, 0
v_mov_b32 v166, 0
v_mov_b32 v167, 0
v_mov_b32 v156, 0
v_mov_b32 v157, 0
v_mov_b32 v158, 0
v_mov_b32 v159, 0
v_mov_b32 v216, 0
v_mov_b32 v217, 0
v_mov_b32 v218, 0
v_mov_b32 v219, 0
v_mov_b32 v208, 0
v_mov_b32 v209, 0
v_mov_b32 v210, 0
v_mov_b32 v211, 0
v_accvgpr_write_b32 a232, 0
v_accvgpr_write_b32 a233, 0
v_accvgpr_write_b32 a234, 0
v_accvgpr_write_b32 a235, 0
v_accvgpr_write_b32 a236, 0
v_accvgpr_write_b32 a237, 0
v_accvgpr_write_b32 a238, 0
v_accvgpr_write_b32 a239, 0
s_mov_b32 s54, 1
s_branch SLOW1_P
SLOW1_E:
s_nop 7
v_accvgpr_read_b32 v180, a232
v_accvgpr_read_b32 v182, a236
s_add_u32 s52, s79, 4096
v_fma_f32 v180, v180, v10, v180
v_fma_f32 v182, v182, v11, v182
v_rcp_f32 v180, v180
v_rcp_f32 v182, v182
s_nop 0
v_pk_mul_f32 v[60:61], v[60:61], v[180:181] op_sel_hi:[1,0]
v_pk_mul_f32 v[62:63], v[62:63], v[180:181] op_sel_hi:[1,0]
v_pk_mul_f32 v[68:69], v[68:69], v[180:181] op_sel_hi:[1,0]
v_pk_mul_f32 v[70:71], v[70:71], v[180:181] op_sel_hi:[1,0]
v_cvt_pk_bf16_f32 v60, v60, v61
v_cvt_pk_bf16_f32 v61, v62, v63
v_cvt_pk_bf16_f32 v62, v68, v69
v_cvt_pk_bf16_f32 v63, v70, v71
s_branch L_EP
.section .rodata,"a"
.p2align 6
.amdhsa_kernel gated_mix__sliding_local_dilated__compressed_kv_cla__prompt_kernel
  .amdhsa_next_free_vgpr 512
  .amdhsa_next_free_sgpr 102
  .amdhsa_accum_offset 256
  .amdhsa_group_segment_fixed_size 0
  .amdhsa_kernarg_size 104
  .amdhsa_user_sgpr_count 2
  .amdhsa_user_sgpr_kernarg_segment_ptr 1
  .amdhsa_system_sgpr_workgroup_id_x 1
.end_amdhsa_kernel
```

```asm
; @launch grid=(256,1,1) block=(256,1,1) lds=163840
.amdgcn_target "amdgcn-amd-amdhsa--gfx950"
.text

.globl gated_mix__sliding_local_dilated__compressed_kv_cla__prompt_kernel
.p2align 8
.type gated_mix__sliding_local_dilated__compressed_kv_cla__prompt_kernel,@function
gated_mix__sliding_local_dilated__compressed_kv_cla__prompt_kernel:
s_cmp_ge_u32 s2, 256
s_cbranch_scc1 L_END
s_load_dwordx2 s[8:9], s[0:1], 32
s_load_dwordx2 s[56:57], s[0:1], 56
s_load_dwordx2 s[16:17], s[0:1], 48
s_load_dwordx2 s[24:25], s[0:1], 96
s_load_dwordx2 s[12:13], s[0:1], 0
s_load_dwordx2 s[20:21], s[0:1], 40
s_load_dwordx2 s[28:29], s[0:1], 8
s_load_dwordx2 s[48:49], s[0:1], 16
s_load_dwordx2 s[32:33], s[0:1], 64
s_load_dwordx2 s[36:37], s[0:1], 72
s_load_dwordx2 s[40:41], s[0:1], 88
s_load_dwordx2 s[44:45], s[0:1], 80
s_getpc_b64 s[96:97]
L_PC:
s_lshr_b32 s6, s2, 3
s_lshl_b32 s98, s6, 11
s_add_u32 s98, s98, L_MAIN-L_PC
s_add_u32 s96, s96, s98
s_addc_u32 s97, s97, 0
v_lshlrev_b32 v16, 3, v0
v_mov_b32 v17, s97
v_add_co_u32 v16, vcc, s96, v16
v_lshrrev_b32 v5, 6, v0
v_and_b32 v1, 63, v0
v_addc_co_u32 v17, vcc, 0, v17, vcc
v_readfirstlane_b32 s3, v5
global_load_dwordx2 a[252:253], v[16:17], off
v_and_b32 v2, 15, v0
v_lshrrev_b32 v3, 4, v1
v_lshlrev_b32 v4, 4, v1
s_and_b32 s7, s2, 7
s_and_b32 s65, s6, 3
s_lshl2_add_u32 s4, s7, s65
s_lshr_b32 s5, s6, 2
s_lshl2_add_u32 s66, s5, s3
s_sub_u32 s67, 63, s66
v_lshrrev_b32 v16, 3, v1
v_and_b32 v17, 7, v1
v_xor_b32 v18, v17, v3
v_lshlrev_b32 v19, 10, v16
v_lshl_add_u32 v5, v18, 4, v19
v_xor_b32 v18, 4, v18
v_lshl_add_u32 v6, v18, 4, v19
v_add_u32 v6, 7168, v6
v_and_b32 v18, 1, v3
v_lshlrev_b32 v18, 1, v18
v_xor_b32 v18, v17, v18
v_lshlrev_b32 v19, 13, v16
v_lshl_add_u32 v7, v18, 4, v19
v_xor_b32 v18, 4, v18
v_lshl_add_u32 v8, v18, 4, v19
v_add_u32 v8, 64512, v8
s_add_u32 s69, s65, s5
s_and_b32 s69, s69, 1
s_mul_i32 s64, s7, 2
s_and_b32 s64, s64, 7
s_or_b32 s69, s69, s64
s_add_u32 s93, s65, s5
s_and_b32 s93, s93, 0
s_mul_i32 s64, s7, 1
s_and_b32 s64, s64, 7
s_or_b32 s93, s93, s64
s_lshl_b32 s70, s69, 7
s_lshl_b32 s75, s69, 19
s_lshr_b32 s54, s3, 1
s_and_b32 s55, s3, 1
s_lshl3_add_u32 s87, s54, s5
s_lshl_b32 s64, s55, 5
s_add_u32 s68, s87, s64
s_lshl_b32 s68, s68, 15
s_lshl_b32 s73, s3, 13
s_add_u32 s73, s73, 65536
s_lshl1_add_u32 s74, s4, s55
s_lshl_b32 s74, s74, 7
s_lshl_b32 s64, s54, 18
s_add_u32 s74, s74, s64
s_lshl_b32 s77, s3, 12
s_add_u32 s71, s68, s70
s_add_u32 s76, s74, s75
s_mov_b32 s10, 2097152
s_mov_b32 s11, 0x20000
s_mov_b32 s58, 4194304
s_mov_b32 s59, 0x20000
s_waitcnt lgkmcnt(0)
s_add_u32 m0, s73, 0
s_add_u32 s64, s71, 0
buffer_load_dwordx4 v5, s[8:11], s64 offen lds
buffer_load_dwordx4 v6, s[8:11], s64 offen offset:1024 lds
s_add_u32 m0, s73, 2048
s_add_u32 s64, s71, 16384
buffer_load_dwordx4 v5, s[8:11], s64 offen lds
buffer_load_dwordx4 v6, s[8:11], s64 offen offset:1024 lds
s_add_u32 m0, s77, 0
s_add_u32 s64, s76, 0
buffer_load_dwordx4 v7, s[56:59], s64 offen lds
buffer_load_dwordx4 v8, s[56:59], s64 offen offset:1024 lds
s_add_u32 m0, s77, 2048
s_add_u32 s64, s76, 131072
buffer_load_dwordx4 v7, s[56:59], s64 offen lds
buffer_load_dwordx4 v8, s[56:59], s64 offen offset:1024 lds
s_add_u32 m0, s73, 4096
s_add_u32 s64, s71, 524288
buffer_load_dwordx4 v5, s[8:11], s64 offen lds
buffer_load_dwordx4 v6, s[8:11], s64 offen offset:1024 lds
s_add_u32 m0, s73, 6144
s_add_u32 s64, s71, 540672
buffer_load_dwordx4 v5, s[8:11], s64 offen lds
buffer_load_dwordx4 v6, s[8:11], s64 offen offset:1024 lds
s_mov_b32 s18, 4194304
s_mov_b32 s19, 0x20000
s_lshl_b32 s65, s54, 7
s_lshl_b32 s53, s55, 12
v_lshrrev_b32 v16, 1, v2
v_xor_b32 v16, v16, v3
v_add_u32 v17, s65, v2
v_lshlrev_b32 v17, 7, v17
v_add_u32 v17, 65536, v17
v_lshl_add_u32 v9, v16, 4, v17
v_xor_b32 v10, 64, v9
v_bfe_u32 v16, v1, 2, 2
v_lshl_add_u32 v17, v3, 3, v16
v_lshlrev_b32 v17, 7, v17
v_and_b32 v18, 3, v1
v_lshl_add_u32 v17, v18, 3, v17
v_add_u32 v17, s53, v17
v_lshrrev_b32 v16, 1, v16
v_and_b32 v18, 1, v3
v_lshl_add_u32 v16, v18, 1, v16
v_xor_b32 v18, 0, v16
v_lshl_add_u32 v11, v18, 5, v17
v_xor_b32 v18, 1, v16
v_lshl_add_u32 v12, v18, 5, v17
v_xor_b32 v18, 2, v16
v_lshl_add_u32 v13, v18, 5, v17
v_xor_b32 v18, 3, v16
v_lshl_add_u32 v14, v18, 5, v17
s_add_u32 m0, s77, 16384
s_add_u32 s64, s76, 0
buffer_load_dwordx4 v7, s[16:19], s64 offen lds
buffer_load_dwordx4 v8, s[16:19], s64 offen offset:1024 lds
s_add_u32 m0, s77, 18432
s_add_u32 s64, s76, 131072
buffer_load_dwordx4 v7, s[16:19], s64 offen lds
buffer_load_dwordx4 v8, s[16:19], s64 offen offset:1024 lds
s_mov_b64 exec, 0
s_cmp_eq_u32 s3, 0
s_cbranch_scc1 L_PAD0
s_cmp_eq_u32 s3, 1
s_cbranch_scc1 L_PAD1
s_cmp_eq_u32 s3, 2
s_cbranch_scc1 L_PAD2
s_branch L_PAD3
.p2align 12
.fill 569, 4, 0xbf800000
L_MAIN:
s_mov_b64 exec, -1
s_xor_b32 s71, s70, 128
s_add_u32 s71, s68, s71
s_add_u32 m0, s73, 32768
s_add_u32 s64, s71, 0
buffer_load_dwordx4 v5, s[8:11], s64 offen lds
buffer_load_dwordx4 v6, s[8:11], s64 offen offset:1024 lds
s_add_u32 m0, s73, 34816
s_add_u32 s64, s71, 16384
buffer_load_dwordx4 v5, s[8:11], s64 offen lds
buffer_load_dwordx4 v6, s[8:11], s64 offen offset:1024 lds
s_add_u32 m0, s73, 36864
s_add_u32 s64, s71, 524288
buffer_load_dwordx4 v5, s[8:11], s64 offen lds
buffer_load_dwordx4 v6, s[8:11], s64 offen offset:1024 lds
s_add_u32 m0, s73, 38912
s_add_u32 s64, s71, 540672
buffer_load_dwordx4 v5, s[8:11], s64 offen lds
buffer_load_dwordx4 v6, s[8:11], s64 offen offset:1024 lds
s_waitcnt vmcnt(12)
s_barrier
ds_read_b128 a[64:67], v9 offset:0
ds_read_b128 a[68:71], v10 offset:0
ds_read_b64_tr_b16 a[128:129], v11 offset:0
ds_read_b64_tr_b16 a[130:131], v11 offset:512
ds_read_b64_tr_b16 a[132:133], v11 offset:8192
ds_read_b64_tr_b16 a[134:135], v11 offset:8704
ds_read_b64_tr_b16 a[136:137], v12 offset:0
ds_read_b64_tr_b16 a[138:139], v12 offset:512
ds_read_b64_tr_b16 a[140:141], v12 offset:8192
ds_read_b64_tr_b16 a[142:143], v12 offset:8704
ds_read_b64_tr_b16 a[144:145], v13 offset:0
ds_read_b64_tr_b16 a[146:147], v13 offset:512
ds_read_b64_tr_b16 a[148:149], v13 offset:8192
ds_read_b64_tr_b16 a[150:151], v13 offset:8704
ds_read_b64_tr_b16 a[152:153], v14 offset:0
ds_read_b64_tr_b16 a[154:155], v14 offset:512
ds_read_b64_tr_b16 a[156:157], v14 offset:8192
ds_read_b64_tr_b16 a[158:159], v14 offset:8704
ds_read_b128 a[72:75], v9 offset:2048
ds_read_b128 a[76:79], v10 offset:2048
ds_read_b128 a[80:83], v9 offset:4096
ds_read_b128 a[84:87], v10 offset:4096
ds_read_b128 a[88:91], v9 offset:6144
ds_read_b128 a[92:95], v10 offset:6144
s_waitcnt lgkmcnt(0)
v_mfma_f32_16x16x32_bf16 v[32:35], a[64:67], a[128:131], 0
s_waitcnt vmcnt(8)
v_mfma_f32_16x16x32_bf16 v[32:35], a[68:71], a[132:135], v[32:35]
s_barrier
v_mfma_f32_16x16x32_bf16 v[40:43], a[68:71], a[140:143], 0
s_mov_b32 s26, 268435456
s_mov_b32 s27, 0x20000
ds_read_b128 a[96:99], v9 offset:8192
v_mfma_f32_16x16x32_bf16 v[40:43], a[64:67], a[136:139], v[40:43]
s_xor_b32 s76, s75, 524288
s_add_u32 s76, s74, s76
s_mov_b32 s14, 2359296
v_mfma_f32_16x16x32_bf16 v[48:51], a[64:67], a[144:147], 0
s_add_u32 m0, s77, 32768
s_add_u32 s64, s76, 0
s_mov_b32 s15, 0x20000
v_mfma_f32_16x16x32_bf16 v[48:51], a[68:71], a[148:151], v[48:51]
buffer_load_dwordx4 v7, s[56:59], s64 offen lds
v_mfma_f32_16x16x32_bf16 v[56:59], a[68:71], a[156:159], 0
s_mov_b32 s22, 4718592
s_mov_b32 s23, 0x20000
ds_read_b128 a[100:103], v10 offset:8192
v_mfma_f32_16x16x32_bf16 v[56:59], a[64:67], a[152:155], v[56:59]
buffer_load_dwordx4 v8, s[56:59], s64 offen offset:1024 lds
v_mfma_f32_16x16x32_bf16 v[60:63], a[72:75], a[152:155], 0
s_add_u32 m0, s77, 34816
s_add_u32 s64, s76, 131072
ds_read_b128 a[104:107], v9 offset:10240
v_mfma_f32_16x16x32_bf16 v[60:63], a[76:79], a[156:159], v[60:63]
s_mov_b32 s30, 1990656
s_mov_b32 s31, 0x20000
s_mov_b32 s34, 4718592
v_mfma_f32_16x16x32_bf16 v[52:55], a[76:79], a[148:151], 0
buffer_load_dwordx4 v7, s[56:59], s64 offen lds
v_mfma_f32_16x16x32_bf16 v[52:55], a[72:75], a[144:147], v[52:55]
s_mov_b32 s35, 0x20000
ds_read_b64_tr_b16 a[160:161], v11 offset:16384
ds_read_b64_tr_b16 a[162:163], v11 offset:16896
v_mfma_f32_16x16x32_bf16 v[44:47], a[72:75], a[136:139], 0
s_mov_b32 s38, 1152
s_mov_b32 s39, 0x20000
s_mov_b32 s42, 256
v_mfma_f32_16x16x32_bf16 v[44:47], a[76:79], a[140:143], v[44:47]
buffer_load_dwordx4 v8, s[56:59], s64 offen offset:1024 lds
v_mfma_f32_16x16x32_bf16 v[36:39], a[76:79], a[132:135], 0
s_mov_b32 s43, 0x20000
s_mov_b32 s46, 2359296
s_mov_b32 s47, 0x20000
v_mfma_f32_16x16x32_bf16 v[36:39], a[72:75], a[128:131], v[36:39]
s_add_u32 m0, s77, 49152
s_add_u32 s64, s76, 0
ds_read_b128 a[108:111], v10 offset:10240
v_mfma_f32_16x16x32_bf16 v[64:67], a[80:83], a[128:131], 0
s_mov_b32 s50, 663552
s_mov_b32 s51, 0x20000
s_lshl_b32 s89, s4, 10
v_mfma_f32_16x16x32_bf16 v[64:67], a[84:87], a[132:135], v[64:67]
buffer_load_dwordx4 v7, s[16:19], s64 offen lds
v_mfma_f32_16x16x32_bf16 v[72:75], a[84:87], a[140:143], 0
s_add_u32 s89, s89, 75497472
ds_read_b64_tr_b16 a[164:165], v11 offset:24576
ds_read_b64_tr_b16 a[166:167], v11 offset:25088
v_mfma_f32_16x16x32_bf16 v[72:75], a[80:83], a[136:139], v[72:75]
s_mul_i32 s94, s4, 1064960
s_cmp_eq_u32 s66, 0
s_cselect_b32 s52, s89, 2147418112
v_mfma_f32_16x16x32_bf16 v[80:83], a[80:83], a[144:147], 0
buffer_load_dwordx4 v8, s[16:19], s64 offen offset:1024 lds
v_mfma_f32_16x16x32_bf16 v[80:83], a[84:87], a[148:151], v[80:83]
s_add_u32 m0, s77, 51200
s_add_u32 s64, s76, 131072
ds_read_b128 a[112:115], v9 offset:12288
v_mfma_f32_16x16x32_bf16 v[88:91], a[84:87], a[156:159], 0
s_lshl_b32 s53, s5, 10
s_add_u32 s53, s53, s94
s_add_u32 s53, s53, 1048576
v_mfma_f32_16x16x32_bf16 v[88:91], a[80:83], a[152:155], v[88:91]
buffer_load_dwordx4 v7, s[16:19], s64 offen lds
v_mfma_f32_16x16x32_bf16 v[92:95], a[88:91], a[152:155], 0
ds_read_b64_tr_b16 a[168:169], v12 offset:16384
ds_read_b64_tr_b16 a[170:171], v12 offset:16896
v_mfma_f32_16x16x32_bf16 v[92:95], a[92:95], a[156:159], v[92:95]
s_cmp_eq_u32 s3, 1
s_cselect_b32 s52, s53, s52
s_mul_i32 s53, s2, 74
v_mfma_f32_16x16x32_bf16 v[84:87], a[92:95], a[148:151], 0
buffer_load_dwordx4 v8, s[16:19], s64 offen offset:1024 lds
v_mfma_f32_16x16x32_bf16 v[84:87], a[88:91], a[144:147], v[84:87]
s_add_u32 s53, s53, s55
s_lshl_b32 s53, s53, 10
s_add_u32 s53, s53, 54599680
v_mfma_f32_16x16x32_bf16 v[76:79], a[88:91], a[136:139], 0
s_cmp_ge_u32 s3, 2
s_cselect_b32 s52, s53, s52
ds_read_b128 a[116:119], v10 offset:12288
v_mfma_f32_16x16x32_bf16 v[76:79], a[92:95], a[140:143], v[76:79]
v_mov_b32 v16, 0
v_mov_b32 v17, 0
v_mfma_f32_16x16x32_bf16 v[68:71], a[92:95], a[132:135], 0
v_mov_b32 v18, 0
v_mov_b32 v19, 0
v_mfma_f32_16x16x32_bf16 v[68:71], a[88:91], a[128:131], v[68:71]
s_waitcnt lgkmcnt(6)
ds_read_b64_tr_b16 a[172:173], v12 offset:24576
ds_read_b64_tr_b16 a[174:175], v12 offset:25088
v_mfma_f32_16x16x32_bf16 v[96:99], a[96:99], a[128:131], 0
v_mfma_f32_16x16x32_bf16 v[96:99], a[100:103], a[132:135], v[96:99]
v_mfma_f32_16x16x32_bf16 v[104:107], a[100:103], a[140:143], 0
ds_read_b128 a[120:123], v9 offset:14336
v_mfma_f32_16x16x32_bf16 v[104:107], a[96:99], a[136:139], v[104:107]
v_mfma_f32_16x16x32_bf16 v[112:115], a[96:99], a[144:147], 0
v_mfma_f32_16x16x32_bf16 v[112:115], a[100:103], a[148:151], v[112:115]
ds_read_b64_tr_b16 a[176:177], v13 offset:16384
ds_read_b64_tr_b16 a[178:179], v13 offset:16896
v_mfma_f32_16x16x32_bf16 v[120:123], a[100:103], a[156:159], 0
v_mfma_f32_16x16x32_bf16 v[120:123], a[96:99], a[152:155], v[120:123]
v_mfma_f32_16x16x32_bf16 v[124:127], a[104:107], a[152:155], 0
v_mfma_f32_16x16x32_bf16 v[124:127], a[108:111], a[156:159], v[124:127]
ds_read_b128 a[124:127], v10 offset:14336
v_mfma_f32_16x16x32_bf16 v[116:119], a[108:111], a[148:151], 0
v_add_u32 v9, 32768, v9
v_add_u32 v10, 32768, v10
v_mfma_f32_16x16x32_bf16 v[116:119], a[104:107], a[144:147], v[116:119]
v_mfma_f32_16x16x32_bf16 v[108:111], a[104:107], a[136:139], 0
ds_read_b64_tr_b16 a[180:181], v13 offset:24576
ds_read_b64_tr_b16 a[182:183], v13 offset:25088
v_mfma_f32_16x16x32_bf16 v[108:111], a[108:111], a[140:143], v[108:111]
v_mfma_f32_16x16x32_bf16 v[100:103], a[108:111], a[132:135], 0
v_mfma_f32_16x16x32_bf16 v[100:103], a[104:107], a[128:131], v[100:103]
s_waitcnt lgkmcnt(2)
ds_read_b64_tr_b16 a[184:185], v14 offset:16384
ds_read_b64_tr_b16 a[186:187], v14 offset:16896
v_mfma_f32_16x16x32_bf16 v[128:131], a[112:115], a[128:131], 0
v_mfma_f32_16x16x32_bf16 v[128:131], a[116:119], a[132:135], v[128:131]
v_mfma_f32_16x16x32_bf16 v[136:139], a[116:119], a[140:143], 0
ds_read_b64_tr_b16 a[188:189], v14 offset:24576
ds_read_b64_tr_b16 a[190:191], v14 offset:25088
v_mfma_f32_16x16x32_bf16 v[136:139], a[112:115], a[136:139], v[136:139]
v_mfma_f32_16x16x32_bf16 v[144:147], a[112:115], a[144:147], 0
v_mfma_f32_16x16x32_bf16 v[144:147], a[116:119], a[148:151], v[144:147]
v_mfma_f32_16x16x32_bf16 v[152:155], a[116:119], a[156:159], 0
v_mfma_f32_16x16x32_bf16 v[152:155], a[112:115], a[152:155], v[152:155]
v_mfma_f32_16x16x32_bf16 v[156:159], a[120:123], a[152:155], 0
v_mfma_f32_16x16x32_bf16 v[156:159], a[124:127], a[156:159], v[156:159]
v_mfma_f32_16x16x32_bf16 v[148:151], a[124:127], a[148:151], 0
v_mfma_f32_16x16x32_bf16 v[148:151], a[120:123], a[144:147], v[148:151]
v_mfma_f32_16x16x32_bf16 v[140:143], a[120:123], a[136:139], 0
v_mfma_f32_16x16x32_bf16 v[140:143], a[124:127], a[140:143], v[140:143]
v_mfma_f32_16x16x32_bf16 v[132:135], a[124:127], a[132:135], 0
v_mfma_f32_16x16x32_bf16 v[132:135], a[120:123], a[128:131], v[132:135]
s_waitcnt lgkmcnt(0)
v_mfma_f32_16x16x32_bf16 v[160:163], a[160:163], a[64:67], 0
s_waitcnt vmcnt(4)
v_mfma_f32_16x16x32_bf16 v[160:163], a[164:167], a[68:71], v[160:163]
s_barrier
v_mfma_f32_16x16x32_bf16 v[164:167], a[172:175], a[68:71], 0
ds_read_b64_tr_b16 a[128:129], v11 offset:32768
ds_read_b64_tr_b16 a[130:131], v11 offset:33280
v_mfma_f32_16x16x32_bf16 v[164:167], a[168:171], a[64:67], v[164:167]
s_xor_b32 s71, s70, 256
s_add_u32 s71, s68, s71
v_mfma_f32_16x16x32_bf16 v[168:171], a[176:179], a[64:67], 0
s_add_u32 m0, s73, 65536
s_add_u32 s64, s71, 0
v_mfma_f32_16x16x32_bf16 v[168:171], a[180:183], a[68:71], v[168:171]
buffer_load_dwordx4 v5, s[8:11], s64 offen lds
v_mfma_f32_16x16x32_bf16 v[172:175], a[188:191], a[68:71], 0
v_mfma_f32_16x16x32_bf16 v[172:175], a[184:187], a[64:67], v[172:175]
ds_read_b128 a[64:67], v9 offset:0
v_mfma_f32_16x16x32_bf16 v[188:191], a[184:187], a[72:75], 0
buffer_load_dwordx4 v6, s[8:11], s64 offen offset:1024 lds
v_mfma_f32_16x16x32_bf16 v[188:191], a[188:191], a[76:79], v[188:191]
ds_read_b64_tr_b16 a[132:133], v11 offset:40960
ds_read_b64_tr_b16 a[134:135], v11 offset:41472
v_mfma_f32_16x16x32_bf16 v[184:187], a[180:183], a[76:79], 0
v_mfma_f32_16x16x32_bf16 v[184:187], a[176:179], a[72:75], v[184:187]
s_add_u32 m0, s73, 67584
s_add_u32 s64, s71, 16384
ds_read_b128 a[68:71], v10 offset:0
v_mfma_f32_16x16x32_bf16 v[180:183], a[168:171], a[72:75], 0
v_mfma_f32_16x16x32_bf16 v[180:183], a[172:175], a[76:79], v[180:183]
buffer_load_dwordx4 v5, s[8:11], s64 offen lds
v_mfma_f32_16x16x32_bf16 v[176:179], a[164:167], a[76:79], 0
v_mfma_f32_16x16x32_bf16 v[176:179], a[160:163], a[72:75], v[176:179]
ds_read_b64_tr_b16 a[136:137], v12 offset:32768
ds_read_b64_tr_b16 a[138:139], v12 offset:33280
v_mfma_f32_16x16x32_bf16 v[192:195], a[160:163], a[80:83], 0
v_mfma_f32_16x16x32_bf16 v[192:195], a[164:167], a[84:87], v[192:195]
v_mfma_f32_16x16x32_bf16 v[196:199], a[172:175], a[84:87], 0
buffer_load_dwordx4 v6, s[8:11], s64 offen offset:1024 lds
v_mfma_f32_16x16x32_bf16 v[196:199], a[168:171], a[80:83], v[196:199]
s_xor_b32 s76, s75, 1048576
s_add_u32 s76, s74, s76
ds_read_b128 a[72:75], v9 offset:2048
v_mfma_f32_16x16x32_bf16 v[200:203], a[176:179], a[80:83], 0
v_mfma_f32_16x16x32_bf16 v[200:203], a[180:183], a[84:87], v[200:203]
s_add_u32 m0, s77, 0
s_add_u32 s64, s76, 0
v_mfma_f32_16x16x32_bf16 v[204:207], a[188:191], a[84:87], 0
L_PAD0:
s_cbranch_execz L_PAD4
ds_read_b64_tr_b16 a[140:141], v12 offset:40960
ds_read_b64_tr_b16 a[142:143], v12 offset:41472
v_mfma_f32_16x16x32_bf16 v[204:207], a[184:187], a[80:83], v[204:207]
buffer_load_dwordx4 v7, s[56:59], s64 offen lds
v_mfma_f32_16x16x32_bf16 v[220:223], a[184:187], a[88:91], 0
ds_read_b128 a[76:79], v10 offset:2048
v_mfma_f32_16x16x32_bf16 v[220:223], a[188:191], a[92:95], v[220:223]
v_mfma_f32_16x16x32_bf16 v[216:219], a[180:183], a[92:95], 0
v_mfma_f32_16x16x32_bf16 v[216:219], a[176:179], a[88:91], v[216:219]
v_mfma_f32_16x16x32_bf16 v[212:215], a[168:171], a[88:91], 0
buffer_load_dwordx4 v8, s[56:59], s64 offen offset:1024 lds
v_mfma_f32_16x16x32_bf16 v[212:215], a[172:175], a[92:95], v[212:215]
ds_read_b64_tr_b16 a[144:145], v13 offset:32768
ds_read_b64_tr_b16 a[146:147], v13 offset:33280
v_mfma_f32_16x16x32_bf16 v[208:211], a[164:167], a[92:95], 0
v_mfma_f32_16x16x32_bf16 v[208:211], a[160:163], a[88:91], v[208:211]
s_add_u32 m0, s77, 2048
s_add_u32 s64, s76, 131072
ds_read_b128 a[80:83], v9 offset:4096
v_mfma_f32_16x16x32_bf16 v[224:227], a[160:163], a[96:99], 0
v_mfma_f32_16x16x32_bf16 v[224:227], a[164:167], a[100:103], v[224:227]
buffer_load_dwordx4 v7, s[56:59], s64 offen lds
v_mfma_f32_16x16x32_bf16 v[228:231], a[172:175], a[100:103], 0
ds_read_b64_tr_b16 a[148:149], v13 offset:40960
ds_read_b64_tr_b16 a[150:151], v13 offset:41472
v_mfma_f32_16x16x32_bf16 v[228:231], a[168:171], a[96:99], v[228:231]
v_mfma_f32_16x16x32_bf16 v[232:235], a[176:179], a[96:99], 0
buffer_store_dwordx4 v[16:19], v4, s[24:27], s52 offen sc1
v_mfma_f32_16x16x32_bf16 v[232:235], a[180:183], a[100:103], v[232:235]
buffer_load_dwordx4 v8, s[56:59], s64 offen offset:1024 lds
v_mfma_f32_16x16x32_bf16 v[236:239], a[188:191], a[100:103], 0
s_add_u32 s89, s89, 512
ds_read_b128 a[84:87], v10 offset:4096
v_mfma_f32_16x16x32_bf16 v[236:239], a[184:187], a[96:99], v[236:239]
s_cmp_eq_u32 s3, 0
s_cselect_b32 s90, s89, 2147418112
v_mov_b32 v24, 2147418112
v_mfma_f32_16x16x32_bf16 v[252:255], a[184:187], a[104:107], 0
s_add_u32 m0, s73, 69632
s_add_u32 s64, s71, 524288
v_cmp_eq_u32 vcc, 1, v1
v_mfma_f32_16x16x32_bf16 v[252:255], a[188:191], a[108:111], v[252:255]
s_lshl_b32 s53, s55, 12
ds_read_b64_tr_b16 a[152:153], v14 offset:32768
ds_read_b64_tr_b16 a[154:155], v14 offset:33280
v_mfma_f32_16x16x32_bf16 v[248:251], a[180:183], a[108:111], 0
buffer_load_dwordx4 v5, s[8:11], s64 offen lds
v_mfma_f32_16x16x32_bf16 v[248:251], a[176:179], a[104:107], v[248:251]
v_cndmask_b32 v0, v24, 0, vcc
v_mfma_f32_16x16x32_bf16 v[244:247], a[168:171], a[104:107], 0
s_mul_i32 s87, s87, 16384
s_add_u32 s87, s87, s94
ds_read_b128 a[88:91], v9 offset:6144
v_mfma_f32_16x16x32_bf16 v[244:247], a[172:175], a[108:111], v[244:247]
s_add_u32 s88, s87, s53
s_add_u32 s88, s88, 24576
s_lshr_b32 s53, s53, 1
v_mfma_f32_16x16x32_bf16 v[240:243], a[164:167], a[108:111], 0
s_add_u32 s87, s87, s53
s_lshl_b32 s80, s3, 10
s_mul_i32 s78, s4, 18
v_mfma_f32_16x16x32_bf16 v[240:243], a[160:163], a[104:107], v[240:243]
buffer_load_dwordx4 v6, s[8:11], s64 offen offset:1024 lds
v_mfma_f32_16x16x32_bf16 a[0:3], a[160:163], a[112:115], 0
s_add_u32 s78, s78, s54
ds_read_b64_tr_b16 a[156:157], v14 offset:40960
ds_read_b64_tr_b16 a[158:159], v14 offset:41472
v_mfma_f32_16x16x32_bf16 a[0:3], a[164:167], a[116:119], a[0:3]
s_lshl2_add_u32 s78, s78, s55
s_lshl_b32 s78, s78, 10
s_add_u32 s78, s78, 35651584
v_mfma_f32_16x16x32_bf16 a[4:7], a[172:175], a[116:119], 0
s_add_u32 m0, s73, 71680
s_add_u32 s64, s71, 540672
ds_read_b128 a[92:95], v10 offset:6144
v_mfma_f32_16x16x32_bf16 a[4:7], a[168:171], a[112:115], a[4:7]
s_add_u32 s80, s80, 8192
s_mov_b32 s91, 0x3e0293ee
s_mov_b32 s85, 0x05040100
v_mfma_f32_16x16x32_bf16 a[8:11], a[176:179], a[112:115], 0
buffer_load_dwordx4 v5, s[8:11], s64 offen lds
v_mfma_f32_16x16x32_bf16 a[8:11], a[180:183], a[116:119], a[8:11]
s_mov_b32 s86, 0x07060302
s_lshl2_add_u32 s52, s7, s3
s_xor_b32 s92, s6, 31
v_mfma_f32_16x16x32_bf16 a[12:15], a[188:191], a[116:119], 0
s_mul_i32 s81, s92, 110592
s_mul_i32 s65, s52, 36
s_add_u32 s81, s81, s65
v_mfma_f32_16x16x32_bf16 a[12:15], a[184:187], a[112:115], a[12:15]
s_mul_i32 s82, s52, 18
s_add_u32 s82, s82, s92
s_lshl_b32 s82, s82, 12
v_mfma_f32_16x16x32_bf16 a[28:31], a[184:187], a[120:123], 0
s_add_u32 s82, s82, 35651584
s_lshl_b32 s83, s92, 6
s_lshl_b32 s84, s52, 10
v_mfma_f32_16x16x32_bf16 a[28:31], a[188:191], a[124:127], a[28:31]
buffer_load_dwordx4 v6, s[8:11], s64 offen offset:1024 lds
v_mfma_f32_16x16x32_bf16 a[24:27], a[180:183], a[124:127], 0
s_add_u32 s84, s84, 75497984
v_mfma_f32_16x16x32_bf16 a[24:27], a[176:179], a[120:123], a[24:27]
s_cmp_lt_u32 s92, 18
s_cselect_b32 s82, s82, 2147418112
s_cselect_b32 s84, s84, 2147418112
v_mfma_f32_16x16x32_bf16 a[20:23], a[168:171], a[120:123], 0
v_lshrrev_b32 v18, 2, v2
v_and_b32 v19, 3, v2
v_mfma_f32_16x16x32_bf16 a[20:23], a[172:175], a[124:127], a[20:23]
v_mul_u32_u24 v20, 1152, v18
v_cmp_eq_u32 vcc, 2, v19
v_mfma_f32_16x16x32_bf16 a[16:19], a[164:167], a[124:127], 0
v_lshl_add_u32 v20, v19, 3, v20
v_add_u32 v21, 1, v19
v_mfma_f32_16x16x32_bf16 a[16:19], a[160:163], a[120:123], a[16:19]
s_waitcnt lgkmcnt(0)
v_cndmask_b32 v21, v21, 0, vcc
v_cmp_eq_u32 vcc, 3, v18
v_mfma_f32_16x16x32_bf16 v[32:35], a[64:67], a[128:131], v[32:35]
s_waitcnt vmcnt(13)
v_mul_u32_u24 v21, 1152, v21
v_add_u32 v21, 32, v21
v_mfma_f32_16x16x32_bf16 v[32:35], a[68:71], a[132:135], v[32:35]
s_barrier
v_mfma_f32_16x16x32_bf16 v[40:43], a[68:71], a[140:143], v[40:43]
ds_read_b128 a[96:99], v9 offset:8192
v_cndmask_b32 v20, v20, v21, vcc
v_mfma_f32_16x16x32_bf16 v[40:43], a[64:67], a[136:139], v[40:43]
s_add_u32 m0, s77, 16384
s_add_u32 s64, s76, 0
v_cmp_eq_u32 vcc, 15, v2
v_mfma_f32_16x16x32_bf16 v[48:51], a[64:67], a[144:147], v[48:51]
buffer_load_dwordx4 v7, s[16:19], s64 offen lds
v_mfma_f32_16x16x32_bf16 v[48:51], a[68:71], a[148:151], v[48:51]
ds_read_b128 a[100:103], v10 offset:8192
v_mul_u32_u24 v21, 27648, v3
v_mfma_f32_16x16x32_bf16 v[56:59], a[68:71], a[156:159], v[56:59]
v_add_u32 v20, v20, v21
v_lshlrev_b32 v21, 4, v3
v_mfma_f32_16x16x32_bf16 v[56:59], a[64:67], a[152:155], v[56:59]
v_cndmask_b32 v26, v20, v24, vcc
v_cndmask_b32 v27, v24, v21, vcc
v_mfma_f32_16x16x32_bf16 v[60:63], a[72:75], a[152:155], v[60:63]
buffer_load_dwordx4 v8, s[16:19], s64 offen offset:1024 lds
v_mfma_f32_16x16x32_bf16 v[60:63], a[76:79], a[156:159], v[60:63]
ds_read_b128 a[104:107], v9 offset:10240
v_and_b32 v18, 7, v1
v_mfma_f32_16x16x32_bf16 v[52:55], a[76:79], a[148:151], v[52:55]
v_cmp_gt_u32 vcc, 48, v1
v_mul_u32_u24 v18, 3456, v18
v_mfma_f32_16x16x32_bf16 v[52:55], a[72:75], a[144:147], v[52:55]
s_add_u32 m0, s77, 18432
s_add_u32 s64, s76, 131072
v_mul_u32_u24 v19, 1152, v3
v_mfma_f32_16x16x32_bf16 v[44:47], a[72:75], a[136:139], v[44:47]
ds_read_b64_tr_b16 a[160:161], v11 offset:49152
ds_read_b64_tr_b16 a[162:163], v11 offset:49664
v_mfma_f32_16x16x32_bf16 v[44:47], a[76:79], a[140:143], v[44:47]
buffer_load_dwordx4 v7, s[16:19], s64 offen lds
v_mfma_f32_16x16x32_bf16 v[36:39], a[76:79], a[132:135], v[36:39]
v_bfe_u32 v20, v1, 3, 1
v_mul_u32_u24 v20, 140, v20
v_mfma_f32_16x16x32_bf16 v[36:39], a[72:75], a[128:131], v[36:39]
ds_read_b128 a[108:111], v10 offset:10240
v_add3_u32 v18, v18, v19, v20
v_mfma_f32_16x16x32_bf16 v[64:67], a[80:83], a[128:131], v[64:67]
v_cndmask_b32 v28, v24, v18, vcc
v_mfma_f32_16x16x32_bf16 v[64:67], a[84:87], a[132:135], v[64:67]
s_lshl_b32 s52, s4, 2
s_cmp_eq_u32 s66, 0
s_cselect_b32 s52, s52, 2147418112
v_mfma_f32_16x16x32_bf16 v[72:75], a[84:87], a[140:143], v[72:75]
buffer_load_dwordx4 v8, s[16:19], s64 offen offset:1024 lds
v_mfma_f32_16x16x32_bf16 v[72:75], a[80:83], a[136:139], v[72:75]
s_xor_b32 s71, s70, 384
s_add_u32 s71, s68, s71
v_mfma_f32_16x16x32_bf16 v[80:83], a[80:83], a[144:147], v[80:83]
ds_read_b64_tr_b16 a[164:165], v11 offset:57344
ds_read_b64_tr_b16 a[166:167], v11 offset:57856
v_mfma_f32_16x16x32_bf16 v[80:83], a[84:87], a[148:151], v[80:83]
s_add_u32 m0, s73, 0
s_add_u32 s64, s71, 0
ds_read_b128 a[112:115], v9 offset:12288
v_mfma_f32_16x16x32_bf16 v[88:91], a[84:87], a[156:159], v[88:91]
v_mfma_f32_16x16x32_bf16 v[88:91], a[80:83], a[152:155], v[88:91]
buffer_load_dwordx4 v5, s[8:11], s64 offen lds
v_mfma_f32_16x16x32_bf16 v[92:95], a[88:91], a[152:155], v[92:95]
ds_read_b64_tr_b16 a[168:169], v12 offset:49152
ds_read_b64_tr_b16 a[170:171], v12 offset:49664
v_mfma_f32_16x16x32_bf16 v[92:95], a[92:95], a[156:159], v[92:95]
v_mfma_f32_16x16x32_bf16 v[84:87], a[92:95], a[148:151], v[84:87]
v_mfma_f32_16x16x32_bf16 v[84:87], a[88:91], a[144:147], v[84:87]
v_mfma_f32_16x16x32_bf16 v[76:79], a[88:91], a[136:139], v[76:79]
buffer_load_dwordx4 v6, s[8:11], s64 offen offset:1024 lds
v_mfma_f32_16x16x32_bf16 v[76:79], a[92:95], a[140:143], v[76:79]
ds_read_b128 a[116:119], v10 offset:12288
v_mfma_f32_16x16x32_bf16 v[68:71], a[92:95], a[132:135], v[68:71]
v_mfma_f32_16x16x32_bf16 v[68:71], a[88:91], a[128:131], v[68:71]
s_add_u32 m0, s73, 2048
s_add_u32 s64, s71, 16384
s_waitcnt lgkmcnt(6)
v_mfma_f32_16x16x32_bf16 v[96:99], a[96:99], a[128:131], v[96:99]
ds_read_b64_tr_b16 a[172:173], v12 offset:57344
ds_read_b64_tr_b16 a[174:175], v12 offset:57856
v_mfma_f32_16x16x32_bf16 v[96:99], a[100:103], a[132:135], v[96:99]
buffer_load_dwordx4 v5, s[8:11], s64 offen lds
v_mfma_f32_16x16x32_bf16 v[104:107], a[100:103], a[140:143], v[104:107]
ds_read_b128 a[120:123], v9 offset:14336
v_mfma_f32_16x16x32_bf16 v[104:107], a[96:99], a[136:139], v[104:107]
v_mfma_f32_16x16x32_bf16 v[112:115], a[96:99], a[144:147], v[112:115]
v_mfma_f32_16x16x32_bf16 v[112:115], a[100:103], a[148:151], v[112:115]
buffer_load_dwordx4 v6, s[8:11], s64 offen offset:1024 lds
v_mfma_f32_16x16x32_bf16 v[120:123], a[100:103], a[156:159], v[120:123]
s_xor_b32 s76, s75, 1572864
s_add_u32 s76, s74, s76
v_mfma_f32_16x16x32_bf16 v[120:123], a[96:99], a[152:155], v[120:123]
ds_read_b64_tr_b16 a[176:177], v13 offset:49152
ds_read_b64_tr_b16 a[178:179], v13 offset:49664
v_mfma_f32_16x16x32_bf16 v[124:127], a[104:107], a[152:155], v[124:127]
s_add_u32 m0, s77, 32768
s_add_u32 s64, s76, 0
v_mfma_f32_16x16x32_bf16 v[124:127], a[108:111], a[156:159], v[124:127]
ds_read_b128 a[124:127], v10 offset:14336
v_mfma_f32_16x16x32_bf16 v[116:119], a[108:111], a[148:151], v[116:119]
buffer_load_dwordx4 v7, s[56:59], s64 offen lds
v_mfma_f32_16x16x32_bf16 v[116:119], a[104:107], a[144:147], v[116:119]
s_waitcnt vmcnt(14)
v_add_u32 v9, 32768, v9
v_add_u32 v10, 32768, v10
v_mfma_f32_16x16x32_bf16 v[108:111], a[104:107], a[136:139], v[108:111]
ds_read_b64_tr_b16 a[180:181], v13 offset:57344
ds_read_b64_tr_b16 a[182:183], v13 offset:57856
v_mfma_f32_16x16x32_bf16 v[108:111], a[108:111], a[140:143], v[108:111]
buffer_store_dword v1, v0, s[40:43], s52 offen sc1
v_mfma_f32_16x16x32_bf16 v[100:103], a[108:111], a[132:135], v[100:103]
s_waitcnt lgkmcnt(2)
v_mfma_f32_16x16x32_bf16 v[100:103], a[104:107], a[128:131], v[100:103]
buffer_load_dwordx4 v8, s[56:59], s64 offen offset:1024 lds
v_mfma_f32_16x16x32_bf16 v[128:131], a[112:115], a[128:131], v[128:131]
ds_read_b64_tr_b16 a[184:185], v14 offset:49152
ds_read_b64_tr_b16 a[186:187], v14 offset:49664
v_mfma_f32_16x16x32_bf16 v[128:131], a[116:119], a[132:135], v[128:131]
v_mfma_f32_16x16x32_bf16 v[136:139], a[116:119], a[140:143], v[136:139]
s_add_u32 m0, s77, 34816
s_add_u32 s64, s76, 131072
v_mfma_f32_16x16x32_bf16 v[136:139], a[112:115], a[136:139], v[136:139]
ds_read_b64_tr_b16 a[188:189], v14 offset:57344
ds_read_b64_tr_b16 a[190:191], v14 offset:57856
v_mfma_f32_16x16x32_bf16 v[144:147], a[112:115], a[144:147], v[144:147]
buffer_load_dwordx4 v7, s[56:59], s64 offen lds
v_mfma_f32_16x16x32_bf16 v[144:147], a[116:119], a[148:151], v[144:147]
v_mfma_f32_16x16x32_bf16 v[152:155], a[116:119], a[156:159], v[152:155]
v_mfma_f32_16x16x32_bf16 v[152:155], a[112:115], a[152:155], v[152:155]
v_mfma_f32_16x16x32_bf16 v[156:159], a[120:123], a[152:155], v[156:159]
v_mfma_f32_16x16x32_bf16 v[156:159], a[124:127], a[156:159], v[156:159]
buffer_load_dwordx4 v8, s[56:59], s64 offen offset:1024 lds
v_mfma_f32_16x16x32_bf16 v[148:151], a[124:127], a[148:151], v[148:151]
v_mfma_f32_16x16x32_bf16 v[148:151], a[120:123], a[144:147], v[148:151]
v_mfma_f32_16x16x32_bf16 v[140:143], a[120:123], a[136:139], v[140:143]
v_mfma_f32_16x16x32_bf16 v[140:143], a[124:127], a[140:143], v[140:143]
v_mfma_f32_16x16x32_bf16 v[132:135], a[124:127], a[132:135], v[132:135]
v_mfma_f32_16x16x32_bf16 v[132:135], a[120:123], a[128:131], v[132:135]
s_waitcnt lgkmcnt(0)
v_mfma_f32_16x16x32_bf16 v[160:163], a[160:163], a[64:67], v[160:163]
s_waitcnt vmcnt(13)
v_mfma_f32_16x16x32_bf16 v[160:163], a[164:167], a[68:71], v[160:163]
s_barrier
v_mfma_f32_16x16x32_bf16 v[164:167], a[172:175], a[68:71], v[164:167]
s_xor_b32 s52, s6, 31
ds_read_b64_tr_b16 a[128:129], v11 offset:0
ds_read_b64_tr_b16 a[130:131], v11 offset:512
v_mfma_f32_16x16x32_bf16 v[164:167], a[168:171], a[64:67], v[164:167]
s_add_u32 m0, s73, 4096
s_add_u32 s64, s71, 524288
s_mul_i32 s52, s52, 110592
v_mfma_f32_16x16x32_bf16 v[168:171], a[176:179], a[64:67], v[168:171]
buffer_load_dwordx4 v5, s[8:11], s64 offen lds
v_mfma_f32_16x16x32_bf16 v[168:171], a[180:183], a[68:71], v[168:171]
s_mul_i32 s53, s3, 27648
s_add_u32 s52, s52, s53
s_mul_i32 s53, s7, 144
v_mfma_f32_16x16x32_bf16 v[172:175], a[188:191], a[68:71], v[172:175]
s_add_u32 s52, s52, s53
v_mfma_f32_16x16x32_bf16 v[172:175], a[184:187], a[64:67], v[172:175]
ds_read_b128 a[64:67], v9 offset:0
v_mfma_f32_16x16x32_bf16 v[188:191], a[184:187], a[72:75], v[188:191]
buffer_load_dwordx4 v6, s[8:11], s64 offen offset:1024 lds
v_mfma_f32_16x16x32_bf16 v[188:191], a[188:191], a[76:79], v[188:191]
ds_read_b64_tr_b16 a[132:133], v11 offset:8192
ds_read_b64_tr_b16 a[134:135], v11 offset:8704
v_mfma_f32_16x16x32_bf16 v[184:187], a[180:183], a[76:79], v[184:187]
buffer_load_dword a252, v28, s[28:31], s52 offen
v_mfma_f32_16x16x32_bf16 v[184:187], a[176:179], a[72:75], v[184:187]
s_add_u32 m0, s73, 6144
s_add_u32 s64, s71, 540672
ds_read_b128 a[68:71], v10 offset:0
v_mfma_f32_16x16x32_bf16 v[180:183], a[168:171], a[72:75], v[180:183]
v_mfma_f32_16x16x32_bf16 v[180:183], a[172:175], a[76:79], v[180:183]
buffer_load_dwordx4 v5, s[8:11], s64 offen lds
v_mfma_f32_16x16x32_bf16 v[176:179], a[164:167], a[76:79], v[176:179]
v_mfma_f32_16x16x32_bf16 v[176:179], a[160:163], a[72:75], v[176:179]
ds_read_b64_tr_b16 a[136:137], v12 offset:0
ds_read_b64_tr_b16 a[138:139], v12 offset:512
v_mfma_f32_16x16x32_bf16 v[192:195], a[160:163], a[80:83], v[192:195]
v_mfma_f32_16x16x32_bf16 v[192:195], a[164:167], a[84:87], v[192:195]
v_mfma_f32_16x16x32_bf16 v[196:199], a[172:175], a[84:87], v[196:199]
buffer_load_dwordx4 v6, s[8:11], s64 offen offset:1024 lds
v_mfma_f32_16x16x32_bf16 v[196:199], a[168:171], a[80:83], v[196:199]
ds_read_b128 a[72:75], v9 offset:2048
v_mfma_f32_16x16x32_bf16 v[200:203], a[176:179], a[80:83], v[200:203]
v_mfma_f32_16x16x32_bf16 v[200:203], a[180:183], a[84:87], v[200:203]
s_add_u32 m0, s77, 49152
s_add_u32 s64, s76, 0
v_mfma_f32_16x16x32_bf16 v[204:207], a[188:191], a[84:87], v[204:207]
ds_read_b64_tr_b16 a[140:141], v12 offset:8192
ds_read_b64_tr_b16 a[142:143], v12 offset:8704
v_mfma_f32_16x16x32_bf16 v[204:207], a[184:187], a[80:83], v[204:207]
buffer_load_dwordx4 v7, s[16:19], s64 offen lds
v_mfma_f32_16x16x32_bf16 v[220:223], a[184:187], a[88:91], v[220:223]
ds_read_b128 a[76:79], v10 offset:2048
v_mfma_f32_16x16x32_bf16 v[220:223], a[188:191], a[92:95], v[220:223]
v_mfma_f32_16x16x32_bf16 v[216:219], a[180:183], a[92:95], v[216:219]
v_mfma_f32_16x16x32_bf16 v[216:219], a[176:179], a[88:91], v[216:219]
v_mfma_f32_16x16x32_bf16 v[212:215], a[168:171], a[88:91], v[212:215]
buffer_load_dwordx4 v8, s[16:19], s64 offen offset:1024 lds
v_mfma_f32_16x16x32_bf16 v[212:215], a[172:175], a[92:95], v[212:215]
ds_read_b64_tr_b16 a[144:145], v13 offset:0
ds_read_b64_tr_b16 a[146:147], v13 offset:512
v_mfma_f32_16x16x32_bf16 v[208:211], a[164:167], a[92:95], v[208:211]
v_mfma_f32_16x16x32_bf16 v[208:211], a[160:163], a[88:91], v[208:211]
s_add_u32 m0, s77, 51200
s_add_u32 s64, s76, 131072
ds_read_b128 a[80:83], v9 offset:4096
v_mfma_f32_16x16x32_bf16 v[224:227], a[160:163], a[96:99], v[224:227]
v_mfma_f32_16x16x32_bf16 v[224:227], a[164:167], a[100:103], v[224:227]
buffer_load_dwordx4 v7, s[16:19], s64 offen lds
v_mfma_f32_16x16x32_bf16 v[228:231], a[172:175], a[100:103], v[228:231]
ds_read_b64_tr_b16 a[148:149], v13 offset:8192
ds_read_b64_tr_b16 a[150:151], v13 offset:8704
v_mfma_f32_16x16x32_bf16 v[228:231], a[168:171], a[96:99], v[228:231]
v_mfma_f32_16x16x32_bf16 v[232:235], a[176:179], a[96:99], v[232:235]
v_mfma_f32_16x16x32_bf16 v[232:235], a[180:183], a[100:103], v[232:235]
buffer_load_dwordx4 v8, s[16:19], s64 offen offset:1024 lds
v_mfma_f32_16x16x32_bf16 v[236:239], a[188:191], a[100:103], v[236:239]
s_xor_b32 s71, s70, 512
s_add_u32 s71, s68, s71
ds_read_b128 a[84:87], v10 offset:4096
v_mfma_f32_16x16x32_bf16 v[236:239], a[184:187], a[96:99], v[236:239]
v_mfma_f32_16x16x32_bf16 v[252:255], a[184:187], a[104:107], v[252:255]
s_add_u32 m0, s73, 32768
s_add_u32 s64, s71, 0
v_mfma_f32_16x16x32_bf16 v[252:255], a[188:191], a[108:111], v[252:255]
ds_read_b64_tr_b16 a[152:153], v14 offset:0
ds_read_b64_tr_b16 a[154:155], v14 offset:512
v_mfma_f32_16x16x32_bf16 v[248:251], a[180:183], a[108:111], v[248:251]
buffer_load_dwordx4 v5, s[8:11], s64 offen lds
v_mfma_f32_16x16x32_bf16 v[248:251], a[176:179], a[104:107], v[248:251]
v_mfma_f32_16x16x32_bf16 v[244:247], a[168:171], a[104:107], v[244:247]
ds_read_b128 a[88:91], v9 offset:6144
v_mfma_f32_16x16x32_bf16 v[244:247], a[172:175], a[108:111], v[244:247]
v_mfma_f32_16x16x32_bf16 v[240:243], a[164:167], a[108:111], v[240:243]
v_mfma_f32_16x16x32_bf16 v[240:243], a[160:163], a[104:107], v[240:243]
buffer_load_dwordx4 v6, s[8:11], s64 offen offset:1024 lds
v_mfma_f32_16x16x32_bf16 a[0:3], a[160:163], a[112:115], a[0:3]
ds_read_b64_tr_b16 a[156:157], v14 offset:8192
ds_read_b64_tr_b16 a[158:159], v14 offset:8704
v_mfma_f32_16x16x32_bf16 a[0:3], a[164:167], a[116:119], a[0:3]
v_mfma_f32_16x16x32_bf16 a[4:7], a[172:175], a[116:119], a[4:7]
s_add_u32 m0, s73, 34816
s_add_u32 s64, s71, 16384
ds_read_b128 a[92:95], v10 offset:6144
v_mfma_f32_16x16x32_bf16 a[4:7], a[168:171], a[112:115], a[4:7]
v_mfma_f32_16x16x32_bf16 a[8:11], a[176:179], a[112:115], a[8:11]
buffer_load_dwordx4 v5, s[8:11], s64 offen lds
v_mfma_f32_16x16x32_bf16 a[8:11], a[180:183], a[116:119], a[8:11]
v_mfma_f32_16x16x32_bf16 a[12:15], a[188:191], a[116:119], a[12:15]
v_mfma_f32_16x16x32_bf16 a[12:15], a[184:187], a[112:115], a[12:15]
v_mfma_f32_16x16x32_bf16 a[28:31], a[184:187], a[120:123], a[28:31]
v_mfma_f32_16x16x32_bf16 a[28:31], a[188:191], a[124:127], a[28:31]
buffer_load_dwordx4 v6, s[8:11], s64 offen offset:1024 lds
v_mfma_f32_16x16x32_bf16 a[24:27], a[180:183], a[124:127], a[24:27]
v_mfma_f32_16x16x32_bf16 a[24:27], a[176:179], a[120:123], a[24:27]
v_mfma_f32_16x16x32_bf16 a[20:23], a[168:171], a[120:123], a[20:23]
v_mfma_f32_16x16x32_bf16 a[20:23], a[172:175], a[124:127], a[20:23]
v_mfma_f32_16x16x32_bf16 a[16:19], a[164:167], a[124:127], a[16:19]
v_mfma_f32_16x16x32_bf16 a[16:19], a[160:163], a[120:123], a[16:19]
s_waitcnt lgkmcnt(0)
v_mfma_f32_16x16x32_bf16 v[32:35], a[64:67], a[128:131], v[32:35]
s_waitcnt vmcnt(22)
v_mfma_f32_16x16x32_bf16 v[32:35], a[68:71], a[132:135], v[32:35]
s_barrier
v_mfma_f32_16x16x32_bf16 v[40:43], a[68:71], a[140:143], v[40:43]
ds_read_b128 a[96:99], v9 offset:8192
v_mfma_f32_16x16x32_bf16 v[40:43], a[64:67], a[136:139], v[40:43]
s_xor_b32 s76, s75, 2097152
s_add_u32 s76, s74, s76
v_mfma_f32_16x16x32_bf16 v[48:51], a[64:67], a[144:147], v[48:51]
s_add_u32 m0, s77, 0
s_add_u32 s64, s76, 0
v_mfma_f32_16x16x32_bf16 v[48:51], a[68:71], a[148:151], v[48:51]
buffer_load_dwordx4 v7, s[56:59], s64 offen lds
v_mfma_f32_16x16x32_bf16 v[56:59], a[68:71], a[156:159], v[56:59]
ds_read_b128 a[100:103], v10 offset:8192
v_mfma_f32_16x16x32_bf16 v[56:59], a[64:67], a[152:155], v[56:59]
v_mfma_f32_16x16x32_bf16 v[60:63], a[72:75], a[152:155], v[60:63]
ds_read_b128 a[104:107], v9 offset:10240
v_mfma_f32_16x16x32_bf16 v[60:63], a[76:79], a[156:159], v[60:63]
v_mfma_f32_16x16x32_bf16 v[52:55], a[76:79], a[148:151], v[52:55]
v_mfma_f32_16x16x32_bf16 v[52:55], a[72:75], a[144:147], v[52:55]
buffer_load_dwordx4 v8, s[56:59], s64 offen offset:1024 lds
v_mfma_f32_16x16x32_bf16 v[44:47], a[72:75], a[136:139], v[44:47]
ds_read_b64_tr_b16 a[160:161], v11 offset:16384
ds_read_b64_tr_b16 a[162:163], v11 offset:16896
v_mfma_f32_16x16x32_bf16 v[44:47], a[76:79], a[140:143], v[44:47]
v_mfma_f32_16x16x32_bf16 v[36:39], a[76:79], a[132:135], v[36:39]
v_mfma_f32_16x16x32_bf16 v[36:39], a[72:75], a[128:131], v[36:39]
ds_read_b128 a[108:111], v10 offset:10240
v_mfma_f32_16x16x32_bf16 v[64:67], a[80:83], a[128:131], v[64:67]
s_add_u32 m0, s77, 2048
s_add_u32 s64, s76, 131072
v_mfma_f32_16x16x32_bf16 v[64:67], a[84:87], a[132:135], v[64:67]
v_mfma_f32_16x16x32_bf16 v[72:75], a[84:87], a[140:143], v[72:75]
buffer_load_dwordx4 v7, s[56:59], s64 offen lds
v_mfma_f32_16x16x32_bf16 v[72:75], a[80:83], a[136:139], v[72:75]
ds_read_b64_tr_b16 a[164:165], v11 offset:24576
ds_read_b64_tr_b16 a[166:167], v11 offset:25088
v_mfma_f32_16x16x32_bf16 v[80:83], a[80:83], a[144:147], v[80:83]
v_mfma_f32_16x16x32_bf16 v[80:83], a[84:87], a[148:151], v[80:83]
ds_read_b128 a[112:115], v9 offset:12288
v_mfma_f32_16x16x32_bf16 v[88:91], a[84:87], a[156:159], v[88:91]
v_mfma_f32_16x16x32_bf16 v[88:91], a[80:83], a[152:155], v[88:91]
v_mfma_f32_16x16x32_bf16 v[92:95], a[88:91], a[152:155], v[92:95]
ds_read_b64_tr_b16 a[168:169], v12 offset:16384
ds_read_b64_tr_b16 a[170:171], v12 offset:16896
v_mfma_f32_16x16x32_bf16 v[92:95], a[92:95], a[156:159], v[92:95]
buffer_load_dwordx4 v8, s[56:59], s64 offen offset:1024 lds
v_mfma_f32_16x16x32_bf16 v[84:87], a[92:95], a[148:151], v[84:87]
v_mfma_f32_16x16x32_bf16 v[84:87], a[88:91], a[144:147], v[84:87]
v_mfma_f32_16x16x32_bf16 v[76:79], a[88:91], a[136:139], v[76:79]
ds_read_b128 a[116:119], v10 offset:12288
v_mfma_f32_16x16x32_bf16 v[76:79], a[92:95], a[140:143], v[76:79]
v_mfma_f32_16x16x32_bf16 v[68:71], a[92:95], a[132:135], v[68:71]
v_mfma_f32_16x16x32_bf16 v[68:71], a[88:91], a[128:131], v[68:71]
s_add_u32 m0, s73, 36864
s_add_u32 s64, s71, 524288
s_waitcnt lgkmcnt(6)
v_mfma_f32_16x16x32_bf16 v[96:99], a[96:99], a[128:131], v[96:99]
ds_read_b64_tr_b16 a[172:173], v12 offset:24576
ds_read_b64_tr_b16 a[174:175], v12 offset:25088
v_mfma_f32_16x16x32_bf16 v[96:99], a[100:103], a[132:135], v[96:99]
buffer_load_dwordx4 v5, s[8:11], s64 offen lds
v_mfma_f32_16x16x32_bf16 v[104:107], a[100:103], a[140:143], v[104:107]
ds_read_b128 a[120:123], v9 offset:14336
v_mfma_f32_16x16x32_bf16 v[104:107], a[96:99], a[136:139], v[104:107]
v_mfma_f32_16x16x32_bf16 v[112:115], a[96:99], a[144:147], v[112:115]
v_mfma_f32_16x16x32_bf16 v[112:115], a[100:103], a[148:151], v[112:115]
ds_read_b64_tr_b16 a[176:177], v13 offset:16384
ds_read_b64_tr_b16 a[178:179], v13 offset:16896
v_mfma_f32_16x16x32_bf16 v[120:123], a[100:103], a[156:159], v[120:123]
v_mfma_f32_16x16x32_bf16 v[120:123], a[96:99], a[152:155], v[120:123]
v_mfma_f32_16x16x32_bf16 v[124:127], a[104:107], a[152:155], v[124:127]
buffer_load_dwordx4 v6, s[8:11], s64 offen offset:1024 lds
v_mfma_f32_16x16x32_bf16 v[124:127], a[108:111], a[156:159], v[124:127]
ds_read_b128 a[124:127], v10 offset:14336
v_mfma_f32_16x16x32_bf16 v[116:119], a[108:111], a[148:151], v[116:119]
v_add_u32 v9, -65536, v9
v_add_u32 v10, -65536, v10
v_mfma_f32_16x16x32_bf16 v[116:119], a[104:107], a[144:147], v[116:119]
v_mfma_f32_16x16x32_bf16 v[108:111], a[104:107], a[136:139], v[108:111]
ds_read_b64_tr_b16 a[180:181], v13 offset:24576
ds_read_b64_tr_b16 a[182:183], v13 offset:25088
v_mfma_f32_16x16x32_bf16 v[108:111], a[108:111], a[140:143], v[108:111]
s_add_u32 m0, s73, 38912
s_add_u32 s64, s71, 540672
v_mfma_f32_16x16x32_bf16 v[100:103], a[108:111], a[132:135], v[100:103]
s_waitcnt lgkmcnt(2)
v_mfma_f32_16x16x32_bf16 v[100:103], a[104:107], a[128:131], v[100:103]
buffer_load_dwordx4 v5, s[8:11], s64 offen lds
v_mfma_f32_16x16x32_bf16 v[128:131], a[112:115], a[128:131], v[128:131]
ds_read_b64_tr_b16 a[184:185], v14 offset:16384
ds_read_b64_tr_b16 a[186:187], v14 offset:16896
v_mfma_f32_16x16x32_bf16 v[128:131], a[116:119], a[132:135], v[128:131]
v_mfma_f32_16x16x32_bf16 v[136:139], a[116:119], a[140:143], v[136:139]
ds_read_b64_tr_b16 a[188:189], v14 offset:24576
ds_read_b64_tr_b16 a[190:191], v14 offset:25088
v_mfma_f32_16x16x32_bf16 v[136:139], a[112:115], a[136:139], v[136:139]
v_mfma_f32_16x16x32_bf16 v[144:147], a[112:115], a[144:147], v[144:147]
v_mfma_f32_16x16x32_bf16 v[144:147], a[116:119], a[148:151], v[144:147]
v_mfma_f32_16x16x32_bf16 v[152:155], a[116:119], a[156:159], v[152:155]
buffer_load_dwordx4 v6, s[8:11], s64 offen offset:1024 lds
v_mfma_f32_16x16x32_bf16 v[152:155], a[112:115], a[152:155], v[152:155]
v_mfma_f32_16x16x32_bf16 v[156:159], a[120:123], a[152:155], v[156:159]
v_mfma_f32_16x16x32_bf16 v[156:159], a[124:127], a[156:159], v[156:159]
v_mfma_f32_16x16x32_bf16 v[148:151], a[124:127], a[148:151], v[148:151]
v_mfma_f32_16x16x32_bf16 v[148:151], a[120:123], a[144:147], v[148:151]
v_mfma_f32_16x16x32_bf16 v[140:143], a[120:123], a[136:139], v[140:143]
v_mfma_f32_16x16x32_bf16 v[140:143], a[124:127], a[140:143], v[140:143]
v_mfma_f32_16x16x32_bf16 v[132:135], a[124:127], a[132:135], v[132:135]
v_mfma_f32_16x16x32_bf16 v[132:135], a[120:123], a[128:131], v[132:135]
s_waitcnt lgkmcnt(0)
v_mfma_f32_16x16x32_bf16 v[160:163], a[160:163], a[64:67], v[160:163]
s_waitcnt vmcnt(16)
v_mfma_f32_16x16x32_bf16 v[160:163], a[164:167], a[68:71], v[160:163]
s_barrier
v_mfma_f32_16x16x32_bf16 v[164:167], a[172:175], a[68:71], v[164:167]
s_add_u32 s52, s81, 0
ds_read_b64_tr_b16 a[128:129], v11 offset:32768
ds_read_b64_tr_b16 a[130:131], v11 offset:33280
v_mfma_f32_16x16x32_bf16 v[164:167], a[168:171], a[64:67], v[164:167]
s_add_u32 m0, s77, 16384
s_add_u32 s64, s76, 0
v_mfma_f32_16x16x32_bf16 v[168:171], a[176:179], a[64:67], v[168:171]
buffer_load_dwordx4 v7, s[16:19], s64 offen lds
v_mfma_f32_16x16x32_bf16 v[168:171], a[180:183], a[68:71], v[168:171]
buffer_load_dwordx2 a[192:193], v26, s[28:31], s52 offen
v_mfma_f32_16x16x32_bf16 v[172:175], a[188:191], a[68:71], v[172:175]
v_mfma_f32_16x16x32_bf16 v[172:175], a[184:187], a[64:67], v[172:175]
ds_read_b128 a[64:67], v9 offset:0
v_mfma_f32_16x16x32_bf16 v[188:191], a[184:187], a[72:75], v[188:191]
ds_read_b64_tr_b16 a[132:133], v11 offset:40960
ds_read_b64_tr_b16 a[134:135], v11 offset:41472
v_mfma_f32_16x16x32_bf16 v[188:191], a[188:191], a[76:79], v[188:191]
v_mfma_f32_16x16x32_bf16 v[184:187], a[180:183], a[76:79], v[184:187]
s_add_u32 s52, s81, 3456
v_mfma_f32_16x16x32_bf16 v[184:187], a[176:179], a[72:75], v[184:187]
buffer_load_dwordx4 v8, s[16:19], s64 offen offset:1024 lds
v_mfma_f32_16x16x32_bf16 v[180:183], a[168:171], a[72:75], v[180:183]
ds_read_b128 a[68:71], v10 offset:0
v_mfma_f32_16x16x32_bf16 v[180:183], a[172:175], a[76:79], v[180:183]
buffer_load_dwordx2 a[194:195], v26, s[28:31], s52 offen
v_mfma_f32_16x16x32_bf16 v[176:179], a[164:167], a[76:79], v[176:179]
v_mfma_f32_16x16x32_bf16 v[176:179], a[160:163], a[72:75], v[176:179]
ds_read_b64_tr_b16 a[136:137], v12 offset:32768
ds_read_b64_tr_b16 a[138:139], v12 offset:33280
v_mfma_f32_16x16x32_bf16 v[192:195], a[160:163], a[80:83], v[192:195]
s_add_u32 m0, s77, 18432
s_add_u32 s64, s76, 131072
v_mfma_f32_16x16x32_bf16 v[192:195], a[164:167], a[84:87], v[192:195]
v_mfma_f32_16x16x32_bf16 v[196:199], a[172:175], a[84:87], v[196:199]
buffer_load_dwordx4 v7, s[16:19], s64 offen lds
v_mfma_f32_16x16x32_bf16 v[196:199], a[168:171], a[80:83], v[196:199]
s_add_u32 s52, s81, 6912
ds_read_b128 a[72:75], v9 offset:2048
v_mfma_f32_16x16x32_bf16 v[200:203], a[176:179], a[80:83], v[200:203]
buffer_load_dwordx2 a[196:197], v26, s[28:31], s52 offen
v_mfma_f32_16x16x32_bf16 v[200:203], a[180:183], a[84:87], v[200:203]
ds_read_b64_tr_b16 a[140:141], v12 offset:40960
ds_read_b64_tr_b16 a[142:143], v12 offset:41472
v_mfma_f32_16x16x32_bf16 v[204:207], a[188:191], a[84:87], v[204:207]
L_PAD1:
s_cbranch_execz L_PAD5
v_mfma_f32_16x16x32_bf16 v[204:207], a[184:187], a[80:83], v[204:207]
v_mfma_f32_16x16x32_bf16 v[220:223], a[184:187], a[88:91], v[220:223]
ds_read_b128 a[76:79], v10 offset:2048
v_mfma_f32_16x16x32_bf16 v[220:223], a[188:191], a[92:95], v[220:223]
buffer_load_dwordx4 v8, s[16:19], s64 offen offset:1024 lds
v_mfma_f32_16x16x32_bf16 v[216:219], a[180:183], a[92:95], v[216:219]
s_xor_b32 s71, s70, 640
s_add_u32 s71, s68, s71
s_add_u32 s52, s81, 10368
v_mfma_f32_16x16x32_bf16 v[216:219], a[176:179], a[88:91], v[216:219]
buffer_load_dwordx2 a[198:199], v26, s[28:31], s52 offen
v_mfma_f32_16x16x32_bf16 v[212:215], a[168:171], a[88:91], v[212:215]
ds_read_b64_tr_b16 a[144:145], v13 offset:32768
ds_read_b64_tr_b16 a[146:147], v13 offset:33280
v_mfma_f32_16x16x32_bf16 v[212:215], a[172:175], a[92:95], v[212:215]
v_mfma_f32_16x16x32_bf16 v[208:211], a[164:167], a[92:95], v[208:211]
v_mfma_f32_16x16x32_bf16 v[208:211], a[160:163], a[88:91], v[208:211]
s_add_u32 m0, s73, 65536
s_add_u32 s64, s71, 0
ds_read_b128 a[80:83], v9 offset:4096
v_mfma_f32_16x16x32_bf16 v[224:227], a[160:163], a[96:99], v[224:227]
s_add_u32 s52, s81, 13824
v_mfma_f32_16x16x32_bf16 v[224:227], a[164:167], a[100:103], v[224:227]
buffer_load_dwordx4 v5, s[8:11], s64 offen lds
v_mfma_f32_16x16x32_bf16 v[228:231], a[172:175], a[100:103], v[228:231]
ds_read_b64_tr_b16 a[148:149], v13 offset:40960
ds_read_b64_tr_b16 a[150:151], v13 offset:41472
v_mfma_f32_16x16x32_bf16 v[228:231], a[168:171], a[96:99], v[228:231]
buffer_load_dwordx2 a[200:201], v26, s[28:31], s52 offen
v_mfma_f32_16x16x32_bf16 v[232:235], a[176:179], a[96:99], v[232:235]
v_mfma_f32_16x16x32_bf16 v[232:235], a[180:183], a[100:103], v[232:235]
ds_read_b128 a[84:87], v10 offset:4096
v_mfma_f32_16x16x32_bf16 v[236:239], a[188:191], a[100:103], v[236:239]
v_mfma_f32_16x16x32_bf16 v[236:239], a[184:187], a[96:99], v[236:239]
v_mfma_f32_16x16x32_bf16 v[252:255], a[184:187], a[104:107], v[252:255]
buffer_load_dwordx4 v6, s[8:11], s64 offen offset:1024 lds
v_mfma_f32_16x16x32_bf16 v[252:255], a[188:191], a[108:111], v[252:255]
s_add_u32 s52, s81, 17280
ds_read_b64_tr_b16 a[152:153], v14 offset:32768
ds_read_b64_tr_b16 a[154:155], v14 offset:33280
v_mfma_f32_16x16x32_bf16 v[248:251], a[180:183], a[108:111], v[248:251]
buffer_load_dwordx2 a[202:203], v26, s[28:31], s52 offen
v_mfma_f32_16x16x32_bf16 v[248:251], a[176:179], a[104:107], v[248:251]
v_mfma_f32_16x16x32_bf16 v[244:247], a[168:171], a[104:107], v[244:247]
ds_read_b128 a[88:91], v9 offset:6144
v_mfma_f32_16x16x32_bf16 v[244:247], a[172:175], a[108:111], v[244:247]
s_add_u32 m0, s73, 67584
s_add_u32 s64, s71, 16384
v_mfma_f32_16x16x32_bf16 v[240:243], a[164:167], a[108:111], v[240:243]
v_mfma_f32_16x16x32_bf16 v[240:243], a[160:163], a[104:107], v[240:243]
buffer_load_dwordx4 v5, s[8:11], s64 offen lds
v_mfma_f32_16x16x32_bf16 a[0:3], a[160:163], a[112:115], a[0:3]
s_add_u32 s52, s81, 20736
ds_read_b64_tr_b16 a[156:157], v14 offset:40960
ds_read_b64_tr_b16 a[158:159], v14 offset:41472
v_mfma_f32_16x16x32_bf16 a[0:3], a[164:167], a[116:119], a[0:3]
buffer_load_dwordx2 a[204:205], v26, s[28:31], s52 offen
v_mfma_f32_16x16x32_bf16 a[4:7], a[172:175], a[116:119], a[4:7]
ds_read_b128 a[92:95], v10 offset:6144
v_mfma_f32_16x16x32_bf16 a[4:7], a[168:171], a[112:115], a[4:7]
v_mfma_f32_16x16x32_bf16 a[8:11], a[176:179], a[112:115], a[8:11]
v_mfma_f32_16x16x32_bf16 a[8:11], a[180:183], a[116:119], a[8:11]
v_mfma_f32_16x16x32_bf16 a[12:15], a[188:191], a[116:119], a[12:15]
buffer_load_dwordx4 v6, s[8:11], s64 offen offset:1024 lds
v_mfma_f32_16x16x32_bf16 a[12:15], a[184:187], a[112:115], a[12:15]
s_add_u32 s52, s81, 24192
v_mfma_f32_16x16x32_bf16 a[28:31], a[184:187], a[120:123], a[28:31]
buffer_load_dwordx2 a[206:207], v26, s[28:31], s52 offen
v_mfma_f32_16x16x32_bf16 a[28:31], a[188:191], a[124:127], a[28:31]
v_mfma_f32_16x16x32_bf16 a[24:27], a[180:183], a[124:127], a[24:27]
v_mfma_f32_16x16x32_bf16 a[24:27], a[176:179], a[120:123], a[24:27]
v_mfma_f32_16x16x32_bf16 a[20:23], a[168:171], a[120:123], a[20:23]
v_mfma_f32_16x16x32_bf16 a[20:23], a[172:175], a[124:127], a[20:23]
buffer_load_dwordx4 a[208:211], v27, s[36:39], s83 offen
v_mfma_f32_16x16x32_bf16 a[16:19], a[164:167], a[124:127], a[16:19]
v_mfma_f32_16x16x32_bf16 a[16:19], a[160:163], a[120:123], a[16:19]
s_waitcnt lgkmcnt(0)
v_mfma_f32_16x16x32_bf16 v[32:35], a[64:67], a[128:131], v[32:35]
s_waitcnt vmcnt(29)
v_mfma_f32_16x16x32_bf16 v[32:35], a[68:71], a[132:135], v[32:35]
s_barrier
v_mfma_f32_16x16x32_bf16 v[40:43], a[68:71], a[140:143], v[40:43]
ds_read_b128 a[96:99], v9 offset:8192
v_mfma_f32_16x16x32_bf16 v[40:43], a[64:67], a[136:139], v[40:43]
s_xor_b32 s76, s75, 2621440
s_add_u32 s76, s74, s76
v_mfma_f32_16x16x32_bf16 v[48:51], a[64:67], a[144:147], v[48:51]
s_add_u32 m0, s77, 32768
s_add_u32 s64, s76, 0
v_mfma_f32_16x16x32_bf16 v[48:51], a[68:71], a[148:151], v[48:51]
buffer_load_dwordx4 v7, s[56:59], s64 offen lds
v_mfma_f32_16x16x32_bf16 v[56:59], a[68:71], a[156:159], v[56:59]
ds_read_b128 a[100:103], v10 offset:8192
v_mfma_f32_16x16x32_bf16 v[56:59], a[64:67], a[152:155], v[56:59]
v_mfma_f32_16x16x32_bf16 v[60:63], a[72:75], a[152:155], v[60:63]
ds_read_b128 a[104:107], v9 offset:10240
v_mfma_f32_16x16x32_bf16 v[60:63], a[76:79], a[156:159], v[60:63]
v_mfma_f32_16x16x32_bf16 v[52:55], a[76:79], a[148:151], v[52:55]
v_mfma_f32_16x16x32_bf16 v[52:55], a[72:75], a[144:147], v[52:55]
buffer_load_dwordx4 v8, s[56:59], s64 offen offset:1024 lds
v_mfma_f32_16x16x32_bf16 v[44:47], a[72:75], a[136:139], v[44:47]
ds_read_b64_tr_b16 a[160:161], v11 offset:49152
ds_read_b64_tr_b16 a[162:163], v11 offset:49664
v_mfma_f32_16x16x32_bf16 v[44:47], a[76:79], a[140:143], v[44:47]
v_mfma_f32_16x16x32_bf16 v[36:39], a[76:79], a[132:135], v[36:39]
v_mfma_f32_16x16x32_bf16 v[36:39], a[72:75], a[128:131], v[36:39]
ds_read_b128 a[108:111], v10 offset:10240
v_mfma_f32_16x16x32_bf16 v[64:67], a[80:83], a[128:131], v[64:67]
s_add_u32 m0, s77, 34816
s_add_u32 s64, s76, 131072
v_mfma_f32_16x16x32_bf16 v[64:67], a[84:87], a[132:135], v[64:67]
v_mfma_f32_16x16x32_bf16 v[72:75], a[84:87], a[140:143], v[72:75]
buffer_load_dwordx4 v7, s[56:59], s64 offen lds
v_mfma_f32_16x16x32_bf16 v[72:75], a[80:83], a[136:139], v[72:75]
ds_read_b64_tr_b16 a[164:165], v11 offset:57344
ds_read_b64_tr_b16 a[166:167], v11 offset:57856
v_mfma_f32_16x16x32_bf16 v[80:83], a[80:83], a[144:147], v[80:83]
v_mfma_f32_16x16x32_bf16 v[80:83], a[84:87], a[148:151], v[80:83]
ds_read_b128 a[112:115], v9 offset:12288
v_mfma_f32_16x16x32_bf16 v[88:91], a[84:87], a[156:159], v[88:91]
v_mfma_f32_16x16x32_bf16 v[88:91], a[80:83], a[152:155], v[88:91]
v_mfma_f32_16x16x32_bf16 v[92:95], a[88:91], a[152:155], v[92:95]
ds_read_b64_tr_b16 a[168:169], v12 offset:49152
ds_read_b64_tr_b16 a[170:171], v12 offset:49664
v_mfma_f32_16x16x32_bf16 v[92:95], a[92:95], a[156:159], v[92:95]
buffer_load_dwordx4 v8, s[56:59], s64 offen offset:1024 lds
v_mfma_f32_16x16x32_bf16 v[84:87], a[92:95], a[148:151], v[84:87]
v_mfma_f32_16x16x32_bf16 v[84:87], a[88:91], a[144:147], v[84:87]
v_mfma_f32_16x16x32_bf16 v[76:79], a[88:91], a[136:139], v[76:79]
ds_read_b128 a[116:119], v10 offset:12288
v_mfma_f32_16x16x32_bf16 v[76:79], a[92:95], a[140:143], v[76:79]
v_mfma_f32_16x16x32_bf16 v[68:71], a[92:95], a[132:135], v[68:71]
v_mfma_f32_16x16x32_bf16 v[68:71], a[88:91], a[128:131], v[68:71]
s_add_u32 m0, s73, 69632
s_add_u32 s64, s71, 524288
s_waitcnt lgkmcnt(6)
v_mfma_f32_16x16x32_bf16 v[96:99], a[96:99], a[128:131], v[96:99]
ds_read_b64_tr_b16 a[172:173], v12 offset:57344
ds_read_b64_tr_b16 a[174:175], v12 offset:57856
v_mfma_f32_16x16x32_bf16 v[96:99], a[100:103], a[132:135], v[96:99]
buffer_load_dwordx4 v5, s[8:11], s64 offen lds
v_mfma_f32_16x16x32_bf16 v[104:107], a[100:103], a[140:143], v[104:107]
ds_read_b128 a[120:123], v9 offset:14336
v_mfma_f32_16x16x32_bf16 v[104:107], a[96:99], a[136:139], v[104:107]
v_mfma_f32_16x16x32_bf16 v[112:115], a[96:99], a[144:147], v[112:115]
v_mfma_f32_16x16x32_bf16 v[112:115], a[100:103], a[148:151], v[112:115]
s_waitcnt vmcnt(5)
ds_read_b64_tr_b16 a[176:177], v13 offset:49152
ds_read_b64_tr_b16 a[178:179], v13 offset:49664
v_mfma_f32_16x16x32_bf16 v[120:123], a[100:103], a[156:159], v[120:123]
v_accvgpr_read_b32 v16, a192
v_accvgpr_read_b32 v17, a194
v_mfma_f32_16x16x32_bf16 v[120:123], a[96:99], a[152:155], v[120:123]
v_accvgpr_read_b32 v18, a196
v_accvgpr_read_b32 v19, a198
v_mfma_f32_16x16x32_bf16 v[124:127], a[104:107], a[152:155], v[124:127]
buffer_load_dwordx4 v6, s[8:11], s64 offen offset:1024 lds
v_mfma_f32_16x16x32_bf16 v[124:127], a[108:111], a[156:159], v[124:127]
ds_read_b128 a[124:127], v10 offset:14336
v_accvgpr_read_b32 v20, a200
v_mfma_f32_16x16x32_bf16 v[116:119], a[108:111], a[148:151], v[116:119]
v_add_u32 v9, 32768, v9
v_add_u32 v10, 32768, v10
v_mfma_f32_16x16x32_bf16 v[116:119], a[104:107], a[144:147], v[116:119]
v_accvgpr_read_b32 v21, a202
v_accvgpr_read_b32 v22, a204
v_mfma_f32_16x16x32_bf16 v[108:111], a[104:107], a[136:139], v[108:111]
ds_read_b64_tr_b16 a[180:181], v13 offset:57344
ds_read_b64_tr_b16 a[182:183], v13 offset:57856
v_mfma_f32_16x16x32_bf16 v[108:111], a[108:111], a[140:143], v[108:111]
s_add_u32 m0, s73, 71680
s_add_u32 s64, s71, 540672
v_accvgpr_read_b32 v23, a206
v_mfma_f32_16x16x32_bf16 v[100:103], a[108:111], a[132:135], v[100:103]
s_waitcnt lgkmcnt(2)
v_mfma_f32_16x16x32_bf16 v[100:103], a[104:107], a[128:131], v[100:103]
buffer_load_dwordx4 v5, s[8:11], s64 offen lds
v_mfma_f32_16x16x32_bf16 v[128:131], a[112:115], a[128:131], v[128:131]
ds_read_b64_tr_b16 a[184:185], v14 offset:49152
ds_read_b64_tr_b16 a[186:187], v14 offset:49664
v_mfma_f32_16x16x32_bf16 v[128:131], a[116:119], a[132:135], v[128:131]
v_perm_b32 v24, v17, v16, s85
v_perm_b32 v25, v19, v18, s85
v_mfma_f32_16x16x32_bf16 v[136:139], a[116:119], a[140:143], v[136:139]
ds_read_b64_tr_b16 a[188:189], v14 offset:57344
ds_read_b64_tr_b16 a[190:191], v14 offset:57856
v_mfma_f32_16x16x32_bf16 v[136:139], a[112:115], a[136:139], v[136:139]
v_perm_b32 v26, v21, v20, s85
v_perm_b32 v27, v23, v22, s85
v_mfma_f32_16x16x32_bf16 v[144:147], a[112:115], a[144:147], v[144:147]
v_perm_b32 v28, v17, v16, s86
v_perm_b32 v29, v19, v18, s86
v_mfma_f32_16x16x32_bf16 v[144:147], a[116:119], a[148:151], v[144:147]
v_perm_b32 v30, v21, v20, s86
v_perm_b32 v31, v23, v22, s86
v_mfma_f32_16x16x32_bf16 v[152:155], a[116:119], a[156:159], v[152:155]
buffer_load_dwordx4 v6, s[8:11], s64 offen offset:1024 lds
v_mfma_f32_16x16x32_bf16 v[152:155], a[112:115], a[152:155], v[152:155]
v_accvgpr_read_b32 v16, a208
v_accvgpr_read_b32 v17, a209
v_mfma_f32_16x16x32_bf16 v[156:159], a[120:123], a[152:155], v[156:159]
v_accvgpr_read_b32 v18, a210
v_accvgpr_read_b32 v19, a211
v_mfma_f32_16x16x32_bf16 v[156:159], a[124:127], a[156:159], v[156:159]
v_or_b32 v24, v24, v16
v_or_b32 v25, v25, v17
v_mfma_f32_16x16x32_bf16 v[148:151], a[124:127], a[148:151], v[148:151]
v_or_b32 v26, v26, v18
v_or_b32 v27, v27, v19
v_mfma_f32_16x16x32_bf16 v[148:151], a[120:123], a[144:147], v[148:151]
buffer_store_dwordx4 v[24:27], v4, s[24:27], s82 offen offset:0 sc1
v_mfma_f32_16x16x32_bf16 v[140:143], a[120:123], a[136:139], v[140:143]
v_mfma_f32_16x16x32_bf16 v[140:143], a[124:127], a[140:143], v[140:143]
v_mfma_f32_16x16x32_bf16 v[132:135], a[124:127], a[132:135], v[132:135]
v_mfma_f32_16x16x32_bf16 v[132:135], a[120:123], a[128:131], v[132:135]
s_waitcnt lgkmcnt(0)
v_mfma_f32_16x16x32_bf16 v[160:163], a[160:163], a[64:67], v[160:163]
s_waitcnt vmcnt(26)
v_mfma_f32_16x16x32_bf16 v[160:163], a[164:167], a[68:71], v[160:163]
s_barrier
v_mfma_f32_16x16x32_bf16 v[164:167], a[172:175], a[68:71], v[164:167]
ds_read_b64_tr_b16 a[128:129], v11 offset:0
ds_read_b64_tr_b16 a[130:131], v11 offset:512
v_mfma_f32_16x16x32_bf16 v[164:167], a[168:171], a[64:67], v[164:167]
s_add_u32 m0, s77, 49152
s_add_u32 s64, s76, 0
v_mfma_f32_16x16x32_bf16 v[168:171], a[176:179], a[64:67], v[168:171]
buffer_load_dwordx4 v7, s[16:19], s64 offen lds
v_mfma_f32_16x16x32_bf16 v[168:171], a[180:183], a[68:71], v[168:171]
buffer_store_dwordx4 v[28:31], v4, s[24:27], s82 offen offset:1024 sc1
v_mfma_f32_16x16x32_bf16 v[172:175], a[188:191], a[68:71], v[172:175]
v_accvgpr_read_b32 v16, a193
v_accvgpr_read_b32 v17, a195
v_mfma_f32_16x16x32_bf16 v[172:175], a[184:187], a[64:67], v[172:175]
ds_read_b128 a[64:67], v9 offset:0
v_accvgpr_read_b32 v18, a197
v_mfma_f32_16x16x32_bf16 v[188:191], a[184:187], a[72:75], v[188:191]
ds_read_b64_tr_b16 a[132:133], v11 offset:8192
ds_read_b64_tr_b16 a[134:135], v11 offset:8704
v_mfma_f32_16x16x32_bf16 v[188:191], a[188:191], a[76:79], v[188:191]
v_accvgpr_read_b32 v19, a199
v_accvgpr_read_b32 v20, a201
v_mfma_f32_16x16x32_bf16 v[184:187], a[180:183], a[76:79], v[184:187]
v_accvgpr_read_b32 v21, a203
v_accvgpr_read_b32 v22, a205
v_mfma_f32_16x16x32_bf16 v[184:187], a[176:179], a[72:75], v[184:187]
buffer_load_dwordx4 v8, s[16:19], s64 offen offset:1024 lds
v_mfma_f32_16x16x32_bf16 v[180:183], a[168:171], a[72:75], v[180:183]
ds_read_b128 a[68:71], v10 offset:0
v_accvgpr_read_b32 v23, a207
v_mfma_f32_16x16x32_bf16 v[180:183], a[172:175], a[76:79], v[180:183]
v_mfma_f32_16x16x32_bf16 v[176:179], a[164:167], a[76:79], v[176:179]
v_perm_b32 v24, v17, v16, s85
v_perm_b32 v25, v19, v18, s85
v_mfma_f32_16x16x32_bf16 v[176:179], a[160:163], a[72:75], v[176:179]
ds_read_b64_tr_b16 a[136:137], v12 offset:0
ds_read_b64_tr_b16 a[138:139], v12 offset:512
v_mfma_f32_16x16x32_bf16 v[192:195], a[160:163], a[80:83], v[192:195]
s_add_u32 m0, s77, 51200
s_add_u32 s64, s76, 131072
v_perm_b32 v26, v21, v20, s85
v_mfma_f32_16x16x32_bf16 v[192:195], a[164:167], a[84:87], v[192:195]
v_perm_b32 v27, v23, v22, s85
v_perm_b32 v28, v17, v16, s86
v_mfma_f32_16x16x32_bf16 v[196:199], a[172:175], a[84:87], v[196:199]
buffer_load_dwordx4 v7, s[16:19], s64 offen lds
v_mfma_f32_16x16x32_bf16 v[196:199], a[168:171], a[80:83], v[196:199]
ds_read_b128 a[72:75], v9 offset:2048
v_perm_b32 v29, v19, v18, s86
v_mfma_f32_16x16x32_bf16 v[200:203], a[176:179], a[80:83], v[200:203]
v_perm_b32 v30, v21, v20, s86
v_perm_b32 v31, v23, v22, s86
v_mfma_f32_16x16x32_bf16 v[200:203], a[180:183], a[84:87], v[200:203]
ds_read_b64_tr_b16 a[140:141], v12 offset:8192
ds_read_b64_tr_b16 a[142:143], v12 offset:8704
v_mfma_f32_16x16x32_bf16 v[204:207], a[188:191], a[84:87], v[204:207]
buffer_store_dwordx4 v[24:27], v4, s[24:27], s82 offen offset:2048 sc1
v_mfma_f32_16x16x32_bf16 v[204:207], a[184:187], a[80:83], v[204:207]
v_mfma_f32_16x16x32_bf16 v[220:223], a[184:187], a[88:91], v[220:223]
ds_read_b128 a[76:79], v10 offset:2048
v_mfma_f32_16x16x32_bf16 v[220:223], a[188:191], a[92:95], v[220:223]
buffer_load_dwordx4 v8, s[16:19], s64 offen offset:1024 lds
v_mfma_f32_16x16x32_bf16 v[216:219], a[180:183], a[92:95], v[216:219]
s_xor_b32 s71, s70, 768
s_add_u32 s71, s68, s71
v_mfma_f32_16x16x32_bf16 v[216:219], a[176:179], a[88:91], v[216:219]
v_mfma_f32_16x16x32_bf16 v[212:215], a[168:171], a[88:91], v[212:215]
ds_read_b64_tr_b16 a[144:145], v13 offset:0
ds_read_b64_tr_b16 a[146:147], v13 offset:512
v_mfma_f32_16x16x32_bf16 v[212:215], a[172:175], a[92:95], v[212:215]
buffer_store_dwordx4 v[28:31], v4, s[24:27], s82 offen offset:3072 sc1
v_mfma_f32_16x16x32_bf16 v[208:211], a[164:167], a[92:95], v[208:211]
s_lshl_b32 s52, s7, 4
v_and_b32 v22, 3, v1
v_lshl_add_u32 v22, v22, 2, s52
v_mfma_f32_16x16x32_bf16 v[208:211], a[160:163], a[88:91], v[208:211]
s_add_u32 m0, s73, 0
s_add_u32 s64, s71, 0
ds_read_b128 a[80:83], v9 offset:4096
v_mfma_f32_16x16x32_bf16 v[224:227], a[160:163], a[96:99], v[224:227]
buffer_load_dword v23, v22, s[40:43], 0 offen sc1
v_mfma_f32_16x16x32_bf16 v[224:227], a[164:167], a[100:103], v[224:227]
buffer_load_dwordx4 v5, s[8:11], s64 offen lds
v_mfma_f32_16x16x32_bf16 v[228:231], a[172:175], a[100:103], v[228:231]
ds_read_b64_tr_b16 a[148:149], v13 offset:8192
ds_read_b64_tr_b16 a[150:151], v13 offset:8704
v_mfma_f32_16x16x32_bf16 v[228:231], a[168:171], a[96:99], v[228:231]
v_mfma_f32_16x16x32_bf16 v[232:235], a[176:179], a[96:99], v[232:235]
v_mfma_f32_16x16x32_bf16 v[232:235], a[180:183], a[100:103], v[232:235]
ds_read_b128 a[84:87], v10 offset:4096
v_mfma_f32_16x16x32_bf16 v[236:239], a[188:191], a[100:103], v[236:239]
v_mfma_f32_16x16x32_bf16 v[236:239], a[184:187], a[96:99], v[236:239]
v_mfma_f32_16x16x32_bf16 v[252:255], a[184:187], a[104:107], v[252:255]
buffer_load_dwordx4 v6, s[8:11], s64 offen offset:1024 lds
v_mfma_f32_16x16x32_bf16 v[252:255], a[188:191], a[108:111], v[252:255]
ds_read_b64_tr_b16 a[152:153], v14 offset:0
ds_read_b64_tr_b16 a[154:155], v14 offset:512
v_mfma_f32_16x16x32_bf16 v[248:251], a[180:183], a[108:111], v[248:251]
v_mfma_f32_16x16x32_bf16 v[248:251], a[176:179], a[104:107], v[248:251]
v_mfma_f32_16x16x32_bf16 v[244:247], a[168:171], a[104:107], v[244:247]
ds_read_b128 a[88:91], v9 offset:6144
v_mfma_f32_16x16x32_bf16 v[244:247], a[172:175], a[108:111], v[244:247]
s_add_u32 m0, s73, 2048
s_add_u32 s64, s71, 16384
v_mfma_f32_16x16x32_bf16 v[240:243], a[164:167], a[108:111], v[240:243]
v_mfma_f32_16x16x32_bf16 v[240:243], a[160:163], a[104:107], v[240:243]
buffer_load_dwordx4 v5, s[8:11], s64 offen lds
v_mfma_f32_16x16x32_bf16 a[0:3], a[160:163], a[112:115], a[0:3]
ds_read_b64_tr_b16 a[156:157], v14 offset:8192
ds_read_b64_tr_b16 a[158:159], v14 offset:8704
v_mfma_f32_16x16x32_bf16 a[0:3], a[164:167], a[116:119], a[0:3]
v_mfma_f32_16x16x32_bf16 a[4:7], a[172:175], a[116:119], a[4:7]
ds_read_b128 a[92:95], v10 offset:6144
v_mfma_f32_16x16x32_bf16 a[4:7], a[168:171], a[112:115], a[4:7]
v_mfma_f32_16x16x32_bf16 a[8:11], a[176:179], a[112:115], a[8:11]
v_mfma_f32_16x16x32_bf16 a[8:11], a[180:183], a[116:119], a[8:11]
v_mfma_f32_16x16x32_bf16 a[12:15], a[188:191], a[116:119], a[12:15]
buffer_load_dwordx4 v6, s[8:11], s64 offen offset:1024 lds
v_mfma_f32_16x16x32_bf16 a[12:15], a[184:187], a[112:115], a[12:15]
v_mfma_f32_16x16x32_bf16 a[28:31], a[184:187], a[120:123], a[28:31]
v_mfma_f32_16x16x32_bf16 a[28:31], a[188:191], a[124:127], a[28:31]
v_mfma_f32_16x16x32_bf16 a[24:27], a[180:183], a[124:127], a[24:27]
v_mfma_f32_16x16x32_bf16 a[24:27], a[176:179], a[120:123], a[24:27]
v_mfma_f32_16x16x32_bf16 a[20:23], a[168:171], a[120:123], a[20:23]
v_mfma_f32_16x16x32_bf16 a[20:23], a[172:175], a[124:127], a[20:23]
v_mfma_f32_16x16x32_bf16 a[16:19], a[164:167], a[124:127], a[16:19]
v_mfma_f32_16x16x32_bf16 a[16:19], a[160:163], a[120:123], a[16:19]
s_waitcnt lgkmcnt(0)
v_mfma_f32_16x16x32_bf16 v[32:35], a[64:67], a[128:131], v[32:35]
s_waitcnt vmcnt(31)
v_mfma_f32_16x16x32_bf16 v[32:35], a[68:71], a[132:135], v[32:35]
s_barrier
v_mfma_f32_16x16x32_bf16 v[40:43], a[68:71], a[140:143], v[40:43]
ds_read_b128 a[96:99], v9 offset:8192
v_mfma_f32_16x16x32_bf16 v[40:43], a[64:67], a[136:139], v[40:43]
s_xor_b32 s76, s75, 3145728
s_add_u32 s76, s74, s76
v_mfma_f32_16x16x32_bf16 v[48:51], a[64:67], a[144:147], v[48:51]
s_add_u32 m0, s77, 0
s_add_u32 s64, s76, 0
v_mfma_f32_16x16x32_bf16 v[48:51], a[68:71], a[148:151], v[48:51]
buffer_load_dwordx4 v7, s[56:59], s64 offen lds
v_mfma_f32_16x16x32_bf16 v[56:59], a[68:71], a[156:159], v[56:59]
ds_read_b128 a[100:103], v10 offset:8192
v_mfma_f32_16x16x32_bf16 v[56:59], a[64:67], a[152:155], v[56:59]
v_mfma_f32_16x16x32_bf16 v[60:63], a[72:75], a[152:155], v[60:63]
ds_read_b128 a[104:107], v9 offset:10240
v_mfma_f32_16x16x32_bf16 v[60:63], a[76:79], a[156:159], v[60:63]
v_mfma_f32_16x16x32_bf16 v[52:55], a[76:79], a[148:151], v[52:55]
v_mfma_f32_16x16x32_bf16 v[52:55], a[72:75], a[144:147], v[52:55]
buffer_load_dwordx4 v8, s[56:59], s64 offen offset:1024 lds
v_mfma_f32_16x16x32_bf16 v[44:47], a[72:75], a[136:139], v[44:47]
ds_read_b64_tr_b16 a[160:161], v11 offset:16384
ds_read_b64_tr_b16 a[162:163], v11 offset:16896
v_mfma_f32_16x16x32_bf16 v[44:47], a[76:79], a[140:143], v[44:47]
v_mfma_f32_16x16x32_bf16 v[36:39], a[76:79], a[132:135], v[36:39]
v_mfma_f32_16x16x32_bf16 v[36:39], a[72:75], a[128:131], v[36:39]
ds_read_b128 a[108:111], v10 offset:10240
v_mfma_f32_16x16x32_bf16 v[64:67], a[80:83], a[128:131], v[64:67]
s_add_u32 m0, s77, 2048
s_add_u32 s64, s76, 131072
s_waitcnt vmcnt(6)
v_mfma_f32_16x16x32_bf16 v[64:67], a[84:87], a[132:135], v[64:67]
v_cmp_gt_u32 vcc, 1, v23
v_mfma_f32_16x16x32_bf16 v[72:75], a[84:87], a[140:143], v[72:75]
buffer_load_dwordx4 v7, s[56:59], s64 offen lds
v_mfma_f32_16x16x32_bf16 v[72:75], a[80:83], a[136:139], v[72:75]
ds_read_b64_tr_b16 a[164:165], v11 offset:24576
ds_read_b64_tr_b16 a[166:167], v11 offset:25088
v_mfma_f32_16x16x32_bf16 v[80:83], a[80:83], a[144:147], v[80:83]
v_mfma_f32_16x16x32_bf16 v[80:83], a[84:87], a[148:151], v[80:83]
ds_read_b128 a[112:115], v9 offset:12288
v_mfma_f32_16x16x32_bf16 v[88:91], a[84:87], a[156:159], v[88:91]
s_cbranch_vccnz CK_Z
CK_Z_R:
v_mfma_f32_16x16x32_bf16 v[88:91], a[80:83], a[152:155], v[88:91]
buffer_atomic_add v1, v0, s[24:27], s84 offen offset:0 sc1
v_mfma_f32_16x16x32_bf16 v[92:95], a[88:91], a[152:155], v[92:95]
s_mul_i32 s52, s66, 147456
ds_read_b64_tr_b16 a[168:169], v12 offset:16384
ds_read_b64_tr_b16 a[170:171], v12 offset:16896
v_mfma_f32_16x16x32_bf16 v[92:95], a[92:95], a[156:159], v[92:95]
buffer_load_dwordx4 v8, s[56:59], s64 offen offset:1024 lds
v_mfma_f32_16x16x32_bf16 v[84:87], a[92:95], a[148:151], v[84:87]
s_lshl_b32 s53, s4, 8
s_add_u32 s52, s52, s53
s_lshl2_add_u32 s53, s2, s3
v_mfma_f32_16x16x32_bf16 v[84:87], a[88:91], a[144:147], v[84:87]
s_mul_i32 s53, s53, 2304
v_lshrrev_b32 v16, 1, v1
v_and_b32 v17, 1, v1
v_mfma_f32_16x16x32_bf16 v[76:79], a[88:91], a[136:139], v[76:79]
ds_read_b128 a[116:119], v10 offset:12288
v_lshlrev_b32 v16, 13, v16
v_mfma_f32_16x16x32_bf16 v[76:79], a[92:95], a[140:143], v[76:79]
v_lshl_add_u32 v16, v17, 7, v16
v_mov_b32 v17, 2147418112
v_mfma_f32_16x16x32_bf16 v[68:71], a[92:95], a[132:135], v[68:71]
v_cmp_gt_u32 s[96:97], 18, v1
v_lshlrev_b32 v18, 7, v1
v_mfma_f32_16x16x32_bf16 v[68:71], a[88:91], a[128:131], v[68:71]
s_add_u32 m0, s73, 4096
s_add_u32 s64, s71, 524288
s_waitcnt lgkmcnt(6)
v_mfma_f32_16x16x32_bf16 v[96:99], a[96:99], a[128:131], v[96:99]
ds_read_b64_tr_b16 a[172:173], v12 offset:24576
ds_read_b64_tr_b16 a[174:175], v12 offset:25088
v_mfma_f32_16x16x32_bf16 v[96:99], a[100:103], a[132:135], v[96:99]
buffer_load_dwordx4 v5, s[8:11], s64 offen lds
v_mfma_f32_16x16x32_bf16 v[104:107], a[100:103], a[140:143], v[104:107]
ds_read_b128 a[120:123], v9 offset:14336
v_mov_b32 v29, 0
v_mfma_f32_16x16x32_bf16 v[104:107], a[96:99], a[136:139], v[104:107]
v_mfma_f32_16x16x32_bf16 v[112:115], a[96:99], a[144:147], v[112:115]
v_cndmask_b32 v16, v17, v16, s[96:97]
v_cndmask_b32 v18, v17, v18, s[96:97]
v_mfma_f32_16x16x32_bf16 v[112:115], a[100:103], a[148:151], v[112:115]
ds_read_b64_tr_b16 a[176:177], v13 offset:16384
ds_read_b64_tr_b16 a[178:179], v13 offset:16896
v_mfma_f32_16x16x32_bf16 v[120:123], a[100:103], a[156:159], v[120:123]
buffer_load_dword a253, v18, s[12:15], s53 offen
v_mfma_f32_16x16x32_bf16 v[120:123], a[96:99], a[152:155], v[120:123]
v_mfma_f32_16x16x32_bf16 v[124:127], a[104:107], a[152:155], v[124:127]
buffer_load_dwordx4 v6, s[8:11], s64 offen offset:1024 lds
v_mfma_f32_16x16x32_bf16 v[124:127], a[108:111], a[156:159], v[124:127]
ds_read_b128 a[124:127], v10 offset:14336
v_mfma_f32_16x16x32_bf16 v[116:119], a[108:111], a[148:151], v[116:119]
v_add_u32 v9, 32768, v9
v_add_u32 v10, 32768, v10
v_mfma_f32_16x16x32_bf16 v[116:119], a[104:107], a[144:147], v[116:119]
v_mfma_f32_16x16x32_bf16 v[108:111], a[104:107], a[136:139], v[108:111]
ds_read_b64_tr_b16 a[180:181], v13 offset:24576
ds_read_b64_tr_b16 a[182:183], v13 offset:25088
v_mfma_f32_16x16x32_bf16 v[108:111], a[108:111], a[140:143], v[108:111]
s_add_u32 m0, s73, 6144
s_add_u32 s64, s71, 540672
v_mfma_f32_16x16x32_bf16 v[100:103], a[108:111], a[132:135], v[100:103]
s_waitcnt lgkmcnt(2)
v_mfma_f32_16x16x32_bf16 v[100:103], a[104:107], a[128:131], v[100:103]
buffer_load_dwordx4 v5, s[8:11], s64 offen lds
v_mfma_f32_16x16x32_bf16 v[128:131], a[112:115], a[128:131], v[128:131]
ds_read_b64_tr_b16 a[184:185], v14 offset:16384
ds_read_b64_tr_b16 a[186:187], v14 offset:16896
v_mfma_f32_16x16x32_bf16 v[128:131], a[116:119], a[132:135], v[128:131]
v_mfma_f32_16x16x32_bf16 v[136:139], a[116:119], a[140:143], v[136:139]
ds_read_b64_tr_b16 a[188:189], v14 offset:24576
ds_read_b64_tr_b16 a[190:191], v14 offset:25088
v_mfma_f32_16x16x32_bf16 v[136:139], a[112:115], a[136:139], v[136:139]
v_mfma_f32_16x16x32_bf16 v[144:147], a[112:115], a[144:147], v[144:147]
v_mfma_f32_16x16x32_bf16 v[144:147], a[116:119], a[148:151], v[144:147]
v_mfma_f32_16x16x32_bf16 v[152:155], a[116:119], a[156:159], v[152:155]
buffer_load_dwordx4 v6, s[8:11], s64 offen offset:1024 lds
v_mfma_f32_16x16x32_bf16 v[152:155], a[112:115], a[152:155], v[152:155]
v_mfma_f32_16x16x32_bf16 v[156:159], a[120:123], a[152:155], v[156:159]
v_mfma_f32_16x16x32_bf16 v[156:159], a[124:127], a[156:159], v[156:159]
v_mfma_f32_16x16x32_bf16 v[148:151], a[124:127], a[148:151], v[148:151]
v_mfma_f32_16x16x32_bf16 v[148:151], a[120:123], a[144:147], v[148:151]
v_mfma_f32_16x16x32_bf16 v[140:143], a[120:123], a[136:139], v[140:143]
v_mfma_f32_16x16x32_bf16 v[140:143], a[124:127], a[140:143], v[140:143]
v_mfma_f32_16x16x32_bf16 v[132:135], a[124:127], a[132:135], v[132:135]
v_mfma_f32_16x16x32_bf16 v[132:135], a[120:123], a[128:131], v[132:135]
s_waitcnt lgkmcnt(0)
v_mfma_f32_16x16x32_bf16 v[160:163], a[160:163], a[64:67], v[160:163]
s_waitcnt vmcnt(23)
v_mfma_f32_16x16x32_bf16 v[160:163], a[164:167], a[68:71], v[160:163]
s_barrier
v_mfma_f32_16x16x32_bf16 v[164:167], a[172:175], a[68:71], v[164:167]
ds_read_b64_tr_b16 a[128:129], v11 offset:32768
ds_read_b64_tr_b16 a[130:131], v11 offset:33280
v_mfma_f32_16x16x32_bf16 v[164:167], a[168:171], a[64:67], v[164:167]
s_add_u32 m0, s77, 16384
s_add_u32 s64, s76, 0
v_mfma_f32_16x16x32_bf16 v[168:171], a[176:179], a[64:67], v[168:171]
buffer_load_dwordx4 v7, s[16:19], s64 offen lds
v_mfma_f32_16x16x32_bf16 v[168:171], a[180:183], a[68:71], v[168:171]
buffer_load_dword a252, v16, s[20:23], s52 offen
v_mfma_f32_16x16x32_bf16 v[172:175], a[188:191], a[68:71], v[172:175]
s_add_u32 s52, s52, 73728
v_mfma_f32_16x16x32_bf16 v[172:175], a[184:187], a[64:67], v[172:175]
ds_read_b128 a[64:67], v9 offset:0
v_mfma_f32_16x16x32_bf16 v[188:191], a[184:187], a[72:75], v[188:191]
ds_read_b64_tr_b16 a[132:133], v11 offset:40960
ds_read_b64_tr_b16 a[134:135], v11 offset:41472
v_mfma_f32_16x16x32_bf16 v[188:191], a[188:191], a[76:79], v[188:191]
v_mfma_f32_16x16x32_bf16 v[184:187], a[180:183], a[76:79], v[184:187]
v_mfma_f32_16x16x32_bf16 v[184:187], a[176:179], a[72:75], v[184:187]
buffer_load_dwordx4 v8, s[16:19], s64 offen offset:1024 lds
v_mfma_f32_16x16x32_bf16 v[180:183], a[168:171], a[72:75], v[180:183]
ds_read_b128 a[68:71], v10 offset:0
v_mfma_f32_16x16x32_bf16 v[180:183], a[172:175], a[76:79], v[180:183]
v_mfma_f32_16x16x32_bf16 v[176:179], a[164:167], a[76:79], v[176:179]
v_mfma_f32_16x16x32_bf16 v[176:179], a[160:163], a[72:75], v[176:179]
ds_read_b64_tr_b16 a[136:137], v12 offset:32768
ds_read_b64_tr_b16 a[138:139], v12 offset:33280
v_mfma_f32_16x16x32_bf16 v[192:195], a[160:163], a[80:83], v[192:195]
s_add_u32 m0, s77, 18432
s_add_u32 s64, s76, 131072
v_mfma_f32_16x16x32_bf16 v[192:195], a[164:167], a[84:87], v[192:195]
v_mfma_f32_16x16x32_bf16 v[196:199], a[172:175], a[84:87], v[196:199]
buffer_load_dwordx4 v7, s[16:19], s64 offen lds
v_mfma_f32_16x16x32_bf16 v[196:199], a[168:171], a[80:83], v[196:199]
ds_read_b128 a[72:75], v9 offset:2048
v_mfma_f32_16x16x32_bf16 v[200:203], a[176:179], a[80:83], v[200:203]
v_mfma_f32_16x16x32_bf16 v[200:203], a[180:183], a[84:87], v[200:203]
ds_read_b64_tr_b16 a[140:141], v12 offset:40960
ds_read_b64_tr_b16 a[142:143], v12 offset:41472
v_mfma_f32_16x16x32_bf16 v[204:207], a[188:191], a[84:87], v[204:207]
v_mfma_f32_16x16x32_bf16 v[204:207], a[184:187], a[80:83], v[204:207]
v_mfma_f32_16x16x32_bf16 v[220:223], a[184:187], a[88:91], v[220:223]
ds_read_b128 a[76:79], v10 offset:2048
v_mfma_f32_16x16x32_bf16 v[220:223], a[188:191], a[92:95], v[220:223]
buffer_load_dwordx4 v8, s[16:19], s64 offen offset:1024 lds
v_mfma_f32_16x16x32_bf16 v[216:219], a[180:183], a[92:95], v[216:219]
s_xor_b32 s71, s70, 896
s_add_u32 s71, s68, s71
v_mfma_f32_16x16x32_bf16 v[216:219], a[176:179], a[88:91], v[216:219]
L_PAD2:
s_cbranch_execz L_PAD6
v_mfma_f32_16x16x32_bf16 v[212:215], a[168:171], a[88:91], v[212:215]
ds_read_b64_tr_b16 a[144:145], v13 offset:32768
ds_read_b64_tr_b16 a[146:147], v13 offset:33280
v_mfma_f32_16x16x32_bf16 v[212:215], a[172:175], a[92:95], v[212:215]
v_mfma_f32_16x16x32_bf16 v[208:211], a[164:167], a[92:95], v[208:211]
v_mfma_f32_16x16x32_bf16 v[208:211], a[160:163], a[88:91], v[208:211]
s_add_u32 m0, s73, 32768
s_add_u32 s64, s71, 0
ds_read_b128 a[80:83], v9 offset:4096
v_mfma_f32_16x16x32_bf16 v[224:227], a[160:163], a[96:99], v[224:227]
v_mfma_f32_16x16x32_bf16 v[224:227], a[164:167], a[100:103], v[224:227]
buffer_load_dwordx4 v5, s[8:11], s64 offen lds
v_mfma_f32_16x16x32_bf16 v[228:231], a[172:175], a[100:103], v[228:231]
ds_read_b64_tr_b16 a[148:149], v13 offset:40960
ds_read_b64_tr_b16 a[150:151], v13 offset:41472
v_mfma_f32_16x16x32_bf16 v[228:231], a[168:171], a[96:99], v[228:231]
v_mfma_f32_16x16x32_bf16 v[232:235], a[176:179], a[96:99], v[232:235]
v_mfma_f32_16x16x32_bf16 v[232:235], a[180:183], a[100:103], v[232:235]
ds_read_b128 a[84:87], v10 offset:4096
v_mfma_f32_16x16x32_bf16 v[236:239], a[188:191], a[100:103], v[236:239]
v_mfma_f32_16x16x32_bf16 v[236:239], a[184:187], a[96:99], v[236:239]
v_mfma_f32_16x16x32_bf16 v[252:255], a[184:187], a[104:107], v[252:255]
buffer_load_dwordx4 v6, s[8:11], s64 offen offset:1024 lds
v_mfma_f32_16x16x32_bf16 v[252:255], a[188:191], a[108:111], v[252:255]
ds_read_b64_tr_b16 a[152:153], v14 offset:32768
ds_read_b64_tr_b16 a[154:155], v14 offset:33280
v_mfma_f32_16x16x32_bf16 v[248:251], a[180:183], a[108:111], v[248:251]
v_mfma_f32_16x16x32_bf16 v[248:251], a[176:179], a[104:107], v[248:251]
v_mfma_f32_16x16x32_bf16 v[244:247], a[168:171], a[104:107], v[244:247]
ds_read_b128 a[88:91], v9 offset:6144
v_mfma_f32_16x16x32_bf16 v[244:247], a[172:175], a[108:111], v[244:247]
s_add_u32 m0, s73, 34816
s_add_u32 s64, s71, 16384
v_mfma_f32_16x16x32_bf16 v[240:243], a[164:167], a[108:111], v[240:243]
v_mfma_f32_16x16x32_bf16 v[240:243], a[160:163], a[104:107], v[240:243]
buffer_load_dwordx4 v5, s[8:11], s64 offen lds
v_mfma_f32_16x16x32_bf16 a[0:3], a[160:163], a[112:115], a[0:3]
ds_read_b64_tr_b16 a[156:157], v14 offset:40960
ds_read_b64_tr_b16 a[158:159], v14 offset:41472
v_mfma_f32_16x16x32_bf16 a[0:3], a[164:167], a[116:119], a[0:3]
v_mfma_f32_16x16x32_bf16 a[4:7], a[172:175], a[116:119], a[4:7]
ds_read_b128 a[92:95], v10 offset:6144
v_mfma_f32_16x16x32_bf16 a[4:7], a[168:171], a[112:115], a[4:7]
v_mfma_f32_16x16x32_bf16 a[8:11], a[176:179], a[112:115], a[8:11]
v_mfma_f32_16x16x32_bf16 a[8:11], a[180:183], a[116:119], a[8:11]
v_mfma_f32_16x16x32_bf16 a[12:15], a[188:191], a[116:119], a[12:15]
buffer_load_dwordx4 v6, s[8:11], s64 offen offset:1024 lds
v_mfma_f32_16x16x32_bf16 a[12:15], a[184:187], a[112:115], a[12:15]
v_mfma_f32_16x16x32_bf16 a[28:31], a[184:187], a[120:123], a[28:31]
v_mfma_f32_16x16x32_bf16 a[28:31], a[188:191], a[124:127], a[28:31]
v_mfma_f32_16x16x32_bf16 a[24:27], a[180:183], a[124:127], a[24:27]
v_mfma_f32_16x16x32_bf16 a[24:27], a[176:179], a[120:123], a[24:27]
v_mfma_f32_16x16x32_bf16 a[20:23], a[168:171], a[120:123], a[20:23]
v_mfma_f32_16x16x32_bf16 a[20:23], a[172:175], a[124:127], a[20:23]
v_mfma_f32_16x16x32_bf16 a[16:19], a[164:167], a[124:127], a[16:19]
v_mfma_f32_16x16x32_bf16 a[16:19], a[160:163], a[120:123], a[16:19]
s_waitcnt lgkmcnt(0)
v_mfma_f32_16x16x32_bf16 v[32:35], a[64:67], a[128:131], v[32:35]
s_waitcnt vmcnt(25)
v_mfma_f32_16x16x32_bf16 v[32:35], a[68:71], a[132:135], v[32:35]
s_barrier
v_mfma_f32_16x16x32_bf16 v[40:43], a[68:71], a[140:143], v[40:43]
ds_read_b128 a[96:99], v9 offset:8192
v_mfma_f32_16x16x32_bf16 v[40:43], a[64:67], a[136:139], v[40:43]
s_xor_b32 s76, s75, 3670016
s_add_u32 s76, s74, s76
v_mfma_f32_16x16x32_bf16 v[48:51], a[64:67], a[144:147], v[48:51]
s_add_u32 m0, s77, 32768
s_add_u32 s64, s76, 0
v_mfma_f32_16x16x32_bf16 v[48:51], a[68:71], a[148:151], v[48:51]
buffer_load_dwordx4 v7, s[56:59], s64 offen lds
v_mfma_f32_16x16x32_bf16 v[56:59], a[68:71], a[156:159], v[56:59]
ds_read_b128 a[100:103], v10 offset:8192
v_mfma_f32_16x16x32_bf16 v[56:59], a[64:67], a[152:155], v[56:59]
buffer_load_dword a252, v16, s[20:23], s52 offen
v_mfma_f32_16x16x32_bf16 v[60:63], a[72:75], a[152:155], v[60:63]
s_lshr_b32 s52, s2, 1
s_lshl2_add_u32 s52, s52, s3
ds_read_b128 a[104:107], v9 offset:10240
v_mfma_f32_16x16x32_bf16 v[60:63], a[76:79], a[156:159], v[60:63]
s_mul_i32 s52, s52, 9216
s_and_b32 s53, s2, 1
s_lshl_b32 s53, s53, 9
v_mfma_f32_16x16x32_bf16 v[52:55], a[76:79], a[148:151], v[52:55]
s_add_u32 s52, s52, s53
s_lshl2_add_u32 s53, s2, s3
s_mul_i32 s53, s53, 768
v_mfma_f32_16x16x32_bf16 v[52:55], a[72:75], a[144:147], v[52:55]
buffer_load_dwordx4 v8, s[56:59], s64 offen offset:1024 lds
v_mfma_f32_16x16x32_bf16 v[44:47], a[72:75], a[136:139], v[44:47]
ds_read_b64_tr_b16 a[160:161], v11 offset:49152
ds_read_b64_tr_b16 a[162:163], v11 offset:49664
v_mfma_f32_16x16x32_bf16 v[44:47], a[76:79], a[140:143], v[44:47]
v_cmp_gt_u32 s[96:97], 40, v1
v_and_b32 v16, 7, v1
v_mfma_f32_16x16x32_bf16 v[36:39], a[76:79], a[132:135], v[36:39]
v_mul_u32_u24 v16, 1152, v16
v_lshrrev_b32 v19, 3, v1
v_mfma_f32_16x16x32_bf16 v[36:39], a[72:75], a[128:131], v[36:39]
ds_read_b128 a[108:111], v10 offset:10240
v_lshl_add_u32 v16, v19, 7, v16
v_mfma_f32_16x16x32_bf16 v[64:67], a[80:83], a[128:131], v[64:67]
s_add_u32 m0, s77, 34816
s_add_u32 s64, s76, 131072
v_cndmask_b32 v16, v17, v16, s[96:97]
v_mfma_f32_16x16x32_bf16 v[64:67], a[84:87], a[132:135], v[64:67]
v_cmp_gt_u32 s[96:97], 6, v1
v_mfma_f32_16x16x32_bf16 v[72:75], a[84:87], a[140:143], v[72:75]
buffer_load_dwordx4 v7, s[56:59], s64 offen lds
v_mfma_f32_16x16x32_bf16 v[72:75], a[80:83], a[136:139], v[72:75]
ds_read_b64_tr_b16 a[164:165], v11 offset:57344
ds_read_b64_tr_b16 a[166:167], v11 offset:57856
v_mfma_f32_16x16x32_bf16 v[80:83], a[80:83], a[144:147], v[80:83]
v_cndmask_b32 v18, v17, v18, s[96:97]
v_mfma_f32_16x16x32_bf16 v[80:83], a[84:87], a[148:151], v[80:83]
ds_read_b128 a[112:115], v9 offset:12288
v_mfma_f32_16x16x32_bf16 v[88:91], a[84:87], a[156:159], v[88:91]
v_mfma_f32_16x16x32_bf16 v[88:91], a[80:83], a[152:155], v[88:91]
v_mfma_f32_16x16x32_bf16 v[92:95], a[88:91], a[152:155], v[92:95]
ds_read_b64_tr_b16 a[168:169], v12 offset:49152
ds_read_b64_tr_b16 a[170:171], v12 offset:49664
v_mfma_f32_16x16x32_bf16 v[92:95], a[92:95], a[156:159], v[92:95]
buffer_load_dwordx4 v8, s[56:59], s64 offen offset:1024 lds
v_mfma_f32_16x16x32_bf16 v[84:87], a[92:95], a[148:151], v[84:87]
v_mfma_f32_16x16x32_bf16 v[84:87], a[88:91], a[144:147], v[84:87]
v_mfma_f32_16x16x32_bf16 v[76:79], a[88:91], a[136:139], v[76:79]
ds_read_b128 a[116:119], v10 offset:12288
v_mfma_f32_16x16x32_bf16 v[76:79], a[92:95], a[140:143], v[76:79]
v_mfma_f32_16x16x32_bf16 v[68:71], a[92:95], a[132:135], v[68:71]
v_mfma_f32_16x16x32_bf16 v[68:71], a[88:91], a[128:131], v[68:71]
s_add_u32 m0, s73, 36864
s_add_u32 s64, s71, 524288
s_waitcnt lgkmcnt(6)
v_mfma_f32_16x16x32_bf16 v[96:99], a[96:99], a[128:131], v[96:99]
ds_read_b64_tr_b16 a[172:173], v12 offset:57344
ds_read_b64_tr_b16 a[174:175], v12 offset:57856
v_mfma_f32_16x16x32_bf16 v[96:99], a[100:103], a[132:135], v[96:99]
buffer_load_dwordx4 v5, s[8:11], s64 offen lds
v_mfma_f32_16x16x32_bf16 v[104:107], a[100:103], a[140:143], v[104:107]
ds_read_b128 a[120:123], v9 offset:14336
v_mfma_f32_16x16x32_bf16 v[104:107], a[96:99], a[136:139], v[104:107]
v_mfma_f32_16x16x32_bf16 v[112:115], a[96:99], a[144:147], v[112:115]
v_mfma_f32_16x16x32_bf16 v[112:115], a[100:103], a[148:151], v[112:115]
ds_read_b64_tr_b16 a[176:177], v13 offset:49152
ds_read_b64_tr_b16 a[178:179], v13 offset:49664
v_mfma_f32_16x16x32_bf16 v[120:123], a[100:103], a[156:159], v[120:123]
v_mfma_f32_16x16x32_bf16 v[120:123], a[96:99], a[152:155], v[120:123]
v_mfma_f32_16x16x32_bf16 v[124:127], a[104:107], a[152:155], v[124:127]
buffer_load_dwordx4 v6, s[8:11], s64 offen offset:1024 lds
v_mfma_f32_16x16x32_bf16 v[124:127], a[108:111], a[156:159], v[124:127]
ds_read_b128 a[124:127], v10 offset:14336
v_mfma_f32_16x16x32_bf16 v[116:119], a[108:111], a[148:151], v[116:119]
v_add_u32 v9, -65536, v9
v_add_u32 v10, -65536, v10
v_mfma_f32_16x16x32_bf16 v[116:119], a[104:107], a[144:147], v[116:119]
buffer_load_dword v30, v29, s[24:27], s89 offen sc1
v_mfma_f32_16x16x32_bf16 v[108:111], a[104:107], a[136:139], v[108:111]
ds_read_b64_tr_b16 a[180:181], v13 offset:57344
ds_read_b64_tr_b16 a[182:183], v13 offset:57856
v_mfma_f32_16x16x32_bf16 v[108:111], a[108:111], a[140:143], v[108:111]
s_add_u32 m0, s73, 38912
s_add_u32 s64, s71, 540672
v_mfma_f32_16x16x32_bf16 v[100:103], a[108:111], a[132:135], v[100:103]
s_waitcnt lgkmcnt(2)
v_mfma_f32_16x16x32_bf16 v[100:103], a[104:107], a[128:131], v[100:103]
buffer_load_dwordx4 v5, s[8:11], s64 offen lds
v_mfma_f32_16x16x32_bf16 v[128:131], a[112:115], a[128:131], v[128:131]
ds_read_b64_tr_b16 a[184:185], v14 offset:49152
ds_read_b64_tr_b16 a[186:187], v14 offset:49664
v_mfma_f32_16x16x32_bf16 v[128:131], a[116:119], a[132:135], v[128:131]
v_mfma_f32_16x16x32_bf16 v[136:139], a[116:119], a[140:143], v[136:139]
ds_read_b64_tr_b16 a[188:189], v14 offset:57344
ds_read_b64_tr_b16 a[190:191], v14 offset:57856
v_mfma_f32_16x16x32_bf16 v[136:139], a[112:115], a[136:139], v[136:139]
v_mfma_f32_16x16x32_bf16 v[144:147], a[112:115], a[144:147], v[144:147]
v_mfma_f32_16x16x32_bf16 v[144:147], a[116:119], a[148:151], v[144:147]
v_mfma_f32_16x16x32_bf16 v[152:155], a[116:119], a[156:159], v[152:155]
buffer_load_dwordx4 v6, s[8:11], s64 offen offset:1024 lds
v_mfma_f32_16x16x32_bf16 v[152:155], a[112:115], a[152:155], v[152:155]
v_mfma_f32_16x16x32_bf16 v[156:159], a[120:123], a[152:155], v[156:159]
v_mfma_f32_16x16x32_bf16 v[156:159], a[124:127], a[156:159], v[156:159]
v_mfma_f32_16x16x32_bf16 v[148:151], a[124:127], a[148:151], v[148:151]
v_mfma_f32_16x16x32_bf16 v[148:151], a[120:123], a[144:147], v[148:151]
v_mfma_f32_16x16x32_bf16 v[140:143], a[120:123], a[136:139], v[140:143]
v_mfma_f32_16x16x32_bf16 v[140:143], a[124:127], a[140:143], v[140:143]
v_mfma_f32_16x16x32_bf16 v[132:135], a[124:127], a[132:135], v[132:135]
v_mfma_f32_16x16x32_bf16 v[132:135], a[120:123], a[128:131], v[132:135]
s_waitcnt lgkmcnt(0)
v_mfma_f32_16x16x32_bf16 v[160:163], a[160:163], a[64:67], v[160:163]
s_waitcnt vmcnt(19)
v_mfma_f32_16x16x32_bf16 v[160:163], a[164:167], a[68:71], v[160:163]
s_barrier
v_mfma_f32_16x16x32_bf16 v[164:167], a[172:175], a[68:71], v[164:167]
ds_read_b64_tr_b16 a[128:129], v11 offset:0
ds_read_b64_tr_b16 a[130:131], v11 offset:512
v_mfma_f32_16x16x32_bf16 v[164:167], a[168:171], a[64:67], v[164:167]
s_add_u32 m0, s77, 49152
s_add_u32 s64, s76, 0
v_mfma_f32_16x16x32_bf16 v[168:171], a[176:179], a[64:67], v[168:171]
buffer_load_dwordx4 v7, s[16:19], s64 offen lds
v_mfma_f32_16x16x32_bf16 v[168:171], a[180:183], a[68:71], v[168:171]
v_mfma_f32_16x16x32_bf16 v[172:175], a[188:191], a[68:71], v[172:175]
v_mfma_f32_16x16x32_bf16 v[172:175], a[184:187], a[64:67], v[172:175]
ds_read_b128 a[64:67], v9 offset:0
v_mfma_f32_16x16x32_bf16 v[188:191], a[184:187], a[72:75], v[188:191]
ds_read_b64_tr_b16 a[132:133], v11 offset:8192
ds_read_b64_tr_b16 a[134:135], v11 offset:8704
v_mfma_f32_16x16x32_bf16 v[188:191], a[188:191], a[76:79], v[188:191]
v_mfma_f32_16x16x32_bf16 v[184:187], a[180:183], a[76:79], v[184:187]
v_mfma_f32_16x16x32_bf16 v[184:187], a[176:179], a[72:75], v[184:187]
buffer_load_dwordx4 v8, s[16:19], s64 offen offset:1024 lds
v_mfma_f32_16x16x32_bf16 v[180:183], a[168:171], a[72:75], v[180:183]
ds_read_b128 a[68:71], v10 offset:0
v_mfma_f32_16x16x32_bf16 v[180:183], a[172:175], a[76:79], v[180:183]
v_mfma_f32_16x16x32_bf16 v[176:179], a[164:167], a[76:79], v[176:179]
v_mfma_f32_16x16x32_bf16 v[176:179], a[160:163], a[72:75], v[176:179]
ds_read_b64_tr_b16 a[136:137], v12 offset:0
ds_read_b64_tr_b16 a[138:139], v12 offset:512
v_mfma_f32_16x16x32_bf16 v[192:195], a[160:163], a[80:83], v[192:195]
s_add_u32 m0, s77, 51200
s_add_u32 s64, s76, 131072
v_mfma_f32_16x16x32_bf16 v[192:195], a[164:167], a[84:87], v[192:195]
v_mfma_f32_16x16x32_bf16 v[196:199], a[172:175], a[84:87], v[196:199]
buffer_load_dwordx4 v7, s[16:19], s64 offen lds
v_mfma_f32_16x16x32_bf16 v[196:199], a[168:171], a[80:83], v[196:199]
ds_read_b128 a[72:75], v9 offset:2048
v_mfma_f32_16x16x32_bf16 v[200:203], a[176:179], a[80:83], v[200:203]
v_mfma_f32_16x16x32_bf16 v[200:203], a[180:183], a[84:87], v[200:203]
ds_read_b64_tr_b16 a[140:141], v12 offset:8192
ds_read_b64_tr_b16 a[142:143], v12 offset:8704
v_mfma_f32_16x16x32_bf16 v[204:207], a[188:191], a[84:87], v[204:207]
v_mfma_f32_16x16x32_bf16 v[204:207], a[184:187], a[80:83], v[204:207]
v_mfma_f32_16x16x32_bf16 v[220:223], a[184:187], a[88:91], v[220:223]
ds_read_b128 a[76:79], v10 offset:2048
v_mfma_f32_16x16x32_bf16 v[220:223], a[188:191], a[92:95], v[220:223]
buffer_load_dwordx4 v8, s[16:19], s64 offen offset:1024 lds
v_mfma_f32_16x16x32_bf16 v[216:219], a[180:183], a[92:95], v[216:219]
s_lshl_b32 s70, s93, 7
s_mul_i32 s68, s66, 36864
s_mul_i32 s69, s67, 36864
v_mfma_f32_16x16x32_bf16 v[216:219], a[176:179], a[88:91], v[216:219]
v_lshrrev_b32 v31, 3, v1
v_lshl_add_u32 v5, v31, 7, v5
v_mfma_f32_16x16x32_bf16 v[212:215], a[168:171], a[88:91], v[212:215]
v_lshl_add_u32 v6, v31, 7, v6
v_add_u32 v6, 1024, v6
v_mfma_f32_16x16x32_bf16 v[212:215], a[172:175], a[92:95], v[212:215]
s_mov_b32 s65, 1024
s_add_u32 s71, s68, s65
s_add_u32 s72, s69, s65
v_mfma_f32_16x16x32_bf16 v[208:211], a[164:167], a[92:95], v[208:211]
ds_read_b64_tr_b16 a[144:145], v13 offset:0
ds_read_b64_tr_b16 a[146:147], v13 offset:512
v_mfma_f32_16x16x32_bf16 v[208:211], a[160:163], a[88:91], v[208:211]
s_add_u32 m0, s73, 65536
s_add_u32 s64, s71, 0
ds_read_b128 a[80:83], v9 offset:4096
v_mfma_f32_16x16x32_bf16 v[224:227], a[160:163], a[96:99], v[224:227]
v_mfma_f32_16x16x32_bf16 v[224:227], a[164:167], a[100:103], v[224:227]
buffer_load_dwordx4 v5, s[12:15], s64 offen lds
v_mfma_f32_16x16x32_bf16 v[228:231], a[172:175], a[100:103], v[228:231]
ds_read_b64_tr_b16 a[148:149], v13 offset:8192
ds_read_b64_tr_b16 a[150:151], v13 offset:8704
v_mfma_f32_16x16x32_bf16 v[228:231], a[168:171], a[96:99], v[228:231]
v_mfma_f32_16x16x32_bf16 v[232:235], a[176:179], a[96:99], v[232:235]
v_mfma_f32_16x16x32_bf16 v[232:235], a[180:183], a[100:103], v[232:235]
ds_read_b128 a[84:87], v10 offset:4096
v_mfma_f32_16x16x32_bf16 v[236:239], a[188:191], a[100:103], v[236:239]
v_mfma_f32_16x16x32_bf16 v[236:239], a[184:187], a[96:99], v[236:239]
v_mfma_f32_16x16x32_bf16 v[252:255], a[184:187], a[104:107], v[252:255]
buffer_load_dwordx4 v6, s[12:15], s64 offen offset:1024 lds
v_mfma_f32_16x16x32_bf16 v[252:255], a[188:191], a[108:111], v[252:255]
ds_read_b64_tr_b16 a[152:153], v14 offset:0
ds_read_b64_tr_b16 a[154:155], v14 offset:512
v_mfma_f32_16x16x32_bf16 v[248:251], a[180:183], a[108:111], v[248:251]
v_mfma_f32_16x16x32_bf16 v[248:251], a[176:179], a[104:107], v[248:251]
v_mfma_f32_16x16x32_bf16 v[244:247], a[168:171], a[104:107], v[244:247]
ds_read_b128 a[88:91], v9 offset:6144
v_mfma_f32_16x16x32_bf16 v[244:247], a[172:175], a[108:111], v[244:247]
s_add_u32 m0, s73, 67584
s_add_u32 s64, s71, 18432
v_mfma_f32_16x16x32_bf16 v[240:243], a[164:167], a[108:111], v[240:243]
v_mfma_f32_16x16x32_bf16 v[240:243], a[160:163], a[104:107], v[240:243]
buffer_load_dwordx4 v5, s[12:15], s64 offen lds
v_mfma_f32_16x16x32_bf16 a[0:3], a[160:163], a[112:115], a[0:3]
ds_read_b64_tr_b16 a[156:157], v14 offset:8192
ds_read_b64_tr_b16 a[158:159], v14 offset:8704
v_mfma_f32_16x16x32_bf16 a[0:3], a[164:167], a[116:119], a[0:3]
v_mfma_f32_16x16x32_bf16 a[4:7], a[172:175], a[116:119], a[4:7]
s_waitcnt vmcnt(9)
ds_read_b128 a[92:95], v10 offset:6144
v_mfma_f32_16x16x32_bf16 a[4:7], a[168:171], a[112:115], a[4:7]
v_cmp_gt_u32 vcc, 18, v30
v_mfma_f32_16x16x32_bf16 a[8:11], a[176:179], a[112:115], a[8:11]
v_mfma_f32_16x16x32_bf16 a[8:11], a[180:183], a[116:119], a[8:11]
v_mfma_f32_16x16x32_bf16 a[12:15], a[188:191], a[116:119], a[12:15]
buffer_load_dwordx4 v6, s[12:15], s64 offen offset:1024 lds
v_mfma_f32_16x16x32_bf16 a[12:15], a[184:187], a[112:115], a[12:15]
v_mfma_f32_16x16x32_bf16 a[28:31], a[184:187], a[120:123], a[28:31]
s_cbranch_vccnz CK_WA
CK_WA_R:
v_mfma_f32_16x16x32_bf16 a[28:31], a[188:191], a[124:127], a[28:31]
v_mfma_f32_16x16x32_bf16 a[24:27], a[180:183], a[124:127], a[24:27]
v_mfma_f32_16x16x32_bf16 a[24:27], a[176:179], a[120:123], a[24:27]
v_mfma_f32_16x16x32_bf16 a[20:23], a[168:171], a[120:123], a[20:23]
v_mfma_f32_16x16x32_bf16 a[20:23], a[172:175], a[124:127], a[20:23]
v_mfma_f32_16x16x32_bf16 a[16:19], a[164:167], a[124:127], a[16:19]
v_mfma_f32_16x16x32_bf16 a[16:19], a[160:163], a[120:123], a[16:19]
s_waitcnt lgkmcnt(0)
v_mfma_f32_16x16x32_bf16 v[32:35], a[64:67], a[128:131], v[32:35]
s_waitcnt vmcnt(22)
v_mfma_f32_16x16x32_bf16 v[32:35], a[68:71], a[132:135], v[32:35]
s_barrier
v_mfma_f32_16x16x32_bf16 v[40:43], a[68:71], a[140:143], v[40:43]
ds_read_b128 a[96:99], v9 offset:8192
v_mfma_f32_16x16x32_bf16 v[40:43], a[64:67], a[136:139], v[40:43]
s_lshl_b32 s77, s3, 11
s_lshl_b32 s74, s3, 9
s_add_u32 s74, s74, s4
v_mfma_f32_16x16x32_bf16 v[48:51], a[64:67], a[144:147], v[48:51]
s_lshl_b32 s74, s74, 8
v_mfma_f32_16x16x32_bf16 v[48:51], a[68:71], a[148:151], v[48:51]
s_mov_b32 s75, 8
s_lshl_b32 s76, s75, 19
s_add_u32 s76, s76, s74
v_mfma_f32_16x16x32_bf16 v[56:59], a[68:71], a[156:159], v[56:59]
s_lshl_b32 s79, s75, 13
s_add_u32 s79, s79, s78
ds_read_b128 a[100:103], v10 offset:8192
v_mfma_f32_16x16x32_bf16 v[56:59], a[64:67], a[152:155], v[56:59]
s_add_u32 m0, s77, 0
s_add_u32 s64, s76, 0
v_mfma_f32_16x16x32_bf16 v[60:63], a[72:75], a[152:155], v[60:63]
buffer_load_dwordx4 v7, s[20:23], s64 offen lds
v_mfma_f32_16x16x32_bf16 v[60:63], a[76:79], a[156:159], v[60:63]
ds_read_b128 a[104:107], v9 offset:10240
v_mfma_f32_16x16x32_bf16 v[52:55], a[76:79], a[148:151], v[52:55]
buffer_load_dword a252, v16, s[32:35], s52 offen
v_mfma_f32_16x16x32_bf16 v[52:55], a[72:75], a[144:147], v[52:55]
ds_read_b64_tr_b16 a[160:161], v11 offset:16384
ds_read_b64_tr_b16 a[162:163], v11 offset:16896
v_mfma_f32_16x16x32_bf16 v[44:47], a[72:75], a[136:139], v[44:47]
buffer_load_dwordx4 v8, s[20:23], s64 offen offset:1024 lds
v_mfma_f32_16x16x32_bf16 v[44:47], a[76:79], a[140:143], v[44:47]
buffer_load_dword a253, v18, s[48:51], s53 offen
v_mfma_f32_16x16x32_bf16 v[36:39], a[76:79], a[132:135], v[36:39]
v_mfma_f32_16x16x32_bf16 v[36:39], a[72:75], a[128:131], v[36:39]
ds_read_b128 a[108:111], v10 offset:10240
v_mfma_f32_16x16x32_bf16 v[64:67], a[80:83], a[128:131], v[64:67]
v_mfma_f32_16x16x32_bf16 v[64:67], a[84:87], a[132:135], v[64:67]
v_mfma_f32_16x16x32_bf16 v[72:75], a[84:87], a[140:143], v[72:75]
s_add_u32 m0, s80, 0
s_add_u32 s64, s79, 0
v_mfma_f32_16x16x32_bf16 v[72:75], a[80:83], a[136:139], v[72:75]
ds_read_b64_tr_b16 a[164:165], v11 offset:24576
ds_read_b64_tr_b16 a[166:167], v11 offset:25088
v_mfma_f32_16x16x32_bf16 v[80:83], a[80:83], a[144:147], v[80:83]
buffer_load_dwordx4 v4, s[24:27], s64 offen sc1 lds
v_mfma_f32_16x16x32_bf16 v[80:83], a[84:87], a[148:151], v[80:83]
ds_read_b128 a[112:115], v9 offset:12288
v_mfma_f32_16x16x32_bf16 v[88:91], a[84:87], a[156:159], v[88:91]
v_mfma_f32_16x16x32_bf16 v[88:91], a[80:83], a[152:155], v[88:91]
v_mfma_f32_16x16x32_bf16 v[92:95], a[88:91], a[152:155], v[92:95]
ds_read_b64_tr_b16 a[168:169], v12 offset:16384
ds_read_b64_tr_b16 a[170:171], v12 offset:16896
v_mfma_f32_16x16x32_bf16 v[92:95], a[92:95], a[156:159], v[92:95]
v_mfma_f32_16x16x32_bf16 v[84:87], a[92:95], a[148:151], v[84:87]
s_add_u32 m0, s73, 69632
s_add_u32 s64, s72, 0
v_mfma_f32_16x16x32_bf16 v[84:87], a[88:91], a[144:147], v[84:87]
v_mfma_f32_16x16x32_bf16 v[76:79], a[88:91], a[136:139], v[76:79]
buffer_load_dwordx4 v5, s[12:15], s64 offen lds
v_mfma_f32_16x16x32_bf16 v[76:79], a[92:95], a[140:143], v[76:79]
ds_read_b128 a[116:119], v10 offset:12288
v_mfma_f32_16x16x32_bf16 v[68:71], a[92:95], a[132:135], v[68:71]
v_mfma_f32_16x16x32_bf16 v[68:71], a[88:91], a[128:131], v[68:71]
s_waitcnt lgkmcnt(6)
ds_read_b64_tr_b16 a[172:173], v12 offset:24576
ds_read_b64_tr_b16 a[174:175], v12 offset:25088
v_mfma_f32_16x16x32_bf16 v[96:99], a[96:99], a[128:131], v[96:99]
v_mfma_f32_16x16x32_bf16 v[96:99], a[100:103], a[132:135], v[96:99]
v_mfma_f32_16x16x32_bf16 v[104:107], a[100:103], a[140:143], v[104:107]
ds_read_b128 a[120:123], v9 offset:14336
v_mfma_f32_16x16x32_bf16 v[104:107], a[96:99], a[136:139], v[104:107]
v_mfma_f32_16x16x32_bf16 v[112:115], a[96:99], a[144:147], v[112:115]
v_mfma_f32_16x16x32_bf16 v[112:115], a[100:103], a[148:151], v[112:115]
buffer_load_dwordx4 v6, s[12:15], s64 offen offset:1024 lds
v_mfma_f32_16x16x32_bf16 v[120:123], a[100:103], a[156:159], v[120:123]
ds_read_b64_tr_b16 a[176:177], v13 offset:16384
ds_read_b64_tr_b16 a[178:179], v13 offset:16896
v_mfma_f32_16x16x32_bf16 v[120:123], a[96:99], a[152:155], v[120:123]
v_mfma_f32_16x16x32_bf16 v[124:127], a[104:107], a[152:155], v[124:127]
v_mfma_f32_16x16x32_bf16 v[124:127], a[108:111], a[156:159], v[124:127]
ds_read_b128 a[124:127], v10 offset:14336
v_mfma_f32_16x16x32_bf16 v[116:119], a[108:111], a[148:151], v[116:119]
v_add_u32 v9, 32768, v9
v_add_u32 v10, 32768, v10
v_mfma_f32_16x16x32_bf16 v[116:119], a[104:107], a[144:147], v[116:119]
s_add_u32 m0, s73, 71680
s_add_u32 s64, s72, 18432
v_mfma_f32_16x16x32_bf16 v[108:111], a[104:107], a[136:139], v[108:111]
ds_read_b64_tr_b16 a[180:181], v13 offset:24576
ds_read_b64_tr_b16 a[182:183], v13 offset:25088
v_mfma_f32_16x16x32_bf16 v[108:111], a[108:111], a[140:143], v[108:111]
buffer_load_dwordx4 v5, s[12:15], s64 offen lds
v_mfma_f32_16x16x32_bf16 v[100:103], a[108:111], a[132:135], v[100:103]
v_mfma_f32_16x16x32_bf16 v[100:103], a[104:107], a[128:131], v[100:103]
s_waitcnt lgkmcnt(2)
ds_read_b64_tr_b16 a[184:185], v14 offset:16384
ds_read_b64_tr_b16 a[186:187], v14 offset:16896
v_mfma_f32_16x16x32_bf16 v[128:131], a[112:115], a[128:131], v[128:131]
v_mfma_f32_16x16x32_bf16 v[128:131], a[116:119], a[132:135], v[128:131]
v_mfma_f32_16x16x32_bf16 v[136:139], a[116:119], a[140:143], v[136:139]
ds_read_b64_tr_b16 a[188:189], v14 offset:24576
ds_read_b64_tr_b16 a[190:191], v14 offset:25088
v_mfma_f32_16x16x32_bf16 v[136:139], a[112:115], a[136:139], v[136:139]
v_mfma_f32_16x16x32_bf16 v[144:147], a[112:115], a[144:147], v[144:147]
v_mfma_f32_16x16x32_bf16 v[144:147], a[116:119], a[148:151], v[144:147]
buffer_load_dwordx4 v6, s[12:15], s64 offen offset:1024 lds
v_mfma_f32_16x16x32_bf16 v[152:155], a[116:119], a[156:159], v[152:155]
v_mfma_f32_16x16x32_bf16 v[152:155], a[112:115], a[152:155], v[152:155]
v_mfma_f32_16x16x32_bf16 v[156:159], a[120:123], a[152:155], v[156:159]
v_mfma_f32_16x16x32_bf16 v[156:159], a[124:127], a[156:159], v[156:159]
v_mfma_f32_16x16x32_bf16 v[148:151], a[124:127], a[148:151], v[148:151]
v_mfma_f32_16x16x32_bf16 v[148:151], a[120:123], a[144:147], v[148:151]
v_mfma_f32_16x16x32_bf16 v[140:143], a[120:123], a[136:139], v[140:143]
v_mfma_f32_16x16x32_bf16 v[140:143], a[124:127], a[140:143], v[140:143]
v_mfma_f32_16x16x32_bf16 v[132:135], a[124:127], a[132:135], v[132:135]
v_mfma_f32_16x16x32_bf16 v[132:135], a[120:123], a[128:131], v[132:135]
s_waitcnt lgkmcnt(0)
v_mfma_f32_16x16x32_bf16 v[160:163], a[160:163], a[64:67], v[160:163]
s_waitcnt vmcnt(17)
v_mfma_f32_16x16x32_bf16 v[160:163], a[164:167], a[68:71], v[160:163]
s_barrier
v_mfma_f32_16x16x32_bf16 v[164:167], a[172:175], a[68:71], v[164:167]
ds_read_b64_tr_b16 a[128:129], v11 offset:32768
ds_read_b64_tr_b16 a[130:131], v11 offset:33280
v_mfma_f32_16x16x32_bf16 v[164:167], a[168:171], a[64:67], v[164:167]
s_add_u32 m0, s77, 16384
s_add_u32 s64, s76, 128
v_mfma_f32_16x16x32_bf16 v[168:171], a[176:179], a[64:67], v[168:171]
buffer_load_dwordx4 v7, s[20:23], s64 offen lds
v_mfma_f32_16x16x32_bf16 v[168:171], a[180:183], a[68:71], v[168:171]
v_mfma_f32_16x16x32_bf16 v[172:175], a[188:191], a[68:71], v[172:175]
v_mfma_f32_16x16x32_bf16 v[172:175], a[184:187], a[64:67], v[172:175]
ds_read_b128 a[64:67], v9 offset:0
v_mfma_f32_16x16x32_bf16 v[188:191], a[184:187], a[72:75], v[188:191]
ds_read_b64_tr_b16 a[132:133], v11 offset:40960
ds_read_b64_tr_b16 a[134:135], v11 offset:41472
v_mfma_f32_16x16x32_bf16 v[188:191], a[188:191], a[76:79], v[188:191]
v_mfma_f32_16x16x32_bf16 v[184:187], a[180:183], a[76:79], v[184:187]
v_mfma_f32_16x16x32_bf16 v[184:187], a[176:179], a[72:75], v[184:187]
ds_read_b128 a[68:71], v10 offset:0
v_mfma_f32_16x16x32_bf16 v[180:183], a[168:171], a[72:75], v[180:183]
buffer_load_dwordx4 v8, s[20:23], s64 offen offset:1024 lds
v_mfma_f32_16x16x32_bf16 v[180:183], a[172:175], a[76:79], v[180:183]
v_mfma_f32_16x16x32_bf16 v[176:179], a[164:167], a[76:79], v[176:179]
v_mfma_f32_16x16x32_bf16 v[176:179], a[160:163], a[72:75], v[176:179]
ds_read_b64_tr_b16 a[136:137], v12 offset:32768
ds_read_b64_tr_b16 a[138:139], v12 offset:33280
v_mfma_f32_16x16x32_bf16 v[192:195], a[160:163], a[80:83], v[192:195]
v_mfma_f32_16x16x32_bf16 v[192:195], a[164:167], a[84:87], v[192:195]
v_mfma_f32_16x16x32_bf16 v[196:199], a[172:175], a[84:87], v[196:199]
s_add_u32 m0, s80, 16384
s_add_u32 s64, s79, 2048
ds_read_b128 a[72:75], v9 offset:2048
v_mfma_f32_16x16x32_bf16 v[196:199], a[168:171], a[80:83], v[196:199]
v_mfma_f32_16x16x32_bf16 v[200:203], a[176:179], a[80:83], v[200:203]
buffer_load_dwordx4 v4, s[24:27], s64 offen sc1 lds
v_mfma_f32_16x16x32_bf16 v[200:203], a[180:183], a[84:87], v[200:203]
s_xor_b32 s65, s70, 0
s_add_u32 s71, s68, s65
s_add_u32 s72, s69, s65
v_mfma_f32_16x16x32_bf16 v[204:207], a[188:191], a[84:87], v[204:207]
ds_read_b64_tr_b16 a[140:141], v12 offset:40960
ds_read_b64_tr_b16 a[142:143], v12 offset:41472
v_mfma_f32_16x16x32_bf16 v[204:207], a[184:187], a[80:83], v[204:207]
v_mfma_f32_16x16x32_bf16 v[220:223], a[184:187], a[88:91], v[220:223]
ds_read_b128 a[76:79], v10 offset:2048
v_mfma_f32_16x16x32_bf16 v[220:223], a[188:191], a[92:95], v[220:223]
v_mfma_f32_16x16x32_bf16 v[216:219], a[180:183], a[92:95], v[216:219]
s_add_u32 m0, s73, 0
s_add_u32 s64, s71, 0
v_mfma_f32_16x16x32_bf16 v[216:219], a[176:179], a[88:91], v[216:219]
v_mfma_f32_16x16x32_bf16 v[212:215], a[168:171], a[88:91], v[212:215]
buffer_load_dwordx4 v5, s[12:15], s64 offen lds
v_mfma_f32_16x16x32_bf16 v[212:215], a[172:175], a[92:95], v[212:215]
ds_read_b64_tr_b16 a[144:145], v13 offset:32768
ds_read_b64_tr_b16 a[146:147], v13 offset:33280
v_mfma_f32_16x16x32_bf16 v[208:211], a[164:167], a[92:95], v[208:211]
v_mfma_f32_16x16x32_bf16 v[208:211], a[160:163], a[88:91], v[208:211]
ds_read_b128 a[80:83], v9 offset:4096
v_mfma_f32_16x16x32_bf16 v[224:227], a[160:163], a[96:99], v[224:227]
v_mfma_f32_16x16x32_bf16 v[224:227], a[164:167], a[100:103], v[224:227]
v_mfma_f32_16x16x32_bf16 v[228:231], a[172:175], a[100:103], v[228:231]
ds_read_b64_tr_b16 a[148:149], v13 offset:40960
ds_read_b64_tr_b16 a[150:151], v13 offset:41472
v_mfma_f32_16x16x32_bf16 v[228:231], a[168:171], a[96:99], v[228:231]
v_mfma_f32_16x16x32_bf16 v[232:235], a[176:179], a[96:99], v[232:235]
v_mfma_f32_16x16x32_bf16 v[232:235], a[180:183], a[100:103], v[232:235]
buffer_load_dwordx4 v6, s[12:15], s64 offen offset:1024 lds
v_mfma_f32_16x16x32_bf16 v[236:239], a[188:191], a[100:103], v[236:239]
ds_read_b128 a[84:87], v10 offset:4096
v_mfma_f32_16x16x32_bf16 v[236:239], a[184:187], a[96:99], v[236:239]
v_mfma_f32_16x16x32_bf16 v[252:255], a[184:187], a[104:107], v[252:255]
v_mfma_f32_16x16x32_bf16 v[252:255], a[188:191], a[108:111], v[252:255]
ds_read_b64_tr_b16 a[152:153], v14 offset:32768
ds_read_b64_tr_b16 a[154:155], v14 offset:33280
v_mfma_f32_16x16x32_bf16 v[248:251], a[180:183], a[108:111], v[248:251]
v_mfma_f32_16x16x32_bf16 v[248:251], a[176:179], a[104:107], v[248:251]
s_add_u32 m0, s73, 2048
s_add_u32 s64, s71, 18432
v_mfma_f32_16x16x32_bf16 v[244:247], a[168:171], a[104:107], v[244:247]
ds_read_b128 a[88:91], v9 offset:6144
v_mfma_f32_16x16x32_bf16 v[244:247], a[172:175], a[108:111], v[244:247]
buffer_load_dwordx4 v5, s[12:15], s64 offen lds
v_mfma_f32_16x16x32_bf16 v[240:243], a[164:167], a[108:111], v[240:243]
v_mfma_f32_16x16x32_bf16 v[240:243], a[160:163], a[104:107], v[240:243]
ds_read_b64_tr_b16 a[156:157], v14 offset:40960
ds_read_b64_tr_b16 a[158:159], v14 offset:41472
v_mfma_f32_16x16x32_bf16 a[0:3], a[160:163], a[112:115], a[0:3]
v_mfma_f32_16x16x32_bf16 a[0:3], a[164:167], a[116:119], a[0:3]
v_mfma_f32_16x16x32_bf16 a[4:7], a[172:175], a[116:119], a[4:7]
ds_read_b128 a[92:95], v10 offset:6144
v_mfma_f32_16x16x32_bf16 a[4:7], a[168:171], a[112:115], a[4:7]
v_mfma_f32_16x16x32_bf16 a[8:11], a[176:179], a[112:115], a[8:11]
v_mfma_f32_16x16x32_bf16 a[8:11], a[180:183], a[116:119], a[8:11]
buffer_load_dwordx4 v6, s[12:15], s64 offen offset:1024 lds
v_mfma_f32_16x16x32_bf16 a[12:15], a[188:191], a[116:119], a[12:15]
v_mfma_f32_16x16x32_bf16 a[12:15], a[184:187], a[112:115], a[12:15]
v_mfma_f32_16x16x32_bf16 a[28:31], a[184:187], a[120:123], a[28:31]
v_mfma_f32_16x16x32_bf16 a[28:31], a[188:191], a[124:127], a[28:31]
v_mfma_f32_16x16x32_bf16 a[24:27], a[180:183], a[124:127], a[24:27]
v_mfma_f32_16x16x32_bf16 a[24:27], a[176:179], a[120:123], a[24:27]
v_mfma_f32_16x16x32_bf16 a[20:23], a[168:171], a[120:123], a[20:23]
v_mfma_f32_16x16x32_bf16 a[20:23], a[172:175], a[124:127], a[20:23]
v_mfma_f32_16x16x32_bf16 a[16:19], a[164:167], a[124:127], a[16:19]
v_mfma_f32_16x16x32_bf16 a[16:19], a[160:163], a[120:123], a[16:19]
s_waitcnt lgkmcnt(0)
v_mfma_f32_16x16x32_bf16 v[32:35], a[64:67], a[128:131], v[32:35]
s_waitcnt vmcnt(20)
v_mfma_f32_16x16x32_bf16 v[32:35], a[68:71], a[132:135], v[32:35]
s_barrier
v_mfma_f32_16x16x32_bf16 v[40:43], a[68:71], a[140:143], v[40:43]
L_PAD3:
s_cbranch_execz L_PAD7
ds_read_b128 a[96:99], v9 offset:8192
v_mfma_f32_16x16x32_bf16 v[40:43], a[64:67], a[136:139], v[40:43]
s_xor_b32 s75, s93, 0
s_lshl_b32 s76, s75, 19
s_add_u32 s76, s76, s74
v_mfma_f32_16x16x32_bf16 v[48:51], a[64:67], a[144:147], v[48:51]
s_lshl_b32 s79, s75, 13
s_add_u32 s79, s79, s78
v_mfma_f32_16x16x32_bf16 v[48:51], a[68:71], a[148:151], v[48:51]
s_add_u32 m0, s77, 32768
s_add_u32 s64, s76, 0
ds_read_b128 a[100:103], v10 offset:8192
v_mfma_f32_16x16x32_bf16 v[56:59], a[68:71], a[156:159], v[56:59]
buffer_load_dwordx4 v7, s[20:23], s64 offen lds
v_mfma_f32_16x16x32_bf16 v[56:59], a[64:67], a[152:155], v[56:59]
v_mfma_f32_16x16x32_bf16 v[60:63], a[72:75], a[152:155], v[60:63]
ds_read_b128 a[104:107], v9 offset:10240
v_mfma_f32_16x16x32_bf16 v[60:63], a[76:79], a[156:159], v[60:63]
v_mfma_f32_16x16x32_bf16 v[52:55], a[76:79], a[148:151], v[52:55]
v_mfma_f32_16x16x32_bf16 v[52:55], a[72:75], a[144:147], v[52:55]
ds_read_b64_tr_b16 a[160:161], v11 offset:49152
ds_read_b64_tr_b16 a[162:163], v11 offset:49664
v_mfma_f32_16x16x32_bf16 v[44:47], a[72:75], a[136:139], v[44:47]
buffer_load_dwordx4 v8, s[20:23], s64 offen offset:1024 lds
v_mfma_f32_16x16x32_bf16 v[44:47], a[76:79], a[140:143], v[44:47]
v_mfma_f32_16x16x32_bf16 v[36:39], a[76:79], a[132:135], v[36:39]
v_mfma_f32_16x16x32_bf16 v[36:39], a[72:75], a[128:131], v[36:39]
ds_read_b128 a[108:111], v10 offset:10240
v_mfma_f32_16x16x32_bf16 v[64:67], a[80:83], a[128:131], v[64:67]
v_mfma_f32_16x16x32_bf16 v[64:67], a[84:87], a[132:135], v[64:67]
v_mfma_f32_16x16x32_bf16 v[72:75], a[84:87], a[140:143], v[72:75]
s_add_u32 m0, s80, 32768
s_add_u32 s64, s79, 0
v_mfma_f32_16x16x32_bf16 v[72:75], a[80:83], a[136:139], v[72:75]
ds_read_b64_tr_b16 a[164:165], v11 offset:57344
ds_read_b64_tr_b16 a[166:167], v11 offset:57856
v_mfma_f32_16x16x32_bf16 v[80:83], a[80:83], a[144:147], v[80:83]
buffer_load_dwordx4 v4, s[24:27], s64 offen sc1 lds
v_mfma_f32_16x16x32_bf16 v[80:83], a[84:87], a[148:151], v[80:83]
ds_read_b128 a[112:115], v9 offset:12288
v_mfma_f32_16x16x32_bf16 v[88:91], a[84:87], a[156:159], v[88:91]
v_cvt_pk_bf16_f32 v32, v32, v33
v_cvt_pk_bf16_f32 v33, v34, v35
v_mfma_f32_16x16x32_bf16 v[88:91], a[80:83], a[152:155], v[88:91]
v_cvt_pk_bf16_f32 v34, v36, v37
v_cvt_pk_bf16_f32 v35, v38, v39
v_mfma_f32_16x16x32_bf16 v[92:95], a[88:91], a[152:155], v[92:95]
ds_read_b64_tr_b16 a[168:169], v12 offset:49152
ds_read_b64_tr_b16 a[170:171], v12 offset:49664
v_mfma_f32_16x16x32_bf16 v[92:95], a[92:95], a[156:159], v[92:95]
v_cvt_pk_bf16_f32 v40, v40, v41
v_cvt_pk_bf16_f32 v41, v42, v43
v_mfma_f32_16x16x32_bf16 v[84:87], a[92:95], a[148:151], v[84:87]
s_add_u32 m0, s73, 4096
s_add_u32 s64, s72, 0
s_lshr_b32 s55, s3, 1
v_mfma_f32_16x16x32_bf16 v[84:87], a[88:91], a[144:147], v[84:87]
s_lshl_b32 s55, s55, 14
s_lshl_b32 s54, s3, 13
s_sub_u32 s55, s54, s55
v_mfma_f32_16x16x32_bf16 v[76:79], a[88:91], a[136:139], v[76:79]
buffer_load_dwordx4 v5, s[12:15], s64 offen lds
v_mfma_f32_16x16x32_bf16 v[76:79], a[92:95], a[140:143], v[76:79]
s_and_b32 s54, s3, 1
s_lshl_b32 s54, s54, 12
ds_read_b128 a[116:119], v10 offset:12288
v_mfma_f32_16x16x32_bf16 v[68:71], a[92:95], a[132:135], v[68:71]
s_add_u32 s53, s88, 0
v_cvt_pk_bf16_f32 v42, v44, v45
v_cvt_pk_bf16_f32 v43, v46, v47
v_mfma_f32_16x16x32_bf16 v[68:71], a[88:91], a[128:131], v[68:71]
s_waitcnt lgkmcnt(6)
ds_read_b64_tr_b16 a[172:173], v12 offset:57344
ds_read_b64_tr_b16 a[174:175], v12 offset:57856
v_mfma_f32_16x16x32_bf16 v[96:99], a[96:99], a[128:131], v[96:99]
buffer_store_dwordx4 v[32:35], v4, s[24:27], s53 offen offset:0 sc1
v_mfma_f32_16x16x32_bf16 v[96:99], a[100:103], a[132:135], v[96:99]
v_cvt_pk_bf16_f32 v48, v48, v49
v_cvt_pk_bf16_f32 v49, v50, v51
v_mfma_f32_16x16x32_bf16 v[104:107], a[100:103], a[140:143], v[104:107]
ds_read_b128 a[120:123], v9 offset:14336
v_cvt_pk_bf16_f32 v50, v52, v53
v_mfma_f32_16x16x32_bf16 v[104:107], a[96:99], a[136:139], v[104:107]
v_cvt_pk_bf16_f32 v51, v54, v55
v_cvt_pk_bf16_f32 v56, v56, v57
v_mfma_f32_16x16x32_bf16 v[112:115], a[96:99], a[144:147], v[112:115]
v_cvt_pk_bf16_f32 v57, v58, v59
v_cvt_pk_bf16_f32 v58, v60, v61
v_mfma_f32_16x16x32_bf16 v[112:115], a[100:103], a[148:151], v[112:115]
buffer_load_dwordx4 v6, s[12:15], s64 offen offset:1024 lds
v_mfma_f32_16x16x32_bf16 v[120:123], a[100:103], a[156:159], v[120:123]
ds_read_b64_tr_b16 a[176:177], v13 offset:49152
ds_read_b64_tr_b16 a[178:179], v13 offset:49664
v_mfma_f32_16x16x32_bf16 v[120:123], a[96:99], a[152:155], v[120:123]
v_cvt_pk_bf16_f32 v59, v62, v63
v_cvt_pk_bf16_f32 v64, v64, v65
v_mfma_f32_16x16x32_bf16 v[124:127], a[104:107], a[152:155], v[124:127]
v_cvt_pk_bf16_f32 v65, v66, v67
v_cvt_pk_bf16_f32 v66, v68, v69
v_mfma_f32_16x16x32_bf16 v[124:127], a[108:111], a[156:159], v[124:127]
ds_read_b128 a[124:127], v10 offset:14336
v_cvt_pk_bf16_f32 v67, v70, v71
v_mfma_f32_16x16x32_bf16 v[116:119], a[108:111], a[148:151], v[116:119]
v_add_u32 v9, 32768, v9
v_add_u32 v10, 32768, v10
v_mfma_f32_16x16x32_bf16 v[116:119], a[104:107], a[144:147], v[116:119]
s_add_u32 m0, s73, 6144
s_add_u32 s64, s72, 18432
v_cvt_pk_bf16_f32 v72, v72, v73
v_mfma_f32_16x16x32_bf16 v[108:111], a[104:107], a[136:139], v[108:111]
ds_read_b64_tr_b16 a[180:181], v13 offset:57344
ds_read_b64_tr_b16 a[182:183], v13 offset:57856
v_mfma_f32_16x16x32_bf16 v[108:111], a[108:111], a[140:143], v[108:111]
buffer_load_dwordx4 v5, s[12:15], s64 offen lds
v_mfma_f32_16x16x32_bf16 v[100:103], a[108:111], a[132:135], v[100:103]
v_cvt_pk_bf16_f32 v73, v74, v75
v_cvt_pk_bf16_f32 v74, v76, v77
v_mfma_f32_16x16x32_bf16 v[100:103], a[104:107], a[128:131], v[100:103]
s_waitcnt lgkmcnt(2)
ds_read_b64_tr_b16 a[184:185], v14 offset:49152
ds_read_b64_tr_b16 a[186:187], v14 offset:49664
v_mfma_f32_16x16x32_bf16 v[128:131], a[112:115], a[128:131], v[128:131]
v_cvt_pk_bf16_f32 v75, v78, v79
v_cvt_pk_bf16_f32 v80, v80, v81
v_mfma_f32_16x16x32_bf16 v[128:131], a[116:119], a[132:135], v[128:131]
v_cvt_pk_bf16_f32 v81, v82, v83
v_cvt_pk_bf16_f32 v82, v84, v85
v_mfma_f32_16x16x32_bf16 v[136:139], a[116:119], a[140:143], v[136:139]
ds_read_b64_tr_b16 a[188:189], v14 offset:57344
ds_read_b64_tr_b16 a[190:191], v14 offset:57856
v_mfma_f32_16x16x32_bf16 v[136:139], a[112:115], a[136:139], v[136:139]
v_add_u32 v9, s55, v9
v_add_u32 v10, s55, v10
v_mfma_f32_16x16x32_bf16 v[144:147], a[112:115], a[144:147], v[144:147]
v_subrev_u32 v11, s54, v11
v_subrev_u32 v12, s54, v12
v_mfma_f32_16x16x32_bf16 v[144:147], a[116:119], a[148:151], v[144:147]
buffer_load_dwordx4 v6, s[12:15], s64 offen offset:1024 lds
v_mfma_f32_16x16x32_bf16 v[152:155], a[116:119], a[156:159], v[152:155]
v_subrev_u32 v13, s54, v13
v_subrev_u32 v14, s54, v14
v_mfma_f32_16x16x32_bf16 v[152:155], a[112:115], a[152:155], v[152:155]
v_cvt_pk_bf16_f32 v83, v86, v87
v_cvt_pk_bf16_f32 v88, v88, v89
v_mfma_f32_16x16x32_bf16 v[156:159], a[120:123], a[152:155], v[156:159]
v_cvt_pk_bf16_f32 v89, v90, v91
v_cvt_pk_bf16_f32 v90, v92, v93
v_mfma_f32_16x16x32_bf16 v[156:159], a[124:127], a[156:159], v[156:159]
s_add_u32 s53, s88, 0
v_cvt_pk_bf16_f32 v91, v94, v95
v_cvt_pk_bf16_f32 v96, v96, v97
v_mfma_f32_16x16x32_bf16 v[148:151], a[124:127], a[148:151], v[148:151]
buffer_store_dwordx4 v[40:43], v4, s[24:27], s53 offen offset:1024 sc1
v_mfma_f32_16x16x32_bf16 v[148:151], a[120:123], a[144:147], v[148:151]
v_cvt_pk_bf16_f32 v97, v98, v99
v_cvt_pk_bf16_f32 v98, v100, v101
v_mfma_f32_16x16x32_bf16 v[140:143], a[120:123], a[136:139], v[140:143]
v_cvt_pk_bf16_f32 v99, v102, v103
v_cvt_pk_bf16_f32 v104, v104, v105
v_mfma_f32_16x16x32_bf16 v[140:143], a[124:127], a[140:143], v[140:143]
v_cvt_pk_bf16_f32 v105, v106, v107
v_cvt_pk_bf16_f32 v106, v108, v109
v_mfma_f32_16x16x32_bf16 v[132:135], a[124:127], a[132:135], v[132:135]
v_cvt_pk_bf16_f32 v107, v110, v111
v_cvt_pk_bf16_f32 v112, v112, v113
v_mfma_f32_16x16x32_bf16 v[132:135], a[120:123], a[128:131], v[132:135]
s_waitcnt lgkmcnt(0)
v_cvt_pk_bf16_f32 v113, v114, v115
v_cvt_pk_bf16_f32 v114, v116, v117
v_mfma_f32_16x16x32_bf16 v[160:163], a[160:163], a[64:67], v[160:163]
s_waitcnt vmcnt(16)
v_cvt_pk_bf16_f32 v115, v118, v119
v_cvt_pk_bf16_f32 v120, v120, v121
v_mfma_f32_16x16x32_bf16 v[160:163], a[164:167], a[68:71], v[160:163]
s_barrier
v_mfma_f32_16x16x32_bf16 v[164:167], a[172:175], a[68:71], v[164:167]
ds_read_b64_tr_b16 a[128:129], v11 offset:0
ds_read_b64_tr_b16 a[130:131], v11 offset:512
v_mfma_f32_16x16x32_bf16 v[164:167], a[168:171], a[64:67], v[164:167]
s_add_u32 m0, s77, 49152
s_add_u32 s64, s76, 128
v_cvt_pk_bf16_f32 v121, v122, v123
v_mfma_f32_16x16x32_bf16 v[168:171], a[176:179], a[64:67], v[168:171]
buffer_load_dwordx4 v7, s[20:23], s64 offen lds
v_mfma_f32_16x16x32_bf16 v[168:171], a[180:183], a[68:71], v[168:171]
ds_read_b64_tr_b16 a[132:133], v11 offset:4096
ds_read_b64_tr_b16 a[134:135], v11 offset:4608
v_mfma_f32_16x16x32_bf16 v[172:175], a[188:191], a[68:71], v[172:175]
v_cvt_pk_bf16_f32 v122, v124, v125
v_cvt_pk_bf16_f32 v123, v126, v127
v_mfma_f32_16x16x32_bf16 v[172:175], a[184:187], a[64:67], v[172:175]
v_cvt_pk_bf16_f32 v128, v128, v129
v_cvt_pk_bf16_f32 v129, v130, v131
v_mfma_f32_16x16x32_bf16 v[188:191], a[184:187], a[72:75], v[188:191]
ds_read_b64_tr_b16 a[136:137], v12 offset:0
ds_read_b64_tr_b16 a[138:139], v12 offset:512
v_mfma_f32_16x16x32_bf16 v[188:191], a[188:191], a[76:79], v[188:191]
v_cvt_pk_bf16_f32 v130, v132, v133
v_cvt_pk_bf16_f32 v131, v134, v135
v_mfma_f32_16x16x32_bf16 v[184:187], a[180:183], a[76:79], v[184:187]
v_cvt_pk_bf16_f32 v136, v136, v137
v_cvt_pk_bf16_f32 v137, v138, v139
v_mfma_f32_16x16x32_bf16 v[184:187], a[176:179], a[72:75], v[184:187]
ds_read_b64_tr_b16 a[140:141], v12 offset:4096
ds_read_b64_tr_b16 a[142:143], v12 offset:4608
v_mfma_f32_16x16x32_bf16 v[180:183], a[168:171], a[72:75], v[180:183]
buffer_load_dwordx4 v8, s[20:23], s64 offen offset:1024 lds
v_mfma_f32_16x16x32_bf16 v[180:183], a[172:175], a[76:79], v[180:183]
v_cvt_pk_bf16_f32 v138, v140, v141
v_cvt_pk_bf16_f32 v139, v142, v143
v_mfma_f32_16x16x32_bf16 v[176:179], a[164:167], a[76:79], v[176:179]
v_cvt_pk_bf16_f32 v144, v144, v145
v_cvt_pk_bf16_f32 v145, v146, v147
v_mfma_f32_16x16x32_bf16 v[176:179], a[160:163], a[72:75], v[176:179]
ds_read_b64_tr_b16 a[144:145], v13 offset:0
ds_read_b64_tr_b16 a[146:147], v13 offset:512
v_mfma_f32_16x16x32_bf16 v[192:195], a[160:163], a[80:83], v[192:195]
v_cvt_pk_bf16_f32 v146, v148, v149
v_cvt_pk_bf16_f32 v147, v150, v151
v_mfma_f32_16x16x32_bf16 v[192:195], a[164:167], a[84:87], v[192:195]
v_cvt_pk_bf16_f32 v152, v152, v153
v_cvt_pk_bf16_f32 v153, v154, v155
v_mfma_f32_16x16x32_bf16 v[196:199], a[172:175], a[84:87], v[196:199]
s_add_u32 m0, s80, 49152
s_add_u32 s64, s79, 2048
v_cvt_pk_bf16_f32 v154, v156, v157
v_mfma_f32_16x16x32_bf16 v[196:199], a[168:171], a[80:83], v[196:199]
ds_read_b64_tr_b16 a[148:149], v13 offset:4096
ds_read_b64_tr_b16 a[150:151], v13 offset:4608
v_mfma_f32_16x16x32_bf16 v[200:203], a[176:179], a[80:83], v[200:203]
buffer_load_dwordx4 v4, s[24:27], s64 offen sc1 lds
v_mfma_f32_16x16x32_bf16 v[200:203], a[180:183], a[84:87], v[200:203]
s_xor_b32 s65, s70, 128
s_add_u32 s71, s68, s65
s_add_u32 s72, s69, s65
v_mfma_f32_16x16x32_bf16 v[204:207], a[188:191], a[84:87], v[204:207]
s_add_u32 s53, s88, 0
ds_read_b64_tr_b16 a[152:153], v14 offset:0
ds_read_b64_tr_b16 a[154:155], v14 offset:512
v_mfma_f32_16x16x32_bf16 v[204:207], a[184:187], a[80:83], v[204:207]
buffer_store_dwordx4 v[48:51], v4, s[24:27], s53 offen offset:2048 sc1
v_mfma_f32_16x16x32_bf16 v[220:223], a[184:187], a[88:91], v[220:223]
ds_read_b64_tr_b16 a[156:157], v14 offset:4096
ds_read_b64_tr_b16 a[158:159], v14 offset:4608
v_mfma_f32_16x16x32_bf16 v[220:223], a[188:191], a[92:95], v[220:223]
v_cvt_pk_bf16_f32 v155, v158, v159
v_mul_f32 v160, s91, v160
v_mfma_f32_16x16x32_bf16 v[216:219], a[180:183], a[92:95], v[216:219]
s_add_u32 m0, s73, 32768
s_add_u32 s64, s71, 0
v_mul_f32 v161, s91, v161
v_mfma_f32_16x16x32_bf16 v[216:219], a[176:179], a[88:91], v[216:219]
v_mul_f32 v162, s91, v162
v_mul_f32 v163, s91, v163
v_mfma_f32_16x16x32_bf16 v[212:215], a[168:171], a[88:91], v[212:215]
buffer_load_dwordx4 v5, s[12:15], s64 offen lds
v_mfma_f32_16x16x32_bf16 v[212:215], a[172:175], a[92:95], v[212:215]
ds_read_b128 a[68:71], v4 offset:10240
v_mul_f32 v164, s91, v164
v_mfma_f32_16x16x32_bf16 v[208:211], a[164:167], a[92:95], v[208:211]
v_mul_f32 v165, s91, v165
v_mul_f32 v166, s91, v166
v_mfma_f32_16x16x32_bf16 v[208:211], a[160:163], a[88:91], v[208:211]
ds_read_b128 a[64:67], v4 offset:8192
v_mul_f32 v167, s91, v167
v_mfma_f32_16x16x32_bf16 v[224:227], a[160:163], a[96:99], v[224:227]
v_cvt_pk_bf16_f32 v160, v160, v161
v_cvt_pk_bf16_f32 v161, v162, v163
v_mfma_f32_16x16x32_bf16 v[224:227], a[164:167], a[100:103], v[224:227]
v_cvt_pk_bf16_f32 v162, v164, v165
v_cvt_pk_bf16_f32 v163, v166, v167
v_mfma_f32_16x16x32_bf16 v[228:231], a[172:175], a[100:103], v[228:231]
ds_read_b128 a[76:79], v4 offset:11264
v_mul_f32 v168, s91, v168
v_mfma_f32_16x16x32_bf16 v[228:231], a[168:171], a[96:99], v[228:231]
v_mul_f32 v169, s91, v169
v_mul_f32 v170, s91, v170
v_mfma_f32_16x16x32_bf16 v[232:235], a[176:179], a[96:99], v[232:235]
v_mul_f32 v171, s91, v171
v_mul_f32 v172, s91, v172
v_mfma_f32_16x16x32_bf16 v[232:235], a[180:183], a[100:103], v[232:235]
buffer_load_dwordx4 v6, s[12:15], s64 offen offset:1024 lds
v_mfma_f32_16x16x32_bf16 v[236:239], a[188:191], a[100:103], v[236:239]
ds_read_b128 a[72:75], v4 offset:9216
v_mul_f32 v173, s91, v173
v_mfma_f32_16x16x32_bf16 v[236:239], a[184:187], a[96:99], v[236:239]
v_mul_f32 v174, s91, v174
v_mul_f32 v175, s91, v175
v_mfma_f32_16x16x32_bf16 v[252:255], a[184:187], a[104:107], v[252:255]
v_cvt_pk_bf16_f32 v168, v168, v169
v_cvt_pk_bf16_f32 v169, v170, v171
v_mfma_f32_16x16x32_bf16 v[252:255], a[188:191], a[108:111], v[252:255]
ds_read_b128 a[84:87], v10 offset:0
v_cvt_pk_bf16_f32 v170, v172, v173
v_mfma_f32_16x16x32_bf16 v[248:251], a[180:183], a[108:111], v[248:251]
v_cvt_pk_bf16_f32 v171, v174, v175
v_mul_f32 v176, s91, v176
v_mfma_f32_16x16x32_bf16 v[248:251], a[176:179], a[104:107], v[248:251]
s_add_u32 m0, s73, 34816
s_add_u32 s64, s71, 18432
v_mul_f32 v177, s91, v177
v_mfma_f32_16x16x32_bf16 v[244:247], a[168:171], a[104:107], v[244:247]
ds_read_b128 a[80:83], v9 offset:0
v_mul_f32 v178, s91, v178
v_mfma_f32_16x16x32_bf16 v[244:247], a[172:175], a[108:111], v[244:247]
buffer_load_dwordx4 v5, s[12:15], s64 offen lds
v_mfma_f32_16x16x32_bf16 v[240:243], a[164:167], a[108:111], v[240:243]
v_mul_f32 v179, s91, v179
v_mul_f32 v180, s91, v180
v_mfma_f32_16x16x32_bf16 v[240:243], a[160:163], a[104:107], v[240:243]
s_add_u32 s53, s88, 0
ds_read_b128 a[92:95], v10 offset:2048
v_mul_f32 v181, s91, v181
v_mfma_f32_16x16x32_bf16 a[0:3], a[160:163], a[112:115], a[0:3]
buffer_store_dwordx4 v[56:59], v4, s[24:27], s53 offen offset:3072 sc1
v_mfma_f32_16x16x32_bf16 a[0:3], a[164:167], a[116:119], a[0:3]
v_mul_f32 v182, s91, v182
v_mul_f32 v183, s91, v183
v_mfma_f32_16x16x32_bf16 a[4:7], a[172:175], a[116:119], a[4:7]
ds_read_b128 a[88:91], v9 offset:2048
v_cvt_pk_bf16_f32 v176, v176, v177
v_mfma_f32_16x16x32_bf16 a[4:7], a[168:171], a[112:115], a[4:7]
v_cvt_pk_bf16_f32 v177, v178, v179
v_cvt_pk_bf16_f32 v178, v180, v181
v_mfma_f32_16x16x32_bf16 a[8:11], a[176:179], a[112:115], a[8:11]
v_cvt_pk_bf16_f32 v179, v182, v183
v_mul_f32 v184, s91, v184
v_mfma_f32_16x16x32_bf16 a[8:11], a[180:183], a[116:119], a[8:11]
buffer_load_dwordx4 v6, s[12:15], s64 offen offset:1024 lds
v_mfma_f32_16x16x32_bf16 a[12:15], a[188:191], a[116:119], a[12:15]
v_mul_f32 v185, s91, v185
v_mul_f32 v186, s91, v186
v_mfma_f32_16x16x32_bf16 a[12:15], a[184:187], a[112:115], a[12:15]
v_mul_f32 v187, s91, v187
v_mul_f32 v188, s91, v188
v_mfma_f32_16x16x32_bf16 a[28:31], a[184:187], a[120:123], a[28:31]
v_mul_f32 v189, s91, v189
v_mul_f32 v190, s91, v190
v_mfma_f32_16x16x32_bf16 a[28:31], a[188:191], a[124:127], a[28:31]
v_mul_f32 v191, s91, v191
v_cvt_pk_bf16_f32 v184, v184, v185
v_mfma_f32_16x16x32_bf16 a[24:27], a[180:183], a[124:127], a[24:27]
v_cvt_pk_bf16_f32 v185, v186, v187
v_cvt_pk_bf16_f32 v186, v188, v189
v_mfma_f32_16x16x32_bf16 a[24:27], a[176:179], a[120:123], a[24:27]
v_cvt_pk_bf16_f32 v187, v190, v191
v_mul_f32 v192, s91, v192
v_mfma_f32_16x16x32_bf16 a[20:23], a[168:171], a[120:123], a[20:23]
v_mul_f32 v193, s91, v193
v_mul_f32 v194, s91, v194
v_mfma_f32_16x16x32_bf16 a[20:23], a[172:175], a[124:127], a[20:23]
v_mul_f32 v195, s91, v195
v_mul_f32 v196, s91, v196
v_mfma_f32_16x16x32_bf16 a[16:19], a[164:167], a[124:127], a[16:19]
v_mul_f32 v197, s91, v197
v_mul_f32 v198, s91, v198
v_mfma_f32_16x16x32_bf16 a[16:19], a[160:163], a[120:123], a[16:19]
s_waitcnt lgkmcnt(0)
v_mul_f32 v199, s91, v199
v_cvt_pk_bf16_f32 v192, v192, v193
v_mfma_f32_16x16x32_bf16 v[36:39], a[128:131], a[80:83], 0
s_waitcnt vmcnt(22)
v_cvt_pk_bf16_f32 v193, v194, v195
v_cvt_pk_bf16_f32 v194, v196, v197
v_mfma_f32_16x16x32_bf16 v[36:39], a[132:135], a[84:87], v[36:39]
s_barrier
v_mfma_f32_16x16x32_bf16 v[44:47], a[140:143], a[84:87], 0
ds_read_b128 a[96:99], v9 offset:4096
v_cvt_pk_bf16_f32 v195, v198, v199
v_mfma_f32_16x16x32_bf16 v[44:47], a[136:139], a[80:83], v[44:47]
s_xor_b32 s75, s93, 1
s_lshl_b32 s76, s75, 19
s_add_u32 s76, s76, s74
v_mfma_f32_16x16x32_bf16 v[32:35], a[144:147], a[80:83], 0
s_lshl_b32 s79, s75, 13
s_add_u32 s79, s79, s78
ds_read_b128 a[100:103], v10 offset:4096
v_mfma_f32_16x16x32_bf16 v[32:35], a[148:151], a[84:87], v[32:35]
s_add_u32 m0, s77, 0
s_add_u32 s64, s76, 0
ds_read_b128 a[104:107], v9 offset:6144
v_mfma_f32_16x16x32_bf16 v[52:55], a[156:159], a[84:87], 0
buffer_load_dwordx4 v7, s[20:23], s64 offen lds
v_mfma_f32_16x16x32_bf16 v[52:55], a[152:155], a[80:83], v[52:55]
ds_read_b64_tr_b16 a[160:161], v11 offset:16384
ds_read_b64_tr_b16 a[162:163], v11 offset:16896
v_mfma_f32_16x16x32_bf16 v[60:63], a[64:67], a[80:83], 0
v_mul_f32 v200, s91, v200
v_mul_f32 v201, s91, v201
v_mfma_f32_16x16x32_bf16 v[60:63], a[68:71], a[84:87], v[60:63]
ds_read_b128 a[108:111], v10 offset:6144
v_mul_f32 v202, s91, v202
v_mfma_f32_16x16x32_bf16 v[68:71], a[76:79], a[84:87], 0
buffer_load_dwordx4 v8, s[20:23], s64 offen offset:1024 lds
v_mfma_f32_16x16x32_bf16 v[68:71], a[72:75], a[80:83], v[68:71]
s_add_u32 s53, s88, 262144
ds_read_b64_tr_b16 a[164:165], v11 offset:20480
ds_read_b64_tr_b16 a[166:167], v11 offset:20992
v_mfma_f32_16x16x32_bf16 v[76:79], a[72:75], a[88:91], 0
v_add_u32 v9, -65536, v9
v_add_u32 v10, -65536, v10
v_mfma_f32_16x16x32_bf16 v[76:79], a[76:79], a[92:95], v[76:79]
ds_read_b64_tr_b16 a[168:169], v12 offset:16384
ds_read_b64_tr_b16 a[170:171], v12 offset:16896
v_mfma_f32_16x16x32_bf16 v[84:87], a[68:71], a[92:95], 0
s_add_u32 m0, s80, 0
s_add_u32 s64, s79, 0
v_mul_f32 v203, s91, v203
v_mfma_f32_16x16x32_bf16 v[84:87], a[64:67], a[88:91], v[84:87]
ds_read_b64_tr_b16 a[172:173], v12 offset:20480
ds_read_b64_tr_b16 a[174:175], v12 offset:20992
v_mfma_f32_16x16x32_bf16 v[92:95], a[152:155], a[88:91], 0
buffer_load_dwordx4 v4, s[24:27], s64 offen sc1 lds
v_mfma_f32_16x16x32_bf16 v[92:95], a[156:159], a[92:95], v[92:95]
buffer_store_dwordx4 v[64:67], v4, s[24:27], s53 offen offset:0 sc1
v_mfma_f32_16x16x32_bf16 v[40:43], a[148:151], a[92:95], 0
ds_read_b64_tr_b16 a[176:177], v13 offset:16384
ds_read_b64_tr_b16 a[178:179], v13 offset:16896
v_mfma_f32_16x16x32_bf16 v[40:43], a[144:147], a[88:91], v[40:43]
v_mul_f32 v204, s91, v204
v_mul_f32 v205, s91, v205
v_mfma_f32_16x16x32_bf16 v[100:103], a[136:139], a[88:91], 0
s_add_u32 m0, s73, 36864
s_add_u32 s64, s72, 0
v_mul_f32 v206, s91, v206
v_mfma_f32_16x16x32_bf16 v[100:103], a[140:143], a[92:95], v[100:103]
ds_read_b64_tr_b16 a[180:181], v13 offset:20480
ds_read_b64_tr_b16 a[182:183], v13 offset:20992
v_mfma_f32_16x16x32_bf16 v[108:111], a[132:135], a[92:95], 0
buffer_load_dwordx4 v5, s[12:15], s64 offen lds
v_mfma_f32_16x16x32_bf16 v[108:111], a[128:131], a[88:91], v[108:111]
s_waitcnt lgkmcnt(14)
ds_read_b64_tr_b16 a[184:185], v14 offset:16384
ds_read_b64_tr_b16 a[186:187], v14 offset:16896
v_mfma_f32_16x16x32_bf16 v[116:119], a[128:131], a[96:99], 0
ds_read_b64_tr_b16 a[188:189], v14 offset:20480
ds_read_b64_tr_b16 a[190:191], v14 offset:20992
v_mfma_f32_16x16x32_bf16 v[116:119], a[132:135], a[100:103], v[116:119]
v_mul_f32 v207, s91, v207
v_cvt_pk_bf16_f32 v200, v200, v201
v_mfma_f32_16x16x32_bf16 v[124:127], a[140:143], a[100:103], 0
v_cvt_pk_bf16_f32 v201, v202, v203
v_cvt_pk_bf16_f32 v202, v204, v205
v_mfma_f32_16x16x32_bf16 v[124:127], a[136:139], a[96:99], v[124:127]
ds_read_b128 a[112:115], v4 offset:24576
v_cvt_pk_bf16_f32 v203, v206, v207
v_mfma_f32_16x16x32_bf16 v[132:135], a[144:147], a[96:99], 0
buffer_load_dwordx4 v6, s[12:15], s64 offen offset:1024 lds
v_mfma_f32_16x16x32_bf16 v[132:135], a[148:151], a[100:103], v[132:135]
ds_read_b128 a[116:119], v4 offset:26624
v_mul_f32 v208, s91, v208
v_mfma_f32_16x16x32_bf16 v[140:143], a[156:159], a[100:103], 0
v_mul_f32 v209, s91, v209
v_mul_f32 v210, s91, v210
v_mfma_f32_16x16x32_bf16 v[140:143], a[152:155], a[96:99], v[140:143]
ds_read_b128 a[120:123], v4 offset:25600
v_mul_f32 v211, s91, v211
v_mfma_f32_16x16x32_bf16 v[148:151], a[64:67], a[96:99], 0
s_add_u32 m0, s73, 38912
s_add_u32 s64, s72, 18432
v_mul_f32 v212, s91, v212
v_mfma_f32_16x16x32_bf16 v[148:151], a[68:71], a[100:103], v[148:151]
ds_read_b128 a[124:127], v4 offset:27648
v_mul_f32 v213, s91, v213
v_mfma_f32_16x16x32_bf16 v[48:51], a[76:79], a[100:103], 0
buffer_load_dwordx4 v5, s[12:15], s64 offen lds
v_mfma_f32_16x16x32_bf16 v[48:51], a[72:75], a[96:99], v[48:51]
s_waitcnt lgkmcnt(15)
v_mul_f32 v214, s91, v214
v_mul_f32 v215, s91, v215
v_mfma_f32_16x16x32_bf16 v[156:159], a[72:75], a[104:107], 0
v_cvt_pk_bf16_f32 v208, v208, v209
v_cvt_pk_bf16_f32 v209, v210, v211
v_mfma_f32_16x16x32_bf16 v[156:159], a[76:79], a[108:111], v[156:159]
s_add_u32 s53, s88, 262144
v_cvt_pk_bf16_f32 v210, v212, v213
v_cvt_pk_bf16_f32 v211, v214, v215
v_mfma_f32_16x16x32_bf16 v[164:167], a[68:71], a[108:111], 0
buffer_store_dwordx4 v[72:75], v4, s[24:27], s53 offen offset:1024 sc1
v_mfma_f32_16x16x32_bf16 v[164:167], a[64:67], a[104:107], v[164:167]
v_mul_f32 v216, s91, v216
v_mul_f32 v217, s91, v217
v_mfma_f32_16x16x32_bf16 v[172:175], a[152:155], a[104:107], 0
buffer_load_dwordx4 v6, s[12:15], s64 offen offset:1024 lds
v_mfma_f32_16x16x32_bf16 v[172:175], a[156:159], a[108:111], v[172:175]
v_mul_f32 v218, s91, v218
v_mul_f32 v219, s91, v219
v_mfma_f32_16x16x32_bf16 v[56:59], a[148:151], a[108:111], 0
v_mul_f32 v220, s91, v220
v_mul_f32 v221, s91, v221
v_mfma_f32_16x16x32_bf16 v[56:59], a[144:147], a[104:107], v[56:59]
v_mul_f32 v222, s91, v222
v_mul_f32 v223, s91, v223
v_mfma_f32_16x16x32_bf16 v[180:183], a[136:139], a[104:107], 0
v_cvt_pk_bf16_f32 v216, v216, v217
v_cvt_pk_bf16_f32 v217, v218, v219
v_mfma_f32_16x16x32_bf16 v[180:183], a[140:143], a[108:111], v[180:183]
v_cvt_pk_bf16_f32 v218, v220, v221
v_cvt_pk_bf16_f32 v219, v222, v223
v_mfma_f32_16x16x32_bf16 v[188:191], a[132:135], a[108:111], 0
v_mul_f32 v224, s91, v224
v_mul_f32 v225, s91, v225
v_mfma_f32_16x16x32_bf16 v[188:191], a[128:131], a[104:107], v[188:191]
s_waitcnt lgkmcnt(0)
v_mul_f32 v226, s91, v226
v_mul_f32 v227, s91, v227
v_mfma_f32_16x16x32_bf16 v[196:199], a[160:163], a[80:83], 0
s_waitcnt vmcnt(19)
v_mul_f32 v228, s91, v228
v_mul_f32 v229, s91, v229
v_mfma_f32_16x16x32_bf16 v[196:199], a[164:167], a[84:87], v[196:199]
s_barrier
v_mfma_f32_16x16x32_bf16 v[64:67], a[172:175], a[84:87], 0
ds_read_b64_tr_b16 a[128:129], v11 offset:32768
ds_read_b64_tr_b16 a[130:131], v11 offset:33280
v_mfma_f32_16x16x32_bf16 v[64:67], a[168:171], a[80:83], v[64:67]
s_add_u32 m0, s77, 16384
s_add_u32 s64, s76, 128
v_mul_f32 v230, s91, v230
v_mfma_f32_16x16x32_bf16 v[204:207], a[176:179], a[80:83], 0
buffer_load_dwordx4 v7, s[20:23], s64 offen lds
v_mfma_f32_16x16x32_bf16 v[204:207], a[180:183], a[84:87], v[204:207]
ds_read_b64_tr_b16 a[132:133], v11 offset:36864
ds_read_b64_tr_b16 a[134:135], v11 offset:37376
v_mfma_f32_16x16x32_bf16 v[212:215], a[188:191], a[84:87], 0
ds_read_b64_tr_b16 a[136:137], v12 offset:32768
ds_read_b64_tr_b16 a[138:139], v12 offset:33280
v_mfma_f32_16x16x32_bf16 v[212:215], a[184:187], a[80:83], v[212:215]
ds_read_b64_tr_b16 a[140:141], v12 offset:36864
ds_read_b64_tr_b16 a[142:143], v12 offset:37376
v_mfma_f32_16x16x32_bf16 v[72:75], a[112:115], a[80:83], 0
v_mul_f32 v231, s91, v231
v_cvt_pk_bf16_f32 v224, v224, v225
v_mfma_f32_16x16x32_bf16 v[72:75], a[116:119], a[84:87], v[72:75]
ds_read_b64_tr_b16 a[144:145], v13 offset:32768
ds_read_b64_tr_b16 a[146:147], v13 offset:33280
v_mfma_f32_16x16x32_bf16 v[220:223], a[124:127], a[84:87], 0
buffer_load_dwordx4 v8, s[20:23], s64 offen offset:1024 lds
v_mfma_f32_16x16x32_bf16 v[220:223], a[120:123], a[80:83], v[220:223]
ds_read_b64_tr_b16 a[148:149], v13 offset:36864
ds_read_b64_tr_b16 a[150:151], v13 offset:37376
v_mfma_f32_16x16x32_bf16 a[32:35], a[120:123], a[88:91], 0
v_cvt_pk_bf16_f32 v225, v226, v227
v_cvt_pk_bf16_f32 v226, v228, v229
v_mfma_f32_16x16x32_bf16 a[32:35], a[124:127], a[92:95], a[32:35]
ds_read_b64_tr_b16 a[152:153], v14 offset:32768
ds_read_b64_tr_b16 a[154:155], v14 offset:33280
v_mfma_f32_16x16x32_bf16 a[36:39], a[116:119], a[92:95], 0
s_add_u32 m0, s80, 16384
s_add_u32 s64, s79, 2048
v_cvt_pk_bf16_f32 v227, v230, v231
v_mfma_f32_16x16x32_bf16 a[36:39], a[112:115], a[88:91], a[36:39]
ds_read_b64_tr_b16 a[156:157], v14 offset:36864
ds_read_b64_tr_b16 a[158:159], v14 offset:37376
v_mfma_f32_16x16x32_bf16 v[228:231], a[184:187], a[88:91], 0
buffer_load_dwordx4 v4, s[24:27], s64 offen sc1 lds
v_mfma_f32_16x16x32_bf16 v[228:231], a[188:191], a[92:95], v[228:231]
s_xor_b32 s65, s70, 256
s_add_u32 s71, s68, s65
s_add_u32 s72, s69, s65
v_mfma_f32_16x16x32_bf16 a[40:43], a[180:183], a[92:95], 0
s_add_u32 s53, s88, 262144
ds_read_b128 a[64:67], v4 offset:40960
v_mul_f32 v232, s91, v232
v_mfma_f32_16x16x32_bf16 a[40:43], a[176:179], a[88:91], a[40:43]
buffer_store_dwordx4 v[80:83], v4, s[24:27], s53 offen offset:2048 sc1
v_mfma_f32_16x16x32_bf16 a[44:47], a[168:171], a[88:91], 0
s_add_u32 m0, s73, 65536
s_add_u32 s64, s71, 0
ds_read_b128 a[80:83], v9 offset:0
v_mfma_f32_16x16x32_bf16 a[44:47], a[172:175], a[92:95], a[44:47]
L_PAD4:
s_cbranch_execz L_PAD8
v_mul_f32 v233, s91, v233
v_mul_f32 v234, s91, v234
v_mfma_f32_16x16x32_bf16 v[80:83], a[164:167], a[92:95], 0
buffer_load_dwordx4 v5, s[12:15], s64 offen lds
v_mfma_f32_16x16x32_bf16 v[80:83], a[160:163], a[88:91], v[80:83]
ds_read_b128 a[68:71], v4 offset:43008
v_mul_f32 v235, s91, v235
v_mfma_f32_16x16x32_bf16 a[48:51], a[160:163], a[96:99], 0
ds_read_b128 a[84:87], v10 offset:0
v_mul_f32 v236, s91, v236
v_mfma_f32_16x16x32_bf16 a[48:51], a[164:167], a[100:103], a[48:51]
v_mul_f32 v237, s91, v237
v_mul_f32 v238, s91, v238
v_mfma_f32_16x16x32_bf16 a[52:55], a[172:175], a[100:103], 0
v_mul_f32 v239, s91, v239
v_cvt_pk_bf16_f32 v232, v232, v233
v_mfma_f32_16x16x32_bf16 a[52:55], a[168:171], a[96:99], a[52:55]
ds_read_b128 a[72:75], v4 offset:41984
v_cvt_pk_bf16_f32 v233, v234, v235
v_mfma_f32_16x16x32_bf16 a[56:59], a[176:179], a[96:99], 0
buffer_load_dwordx4 v6, s[12:15], s64 offen offset:1024 lds
v_mfma_f32_16x16x32_bf16 a[56:59], a[180:183], a[100:103], a[56:59]
ds_read_b128 a[88:91], v9 offset:2048
v_cvt_pk_bf16_f32 v234, v236, v237
v_mfma_f32_16x16x32_bf16 a[60:63], a[188:191], a[100:103], 0
v_cvt_pk_bf16_f32 v235, v238, v239
v_mul_f32 v240, s91, v240
v_mfma_f32_16x16x32_bf16 a[60:63], a[184:187], a[96:99], a[60:63]
ds_read_b128 a[76:79], v4 offset:44032
v_mul_f32 v241, s91, v241
v_mfma_f32_16x16x32_bf16 v[236:239], a[112:115], a[96:99], 0
s_add_u32 m0, s73, 67584
s_add_u32 s64, s71, 18432
v_mul_f32 v242, s91, v242
v_mfma_f32_16x16x32_bf16 v[236:239], a[116:119], a[100:103], v[236:239]
ds_read_b128 a[92:95], v10 offset:2048
v_mul_f32 v243, s91, v243
v_mfma_f32_16x16x32_bf16 a[192:195], a[124:127], a[100:103], 0
buffer_load_dwordx4 v5, s[12:15], s64 offen lds
v_mfma_f32_16x16x32_bf16 a[192:195], a[120:123], a[96:99], a[192:195]
v_mul_f32 v244, s91, v244
v_mul_f32 v245, s91, v245
v_mfma_f32_16x16x32_bf16 a[196:199], a[120:123], a[104:107], 0
v_mul_f32 v246, s91, v246
v_mul_f32 v247, s91, v247
v_mfma_f32_16x16x32_bf16 a[196:199], a[124:127], a[108:111], a[196:199]
v_cvt_pk_bf16_f32 v240, v240, v241
v_cvt_pk_bf16_f32 v241, v242, v243
v_mfma_f32_16x16x32_bf16 a[200:203], a[116:119], a[108:111], 0
v_cvt_pk_bf16_f32 v242, v244, v245
v_cvt_pk_bf16_f32 v243, v246, v247
v_mfma_f32_16x16x32_bf16 a[200:203], a[112:115], a[104:107], a[200:203]
v_mul_f32 v248, s91, v248
v_mul_f32 v249, s91, v249
v_mfma_f32_16x16x32_bf16 v[244:247], a[184:187], a[104:107], 0
buffer_load_dwordx4 v6, s[12:15], s64 offen offset:1024 lds
v_mfma_f32_16x16x32_bf16 v[244:247], a[188:191], a[108:111], v[244:247]
v_mul_f32 v250, s91, v250
v_mul_f32 v251, s91, v251
v_mfma_f32_16x16x32_bf16 a[204:207], a[180:183], a[108:111], 0
v_mul_f32 v252, s91, v252
v_mul_f32 v253, s91, v253
v_mfma_f32_16x16x32_bf16 a[204:207], a[176:179], a[104:107], a[204:207]
s_add_u32 s53, s88, 262144
v_mul_f32 v254, s91, v254
v_mul_f32 v255, s91, v255
v_mfma_f32_16x16x32_bf16 a[208:211], a[168:171], a[104:107], 0
buffer_store_dwordx4 v[88:91], v4, s[24:27], s53 offen offset:3072 sc1
v_mfma_f32_16x16x32_bf16 a[208:211], a[172:175], a[108:111], a[208:211]
v_cvt_pk_bf16_f32 v248, v248, v249
v_cvt_pk_bf16_f32 v249, v250, v251
v_mfma_f32_16x16x32_bf16 v[88:91], a[164:167], a[108:111], 0
v_cvt_pk_bf16_f32 v250, v252, v253
v_cvt_pk_bf16_f32 v251, v254, v255
v_mfma_f32_16x16x32_bf16 v[88:91], a[160:163], a[104:107], v[88:91]
s_waitcnt lgkmcnt(0)
v_accvgpr_read_b32 v16, a0
v_accvgpr_read_b32 v17, a1
v_mfma_f32_16x16x32_bf16 v[36:39], a[128:131], a[80:83], v[36:39]
s_waitcnt vmcnt(24)
v_accvgpr_read_b32 v18, a2
v_accvgpr_read_b32 v19, a3
v_mfma_f32_16x16x32_bf16 v[36:39], a[132:135], a[84:87], v[36:39]
s_barrier
v_mfma_f32_16x16x32_bf16 v[44:47], a[140:143], a[84:87], v[44:47]
ds_read_b128 a[96:99], v9 offset:4096
v_accvgpr_read_b32 v20, a4
v_mfma_f32_16x16x32_bf16 v[44:47], a[136:139], a[80:83], v[44:47]
s_xor_b32 s75, s93, 2
s_lshl_b32 s76, s75, 19
s_add_u32 s76, s76, s74
v_mfma_f32_16x16x32_bf16 v[32:35], a[144:147], a[80:83], v[32:35]
s_lshl_b32 s79, s75, 13
s_add_u32 s79, s79, s78
ds_read_b128 a[100:103], v10 offset:4096
v_mfma_f32_16x16x32_bf16 v[32:35], a[148:151], a[84:87], v[32:35]
s_add_u32 m0, s77, 32768
s_add_u32 s64, s76, 0
ds_read_b128 a[104:107], v9 offset:6144
v_mfma_f32_16x16x32_bf16 v[52:55], a[156:159], a[84:87], v[52:55]
buffer_load_dwordx4 v7, s[20:23], s64 offen lds
v_mfma_f32_16x16x32_bf16 v[52:55], a[152:155], a[80:83], v[52:55]
ds_read_b64_tr_b16 a[160:161], v11 offset:49152
ds_read_b64_tr_b16 a[162:163], v11 offset:49664
v_mfma_f32_16x16x32_bf16 v[60:63], a[64:67], a[80:83], v[60:63]
v_accvgpr_read_b32 v21, a5
v_accvgpr_read_b32 v22, a6
v_mfma_f32_16x16x32_bf16 v[60:63], a[68:71], a[84:87], v[60:63]
ds_read_b128 a[108:111], v10 offset:6144
v_accvgpr_read_b32 v23, a7
v_mfma_f32_16x16x32_bf16 v[68:71], a[76:79], a[84:87], v[68:71]
buffer_load_dwordx4 v8, s[20:23], s64 offen offset:1024 lds
v_mfma_f32_16x16x32_bf16 v[68:71], a[72:75], a[80:83], v[68:71]
ds_read_b64_tr_b16 a[164:165], v11 offset:53248
ds_read_b64_tr_b16 a[166:167], v11 offset:53760
v_mfma_f32_16x16x32_bf16 v[76:79], a[72:75], a[88:91], v[76:79]
v_add_u32 v9, 32768, v9
v_add_u32 v10, 32768, v10
v_mfma_f32_16x16x32_bf16 v[76:79], a[76:79], a[92:95], v[76:79]
ds_read_b64_tr_b16 a[168:169], v12 offset:49152
ds_read_b64_tr_b16 a[170:171], v12 offset:49664
v_mfma_f32_16x16x32_bf16 v[84:87], a[68:71], a[92:95], v[84:87]
s_add_u32 m0, s80, 32768
s_add_u32 s64, s79, 0
v_mul_f32 v16, s91, v16
v_mfma_f32_16x16x32_bf16 v[84:87], a[64:67], a[88:91], v[84:87]
ds_read_b64_tr_b16 a[172:173], v12 offset:53248
ds_read_b64_tr_b16 a[174:175], v12 offset:53760
v_mfma_f32_16x16x32_bf16 v[92:95], a[152:155], a[88:91], v[92:95]
buffer_load_dwordx4 v4, s[24:27], s64 offen sc1 lds
v_mfma_f32_16x16x32_bf16 v[92:95], a[156:159], a[92:95], v[92:95]
v_mul_f32 v17, s91, v17
v_mul_f32 v18, s91, v18
v_mfma_f32_16x16x32_bf16 v[40:43], a[148:151], a[92:95], v[40:43]
ds_read_b64_tr_b16 a[176:177], v13 offset:49152
ds_read_b64_tr_b16 a[178:179], v13 offset:49664
v_mfma_f32_16x16x32_bf16 v[40:43], a[144:147], a[88:91], v[40:43]
v_mul_f32 v19, s91, v19
v_mul_f32 v20, s91, v20
v_mfma_f32_16x16x32_bf16 v[100:103], a[136:139], a[88:91], v[100:103]
s_add_u32 m0, s73, 69632
s_add_u32 s64, s72, 0
v_mul_f32 v21, s91, v21
v_mfma_f32_16x16x32_bf16 v[100:103], a[140:143], a[92:95], v[100:103]
ds_read_b64_tr_b16 a[180:181], v13 offset:53248
ds_read_b64_tr_b16 a[182:183], v13 offset:53760
v_mfma_f32_16x16x32_bf16 v[108:111], a[132:135], a[92:95], v[108:111]
buffer_load_dwordx4 v5, s[12:15], s64 offen lds
v_mfma_f32_16x16x32_bf16 v[108:111], a[128:131], a[88:91], v[108:111]
s_waitcnt lgkmcnt(14)
ds_read_b64_tr_b16 a[184:185], v14 offset:49152
ds_read_b64_tr_b16 a[186:187], v14 offset:49664
v_mfma_f32_16x16x32_bf16 v[116:119], a[128:131], a[96:99], v[116:119]
s_add_u32 s53, s87, 0
ds_read_b64_tr_b16 a[188:189], v14 offset:53248
ds_read_b64_tr_b16 a[190:191], v14 offset:53760
v_mfma_f32_16x16x32_bf16 v[116:119], a[132:135], a[100:103], v[116:119]
buffer_store_dwordx4 v[160:163], v4, s[24:27], s53 offen offset:0 sc1
v_mfma_f32_16x16x32_bf16 v[124:127], a[140:143], a[100:103], v[124:127]
v_mul_f32 v22, s91, v22
v_mul_f32 v23, s91, v23
v_mfma_f32_16x16x32_bf16 v[124:127], a[136:139], a[96:99], v[124:127]
ds_read_b128 a[112:115], v4 offset:57344
v_cvt_pk_bf16_f32 v16, v16, v17
v_mfma_f32_16x16x32_bf16 v[132:135], a[144:147], a[96:99], v[132:135]
buffer_load_dwordx4 v6, s[12:15], s64 offen offset:1024 lds
v_mfma_f32_16x16x32_bf16 v[132:135], a[148:151], a[100:103], v[132:135]
ds_read_b128 a[116:119], v4 offset:59392
v_cvt_pk_bf16_f32 v17, v18, v19
v_mfma_f32_16x16x32_bf16 v[140:143], a[156:159], a[100:103], v[140:143]
v_cvt_pk_bf16_f32 v18, v20, v21
v_cvt_pk_bf16_f32 v19, v22, v23
v_mfma_f32_16x16x32_bf16 v[140:143], a[152:155], a[96:99], v[140:143]
ds_read_b128 a[120:123], v4 offset:58368
v_accvgpr_write_b32 a0, v16
v_mfma_f32_16x16x32_bf16 v[148:151], a[64:67], a[96:99], v[148:151]
s_add_u32 m0, s73, 71680
s_add_u32 s64, s72, 18432
v_accvgpr_write_b32 a1, v17
v_mfma_f32_16x16x32_bf16 v[148:151], a[68:71], a[100:103], v[148:151]
ds_read_b128 a[124:127], v4 offset:60416
v_accvgpr_write_b32 a2, v18
v_mfma_f32_16x16x32_bf16 v[48:51], a[76:79], a[100:103], v[48:51]
buffer_load_dwordx4 v5, s[12:15], s64 offen lds
v_mfma_f32_16x16x32_bf16 v[48:51], a[72:75], a[96:99], v[48:51]
s_waitcnt lgkmcnt(15)
v_accvgpr_write_b32 a3, v19
v_accvgpr_read_b32 v16, a8
v_mfma_f32_16x16x32_bf16 v[156:159], a[72:75], a[104:107], v[156:159]
v_accvgpr_read_b32 v17, a9
v_accvgpr_read_b32 v18, a10
v_mfma_f32_16x16x32_bf16 v[156:159], a[76:79], a[108:111], v[156:159]
v_accvgpr_read_b32 v19, a11
v_accvgpr_read_b32 v20, a12
v_mfma_f32_16x16x32_bf16 v[164:167], a[68:71], a[108:111], v[164:167]
v_accvgpr_read_b32 v21, a13
v_accvgpr_read_b32 v22, a14
v_mfma_f32_16x16x32_bf16 v[164:167], a[64:67], a[104:107], v[164:167]
v_accvgpr_read_b32 v23, a15
v_mul_f32 v16, s91, v16
v_mfma_f32_16x16x32_bf16 v[172:175], a[152:155], a[104:107], v[172:175]
buffer_load_dwordx4 v6, s[12:15], s64 offen offset:1024 lds
v_mfma_f32_16x16x32_bf16 v[172:175], a[156:159], a[108:111], v[172:175]
v_mul_f32 v17, s91, v17
v_mul_f32 v18, s91, v18
v_mfma_f32_16x16x32_bf16 v[56:59], a[148:151], a[108:111], v[56:59]
v_mul_f32 v19, s91, v19
v_mul_f32 v20, s91, v20
v_mfma_f32_16x16x32_bf16 v[56:59], a[144:147], a[104:107], v[56:59]
v_mul_f32 v21, s91, v21
v_mul_f32 v22, s91, v22
v_mfma_f32_16x16x32_bf16 v[180:183], a[136:139], a[104:107], v[180:183]
v_mul_f32 v23, s91, v23
v_cvt_pk_bf16_f32 v16, v16, v17
v_mfma_f32_16x16x32_bf16 v[180:183], a[140:143], a[108:111], v[180:183]
v_cvt_pk_bf16_f32 v17, v18, v19
v_cvt_pk_bf16_f32 v18, v20, v21
v_mfma_f32_16x16x32_bf16 v[188:191], a[132:135], a[108:111], v[188:191]
v_cvt_pk_bf16_f32 v19, v22, v23
v_accvgpr_write_b32 a8, v16
v_mfma_f32_16x16x32_bf16 v[188:191], a[128:131], a[104:107], v[188:191]
s_waitcnt lgkmcnt(0)
v_accvgpr_write_b32 a9, v17
v_accvgpr_write_b32 a10, v18
v_mfma_f32_16x16x32_bf16 v[196:199], a[160:163], a[80:83], v[196:199]
s_waitcnt vmcnt(17)
v_accvgpr_write_b32 a11, v19
v_accvgpr_read_b32 v16, a16
v_mfma_f32_16x16x32_bf16 v[196:199], a[164:167], a[84:87], v[196:199]
s_barrier
v_mfma_f32_16x16x32_bf16 v[64:67], a[172:175], a[84:87], v[64:67]
s_add_u32 s53, s87, 0
ds_read_b64_tr_b16 a[128:129], v11 offset:0
ds_read_b64_tr_b16 a[130:131], v11 offset:512
v_mfma_f32_16x16x32_bf16 v[64:67], a[168:171], a[80:83], v[64:67]
s_add_u32 m0, s77, 49152
s_add_u32 s64, s76, 128
v_accvgpr_read_b32 v17, a17
v_mfma_f32_16x16x32_bf16 v[204:207], a[176:179], a[80:83], v[204:207]
buffer_load_dwordx4 v7, s[20:23], s64 offen lds
v_mfma_f32_16x16x32_bf16 v[204:207], a[180:183], a[84:87], v[204:207]
ds_read_b64_tr_b16 a[132:133], v11 offset:4096
ds_read_b64_tr_b16 a[134:135], v11 offset:4608
v_mfma_f32_16x16x32_bf16 v[212:215], a[188:191], a[84:87], v[212:215]
ds_read_b64_tr_b16 a[136:137], v12 offset:0
ds_read_b64_tr_b16 a[138:139], v12 offset:512
v_mfma_f32_16x16x32_bf16 v[212:215], a[184:187], a[80:83], v[212:215]
ds_read_b64_tr_b16 a[140:141], v12 offset:4096
ds_read_b64_tr_b16 a[142:143], v12 offset:4608
v_mfma_f32_16x16x32_bf16 v[72:75], a[112:115], a[80:83], v[72:75]
buffer_store_dwordx4 v[168:171], v4, s[24:27], s53 offen offset:1024 sc1
v_mfma_f32_16x16x32_bf16 v[72:75], a[116:119], a[84:87], v[72:75]
ds_read_b64_tr_b16 a[144:145], v13 offset:0
ds_read_b64_tr_b16 a[146:147], v13 offset:512
v_mfma_f32_16x16x32_bf16 v[220:223], a[124:127], a[84:87], v[220:223]
buffer_load_dwordx4 v8, s[20:23], s64 offen offset:1024 lds
v_mfma_f32_16x16x32_bf16 v[220:223], a[120:123], a[80:83], v[220:223]
ds_read_b64_tr_b16 a[148:149], v13 offset:4096
ds_read_b64_tr_b16 a[150:151], v13 offset:4608
v_mfma_f32_16x16x32_bf16 a[32:35], a[120:123], a[88:91], a[32:35]
v_accvgpr_read_b32 v18, a18
v_accvgpr_read_b32 v19, a19
v_mfma_f32_16x16x32_bf16 a[32:35], a[124:127], a[92:95], a[32:35]
ds_read_b64_tr_b16 a[152:153], v14 offset:0
ds_read_b64_tr_b16 a[154:155], v14 offset:512
v_mfma_f32_16x16x32_bf16 a[36:39], a[116:119], a[92:95], a[36:39]
s_add_u32 m0, s80, 49152
s_add_u32 s64, s79, 2048
v_accvgpr_read_b32 v20, a20
v_mfma_f32_16x16x32_bf16 a[36:39], a[112:115], a[88:91], a[36:39]
ds_read_b64_tr_b16 a[156:157], v14 offset:4096
ds_read_b64_tr_b16 a[158:159], v14 offset:4608
v_mfma_f32_16x16x32_bf16 v[228:231], a[184:187], a[88:91], v[228:231]
buffer_load_dwordx4 v4, s[24:27], s64 offen sc1 lds
v_mfma_f32_16x16x32_bf16 v[228:231], a[188:191], a[92:95], v[228:231]
s_xor_b32 s65, s70, 384
s_add_u32 s71, s68, s65
s_add_u32 s72, s69, s65
v_mfma_f32_16x16x32_bf16 a[40:43], a[180:183], a[92:95], a[40:43]
ds_read_b128 a[64:67], v4 offset:8192
v_accvgpr_read_b32 v21, a21
v_mfma_f32_16x16x32_bf16 a[40:43], a[176:179], a[88:91], a[40:43]
v_accvgpr_read_b32 v22, a22
v_accvgpr_read_b32 v23, a23
v_mfma_f32_16x16x32_bf16 a[44:47], a[168:171], a[88:91], a[44:47]
s_add_u32 m0, s73, 0
s_add_u32 s64, s71, 0
ds_read_b128 a[80:83], v9 offset:0
v_mfma_f32_16x16x32_bf16 a[44:47], a[172:175], a[92:95], a[44:47]
v_mul_f32 v16, s91, v16
v_mul_f32 v17, s91, v17
v_mfma_f32_16x16x32_bf16 v[80:83], a[164:167], a[92:95], v[80:83]
buffer_load_dwordx4 v5, s[12:15], s64 offen lds
v_mfma_f32_16x16x32_bf16 v[80:83], a[160:163], a[88:91], v[80:83]
ds_read_b128 a[68:71], v4 offset:10240
v_mul_f32 v18, s91, v18
v_mfma_f32_16x16x32_bf16 a[48:51], a[160:163], a[96:99], a[48:51]
ds_read_b128 a[84:87], v10 offset:0
v_mul_f32 v19, s91, v19
v_mfma_f32_16x16x32_bf16 a[48:51], a[164:167], a[100:103], a[48:51]
v_mul_f32 v20, s91, v20
v_mul_f32 v21, s91, v21
v_mfma_f32_16x16x32_bf16 a[52:55], a[172:175], a[100:103], a[52:55]
v_mul_f32 v22, s91, v22
v_mul_f32 v23, s91, v23
v_mfma_f32_16x16x32_bf16 a[52:55], a[168:171], a[96:99], a[52:55]
ds_read_b128 a[72:75], v4 offset:9216
v_cvt_pk_bf16_f32 v16, v16, v17
v_mfma_f32_16x16x32_bf16 a[56:59], a[176:179], a[96:99], a[56:59]
buffer_load_dwordx4 v6, s[12:15], s64 offen offset:1024 lds
v_mfma_f32_16x16x32_bf16 a[56:59], a[180:183], a[100:103], a[56:59]
s_add_u32 s53, s87, 4096
ds_read_b128 a[88:91], v9 offset:2048
v_cvt_pk_bf16_f32 v17, v18, v19
v_mfma_f32_16x16x32_bf16 a[60:63], a[188:191], a[100:103], a[60:63]
buffer_store_dwordx4 v[176:179], v4, s[24:27], s53 offen offset:0 sc1
v_mfma_f32_16x16x32_bf16 a[60:63], a[184:187], a[96:99], a[60:63]
ds_read_b128 a[76:79], v4 offset:11264
v_cvt_pk_bf16_f32 v18, v20, v21
v_mfma_f32_16x16x32_bf16 v[236:239], a[112:115], a[96:99], v[236:239]
s_add_u32 m0, s73, 2048
s_add_u32 s64, s71, 18432
v_cvt_pk_bf16_f32 v19, v22, v23
v_mfma_f32_16x16x32_bf16 v[236:239], a[116:119], a[100:103], v[236:239]
ds_read_b128 a[92:95], v10 offset:2048
v_accvgpr_write_b32 a16, v16
v_mfma_f32_16x16x32_bf16 a[192:195], a[124:127], a[100:103], a[192:195]
buffer_load_dwordx4 v5, s[12:15], s64 offen lds
v_mfma_f32_16x16x32_bf16 a[192:195], a[120:123], a[96:99], a[192:195]
v_accvgpr_write_b32 a17, v17
v_accvgpr_write_b32 a18, v18
v_mfma_f32_16x16x32_bf16 a[196:199], a[120:123], a[104:107], a[196:199]
v_accvgpr_write_b32 a19, v19
v_accvgpr_read_b32 v16, a24
v_mfma_f32_16x16x32_bf16 a[196:199], a[124:127], a[108:111], a[196:199]
v_accvgpr_read_b32 v17, a25
v_accvgpr_read_b32 v18, a26
v_mfma_f32_16x16x32_bf16 a[200:203], a[116:119], a[108:111], a[200:203]
v_accvgpr_read_b32 v19, a27
v_accvgpr_read_b32 v20, a28
v_mfma_f32_16x16x32_bf16 a[200:203], a[112:115], a[104:107], a[200:203]
v_accvgpr_read_b32 v21, a29
v_accvgpr_read_b32 v22, a30
v_mfma_f32_16x16x32_bf16 v[244:247], a[184:187], a[104:107], v[244:247]
buffer_load_dwordx4 v6, s[12:15], s64 offen offset:1024 lds
v_mfma_f32_16x16x32_bf16 v[244:247], a[188:191], a[108:111], v[244:247]
v_accvgpr_read_b32 v23, a31
v_mul_f32 v16, s91, v16
v_mfma_f32_16x16x32_bf16 a[204:207], a[180:183], a[108:111], a[204:207]
v_mul_f32 v17, s91, v17
v_mul_f32 v18, s91, v18
v_mfma_f32_16x16x32_bf16 a[204:207], a[176:179], a[104:107], a[204:207]
v_mul_f32 v19, s91, v19
v_mul_f32 v20, s91, v20
v_mfma_f32_16x16x32_bf16 a[208:211], a[168:171], a[104:107], a[208:211]
v_mul_f32 v21, s91, v21
v_mul_f32 v22, s91, v22
v_mfma_f32_16x16x32_bf16 a[208:211], a[172:175], a[108:111], a[208:211]
v_mul_f32 v23, s91, v23
v_cvt_pk_bf16_f32 v16, v16, v17
v_mfma_f32_16x16x32_bf16 v[88:91], a[164:167], a[108:111], v[88:91]
v_cvt_pk_bf16_f32 v17, v18, v19
v_cvt_pk_bf16_f32 v18, v20, v21
v_mfma_f32_16x16x32_bf16 v[88:91], a[160:163], a[104:107], v[88:91]
s_waitcnt lgkmcnt(0)
v_cvt_pk_bf16_f32 v19, v22, v23
v_accvgpr_write_b32 a24, v16
v_mfma_f32_16x16x32_bf16 v[36:39], a[128:131], a[80:83], v[36:39]
s_waitcnt vmcnt(23)
v_accvgpr_write_b32 a25, v17
v_accvgpr_write_b32 a26, v18
v_mfma_f32_16x16x32_bf16 v[36:39], a[132:135], a[84:87], v[36:39]
s_barrier
v_mfma_f32_16x16x32_bf16 v[44:47], a[140:143], a[84:87], v[44:47]
ds_read_b128 a[96:99], v9 offset:4096
v_accvgpr_write_b32 a27, v19
v_mfma_f32_16x16x32_bf16 v[44:47], a[136:139], a[80:83], v[44:47]
s_xor_b32 s75, s93, 3
s_lshl_b32 s76, s75, 19
s_add_u32 s76, s76, s74
v_mfma_f32_16x16x32_bf16 v[32:35], a[144:147], a[80:83], v[32:35]
s_lshl_b32 s79, s75, 13
s_add_u32 s79, s79, s78
ds_read_b128 a[100:103], v10 offset:4096
v_mfma_f32_16x16x32_bf16 v[32:35], a[148:151], a[84:87], v[32:35]
s_add_u32 m0, s77, 0
s_add_u32 s64, s76, 0
ds_read_b128 a[104:107], v9 offset:6144
v_mfma_f32_16x16x32_bf16 v[52:55], a[156:159], a[84:87], v[52:55]
buffer_load_dwordx4 v7, s[20:23], s64 offen lds
v_mfma_f32_16x16x32_bf16 v[52:55], a[152:155], a[80:83], v[52:55]
s_add_u32 s53, s87, 4096
ds_read_b64_tr_b16 a[160:161], v11 offset:16384
ds_read_b64_tr_b16 a[162:163], v11 offset:16896
v_mfma_f32_16x16x32_bf16 v[60:63], a[64:67], a[80:83], v[60:63]
buffer_store_dwordx4 v[184:187], v4, s[24:27], s53 offen offset:1024 sc1
v_mfma_f32_16x16x32_bf16 v[60:63], a[68:71], a[84:87], v[60:63]
ds_read_b128 a[108:111], v10 offset:6144
v_accvgpr_write_b32 a4, v248
v_mfma_f32_16x16x32_bf16 v[68:71], a[76:79], a[84:87], v[68:71]
buffer_load_dwordx4 v8, s[20:23], s64 offen offset:1024 lds
v_mfma_f32_16x16x32_bf16 v[68:71], a[72:75], a[80:83], v[68:71]
ds_read_b64_tr_b16 a[164:165], v11 offset:20480
ds_read_b64_tr_b16 a[166:167], v11 offset:20992
v_mfma_f32_16x16x32_bf16 v[76:79], a[72:75], a[88:91], v[76:79]
v_add_u32 v9, 32768, v9
v_add_u32 v10, 32768, v10
v_mfma_f32_16x16x32_bf16 v[76:79], a[76:79], a[92:95], v[76:79]
ds_read_b64_tr_b16 a[168:169], v12 offset:16384
ds_read_b64_tr_b16 a[170:171], v12 offset:16896
v_mfma_f32_16x16x32_bf16 v[84:87], a[68:71], a[92:95], v[84:87]
s_add_u32 m0, s80, 0
s_add_u32 s64, s79, 0
v_accvgpr_write_b32 a5, v249
v_mfma_f32_16x16x32_bf16 v[84:87], a[64:67], a[88:91], v[84:87]
ds_read_b64_tr_b16 a[172:173], v12 offset:20480
ds_read_b64_tr_b16 a[174:175], v12 offset:20992
v_mfma_f32_16x16x32_bf16 v[92:95], a[152:155], a[88:91], v[92:95]
buffer_load_dwordx4 v4, s[24:27], s64 offen sc1 lds
v_mfma_f32_16x16x32_bf16 v[92:95], a[156:159], a[92:95], v[92:95]
v_accvgpr_write_b32 a6, v250
v_accvgpr_write_b32 a7, v251
v_mfma_f32_16x16x32_bf16 v[40:43], a[148:151], a[92:95], v[40:43]
ds_read_b64_tr_b16 a[176:177], v13 offset:16384
ds_read_b64_tr_b16 a[178:179], v13 offset:16896
v_mfma_f32_16x16x32_bf16 v[40:43], a[144:147], a[88:91], v[40:43]
v_accvgpr_write_b32 a12, v240
v_accvgpr_write_b32 a13, v241
v_mfma_f32_16x16x32_bf16 v[100:103], a[136:139], a[88:91], v[100:103]
s_add_u32 m0, s73, 4096
s_add_u32 s64, s72, 0
v_accvgpr_write_b32 a14, v242
v_mfma_f32_16x16x32_bf16 v[100:103], a[140:143], a[92:95], v[100:103]
ds_read_b64_tr_b16 a[180:181], v13 offset:20480
ds_read_b64_tr_b16 a[182:183], v13 offset:20992
v_mfma_f32_16x16x32_bf16 v[108:111], a[132:135], a[92:95], v[108:111]
buffer_load_dwordx4 v5, s[12:15], s64 offen lds
v_mfma_f32_16x16x32_bf16 v[108:111], a[128:131], a[88:91], v[108:111]
s_waitcnt lgkmcnt(14)
ds_read_b64_tr_b16 a[184:185], v14 offset:16384
ds_read_b64_tr_b16 a[186:187], v14 offset:16896
v_mfma_f32_16x16x32_bf16 v[116:119], a[128:131], a[96:99], v[116:119]
ds_read_b64_tr_b16 a[188:189], v14 offset:20480
ds_read_b64_tr_b16 a[190:191], v14 offset:20992
v_mfma_f32_16x16x32_bf16 v[116:119], a[132:135], a[100:103], v[116:119]
v_accvgpr_write_b32 a15, v243
v_accvgpr_write_b32 a20, v232
v_mfma_f32_16x16x32_bf16 v[124:127], a[140:143], a[100:103], v[124:127]
v_accvgpr_write_b32 a21, v233
v_accvgpr_write_b32 a22, v234
v_mfma_f32_16x16x32_bf16 v[124:127], a[136:139], a[96:99], v[124:127]
ds_read_b128 a[112:115], v4 offset:24576
v_accvgpr_write_b32 a23, v235
v_mfma_f32_16x16x32_bf16 v[132:135], a[144:147], a[96:99], v[132:135]
buffer_load_dwordx4 v6, s[12:15], s64 offen offset:1024 lds
v_mfma_f32_16x16x32_bf16 v[132:135], a[148:151], a[100:103], v[132:135]
ds_read_b128 a[116:119], v4 offset:26624
v_accvgpr_write_b32 a28, v224
v_mfma_f32_16x16x32_bf16 v[140:143], a[156:159], a[100:103], v[140:143]
v_accvgpr_write_b32 a29, v225
v_accvgpr_write_b32 a30, v226
v_mfma_f32_16x16x32_bf16 v[140:143], a[152:155], a[96:99], v[140:143]
ds_read_b128 a[120:123], v4 offset:25600
v_accvgpr_write_b32 a31, v227
v_mfma_f32_16x16x32_bf16 v[148:151], a[64:67], a[96:99], v[148:151]
s_add_u32 m0, s73, 6144
s_add_u32 s64, s72, 18432
v_accvgpr_read_b32 v252, a32
v_mfma_f32_16x16x32_bf16 v[148:151], a[68:71], a[100:103], v[148:151]
ds_read_b128 a[124:127], v4 offset:27648
v_accvgpr_read_b32 v253, a33
v_mfma_f32_16x16x32_bf16 v[48:51], a[76:79], a[100:103], v[48:51]
buffer_load_dwordx4 v5, s[12:15], s64 offen lds
v_mfma_f32_16x16x32_bf16 v[48:51], a[72:75], a[96:99], v[48:51]
s_waitcnt lgkmcnt(15)
s_add_u32 s53, s87, 262144
v_accvgpr_read_b32 v254, a34
v_mfma_f32_16x16x32_bf16 v[156:159], a[72:75], a[104:107], v[156:159]
buffer_store_dwordx4 v[192:195], v4, s[24:27], s53 offen offset:0 sc1
v_mfma_f32_16x16x32_bf16 v[156:159], a[76:79], a[108:111], v[156:159]
v_accvgpr_read_b32 v255, a35
v_accvgpr_read_b32 v160, a36
v_mfma_f32_16x16x32_bf16 v[164:167], a[68:71], a[108:111], v[164:167]
v_accvgpr_read_b32 v161, a37
v_accvgpr_read_b32 v162, a38
v_mfma_f32_16x16x32_bf16 v[164:167], a[64:67], a[104:107], v[164:167]
v_accvgpr_read_b32 v163, a39
v_accvgpr_read_b32 v168, a40
v_mfma_f32_16x16x32_bf16 v[172:175], a[152:155], a[104:107], v[172:175]
buffer_load_dwordx4 v6, s[12:15], s64 offen offset:1024 lds
v_mfma_f32_16x16x32_bf16 v[172:175], a[156:159], a[108:111], v[172:175]
v_accvgpr_read_b32 v169, a41
v_accvgpr_read_b32 v170, a42
v_mfma_f32_16x16x32_bf16 v[56:59], a[148:151], a[108:111], v[56:59]
v_accvgpr_read_b32 v171, a43
v_accvgpr_read_b32 v176, a44
v_mfma_f32_16x16x32_bf16 v[56:59], a[144:147], a[104:107], v[56:59]
v_accvgpr_read_b32 v177, a45
v_accvgpr_read_b32 v178, a46
v_mfma_f32_16x16x32_bf16 v[180:183], a[136:139], a[104:107], v[180:183]
v_accvgpr_read_b32 v179, a47
v_accvgpr_read_b32 v184, a48
v_mfma_f32_16x16x32_bf16 v[180:183], a[140:143], a[108:111], v[180:183]
v_accvgpr_read_b32 v185, a49
v_accvgpr_read_b32 v186, a50
v_mfma_f32_16x16x32_bf16 v[188:191], a[132:135], a[108:111], v[188:191]
v_accvgpr_read_b32 v187, a51
v_accvgpr_read_b32 v248, a52
v_mfma_f32_16x16x32_bf16 v[188:191], a[128:131], a[104:107], v[188:191]
s_waitcnt lgkmcnt(0)
v_accvgpr_read_b32 v249, a53
v_accvgpr_read_b32 v250, a54
v_mfma_f32_16x16x32_bf16 v[196:199], a[160:163], a[80:83], v[196:199]
s_waitcnt vmcnt(18)
v_accvgpr_read_b32 v251, a55
v_accvgpr_read_b32 v240, a56
v_mfma_f32_16x16x32_bf16 v[196:199], a[164:167], a[84:87], v[196:199]
s_barrier
v_mfma_f32_16x16x32_bf16 v[64:67], a[172:175], a[84:87], v[64:67]
ds_read_b64_tr_b16 a[128:129], v11 offset:32768
ds_read_b64_tr_b16 a[130:131], v11 offset:33280
v_mfma_f32_16x16x32_bf16 v[64:67], a[168:171], a[80:83], v[64:67]
s_add_u32 m0, s77, 16384
s_add_u32 s64, s76, 128
v_accvgpr_read_b32 v241, a57
v_mfma_f32_16x16x32_bf16 v[204:207], a[176:179], a[80:83], v[204:207]
buffer_load_dwordx4 v7, s[20:23], s64 offen lds
v_mfma_f32_16x16x32_bf16 v[204:207], a[180:183], a[84:87], v[204:207]
ds_read_b64_tr_b16 a[132:133], v11 offset:36864
ds_read_b64_tr_b16 a[134:135], v11 offset:37376
v_mfma_f32_16x16x32_bf16 v[212:215], a[188:191], a[84:87], v[212:215]
ds_read_b64_tr_b16 a[136:137], v12 offset:32768
ds_read_b64_tr_b16 a[138:139], v12 offset:33280
v_mfma_f32_16x16x32_bf16 v[212:215], a[184:187], a[80:83], v[212:215]
ds_read_b64_tr_b16 a[140:141], v12 offset:36864
ds_read_b64_tr_b16 a[142:143], v12 offset:37376
v_mfma_f32_16x16x32_bf16 v[72:75], a[112:115], a[80:83], v[72:75]
v_accvgpr_read_b32 v242, a58
v_accvgpr_read_b32 v243, a59
v_mfma_f32_16x16x32_bf16 v[72:75], a[116:119], a[84:87], v[72:75]
ds_read_b64_tr_b16 a[144:145], v13 offset:32768
ds_read_b64_tr_b16 a[146:147], v13 offset:33280
v_mfma_f32_16x16x32_bf16 v[220:223], a[124:127], a[84:87], v[220:223]
buffer_load_dwordx4 v8, s[20:23], s64 offen offset:1024 lds
v_mfma_f32_16x16x32_bf16 v[220:223], a[120:123], a[80:83], v[220:223]
ds_read_b64_tr_b16 a[148:149], v13 offset:36864
ds_read_b64_tr_b16 a[150:151], v13 offset:37376
v_mfma_f32_16x16x32_bf16 v[252:255], a[120:123], a[88:91], v[252:255]
v_accvgpr_read_b32 v232, a60
v_accvgpr_read_b32 v233, a61
v_mfma_f32_16x16x32_bf16 v[252:255], a[124:127], a[92:95], v[252:255]
s_add_u32 s53, s87, 262144
ds_read_b64_tr_b16 a[152:153], v14 offset:32768
ds_read_b64_tr_b16 a[154:155], v14 offset:33280
v_mfma_f32_16x16x32_bf16 v[160:163], a[116:119], a[92:95], v[160:163]
s_add_u32 m0, s80, 16384
s_add_u32 s64, s79, 2048
v_accvgpr_read_b32 v234, a62
v_mfma_f32_16x16x32_bf16 v[160:163], a[112:115], a[88:91], v[160:163]
L_PAD5:
s_cbranch_execz L_PAD9
ds_read_b64_tr_b16 a[156:157], v14 offset:36864
ds_read_b64_tr_b16 a[158:159], v14 offset:37376
v_mfma_f32_16x16x32_bf16 v[228:231], a[184:187], a[88:91], v[228:231]
buffer_load_dwordx4 v4, s[24:27], s64 offen sc1 lds
v_mfma_f32_16x16x32_bf16 v[228:231], a[188:191], a[92:95], v[228:231]
s_xor_b32 s65, s70, 512
s_add_u32 s71, s68, s65
s_add_u32 s72, s69, s65
v_mfma_f32_16x16x32_bf16 v[168:171], a[180:183], a[92:95], v[168:171]
ds_read_b128 a[64:67], v4 offset:40960
v_accvgpr_read_b32 v235, a63
v_mfma_f32_16x16x32_bf16 v[168:171], a[176:179], a[88:91], v[168:171]
buffer_store_dwordx4 v[200:203], v4, s[24:27], s53 offen offset:1024 sc1
v_mfma_f32_16x16x32_bf16 v[176:179], a[168:171], a[88:91], v[176:179]
s_add_u32 m0, s73, 32768
s_add_u32 s64, s71, 0
ds_read_b128 a[80:83], v9 offset:0
v_mfma_f32_16x16x32_bf16 v[176:179], a[172:175], a[92:95], v[176:179]
v_accvgpr_read_b32 v224, a192
v_accvgpr_read_b32 v225, a193
v_mfma_f32_16x16x32_bf16 v[80:83], a[164:167], a[92:95], v[80:83]
buffer_load_dwordx4 v5, s[12:15], s64 offen lds
v_mfma_f32_16x16x32_bf16 v[80:83], a[160:163], a[88:91], v[80:83]
ds_read_b128 a[68:71], v4 offset:43008
v_accvgpr_read_b32 v226, a194
v_mfma_f32_16x16x32_bf16 v[184:187], a[160:163], a[96:99], v[184:187]
ds_read_b128 a[84:87], v10 offset:0
v_accvgpr_read_b32 v227, a195
v_mfma_f32_16x16x32_bf16 v[184:187], a[164:167], a[100:103], v[184:187]
v_accvgpr_read_b32 v192, a204
v_accvgpr_read_b32 v193, a205
v_mfma_f32_16x16x32_bf16 v[248:251], a[172:175], a[100:103], v[248:251]
v_accvgpr_read_b32 v194, a206
v_accvgpr_read_b32 v195, a207
v_mfma_f32_16x16x32_bf16 v[248:251], a[168:171], a[96:99], v[248:251]
ds_read_b128 a[72:75], v4 offset:41984
v_accvgpr_read_b32 v200, a208
v_mfma_f32_16x16x32_bf16 v[240:243], a[176:179], a[96:99], v[240:243]
buffer_load_dwordx4 v6, s[12:15], s64 offen offset:1024 lds
v_mfma_f32_16x16x32_bf16 v[240:243], a[180:183], a[100:103], v[240:243]
ds_read_b128 a[88:91], v9 offset:2048
v_accvgpr_read_b32 v201, a209
v_mfma_f32_16x16x32_bf16 v[232:235], a[188:191], a[100:103], v[232:235]
v_accvgpr_read_b32 v202, a210
v_accvgpr_read_b32 v203, a211
v_mfma_f32_16x16x32_bf16 v[232:235], a[184:187], a[96:99], v[232:235]
ds_read_b128 a[76:79], v4 offset:44032
v_and_b32 v28, 31, v1
v_mfma_f32_16x16x32_bf16 v[236:239], a[112:115], a[96:99], v[236:239]
s_add_u32 m0, s73, 34816
s_add_u32 s64, s71, 18432
v_lshlrev_b32 v28, 2, v28
v_mfma_f32_16x16x32_bf16 v[236:239], a[116:119], a[100:103], v[236:239]
ds_read_b128 a[92:95], v10 offset:2048
v_mfma_f32_16x16x32_bf16 v[224:227], a[124:127], a[100:103], v[224:227]
buffer_load_dwordx4 v5, s[12:15], s64 offen lds
v_mfma_f32_16x16x32_bf16 v[224:227], a[120:123], a[96:99], v[224:227]
buffer_load_dword v30, v28, s[40:43], 0 offen sc1
v_mfma_f32_16x16x32_bf16 a[196:199], a[120:123], a[104:107], a[196:199]
v_mfma_f32_16x16x32_bf16 a[196:199], a[124:127], a[108:111], a[196:199]
v_mfma_f32_16x16x32_bf16 a[200:203], a[116:119], a[108:111], a[200:203]
v_mfma_f32_16x16x32_bf16 a[200:203], a[112:115], a[104:107], a[200:203]
v_mfma_f32_16x16x32_bf16 v[244:247], a[184:187], a[104:107], v[244:247]
buffer_load_dwordx4 v6, s[12:15], s64 offen offset:1024 lds
v_mfma_f32_16x16x32_bf16 v[244:247], a[188:191], a[108:111], v[244:247]
s_add_u32 s53, s87, 266240
v_mfma_f32_16x16x32_bf16 v[192:195], a[180:183], a[108:111], v[192:195]
buffer_store_dwordx4 v[208:211], v4, s[24:27], s53 offen offset:0 sc1
v_mfma_f32_16x16x32_bf16 v[192:195], a[176:179], a[104:107], v[192:195]
v_mfma_f32_16x16x32_bf16 v[200:203], a[168:171], a[104:107], v[200:203]
v_mfma_f32_16x16x32_bf16 v[200:203], a[172:175], a[108:111], v[200:203]
v_accvgpr_read_b32 v208, a196
v_accvgpr_read_b32 v209, a197
v_mfma_f32_16x16x32_bf16 v[88:91], a[164:167], a[108:111], v[88:91]
v_accvgpr_read_b32 v210, a198
v_accvgpr_read_b32 v211, a199
v_mfma_f32_16x16x32_bf16 v[88:91], a[160:163], a[104:107], v[88:91]
s_waitcnt lgkmcnt(0)
v_mfma_f32_16x16x32_bf16 v[36:39], a[128:131], a[80:83], v[36:39]
s_waitcnt vmcnt(24)
v_mfma_f32_16x16x32_bf16 v[36:39], a[132:135], a[84:87], v[36:39]
s_barrier
v_mfma_f32_16x16x32_bf16 v[44:47], a[140:143], a[84:87], v[44:47]
ds_read_b128 a[96:99], v9 offset:4096
v_mfma_f32_16x16x32_bf16 v[44:47], a[136:139], a[80:83], v[44:47]
s_xor_b32 s75, s93, 4
s_lshl_b32 s76, s75, 19
s_add_u32 s76, s76, s74
v_mfma_f32_16x16x32_bf16 v[32:35], a[144:147], a[80:83], v[32:35]
s_lshl_b32 s79, s75, 13
s_add_u32 s79, s79, s78
ds_read_b128 a[100:103], v10 offset:4096
v_mfma_f32_16x16x32_bf16 v[32:35], a[148:151], a[84:87], v[32:35]
s_add_u32 m0, s77, 32768
s_add_u32 s64, s76, 0
ds_read_b128 a[104:107], v9 offset:6144
v_mfma_f32_16x16x32_bf16 v[52:55], a[156:159], a[84:87], v[52:55]
buffer_load_dwordx4 v7, s[20:23], s64 offen lds
v_mfma_f32_16x16x32_bf16 v[52:55], a[152:155], a[80:83], v[52:55]
ds_read_b64_tr_b16 a[160:161], v11 offset:49152
ds_read_b64_tr_b16 a[162:163], v11 offset:49664
v_mfma_f32_16x16x32_bf16 v[60:63], a[64:67], a[80:83], v[60:63]
v_mfma_f32_16x16x32_bf16 v[60:63], a[68:71], a[84:87], v[60:63]
ds_read_b128 a[108:111], v10 offset:6144
v_mfma_f32_16x16x32_bf16 v[68:71], a[76:79], a[84:87], v[68:71]
buffer_load_dwordx4 v8, s[20:23], s64 offen offset:1024 lds
v_mfma_f32_16x16x32_bf16 v[68:71], a[72:75], a[80:83], v[68:71]
ds_read_b64_tr_b16 a[164:165], v11 offset:53248
ds_read_b64_tr_b16 a[166:167], v11 offset:53760
v_mfma_f32_16x16x32_bf16 v[76:79], a[72:75], a[88:91], v[76:79]
v_add_u32 v9, -65536, v9
v_add_u32 v10, -65536, v10
v_mfma_f32_16x16x32_bf16 v[76:79], a[76:79], a[92:95], v[76:79]
ds_read_b64_tr_b16 a[168:169], v12 offset:49152
ds_read_b64_tr_b16 a[170:171], v12 offset:49664
v_mfma_f32_16x16x32_bf16 v[84:87], a[68:71], a[92:95], v[84:87]
s_add_u32 m0, s80, 32768
s_add_u32 s64, s79, 0
v_mfma_f32_16x16x32_bf16 v[84:87], a[64:67], a[88:91], v[84:87]
ds_read_b64_tr_b16 a[172:173], v12 offset:53248
ds_read_b64_tr_b16 a[174:175], v12 offset:53760
v_mfma_f32_16x16x32_bf16 v[92:95], a[152:155], a[88:91], v[92:95]
buffer_load_dwordx4 v4, s[24:27], s64 offen sc1 lds
v_mfma_f32_16x16x32_bf16 v[92:95], a[156:159], a[92:95], v[92:95]
v_mfma_f32_16x16x32_bf16 v[40:43], a[148:151], a[92:95], v[40:43]
ds_read_b64_tr_b16 a[176:177], v13 offset:49152
ds_read_b64_tr_b16 a[178:179], v13 offset:49664
v_mfma_f32_16x16x32_bf16 v[40:43], a[144:147], a[88:91], v[40:43]
s_add_u32 s53, s87, 266240
v_mfma_f32_16x16x32_bf16 v[100:103], a[136:139], a[88:91], v[100:103]
s_add_u32 m0, s73, 36864
s_add_u32 s64, s72, 0
v_mfma_f32_16x16x32_bf16 v[100:103], a[140:143], a[92:95], v[100:103]
ds_read_b64_tr_b16 a[180:181], v13 offset:53248
ds_read_b64_tr_b16 a[182:183], v13 offset:53760
v_mfma_f32_16x16x32_bf16 v[108:111], a[132:135], a[92:95], v[108:111]
buffer_load_dwordx4 v5, s[12:15], s64 offen lds
v_mfma_f32_16x16x32_bf16 v[108:111], a[128:131], a[88:91], v[108:111]
s_waitcnt lgkmcnt(14)
ds_read_b64_tr_b16 a[184:185], v14 offset:49152
ds_read_b64_tr_b16 a[186:187], v14 offset:49664
v_mfma_f32_16x16x32_bf16 v[116:119], a[128:131], a[96:99], v[116:119]
s_waitcnt vmcnt(6)
ds_read_b64_tr_b16 a[188:189], v14 offset:53248
ds_read_b64_tr_b16 a[190:191], v14 offset:53760
v_mfma_f32_16x16x32_bf16 v[116:119], a[132:135], a[100:103], v[116:119]
buffer_store_dwordx4 v[216:219], v4, s[24:27], s53 offen offset:1024 sc1
v_mfma_f32_16x16x32_bf16 v[124:127], a[140:143], a[100:103], v[124:127]
v_cmp_gt_u32 vcc, 1, v30
v_mfma_f32_16x16x32_bf16 v[124:127], a[136:139], a[96:99], v[124:127]
ds_read_b128 a[112:115], v4 offset:57344
v_accvgpr_read_b32 v216, a200
v_mfma_f32_16x16x32_bf16 v[132:135], a[144:147], a[96:99], v[132:135]
buffer_load_dwordx4 v6, s[12:15], s64 offen offset:1024 lds
v_mfma_f32_16x16x32_bf16 v[132:135], a[148:151], a[100:103], v[132:135]
ds_read_b128 a[116:119], v4 offset:59392
v_accvgpr_read_b32 v217, a201
v_mfma_f32_16x16x32_bf16 v[140:143], a[156:159], a[100:103], v[140:143]
v_accvgpr_read_b32 v218, a202
v_accvgpr_read_b32 v219, a203
v_mfma_f32_16x16x32_bf16 v[140:143], a[152:155], a[96:99], v[140:143]
s_lshr_b32 s84, s7, 1
s_and_b32 s85, s7, 1
ds_read_b128 a[120:123], v4 offset:58368
v_mfma_f32_16x16x32_bf16 v[148:151], a[64:67], a[96:99], v[148:151]
s_add_u32 m0, s73, 38912
s_add_u32 s64, s72, 18432
s_xor_b32 s52, s5, 0
v_mfma_f32_16x16x32_bf16 v[148:151], a[68:71], a[100:103], v[148:151]
s_lshl1_add_u32 s85, s52, s85
s_and_b32 s86, s6, 3
ds_read_b128 a[124:127], v4 offset:60416
v_mfma_f32_16x16x32_bf16 v[48:51], a[76:79], a[100:103], v[48:51]
buffer_load_dwordx4 v5, s[12:15], s64 offen lds
v_mfma_f32_16x16x32_bf16 v[48:51], a[72:75], a[96:99], v[48:51]
s_waitcnt lgkmcnt(15)
s_lshl_b32 s83, s3, 13
s_add_u32 s83, s83, 131072
v_mfma_f32_16x16x32_bf16 v[156:159], a[72:75], a[104:107], v[156:159]
s_cbranch_vccnz CK_ZA
CK_ZA_R:
v_mfma_f32_16x16x32_bf16 v[156:159], a[76:79], a[108:111], v[156:159]
s_mul_i32 s52, s2, 5462
s_lshr_b32 s52, s52, 16
s_mul_i32 s54, s52, 12
v_mfma_f32_16x16x32_bf16 v[164:167], a[68:71], a[108:111], v[164:167]
s_sub_u32 s54, s2, s54
s_mul_i32 s54, s54, 3
s_add_u32 s54, s54, s3
v_mfma_f32_16x16x32_bf16 v[164:167], a[64:67], a[104:107], v[164:167]
s_mul_i32 s55, s52, 13108
s_lshr_b32 s55, s55, 16
s_mul_i32 s82, s55, 5
v_mfma_f32_16x16x32_bf16 v[172:175], a[152:155], a[104:107], v[172:175]
buffer_load_dwordx4 v6, s[12:15], s64 offen offset:1024 lds
v_mfma_f32_16x16x32_bf16 v[172:175], a[156:159], a[108:111], v[172:175]
s_sub_u32 s52, s52, s82
v_mfma_f32_16x16x32_bf16 v[56:59], a[148:151], a[108:111], v[56:59]
v_lshrrev_b32 v16, 1, v1
v_and_b32 v17, 1, v1
v_mfma_f32_16x16x32_bf16 v[56:59], a[144:147], a[104:107], v[56:59]
v_mul_u32_u24 v18, 1152, v16
v_lshl_add_u32 v18, v17, 4, v18
v_mfma_f32_16x16x32_bf16 v[180:183], a[136:139], a[104:107], v[180:183]
v_mov_b32 v24, v18
v_lshrrev_b32 v18, 4, v16
v_mfma_f32_16x16x32_bf16 v[180:183], a[140:143], a[108:111], v[180:183]
v_bfe_u32 v19, v16, 2, 2
v_and_b32 v16, 3, v16
v_mfma_f32_16x16x32_bf16 v[188:191], a[132:135], a[108:111], v[188:191]
s_add_u32 s53, s88, 524288
v_lshrrev_b32 v20, 1, v19
v_mul_u32_u24 v20, 18, v20
v_mfma_f32_16x16x32_bf16 v[188:191], a[128:131], a[104:107], v[188:191]
s_waitcnt lgkmcnt(0)
v_and_b32 v21, 1, v19
v_lshl_add_u32 v20, v21, 1, v20
v_mfma_f32_16x16x32_bf16 v[196:199], a[160:163], a[80:83], v[196:199]
s_waitcnt vmcnt(18)
v_lshl_add_u32 v20, v16, 2, v20
v_add_u32 v20, v20, v18
v_mfma_f32_16x16x32_bf16 v[196:199], a[164:167], a[84:87], v[196:199]
s_barrier
v_mfma_f32_16x16x32_bf16 v[64:67], a[172:175], a[84:87], v[64:67]
ds_read_b64_tr_b16 a[128:129], v11 offset:0
ds_read_b64_tr_b16 a[130:131], v11 offset:512
v_mfma_f32_16x16x32_bf16 v[64:67], a[168:171], a[80:83], v[64:67]
s_add_u32 m0, s77, 49152
s_add_u32 s64, s76, 128
v_mad_u32_u24 v20, s52, 36, v20
v_mfma_f32_16x16x32_bf16 v[204:207], a[176:179], a[80:83], v[204:207]
buffer_load_dwordx4 v7, s[20:23], s64 offen lds
v_mfma_f32_16x16x32_bf16 v[204:207], a[180:183], a[84:87], v[204:207]
ds_read_b64_tr_b16 a[132:133], v11 offset:4096
ds_read_b64_tr_b16 a[134:135], v11 offset:4608
v_mfma_f32_16x16x32_bf16 v[212:215], a[188:191], a[84:87], v[212:215]
ds_read_b64_tr_b16 a[136:137], v12 offset:0
ds_read_b64_tr_b16 a[138:139], v12 offset:512
v_mfma_f32_16x16x32_bf16 v[212:215], a[184:187], a[80:83], v[212:215]
ds_read_b64_tr_b16 a[140:141], v12 offset:4096
ds_read_b64_tr_b16 a[142:143], v12 offset:4608
v_mfma_f32_16x16x32_bf16 v[72:75], a[112:115], a[80:83], v[72:75]
buffer_store_dwordx4 v[96:99], v4, s[24:27], s53 offen offset:0 sc1
v_mfma_f32_16x16x32_bf16 v[72:75], a[116:119], a[84:87], v[72:75]
ds_read_b64_tr_b16 a[144:145], v13 offset:0
ds_read_b64_tr_b16 a[146:147], v13 offset:512
v_mfma_f32_16x16x32_bf16 v[220:223], a[124:127], a[84:87], v[220:223]
buffer_load_dwordx4 v8, s[20:23], s64 offen offset:1024 lds
v_mfma_f32_16x16x32_bf16 v[220:223], a[120:123], a[80:83], v[220:223]
ds_read_b64_tr_b16 a[148:149], v13 offset:4096
ds_read_b64_tr_b16 a[150:151], v13 offset:4608
v_mfma_f32_16x16x32_bf16 v[252:255], a[120:123], a[88:91], v[252:255]
v_lshlrev_b32 v21, 1, v18
v_lshl_add_u32 v21, v19, 2, v21
v_mfma_f32_16x16x32_bf16 v[252:255], a[124:127], a[92:95], v[252:255]
ds_read_b64_tr_b16 a[152:153], v14 offset:0
ds_read_b64_tr_b16 a[154:155], v14 offset:512
v_mfma_f32_16x16x32_bf16 v[160:163], a[116:119], a[92:95], v[160:163]
s_add_u32 m0, s80, 49152
s_add_u32 s64, s79, 2048
v_lshrrev_b32 v22, 1, v16
v_mfma_f32_16x16x32_bf16 v[160:163], a[112:115], a[88:91], v[160:163]
ds_read_b64_tr_b16 a[156:157], v14 offset:4096
ds_read_b64_tr_b16 a[158:159], v14 offset:4608
v_mfma_f32_16x16x32_bf16 v[228:231], a[184:187], a[88:91], v[228:231]
buffer_load_dwordx4 v4, s[24:27], s64 offen sc1 lds
v_mfma_f32_16x16x32_bf16 v[228:231], a[188:191], a[92:95], v[228:231]
s_xor_b32 s65, s70, 640
s_add_u32 s71, s68, s65
s_add_u32 s72, s69, s65
v_mfma_f32_16x16x32_bf16 v[168:171], a[180:183], a[92:95], v[168:171]
ds_read_b128 a[64:67], v4 offset:8192
v_add_u32 v21, v21, v22
v_mfma_f32_16x16x32_bf16 v[168:171], a[176:179], a[88:91], v[168:171]
v_mul_u32_u24 v21, 18, v21
v_and_b32 v22, 1, v16
v_mfma_f32_16x16x32_bf16 v[176:179], a[168:171], a[88:91], v[176:179]
s_add_u32 m0, s73, 65536
s_add_u32 s64, s71, 0
ds_read_b128 a[80:83], v9 offset:0
v_mfma_f32_16x16x32_bf16 v[176:179], a[172:175], a[92:95], v[176:179]
v_add3_u32 v21, v21, v22, 16
v_cmp_lt_u32 s[96:97], 1, v19
v_mfma_f32_16x16x32_bf16 v[80:83], a[164:167], a[92:95], v[80:83]
buffer_load_dwordx4 v5, s[12:15], s64 offen lds
v_mfma_f32_16x16x32_bf16 v[80:83], a[160:163], a[88:91], v[80:83]
ds_read_b128 a[68:71], v4 offset:10240
v_mov_b32 v22, 0x100000
v_mfma_f32_16x16x32_bf16 v[184:187], a[160:163], a[96:99], v[184:187]
ds_read_b128 a[84:87], v10 offset:0
v_mul_u32_u24 v23, 1, v23
v_mfma_f32_16x16x32_bf16 v[184:187], a[164:167], a[100:103], v[184:187]
s_add_u32 s53, s88, 524288
v_cndmask_b32 v21, v21, v22, s[96:97]
v_mov_b32 v22, s52
v_mfma_f32_16x16x32_bf16 v[248:251], a[172:175], a[100:103], v[248:251]
buffer_store_dwordx4 v[104:107], v4, s[24:27], s53 offen offset:1024 sc1
v_mfma_f32_16x16x32_bf16 v[248:251], a[168:171], a[96:99], v[248:251]
ds_read_b128 a[72:75], v4 offset:9216
v_cmp_eq_u32 s[96:97], 4, v22
v_mfma_f32_16x16x32_bf16 v[240:243], a[176:179], a[96:99], v[240:243]
buffer_load_dwordx4 v6, s[12:15], s64 offen offset:1024 lds
v_mfma_f32_16x16x32_bf16 v[240:243], a[180:183], a[100:103], v[240:243]
ds_read_b128 a[88:91], v9 offset:2048
v_cndmask_b32 v20, v20, v21, s[96:97]
v_mfma_f32_16x16x32_bf16 v[232:235], a[188:191], a[100:103], v[232:235]
v_mul_u32_u24 v20, 1152, v20
v_lshl_add_u32 v20, v17, 4, v20
v_mfma_f32_16x16x32_bf16 v[232:235], a[184:187], a[96:99], v[232:235]
ds_read_b128 a[76:79], v4 offset:11264
v_mov_b32 v25, v20
v_mfma_f32_16x16x32_bf16 v[236:239], a[112:115], a[96:99], v[236:239]
s_add_u32 m0, s73, 67584
s_add_u32 s64, s71, 18432
v_mov_b32 v16, s54
v_mfma_f32_16x16x32_bf16 v[236:239], a[116:119], a[100:103], v[236:239]
ds_read_b128 a[92:95], v10 offset:2048
v_mov_b32 v17, s55
v_mfma_f32_16x16x32_bf16 v[224:227], a[124:127], a[100:103], v[224:227]
buffer_load_dwordx4 v5, s[12:15], s64 offen lds
v_mfma_f32_16x16x32_bf16 v[224:227], a[120:123], a[96:99], v[224:227]
v_add_u32 v18, 32, v22
v_mfma_f32_16x16x32_bf16 v[208:211], a[120:123], a[104:107], v[208:211]
s_mul_i32 s82, s55, 165888
s_lshl_b32 s54, s54, 5
s_add_u32 s82, s82, s54
v_mfma_f32_16x16x32_bf16 v[208:211], a[124:127], a[108:111], v[208:211]
s_and_b32 s52, s2, 1
s_lshr_b32 s54, s3, 1
s_lshl1_add_u32 s52, s52, s54
v_mfma_f32_16x16x32_bf16 v[216:219], a[116:119], a[108:111], v[216:219]
s_mul_i32 s52, s52, 9
s_and_b32 s54, s3, 1
s_mul_i32 s55, s54, 5
v_mfma_f32_16x16x32_bf16 v[216:219], a[112:115], a[104:107], v[216:219]
s_add_u32 s52, s52, s55
s_lshr_b32 s55, s2, 1
s_mul_i32 s81, s55, 1152
v_mfma_f32_16x16x32_bf16 v[244:247], a[184:187], a[104:107], v[244:247]
buffer_load_dwordx4 v6, s[12:15], s64 offen offset:1024 lds
v_mfma_f32_16x16x32_bf16 v[244:247], a[188:191], a[108:111], v[244:247]
s_add_u32 s81, s81, s52
s_lshl_b32 s81, s81, 5
v_mfma_f32_16x16x32_bf16 v[192:195], a[180:183], a[108:111], v[192:195]
v_cmp_gt_u32 s[96:97], 5, v1
v_add_u32 v19, s52, v1
v_mfma_f32_16x16x32_bf16 v[192:195], a[176:179], a[104:107], v[192:195]
v_lshrrev_b32 v20, 5, s55
v_and_b32 v21, 31, s55
v_mfma_f32_16x16x32_bf16 v[200:203], a[168:171], a[104:107], v[200:203]
v_cndmask_b32 v16, v16, v19, s[96:97]
v_cndmask_b32 v17, v17, v20, s[96:97]
v_mfma_f32_16x16x32_bf16 v[200:203], a[172:175], a[108:111], v[200:203]
v_cndmask_b32 v18, v18, v21, s[96:97]
v_mul_u32_u24 v19, 7282, v16
v_mfma_f32_16x16x32_bf16 v[88:91], a[164:167], a[108:111], v[88:91]
v_lshrrev_b32 v19, 16, v19
v_mul_u32_u24 v20, 9, v19
v_mfma_f32_16x16x32_bf16 v[88:91], a[160:163], a[104:107], v[88:91]
s_waitcnt lgkmcnt(0)
v_sub_u32 v16, v16, v20
v_and_b32 v20, 1, v19
v_mfma_f32_16x16x32_bf16 v[36:39], a[128:131], a[80:83], v[36:39]
s_waitcnt vmcnt(24)
v_lshlrev_b32 v20, 2, v20
v_cndmask_b32 v20, 0, v20, s[96:97]
v_mfma_f32_16x16x32_bf16 v[36:39], a[132:135], a[84:87], v[36:39]
s_barrier
v_mfma_f32_16x16x32_bf16 v[44:47], a[140:143], a[84:87], v[44:47]
ds_read_b128 a[96:99], v9 offset:4096
v_xor_b32 v18, v18, v20
v_mfma_f32_16x16x32_bf16 v[44:47], a[136:139], a[80:83], v[44:47]
s_xor_b32 s75, s93, 5
s_lshl_b32 s76, s75, 19
s_add_u32 s76, s76, s74
v_mfma_f32_16x16x32_bf16 v[32:35], a[144:147], a[80:83], v[32:35]
s_lshl_b32 s79, s75, 13
s_add_u32 s79, s79, s78
ds_read_b128 a[100:103], v10 offset:4096
v_mfma_f32_16x16x32_bf16 v[32:35], a[148:151], a[84:87], v[32:35]
s_add_u32 m0, s77, 0
s_add_u32 s64, s76, 0
ds_read_b128 a[104:107], v9 offset:6144
v_mfma_f32_16x16x32_bf16 v[52:55], a[156:159], a[84:87], v[52:55]
buffer_load_dwordx4 v7, s[20:23], s64 offen lds
v_mfma_f32_16x16x32_bf16 v[52:55], a[152:155], a[80:83], v[52:55]
s_add_u32 s53, s88, 524288
ds_read_b64_tr_b16 a[160:161], v11 offset:16384
ds_read_b64_tr_b16 a[162:163], v11 offset:16896
v_mfma_f32_16x16x32_bf16 v[60:63], a[64:67], a[80:83], v[60:63]
buffer_store_dwordx4 v[112:115], v4, s[24:27], s53 offen offset:2048 sc1
v_mfma_f32_16x16x32_bf16 v[60:63], a[68:71], a[84:87], v[60:63]
ds_read_b128 a[108:111], v10 offset:6144
v_lshl_add_u32 v19, v19, 2, v17
v_mfma_f32_16x16x32_bf16 v[68:71], a[76:79], a[84:87], v[68:71]
buffer_load_dwordx4 v8, s[20:23], s64 offen offset:1024 lds
v_mfma_f32_16x16x32_bf16 v[68:71], a[72:75], a[80:83], v[68:71]
ds_read_b64_tr_b16 a[164:165], v11 offset:20480
ds_read_b64_tr_b16 a[166:167], v11 offset:20992
v_mfma_f32_16x16x32_bf16 v[76:79], a[72:75], a[88:91], v[76:79]
v_add_u32 v9, 32768, v9
v_add_u32 v10, 32768, v10
v_mfma_f32_16x16x32_bf16 v[76:79], a[76:79], a[92:95], v[76:79]
ds_read_b64_tr_b16 a[168:169], v12 offset:16384
ds_read_b64_tr_b16 a[170:171], v12 offset:16896
v_mfma_f32_16x16x32_bf16 v[84:87], a[68:71], a[92:95], v[84:87]
s_add_u32 m0, s80, 0
s_add_u32 s64, s79, 0
v_mul_u32_u24 v19, 344064, v19
v_mfma_f32_16x16x32_bf16 v[84:87], a[64:67], a[88:91], v[84:87]
ds_read_b64_tr_b16 a[172:173], v12 offset:20480
ds_read_b64_tr_b16 a[174:175], v12 offset:20992
v_mfma_f32_16x16x32_bf16 v[92:95], a[152:155], a[88:91], v[92:95]
buffer_load_dwordx4 v4, s[24:27], s64 offen sc1 lds
v_mfma_f32_16x16x32_bf16 v[92:95], a[156:159], a[92:95], v[92:95]
v_lshrrev_b32 v20, 1, v16
v_sub_u32 v20, v20, v17
v_mfma_f32_16x16x32_bf16 v[40:43], a[148:151], a[92:95], v[40:43]
ds_read_b64_tr_b16 a[176:177], v13 offset:16384
ds_read_b64_tr_b16 a[178:179], v13 offset:16896
v_mfma_f32_16x16x32_bf16 v[40:43], a[144:147], a[88:91], v[40:43]
v_add_u32 v20, 3, v20
v_and_b32 v20, 3, v20
v_mfma_f32_16x16x32_bf16 v[100:103], a[136:139], a[88:91], v[100:103]
s_add_u32 m0, s73, 69632
s_add_u32 s64, s72, 0
v_cmp_eq_u32 s[96:97], 8, v16
v_mfma_f32_16x16x32_bf16 v[100:103], a[140:143], a[92:95], v[100:103]
ds_read_b64_tr_b16 a[180:181], v13 offset:20480
ds_read_b64_tr_b16 a[182:183], v13 offset:20992
v_mfma_f32_16x16x32_bf16 v[108:111], a[132:135], a[92:95], v[108:111]
buffer_load_dwordx4 v5, s[12:15], s64 offen lds
v_mfma_f32_16x16x32_bf16 v[108:111], a[128:131], a[88:91], v[108:111]
s_waitcnt lgkmcnt(14)
ds_read_b64_tr_b16 a[184:185], v14 offset:16384
ds_read_b64_tr_b16 a[186:187], v14 offset:16896
v_mfma_f32_16x16x32_bf16 v[116:119], a[128:131], a[96:99], v[116:119]
ds_read_b64_tr_b16 a[188:189], v14 offset:20480
ds_read_b64_tr_b16 a[190:191], v14 offset:20992
v_mfma_f32_16x16x32_bf16 v[116:119], a[132:135], a[100:103], v[116:119]
v_and_b32 v16, 1, v16
v_lshl_add_u32 v21, v20, 1, v16
v_mfma_f32_16x16x32_bf16 v[124:127], a[140:143], a[100:103], v[124:127]
v_and_b32 v22, 1, v18
v_lshl_add_u32 v19, v22, 10, v19
v_mfma_f32_16x16x32_bf16 v[124:127], a[136:139], a[96:99], v[124:127]
ds_read_b128 a[112:115], v4 offset:24576
v_and_b32 v18, -2, v18
v_mfma_f32_16x16x32_bf16 v[132:135], a[144:147], a[96:99], v[132:135]
buffer_load_dwordx4 v6, s[12:15], s64 offen offset:1024 lds
v_mfma_f32_16x16x32_bf16 v[132:135], a[148:151], a[100:103], v[132:135]
ds_read_b128 a[116:119], v4 offset:26624
v_add_u32 v21, 1, v21
v_mfma_f32_16x16x32_bf16 v[140:143], a[156:159], a[100:103], v[140:143]
v_cndmask_b32 v21, v21, 0, s[96:97]
v_cndmask_b32 v20, v20, 0, s[96:97]
v_mfma_f32_16x16x32_bf16 v[140:143], a[152:155], a[96:99], v[140:143]
s_add_u32 s53, s88, 524288
ds_read_b128 a[120:123], v4 offset:25600
v_sub_u32 v17, 37, v18
v_mfma_f32_16x16x32_bf16 v[148:151], a[64:67], a[96:99], v[148:151]
s_add_u32 m0, s73, 71680
s_add_u32 s64, s72, 18432
v_min_u32 v17, 2, v17
v_mfma_f32_16x16x32_bf16 v[148:151], a[68:71], a[100:103], v[148:151]
ds_read_b128 a[124:127], v4 offset:27648
v_mul_u32_u24 v21, v21, v17
v_mfma_f32_16x16x32_bf16 v[48:51], a[76:79], a[100:103], v[48:51]
buffer_load_dwordx4 v5, s[12:15], s64 offen lds
v_mfma_f32_16x16x32_bf16 v[48:51], a[72:75], a[96:99], v[48:51]
s_waitcnt lgkmcnt(15)
v_mul_u32_u24 v22, v16, v17
v_min_u32 v23, 8, v18
v_mfma_f32_16x16x32_bf16 v[156:159], a[72:75], a[104:107], v[156:159]
buffer_store_dwordx4 v[120:123], v4, s[24:27], s53 offen offset:3072 sc1
v_mfma_f32_16x16x32_bf16 v[156:159], a[76:79], a[108:111], v[156:159]
v_mad_u32_u24 v21, v18, 5, v21
v_lshl_add_u32 v21, v23, 1, v21
v_mfma_f32_16x16x32_bf16 v[164:167], a[68:71], a[108:111], v[164:167]
v_lshl_add_u32 v22, v18, 1, v22
v_mad_u32_u24 v22, v20, 37, v22
v_mfma_f32_16x16x32_bf16 v[164:167], a[64:67], a[104:107], v[164:167]
v_mad_u32_u24 v22, v20, 37, v22
v_lshl_add_u32 v20, v20, 6, v18
v_mfma_f32_16x16x32_bf16 v[172:175], a[152:155], a[104:107], v[172:175]
buffer_load_dwordx4 v6, s[12:15], s64 offen offset:1024 lds
v_mfma_f32_16x16x32_bf16 v[172:175], a[156:159], a[108:111], v[172:175]
v_mov_b32 v23, 136
v_cmp_gt_u32 s[96:97], v23, v20
v_mfma_f32_16x16x32_bf16 v[56:59], a[148:151], a[108:111], v[56:59]
v_add_u32 v22, 37, v22
v_add_u32 v19, 38797312, v19
v_mfma_f32_16x16x32_bf16 v[56:59], a[144:147], a[104:107], v[56:59]
v_cndmask_b32 v21, v22, v21, s[96:97]
v_lshl_add_u32 v19, v21, 10, v19
v_mfma_f32_16x16x32_bf16 v[180:183], a[136:139], a[104:107], v[180:183]
s_cmp_eq_u32 s54, 1
s_cselect_b32 s96, 16, 0
v_mfma_f32_16x16x32_bf16 v[180:183], a[140:143], a[108:111], v[180:183]
s_cmp_eq_u32 s3, 3
s_cselect_b32 s52, 32, 0
s_or_b32 s96, s96, s52
v_mfma_f32_16x16x32_bf16 v[188:191], a[132:135], a[108:111], v[188:191]
s_cmp_ge_u32 s2, 240
s_cselect_b32 s52, 32, 0
s_or_b32 s96, s96, s52
v_mfma_f32_16x16x32_bf16 v[188:191], a[128:131], a[104:107], v[188:191]
s_waitcnt lgkmcnt(0)
s_mov_b32 s97, 0
v_mfma_f32_16x16x32_bf16 v[196:199], a[160:163], a[80:83], v[196:199]
s_waitcnt vmcnt(18)
v_mov_b32 v20, 2147418112
v_cndmask_b32 v26, v19, v20, s[96:97]
v_mfma_f32_16x16x32_bf16 v[196:199], a[164:167], a[84:87], v[196:199]
s_barrier
v_mfma_f32_16x16x32_bf16 v[64:67], a[172:175], a[84:87], v[64:67]
ds_read_b64_tr_b16 a[128:129], v11 offset:32768
ds_read_b64_tr_b16 a[130:131], v11 offset:33280
v_mfma_f32_16x16x32_bf16 v[64:67], a[168:171], a[80:83], v[64:67]
s_add_u32 m0, s77, 16384
s_add_u32 s64, s76, 128
v_lshlrev_b32 v27, 3, v1
v_mfma_f32_16x16x32_bf16 v[204:207], a[176:179], a[80:83], v[204:207]
buffer_load_dwordx4 v7, s[20:23], s64 offen lds
v_mfma_f32_16x16x32_bf16 v[204:207], a[180:183], a[84:87], v[204:207]
ds_read_b64_tr_b16 a[132:133], v11 offset:36864
ds_read_b64_tr_b16 a[134:135], v11 offset:37376
v_mfma_f32_16x16x32_bf16 v[212:215], a[188:191], a[84:87], v[212:215]
ds_read_b64_tr_b16 a[136:137], v12 offset:32768
ds_read_b64_tr_b16 a[138:139], v12 offset:33280
v_mfma_f32_16x16x32_bf16 v[212:215], a[184:187], a[80:83], v[212:215]
ds_read_b64_tr_b16 a[140:141], v12 offset:36864
ds_read_b64_tr_b16 a[142:143], v12 offset:37376
v_mfma_f32_16x16x32_bf16 v[72:75], a[112:115], a[80:83], v[72:75]
buffer_atomic_add v1, v0, s[24:27], s90 offen offset:4 sc1
v_mfma_f32_16x16x32_bf16 v[72:75], a[116:119], a[84:87], v[72:75]
ds_read_b64_tr_b16 a[144:145], v13 offset:32768
ds_read_b64_tr_b16 a[146:147], v13 offset:33280
v_mfma_f32_16x16x32_bf16 v[220:223], a[124:127], a[84:87], v[220:223]
buffer_load_dwordx4 v8, s[20:23], s64 offen offset:1024 lds
v_mfma_f32_16x16x32_bf16 v[220:223], a[120:123], a[80:83], v[220:223]
s_add_u32 s53, s88, 786432
ds_read_b64_tr_b16 a[148:149], v13 offset:36864
ds_read_b64_tr_b16 a[150:151], v13 offset:37376
v_mfma_f32_16x16x32_bf16 v[252:255], a[120:123], a[88:91], v[252:255]
buffer_store_dwordx4 v[128:131], v4, s[24:27], s53 offen offset:0 sc1
v_mfma_f32_16x16x32_bf16 v[252:255], a[124:127], a[92:95], v[252:255]
ds_read_b64_tr_b16 a[152:153], v14 offset:32768
ds_read_b64_tr_b16 a[154:155], v14 offset:33280
v_mfma_f32_16x16x32_bf16 v[160:163], a[116:119], a[92:95], v[160:163]
s_add_u32 m0, s80, 16384
s_add_u32 s64, s79, 2048
v_add_u32 v27, s83, v27
v_mfma_f32_16x16x32_bf16 v[160:163], a[112:115], a[88:91], v[160:163]
ds_read_b64_tr_b16 a[156:157], v14 offset:36864
ds_read_b64_tr_b16 a[158:159], v14 offset:37376
v_mfma_f32_16x16x32_bf16 v[228:231], a[184:187], a[88:91], v[228:231]
buffer_load_dwordx4 v4, s[24:27], s64 offen sc1 lds
v_mfma_f32_16x16x32_bf16 v[228:231], a[188:191], a[92:95], v[228:231]
s_xor_b32 s65, s70, 768
s_add_u32 s71, s68, s65
s_add_u32 s72, s69, s65
v_mfma_f32_16x16x32_bf16 v[168:171], a[180:183], a[92:95], v[168:171]
ds_read_b128 a[64:67], v4 offset:40960
v_lshrrev_b32 v22, 3, v1
v_mfma_f32_16x16x32_bf16 v[168:171], a[176:179], a[88:91], v[168:171]
v_mul_u32_u24 v22, 1152, v22
v_and_b32 v23, 7, v1
v_mfma_f32_16x16x32_bf16 v[176:179], a[168:171], a[88:91], v[176:179]
s_add_u32 m0, s73, 0
s_add_u32 s64, s71, 0
ds_read_b128 a[80:83], v9 offset:0
v_mfma_f32_16x16x32_bf16 v[176:179], a[172:175], a[92:95], v[176:179]
v_lshl_add_u32 v22, v23, 4, v22
v_lshrrev_b32 v23, 2, v1
v_mfma_f32_16x16x32_bf16 v[80:83], a[164:167], a[92:95], v[80:83]
buffer_load_dwordx4 v5, s[12:15], s64 offen lds
v_mfma_f32_16x16x32_bf16 v[80:83], a[160:163], a[88:91], v[80:83]
L_PAD6:
s_cbranch_execz L_PAD10
ds_read_b128 a[68:71], v4 offset:43008
v_mul_u32_u24 v23, 96, v23
v_mfma_f32_16x16x32_bf16 v[184:187], a[160:163], a[96:99], v[184:187]
ds_read_b128 a[84:87], v10 offset:0
v_add_u32 v23, v23, v27
v_mfma_f32_16x16x32_bf16 v[184:187], a[164:167], a[100:103], v[184:187]
v_and_b32 v16, 3, v1
v_cmp_eq_u32 s[96:97], 0, v16
v_mfma_f32_16x16x32_bf16 v[248:251], a[172:175], a[100:103], v[248:251]
v_mov_b32 v16, 0x3f803f80
v_mfma_f32_16x16x32_bf16 v[248:251], a[168:171], a[96:99], v[248:251]
ds_read_b128 a[72:75], v4 offset:41984
v_cndmask_b32 v16, 0, v16, s[96:97]
v_mfma_f32_16x16x32_bf16 v[240:243], a[176:179], a[96:99], v[240:243]
buffer_load_dwordx4 v6, s[12:15], s64 offen offset:1024 lds
v_mfma_f32_16x16x32_bf16 v[240:243], a[180:183], a[100:103], v[240:243]
ds_read_b128 a[88:91], v9 offset:2048
v_accvgpr_write_b32 a240, v16
v_mfma_f32_16x16x32_bf16 v[232:235], a[188:191], a[100:103], v[232:235]
v_accvgpr_write_b32 a241, v16
v_accvgpr_write_b32 a242, v16
v_mfma_f32_16x16x32_bf16 v[232:235], a[184:187], a[96:99], v[232:235]
ds_read_b128 a[76:79], v4 offset:44032
v_accvgpr_write_b32 a243, v16
v_mfma_f32_16x16x32_bf16 v[236:239], a[112:115], a[96:99], v[236:239]
s_add_u32 m0, s73, 2048
s_add_u32 s64, s71, 18432
v_accvgpr_write_b32 a232, 0
v_mfma_f32_16x16x32_bf16 v[236:239], a[116:119], a[100:103], v[236:239]
ds_read_b128 a[92:95], v10 offset:2048
v_accvgpr_write_b32 a233, 0
v_mfma_f32_16x16x32_bf16 v[224:227], a[124:127], a[100:103], v[224:227]
buffer_load_dwordx4 v5, s[12:15], s64 offen lds
v_mfma_f32_16x16x32_bf16 v[224:227], a[120:123], a[96:99], v[224:227]
v_accvgpr_write_b32 a234, 0
v_accvgpr_write_b32 a235, 0
v_mfma_f32_16x16x32_bf16 v[208:211], a[120:123], a[104:107], v[208:211]
v_accvgpr_write_b32 a236, 0
v_accvgpr_write_b32 a237, 0
v_mfma_f32_16x16x32_bf16 v[208:211], a[124:127], a[108:111], v[208:211]
s_add_u32 s53, s88, 786432
v_accvgpr_write_b32 a238, 0
v_accvgpr_write_b32 a239, 0
v_mfma_f32_16x16x32_bf16 v[216:219], a[116:119], a[108:111], v[216:219]
buffer_store_dwordx4 v[136:139], v4, s[24:27], s53 offen offset:1024 sc1
v_mfma_f32_16x16x32_bf16 v[216:219], a[112:115], a[104:107], v[216:219]
v_lshlrev_b32 v16, 2, v3
v_sub_u32 v16, v2, v16
v_mfma_f32_16x16x32_bf16 v[244:247], a[184:187], a[104:107], v[244:247]
buffer_load_dwordx4 v6, s[12:15], s64 offen offset:1024 lds
v_mfma_f32_16x16x32_bf16 v[244:247], a[188:191], a[108:111], v[244:247]
v_cmp_gt_i32 s[56:57], 0, v16
v_cmp_gt_i32 s[58:59], 1, v16
v_mfma_f32_16x16x32_bf16 v[192:195], a[180:183], a[108:111], v[192:195]
v_cmp_gt_i32 s[60:61], 2, v16
v_cmp_gt_i32 s[62:63], 3, v16
v_mfma_f32_16x16x32_bf16 v[192:195], a[176:179], a[104:107], v[192:195]
v_cmp_eq_u32 s[96:97], 3, v3
v_add_u32 v17, 48, v2
v_mfma_f32_16x16x32_bf16 v[200:203], a[168:171], a[104:107], v[200:203]
v_lshlrev_b32 v17, 2, v17
v_lshlrev_b32 v18, 16, v3
v_mfma_f32_16x16x32_bf16 v[200:203], a[172:175], a[108:111], v[200:203]
v_lshl_add_u32 v18, v2, 4, v18
v_add_u32 v19, 0x8000, v18
v_mfma_f32_16x16x32_bf16 v[88:91], a[164:167], a[108:111], v[88:91]
v_cndmask_b32 v19, v19, v20, s[96:97]
v_cmp_eq_u32 s[96:97], 0, v3
v_mfma_f32_16x16x32_bf16 v[88:91], a[160:163], a[104:107], v[88:91]
s_waitcnt lgkmcnt(0)
v_mfma_f32_16x16x32_bf16 v[36:39], a[128:131], a[80:83], v[36:39]
s_waitcnt vmcnt(24)
v_cndmask_b32 v18, v18, v20, s[96:97]
v_cndmask_b32 v19, v19, v20, s[96:97]
v_mfma_f32_16x16x32_bf16 v[36:39], a[132:135], a[84:87], v[36:39]
s_barrier
v_mfma_f32_16x16x32_bf16 v[44:47], a[140:143], a[84:87], v[44:47]
ds_read_b128 a[96:99], v9 offset:4096
v_mfma_f32_16x16x32_bf16 v[44:47], a[136:139], a[80:83], v[44:47]
s_xor_b32 s75, s93, 6
s_lshl_b32 s76, s75, 19
s_add_u32 s76, s76, s74
v_mfma_f32_16x16x32_bf16 v[32:35], a[144:147], a[80:83], v[32:35]
s_lshl_b32 s79, s75, 13
s_add_u32 s79, s79, s78
ds_read_b128 a[100:103], v10 offset:4096
v_mfma_f32_16x16x32_bf16 v[32:35], a[148:151], a[84:87], v[32:35]
s_add_u32 m0, s77, 32768
s_add_u32 s64, s76, 0
ds_read_b128 a[104:107], v9 offset:6144
v_mfma_f32_16x16x32_bf16 v[52:55], a[156:159], a[84:87], v[52:55]
buffer_load_dwordx4 v7, s[20:23], s64 offen lds
v_mfma_f32_16x16x32_bf16 v[52:55], a[152:155], a[80:83], v[52:55]
ds_read_b64_tr_b16 a[160:161], v11 offset:49152
ds_read_b64_tr_b16 a[162:163], v11 offset:49664
v_mfma_f32_16x16x32_bf16 v[60:63], a[64:67], a[80:83], v[60:63]
v_mfma_f32_16x16x32_bf16 v[60:63], a[68:71], a[84:87], v[60:63]
ds_read_b128 a[108:111], v10 offset:6144
v_mfma_f32_16x16x32_bf16 v[68:71], a[76:79], a[84:87], v[68:71]
buffer_load_dwordx4 v8, s[20:23], s64 offen offset:1024 lds
v_mfma_f32_16x16x32_bf16 v[68:71], a[72:75], a[80:83], v[68:71]
ds_read_b64_tr_b16 a[164:165], v11 offset:53248
ds_read_b64_tr_b16 a[166:167], v11 offset:53760
v_mfma_f32_16x16x32_bf16 v[76:79], a[72:75], a[88:91], v[76:79]
v_add_u32 v9, 32768, v9
v_add_u32 v10, 32768, v10
v_mfma_f32_16x16x32_bf16 v[76:79], a[76:79], a[92:95], v[76:79]
ds_read_b64_tr_b16 a[168:169], v12 offset:49152
ds_read_b64_tr_b16 a[170:171], v12 offset:49664
v_mfma_f32_16x16x32_bf16 v[84:87], a[68:71], a[92:95], v[84:87]
s_add_u32 m0, s80, 32768
s_add_u32 s64, s79, 0
v_mfma_f32_16x16x32_bf16 v[84:87], a[64:67], a[88:91], v[84:87]
ds_read_b64_tr_b16 a[172:173], v12 offset:53248
ds_read_b64_tr_b16 a[174:175], v12 offset:53760
v_mfma_f32_16x16x32_bf16 v[92:95], a[152:155], a[88:91], v[92:95]
buffer_load_dwordx4 v4, s[24:27], s64 offen sc1 lds
v_mfma_f32_16x16x32_bf16 v[92:95], a[156:159], a[92:95], v[92:95]
s_add_u32 s53, s88, 786432
v_mfma_f32_16x16x32_bf16 v[40:43], a[148:151], a[92:95], v[40:43]
ds_read_b64_tr_b16 a[176:177], v13 offset:49152
ds_read_b64_tr_b16 a[178:179], v13 offset:49664
v_mfma_f32_16x16x32_bf16 v[40:43], a[144:147], a[88:91], v[40:43]
buffer_store_dwordx4 v[144:147], v4, s[24:27], s53 offen offset:2048 sc1
v_mfma_f32_16x16x32_bf16 v[100:103], a[136:139], a[88:91], v[100:103]
s_add_u32 m0, s73, 4096
s_add_u32 s64, s72, 0
v_mfma_f32_16x16x32_bf16 v[100:103], a[140:143], a[92:95], v[100:103]
ds_read_b64_tr_b16 a[180:181], v13 offset:53248
ds_read_b64_tr_b16 a[182:183], v13 offset:53760
v_mfma_f32_16x16x32_bf16 v[108:111], a[132:135], a[92:95], v[108:111]
buffer_load_dwordx4 v5, s[12:15], s64 offen lds
v_mfma_f32_16x16x32_bf16 v[108:111], a[128:131], a[88:91], v[108:111]
s_waitcnt lgkmcnt(14)
ds_read_b64_tr_b16 a[184:185], v14 offset:49152
ds_read_b64_tr_b16 a[186:187], v14 offset:49664
v_mfma_f32_16x16x32_bf16 v[116:119], a[128:131], a[96:99], v[116:119]
ds_read_b64_tr_b16 a[188:189], v14 offset:53248
ds_read_b64_tr_b16 a[190:191], v14 offset:53760
v_mfma_f32_16x16x32_bf16 v[116:119], a[132:135], a[100:103], v[116:119]
v_mfma_f32_16x16x32_bf16 v[124:127], a[140:143], a[100:103], v[124:127]
v_mfma_f32_16x16x32_bf16 v[124:127], a[136:139], a[96:99], v[124:127]
ds_read_b128 a[112:115], v4 offset:57344
v_mfma_f32_16x16x32_bf16 v[132:135], a[144:147], a[96:99], v[132:135]
buffer_load_dwordx4 v6, s[12:15], s64 offen offset:1024 lds
v_mfma_f32_16x16x32_bf16 v[132:135], a[148:151], a[100:103], v[132:135]
ds_read_b128 a[116:119], v4 offset:59392
v_mfma_f32_16x16x32_bf16 v[140:143], a[156:159], a[100:103], v[140:143]
v_mfma_f32_16x16x32_bf16 v[140:143], a[152:155], a[96:99], v[140:143]
ds_read_b128 a[120:123], v4 offset:58368
v_mfma_f32_16x16x32_bf16 v[148:151], a[64:67], a[96:99], v[148:151]
s_add_u32 m0, s73, 6144
s_add_u32 s64, s72, 18432
v_mfma_f32_16x16x32_bf16 v[148:151], a[68:71], a[100:103], v[148:151]
ds_read_b128 a[124:127], v4 offset:60416
v_mfma_f32_16x16x32_bf16 v[48:51], a[76:79], a[100:103], v[48:51]
buffer_load_dwordx4 v5, s[12:15], s64 offen lds
v_mfma_f32_16x16x32_bf16 v[48:51], a[72:75], a[96:99], v[48:51]
s_waitcnt lgkmcnt(15)
v_mfma_f32_16x16x32_bf16 v[156:159], a[72:75], a[104:107], v[156:159]
v_mfma_f32_16x16x32_bf16 v[156:159], a[76:79], a[108:111], v[156:159]
v_mfma_f32_16x16x32_bf16 v[164:167], a[68:71], a[108:111], v[164:167]
v_mfma_f32_16x16x32_bf16 v[164:167], a[64:67], a[104:107], v[164:167]
v_mfma_f32_16x16x32_bf16 v[172:175], a[152:155], a[104:107], v[172:175]
buffer_load_dwordx4 v6, s[12:15], s64 offen offset:1024 lds
v_mfma_f32_16x16x32_bf16 v[172:175], a[156:159], a[108:111], v[172:175]
v_mfma_f32_16x16x32_bf16 v[56:59], a[148:151], a[108:111], v[56:59]
v_mfma_f32_16x16x32_bf16 v[56:59], a[144:147], a[104:107], v[56:59]
s_add_u32 s53, s88, 786432
v_mfma_f32_16x16x32_bf16 v[180:183], a[136:139], a[104:107], v[180:183]
buffer_store_dwordx4 v[152:155], v4, s[24:27], s53 offen offset:3072 sc1
v_mfma_f32_16x16x32_bf16 v[180:183], a[140:143], a[108:111], v[180:183]
v_mfma_f32_16x16x32_bf16 v[188:191], a[132:135], a[108:111], v[188:191]
v_mfma_f32_16x16x32_bf16 v[188:191], a[128:131], a[104:107], v[188:191]
s_waitcnt lgkmcnt(0)
v_mov_b32 v96, 0
v_mov_b32 v97, 0
v_mfma_f32_16x16x32_bf16 v[196:199], a[160:163], a[80:83], v[196:199]
s_waitcnt vmcnt(19)
v_mov_b32 v98, 0
v_mov_b32 v99, 0
v_mfma_f32_16x16x32_bf16 v[196:199], a[164:167], a[84:87], v[196:199]
s_barrier
v_mfma_f32_16x16x32_bf16 v[64:67], a[172:175], a[84:87], v[64:67]
ds_read_b64_tr_b16 a[128:129], v11 offset:0
ds_read_b64_tr_b16 a[130:131], v11 offset:512
v_mfma_f32_16x16x32_bf16 v[64:67], a[168:171], a[80:83], v[64:67]
s_add_u32 m0, s77, 49152
s_add_u32 s64, s76, 128
v_mov_b32 v104, 0
v_mfma_f32_16x16x32_bf16 v[204:207], a[176:179], a[80:83], v[204:207]
buffer_load_dwordx4 v7, s[20:23], s64 offen lds
v_mfma_f32_16x16x32_bf16 v[204:207], a[180:183], a[84:87], v[204:207]
ds_read_b64_tr_b16 a[132:133], v11 offset:4096
ds_read_b64_tr_b16 a[134:135], v11 offset:4608
v_mfma_f32_16x16x32_bf16 v[212:215], a[188:191], a[84:87], v[212:215]
ds_read_b64_tr_b16 a[136:137], v12 offset:0
ds_read_b64_tr_b16 a[138:139], v12 offset:512
v_mfma_f32_16x16x32_bf16 v[212:215], a[184:187], a[80:83], v[212:215]
ds_read_b64_tr_b16 a[140:141], v12 offset:4096
ds_read_b64_tr_b16 a[142:143], v12 offset:4608
v_mfma_f32_16x16x32_bf16 v[72:75], a[112:115], a[80:83], v[72:75]
buffer_load_dword v30, v29, s[24:27], s89 offen offset:4 sc1
v_mfma_f32_16x16x32_bf16 v[72:75], a[116:119], a[84:87], v[72:75]
ds_read_b64_tr_b16 a[144:145], v13 offset:0
ds_read_b64_tr_b16 a[146:147], v13 offset:512
v_mfma_f32_16x16x32_bf16 v[220:223], a[124:127], a[84:87], v[220:223]
buffer_load_dwordx4 v8, s[20:23], s64 offen offset:1024 lds
v_mfma_f32_16x16x32_bf16 v[220:223], a[120:123], a[80:83], v[220:223]
ds_read_b64_tr_b16 a[148:149], v13 offset:4096
ds_read_b64_tr_b16 a[150:151], v13 offset:4608
v_mfma_f32_16x16x32_bf16 v[252:255], a[120:123], a[88:91], v[252:255]
v_mov_b32 v105, 0
v_mov_b32 v106, 0
v_mfma_f32_16x16x32_bf16 v[252:255], a[124:127], a[92:95], v[252:255]
ds_read_b64_tr_b16 a[152:153], v14 offset:0
ds_read_b64_tr_b16 a[154:155], v14 offset:512
v_mfma_f32_16x16x32_bf16 v[160:163], a[116:119], a[92:95], v[160:163]
s_add_u32 m0, s80, 49152
s_add_u32 s64, s79, 2048
v_mov_b32 v107, 0
v_mfma_f32_16x16x32_bf16 v[160:163], a[112:115], a[88:91], v[160:163]
ds_read_b64_tr_b16 a[156:157], v14 offset:4096
ds_read_b64_tr_b16 a[158:159], v14 offset:4608
v_mfma_f32_16x16x32_bf16 v[228:231], a[184:187], a[88:91], v[228:231]
buffer_load_dwordx4 v4, s[24:27], s64 offen sc1 lds
v_mfma_f32_16x16x32_bf16 v[228:231], a[188:191], a[92:95], v[228:231]
s_xor_b32 s65, s70, 896
s_add_u32 s71, s68, s65
s_add_u32 s72, s69, s65
v_mfma_f32_16x16x32_bf16 v[168:171], a[180:183], a[92:95], v[168:171]
ds_read_b128 a[64:67], v4 offset:8192
v_mov_b32 v112, 0
v_mfma_f32_16x16x32_bf16 v[168:171], a[176:179], a[88:91], v[168:171]
v_mov_b32 v113, 0
v_mov_b32 v114, 0
v_mfma_f32_16x16x32_bf16 v[176:179], a[168:171], a[88:91], v[176:179]
s_add_u32 m0, s73, 32768
s_add_u32 s64, s71, 0
ds_read_b128 a[80:83], v9 offset:0
v_mfma_f32_16x16x32_bf16 v[176:179], a[172:175], a[92:95], v[176:179]
v_mov_b32 v115, 0
v_mov_b32 v120, 0
v_mfma_f32_16x16x32_bf16 v[80:83], a[164:167], a[92:95], v[80:83]
buffer_load_dwordx4 v5, s[12:15], s64 offen lds
v_mfma_f32_16x16x32_bf16 v[80:83], a[160:163], a[88:91], v[80:83]
s_add_u32 s53, s87, 524288
ds_read_b128 a[68:71], v4 offset:10240
v_mov_b32 v121, 0
v_mfma_f32_16x16x32_bf16 v[184:187], a[160:163], a[96:99], v[184:187]
ds_read_b128 a[84:87], v10 offset:0
v_mov_b32 v122, 0
v_mfma_f32_16x16x32_bf16 v[184:187], a[164:167], a[100:103], v[184:187]
buffer_store_dwordx4 a[28:31], v4, s[24:27], s53 offen offset:0 sc1
v_mfma_f32_16x16x32_bf16 v[248:251], a[172:175], a[100:103], v[248:251]
v_mov_b32 v123, 0
v_mov_b32 v128, 0
v_mfma_f32_16x16x32_bf16 v[248:251], a[168:171], a[96:99], v[248:251]
ds_read_b128 a[72:75], v4 offset:9216
v_mov_b32 v129, 0
v_mfma_f32_16x16x32_bf16 v[240:243], a[176:179], a[96:99], v[240:243]
buffer_load_dwordx4 v6, s[12:15], s64 offen offset:1024 lds
v_mfma_f32_16x16x32_bf16 v[240:243], a[180:183], a[100:103], v[240:243]
ds_read_b128 a[88:91], v9 offset:2048
v_mov_b32 v130, 0
v_mfma_f32_16x16x32_bf16 v[232:235], a[188:191], a[100:103], v[232:235]
v_mov_b32 v131, 0
v_mov_b32 v136, 0
v_mfma_f32_16x16x32_bf16 v[232:235], a[184:187], a[96:99], v[232:235]
ds_read_b128 a[76:79], v4 offset:11264
v_mov_b32 v137, 0
v_mfma_f32_16x16x32_bf16 v[236:239], a[112:115], a[96:99], v[236:239]
s_add_u32 m0, s73, 34816
s_add_u32 s64, s71, 18432
v_mov_b32 v138, 0
v_mfma_f32_16x16x32_bf16 v[236:239], a[116:119], a[100:103], v[236:239]
ds_read_b128 a[92:95], v10 offset:2048
v_mov_b32 v139, 0
v_mfma_f32_16x16x32_bf16 v[224:227], a[124:127], a[100:103], v[224:227]
buffer_load_dwordx4 v5, s[12:15], s64 offen lds
v_mfma_f32_16x16x32_bf16 v[224:227], a[120:123], a[96:99], v[224:227]
v_mov_b32 v144, 0
v_mov_b32 v145, 0
v_mfma_f32_16x16x32_bf16 v[208:211], a[120:123], a[104:107], v[208:211]
v_mov_b32 v146, 0
v_mov_b32 v147, 0
v_mfma_f32_16x16x32_bf16 v[208:211], a[124:127], a[108:111], v[208:211]
v_mov_b32 v152, 0
v_mov_b32 v153, 0
v_mfma_f32_16x16x32_bf16 v[216:219], a[116:119], a[108:111], v[216:219]
v_mov_b32 v154, 0
v_mov_b32 v155, 0
v_mfma_f32_16x16x32_bf16 v[216:219], a[112:115], a[104:107], v[216:219]
v_mfma_f32_16x16x32_bf16 v[244:247], a[184:187], a[104:107], v[244:247]
buffer_load_dwordx4 v6, s[12:15], s64 offen offset:1024 lds
v_mfma_f32_16x16x32_bf16 v[244:247], a[188:191], a[108:111], v[244:247]
v_mfma_f32_16x16x32_bf16 v[192:195], a[180:183], a[108:111], v[192:195]
v_mfma_f32_16x16x32_bf16 v[192:195], a[176:179], a[104:107], v[192:195]
v_mfma_f32_16x16x32_bf16 v[200:203], a[168:171], a[104:107], v[200:203]
v_mfma_f32_16x16x32_bf16 v[200:203], a[172:175], a[108:111], v[200:203]
v_mfma_f32_16x16x32_bf16 v[88:91], a[164:167], a[108:111], v[88:91]
v_mfma_f32_16x16x32_bf16 v[88:91], a[160:163], a[104:107], v[88:91]
s_waitcnt lgkmcnt(0)
v_mfma_f32_16x16x32_bf16 v[36:39], a[128:131], a[80:83], v[36:39]
s_waitcnt vmcnt(23)
v_mfma_f32_16x16x32_bf16 v[36:39], a[132:135], a[84:87], v[36:39]
s_barrier
v_mfma_f32_16x16x32_bf16 v[44:47], a[140:143], a[84:87], v[44:47]
s_add_u32 s53, s87, 524288
ds_read_b128 a[96:99], v9 offset:4096
v_mfma_f32_16x16x32_bf16 v[44:47], a[136:139], a[80:83], v[44:47]
s_xor_b32 s75, s93, 7
s_lshl_b32 s76, s75, 19
s_add_u32 s76, s76, s74
v_mfma_f32_16x16x32_bf16 v[32:35], a[144:147], a[80:83], v[32:35]
s_lshl_b32 s79, s75, 13
s_add_u32 s79, s79, s78
ds_read_b128 a[100:103], v10 offset:4096
v_mfma_f32_16x16x32_bf16 v[32:35], a[148:151], a[84:87], v[32:35]
s_add_u32 m0, s77, 0
s_add_u32 s64, s76, 0
ds_read_b128 a[104:107], v9 offset:6144
v_mfma_f32_16x16x32_bf16 v[52:55], a[156:159], a[84:87], v[52:55]
buffer_load_dwordx4 v7, s[20:23], s64 offen lds
v_mfma_f32_16x16x32_bf16 v[52:55], a[152:155], a[80:83], v[52:55]
ds_read_b64_tr_b16 a[160:161], v11 offset:16384
ds_read_b64_tr_b16 a[162:163], v11 offset:16896
v_mfma_f32_16x16x32_bf16 v[60:63], a[64:67], a[80:83], v[60:63]
buffer_store_dwordx4 a[20:23], v4, s[24:27], s53 offen offset:1024 sc1
v_mfma_f32_16x16x32_bf16 v[60:63], a[68:71], a[84:87], v[60:63]
ds_read_b128 a[108:111], v10 offset:6144
v_mfma_f32_16x16x32_bf16 v[68:71], a[76:79], a[84:87], v[68:71]
buffer_load_dwordx4 v8, s[20:23], s64 offen offset:1024 lds
v_mfma_f32_16x16x32_bf16 v[68:71], a[72:75], a[80:83], v[68:71]
ds_read_b64_tr_b16 a[164:165], v11 offset:20480
ds_read_b64_tr_b16 a[166:167], v11 offset:20992
v_mfma_f32_16x16x32_bf16 v[76:79], a[72:75], a[88:91], v[76:79]
v_add_u32 v9, -65536, v9
v_add_u32 v10, -65536, v10
v_mfma_f32_16x16x32_bf16 v[76:79], a[76:79], a[92:95], v[76:79]
ds_read_b64_tr_b16 a[168:169], v12 offset:16384
ds_read_b64_tr_b16 a[170:171], v12 offset:16896
v_mfma_f32_16x16x32_bf16 v[84:87], a[68:71], a[92:95], v[84:87]
s_add_u32 m0, s80, 0
s_add_u32 s64, s79, 0
v_mfma_f32_16x16x32_bf16 v[84:87], a[64:67], a[88:91], v[84:87]
ds_read_b64_tr_b16 a[172:173], v12 offset:20480
ds_read_b64_tr_b16 a[174:175], v12 offset:20992
v_mfma_f32_16x16x32_bf16 v[92:95], a[152:155], a[88:91], v[92:95]
buffer_load_dwordx4 v4, s[24:27], s64 offen sc1 lds
v_mfma_f32_16x16x32_bf16 v[92:95], a[156:159], a[92:95], v[92:95]
v_mfma_f32_16x16x32_bf16 v[40:43], a[148:151], a[92:95], v[40:43]
ds_read_b64_tr_b16 a[176:177], v13 offset:16384
ds_read_b64_tr_b16 a[178:179], v13 offset:16896
v_mfma_f32_16x16x32_bf16 v[40:43], a[144:147], a[88:91], v[40:43]
v_mfma_f32_16x16x32_bf16 v[100:103], a[136:139], a[88:91], v[100:103]
s_add_u32 m0, s73, 36864
s_add_u32 s64, s72, 0
v_mfma_f32_16x16x32_bf16 v[100:103], a[140:143], a[92:95], v[100:103]
ds_read_b64_tr_b16 a[180:181], v13 offset:20480
ds_read_b64_tr_b16 a[182:183], v13 offset:20992
v_mfma_f32_16x16x32_bf16 v[108:111], a[132:135], a[92:95], v[108:111]
buffer_load_dwordx4 v5, s[12:15], s64 offen lds
v_mfma_f32_16x16x32_bf16 v[108:111], a[128:131], a[88:91], v[108:111]
s_waitcnt lgkmcnt(14)
ds_read_b64_tr_b16 a[184:185], v14 offset:16384
ds_read_b64_tr_b16 a[186:187], v14 offset:16896
v_mfma_f32_16x16x32_bf16 v[116:119], a[128:131], a[96:99], v[116:119]
ds_read_b64_tr_b16 a[188:189], v14 offset:20480
ds_read_b64_tr_b16 a[190:191], v14 offset:20992
v_mfma_f32_16x16x32_bf16 v[116:119], a[132:135], a[100:103], v[116:119]
v_mfma_f32_16x16x32_bf16 v[124:127], a[140:143], a[100:103], v[124:127]
v_mfma_f32_16x16x32_bf16 v[124:127], a[136:139], a[96:99], v[124:127]
ds_read_b128 a[112:115], v4 offset:24576
v_mfma_f32_16x16x32_bf16 v[132:135], a[144:147], a[96:99], v[132:135]
buffer_load_dwordx4 v6, s[12:15], s64 offen offset:1024 lds
v_mfma_f32_16x16x32_bf16 v[132:135], a[148:151], a[100:103], v[132:135]
s_add_u32 s53, s87, 528384
ds_read_b128 a[116:119], v4 offset:26624
v_mfma_f32_16x16x32_bf16 v[140:143], a[156:159], a[100:103], v[140:143]
buffer_store_dwordx4 a[12:15], v4, s[24:27], s53 offen offset:0 sc1
v_mfma_f32_16x16x32_bf16 v[140:143], a[152:155], a[96:99], v[140:143]
ds_read_b128 a[120:123], v4 offset:25600
v_mfma_f32_16x16x32_bf16 v[148:151], a[64:67], a[96:99], v[148:151]
s_add_u32 m0, s73, 38912
s_add_u32 s64, s72, 18432
v_mfma_f32_16x16x32_bf16 v[148:151], a[68:71], a[100:103], v[148:151]
ds_read_b128 a[124:127], v4 offset:27648
v_mfma_f32_16x16x32_bf16 v[48:51], a[76:79], a[100:103], v[48:51]
buffer_load_dwordx4 v5, s[12:15], s64 offen lds
v_mfma_f32_16x16x32_bf16 v[48:51], a[72:75], a[96:99], v[48:51]
s_waitcnt lgkmcnt(15)
v_mfma_f32_16x16x32_bf16 v[156:159], a[72:75], a[104:107], v[156:159]
v_mfma_f32_16x16x32_bf16 v[156:159], a[76:79], a[108:111], v[156:159]
v_mfma_f32_16x16x32_bf16 v[164:167], a[68:71], a[108:111], v[164:167]
v_mfma_f32_16x16x32_bf16 v[164:167], a[64:67], a[104:107], v[164:167]
v_mfma_f32_16x16x32_bf16 v[172:175], a[152:155], a[104:107], v[172:175]
buffer_load_dwordx4 v6, s[12:15], s64 offen offset:1024 lds
v_mfma_f32_16x16x32_bf16 v[172:175], a[156:159], a[108:111], v[172:175]
v_mfma_f32_16x16x32_bf16 v[56:59], a[148:151], a[108:111], v[56:59]
v_mfma_f32_16x16x32_bf16 v[56:59], a[144:147], a[104:107], v[56:59]
v_mfma_f32_16x16x32_bf16 v[180:183], a[136:139], a[104:107], v[180:183]
v_mfma_f32_16x16x32_bf16 v[180:183], a[140:143], a[108:111], v[180:183]
v_mfma_f32_16x16x32_bf16 v[188:191], a[132:135], a[108:111], v[188:191]
v_mfma_f32_16x16x32_bf16 v[188:191], a[128:131], a[104:107], v[188:191]
s_waitcnt lgkmcnt(0)
v_mfma_f32_16x16x32_bf16 v[196:199], a[160:163], a[80:83], v[196:199]
s_waitcnt vmcnt(19)
v_mfma_f32_16x16x32_bf16 v[196:199], a[164:167], a[84:87], v[196:199]
s_barrier
v_mfma_f32_16x16x32_bf16 v[64:67], a[172:175], a[84:87], v[64:67]
ds_read_b64_tr_b16 a[128:129], v11 offset:32768
ds_read_b64_tr_b16 a[130:131], v11 offset:33280
v_mfma_f32_16x16x32_bf16 v[64:67], a[168:171], a[80:83], v[64:67]
s_add_u32 m0, s77, 16384
s_add_u32 s64, s76, 128
v_mfma_f32_16x16x32_bf16 v[204:207], a[176:179], a[80:83], v[204:207]
buffer_load_dwordx4 v7, s[20:23], s64 offen lds
v_mfma_f32_16x16x32_bf16 v[204:207], a[180:183], a[84:87], v[204:207]
ds_read_b64_tr_b16 a[132:133], v11 offset:36864
ds_read_b64_tr_b16 a[134:135], v11 offset:37376
v_mfma_f32_16x16x32_bf16 v[212:215], a[188:191], a[84:87], v[212:215]
ds_read_b64_tr_b16 a[136:137], v12 offset:32768
ds_read_b64_tr_b16 a[138:139], v12 offset:33280
v_mfma_f32_16x16x32_bf16 v[212:215], a[184:187], a[80:83], v[212:215]
s_add_u32 s53, s87, 528384
ds_read_b64_tr_b16 a[140:141], v12 offset:36864
ds_read_b64_tr_b16 a[142:143], v12 offset:37376
v_mfma_f32_16x16x32_bf16 v[72:75], a[112:115], a[80:83], v[72:75]
buffer_load_dwordx4 v8, s[20:23], s64 offen offset:1024 lds
v_mfma_f32_16x16x32_bf16 v[72:75], a[116:119], a[84:87], v[72:75]
ds_read_b64_tr_b16 a[144:145], v13 offset:32768
ds_read_b64_tr_b16 a[146:147], v13 offset:33280
v_mfma_f32_16x16x32_bf16 v[220:223], a[124:127], a[84:87], v[220:223]
buffer_store_dwordx4 a[4:7], v4, s[24:27], s53 offen offset:1024 sc1
v_mfma_f32_16x16x32_bf16 v[220:223], a[120:123], a[80:83], v[220:223]
s_add_u32 m0, s80, 16384
s_add_u32 s64, s79, 2048
v_mfma_f32_16x16x32_bf16 v[252:255], a[120:123], a[88:91], v[252:255]
ds_read_b64_tr_b16 a[148:149], v13 offset:36864
ds_read_b64_tr_b16 a[150:151], v13 offset:37376
v_mfma_f32_16x16x32_bf16 v[252:255], a[124:127], a[92:95], v[252:255]
buffer_load_dwordx4 v4, s[24:27], s64 offen sc1 lds
v_mfma_f32_16x16x32_bf16 v[160:163], a[116:119], a[92:95], v[160:163]
ds_read_b64_tr_b16 a[152:153], v14 offset:32768
ds_read_b64_tr_b16 a[154:155], v14 offset:33280
v_mfma_f32_16x16x32_bf16 v[160:163], a[112:115], a[88:91], v[160:163]
ds_read_b64_tr_b16 a[156:157], v14 offset:36864
ds_read_b64_tr_b16 a[158:159], v14 offset:37376
v_mfma_f32_16x16x32_bf16 v[228:231], a[184:187], a[88:91], v[228:231]
s_add_u32 m0, s83, 0
s_add_u32 s64, s81, 0
v_mfma_f32_16x16x32_bf16 v[228:231], a[188:191], a[92:95], v[228:231]
v_mfma_f32_16x16x32_bf16 v[168:171], a[180:183], a[92:95], v[168:171]
buffer_load_dwordx4 v22, s[32:35], s64 offen lds
v_mfma_f32_16x16x32_bf16 v[168:171], a[176:179], a[88:91], v[168:171]
ds_read_b128 a[64:67], v4 offset:40960
v_mfma_f32_16x16x32_bf16 v[176:179], a[168:171], a[88:91], v[176:179]
s_add_u32 m0, s83, 1024
s_add_u32 s64, s81, 9216
ds_read_b128 a[80:83], v9 offset:0
v_mfma_f32_16x16x32_bf16 v[176:179], a[172:175], a[92:95], v[176:179]
v_mfma_f32_16x16x32_bf16 v[80:83], a[164:167], a[92:95], v[80:83]
buffer_load_dwordx4 v22, s[32:35], s64 offen lds
v_mfma_f32_16x16x32_bf16 v[80:83], a[160:163], a[88:91], v[80:83]
ds_read_b128 a[68:71], v4 offset:43008
v_mfma_f32_16x16x32_bf16 v[184:187], a[160:163], a[96:99], v[184:187]
ds_read_b128 a[84:87], v10 offset:0
v_mfma_f32_16x16x32_bf16 v[184:187], a[164:167], a[100:103], v[184:187]
s_add_u32 m0, s83, 2048
s_add_u32 s64, s81, 18432
v_mfma_f32_16x16x32_bf16 v[248:251], a[172:175], a[100:103], v[248:251]
v_mfma_f32_16x16x32_bf16 v[248:251], a[168:171], a[96:99], v[248:251]
buffer_load_dwordx4 v22, s[32:35], s64 offen lds
v_mfma_f32_16x16x32_bf16 v[240:243], a[176:179], a[96:99], v[240:243]
ds_read_b128 a[72:75], v4 offset:41984
v_mfma_f32_16x16x32_bf16 v[240:243], a[180:183], a[100:103], v[240:243]
ds_read_b128 a[88:91], v9 offset:2048
v_mfma_f32_16x16x32_bf16 v[232:235], a[188:191], a[100:103], v[232:235]
s_add_u32 m0, s83, 3072
s_add_u32 s64, s81, 27648
v_mfma_f32_16x16x32_bf16 v[232:235], a[184:187], a[96:99], v[232:235]
ds_read_b128 a[76:79], v4 offset:44032
v_mfma_f32_16x16x32_bf16 v[236:239], a[112:115], a[96:99], v[236:239]
buffer_load_dwordx4 v22, s[32:35], s64 offen lds
v_mfma_f32_16x16x32_bf16 v[236:239], a[116:119], a[100:103], v[236:239]
ds_read_b128 a[92:95], v10 offset:2048
v_mfma_f32_16x16x32_bf16 v[224:227], a[124:127], a[100:103], v[224:227]
s_add_u32 m0, s83, 4096
s_add_u32 s64, s81, 128
s_add_u32 s53, s87, 786432
v_mfma_f32_16x16x32_bf16 v[224:227], a[120:123], a[96:99], v[224:227]
buffer_store_dwordx4 a[0:3], v4, s[24:27], s53 offen offset:0 sc1
v_mfma_f32_16x16x32_bf16 v[208:211], a[120:123], a[104:107], v[208:211]
buffer_load_dwordx4 v24, s[32:35], s64 offen lds
v_mfma_f32_16x16x32_bf16 v[208:211], a[124:127], a[108:111], v[208:211]
s_waitcnt vmcnt(26)
v_mfma_f32_16x16x32_bf16 v[216:219], a[116:119], a[108:111], v[216:219]
v_cmp_gt_u32 vcc, 8, v30
v_mfma_f32_16x16x32_bf16 v[216:219], a[112:115], a[104:107], v[216:219]
s_add_u32 m0, s83, 5120
s_add_u32 s64, s82, 0
v_mfma_f32_16x16x32_bf16 v[244:247], a[184:187], a[104:107], v[244:247]
v_mfma_f32_16x16x32_bf16 v[244:247], a[188:191], a[108:111], v[244:247]
buffer_load_dwordx4 v25, s[48:51], s64 offen lds
v_mfma_f32_16x16x32_bf16 v[192:195], a[180:183], a[108:111], v[192:195]
v_mfma_f32_16x16x32_bf16 v[192:195], a[176:179], a[104:107], v[192:195]
s_cbranch_vccnz CK_KV
CK_KV_R:
v_mfma_f32_16x16x32_bf16 v[200:203], a[168:171], a[104:107], v[200:203]
v_mfma_f32_16x16x32_bf16 v[200:203], a[172:175], a[108:111], v[200:203]
v_mfma_f32_16x16x32_bf16 v[88:91], a[164:167], a[108:111], v[88:91]
v_mfma_f32_16x16x32_bf16 v[88:91], a[160:163], a[104:107], v[88:91]
s_waitcnt lgkmcnt(0)
v_mfma_f32_16x16x32_bf16 v[36:39], a[128:131], a[80:83], v[36:39]
s_waitcnt vmcnt(25)
v_mov_b32 v6, 0xf149f2ca
v_mfma_f32_16x16x32_bf16 v[36:39], a[132:135], a[84:87], v[36:39]
s_barrier
v_mfma_f32_16x16x32_bf16 v[44:47], a[140:143], a[84:87], v[44:47]
ds_read_b128 a[96:99], v9 offset:4096
v_mfma_f32_16x16x32_bf16 v[44:47], a[136:139], a[80:83], v[44:47]
s_lshl_b32 s70, s3, 12
s_add_u32 s68, s70, s94
ds_read_b128 a[100:103], v10 offset:4096
v_mfma_f32_16x16x32_bf16 v[32:35], a[144:147], a[80:83], v[32:35]
s_add_u32 m0, s70, 32768
s_cmp_lt_u32 s3, 2
s_cselect_b32 s64, s68, 2147418112
v_mfma_f32_16x16x32_bf16 v[32:35], a[148:151], a[84:87], v[32:35]
buffer_load_dwordx4 v4, s[24:27], s64 offen offset:0 sc1 lds
v_mfma_f32_16x16x32_bf16 v[52:55], a[156:159], a[84:87], v[52:55]
ds_read_b128 a[104:107], v9 offset:6144
v_mfma_f32_16x16x32_bf16 v[52:55], a[152:155], a[80:83], v[52:55]
ds_read_b64_tr_b16 a[160:161], v11 offset:49152
ds_read_b64_tr_b16 a[162:163], v11 offset:49664
v_mfma_f32_16x16x32_bf16 v[60:63], a[64:67], a[80:83], v[60:63]
s_cmp_eq_u32 s66, 0
s_cbranch_scc1 D0
D0_R:
v_mfma_f32_16x16x32_bf16 v[60:63], a[68:71], a[84:87], v[60:63]
s_lshl_b32 s52, s4, 18
s_add_u32 s52, s52, 45088768
ds_read_b128 a[108:111], v10 offset:6144
v_mfma_f32_16x16x32_bf16 v[68:71], a[76:79], a[84:87], v[68:71]
s_lshl_b32 s54, s66, 9
v_add_u32 v9, 32768, v9
v_add_u32 v10, 32768, v10
v_mfma_f32_16x16x32_bf16 v[68:71], a[72:75], a[80:83], v[68:71]
s_add_u32 s54, s54, s52
ds_read_b64_tr_b16 a[164:165], v11 offset:53248
ds_read_b64_tr_b16 a[166:167], v11 offset:53760
v_mfma_f32_16x16x32_bf16 v[76:79], a[72:75], a[88:91], v[76:79]
s_lshl_b32 s55, s67, 9
s_add_u32 s55, s55, s52
v_mfma_f32_16x16x32_bf16 v[76:79], a[76:79], a[92:95], v[76:79]
s_add_u32 s53, s87, 786432
ds_read_b64_tr_b16 a[168:169], v12 offset:49152
ds_read_b64_tr_b16 a[170:171], v12 offset:49664
v_mfma_f32_16x16x32_bf16 v[84:87], a[68:71], a[92:95], v[84:87]
buffer_load_dwordx4 v4, s[24:27], s64 offen offset:1024 sc1 lds
v_mfma_f32_16x16x32_bf16 v[84:87], a[64:67], a[88:91], v[84:87]
s_max_u32 s65, s66, 1
ds_read_b64_tr_b16 a[172:173], v12 offset:53248
ds_read_b64_tr_b16 a[174:175], v12 offset:53760
v_mfma_f32_16x16x32_bf16 v[92:95], a[152:155], a[88:91], v[92:95]
L_PAD7:
s_cbranch_execz L_PAD11
buffer_store_dwordx4 a[8:11], v4, s[24:27], s53 offen offset:1024 sc1
v_mfma_f32_16x16x32_bf16 v[92:95], a[156:159], a[92:95], v[92:95]
s_lshl_b32 s65, s65, 9
s_add_u32 s52, s52, s65
s_sub_u32 s65, s55, s52
v_mfma_f32_16x16x32_bf16 v[40:43], a[148:151], a[92:95], v[40:43]
s_sub_u32 s65, s65, 163840
ds_read_b64_tr_b16 a[176:177], v13 offset:49152
ds_read_b64_tr_b16 a[178:179], v13 offset:49664
v_mfma_f32_16x16x32_bf16 v[40:43], a[144:147], a[88:91], v[40:43]
s_add_u32 s52, s52, 65280
v_mfma_f32_16x16x32_bf16 v[100:103], a[136:139], a[88:91], v[100:103]
ds_read_b64_tr_b16 a[180:181], v13 offset:53248
ds_read_b64_tr_b16 a[182:183], v13 offset:53760
v_mfma_f32_16x16x32_bf16 v[100:103], a[140:143], a[92:95], v[100:103]
v_cmp_lt_u32 s[96:97], 0, v3
v_lshlrev_b32 v16, 15, v3
v_mfma_f32_16x16x32_bf16 v[108:111], a[132:135], a[92:95], v[108:111]
ds_read_b64_tr_b16 a[184:185], v14 offset:49152
ds_read_b64_tr_b16 a[186:187], v14 offset:49664
v_mfma_f32_16x16x32_bf16 v[108:111], a[128:131], a[88:91], v[108:111]
s_waitcnt lgkmcnt(15)
v_lshl_add_u32 v16, v2, 4, v16
v_add_u32 v16, s52, v16
v_mfma_f32_16x16x32_bf16 v[116:119], a[128:131], a[96:99], v[116:119]
ds_read_b64_tr_b16 a[188:189], v14 offset:53248
ds_read_b64_tr_b16 a[190:191], v14 offset:53760
v_mfma_f32_16x16x32_bf16 v[116:119], a[132:135], a[100:103], v[116:119]
buffer_load_dwordx4 v4, s[24:27], s64 offen offset:2048 sc1 lds
v_mfma_f32_16x16x32_bf16 v[124:127], a[140:143], a[100:103], v[124:127]
v_accvgpr_write_b32 a244, v16
v_add_u32 v16, 131072, v16
v_mfma_f32_16x16x32_bf16 v[124:127], a[136:139], a[96:99], v[124:127]
ds_read_b128 a[112:115], v4 offset:57344
v_add_u32 v21, s65, v16
v_mfma_f32_16x16x32_bf16 v[132:135], a[144:147], a[96:99], v[132:135]
v_cndmask_b32 v16, v16, v21, s[96:97]
v_accvgpr_write_b32 a248, v16
v_mfma_f32_16x16x32_bf16 v[132:135], a[148:151], a[100:103], v[132:135]
ds_read_b128 a[116:119], v4 offset:59392
v_cmp_lt_u32 s[96:97], 1, v3
v_mfma_f32_16x16x32_bf16 v[140:143], a[156:159], a[100:103], v[140:143]
v_add_u32 v21, 131072, v21
v_mfma_f32_16x16x32_bf16 v[140:143], a[152:155], a[96:99], v[140:143]
ds_read_b128 a[120:123], v4 offset:58368
v_cndmask_b32 v21, v21, v20, s[96:97]
v_mfma_f32_16x16x32_bf16 v[148:151], a[64:67], a[96:99], v[148:151]
v_accvgpr_write_b32 a252, v21
v_mfma_f32_16x16x32_bf16 v[148:151], a[68:71], a[100:103], v[148:151]
ds_read_b128 a[124:127], v4 offset:60416
v_mfma_f32_16x16x32_bf16 v[48:51], a[76:79], a[100:103], v[48:51]
s_waitcnt lgkmcnt(15)
v_mfma_f32_16x16x32_bf16 v[48:51], a[72:75], a[96:99], v[48:51]
buffer_load_dwordx4 v4, s[24:27], s64 offen offset:3072 sc1 lds
v_mfma_f32_16x16x32_bf16 v[156:159], a[72:75], a[104:107], v[156:159]
v_mfma_f32_16x16x32_bf16 v[156:159], a[76:79], a[108:111], v[156:159]
v_mfma_f32_16x16x32_bf16 v[164:167], a[68:71], a[108:111], v[164:167]
v_mfma_f32_16x16x32_bf16 v[164:167], a[64:67], a[104:107], v[164:167]
v_mfma_f32_16x16x32_bf16 v[172:175], a[152:155], a[104:107], v[172:175]
s_add_u32 s53, s87, 790528
v_mfma_f32_16x16x32_bf16 v[172:175], a[156:159], a[108:111], v[172:175]
buffer_store_dwordx4 a[16:19], v4, s[24:27], s53 offen offset:0 sc1
v_mfma_f32_16x16x32_bf16 v[56:59], a[148:151], a[108:111], v[56:59]
v_mfma_f32_16x16x32_bf16 v[56:59], a[144:147], a[104:107], v[56:59]
v_mfma_f32_16x16x32_bf16 v[180:183], a[136:139], a[104:107], v[180:183]
v_mfma_f32_16x16x32_bf16 v[180:183], a[140:143], a[108:111], v[180:183]
v_mfma_f32_16x16x32_bf16 v[188:191], a[132:135], a[108:111], v[188:191]
v_mfma_f32_16x16x32_bf16 v[188:191], a[128:131], a[104:107], v[188:191]
s_waitcnt lgkmcnt(0)
v_mfma_f32_16x16x32_bf16 v[196:199], a[160:163], a[80:83], v[196:199]
s_waitcnt vmcnt(17)
v_mfma_f32_16x16x32_bf16 v[196:199], a[164:167], a[84:87], v[196:199]
s_barrier
v_mfma_f32_16x16x32_bf16 v[64:67], a[172:175], a[84:87], v[64:67]
ds_read_b64_tr_b16 a[128:129], v11 offset:0
ds_read_b64_tr_b16 a[130:131], v11 offset:512
v_mfma_f32_16x16x32_bf16 v[64:67], a[168:171], a[80:83], v[64:67]
s_add_u32 m0, s70, 49152
s_add_u32 s64, s68, 16384
s_waitcnt vmcnt(6)
v_mfma_f32_16x16x32_bf16 v[204:207], a[176:179], a[80:83], v[204:207]
buffer_load_dwordx4 v4, s[24:27], s64 offen offset:0 sc1 lds
v_mfma_f32_16x16x32_bf16 v[204:207], a[180:183], a[84:87], v[204:207]
ds_read_b64_tr_b16 a[132:133], v11 offset:4096
ds_read_b64_tr_b16 a[134:135], v11 offset:4608
v_mfma_f32_16x16x32_bf16 v[212:215], a[188:191], a[84:87], v[212:215]
ds_read_b64_tr_b16 a[136:137], v12 offset:0
ds_read_b64_tr_b16 a[138:139], v12 offset:512
v_mfma_f32_16x16x32_bf16 v[212:215], a[184:187], a[80:83], v[212:215]
ds_read_b64_tr_b16 a[140:141], v12 offset:4096
ds_read_b64_tr_b16 a[142:143], v12 offset:4608
v_mfma_f32_16x16x32_bf16 v[72:75], a[112:115], a[80:83], v[72:75]
ds_read_b64_tr_b16 a[192:193], v23 offset:0
ds_read_b64_tr_b16 a[194:195], v23 offset:2048
v_mfma_f32_16x16x32_bf16 v[72:75], a[116:119], a[84:87], v[72:75]
ds_read_b64_tr_b16 a[144:145], v13 offset:0
ds_read_b64_tr_b16 a[146:147], v13 offset:512
v_mfma_f32_16x16x32_bf16 v[220:223], a[124:127], a[84:87], v[220:223]
ds_read_b64_tr_b16 a[196:197], v23 offset:32
ds_read_b64_tr_b16 a[198:199], v23 offset:2080
v_mfma_f32_16x16x32_bf16 v[220:223], a[120:123], a[80:83], v[220:223]
ds_read_b64_tr_b16 a[148:149], v13 offset:4096
ds_read_b64_tr_b16 a[150:151], v13 offset:4608
v_mfma_f32_16x16x32_bf16 v[252:255], a[120:123], a[88:91], v[252:255]
ds_read_b64_tr_b16 a[200:201], v23 offset:64
ds_read_b64_tr_b16 a[202:203], v23 offset:2112
v_mfma_f32_16x16x32_bf16 v[252:255], a[124:127], a[92:95], v[252:255]
ds_read_b64_tr_b16 a[152:153], v14 offset:0
ds_read_b64_tr_b16 a[154:155], v14 offset:512
v_mfma_f32_16x16x32_bf16 v[160:163], a[116:119], a[92:95], v[160:163]
buffer_load_dwordx4 v4, s[24:27], s64 offen offset:1024 sc1 lds
v_mfma_f32_16x16x32_bf16 v[160:163], a[112:115], a[88:91], v[160:163]
ds_read_b64_tr_b16 a[156:157], v14 offset:4096
ds_read_b64_tr_b16 a[158:159], v14 offset:4608
v_mfma_f32_16x16x32_bf16 v[228:231], a[184:187], a[88:91], v[228:231]
ds_read_b64_tr_b16 a[204:205], v23 offset:96
ds_read_b64_tr_b16 a[206:207], v23 offset:2144
v_mfma_f32_16x16x32_bf16 v[228:231], a[188:191], a[92:95], v[228:231]
ds_read_b64_tr_b16 a[208:209], v27 offset:4096
ds_read_b64_tr_b16 a[210:211], v27 offset:4608
v_mfma_f32_16x16x32_bf16 v[168:171], a[180:183], a[92:95], v[168:171]
ds_read_b128 a[64:67], v4 offset:8192
v_mfma_f32_16x16x32_bf16 v[168:171], a[176:179], a[88:91], v[168:171]
s_add_u32 s53, s87, 790528
ds_read_b64_tr_b16 a[212:213], v27 offset:5120
ds_read_b64_tr_b16 a[214:215], v27 offset:5632
v_mfma_f32_16x16x32_bf16 v[176:179], a[168:171], a[88:91], v[176:179]
ds_read_b128 a[80:83], v9 offset:0
v_readlane_b32 s81, v26, 0
v_mfma_f32_16x16x32_bf16 v[176:179], a[172:175], a[92:95], v[176:179]
buffer_store_dwordx4 a[24:27], v4, s[24:27], s53 offen offset:1024 sc1
v_mfma_f32_16x16x32_bf16 v[80:83], a[164:167], a[92:95], v[80:83]
ds_read_b128 a[68:71], v4 offset:10240
v_readlane_b32 s82, v26, 1
v_mfma_f32_16x16x32_bf16 v[80:83], a[160:163], a[88:91], v[80:83]
v_readlane_b32 s71, v26, 2
v_readlane_b32 s72, v26, 3
v_mfma_f32_16x16x32_bf16 v[184:187], a[160:163], a[96:99], v[184:187]
ds_read_b128 a[84:87], v10 offset:0
v_readlane_b32 s74, v26, 4
v_mfma_f32_16x16x32_bf16 v[184:187], a[164:167], a[100:103], v[184:187]
buffer_load_dwordx4 v4, s[24:27], s64 offen offset:2048 sc1 lds
v_mfma_f32_16x16x32_bf16 v[248:251], a[172:175], a[100:103], v[248:251]
v_readlane_b32 s75, v26, 5
v_mfma_f32_16x16x32_bf16 v[248:251], a[168:171], a[96:99], v[248:251]
ds_read_b128 a[72:75], v4 offset:9216
v_mfma_f32_16x16x32_bf16 v[240:243], a[176:179], a[96:99], v[240:243]
v_mfma_f32_16x16x32_bf16 v[240:243], a[180:183], a[100:103], v[240:243]
ds_read_b128 a[88:91], v9 offset:2048
v_mfma_f32_16x16x32_bf16 v[232:235], a[188:191], a[100:103], v[232:235]
v_mfma_f32_16x16x32_bf16 v[232:235], a[184:187], a[96:99], v[232:235]
ds_read_b128 a[76:79], v4 offset:11264
v_mfma_f32_16x16x32_bf16 v[236:239], a[112:115], a[96:99], v[236:239]
v_mfma_f32_16x16x32_bf16 v[236:239], a[116:119], a[100:103], v[236:239]
ds_read_b128 a[92:95], v10 offset:2048
v_mfma_f32_16x16x32_bf16 v[224:227], a[124:127], a[100:103], v[224:227]
v_mfma_f32_16x16x32_bf16 v[224:227], a[120:123], a[96:99], v[224:227]
buffer_load_dwordx4 v4, s[24:27], s64 offen offset:3072 sc1 lds
v_mfma_f32_16x16x32_bf16 v[208:211], a[120:123], a[104:107], v[208:211]
v_mfma_f32_16x16x32_bf16 v[208:211], a[124:127], a[108:111], v[208:211]
v_mfma_f32_16x16x32_bf16 v[216:219], a[116:119], a[108:111], v[216:219]
v_mfma_f32_16x16x32_bf16 v[216:219], a[112:115], a[104:107], v[216:219]
v_mfma_f32_16x16x32_bf16 v[244:247], a[184:187], a[104:107], v[244:247]
v_mfma_f32_16x16x32_bf16 v[244:247], a[188:191], a[108:111], v[244:247]
v_mfma_f32_16x16x32_bf16 v[192:195], a[180:183], a[108:111], v[192:195]
v_mfma_f32_16x16x32_bf16 v[192:195], a[176:179], a[104:107], v[192:195]
v_mfma_f32_16x16x32_bf16 v[200:203], a[168:171], a[104:107], v[200:203]
v_mfma_f32_16x16x32_bf16 v[200:203], a[172:175], a[108:111], v[200:203]
v_mfma_f32_16x16x32_bf16 v[88:91], a[164:167], a[108:111], v[88:91]
v_mfma_f32_16x16x32_bf16 v[88:91], a[160:163], a[104:107], v[88:91]
s_waitcnt lgkmcnt(0)
v_mfma_f32_16x16x32_bf16 v[36:39], a[128:131], a[80:83], v[36:39]
s_waitcnt vmcnt(18)
v_mfma_f32_16x16x32_bf16 v[36:39], a[132:135], a[84:87], v[36:39]
s_barrier
v_mfma_f32_16x16x32_bf16 v[44:47], a[140:143], a[84:87], v[44:47]
ds_read_b128 a[96:99], v9 offset:4096
v_mfma_f32_16x16x32_bf16 v[44:47], a[136:139], a[80:83], v[44:47]
s_add_u32 m0, s70, 65536
s_add_u32 s64, s68, 32768
ds_read_b128 a[100:103], v10 offset:4096
v_mfma_f32_16x16x32_bf16 v[32:35], a[144:147], a[80:83], v[32:35]
buffer_load_dwordx4 v4, s[24:27], s64 offen offset:0 sc1 lds
v_mfma_f32_16x16x32_bf16 v[32:35], a[148:151], a[84:87], v[32:35]
ds_read_b128 a[104:107], v9 offset:6144
v_mfma_f32_16x16x32_bf16 v[52:55], a[156:159], a[84:87], v[52:55]
ds_read_b64_tr_b16 a[160:161], v11 offset:16384
ds_read_b64_tr_b16 a[162:163], v11 offset:16896
v_mfma_f32_16x16x32_bf16 v[52:55], a[152:155], a[80:83], v[52:55]
buffer_store_dwordx4 a[192:195], v4, s[24:27], s81 offen sc1
v_mfma_f32_16x16x32_bf16 v[60:63], a[64:67], a[80:83], v[60:63]
v_mfma_f32_16x16x32_bf16 v[60:63], a[68:71], a[84:87], v[60:63]
ds_read_b128 a[108:111], v10 offset:6144
v_mfma_f32_16x16x32_bf16 v[68:71], a[76:79], a[84:87], v[68:71]
v_cvt_pk_bf16_f32 v36, v36, v37
v_cvt_pk_bf16_f32 v37, v38, v39
v_mfma_f32_16x16x32_bf16 v[68:71], a[72:75], a[80:83], v[68:71]
ds_read_b64_tr_b16 a[164:165], v11 offset:20480
ds_read_b64_tr_b16 a[166:167], v11 offset:20992
v_mfma_f32_16x16x32_bf16 v[76:79], a[72:75], a[88:91], v[76:79]
buffer_store_dwordx4 a[196:199], v4, s[24:27], s82 offen sc1
v_mfma_f32_16x16x32_bf16 v[76:79], a[76:79], a[92:95], v[76:79]
ds_read_b64_tr_b16 a[168:169], v12 offset:16384
ds_read_b64_tr_b16 a[170:171], v12 offset:16896
v_mfma_f32_16x16x32_bf16 v[84:87], a[68:71], a[92:95], v[84:87]
buffer_load_dwordx4 v4, s[24:27], s64 offen offset:1024 sc1 lds
v_mfma_f32_16x16x32_bf16 v[84:87], a[64:67], a[88:91], v[84:87]
ds_read_b64_tr_b16 a[172:173], v12 offset:20480
ds_read_b64_tr_b16 a[174:175], v12 offset:20992
v_mfma_f32_16x16x32_bf16 v[92:95], a[152:155], a[88:91], v[92:95]
v_cvt_pk_bf16_f32 v38, v44, v45
v_cvt_pk_bf16_f32 v39, v46, v47
v_mfma_f32_16x16x32_bf16 v[92:95], a[156:159], a[92:95], v[92:95]
buffer_store_dwordx4 a[200:203], v4, s[24:27], s71 offen sc1
v_mfma_f32_16x16x32_bf16 v[40:43], a[148:151], a[92:95], v[40:43]
ds_read_b64_tr_b16 a[176:177], v13 offset:16384
ds_read_b64_tr_b16 a[178:179], v13 offset:16896
v_mfma_f32_16x16x32_bf16 v[40:43], a[144:147], a[88:91], v[40:43]
v_accvgpr_write_b32 a32, v36
v_accvgpr_write_b32 a33, v37
v_mfma_f32_16x16x32_bf16 v[100:103], a[136:139], a[88:91], v[100:103]
ds_read_b64_tr_b16 a[180:181], v13 offset:20480
ds_read_b64_tr_b16 a[182:183], v13 offset:20992
v_mfma_f32_16x16x32_bf16 v[100:103], a[140:143], a[92:95], v[100:103]
v_accvgpr_write_b32 a34, v38
v_accvgpr_write_b32 a35, v39
v_mfma_f32_16x16x32_bf16 v[108:111], a[132:135], a[92:95], v[108:111]
ds_read_b64_tr_b16 a[184:185], v14 offset:16384
ds_read_b64_tr_b16 a[186:187], v14 offset:16896
v_mfma_f32_16x16x32_bf16 v[108:111], a[128:131], a[88:91], v[108:111]
s_waitcnt lgkmcnt(15)
v_cvt_pk_bf16_f32 v32, v32, v33
v_cvt_pk_bf16_f32 v33, v34, v35
v_mfma_f32_16x16x32_bf16 v[116:119], a[128:131], a[96:99], v[116:119]
ds_read_b64_tr_b16 a[188:189], v14 offset:20480
ds_read_b64_tr_b16 a[190:191], v14 offset:20992
v_mfma_f32_16x16x32_bf16 v[116:119], a[132:135], a[100:103], v[116:119]
buffer_load_dwordx4 v4, s[24:27], s64 offen offset:2048 sc1 lds
v_mfma_f32_16x16x32_bf16 v[124:127], a[140:143], a[100:103], v[124:127]
buffer_store_dwordx4 a[204:207], v4, s[24:27], s72 offen sc1
v_mfma_f32_16x16x32_bf16 v[124:127], a[136:139], a[96:99], v[124:127]
ds_read_b128 a[112:115], v4 offset:24576
v_cvt_pk_bf16_f32 v34, v52, v53
v_mfma_f32_16x16x32_bf16 v[132:135], a[144:147], a[96:99], v[132:135]
v_cvt_pk_bf16_f32 v35, v54, v55
v_accvgpr_write_b32 a36, v32
v_mfma_f32_16x16x32_bf16 v[132:135], a[148:151], a[100:103], v[132:135]
ds_read_b128 a[116:119], v4 offset:26624
v_accvgpr_write_b32 a37, v33
v_mfma_f32_16x16x32_bf16 v[140:143], a[156:159], a[100:103], v[140:143]
v_accvgpr_write_b32 a38, v34
v_accvgpr_write_b32 a39, v35
v_mfma_f32_16x16x32_bf16 v[140:143], a[152:155], a[96:99], v[140:143]
ds_read_b128 a[120:123], v4 offset:25600
v_cvt_pk_bf16_f32 v40, v40, v41
v_mfma_f32_16x16x32_bf16 v[148:151], a[64:67], a[96:99], v[148:151]
buffer_store_dwordx4 a[208:211], v4, s[24:27], s74 offen sc1
v_mfma_f32_16x16x32_bf16 v[148:151], a[68:71], a[100:103], v[148:151]
ds_read_b128 a[124:127], v4 offset:27648
v_cvt_pk_bf16_f32 v41, v42, v43
v_mfma_f32_16x16x32_bf16 v[48:51], a[76:79], a[100:103], v[48:51]
s_waitcnt lgkmcnt(15)
v_cvt_pk_bf16_f32 v42, v92, v93
v_cvt_pk_bf16_f32 v43, v94, v95
v_mfma_f32_16x16x32_bf16 v[48:51], a[72:75], a[96:99], v[48:51]
buffer_load_dwordx4 v4, s[24:27], s64 offen offset:3072 sc1 lds
v_mfma_f32_16x16x32_bf16 v[156:159], a[72:75], a[104:107], v[156:159]
v_accvgpr_write_b32 a40, v40
v_accvgpr_write_b32 a41, v41
v_mfma_f32_16x16x32_bf16 v[156:159], a[76:79], a[108:111], v[156:159]
buffer_store_dwordx4 a[212:215], v4, s[24:27], s75 offen sc1
v_mfma_f32_16x16x32_bf16 v[164:167], a[68:71], a[108:111], v[164:167]
v_accvgpr_write_b32 a42, v42
v_accvgpr_write_b32 a43, v43
v_mfma_f32_16x16x32_bf16 v[164:167], a[64:67], a[104:107], v[164:167]
v_cvt_pk_bf16_f32 v108, v108, v109
v_cvt_pk_bf16_f32 v109, v110, v111
v_mfma_f32_16x16x32_bf16 v[172:175], a[152:155], a[104:107], v[172:175]
v_cvt_pk_bf16_f32 v110, v100, v101
v_cvt_pk_bf16_f32 v111, v102, v103
v_mfma_f32_16x16x32_bf16 v[172:175], a[156:159], a[108:111], v[172:175]
v_accvgpr_write_b32 a44, v108
v_accvgpr_write_b32 a45, v109
v_mfma_f32_16x16x32_bf16 v[56:59], a[148:151], a[108:111], v[56:59]
v_accvgpr_write_b32 a46, v110
v_accvgpr_write_b32 a47, v111
v_mfma_f32_16x16x32_bf16 v[56:59], a[144:147], a[104:107], v[56:59]
v_cvt_pk_bf16_f32 v116, v116, v117
v_cvt_pk_bf16_f32 v117, v118, v119
v_mfma_f32_16x16x32_bf16 v[180:183], a[136:139], a[104:107], v[180:183]
v_cvt_pk_bf16_f32 v118, v124, v125
v_cvt_pk_bf16_f32 v119, v126, v127
v_mfma_f32_16x16x32_bf16 v[180:183], a[140:143], a[108:111], v[180:183]
v_accvgpr_write_b32 a48, v116
v_accvgpr_write_b32 a49, v117
v_mfma_f32_16x16x32_bf16 v[188:191], a[132:135], a[108:111], v[188:191]
v_accvgpr_write_b32 a50, v118
v_accvgpr_write_b32 a51, v119
v_mfma_f32_16x16x32_bf16 v[188:191], a[128:131], a[104:107], v[188:191]
s_waitcnt lgkmcnt(0)
v_cvt_pk_bf16_f32 v132, v132, v133
v_cvt_pk_bf16_f32 v133, v134, v135
v_mfma_f32_16x16x32_bf16 v[196:199], a[160:163], a[80:83], v[196:199]
s_waitcnt vmcnt(16)
v_cvt_pk_bf16_f32 v134, v140, v141
v_cvt_pk_bf16_f32 v135, v142, v143
v_mfma_f32_16x16x32_bf16 v[196:199], a[164:167], a[84:87], v[196:199]
s_barrier
v_mfma_f32_16x16x32_bf16 v[64:67], a[172:175], a[84:87], v[64:67]
ds_read_b128 a[192:195], v4 offset:32768
v_accvgpr_write_b32 a52, v132
v_mfma_f32_16x16x32_bf16 v[64:67], a[168:171], a[80:83], v[64:67]
s_add_u32 m0, s70, 81920
s_add_u32 s64, s68, 49152
v_accvgpr_write_b32 a53, v133
v_mfma_f32_16x16x32_bf16 v[204:207], a[176:179], a[80:83], v[204:207]
buffer_load_dwordx4 v4, s[24:27], s64 offen offset:0 sc1 lds
v_mfma_f32_16x16x32_bf16 v[204:207], a[180:183], a[84:87], v[204:207]
ds_read_b128 a[196:199], v4 offset:33792
v_accvgpr_write_b32 a54, v134
v_mfma_f32_16x16x32_bf16 v[212:215], a[188:191], a[84:87], v[212:215]
v_accvgpr_write_b32 a55, v135
v_cvt_pk_bf16_f32 v56, v56, v57
v_mfma_f32_16x16x32_bf16 v[212:215], a[184:187], a[80:83], v[212:215]
ds_read_b128 a[200:203], v4 offset:34816
v_cvt_pk_bf16_f32 v57, v58, v59
v_mfma_f32_16x16x32_bf16 v[80:83], a[160:163], a[88:91], v[80:83]
v_cvt_pk_bf16_f32 v58, v172, v173
v_cvt_pk_bf16_f32 v59, v174, v175
v_mfma_f32_16x16x32_bf16 v[80:83], a[164:167], a[92:95], v[80:83]
ds_read_b128 a[204:207], v4 offset:35840
v_accvgpr_write_b32 a56, v56
v_mfma_f32_16x16x32_bf16 v[176:179], a[172:175], a[92:95], v[176:179]
v_accvgpr_write_b32 a57, v57
v_accvgpr_write_b32 a58, v58
v_mfma_f32_16x16x32_bf16 v[176:179], a[168:171], a[88:91], v[176:179]
ds_read_b128 a[208:211], v4 offset:36864
v_accvgpr_write_b32 a59, v59
v_mfma_f32_16x16x32_bf16 v[168:171], a[176:179], a[88:91], v[168:171]
v_cvt_pk_bf16_f32 v188, v188, v189
v_cvt_pk_bf16_f32 v189, v190, v191
v_mfma_f32_16x16x32_bf16 v[168:171], a[180:183], a[92:95], v[168:171]
ds_read_b128 a[212:215], v4 offset:37888
v_cvt_pk_bf16_f32 v190, v180, v181
v_mfma_f32_16x16x32_bf16 v[228:231], a[188:191], a[92:95], v[228:231]
buffer_load_dwordx4 v4, s[24:27], s64 offen offset:1024 sc1 lds
v_mfma_f32_16x16x32_bf16 v[228:231], a[184:187], a[88:91], v[228:231]
ds_read_b128 a[216:219], v4 offset:38912
v_cvt_pk_bf16_f32 v191, v182, v183
v_mfma_f32_16x16x32_bf16 v[184:187], a[160:163], a[96:99], v[184:187]
v_accvgpr_write_b32 a60, v188
v_accvgpr_write_b32 a61, v189
v_mfma_f32_16x16x32_bf16 v[184:187], a[164:167], a[100:103], v[184:187]
ds_read_b128 a[220:223], v4 offset:39936
v_accvgpr_write_b32 a62, v190
v_mfma_f32_16x16x32_bf16 v[248:251], a[172:175], a[100:103], v[248:251]
v_accvgpr_write_b32 a63, v191
v_cvt_pk_bf16_f32 v196, v196, v197
v_mfma_f32_16x16x32_bf16 v[248:251], a[168:171], a[96:99], v[248:251]
v_cvt_pk_bf16_f32 v197, v198, v199
v_cvt_pk_bf16_f32 v198, v64, v65
v_mfma_f32_16x16x32_bf16 v[240:243], a[176:179], a[96:99], v[240:243]
v_cvt_pk_bf16_f32 v199, v66, v67
v_accvgpr_write_b32 a28, v196
v_mfma_f32_16x16x32_bf16 v[240:243], a[180:183], a[100:103], v[240:243]
v_accvgpr_write_b32 a29, v197
v_accvgpr_write_b32 a30, v198
v_mfma_f32_16x16x32_bf16 v[232:235], a[188:191], a[100:103], v[232:235]
v_accvgpr_write_b32 a31, v199
v_cvt_pk_bf16_f32 v204, v204, v205
v_mfma_f32_16x16x32_bf16 v[232:235], a[184:187], a[96:99], v[232:235]
v_cvt_pk_bf16_f32 v205, v206, v207
v_cvt_pk_bf16_f32 v206, v212, v213
v_mfma_f32_16x16x32_bf16 v[88:91], a[160:163], a[104:107], v[88:91]
v_cvt_pk_bf16_f32 v207, v214, v215
v_accvgpr_write_b32 a20, v204
v_mfma_f32_16x16x32_bf16 v[88:91], a[164:167], a[108:111], v[88:91]
buffer_load_dwordx4 v4, s[24:27], s64 offen offset:2048 sc1 lds
v_mfma_f32_16x16x32_bf16 v[200:203], a[172:175], a[108:111], v[200:203]
v_accvgpr_write_b32 a21, v205
v_accvgpr_write_b32 a22, v206
v_mfma_f32_16x16x32_bf16 v[200:203], a[168:171], a[104:107], v[200:203]
v_accvgpr_write_b32 a23, v207
v_cvt_pk_bf16_f32 v80, v80, v81
v_mfma_f32_16x16x32_bf16 v[192:195], a[176:179], a[104:107], v[192:195]
v_cvt_pk_bf16_f32 v81, v82, v83
v_cvt_pk_bf16_f32 v82, v176, v177
v_mfma_f32_16x16x32_bf16 v[192:195], a[180:183], a[108:111], v[192:195]
v_cvt_pk_bf16_f32 v83, v178, v179
v_accvgpr_write_b32 a12, v80
v_mfma_f32_16x16x32_bf16 v[244:247], a[188:191], a[108:111], v[244:247]
v_accvgpr_write_b32 a13, v81
v_accvgpr_write_b32 a14, v82
v_mfma_f32_16x16x32_bf16 v[244:247], a[184:187], a[104:107], v[244:247]
v_accvgpr_write_b32 a15, v83
v_cvt_pk_bf16_f32 v168, v168, v169
v_mfma_f32_16x16x32_bf16 v[72:75], a[112:115], a[80:83], v[72:75]
v_cvt_pk_bf16_f32 v169, v170, v171
v_cvt_pk_bf16_f32 v170, v228, v229
v_mfma_f32_16x16x32_bf16 v[72:75], a[116:119], a[84:87], v[72:75]
v_cvt_pk_bf16_f32 v171, v230, v231
v_accvgpr_write_b32 a4, v168
v_mfma_f32_16x16x32_bf16 v[220:223], a[124:127], a[84:87], v[220:223]
v_accvgpr_write_b32 a5, v169
v_accvgpr_write_b32 a6, v170
v_mfma_f32_16x16x32_bf16 v[220:223], a[120:123], a[80:83], v[220:223]
buffer_load_dwordx4 v4, s[24:27], s64 offen offset:3072 sc1 lds
v_mfma_f32_16x16x32_bf16 v[160:163], a[112:115], a[88:91], v[160:163]
v_accvgpr_write_b32 a7, v171
v_cvt_pk_bf16_f32 v184, v184, v185
v_mfma_f32_16x16x32_bf16 v[160:163], a[116:119], a[92:95], v[160:163]
v_cvt_pk_bf16_f32 v185, v186, v187
v_cvt_pk_bf16_f32 v186, v248, v249
v_mfma_f32_16x16x32_bf16 v[252:255], a[124:127], a[92:95], v[252:255]
v_cvt_pk_bf16_f32 v187, v250, v251
v_accvgpr_write_b32 a0, v184
v_mfma_f32_16x16x32_bf16 v[252:255], a[120:123], a[88:91], v[252:255]
v_accvgpr_write_b32 a1, v185
v_accvgpr_write_b32 a2, v186
v_mfma_f32_16x16x32_bf16 v[236:239], a[112:115], a[96:99], v[236:239]
v_accvgpr_write_b32 a3, v187
v_cvt_pk_bf16_f32 v240, v240, v241
v_mfma_f32_16x16x32_bf16 v[236:239], a[116:119], a[100:103], v[236:239]
v_cvt_pk_bf16_f32 v241, v242, v243
v_cvt_pk_bf16_f32 v242, v232, v233
v_mfma_f32_16x16x32_bf16 v[224:227], a[124:127], a[100:103], v[224:227]
v_cvt_pk_bf16_f32 v243, v234, v235
v_accvgpr_write_b32 a8, v240
v_mfma_f32_16x16x32_bf16 v[224:227], a[120:123], a[96:99], v[224:227]
v_accvgpr_write_b32 a9, v241
v_accvgpr_write_b32 a10, v242
v_mfma_f32_16x16x32_bf16 v[216:219], a[112:115], a[104:107], v[216:219]
v_accvgpr_write_b32 a11, v243
v_cvt_pk_bf16_f32 v88, v88, v89
v_mfma_f32_16x16x32_bf16 v[216:219], a[116:119], a[108:111], v[216:219]
v_cvt_pk_bf16_f32 v89, v90, v91
v_cvt_pk_bf16_f32 v90, v200, v201
v_mfma_f32_16x16x32_bf16 v[208:211], a[124:127], a[108:111], v[208:211]
v_cvt_pk_bf16_f32 v91, v202, v203
v_accvgpr_write_b32 a16, v88
v_mfma_f32_16x16x32_bf16 v[208:211], a[120:123], a[104:107], v[208:211]
s_waitcnt lgkmcnt(0)
v_accvgpr_write_b32 a17, v89
v_accvgpr_write_b32 a18, v90
v_mfma_f32_16x16x32_bf16 v[44:47], a[192:195], a[32:35], v[96:99]
v_accvgpr_write_b32 a19, v91
v_cvt_pk_bf16_f32 v192, v192, v193
v_mfma_f32_16x16x32_bf16 v[44:47], a[196:199], a[36:39], v[44:47]
v_cvt_pk_bf16_f32 v193, v194, v195
v_cvt_pk_bf16_f32 v194, v244, v245
v_mfma_f32_16x16x32_bf16 v[44:47], a[200:203], a[28:31], v[44:47]
v_cvt_pk_bf16_f32 v195, v246, v247
v_accvgpr_write_b32 a24, v192
v_mfma_f32_16x16x32_bf16 v[44:47], a[204:207], a[20:23], v[44:47]
v_accvgpr_write_b32 a25, v193
v_accvgpr_write_b32 a26, v194
v_mfma_f32_16x16x32_bf16 v[52:55], a[192:195], a[44:47], v[104:107]
ds_bpermute_b32 v8, v17, v63
v_accvgpr_write_b32 a27, v195
v_mfma_f32_16x16x32_bf16 v[52:55], a[196:199], a[40:43], v[52:55]
v_cvt_pk_bf16_f32 v60, v60, v61
v_cvt_pk_bf16_f32 v61, v62, v63
v_mfma_f32_16x16x32_bf16 v[52:55], a[200:203], a[12:15], v[52:55]
v_cvt_pk_bf16_f32 v62, v68, v69
v_cvt_pk_bf16_f32 v63, v70, v71
v_mfma_f32_16x16x32_bf16 v[52:55], a[204:207], a[4:7], v[52:55]
v_accvgpr_write_b32 a128, v60
v_accvgpr_write_b32 a129, v61
v_mfma_f32_16x16x32_bf16 v[64:67], a[208:211], a[32:35], v[112:115]
v_accvgpr_write_b32 a130, v62
v_accvgpr_write_b32 a131, v63
v_mfma_f32_16x16x32_bf16 v[64:67], a[212:215], a[36:39], v[64:67]
ds_bpermute_b32 v9, v17, v87
v_cvt_pk_bf16_f32 v84, v84, v85
v_mfma_f32_16x16x32_bf16 v[64:67], a[216:219], a[28:31], v[64:67]
v_cvt_pk_bf16_f32 v85, v86, v87
v_cvt_pk_bf16_f32 v86, v76, v77
v_mfma_f32_16x16x32_bf16 v[64:67], a[220:223], a[20:23], v[64:67]
v_cvt_pk_bf16_f32 v87, v78, v79
v_mfma_f32_16x16x32_bf16 v[212:215], a[208:211], a[44:47], v[120:123]
buffer_store_dwordx4 v[84:87], v18, s[24:27], s54 offen offset:256 sc1
v_mfma_f32_16x16x32_bf16 v[212:215], a[212:215], a[40:43], v[212:215]
v_accvgpr_write_b32 a136, v84
v_accvgpr_write_b32 a137, v85
v_mfma_f32_16x16x32_bf16 v[212:215], a[216:219], a[12:15], v[212:215]
v_accvgpr_write_b32 a138, v86
v_accvgpr_write_b32 a139, v87
v_mfma_f32_16x16x32_bf16 v[212:215], a[220:223], a[4:7], v[212:215]
s_waitcnt vmcnt(15)
ds_bpermute_b32 v10, v17, v151
v_cvt_pk_bf16_f32 v148, v148, v149
v_mfma_f32_16x16x32_bf16 v[100:103], a[192:195], a[48:51], v[128:131]
s_barrier
v_cvt_pk_bf16_f32 v149, v150, v151
v_cvt_pk_bf16_f32 v150, v48, v49
v_mfma_f32_16x16x32_bf16 v[100:103], a[196:199], a[52:55], v[100:103]
v_cvt_pk_bf16_f32 v151, v50, v51
v_accvgpr_write_b32 a144, v148
v_mfma_f32_16x16x32_bf16 v[100:103], a[200:203], a[0:3], v[100:103]
ds_bpermute_b32 v11, v17, v167
v_accvgpr_write_b32 a145, v149
v_mfma_f32_16x16x32_bf16 v[100:103], a[204:207], a[8:11], v[100:103]
v_cvt_pk_bf16_f32 v164, v164, v165
v_cvt_pk_bf16_f32 v165, v166, v167
v_mfma_f32_16x16x32_bf16 v[92:95], a[192:195], a[60:63], v[136:139]
v_cvt_pk_bf16_f32 v166, v156, v157
v_cvt_pk_bf16_f32 v167, v158, v159
v_mfma_f32_16x16x32_bf16 v[92:95], a[196:199], a[56:59], v[92:95]
buffer_store_dwordx4 v[164:167], v18, s[24:27], s55 offen offset:256 sc1
v_mfma_f32_16x16x32_bf16 v[92:95], a[200:203], a[16:19], v[92:95]
v_cvt_pk_bf16_f32 v72, v72, v73
v_cvt_pk_bf16_f32 v73, v74, v75
v_mfma_f32_16x16x32_bf16 v[92:95], a[204:207], a[24:27], v[92:95]
v_cvt_pk_bf16_f32 v74, v220, v221
v_cvt_pk_bf16_f32 v75, v222, v223
v_mfma_f32_16x16x32_bf16 v[176:179], a[208:211], a[48:51], v[144:147]
v_cvt_pk_bf16_f32 v160, v160, v161
v_cvt_pk_bf16_f32 v161, v162, v163
v_mfma_f32_16x16x32_bf16 v[176:179], a[212:215], a[52:55], v[176:179]
L_PAD8:
s_cbranch_execz L_PAD12
v_cvt_pk_bf16_f32 v162, v252, v253
v_cvt_pk_bf16_f32 v163, v254, v255
v_mfma_f32_16x16x32_bf16 v[176:179], a[216:219], a[0:3], v[176:179]
buffer_store_dwordx4 v[160:163], v19, s[24:27], s54 offen offset:256 sc1
v_mfma_f32_16x16x32_bf16 v[176:179], a[220:223], a[8:11], v[176:179]
v_cvt_pk_bf16_f32 v236, v236, v237
v_cvt_pk_bf16_f32 v237, v238, v239
v_mfma_f32_16x16x32_bf16 v[228:231], a[208:211], a[60:63], v[152:155]
v_cvt_pk_bf16_f32 v238, v224, v225
v_cvt_pk_bf16_f32 v239, v226, v227
v_mfma_f32_16x16x32_bf16 v[228:231], a[212:215], a[56:59], v[228:231]
v_cvt_pk_bf16_f32 v216, v216, v217
v_cvt_pk_bf16_f32 v217, v218, v219
v_mfma_f32_16x16x32_bf16 v[228:231], a[216:219], a[16:19], v[228:231]
v_cvt_pk_bf16_f32 v218, v208, v209
v_cvt_pk_bf16_f32 v219, v210, v211
v_mfma_f32_16x16x32_bf16 v[228:231], a[220:223], a[24:27], v[228:231]
buffer_store_dwordx4 v[216:219], v19, s[24:27], s55 offen offset:256 sc1
ds_read_b128 a[64:67], v4 offset:57344
ds_read_b128 a[68:71], v4 offset:58368
ds_read_b128 a[72:75], v4 offset:59392
ds_read_b128 a[76:79], v4 offset:60416
ds_read_b128 a[80:83], v4 offset:61440
ds_read_b128 a[84:87], v4 offset:62464
ds_read_b128 a[88:91], v4 offset:63488
ds_read_b128 a[92:95], v4 offset:64512
s_add_u32 m0, s70, 98304
s_add_u32 s64, s68, 65536
buffer_load_dwordx4 v4, s[24:27], s64 offen offset:0 sc1 lds
v_max3_f32 v24, v44, v45, v46
v_max3_f32 v25, v47, v64, v65
v_max3_f32 v26, v52, v53, v54
v_max3_f32 v27, v55, v212, v213
v_max3_f32 v24, v24, v66, v67
v_max_f32 v24, v24, v25
buffer_load_dwordx4 v4, s[24:27], s64 offen offset:1024 sc1 lds
v_max3_f32 v26, v26, v214, v215
v_max_f32 v26, v26, v27
v_mov_b32 v25, v24
v_mov_b32 v27, v26
s_nop 1
v_permlane32_swap_b32 v25, v24
buffer_load_dwordx4 v4, s[24:27], s64 offen offset:2048 sc1 lds
v_permlane32_swap_b32 v27, v26
s_nop 0
v_max_f32 v24, v24, v25
v_max_f32 v26, v26, v27
v_mov_b32 v25, v24
v_mov_b32 v27, v26
buffer_load_dwordx4 v4, s[24:27], s64 offen offset:3072 sc1 lds
s_nop 1
v_permlane16_swap_b32 v25, v24
v_permlane16_swap_b32 v27, v26
s_nop 0
v_max_f32 v24, v24, v25
v_max_f32 v26, v26, v27
s_add_u32 m0, s70, 114688
s_add_u32 s64, s68, 81920
buffer_load_dwordx4 v4, s[24:27], s64 offen offset:0 sc1 lds
v_pk_add_f32 v[44:45], v[44:45], v[24:25] op_sel_hi:[1,0] neg_lo:[0,1] neg_hi:[0,1]
v_pk_add_f32 v[46:47], v[46:47], v[24:25] op_sel_hi:[1,0] neg_lo:[0,1] neg_hi:[0,1]
v_pk_add_f32 v[52:53], v[52:53], v[26:27] op_sel_hi:[1,0] neg_lo:[0,1] neg_hi:[0,1]
v_pk_add_f32 v[54:55], v[54:55], v[26:27] op_sel_hi:[1,0] neg_lo:[0,1] neg_hi:[0,1]
v_pk_add_f32 v[64:65], v[64:65], v[24:25] op_sel_hi:[1,0] neg_lo:[0,1] neg_hi:[0,1]
v_pk_add_f32 v[66:67], v[66:67], v[24:25] op_sel_hi:[1,0] neg_lo:[0,1] neg_hi:[0,1]
buffer_load_dwordx4 v4, s[24:27], s64 offen offset:1024 sc1 lds
v_pk_add_f32 v[212:213], v[212:213], v[26:27] op_sel_hi:[1,0] neg_lo:[0,1] neg_hi:[0,1]
v_pk_add_f32 v[214:215], v[214:215], v[26:27] op_sel_hi:[1,0] neg_lo:[0,1] neg_hi:[0,1]
v_pk_add_f32 v[96:97], v[96:97], v[24:25] op_sel_hi:[1,0] neg_lo:[0,1] neg_hi:[0,1]
v_pk_add_f32 v[98:99], v[98:99], v[24:25] op_sel_hi:[1,0] neg_lo:[0,1] neg_hi:[0,1]
v_pk_add_f32 v[104:105], v[104:105], v[26:27] op_sel_hi:[1,0] neg_lo:[0,1] neg_hi:[0,1]
v_pk_add_f32 v[106:107], v[106:107], v[26:27] op_sel_hi:[1,0] neg_lo:[0,1] neg_hi:[0,1]
buffer_load_dwordx4 v4, s[24:27], s64 offen offset:2048 sc1 lds
v_pk_add_f32 v[112:113], v[112:113], v[24:25] op_sel_hi:[1,0] neg_lo:[0,1] neg_hi:[0,1]
v_pk_add_f32 v[114:115], v[114:115], v[24:25] op_sel_hi:[1,0] neg_lo:[0,1] neg_hi:[0,1]
v_pk_add_f32 v[120:121], v[120:121], v[26:27] op_sel_hi:[1,0] neg_lo:[0,1] neg_hi:[0,1]
v_pk_add_f32 v[122:123], v[122:123], v[26:27] op_sel_hi:[1,0] neg_lo:[0,1] neg_hi:[0,1]
v_exp_f32 v44, v44
v_exp_f32 v45, v45
buffer_load_dwordx4 v4, s[24:27], s64 offen offset:3072 sc1 lds
v_exp_f32 v46, v46
v_exp_f32 v47, v47
v_cvt_pk_bf16_f32 v124, v44, v45
v_exp_f32 v52, v52
v_exp_f32 v53, v53
v_cvt_pk_bf16_f32 v125, v46, v47
s_add_u32 m0, s70, 131072
s_add_u32 s64, s68, 98304
s_cmp_ge_u32 s3, 1
s_cselect_b32 s64, s64, 2147418112
buffer_load_dwordx4 v4, s[24:27], s64 offen offset:0 sc1 lds
v_exp_f32 v54, v54
v_exp_f32 v55, v55
v_cvt_pk_bf16_f32 v140, v52, v53
v_exp_f32 v64, v64
v_exp_f32 v65, v65
v_cvt_pk_bf16_f32 v141, v54, v55
buffer_load_dwordx4 v4, s[24:27], s64 offen offset:1024 sc1 lds
v_exp_f32 v66, v66
v_exp_f32 v67, v67
v_cvt_pk_bf16_f32 v126, v64, v65
v_exp_f32 v212, v212
v_exp_f32 v213, v213
v_cvt_pk_bf16_f32 v127, v66, v67
buffer_load_dwordx4 v4, s[24:27], s64 offen offset:2048 sc1 lds
v_exp_f32 v214, v214
v_exp_f32 v215, v215
v_cvt_pk_bf16_f32 v142, v212, v213
v_max3_f32 v24, v100, v101, v102
v_cvt_pk_bf16_f32 v143, v214, v215
v_max3_f32 v25, v103, v176, v177
buffer_load_dwordx4 v4, s[24:27], s64 offen offset:3072 sc1 lds
v_max3_f32 v26, v92, v93, v94
v_max3_f32 v27, v95, v228, v229
v_max3_f32 v24, v24, v178, v179
v_max_f32 v24, v24, v25
v_max3_f32 v26, v26, v230, v231
v_max_f32 v26, v26, v27
s_add_u32 m0, s70, 147456
s_add_u32 s64, s68, 114688
s_cmp_ge_u32 s3, 2
s_cselect_b32 s64, s64, 2147418112
buffer_load_dwordx4 v4, s[24:27], s64 offen offset:0 sc1 lds
v_mov_b32 v25, v24
v_mov_b32 v27, v26
s_nop 1
v_permlane32_swap_b32 v25, v24
v_permlane32_swap_b32 v27, v26
s_nop 0
buffer_load_dwordx4 v4, s[24:27], s64 offen offset:1024 sc1 lds
v_max_f32 v24, v24, v25
v_max_f32 v26, v26, v27
v_mov_b32 v25, v24
v_mov_b32 v27, v26
s_nop 1
v_permlane16_swap_b32 v25, v24
buffer_load_dwordx4 v4, s[24:27], s64 offen offset:2048 sc1 lds
v_permlane16_swap_b32 v27, v26
s_nop 0
v_max_f32 v24, v24, v25
v_max_f32 v26, v26, v27
v_pk_add_f32 v[100:101], v[100:101], v[24:25] op_sel_hi:[1,0] neg_lo:[0,1] neg_hi:[0,1]
v_pk_add_f32 v[102:103], v[102:103], v[24:25] op_sel_hi:[1,0] neg_lo:[0,1] neg_hi:[0,1]
buffer_load_dwordx4 v4, s[24:27], s64 offen offset:3072 sc1 lds
v_pk_add_f32 v[92:93], v[92:93], v[26:27] op_sel_hi:[1,0] neg_lo:[0,1] neg_hi:[0,1]
v_pk_add_f32 v[94:95], v[94:95], v[26:27] op_sel_hi:[1,0] neg_lo:[0,1] neg_hi:[0,1]
v_pk_add_f32 v[176:177], v[176:177], v[24:25] op_sel_hi:[1,0] neg_lo:[0,1] neg_hi:[0,1]
v_pk_add_f32 v[178:179], v[178:179], v[24:25] op_sel_hi:[1,0] neg_lo:[0,1] neg_hi:[0,1]
v_pk_add_f32 v[228:229], v[228:229], v[26:27] op_sel_hi:[1,0] neg_lo:[0,1] neg_hi:[0,1]
v_pk_add_f32 v[230:231], v[230:231], v[26:27] op_sel_hi:[1,0] neg_lo:[0,1] neg_hi:[0,1]
s_add_u32 m0, s70, 0
s_add_u32 s64, s68, 131072
s_cmp_ge_u32 s3, 3
s_cselect_b32 s64, s64, 2147418112
buffer_load_dwordx4 v4, s[24:27], s64 offen offset:0 sc1 lds
v_pk_add_f32 v[128:129], v[128:129], v[24:25] op_sel_hi:[1,0] neg_lo:[0,1] neg_hi:[0,1]
v_pk_add_f32 v[130:131], v[130:131], v[24:25] op_sel_hi:[1,0] neg_lo:[0,1] neg_hi:[0,1]
v_pk_add_f32 v[136:137], v[136:137], v[26:27] op_sel_hi:[1,0] neg_lo:[0,1] neg_hi:[0,1]
v_pk_add_f32 v[138:139], v[138:139], v[26:27] op_sel_hi:[1,0] neg_lo:[0,1] neg_hi:[0,1]
v_pk_add_f32 v[144:145], v[144:145], v[24:25] op_sel_hi:[1,0] neg_lo:[0,1] neg_hi:[0,1]
v_pk_add_f32 v[146:147], v[146:147], v[24:25] op_sel_hi:[1,0] neg_lo:[0,1] neg_hi:[0,1]
buffer_load_dwordx4 v4, s[24:27], s64 offen offset:1024 sc1 lds
v_pk_add_f32 v[152:153], v[152:153], v[26:27] op_sel_hi:[1,0] neg_lo:[0,1] neg_hi:[0,1]
v_pk_add_f32 v[154:155], v[154:155], v[26:27] op_sel_hi:[1,0] neg_lo:[0,1] neg_hi:[0,1]
v_accvgpr_write_b32 a146, v150
v_accvgpr_write_b32 a147, v151
v_accvgpr_write_b32 a152, v164
v_accvgpr_write_b32 a153, v165
buffer_load_dwordx4 v4, s[24:27], s64 offen offset:2048 sc1 lds
v_accvgpr_write_b32 a154, v166
v_accvgpr_write_b32 a155, v167
v_accvgpr_write_b32 a132, v72
v_accvgpr_write_b32 a133, v73
v_accvgpr_write_b32 a134, v74
v_accvgpr_write_b32 a135, v75
buffer_load_dwordx4 v4, s[24:27], s64 offen offset:3072 sc1 lds
v_accvgpr_write_b32 a140, v160
v_accvgpr_write_b32 a141, v161
v_accvgpr_write_b32 a142, v162
v_accvgpr_write_b32 a143, v163
v_accvgpr_write_b32 a148, v236
v_accvgpr_write_b32 a149, v237
v_accvgpr_write_b32 a150, v238
v_accvgpr_write_b32 a151, v239
v_accvgpr_write_b32 a156, v216
v_accvgpr_write_b32 a157, v217
v_accvgpr_write_b32 a158, v218
v_accvgpr_write_b32 a159, v219
v_mov_b64 v[60:61], 0
v_mov_b64 v[62:63], 0
v_mov_b64 v[68:69], 0
v_mov_b64 v[70:71], 0
v_mov_b64 v[72:73], 0
v_mov_b64 v[74:75], 0
v_mov_b64 v[220:221], 0
v_mov_b64 v[222:223], 0
v_mov_b64 v[84:85], 0
v_mov_b64 v[86:87], 0
v_mov_b64 v[76:77], 0
v_mov_b64 v[78:79], 0
v_mov_b64 v[160:161], 0
v_mov_b64 v[162:163], 0
v_mov_b64 v[252:253], 0
v_mov_b64 v[254:255], 0
v_mov_b64 v[148:149], 0
v_mov_b64 v[150:151], 0
v_mov_b64 v[48:49], 0
v_mov_b64 v[50:51], 0
v_mov_b64 v[236:237], 0
v_mov_b64 v[238:239], 0
v_mov_b64 v[224:225], 0
v_mov_b64 v[226:227], 0
v_mov_b64 v[164:165], 0
v_mov_b64 v[166:167], 0
v_mov_b64 v[156:157], 0
v_mov_b64 v[158:159], 0
v_mov_b64 v[216:217], 0
v_mov_b64 v[218:219], 0
v_mov_b64 v[208:209], 0
v_mov_b64 v[210:211], 0
ds_read_b128 a[192:195], v4 offset:49152
ds_read_b128 a[196:199], v4 offset:50176
ds_read_b128 a[200:203], v4 offset:51200
ds_read_b128 a[204:207], v4 offset:52224
ds_read_b128 a[208:211], v4 offset:53248
ds_read_b128 a[212:215], v4 offset:54272
ds_read_b128 a[216:219], v4 offset:55296
ds_read_b128 a[220:223], v4 offset:56320
s_waitcnt lgkmcnt(8)
s_lshl2_add_u32 s77, s86, s84
s_mul_i32 s77, s77, 344064
s_mov_b32 s80, s70
s_cmp_lt_u32 s3, 2
s_cselect_b32 s53, 8, -2
s_add_u32 s53, s53, s3
v_mfma_f32_16x16x32_bf16 v[36:39], a[64:67], v[124:127], 0
s_mul_i32 s52, s5, 65536
v_exp_f32 v100, v100
v_mfma_f32_16x16x32_bf16 v[116:119], a[64:67], v[140:143], 0
s_sub_u32 s52, 1064960, s52
v_exp_f32 v101, v101
v_mfma_f32_16x16x32_bf16 v[132:135], a[68:71], v[140:143], 0
s_add_u32 s71, s68, s52
v_exp_f32 v102, v102
v_mfma_f32_16x16x32_bf16 v[32:35], a[68:71], v[124:127], 0
s_add_u32 s77, s77, s80
v_exp_f32 v103, v103
v_mfma_f32_16x16x32_bf16 v[196:199], a[72:75], v[124:127], 0
s_add_u32 s77, s77, 38797312
v_cvt_pk_bf16_f32 v248, v100, v101
v_cvt_pk_bf16_f32 v249, v102, v103
v_mfma_f32_16x16x32_bf16 v[184:187], a[72:75], v[140:143], 0
s_add_u32 s52, s3, 6
v_exp_f32 v92, v92
v_mfma_f32_16x16x32_bf16 v[240:243], a[76:79], v[140:143], 0
s_mul_i32 s52, s52, 16384
v_exp_f32 v93, v93
v_mfma_f32_16x16x32_bf16 v[204:207], a[76:79], v[124:127], 0
s_add_u32 s68, s68, s52
v_exp_f32 v94, v94
v_mfma_f32_16x16x32_bf16 v[108:111], a[80:83], v[124:127], 0
s_lshl_b32 s53, s53, 14
v_exp_f32 v95, v95
v_mfma_f32_16x16x32_bf16 v[188:191], a[80:83], v[140:143], 0
s_add_u32 s70, s70, s53
v_cvt_pk_bf16_f32 v232, v92, v93
v_cvt_pk_bf16_f32 v233, v94, v95
v_mfma_f32_16x16x32_bf16 v[56:59], a[84:87], v[140:143], 0
s_mov_b32 s75, 65536
v_exp_f32 v176, v176
v_mfma_f32_16x16x32_bf16 v[40:43], a[84:87], v[124:127], 0
s_mov_b32 s72, 1
v_exp_f32 v177, v177
v_mfma_f32_16x16x32_bf16 v[80:83], a[88:91], v[124:127], 0
s_mov_b32 s73, 3
v_exp_f32 v178, v178
v_mfma_f32_16x16x32_bf16 v[88:91], a[88:91], v[140:143], 0
s_lshl2_add_u32 s69, s5, 4
v_exp_f32 v179, v179
v_mfma_f32_16x16x32_bf16 v[192:195], a[92:95], v[140:143], 0
s_max_u32 s69, s69, 12
v_cvt_pk_bf16_f32 v250, v176, v177
v_cvt_pk_bf16_f32 v251, v178, v179
v_mfma_f32_16x16x32_bf16 v[168:171], a[92:95], v[124:127], 0
s_min_u32 s74, s73, s66
v_exp_f32 v228, v228
v_mfma_f32_16x16x32_bf16 a[224:227], a[240:243], v[124:127], 0
s_mov_b32 s93, 3
v_mfma_f32_16x16x32_bf16 a[228:231], a[240:243], v[140:143], 0
s_cmp_lt_u32 s66, 2
s_waitcnt vmcnt(24) lgkmcnt(0)
s_cbranch_scc1 L_NE
L_DUAL:
v_mfma_f32_16x16x32_bf16 v[44:47], a[192:195], a[32:35], v[96:99]
s_barrier
v_mfma_f32_16x16x32_bf16 v[44:47], a[196:199], a[36:39], v[44:47]
s_cmp_eq_u32 s68, s71
v_exp_f32 v229, v229
v_mfma_f32_16x16x32_bf16 v[44:47], a[200:203], a[28:31], v[44:47]
s_cselect_b32 s64, s77, s68
v_add_u32 v5, s75, v4
v_cvt_pk_bf16_f32 v234, v228, v229
v_mfma_f32_16x16x32_bf16 v[44:47], a[204:207], a[20:23], v[44:47]
s_mov_b32 m0, s70
v_exp_f32 v230, v230
v_mfma_f32_16x16x32_bf16 v[52:55], a[192:195], a[44:47], v[104:107]
buffer_load_dwordx4 v4, s[24:27], s64 offen offset:0 sc1 lds
v_mfma_f32_16x16x32_bf16 v[52:55], a[196:199], a[40:43], v[52:55]
s_add_u32 s75, s75, 16384
v_exp_f32 v231, v231
v_mfma_f32_16x16x32_bf16 v[52:55], a[200:203], a[12:15], v[52:55]
v_cvt_pk_bf16_f32 v235, v230, v231
v_mfma_f32_16x16x32_bf16 v[52:55], a[204:207], a[4:7], v[52:55]
s_cmp_ge_u32 s75, 163840
v_exp_f32 v44, v44
v_mfma_f32_16x16x32_bf16 v[64:67], a[208:211], a[32:35], v[112:115]
v_mfma_f32_16x16x32_bf16 v[64:67], a[212:215], a[36:39], v[64:67]
s_cselect_b32 s75, 0, s75
v_exp_f32 v45, v45
v_mfma_f32_16x16x32_bf16 v[64:67], a[216:219], a[28:31], v[64:67]
v_cvt_pk_bf16_f32 v124, v44, v45
v_mfma_f32_16x16x32_bf16 v[64:67], a[220:223], a[20:23], v[64:67]
s_add_u32 s68, s64, 16384
v_exp_f32 v46, v46
v_mfma_f32_16x16x32_bf16 v[212:215], a[208:211], a[44:47], v[120:123]
buffer_load_dwordx4 v4, s[24:27], s64 offen offset:1024 sc1 lds
v_mfma_f32_16x16x32_bf16 v[212:215], a[212:215], a[40:43], v[212:215]
s_add_u32 s70, s70, 16384
v_exp_f32 v47, v47
v_mfma_f32_16x16x32_bf16 v[212:215], a[216:219], a[12:15], v[212:215]
v_cvt_pk_bf16_f32 v125, v46, v47
v_mfma_f32_16x16x32_bf16 v[212:215], a[220:223], a[4:7], v[212:215]
v_exp_f32 v52, v52
v_mfma_f32_16x16x32_bf16 v[60:63], a[64:67], v[248:251], v[60:63]
v_mfma_f32_16x16x32_bf16 v[148:151], a[64:67], v[232:235], v[148:151]
s_cmp_ge_u32 s70, 163840
v_exp_f32 v53, v53
v_mfma_f32_16x16x32_bf16 v[48:51], a[68:71], v[232:235], v[48:51]
ds_read_b128 a[64:67], v5 offset:8192
v_cvt_pk_bf16_f32 v140, v52, v53
v_mfma_f32_16x16x32_bf16 v[68:71], a[68:71], v[248:251], v[68:71]
s_cselect_b32 s70, s80, s70
v_exp_f32 v54, v54
v_mfma_f32_16x16x32_bf16 v[72:75], a[72:75], v[248:251], v[72:75]
buffer_load_dwordx4 v4, s[24:27], s64 offen offset:2048 sc1 lds
v_mfma_f32_16x16x32_bf16 v[236:239], a[72:75], v[232:235], v[236:239]
v_exp_f32 v55, v55
v_mfma_f32_16x16x32_bf16 v[224:227], a[76:79], v[232:235], v[224:227]
ds_read_b128 a[68:71], v5 offset:9216
v_cvt_pk_bf16_f32 v141, v54, v55
v_mfma_f32_16x16x32_bf16 v[220:223], a[76:79], v[248:251], v[220:223]
v_exp_f32 v64, v64
v_mfma_f32_16x16x32_bf16 v[84:87], a[80:83], v[248:251], v[84:87]
ds_read_b128 a[72:75], v5 offset:10240
v_mfma_f32_16x16x32_bf16 v[164:167], a[80:83], v[232:235], v[164:167]
v_exp_f32 v65, v65
v_mfma_f32_16x16x32_bf16 v[156:159], a[84:87], v[232:235], v[156:159]
ds_read_b128 a[76:79], v5 offset:11264
v_cvt_pk_bf16_f32 v126, v64, v65
v_mfma_f32_16x16x32_bf16 v[76:79], a[84:87], v[248:251], v[76:79]
v_exp_f32 v66, v66
v_mfma_f32_16x16x32_bf16 v[160:163], a[88:91], v[248:251], v[160:163]
buffer_load_dwordx4 v4, s[24:27], s64 offen offset:3072 sc1 lds
v_mfma_f32_16x16x32_bf16 v[216:219], a[88:91], v[232:235], v[216:219]
v_exp_f32 v67, v67
v_mfma_f32_16x16x32_bf16 v[208:211], a[92:95], v[232:235], v[208:211]
ds_read_b128 a[80:83], v5 offset:12288
v_cvt_pk_bf16_f32 v127, v66, v67
v_mfma_f32_16x16x32_bf16 v[252:255], a[92:95], v[248:251], v[252:255]
v_exp_f32 v212, v212
v_mfma_f32_16x16x32_bf16 a[232:235], a[240:243], v[248:251], a[232:235]
ds_read_b128 a[84:87], v5 offset:13312
v_mfma_f32_16x16x32_bf16 a[236:239], a[240:243], v[232:235], a[236:239]
ds_read_b128 a[88:91], v5 offset:14336
v_mfma_f32_16x16x32_bf16 v[100:103], a[192:195], a[48:51], v[128:131]
ds_read_b128 a[92:95], v5 offset:15360
v_mfma_f32_16x16x32_bf16 v[100:103], a[196:199], a[52:55], v[100:103]
v_exp_f32 v213, v213
v_mfma_f32_16x16x32_bf16 v[100:103], a[200:203], a[0:3], v[100:103]
v_cvt_pk_bf16_f32 v142, v212, v213
v_mfma_f32_16x16x32_bf16 v[100:103], a[204:207], a[8:11], v[100:103]
v_exp_f32 v214, v214
v_mfma_f32_16x16x32_bf16 v[92:95], a[192:195], a[60:63], v[136:139]
s_nop 0
v_mfma_f32_16x16x32_bf16 v[92:95], a[196:199], a[56:59], v[92:95]
v_exp_f32 v215, v215
v_mfma_f32_16x16x32_bf16 v[92:95], a[200:203], a[16:19], v[92:95]
ds_read_b128 a[192:195], v5 offset:0
v_cvt_pk_bf16_f32 v143, v214, v215
v_mfma_f32_16x16x32_bf16 v[92:95], a[204:207], a[24:27], v[92:95]
v_exp_f32 v100, v100
v_mfma_f32_16x16x32_bf16 v[176:179], a[208:211], a[48:51], v[144:147]
ds_read_b128 a[196:199], v5 offset:1024
v_mfma_f32_16x16x32_bf16 v[176:179], a[212:215], a[52:55], v[176:179]
v_exp_f32 v101, v101
v_mfma_f32_16x16x32_bf16 v[176:179], a[216:219], a[0:3], v[176:179]
ds_read_b128 a[200:203], v5 offset:2048
v_cvt_pk_bf16_f32 v248, v100, v101
v_mfma_f32_16x16x32_bf16 v[176:179], a[220:223], a[8:11], v[176:179]
v_exp_f32 v102, v102
v_mfma_f32_16x16x32_bf16 v[228:231], a[208:211], a[60:63], v[152:155]
ds_read_b128 a[204:207], v5 offset:3072
v_mfma_f32_16x16x32_bf16 v[228:231], a[212:215], a[56:59], v[228:231]
v_exp_f32 v103, v103
v_mfma_f32_16x16x32_bf16 v[228:231], a[216:219], a[16:19], v[228:231]
ds_read_b128 a[208:211], v5 offset:4096
v_cvt_pk_bf16_f32 v249, v102, v103
v_mfma_f32_16x16x32_bf16 v[228:231], a[220:223], a[24:27], v[228:231]
s_waitcnt lgkmcnt(5)
v_exp_f32 v92, v92
v_mfma_f32_16x16x32_bf16 v[36:39], a[64:67], v[124:127], v[36:39]
ds_read_b128 a[212:215], v5 offset:5120
v_mfma_f32_16x16x32_bf16 v[116:119], a[64:67], v[140:143], v[116:119]
v_exp_f32 v93, v93
v_mfma_f32_16x16x32_bf16 v[132:135], a[68:71], v[140:143], v[132:135]
ds_read_b128 a[216:219], v5 offset:6144
v_cvt_pk_bf16_f32 v232, v92, v93
v_mfma_f32_16x16x32_bf16 v[32:35], a[68:71], v[124:127], v[32:35]
v_exp_f32 v94, v94
v_mfma_f32_16x16x32_bf16 v[196:199], a[72:75], v[124:127], v[196:199]
ds_read_b128 a[220:223], v5 offset:7168
v_mfma_f32_16x16x32_bf16 v[184:187], a[72:75], v[140:143], v[184:187]
s_add_u32 s72, s72, 1
v_exp_f32 v95, v95
v_mfma_f32_16x16x32_bf16 v[240:243], a[76:79], v[140:143], v[240:243]
v_cvt_pk_bf16_f32 v233, v94, v95
v_mfma_f32_16x16x32_bf16 v[204:207], a[76:79], v[124:127], v[204:207]
v_exp_f32 v176, v176
v_mfma_f32_16x16x32_bf16 v[108:111], a[80:83], v[124:127], v[108:111]
v_mfma_f32_16x16x32_bf16 v[188:191], a[80:83], v[140:143], v[188:191]
v_exp_f32 v177, v177
v_mfma_f32_16x16x32_bf16 v[56:59], a[84:87], v[140:143], v[56:59]
v_cvt_pk_bf16_f32 v250, v176, v177
v_mfma_f32_16x16x32_bf16 v[40:43], a[84:87], v[124:127], v[40:43]
v_exp_f32 v178, v178
v_mfma_f32_16x16x32_bf16 v[80:83], a[88:91], v[124:127], v[80:83]
v_mfma_f32_16x16x32_bf16 v[88:91], a[88:91], v[140:143], v[88:91]
s_cmp_lt_u32 s72, s74
v_exp_f32 v179, v179
v_mfma_f32_16x16x32_bf16 v[192:195], a[92:95], v[140:143], v[192:195]
v_cvt_pk_bf16_f32 v251, v178, v179
v_mfma_f32_16x16x32_bf16 v[168:171], a[92:95], v[124:127], v[168:171]
s_waitcnt vmcnt(8) lgkmcnt(0)
v_exp_f32 v228, v228
v_mfma_f32_16x16x32_bf16 a[224:227], a[240:243], v[124:127], a[224:227]
v_mfma_f32_16x16x32_bf16 a[228:231], a[240:243], v[140:143], a[228:231]
s_cbranch_scc1 L_DUAL
L_DISP:
s_cmp_eq_u32 s72, s93
s_cbranch_scc1 L_STOP
L_NE:
s_mov_b32 s74, s93
s_cmp_gt_u32 s72, s66
s_cbranch_scc1 L_SINGLE
v_cndmask_b32 v96, v96, v6, s[56:57]
v_cndmask_b32 v120, v120, v6, s[56:57]
v_mov_b32 v112, v6
v_cndmask_b32 v97, v97, v6, s[58:59]
v_cndmask_b32 v121, v121, v6, s[58:59]
v_mov_b32 v113, v6
v_cndmask_b32 v98, v98, v6, s[60:61]
v_cndmask_b32 v122, v122, v6, s[60:61]
v_mov_b32 v114, v6
v_cndmask_b32 v99, v99, v6, s[62:63]
v_cndmask_b32 v123, v123, v6, s[62:63]
v_mov_b32 v115, v6
s_mov_b32 s74, 0
s_branch L_DUAL
L_STOP:
s_cmp_eq_u32 s72, 3
s_cbranch_scc1 L_E0
s_cmp_eq_u32 s72, 9
s_cbranch_scc1 L_E1
s_cmp_lg_u32 s72, 11
s_cbranch_scc1 L_SE
v_cmp_gt_u32 vcc, 32, v172
s_mov_b32 s73, 32
s_min_u32 s93, s73, s69
s_min_u32 s74, s93, s66
v_accvgpr_read_b32 v16, a244
v_accvgpr_read_b32 v17, a248
v_accvgpr_read_b32 v18, a252
s_cbranch_vccnz CK_Q
CK_Q_R:
buffer_load_dwordx4 a[244:247], v16, s[24:27], 0 offen sc1
buffer_load_dwordx4 a[248:251], v17, s[24:27], 0 offen sc1
buffer_load_dwordx4 a[252:255], v18, s[24:27], 0 offen sc1
s_add_u32 s53, s77, 163840
buffer_load_dwordx4 a[96:99], v4, s[24:27], s53 offen offset:0 sc1
buffer_load_dwordx4 a[100:103], v4, s[24:27], s53 offen offset:1024 sc1
buffer_load_dwordx4 a[104:107], v4, s[24:27], s53 offen offset:2048 sc1
buffer_load_dwordx4 a[108:111], v4, s[24:27], s53 offen offset:3072 sc1
s_cmp_lt_u32 s72, s66
s_cbranch_scc1 L_DUAL
s_mov_b32 s74, s93
s_cmp_gt_u32 s72, s66
s_cbranch_scc1 L_SINGLE
s_branch L_NE
L_E0:
buffer_atomic_add v1, v0, s[24:27], s89 offen offset:8 sc1
s_mov_b32 s73, 9
s_min_u32 s93, s73, s69
s_min_u32 s74, s93, s66
s_cmp_lt_u32 s72, s66
s_cbranch_scc1 L_DUAL
s_mov_b32 s74, s93
s_cmp_gt_u32 s72, s66
s_cbranch_scc1 L_SINGLE
s_branch L_NE
L_E1:
v_and_b32 v173, 31, v1
v_lshlrev_b32 v173, 10, v173
v_add_u32 v173, 75497992, v173
buffer_load_dword v172, v173, s[24:27], 0 offen sc1
s_mov_b32 s73, 11
s_cmp_lt_u32 s4, 16
s_cselect_b32 s52, s66, s67
s_and_b32 s53, s4, 15
s_lshl4_add_u32 s52, s52, s53
s_mul_i32 s52, s52, 2304
v_lshlrev_b32 v16, 2, v1
buffer_store_dwordx4 v[0:3], v4, s[44:47], s52 offen sc1
buffer_store_dwordx4 v[0:3], v4, s[44:47], s52 offen offset:1024 sc1
buffer_store_dword v0, v16, s[44:47], s52 offen offset:2048 sc1
s_min_u32 s93, s73, s69
s_min_u32 s74, s93, s66
s_cmp_lt_u32 s72, s66
s_cbranch_scc1 L_DUAL
s_mov_b32 s74, s93
s_cmp_gt_u32 s72, s66
s_cbranch_scc1 L_SINGLE
s_branch L_NE
L_SE:
s_lshr_b32 s52, s4, 3
s_mul_i32 s52, s52, 75776
s_add_u32 s52, s52, 54525952
s_and_b32 s53, s4, 7
s_mul_i32 s53, s53, 8192
s_add_u32 s52, s52, s53
s_mul_i32 s78, s66, 303104
s_add_u32 s78, s78, s52
s_mul_i32 s79, s67, 303104
s_add_u32 s79, s79, s52
s_mov_b32 s76, 0
v_mov_b32 v7, 0x5d800000
s_mov_b32 s69, 64
v_accvgpr_read_b32 v180, a224
v_accvgpr_read_b32 v182, a228
v_cmp_nle_f32 vcc, v180, v7
v_cmp_nle_f32 s[96:97], v182, v7
s_nop 3
s_or_b64 vcc, vcc, s[96:97]
s_cbranch_vccnz L_NS
s_add_u32 s53, s77, 180224
buffer_load_dwordx4 a[112:115], v4, s[24:27], s53 offen offset:0 sc1
v_mul_f32 v8, 0x3fb8aa3b, v8
v_mul_f32 v9, 0x3fb8aa3b, v9
v_exp_f32 v8, v8
v_exp_f32 v9, v9
s_nop 0
v_fma_f32 v180, v180, v8, v180
v_fma_f32 v182, v182, v9, v182
v_rcp_f32 v180, v180
v_rcp_f32 v182, v182
s_add_u32 s52, s78, 4096
v_mov_b32 v181, v180
v_mov_b32 v183, v182
v_pk_mul_f32 v[36:37], v[36:37], v[180:181]
v_pk_mul_f32 v[38:39], v[38:39], v[180:181]
v_pk_mul_f32 v[32:33], v[32:33], v[180:181]
v_pk_mul_f32 v[34:35], v[34:35], v[180:181]
v_cvt_pk_bf16_f32 v36, v36, v37
v_cvt_pk_bf16_f32 v37, v38, v39
v_cvt_pk_bf16_f32 v38, v32, v33
v_cvt_pk_bf16_f32 v39, v34, v35
buffer_store_dwordx4 v[36:39], v4, s[24:27], s78 offen offset:0 sc1
buffer_load_dwordx4 a[116:119], v4, s[24:27], s53 offen offset:1024 sc1
v_pk_mul_f32 v[116:117], v[116:117], v[182:183]
v_pk_mul_f32 v[118:119], v[118:119], v[182:183]
v_pk_mul_f32 v[132:133], v[132:133], v[182:183]
v_pk_mul_f32 v[134:135], v[134:135], v[182:183]
v_cvt_pk_bf16_f32 v116, v116, v117
v_cvt_pk_bf16_f32 v117, v118, v119
v_cvt_pk_bf16_f32 v118, v132, v133
v_cvt_pk_bf16_f32 v119, v134, v135
buffer_store_dwordx4 v[116:119], v4, s[24:27], s78 offen offset:1024 sc1
v_pk_mul_f32 v[196:197], v[196:197], v[180:181]
v_pk_mul_f32 v[198:199], v[198:199], v[180:181]
v_pk_mul_f32 v[204:205], v[204:205], v[180:181]
v_pk_mul_f32 v[206:207], v[206:207], v[180:181]
v_cvt_pk_bf16_f32 v196, v196, v197
v_cvt_pk_bf16_f32 v197, v198, v199
v_cvt_pk_bf16_f32 v198, v204, v205
v_cvt_pk_bf16_f32 v199, v206, v207
buffer_store_dwordx4 v[196:199], v4, s[24:27], s78 offen offset:2048 sc1
v_pk_mul_f32 v[184:185], v[184:185], v[182:183]
v_pk_mul_f32 v[186:187], v[186:187], v[182:183]
v_pk_mul_f32 v[240:241], v[240:241], v[182:183]
buffer_load_dwordx4 a[120:123], v4, s[24:27], s53 offen offset:2048 sc1
v_pk_mul_f32 v[242:243], v[242:243], v[182:183]
v_cvt_pk_bf16_f32 v184, v184, v185
v_cvt_pk_bf16_f32 v185, v186, v187
v_cvt_pk_bf16_f32 v186, v240, v241
v_cvt_pk_bf16_f32 v187, v242, v243
buffer_store_dwordx4 v[184:187], v4, s[24:27], s78 offen offset:3072 sc1
v_pk_mul_f32 v[108:109], v[108:109], v[180:181]
v_pk_mul_f32 v[110:111], v[110:111], v[180:181]
v_pk_mul_f32 v[40:41], v[40:41], v[180:181]
v_pk_mul_f32 v[42:43], v[42:43], v[180:181]
v_cvt_pk_bf16_f32 v108, v108, v109
v_cvt_pk_bf16_f32 v109, v110, v111
v_cvt_pk_bf16_f32 v110, v40, v41
v_cvt_pk_bf16_f32 v111, v42, v43
buffer_store_dwordx4 v[108:111], v4, s[24:27], s52 offen offset:0 sc1
v_pk_mul_f32 v[188:189], v[188:189], v[182:183]
v_pk_mul_f32 v[190:191], v[190:191], v[182:183]
v_pk_mul_f32 v[56:57], v[56:57], v[182:183]
v_pk_mul_f32 v[58:59], v[58:59], v[182:183]
v_cvt_pk_bf16_f32 v188, v188, v189
v_cvt_pk_bf16_f32 v189, v190, v191
buffer_load_dwordx4 a[124:127], v4, s[24:27], s53 offen offset:3072 sc1
v_cvt_pk_bf16_f32 v190, v56, v57
v_cvt_pk_bf16_f32 v191, v58, v59
buffer_store_dwordx4 v[188:191], v4, s[24:27], s52 offen offset:1024 sc1
v_pk_mul_f32 v[80:81], v[80:81], v[180:181]
v_pk_mul_f32 v[82:83], v[82:83], v[180:181]
v_pk_mul_f32 v[168:169], v[168:169], v[180:181]
v_pk_mul_f32 v[170:171], v[170:171], v[180:181]
v_cvt_pk_bf16_f32 v80, v80, v81
v_cvt_pk_bf16_f32 v81, v82, v83
v_cvt_pk_bf16_f32 v82, v168, v169
v_cvt_pk_bf16_f32 v83, v170, v171
buffer_store_dwordx4 v[80:83], v4, s[24:27], s52 offen offset:2048 sc1
v_pk_mul_f32 v[88:89], v[88:89], v[182:183]
v_pk_mul_f32 v[90:91], v[90:91], v[182:183]
v_pk_mul_f32 v[192:193], v[192:193], v[182:183]
v_pk_mul_f32 v[194:195], v[194:195], v[182:183]
v_cvt_pk_bf16_f32 v88, v88, v89
v_cvt_pk_bf16_f32 v89, v90, v91
v_cvt_pk_bf16_f32 v90, v192, v193
v_cvt_pk_bf16_f32 v91, v194, v195
buffer_store_dwordx4 v[88:91], v4, s[24:27], s52 offen offset:3072 sc1
L_PAD9:
s_cbranch_execz L_PAD13
s_mov_b32 s76, 1
L_NS:
s_mov_b32 s74, s73
s_mov_b32 s93, s73
s_cmp_eq_u32 s72, 32
s_cbranch_scc1 L_FIN
L_SINGLE:
v_mfma_f32_16x16x32_bf16 v[44:47], a[192:195], a[48:51], v[128:131]
s_barrier
v_mfma_f32_16x16x32_bf16 v[44:47], a[196:199], a[52:55], v[44:47]
s_cmp_eq_u32 s68, s71
v_exp_f32 v229, v229
v_mfma_f32_16x16x32_bf16 v[44:47], a[200:203], a[0:3], v[44:47]
s_cselect_b32 s64, s77, s68
v_add_u32 v5, s75, v4
v_cvt_pk_bf16_f32 v234, v228, v229
v_mfma_f32_16x16x32_bf16 v[44:47], a[204:207], a[8:11], v[44:47]
s_mov_b32 m0, s70
v_exp_f32 v230, v230
v_mfma_f32_16x16x32_bf16 v[52:55], a[192:195], a[60:63], v[136:139]
buffer_load_dwordx4 v4, s[24:27], s64 offen offset:0 sc1 lds
v_mfma_f32_16x16x32_bf16 v[52:55], a[196:199], a[56:59], v[52:55]
s_add_u32 s75, s75, 16384
v_exp_f32 v231, v231
v_mfma_f32_16x16x32_bf16 v[52:55], a[200:203], a[16:19], v[52:55]
ds_read_b128 a[192:195], v5 offset:0
v_cvt_pk_bf16_f32 v235, v230, v231
v_mfma_f32_16x16x32_bf16 v[52:55], a[204:207], a[24:27], v[52:55]
s_cmp_ge_u32 s75, 163840
v_exp_f32 v44, v44
v_mfma_f32_16x16x32_bf16 v[64:67], a[208:211], a[48:51], v[144:147]
ds_read_b128 a[196:199], v5 offset:1024
ds_read_b128 a[200:203], v5 offset:2048
v_mfma_f32_16x16x32_bf16 v[64:67], a[212:215], a[52:55], v[64:67]
s_cselect_b32 s75, 0, s75
v_exp_f32 v45, v45
v_mfma_f32_16x16x32_bf16 v[64:67], a[216:219], a[0:3], v[64:67]
ds_read_b128 a[204:207], v5 offset:3072
v_cvt_pk_bf16_f32 v124, v44, v45
v_mfma_f32_16x16x32_bf16 v[64:67], a[220:223], a[8:11], v[64:67]
s_add_u32 s68, s64, 16384
v_exp_f32 v46, v46
v_mfma_f32_16x16x32_bf16 v[212:215], a[208:211], a[60:63], v[152:155]
buffer_load_dwordx4 v4, s[24:27], s64 offen offset:1024 sc1 lds
v_mfma_f32_16x16x32_bf16 v[212:215], a[212:215], a[56:59], v[212:215]
s_add_u32 s70, s70, 16384
v_exp_f32 v47, v47
v_mfma_f32_16x16x32_bf16 v[212:215], a[216:219], a[16:19], v[212:215]
ds_read_b128 a[208:211], v5 offset:4096
v_cvt_pk_bf16_f32 v125, v46, v47
v_mfma_f32_16x16x32_bf16 v[212:215], a[220:223], a[24:27], v[212:215]
s_waitcnt lgkmcnt(5)
v_exp_f32 v52, v52
v_mfma_f32_16x16x32_bf16 v[60:63], a[64:67], v[248:251], v[60:63]
ds_read_b128 a[212:215], v5 offset:5120
ds_read_b128 a[216:219], v5 offset:6144
v_mfma_f32_16x16x32_bf16 v[148:151], a[64:67], v[232:235], v[148:151]
s_cmp_ge_u32 s70, 163840
v_exp_f32 v53, v53
v_mfma_f32_16x16x32_bf16 v[48:51], a[68:71], v[232:235], v[48:51]
ds_read_b128 a[220:223], v5 offset:7168
v_cvt_pk_bf16_f32 v140, v52, v53
v_mfma_f32_16x16x32_bf16 v[68:71], a[68:71], v[248:251], v[68:71]
s_cselect_b32 s70, s80, s70
v_exp_f32 v54, v54
v_mfma_f32_16x16x32_bf16 v[72:75], a[72:75], v[248:251], v[72:75]
buffer_load_dwordx4 v4, s[24:27], s64 offen offset:2048 sc1 lds
v_mfma_f32_16x16x32_bf16 v[236:239], a[72:75], v[232:235], v[236:239]
v_exp_f32 v55, v55
v_mfma_f32_16x16x32_bf16 v[224:227], a[76:79], v[232:235], v[224:227]
ds_read_b128 a[64:67], v5 offset:8192
v_cvt_pk_bf16_f32 v141, v54, v55
v_mfma_f32_16x16x32_bf16 v[220:223], a[76:79], v[248:251], v[220:223]
v_exp_f32 v64, v64
v_mfma_f32_16x16x32_bf16 v[84:87], a[80:83], v[248:251], v[84:87]
ds_read_b128 a[68:71], v5 offset:9216
ds_read_b128 a[72:75], v5 offset:10240
v_mfma_f32_16x16x32_bf16 v[164:167], a[80:83], v[232:235], v[164:167]
v_exp_f32 v65, v65
v_mfma_f32_16x16x32_bf16 v[156:159], a[84:87], v[232:235], v[156:159]
ds_read_b128 a[76:79], v5 offset:11264
v_cvt_pk_bf16_f32 v126, v64, v65
v_mfma_f32_16x16x32_bf16 v[76:79], a[84:87], v[248:251], v[76:79]
s_cmp_eq_u32 s68, s71
v_exp_f32 v66, v66
v_mfma_f32_16x16x32_bf16 v[160:163], a[88:91], v[248:251], v[160:163]
buffer_load_dwordx4 v4, s[24:27], s64 offen offset:3072 sc1 lds
v_mfma_f32_16x16x32_bf16 v[216:219], a[88:91], v[232:235], v[216:219]
s_cselect_b32 s64, s77, s68
v_exp_f32 v67, v67
v_mfma_f32_16x16x32_bf16 v[208:211], a[92:95], v[232:235], v[208:211]
ds_read_b128 a[80:83], v5 offset:12288
v_cvt_pk_bf16_f32 v127, v66, v67
v_mfma_f32_16x16x32_bf16 v[252:255], a[92:95], v[248:251], v[252:255]
s_waitcnt lgkmcnt(5)
v_exp_f32 v212, v212
v_mfma_f32_16x16x32_bf16 a[232:235], a[240:243], v[248:251], a[232:235]
ds_read_b128 a[84:87], v5 offset:13312
ds_read_b128 a[88:91], v5 offset:14336
v_mfma_f32_16x16x32_bf16 a[236:239], a[240:243], v[232:235], a[236:239]
s_mov_b32 m0, s70
ds_read_b128 a[92:95], v5 offset:15360
v_mfma_f32_16x16x32_bf16 v[100:103], a[192:195], a[48:51], v[128:131]
buffer_load_dwordx4 v4, s[24:27], s64 offen offset:0 sc1 lds
v_mfma_f32_16x16x32_bf16 v[100:103], a[196:199], a[52:55], v[100:103]
v_exp_f32 v213, v213
v_mfma_f32_16x16x32_bf16 v[100:103], a[200:203], a[0:3], v[100:103]
v_add_u32 v5, s75, v4
v_cvt_pk_bf16_f32 v142, v212, v213
v_mfma_f32_16x16x32_bf16 v[100:103], a[204:207], a[8:11], v[100:103]
v_exp_f32 v214, v214
v_mfma_f32_16x16x32_bf16 v[92:95], a[192:195], a[60:63], v[136:139]
buffer_load_dwordx4 v4, s[24:27], s64 offen offset:1024 sc1 lds
v_mfma_f32_16x16x32_bf16 v[92:95], a[196:199], a[56:59], v[92:95]
s_add_u32 s75, s75, 16384
v_exp_f32 v215, v215
v_mfma_f32_16x16x32_bf16 v[92:95], a[200:203], a[16:19], v[92:95]
ds_read_b128 a[192:195], v5 offset:0
v_cvt_pk_bf16_f32 v143, v214, v215
v_mfma_f32_16x16x32_bf16 v[92:95], a[204:207], a[24:27], v[92:95]
s_cmp_ge_u32 s75, 163840
v_exp_f32 v100, v100
v_mfma_f32_16x16x32_bf16 v[176:179], a[208:211], a[48:51], v[144:147]
ds_read_b128 a[196:199], v5 offset:1024
ds_read_b128 a[200:203], v5 offset:2048
v_mfma_f32_16x16x32_bf16 v[176:179], a[212:215], a[52:55], v[176:179]
s_cselect_b32 s75, 0, s75
v_exp_f32 v101, v101
v_mfma_f32_16x16x32_bf16 v[176:179], a[216:219], a[0:3], v[176:179]
ds_read_b128 a[204:207], v5 offset:3072
v_cvt_pk_bf16_f32 v248, v100, v101
v_mfma_f32_16x16x32_bf16 v[176:179], a[220:223], a[8:11], v[176:179]
s_add_u32 s68, s64, 16384
v_exp_f32 v102, v102
v_mfma_f32_16x16x32_bf16 v[228:231], a[208:211], a[60:63], v[152:155]
buffer_load_dwordx4 v4, s[24:27], s64 offen offset:2048 sc1 lds
v_mfma_f32_16x16x32_bf16 v[228:231], a[212:215], a[56:59], v[228:231]
s_add_u32 s70, s70, 16384
v_exp_f32 v103, v103
v_mfma_f32_16x16x32_bf16 v[228:231], a[216:219], a[16:19], v[228:231]
ds_read_b128 a[208:211], v5 offset:4096
v_cvt_pk_bf16_f32 v249, v102, v103
v_mfma_f32_16x16x32_bf16 v[228:231], a[220:223], a[24:27], v[228:231]
s_waitcnt lgkmcnt(5)
v_exp_f32 v92, v92
v_mfma_f32_16x16x32_bf16 v[60:63], a[64:67], v[124:127], v[60:63]
ds_read_b128 a[212:215], v5 offset:5120
ds_read_b128 a[216:219], v5 offset:6144
v_mfma_f32_16x16x32_bf16 v[148:151], a[64:67], v[140:143], v[148:151]
s_cmp_ge_u32 s70, 163840
v_exp_f32 v93, v93
v_mfma_f32_16x16x32_bf16 v[48:51], a[68:71], v[140:143], v[48:51]
ds_read_b128 a[220:223], v5 offset:7168
v_cvt_pk_bf16_f32 v232, v92, v93
v_mfma_f32_16x16x32_bf16 v[68:71], a[68:71], v[124:127], v[68:71]
s_cselect_b32 s70, s80, s70
v_exp_f32 v94, v94
v_mfma_f32_16x16x32_bf16 v[72:75], a[72:75], v[124:127], v[72:75]
buffer_load_dwordx4 v4, s[24:27], s64 offen offset:3072 sc1 lds
v_mfma_f32_16x16x32_bf16 v[236:239], a[72:75], v[140:143], v[236:239]
s_add_u32 s72, s72, 1
v_exp_f32 v95, v95
v_mfma_f32_16x16x32_bf16 v[224:227], a[76:79], v[140:143], v[224:227]
ds_read_b128 a[64:67], v5 offset:8192
v_cvt_pk_bf16_f32 v233, v94, v95
v_mfma_f32_16x16x32_bf16 v[220:223], a[76:79], v[124:127], v[220:223]
v_exp_f32 v176, v176
v_mfma_f32_16x16x32_bf16 v[84:87], a[80:83], v[124:127], v[84:87]
ds_read_b128 a[68:71], v5 offset:9216
ds_read_b128 a[72:75], v5 offset:10240
v_mfma_f32_16x16x32_bf16 v[164:167], a[80:83], v[140:143], v[164:167]
v_exp_f32 v177, v177
v_mfma_f32_16x16x32_bf16 v[156:159], a[84:87], v[140:143], v[156:159]
ds_read_b128 a[76:79], v5 offset:11264
v_cvt_pk_bf16_f32 v250, v176, v177
v_mfma_f32_16x16x32_bf16 v[76:79], a[84:87], v[124:127], v[76:79]
v_exp_f32 v178, v178
v_mfma_f32_16x16x32_bf16 v[160:163], a[88:91], v[124:127], v[160:163]
ds_read_b128 a[80:83], v5 offset:12288
ds_read_b128 a[84:87], v5 offset:13312
v_mfma_f32_16x16x32_bf16 v[216:219], a[88:91], v[140:143], v[216:219]
s_cmp_lt_u32 s72, s74
v_exp_f32 v179, v179
v_mfma_f32_16x16x32_bf16 v[208:211], a[92:95], v[140:143], v[208:211]
ds_read_b128 a[88:91], v5 offset:14336
v_cvt_pk_bf16_f32 v251, v178, v179
v_mfma_f32_16x16x32_bf16 v[252:255], a[92:95], v[124:127], v[252:255]
s_waitcnt vmcnt(8) lgkmcnt(7)
v_exp_f32 v228, v228
v_mfma_f32_16x16x32_bf16 a[232:235], a[240:243], v[124:127], a[232:235]
ds_read_b128 a[92:95], v5 offset:15360
v_mfma_f32_16x16x32_bf16 a[236:239], a[240:243], v[140:143], a[236:239]
s_cbranch_scc1 L_SINGLE
s_cmp_eq_u32 s72, s69
s_cbranch_scc1 L_SE
s_cmp_lt_u32 s72, 32
s_cbranch_scc1 L_STOP
L_FIN:
s_add_u32 s53, s77, 196608
buffer_load_dwordx4 a[160:163], v4, s[24:27], s53 offen offset:0 sc1
v_cndmask_b32 v128, v128, v6, s[56:57]
v_cndmask_b32 v152, v152, v6, s[56:57]
v_mov_b32 v144, v6
buffer_load_dwordx4 a[164:167], v4, s[24:27], s53 offen offset:1024 sc1
v_cndmask_b32 v129, v129, v6, s[58:59]
v_cndmask_b32 v153, v153, v6, s[58:59]
v_mov_b32 v145, v6
buffer_load_dwordx4 a[168:171], v4, s[24:27], s53 offen offset:2048 sc1
v_cndmask_b32 v130, v130, v6, s[60:61]
v_cndmask_b32 v154, v154, v6, s[60:61]
v_mov_b32 v146, v6
buffer_load_dwordx4 a[172:175], v4, s[24:27], s53 offen offset:3072 sc1
v_cndmask_b32 v131, v131, v6, s[62:63]
v_cndmask_b32 v155, v155, v6, s[62:63]
v_mov_b32 v147, v6
s_mov_b32 s83, s75
s_sub_u32 s91, s70, s80
v_mfma_f32_16x16x32_bf16 v[44:47], a[192:195], a[48:51], v[128:131]
s_barrier
v_mfma_f32_16x16x32_bf16 v[44:47], a[196:199], a[52:55], v[44:47]
s_mov_b32 m0, s70
v_exp_f32 v229, v229
v_mfma_f32_16x16x32_bf16 v[44:47], a[200:203], a[0:3], v[44:47]
s_mov_b32 s64, s68
v_add_u32 v5, s75, v4
v_cvt_pk_bf16_f32 v234, v228, v229
v_mfma_f32_16x16x32_bf16 v[44:47], a[204:207], a[8:11], v[44:47]
s_add_u32 s68, s68, 16384
v_exp_f32 v230, v230
v_mfma_f32_16x16x32_bf16 v[52:55], a[192:195], a[60:63], v[136:139]
buffer_load_dwordx4 v4, s[24:27], s64 offen offset:0 sc1 lds
v_mfma_f32_16x16x32_bf16 v[52:55], a[196:199], a[56:59], v[52:55]
s_add_u32 s70, s70, 16384
v_exp_f32 v231, v231
v_mfma_f32_16x16x32_bf16 v[52:55], a[200:203], a[16:19], v[52:55]
v_cvt_pk_bf16_f32 v235, v230, v231
v_mul_f32 v10, 0x3fb8aa3b, v10
v_mfma_f32_16x16x32_bf16 v[52:55], a[204:207], a[24:27], v[52:55]
s_cmp_ge_u32 s70, 163840
v_exp_f32 v44, v44
v_mfma_f32_16x16x32_bf16 v[64:67], a[208:211], a[48:51], v[144:147]
buffer_load_dwordx4 v4, s[24:27], s64 offen offset:1024 sc1 lds
v_mfma_f32_16x16x32_bf16 v[64:67], a[212:215], a[52:55], v[64:67]
s_cselect_b32 s70, s80, s70
v_exp_f32 v45, v45
v_mfma_f32_16x16x32_bf16 v[64:67], a[216:219], a[0:3], v[64:67]
v_cvt_pk_bf16_f32 v124, v44, v45
v_mul_f32 v11, 0x3fb8aa3b, v11
v_mfma_f32_16x16x32_bf16 v[64:67], a[220:223], a[8:11], v[64:67]
v_exp_f32 v46, v46
v_mfma_f32_16x16x32_bf16 v[212:215], a[208:211], a[60:63], v[152:155]
buffer_load_dwordx4 v4, s[24:27], s64 offen offset:2048 sc1 lds
v_mfma_f32_16x16x32_bf16 v[212:215], a[212:215], a[56:59], v[212:215]
v_exp_f32 v47, v47
v_mfma_f32_16x16x32_bf16 v[212:215], a[216:219], a[16:19], v[212:215]
v_cvt_pk_bf16_f32 v125, v46, v47
v_mfma_f32_16x16x32_bf16 v[212:215], a[220:223], a[24:27], v[212:215]
s_waitcnt lgkmcnt(0)
v_exp_f32 v52, v52
v_mfma_f32_16x16x32_bf16 v[60:63], a[64:67], v[248:251], v[60:63]
buffer_load_dwordx4 v4, s[24:27], s64 offen offset:3072 sc1 lds
v_mfma_f32_16x16x32_bf16 v[148:151], a[64:67], v[232:235], v[148:151]
s_mov_b32 m0, s70
v_exp_f32 v53, v53
v_mfma_f32_16x16x32_bf16 v[48:51], a[68:71], v[232:235], v[48:51]
s_mov_b32 s64, s68
ds_read_b128 a[64:67], v5 offset:8192
v_cvt_pk_bf16_f32 v140, v52, v53
v_mfma_f32_16x16x32_bf16 v[68:71], a[68:71], v[248:251], v[68:71]
s_add_u32 s68, s68, 16384
v_exp_f32 v54, v54
v_mfma_f32_16x16x32_bf16 v[72:75], a[72:75], v[248:251], v[72:75]
buffer_load_dwordx4 v4, s[24:27], s64 offen offset:0 sc1 lds
v_mfma_f32_16x16x32_bf16 v[236:239], a[72:75], v[232:235], v[236:239]
s_add_u32 s70, s70, 16384
v_exp_f32 v55, v55
v_mfma_f32_16x16x32_bf16 v[224:227], a[76:79], v[232:235], v[224:227]
ds_read_b128 a[68:71], v5 offset:9216
v_cvt_pk_bf16_f32 v141, v54, v55
v_mfma_f32_16x16x32_bf16 v[220:223], a[76:79], v[248:251], v[220:223]
s_cmp_ge_u32 s70, 163840
v_exp_f32 v64, v64
v_mfma_f32_16x16x32_bf16 v[84:87], a[80:83], v[248:251], v[84:87]
ds_read_b128 a[72:75], v5 offset:10240
v_mfma_f32_16x16x32_bf16 v[164:167], a[80:83], v[232:235], v[164:167]
s_cselect_b32 s70, s80, s70
v_exp_f32 v65, v65
v_mfma_f32_16x16x32_bf16 v[156:159], a[84:87], v[232:235], v[156:159]
ds_read_b128 a[76:79], v5 offset:11264
v_cvt_pk_bf16_f32 v126, v64, v65
v_mfma_f32_16x16x32_bf16 v[76:79], a[84:87], v[248:251], v[76:79]
v_exp_f32 v66, v66
v_mfma_f32_16x16x32_bf16 v[160:163], a[88:91], v[248:251], v[160:163]
buffer_load_dwordx4 v4, s[24:27], s64 offen offset:1024 sc1 lds
v_mfma_f32_16x16x32_bf16 v[216:219], a[88:91], v[232:235], v[216:219]
s_add_u32 s52, s79, 4096
v_exp_f32 v67, v67
v_mfma_f32_16x16x32_bf16 v[208:211], a[92:95], v[232:235], v[208:211]
ds_read_b128 a[80:83], v5 offset:12288
v_cvt_pk_bf16_f32 v127, v66, v67
v_mfma_f32_16x16x32_bf16 v[252:255], a[92:95], v[248:251], v[252:255]
v_exp_f32 v212, v212
v_mfma_f32_16x16x32_bf16 a[232:235], a[240:243], v[248:251], a[232:235]
ds_read_b128 a[84:87], v5 offset:13312
ds_read_b128 a[88:91], v5 offset:14336
v_mfma_f32_16x16x32_bf16 a[236:239], a[240:243], v[232:235], a[236:239]
ds_read_b128 a[92:95], v5 offset:15360
v_exp_f32 v213, v213
v_exp_f32 v214, v214
v_exp_f32 v215, v215
v_exp_f32 v10, v10
v_cvt_pk_bf16_f32 v142, v212, v213
v_cvt_pk_bf16_f32 v143, v214, v215
v_exp_f32 v11, v11
s_waitcnt lgkmcnt(0)
v_mfma_f32_16x16x32_bf16 a[232:235], a[240:243], v[124:127], a[232:235]
buffer_load_dwordx4 v4, s[24:27], s64 offen offset:2048 sc1 lds
v_mfma_f32_16x16x32_bf16 a[236:239], a[240:243], v[140:143], a[236:239]
s_barrier
v_mfma_f32_16x16x32_bf16 v[60:63], a[64:67], v[124:127], v[60:63]
v_cmp_eq_u32 vcc, 0, v3
v_mul_u32_u24 v244, 1536, v3
v_mfma_f32_16x16x32_bf16 v[148:151], a[64:67], v[140:143], v[148:151]
v_mov_b32 v246, 9728
v_cndmask_b32 v244, v244, v246, vcc
v_mfma_f32_16x16x32_bf16 v[48:51], a[68:71], v[140:143], v[48:51]
buffer_load_dwordx4 v4, s[24:27], s64 offen offset:3072 sc1 lds
v_mfma_f32_16x16x32_bf16 v[68:71], a[68:71], v[124:127], v[68:71]
v_lshl_add_u32 v247, v2, 4, s83
v_mov_b32 v246, 10496
v_mfma_f32_16x16x32_bf16 v[72:75], a[72:75], v[124:127], v[72:75]
v_accvgpr_read_b32 v180, a232
v_accvgpr_read_b32 v182, a236
v_mfma_f32_16x16x32_bf16 v[236:239], a[72:75], v[140:143], v[236:239]
v_cmp_nle_f32 vcc, v180, v7
v_cmp_nle_f32 s[96:97], v182, v7
v_mfma_f32_16x16x32_bf16 v[224:227], a[76:79], v[140:143], v[224:227]
v_fma_f32 v180, v180, v10, v180
v_fma_f32 v182, v182, v11, v182
v_mfma_f32_16x16x32_bf16 v[220:223], a[76:79], v[124:127], v[220:223]
v_rcp_f32 v180, v180
v_mfma_f32_16x16x32_bf16 v[84:87], a[80:83], v[124:127], v[84:87]
s_or_b64 vcc, vcc, s[96:97]
v_rcp_f32 v182, v182
v_mfma_f32_16x16x32_bf16 v[164:167], a[80:83], v[140:143], v[164:167]
v_mul_f32 v60, v180, v60
v_mul_f32 v61, v180, v61
v_mfma_f32_16x16x32_bf16 v[156:159], a[84:87], v[140:143], v[156:159]
v_mul_f32 v62, v180, v62
v_mul_f32 v63, v180, v63
v_mfma_f32_16x16x32_bf16 v[76:79], a[84:87], v[124:127], v[76:79]
v_mul_f32 v68, v180, v68
v_mul_f32 v69, v180, v69
v_mfma_f32_16x16x32_bf16 v[160:163], a[88:91], v[124:127], v[160:163]
v_mul_f32 v70, v180, v70
v_mul_f32 v71, v180, v71
v_mfma_f32_16x16x32_bf16 v[216:219], a[88:91], v[140:143], v[216:219]
v_cvt_pk_bf16_f32 v60, v60, v61
v_cvt_pk_bf16_f32 v61, v62, v63
v_mfma_f32_16x16x32_bf16 v[208:211], a[92:95], v[140:143], v[208:211]
v_cvt_pk_bf16_f32 v62, v68, v69
v_cvt_pk_bf16_f32 v63, v70, v71
v_mfma_f32_16x16x32_bf16 v[252:255], a[92:95], v[124:127], v[252:255]
s_cbranch_vccnz SLOW1
L_EP:
buffer_store_dwordx4 v[60:63], v4, s[24:27], s79 offen offset:0 sc1
v_pk_mul_f32 v[148:149], v[148:149], v[182:183] op_sel_hi:[1,0]
v_pk_mul_f32 v[150:151], v[150:151], v[182:183] op_sel_hi:[1,0]
v_pk_mul_f32 v[48:49], v[48:49], v[182:183] op_sel_hi:[1,0]
v_pk_mul_f32 v[50:51], v[50:51], v[182:183] op_sel_hi:[1,0]
v_cvt_pk_bf16_f32 v148, v148, v149
v_cvt_pk_bf16_f32 v149, v150, v151
v_cvt_pk_bf16_f32 v150, v48, v49
v_cvt_pk_bf16_f32 v151, v50, v51
buffer_store_dwordx4 v[148:151], v4, s[24:27], s79 offen offset:1024 sc1
v_pk_mul_f32 v[72:73], v[72:73], v[180:181] op_sel_hi:[1,0]
v_pk_mul_f32 v[74:75], v[74:75], v[180:181] op_sel_hi:[1,0]
v_pk_mul_f32 v[220:221], v[220:221], v[180:181] op_sel_hi:[1,0]
v_pk_mul_f32 v[222:223], v[222:223], v[180:181] op_sel_hi:[1,0]
v_cvt_pk_bf16_f32 v72, v72, v73
v_cvt_pk_bf16_f32 v73, v74, v75
v_cvt_pk_bf16_f32 v74, v220, v221
v_cvt_pk_bf16_f32 v75, v222, v223
buffer_store_dwordx4 v[72:75], v4, s[24:27], s79 offen offset:2048 sc1
v_pk_mul_f32 v[236:237], v[236:237], v[182:183] op_sel_hi:[1,0]
v_pk_mul_f32 v[238:239], v[238:239], v[182:183] op_sel_hi:[1,0]
v_pk_mul_f32 v[224:225], v[224:225], v[182:183] op_sel_hi:[1,0]
v_pk_mul_f32 v[226:227], v[226:227], v[182:183] op_sel_hi:[1,0]
v_cvt_pk_bf16_f32 v236, v236, v237
v_cvt_pk_bf16_f32 v237, v238, v239
v_cvt_pk_bf16_f32 v238, v224, v225
v_cvt_pk_bf16_f32 v239, v226, v227
buffer_store_dwordx4 v[236:239], v4, s[24:27], s79 offen offset:3072 sc1
v_pk_mul_f32 v[84:85], v[84:85], v[180:181] op_sel_hi:[1,0]
v_pk_mul_f32 v[86:87], v[86:87], v[180:181] op_sel_hi:[1,0]
v_pk_mul_f32 v[76:77], v[76:77], v[180:181] op_sel_hi:[1,0]
v_pk_mul_f32 v[78:79], v[78:79], v[180:181] op_sel_hi:[1,0]
v_cvt_pk_bf16_f32 v84, v84, v85
v_cvt_pk_bf16_f32 v85, v86, v87
v_cvt_pk_bf16_f32 v86, v76, v77
v_cvt_pk_bf16_f32 v87, v78, v79
buffer_store_dwordx4 v[84:87], v4, s[24:27], s52 offen offset:0 sc1
v_pk_mul_f32 v[164:165], v[164:165], v[182:183] op_sel_hi:[1,0]
v_pk_mul_f32 v[166:167], v[166:167], v[182:183] op_sel_hi:[1,0]
v_pk_mul_f32 v[156:157], v[156:157], v[182:183] op_sel_hi:[1,0]
v_pk_mul_f32 v[158:159], v[158:159], v[182:183] op_sel_hi:[1,0]
v_cvt_pk_bf16_f32 v164, v164, v165
v_cvt_pk_bf16_f32 v165, v166, v167
v_cvt_pk_bf16_f32 v166, v156, v157
v_cvt_pk_bf16_f32 v167, v158, v159
buffer_store_dwordx4 v[164:167], v4, s[24:27], s52 offen offset:1024 sc1
v_pk_mul_f32 v[160:161], v[160:161], v[180:181] op_sel_hi:[1,0]
v_pk_mul_f32 v[162:163], v[162:163], v[180:181] op_sel_hi:[1,0]
v_pk_mul_f32 v[252:253], v[252:253], v[180:181] op_sel_hi:[1,0]
v_pk_mul_f32 v[254:255], v[254:255], v[180:181] op_sel_hi:[1,0]
v_cvt_pk_bf16_f32 v160, v160, v161
v_cvt_pk_bf16_f32 v161, v162, v163
v_cvt_pk_bf16_f32 v162, v252, v253
v_cvt_pk_bf16_f32 v163, v254, v255
buffer_store_dwordx4 v[160:163], v4, s[24:27], s52 offen offset:2048 sc1
v_pk_mul_f32 v[216:217], v[216:217], v[182:183] op_sel_hi:[1,0]
v_pk_mul_f32 v[218:219], v[218:219], v[182:183] op_sel_hi:[1,0]
v_pk_mul_f32 v[208:209], v[208:209], v[182:183] op_sel_hi:[1,0]
v_pk_mul_f32 v[210:211], v[210:211], v[182:183] op_sel_hi:[1,0]
v_cvt_pk_bf16_f32 v216, v216, v217
v_cvt_pk_bf16_f32 v217, v218, v219
v_cvt_pk_bf16_f32 v218, v208, v209
v_cvt_pk_bf16_f32 v219, v210, v211
buffer_store_dwordx4 v[216:219], v4, s[24:27], s52 offen offset:3072 sc1
v_cmp_eq_u32 vcc, 3, v3
v_mul_u32_u24 v200, 768, v3
v_add_u32 v200, v200, v247
ds_write_b128 v200, a[244:247] offset:0
v_cndmask_b32 v245, v244, v246, vcc
ds_write_b128 v200, a[248:251] offset:3072
v_add_u32 v247, -1280, v247
ds_write_b128 v200, a[252:255] offset:6144
v_add_u32 v244, v244, v247
v_add_u32 v245, v245, v247
ds_write_b128 v244, a[128:131] offset:0
v_cmp_lt_u32 vcc, 31, v1
ds_write_b128 v245, a[132:135] offset:768
v_and_b32 v202, 31, v1
ds_write_b128 v244, a[136:139] offset:256
v_mov_b32 v200, s66
ds_write_b128 v245, a[140:143] offset:1024
v_mov_b32 v203, s67
ds_write_b128 v244, a[144:147] offset:3840
v_cndmask_b32 v200, v200, v203, vcc
ds_write_b128 v245, a[148:151] offset:4608
v_lshl_add_u32 v200, v200, 5, v202
ds_write_b128 v244, a[152:155] offset:4096
v_lshrrev_b32 v201, 5, v1
ds_write_b128 v245, a[156:159] offset:4864
v_mul_u32_u24 v201, 3840, v201
v_lshl_add_u32 v201, v202, 4, v201
v_add_u32 v201, s83, v201
s_cmp_eq_u32 s76, 0
s_cbranch_scc1 L_SE2
L_LA:
v_mov_b32 v5, v200
v_mov_b32 v6, v201
v_mov_b32 v13, 0
s_lshl_b32 s74, s66, 10
s_lshr_b32 s52, s4, 3
s_lshl_b32 s52, s52, 7
s_add_u32 s74, s74, s52
s_add_u32 s74, s74, 75497472
ds_read_b128 v[16:19], v6 offset:8448
ds_read_b128 v[20:23], v6 offset:9216
ds_read_b128 v[96:99], v6 offset:3328
ds_read_b128 v[32:35], v6 offset:256
ds_read_b128 v[36:39], v6 offset:1024
ds_read_b128 v[100:103], v6 offset:3296
ds_read_b128 v[40:43], v6 offset:224
ds_read_b128 v[44:47], v6 offset:992
ds_read_b128 v[104:107], v6 offset:3264
ds_read_b128 v[48:51], v6 offset:192
ds_read_b128 v[52:55], v6 offset:960
ds_read_b128 v[108:111], v6 offset:3232
ds_read_b128 v[56:59], v6 offset:160
ds_read_b128 v[60:63], v6 offset:928
ds_read_b128 v[112:115], v6 offset:3200
ds_read_b128 v[64:67], v6 offset:128
ds_read_b128 v[68:71], v6 offset:896
ds_read_b128 v[116:119], v6 offset:3168
ds_read_b128 v[72:75], v6 offset:96
ds_read_b128 v[76:79], v6 offset:864
ds_read_b128 v[120:123], v6 offset:3136
ds_read_b128 v[80:83], v6 offset:64
ds_read_b128 v[84:87], v6 offset:832
ds_read_b128 v[124:127], v6 offset:3104
ds_read_b128 v[88:91], v6 offset:32
ds_read_b128 v[92:95], v6 offset:800
ds_read_b128 v[128:131], v6 offset:1792
ds_read_b128 v[132:135], v6 offset:2560
s_waitcnt vmcnt(0)
buffer_atomic_add v1, v0, s[24:27], s74 offen offset:0 sc1
ds_read_b128 v[136:139], v6 offset:1760
ds_read_b128 v[140:143], v6 offset:2528
ds_read_b128 v[144:147], v6 offset:1728
ds_read_b128 v[148:151], v6 offset:2496
ds_read_b128 v[152:155], v6 offset:1696
ds_read_b128 v[156:159], v6 offset:2464
ds_read_b128 v[160:163], v6 offset:1664
ds_read_b128 v[164:167], v6 offset:2432
ds_read_b128 v[168:171], v6 offset:1632
ds_read_b128 v[172:175], v6 offset:2400
ds_read_b128 v[176:179], v6 offset:1600
ds_read_b128 v[180:183], v6 offset:2368
ds_read_b128 v[184:187], v6 offset:1568
ds_read_b128 v[188:191], v6 offset:2336
s_lshr_b32 s52, s3, 1
s_lshl1_add_u32 s72, s85, s52
s_lshl3_add_u32 s75, s72, s84
s_lshl_b32 s75, s75, 7
s_add_u32 s75, s75, 75497472
s_and_b32 s82, s86, 1
s_lshl_b32 s82, s82, 13
s_lshr_b32 s53, s4, 3
s_mul_i32 s53, s53, 75776
s_add_u32 s53, s53, 54525952
s_and_b32 s52, s3, 1
s_lshl_b32 s52, s52, 10
s_add_u32 s52, s52, s53
s_sub_u32 s54, 63, s72
s_mul_i32 s77, s72, 303104
s_add_u32 s77, s77, s52
s_mul_i32 s81, s54, 303104
s_add_u32 s81, s81, s52
s_add_u32 s91, s91, 114688
s_sub_u32 s52, s91, 163840
s_cmp_ge_u32 s91, 163840
s_cselect_b32 s91, s52, s91
v_add_u32 v14, 4096, v4
v_add_u32 v7, s91, v4
s_waitcnt lgkmcnt(0)
s_barrier
s_mov_b32 m0, s70
s_mov_b32 s64, s68
s_add_u32 s68, s68, 16384
s_add_u32 s70, s70, 16384
s_cmp_ge_u32 s70, 163840
s_cselect_b32 s70, s80, s70
buffer_load_dwordx4 v4, s[24:27], s64 offen offset:0 sc1 lds
v_and_b32 v9, 0xffff, v97
v_and_b32 v11, 0xffff0000, v97
v_dot2_f32_bf16 v24, v98, v99, 0
v_dot2_f32_bf16 v25, v102, v99, 0
v_dot2_f32_bf16 v26, v106, v99, 0
v_dot2_f32_bf16 v27, v110, v99, 0
v_dot2_f32_bf16 v28, v114, v99, 0
v_dot2_f32_bf16 v29, v118, v99, 0
v_dot2_f32_bf16 v30, v122, v99, 0
v_dot2_f32_bf16 v31, v126, v99, 0
v_dot2c_f32_bf16 v24, v96, v9
v_dot2c_f32_bf16 v25, v100, v9
v_dot2c_f32_bf16 v26, v104, v9
v_dot2c_f32_bf16 v27, v108, v9
v_dot2c_f32_bf16 v28, v112, v9
buffer_load_dwordx4 v4, s[24:27], s64 offen offset:1024 sc1 lds
v_dot2c_f32_bf16 v29, v116, v9
v_dot2c_f32_bf16 v30, v120, v9
v_dot2c_f32_bf16 v31, v124, v9
v_dot2c_f32_bf16 v24, v16, v32
v_dot2c_f32_bf16 v25, v16, v40
v_dot2c_f32_bf16 v26, v16, v48
v_dot2c_f32_bf16 v27, v16, v56
v_dot2c_f32_bf16 v28, v16, v64
v_dot2c_f32_bf16 v29, v16, v72
v_dot2c_f32_bf16 v30, v16, v80
v_dot2c_f32_bf16 v31, v16, v88
v_dot2c_f32_bf16 v24, v17, v33
v_dot2c_f32_bf16 v25, v17, v41
v_dot2c_f32_bf16 v26, v17, v49
v_dot2c_f32_bf16 v27, v17, v57
buffer_load_dwordx4 v4, s[24:27], s64 offen offset:2048 sc1 lds
v_dot2c_f32_bf16 v28, v17, v65
v_dot2c_f32_bf16 v29, v17, v73
v_dot2c_f32_bf16 v30, v17, v81
v_dot2c_f32_bf16 v31, v17, v89
v_dot2c_f32_bf16 v24, v18, v34
v_dot2c_f32_bf16 v25, v18, v42
v_dot2c_f32_bf16 v26, v18, v50
v_dot2c_f32_bf16 v27, v18, v58
v_dot2c_f32_bf16 v28, v18, v66
v_dot2c_f32_bf16 v29, v18, v74
v_dot2c_f32_bf16 v30, v18, v82
v_dot2c_f32_bf16 v31, v18, v90
v_dot2c_f32_bf16 v24, v19, v35
v_dot2c_f32_bf16 v25, v19, v43
v_dot2c_f32_bf16 v26, v19, v51
buffer_load_dwordx4 v4, s[24:27], s64 offen offset:3072 sc1 lds
v_dot2c_f32_bf16 v27, v19, v59
v_dot2c_f32_bf16 v28, v19, v67
v_dot2c_f32_bf16 v29, v19, v75
v_dot2c_f32_bf16 v30, v19, v83
v_dot2c_f32_bf16 v31, v19, v91
v_dot2c_f32_bf16 v24, v20, v36
v_dot2c_f32_bf16 v25, v20, v44
v_dot2c_f32_bf16 v26, v20, v52
v_dot2c_f32_bf16 v27, v20, v60
v_dot2c_f32_bf16 v28, v20, v68
v_dot2c_f32_bf16 v29, v20, v76
v_dot2c_f32_bf16 v30, v20, v84
v_dot2c_f32_bf16 v31, v20, v92
v_dot2c_f32_bf16 v24, v21, v37
v_dot2c_f32_bf16 v25, v21, v45
s_mov_b32 m0, s70
s_mov_b32 s64, s68
s_add_u32 s68, s68, 16384
s_add_u32 s70, s70, 16384
s_cmp_ge_u32 s70, 163840
s_cselect_b32 s70, s80, s70
buffer_load_dwordx4 v4, s[24:27], s64 offen offset:0 sc1 lds
v_dot2c_f32_bf16 v26, v21, v53
v_dot2c_f32_bf16 v27, v21, v61
v_dot2c_f32_bf16 v28, v21, v69
v_dot2c_f32_bf16 v29, v21, v77
v_dot2c_f32_bf16 v30, v21, v85
v_dot2c_f32_bf16 v31, v21, v93
v_dot2c_f32_bf16 v24, v22, v38
v_dot2c_f32_bf16 v25, v22, v46
v_dot2c_f32_bf16 v26, v22, v54
v_dot2c_f32_bf16 v27, v22, v62
v_dot2c_f32_bf16 v28, v22, v70
v_dot2c_f32_bf16 v29, v22, v78
L_PAD10:
s_cbranch_execz L_MAIN
v_dot2c_f32_bf16 v30, v22, v86
v_dot2c_f32_bf16 v31, v22, v94
v_dot2c_f32_bf16 v24, v23, v39
buffer_load_dwordx4 v4, s[24:27], s64 offen offset:1024 sc1 lds
v_dot2c_f32_bf16 v25, v23, v47
v_dot2c_f32_bf16 v26, v23, v55
v_dot2c_f32_bf16 v27, v23, v63
v_dot2c_f32_bf16 v28, v23, v71
v_dot2c_f32_bf16 v29, v23, v79
v_dot2c_f32_bf16 v30, v23, v87
v_dot2c_f32_bf16 v31, v23, v95
v_mov_b32 v9, 0xf149f2ca
v_mul_f32 v11, 0xbfb8aa3b, v11
v_exp_f32 v11, v11
v_cmp_gt_u32 vcc, 2, v5
v_cmp_gt_u32 s[56:57], 4, v5
s_nop 0
v_cndmask_b32 v25, v25, v9, vcc
v_cndmask_b32 v26, v26, v9, s[56:57]
buffer_load_dwordx4 v4, s[24:27], s64 offen offset:2048 sc1 lds
v_cmp_gt_u32 vcc, 6, v5
v_cmp_gt_u32 s[56:57], 8, v5
s_nop 0
v_cndmask_b32 v27, v27, v9, vcc
v_cndmask_b32 v28, v28, v9, s[56:57]
v_cmp_gt_u32 vcc, 10, v5
v_cmp_gt_u32 s[56:57], 12, v5
s_nop 0
v_cndmask_b32 v29, v29, v9, vcc
v_cndmask_b32 v30, v30, v9, s[56:57]
v_cmp_gt_u32 vcc, 14, v5
s_nop 0
s_nop 0
v_cndmask_b32 v31, v31, v9, vcc
v_max3_f32 v10, v24, v25, v26
buffer_load_dwordx4 v4, s[24:27], s64 offen offset:3072 sc1 lds
v_max3_f32 v10, v10, v27, v28
v_max3_f32 v10, v10, v29, v30
v_max_f32 v10, v10, v31
s_mov_b32 s52, 0x3eae1a93
v_sub_f32 v24, v24, v10
v_sub_f32 v25, v25, v10
v_sub_f32 v26, v26, v10
v_sub_f32 v27, v27, v10
v_sub_f32 v28, v28, v10
v_sub_f32 v29, v29, v10
v_sub_f32 v30, v30, v10
v_sub_f32 v31, v31, v10
v_mul_f32 v24, s52, v24
v_mul_f32 v25, s52, v25
v_mul_f32 v26, s52, v26
s_mov_b32 m0, s70
s_mov_b32 s64, s68
s_add_u32 s68, s68, 16384
s_add_u32 s70, s70, 16384
s_cmp_ge_u32 s70, 163840
s_cselect_b32 s70, s80, s70
buffer_load_dwordx4 v4, s[24:27], s64 offen offset:0 sc1 lds
v_mul_f32 v27, s52, v27
v_mul_f32 v28, s52, v28
v_mul_f32 v29, s52, v29
v_mul_f32 v30, s52, v30
v_mul_f32 v31, s52, v31
v_exp_f32 v24, v24
v_exp_f32 v25, v25
v_exp_f32 v26, v26
v_exp_f32 v27, v27
v_exp_f32 v28, v28
v_exp_f32 v29, v29
v_exp_f32 v30, v30
v_exp_f32 v31, v31
v_cvt_pk_bf16_f32 v32, v24, 0
v_cvt_pk_bf16_f32 v40, v25, 0
buffer_load_dwordx4 v4, s[24:27], s64 offen offset:1024 sc1 lds
v_cvt_pk_bf16_f32 v48, v26, 0
v_cvt_pk_bf16_f32 v56, v27, 0
v_cvt_pk_bf16_f32 v64, v28, 0
v_cvt_pk_bf16_f32 v72, v29, 0
v_cvt_pk_bf16_f32 v80, v30, 0
v_cvt_pk_bf16_f32 v88, v31, 0
v_lshlrev_b32 v33, 16, v32
v_lshlrev_b32 v41, 16, v40
v_lshlrev_b32 v49, 16, v48
v_lshlrev_b32 v57, 16, v56
v_lshlrev_b32 v65, 16, v64
v_lshlrev_b32 v73, 16, v72
v_lshlrev_b32 v81, 16, v80
v_lshlrev_b32 v89, 16, v88
v_add_f32 v10, v33, v41
buffer_load_dwordx4 v4, s[24:27], s64 offen offset:2048 sc1 lds
v_add_f32 v10, v10, v49
v_add_f32 v10, v10, v57
v_add_f32 v10, v10, v65
v_add_f32 v10, v10, v73
v_add_f32 v10, v10, v81
v_add_f32 v10, v10, v89
v_fmac_f32 v10, v10, v11
v_rcp_f32 v10, v10
v_dot2_f32_bf16 v192, v128, v32, 0
v_dot2_f32_bf16 v193, v128, v33, 0
v_dot2_f32_bf16 v194, v129, v32, 0
v_dot2_f32_bf16 v195, v129, v33, 0
v_dot2_f32_bf16 v196, v130, v32, 0
v_dot2_f32_bf16 v197, v130, v33, 0
v_dot2_f32_bf16 v198, v131, v32, 0
buffer_load_dwordx4 v4, s[24:27], s64 offen offset:3072 sc1 lds
v_dot2_f32_bf16 v199, v131, v33, 0
v_dot2_f32_bf16 v200, v132, v32, 0
v_dot2_f32_bf16 v201, v132, v33, 0
v_dot2_f32_bf16 v202, v133, v32, 0
v_dot2_f32_bf16 v203, v133, v33, 0
v_dot2_f32_bf16 v204, v134, v32, 0
v_dot2_f32_bf16 v205, v134, v33, 0
v_dot2_f32_bf16 v206, v135, v32, 0
v_dot2_f32_bf16 v207, v135, v33, 0
v_dot2_f32_bf16 v208, v96, v33, 0
v_dot2_f32_bf16 v209, v98, v33, 0
v_dot2c_f32_bf16 v192, v136, v40
v_dot2c_f32_bf16 v193, v136, v41
v_dot2c_f32_bf16 v194, v137, v40
v_dot2c_f32_bf16 v195, v137, v41
s_mov_b32 m0, s70
s_mov_b32 s64, s68
s_add_u32 s68, s68, 16384
s_add_u32 s70, s70, 16384
s_cmp_ge_u32 s70, 163840
s_cselect_b32 s70, s80, s70
buffer_load_dwordx4 v4, s[24:27], s64 offen offset:0 sc1 lds
v_dot2c_f32_bf16 v196, v138, v40
v_dot2c_f32_bf16 v197, v138, v41
v_dot2c_f32_bf16 v198, v139, v40
v_dot2c_f32_bf16 v199, v139, v41
v_dot2c_f32_bf16 v200, v140, v40
v_dot2c_f32_bf16 v201, v140, v41
v_dot2c_f32_bf16 v202, v141, v40
v_dot2c_f32_bf16 v203, v141, v41
v_dot2c_f32_bf16 v204, v142, v40
v_dot2c_f32_bf16 v205, v142, v41
v_dot2c_f32_bf16 v206, v143, v40
v_dot2c_f32_bf16 v207, v143, v41
v_dot2c_f32_bf16 v208, v100, v41
v_dot2c_f32_bf16 v209, v102, v41
v_dot2c_f32_bf16 v192, v144, v48
buffer_load_dwordx4 v4, s[24:27], s64 offen offset:1024 sc1 lds
v_dot2c_f32_bf16 v193, v144, v49
v_dot2c_f32_bf16 v194, v145, v48
v_dot2c_f32_bf16 v195, v145, v49
v_dot2c_f32_bf16 v196, v146, v48
v_dot2c_f32_bf16 v197, v146, v49
v_dot2c_f32_bf16 v198, v147, v48
v_dot2c_f32_bf16 v199, v147, v49
v_dot2c_f32_bf16 v200, v148, v48
v_dot2c_f32_bf16 v201, v148, v49
v_dot2c_f32_bf16 v202, v149, v48
v_dot2c_f32_bf16 v203, v149, v49
v_dot2c_f32_bf16 v204, v150, v48
v_dot2c_f32_bf16 v205, v150, v49
v_dot2c_f32_bf16 v206, v151, v48
v_dot2c_f32_bf16 v207, v151, v49
buffer_load_dwordx4 v4, s[24:27], s64 offen offset:2048 sc1 lds
v_dot2c_f32_bf16 v208, v104, v49
v_dot2c_f32_bf16 v209, v106, v49
v_dot2c_f32_bf16 v192, v152, v56
v_dot2c_f32_bf16 v193, v152, v57
v_dot2c_f32_bf16 v194, v153, v56
v_dot2c_f32_bf16 v195, v153, v57
v_dot2c_f32_bf16 v196, v154, v56
v_dot2c_f32_bf16 v197, v154, v57
v_dot2c_f32_bf16 v198, v155, v56
v_dot2c_f32_bf16 v199, v155, v57
v_dot2c_f32_bf16 v200, v156, v56
v_dot2c_f32_bf16 v201, v156, v57
v_dot2c_f32_bf16 v202, v157, v56
v_dot2c_f32_bf16 v203, v157, v57
v_dot2c_f32_bf16 v204, v158, v56
buffer_load_dword v12, v13, s[24:27], s75 offen sc1
v_dot2c_f32_bf16 v205, v158, v57
v_dot2c_f32_bf16 v206, v159, v56
v_dot2c_f32_bf16 v207, v159, v57
v_dot2c_f32_bf16 v208, v108, v57
v_dot2c_f32_bf16 v209, v110, v57
v_dot2c_f32_bf16 v192, v160, v64
v_dot2c_f32_bf16 v193, v160, v65
v_dot2c_f32_bf16 v194, v161, v64
v_dot2c_f32_bf16 v195, v161, v65
v_dot2c_f32_bf16 v196, v162, v64
v_dot2c_f32_bf16 v197, v162, v65
v_dot2c_f32_bf16 v198, v163, v64
v_dot2c_f32_bf16 v199, v163, v65
v_dot2c_f32_bf16 v200, v164, v64
v_dot2c_f32_bf16 v201, v164, v65
buffer_load_dwordx4 v4, s[24:27], s64 offen offset:3072 sc1 lds
v_dot2c_f32_bf16 v202, v165, v64
v_dot2c_f32_bf16 v203, v165, v65
v_dot2c_f32_bf16 v204, v166, v64
v_dot2c_f32_bf16 v205, v166, v65
v_dot2c_f32_bf16 v206, v167, v64
v_dot2c_f32_bf16 v207, v167, v65
v_dot2c_f32_bf16 v208, v112, v65
v_dot2c_f32_bf16 v209, v114, v65
v_dot2c_f32_bf16 v192, v168, v72
v_dot2c_f32_bf16 v193, v168, v73
v_dot2c_f32_bf16 v194, v169, v72
v_dot2c_f32_bf16 v195, v169, v73
v_dot2c_f32_bf16 v196, v170, v72
v_dot2c_f32_bf16 v197, v170, v73
v_dot2c_f32_bf16 v198, v171, v72
s_mov_b32 m0, s70
s_mov_b32 s64, s68
s_add_u32 s68, s68, 16384
s_add_u32 s70, s70, 16384
s_cmp_ge_u32 s70, 163840
s_cselect_b32 s70, s80, s70
buffer_load_dwordx4 v4, s[24:27], s64 offen offset:0 sc1 lds
v_dot2c_f32_bf16 v199, v171, v73
v_dot2c_f32_bf16 v200, v172, v72
v_dot2c_f32_bf16 v201, v172, v73
v_dot2c_f32_bf16 v202, v173, v72
v_dot2c_f32_bf16 v203, v173, v73
v_dot2c_f32_bf16 v204, v174, v72
v_dot2c_f32_bf16 v205, v174, v73
v_dot2c_f32_bf16 v206, v175, v72
v_dot2c_f32_bf16 v207, v175, v73
v_dot2c_f32_bf16 v208, v116, v73
v_dot2c_f32_bf16 v209, v118, v73
v_dot2c_f32_bf16 v192, v176, v80
v_dot2c_f32_bf16 v193, v176, v81
v_dot2c_f32_bf16 v194, v177, v80
v_dot2c_f32_bf16 v195, v177, v81
buffer_load_dwordx4 v4, s[24:27], s64 offen offset:1024 sc1 lds
v_dot2c_f32_bf16 v196, v178, v80
v_dot2c_f32_bf16 v197, v178, v81
v_dot2c_f32_bf16 v198, v179, v80
v_dot2c_f32_bf16 v199, v179, v81
v_dot2c_f32_bf16 v200, v180, v80
v_dot2c_f32_bf16 v201, v180, v81
v_dot2c_f32_bf16 v202, v181, v80
v_dot2c_f32_bf16 v203, v181, v81
v_dot2c_f32_bf16 v204, v182, v80
v_dot2c_f32_bf16 v205, v182, v81
v_dot2c_f32_bf16 v206, v183, v80
v_dot2c_f32_bf16 v207, v183, v81
v_dot2c_f32_bf16 v208, v120, v81
v_dot2c_f32_bf16 v209, v122, v81
v_dot2c_f32_bf16 v192, v184, v88
buffer_load_dwordx4 v4, s[24:27], s64 offen offset:2048 sc1 lds
v_dot2c_f32_bf16 v193, v184, v89
v_dot2c_f32_bf16 v194, v185, v88
v_dot2c_f32_bf16 v195, v185, v89
v_dot2c_f32_bf16 v196, v186, v88
v_dot2c_f32_bf16 v197, v186, v89
v_dot2c_f32_bf16 v198, v187, v88
v_dot2c_f32_bf16 v199, v187, v89
v_dot2c_f32_bf16 v200, v188, v88
v_dot2c_f32_bf16 v201, v188, v89
v_dot2c_f32_bf16 v202, v189, v88
v_dot2c_f32_bf16 v203, v189, v89
v_dot2c_f32_bf16 v204, v190, v88
v_dot2c_f32_bf16 v205, v190, v89
v_dot2c_f32_bf16 v206, v191, v88
v_dot2c_f32_bf16 v207, v191, v89
buffer_load_dwordx4 v4, s[24:27], s64 offen offset:3072 sc1 lds
v_dot2c_f32_bf16 v208, v124, v89
v_dot2c_f32_bf16 v209, v126, v89
v_lshrrev_b32 v9, 5, v5
v_mul_u32_u24 v9, 303104, v9
v_and_b32 v11, 1, v3
v_lshl_add_u32 v9, v11, 10, v9
v_lshl_add_u32 v9, v2, 4, v9
v_mul_f32 v192, v10, v192
v_mul_f32 v193, v10, v193
v_mul_f32 v194, v10, v194
v_mul_f32 v195, v10, v195
v_mul_f32 v196, v10, v196
v_mul_f32 v197, v10, v197
v_mul_f32 v198, v10, v198
v_mul_f32 v199, v10, v199
v_mul_f32 v200, v10, v200
v_mul_f32 v201, v10, v201
v_mul_f32 v202, v10, v202
v_mul_f32 v203, v10, v203
v_mul_f32 v204, v10, v204
v_mul_f32 v205, v10, v205
v_mul_f32 v206, v10, v206
v_mul_f32 v207, v10, v207
v_mul_f32 v208, v10, v208
v_mul_f32 v209, v10, v209
v_cvt_pk_bf16_f32 v192, v192, v193
v_cvt_pk_bf16_f32 v193, v194, v195
v_cvt_pk_bf16_f32 v194, v196, v197
v_cvt_pk_bf16_f32 v195, v198, v199
v_cvt_pk_bf16_f32 v196, v200, v201
v_cvt_pk_bf16_f32 v197, v202, v203
v_cvt_pk_bf16_f32 v198, v204, v205
v_cvt_pk_bf16_f32 v199, v206, v207
v_cvt_pk_bf16_f32 v200, v208, v209
s_add_u32 s53, s53, 65536
s_bfe_u32 s54, s4, 131073
s_lshl_b32 s54, s54, 11
s_add_u32 s54, s54, s53
s_and_b32 s55, s4, 1
s_lshl_b32 s55, s55, 9
s_add_u32 s54, s54, s55
s_lshl2_add_u32 s52, s85, s86
s_lshl2_add_u32 s69, s52, s3
s_mul_i32 s69, s69, 28672
s_add_u32 s69, s69, 76546048
s_lshr_b32 s73, s52, 1
s_lshl_b32 s73, s73, 10
s_and_b32 s52, s52, 1
s_lshl_b32 s52, s52, 7
s_add_u32 s73, s73, s52
s_lshl2_add_u32 s73, s3, s73
s_add_u32 s73, s73, 75498112
ds_read_b128 v[144:147], v7 offset:0
ds_read_b128 v[148:151], v7 offset:1024
ds_read_b128 v[152:155], v7 offset:2048
ds_read_b128 v[156:159], v7 offset:3072
ds_read_b128 v[160:163], v7 offset:4096
ds_read_b128 v[164:167], v7 offset:5120
ds_read_b128 v[168:171], v7 offset:6144
ds_read_b128 v[172:175], v7 offset:7168
v_mov_b32 v10, 0
s_waitcnt vmcnt(5)
v_cmp_gt_u32 vcc, 8, v12
s_mov_b32 s92, 0
s_nop 3
s_cbranch_vccz L_ZBX
L_ZB:
s_sleep 2
buffer_load_dword v12, v13, s[24:27], s75 offen sc1
s_add_u32 s92, s92, 1
s_waitcnt vmcnt(0)
v_cmp_gt_u32 vcc, 8, v12
s_cmp_gt_u32 s92, 1048576
s_cbranch_scc1 L_ZBX
s_nop 2
s_cbranch_vccnz L_ZB
L_ZBX:
s_xor_b32 s65, s82, 0
s_add_u32 s65, s65, s77
buffer_load_dwordx4 a[0:3], v4, s[24:27], s65 offen offset:0 sc1
buffer_load_dwordx4 a[8:11], v4, s[24:27], s65 offen offset:2048 sc1
s_xor_b32 s93, s82, 0
s_add_u32 s93, s93, s81
buffer_load_dwordx4 a[4:7], v4, s[24:27], s93 offen offset:0 sc1
buffer_load_dwordx4 a[12:15], v4, s[24:27], s93 offen offset:2048 sc1
buffer_load_dwordx4 a[16:19], v14, s[24:27], s65 offen offset:0 sc1
buffer_load_dwordx4 a[24:27], v14, s[24:27], s65 offen offset:2048 sc1
buffer_load_dwordx4 a[20:23], v14, s[24:27], s93 offen offset:0 sc1
buffer_load_dwordx4 a[28:31], v14, s[24:27], s93 offen offset:2048 sc1
buffer_store_dwordx4 v[192:195], v9, s[24:27], s54 offen sc1
buffer_store_dwordx4 v[196:199], v9, s[24:27], s54 offen offset:256 sc1
s_bfe_u32 s55, s4, 65538
s_lshl_b32 s55, s55, 8
s_add_u32 s54, s53, s55
s_and_b32 s55, s4, 3
s_lshl2_add_u32 s54, s55, s54
s_add_u32 s54, s54, 8192
buffer_store_dword v200, v9, s[24:27], s54 offen sc1
s_waitcnt vmcnt(9) lgkmcnt(6)
v_mfma_f32_16x16x32_bf16 v[120:123], v[144:147], a[0:3], 0
s_waitcnt vmcnt(7)
s_add_u32 s91, s91, 16384
ds_read_b128 v[176:179], v7 offset:8192
v_mfma_f32_16x16x32_bf16 v[120:123], v[148:151], a[8:11], v[120:123]
s_xor_b32 s65, s82, 8192
s_add_u32 s65, s65, s77
ds_read_b128 v[180:183], v7 offset:9216
v_mfma_f32_16x16x32_bf16 v[124:127], v[148:151], a[12:15], 0
s_waitcnt lgkmcnt(6)
ds_read_b128 v[184:187], v7 offset:10240
v_mfma_f32_16x16x32_bf16 v[124:127], v[144:147], a[4:7], v[124:127]
buffer_load_dwordx4 a[32:35], v4, s[24:27], s65 offen offset:0 sc1
v_mfma_f32_16x16x32_bf16 v[72:75], v[152:155], a[0:3], 0
s_cmp_ge_u32 s91, 163840
s_cselect_b32 s91, 0, s91
ds_read_b128 v[188:191], v7 offset:11264
v_mfma_f32_16x16x32_bf16 v[72:75], v[156:159], a[8:11], v[72:75]
s_waitcnt lgkmcnt(6)
v_add_u32 v8, s91, v4
v_mfma_f32_16x16x32_bf16 v[76:79], v[156:159], a[12:15], 0
buffer_load_dwordx4 a[40:43], v4, s[24:27], s65 offen offset:2048 sc1
v_mfma_f32_16x16x32_bf16 v[76:79], v[152:155], a[4:7], v[76:79]
s_xor_b32 s93, s82, 8192
s_add_u32 s93, s93, s81
ds_read_b128 v[144:147], v7 offset:12288
v_mfma_f32_16x16x32_bf16 v[80:83], v[160:163], a[0:3], 0
ds_read_b128 v[148:151], v7 offset:13312
v_mfma_f32_16x16x32_bf16 v[80:83], v[164:167], a[8:11], v[80:83]
buffer_load_dwordx4 a[36:39], v4, s[24:27], s93 offen offset:0 sc1
v_mfma_f32_16x16x32_bf16 v[84:87], v[164:167], a[12:15], 0
ds_read_b128 v[152:155], v7 offset:14336
v_mfma_f32_16x16x32_bf16 v[84:87], v[160:163], a[4:7], v[84:87]
s_waitcnt lgkmcnt(7)
v_mfma_f32_16x16x32_bf16 v[88:91], v[168:171], a[0:3], 0
buffer_load_dwordx4 a[44:47], v4, s[24:27], s93 offen offset:2048 sc1
v_mfma_f32_16x16x32_bf16 v[88:91], v[172:175], a[8:11], v[88:91]
ds_read_b128 v[156:159], v7 offset:15360
v_mfma_f32_16x16x32_bf16 v[92:95], v[172:175], a[12:15], 0
s_waitcnt lgkmcnt(6)
s_add_u32 s91, s91, 16384
ds_read_b128 v[160:163], v8 offset:0
v_mfma_f32_16x16x32_bf16 v[92:95], v[168:171], a[4:7], v[92:95]
buffer_load_dwordx4 a[48:51], v14, s[24:27], s65 offen offset:0 sc1
v_mfma_f32_16x16x32_bf16 v[96:99], v[176:179], a[0:3], 0
s_cmp_ge_u32 s91, 163840
s_cselect_b32 s91, 0, s91
ds_read_b128 v[164:167], v8 offset:1024
v_mfma_f32_16x16x32_bf16 v[96:99], v[180:183], a[8:11], v[96:99]
v_add_u32 v7, s91, v4
v_mfma_f32_16x16x32_bf16 v[100:103], v[180:183], a[12:15], 0
buffer_load_dwordx4 a[56:59], v14, s[24:27], s65 offen offset:2048 sc1
v_mfma_f32_16x16x32_bf16 v[100:103], v[176:179], a[4:7], v[100:103]
s_waitcnt lgkmcnt(6)
ds_read_b128 v[168:171], v8 offset:2048
v_mfma_f32_16x16x32_bf16 v[104:107], v[184:187], a[0:3], 0
ds_read_b128 v[172:175], v8 offset:3072
v_mfma_f32_16x16x32_bf16 v[104:107], v[188:191], a[8:11], v[104:107]
v_mfma_f32_16x16x32_bf16 v[108:111], v[188:191], a[12:15], 0
buffer_load_dwordx4 a[52:55], v14, s[24:27], s93 offen offset:0 sc1
v_mfma_f32_16x16x32_bf16 v[108:111], v[184:187], a[4:7], v[108:111]
s_waitcnt lgkmcnt(6)
ds_read_b128 v[176:179], v8 offset:4096
v_mfma_f32_16x16x32_bf16 v[112:115], v[144:147], a[0:3], 0
ds_read_b128 v[180:183], v8 offset:5120
v_mfma_f32_16x16x32_bf16 v[112:115], v[148:151], a[8:11], v[112:115]
v_mfma_f32_16x16x32_bf16 v[116:119], v[148:151], a[12:15], 0
buffer_load_dwordx4 a[60:63], v14, s[24:27], s93 offen offset:2048 sc1
v_mfma_f32_16x16x32_bf16 v[116:119], v[144:147], a[4:7], v[116:119]
s_waitcnt lgkmcnt(6) vmcnt(13)
ds_read_b128 v[184:187], v8 offset:6144
v_mfma_f32_16x16x32_bf16 v[120:123], v[152:155], a[16:19], v[120:123]
ds_read_b128 v[188:191], v8 offset:7168
v_mfma_f32_16x16x32_bf16 v[120:123], v[156:159], a[24:27], v[120:123]
s_waitcnt vmcnt(11)
v_mfma_f32_16x16x32_bf16 v[124:127], v[156:159], a[28:31], v[124:127]
ds_read_b128 v[144:147], v8 offset:8192
v_mfma_f32_16x16x32_bf16 v[124:127], v[152:155], a[20:23], v[124:127]
s_waitcnt lgkmcnt(7)
v_mfma_f32_16x16x32_bf16 v[72:75], v[160:163], a[16:19], v[72:75]
ds_read_b128 v[148:151], v8 offset:9216
v_mfma_f32_16x16x32_bf16 v[72:75], v[164:167], a[24:27], v[72:75]
v_mfma_f32_16x16x32_bf16 v[76:79], v[164:167], a[28:31], v[76:79]
ds_read_b128 v[152:155], v8 offset:10240
v_mfma_f32_16x16x32_bf16 v[76:79], v[160:163], a[20:23], v[76:79]
s_waitcnt lgkmcnt(7)
v_mfma_f32_16x16x32_bf16 v[80:83], v[168:171], a[16:19], v[80:83]
ds_read_b128 v[156:159], v8 offset:11264
v_mfma_f32_16x16x32_bf16 v[80:83], v[172:175], a[24:27], v[80:83]
v_mfma_f32_16x16x32_bf16 v[84:87], v[172:175], a[28:31], v[84:87]
ds_read_b128 v[160:163], v8 offset:12288
v_mfma_f32_16x16x32_bf16 v[84:87], v[168:171], a[20:23], v[84:87]
s_waitcnt lgkmcnt(7)
v_mfma_f32_16x16x32_bf16 v[88:91], v[176:179], a[16:19], v[88:91]
s_xor_b32 s65, s82, 16384
s_add_u32 s65, s65, s77
ds_read_b128 v[164:167], v8 offset:13312
v_mfma_f32_16x16x32_bf16 v[88:91], v[180:183], a[24:27], v[88:91]
v_mfma_f32_16x16x32_bf16 v[92:95], v[180:183], a[28:31], v[92:95]
s_waitcnt lgkmcnt(6)
ds_read_b128 v[168:171], v8 offset:14336
v_add_u32 v11, s70, v4
v_mfma_f32_16x16x32_bf16 v[92:95], v[176:179], a[20:23], v[92:95]
s_add_u32 s70, s70, 16384
s_cmp_ge_u32 s70, 163840
s_cselect_b32 s70, s80, s70
v_mfma_f32_16x16x32_bf16 v[96:99], v[184:187], a[16:19], v[96:99]
buffer_load_dwordx4 a[64:67], v4, s[24:27], s65 offen offset:0 sc1
v_mfma_f32_16x16x32_bf16 v[96:99], v[188:191], a[24:27], v[96:99]
s_barrier
v_mfma_f32_16x16x32_bf16 v[100:103], v[188:191], a[28:31], v[100:103]
s_waitcnt lgkmcnt(5)
ds_read_b128 v[172:175], v8 offset:15360
v_mfma_f32_16x16x32_bf16 v[100:103], v[184:187], a[20:23], v[100:103]
buffer_load_dwordx4 a[72:75], v4, s[24:27], s65 offen offset:2048 sc1
v_mfma_f32_16x16x32_bf16 v[104:107], v[144:147], a[16:19], v[104:107]
ds_write_b64 v11, a[96:97] offset:0
v_mfma_f32_16x16x32_bf16 v[104:107], v[148:151], a[24:27], v[104:107]
s_xor_b32 s93, s82, 16384
s_add_u32 s93, s93, s81
ds_read_b128 v[176:179], v7 offset:0
v_mfma_f32_16x16x32_bf16 v[108:111], v[148:151], a[28:31], v[108:111]
buffer_load_dwordx4 a[68:71], v4, s[24:27], s93 offen offset:0 sc1
v_mfma_f32_16x16x32_bf16 v[108:111], v[144:147], a[20:23], v[108:111]
s_waitcnt lgkmcnt(6)
s_add_u32 s91, s91, 16384
ds_read_b128 v[180:183], v7 offset:1024
v_mfma_f32_16x16x32_bf16 v[112:115], v[152:155], a[16:19], v[112:115]
ds_write_b64 v11, a[98:99] offset:8
v_mfma_f32_16x16x32_bf16 v[112:115], v[156:159], a[24:27], v[112:115]
s_cmp_ge_u32 s91, 163840
s_cselect_b32 s91, 0, s91
ds_read_b128 v[184:187], v7 offset:2048
v_mfma_f32_16x16x32_bf16 v[116:119], v[156:159], a[28:31], v[116:119]
buffer_load_dwordx4 a[76:79], v4, s[24:27], s93 offen offset:2048 sc1
v_mfma_f32_16x16x32_bf16 v[116:119], v[152:155], a[20:23], v[116:119]
s_waitcnt lgkmcnt(7) vmcnt(10)
ds_read_b128 v[188:191], v7 offset:3072
v_add_u32 v8, s91, v4
v_mfma_f32_16x16x32_bf16 v[120:123], v[160:163], a[32:35], v[120:123]
s_waitcnt vmcnt(12)
s_waitcnt vmcnt(8)
ds_read_b128 v[144:147], v7 offset:4096
v_mfma_f32_16x16x32_bf16 v[120:123], v[164:167], a[40:43], v[120:123]
buffer_atomic_add v1, v0, s[24:27], s74 offen offset:4 sc1
v_mfma_f32_16x16x32_bf16 v[124:127], v[164:167], a[44:47], v[124:127]
ds_write_b64 v11, a[100:101] offset:1024
v_mfma_f32_16x16x32_bf16 v[124:127], v[160:163], a[36:39], v[124:127]
s_waitcnt lgkmcnt(8)
ds_read_b128 v[148:151], v7 offset:5120
v_mfma_f32_16x16x32_bf16 v[72:75], v[168:171], a[32:35], v[72:75]
ds_read_b128 v[152:155], v7 offset:6144
v_mfma_f32_16x16x32_bf16 v[72:75], v[172:175], a[40:43], v[72:75]
s_waitcnt lgkmcnt(7)
ds_read_b128 v[156:159], v7 offset:7168
v_mfma_f32_16x16x32_bf16 v[76:79], v[172:175], a[44:47], v[76:79]
ds_write_b64 v11, a[102:103] offset:1032
v_mfma_f32_16x16x32_bf16 v[76:79], v[168:171], a[36:39], v[76:79]
buffer_load_dwordx4 a[80:83], v14, s[24:27], s65 offen offset:0 sc1
v_mfma_f32_16x16x32_bf16 v[80:83], v[176:179], a[32:35], v[80:83]
ds_read_b128 v[160:163], v7 offset:8192
v_mfma_f32_16x16x32_bf16 v[80:83], v[180:183], a[40:43], v[80:83]
s_waitcnt lgkmcnt(7)
ds_read_b128 v[164:167], v7 offset:9216
v_mfma_f32_16x16x32_bf16 v[84:87], v[180:183], a[44:47], v[84:87]
ds_write_b64 v11, a[104:105] offset:2048
v_mfma_f32_16x16x32_bf16 v[84:87], v[176:179], a[36:39], v[84:87]
buffer_load_dwordx4 a[88:91], v14, s[24:27], s65 offen offset:2048 sc1
v_mfma_f32_16x16x32_bf16 v[88:91], v[184:187], a[32:35], v[88:91]
ds_read_b128 v[168:171], v7 offset:10240
v_mfma_f32_16x16x32_bf16 v[88:91], v[188:191], a[40:43], v[88:91]
s_waitcnt lgkmcnt(7)
ds_read_b128 v[172:175], v7 offset:11264
v_mfma_f32_16x16x32_bf16 v[92:95], v[188:191], a[44:47], v[92:95]
ds_write_b64 v11, a[106:107] offset:2056
v_mfma_f32_16x16x32_bf16 v[92:95], v[184:187], a[36:39], v[92:95]
buffer_load_dwordx4 a[84:87], v14, s[24:27], s93 offen offset:0 sc1
v_mfma_f32_16x16x32_bf16 v[96:99], v[144:147], a[32:35], v[96:99]
ds_read_b128 v[176:179], v7 offset:12288
v_mfma_f32_16x16x32_bf16 v[96:99], v[148:151], a[40:43], v[96:99]
s_waitcnt lgkmcnt(8)
ds_read_b128 v[180:183], v7 offset:13312
v_mfma_f32_16x16x32_bf16 v[100:103], v[148:151], a[44:47], v[100:103]
ds_write_b64 v11, a[108:109] offset:3072
v_mfma_f32_16x16x32_bf16 v[100:103], v[144:147], a[36:39], v[100:103]
buffer_load_dwordx4 a[92:95], v14, s[24:27], s93 offen offset:2048 sc1
v_mfma_f32_16x16x32_bf16 v[104:107], v[152:155], a[32:35], v[104:107]
ds_read_b128 v[184:187], v7 offset:14336
v_mfma_f32_16x16x32_bf16 v[104:107], v[156:159], a[40:43], v[104:107]
ds_read_b128 v[188:191], v7 offset:15360
v_mfma_f32_16x16x32_bf16 v[108:111], v[156:159], a[44:47], v[108:111]
ds_write_b64 v11, a[110:111] offset:3080
v_mfma_f32_16x16x32_bf16 v[108:111], v[152:155], a[36:39], v[108:111]
s_waitcnt lgkmcnt(10)
s_add_u32 s91, s91, 16384
ds_read_b128 v[144:147], v8 offset:0
v_mfma_f32_16x16x32_bf16 v[112:115], v[160:163], a[32:35], v[112:115]
s_xor_b32 s65, s82, 24576
s_add_u32 s65, s65, s77
ds_read_b128 v[148:151], v8 offset:1024
v_mfma_f32_16x16x32_bf16 v[112:115], v[164:167], a[40:43], v[112:115]
s_cmp_ge_u32 s91, 163840
s_cselect_b32 s91, 0, s91
v_add_u32 v7, s91, v4
v_mfma_f32_16x16x32_bf16 v[116:119], v[164:167], a[44:47], v[116:119]
buffer_load_dwordx4 a[192:195], v4, s[24:27], s65 offen offset:0 sc1
v_mfma_f32_16x16x32_bf16 v[116:119], v[160:163], a[36:39], v[116:119]
s_waitcnt lgkmcnt(9) vmcnt(12)
ds_read_b128 v[152:155], v8 offset:2048
v_mfma_f32_16x16x32_bf16 v[120:123], v[168:171], a[48:51], v[120:123]
ds_read_b128 v[156:159], v8 offset:3072
v_mfma_f32_16x16x32_bf16 v[120:123], v[172:175], a[56:59], v[120:123]
s_waitcnt vmcnt(10)
v_mfma_f32_16x16x32_bf16 v[124:127], v[172:175], a[60:63], v[124:127]
buffer_load_dwordx4 a[200:203], v4, s[24:27], s65 offen offset:2048 sc1
v_mfma_f32_16x16x32_bf16 v[124:127], v[168:171], a[52:55], v[124:127]
s_waitcnt lgkmcnt(8)
ds_read_b128 v[160:163], v8 offset:4096
v_mfma_f32_16x16x32_bf16 v[72:75], v[176:179], a[48:51], v[72:75]
s_xor_b32 s93, s82, 24576
s_add_u32 s93, s93, s81
ds_read_b128 v[164:167], v8 offset:5120
v_mfma_f32_16x16x32_bf16 v[72:75], v[180:183], a[56:59], v[72:75]
v_mfma_f32_16x16x32_bf16 v[76:79], v[180:183], a[60:63], v[76:79]
buffer_load_dwordx4 a[196:199], v4, s[24:27], s93 offen offset:0 sc1
v_mfma_f32_16x16x32_bf16 v[76:79], v[176:179], a[52:55], v[76:79]
s_waitcnt lgkmcnt(7)
ds_read_b128 v[168:171], v8 offset:6144
v_mfma_f32_16x16x32_bf16 v[80:83], v[184:187], a[48:51], v[80:83]
ds_read_b128 v[172:175], v8 offset:7168
v_mfma_f32_16x16x32_bf16 v[80:83], v[188:191], a[56:59], v[80:83]
v_mfma_f32_16x16x32_bf16 v[84:87], v[188:191], a[60:63], v[84:87]
buffer_load_dwordx4 a[204:207], v4, s[24:27], s93 offen offset:2048 sc1
v_mfma_f32_16x16x32_bf16 v[84:87], v[184:187], a[52:55], v[84:87]
s_waitcnt lgkmcnt(6)
ds_read_b128 v[176:179], v8 offset:8192
v_mfma_f32_16x16x32_bf16 v[88:91], v[144:147], a[48:51], v[88:91]
ds_read_b128 v[180:183], v8 offset:9216
v_mfma_f32_16x16x32_bf16 v[88:91], v[148:151], a[56:59], v[88:91]
v_mfma_f32_16x16x32_bf16 v[92:95], v[148:151], a[60:63], v[92:95]
ds_read_b128 v[184:187], v8 offset:10240
v_mfma_f32_16x16x32_bf16 v[92:95], v[144:147], a[52:55], v[92:95]
s_waitcnt lgkmcnt(7)
v_mfma_f32_16x16x32_bf16 v[96:99], v[152:155], a[48:51], v[96:99]
s_add_u32 s52, s84, 1
ds_read_b128 v[188:191], v8 offset:11264
v_mfma_f32_16x16x32_bf16 v[96:99], v[156:159], a[56:59], v[96:99]
v_mfma_f32_16x16x32_bf16 v[100:103], v[156:159], a[60:63], v[100:103]
buffer_load_dwordx4 a[208:211], v14, s[24:27], s65 offen offset:0 sc1
v_mfma_f32_16x16x32_bf16 v[100:103], v[152:155], a[52:55], v[100:103]
s_and_b32 s52, s52, 3
s_waitcnt lgkmcnt(6)
ds_read_b128 v[144:147], v8 offset:12288
v_mfma_f32_16x16x32_bf16 v[104:107], v[160:163], a[48:51], v[104:107]
ds_read_b128 v[148:151], v8 offset:13312
v_mfma_f32_16x16x32_bf16 v[104:107], v[164:167], a[56:59], v[104:107]
s_waitcnt lgkmcnt(6)
v_mfma_f32_16x16x32_bf16 v[108:111], v[164:167], a[60:63], v[108:111]
s_mul_i32 s52, s52, 6144
ds_read_b128 v[152:155], v8 offset:14336
v_add_u32 v11, s70, v4
v_mfma_f32_16x16x32_bf16 v[108:111], v[160:163], a[52:55], v[108:111]
s_add_u32 s70, s70, 16384
s_cmp_ge_u32 s70, 163840
s_cselect_b32 s70, s80, s70
v_mfma_f32_16x16x32_bf16 v[112:115], v[168:171], a[48:51], v[112:115]
s_waitcnt vmcnt(50)
ds_read_b128 v[156:159], v8 offset:15360
v_mfma_f32_16x16x32_bf16 v[112:115], v[172:175], a[56:59], v[112:115]
s_barrier
v_mfma_f32_16x16x32_bf16 v[116:119], v[172:175], a[60:63], v[116:119]
s_add_u32 s52, s52, s69
s_waitcnt lgkmcnt(6) vmcnt(12)
ds_read_b128 v[160:163], v7 offset:0
v_mfma_f32_16x16x32_bf16 v[116:119], v[168:171], a[52:55], v[116:119]
buffer_load_dwordx4 a[216:219], v14, s[24:27], s65 offen offset:2048 sc1
v_mfma_f32_16x16x32_bf16 v[120:123], v[176:179], a[64:67], v[120:123]
ds_write_b64 v11, a[112:113] offset:0
v_mfma_f32_16x16x32_bf16 v[120:123], v[180:183], a[72:75], v[120:123]
s_add_u32 s52, s52, 0
s_waitcnt vmcnt(11)
ds_read_b128 v[164:167], v7 offset:1024
v_mfma_f32_16x16x32_bf16 v[124:127], v[180:183], a[76:79], v[124:127]
buffer_load_dwordx4 a[212:215], v14, s[24:27], s93 offen offset:0 sc1
v_mfma_f32_16x16x32_bf16 v[124:127], v[176:179], a[68:71], v[124:127]
s_waitcnt lgkmcnt(7)
s_add_u32 s91, s91, 16384
ds_read_b128 v[168:171], v7 offset:2048
v_mfma_f32_16x16x32_bf16 v[72:75], v[184:187], a[64:67], v[72:75]
s_add_u32 s53, s84, 2
ds_read_b128 v[172:175], v7 offset:3072
v_mfma_f32_16x16x32_bf16 v[72:75], v[188:191], a[72:75], v[72:75]
ds_write_b64 v11, a[114:115] offset:8
v_mfma_f32_16x16x32_bf16 v[76:79], v[188:191], a[76:79], v[76:79]
buffer_load_dwordx4 a[220:223], v14, s[24:27], s93 offen offset:2048 sc1
v_mfma_f32_16x16x32_bf16 v[76:79], v[184:187], a[68:71], v[76:79]
s_and_b32 s53, s53, 3
s_waitcnt lgkmcnt(8)
ds_read_b128 v[176:179], v7 offset:4096
v_mfma_f32_16x16x32_bf16 v[80:83], v[144:147], a[64:67], v[80:83]
s_xor_b32 s65, s82, 32768
s_add_u32 s65, s65, s77
ds_read_b128 v[180:183], v7 offset:5120
v_mfma_f32_16x16x32_bf16 v[80:83], v[148:151], a[72:75], v[80:83]
ds_write_b64 v11, a[116:117] offset:1024
v_mfma_f32_16x16x32_bf16 v[84:87], v[148:151], a[76:79], v[84:87]
s_mul_i32 s53, s53, 6144
s_waitcnt lgkmcnt(9)
ds_read_b128 v[184:187], v7 offset:6144
v_mfma_f32_16x16x32_bf16 v[84:87], v[144:147], a[68:71], v[84:87]
buffer_load_dwordx4 a[224:227], v4, s[24:27], s65 offen offset:0 sc1
v_mfma_f32_16x16x32_bf16 v[88:91], v[152:155], a[64:67], v[88:91]
s_cmp_ge_u32 s91, 163840
L_PAD11:
s_cbranch_execz L_MAIN
s_cselect_b32 s91, 0, s91
ds_read_b128 v[188:191], v7 offset:7168
v_mfma_f32_16x16x32_bf16 v[88:91], v[156:159], a[72:75], v[88:91]
s_add_u32 s53, s53, s69
s_waitcnt lgkmcnt(8)
v_add_u32 v8, s91, v4
v_mfma_f32_16x16x32_bf16 v[92:95], v[156:159], a[76:79], v[92:95]
ds_write_b64 v11, a[118:119] offset:1032
v_mfma_f32_16x16x32_bf16 v[92:95], v[152:155], a[68:71], v[92:95]
buffer_load_dwordx4 a[232:235], v4, s[24:27], s65 offen offset:2048 sc1
v_mfma_f32_16x16x32_bf16 v[96:99], v[160:163], a[64:67], v[96:99]
s_add_u32 s53, s53, 2048
s_xor_b32 s93, s82, 32768
s_add_u32 s93, s93, s81
v_mfma_f32_16x16x32_bf16 v[96:99], v[164:167], a[72:75], v[96:99]
ds_read_b128 v[144:147], v7 offset:8192
v_mfma_f32_16x16x32_bf16 v[100:103], v[164:167], a[76:79], v[100:103]
ds_write_b64 v11, a[120:121] offset:2048
v_mfma_f32_16x16x32_bf16 v[100:103], v[160:163], a[68:71], v[100:103]
s_add_u32 s54, s84, 3
s_waitcnt lgkmcnt(9) vmcnt(12)
ds_read_b128 v[148:151], v7 offset:9216
v_mfma_f32_16x16x32_bf16 v[120:123], v[168:171], a[80:83], v[120:123]
buffer_load_dwordx4 a[228:231], v4, s[24:27], s93 offen offset:0 sc1
v_mfma_f32_16x16x32_bf16 v[120:123], v[172:175], a[88:91], v[120:123]
s_waitcnt vmcnt(11)
ds_read_b128 v[152:155], v7 offset:10240
v_mfma_f32_16x16x32_bf16 v[124:127], v[172:175], a[92:95], v[124:127]
s_and_b32 s54, s54, 3
s_waitcnt lgkmcnt(8)
ds_read_b128 v[156:159], v7 offset:11264
v_mfma_f32_16x16x32_bf16 v[124:127], v[168:171], a[84:87], v[124:127]
ds_write_b64 v11, a[122:123] offset:2056
v_mfma_f32_16x16x32_bf16 v[72:75], v[176:179], a[80:83], v[72:75]
buffer_load_dwordx4 a[236:239], v4, s[24:27], s93 offen offset:2048 sc1
v_mfma_f32_16x16x32_bf16 v[72:75], v[180:183], a[88:91], v[72:75]
s_mul_i32 s54, s54, 6144
ds_read_b128 v[160:163], v7 offset:12288
v_mfma_f32_16x16x32_bf16 v[76:79], v[180:183], a[92:95], v[76:79]
s_waitcnt lgkmcnt(8)
ds_read_b128 v[164:167], v7 offset:13312
v_mfma_f32_16x16x32_bf16 v[76:79], v[176:179], a[84:87], v[76:79]
ds_write_b64 v11, a[124:125] offset:3072
v_mfma_f32_16x16x32_bf16 v[80:83], v[184:187], a[80:83], v[80:83]
s_add_u32 s54, s54, s69
ds_read_b128 v[168:171], v7 offset:14336
v_mfma_f32_16x16x32_bf16 v[80:83], v[188:191], a[88:91], v[80:83]
ds_read_b128 v[172:175], v7 offset:15360
v_mfma_f32_16x16x32_bf16 v[84:87], v[188:191], a[92:95], v[84:87]
buffer_load_dwordx4 a[240:243], v14, s[24:27], s65 offen offset:0 sc1
v_mfma_f32_16x16x32_bf16 v[84:87], v[184:187], a[84:87], v[84:87]
s_add_u32 s54, s54, 4096
s_waitcnt lgkmcnt(8)
ds_read_b128 v[176:179], v8 offset:0
v_mfma_f32_16x16x32_bf16 v[88:91], v[144:147], a[80:83], v[88:91]
ds_write_b64 v11, a[126:127] offset:3080
v_mfma_f32_16x16x32_bf16 v[88:91], v[148:151], a[88:91], v[88:91]
s_add_u32 s91, s91, 16384
ds_read_b128 v[180:183], v8 offset:1024
v_add_u32 v11, s70, v4
v_mfma_f32_16x16x32_bf16 v[92:95], v[148:151], a[92:95], v[92:95]
s_sub_u32 s55, s3, s84
s_add_u32 s70, s70, 16384
ds_read_b128 v[184:187], v8 offset:2048
v_mfma_f32_16x16x32_bf16 v[92:95], v[144:147], a[84:87], v[92:95]
s_cmp_ge_u32 s70, 163840
s_cselect_b32 s70, s80, s70
s_waitcnt lgkmcnt(10)
v_mfma_f32_16x16x32_bf16 v[96:99], v[152:155], a[80:83], v[96:99]
buffer_load_dwordx4 a[248:251], v14, s[24:27], s65 offen offset:2048 sc1
v_mfma_f32_16x16x32_bf16 v[96:99], v[156:159], a[88:91], v[96:99]
s_and_b32 s55, s55, 3
s_waitcnt lgkmcnt(7) vmcnt(12)
ds_read_b128 v[188:191], v8 offset:3072
v_mfma_f32_16x16x32_bf16 v[100:103], v[156:159], a[92:95], v[100:103]
ds_write_b64 v11, a[160:161] offset:0
v_mfma_f32_16x16x32_bf16 v[100:103], v[152:155], a[84:87], v[100:103]
buffer_load_dwordx4 a[244:247], v14, s[24:27], s93 offen offset:0 sc1
v_mfma_f32_16x16x32_bf16 v[120:123], v[160:163], a[192:195], v[120:123]
s_lshl_b32 s55, s55, 10
ds_read_b128 v[144:147], v8 offset:4096
v_mfma_f32_16x16x32_bf16 v[120:123], v[164:167], a[200:203], v[120:123]
s_waitcnt vmcnt(11)
ds_read_b128 v[148:151], v8 offset:5120
v_mfma_f32_16x16x32_bf16 v[124:127], v[164:167], a[204:207], v[124:127]
ds_write_b64 v11, a[162:163] offset:8
v_mfma_f32_16x16x32_bf16 v[124:127], v[160:163], a[196:199], v[124:127]
s_add_u32 s55, s55, s69
s_waitcnt lgkmcnt(9)
ds_read_b128 v[152:155], v8 offset:6144
v_mfma_f32_16x16x32_bf16 v[72:75], v[168:171], a[192:195], v[72:75]
buffer_load_dwordx4 a[252:255], v14, s[24:27], s93 offen offset:2048 sc1
v_mfma_f32_16x16x32_bf16 v[72:75], v[172:175], a[200:203], v[72:75]
s_cmp_ge_u32 s91, 163840
s_cselect_b32 s91, 0, s91
ds_read_b128 v[156:159], v8 offset:7168
v_mfma_f32_16x16x32_bf16 v[76:79], v[172:175], a[204:207], v[76:79]
s_add_u32 s55, s55, 23552
s_waitcnt lgkmcnt(8)
ds_read_b128 v[160:163], v8 offset:8192
v_mfma_f32_16x16x32_bf16 v[76:79], v[168:171], a[196:199], v[76:79]
ds_write_b64 v11, a[164:165] offset:1024
v_mfma_f32_16x16x32_bf16 v[80:83], v[176:179], a[192:195], v[80:83]
s_xor_b32 s65, s82, 40960
s_add_u32 s65, s65, s77
ds_read_b128 v[164:167], v8 offset:9216
v_mfma_f32_16x16x32_bf16 v[80:83], v[180:183], a[200:203], v[80:83]
s_add_u32 s71, s69, 24576
s_waitcnt lgkmcnt(9)
v_add_u32 v7, s91, v4
v_mfma_f32_16x16x32_bf16 v[84:87], v[180:183], a[204:207], v[84:87]
buffer_load_dwordx4 a[96:99], v4, s[24:27], s65 offen offset:0 sc1
v_mfma_f32_16x16x32_bf16 v[84:87], v[176:179], a[196:199], v[84:87]
ds_write_b64 v11, a[166:167] offset:1032
v_mfma_f32_16x16x32_bf16 v[88:91], v[184:187], a[192:195], v[88:91]
s_cmp_eq_u32 s3, s84
s_cselect_b32 s55, 2147418112, s55
s_cselect_b32 s71, s71, 2147418112
v_mfma_f32_16x16x32_bf16 v[88:91], v[188:191], a[200:203], v[88:91]
ds_read_b128 v[168:171], v8 offset:10240
v_mfma_f32_16x16x32_bf16 v[92:95], v[188:191], a[204:207], v[92:95]
buffer_load_dwordx4 a[104:107], v4, s[24:27], s65 offen offset:2048 sc1
v_mfma_f32_16x16x32_bf16 v[92:95], v[184:187], a[196:199], v[92:95]
s_mul_i32 s83, s84, 6144
s_waitcnt lgkmcnt(8)
ds_read_b128 v[172:175], v8 offset:11264
v_mfma_f32_16x16x32_bf16 v[96:99], v[144:147], a[192:195], v[96:99]
ds_write_b64 v11, a[168:169] offset:2048
v_mfma_f32_16x16x32_bf16 v[96:99], v[148:151], a[200:203], v[96:99]
s_xor_b32 s93, s82, 40960
s_add_u32 s93, s93, s81
ds_read_b128 v[176:179], v8 offset:12288
v_mfma_f32_16x16x32_bf16 v[100:103], v[148:151], a[204:207], v[100:103]
s_add_u32 s69, s69, s83
s_waitcnt lgkmcnt(8) vmcnt(12)
ds_read_b128 v[180:183], v8 offset:13312
v_mfma_f32_16x16x32_bf16 v[100:103], v[144:147], a[196:199], v[100:103]
buffer_load_dwordx4 a[100:103], v4, s[24:27], s93 offen offset:0 sc1
v_mfma_f32_16x16x32_bf16 v[120:123], v[152:155], a[208:211], v[120:123]
s_waitcnt vmcnt(56)
s_waitcnt vmcnt(11)
ds_read_b128 v[184:187], v8 offset:14336
v_mfma_f32_16x16x32_bf16 v[120:123], v[156:159], a[216:219], v[120:123]
s_barrier
v_mfma_f32_16x16x32_bf16 v[124:127], v[156:159], a[220:223], v[124:127]
s_add_u32 s83, s69, 4096
s_waitcnt lgkmcnt(7)
ds_read_b128 v[188:191], v8 offset:15360
v_mfma_f32_16x16x32_bf16 v[124:127], v[152:155], a[212:215], v[124:127]
ds_write_b64 v11, a[170:171] offset:2056
v_mfma_f32_16x16x32_bf16 v[72:75], v[160:163], a[208:211], v[72:75]
buffer_load_dwordx4 a[108:111], v4, s[24:27], s93 offen offset:2048 sc1
v_mfma_f32_16x16x32_bf16 v[72:75], v[164:167], a[216:219], v[72:75]
s_add_u32 s91, s91, 16384
ds_read_b128 v[144:147], v7 offset:0
v_mfma_f32_16x16x32_bf16 v[76:79], v[164:167], a[220:223], v[76:79]
s_waitcnt lgkmcnt(7)
ds_read_b128 v[148:151], v7 offset:1024
v_mfma_f32_16x16x32_bf16 v[76:79], v[160:163], a[212:215], v[76:79]
ds_write_b64 v11, a[172:173] offset:3072
v_mfma_f32_16x16x32_bf16 v[80:83], v[168:171], a[208:211], v[80:83]
s_cmp_ge_u32 s91, 163840
s_cselect_b32 s91, 0, s91
ds_read_b128 v[152:155], v7 offset:2048
v_mfma_f32_16x16x32_bf16 v[80:83], v[172:175], a[216:219], v[80:83]
s_waitcnt lgkmcnt(7)
ds_read_b128 v[156:159], v7 offset:3072
v_add_u32 v8, s91, v4
v_mfma_f32_16x16x32_bf16 v[84:87], v[172:175], a[220:223], v[84:87]
buffer_load_dwordx4 a[112:115], v14, s[24:27], s65 offen offset:0 sc1
v_mfma_f32_16x16x32_bf16 v[84:87], v[168:171], a[212:215], v[84:87]
ds_write_b64 v11, a[174:175] offset:3080
v_mfma_f32_16x16x32_bf16 v[88:91], v[176:179], a[208:211], v[88:91]
s_add_u32 s68, s68, 49152
ds_read_b128 v[160:163], v7 offset:4096
v_mfma_f32_16x16x32_bf16 v[88:91], v[180:183], a[216:219], v[88:91]
ds_read_b128 v[164:167], v7 offset:5120
v_mfma_f32_16x16x32_bf16 v[92:95], v[180:183], a[220:223], v[92:95]
buffer_load_dwordx4 a[120:123], v14, s[24:27], s65 offen offset:2048 sc1
v_mfma_f32_16x16x32_bf16 v[92:95], v[176:179], a[212:215], v[92:95]
s_waitcnt lgkmcnt(9)
ds_read_b128 v[168:171], v7 offset:6144
v_mfma_f32_16x16x32_bf16 v[96:99], v[184:187], a[208:211], v[96:99]
ds_read_b128 v[172:175], v7 offset:7168
v_mfma_f32_16x16x32_bf16 v[96:99], v[188:191], a[216:219], v[96:99]
v_mfma_f32_16x16x32_bf16 v[100:103], v[188:191], a[220:223], v[100:103]
buffer_load_dwordx4 a[116:119], v14, s[24:27], s93 offen offset:0 sc1
v_mfma_f32_16x16x32_bf16 v[100:103], v[184:187], a[212:215], v[100:103]
s_waitcnt lgkmcnt(8) vmcnt(13)
ds_read_b128 v[176:179], v7 offset:8192
v_mfma_f32_16x16x32_bf16 v[120:123], v[144:147], a[224:227], v[120:123]
ds_read_b128 v[180:183], v7 offset:9216
v_mfma_f32_16x16x32_bf16 v[120:123], v[148:151], a[232:235], v[120:123]
s_waitcnt vmcnt(11)
v_mfma_f32_16x16x32_bf16 v[124:127], v[148:151], a[236:239], v[124:127]
buffer_load_dwordx4 a[124:127], v14, s[24:27], s93 offen offset:2048 sc1
v_mfma_f32_16x16x32_bf16 v[124:127], v[144:147], a[228:231], v[124:127]
s_waitcnt lgkmcnt(7)
ds_read_b128 v[184:187], v7 offset:10240
v_mfma_f32_16x16x32_bf16 v[72:75], v[152:155], a[224:227], v[72:75]
ds_read_b128 v[188:191], v7 offset:11264
v_mfma_f32_16x16x32_bf16 v[72:75], v[156:159], a[232:235], v[72:75]
v_mfma_f32_16x16x32_bf16 v[76:79], v[156:159], a[236:239], v[76:79]
ds_read_b128 v[144:147], v7 offset:12288
v_mfma_f32_16x16x32_bf16 v[76:79], v[152:155], a[228:231], v[76:79]
s_waitcnt lgkmcnt(7)
v_mfma_f32_16x16x32_bf16 v[80:83], v[160:163], a[224:227], v[80:83]
s_xor_b32 s65, s82, 49152
s_add_u32 s65, s65, s77
ds_read_b128 v[148:151], v7 offset:13312
v_mfma_f32_16x16x32_bf16 v[80:83], v[164:167], a[232:235], v[80:83]
v_mov_b32 v13, 0xffff0000
v_mul_u32_u24 v5, 1152, v2
v_mfma_f32_16x16x32_bf16 v[84:87], v[164:167], a[236:239], v[84:87]
buffer_load_dwordx4 a[128:131], v4, s[24:27], s65 offen offset:0 sc1
v_mfma_f32_16x16x32_bf16 v[84:87], v[160:163], a[228:231], v[84:87]
s_waitcnt lgkmcnt(6)
ds_read_b128 v[152:155], v7 offset:14336
v_lshl_add_u32 v6, v3, 3, v5
v_mfma_f32_16x16x32_bf16 v[88:91], v[168:171], a[224:227], v[88:91]
ds_read_b128 v[156:159], v7 offset:15360
v_and_b32 v9, 1, v3
v_mfma_f32_16x16x32_bf16 v[88:91], v[172:175], a[232:235], v[88:91]
s_add_u32 s91, s91, 16384
s_cmp_ge_u32 s91, 163840
s_cselect_b32 s91, 0, s91
v_mfma_f32_16x16x32_bf16 v[92:95], v[172:175], a[236:239], v[92:95]
buffer_load_dwordx4 a[136:139], v4, s[24:27], s65 offen offset:2048 sc1
v_mfma_f32_16x16x32_bf16 v[92:95], v[168:171], a[228:231], v[92:95]
s_waitcnt lgkmcnt(6)
ds_read_b128 v[160:163], v8 offset:0
v_add_u32 v7, s91, v4
v_mfma_f32_16x16x32_bf16 v[96:99], v[176:179], a[224:227], v[96:99]
s_xor_b32 s93, s82, 49152
s_add_u32 s93, s93, s81
ds_read_b128 v[164:167], v8 offset:1024
v_mfma_f32_16x16x32_bf16 v[96:99], v[180:183], a[232:235], v[96:99]
v_lshl_add_u32 v5, v9, 5, v5
v_lshrrev_b32 v9, 1, v3
v_mfma_f32_16x16x32_bf16 v[100:103], v[180:183], a[236:239], v[100:103]
buffer_load_dwordx4 a[132:135], v4, s[24:27], s93 offen offset:0 sc1
v_mfma_f32_16x16x32_bf16 v[100:103], v[176:179], a[228:231], v[100:103]
s_waitcnt lgkmcnt(6) vmcnt(13)
ds_read_b128 v[168:171], v8 offset:2048
v_lshl_add_u32 v5, v9, 4, v5
v_mfma_f32_16x16x32_bf16 v[120:123], v[184:187], a[240:243], v[120:123]
ds_read_b128 v[172:175], v8 offset:3072
v_mfma_f32_16x16x32_bf16 v[120:123], v[188:191], a[248:251], v[120:123]
s_waitcnt vmcnt(11)
v_mfma_f32_16x16x32_bf16 v[124:127], v[188:191], a[252:255], v[124:127]
buffer_load_dwordx4 a[140:143], v4, s[24:27], s93 offen offset:2048 sc1
v_mfma_f32_16x16x32_bf16 v[124:127], v[184:187], a[244:247], v[124:127]
s_waitcnt lgkmcnt(6)
ds_read_b128 v[176:179], v8 offset:4096
v_mfma_f32_16x16x32_bf16 v[72:75], v[144:147], a[240:243], v[72:75]
ds_read_b128 v[180:183], v8 offset:5120
v_mfma_f32_16x16x32_bf16 v[72:75], v[148:151], a[248:251], v[72:75]
v_mfma_f32_16x16x32_bf16 v[76:79], v[148:151], a[252:255], v[76:79]
ds_read_b128 v[184:187], v8 offset:6144
v_mfma_f32_16x16x32_bf16 v[76:79], v[144:147], a[244:247], v[76:79]
s_waitcnt lgkmcnt(7)
v_mfma_f32_16x16x32_bf16 v[80:83], v[152:155], a[240:243], v[80:83]
ds_read_b128 v[188:191], v8 offset:7168
v_mfma_f32_16x16x32_bf16 v[80:83], v[156:159], a[248:251], v[80:83]
s_waitcnt lgkmcnt(6)
v_mfma_f32_16x16x32_bf16 v[84:87], v[156:159], a[252:255], v[84:87]
buffer_load_dword v12, v10, s[24:27], s75 offen offset:4 sc1
v_mfma_f32_16x16x32_bf16 v[84:87], v[152:155], a[244:247], v[84:87]
buffer_load_dwordx4 a[144:147], v14, s[24:27], s65 offen offset:0 sc1
v_mfma_f32_16x16x32_bf16 v[88:91], v[160:163], a[240:243], v[88:91]
ds_read_b128 v[144:147], v8 offset:8192
v_mfma_f32_16x16x32_bf16 v[88:91], v[164:167], a[248:251], v[88:91]
ds_read_b128 v[148:151], v8 offset:9216
v_mfma_f32_16x16x32_bf16 v[92:95], v[164:167], a[252:255], v[92:95]
buffer_load_dwordx4 a[152:155], v14, s[24:27], s65 offen offset:2048 sc1
v_mfma_f32_16x16x32_bf16 v[92:95], v[160:163], a[244:247], v[92:95]
s_waitcnt lgkmcnt(6)
ds_read_b128 v[152:155], v8 offset:10240
v_mfma_f32_16x16x32_bf16 v[96:99], v[168:171], a[240:243], v[96:99]
ds_read_b128 v[156:159], v8 offset:11264
v_mfma_f32_16x16x32_bf16 v[96:99], v[172:175], a[248:251], v[96:99]
v_mfma_f32_16x16x32_bf16 v[100:103], v[172:175], a[252:255], v[100:103]
buffer_load_dwordx4 a[148:151], v14, s[24:27], s93 offen offset:0 sc1
v_mfma_f32_16x16x32_bf16 v[100:103], v[168:171], a[244:247], v[100:103]
s_waitcnt lgkmcnt(6) vmcnt(14)
ds_read_b128 v[160:163], v8 offset:12288
v_mfma_f32_16x16x32_bf16 v[120:123], v[176:179], a[96:99], v[120:123]
ds_read_b128 v[164:167], v8 offset:13312
v_mfma_f32_16x16x32_bf16 v[120:123], v[180:183], a[104:107], v[120:123]
s_waitcnt vmcnt(12)
v_mfma_f32_16x16x32_bf16 v[124:127], v[180:183], a[108:111], v[124:127]
buffer_load_dwordx4 a[156:159], v14, s[24:27], s93 offen offset:2048 sc1
v_mfma_f32_16x16x32_bf16 v[124:127], v[176:179], a[100:103], v[124:127]
s_waitcnt lgkmcnt(6)
ds_read_b128 v[168:171], v8 offset:14336
v_mfma_f32_16x16x32_bf16 v[72:75], v[184:187], a[96:99], v[72:75]
s_waitcnt vmcnt(61)
ds_read_b128 v[172:175], v8 offset:15360
v_mfma_f32_16x16x32_bf16 v[72:75], v[188:191], a[104:107], v[72:75]
s_barrier
v_mfma_f32_16x16x32_bf16 v[76:79], v[188:191], a[108:111], v[76:79]
s_add_u32 s91, s91, 16384
ds_read_b128 v[176:179], v7 offset:0
v_mfma_f32_16x16x32_bf16 v[76:79], v[184:187], a[100:103], v[76:79]
s_waitcnt lgkmcnt(7)
s_cmp_ge_u32 s91, 163840
s_cselect_b32 s91, 0, s91
v_mfma_f32_16x16x32_bf16 v[80:83], v[144:147], a[96:99], v[80:83]
s_xor_b32 s65, s82, 57344
s_add_u32 s65, s65, s77
ds_read_b128 v[180:183], v7 offset:1024
v_mfma_f32_16x16x32_bf16 v[80:83], v[148:151], a[104:107], v[80:83]
v_add_u32 v8, s91, v4
v_mfma_f32_16x16x32_bf16 v[84:87], v[148:151], a[108:111], v[84:87]
buffer_load_dwordx4 a[160:163], v4, s[24:27], s65 offen offset:0 sc1
v_mfma_f32_16x16x32_bf16 v[84:87], v[144:147], a[100:103], v[84:87]
s_waitcnt lgkmcnt(6)
ds_read_b128 v[184:187], v7 offset:2048
v_mfma_f32_16x16x32_bf16 v[88:91], v[152:155], a[96:99], v[88:91]
ds_read_b128 v[188:191], v7 offset:3072
v_mfma_f32_16x16x32_bf16 v[88:91], v[156:159], a[104:107], v[88:91]
v_mfma_f32_16x16x32_bf16 v[92:95], v[156:159], a[108:111], v[92:95]
buffer_load_dwordx4 a[168:171], v4, s[24:27], s65 offen offset:2048 sc1
v_mfma_f32_16x16x32_bf16 v[92:95], v[152:155], a[100:103], v[92:95]
s_waitcnt lgkmcnt(6)
ds_read_b128 v[144:147], v7 offset:4096
v_mfma_f32_16x16x32_bf16 v[96:99], v[160:163], a[96:99], v[96:99]
s_xor_b32 s93, s82, 57344
s_add_u32 s93, s93, s81
ds_read_b128 v[148:151], v7 offset:5120
v_mfma_f32_16x16x32_bf16 v[96:99], v[164:167], a[104:107], v[96:99]
v_mfma_f32_16x16x32_bf16 v[100:103], v[164:167], a[108:111], v[100:103]
buffer_load_dwordx4 a[164:167], v4, s[24:27], s93 offen offset:0 sc1
v_mfma_f32_16x16x32_bf16 v[100:103], v[160:163], a[100:103], v[100:103]
s_waitcnt lgkmcnt(6) vmcnt(14)
ds_read_b128 v[152:155], v7 offset:6144
v_mfma_f32_16x16x32_bf16 v[120:123], v[168:171], a[112:115], v[120:123]
ds_read_b128 v[156:159], v7 offset:7168
v_mfma_f32_16x16x32_bf16 v[120:123], v[172:175], a[120:123], v[120:123]
s_waitcnt vmcnt(12)
v_mfma_f32_16x16x32_bf16 v[124:127], v[172:175], a[124:127], v[124:127]
buffer_load_dwordx4 a[172:175], v4, s[24:27], s93 offen offset:2048 sc1
v_mfma_f32_16x16x32_bf16 v[124:127], v[168:171], a[116:119], v[124:127]
s_waitcnt lgkmcnt(6)
ds_read_b128 v[160:163], v7 offset:8192
v_mfma_f32_16x16x32_bf16 v[72:75], v[176:179], a[112:115], v[72:75]
ds_read_b128 v[164:167], v7 offset:9216
v_mfma_f32_16x16x32_bf16 v[72:75], v[180:183], a[120:123], v[72:75]
v_mfma_f32_16x16x32_bf16 v[76:79], v[180:183], a[124:127], v[76:79]
ds_read_b128 v[168:171], v7 offset:10240
v_mfma_f32_16x16x32_bf16 v[76:79], v[176:179], a[116:119], v[76:79]
s_waitcnt lgkmcnt(7)
v_mfma_f32_16x16x32_bf16 v[80:83], v[184:187], a[112:115], v[80:83]
ds_read_b128 v[172:175], v7 offset:11264
v_mfma_f32_16x16x32_bf16 v[80:83], v[188:191], a[120:123], v[80:83]
v_mfma_f32_16x16x32_bf16 v[84:87], v[188:191], a[124:127], v[84:87]
buffer_load_dwordx4 a[176:179], v14, s[24:27], s65 offen offset:0 sc1
v_mfma_f32_16x16x32_bf16 v[84:87], v[184:187], a[116:119], v[84:87]
s_waitcnt lgkmcnt(6)
ds_read_b128 v[176:179], v7 offset:12288
v_mfma_f32_16x16x32_bf16 v[88:91], v[144:147], a[112:115], v[88:91]
ds_read_b128 v[180:183], v7 offset:13312
v_mfma_f32_16x16x32_bf16 v[88:91], v[148:151], a[120:123], v[88:91]
v_mfma_f32_16x16x32_bf16 v[92:95], v[148:151], a[124:127], v[92:95]
buffer_load_dwordx4 a[184:187], v14, s[24:27], s65 offen offset:2048 sc1
v_mfma_f32_16x16x32_bf16 v[92:95], v[144:147], a[116:119], v[92:95]
s_waitcnt lgkmcnt(6)
ds_read_b128 v[184:187], v7 offset:14336
v_mfma_f32_16x16x32_bf16 v[96:99], v[152:155], a[112:115], v[96:99]
s_waitcnt vmcnt(10)
ds_read_b128 v[188:191], v7 offset:15360
v_mfma_f32_16x16x32_bf16 v[96:99], v[156:159], a[120:123], v[96:99]
s_add_u32 s91, s91, 16384
v_cmp_gt_u32 vcc, 8, v12
v_mfma_f32_16x16x32_bf16 v[100:103], v[156:159], a[124:127], v[100:103]
buffer_load_dwordx4 a[180:183], v14, s[24:27], s93 offen offset:0 sc1
v_mfma_f32_16x16x32_bf16 v[100:103], v[152:155], a[116:119], v[100:103]
s_waitcnt lgkmcnt(6) vmcnt(14)
ds_read_b128 v[144:147], v8 offset:0
v_mfma_f32_16x16x32_bf16 v[120:123], v[160:163], a[128:131], v[120:123]
s_cmp_ge_u32 s91, 163840
s_cselect_b32 s91, 0, s91
ds_read_b128 v[148:151], v8 offset:1024
v_mfma_f32_16x16x32_bf16 v[120:123], v[164:167], a[136:139], v[120:123]
s_waitcnt lgkmcnt(6) vmcnt(12)
v_add_u32 v7, s91, v4
v_mfma_f32_16x16x32_bf16 v[124:127], v[164:167], a[140:143], v[124:127]
s_cbranch_vccnz CK_ZAA
CK_ZAA_R:
v_mfma_f32_16x16x32_bf16 v[124:127], v[160:163], a[132:135], v[124:127]
buffer_load_dwordx4 a[188:191], v14, s[24:27], s93 offen offset:2048 sc1
v_mfma_f32_16x16x32_bf16 v[72:75], v[168:171], a[128:131], v[72:75]
ds_read_b128 v[152:155], v8 offset:2048
v_mfma_f32_16x16x32_bf16 v[72:75], v[172:175], a[136:139], v[72:75]
ds_read_b128 v[156:159], v8 offset:3072
v_mfma_f32_16x16x32_bf16 v[76:79], v[172:175], a[140:143], v[76:79]
ds_read_b128 v[160:163], v8 offset:4096
v_mfma_f32_16x16x32_bf16 v[76:79], v[168:171], a[132:135], v[76:79]
s_waitcnt lgkmcnt(7)
v_mfma_f32_16x16x32_bf16 v[80:83], v[176:179], a[128:131], v[80:83]
s_add_u32 s65, s77, 65536
ds_read_b128 v[164:167], v8 offset:5120
v_mfma_f32_16x16x32_bf16 v[80:83], v[180:183], a[136:139], v[80:83]
v_mfma_f32_16x16x32_bf16 v[84:87], v[180:183], a[140:143], v[84:87]
buffer_load_dwordx4 v[32:35], v4, s[24:27], s65 offen offset:0 sc1
v_mfma_f32_16x16x32_bf16 v[84:87], v[176:179], a[132:135], v[84:87]
s_waitcnt lgkmcnt(6)
ds_read_b128 v[168:171], v8 offset:6144
v_mfma_f32_16x16x32_bf16 v[88:91], v[184:187], a[128:131], v[88:91]
ds_read_b128 v[172:175], v8 offset:7168
v_mfma_f32_16x16x32_bf16 v[88:91], v[188:191], a[136:139], v[88:91]
v_mfma_f32_16x16x32_bf16 v[92:95], v[188:191], a[140:143], v[92:95]
buffer_load_dwordx4 v[40:43], v4, s[24:27], s65 offen offset:2048 sc1
v_mfma_f32_16x16x32_bf16 v[92:95], v[184:187], a[132:135], v[92:95]
s_waitcnt lgkmcnt(6)
ds_read_b128 v[176:179], v8 offset:8192
v_mfma_f32_16x16x32_bf16 v[96:99], v[144:147], a[128:131], v[96:99]
s_add_u32 s93, s81, 65536
ds_read_b128 v[180:183], v8 offset:9216
v_mfma_f32_16x16x32_bf16 v[96:99], v[148:151], a[136:139], v[96:99]
s_waitcnt lgkmcnt(6) vmcnt(12)
v_mfma_f32_16x16x32_bf16 v[100:103], v[148:151], a[140:143], v[100:103]
buffer_load_dwordx4 v[36:39], v4, s[24:27], s93 offen offset:0 sc1
v_mfma_f32_16x16x32_bf16 v[100:103], v[144:147], a[132:135], v[100:103]
s_mov_b32 m0, s70
s_mov_b32 s64, s68
s_add_u32 s68, s68, 16384
v_mfma_f32_16x16x32_bf16 v[120:123], v[152:155], a[144:147], v[120:123]
s_waitcnt vmcnt(11)
ds_read_b128 v[184:187], v8 offset:10240
v_mfma_f32_16x16x32_bf16 v[120:123], v[156:159], a[152:155], v[120:123]
s_add_u32 s70, s70, 16384
s_cmp_ge_u32 s70, 163840
s_cselect_b32 s70, s80, s70
v_mfma_f32_16x16x32_bf16 v[124:127], v[156:159], a[156:159], v[124:127]
buffer_load_dwordx4 v4, s[24:27], s64 offen offset:0 sc1 lds
v_mfma_f32_16x16x32_bf16 v[124:127], v[152:155], a[148:151], v[124:127]
s_waitcnt lgkmcnt(5)
ds_read_b128 v[188:191], v8 offset:11264
v_mfma_f32_16x16x32_bf16 v[72:75], v[160:163], a[144:147], v[72:75]
ds_read_b128 v[144:147], v8 offset:12288
v_mfma_f32_16x16x32_bf16 v[72:75], v[164:167], a[152:155], v[72:75]
buffer_load_dwordx4 v4, s[24:27], s64 offen offset:1024 sc1 lds
v_mfma_f32_16x16x32_bf16 v[76:79], v[164:167], a[156:159], v[76:79]
ds_read_b128 v[148:151], v8 offset:13312
v_mfma_f32_16x16x32_bf16 v[76:79], v[160:163], a[148:151], v[76:79]
s_waitcnt lgkmcnt(6)
ds_read_b128 v[152:155], v8 offset:14336
v_mfma_f32_16x16x32_bf16 v[80:83], v[168:171], a[144:147], v[80:83]
buffer_load_dwordx4 v[44:47], v4, s[24:27], s93 offen offset:2048 sc1
v_mfma_f32_16x16x32_bf16 v[80:83], v[172:175], a[152:155], v[80:83]
s_barrier
v_mfma_f32_16x16x32_bf16 v[84:87], v[172:175], a[156:159], v[84:87]
s_waitcnt lgkmcnt(5)
ds_read_b128 v[156:159], v8 offset:15360
v_mfma_f32_16x16x32_bf16 v[84:87], v[168:171], a[148:151], v[84:87]
buffer_load_dwordx4 v4, s[24:27], s64 offen offset:2048 sc1 lds
v_mfma_f32_16x16x32_bf16 v[88:91], v[176:179], a[144:147], v[88:91]
s_add_u32 s91, s91, 16384
ds_read_b128 v[160:163], v7 offset:0
v_mfma_f32_16x16x32_bf16 v[88:91], v[180:183], a[152:155], v[88:91]
s_cmp_ge_u32 s91, 163840
s_cselect_b32 s91, 0, s91
ds_read_b128 v[164:167], v7 offset:1024
v_mfma_f32_16x16x32_bf16 v[92:95], v[180:183], a[156:159], v[92:95]
buffer_load_dwordx4 v4, s[24:27], s64 offen offset:3072 sc1 lds
v_mfma_f32_16x16x32_bf16 v[92:95], v[176:179], a[148:151], v[92:95]
s_waitcnt lgkmcnt(6)
ds_read_b128 v[168:171], v7 offset:2048
v_add_u32 v8, s91, v4
v_mfma_f32_16x16x32_bf16 v[96:99], v[184:187], a[144:147], v[96:99]
ds_read_b128 v[172:175], v7 offset:3072
v_mfma_f32_16x16x32_bf16 v[96:99], v[188:191], a[152:155], v[96:99]
buffer_load_dwordx4 v[48:51], v14, s[24:27], s65 offen offset:0 sc1
v_mfma_f32_16x16x32_bf16 v[100:103], v[188:191], a[156:159], v[100:103]
ds_read_b128 v[176:179], v7 offset:4096
v_mfma_f32_16x16x32_bf16 v[100:103], v[184:187], a[148:151], v[100:103]
s_waitcnt lgkmcnt(7) vmcnt(15)
v_mfma_f32_16x16x32_bf16 v[120:123], v[144:147], a[160:163], v[120:123]
buffer_load_dwordx4 v[56:59], v14, s[24:27], s65 offen offset:2048 sc1
v_mfma_f32_16x16x32_bf16 v[120:123], v[148:151], a[168:171], v[120:123]
s_waitcnt vmcnt(14)
ds_read_b128 v[180:183], v7 offset:5120
v_mfma_f32_16x16x32_bf16 v[124:127], v[148:151], a[172:175], v[124:127]
s_waitcnt lgkmcnt(6)
ds_read_b128 v[184:187], v7 offset:6144
v_mfma_f32_16x16x32_bf16 v[124:127], v[144:147], a[164:167], v[124:127]
buffer_load_dwordx4 v[52:55], v14, s[24:27], s93 offen offset:0 sc1
v_mfma_f32_16x16x32_bf16 v[72:75], v[152:155], a[160:163], v[72:75]
ds_read_b128 v[188:191], v7 offset:7168
v_mfma_f32_16x16x32_bf16 v[72:75], v[156:159], a[168:171], v[72:75]
v_mfma_f32_16x16x32_bf16 v[76:79], v[156:159], a[172:175], v[76:79]
buffer_load_dwordx4 v[60:63], v14, s[24:27], s93 offen offset:2048 sc1
v_mfma_f32_16x16x32_bf16 v[76:79], v[152:155], a[164:167], v[76:79]
s_waitcnt lgkmcnt(6)
ds_read_b128 v[144:147], v7 offset:8192
v_mfma_f32_16x16x32_bf16 v[80:83], v[160:163], a[160:163], v[80:83]
ds_read_b128 v[148:151], v7 offset:9216
v_mfma_f32_16x16x32_bf16 v[80:83], v[164:167], a[168:171], v[80:83]
v_mfma_f32_16x16x32_bf16 v[84:87], v[164:167], a[172:175], v[84:87]
ds_read_b128 v[152:155], v7 offset:10240
v_mfma_f32_16x16x32_bf16 v[84:87], v[160:163], a[164:167], v[84:87]
s_waitcnt lgkmcnt(7)
v_mfma_f32_16x16x32_bf16 v[88:91], v[168:171], a[160:163], v[88:91]
s_add_u32 s65, s77, 73728
ds_read_b128 v[156:159], v7 offset:11264
v_mfma_f32_16x16x32_bf16 v[88:91], v[172:175], a[168:171], v[88:91]
v_mfma_f32_16x16x32_bf16 v[92:95], v[172:175], a[172:175], v[92:95]
buffer_load_dwordx4 v[64:67], v4, s[24:27], s65 offen offset:0 sc1
v_mfma_f32_16x16x32_bf16 v[92:95], v[168:171], a[164:167], v[92:95]
s_waitcnt lgkmcnt(6)
ds_read_b128 v[160:163], v7 offset:12288
v_mfma_f32_16x16x32_bf16 v[96:99], v[176:179], a[160:163], v[96:99]
ds_read_b128 v[164:167], v7 offset:13312
v_mfma_f32_16x16x32_bf16 v[96:99], v[180:183], a[168:171], v[96:99]
v_mfma_f32_16x16x32_bf16 v[100:103], v[180:183], a[172:175], v[100:103]
ds_read_b128 v[168:171], v7 offset:14336
v_mfma_f32_16x16x32_bf16 v[100:103], v[176:179], a[164:167], v[100:103]
s_add_u32 s93, s81, 73728
s_waitcnt lgkmcnt(7) vmcnt(15)
v_mfma_f32_16x16x32_bf16 v[120:123], v[184:187], a[176:179], v[120:123]
s_waitcnt vmcnt(13)
ds_read_b128 v[172:175], v7 offset:15360
v_mfma_f32_16x16x32_bf16 v[120:123], v[188:191], a[184:187], v[120:123]
buffer_load_dwordx4 v[68:71], v4, s[24:27], s93 offen offset:0 sc1
v_mfma_f32_16x16x32_bf16 v[124:127], v[188:191], a[188:191], v[124:127]
s_add_u32 s91, s91, 16384
ds_read_b128 v[176:179], v8 offset:0
v_mfma_f32_16x16x32_bf16 v[124:127], v[184:187], a[180:183], v[124:127]
s_waitcnt lgkmcnt(7)
s_cmp_ge_u32 s91, 163840
s_cselect_b32 s91, 0, s91
v_mfma_f32_16x16x32_bf16 v[72:75], v[144:147], a[176:179], v[72:75]
ds_read_b128 v[180:183], v8 offset:1024
v_add_u32 v7, s91, v4
v_mfma_f32_16x16x32_bf16 v[72:75], v[148:151], a[184:187], v[72:75]
v_mfma_f32_16x16x32_bf16 v[76:79], v[148:151], a[188:191], v[76:79]
s_mov_b32 m0, s70
s_mov_b32 s64, s68
s_add_u32 s68, s68, 16384
v_mfma_f32_16x16x32_bf16 v[76:79], v[144:147], a[180:183], v[76:79]
s_waitcnt lgkmcnt(6)
ds_read_b128 v[184:187], v8 offset:2048
v_mfma_f32_16x16x32_bf16 v[80:83], v[152:155], a[176:179], v[80:83]
s_add_u32 s70, s70, 16384
s_cmp_ge_u32 s70, 163840
s_cselect_b32 s70, s80, s70
v_mfma_f32_16x16x32_bf16 v[80:83], v[156:159], a[184:187], v[80:83]
buffer_load_dwordx4 v4, s[24:27], s64 offen offset:0 sc1 lds
v_mfma_f32_16x16x32_bf16 v[84:87], v[156:159], a[188:191], v[84:87]
ds_read_b128 v[188:191], v8 offset:3072
v_mfma_f32_16x16x32_bf16 v[84:87], v[152:155], a[180:183], v[84:87]
s_waitcnt lgkmcnt(6)
ds_read_b128 v[144:147], v8 offset:4096
v_mfma_f32_16x16x32_bf16 v[88:91], v[160:163], a[176:179], v[88:91]
buffer_load_dwordx4 v4, s[24:27], s64 offen offset:1024 sc1 lds
v_mfma_f32_16x16x32_bf16 v[88:91], v[164:167], a[184:187], v[88:91]
ds_read_b128 v[148:151], v8 offset:5120
v_mfma_f32_16x16x32_bf16 v[92:95], v[164:167], a[188:191], v[92:95]
s_waitcnt lgkmcnt(6)
ds_read_b128 v[152:155], v8 offset:6144
v_mfma_f32_16x16x32_bf16 v[92:95], v[160:163], a[180:183], v[92:95]
buffer_load_dwordx4 v4, s[24:27], s64 offen offset:2048 sc1 lds
v_mfma_f32_16x16x32_bf16 v[96:99], v[168:171], a[176:179], v[96:99]
ds_read_b128 v[156:159], v8 offset:7168
v_mfma_f32_16x16x32_bf16 v[96:99], v[172:175], a[184:187], v[96:99]
L_PAD12:
s_cbranch_execz L_MAIN
v_mfma_f32_16x16x32_bf16 v[100:103], v[172:175], a[188:191], v[100:103]
buffer_load_dwordx4 v4, s[24:27], s64 offen offset:3072 sc1 lds
v_mfma_f32_16x16x32_bf16 v[100:103], v[168:171], a[180:183], v[100:103]
s_waitcnt lgkmcnt(6) vmcnt(16)
ds_read_b128 v[160:163], v8 offset:8192
v_mfma_f32_16x16x32_bf16 v[120:123], v[176:179], v[32:35], v[120:123]
s_mov_b32 m0, s70
s_mov_b32 s64, s68
s_add_u32 s68, s68, 16384
v_mfma_f32_16x16x32_bf16 v[120:123], v[180:183], v[40:43], v[120:123]
s_waitcnt lgkmcnt(5) vmcnt(12)
ds_read_b128 v[164:167], v8 offset:9216
v_mfma_f32_16x16x32_bf16 v[124:127], v[180:183], v[44:47], v[124:127]
s_add_u32 s70, s70, 16384
s_cmp_ge_u32 s70, 163840
s_cselect_b32 s70, s80, s70
v_mfma_f32_16x16x32_bf16 v[124:127], v[176:179], v[36:39], v[124:127]
buffer_load_dwordx4 v4, s[24:27], s64 offen offset:0 sc1 lds
v_mfma_f32_16x16x32_bf16 v[72:75], v[184:187], v[32:35], v[72:75]
ds_read_b128 v[168:171], v8 offset:10240
v_mfma_f32_16x16x32_bf16 v[72:75], v[188:191], v[40:43], v[72:75]
ds_read_b128 v[172:175], v8 offset:11264
v_mfma_f32_16x16x32_bf16 v[76:79], v[188:191], v[44:47], v[76:79]
buffer_load_dwordx4 v4, s[24:27], s64 offen offset:1024 sc1 lds
v_mfma_f32_16x16x32_bf16 v[76:79], v[184:187], v[36:39], v[76:79]
s_waitcnt lgkmcnt(6)
ds_read_b128 v[176:179], v8 offset:12288
v_mfma_f32_16x16x32_bf16 v[80:83], v[144:147], v[32:35], v[80:83]
ds_read_b128 v[180:183], v8 offset:13312
v_mfma_f32_16x16x32_bf16 v[80:83], v[148:151], v[40:43], v[80:83]
buffer_load_dwordx4 v4, s[24:27], s64 offen offset:2048 sc1 lds
v_mfma_f32_16x16x32_bf16 v[84:87], v[148:151], v[44:47], v[84:87]
ds_read_b128 v[184:187], v8 offset:14336
v_mfma_f32_16x16x32_bf16 v[84:87], v[144:147], v[36:39], v[84:87]
s_waitcnt lgkmcnt(7)
v_mfma_f32_16x16x32_bf16 v[88:91], v[152:155], v[32:35], v[88:91]
s_waitcnt vmcnt(13)
ds_read_b128 v[188:191], v8 offset:15360
v_mfma_f32_16x16x32_bf16 v[88:91], v[156:159], v[40:43], v[88:91]
s_barrier
v_mfma_f32_16x16x32_bf16 v[92:95], v[156:159], v[44:47], v[92:95]
buffer_load_dwordx4 v4, s[24:27], s64 offen offset:3072 sc1 lds
v_mfma_f32_16x16x32_bf16 v[92:95], v[152:155], v[36:39], v[92:95]
s_waitcnt lgkmcnt(6)
s_add_u32 s91, s91, 16384
ds_read_b128 v[144:147], v7 offset:0
v_mfma_f32_16x16x32_bf16 v[96:99], v[160:163], v[32:35], v[96:99]
s_cmp_ge_u32 s91, 163840
s_cselect_b32 s91, 0, s91
ds_read_b128 v[148:151], v7 offset:1024
v_mfma_f32_16x16x32_bf16 v[96:99], v[164:167], v[40:43], v[96:99]
v_add_u32 v8, s91, v4
v_mfma_f32_16x16x32_bf16 v[100:103], v[164:167], v[44:47], v[100:103]
ds_read_b128 v[152:155], v7 offset:2048
v_mfma_f32_16x16x32_bf16 v[100:103], v[160:163], v[36:39], v[100:103]
s_waitcnt lgkmcnt(7) vmcnt(12)
v_mfma_f32_16x16x32_bf16 v[120:123], v[168:171], v[48:51], v[120:123]
ds_read_b128 v[156:159], v7 offset:3072
v_mfma_f32_16x16x32_bf16 v[120:123], v[172:175], v[56:59], v[120:123]
s_waitcnt vmcnt(10)
v_mfma_f32_16x16x32_bf16 v[124:127], v[172:175], v[60:63], v[124:127]
ds_read_b128 v[160:163], v7 offset:4096
v_mfma_f32_16x16x32_bf16 v[124:127], v[168:171], v[52:55], v[124:127]
s_waitcnt lgkmcnt(7)
v_mfma_f32_16x16x32_bf16 v[72:75], v[176:179], v[48:51], v[72:75]
ds_read_b128 v[164:167], v7 offset:5120
v_mfma_f32_16x16x32_bf16 v[72:75], v[180:183], v[56:59], v[72:75]
v_mfma_f32_16x16x32_bf16 v[76:79], v[180:183], v[60:63], v[76:79]
ds_read_b128 v[168:171], v7 offset:6144
v_mfma_f32_16x16x32_bf16 v[76:79], v[176:179], v[52:55], v[76:79]
s_waitcnt lgkmcnt(7)
v_mfma_f32_16x16x32_bf16 v[80:83], v[184:187], v[48:51], v[80:83]
ds_read_b128 v[172:175], v7 offset:7168
v_mfma_f32_16x16x32_bf16 v[80:83], v[188:191], v[56:59], v[80:83]
v_mfma_f32_16x16x32_bf16 v[84:87], v[188:191], v[60:63], v[84:87]
ds_read_b128 v[176:179], v7 offset:8192
v_mfma_f32_16x16x32_bf16 v[84:87], v[184:187], v[52:55], v[84:87]
s_waitcnt lgkmcnt(7)
v_mfma_f32_16x16x32_bf16 v[88:91], v[144:147], v[48:51], v[88:91]
ds_read_b128 v[180:183], v7 offset:9216
v_mfma_f32_16x16x32_bf16 v[88:91], v[148:151], v[56:59], v[88:91]
v_mfma_f32_16x16x32_bf16 v[92:95], v[148:151], v[60:63], v[92:95]
ds_read_b128 v[184:187], v7 offset:10240
v_mfma_f32_16x16x32_bf16 v[92:95], v[144:147], v[52:55], v[92:95]
s_waitcnt lgkmcnt(7)
v_mfma_f32_16x16x32_bf16 v[96:99], v[152:155], v[48:51], v[96:99]
ds_read_b128 v[188:191], v7 offset:11264
v_mfma_f32_16x16x32_bf16 v[96:99], v[156:159], v[56:59], v[96:99]
v_mfma_f32_16x16x32_bf16 v[100:103], v[156:159], v[60:63], v[100:103]
ds_read_b128 v[144:147], v7 offset:12288
v_mfma_f32_16x16x32_bf16 v[100:103], v[152:155], v[52:55], v[100:103]
s_waitcnt lgkmcnt(7) vmcnt(9)
v_mfma_f32_16x16x32_bf16 v[120:123], v[160:163], v[64:67], v[120:123]
s_waitcnt vmcnt(8)
ds_read_b128 v[148:151], v7 offset:13312
v_mfma_f32_16x16x32_bf16 v[124:127], v[160:163], v[68:71], v[124:127]
v_mfma_f32_16x16x32_bf16 v[72:75], v[164:167], v[64:67], v[72:75]
ds_read_b128 v[152:155], v7 offset:14336
v_mfma_f32_16x16x32_bf16 v[76:79], v[164:167], v[68:71], v[76:79]
s_waitcnt lgkmcnt(7)
v_mfma_f32_16x16x32_bf16 v[80:83], v[168:171], v[64:67], v[80:83]
ds_read_b128 v[156:159], v7 offset:15360
v_mfma_f32_16x16x32_bf16 v[84:87], v[168:171], v[68:71], v[84:87]
s_add_u32 s91, s91, 16384
s_cmp_ge_u32 s91, 163840
s_cselect_b32 s91, 0, s91
v_mfma_f32_16x16x32_bf16 v[88:91], v[172:175], v[64:67], v[88:91]
ds_read_b128 v[160:163], v8 offset:0
v_add_u32 v7, s91, v4
v_mfma_f32_16x16x32_bf16 v[92:95], v[172:175], v[68:71], v[92:95]
s_waitcnt lgkmcnt(7)
v_mfma_f32_16x16x32_bf16 v[96:99], v[176:179], v[64:67], v[96:99]
ds_read_b128 v[164:167], v8 offset:1024
v_cvt_pk_bf16_f32 v228, v120, v121
v_mfma_f32_16x16x32_bf16 v[100:103], v[176:179], v[68:71], v[100:103]
v_cvt_pk_bf16_f32 v229, v122, v123
v_mfma_f32_16x16x32_bf16 v[104:107], v[180:183], a[64:67], v[104:107]
s_waitcnt lgkmcnt(6)
ds_read_b128 v[168:171], v8 offset:2048
v_cvt_pk_bf16_f32 v230, v124, v125
v_mfma_f32_16x16x32_bf16 v[104:107], v[184:187], a[72:75], v[104:107]
v_cvt_pk_bf16_f32 v231, v126, v127
v_mfma_f32_16x16x32_bf16 v[108:111], v[184:187], a[76:79], v[108:111]
buffer_store_dwordx4 v[228:231], v4, s[24:27], s55 offen offset:0 sc1
v_mfma_f32_16x16x32_bf16 v[108:111], v[180:183], a[68:71], v[108:111]
ds_read_b128 v[172:175], v8 offset:3072
v_cvt_pk_bf16_f32 v72, v72, v73
v_mfma_f32_16x16x32_bf16 v[112:115], v[188:191], a[64:67], v[112:115]
s_waitcnt lgkmcnt(6)
ds_read_b128 v[176:179], v8 offset:4096
v_cvt_pk_bf16_f32 v73, v74, v75
v_mfma_f32_16x16x32_bf16 v[112:115], v[144:147], a[72:75], v[112:115]
v_cvt_pk_bf16_f32 v74, v80, v81
v_mfma_f32_16x16x32_bf16 v[116:119], v[144:147], a[76:79], v[116:119]
ds_read_b128 v[180:183], v8 offset:5120
v_cvt_pk_bf16_f32 v75, v82, v83
v_mfma_f32_16x16x32_bf16 v[116:119], v[188:191], a[68:71], v[116:119]
buffer_store_dwordx4 v[72:75], v4, s[24:27], s52 offen offset:0 sc1
v_mfma_f32_16x16x32_bf16 v[104:107], v[148:151], a[80:83], v[104:107]
s_waitcnt lgkmcnt(6)
ds_read_b128 v[184:187], v8 offset:6144
v_cvt_pk_bf16_f32 v76, v76, v77
v_mfma_f32_16x16x32_bf16 v[104:107], v[152:155], a[88:91], v[104:107]
v_cvt_pk_bf16_f32 v77, v78, v79
v_mfma_f32_16x16x32_bf16 v[108:111], v[152:155], a[92:95], v[108:111]
ds_read_b128 v[188:191], v8 offset:7168
v_cvt_pk_bf16_f32 v78, v84, v85
v_mfma_f32_16x16x32_bf16 v[108:111], v[148:151], a[84:87], v[108:111]
s_waitcnt lgkmcnt(6)
v_cvt_pk_bf16_f32 v79, v86, v87
v_mfma_f32_16x16x32_bf16 v[112:115], v[156:159], a[80:83], v[112:115]
buffer_store_dwordx4 v[76:79], v4, s[24:27], s52 offen offset:1024 sc1
v_mfma_f32_16x16x32_bf16 v[112:115], v[160:163], a[88:91], v[112:115]
ds_read_b128 v[144:147], v8 offset:8192
v_cvt_pk_bf16_f32 v88, v88, v89
v_mfma_f32_16x16x32_bf16 v[116:119], v[160:163], a[92:95], v[116:119]
ds_read_b128 v[148:151], v8 offset:9216
v_cvt_pk_bf16_f32 v89, v90, v91
v_mfma_f32_16x16x32_bf16 v[116:119], v[156:159], a[84:87], v[116:119]
v_cvt_pk_bf16_f32 v90, v96, v97
v_mfma_f32_16x16x32_bf16 v[104:107], v[164:167], a[192:195], v[104:107]
s_waitcnt lgkmcnt(6)
ds_read_b128 v[152:155], v8 offset:10240
v_cvt_pk_bf16_f32 v91, v98, v99
v_mfma_f32_16x16x32_bf16 v[104:107], v[168:171], a[200:203], v[104:107]
buffer_store_dwordx4 v[88:91], v4, s[24:27], s53 offen offset:0 sc1
v_mfma_f32_16x16x32_bf16 v[108:111], v[168:171], a[204:207], v[108:111]
ds_read_b128 v[156:159], v8 offset:11264
v_cvt_pk_bf16_f32 v92, v92, v93
v_mfma_f32_16x16x32_bf16 v[108:111], v[164:167], a[196:199], v[108:111]
v_cvt_pk_bf16_f32 v93, v94, v95
v_mfma_f32_16x16x32_bf16 v[112:115], v[172:175], a[192:195], v[112:115]
s_waitcnt lgkmcnt(6)
ds_read_b128 v[160:163], v8 offset:12288
v_cvt_pk_bf16_f32 v94, v100, v101
v_mfma_f32_16x16x32_bf16 v[112:115], v[176:179], a[200:203], v[112:115]
s_waitcnt lgkmcnt(5)
v_cvt_pk_bf16_f32 v95, v102, v103
v_mfma_f32_16x16x32_bf16 v[116:119], v[176:179], a[204:207], v[116:119]
buffer_store_dwordx4 v[92:95], v4, s[24:27], s53 offen offset:1024 sc1
v_mfma_f32_16x16x32_bf16 v[116:119], v[172:175], a[196:199], v[116:119]
s_mov_b32 m0, s70
s_mov_b32 s64, s68
s_add_u32 s68, s68, 16384
v_mfma_f32_16x16x32_bf16 v[104:107], v[180:183], a[208:211], v[104:107]
s_add_u32 s70, s70, 16384
s_cmp_ge_u32 s70, 163840
s_cselect_b32 s70, s80, s70
v_mfma_f32_16x16x32_bf16 v[104:107], v[184:187], a[216:219], v[104:107]
buffer_load_dwordx4 v4, s[24:27], s64 offen offset:0 sc1 lds
v_mfma_f32_16x16x32_bf16 v[108:111], v[184:187], a[220:223], v[108:111]
s_waitcnt vmcnt(6) lgkmcnt(3)
ds_read_b128 v[164:167], v8 offset:13312
v_mfma_f32_16x16x32_bf16 v[108:111], v[180:183], a[212:215], v[108:111]
s_barrier
v_mfma_f32_16x16x32_bf16 v[112:115], v[188:191], a[208:211], v[112:115]
buffer_load_dwordx4 v4, s[24:27], s64 offen offset:1024 sc1 lds
v_mfma_f32_16x16x32_bf16 v[112:115], v[144:147], a[216:219], v[112:115]
ds_read_b128 v[168:171], v8 offset:14336
v_mfma_f32_16x16x32_bf16 v[116:119], v[144:147], a[220:223], v[116:119]
ds_read_b128 v[172:175], v8 offset:15360
v_mfma_f32_16x16x32_bf16 v[116:119], v[188:191], a[212:215], v[116:119]
buffer_load_dwordx4 v4, s[24:27], s64 offen offset:2048 sc1 lds
v_mfma_f32_16x16x32_bf16 v[104:107], v[148:151], a[224:227], v[104:107]
s_waitcnt lgkmcnt(4)
s_add_u32 s91, s91, 16384
ds_read_b128 v[176:179], v7 offset:0
v_mfma_f32_16x16x32_bf16 v[104:107], v[152:155], a[232:235], v[104:107]
s_cmp_ge_u32 s91, 163840
s_cselect_b32 s91, 0, s91
ds_read_b128 v[180:183], v7 offset:1024
v_mfma_f32_16x16x32_bf16 v[108:111], v[152:155], a[236:239], v[108:111]
buffer_load_dwordx4 v4, s[24:27], s64 offen offset:3072 sc1 lds
v_mfma_f32_16x16x32_bf16 v[108:111], v[148:151], a[228:231], v[108:111]
s_mov_b32 m0, s70
s_mov_b32 s64, s68
s_add_u32 s68, s68, 16384
v_mfma_f32_16x16x32_bf16 v[112:115], v[156:159], a[224:227], v[112:115]
s_waitcnt lgkmcnt(4)
ds_read_b128 v[184:187], v7 offset:2048
v_add_u32 v8, s91, v4
v_mfma_f32_16x16x32_bf16 v[112:115], v[160:163], a[232:235], v[112:115]
s_add_u32 s70, s70, 16384
s_cmp_ge_u32 s70, 163840
s_cselect_b32 s70, s80, s70
v_mfma_f32_16x16x32_bf16 v[116:119], v[160:163], a[236:239], v[116:119]
buffer_load_dwordx4 v4, s[24:27], s64 offen offset:0 sc1 lds
v_mfma_f32_16x16x32_bf16 v[116:119], v[156:159], a[228:231], v[116:119]
ds_read_b128 v[188:191], v7 offset:3072
v_mfma_f32_16x16x32_bf16 v[104:107], v[164:167], a[240:243], v[104:107]
s_waitcnt lgkmcnt(4)
ds_read_b128 v[144:147], v7 offset:4096
v_mfma_f32_16x16x32_bf16 v[104:107], v[168:171], a[248:251], v[104:107]
buffer_load_dwordx4 v4, s[24:27], s64 offen offset:1024 sc1 lds
v_mfma_f32_16x16x32_bf16 v[108:111], v[168:171], a[252:255], v[108:111]
ds_read_b128 v[148:151], v7 offset:5120
v_mfma_f32_16x16x32_bf16 v[108:111], v[164:167], a[244:247], v[108:111]
s_waitcnt lgkmcnt(4)
ds_read_b128 v[152:155], v7 offset:6144
v_mfma_f32_16x16x32_bf16 v[112:115], v[172:175], a[240:243], v[112:115]
buffer_load_dwordx4 v4, s[24:27], s64 offen offset:2048 sc1 lds
v_mfma_f32_16x16x32_bf16 v[112:115], v[176:179], a[248:251], v[112:115]
ds_read_b128 v[156:159], v7 offset:7168
v_mfma_f32_16x16x32_bf16 v[116:119], v[176:179], a[252:255], v[116:119]
ds_read_b128 v[160:163], v7 offset:8192
v_mfma_f32_16x16x32_bf16 v[116:119], v[172:175], a[244:247], v[116:119]
buffer_load_dwordx4 v4, s[24:27], s64 offen offset:3072 sc1 lds
v_mfma_f32_16x16x32_bf16 v[104:107], v[180:183], a[96:99], v[104:107]
s_waitcnt lgkmcnt(5)
ds_read_b128 v[164:167], v7 offset:9216
v_mfma_f32_16x16x32_bf16 v[104:107], v[184:187], a[104:107], v[104:107]
ds_read_b128 v[168:171], v7 offset:10240
v_mfma_f32_16x16x32_bf16 v[108:111], v[184:187], a[108:111], v[108:111]
ds_read_b128 v[172:175], v7 offset:11264
v_mfma_f32_16x16x32_bf16 v[108:111], v[180:183], a[100:103], v[108:111]
v_mfma_f32_16x16x32_bf16 v[112:115], v[188:191], a[96:99], v[112:115]
s_waitcnt lgkmcnt(6)
ds_read_b128 v[176:179], v7 offset:12288
v_mfma_f32_16x16x32_bf16 v[112:115], v[144:147], a[104:107], v[112:115]
v_mfma_f32_16x16x32_bf16 v[116:119], v[144:147], a[108:111], v[116:119]
ds_read_b128 v[180:183], v7 offset:13312
v_mfma_f32_16x16x32_bf16 v[116:119], v[188:191], a[100:103], v[116:119]
v_mfma_f32_16x16x32_bf16 v[104:107], v[148:151], a[112:115], v[104:107]
s_waitcnt lgkmcnt(6)
ds_read_b128 v[184:187], v7 offset:14336
v_mfma_f32_16x16x32_bf16 v[104:107], v[152:155], a[120:123], v[104:107]
v_mfma_f32_16x16x32_bf16 v[108:111], v[152:155], a[124:127], v[108:111]
ds_read_b128 v[188:191], v7 offset:15360
v_mfma_f32_16x16x32_bf16 v[108:111], v[148:151], a[116:119], v[108:111]
s_add_u32 s91, s91, 16384
s_cmp_ge_u32 s91, 163840
s_cselect_b32 s91, 0, s91
v_mfma_f32_16x16x32_bf16 v[112:115], v[156:159], a[112:115], v[112:115]
s_waitcnt lgkmcnt(6)
ds_read_b128 v[144:147], v8 offset:0
v_add_u32 v7, s91, v4
v_mfma_f32_16x16x32_bf16 v[112:115], v[160:163], a[120:123], v[112:115]
v_mfma_f32_16x16x32_bf16 v[116:119], v[160:163], a[124:127], v[116:119]
ds_read_b128 v[148:151], v8 offset:1024
v_mfma_f32_16x16x32_bf16 v[116:119], v[156:159], a[116:119], v[116:119]
s_waitcnt lgkmcnt(6)
v_mfma_f32_16x16x32_bf16 v[104:107], v[164:167], a[128:131], v[104:107]
s_mov_b32 m0, s70
s_mov_b32 s64, s68
s_add_u32 s68, s68, 16384
v_mfma_f32_16x16x32_bf16 v[104:107], v[168:171], a[136:139], v[104:107]
ds_read_b128 v[152:155], v8 offset:2048
v_mfma_f32_16x16x32_bf16 v[108:111], v[168:171], a[140:143], v[108:111]
s_add_u32 s70, s70, 16384
s_cmp_ge_u32 s70, 163840
s_cselect_b32 s70, s80, s70
v_mfma_f32_16x16x32_bf16 v[108:111], v[164:167], a[132:135], v[108:111]
buffer_load_dwordx4 v4, s[24:27], s64 offen offset:0 sc1 lds
v_mfma_f32_16x16x32_bf16 v[112:115], v[172:175], a[128:131], v[112:115]
s_waitcnt lgkmcnt(5)
ds_read_b128 v[156:159], v8 offset:3072
v_mfma_f32_16x16x32_bf16 v[112:115], v[176:179], a[136:139], v[112:115]
ds_read_b128 v[160:163], v8 offset:4096
v_mfma_f32_16x16x32_bf16 v[116:119], v[176:179], a[140:143], v[116:119]
buffer_load_dwordx4 v4, s[24:27], s64 offen offset:1024 sc1 lds
v_mfma_f32_16x16x32_bf16 v[116:119], v[172:175], a[132:135], v[116:119]
ds_read_b128 v[164:167], v8 offset:5120
v_mfma_f32_16x16x32_bf16 v[104:107], v[180:183], a[144:147], v[104:107]
s_waitcnt vmcnt(10) lgkmcnt(6)
ds_read_b128 v[168:171], v8 offset:6144
v_mfma_f32_16x16x32_bf16 v[104:107], v[184:187], a[152:155], v[104:107]
buffer_atomic_add v1, v0, s[24:27], s73 offen offset:0 sc1
v_mfma_f32_16x16x32_bf16 v[108:111], v[184:187], a[156:159], v[108:111]
buffer_load_dwordx4 v4, s[24:27], s64 offen offset:2048 sc1 lds
v_mfma_f32_16x16x32_bf16 v[108:111], v[180:183], a[148:151], v[108:111]
ds_read_b128 v[172:175], v8 offset:7168
v_mfma_f32_16x16x32_bf16 v[112:115], v[188:191], a[144:147], v[112:115]
s_waitcnt lgkmcnt(6)
ds_read_b128 v[176:179], v8 offset:8192
v_mfma_f32_16x16x32_bf16 v[112:115], v[144:147], a[152:155], v[112:115]
buffer_load_dwordx4 v4, s[24:27], s64 offen offset:3072 sc1 lds
v_mfma_f32_16x16x32_bf16 v[116:119], v[144:147], a[156:159], v[116:119]
s_mov_b32 m0, s70
s_mov_b32 s64, s68
s_add_u32 s68, s68, 16384
v_mfma_f32_16x16x32_bf16 v[116:119], v[188:191], a[148:151], v[116:119]
s_waitcnt lgkmcnt(5)
ds_read_b128 v[180:183], v8 offset:9216
v_mfma_f32_16x16x32_bf16 v[104:107], v[148:151], a[160:163], v[104:107]
s_add_u32 s70, s70, 16384
s_cmp_ge_u32 s70, 163840
s_cselect_b32 s70, s80, s70
v_mfma_f32_16x16x32_bf16 v[104:107], v[152:155], a[168:171], v[104:107]
buffer_load_dwordx4 v4, s[24:27], s64 offen offset:0 sc1 lds
v_mfma_f32_16x16x32_bf16 v[108:111], v[152:155], a[172:175], v[108:111]
ds_read_b128 v[184:187], v8 offset:10240
v_mfma_f32_16x16x32_bf16 v[108:111], v[148:151], a[164:167], v[108:111]
s_waitcnt lgkmcnt(5)
ds_read_b128 v[188:191], v8 offset:11264
v_mfma_f32_16x16x32_bf16 v[112:115], v[156:159], a[160:163], v[112:115]
buffer_load_dwordx4 v4, s[24:27], s64 offen offset:1024 sc1 lds
v_mfma_f32_16x16x32_bf16 v[112:115], v[160:163], a[168:171], v[112:115]
ds_read_b128 v[144:147], v8 offset:12288
v_mfma_f32_16x16x32_bf16 v[116:119], v[160:163], a[172:175], v[116:119]
s_add_u32 s82, s84, 3
ds_read_b128 v[148:151], v8 offset:13312
v_mfma_f32_16x16x32_bf16 v[116:119], v[156:159], a[164:167], v[116:119]
buffer_load_dwordx4 v4, s[24:27], s64 offen offset:2048 sc1 lds
v_mfma_f32_16x16x32_bf16 v[104:107], v[164:167], a[176:179], v[104:107]
s_and_b32 s82, s82, 3
s_waitcnt lgkmcnt(6)
ds_read_b128 v[152:155], v8 offset:14336
v_mfma_f32_16x16x32_bf16 v[104:107], v[168:171], a[184:187], v[104:107]
v_mfma_f32_16x16x32_bf16 v[108:111], v[168:171], a[188:191], v[108:111]
s_waitcnt vmcnt(8)
s_lshl4_add_u32 s82, s82, s73
ds_read_b128 v[156:159], v8 offset:15360
v_mfma_f32_16x16x32_bf16 v[108:111], v[164:167], a[180:183], v[108:111]
s_barrier
v_mfma_f32_16x16x32_bf16 v[112:115], v[172:175], a[176:179], v[112:115]
s_lshl4_add_u32 s75, s84, s73
s_waitcnt lgkmcnt(6)
ds_read_b128 v[160:163], v7 offset:0
v_mfma_f32_16x16x32_bf16 v[112:115], v[176:179], a[184:187], v[112:115]
buffer_load_dwordx4 v4, s[24:27], s64 offen offset:3072 sc1 lds
v_mfma_f32_16x16x32_bf16 v[116:119], v[176:179], a[188:191], v[116:119]
s_add_u32 s91, s91, 16384
ds_read_b128 v[164:167], v7 offset:1024
v_mfma_f32_16x16x32_bf16 v[116:119], v[172:175], a[180:183], v[116:119]
s_cmp_ge_u32 s91, 163840
s_cselect_b32 s91, 0, s91
v_add_u32 v8, s91, v4
v_mfma_f32_16x16x32_bf16 v[104:107], v[180:183], v[32:35], v[104:107]
s_waitcnt lgkmcnt(6)
ds_read_b128 v[168:171], v7 offset:2048
v_mfma_f32_16x16x32_bf16 v[104:107], v[184:187], v[40:43], v[104:107]
v_mfma_f32_16x16x32_bf16 v[108:111], v[184:187], v[44:47], v[108:111]
ds_read_b128 v[172:175], v7 offset:3072
v_mfma_f32_16x16x32_bf16 v[108:111], v[180:183], v[36:39], v[108:111]
v_mfma_f32_16x16x32_bf16 v[112:115], v[188:191], v[32:35], v[112:115]
s_waitcnt lgkmcnt(6)
ds_read_b128 v[176:179], v7 offset:4096
v_mfma_f32_16x16x32_bf16 v[112:115], v[144:147], v[40:43], v[112:115]
v_mfma_f32_16x16x32_bf16 v[116:119], v[144:147], v[44:47], v[116:119]
ds_read_b128 v[180:183], v7 offset:5120
v_mfma_f32_16x16x32_bf16 v[116:119], v[188:191], v[36:39], v[116:119]
v_mfma_f32_16x16x32_bf16 v[104:107], v[148:151], v[48:51], v[104:107]
s_waitcnt lgkmcnt(6)
ds_read_b128 v[184:187], v7 offset:6144
v_mfma_f32_16x16x32_bf16 v[104:107], v[152:155], v[56:59], v[104:107]
v_mfma_f32_16x16x32_bf16 v[108:111], v[152:155], v[60:63], v[108:111]
ds_read_b128 v[188:191], v7 offset:7168
v_mfma_f32_16x16x32_bf16 v[108:111], v[148:151], v[52:55], v[108:111]
v_mfma_f32_16x16x32_bf16 v[112:115], v[156:159], v[48:51], v[112:115]
s_waitcnt lgkmcnt(6)
ds_read_b128 v[144:147], v7 offset:8192
v_mfma_f32_16x16x32_bf16 v[112:115], v[160:163], v[56:59], v[112:115]
v_mfma_f32_16x16x32_bf16 v[116:119], v[160:163], v[60:63], v[116:119]
ds_read_b128 v[148:151], v7 offset:9216
v_mfma_f32_16x16x32_bf16 v[116:119], v[156:159], v[52:55], v[116:119]
v_mfma_f32_16x16x32_bf16 v[104:107], v[164:167], v[64:67], v[104:107]
ds_read_b128 v[152:155], v7 offset:10240
v_mfma_f32_16x16x32_bf16 v[108:111], v[164:167], v[68:71], v[108:111]
s_waitcnt lgkmcnt(7)
v_mfma_f32_16x16x32_bf16 v[112:115], v[168:171], v[64:67], v[112:115]
ds_read_b128 v[156:159], v7 offset:11264
v_mfma_f32_16x16x32_bf16 v[116:119], v[168:171], v[68:71], v[116:119]
v_mfma_f32_16x16x32_bf16 v[128:131], v[172:175], a[0:3], 0
s_waitcnt lgkmcnt(6)
ds_read_b128 v[160:163], v7 offset:12288
v_mfma_f32_16x16x32_bf16 v[128:131], v[176:179], a[8:11], v[128:131]
v_mfma_f32_16x16x32_bf16 v[132:135], v[176:179], a[12:15], 0
ds_read_b128 v[164:167], v7 offset:13312
v_mfma_f32_16x16x32_bf16 v[132:135], v[172:175], a[4:7], v[132:135]
v_mfma_f32_16x16x32_bf16 v[136:139], v[180:183], a[0:3], 0
s_waitcnt lgkmcnt(6)
ds_read_b128 v[168:171], v7 offset:14336
v_mfma_f32_16x16x32_bf16 v[136:139], v[184:187], a[8:11], v[136:139]
v_cvt_pk_bf16_f32 v104, v104, v105
v_mfma_f32_16x16x32_bf16 v[140:143], v[184:187], a[12:15], 0
ds_read_b128 v[172:175], v7 offset:15360
v_cvt_pk_bf16_f32 v105, v106, v107
v_mfma_f32_16x16x32_bf16 v[140:143], v[180:183], a[4:7], v[140:143]
s_add_u32 s91, s91, 16384
v_cvt_pk_bf16_f32 v106, v112, v113
v_mfma_f32_16x16x32_bf16 v[128:131], v[188:191], a[16:19], v[128:131]
s_waitcnt lgkmcnt(6)
ds_read_b128 v[176:179], v8 offset:0
v_cvt_pk_bf16_f32 v107, v114, v115
v_mfma_f32_16x16x32_bf16 v[128:131], v[144:147], a[24:27], v[128:131]
buffer_store_dwordx4 v[104:107], v4, s[24:27], s54 offen offset:0 sc1
v_mfma_f32_16x16x32_bf16 v[132:135], v[144:147], a[28:31], v[132:135]
ds_read_b128 v[180:183], v8 offset:1024
v_cvt_pk_bf16_f32 v108, v108, v109
v_mfma_f32_16x16x32_bf16 v[132:135], v[188:191], a[20:23], v[132:135]
s_cmp_ge_u32 s91, 163840
s_cselect_b32 s91, 0, s91
v_cvt_pk_bf16_f32 v109, v110, v111
v_mfma_f32_16x16x32_bf16 v[136:139], v[148:151], a[16:19], v[136:139]
s_waitcnt lgkmcnt(6)
ds_read_b128 v[184:187], v8 offset:2048
v_cvt_pk_bf16_f32 v110, v116, v117
v_mfma_f32_16x16x32_bf16 v[136:139], v[152:155], a[24:27], v[136:139]
s_waitcnt lgkmcnt(5)
v_cvt_pk_bf16_f32 v111, v118, v119
v_add_u32 v7, s91, v4
v_mfma_f32_16x16x32_bf16 v[140:143], v[152:155], a[28:31], v[140:143]
buffer_store_dwordx4 v[108:111], v4, s[24:27], s54 offen offset:1024 sc1
v_mfma_f32_16x16x32_bf16 v[140:143], v[148:151], a[20:23], v[140:143]
s_mov_b32 m0, s70
s_mov_b32 s64, s68
s_add_u32 s68, s68, 16384
v_mfma_f32_16x16x32_bf16 v[128:131], v[156:159], a[32:35], v[128:131]
s_cmp_lt_u32 s3, 3
s_cselect_b32 s68, s64, 2147418112
ds_read_b128 v[188:191], v8 offset:3072
v_mfma_f32_16x16x32_bf16 v[128:131], v[160:163], a[40:43], v[128:131]
buffer_load_dwordx4 v4, s[24:27], s64 offen offset:0 sc1 lds
v_mfma_f32_16x16x32_bf16 v[132:135], v[160:163], a[44:47], v[132:135]
ds_read_b128 v[144:147], v8 offset:4096
v_mfma_f32_16x16x32_bf16 v[132:135], v[156:159], a[36:39], v[132:135]
s_waitcnt lgkmcnt(5)
ds_read_b128 v[148:151], v8 offset:5120
v_mfma_f32_16x16x32_bf16 v[136:139], v[164:167], a[32:35], v[136:139]
buffer_load_dwordx4 v4, s[24:27], s68 offen offset:1024 sc1 lds
v_mfma_f32_16x16x32_bf16 v[136:139], v[168:171], a[40:43], v[136:139]
ds_read_b128 v[152:155], v8 offset:6144
v_mfma_f32_16x16x32_bf16 v[140:143], v[168:171], a[44:47], v[140:143]
ds_read_b128 v[156:159], v8 offset:7168
v_mfma_f32_16x16x32_bf16 v[140:143], v[164:167], a[36:39], v[140:143]
buffer_load_dwordx4 v4, s[24:27], s68 offen offset:2048 sc1 lds
v_mfma_f32_16x16x32_bf16 v[128:131], v[172:175], a[48:51], v[128:131]
s_waitcnt lgkmcnt(6)
ds_read_b128 v[160:163], v8 offset:8192
v_mfma_f32_16x16x32_bf16 v[128:131], v[176:179], a[56:59], v[128:131]
v_mfma_f32_16x16x32_bf16 v[132:135], v[176:179], a[60:63], v[132:135]
buffer_load_dwordx4 v4, s[24:27], s68 offen offset:3072 sc1 lds
v_mfma_f32_16x16x32_bf16 v[132:135], v[172:175], a[52:55], v[132:135]
buffer_load_dword v12, v10, s[24:27], s73 offen sc1
v_mfma_f32_16x16x32_bf16 v[136:139], v[180:183], a[48:51], v[136:139]
s_waitcnt lgkmcnt(5)
ds_read_b128 v[164:167], v8 offset:9216
v_mfma_f32_16x16x32_bf16 v[136:139], v[184:187], a[56:59], v[136:139]
ds_read_b128 v[168:171], v8 offset:10240
v_mfma_f32_16x16x32_bf16 v[140:143], v[184:187], a[60:63], v[140:143]
ds_read_b128 v[172:175], v8 offset:11264
v_mfma_f32_16x16x32_bf16 v[140:143], v[180:183], a[52:55], v[140:143]
v_mfma_f32_16x16x32_bf16 v[128:131], v[188:191], a[64:67], v[128:131]
s_waitcnt lgkmcnt(6)
ds_read_b128 v[176:179], v8 offset:12288
v_mfma_f32_16x16x32_bf16 v[128:131], v[144:147], a[72:75], v[128:131]
v_mfma_f32_16x16x32_bf16 v[132:135], v[144:147], a[76:79], v[132:135]
ds_read_b128 v[180:183], v8 offset:13312
v_mfma_f32_16x16x32_bf16 v[132:135], v[188:191], a[68:71], v[132:135]
v_mfma_f32_16x16x32_bf16 v[136:139], v[148:151], a[64:67], v[136:139]
s_waitcnt lgkmcnt(6)
ds_read_b128 v[184:187], v8 offset:14336
v_mfma_f32_16x16x32_bf16 v[136:139], v[152:155], a[72:75], v[136:139]
v_mfma_f32_16x16x32_bf16 v[140:143], v[152:155], a[76:79], v[140:143]
s_waitcnt vmcnt(7)
ds_read_b128 v[188:191], v8 offset:15360
v_mfma_f32_16x16x32_bf16 v[140:143], v[148:151], a[68:71], v[140:143]
s_barrier
v_mfma_f32_16x16x32_bf16 v[128:131], v[156:159], a[80:83], v[128:131]
s_waitcnt lgkmcnt(6)
s_add_u32 s91, s91, 16384
ds_read_b128 v[144:147], v7 offset:0
v_mfma_f32_16x16x32_bf16 v[128:131], v[160:163], a[88:91], v[128:131]
s_cmp_ge_u32 s91, 163840
s_cselect_b32 s91, 0, s91
v_add_u32 v8, s91, v4
v_mfma_f32_16x16x32_bf16 v[132:135], v[160:163], a[92:95], v[132:135]
ds_read_b128 v[148:151], v7 offset:1024
v_mfma_f32_16x16x32_bf16 v[132:135], v[156:159], a[84:87], v[132:135]
v_mfma_f32_16x16x32_bf16 v[136:139], v[164:167], a[80:83], v[136:139]
s_waitcnt vmcnt(5) lgkmcnt(6)
ds_read_b128 v[152:155], v7 offset:2048
v_mfma_f32_16x16x32_bf16 v[136:139], v[168:171], a[88:91], v[136:139]
buffer_atomic_add v1, v0, s[24:27], s82 offen offset:16 sc1
v_mfma_f32_16x16x32_bf16 v[140:143], v[168:171], a[92:95], v[140:143]
s_and_b32 s54, s3, 1
ds_read_b128 v[156:159], v7 offset:3072
v_mfma_f32_16x16x32_bf16 v[140:143], v[164:167], a[84:87], v[140:143]
s_mul_i32 s54, s54, 18432
v_mfma_f32_16x16x32_bf16 v[128:131], v[172:175], a[192:195], v[128:131]
s_waitcnt lgkmcnt(6)
s_mul_i32 s55, s86, 288
ds_read_b128 v[160:163], v7 offset:4096
v_mfma_f32_16x16x32_bf16 v[128:131], v[176:179], a[200:203], v[128:131]
s_add_u32 s54, s54, s55
v_mfma_f32_16x16x32_bf16 v[132:135], v[176:179], a[204:207], v[132:135]
s_add_u32 s54, s54, 256
ds_read_b128 v[164:167], v7 offset:5120
v_mfma_f32_16x16x32_bf16 v[132:135], v[172:175], a[196:199], v[132:135]
s_sub_u32 s55, 63, s72
v_mfma_f32_16x16x32_bf16 v[136:139], v[180:183], a[192:195], v[136:139]
s_waitcnt lgkmcnt(6)
s_mul_i32 s55, s55, 36864
ds_read_b128 v[168:171], v7 offset:6144
v_mfma_f32_16x16x32_bf16 v[136:139], v[184:187], a[200:203], v[136:139]
s_waitcnt vmcnt(1)
s_add_u32 s55, s55, s54
v_cmp_gt_u32 vcc, 4, v12
v_mfma_f32_16x16x32_bf16 v[140:143], v[184:187], a[204:207], v[140:143]
s_mul_i32 s52, s72, 36864
ds_read_b128 v[172:175], v7 offset:7168
v_mfma_f32_16x16x32_bf16 v[140:143], v[180:183], a[196:199], v[140:143]
s_waitcnt lgkmcnt(6)
s_add_u32 s54, s54, s52
v_mfma_f32_16x16x32_bf16 v[128:131], v[188:191], a[208:211], v[128:131]
s_cmp_eq_u64 vcc, 0
s_cselect_b32 s81, s69, 2147418112
s_cselect_b32 s93, s71, 2147418112
v_mfma_f32_16x16x32_bf16 v[128:131], v[144:147], a[216:219], v[128:131]
s_lshl_b32 s53, s84, 6
ds_read_b128 v[176:179], v7 offset:8192
v_mfma_f32_16x16x32_bf16 v[132:135], v[144:147], a[220:223], v[132:135]
s_sub_u32 s53, s53, 256
ds_read_b128 v[180:183], v7 offset:9216
v_mfma_f32_16x16x32_bf16 v[132:135], v[188:191], a[212:215], v[132:135]
buffer_load_dwordx4 v[192:195], v4, s[24:27], s81 offen offset:0 sc1
v_mfma_f32_16x16x32_bf16 v[136:139], v[148:151], a[208:211], v[136:139]
s_waitcnt lgkmcnt(6)
s_add_u32 s52, s54, s53
ds_read_b128 v[184:187], v7 offset:10240
v_mfma_f32_16x16x32_bf16 v[136:139], v[152:155], a[216:219], v[136:139]
s_add_u32 s53, s55, s53
v_mfma_f32_16x16x32_bf16 v[140:143], v[152:155], a[220:223], v[140:143]
buffer_load_dwordx4 v[196:199], v4, s[24:27], s81 offen offset:1024 sc1
v_mfma_f32_16x16x32_bf16 v[140:143], v[148:151], a[212:215], v[140:143]
ds_read_b128 v[188:191], v7 offset:11264
v_mfma_f32_16x16x32_bf16 v[128:131], v[156:159], a[224:227], v[128:131]
s_waitcnt lgkmcnt(6)
ds_read_b128 v[144:147], v7 offset:12288
v_mfma_f32_16x16x32_bf16 v[128:131], v[160:163], a[232:235], v[128:131]
buffer_load_dwordx4 v[200:203], v4, s[24:27], s81 offen offset:2048 sc1
v_mfma_f32_16x16x32_bf16 v[132:135], v[160:163], a[236:239], v[132:135]
L_PAD13:
s_cbranch_execz L_MAIN
ds_read_b128 v[148:151], v7 offset:13312
v_mfma_f32_16x16x32_bf16 v[132:135], v[156:159], a[228:231], v[132:135]
s_waitcnt lgkmcnt(6)
v_mfma_f32_16x16x32_bf16 v[136:139], v[164:167], a[224:227], v[136:139]
buffer_load_dwordx4 v[204:207], v4, s[24:27], s81 offen offset:3072 sc1
v_mfma_f32_16x16x32_bf16 v[136:139], v[168:171], a[232:235], v[136:139]
ds_read_b128 v[152:155], v7 offset:14336
v_mfma_f32_16x16x32_bf16 v[140:143], v[168:171], a[236:239], v[140:143]
ds_read_b128 v[156:159], v7 offset:15360
v_mfma_f32_16x16x32_bf16 v[140:143], v[164:167], a[228:231], v[140:143]
buffer_load_dwordx4 v[208:211], v4, s[24:27], s93 offen offset:0 sc1
v_mfma_f32_16x16x32_bf16 v[128:131], v[172:175], a[240:243], v[128:131]
s_waitcnt lgkmcnt(6)
s_add_u32 s91, s91, 16384
ds_read_b128 v[160:163], v8 offset:0
v_mfma_f32_16x16x32_bf16 v[128:131], v[176:179], a[248:251], v[128:131]
s_cmp_ge_u32 s91, 163840
s_cselect_b32 s91, 0, s91
v_add_u32 v7, s91, v4
v_mfma_f32_16x16x32_bf16 v[132:135], v[176:179], a[252:255], v[132:135]
buffer_load_dwordx4 v[212:215], v4, s[24:27], s93 offen offset:1024 sc1
v_mfma_f32_16x16x32_bf16 v[132:135], v[172:175], a[244:247], v[132:135]
ds_read_b128 v[164:167], v8 offset:1024
v_mfma_f32_16x16x32_bf16 v[136:139], v[180:183], a[240:243], v[136:139]
s_waitcnt lgkmcnt(6)
ds_read_b128 v[168:171], v8 offset:2048
v_mfma_f32_16x16x32_bf16 v[136:139], v[184:187], a[248:251], v[136:139]
buffer_load_dwordx4 v[216:219], v4, s[24:27], s93 offen offset:2048 sc1
v_mfma_f32_16x16x32_bf16 v[140:143], v[184:187], a[252:255], v[140:143]
ds_read_b128 v[172:175], v8 offset:3072
v_mfma_f32_16x16x32_bf16 v[140:143], v[180:183], a[244:247], v[140:143]
v_mfma_f32_16x16x32_bf16 v[128:131], v[188:191], a[96:99], v[128:131]
s_waitcnt lgkmcnt(6)
ds_read_b128 v[176:179], v8 offset:4096
v_mfma_f32_16x16x32_bf16 v[128:131], v[144:147], a[104:107], v[128:131]
v_mfma_f32_16x16x32_bf16 v[132:135], v[144:147], a[108:111], v[132:135]
ds_read_b128 v[180:183], v8 offset:5120
v_mfma_f32_16x16x32_bf16 v[132:135], v[188:191], a[100:103], v[132:135]
v_mfma_f32_16x16x32_bf16 v[136:139], v[148:151], a[96:99], v[136:139]
s_waitcnt lgkmcnt(6)
ds_read_b128 v[184:187], v8 offset:6144
v_mfma_f32_16x16x32_bf16 v[136:139], v[152:155], a[104:107], v[136:139]
v_mfma_f32_16x16x32_bf16 v[140:143], v[152:155], a[108:111], v[140:143]
ds_read_b128 v[188:191], v8 offset:7168
v_mfma_f32_16x16x32_bf16 v[140:143], v[148:151], a[100:103], v[140:143]
v_mfma_f32_16x16x32_bf16 v[128:131], v[156:159], a[112:115], v[128:131]
s_waitcnt lgkmcnt(6)
ds_read_b128 v[144:147], v8 offset:8192
v_mfma_f32_16x16x32_bf16 v[128:131], v[160:163], a[120:123], v[128:131]
v_mfma_f32_16x16x32_bf16 v[132:135], v[160:163], a[124:127], v[132:135]
ds_read_b128 v[148:151], v8 offset:9216
v_mfma_f32_16x16x32_bf16 v[132:135], v[156:159], a[116:119], v[132:135]
s_waitcnt lgkmcnt(6)
v_mfma_f32_16x16x32_bf16 v[136:139], v[164:167], a[112:115], v[136:139]
buffer_load_dword v12, v10, s[24:27], s75 offen offset:16 sc1
v_mfma_f32_16x16x32_bf16 v[136:139], v[168:171], a[120:123], v[136:139]
ds_read_b128 v[152:155], v8 offset:10240
v_mfma_f32_16x16x32_bf16 v[140:143], v[168:171], a[124:127], v[140:143]
ds_read_b128 v[156:159], v8 offset:11264
v_mfma_f32_16x16x32_bf16 v[140:143], v[164:167], a[116:119], v[140:143]
v_mfma_f32_16x16x32_bf16 v[128:131], v[172:175], a[128:131], v[128:131]
s_waitcnt lgkmcnt(6)
ds_read_b128 v[160:163], v8 offset:12288
v_mfma_f32_16x16x32_bf16 v[128:131], v[176:179], a[136:139], v[128:131]
v_mfma_f32_16x16x32_bf16 v[132:135], v[176:179], a[140:143], v[132:135]
ds_read_b128 v[164:167], v8 offset:13312
v_mfma_f32_16x16x32_bf16 v[132:135], v[172:175], a[132:135], v[132:135]
v_mfma_f32_16x16x32_bf16 v[136:139], v[180:183], a[128:131], v[136:139]
s_waitcnt lgkmcnt(6)
ds_read_b128 v[168:171], v8 offset:14336
v_mfma_f32_16x16x32_bf16 v[136:139], v[184:187], a[136:139], v[136:139]
v_mfma_f32_16x16x32_bf16 v[140:143], v[184:187], a[140:143], v[140:143]
s_waitcnt vmcnt(10)
ds_read_b128 v[172:175], v8 offset:15360
v_mfma_f32_16x16x32_bf16 v[140:143], v[180:183], a[132:135], v[140:143]
s_barrier
v_mfma_f32_16x16x32_bf16 v[128:131], v[188:191], a[144:147], v[128:131]
s_waitcnt lgkmcnt(6)
ds_read_b128 v[176:179], v7 offset:0
v_mfma_f32_16x16x32_bf16 v[128:131], v[144:147], a[152:155], v[128:131]
v_mfma_f32_16x16x32_bf16 v[132:135], v[144:147], a[156:159], v[132:135]
ds_read_b128 v[180:183], v7 offset:1024
v_mfma_f32_16x16x32_bf16 v[132:135], v[188:191], a[148:151], v[132:135]
v_mfma_f32_16x16x32_bf16 v[136:139], v[148:151], a[144:147], v[136:139]
s_waitcnt lgkmcnt(6)
ds_read_b128 v[184:187], v7 offset:2048
v_mfma_f32_16x16x32_bf16 v[136:139], v[152:155], a[152:155], v[136:139]
v_mfma_f32_16x16x32_bf16 v[140:143], v[152:155], a[156:159], v[140:143]
ds_read_b128 v[188:191], v7 offset:3072
v_mfma_f32_16x16x32_bf16 v[140:143], v[148:151], a[148:151], v[140:143]
v_mfma_f32_16x16x32_bf16 v[128:131], v[156:159], a[160:163], v[128:131]
s_waitcnt lgkmcnt(6)
ds_read_b128 v[144:147], v7 offset:4096
v_mfma_f32_16x16x32_bf16 v[128:131], v[160:163], a[168:171], v[128:131]
v_mfma_f32_16x16x32_bf16 v[132:135], v[160:163], a[172:175], v[132:135]
ds_read_b128 v[148:151], v7 offset:5120
v_mfma_f32_16x16x32_bf16 v[132:135], v[156:159], a[164:167], v[132:135]
v_mfma_f32_16x16x32_bf16 v[136:139], v[164:167], a[160:163], v[136:139]
s_waitcnt lgkmcnt(6)
ds_read_b128 v[152:155], v7 offset:6144
v_mfma_f32_16x16x32_bf16 v[136:139], v[168:171], a[168:171], v[136:139]
v_mfma_f32_16x16x32_bf16 v[140:143], v[168:171], a[172:175], v[140:143]
s_waitcnt vmcnt(0)
ds_read_b128 v[156:159], v7 offset:7168
v_cmp_gt_u32 vcc, 1, v12
v_mfma_f32_16x16x32_bf16 v[140:143], v[164:167], a[164:167], v[140:143]
v_lshlrev_b32 v72, 16, v192
v_and_b32 v73, v13, v192
v_mfma_f32_16x16x32_bf16 v[128:131], v[172:175], a[176:179], v[128:131]
s_waitcnt lgkmcnt(6)
ds_read_b128 v[160:163], v7 offset:8192
v_lshlrev_b32 v74, 16, v193
v_mfma_f32_16x16x32_bf16 v[128:131], v[176:179], a[184:187], v[128:131]
s_cmp_eq_u64 vcc, 0
s_cselect_b32 s77, s83, 2147418112
v_and_b32 v75, v13, v193
v_mfma_f32_16x16x32_bf16 v[132:135], v[176:179], a[188:191], v[132:135]
buffer_load_dwordx4 v[220:223], v4, s[24:27], s77 offen offset:0 sc1
v_mfma_f32_16x16x32_bf16 v[132:135], v[172:175], a[180:183], v[132:135]
s_waitcnt lgkmcnt(5)
ds_read_b128 v[164:167], v7 offset:9216
v_lshlrev_b32 v80, 16, v194
v_mfma_f32_16x16x32_bf16 v[136:139], v[180:183], a[176:179], v[136:139]
buffer_load_dwordx4 v[224:227], v4, s[24:27], s77 offen offset:1024 sc1
v_mfma_f32_16x16x32_bf16 v[136:139], v[184:187], a[184:187], v[136:139]
ds_read_b128 v[168:171], v7 offset:10240
v_and_b32 v81, v13, v194
v_mfma_f32_16x16x32_bf16 v[140:143], v[184:187], a[188:191], v[140:143]
ds_read_b128 v[172:175], v7 offset:11264
v_lshlrev_b32 v82, 16, v195
v_mfma_f32_16x16x32_bf16 v[140:143], v[180:183], a[180:183], v[140:143]
s_waitcnt lgkmcnt(6)
v_and_b32 v83, v13, v195
v_lshlrev_b32 v76, 16, v196
v_mfma_f32_16x16x32_bf16 v[128:131], v[188:191], v[32:35], v[128:131]
buffer_load_dword v11, v10, s[24:27], s73 offen sc1
v_mfma_f32_16x16x32_bf16 v[128:131], v[144:147], v[40:43], v[128:131]
ds_read_b128 v[176:179], v7 offset:12288
v_and_b32 v77, v13, v196
v_mfma_f32_16x16x32_bf16 v[132:135], v[144:147], v[44:47], v[132:135]
buffer_load_dword v12, v10, s[24:27], s75 offen offset:16 sc1
v_mfma_f32_16x16x32_bf16 v[132:135], v[188:191], v[36:39], v[132:135]
v_lshlrev_b32 v78, 16, v197
v_and_b32 v79, v13, v197
v_mfma_f32_16x16x32_bf16 v[136:139], v[148:151], v[32:35], v[136:139]
s_waitcnt lgkmcnt(5)
v_lshlrev_b32 v84, 16, v198
v_and_b32 v85, v13, v198
v_mfma_f32_16x16x32_bf16 v[136:139], v[152:155], v[40:43], v[136:139]
v_lshlrev_b32 v86, 16, v199
v_and_b32 v87, v13, v199
v_mfma_f32_16x16x32_bf16 v[140:143], v[152:155], v[44:47], v[140:143]
v_lshlrev_b32 v88, 16, v200
v_and_b32 v89, v13, v200
v_mfma_f32_16x16x32_bf16 v[140:143], v[148:151], v[36:39], v[140:143]
v_lshlrev_b32 v90, 16, v201
v_and_b32 v91, v13, v201
v_mfma_f32_16x16x32_bf16 v[128:131], v[156:159], v[48:51], v[128:131]
s_waitcnt lgkmcnt(3)
v_lshlrev_b32 v96, 16, v202
v_and_b32 v97, v13, v202
v_mfma_f32_16x16x32_bf16 v[128:131], v[160:163], v[56:59], v[128:131]
v_lshlrev_b32 v98, 16, v203
v_and_b32 v99, v13, v203
v_mfma_f32_16x16x32_bf16 v[132:135], v[160:163], v[60:63], v[132:135]
v_lshlrev_b32 v92, 16, v204
v_and_b32 v93, v13, v204
v_mfma_f32_16x16x32_bf16 v[132:135], v[156:159], v[52:55], v[132:135]
v_lshlrev_b32 v94, 16, v205
v_and_b32 v95, v13, v205
v_mfma_f32_16x16x32_bf16 v[136:139], v[164:167], v[48:51], v[136:139]
s_waitcnt lgkmcnt(1)
v_lshlrev_b32 v100, 16, v206
v_and_b32 v101, v13, v206
v_mfma_f32_16x16x32_bf16 v[136:139], v[168:171], v[56:59], v[136:139]
v_lshlrev_b32 v102, 16, v207
v_and_b32 v103, v13, v207
v_mfma_f32_16x16x32_bf16 v[140:143], v[168:171], v[60:63], v[140:143]
v_mfma_f32_16x16x32_bf16 v[140:143], v[164:167], v[52:55], v[140:143]
v_mfma_f32_16x16x32_bf16 v[128:131], v[172:175], v[64:67], v[128:131]
v_mfma_f32_16x16x32_bf16 v[132:135], v[172:175], v[68:71], v[132:135]
s_waitcnt lgkmcnt(0)
v_mfma_f32_16x16x32_bf16 v[136:139], v[176:179], v[64:67], v[136:139]
v_mfma_f32_16x16x32_bf16 v[140:143], v[176:179], v[68:71], v[140:143]
s_max_u32 s92, s81, s77
s_cmp_lt_u32 s92, 2147418112
s_cbranch_scc1 L_P1
s_mov_b32 s92, 0
s_branch L_S1
L_S0:
buffer_load_dword v11, v10, s[24:27], s73 offen sc1
buffer_load_dword v12, v10, s[24:27], s75 offen offset:16 sc1
L_S1:
s_add_u32 s92, s92, 1
s_waitcnt vmcnt(0)
v_lshrrev_b32 v11, 2, v11
v_min_u32 v11, v11, v12
v_cmp_gt_u32 vcc, 1, v11
s_cmp_gt_u32 s92, 1048576
s_cbranch_scc1 L_S2
s_nop 2
s_cbranch_vccnz L_S0
L_S2:
buffer_load_dwordx4 v[220:223], v4, s[24:27], s83 offen offset:0 sc1
buffer_load_dwordx4 v[224:227], v4, s[24:27], s83 offen offset:1024 sc1
s_cmp_eq_u32 s81, s69
s_cbranch_scc1 L_P1
buffer_load_dwordx4 v[192:195], v4, s[24:27], s69 offen offset:0 sc1
buffer_load_dwordx4 v[196:199], v4, s[24:27], s69 offen offset:1024 sc1
buffer_load_dwordx4 v[200:203], v4, s[24:27], s69 offen offset:2048 sc1
buffer_load_dwordx4 v[204:207], v4, s[24:27], s69 offen offset:3072 sc1
buffer_load_dwordx4 v[208:211], v4, s[24:27], s71 offen offset:0 sc1
buffer_load_dwordx4 v[212:215], v4, s[24:27], s71 offen offset:1024 sc1
buffer_load_dwordx4 v[216:219], v4, s[24:27], s71 offen offset:2048 sc1
s_waitcnt vmcnt(3)
v_lshlrev_b32 v72, 16, v192
v_and_b32 v73, v13, v192
v_lshlrev_b32 v74, 16, v193
v_and_b32 v75, v13, v193
v_lshlrev_b32 v80, 16, v194
v_and_b32 v81, v13, v194
v_lshlrev_b32 v82, 16, v195
v_and_b32 v83, v13, v195
v_lshlrev_b32 v76, 16, v196
v_and_b32 v77, v13, v196
v_lshlrev_b32 v78, 16, v197
v_and_b32 v79, v13, v197
v_lshlrev_b32 v84, 16, v198
v_and_b32 v85, v13, v198
v_lshlrev_b32 v86, 16, v199
v_and_b32 v87, v13, v199
v_lshlrev_b32 v88, 16, v200
v_and_b32 v89, v13, v200
v_lshlrev_b32 v90, 16, v201
v_and_b32 v91, v13, v201
v_lshlrev_b32 v96, 16, v202
v_and_b32 v97, v13, v202
v_lshlrev_b32 v98, 16, v203
v_and_b32 v99, v13, v203
v_lshlrev_b32 v92, 16, v204
v_and_b32 v93, v13, v204
v_lshlrev_b32 v94, 16, v205
v_and_b32 v95, v13, v205
v_lshlrev_b32 v100, 16, v206
v_and_b32 v101, v13, v206
v_lshlrev_b32 v102, 16, v207
v_and_b32 v103, v13, v207
s_waitcnt vmcnt(0)
L_P1:
s_nop 1
v_pk_add_f32 v[72:73], v[72:73], v[88:89]
v_pk_add_f32 v[74:75], v[74:75], v[90:91]
v_pk_add_f32 v[76:77], v[76:77], v[92:93]
v_pk_add_f32 v[78:79], v[78:79], v[94:95]
v_pk_add_f32 v[80:81], v[80:81], v[96:97]
v_pk_add_f32 v[82:83], v[82:83], v[98:99]
v_pk_add_f32 v[84:85], v[84:85], v[100:101]
v_pk_add_f32 v[86:87], v[86:87], v[102:103]
v_pk_add_f32 v[128:129], v[128:129], v[72:73]
v_pk_add_f32 v[130:131], v[130:131], v[74:75]
v_pk_add_f32 v[132:133], v[132:133], v[76:77]
v_pk_add_f32 v[134:135], v[134:135], v[78:79]
v_pk_add_f32 v[136:137], v[136:137], v[80:81]
v_pk_add_f32 v[138:139], v[138:139], v[82:83]
v_pk_add_f32 v[140:141], v[140:141], v[84:85]
v_pk_add_f32 v[142:143], v[142:143], v[86:87]
s_cmp_lg_u32 s3, s84
s_cbranch_scc1 L_NO9
v_lshlrev_b32 v16, 16, v208
v_and_b32 v17, v13, v208
v_lshlrev_b32 v18, 16, v209
v_and_b32 v19, v13, v209
v_lshlrev_b32 v20, 16, v210
v_and_b32 v21, v13, v210
v_lshlrev_b32 v22, 16, v211
v_and_b32 v23, v13, v211
v_pk_add_f32 v[120:121], v[120:121], v[16:17]
v_pk_add_f32 v[122:123], v[122:123], v[18:19]
v_pk_add_f32 v[124:125], v[124:125], v[20:21]
v_pk_add_f32 v[126:127], v[126:127], v[22:23]
v_lshlrev_b32 v16, 16, v212
v_and_b32 v17, v13, v212
v_lshlrev_b32 v18, 16, v213
v_and_b32 v19, v13, v213
v_lshlrev_b32 v20, 16, v214
v_and_b32 v21, v13, v214
v_lshlrev_b32 v22, 16, v215
v_and_b32 v23, v13, v215
v_pk_add_f32 v[120:121], v[120:121], v[16:17]
v_pk_add_f32 v[122:123], v[122:123], v[18:19]
v_pk_add_f32 v[124:125], v[124:125], v[20:21]
v_pk_add_f32 v[126:127], v[126:127], v[22:23]
v_lshlrev_b32 v16, 16, v216
v_and_b32 v17, v13, v216
v_lshlrev_b32 v18, 16, v217
v_and_b32 v19, v13, v217
v_lshlrev_b32 v20, 16, v218
v_and_b32 v21, v13, v218
v_lshlrev_b32 v22, 16, v219
v_and_b32 v23, v13, v219
v_pk_add_f32 v[120:121], v[120:121], v[16:17]
v_pk_add_f32 v[122:123], v[122:123], v[18:19]
v_pk_add_f32 v[124:125], v[124:125], v[20:21]
v_pk_add_f32 v[126:127], v[126:127], v[22:23]
v_cvt_pk_bf16_f32 v228, v120, v121
v_cvt_pk_bf16_f32 v229, v122, v123
v_cvt_pk_bf16_f32 v230, v124, v125
v_cvt_pk_bf16_f32 v231, v126, v127
s_waitcnt vmcnt(0)
buffer_store_dwordx2 v[228:229], v6, s[44:47], s54 offen sc1
buffer_store_dwordx2 v[230:231], v6, s[44:47], s55 offen sc1
s_branch L_9D
L_NO9:
s_waitcnt vmcnt(0)
L_9D:
v_lshlrev_b32 v16, 16, v220
v_and_b32 v17, v13, v220
v_lshlrev_b32 v18, 16, v221
v_and_b32 v19, v13, v221
v_lshlrev_b32 v20, 16, v222
v_and_b32 v21, v13, v222
v_lshlrev_b32 v22, 16, v223
v_and_b32 v23, v13, v223
v_pk_add_f32 v[128:129], v[128:129], v[16:17]
v_pk_add_f32 v[130:131], v[130:131], v[18:19]
v_pk_add_f32 v[136:137], v[136:137], v[20:21]
v_pk_add_f32 v[138:139], v[138:139], v[22:23]
v_cvt_pk_bf16_f32 v128, v128, v129
v_cvt_pk_bf16_f32 v129, v130, v131
v_cvt_pk_bf16_f32 v130, v136, v137
v_cvt_pk_bf16_f32 v131, v138, v139
s_nop 1
v_permlane16_swap_b32 v128, v130
v_permlane16_swap_b32 v129, v131
buffer_store_dwordx4 v[128:131], v5, s[44:47], s52 offen sc1
v_lshlrev_b32 v16, 16, v224
v_and_b32 v17, v13, v224
v_lshlrev_b32 v18, 16, v225
v_and_b32 v19, v13, v225
v_lshlrev_b32 v20, 16, v226
v_and_b32 v21, v13, v226
v_lshlrev_b32 v22, 16, v227
v_and_b32 v23, v13, v227
v_pk_add_f32 v[132:133], v[132:133], v[16:17]
v_pk_add_f32 v[134:135], v[134:135], v[18:19]
v_pk_add_f32 v[140:141], v[140:141], v[20:21]
v_pk_add_f32 v[142:143], v[142:143], v[22:23]
v_cvt_pk_bf16_f32 v132, v132, v133
v_cvt_pk_bf16_f32 v133, v134, v135
v_cvt_pk_bf16_f32 v134, v140, v141
v_cvt_pk_bf16_f32 v135, v142, v143
s_nop 1
v_permlane16_swap_b32 v132, v134
v_permlane16_swap_b32 v133, v135
buffer_store_dwordx4 v[132:135], v5, s[44:47], s53 offen sc1
L_END:
s_endpgm
L_SE2:
v_accvgpr_read_b32 v180, a224
v_accvgpr_read_b32 v182, a228
v_cmp_nle_f32 vcc, v180, v7
v_cmp_nle_f32 s[96:97], v182, v7
s_nop 3
s_or_b64 vcc, vcc, s[96:97]
s_cbranch_vccnz SLOW0
SLOW0_R:
s_add_u32 s53, s77, 180224
buffer_load_dwordx4 a[112:115], v4, s[24:27], s53 offen offset:0 sc1
v_mul_f32 v8, 0x3fb8aa3b, v8
v_mul_f32 v9, 0x3fb8aa3b, v9
v_exp_f32 v8, v8
v_exp_f32 v9, v9
s_nop 0
v_fma_f32 v180, v180, v8, v180
v_fma_f32 v182, v182, v9, v182
v_rcp_f32 v180, v180
v_rcp_f32 v182, v182
s_add_u32 s52, s78, 4096
v_mov_b32 v181, v180
v_mov_b32 v183, v182
v_pk_mul_f32 v[36:37], v[36:37], v[180:181]
v_pk_mul_f32 v[38:39], v[38:39], v[180:181]
v_pk_mul_f32 v[32:33], v[32:33], v[180:181]
v_pk_mul_f32 v[34:35], v[34:35], v[180:181]
v_cvt_pk_bf16_f32 v36, v36, v37
v_cvt_pk_bf16_f32 v37, v38, v39
v_cvt_pk_bf16_f32 v38, v32, v33
v_cvt_pk_bf16_f32 v39, v34, v35
buffer_store_dwordx4 v[36:39], v4, s[24:27], s78 offen offset:0 sc1
buffer_load_dwordx4 a[116:119], v4, s[24:27], s53 offen offset:1024 sc1
v_pk_mul_f32 v[116:117], v[116:117], v[182:183]
v_pk_mul_f32 v[118:119], v[118:119], v[182:183]
v_pk_mul_f32 v[132:133], v[132:133], v[182:183]
v_pk_mul_f32 v[134:135], v[134:135], v[182:183]
v_cvt_pk_bf16_f32 v116, v116, v117
v_cvt_pk_bf16_f32 v117, v118, v119
v_cvt_pk_bf16_f32 v118, v132, v133
v_cvt_pk_bf16_f32 v119, v134, v135
buffer_store_dwordx4 v[116:119], v4, s[24:27], s78 offen offset:1024 sc1
v_pk_mul_f32 v[196:197], v[196:197], v[180:181]
v_pk_mul_f32 v[198:199], v[198:199], v[180:181]
v_pk_mul_f32 v[204:205], v[204:205], v[180:181]
v_pk_mul_f32 v[206:207], v[206:207], v[180:181]
v_cvt_pk_bf16_f32 v196, v196, v197
v_cvt_pk_bf16_f32 v197, v198, v199
v_cvt_pk_bf16_f32 v198, v204, v205
v_cvt_pk_bf16_f32 v199, v206, v207
buffer_store_dwordx4 v[196:199], v4, s[24:27], s78 offen offset:2048 sc1
v_pk_mul_f32 v[184:185], v[184:185], v[182:183]
v_pk_mul_f32 v[186:187], v[186:187], v[182:183]
v_pk_mul_f32 v[240:241], v[240:241], v[182:183]
buffer_load_dwordx4 a[120:123], v4, s[24:27], s53 offen offset:2048 sc1
v_pk_mul_f32 v[242:243], v[242:243], v[182:183]
v_cvt_pk_bf16_f32 v184, v184, v185
v_cvt_pk_bf16_f32 v185, v186, v187
v_cvt_pk_bf16_f32 v186, v240, v241
v_cvt_pk_bf16_f32 v187, v242, v243
buffer_store_dwordx4 v[184:187], v4, s[24:27], s78 offen offset:3072 sc1
v_pk_mul_f32 v[108:109], v[108:109], v[180:181]
v_pk_mul_f32 v[110:111], v[110:111], v[180:181]
v_pk_mul_f32 v[40:41], v[40:41], v[180:181]
v_pk_mul_f32 v[42:43], v[42:43], v[180:181]
v_cvt_pk_bf16_f32 v108, v108, v109
v_cvt_pk_bf16_f32 v109, v110, v111
v_cvt_pk_bf16_f32 v110, v40, v41
v_cvt_pk_bf16_f32 v111, v42, v43
buffer_store_dwordx4 v[108:111], v4, s[24:27], s52 offen offset:0 sc1
v_pk_mul_f32 v[188:189], v[188:189], v[182:183]
v_pk_mul_f32 v[190:191], v[190:191], v[182:183]
v_pk_mul_f32 v[56:57], v[56:57], v[182:183]
v_pk_mul_f32 v[58:59], v[58:59], v[182:183]
v_cvt_pk_bf16_f32 v188, v188, v189
v_cvt_pk_bf16_f32 v189, v190, v191
buffer_load_dwordx4 a[124:127], v4, s[24:27], s53 offen offset:3072 sc1
v_cvt_pk_bf16_f32 v190, v56, v57
v_cvt_pk_bf16_f32 v191, v58, v59
buffer_store_dwordx4 v[188:191], v4, s[24:27], s52 offen offset:1024 sc1
v_pk_mul_f32 v[80:81], v[80:81], v[180:181]
v_pk_mul_f32 v[82:83], v[82:83], v[180:181]
v_pk_mul_f32 v[168:169], v[168:169], v[180:181]
v_pk_mul_f32 v[170:171], v[170:171], v[180:181]
v_cvt_pk_bf16_f32 v80, v80, v81
v_cvt_pk_bf16_f32 v81, v82, v83
v_cvt_pk_bf16_f32 v82, v168, v169
v_cvt_pk_bf16_f32 v83, v170, v171
buffer_store_dwordx4 v[80:83], v4, s[24:27], s52 offen offset:2048 sc1
v_pk_mul_f32 v[88:89], v[88:89], v[182:183]
v_pk_mul_f32 v[90:91], v[90:91], v[182:183]
v_pk_mul_f32 v[192:193], v[192:193], v[182:183]
v_pk_mul_f32 v[194:195], v[194:195], v[182:183]
v_cvt_pk_bf16_f32 v88, v88, v89
v_cvt_pk_bf16_f32 v89, v90, v91
v_cvt_pk_bf16_f32 v90, v192, v193
v_cvt_pk_bf16_f32 v91, v194, v195
buffer_store_dwordx4 v[88:91], v4, s[24:27], s52 offen offset:3072 sc1
s_branch L_LA
CK_Z:
s_mov_b32 s92, 0
CK_Z_L:
s_sleep 1
buffer_load_dword v23, v22, s[40:43], 0 offen sc1
s_add_u32 s92, s92, 1
s_waitcnt vmcnt(0)
v_cmp_gt_u32 vcc, 1, v23
s_cmp_gt_u32 s92, 1048576
s_cbranch_scc1 CK_Z_R
s_nop 3
s_cbranch_vccnz CK_Z_L
s_branch CK_Z_R
CK_WA:
s_mov_b32 s92, 0
CK_WA_L:
s_sleep 1
buffer_load_dword v30, v29, s[24:27], s89 offen sc1
s_add_u32 s92, s92, 1
s_waitcnt vmcnt(0)
v_cmp_gt_u32 vcc, 18, v30
s_cmp_gt_u32 s92, 1048576
s_cbranch_scc1 CK_WA_R
s_nop 3
s_cbranch_vccnz CK_WA_L
s_branch CK_WA_R
CK_ZA:
s_mov_b32 s92, 0
CK_ZA_L:
s_sleep 1
buffer_load_dword v30, v28, s[40:43], 0 offen sc1
s_add_u32 s92, s92, 1
s_waitcnt vmcnt(0)
v_cmp_gt_u32 vcc, 1, v30
s_cmp_gt_u32 s92, 1048576
s_cbranch_scc1 CK_ZA_R
s_nop 3
s_cbranch_vccnz CK_ZA_L
s_branch CK_ZA_R
CK_KV:
s_mov_b32 s92, 0
CK_KV_L:
s_sleep 1
buffer_load_dword v30, v29, s[24:27], s89 offen offset:4 sc1
s_add_u32 s92, s92, 1
s_waitcnt vmcnt(0)
v_cmp_gt_u32 vcc, 8, v30
s_cmp_gt_u32 s92, 1048576
s_cbranch_scc1 CK_KV_R
s_nop 3
s_cbranch_vccnz CK_KV_L
s_branch CK_KV_R
D0:
v_cndmask_b32 v96, v96, v6, s[56:57]
v_cndmask_b32 v120, v120, v6, s[56:57]
v_mov_b32 v112, v6
v_cndmask_b32 v97, v97, v6, s[58:59]
v_cndmask_b32 v121, v121, v6, s[58:59]
v_mov_b32 v113, v6
v_cndmask_b32 v98, v98, v6, s[60:61]
v_cndmask_b32 v122, v122, v6, s[60:61]
v_mov_b32 v114, v6
v_cndmask_b32 v99, v99, v6, s[62:63]
v_cndmask_b32 v123, v123, v6, s[62:63]
v_mov_b32 v115, v6
s_branch D0_R
CK_Q:
s_mov_b32 s92, 0
CK_Q_L:
s_sleep 1
buffer_load_dword v172, v173, s[24:27], 0 offen sc1
s_add_u32 s92, s92, 1
s_waitcnt vmcnt(0)
v_cmp_gt_u32 vcc, 32, v172
s_cmp_gt_u32 s92, 1048576
s_cbranch_scc1 CK_Q_R
s_nop 3
s_cbranch_vccnz CK_Q_L
s_branch CK_Q_R
CK_ZAA:
s_mov_b32 s92, 0
CK_ZAA_L:
s_sleep 1
buffer_load_dword v12, v10, s[24:27], s75 offen offset:4 sc1
s_add_u32 s92, s92, 1
s_waitcnt vmcnt(0)
v_cmp_gt_u32 vcc, 8, v12
s_cmp_gt_u32 s92, 1048576
s_cbranch_scc1 CK_ZAA_R
s_nop 3
s_cbranch_vccnz CK_ZAA_L
s_branch CK_ZAA_R
SLOW0:
v_add_u32 v20, 4096, v4
s_mov_b32 s54, 0
v_mov_b32 v16, v6
v_mov_b32 v18, v6
SLOW0_P:
s_mov_b32 s53, 0
s_mov_b32 s52, s94
SLOW0_T:
s_add_u32 s55, s52, 24576
buffer_load_dwordx4 a[192:195], v4, s[24:27], s52 offen offset:0 sc1
buffer_load_dwordx4 a[196:199], v4, s[24:27], s52 offen offset:1024 sc1
buffer_load_dwordx4 a[200:203], v4, s[24:27], s52 offen offset:2048 sc1
buffer_load_dwordx4 a[204:207], v4, s[24:27], s52 offen offset:3072 sc1
buffer_load_dwordx4 a[208:211], v20, s[24:27], s52 offen offset:0 sc1
buffer_load_dwordx4 a[212:215], v20, s[24:27], s52 offen offset:1024 sc1
buffer_load_dwordx4 a[216:219], v20, s[24:27], s52 offen offset:2048 sc1
buffer_load_dwordx4 a[220:223], v20, s[24:27], s52 offen offset:3072 sc1
buffer_load_dwordx4 a[64:67], v4, s[24:27], s55 offen offset:0 sc1
buffer_load_dwordx4 a[68:71], v4, s[24:27], s55 offen offset:1024 sc1
buffer_load_dwordx4 a[72:75], v4, s[24:27], s55 offen offset:2048 sc1
buffer_load_dwordx4 a[76:79], v4, s[24:27], s55 offen offset:3072 sc1
buffer_load_dwordx4 a[80:83], v20, s[24:27], s55 offen offset:0 sc1
buffer_load_dwordx4 a[84:87], v20, s[24:27], s55 offen offset:1024 sc1
buffer_load_dwordx4 a[88:91], v20, s[24:27], s55 offen offset:2048 sc1
buffer_load_dwordx4 a[92:95], v20, s[24:27], s55 offen offset:3072 sc1
s_waitcnt vmcnt(0)
v_mfma_f32_16x16x32_bf16 v[44:47], a[192:195], a[32:35], 0
v_mfma_f32_16x16x32_bf16 v[44:47], a[196:199], a[36:39], v[44:47]
v_mfma_f32_16x16x32_bf16 v[44:47], a[200:203], a[28:31], v[44:47]
v_mfma_f32_16x16x32_bf16 v[44:47], a[204:207], a[20:23], v[44:47]
v_mfma_f32_16x16x32_bf16 v[52:55], a[192:195], a[44:47], 0
v_mfma_f32_16x16x32_bf16 v[52:55], a[196:199], a[40:43], v[52:55]
v_mfma_f32_16x16x32_bf16 v[52:55], a[200:203], a[12:15], v[52:55]
v_mfma_f32_16x16x32_bf16 v[52:55], a[204:207], a[4:7], v[52:55]
v_mfma_f32_16x16x32_bf16 v[64:67], a[208:211], a[32:35], 0
v_mfma_f32_16x16x32_bf16 v[64:67], a[212:215], a[36:39], v[64:67]
v_mfma_f32_16x16x32_bf16 v[64:67], a[216:219], a[28:31], v[64:67]
v_mfma_f32_16x16x32_bf16 v[64:67], a[220:223], a[20:23], v[64:67]
v_mfma_f32_16x16x32_bf16 v[212:215], a[208:211], a[44:47], 0
v_mfma_f32_16x16x32_bf16 v[212:215], a[212:215], a[40:43], v[212:215]
v_mfma_f32_16x16x32_bf16 v[212:215], a[216:219], a[12:15], v[212:215]
v_mfma_f32_16x16x32_bf16 v[212:215], a[220:223], a[4:7], v[212:215]
s_nop 7
s_cmp_lg_u32 s53, s66
s_cbranch_scc1 SLOW0_U
v_cndmask_b32 v44, v44, v6, s[56:57]
v_cndmask_b32 v212, v212, v6, s[56:57]
v_mov_b32 v64, v6
v_cndmask_b32 v45, v45, v6, s[58:59]
v_cndmask_b32 v213, v213, v6, s[58:59]
v_mov_b32 v65, v6
v_cndmask_b32 v46, v46, v6, s[60:61]
v_cndmask_b32 v214, v214, v6, s[60:61]
v_mov_b32 v66, v6
v_cndmask_b32 v47, v47, v6, s[62:63]
v_cndmask_b32 v215, v215, v6, s[62:63]
v_mov_b32 v67, v6
SLOW0_U:
s_cmp_lg_u32 s54, 0
s_cbranch_scc1 SLOW0_A
v_max3_f32 v16, v16, v44, v45
v_max3_f32 v16, v16, v46, v47
v_max3_f32 v18, v18, v52, v53
v_max3_f32 v18, v18, v54, v55
v_max3_f32 v16, v16, v64, v65
v_max3_f32 v16, v16, v66, v67
v_max3_f32 v18, v18, v212, v213
v_max3_f32 v18, v18, v214, v215
s_branch SLOW0_N
SLOW0_A:
v_sub_f32 v44, v44, v16
v_sub_f32 v45, v45, v16
v_sub_f32 v46, v46, v16
v_sub_f32 v47, v47, v16
v_sub_f32 v52, v52, v18
v_sub_f32 v53, v53, v18
v_sub_f32 v54, v54, v18
v_sub_f32 v55, v55, v18
v_sub_f32 v64, v64, v16
v_sub_f32 v65, v65, v16
v_sub_f32 v66, v66, v16
v_sub_f32 v67, v67, v16
v_sub_f32 v212, v212, v18
v_sub_f32 v213, v213, v18
v_sub_f32 v214, v214, v18
v_sub_f32 v215, v215, v18
v_exp_f32 v44, v44
v_exp_f32 v45, v45
v_exp_f32 v46, v46
v_exp_f32 v47, v47
v_exp_f32 v52, v52
v_exp_f32 v53, v53
v_exp_f32 v54, v54
v_exp_f32 v55, v55
v_exp_f32 v64, v64
v_exp_f32 v65, v65
v_exp_f32 v66, v66
v_exp_f32 v67, v67
v_exp_f32 v212, v212
v_exp_f32 v213, v213
v_exp_f32 v214, v214
v_exp_f32 v215, v215
s_nop 0
v_cvt_pk_bf16_f32 v124, v44, v45
v_cvt_pk_bf16_f32 v125, v46, v47
v_cvt_pk_bf16_f32 v140, v52, v53
v_cvt_pk_bf16_f32 v141, v54, v55
v_cvt_pk_bf16_f32 v126, v64, v65
v_cvt_pk_bf16_f32 v127, v66, v67
v_cvt_pk_bf16_f32 v142, v212, v213
v_cvt_pk_bf16_f32 v143, v214, v215
s_nop 1
v_mfma_f32_16x16x32_bf16 v[36:39], a[64:67], v[124:127], v[36:39]
v_mfma_f32_16x16x32_bf16 v[116:119], a[64:67], v[140:143], v[116:119]
v_mfma_f32_16x16x32_bf16 v[132:135], a[68:71], v[140:143], v[132:135]
v_mfma_f32_16x16x32_bf16 v[32:35], a[68:71], v[124:127], v[32:35]
v_mfma_f32_16x16x32_bf16 v[196:199], a[72:75], v[124:127], v[196:199]
v_mfma_f32_16x16x32_bf16 v[184:187], a[72:75], v[140:143], v[184:187]
v_mfma_f32_16x16x32_bf16 v[240:243], a[76:79], v[140:143], v[240:243]
v_mfma_f32_16x16x32_bf16 v[204:207], a[76:79], v[124:127], v[204:207]
v_mfma_f32_16x16x32_bf16 v[108:111], a[80:83], v[124:127], v[108:111]
v_mfma_f32_16x16x32_bf16 v[188:191], a[80:83], v[140:143], v[188:191]
v_mfma_f32_16x16x32_bf16 v[56:59], a[84:87], v[140:143], v[56:59]
v_mfma_f32_16x16x32_bf16 v[40:43], a[84:87], v[124:127], v[40:43]
v_mfma_f32_16x16x32_bf16 v[80:83], a[88:91], v[124:127], v[80:83]
v_mfma_f32_16x16x32_bf16 v[88:91], a[88:91], v[140:143], v[88:91]
v_mfma_f32_16x16x32_bf16 v[192:195], a[92:95], v[140:143], v[192:195]
v_mfma_f32_16x16x32_bf16 v[168:171], a[92:95], v[124:127], v[168:171]
v_mfma_f32_16x16x32_bf16 a[224:227], a[240:243], v[124:127], a[224:227]
v_mfma_f32_16x16x32_bf16 a[228:231], a[240:243], v[140:143], a[228:231]
SLOW0_N:
s_add_u32 s52, s52, 16384
s_add_u32 s53, s53, 1
s_cmp_le_u32 s53, s66
s_cbranch_scc1 SLOW0_T
s_cmp_lg_u32 s54, 0
s_cbranch_scc1 SLOW0_E
v_mov_b32 v17, v16
v_mov_b32 v19, v18
s_nop 1
v_permlane32_swap_b32 v17, v16
v_permlane32_swap_b32 v19, v18
s_nop 1
v_max_f32 v16, v16, v17
v_max_f32 v18, v18, v19
v_mov_b32 v17, v16
v_mov_b32 v19, v18
s_nop 1
v_permlane16_swap_b32 v17, v16
v_permlane16_swap_b32 v19, v18
s_nop 1
v_max_f32 v16, v16, v17
v_max_f32 v18, v18, v19
v_mov_b32 v36, 0
v_mov_b32 v37, 0
v_mov_b32 v38, 0
v_mov_b32 v39, 0
v_mov_b32 v32, 0
v_mov_b32 v33, 0
v_mov_b32 v34, 0
v_mov_b32 v35, 0
v_mov_b32 v196, 0
v_mov_b32 v197, 0
v_mov_b32 v198, 0
v_mov_b32 v199, 0
v_mov_b32 v204, 0
v_mov_b32 v205, 0
v_mov_b32 v206, 0
v_mov_b32 v207, 0
v_mov_b32 v108, 0
v_mov_b32 v109, 0
v_mov_b32 v110, 0
v_mov_b32 v111, 0
v_mov_b32 v40, 0
v_mov_b32 v41, 0
v_mov_b32 v42, 0
v_mov_b32 v43, 0
v_mov_b32 v80, 0
v_mov_b32 v81, 0
v_mov_b32 v82, 0
v_mov_b32 v83, 0
v_mov_b32 v168, 0
v_mov_b32 v169, 0
v_mov_b32 v170, 0
v_mov_b32 v171, 0
v_mov_b32 v116, 0
v_mov_b32 v117, 0
v_mov_b32 v118, 0
v_mov_b32 v119, 0
v_mov_b32 v132, 0
v_mov_b32 v133, 0
v_mov_b32 v134, 0
v_mov_b32 v135, 0
v_mov_b32 v184, 0
v_mov_b32 v185, 0
v_mov_b32 v186, 0
v_mov_b32 v187, 0
v_mov_b32 v240, 0
v_mov_b32 v241, 0
v_mov_b32 v242, 0
v_mov_b32 v243, 0
v_mov_b32 v188, 0
v_mov_b32 v189, 0
v_mov_b32 v190, 0
v_mov_b32 v191, 0
v_mov_b32 v56, 0
v_mov_b32 v57, 0
v_mov_b32 v58, 0
v_mov_b32 v59, 0
v_mov_b32 v88, 0
v_mov_b32 v89, 0
v_mov_b32 v90, 0
v_mov_b32 v91, 0
v_mov_b32 v192, 0
v_mov_b32 v193, 0
v_mov_b32 v194, 0
v_mov_b32 v195, 0
v_accvgpr_write_b32 a224, 0
v_accvgpr_write_b32 a225, 0
v_accvgpr_write_b32 a226, 0
v_accvgpr_write_b32 a227, 0
v_accvgpr_write_b32 a228, 0
v_accvgpr_write_b32 a229, 0
v_accvgpr_write_b32 a230, 0
v_accvgpr_write_b32 a231, 0
s_mov_b32 s54, 1
s_branch SLOW0_P
SLOW0_E:
s_nop 7
v_accvgpr_read_b32 v180, a224
v_accvgpr_read_b32 v182, a228
s_branch SLOW0_R
SLOW1:
v_add_u32 v20, 4096, v4
s_mov_b32 s54, 0
v_mov_b32 v16, v6
v_mov_b32 v18, v6
SLOW1_P:
s_mov_b32 s53, 0
s_mov_b32 s52, s94
SLOW1_T:
s_add_u32 s55, s52, 24576
buffer_load_dwordx4 a[192:195], v4, s[24:27], s52 offen offset:0 sc1
buffer_load_dwordx4 a[196:199], v4, s[24:27], s52 offen offset:1024 sc1
buffer_load_dwordx4 a[200:203], v4, s[24:27], s52 offen offset:2048 sc1
buffer_load_dwordx4 a[204:207], v4, s[24:27], s52 offen offset:3072 sc1
buffer_load_dwordx4 a[208:211], v20, s[24:27], s52 offen offset:0 sc1
buffer_load_dwordx4 a[212:215], v20, s[24:27], s52 offen offset:1024 sc1
buffer_load_dwordx4 a[216:219], v20, s[24:27], s52 offen offset:2048 sc1
buffer_load_dwordx4 a[220:223], v20, s[24:27], s52 offen offset:3072 sc1
buffer_load_dwordx4 a[64:67], v4, s[24:27], s55 offen offset:0 sc1
buffer_load_dwordx4 a[68:71], v4, s[24:27], s55 offen offset:1024 sc1
buffer_load_dwordx4 a[72:75], v4, s[24:27], s55 offen offset:2048 sc1
buffer_load_dwordx4 a[76:79], v4, s[24:27], s55 offen offset:3072 sc1
buffer_load_dwordx4 a[80:83], v20, s[24:27], s55 offen offset:0 sc1
buffer_load_dwordx4 a[84:87], v20, s[24:27], s55 offen offset:1024 sc1
buffer_load_dwordx4 a[88:91], v20, s[24:27], s55 offen offset:2048 sc1
buffer_load_dwordx4 a[92:95], v20, s[24:27], s55 offen offset:3072 sc1
s_waitcnt vmcnt(0)
v_mfma_f32_16x16x32_bf16 v[44:47], a[192:195], a[48:51], 0
v_mfma_f32_16x16x32_bf16 v[44:47], a[196:199], a[52:55], v[44:47]
v_mfma_f32_16x16x32_bf16 v[44:47], a[200:203], a[0:3], v[44:47]
v_mfma_f32_16x16x32_bf16 v[44:47], a[204:207], a[8:11], v[44:47]
v_mfma_f32_16x16x32_bf16 v[52:55], a[192:195], a[60:63], 0
v_mfma_f32_16x16x32_bf16 v[52:55], a[196:199], a[56:59], v[52:55]
v_mfma_f32_16x16x32_bf16 v[52:55], a[200:203], a[16:19], v[52:55]
v_mfma_f32_16x16x32_bf16 v[52:55], a[204:207], a[24:27], v[52:55]
v_mfma_f32_16x16x32_bf16 v[64:67], a[208:211], a[48:51], 0
v_mfma_f32_16x16x32_bf16 v[64:67], a[212:215], a[52:55], v[64:67]
v_mfma_f32_16x16x32_bf16 v[64:67], a[216:219], a[0:3], v[64:67]
v_mfma_f32_16x16x32_bf16 v[64:67], a[220:223], a[8:11], v[64:67]
v_mfma_f32_16x16x32_bf16 v[212:215], a[208:211], a[60:63], 0
v_mfma_f32_16x16x32_bf16 v[212:215], a[212:215], a[56:59], v[212:215]
v_mfma_f32_16x16x32_bf16 v[212:215], a[216:219], a[16:19], v[212:215]
v_mfma_f32_16x16x32_bf16 v[212:215], a[220:223], a[24:27], v[212:215]
s_nop 7
s_cmp_lg_u32 s53, s67
s_cbranch_scc1 SLOW1_U
v_cndmask_b32 v44, v44, v6, s[56:57]
v_cndmask_b32 v212, v212, v6, s[56:57]
v_mov_b32 v64, v6
v_cndmask_b32 v45, v45, v6, s[58:59]
v_cndmask_b32 v213, v213, v6, s[58:59]
v_mov_b32 v65, v6
v_cndmask_b32 v46, v46, v6, s[60:61]
v_cndmask_b32 v214, v214, v6, s[60:61]
v_mov_b32 v66, v6
v_cndmask_b32 v47, v47, v6, s[62:63]
v_cndmask_b32 v215, v215, v6, s[62:63]
v_mov_b32 v67, v6
SLOW1_U:
s_cmp_lg_u32 s54, 0
s_cbranch_scc1 SLOW1_A
v_max3_f32 v16, v16, v44, v45
v_max3_f32 v16, v16, v46, v47
v_max3_f32 v18, v18, v52, v53
v_max3_f32 v18, v18, v54, v55
v_max3_f32 v16, v16, v64, v65
v_max3_f32 v16, v16, v66, v67
v_max3_f32 v18, v18, v212, v213
v_max3_f32 v18, v18, v214, v215
s_branch SLOW1_N
SLOW1_A:
v_sub_f32 v44, v44, v16
v_sub_f32 v45, v45, v16
v_sub_f32 v46, v46, v16
v_sub_f32 v47, v47, v16
v_sub_f32 v52, v52, v18
v_sub_f32 v53, v53, v18
v_sub_f32 v54, v54, v18
v_sub_f32 v55, v55, v18
v_sub_f32 v64, v64, v16
v_sub_f32 v65, v65, v16
v_sub_f32 v66, v66, v16
v_sub_f32 v67, v67, v16
v_sub_f32 v212, v212, v18
v_sub_f32 v213, v213, v18
v_sub_f32 v214, v214, v18
v_sub_f32 v215, v215, v18
v_exp_f32 v44, v44
v_exp_f32 v45, v45
v_exp_f32 v46, v46
v_exp_f32 v47, v47
v_exp_f32 v52, v52
v_exp_f32 v53, v53
v_exp_f32 v54, v54
v_exp_f32 v55, v55
v_exp_f32 v64, v64
v_exp_f32 v65, v65
v_exp_f32 v66, v66
v_exp_f32 v67, v67
v_exp_f32 v212, v212
v_exp_f32 v213, v213
v_exp_f32 v214, v214
v_exp_f32 v215, v215
s_nop 0
v_cvt_pk_bf16_f32 v124, v44, v45
v_cvt_pk_bf16_f32 v125, v46, v47
v_cvt_pk_bf16_f32 v140, v52, v53
v_cvt_pk_bf16_f32 v141, v54, v55
v_cvt_pk_bf16_f32 v126, v64, v65
v_cvt_pk_bf16_f32 v127, v66, v67
v_cvt_pk_bf16_f32 v142, v212, v213
v_cvt_pk_bf16_f32 v143, v214, v215
s_nop 1
v_mfma_f32_16x16x32_bf16 v[60:63], a[64:67], v[124:127], v[60:63]
v_mfma_f32_16x16x32_bf16 v[148:151], a[64:67], v[140:143], v[148:151]
v_mfma_f32_16x16x32_bf16 v[48:51], a[68:71], v[140:143], v[48:51]
v_mfma_f32_16x16x32_bf16 v[68:71], a[68:71], v[124:127], v[68:71]
v_mfma_f32_16x16x32_bf16 v[72:75], a[72:75], v[124:127], v[72:75]
v_mfma_f32_16x16x32_bf16 v[236:239], a[72:75], v[140:143], v[236:239]
v_mfma_f32_16x16x32_bf16 v[224:227], a[76:79], v[140:143], v[224:227]
v_mfma_f32_16x16x32_bf16 v[220:223], a[76:79], v[124:127], v[220:223]
v_mfma_f32_16x16x32_bf16 v[84:87], a[80:83], v[124:127], v[84:87]
v_mfma_f32_16x16x32_bf16 v[164:167], a[80:83], v[140:143], v[164:167]
v_mfma_f32_16x16x32_bf16 v[156:159], a[84:87], v[140:143], v[156:159]
v_mfma_f32_16x16x32_bf16 v[76:79], a[84:87], v[124:127], v[76:79]
v_mfma_f32_16x16x32_bf16 v[160:163], a[88:91], v[124:127], v[160:163]
v_mfma_f32_16x16x32_bf16 v[216:219], a[88:91], v[140:143], v[216:219]
v_mfma_f32_16x16x32_bf16 v[208:211], a[92:95], v[140:143], v[208:211]
v_mfma_f32_16x16x32_bf16 v[252:255], a[92:95], v[124:127], v[252:255]
v_mfma_f32_16x16x32_bf16 a[232:235], a[240:243], v[124:127], a[232:235]
v_mfma_f32_16x16x32_bf16 a[236:239], a[240:243], v[140:143], a[236:239]
SLOW1_N:
s_add_u32 s52, s52, 16384
s_add_u32 s53, s53, 1
s_cmp_le_u32 s53, s67
s_cbranch_scc1 SLOW1_T
s_cmp_lg_u32 s54, 0
s_cbranch_scc1 SLOW1_E
v_mov_b32 v17, v16
v_mov_b32 v19, v18
s_nop 1
v_permlane32_swap_b32 v17, v16
v_permlane32_swap_b32 v19, v18
s_nop 1
v_max_f32 v16, v16, v17
v_max_f32 v18, v18, v19
v_mov_b32 v17, v16
v_mov_b32 v19, v18
s_nop 1
v_permlane16_swap_b32 v17, v16
v_permlane16_swap_b32 v19, v18
s_nop 1
v_max_f32 v16, v16, v17
v_max_f32 v18, v18, v19
v_mov_b32 v60, 0
v_mov_b32 v61, 0
v_mov_b32 v62, 0
v_mov_b32 v63, 0
v_mov_b32 v68, 0
v_mov_b32 v69, 0
v_mov_b32 v70, 0
v_mov_b32 v71, 0
v_mov_b32 v72, 0
v_mov_b32 v73, 0
v_mov_b32 v74, 0
v_mov_b32 v75, 0
v_mov_b32 v220, 0
v_mov_b32 v221, 0
v_mov_b32 v222, 0
v_mov_b32 v223, 0
v_mov_b32 v84, 0
v_mov_b32 v85, 0
v_mov_b32 v86, 0
v_mov_b32 v87, 0
v_mov_b32 v76, 0
v_mov_b32 v77, 0
v_mov_b32 v78, 0
v_mov_b32 v79, 0
v_mov_b32 v160, 0
v_mov_b32 v161, 0
v_mov_b32 v162, 0
v_mov_b32 v163, 0
v_mov_b32 v252, 0
v_mov_b32 v253, 0
v_mov_b32 v254, 0
v_mov_b32 v255, 0
v_mov_b32 v148, 0
v_mov_b32 v149, 0
v_mov_b32 v150, 0
v_mov_b32 v151, 0
v_mov_b32 v48, 0
v_mov_b32 v49, 0
v_mov_b32 v50, 0
v_mov_b32 v51, 0
v_mov_b32 v236, 0
v_mov_b32 v237, 0
v_mov_b32 v238, 0
v_mov_b32 v239, 0
v_mov_b32 v224, 0
v_mov_b32 v225, 0
v_mov_b32 v226, 0
v_mov_b32 v227, 0
v_mov_b32 v164, 0
v_mov_b32 v165, 0
v_mov_b32 v166, 0
v_mov_b32 v167, 0
v_mov_b32 v156, 0
v_mov_b32 v157, 0
v_mov_b32 v158, 0
v_mov_b32 v159, 0
v_mov_b32 v216, 0
v_mov_b32 v217, 0
v_mov_b32 v218, 0
v_mov_b32 v219, 0
v_mov_b32 v208, 0
v_mov_b32 v209, 0
v_mov_b32 v210, 0
v_mov_b32 v211, 0
v_accvgpr_write_b32 a232, 0
v_accvgpr_write_b32 a233, 0
v_accvgpr_write_b32 a234, 0
v_accvgpr_write_b32 a235, 0
v_accvgpr_write_b32 a236, 0
v_accvgpr_write_b32 a237, 0
v_accvgpr_write_b32 a238, 0
v_accvgpr_write_b32 a239, 0
s_mov_b32 s54, 1
s_branch SLOW1_P
SLOW1_E:
s_nop 7
v_accvgpr_read_b32 v180, a232
v_accvgpr_read_b32 v182, a236
s_add_u32 s52, s79, 4096
v_fma_f32 v180, v180, v10, v180
v_fma_f32 v182, v182, v11, v182
v_rcp_f32 v180, v180
v_rcp_f32 v182, v182
s_nop 0
v_pk_mul_f32 v[60:61], v[60:61], v[180:181] op_sel_hi:[1,0]
v_pk_mul_f32 v[62:63], v[62:63], v[180:181] op_sel_hi:[1,0]
v_pk_mul_f32 v[68:69], v[68:69], v[180:181] op_sel_hi:[1,0]
v_pk_mul_f32 v[70:71], v[70:71], v[180:181] op_sel_hi:[1,0]
v_cvt_pk_bf16_f32 v60, v60, v61
v_cvt_pk_bf16_f32 v61, v62, v63
v_cvt_pk_bf16_f32 v62, v68, v69
v_cvt_pk_bf16_f32 v63, v70, v71
s_branch L_EP
.section .rodata,"a"
.p2align 6
.amdhsa_kernel gated_mix__sliding_local_dilated__compressed_kv_cla__prompt_kernel
  .amdhsa_next_free_vgpr 512
  .amdhsa_next_free_sgpr 102
  .amdhsa_accum_offset 256
  .amdhsa_group_segment_fixed_size 0
  .amdhsa_kernarg_size 104
  .amdhsa_user_sgpr_count 2
  .amdhsa_user_sgpr_kernarg_segment_ptr 1
  .amdhsa_system_sgpr_workgroup_id_x 1
.end_amdhsa_kernel
```

```asm
; @launch grid=(256,1,1) block=(256,1,1) lds=163840
.amdgcn_target "amdgcn-amd-amdhsa--gfx950"
.text

.globl gated_mix__sliding_local_dilated__compressed_kv_cla__prompt_kernel
.p2align 8
.type gated_mix__sliding_local_dilated__compressed_kv_cla__prompt_kernel,@function
gated_mix__sliding_local_dilated__compressed_kv_cla__prompt_kernel:
s_cmp_ge_u32 s2, 256
s_cbranch_scc1 L_END
s_load_dwordx2 s[8:9], s[0:1], 32
s_load_dwordx2 s[56:57], s[0:1], 56
s_load_dwordx2 s[16:17], s[0:1], 48
s_load_dwordx2 s[24:25], s[0:1], 96
s_load_dwordx2 s[12:13], s[0:1], 0
s_load_dwordx2 s[20:21], s[0:1], 40
s_load_dwordx2 s[28:29], s[0:1], 8
s_load_dwordx2 s[48:49], s[0:1], 16
s_load_dwordx2 s[32:33], s[0:1], 64
s_load_dwordx2 s[36:37], s[0:1], 72
s_load_dwordx2 s[40:41], s[0:1], 88
s_load_dwordx2 s[44:45], s[0:1], 80
s_getpc_b64 s[96:97]
L_PC:
s_lshr_b32 s6, s2, 3
s_lshl_b32 s98, s6, 11
s_add_u32 s98, s98, L_MAIN-L_PC
s_add_u32 s96, s96, s98
s_addc_u32 s97, s97, 0
v_lshlrev_b32 v16, 3, v0
v_mov_b32 v17, s97
v_add_co_u32 v16, vcc, s96, v16
v_lshrrev_b32 v5, 6, v0
v_and_b32 v1, 63, v0
v_addc_co_u32 v17, vcc, 0, v17, vcc
v_readfirstlane_b32 s3, v5
global_load_dwordx2 a[252:253], v[16:17], off
v_and_b32 v2, 15, v0
v_lshrrev_b32 v3, 4, v1
v_lshlrev_b32 v4, 4, v1
s_and_b32 s7, s2, 7
s_and_b32 s65, s6, 3
s_lshl2_add_u32 s4, s7, s65
s_lshr_b32 s5, s6, 2
s_lshl2_add_u32 s66, s5, s3
s_sub_u32 s67, 63, s66
v_lshrrev_b32 v16, 3, v1
v_and_b32 v17, 7, v1
v_xor_b32 v18, v17, v3
v_lshlrev_b32 v19, 10, v16
v_lshl_add_u32 v5, v18, 4, v19
v_xor_b32 v18, 4, v18
v_lshl_add_u32 v6, v18, 4, v19
v_add_u32 v6, 7168, v6
v_and_b32 v18, 1, v3
v_lshlrev_b32 v18, 1, v18
v_xor_b32 v18, v17, v18
v_lshlrev_b32 v19, 13, v16
v_lshl_add_u32 v7, v18, 4, v19
v_xor_b32 v18, 4, v18
v_lshl_add_u32 v8, v18, 4, v19
v_add_u32 v8, 64512, v8
s_add_u32 s69, s65, s5
s_and_b32 s69, s69, 1
s_mul_i32 s64, s7, 2
s_and_b32 s64, s64, 7
s_or_b32 s69, s69, s64
s_add_u32 s93, s65, s5
s_and_b32 s93, s93, 0
s_mul_i32 s64, s7, 1
s_and_b32 s64, s64, 7
s_or_b32 s93, s93, s64
s_lshl_b32 s70, s69, 7
s_lshl_b32 s75, s69, 19
s_lshr_b32 s54, s3, 1
s_and_b32 s55, s3, 1
s_lshl3_add_u32 s87, s54, s5
s_lshl_b32 s64, s55, 5
s_add_u32 s68, s87, s64
s_lshl_b32 s68, s68, 15
s_lshl_b32 s73, s3, 13
s_add_u32 s73, s73, 65536
s_lshl1_add_u32 s74, s4, s55
s_lshl_b32 s74, s74, 7
s_lshl_b32 s64, s54, 18
s_add_u32 s74, s74, s64
s_lshl_b32 s77, s3, 12
s_add_u32 s71, s68, s70
s_add_u32 s76, s74, s75
s_mov_b32 s10, 2097152
s_mov_b32 s11, 0x20000
s_mov_b32 s58, 4194304
s_mov_b32 s59, 0x20000
s_waitcnt lgkmcnt(0)
s_add_u32 m0, s73, 0
s_add_u32 s64, s71, 0
buffer_load_dwordx4 v5, s[8:11], s64 offen lds
buffer_load_dwordx4 v6, s[8:11], s64 offen offset:1024 lds
s_add_u32 m0, s73, 2048
s_add_u32 s64, s71, 16384
buffer_load_dwordx4 v5, s[8:11], s64 offen lds
buffer_load_dwordx4 v6, s[8:11], s64 offen offset:1024 lds
s_add_u32 m0, s77, 0
s_add_u32 s64, s76, 0
buffer_load_dwordx4 v7, s[56:59], s64 offen lds
buffer_load_dwordx4 v8, s[56:59], s64 offen offset:1024 lds
s_add_u32 m0, s77, 2048
s_add_u32 s64, s76, 131072
buffer_load_dwordx4 v7, s[56:59], s64 offen lds
buffer_load_dwordx4 v8, s[56:59], s64 offen offset:1024 lds
s_add_u32 m0, s73, 4096
s_add_u32 s64, s71, 524288
buffer_load_dwordx4 v5, s[8:11], s64 offen lds
buffer_load_dwordx4 v6, s[8:11], s64 offen offset:1024 lds
s_add_u32 m0, s73, 6144
s_add_u32 s64, s71, 540672
buffer_load_dwordx4 v5, s[8:11], s64 offen lds
buffer_load_dwordx4 v6, s[8:11], s64 offen offset:1024 lds
s_mov_b32 s18, 4194304
s_mov_b32 s19, 0x20000
s_lshl_b32 s65, s54, 7
s_lshl_b32 s53, s55, 12
v_lshrrev_b32 v16, 1, v2
v_xor_b32 v16, v16, v3
v_add_u32 v17, s65, v2
v_lshlrev_b32 v17, 7, v17
v_add_u32 v17, 65536, v17
v_lshl_add_u32 v9, v16, 4, v17
v_xor_b32 v10, 64, v9
v_bfe_u32 v16, v1, 2, 2
v_lshl_add_u32 v17, v3, 3, v16
v_lshlrev_b32 v17, 7, v17
v_and_b32 v18, 3, v1
v_lshl_add_u32 v17, v18, 3, v17
v_add_u32 v17, s53, v17
v_lshrrev_b32 v16, 1, v16
v_and_b32 v18, 1, v3
v_lshl_add_u32 v16, v18, 1, v16
v_xor_b32 v18, 0, v16
v_lshl_add_u32 v11, v18, 5, v17
v_xor_b32 v18, 1, v16
v_lshl_add_u32 v12, v18, 5, v17
v_xor_b32 v18, 2, v16
v_lshl_add_u32 v13, v18, 5, v17
v_xor_b32 v18, 3, v16
v_lshl_add_u32 v14, v18, 5, v17
s_add_u32 m0, s77, 16384
s_add_u32 s64, s76, 0
buffer_load_dwordx4 v7, s[16:19], s64 offen lds
buffer_load_dwordx4 v8, s[16:19], s64 offen offset:1024 lds
s_add_u32 m0, s77, 18432
s_add_u32 s64, s76, 131072
buffer_load_dwordx4 v7, s[16:19], s64 offen lds
buffer_load_dwordx4 v8, s[16:19], s64 offen offset:1024 lds
s_mov_b64 exec, 0
s_cmp_eq_u32 s3, 0
s_cbranch_scc1 L_PAD0
s_cmp_eq_u32 s3, 1
s_cbranch_scc1 L_PAD1
s_cmp_eq_u32 s3, 2
s_cbranch_scc1 L_PAD2
s_branch L_PAD3
.p2align 12
.fill 585, 4, 0xbf800000
L_MAIN:
s_mov_b64 exec, -1
s_xor_b32 s71, s70, 128
s_add_u32 s71, s68, s71
s_add_u32 m0, s73, 32768
s_add_u32 s64, s71, 0
buffer_load_dwordx4 v5, s[8:11], s64 offen lds
buffer_load_dwordx4 v6, s[8:11], s64 offen offset:1024 lds
s_add_u32 m0, s73, 34816
s_add_u32 s64, s71, 16384
buffer_load_dwordx4 v5, s[8:11], s64 offen lds
buffer_load_dwordx4 v6, s[8:11], s64 offen offset:1024 lds
s_add_u32 m0, s73, 36864
s_add_u32 s64, s71, 524288
buffer_load_dwordx4 v5, s[8:11], s64 offen lds
buffer_load_dwordx4 v6, s[8:11], s64 offen offset:1024 lds
s_add_u32 m0, s73, 38912
s_add_u32 s64, s71, 540672
buffer_load_dwordx4 v5, s[8:11], s64 offen lds
buffer_load_dwordx4 v6, s[8:11], s64 offen offset:1024 lds
s_waitcnt vmcnt(12)
s_barrier
ds_read_b128 a[64:67], v9 offset:0
ds_read_b128 a[68:71], v10 offset:0
ds_read_b64_tr_b16 a[128:129], v11 offset:0
ds_read_b64_tr_b16 a[130:131], v11 offset:512
ds_read_b64_tr_b16 a[132:133], v11 offset:8192
ds_read_b64_tr_b16 a[134:135], v11 offset:8704
ds_read_b64_tr_b16 a[136:137], v12 offset:0
ds_read_b64_tr_b16 a[138:139], v12 offset:512
ds_read_b64_tr_b16 a[140:141], v12 offset:8192
ds_read_b64_tr_b16 a[142:143], v12 offset:8704
ds_read_b64_tr_b16 a[144:145], v13 offset:0
ds_read_b64_tr_b16 a[146:147], v13 offset:512
ds_read_b64_tr_b16 a[148:149], v13 offset:8192
ds_read_b64_tr_b16 a[150:151], v13 offset:8704
ds_read_b64_tr_b16 a[152:153], v14 offset:0
ds_read_b64_tr_b16 a[154:155], v14 offset:512
ds_read_b64_tr_b16 a[156:157], v14 offset:8192
ds_read_b64_tr_b16 a[158:159], v14 offset:8704
ds_read_b128 a[72:75], v9 offset:2048
ds_read_b128 a[76:79], v10 offset:2048
ds_read_b128 a[80:83], v9 offset:4096
ds_read_b128 a[84:87], v10 offset:4096
ds_read_b128 a[88:91], v9 offset:6144
ds_read_b128 a[92:95], v10 offset:6144
s_waitcnt lgkmcnt(0)
v_mfma_f32_16x16x32_bf16 v[32:35], a[64:67], a[128:131], 0
s_waitcnt vmcnt(8)
v_mfma_f32_16x16x32_bf16 v[32:35], a[68:71], a[132:135], v[32:35]
s_barrier
v_mfma_f32_16x16x32_bf16 v[40:43], a[68:71], a[140:143], 0
s_mov_b32 s26, 268435456
s_mov_b32 s27, 0x20000
ds_read_b128 a[96:99], v9 offset:8192
v_mfma_f32_16x16x32_bf16 v[40:43], a[64:67], a[136:139], v[40:43]
s_xor_b32 s76, s75, 524288
s_add_u32 s76, s74, s76
s_mov_b32 s14, 2359296
v_mfma_f32_16x16x32_bf16 v[48:51], a[64:67], a[144:147], 0
s_add_u32 m0, s77, 32768
s_add_u32 s64, s76, 0
s_mov_b32 s15, 0x20000
v_mfma_f32_16x16x32_bf16 v[48:51], a[68:71], a[148:151], v[48:51]
buffer_load_dwordx4 v7, s[56:59], s64 offen lds
v_mfma_f32_16x16x32_bf16 v[56:59], a[68:71], a[156:159], 0
s_mov_b32 s22, 4718592
s_mov_b32 s23, 0x20000
ds_read_b128 a[100:103], v10 offset:8192
v_mfma_f32_16x16x32_bf16 v[56:59], a[64:67], a[152:155], v[56:59]
buffer_load_dwordx4 v8, s[56:59], s64 offen offset:1024 lds
v_mfma_f32_16x16x32_bf16 v[60:63], a[72:75], a[152:155], 0
s_add_u32 m0, s77, 34816
s_add_u32 s64, s76, 131072
ds_read_b128 a[104:107], v9 offset:10240
v_mfma_f32_16x16x32_bf16 v[60:63], a[76:79], a[156:159], v[60:63]
s_mov_b32 s30, 1990656
s_mov_b32 s31, 0x20000
s_mov_b32 s34, 4718592
v_mfma_f32_16x16x32_bf16 v[52:55], a[76:79], a[148:151], 0
buffer_load_dwordx4 v7, s[56:59], s64 offen lds
v_mfma_f32_16x16x32_bf16 v[52:55], a[72:75], a[144:147], v[52:55]
s_mov_b32 s35, 0x20000
ds_read_b64_tr_b16 a[160:161], v11 offset:16384
ds_read_b64_tr_b16 a[162:163], v11 offset:16896
v_mfma_f32_16x16x32_bf16 v[44:47], a[72:75], a[136:139], 0
s_mov_b32 s38, 1152
s_mov_b32 s39, 0x20000
s_mov_b32 s42, 256
v_mfma_f32_16x16x32_bf16 v[44:47], a[76:79], a[140:143], v[44:47]
buffer_load_dwordx4 v8, s[56:59], s64 offen offset:1024 lds
v_mfma_f32_16x16x32_bf16 v[36:39], a[76:79], a[132:135], 0
s_mov_b32 s43, 0x20000
s_mov_b32 s46, 2359296
s_mov_b32 s47, 0x20000
v_mfma_f32_16x16x32_bf16 v[36:39], a[72:75], a[128:131], v[36:39]
s_add_u32 m0, s77, 49152
s_add_u32 s64, s76, 0
ds_read_b128 a[108:111], v10 offset:10240
v_mfma_f32_16x16x32_bf16 v[64:67], a[80:83], a[128:131], 0
s_mov_b32 s50, 663552
s_mov_b32 s51, 0x20000
s_lshl_b32 s89, s4, 10
v_mfma_f32_16x16x32_bf16 v[64:67], a[84:87], a[132:135], v[64:67]
buffer_load_dwordx4 v7, s[16:19], s64 offen lds
v_mfma_f32_16x16x32_bf16 v[72:75], a[84:87], a[140:143], 0
s_add_u32 s89, s89, 75497472
ds_read_b64_tr_b16 a[164:165], v11 offset:24576
ds_read_b64_tr_b16 a[166:167], v11 offset:25088
v_mfma_f32_16x16x32_bf16 v[72:75], a[80:83], a[136:139], v[72:75]
s_mul_i32 s94, s4, 1064960
s_cmp_eq_u32 s66, 0
s_cselect_b32 s52, s89, 2147418112
v_mfma_f32_16x16x32_bf16 v[80:83], a[80:83], a[144:147], 0
buffer_load_dwordx4 v8, s[16:19], s64 offen offset:1024 lds
v_mfma_f32_16x16x32_bf16 v[80:83], a[84:87], a[148:151], v[80:83]
s_add_u32 m0, s77, 51200
s_add_u32 s64, s76, 131072
ds_read_b128 a[112:115], v9 offset:12288
v_mfma_f32_16x16x32_bf16 v[88:91], a[84:87], a[156:159], 0
s_lshl_b32 s53, s5, 10
s_add_u32 s53, s53, s94
s_add_u32 s53, s53, 1048576
v_mfma_f32_16x16x32_bf16 v[88:91], a[80:83], a[152:155], v[88:91]
buffer_load_dwordx4 v7, s[16:19], s64 offen lds
v_mfma_f32_16x16x32_bf16 v[92:95], a[88:91], a[152:155], 0
ds_read_b64_tr_b16 a[168:169], v12 offset:16384
ds_read_b64_tr_b16 a[170:171], v12 offset:16896
v_mfma_f32_16x16x32_bf16 v[92:95], a[92:95], a[156:159], v[92:95]
s_cmp_eq_u32 s3, 1
s_cselect_b32 s52, s53, s52
s_mul_i32 s53, s2, 74
v_mfma_f32_16x16x32_bf16 v[84:87], a[92:95], a[148:151], 0
buffer_load_dwordx4 v8, s[16:19], s64 offen offset:1024 lds
v_mfma_f32_16x16x32_bf16 v[84:87], a[88:91], a[144:147], v[84:87]
s_add_u32 s53, s53, s55
s_lshl_b32 s53, s53, 10
s_add_u32 s53, s53, 54599680
v_mfma_f32_16x16x32_bf16 v[76:79], a[88:91], a[136:139], 0
s_cmp_ge_u32 s3, 2
s_cselect_b32 s52, s53, s52
ds_read_b128 a[116:119], v10 offset:12288
v_mfma_f32_16x16x32_bf16 v[76:79], a[92:95], a[140:143], v[76:79]
v_mov_b32 v16, 0
v_mov_b32 v17, 0
v_mfma_f32_16x16x32_bf16 v[68:71], a[92:95], a[132:135], 0
v_mov_b32 v18, 0
v_mov_b32 v19, 0
v_mfma_f32_16x16x32_bf16 v[68:71], a[88:91], a[128:131], v[68:71]
s_waitcnt lgkmcnt(6)
ds_read_b64_tr_b16 a[172:173], v12 offset:24576
ds_read_b64_tr_b16 a[174:175], v12 offset:25088
v_mfma_f32_16x16x32_bf16 v[96:99], a[96:99], a[128:131], 0
v_mfma_f32_16x16x32_bf16 v[96:99], a[100:103], a[132:135], v[96:99]
v_mfma_f32_16x16x32_bf16 v[104:107], a[100:103], a[140:143], 0
ds_read_b128 a[120:123], v9 offset:14336
v_mfma_f32_16x16x32_bf16 v[104:107], a[96:99], a[136:139], v[104:107]
v_mfma_f32_16x16x32_bf16 v[112:115], a[96:99], a[144:147], 0
v_mfma_f32_16x16x32_bf16 v[112:115], a[100:103], a[148:151], v[112:115]
ds_read_b64_tr_b16 a[176:177], v13 offset:16384
ds_read_b64_tr_b16 a[178:179], v13 offset:16896
v_mfma_f32_16x16x32_bf16 v[120:123], a[100:103], a[156:159], 0
v_mfma_f32_16x16x32_bf16 v[120:123], a[96:99], a[152:155], v[120:123]
v_mfma_f32_16x16x32_bf16 v[124:127], a[104:107], a[152:155], 0
v_mfma_f32_16x16x32_bf16 v[124:127], a[108:111], a[156:159], v[124:127]
ds_read_b128 a[124:127], v10 offset:14336
v_mfma_f32_16x16x32_bf16 v[116:119], a[108:111], a[148:151], 0
v_add_u32 v9, 32768, v9
v_add_u32 v10, 32768, v10
v_mfma_f32_16x16x32_bf16 v[116:119], a[104:107], a[144:147], v[116:119]
v_mfma_f32_16x16x32_bf16 v[108:111], a[104:107], a[136:139], 0
ds_read_b64_tr_b16 a[180:181], v13 offset:24576
ds_read_b64_tr_b16 a[182:183], v13 offset:25088
v_mfma_f32_16x16x32_bf16 v[108:111], a[108:111], a[140:143], v[108:111]
v_mfma_f32_16x16x32_bf16 v[100:103], a[108:111], a[132:135], 0
v_mfma_f32_16x16x32_bf16 v[100:103], a[104:107], a[128:131], v[100:103]
s_waitcnt lgkmcnt(2)
ds_read_b64_tr_b16 a[184:185], v14 offset:16384
ds_read_b64_tr_b16 a[186:187], v14 offset:16896
v_mfma_f32_16x16x32_bf16 v[128:131], a[112:115], a[128:131], 0
v_mfma_f32_16x16x32_bf16 v[128:131], a[116:119], a[132:135], v[128:131]
v_mfma_f32_16x16x32_bf16 v[136:139], a[116:119], a[140:143], 0
ds_read_b64_tr_b16 a[188:189], v14 offset:24576
ds_read_b64_tr_b16 a[190:191], v14 offset:25088
v_mfma_f32_16x16x32_bf16 v[136:139], a[112:115], a[136:139], v[136:139]
v_mfma_f32_16x16x32_bf16 v[144:147], a[112:115], a[144:147], 0
v_mfma_f32_16x16x32_bf16 v[144:147], a[116:119], a[148:151], v[144:147]
v_mfma_f32_16x16x32_bf16 v[152:155], a[116:119], a[156:159], 0
v_mfma_f32_16x16x32_bf16 v[152:155], a[112:115], a[152:155], v[152:155]
v_mfma_f32_16x16x32_bf16 v[156:159], a[120:123], a[152:155], 0
v_mfma_f32_16x16x32_bf16 v[156:159], a[124:127], a[156:159], v[156:159]
v_mfma_f32_16x16x32_bf16 v[148:151], a[124:127], a[148:151], 0
v_mfma_f32_16x16x32_bf16 v[148:151], a[120:123], a[144:147], v[148:151]
v_mfma_f32_16x16x32_bf16 v[140:143], a[120:123], a[136:139], 0
v_mfma_f32_16x16x32_bf16 v[140:143], a[124:127], a[140:143], v[140:143]
v_mfma_f32_16x16x32_bf16 v[132:135], a[124:127], a[132:135], 0
v_mfma_f32_16x16x32_bf16 v[132:135], a[120:123], a[128:131], v[132:135]
s_waitcnt lgkmcnt(0)
v_mfma_f32_16x16x32_bf16 v[160:163], a[160:163], a[64:67], 0
s_waitcnt vmcnt(4)
v_mfma_f32_16x16x32_bf16 v[160:163], a[164:167], a[68:71], v[160:163]
s_barrier
v_mfma_f32_16x16x32_bf16 v[164:167], a[172:175], a[68:71], 0
ds_read_b64_tr_b16 a[128:129], v11 offset:32768
ds_read_b64_tr_b16 a[130:131], v11 offset:33280
v_mfma_f32_16x16x32_bf16 v[164:167], a[168:171], a[64:67], v[164:167]
s_xor_b32 s71, s70, 256
s_add_u32 s71, s68, s71
v_mfma_f32_16x16x32_bf16 v[168:171], a[176:179], a[64:67], 0
s_add_u32 m0, s73, 65536
s_add_u32 s64, s71, 0
v_mfma_f32_16x16x32_bf16 v[168:171], a[180:183], a[68:71], v[168:171]
buffer_load_dwordx4 v5, s[8:11], s64 offen lds
v_mfma_f32_16x16x32_bf16 v[172:175], a[188:191], a[68:71], 0
v_mfma_f32_16x16x32_bf16 v[172:175], a[184:187], a[64:67], v[172:175]
ds_read_b128 a[64:67], v9 offset:0
v_mfma_f32_16x16x32_bf16 v[188:191], a[184:187], a[72:75], 0
buffer_load_dwordx4 v6, s[8:11], s64 offen offset:1024 lds
v_mfma_f32_16x16x32_bf16 v[188:191], a[188:191], a[76:79], v[188:191]
ds_read_b64_tr_b16 a[132:133], v11 offset:40960
ds_read_b64_tr_b16 a[134:135], v11 offset:41472
v_mfma_f32_16x16x32_bf16 v[184:187], a[180:183], a[76:79], 0
v_mfma_f32_16x16x32_bf16 v[184:187], a[176:179], a[72:75], v[184:187]
s_add_u32 m0, s73, 67584
s_add_u32 s64, s71, 16384
ds_read_b128 a[68:71], v10 offset:0
v_mfma_f32_16x16x32_bf16 v[180:183], a[168:171], a[72:75], 0
v_mfma_f32_16x16x32_bf16 v[180:183], a[172:175], a[76:79], v[180:183]
buffer_load_dwordx4 v5, s[8:11], s64 offen lds
v_mfma_f32_16x16x32_bf16 v[176:179], a[164:167], a[76:79], 0
v_mfma_f32_16x16x32_bf16 v[176:179], a[160:163], a[72:75], v[176:179]
ds_read_b64_tr_b16 a[136:137], v12 offset:32768
ds_read_b64_tr_b16 a[138:139], v12 offset:33280
v_mfma_f32_16x16x32_bf16 v[192:195], a[160:163], a[80:83], 0
v_mfma_f32_16x16x32_bf16 v[192:195], a[164:167], a[84:87], v[192:195]
v_mfma_f32_16x16x32_bf16 v[196:199], a[172:175], a[84:87], 0
buffer_load_dwordx4 v6, s[8:11], s64 offen offset:1024 lds
v_mfma_f32_16x16x32_bf16 v[196:199], a[168:171], a[80:83], v[196:199]
s_xor_b32 s76, s75, 1048576
s_add_u32 s76, s74, s76
ds_read_b128 a[72:75], v9 offset:2048
v_mfma_f32_16x16x32_bf16 v[200:203], a[176:179], a[80:83], 0
L_PAD0:
s_cbranch_execz L_PAD4
v_mfma_f32_16x16x32_bf16 v[200:203], a[180:183], a[84:87], v[200:203]
s_add_u32 m0, s77, 0
s_add_u32 s64, s76, 0
v_mfma_f32_16x16x32_bf16 v[204:207], a[188:191], a[84:87], 0
ds_read_b64_tr_b16 a[140:141], v12 offset:40960
ds_read_b64_tr_b16 a[142:143], v12 offset:41472
v_mfma_f32_16x16x32_bf16 v[204:207], a[184:187], a[80:83], v[204:207]
buffer_load_dwordx4 v7, s[56:59], s64 offen lds
v_mfma_f32_16x16x32_bf16 v[220:223], a[184:187], a[88:91], 0
ds_read_b128 a[76:79], v10 offset:2048
v_mfma_f32_16x16x32_bf16 v[220:223], a[188:191], a[92:95], v[220:223]
v_mfma_f32_16x16x32_bf16 v[216:219], a[180:183], a[92:95], 0
v_mfma_f32_16x16x32_bf16 v[216:219], a[176:179], a[88:91], v[216:219]
v_mfma_f32_16x16x32_bf16 v[212:215], a[168:171], a[88:91], 0
buffer_load_dwordx4 v8, s[56:59], s64 offen offset:1024 lds
v_mfma_f32_16x16x32_bf16 v[212:215], a[172:175], a[92:95], v[212:215]
ds_read_b64_tr_b16 a[144:145], v13 offset:32768
ds_read_b64_tr_b16 a[146:147], v13 offset:33280
v_mfma_f32_16x16x32_bf16 v[208:211], a[164:167], a[92:95], 0
v_mfma_f32_16x16x32_bf16 v[208:211], a[160:163], a[88:91], v[208:211]
s_add_u32 m0, s77, 2048
s_add_u32 s64, s76, 131072
ds_read_b128 a[80:83], v9 offset:4096
v_mfma_f32_16x16x32_bf16 v[224:227], a[160:163], a[96:99], 0
v_mfma_f32_16x16x32_bf16 v[224:227], a[164:167], a[100:103], v[224:227]
buffer_load_dwordx4 v7, s[56:59], s64 offen lds
v_mfma_f32_16x16x32_bf16 v[228:231], a[172:175], a[100:103], 0
ds_read_b64_tr_b16 a[148:149], v13 offset:40960
ds_read_b64_tr_b16 a[150:151], v13 offset:41472
v_mfma_f32_16x16x32_bf16 v[228:231], a[168:171], a[96:99], v[228:231]
v_mfma_f32_16x16x32_bf16 v[232:235], a[176:179], a[96:99], 0
buffer_store_dwordx4 v[16:19], v4, s[24:27], s52 offen sc1
v_mfma_f32_16x16x32_bf16 v[232:235], a[180:183], a[100:103], v[232:235]
buffer_load_dwordx4 v8, s[56:59], s64 offen offset:1024 lds
v_mfma_f32_16x16x32_bf16 v[236:239], a[188:191], a[100:103], 0
s_add_u32 s89, s89, 512
ds_read_b128 a[84:87], v10 offset:4096
v_mfma_f32_16x16x32_bf16 v[236:239], a[184:187], a[96:99], v[236:239]
s_cmp_eq_u32 s3, 0
s_cselect_b32 s90, s89, 2147418112
v_mov_b32 v24, 2147418112
v_mfma_f32_16x16x32_bf16 v[252:255], a[184:187], a[104:107], 0
s_add_u32 m0, s73, 69632
s_add_u32 s64, s71, 524288
v_cmp_eq_u32 vcc, 1, v1
v_mfma_f32_16x16x32_bf16 v[252:255], a[188:191], a[108:111], v[252:255]
s_lshl_b32 s53, s55, 12
ds_read_b64_tr_b16 a[152:153], v14 offset:32768
ds_read_b64_tr_b16 a[154:155], v14 offset:33280
v_mfma_f32_16x16x32_bf16 v[248:251], a[180:183], a[108:111], 0
buffer_load_dwordx4 v5, s[8:11], s64 offen lds
v_mfma_f32_16x16x32_bf16 v[248:251], a[176:179], a[104:107], v[248:251]
v_cndmask_b32 v0, v24, 0, vcc
v_mfma_f32_16x16x32_bf16 v[244:247], a[168:171], a[104:107], 0
s_mul_i32 s87, s87, 16384
s_add_u32 s87, s87, s94
ds_read_b128 a[88:91], v9 offset:6144
v_mfma_f32_16x16x32_bf16 v[244:247], a[172:175], a[108:111], v[244:247]
s_add_u32 s88, s87, s53
s_add_u32 s88, s88, 24576
s_lshr_b32 s53, s53, 1
v_mfma_f32_16x16x32_bf16 v[240:243], a[164:167], a[108:111], 0
s_add_u32 s87, s87, s53
s_lshl_b32 s80, s3, 10
s_mul_i32 s78, s4, 18
v_mfma_f32_16x16x32_bf16 v[240:243], a[160:163], a[104:107], v[240:243]
buffer_load_dwordx4 v6, s[8:11], s64 offen offset:1024 lds
v_mfma_f32_16x16x32_bf16 a[0:3], a[160:163], a[112:115], 0
s_add_u32 s78, s78, s54
ds_read_b64_tr_b16 a[156:157], v14 offset:40960
ds_read_b64_tr_b16 a[158:159], v14 offset:41472
v_mfma_f32_16x16x32_bf16 a[0:3], a[164:167], a[116:119], a[0:3]
s_lshl2_add_u32 s78, s78, s55
s_lshl_b32 s78, s78, 10
s_add_u32 s78, s78, 35651584
v_mfma_f32_16x16x32_bf16 a[4:7], a[172:175], a[116:119], 0
s_add_u32 m0, s73, 71680
s_add_u32 s64, s71, 540672
ds_read_b128 a[92:95], v10 offset:6144
v_mfma_f32_16x16x32_bf16 a[4:7], a[168:171], a[112:115], a[4:7]
s_add_u32 s80, s80, 8192
s_mov_b32 s91, 0x3e0293ee
s_mov_b32 s85, 0x05040100
v_mfma_f32_16x16x32_bf16 a[8:11], a[176:179], a[112:115], 0
buffer_load_dwordx4 v5, s[8:11], s64 offen lds
v_mfma_f32_16x16x32_bf16 a[8:11], a[180:183], a[116:119], a[8:11]
s_mov_b32 s86, 0x07060302
s_lshl2_add_u32 s52, s7, s3
s_and_b32 s65, s6, 3
v_mfma_f32_16x16x32_bf16 a[12:15], a[188:191], a[116:119], 0
s_max_u32 s95, s65, 1
s_mul_i32 s92, s5, 3
s_add_u32 s95, s95, s92
v_mfma_f32_16x16x32_bf16 a[12:15], a[184:187], a[112:115], a[12:15]
s_sub_u32 s95, 24, s95
s_cmp_eq_u32 s65, 1
s_cselect_b32 s95, 63, s95
v_mfma_f32_16x16x32_bf16 a[28:31], a[184:187], a[120:123], 0
s_mov_b32 s92, s95
s_mul_i32 s81, s92, 110592
s_mul_i32 s65, s52, 36
v_mfma_f32_16x16x32_bf16 a[28:31], a[188:191], a[124:127], a[28:31]
buffer_load_dwordx4 v6, s[8:11], s64 offen offset:1024 lds
v_mfma_f32_16x16x32_bf16 a[24:27], a[180:183], a[124:127], 0
s_add_u32 s81, s81, s65
s_mul_i32 s82, s52, 18
s_add_u32 s82, s82, s92
v_mfma_f32_16x16x32_bf16 a[24:27], a[176:179], a[120:123], a[24:27]
s_lshl_b32 s82, s82, 12
s_add_u32 s82, s82, 35651584
s_lshl_b32 s83, s92, 6
v_mfma_f32_16x16x32_bf16 a[20:23], a[168:171], a[120:123], 0
s_lshl_b32 s84, s52, 10
s_add_u32 s84, s84, 75497984
v_mfma_f32_16x16x32_bf16 a[20:23], a[172:175], a[124:127], a[20:23]
s_cmp_lt_u32 s92, 18
s_cselect_b32 s82, s82, 2147418112
s_cselect_b32 s84, s84, 2147418112
v_mfma_f32_16x16x32_bf16 a[16:19], a[164:167], a[124:127], 0
v_lshrrev_b32 v18, 2, v2
v_and_b32 v19, 3, v2
v_mfma_f32_16x16x32_bf16 a[16:19], a[160:163], a[120:123], a[16:19]
s_waitcnt lgkmcnt(0)
v_mul_u32_u24 v20, 1152, v18
v_cmp_eq_u32 vcc, 2, v19
v_mfma_f32_16x16x32_bf16 v[32:35], a[64:67], a[128:131], v[32:35]
s_waitcnt vmcnt(13)
v_lshl_add_u32 v20, v19, 3, v20
v_add_u32 v21, 1, v19
v_mfma_f32_16x16x32_bf16 v[32:35], a[68:71], a[132:135], v[32:35]
s_barrier
v_mfma_f32_16x16x32_bf16 v[40:43], a[68:71], a[140:143], v[40:43]
ds_read_b128 a[96:99], v9 offset:8192
v_cndmask_b32 v21, v21, 0, vcc
v_mfma_f32_16x16x32_bf16 v[40:43], a[64:67], a[136:139], v[40:43]
s_add_u32 m0, s77, 16384
s_add_u32 s64, s76, 0
v_cmp_eq_u32 vcc, 3, v18
v_mfma_f32_16x16x32_bf16 v[48:51], a[64:67], a[144:147], v[48:51]
buffer_load_dwordx4 v7, s[16:19], s64 offen lds
v_mfma_f32_16x16x32_bf16 v[48:51], a[68:71], a[148:151], v[48:51]
ds_read_b128 a[100:103], v10 offset:8192
v_mul_u32_u24 v21, 1152, v21
v_mfma_f32_16x16x32_bf16 v[56:59], a[68:71], a[156:159], v[56:59]
v_add_u32 v21, 32, v21
v_cndmask_b32 v20, v20, v21, vcc
v_mfma_f32_16x16x32_bf16 v[56:59], a[64:67], a[152:155], v[56:59]
v_cmp_eq_u32 vcc, 15, v2
v_mul_u32_u24 v21, 27648, v3
v_mfma_f32_16x16x32_bf16 v[60:63], a[72:75], a[152:155], v[60:63]
buffer_load_dwordx4 v8, s[16:19], s64 offen offset:1024 lds
v_mfma_f32_16x16x32_bf16 v[60:63], a[76:79], a[156:159], v[60:63]
ds_read_b128 a[104:107], v9 offset:10240
v_add_u32 v20, v20, v21
v_mfma_f32_16x16x32_bf16 v[52:55], a[76:79], a[148:151], v[52:55]
v_lshlrev_b32 v21, 4, v3
v_cndmask_b32 v26, v20, v24, vcc
v_mfma_f32_16x16x32_bf16 v[52:55], a[72:75], a[144:147], v[52:55]
s_add_u32 m0, s77, 18432
s_add_u32 s64, s76, 131072
v_cndmask_b32 v27, v24, v21, vcc
v_mfma_f32_16x16x32_bf16 v[44:47], a[72:75], a[136:139], v[44:47]
ds_read_b64_tr_b16 a[160:161], v11 offset:49152
ds_read_b64_tr_b16 a[162:163], v11 offset:49664
v_mfma_f32_16x16x32_bf16 v[44:47], a[76:79], a[140:143], v[44:47]
buffer_load_dwordx4 v7, s[16:19], s64 offen lds
v_mfma_f32_16x16x32_bf16 v[36:39], a[76:79], a[132:135], v[36:39]
v_and_b32 v18, 7, v1
v_cmp_gt_u32 vcc, 48, v1
v_mfma_f32_16x16x32_bf16 v[36:39], a[72:75], a[128:131], v[36:39]
ds_read_b128 a[108:111], v10 offset:10240
v_mul_u32_u24 v18, 3456, v18
v_mfma_f32_16x16x32_bf16 v[64:67], a[80:83], a[128:131], v[64:67]
v_mul_u32_u24 v19, 1152, v3
v_bfe_u32 v20, v1, 3, 1
v_mfma_f32_16x16x32_bf16 v[64:67], a[84:87], a[132:135], v[64:67]
v_mul_u32_u24 v20, 140, v20
v_add3_u32 v18, v18, v19, v20
v_mfma_f32_16x16x32_bf16 v[72:75], a[84:87], a[140:143], v[72:75]
buffer_load_dwordx4 v8, s[16:19], s64 offen offset:1024 lds
v_mfma_f32_16x16x32_bf16 v[72:75], a[80:83], a[136:139], v[72:75]
s_xor_b32 s71, s70, 384
s_add_u32 s71, s68, s71
v_cndmask_b32 v28, v24, v18, vcc
v_mfma_f32_16x16x32_bf16 v[80:83], a[80:83], a[144:147], v[80:83]
s_lshl_b32 s52, s4, 2
ds_read_b64_tr_b16 a[164:165], v11 offset:57344
ds_read_b64_tr_b16 a[166:167], v11 offset:57856
v_mfma_f32_16x16x32_bf16 v[80:83], a[84:87], a[148:151], v[80:83]
s_add_u32 m0, s73, 0
s_add_u32 s64, s71, 0
ds_read_b128 a[112:115], v9 offset:12288
v_mfma_f32_16x16x32_bf16 v[88:91], a[84:87], a[156:159], v[88:91]
s_cmp_eq_u32 s66, 0
s_cselect_b32 s52, s52, 2147418112
v_mfma_f32_16x16x32_bf16 v[88:91], a[80:83], a[152:155], v[88:91]
buffer_load_dwordx4 v5, s[8:11], s64 offen lds
v_mfma_f32_16x16x32_bf16 v[92:95], a[88:91], a[152:155], v[92:95]
ds_read_b64_tr_b16 a[168:169], v12 offset:49152
ds_read_b64_tr_b16 a[170:171], v12 offset:49664
v_mfma_f32_16x16x32_bf16 v[92:95], a[92:95], a[156:159], v[92:95]
v_mfma_f32_16x16x32_bf16 v[84:87], a[92:95], a[148:151], v[84:87]
v_mfma_f32_16x16x32_bf16 v[84:87], a[88:91], a[144:147], v[84:87]
v_mfma_f32_16x16x32_bf16 v[76:79], a[88:91], a[136:139], v[76:79]
buffer_load_dwordx4 v6, s[8:11], s64 offen offset:1024 lds
v_mfma_f32_16x16x32_bf16 v[76:79], a[92:95], a[140:143], v[76:79]
ds_read_b128 a[116:119], v10 offset:12288
v_mfma_f32_16x16x32_bf16 v[68:71], a[92:95], a[132:135], v[68:71]
v_mfma_f32_16x16x32_bf16 v[68:71], a[88:91], a[128:131], v[68:71]
s_add_u32 m0, s73, 2048
s_add_u32 s64, s71, 16384
s_waitcnt lgkmcnt(6)
v_mfma_f32_16x16x32_bf16 v[96:99], a[96:99], a[128:131], v[96:99]
ds_read_b64_tr_b16 a[172:173], v12 offset:57344
ds_read_b64_tr_b16 a[174:175], v12 offset:57856
v_mfma_f32_16x16x32_bf16 v[96:99], a[100:103], a[132:135], v[96:99]
buffer_load_dwordx4 v5, s[8:11], s64 offen lds
v_mfma_f32_16x16x32_bf16 v[104:107], a[100:103], a[140:143], v[104:107]
ds_read_b128 a[120:123], v9 offset:14336
v_mfma_f32_16x16x32_bf16 v[104:107], a[96:99], a[136:139], v[104:107]
v_mfma_f32_16x16x32_bf16 v[112:115], a[96:99], a[144:147], v[112:115]
v_mfma_f32_16x16x32_bf16 v[112:115], a[100:103], a[148:151], v[112:115]
buffer_load_dwordx4 v6, s[8:11], s64 offen offset:1024 lds
v_mfma_f32_16x16x32_bf16 v[120:123], a[100:103], a[156:159], v[120:123]
s_xor_b32 s76, s75, 1572864
s_add_u32 s76, s74, s76
v_mfma_f32_16x16x32_bf16 v[120:123], a[96:99], a[152:155], v[120:123]
ds_read_b64_tr_b16 a[176:177], v13 offset:49152
ds_read_b64_tr_b16 a[178:179], v13 offset:49664
v_mfma_f32_16x16x32_bf16 v[124:127], a[104:107], a[152:155], v[124:127]
s_add_u32 m0, s77, 32768
s_add_u32 s64, s76, 0
v_mfma_f32_16x16x32_bf16 v[124:127], a[108:111], a[156:159], v[124:127]
ds_read_b128 a[124:127], v10 offset:14336
v_mfma_f32_16x16x32_bf16 v[116:119], a[108:111], a[148:151], v[116:119]
buffer_load_dwordx4 v7, s[56:59], s64 offen lds
v_mfma_f32_16x16x32_bf16 v[116:119], a[104:107], a[144:147], v[116:119]
s_waitcnt vmcnt(14)
v_add_u32 v9, 32768, v9
v_add_u32 v10, 32768, v10
v_mfma_f32_16x16x32_bf16 v[108:111], a[104:107], a[136:139], v[108:111]
ds_read_b64_tr_b16 a[180:181], v13 offset:57344
ds_read_b64_tr_b16 a[182:183], v13 offset:57856
v_mfma_f32_16x16x32_bf16 v[108:111], a[108:111], a[140:143], v[108:111]
buffer_store_dword v1, v0, s[40:43], s52 offen sc1
v_mfma_f32_16x16x32_bf16 v[100:103], a[108:111], a[132:135], v[100:103]
s_waitcnt lgkmcnt(2)
v_mfma_f32_16x16x32_bf16 v[100:103], a[104:107], a[128:131], v[100:103]
buffer_load_dwordx4 v8, s[56:59], s64 offen offset:1024 lds
v_mfma_f32_16x16x32_bf16 v[128:131], a[112:115], a[128:131], v[128:131]
ds_read_b64_tr_b16 a[184:185], v14 offset:49152
ds_read_b64_tr_b16 a[186:187], v14 offset:49664
v_mfma_f32_16x16x32_bf16 v[128:131], a[116:119], a[132:135], v[128:131]
v_mfma_f32_16x16x32_bf16 v[136:139], a[116:119], a[140:143], v[136:139]
s_add_u32 m0, s77, 34816
s_add_u32 s64, s76, 131072
v_mfma_f32_16x16x32_bf16 v[136:139], a[112:115], a[136:139], v[136:139]
ds_read_b64_tr_b16 a[188:189], v14 offset:57344
ds_read_b64_tr_b16 a[190:191], v14 offset:57856
v_mfma_f32_16x16x32_bf16 v[144:147], a[112:115], a[144:147], v[144:147]
buffer_load_dwordx4 v7, s[56:59], s64 offen lds
v_mfma_f32_16x16x32_bf16 v[144:147], a[116:119], a[148:151], v[144:147]
v_mfma_f32_16x16x32_bf16 v[152:155], a[116:119], a[156:159], v[152:155]
v_mfma_f32_16x16x32_bf16 v[152:155], a[112:115], a[152:155], v[152:155]
v_mfma_f32_16x16x32_bf16 v[156:159], a[120:123], a[152:155], v[156:159]
v_mfma_f32_16x16x32_bf16 v[156:159], a[124:127], a[156:159], v[156:159]
buffer_load_dwordx4 v8, s[56:59], s64 offen offset:1024 lds
v_mfma_f32_16x16x32_bf16 v[148:151], a[124:127], a[148:151], v[148:151]
v_mfma_f32_16x16x32_bf16 v[148:151], a[120:123], a[144:147], v[148:151]
v_mfma_f32_16x16x32_bf16 v[140:143], a[120:123], a[136:139], v[140:143]
v_mfma_f32_16x16x32_bf16 v[140:143], a[124:127], a[140:143], v[140:143]
v_mfma_f32_16x16x32_bf16 v[132:135], a[124:127], a[132:135], v[132:135]
v_mfma_f32_16x16x32_bf16 v[132:135], a[120:123], a[128:131], v[132:135]
s_waitcnt lgkmcnt(0)
v_mfma_f32_16x16x32_bf16 v[160:163], a[160:163], a[64:67], v[160:163]
s_waitcnt vmcnt(13)
v_mfma_f32_16x16x32_bf16 v[160:163], a[164:167], a[68:71], v[160:163]
s_barrier
v_mfma_f32_16x16x32_bf16 v[164:167], a[172:175], a[68:71], v[164:167]
s_add_u32 s52, s81, 0
ds_read_b64_tr_b16 a[128:129], v11 offset:0
ds_read_b64_tr_b16 a[130:131], v11 offset:512
v_mfma_f32_16x16x32_bf16 v[164:167], a[168:171], a[64:67], v[164:167]
s_add_u32 m0, s73, 4096
s_add_u32 s64, s71, 524288
v_mfma_f32_16x16x32_bf16 v[168:171], a[176:179], a[64:67], v[168:171]
buffer_load_dwordx4 v5, s[8:11], s64 offen lds
v_mfma_f32_16x16x32_bf16 v[168:171], a[180:183], a[68:71], v[168:171]
buffer_load_dwordx2 a[192:193], v26, s[28:31], s52 offen
v_mfma_f32_16x16x32_bf16 v[172:175], a[188:191], a[68:71], v[172:175]
v_mfma_f32_16x16x32_bf16 v[172:175], a[184:187], a[64:67], v[172:175]
ds_read_b128 a[64:67], v9 offset:0
v_mfma_f32_16x16x32_bf16 v[188:191], a[184:187], a[72:75], v[188:191]
buffer_load_dwordx4 v6, s[8:11], s64 offen offset:1024 lds
v_mfma_f32_16x16x32_bf16 v[188:191], a[188:191], a[76:79], v[188:191]
ds_read_b64_tr_b16 a[132:133], v11 offset:8192
ds_read_b64_tr_b16 a[134:135], v11 offset:8704
v_mfma_f32_16x16x32_bf16 v[184:187], a[180:183], a[76:79], v[184:187]
v_mfma_f32_16x16x32_bf16 v[184:187], a[176:179], a[72:75], v[184:187]
s_add_u32 m0, s73, 6144
s_add_u32 s64, s71, 540672
ds_read_b128 a[68:71], v10 offset:0
v_mfma_f32_16x16x32_bf16 v[180:183], a[168:171], a[72:75], v[180:183]
v_mfma_f32_16x16x32_bf16 v[180:183], a[172:175], a[76:79], v[180:183]
buffer_load_dwordx4 v5, s[8:11], s64 offen lds
v_mfma_f32_16x16x32_bf16 v[176:179], a[164:167], a[76:79], v[176:179]
s_add_u32 s52, s81, 3456
v_mfma_f32_16x16x32_bf16 v[176:179], a[160:163], a[72:75], v[176:179]
ds_read_b64_tr_b16 a[136:137], v12 offset:0
ds_read_b64_tr_b16 a[138:139], v12 offset:512
v_mfma_f32_16x16x32_bf16 v[192:195], a[160:163], a[80:83], v[192:195]
buffer_load_dwordx2 a[194:195], v26, s[28:31], s52 offen
v_mfma_f32_16x16x32_bf16 v[192:195], a[164:167], a[84:87], v[192:195]
v_mfma_f32_16x16x32_bf16 v[196:199], a[172:175], a[84:87], v[196:199]
buffer_load_dwordx4 v6, s[8:11], s64 offen offset:1024 lds
v_mfma_f32_16x16x32_bf16 v[196:199], a[168:171], a[80:83], v[196:199]
ds_read_b128 a[72:75], v9 offset:2048
v_mfma_f32_16x16x32_bf16 v[200:203], a[176:179], a[80:83], v[200:203]
v_mfma_f32_16x16x32_bf16 v[200:203], a[180:183], a[84:87], v[200:203]
s_add_u32 m0, s77, 49152
s_add_u32 s64, s76, 0
v_mfma_f32_16x16x32_bf16 v[204:207], a[188:191], a[84:87], v[204:207]
ds_read_b64_tr_b16 a[140:141], v12 offset:8192
ds_read_b64_tr_b16 a[142:143], v12 offset:8704
v_mfma_f32_16x16x32_bf16 v[204:207], a[184:187], a[80:83], v[204:207]
buffer_load_dwordx4 v7, s[16:19], s64 offen lds
v_mfma_f32_16x16x32_bf16 v[220:223], a[184:187], a[88:91], v[220:223]
ds_read_b128 a[76:79], v10 offset:2048
v_mfma_f32_16x16x32_bf16 v[220:223], a[188:191], a[92:95], v[220:223]
s_add_u32 s52, s81, 6912
v_mfma_f32_16x16x32_bf16 v[216:219], a[180:183], a[92:95], v[216:219]
buffer_load_dwordx2 a[196:197], v26, s[28:31], s52 offen
v_mfma_f32_16x16x32_bf16 v[216:219], a[176:179], a[88:91], v[216:219]
v_mfma_f32_16x16x32_bf16 v[212:215], a[168:171], a[88:91], v[212:215]
buffer_load_dwordx4 v8, s[16:19], s64 offen offset:1024 lds
v_mfma_f32_16x16x32_bf16 v[212:215], a[172:175], a[92:95], v[212:215]
ds_read_b64_tr_b16 a[144:145], v13 offset:0
ds_read_b64_tr_b16 a[146:147], v13 offset:512
v_mfma_f32_16x16x32_bf16 v[208:211], a[164:167], a[92:95], v[208:211]
v_mfma_f32_16x16x32_bf16 v[208:211], a[160:163], a[88:91], v[208:211]
s_add_u32 m0, s77, 51200
s_add_u32 s64, s76, 131072
ds_read_b128 a[80:83], v9 offset:4096
v_mfma_f32_16x16x32_bf16 v[224:227], a[160:163], a[96:99], v[224:227]
v_mfma_f32_16x16x32_bf16 v[224:227], a[164:167], a[100:103], v[224:227]
buffer_load_dwordx4 v7, s[16:19], s64 offen lds
v_mfma_f32_16x16x32_bf16 v[228:231], a[172:175], a[100:103], v[228:231]
ds_read_b64_tr_b16 a[148:149], v13 offset:8192
ds_read_b64_tr_b16 a[150:151], v13 offset:8704
v_mfma_f32_16x16x32_bf16 v[228:231], a[168:171], a[96:99], v[228:231]
s_add_u32 s52, s81, 10368
v_mfma_f32_16x16x32_bf16 v[232:235], a[176:179], a[96:99], v[232:235]
buffer_load_dwordx2 a[198:199], v26, s[28:31], s52 offen
v_mfma_f32_16x16x32_bf16 v[232:235], a[180:183], a[100:103], v[232:235]
buffer_load_dwordx4 v8, s[16:19], s64 offen offset:1024 lds
v_mfma_f32_16x16x32_bf16 v[236:239], a[188:191], a[100:103], v[236:239]
s_xor_b32 s71, s70, 512
s_add_u32 s71, s68, s71
ds_read_b128 a[84:87], v10 offset:4096
v_mfma_f32_16x16x32_bf16 v[236:239], a[184:187], a[96:99], v[236:239]
v_mfma_f32_16x16x32_bf16 v[252:255], a[184:187], a[104:107], v[252:255]
s_add_u32 m0, s73, 32768
s_add_u32 s64, s71, 0
v_mfma_f32_16x16x32_bf16 v[252:255], a[188:191], a[108:111], v[252:255]
ds_read_b64_tr_b16 a[152:153], v14 offset:0
ds_read_b64_tr_b16 a[154:155], v14 offset:512
v_mfma_f32_16x16x32_bf16 v[248:251], a[180:183], a[108:111], v[248:251]
buffer_load_dwordx4 v5, s[8:11], s64 offen lds
v_mfma_f32_16x16x32_bf16 v[248:251], a[176:179], a[104:107], v[248:251]
v_mfma_f32_16x16x32_bf16 v[244:247], a[168:171], a[104:107], v[244:247]
ds_read_b128 a[88:91], v9 offset:6144
v_mfma_f32_16x16x32_bf16 v[244:247], a[172:175], a[108:111], v[244:247]
s_add_u32 s52, s81, 13824
v_mfma_f32_16x16x32_bf16 v[240:243], a[164:167], a[108:111], v[240:243]
buffer_load_dwordx2 a[200:201], v26, s[28:31], s52 offen
v_mfma_f32_16x16x32_bf16 v[240:243], a[160:163], a[104:107], v[240:243]
buffer_load_dwordx4 v6, s[8:11], s64 offen offset:1024 lds
v_mfma_f32_16x16x32_bf16 a[0:3], a[160:163], a[112:115], a[0:3]
ds_read_b64_tr_b16 a[156:157], v14 offset:8192
ds_read_b64_tr_b16 a[158:159], v14 offset:8704
v_mfma_f32_16x16x32_bf16 a[0:3], a[164:167], a[116:119], a[0:3]
v_mfma_f32_16x16x32_bf16 a[4:7], a[172:175], a[116:119], a[4:7]
s_add_u32 m0, s73, 34816
s_add_u32 s64, s71, 16384
ds_read_b128 a[92:95], v10 offset:6144
v_mfma_f32_16x16x32_bf16 a[4:7], a[168:171], a[112:115], a[4:7]
v_mfma_f32_16x16x32_bf16 a[8:11], a[176:179], a[112:115], a[8:11]
buffer_load_dwordx4 v5, s[8:11], s64 offen lds
v_mfma_f32_16x16x32_bf16 a[8:11], a[180:183], a[116:119], a[8:11]
v_mfma_f32_16x16x32_bf16 a[12:15], a[188:191], a[116:119], a[12:15]
v_mfma_f32_16x16x32_bf16 a[12:15], a[184:187], a[112:115], a[12:15]
s_add_u32 s52, s81, 17280
v_mfma_f32_16x16x32_bf16 a[28:31], a[184:187], a[120:123], a[28:31]
buffer_load_dwordx2 a[202:203], v26, s[28:31], s52 offen
v_mfma_f32_16x16x32_bf16 a[28:31], a[188:191], a[124:127], a[28:31]
buffer_load_dwordx4 v6, s[8:11], s64 offen offset:1024 lds
v_mfma_f32_16x16x32_bf16 a[24:27], a[180:183], a[124:127], a[24:27]
v_mfma_f32_16x16x32_bf16 a[24:27], a[176:179], a[120:123], a[24:27]
v_mfma_f32_16x16x32_bf16 a[20:23], a[168:171], a[120:123], a[20:23]
v_mfma_f32_16x16x32_bf16 a[20:23], a[172:175], a[124:127], a[20:23]
v_mfma_f32_16x16x32_bf16 a[16:19], a[164:167], a[124:127], a[16:19]
v_mfma_f32_16x16x32_bf16 a[16:19], a[160:163], a[120:123], a[16:19]
s_waitcnt lgkmcnt(0)
v_mfma_f32_16x16x32_bf16 v[32:35], a[64:67], a[128:131], v[32:35]
s_waitcnt vmcnt(27)
v_mfma_f32_16x16x32_bf16 v[32:35], a[68:71], a[132:135], v[32:35]
s_barrier
v_mfma_f32_16x16x32_bf16 v[40:43], a[68:71], a[140:143], v[40:43]
s_add_u32 s52, s81, 20736
ds_read_b128 a[96:99], v9 offset:8192
v_mfma_f32_16x16x32_bf16 v[40:43], a[64:67], a[136:139], v[40:43]
s_xor_b32 s76, s75, 2097152
s_add_u32 s76, s74, s76
v_mfma_f32_16x16x32_bf16 v[48:51], a[64:67], a[144:147], v[48:51]
s_add_u32 m0, s77, 0
s_add_u32 s64, s76, 0
v_mfma_f32_16x16x32_bf16 v[48:51], a[68:71], a[148:151], v[48:51]
buffer_load_dwordx4 v7, s[56:59], s64 offen lds
v_mfma_f32_16x16x32_bf16 v[56:59], a[68:71], a[156:159], v[56:59]
ds_read_b128 a[100:103], v10 offset:8192
v_mfma_f32_16x16x32_bf16 v[56:59], a[64:67], a[152:155], v[56:59]
buffer_load_dwordx2 a[204:205], v26, s[28:31], s52 offen
v_mfma_f32_16x16x32_bf16 v[60:63], a[72:75], a[152:155], v[60:63]
ds_read_b128 a[104:107], v9 offset:10240
v_mfma_f32_16x16x32_bf16 v[60:63], a[76:79], a[156:159], v[60:63]
v_mfma_f32_16x16x32_bf16 v[52:55], a[76:79], a[148:151], v[52:55]
v_mfma_f32_16x16x32_bf16 v[52:55], a[72:75], a[144:147], v[52:55]
buffer_load_dwordx4 v8, s[56:59], s64 offen offset:1024 lds
v_mfma_f32_16x16x32_bf16 v[44:47], a[72:75], a[136:139], v[44:47]
ds_read_b64_tr_b16 a[160:161], v11 offset:16384
ds_read_b64_tr_b16 a[162:163], v11 offset:16896
v_mfma_f32_16x16x32_bf16 v[44:47], a[76:79], a[140:143], v[44:47]
v_mfma_f32_16x16x32_bf16 v[36:39], a[76:79], a[132:135], v[36:39]
v_mfma_f32_16x16x32_bf16 v[36:39], a[72:75], a[128:131], v[36:39]
ds_read_b128 a[108:111], v10 offset:10240
v_mfma_f32_16x16x32_bf16 v[64:67], a[80:83], a[128:131], v[64:67]
s_add_u32 m0, s77, 2048
s_add_u32 s64, s76, 131072
s_add_u32 s52, s81, 24192
v_mfma_f32_16x16x32_bf16 v[64:67], a[84:87], a[132:135], v[64:67]
buffer_load_dwordx2 a[206:207], v26, s[28:31], s52 offen
v_mfma_f32_16x16x32_bf16 v[72:75], a[84:87], a[140:143], v[72:75]
buffer_load_dwordx4 v7, s[56:59], s64 offen lds
v_mfma_f32_16x16x32_bf16 v[72:75], a[80:83], a[136:139], v[72:75]
ds_read_b64_tr_b16 a[164:165], v11 offset:24576
ds_read_b64_tr_b16 a[166:167], v11 offset:25088
v_mfma_f32_16x16x32_bf16 v[80:83], a[80:83], a[144:147], v[80:83]
v_mfma_f32_16x16x32_bf16 v[80:83], a[84:87], a[148:151], v[80:83]
ds_read_b128 a[112:115], v9 offset:12288
v_mfma_f32_16x16x32_bf16 v[88:91], a[84:87], a[156:159], v[88:91]
v_mfma_f32_16x16x32_bf16 v[88:91], a[80:83], a[152:155], v[88:91]
v_mfma_f32_16x16x32_bf16 v[92:95], a[88:91], a[152:155], v[92:95]
ds_read_b64_tr_b16 a[168:169], v12 offset:16384
ds_read_b64_tr_b16 a[170:171], v12 offset:16896
v_mfma_f32_16x16x32_bf16 v[92:95], a[92:95], a[156:159], v[92:95]
buffer_load_dwordx4 v8, s[56:59], s64 offen offset:1024 lds
v_mfma_f32_16x16x32_bf16 v[84:87], a[92:95], a[148:151], v[84:87]
buffer_load_dwordx4 a[208:211], v27, s[36:39], s83 offen
v_mfma_f32_16x16x32_bf16 v[84:87], a[88:91], a[144:147], v[84:87]
v_mfma_f32_16x16x32_bf16 v[76:79], a[88:91], a[136:139], v[76:79]
ds_read_b128 a[116:119], v10 offset:12288
v_mfma_f32_16x16x32_bf16 v[76:79], a[92:95], a[140:143], v[76:79]
v_mfma_f32_16x16x32_bf16 v[68:71], a[92:95], a[132:135], v[68:71]
v_mfma_f32_16x16x32_bf16 v[68:71], a[88:91], a[128:131], v[68:71]
s_add_u32 m0, s73, 36864
s_add_u32 s64, s71, 524288
s_waitcnt lgkmcnt(6)
v_mfma_f32_16x16x32_bf16 v[96:99], a[96:99], a[128:131], v[96:99]
ds_read_b64_tr_b16 a[172:173], v12 offset:24576
ds_read_b64_tr_b16 a[174:175], v12 offset:25088
v_mfma_f32_16x16x32_bf16 v[96:99], a[100:103], a[132:135], v[96:99]
buffer_load_dwordx4 v5, s[8:11], s64 offen lds
v_mfma_f32_16x16x32_bf16 v[104:107], a[100:103], a[140:143], v[104:107]
ds_read_b128 a[120:123], v9 offset:14336
v_mfma_f32_16x16x32_bf16 v[104:107], a[96:99], a[136:139], v[104:107]
v_mfma_f32_16x16x32_bf16 v[112:115], a[96:99], a[144:147], v[112:115]
v_mfma_f32_16x16x32_bf16 v[112:115], a[100:103], a[148:151], v[112:115]
ds_read_b64_tr_b16 a[176:177], v13 offset:16384
ds_read_b64_tr_b16 a[178:179], v13 offset:16896
v_mfma_f32_16x16x32_bf16 v[120:123], a[100:103], a[156:159], v[120:123]
v_mfma_f32_16x16x32_bf16 v[120:123], a[96:99], a[152:155], v[120:123]
v_mfma_f32_16x16x32_bf16 v[124:127], a[104:107], a[152:155], v[124:127]
buffer_load_dwordx4 v6, s[8:11], s64 offen offset:1024 lds
v_mfma_f32_16x16x32_bf16 v[124:127], a[108:111], a[156:159], v[124:127]
ds_read_b128 a[124:127], v10 offset:14336
v_mfma_f32_16x16x32_bf16 v[116:119], a[108:111], a[148:151], v[116:119]
v_add_u32 v9, -65536, v9
v_add_u32 v10, -65536, v10
v_mfma_f32_16x16x32_bf16 v[116:119], a[104:107], a[144:147], v[116:119]
v_mfma_f32_16x16x32_bf16 v[108:111], a[104:107], a[136:139], v[108:111]
ds_read_b64_tr_b16 a[180:181], v13 offset:24576
ds_read_b64_tr_b16 a[182:183], v13 offset:25088
v_mfma_f32_16x16x32_bf16 v[108:111], a[108:111], a[140:143], v[108:111]
s_add_u32 m0, s73, 38912
s_add_u32 s64, s71, 540672
v_mfma_f32_16x16x32_bf16 v[100:103], a[108:111], a[132:135], v[100:103]
s_waitcnt lgkmcnt(2)
v_mfma_f32_16x16x32_bf16 v[100:103], a[104:107], a[128:131], v[100:103]
buffer_load_dwordx4 v5, s[8:11], s64 offen lds
v_mfma_f32_16x16x32_bf16 v[128:131], a[112:115], a[128:131], v[128:131]
ds_read_b64_tr_b16 a[184:185], v14 offset:16384
ds_read_b64_tr_b16 a[186:187], v14 offset:16896
v_mfma_f32_16x16x32_bf16 v[128:131], a[116:119], a[132:135], v[128:131]
v_mfma_f32_16x16x32_bf16 v[136:139], a[116:119], a[140:143], v[136:139]
ds_read_b64_tr_b16 a[188:189], v14 offset:24576
ds_read_b64_tr_b16 a[190:191], v14 offset:25088
v_mfma_f32_16x16x32_bf16 v[136:139], a[112:115], a[136:139], v[136:139]
v_mfma_f32_16x16x32_bf16 v[144:147], a[112:115], a[144:147], v[144:147]
v_mfma_f32_16x16x32_bf16 v[144:147], a[116:119], a[148:151], v[144:147]
v_mfma_f32_16x16x32_bf16 v[152:155], a[116:119], a[156:159], v[152:155]
buffer_load_dwordx4 v6, s[8:11], s64 offen offset:1024 lds
v_mfma_f32_16x16x32_bf16 v[152:155], a[112:115], a[152:155], v[152:155]
v_mfma_f32_16x16x32_bf16 v[156:159], a[120:123], a[152:155], v[156:159]
v_mfma_f32_16x16x32_bf16 v[156:159], a[124:127], a[156:159], v[156:159]
v_mfma_f32_16x16x32_bf16 v[148:151], a[124:127], a[148:151], v[148:151]
v_mfma_f32_16x16x32_bf16 v[148:151], a[120:123], a[144:147], v[148:151]
v_mfma_f32_16x16x32_bf16 v[140:143], a[120:123], a[136:139], v[140:143]
v_mfma_f32_16x16x32_bf16 v[140:143], a[124:127], a[140:143], v[140:143]
v_mfma_f32_16x16x32_bf16 v[132:135], a[124:127], a[132:135], v[132:135]
v_mfma_f32_16x16x32_bf16 v[132:135], a[120:123], a[128:131], v[132:135]
s_waitcnt lgkmcnt(0)
v_mfma_f32_16x16x32_bf16 v[160:163], a[160:163], a[64:67], v[160:163]
s_waitcnt vmcnt(23)
v_mfma_f32_16x16x32_bf16 v[160:163], a[164:167], a[68:71], v[160:163]
s_barrier
v_mfma_f32_16x16x32_bf16 v[164:167], a[172:175], a[68:71], v[164:167]
s_waitcnt vmcnt(4)
ds_read_b64_tr_b16 a[128:129], v11 offset:32768
ds_read_b64_tr_b16 a[130:131], v11 offset:33280
v_mfma_f32_16x16x32_bf16 v[164:167], a[168:171], a[64:67], v[164:167]
s_add_u32 m0, s77, 16384
s_add_u32 s64, s76, 0
v_accvgpr_read_b32 v16, a192
v_mfma_f32_16x16x32_bf16 v[168:171], a[176:179], a[64:67], v[168:171]
buffer_load_dwordx4 v7, s[16:19], s64 offen lds
v_mfma_f32_16x16x32_bf16 v[168:171], a[180:183], a[68:71], v[168:171]
v_accvgpr_read_b32 v17, a194
v_accvgpr_read_b32 v18, a196
v_mfma_f32_16x16x32_bf16 v[172:175], a[188:191], a[68:71], v[172:175]
v_accvgpr_read_b32 v19, a198
v_accvgpr_read_b32 v20, a200
v_mfma_f32_16x16x32_bf16 v[172:175], a[184:187], a[64:67], v[172:175]
ds_read_b128 a[64:67], v9 offset:0
v_accvgpr_read_b32 v21, a202
v_mfma_f32_16x16x32_bf16 v[188:191], a[184:187], a[72:75], v[188:191]
ds_read_b64_tr_b16 a[132:133], v11 offset:40960
ds_read_b64_tr_b16 a[134:135], v11 offset:41472
v_mfma_f32_16x16x32_bf16 v[188:191], a[188:191], a[76:79], v[188:191]
L_PAD1:
s_cbranch_execz L_PAD5
v_accvgpr_read_b32 v22, a204
v_accvgpr_read_b32 v23, a206
v_mfma_f32_16x16x32_bf16 v[184:187], a[180:183], a[76:79], v[184:187]
v_mfma_f32_16x16x32_bf16 v[184:187], a[176:179], a[72:75], v[184:187]
buffer_load_dwordx4 v8, s[16:19], s64 offen offset:1024 lds
v_mfma_f32_16x16x32_bf16 v[180:183], a[168:171], a[72:75], v[180:183]
ds_read_b128 a[68:71], v10 offset:0
v_perm_b32 v24, v17, v16, s85
v_mfma_f32_16x16x32_bf16 v[180:183], a[172:175], a[76:79], v[180:183]
v_perm_b32 v25, v19, v18, s85
v_perm_b32 v26, v21, v20, s85
v_mfma_f32_16x16x32_bf16 v[176:179], a[164:167], a[76:79], v[176:179]
v_perm_b32 v27, v23, v22, s85
v_perm_b32 v28, v17, v16, s86
v_mfma_f32_16x16x32_bf16 v[176:179], a[160:163], a[72:75], v[176:179]
ds_read_b64_tr_b16 a[136:137], v12 offset:32768
ds_read_b64_tr_b16 a[138:139], v12 offset:33280
v_mfma_f32_16x16x32_bf16 v[192:195], a[160:163], a[80:83], v[192:195]
s_add_u32 m0, s77, 18432
s_add_u32 s64, s76, 131072
v_perm_b32 v29, v19, v18, s86
v_mfma_f32_16x16x32_bf16 v[192:195], a[164:167], a[84:87], v[192:195]
v_perm_b32 v30, v21, v20, s86
v_perm_b32 v31, v23, v22, s86
v_mfma_f32_16x16x32_bf16 v[196:199], a[172:175], a[84:87], v[196:199]
buffer_load_dwordx4 v7, s[16:19], s64 offen lds
v_mfma_f32_16x16x32_bf16 v[196:199], a[168:171], a[80:83], v[196:199]
ds_read_b128 a[72:75], v9 offset:2048
v_accvgpr_read_b32 v16, a208
v_mfma_f32_16x16x32_bf16 v[200:203], a[176:179], a[80:83], v[200:203]
v_accvgpr_read_b32 v17, a209
v_accvgpr_read_b32 v18, a210
v_mfma_f32_16x16x32_bf16 v[200:203], a[180:183], a[84:87], v[200:203]
ds_read_b64_tr_b16 a[140:141], v12 offset:40960
ds_read_b64_tr_b16 a[142:143], v12 offset:41472
v_mfma_f32_16x16x32_bf16 v[204:207], a[188:191], a[84:87], v[204:207]
v_accvgpr_read_b32 v19, a211
v_or_b32 v24, v24, v16
v_mfma_f32_16x16x32_bf16 v[204:207], a[184:187], a[80:83], v[204:207]
v_or_b32 v25, v25, v17
v_or_b32 v26, v26, v18
v_mfma_f32_16x16x32_bf16 v[220:223], a[184:187], a[88:91], v[220:223]
ds_read_b128 a[76:79], v10 offset:2048
v_or_b32 v27, v27, v19
v_mfma_f32_16x16x32_bf16 v[220:223], a[188:191], a[92:95], v[220:223]
buffer_load_dwordx4 v8, s[16:19], s64 offen offset:1024 lds
v_mfma_f32_16x16x32_bf16 v[216:219], a[180:183], a[92:95], v[216:219]
s_xor_b32 s71, s70, 640
s_add_u32 s71, s68, s71
v_mfma_f32_16x16x32_bf16 v[216:219], a[176:179], a[88:91], v[216:219]
buffer_store_dwordx4 v[24:27], v4, s[24:27], s82 offen offset:0 sc1
v_mfma_f32_16x16x32_bf16 v[212:215], a[168:171], a[88:91], v[212:215]
ds_read_b64_tr_b16 a[144:145], v13 offset:32768
ds_read_b64_tr_b16 a[146:147], v13 offset:33280
v_mfma_f32_16x16x32_bf16 v[212:215], a[172:175], a[92:95], v[212:215]
v_mfma_f32_16x16x32_bf16 v[208:211], a[164:167], a[92:95], v[208:211]
v_mfma_f32_16x16x32_bf16 v[208:211], a[160:163], a[88:91], v[208:211]
s_add_u32 m0, s73, 65536
s_add_u32 s64, s71, 0
ds_read_b128 a[80:83], v9 offset:4096
v_mfma_f32_16x16x32_bf16 v[224:227], a[160:163], a[96:99], v[224:227]
v_mfma_f32_16x16x32_bf16 v[224:227], a[164:167], a[100:103], v[224:227]
buffer_load_dwordx4 v5, s[8:11], s64 offen lds
v_mfma_f32_16x16x32_bf16 v[228:231], a[172:175], a[100:103], v[228:231]
ds_read_b64_tr_b16 a[148:149], v13 offset:40960
ds_read_b64_tr_b16 a[150:151], v13 offset:41472
v_mfma_f32_16x16x32_bf16 v[228:231], a[168:171], a[96:99], v[228:231]
v_mfma_f32_16x16x32_bf16 v[232:235], a[176:179], a[96:99], v[232:235]
v_mfma_f32_16x16x32_bf16 v[232:235], a[180:183], a[100:103], v[232:235]
ds_read_b128 a[84:87], v10 offset:4096
v_mfma_f32_16x16x32_bf16 v[236:239], a[188:191], a[100:103], v[236:239]
buffer_store_dwordx4 v[28:31], v4, s[24:27], s82 offen offset:1024 sc1
v_mfma_f32_16x16x32_bf16 v[236:239], a[184:187], a[96:99], v[236:239]
v_accvgpr_read_b32 v16, a193
v_accvgpr_read_b32 v17, a195
v_mfma_f32_16x16x32_bf16 v[252:255], a[184:187], a[104:107], v[252:255]
buffer_load_dwordx4 v6, s[8:11], s64 offen offset:1024 lds
v_mfma_f32_16x16x32_bf16 v[252:255], a[188:191], a[108:111], v[252:255]
ds_read_b64_tr_b16 a[152:153], v14 offset:32768
ds_read_b64_tr_b16 a[154:155], v14 offset:33280
v_mfma_f32_16x16x32_bf16 v[248:251], a[180:183], a[108:111], v[248:251]
v_accvgpr_read_b32 v18, a197
v_accvgpr_read_b32 v19, a199
v_mfma_f32_16x16x32_bf16 v[248:251], a[176:179], a[104:107], v[248:251]
v_accvgpr_read_b32 v20, a201
v_accvgpr_read_b32 v21, a203
v_mfma_f32_16x16x32_bf16 v[244:247], a[168:171], a[104:107], v[244:247]
ds_read_b128 a[88:91], v9 offset:6144
v_accvgpr_read_b32 v22, a205
v_mfma_f32_16x16x32_bf16 v[244:247], a[172:175], a[108:111], v[244:247]
s_add_u32 m0, s73, 67584
s_add_u32 s64, s71, 16384
v_accvgpr_read_b32 v23, a207
v_mfma_f32_16x16x32_bf16 v[240:243], a[164:167], a[108:111], v[240:243]
v_mfma_f32_16x16x32_bf16 v[240:243], a[160:163], a[104:107], v[240:243]
buffer_load_dwordx4 v5, s[8:11], s64 offen lds
v_mfma_f32_16x16x32_bf16 a[0:3], a[160:163], a[112:115], a[0:3]
ds_read_b64_tr_b16 a[156:157], v14 offset:40960
ds_read_b64_tr_b16 a[158:159], v14 offset:41472
v_mfma_f32_16x16x32_bf16 a[0:3], a[164:167], a[116:119], a[0:3]
v_perm_b32 v24, v17, v16, s85
v_perm_b32 v25, v19, v18, s85
v_mfma_f32_16x16x32_bf16 a[4:7], a[172:175], a[116:119], a[4:7]
ds_read_b128 a[92:95], v10 offset:6144
v_perm_b32 v26, v21, v20, s85
v_mfma_f32_16x16x32_bf16 a[4:7], a[168:171], a[112:115], a[4:7]
v_perm_b32 v27, v23, v22, s85
v_perm_b32 v28, v17, v16, s86
v_mfma_f32_16x16x32_bf16 a[8:11], a[176:179], a[112:115], a[8:11]
v_perm_b32 v29, v19, v18, s86
v_perm_b32 v30, v21, v20, s86
v_mfma_f32_16x16x32_bf16 a[8:11], a[180:183], a[116:119], a[8:11]
v_perm_b32 v31, v23, v22, s86
v_mfma_f32_16x16x32_bf16 a[12:15], a[188:191], a[116:119], a[12:15]
buffer_load_dwordx4 v6, s[8:11], s64 offen offset:1024 lds
v_mfma_f32_16x16x32_bf16 a[12:15], a[184:187], a[112:115], a[12:15]
buffer_store_dwordx4 v[24:27], v4, s[24:27], s82 offen offset:2048 sc1
v_mfma_f32_16x16x32_bf16 a[28:31], a[184:187], a[120:123], a[28:31]
v_mfma_f32_16x16x32_bf16 a[28:31], a[188:191], a[124:127], a[28:31]
v_mfma_f32_16x16x32_bf16 a[24:27], a[180:183], a[124:127], a[24:27]
v_mfma_f32_16x16x32_bf16 a[24:27], a[176:179], a[120:123], a[24:27]
v_mfma_f32_16x16x32_bf16 a[20:23], a[168:171], a[120:123], a[20:23]
v_mfma_f32_16x16x32_bf16 a[20:23], a[172:175], a[124:127], a[20:23]
v_mfma_f32_16x16x32_bf16 a[16:19], a[164:167], a[124:127], a[16:19]
v_mfma_f32_16x16x32_bf16 a[16:19], a[160:163], a[120:123], a[16:19]
s_waitcnt lgkmcnt(0)
v_mfma_f32_16x16x32_bf16 v[32:35], a[64:67], a[128:131], v[32:35]
s_waitcnt vmcnt(28)
v_mfma_f32_16x16x32_bf16 v[32:35], a[68:71], a[132:135], v[32:35]
s_barrier
v_mfma_f32_16x16x32_bf16 v[40:43], a[68:71], a[140:143], v[40:43]
ds_read_b128 a[96:99], v9 offset:8192
v_mfma_f32_16x16x32_bf16 v[40:43], a[64:67], a[136:139], v[40:43]
s_xor_b32 s76, s75, 2621440
s_add_u32 s76, s74, s76
v_mfma_f32_16x16x32_bf16 v[48:51], a[64:67], a[144:147], v[48:51]
s_add_u32 m0, s77, 32768
s_add_u32 s64, s76, 0
v_mfma_f32_16x16x32_bf16 v[48:51], a[68:71], a[148:151], v[48:51]
buffer_load_dwordx4 v7, s[56:59], s64 offen lds
v_mfma_f32_16x16x32_bf16 v[56:59], a[68:71], a[156:159], v[56:59]
ds_read_b128 a[100:103], v10 offset:8192
v_mfma_f32_16x16x32_bf16 v[56:59], a[64:67], a[152:155], v[56:59]
buffer_store_dwordx4 v[28:31], v4, s[24:27], s82 offen offset:3072 sc1
v_mfma_f32_16x16x32_bf16 v[60:63], a[72:75], a[152:155], v[60:63]
s_lshl_b32 s52, s7, 4
ds_read_b128 a[104:107], v9 offset:10240
v_and_b32 v22, 3, v1
v_mfma_f32_16x16x32_bf16 v[60:63], a[76:79], a[156:159], v[60:63]
v_lshl_add_u32 v22, v22, 2, s52
v_mfma_f32_16x16x32_bf16 v[52:55], a[76:79], a[148:151], v[52:55]
buffer_load_dword v23, v22, s[40:43], 0 offen sc1
v_mfma_f32_16x16x32_bf16 v[52:55], a[72:75], a[144:147], v[52:55]
buffer_load_dwordx4 v8, s[56:59], s64 offen offset:1024 lds
v_mfma_f32_16x16x32_bf16 v[44:47], a[72:75], a[136:139], v[44:47]
ds_read_b64_tr_b16 a[160:161], v11 offset:49152
ds_read_b64_tr_b16 a[162:163], v11 offset:49664
v_mfma_f32_16x16x32_bf16 v[44:47], a[76:79], a[140:143], v[44:47]
v_mfma_f32_16x16x32_bf16 v[36:39], a[76:79], a[132:135], v[36:39]
v_mfma_f32_16x16x32_bf16 v[36:39], a[72:75], a[128:131], v[36:39]
ds_read_b128 a[108:111], v10 offset:10240
v_mfma_f32_16x16x32_bf16 v[64:67], a[80:83], a[128:131], v[64:67]
s_add_u32 m0, s77, 34816
s_add_u32 s64, s76, 131072
v_mfma_f32_16x16x32_bf16 v[64:67], a[84:87], a[132:135], v[64:67]
v_mfma_f32_16x16x32_bf16 v[72:75], a[84:87], a[140:143], v[72:75]
buffer_load_dwordx4 v7, s[56:59], s64 offen lds
v_mfma_f32_16x16x32_bf16 v[72:75], a[80:83], a[136:139], v[72:75]
ds_read_b64_tr_b16 a[164:165], v11 offset:57344
ds_read_b64_tr_b16 a[166:167], v11 offset:57856
v_mfma_f32_16x16x32_bf16 v[80:83], a[80:83], a[144:147], v[80:83]
v_mfma_f32_16x16x32_bf16 v[80:83], a[84:87], a[148:151], v[80:83]
ds_read_b128 a[112:115], v9 offset:12288
v_mfma_f32_16x16x32_bf16 v[88:91], a[84:87], a[156:159], v[88:91]
v_mfma_f32_16x16x32_bf16 v[88:91], a[80:83], a[152:155], v[88:91]
v_mfma_f32_16x16x32_bf16 v[92:95], a[88:91], a[152:155], v[92:95]
ds_read_b64_tr_b16 a[168:169], v12 offset:49152
ds_read_b64_tr_b16 a[170:171], v12 offset:49664
v_mfma_f32_16x16x32_bf16 v[92:95], a[92:95], a[156:159], v[92:95]
buffer_load_dwordx4 v8, s[56:59], s64 offen offset:1024 lds
v_mfma_f32_16x16x32_bf16 v[84:87], a[92:95], a[148:151], v[84:87]
v_mfma_f32_16x16x32_bf16 v[84:87], a[88:91], a[144:147], v[84:87]
v_mfma_f32_16x16x32_bf16 v[76:79], a[88:91], a[136:139], v[76:79]
ds_read_b128 a[116:119], v10 offset:12288
v_mfma_f32_16x16x32_bf16 v[76:79], a[92:95], a[140:143], v[76:79]
v_mfma_f32_16x16x32_bf16 v[68:71], a[92:95], a[132:135], v[68:71]
v_mfma_f32_16x16x32_bf16 v[68:71], a[88:91], a[128:131], v[68:71]
s_add_u32 m0, s73, 69632
s_add_u32 s64, s71, 524288
s_waitcnt lgkmcnt(6)
v_mfma_f32_16x16x32_bf16 v[96:99], a[96:99], a[128:131], v[96:99]
ds_read_b64_tr_b16 a[172:173], v12 offset:57344
ds_read_b64_tr_b16 a[174:175], v12 offset:57856
v_mfma_f32_16x16x32_bf16 v[96:99], a[100:103], a[132:135], v[96:99]
buffer_load_dwordx4 v5, s[8:11], s64 offen lds
v_mfma_f32_16x16x32_bf16 v[104:107], a[100:103], a[140:143], v[104:107]
ds_read_b128 a[120:123], v9 offset:14336
v_mfma_f32_16x16x32_bf16 v[104:107], a[96:99], a[136:139], v[104:107]
v_mfma_f32_16x16x32_bf16 v[112:115], a[96:99], a[144:147], v[112:115]
v_mfma_f32_16x16x32_bf16 v[112:115], a[100:103], a[148:151], v[112:115]
ds_read_b64_tr_b16 a[176:177], v13 offset:49152
ds_read_b64_tr_b16 a[178:179], v13 offset:49664
v_mfma_f32_16x16x32_bf16 v[120:123], a[100:103], a[156:159], v[120:123]
v_mfma_f32_16x16x32_bf16 v[120:123], a[96:99], a[152:155], v[120:123]
v_mfma_f32_16x16x32_bf16 v[124:127], a[104:107], a[152:155], v[124:127]
buffer_load_dwordx4 v6, s[8:11], s64 offen offset:1024 lds
v_mfma_f32_16x16x32_bf16 v[124:127], a[108:111], a[156:159], v[124:127]
ds_read_b128 a[124:127], v10 offset:14336
v_mfma_f32_16x16x32_bf16 v[116:119], a[108:111], a[148:151], v[116:119]
v_add_u32 v9, 32768, v9
v_add_u32 v10, 32768, v10
v_mfma_f32_16x16x32_bf16 v[116:119], a[104:107], a[144:147], v[116:119]
v_mfma_f32_16x16x32_bf16 v[108:111], a[104:107], a[136:139], v[108:111]
ds_read_b64_tr_b16 a[180:181], v13 offset:57344
ds_read_b64_tr_b16 a[182:183], v13 offset:57856
v_mfma_f32_16x16x32_bf16 v[108:111], a[108:111], a[140:143], v[108:111]
s_add_u32 m0, s73, 71680
s_add_u32 s64, s71, 540672
v_mfma_f32_16x16x32_bf16 v[100:103], a[108:111], a[132:135], v[100:103]
s_waitcnt lgkmcnt(2)
v_mfma_f32_16x16x32_bf16 v[100:103], a[104:107], a[128:131], v[100:103]
buffer_load_dwordx4 v5, s[8:11], s64 offen lds
v_mfma_f32_16x16x32_bf16 v[128:131], a[112:115], a[128:131], v[128:131]
ds_read_b64_tr_b16 a[184:185], v14 offset:49152
ds_read_b64_tr_b16 a[186:187], v14 offset:49664
v_mfma_f32_16x16x32_bf16 v[128:131], a[116:119], a[132:135], v[128:131]
v_mfma_f32_16x16x32_bf16 v[136:139], a[116:119], a[140:143], v[136:139]
ds_read_b64_tr_b16 a[188:189], v14 offset:57344
ds_read_b64_tr_b16 a[190:191], v14 offset:57856
v_mfma_f32_16x16x32_bf16 v[136:139], a[112:115], a[136:139], v[136:139]
v_mfma_f32_16x16x32_bf16 v[144:147], a[112:115], a[144:147], v[144:147]
v_mfma_f32_16x16x32_bf16 v[144:147], a[116:119], a[148:151], v[144:147]
v_mfma_f32_16x16x32_bf16 v[152:155], a[116:119], a[156:159], v[152:155]
buffer_load_dwordx4 v6, s[8:11], s64 offen offset:1024 lds
v_mfma_f32_16x16x32_bf16 v[152:155], a[112:115], a[152:155], v[152:155]
v_mfma_f32_16x16x32_bf16 v[156:159], a[120:123], a[152:155], v[156:159]
v_mfma_f32_16x16x32_bf16 v[156:159], a[124:127], a[156:159], v[156:159]
v_mfma_f32_16x16x32_bf16 v[148:151], a[124:127], a[148:151], v[148:151]
v_mfma_f32_16x16x32_bf16 v[148:151], a[120:123], a[144:147], v[148:151]
s_waitcnt vmcnt(7)
v_mfma_f32_16x16x32_bf16 v[140:143], a[120:123], a[136:139], v[140:143]
v_cmp_gt_u32 vcc, 1, v23
v_mfma_f32_16x16x32_bf16 v[140:143], a[124:127], a[140:143], v[140:143]
v_mfma_f32_16x16x32_bf16 v[132:135], a[124:127], a[132:135], v[132:135]
v_mfma_f32_16x16x32_bf16 v[132:135], a[120:123], a[128:131], v[132:135]
s_waitcnt lgkmcnt(0)
v_mfma_f32_16x16x32_bf16 v[160:163], a[160:163], a[64:67], v[160:163]
s_waitcnt vmcnt(21)
v_mfma_f32_16x16x32_bf16 v[160:163], a[164:167], a[68:71], v[160:163]
s_barrier
v_mfma_f32_16x16x32_bf16 v[164:167], a[172:175], a[68:71], v[164:167]
ds_read_b64_tr_b16 a[128:129], v11 offset:0
ds_read_b64_tr_b16 a[130:131], v11 offset:512
v_mfma_f32_16x16x32_bf16 v[164:167], a[168:171], a[64:67], v[164:167]
s_add_u32 m0, s77, 49152
s_add_u32 s64, s76, 0
v_mfma_f32_16x16x32_bf16 v[168:171], a[176:179], a[64:67], v[168:171]
buffer_load_dwordx4 v7, s[16:19], s64 offen lds
v_mfma_f32_16x16x32_bf16 v[168:171], a[180:183], a[68:71], v[168:171]
s_cbranch_vccnz CK_Z
CK_Z_R:
v_mfma_f32_16x16x32_bf16 v[172:175], a[188:191], a[68:71], v[172:175]
buffer_atomic_add v1, v0, s[24:27], s84 offen offset:0 sc1
v_mfma_f32_16x16x32_bf16 v[172:175], a[184:187], a[64:67], v[172:175]
s_lshl2_add_u32 s52, s95, s3
s_lshl3_add_u32 s54, s52, s7
ds_read_b128 a[64:67], v9 offset:0
v_mfma_f32_16x16x32_bf16 v[188:191], a[184:187], a[72:75], v[188:191]
s_mul_i32 s53, s54, 3072
ds_read_b64_tr_b16 a[132:133], v11 offset:8192
ds_read_b64_tr_b16 a[134:135], v11 offset:8704
v_mfma_f32_16x16x32_bf16 v[188:191], a[188:191], a[76:79], v[188:191]
s_mul_i32 s52, s52, 48
s_add_u32 s52, s52, s7
s_lshl_b32 s52, s52, 10
v_mfma_f32_16x16x32_bf16 v[184:187], a[180:183], a[76:79], v[184:187]
v_min_u32 v18, 23, v1
v_lshrrev_b32 v16, 3, v18
v_mfma_f32_16x16x32_bf16 v[184:187], a[176:179], a[72:75], v[184:187]
buffer_load_dwordx4 v8, s[16:19], s64 offen offset:1024 lds
v_mfma_f32_16x16x32_bf16 v[180:183], a[168:171], a[72:75], v[180:183]
ds_read_b128 a[68:71], v10 offset:0
v_and_b32 v17, 7, v18
v_mfma_f32_16x16x32_bf16 v[180:183], a[172:175], a[76:79], v[180:183]
v_lshlrev_b32 v16, 13, v16
v_lshl_add_u32 v16, v17, 7, v16
v_mfma_f32_16x16x32_bf16 v[176:179], a[164:167], a[76:79], v[176:179]
v_lshlrev_b32 v18, 7, v18
v_min_u32 v17, 6, v1
v_mfma_f32_16x16x32_bf16 v[176:179], a[160:163], a[72:75], v[176:179]
ds_read_b64_tr_b16 a[136:137], v12 offset:0
ds_read_b64_tr_b16 a[138:139], v12 offset:512
v_mfma_f32_16x16x32_bf16 v[192:195], a[160:163], a[80:83], v[192:195]
s_add_u32 m0, s77, 51200
s_add_u32 s64, s76, 131072
v_lshlrev_b32 v17, 7, v17
v_mfma_f32_16x16x32_bf16 v[192:195], a[164:167], a[84:87], v[192:195]
v_mov_b32 v29, 0
v_mfma_f32_16x16x32_bf16 v[196:199], a[172:175], a[84:87], v[196:199]
buffer_load_dwordx4 v7, s[16:19], s64 offen lds
v_mfma_f32_16x16x32_bf16 v[196:199], a[168:171], a[80:83], v[196:199]
ds_read_b128 a[72:75], v9 offset:2048
v_mfma_f32_16x16x32_bf16 v[200:203], a[176:179], a[80:83], v[200:203]
buffer_load_dword a253, v18, s[12:15], s53 offen
v_mfma_f32_16x16x32_bf16 v[200:203], a[180:183], a[84:87], v[200:203]
ds_read_b64_tr_b16 a[140:141], v12 offset:8192
ds_read_b64_tr_b16 a[142:143], v12 offset:8704
v_mfma_f32_16x16x32_bf16 v[204:207], a[188:191], a[84:87], v[204:207]
v_mfma_f32_16x16x32_bf16 v[204:207], a[184:187], a[80:83], v[204:207]
v_mfma_f32_16x16x32_bf16 v[220:223], a[184:187], a[88:91], v[220:223]
ds_read_b128 a[76:79], v10 offset:2048
v_mfma_f32_16x16x32_bf16 v[220:223], a[188:191], a[92:95], v[220:223]
buffer_load_dwordx4 v8, s[16:19], s64 offen offset:1024 lds
v_mfma_f32_16x16x32_bf16 v[216:219], a[180:183], a[92:95], v[216:219]
s_xor_b32 s71, s70, 768
s_add_u32 s71, s68, s71
v_mfma_f32_16x16x32_bf16 v[216:219], a[176:179], a[88:91], v[216:219]
v_mfma_f32_16x16x32_bf16 v[212:215], a[168:171], a[88:91], v[212:215]
ds_read_b64_tr_b16 a[144:145], v13 offset:0
ds_read_b64_tr_b16 a[146:147], v13 offset:512
v_mfma_f32_16x16x32_bf16 v[212:215], a[172:175], a[92:95], v[212:215]
v_mfma_f32_16x16x32_bf16 v[208:211], a[164:167], a[92:95], v[208:211]
v_mfma_f32_16x16x32_bf16 v[208:211], a[160:163], a[88:91], v[208:211]
s_add_u32 m0, s73, 0
s_add_u32 s64, s71, 0
ds_read_b128 a[80:83], v9 offset:4096
v_mfma_f32_16x16x32_bf16 v[224:227], a[160:163], a[96:99], v[224:227]
v_mfma_f32_16x16x32_bf16 v[224:227], a[164:167], a[100:103], v[224:227]
buffer_load_dwordx4 v5, s[8:11], s64 offen lds
v_mfma_f32_16x16x32_bf16 v[228:231], a[172:175], a[100:103], v[228:231]
ds_read_b64_tr_b16 a[148:149], v13 offset:8192
ds_read_b64_tr_b16 a[150:151], v13 offset:8704
v_mfma_f32_16x16x32_bf16 v[228:231], a[168:171], a[96:99], v[228:231]
v_mfma_f32_16x16x32_bf16 v[232:235], a[176:179], a[96:99], v[232:235]
v_mfma_f32_16x16x32_bf16 v[232:235], a[180:183], a[100:103], v[232:235]
ds_read_b128 a[84:87], v10 offset:4096
v_mfma_f32_16x16x32_bf16 v[236:239], a[188:191], a[100:103], v[236:239]
v_mfma_f32_16x16x32_bf16 v[236:239], a[184:187], a[96:99], v[236:239]
v_mfma_f32_16x16x32_bf16 v[252:255], a[184:187], a[104:107], v[252:255]
buffer_load_dwordx4 v6, s[8:11], s64 offen offset:1024 lds
v_mfma_f32_16x16x32_bf16 v[252:255], a[188:191], a[108:111], v[252:255]
ds_read_b64_tr_b16 a[152:153], v14 offset:0
ds_read_b64_tr_b16 a[154:155], v14 offset:512
v_mfma_f32_16x16x32_bf16 v[248:251], a[180:183], a[108:111], v[248:251]
v_mfma_f32_16x16x32_bf16 v[248:251], a[176:179], a[104:107], v[248:251]
v_mfma_f32_16x16x32_bf16 v[244:247], a[168:171], a[104:107], v[244:247]
ds_read_b128 a[88:91], v9 offset:6144
v_mfma_f32_16x16x32_bf16 v[244:247], a[172:175], a[108:111], v[244:247]
s_add_u32 m0, s73, 2048
s_add_u32 s64, s71, 16384
v_mfma_f32_16x16x32_bf16 v[240:243], a[164:167], a[108:111], v[240:243]
v_mfma_f32_16x16x32_bf16 v[240:243], a[160:163], a[104:107], v[240:243]
buffer_load_dwordx4 v5, s[8:11], s64 offen lds
v_mfma_f32_16x16x32_bf16 a[0:3], a[160:163], a[112:115], a[0:3]
ds_read_b64_tr_b16 a[156:157], v14 offset:8192
ds_read_b64_tr_b16 a[158:159], v14 offset:8704
v_mfma_f32_16x16x32_bf16 a[0:3], a[164:167], a[116:119], a[0:3]
v_mfma_f32_16x16x32_bf16 a[4:7], a[172:175], a[116:119], a[4:7]
ds_read_b128 a[92:95], v10 offset:6144
v_mfma_f32_16x16x32_bf16 a[4:7], a[168:171], a[112:115], a[4:7]
v_mfma_f32_16x16x32_bf16 a[8:11], a[176:179], a[112:115], a[8:11]
v_mfma_f32_16x16x32_bf16 a[8:11], a[180:183], a[116:119], a[8:11]
v_mfma_f32_16x16x32_bf16 a[12:15], a[188:191], a[116:119], a[12:15]
buffer_load_dwordx4 v6, s[8:11], s64 offen offset:1024 lds
v_mfma_f32_16x16x32_bf16 a[12:15], a[184:187], a[112:115], a[12:15]
v_mfma_f32_16x16x32_bf16 a[28:31], a[184:187], a[120:123], a[28:31]
v_mfma_f32_16x16x32_bf16 a[28:31], a[188:191], a[124:127], a[28:31]
v_mfma_f32_16x16x32_bf16 a[24:27], a[180:183], a[124:127], a[24:27]
v_mfma_f32_16x16x32_bf16 a[24:27], a[176:179], a[120:123], a[24:27]
v_mfma_f32_16x16x32_bf16 a[20:23], a[168:171], a[120:123], a[20:23]
v_mfma_f32_16x16x32_bf16 a[20:23], a[172:175], a[124:127], a[20:23]
v_mfma_f32_16x16x32_bf16 a[16:19], a[164:167], a[124:127], a[16:19]
v_mfma_f32_16x16x32_bf16 a[16:19], a[160:163], a[120:123], a[16:19]
s_waitcnt lgkmcnt(0)
v_mfma_f32_16x16x32_bf16 v[32:35], a[64:67], a[128:131], v[32:35]
s_waitcnt vmcnt(27)
v_mfma_f32_16x16x32_bf16 v[32:35], a[68:71], a[132:135], v[32:35]
s_barrier
v_mfma_f32_16x16x32_bf16 v[40:43], a[68:71], a[140:143], v[40:43]
ds_read_b128 a[96:99], v9 offset:8192
v_mfma_f32_16x16x32_bf16 v[40:43], a[64:67], a[136:139], v[40:43]
s_xor_b32 s76, s75, 3145728
s_add_u32 s76, s74, s76
v_mfma_f32_16x16x32_bf16 v[48:51], a[64:67], a[144:147], v[48:51]
s_add_u32 m0, s77, 0
s_add_u32 s64, s76, 0
v_mfma_f32_16x16x32_bf16 v[48:51], a[68:71], a[148:151], v[48:51]
buffer_load_dwordx4 v7, s[56:59], s64 offen lds
v_mfma_f32_16x16x32_bf16 v[56:59], a[68:71], a[156:159], v[56:59]
ds_read_b128 a[100:103], v10 offset:8192
v_mfma_f32_16x16x32_bf16 v[56:59], a[64:67], a[152:155], v[56:59]
buffer_load_dword a252, v16, s[20:23], s52 offen
v_mfma_f32_16x16x32_bf16 v[60:63], a[72:75], a[152:155], v[60:63]
ds_read_b128 a[104:107], v9 offset:10240
v_mfma_f32_16x16x32_bf16 v[60:63], a[76:79], a[156:159], v[60:63]
s_add_u32 s52, s52, 24576
s_lshl_b32 s53, s53, 1
s_mul_i32 s54, s54, 896
v_mfma_f32_16x16x32_bf16 v[52:55], a[76:79], a[148:151], v[52:55]
v_mfma_f32_16x16x32_bf16 v[52:55], a[72:75], a[144:147], v[52:55]
buffer_load_dwordx4 v8, s[56:59], s64 offen offset:1024 lds
v_mfma_f32_16x16x32_bf16 v[44:47], a[72:75], a[136:139], v[44:47]
ds_read_b64_tr_b16 a[160:161], v11 offset:16384
ds_read_b64_tr_b16 a[162:163], v11 offset:16896
v_mfma_f32_16x16x32_bf16 v[44:47], a[76:79], a[140:143], v[44:47]
v_mfma_f32_16x16x32_bf16 v[36:39], a[76:79], a[132:135], v[36:39]
v_mfma_f32_16x16x32_bf16 v[36:39], a[72:75], a[128:131], v[36:39]
ds_read_b128 a[108:111], v10 offset:10240
v_mfma_f32_16x16x32_bf16 v[64:67], a[80:83], a[128:131], v[64:67]
s_add_u32 m0, s77, 2048
s_add_u32 s64, s76, 131072
v_mfma_f32_16x16x32_bf16 v[64:67], a[84:87], a[132:135], v[64:67]
v_mfma_f32_16x16x32_bf16 v[72:75], a[84:87], a[140:143], v[72:75]
buffer_load_dwordx4 v7, s[56:59], s64 offen lds
v_mfma_f32_16x16x32_bf16 v[72:75], a[80:83], a[136:139], v[72:75]
ds_read_b64_tr_b16 a[164:165], v11 offset:24576
ds_read_b64_tr_b16 a[166:167], v11 offset:25088
v_mfma_f32_16x16x32_bf16 v[80:83], a[80:83], a[144:147], v[80:83]
v_mfma_f32_16x16x32_bf16 v[80:83], a[84:87], a[148:151], v[80:83]
ds_read_b128 a[112:115], v9 offset:12288
v_mfma_f32_16x16x32_bf16 v[88:91], a[84:87], a[156:159], v[88:91]
v_mfma_f32_16x16x32_bf16 v[88:91], a[80:83], a[152:155], v[88:91]
v_mfma_f32_16x16x32_bf16 v[92:95], a[88:91], a[152:155], v[92:95]
ds_read_b64_tr_b16 a[168:169], v12 offset:16384
ds_read_b64_tr_b16 a[170:171], v12 offset:16896
v_mfma_f32_16x16x32_bf16 v[92:95], a[92:95], a[156:159], v[92:95]
buffer_load_dwordx4 v8, s[56:59], s64 offen offset:1024 lds
v_mfma_f32_16x16x32_bf16 v[84:87], a[92:95], a[148:151], v[84:87]
v_mfma_f32_16x16x32_bf16 v[84:87], a[88:91], a[144:147], v[84:87]
v_mfma_f32_16x16x32_bf16 v[76:79], a[88:91], a[136:139], v[76:79]
ds_read_b128 a[116:119], v10 offset:12288
v_mfma_f32_16x16x32_bf16 v[76:79], a[92:95], a[140:143], v[76:79]
v_mfma_f32_16x16x32_bf16 v[68:71], a[92:95], a[132:135], v[68:71]
v_mfma_f32_16x16x32_bf16 v[68:71], a[88:91], a[128:131], v[68:71]
s_add_u32 m0, s73, 4096
s_add_u32 s64, s71, 524288
s_waitcnt lgkmcnt(6)
v_mfma_f32_16x16x32_bf16 v[96:99], a[96:99], a[128:131], v[96:99]
ds_read_b64_tr_b16 a[172:173], v12 offset:24576
ds_read_b64_tr_b16 a[174:175], v12 offset:25088
v_mfma_f32_16x16x32_bf16 v[96:99], a[100:103], a[132:135], v[96:99]
buffer_load_dwordx4 v5, s[8:11], s64 offen lds
v_mfma_f32_16x16x32_bf16 v[104:107], a[100:103], a[140:143], v[104:107]
ds_read_b128 a[120:123], v9 offset:14336
v_mfma_f32_16x16x32_bf16 v[104:107], a[96:99], a[136:139], v[104:107]
v_mfma_f32_16x16x32_bf16 v[112:115], a[96:99], a[144:147], v[112:115]
v_mfma_f32_16x16x32_bf16 v[112:115], a[100:103], a[148:151], v[112:115]
ds_read_b64_tr_b16 a[176:177], v13 offset:16384
ds_read_b64_tr_b16 a[178:179], v13 offset:16896
v_mfma_f32_16x16x32_bf16 v[120:123], a[100:103], a[156:159], v[120:123]
v_mfma_f32_16x16x32_bf16 v[120:123], a[96:99], a[152:155], v[120:123]
v_mfma_f32_16x16x32_bf16 v[124:127], a[104:107], a[152:155], v[124:127]
buffer_load_dwordx4 v6, s[8:11], s64 offen offset:1024 lds
v_mfma_f32_16x16x32_bf16 v[124:127], a[108:111], a[156:159], v[124:127]
ds_read_b128 a[124:127], v10 offset:14336
v_mfma_f32_16x16x32_bf16 v[116:119], a[108:111], a[148:151], v[116:119]
v_add_u32 v9, 32768, v9
v_add_u32 v10, 32768, v10
v_mfma_f32_16x16x32_bf16 v[116:119], a[104:107], a[144:147], v[116:119]
v_mfma_f32_16x16x32_bf16 v[108:111], a[104:107], a[136:139], v[108:111]
ds_read_b64_tr_b16 a[180:181], v13 offset:24576
ds_read_b64_tr_b16 a[182:183], v13 offset:25088
v_mfma_f32_16x16x32_bf16 v[108:111], a[108:111], a[140:143], v[108:111]
s_add_u32 m0, s73, 6144
s_add_u32 s64, s71, 540672
v_mfma_f32_16x16x32_bf16 v[100:103], a[108:111], a[132:135], v[100:103]
s_waitcnt lgkmcnt(2)
v_mfma_f32_16x16x32_bf16 v[100:103], a[104:107], a[128:131], v[100:103]
buffer_load_dwordx4 v5, s[8:11], s64 offen lds
v_mfma_f32_16x16x32_bf16 v[128:131], a[112:115], a[128:131], v[128:131]
ds_read_b64_tr_b16 a[184:185], v14 offset:16384
ds_read_b64_tr_b16 a[186:187], v14 offset:16896
v_mfma_f32_16x16x32_bf16 v[128:131], a[116:119], a[132:135], v[128:131]
v_mfma_f32_16x16x32_bf16 v[136:139], a[116:119], a[140:143], v[136:139]
ds_read_b64_tr_b16 a[188:189], v14 offset:24576
ds_read_b64_tr_b16 a[190:191], v14 offset:25088
v_mfma_f32_16x16x32_bf16 v[136:139], a[112:115], a[136:139], v[136:139]
v_mfma_f32_16x16x32_bf16 v[144:147], a[112:115], a[144:147], v[144:147]
v_mfma_f32_16x16x32_bf16 v[144:147], a[116:119], a[148:151], v[144:147]
v_mfma_f32_16x16x32_bf16 v[152:155], a[116:119], a[156:159], v[152:155]
buffer_load_dwordx4 v6, s[8:11], s64 offen offset:1024 lds
v_mfma_f32_16x16x32_bf16 v[152:155], a[112:115], a[152:155], v[152:155]
v_mfma_f32_16x16x32_bf16 v[156:159], a[120:123], a[152:155], v[156:159]
v_mfma_f32_16x16x32_bf16 v[156:159], a[124:127], a[156:159], v[156:159]
v_mfma_f32_16x16x32_bf16 v[148:151], a[124:127], a[148:151], v[148:151]
v_mfma_f32_16x16x32_bf16 v[148:151], a[120:123], a[144:147], v[148:151]
v_mfma_f32_16x16x32_bf16 v[140:143], a[120:123], a[136:139], v[140:143]
v_mfma_f32_16x16x32_bf16 v[140:143], a[124:127], a[140:143], v[140:143]
v_mfma_f32_16x16x32_bf16 v[132:135], a[124:127], a[132:135], v[132:135]
v_mfma_f32_16x16x32_bf16 v[132:135], a[120:123], a[128:131], v[132:135]
s_waitcnt lgkmcnt(0)
v_mfma_f32_16x16x32_bf16 v[160:163], a[160:163], a[64:67], v[160:163]
s_waitcnt vmcnt(19)
v_mfma_f32_16x16x32_bf16 v[160:163], a[164:167], a[68:71], v[160:163]
s_barrier
v_mfma_f32_16x16x32_bf16 v[164:167], a[172:175], a[68:71], v[164:167]
ds_read_b64_tr_b16 a[128:129], v11 offset:32768
ds_read_b64_tr_b16 a[130:131], v11 offset:33280
v_mfma_f32_16x16x32_bf16 v[164:167], a[168:171], a[64:67], v[164:167]
s_add_u32 m0, s77, 16384
s_add_u32 s64, s76, 0
v_mfma_f32_16x16x32_bf16 v[168:171], a[176:179], a[64:67], v[168:171]
buffer_load_dwordx4 v7, s[16:19], s64 offen lds
v_mfma_f32_16x16x32_bf16 v[168:171], a[180:183], a[68:71], v[168:171]
v_mfma_f32_16x16x32_bf16 v[172:175], a[188:191], a[68:71], v[172:175]
v_mfma_f32_16x16x32_bf16 v[172:175], a[184:187], a[64:67], v[172:175]
ds_read_b128 a[64:67], v9 offset:0
v_mfma_f32_16x16x32_bf16 v[188:191], a[184:187], a[72:75], v[188:191]
ds_read_b64_tr_b16 a[132:133], v11 offset:40960
ds_read_b64_tr_b16 a[134:135], v11 offset:41472
v_mfma_f32_16x16x32_bf16 v[188:191], a[188:191], a[76:79], v[188:191]
v_mfma_f32_16x16x32_bf16 v[184:187], a[180:183], a[76:79], v[184:187]
v_mfma_f32_16x16x32_bf16 v[184:187], a[176:179], a[72:75], v[184:187]
buffer_load_dwordx4 v8, s[16:19], s64 offen offset:1024 lds
v_mfma_f32_16x16x32_bf16 v[180:183], a[168:171], a[72:75], v[180:183]
ds_read_b128 a[68:71], v10 offset:0
v_mfma_f32_16x16x32_bf16 v[180:183], a[172:175], a[76:79], v[180:183]
v_mfma_f32_16x16x32_bf16 v[176:179], a[164:167], a[76:79], v[176:179]
v_mfma_f32_16x16x32_bf16 v[176:179], a[160:163], a[72:75], v[176:179]
ds_read_b64_tr_b16 a[136:137], v12 offset:32768
ds_read_b64_tr_b16 a[138:139], v12 offset:33280
v_mfma_f32_16x16x32_bf16 v[192:195], a[160:163], a[80:83], v[192:195]
s_add_u32 m0, s77, 18432
s_add_u32 s64, s76, 131072
v_mfma_f32_16x16x32_bf16 v[192:195], a[164:167], a[84:87], v[192:195]
v_mfma_f32_16x16x32_bf16 v[196:199], a[172:175], a[84:87], v[196:199]
buffer_load_dwordx4 v7, s[16:19], s64 offen lds
v_mfma_f32_16x16x32_bf16 v[196:199], a[168:171], a[80:83], v[196:199]
ds_read_b128 a[72:75], v9 offset:2048
v_mfma_f32_16x16x32_bf16 v[200:203], a[176:179], a[80:83], v[200:203]
v_mfma_f32_16x16x32_bf16 v[200:203], a[180:183], a[84:87], v[200:203]
ds_read_b64_tr_b16 a[140:141], v12 offset:40960
ds_read_b64_tr_b16 a[142:143], v12 offset:41472
v_mfma_f32_16x16x32_bf16 v[204:207], a[188:191], a[84:87], v[204:207]
v_mfma_f32_16x16x32_bf16 v[204:207], a[184:187], a[80:83], v[204:207]
v_mfma_f32_16x16x32_bf16 v[220:223], a[184:187], a[88:91], v[220:223]
ds_read_b128 a[76:79], v10 offset:2048
v_mfma_f32_16x16x32_bf16 v[220:223], a[188:191], a[92:95], v[220:223]
buffer_load_dwordx4 v8, s[16:19], s64 offen offset:1024 lds
v_mfma_f32_16x16x32_bf16 v[216:219], a[180:183], a[92:95], v[216:219]
s_xor_b32 s71, s70, 896
s_add_u32 s71, s68, s71
L_PAD2:
s_cbranch_execz L_PAD6
v_mfma_f32_16x16x32_bf16 v[216:219], a[176:179], a[88:91], v[216:219]
v_mfma_f32_16x16x32_bf16 v[212:215], a[168:171], a[88:91], v[212:215]
ds_read_b64_tr_b16 a[144:145], v13 offset:32768
ds_read_b64_tr_b16 a[146:147], v13 offset:33280
v_mfma_f32_16x16x32_bf16 v[212:215], a[172:175], a[92:95], v[212:215]
v_mfma_f32_16x16x32_bf16 v[208:211], a[164:167], a[92:95], v[208:211]
v_mfma_f32_16x16x32_bf16 v[208:211], a[160:163], a[88:91], v[208:211]
s_add_u32 m0, s73, 32768
s_add_u32 s64, s71, 0
ds_read_b128 a[80:83], v9 offset:4096
v_mfma_f32_16x16x32_bf16 v[224:227], a[160:163], a[96:99], v[224:227]
v_mfma_f32_16x16x32_bf16 v[224:227], a[164:167], a[100:103], v[224:227]
buffer_load_dwordx4 v5, s[8:11], s64 offen lds
v_mfma_f32_16x16x32_bf16 v[228:231], a[172:175], a[100:103], v[228:231]
ds_read_b64_tr_b16 a[148:149], v13 offset:40960
ds_read_b64_tr_b16 a[150:151], v13 offset:41472
v_mfma_f32_16x16x32_bf16 v[228:231], a[168:171], a[96:99], v[228:231]
v_mfma_f32_16x16x32_bf16 v[232:235], a[176:179], a[96:99], v[232:235]
v_mfma_f32_16x16x32_bf16 v[232:235], a[180:183], a[100:103], v[232:235]
ds_read_b128 a[84:87], v10 offset:4096
v_mfma_f32_16x16x32_bf16 v[236:239], a[188:191], a[100:103], v[236:239]
v_mfma_f32_16x16x32_bf16 v[236:239], a[184:187], a[96:99], v[236:239]
v_mfma_f32_16x16x32_bf16 v[252:255], a[184:187], a[104:107], v[252:255]
buffer_load_dwordx4 v6, s[8:11], s64 offen offset:1024 lds
v_mfma_f32_16x16x32_bf16 v[252:255], a[188:191], a[108:111], v[252:255]
ds_read_b64_tr_b16 a[152:153], v14 offset:32768
ds_read_b64_tr_b16 a[154:155], v14 offset:33280
v_mfma_f32_16x16x32_bf16 v[248:251], a[180:183], a[108:111], v[248:251]
v_mfma_f32_16x16x32_bf16 v[248:251], a[176:179], a[104:107], v[248:251]
v_mfma_f32_16x16x32_bf16 v[244:247], a[168:171], a[104:107], v[244:247]
ds_read_b128 a[88:91], v9 offset:6144
v_mfma_f32_16x16x32_bf16 v[244:247], a[172:175], a[108:111], v[244:247]
s_add_u32 m0, s73, 34816
s_add_u32 s64, s71, 16384
v_mfma_f32_16x16x32_bf16 v[240:243], a[164:167], a[108:111], v[240:243]
v_mfma_f32_16x16x32_bf16 v[240:243], a[160:163], a[104:107], v[240:243]
buffer_load_dwordx4 v5, s[8:11], s64 offen lds
v_mfma_f32_16x16x32_bf16 a[0:3], a[160:163], a[112:115], a[0:3]
ds_read_b64_tr_b16 a[156:157], v14 offset:40960
ds_read_b64_tr_b16 a[158:159], v14 offset:41472
v_mfma_f32_16x16x32_bf16 a[0:3], a[164:167], a[116:119], a[0:3]
v_mfma_f32_16x16x32_bf16 a[4:7], a[172:175], a[116:119], a[4:7]
ds_read_b128 a[92:95], v10 offset:6144
v_mfma_f32_16x16x32_bf16 a[4:7], a[168:171], a[112:115], a[4:7]
v_mfma_f32_16x16x32_bf16 a[8:11], a[176:179], a[112:115], a[8:11]
v_mfma_f32_16x16x32_bf16 a[8:11], a[180:183], a[116:119], a[8:11]
v_mfma_f32_16x16x32_bf16 a[12:15], a[188:191], a[116:119], a[12:15]
buffer_load_dwordx4 v6, s[8:11], s64 offen offset:1024 lds
v_mfma_f32_16x16x32_bf16 a[12:15], a[184:187], a[112:115], a[12:15]
v_mfma_f32_16x16x32_bf16 a[28:31], a[184:187], a[120:123], a[28:31]
v_mfma_f32_16x16x32_bf16 a[28:31], a[188:191], a[124:127], a[28:31]
v_mfma_f32_16x16x32_bf16 a[24:27], a[180:183], a[124:127], a[24:27]
v_mfma_f32_16x16x32_bf16 a[24:27], a[176:179], a[120:123], a[24:27]
v_mfma_f32_16x16x32_bf16 a[20:23], a[168:171], a[120:123], a[20:23]
v_mfma_f32_16x16x32_bf16 a[20:23], a[172:175], a[124:127], a[20:23]
v_mfma_f32_16x16x32_bf16 a[16:19], a[164:167], a[124:127], a[16:19]
v_mfma_f32_16x16x32_bf16 a[16:19], a[160:163], a[120:123], a[16:19]
s_waitcnt lgkmcnt(0)
v_mfma_f32_16x16x32_bf16 v[32:35], a[64:67], a[128:131], v[32:35]
s_waitcnt vmcnt(21)
v_mfma_f32_16x16x32_bf16 v[32:35], a[68:71], a[132:135], v[32:35]
s_barrier
v_mfma_f32_16x16x32_bf16 v[40:43], a[68:71], a[140:143], v[40:43]
ds_read_b128 a[96:99], v9 offset:8192
v_mfma_f32_16x16x32_bf16 v[40:43], a[64:67], a[136:139], v[40:43]
s_xor_b32 s76, s75, 3670016
s_add_u32 s76, s74, s76
v_mfma_f32_16x16x32_bf16 v[48:51], a[64:67], a[144:147], v[48:51]
s_add_u32 m0, s77, 32768
s_add_u32 s64, s76, 0
v_mfma_f32_16x16x32_bf16 v[48:51], a[68:71], a[148:151], v[48:51]
buffer_load_dwordx4 v7, s[56:59], s64 offen lds
v_mfma_f32_16x16x32_bf16 v[56:59], a[68:71], a[156:159], v[56:59]
ds_read_b128 a[100:103], v10 offset:8192
v_mfma_f32_16x16x32_bf16 v[56:59], a[64:67], a[152:155], v[56:59]
buffer_load_dword a252, v16, s[20:23], s52 offen
v_mfma_f32_16x16x32_bf16 v[60:63], a[72:75], a[152:155], v[60:63]
s_lshr_b32 s52, s2, 1
s_lshl2_add_u32 s52, s52, s3
ds_read_b128 a[104:107], v9 offset:10240
v_mfma_f32_16x16x32_bf16 v[60:63], a[76:79], a[156:159], v[60:63]
s_mul_i32 s52, s52, 9216
s_and_b32 s53, s2, 1
s_lshl_b32 s53, s53, 9
v_mfma_f32_16x16x32_bf16 v[52:55], a[76:79], a[148:151], v[52:55]
s_add_u32 s52, s52, s53
v_min_u32 v18, 39, v1
v_and_b32 v16, 7, v18
v_mfma_f32_16x16x32_bf16 v[52:55], a[72:75], a[144:147], v[52:55]
buffer_load_dwordx4 v8, s[56:59], s64 offen offset:1024 lds
v_mfma_f32_16x16x32_bf16 v[44:47], a[72:75], a[136:139], v[44:47]
ds_read_b64_tr_b16 a[160:161], v11 offset:49152
ds_read_b64_tr_b16 a[162:163], v11 offset:49664
v_mfma_f32_16x16x32_bf16 v[44:47], a[76:79], a[140:143], v[44:47]
v_mul_u32_u24 v16, 1152, v16
v_lshrrev_b32 v18, 3, v18
v_mfma_f32_16x16x32_bf16 v[36:39], a[76:79], a[132:135], v[36:39]
v_lshl_add_u32 v16, v18, 7, v16
v_mfma_f32_16x16x32_bf16 v[36:39], a[72:75], a[128:131], v[36:39]
ds_read_b128 a[108:111], v10 offset:10240
v_mfma_f32_16x16x32_bf16 v[64:67], a[80:83], a[128:131], v[64:67]
s_add_u32 m0, s77, 34816
s_add_u32 s64, s76, 131072
v_mfma_f32_16x16x32_bf16 v[64:67], a[84:87], a[132:135], v[64:67]
v_mfma_f32_16x16x32_bf16 v[72:75], a[84:87], a[140:143], v[72:75]
buffer_load_dwordx4 v7, s[56:59], s64 offen lds
v_mfma_f32_16x16x32_bf16 v[72:75], a[80:83], a[136:139], v[72:75]
ds_read_b64_tr_b16 a[164:165], v11 offset:57344
ds_read_b64_tr_b16 a[166:167], v11 offset:57856
v_mfma_f32_16x16x32_bf16 v[80:83], a[80:83], a[144:147], v[80:83]
v_mfma_f32_16x16x32_bf16 v[80:83], a[84:87], a[148:151], v[80:83]
ds_read_b128 a[112:115], v9 offset:12288
v_mfma_f32_16x16x32_bf16 v[88:91], a[84:87], a[156:159], v[88:91]
v_mfma_f32_16x16x32_bf16 v[88:91], a[80:83], a[152:155], v[88:91]
v_mfma_f32_16x16x32_bf16 v[92:95], a[88:91], a[152:155], v[92:95]
ds_read_b64_tr_b16 a[168:169], v12 offset:49152
ds_read_b64_tr_b16 a[170:171], v12 offset:49664
v_mfma_f32_16x16x32_bf16 v[92:95], a[92:95], a[156:159], v[92:95]
buffer_load_dwordx4 v8, s[56:59], s64 offen offset:1024 lds
v_mfma_f32_16x16x32_bf16 v[84:87], a[92:95], a[148:151], v[84:87]
v_mfma_f32_16x16x32_bf16 v[84:87], a[88:91], a[144:147], v[84:87]
v_mfma_f32_16x16x32_bf16 v[76:79], a[88:91], a[136:139], v[76:79]
ds_read_b128 a[116:119], v10 offset:12288
v_mfma_f32_16x16x32_bf16 v[76:79], a[92:95], a[140:143], v[76:79]
v_mfma_f32_16x16x32_bf16 v[68:71], a[92:95], a[132:135], v[68:71]
v_mfma_f32_16x16x32_bf16 v[68:71], a[88:91], a[128:131], v[68:71]
s_add_u32 m0, s73, 36864
s_add_u32 s64, s71, 524288
s_waitcnt lgkmcnt(6)
v_mfma_f32_16x16x32_bf16 v[96:99], a[96:99], a[128:131], v[96:99]
ds_read_b64_tr_b16 a[172:173], v12 offset:57344
ds_read_b64_tr_b16 a[174:175], v12 offset:57856
v_mfma_f32_16x16x32_bf16 v[96:99], a[100:103], a[132:135], v[96:99]
buffer_load_dwordx4 v5, s[8:11], s64 offen lds
v_mfma_f32_16x16x32_bf16 v[104:107], a[100:103], a[140:143], v[104:107]
ds_read_b128 a[120:123], v9 offset:14336
v_mfma_f32_16x16x32_bf16 v[104:107], a[96:99], a[136:139], v[104:107]
v_mfma_f32_16x16x32_bf16 v[112:115], a[96:99], a[144:147], v[112:115]
v_mfma_f32_16x16x32_bf16 v[112:115], a[100:103], a[148:151], v[112:115]
ds_read_b64_tr_b16 a[176:177], v13 offset:49152
ds_read_b64_tr_b16 a[178:179], v13 offset:49664
v_mfma_f32_16x16x32_bf16 v[120:123], a[100:103], a[156:159], v[120:123]
v_mfma_f32_16x16x32_bf16 v[120:123], a[96:99], a[152:155], v[120:123]
v_mfma_f32_16x16x32_bf16 v[124:127], a[104:107], a[152:155], v[124:127]
buffer_load_dwordx4 v6, s[8:11], s64 offen offset:1024 lds
v_mfma_f32_16x16x32_bf16 v[124:127], a[108:111], a[156:159], v[124:127]
ds_read_b128 a[124:127], v10 offset:14336
v_mfma_f32_16x16x32_bf16 v[116:119], a[108:111], a[148:151], v[116:119]
v_add_u32 v9, -65536, v9
v_add_u32 v10, -65536, v10
v_mfma_f32_16x16x32_bf16 v[116:119], a[104:107], a[144:147], v[116:119]
buffer_load_dword v30, v29, s[24:27], s89 offen sc1
v_mfma_f32_16x16x32_bf16 v[108:111], a[104:107], a[136:139], v[108:111]
ds_read_b64_tr_b16 a[180:181], v13 offset:57344
ds_read_b64_tr_b16 a[182:183], v13 offset:57856
v_mfma_f32_16x16x32_bf16 v[108:111], a[108:111], a[140:143], v[108:111]
s_add_u32 m0, s73, 38912
s_add_u32 s64, s71, 540672
v_mfma_f32_16x16x32_bf16 v[100:103], a[108:111], a[132:135], v[100:103]
s_waitcnt lgkmcnt(2)
v_mfma_f32_16x16x32_bf16 v[100:103], a[104:107], a[128:131], v[100:103]
buffer_load_dwordx4 v5, s[8:11], s64 offen lds
v_mfma_f32_16x16x32_bf16 v[128:131], a[112:115], a[128:131], v[128:131]
ds_read_b64_tr_b16 a[184:185], v14 offset:49152
ds_read_b64_tr_b16 a[186:187], v14 offset:49664
v_mfma_f32_16x16x32_bf16 v[128:131], a[116:119], a[132:135], v[128:131]
v_mfma_f32_16x16x32_bf16 v[136:139], a[116:119], a[140:143], v[136:139]
ds_read_b64_tr_b16 a[188:189], v14 offset:57344
ds_read_b64_tr_b16 a[190:191], v14 offset:57856
v_mfma_f32_16x16x32_bf16 v[136:139], a[112:115], a[136:139], v[136:139]
v_mfma_f32_16x16x32_bf16 v[144:147], a[112:115], a[144:147], v[144:147]
v_mfma_f32_16x16x32_bf16 v[144:147], a[116:119], a[148:151], v[144:147]
v_mfma_f32_16x16x32_bf16 v[152:155], a[116:119], a[156:159], v[152:155]
buffer_load_dwordx4 v6, s[8:11], s64 offen offset:1024 lds
v_mfma_f32_16x16x32_bf16 v[152:155], a[112:115], a[152:155], v[152:155]
v_mfma_f32_16x16x32_bf16 v[156:159], a[120:123], a[152:155], v[156:159]
v_mfma_f32_16x16x32_bf16 v[156:159], a[124:127], a[156:159], v[156:159]
v_mfma_f32_16x16x32_bf16 v[148:151], a[124:127], a[148:151], v[148:151]
v_mfma_f32_16x16x32_bf16 v[148:151], a[120:123], a[144:147], v[148:151]
v_mfma_f32_16x16x32_bf16 v[140:143], a[120:123], a[136:139], v[140:143]
v_mfma_f32_16x16x32_bf16 v[140:143], a[124:127], a[140:143], v[140:143]
v_mfma_f32_16x16x32_bf16 v[132:135], a[124:127], a[132:135], v[132:135]
v_mfma_f32_16x16x32_bf16 v[132:135], a[120:123], a[128:131], v[132:135]
s_waitcnt lgkmcnt(0)
v_mfma_f32_16x16x32_bf16 v[160:163], a[160:163], a[64:67], v[160:163]
s_waitcnt vmcnt(18)
v_mfma_f32_16x16x32_bf16 v[160:163], a[164:167], a[68:71], v[160:163]
s_barrier
v_mfma_f32_16x16x32_bf16 v[164:167], a[172:175], a[68:71], v[164:167]
ds_read_b64_tr_b16 a[128:129], v11 offset:0
ds_read_b64_tr_b16 a[130:131], v11 offset:512
v_mfma_f32_16x16x32_bf16 v[164:167], a[168:171], a[64:67], v[164:167]
s_add_u32 m0, s77, 49152
s_add_u32 s64, s76, 0
v_mfma_f32_16x16x32_bf16 v[168:171], a[176:179], a[64:67], v[168:171]
buffer_load_dwordx4 v7, s[16:19], s64 offen lds
v_mfma_f32_16x16x32_bf16 v[168:171], a[180:183], a[68:71], v[168:171]
v_mfma_f32_16x16x32_bf16 v[172:175], a[188:191], a[68:71], v[172:175]
v_mfma_f32_16x16x32_bf16 v[172:175], a[184:187], a[64:67], v[172:175]
ds_read_b128 a[64:67], v9 offset:0
v_mfma_f32_16x16x32_bf16 v[188:191], a[184:187], a[72:75], v[188:191]
ds_read_b64_tr_b16 a[132:133], v11 offset:8192
ds_read_b64_tr_b16 a[134:135], v11 offset:8704
v_mfma_f32_16x16x32_bf16 v[188:191], a[188:191], a[76:79], v[188:191]
v_mfma_f32_16x16x32_bf16 v[184:187], a[180:183], a[76:79], v[184:187]
v_mfma_f32_16x16x32_bf16 v[184:187], a[176:179], a[72:75], v[184:187]
buffer_load_dwordx4 v8, s[16:19], s64 offen offset:1024 lds
v_mfma_f32_16x16x32_bf16 v[180:183], a[168:171], a[72:75], v[180:183]
ds_read_b128 a[68:71], v10 offset:0
v_mfma_f32_16x16x32_bf16 v[180:183], a[172:175], a[76:79], v[180:183]
v_mfma_f32_16x16x32_bf16 v[176:179], a[164:167], a[76:79], v[176:179]
v_mfma_f32_16x16x32_bf16 v[176:179], a[160:163], a[72:75], v[176:179]
ds_read_b64_tr_b16 a[136:137], v12 offset:0
ds_read_b64_tr_b16 a[138:139], v12 offset:512
v_mfma_f32_16x16x32_bf16 v[192:195], a[160:163], a[80:83], v[192:195]
s_add_u32 m0, s77, 51200
s_add_u32 s64, s76, 131072
v_mfma_f32_16x16x32_bf16 v[192:195], a[164:167], a[84:87], v[192:195]
v_mfma_f32_16x16x32_bf16 v[196:199], a[172:175], a[84:87], v[196:199]
buffer_load_dwordx4 v7, s[16:19], s64 offen lds
v_mfma_f32_16x16x32_bf16 v[196:199], a[168:171], a[80:83], v[196:199]
ds_read_b128 a[72:75], v9 offset:2048
v_mfma_f32_16x16x32_bf16 v[200:203], a[176:179], a[80:83], v[200:203]
v_mfma_f32_16x16x32_bf16 v[200:203], a[180:183], a[84:87], v[200:203]
ds_read_b64_tr_b16 a[140:141], v12 offset:8192
ds_read_b64_tr_b16 a[142:143], v12 offset:8704
v_mfma_f32_16x16x32_bf16 v[204:207], a[188:191], a[84:87], v[204:207]
v_mfma_f32_16x16x32_bf16 v[204:207], a[184:187], a[80:83], v[204:207]
v_mfma_f32_16x16x32_bf16 v[220:223], a[184:187], a[88:91], v[220:223]
ds_read_b128 a[76:79], v10 offset:2048
v_mfma_f32_16x16x32_bf16 v[220:223], a[188:191], a[92:95], v[220:223]
buffer_load_dwordx4 v8, s[16:19], s64 offen offset:1024 lds
v_mfma_f32_16x16x32_bf16 v[216:219], a[180:183], a[92:95], v[216:219]
s_lshl_b32 s70, s93, 7
s_mul_i32 s68, s66, 36864
s_mul_i32 s69, s67, 36864
v_mfma_f32_16x16x32_bf16 v[216:219], a[176:179], a[88:91], v[216:219]
v_lshrrev_b32 v31, 3, v1
v_lshl_add_u32 v5, v31, 7, v5
v_mfma_f32_16x16x32_bf16 v[212:215], a[168:171], a[88:91], v[212:215]
v_lshl_add_u32 v6, v31, 7, v6
v_add_u32 v6, 1024, v6
v_mfma_f32_16x16x32_bf16 v[212:215], a[172:175], a[92:95], v[212:215]
s_mov_b32 s65, 1024
s_add_u32 s71, s68, s65
s_add_u32 s72, s69, s65
v_mfma_f32_16x16x32_bf16 v[208:211], a[164:167], a[92:95], v[208:211]
ds_read_b64_tr_b16 a[144:145], v13 offset:0
ds_read_b64_tr_b16 a[146:147], v13 offset:512
v_mfma_f32_16x16x32_bf16 v[208:211], a[160:163], a[88:91], v[208:211]
s_add_u32 m0, s73, 65536
s_add_u32 s64, s71, 0
ds_read_b128 a[80:83], v9 offset:4096
v_mfma_f32_16x16x32_bf16 v[224:227], a[160:163], a[96:99], v[224:227]
v_mfma_f32_16x16x32_bf16 v[224:227], a[164:167], a[100:103], v[224:227]
buffer_load_dwordx4 v5, s[12:15], s64 offen lds
v_mfma_f32_16x16x32_bf16 v[228:231], a[172:175], a[100:103], v[228:231]
ds_read_b64_tr_b16 a[148:149], v13 offset:8192
ds_read_b64_tr_b16 a[150:151], v13 offset:8704
v_mfma_f32_16x16x32_bf16 v[228:231], a[168:171], a[96:99], v[228:231]
v_mfma_f32_16x16x32_bf16 v[232:235], a[176:179], a[96:99], v[232:235]
v_mfma_f32_16x16x32_bf16 v[232:235], a[180:183], a[100:103], v[232:235]
ds_read_b128 a[84:87], v10 offset:4096
v_mfma_f32_16x16x32_bf16 v[236:239], a[188:191], a[100:103], v[236:239]
v_mfma_f32_16x16x32_bf16 v[236:239], a[184:187], a[96:99], v[236:239]
v_mfma_f32_16x16x32_bf16 v[252:255], a[184:187], a[104:107], v[252:255]
buffer_load_dwordx4 v6, s[12:15], s64 offen offset:1024 lds
v_mfma_f32_16x16x32_bf16 v[252:255], a[188:191], a[108:111], v[252:255]
ds_read_b64_tr_b16 a[152:153], v14 offset:0
ds_read_b64_tr_b16 a[154:155], v14 offset:512
v_mfma_f32_16x16x32_bf16 v[248:251], a[180:183], a[108:111], v[248:251]
v_mfma_f32_16x16x32_bf16 v[248:251], a[176:179], a[104:107], v[248:251]
v_mfma_f32_16x16x32_bf16 v[244:247], a[168:171], a[104:107], v[244:247]
ds_read_b128 a[88:91], v9 offset:6144
v_mfma_f32_16x16x32_bf16 v[244:247], a[172:175], a[108:111], v[244:247]
s_add_u32 m0, s73, 67584
s_add_u32 s64, s71, 18432
v_mfma_f32_16x16x32_bf16 v[240:243], a[164:167], a[108:111], v[240:243]
v_mfma_f32_16x16x32_bf16 v[240:243], a[160:163], a[104:107], v[240:243]
buffer_load_dwordx4 v5, s[12:15], s64 offen lds
v_mfma_f32_16x16x32_bf16 a[0:3], a[160:163], a[112:115], a[0:3]
ds_read_b64_tr_b16 a[156:157], v14 offset:8192
ds_read_b64_tr_b16 a[158:159], v14 offset:8704
v_mfma_f32_16x16x32_bf16 a[0:3], a[164:167], a[116:119], a[0:3]
v_mfma_f32_16x16x32_bf16 a[4:7], a[172:175], a[116:119], a[4:7]
s_waitcnt vmcnt(9)
ds_read_b128 a[92:95], v10 offset:6144
v_mfma_f32_16x16x32_bf16 a[4:7], a[168:171], a[112:115], a[4:7]
v_cmp_gt_u32 vcc, 18, v30
v_mfma_f32_16x16x32_bf16 a[8:11], a[176:179], a[112:115], a[8:11]
v_mfma_f32_16x16x32_bf16 a[8:11], a[180:183], a[116:119], a[8:11]
v_mfma_f32_16x16x32_bf16 a[12:15], a[188:191], a[116:119], a[12:15]
buffer_load_dwordx4 v6, s[12:15], s64 offen offset:1024 lds
v_mfma_f32_16x16x32_bf16 a[12:15], a[184:187], a[112:115], a[12:15]
v_mfma_f32_16x16x32_bf16 a[28:31], a[184:187], a[120:123], a[28:31]
s_cbranch_vccnz CK_WA
CK_WA_R:
v_mfma_f32_16x16x32_bf16 a[28:31], a[188:191], a[124:127], a[28:31]
v_mfma_f32_16x16x32_bf16 a[24:27], a[180:183], a[124:127], a[24:27]
v_mfma_f32_16x16x32_bf16 a[24:27], a[176:179], a[120:123], a[24:27]
v_mfma_f32_16x16x32_bf16 a[20:23], a[168:171], a[120:123], a[20:23]
v_mfma_f32_16x16x32_bf16 a[20:23], a[172:175], a[124:127], a[20:23]
v_mfma_f32_16x16x32_bf16 a[16:19], a[164:167], a[124:127], a[16:19]
v_mfma_f32_16x16x32_bf16 a[16:19], a[160:163], a[120:123], a[16:19]
s_waitcnt lgkmcnt(0)
v_mfma_f32_16x16x32_bf16 v[32:35], a[64:67], a[128:131], v[32:35]
s_waitcnt vmcnt(22)
v_mfma_f32_16x16x32_bf16 v[32:35], a[68:71], a[132:135], v[32:35]
s_barrier
v_mfma_f32_16x16x32_bf16 v[40:43], a[68:71], a[140:143], v[40:43]
ds_read_b128 a[96:99], v9 offset:8192
v_mfma_f32_16x16x32_bf16 v[40:43], a[64:67], a[136:139], v[40:43]
s_lshl_b32 s77, s3, 11
s_lshl_b32 s74, s3, 9
s_add_u32 s74, s74, s4
v_mfma_f32_16x16x32_bf16 v[48:51], a[64:67], a[144:147], v[48:51]
s_lshl_b32 s74, s74, 8
v_mfma_f32_16x16x32_bf16 v[48:51], a[68:71], a[148:151], v[48:51]
s_mov_b32 s75, 8
s_lshl_b32 s76, s75, 19
s_add_u32 s76, s76, s74
v_mfma_f32_16x16x32_bf16 v[56:59], a[68:71], a[156:159], v[56:59]
s_lshl_b32 s79, s75, 13
s_add_u32 s79, s79, s78
ds_read_b128 a[100:103], v10 offset:8192
v_mfma_f32_16x16x32_bf16 v[56:59], a[64:67], a[152:155], v[56:59]
s_add_u32 m0, s77, 0
s_add_u32 s64, s76, 0
v_mfma_f32_16x16x32_bf16 v[60:63], a[72:75], a[152:155], v[60:63]
buffer_load_dwordx4 v7, s[20:23], s64 offen lds
v_mfma_f32_16x16x32_bf16 v[60:63], a[76:79], a[156:159], v[60:63]
ds_read_b128 a[104:107], v9 offset:10240
v_mfma_f32_16x16x32_bf16 v[52:55], a[76:79], a[148:151], v[52:55]
buffer_load_dword a252, v16, s[32:35], s52 offen
v_mfma_f32_16x16x32_bf16 v[52:55], a[72:75], a[144:147], v[52:55]
ds_read_b64_tr_b16 a[160:161], v11 offset:16384
ds_read_b64_tr_b16 a[162:163], v11 offset:16896
v_mfma_f32_16x16x32_bf16 v[44:47], a[72:75], a[136:139], v[44:47]
buffer_load_dwordx4 v8, s[20:23], s64 offen offset:1024 lds
v_mfma_f32_16x16x32_bf16 v[44:47], a[76:79], a[140:143], v[44:47]
buffer_load_dword a253, v17, s[48:51], s54 offen
v_mfma_f32_16x16x32_bf16 v[36:39], a[76:79], a[132:135], v[36:39]
v_mfma_f32_16x16x32_bf16 v[36:39], a[72:75], a[128:131], v[36:39]
ds_read_b128 a[108:111], v10 offset:10240
v_mfma_f32_16x16x32_bf16 v[64:67], a[80:83], a[128:131], v[64:67]
v_mfma_f32_16x16x32_bf16 v[64:67], a[84:87], a[132:135], v[64:67]
v_mfma_f32_16x16x32_bf16 v[72:75], a[84:87], a[140:143], v[72:75]
s_add_u32 m0, s80, 0
s_add_u32 s64, s79, 0
v_mfma_f32_16x16x32_bf16 v[72:75], a[80:83], a[136:139], v[72:75]
ds_read_b64_tr_b16 a[164:165], v11 offset:24576
ds_read_b64_tr_b16 a[166:167], v11 offset:25088
v_mfma_f32_16x16x32_bf16 v[80:83], a[80:83], a[144:147], v[80:83]
buffer_load_dwordx4 v4, s[24:27], s64 offen sc1 lds
v_mfma_f32_16x16x32_bf16 v[80:83], a[84:87], a[148:151], v[80:83]
ds_read_b128 a[112:115], v9 offset:12288
v_mfma_f32_16x16x32_bf16 v[88:91], a[84:87], a[156:159], v[88:91]
v_mfma_f32_16x16x32_bf16 v[88:91], a[80:83], a[152:155], v[88:91]
v_mfma_f32_16x16x32_bf16 v[92:95], a[88:91], a[152:155], v[92:95]
ds_read_b64_tr_b16 a[168:169], v12 offset:16384
ds_read_b64_tr_b16 a[170:171], v12 offset:16896
v_mfma_f32_16x16x32_bf16 v[92:95], a[92:95], a[156:159], v[92:95]
v_mfma_f32_16x16x32_bf16 v[84:87], a[92:95], a[148:151], v[84:87]
s_add_u32 m0, s73, 69632
s_add_u32 s64, s72, 0
v_mfma_f32_16x16x32_bf16 v[84:87], a[88:91], a[144:147], v[84:87]
v_mfma_f32_16x16x32_bf16 v[76:79], a[88:91], a[136:139], v[76:79]
buffer_load_dwordx4 v5, s[12:15], s64 offen lds
v_mfma_f32_16x16x32_bf16 v[76:79], a[92:95], a[140:143], v[76:79]
ds_read_b128 a[116:119], v10 offset:12288
v_mfma_f32_16x16x32_bf16 v[68:71], a[92:95], a[132:135], v[68:71]
v_mfma_f32_16x16x32_bf16 v[68:71], a[88:91], a[128:131], v[68:71]
s_waitcnt lgkmcnt(6)
ds_read_b64_tr_b16 a[172:173], v12 offset:24576
ds_read_b64_tr_b16 a[174:175], v12 offset:25088
v_mfma_f32_16x16x32_bf16 v[96:99], a[96:99], a[128:131], v[96:99]
v_mfma_f32_16x16x32_bf16 v[96:99], a[100:103], a[132:135], v[96:99]
v_mfma_f32_16x16x32_bf16 v[104:107], a[100:103], a[140:143], v[104:107]
ds_read_b128 a[120:123], v9 offset:14336
v_mfma_f32_16x16x32_bf16 v[104:107], a[96:99], a[136:139], v[104:107]
v_mfma_f32_16x16x32_bf16 v[112:115], a[96:99], a[144:147], v[112:115]
v_mfma_f32_16x16x32_bf16 v[112:115], a[100:103], a[148:151], v[112:115]
buffer_load_dwordx4 v6, s[12:15], s64 offen offset:1024 lds
v_mfma_f32_16x16x32_bf16 v[120:123], a[100:103], a[156:159], v[120:123]
ds_read_b64_tr_b16 a[176:177], v13 offset:16384
ds_read_b64_tr_b16 a[178:179], v13 offset:16896
v_mfma_f32_16x16x32_bf16 v[120:123], a[96:99], a[152:155], v[120:123]
v_mfma_f32_16x16x32_bf16 v[124:127], a[104:107], a[152:155], v[124:127]
v_mfma_f32_16x16x32_bf16 v[124:127], a[108:111], a[156:159], v[124:127]
ds_read_b128 a[124:127], v10 offset:14336
v_mfma_f32_16x16x32_bf16 v[116:119], a[108:111], a[148:151], v[116:119]
v_add_u32 v9, 32768, v9
v_add_u32 v10, 32768, v10
v_mfma_f32_16x16x32_bf16 v[116:119], a[104:107], a[144:147], v[116:119]
s_add_u32 m0, s73, 71680
s_add_u32 s64, s72, 18432
v_mfma_f32_16x16x32_bf16 v[108:111], a[104:107], a[136:139], v[108:111]
ds_read_b64_tr_b16 a[180:181], v13 offset:24576
ds_read_b64_tr_b16 a[182:183], v13 offset:25088
v_mfma_f32_16x16x32_bf16 v[108:111], a[108:111], a[140:143], v[108:111]
buffer_load_dwordx4 v5, s[12:15], s64 offen lds
v_mfma_f32_16x16x32_bf16 v[100:103], a[108:111], a[132:135], v[100:103]
v_mfma_f32_16x16x32_bf16 v[100:103], a[104:107], a[128:131], v[100:103]
s_waitcnt lgkmcnt(2)
ds_read_b64_tr_b16 a[184:185], v14 offset:16384
ds_read_b64_tr_b16 a[186:187], v14 offset:16896
v_mfma_f32_16x16x32_bf16 v[128:131], a[112:115], a[128:131], v[128:131]
v_mfma_f32_16x16x32_bf16 v[128:131], a[116:119], a[132:135], v[128:131]
v_mfma_f32_16x16x32_bf16 v[136:139], a[116:119], a[140:143], v[136:139]
ds_read_b64_tr_b16 a[188:189], v14 offset:24576
ds_read_b64_tr_b16 a[190:191], v14 offset:25088
v_mfma_f32_16x16x32_bf16 v[136:139], a[112:115], a[136:139], v[136:139]
v_mfma_f32_16x16x32_bf16 v[144:147], a[112:115], a[144:147], v[144:147]
v_mfma_f32_16x16x32_bf16 v[144:147], a[116:119], a[148:151], v[144:147]
buffer_load_dwordx4 v6, s[12:15], s64 offen offset:1024 lds
v_mfma_f32_16x16x32_bf16 v[152:155], a[116:119], a[156:159], v[152:155]
v_mfma_f32_16x16x32_bf16 v[152:155], a[112:115], a[152:155], v[152:155]
v_mfma_f32_16x16x32_bf16 v[156:159], a[120:123], a[152:155], v[156:159]
v_mfma_f32_16x16x32_bf16 v[156:159], a[124:127], a[156:159], v[156:159]
v_mfma_f32_16x16x32_bf16 v[148:151], a[124:127], a[148:151], v[148:151]
v_mfma_f32_16x16x32_bf16 v[148:151], a[120:123], a[144:147], v[148:151]
v_mfma_f32_16x16x32_bf16 v[140:143], a[120:123], a[136:139], v[140:143]
v_mfma_f32_16x16x32_bf16 v[140:143], a[124:127], a[140:143], v[140:143]
v_mfma_f32_16x16x32_bf16 v[132:135], a[124:127], a[132:135], v[132:135]
v_mfma_f32_16x16x32_bf16 v[132:135], a[120:123], a[128:131], v[132:135]
s_waitcnt lgkmcnt(0)
v_mfma_f32_16x16x32_bf16 v[160:163], a[160:163], a[64:67], v[160:163]
s_waitcnt vmcnt(17)
v_mfma_f32_16x16x32_bf16 v[160:163], a[164:167], a[68:71], v[160:163]
s_barrier
v_mfma_f32_16x16x32_bf16 v[164:167], a[172:175], a[68:71], v[164:167]
ds_read_b64_tr_b16 a[128:129], v11 offset:32768
ds_read_b64_tr_b16 a[130:131], v11 offset:33280
v_mfma_f32_16x16x32_bf16 v[164:167], a[168:171], a[64:67], v[164:167]
s_add_u32 m0, s77, 16384
s_add_u32 s64, s76, 128
v_mfma_f32_16x16x32_bf16 v[168:171], a[176:179], a[64:67], v[168:171]
buffer_load_dwordx4 v7, s[20:23], s64 offen lds
v_mfma_f32_16x16x32_bf16 v[168:171], a[180:183], a[68:71], v[168:171]
v_mfma_f32_16x16x32_bf16 v[172:175], a[188:191], a[68:71], v[172:175]
v_mfma_f32_16x16x32_bf16 v[172:175], a[184:187], a[64:67], v[172:175]
ds_read_b128 a[64:67], v9 offset:0
v_mfma_f32_16x16x32_bf16 v[188:191], a[184:187], a[72:75], v[188:191]
ds_read_b64_tr_b16 a[132:133], v11 offset:40960
ds_read_b64_tr_b16 a[134:135], v11 offset:41472
v_mfma_f32_16x16x32_bf16 v[188:191], a[188:191], a[76:79], v[188:191]
v_mfma_f32_16x16x32_bf16 v[184:187], a[180:183], a[76:79], v[184:187]
v_mfma_f32_16x16x32_bf16 v[184:187], a[176:179], a[72:75], v[184:187]
ds_read_b128 a[68:71], v10 offset:0
v_mfma_f32_16x16x32_bf16 v[180:183], a[168:171], a[72:75], v[180:183]
buffer_load_dwordx4 v8, s[20:23], s64 offen offset:1024 lds
v_mfma_f32_16x16x32_bf16 v[180:183], a[172:175], a[76:79], v[180:183]
v_mfma_f32_16x16x32_bf16 v[176:179], a[164:167], a[76:79], v[176:179]
v_mfma_f32_16x16x32_bf16 v[176:179], a[160:163], a[72:75], v[176:179]
ds_read_b64_tr_b16 a[136:137], v12 offset:32768
ds_read_b64_tr_b16 a[138:139], v12 offset:33280
v_mfma_f32_16x16x32_bf16 v[192:195], a[160:163], a[80:83], v[192:195]
v_mfma_f32_16x16x32_bf16 v[192:195], a[164:167], a[84:87], v[192:195]
v_mfma_f32_16x16x32_bf16 v[196:199], a[172:175], a[84:87], v[196:199]
s_add_u32 m0, s80, 16384
s_add_u32 s64, s79, 2048
ds_read_b128 a[72:75], v9 offset:2048
v_mfma_f32_16x16x32_bf16 v[196:199], a[168:171], a[80:83], v[196:199]
v_mfma_f32_16x16x32_bf16 v[200:203], a[176:179], a[80:83], v[200:203]
buffer_load_dwordx4 v4, s[24:27], s64 offen sc1 lds
v_mfma_f32_16x16x32_bf16 v[200:203], a[180:183], a[84:87], v[200:203]
s_xor_b32 s65, s70, 0
s_add_u32 s71, s68, s65
s_add_u32 s72, s69, s65
v_mfma_f32_16x16x32_bf16 v[204:207], a[188:191], a[84:87], v[204:207]
ds_read_b64_tr_b16 a[140:141], v12 offset:40960
ds_read_b64_tr_b16 a[142:143], v12 offset:41472
v_mfma_f32_16x16x32_bf16 v[204:207], a[184:187], a[80:83], v[204:207]
v_mfma_f32_16x16x32_bf16 v[220:223], a[184:187], a[88:91], v[220:223]
ds_read_b128 a[76:79], v10 offset:2048
v_mfma_f32_16x16x32_bf16 v[220:223], a[188:191], a[92:95], v[220:223]
v_mfma_f32_16x16x32_bf16 v[216:219], a[180:183], a[92:95], v[216:219]
s_add_u32 m0, s73, 0
s_add_u32 s64, s71, 0
v_mfma_f32_16x16x32_bf16 v[216:219], a[176:179], a[88:91], v[216:219]
v_mfma_f32_16x16x32_bf16 v[212:215], a[168:171], a[88:91], v[212:215]
buffer_load_dwordx4 v5, s[12:15], s64 offen lds
v_mfma_f32_16x16x32_bf16 v[212:215], a[172:175], a[92:95], v[212:215]
ds_read_b64_tr_b16 a[144:145], v13 offset:32768
ds_read_b64_tr_b16 a[146:147], v13 offset:33280
v_mfma_f32_16x16x32_bf16 v[208:211], a[164:167], a[92:95], v[208:211]
v_mfma_f32_16x16x32_bf16 v[208:211], a[160:163], a[88:91], v[208:211]
ds_read_b128 a[80:83], v9 offset:4096
v_mfma_f32_16x16x32_bf16 v[224:227], a[160:163], a[96:99], v[224:227]
v_mfma_f32_16x16x32_bf16 v[224:227], a[164:167], a[100:103], v[224:227]
v_mfma_f32_16x16x32_bf16 v[228:231], a[172:175], a[100:103], v[228:231]
ds_read_b64_tr_b16 a[148:149], v13 offset:40960
ds_read_b64_tr_b16 a[150:151], v13 offset:41472
v_mfma_f32_16x16x32_bf16 v[228:231], a[168:171], a[96:99], v[228:231]
v_mfma_f32_16x16x32_bf16 v[232:235], a[176:179], a[96:99], v[232:235]
v_mfma_f32_16x16x32_bf16 v[232:235], a[180:183], a[100:103], v[232:235]
buffer_load_dwordx4 v6, s[12:15], s64 offen offset:1024 lds
v_mfma_f32_16x16x32_bf16 v[236:239], a[188:191], a[100:103], v[236:239]
ds_read_b128 a[84:87], v10 offset:4096
v_mfma_f32_16x16x32_bf16 v[236:239], a[184:187], a[96:99], v[236:239]
v_mfma_f32_16x16x32_bf16 v[252:255], a[184:187], a[104:107], v[252:255]
v_mfma_f32_16x16x32_bf16 v[252:255], a[188:191], a[108:111], v[252:255]
ds_read_b64_tr_b16 a[152:153], v14 offset:32768
ds_read_b64_tr_b16 a[154:155], v14 offset:33280
v_mfma_f32_16x16x32_bf16 v[248:251], a[180:183], a[108:111], v[248:251]
v_mfma_f32_16x16x32_bf16 v[248:251], a[176:179], a[104:107], v[248:251]
s_add_u32 m0, s73, 2048
s_add_u32 s64, s71, 18432
v_mfma_f32_16x16x32_bf16 v[244:247], a[168:171], a[104:107], v[244:247]
ds_read_b128 a[88:91], v9 offset:6144
v_mfma_f32_16x16x32_bf16 v[244:247], a[172:175], a[108:111], v[244:247]
buffer_load_dwordx4 v5, s[12:15], s64 offen lds
v_mfma_f32_16x16x32_bf16 v[240:243], a[164:167], a[108:111], v[240:243]
v_mfma_f32_16x16x32_bf16 v[240:243], a[160:163], a[104:107], v[240:243]
ds_read_b64_tr_b16 a[156:157], v14 offset:40960
ds_read_b64_tr_b16 a[158:159], v14 offset:41472
v_mfma_f32_16x16x32_bf16 a[0:3], a[160:163], a[112:115], a[0:3]
v_mfma_f32_16x16x32_bf16 a[0:3], a[164:167], a[116:119], a[0:3]
v_mfma_f32_16x16x32_bf16 a[4:7], a[172:175], a[116:119], a[4:7]
ds_read_b128 a[92:95], v10 offset:6144
v_mfma_f32_16x16x32_bf16 a[4:7], a[168:171], a[112:115], a[4:7]
v_mfma_f32_16x16x32_bf16 a[8:11], a[176:179], a[112:115], a[8:11]
v_mfma_f32_16x16x32_bf16 a[8:11], a[180:183], a[116:119], a[8:11]
buffer_load_dwordx4 v6, s[12:15], s64 offen offset:1024 lds
v_mfma_f32_16x16x32_bf16 a[12:15], a[188:191], a[116:119], a[12:15]
v_mfma_f32_16x16x32_bf16 a[12:15], a[184:187], a[112:115], a[12:15]
v_mfma_f32_16x16x32_bf16 a[28:31], a[184:187], a[120:123], a[28:31]
v_mfma_f32_16x16x32_bf16 a[28:31], a[188:191], a[124:127], a[28:31]
v_mfma_f32_16x16x32_bf16 a[24:27], a[180:183], a[124:127], a[24:27]
v_mfma_f32_16x16x32_bf16 a[24:27], a[176:179], a[120:123], a[24:27]
v_mfma_f32_16x16x32_bf16 a[20:23], a[168:171], a[120:123], a[20:23]
v_mfma_f32_16x16x32_bf16 a[20:23], a[172:175], a[124:127], a[20:23]
v_mfma_f32_16x16x32_bf16 a[16:19], a[164:167], a[124:127], a[16:19]
v_mfma_f32_16x16x32_bf16 a[16:19], a[160:163], a[120:123], a[16:19]
s_waitcnt lgkmcnt(0)
v_mfma_f32_16x16x32_bf16 v[32:35], a[64:67], a[128:131], v[32:35]
s_waitcnt vmcnt(20)
v_mfma_f32_16x16x32_bf16 v[32:35], a[68:71], a[132:135], v[32:35]
s_barrier
v_mfma_f32_16x16x32_bf16 v[40:43], a[68:71], a[140:143], v[40:43]
L_PAD3:
s_cbranch_execz L_PAD7
ds_read_b128 a[96:99], v9 offset:8192
v_mfma_f32_16x16x32_bf16 v[40:43], a[64:67], a[136:139], v[40:43]
s_xor_b32 s75, s93, 0
s_lshl_b32 s76, s75, 19
s_add_u32 s76, s76, s74
v_mfma_f32_16x16x32_bf16 v[48:51], a[64:67], a[144:147], v[48:51]
s_lshl_b32 s79, s75, 13
s_add_u32 s79, s79, s78
v_mfma_f32_16x16x32_bf16 v[48:51], a[68:71], a[148:151], v[48:51]
s_add_u32 m0, s77, 32768
s_add_u32 s64, s76, 0
ds_read_b128 a[100:103], v10 offset:8192
v_mfma_f32_16x16x32_bf16 v[56:59], a[68:71], a[156:159], v[56:59]
buffer_load_dwordx4 v7, s[20:23], s64 offen lds
v_mfma_f32_16x16x32_bf16 v[56:59], a[64:67], a[152:155], v[56:59]
v_mfma_f32_16x16x32_bf16 v[60:63], a[72:75], a[152:155], v[60:63]
ds_read_b128 a[104:107], v9 offset:10240
v_mfma_f32_16x16x32_bf16 v[60:63], a[76:79], a[156:159], v[60:63]
v_mfma_f32_16x16x32_bf16 v[52:55], a[76:79], a[148:151], v[52:55]
v_mfma_f32_16x16x32_bf16 v[52:55], a[72:75], a[144:147], v[52:55]
ds_read_b64_tr_b16 a[160:161], v11 offset:49152
ds_read_b64_tr_b16 a[162:163], v11 offset:49664
v_mfma_f32_16x16x32_bf16 v[44:47], a[72:75], a[136:139], v[44:47]
buffer_load_dwordx4 v8, s[20:23], s64 offen offset:1024 lds
v_mfma_f32_16x16x32_bf16 v[44:47], a[76:79], a[140:143], v[44:47]
v_mfma_f32_16x16x32_bf16 v[36:39], a[76:79], a[132:135], v[36:39]
v_mfma_f32_16x16x32_bf16 v[36:39], a[72:75], a[128:131], v[36:39]
ds_read_b128 a[108:111], v10 offset:10240
v_mfma_f32_16x16x32_bf16 v[64:67], a[80:83], a[128:131], v[64:67]
v_mfma_f32_16x16x32_bf16 v[64:67], a[84:87], a[132:135], v[64:67]
v_mfma_f32_16x16x32_bf16 v[72:75], a[84:87], a[140:143], v[72:75]
s_add_u32 m0, s80, 32768
s_add_u32 s64, s79, 0
v_mfma_f32_16x16x32_bf16 v[72:75], a[80:83], a[136:139], v[72:75]
ds_read_b64_tr_b16 a[164:165], v11 offset:57344
ds_read_b64_tr_b16 a[166:167], v11 offset:57856
v_mfma_f32_16x16x32_bf16 v[80:83], a[80:83], a[144:147], v[80:83]
buffer_load_dwordx4 v4, s[24:27], s64 offen sc1 lds
v_mfma_f32_16x16x32_bf16 v[80:83], a[84:87], a[148:151], v[80:83]
ds_read_b128 a[112:115], v9 offset:12288
v_mfma_f32_16x16x32_bf16 v[88:91], a[84:87], a[156:159], v[88:91]
v_cvt_pk_bf16_f32 v32, v32, v33
v_cvt_pk_bf16_f32 v33, v34, v35
v_mfma_f32_16x16x32_bf16 v[88:91], a[80:83], a[152:155], v[88:91]
v_cvt_pk_bf16_f32 v34, v36, v37
v_cvt_pk_bf16_f32 v35, v38, v39
v_mfma_f32_16x16x32_bf16 v[92:95], a[88:91], a[152:155], v[92:95]
ds_read_b64_tr_b16 a[168:169], v12 offset:49152
ds_read_b64_tr_b16 a[170:171], v12 offset:49664
v_mfma_f32_16x16x32_bf16 v[92:95], a[92:95], a[156:159], v[92:95]
v_cvt_pk_bf16_f32 v40, v40, v41
v_cvt_pk_bf16_f32 v41, v42, v43
v_mfma_f32_16x16x32_bf16 v[84:87], a[92:95], a[148:151], v[84:87]
s_add_u32 m0, s73, 4096
s_add_u32 s64, s72, 0
s_lshr_b32 s55, s3, 1
v_mfma_f32_16x16x32_bf16 v[84:87], a[88:91], a[144:147], v[84:87]
s_lshl_b32 s55, s55, 14
s_lshl_b32 s54, s3, 13
s_sub_u32 s55, s54, s55
v_mfma_f32_16x16x32_bf16 v[76:79], a[88:91], a[136:139], v[76:79]
buffer_load_dwordx4 v5, s[12:15], s64 offen lds
v_mfma_f32_16x16x32_bf16 v[76:79], a[92:95], a[140:143], v[76:79]
s_and_b32 s54, s3, 1
s_lshl_b32 s54, s54, 12
ds_read_b128 a[116:119], v10 offset:12288
v_mfma_f32_16x16x32_bf16 v[68:71], a[92:95], a[132:135], v[68:71]
s_add_u32 s53, s88, 0
v_cvt_pk_bf16_f32 v42, v44, v45
v_cvt_pk_bf16_f32 v43, v46, v47
v_mfma_f32_16x16x32_bf16 v[68:71], a[88:91], a[128:131], v[68:71]
s_waitcnt lgkmcnt(6)
ds_read_b64_tr_b16 a[172:173], v12 offset:57344
ds_read_b64_tr_b16 a[174:175], v12 offset:57856
v_mfma_f32_16x16x32_bf16 v[96:99], a[96:99], a[128:131], v[96:99]
buffer_store_dwordx4 v[32:35], v4, s[24:27], s53 offen offset:0 sc1
v_mfma_f32_16x16x32_bf16 v[96:99], a[100:103], a[132:135], v[96:99]
v_cvt_pk_bf16_f32 v48, v48, v49
v_cvt_pk_bf16_f32 v49, v50, v51
v_mfma_f32_16x16x32_bf16 v[104:107], a[100:103], a[140:143], v[104:107]
ds_read_b128 a[120:123], v9 offset:14336
v_cvt_pk_bf16_f32 v50, v52, v53
v_mfma_f32_16x16x32_bf16 v[104:107], a[96:99], a[136:139], v[104:107]
v_cvt_pk_bf16_f32 v51, v54, v55
v_cvt_pk_bf16_f32 v56, v56, v57
v_mfma_f32_16x16x32_bf16 v[112:115], a[96:99], a[144:147], v[112:115]
v_cvt_pk_bf16_f32 v57, v58, v59
v_cvt_pk_bf16_f32 v58, v60, v61
v_mfma_f32_16x16x32_bf16 v[112:115], a[100:103], a[148:151], v[112:115]
buffer_load_dwordx4 v6, s[12:15], s64 offen offset:1024 lds
v_mfma_f32_16x16x32_bf16 v[120:123], a[100:103], a[156:159], v[120:123]
ds_read_b64_tr_b16 a[176:177], v13 offset:49152
ds_read_b64_tr_b16 a[178:179], v13 offset:49664
v_mfma_f32_16x16x32_bf16 v[120:123], a[96:99], a[152:155], v[120:123]
v_cvt_pk_bf16_f32 v59, v62, v63
v_cvt_pk_bf16_f32 v64, v64, v65
v_mfma_f32_16x16x32_bf16 v[124:127], a[104:107], a[152:155], v[124:127]
v_cvt_pk_bf16_f32 v65, v66, v67
v_cvt_pk_bf16_f32 v66, v68, v69
v_mfma_f32_16x16x32_bf16 v[124:127], a[108:111], a[156:159], v[124:127]
ds_read_b128 a[124:127], v10 offset:14336
v_cvt_pk_bf16_f32 v67, v70, v71
v_mfma_f32_16x16x32_bf16 v[116:119], a[108:111], a[148:151], v[116:119]
v_add_u32 v9, 32768, v9
v_add_u32 v10, 32768, v10
v_mfma_f32_16x16x32_bf16 v[116:119], a[104:107], a[144:147], v[116:119]
s_add_u32 m0, s73, 6144
s_add_u32 s64, s72, 18432
v_cvt_pk_bf16_f32 v72, v72, v73
v_mfma_f32_16x16x32_bf16 v[108:111], a[104:107], a[136:139], v[108:111]
ds_read_b64_tr_b16 a[180:181], v13 offset:57344
ds_read_b64_tr_b16 a[182:183], v13 offset:57856
v_mfma_f32_16x16x32_bf16 v[108:111], a[108:111], a[140:143], v[108:111]
buffer_load_dwordx4 v5, s[12:15], s64 offen lds
v_mfma_f32_16x16x32_bf16 v[100:103], a[108:111], a[132:135], v[100:103]
v_cvt_pk_bf16_f32 v73, v74, v75
v_cvt_pk_bf16_f32 v74, v76, v77
v_mfma_f32_16x16x32_bf16 v[100:103], a[104:107], a[128:131], v[100:103]
s_waitcnt lgkmcnt(2)
ds_read_b64_tr_b16 a[184:185], v14 offset:49152
ds_read_b64_tr_b16 a[186:187], v14 offset:49664
v_mfma_f32_16x16x32_bf16 v[128:131], a[112:115], a[128:131], v[128:131]
v_cvt_pk_bf16_f32 v75, v78, v79
v_cvt_pk_bf16_f32 v80, v80, v81
v_mfma_f32_16x16x32_bf16 v[128:131], a[116:119], a[132:135], v[128:131]
v_cvt_pk_bf16_f32 v81, v82, v83
v_cvt_pk_bf16_f32 v82, v84, v85
v_mfma_f32_16x16x32_bf16 v[136:139], a[116:119], a[140:143], v[136:139]
ds_read_b64_tr_b16 a[188:189], v14 offset:57344
ds_read_b64_tr_b16 a[190:191], v14 offset:57856
v_mfma_f32_16x16x32_bf16 v[136:139], a[112:115], a[136:139], v[136:139]
v_add_u32 v9, s55, v9
v_add_u32 v10, s55, v10
v_mfma_f32_16x16x32_bf16 v[144:147], a[112:115], a[144:147], v[144:147]
v_subrev_u32 v11, s54, v11
v_subrev_u32 v12, s54, v12
v_mfma_f32_16x16x32_bf16 v[144:147], a[116:119], a[148:151], v[144:147]
buffer_load_dwordx4 v6, s[12:15], s64 offen offset:1024 lds
v_mfma_f32_16x16x32_bf16 v[152:155], a[116:119], a[156:159], v[152:155]
v_subrev_u32 v13, s54, v13
v_subrev_u32 v14, s54, v14
v_mfma_f32_16x16x32_bf16 v[152:155], a[112:115], a[152:155], v[152:155]
v_cvt_pk_bf16_f32 v83, v86, v87
v_cvt_pk_bf16_f32 v88, v88, v89
v_mfma_f32_16x16x32_bf16 v[156:159], a[120:123], a[152:155], v[156:159]
v_cvt_pk_bf16_f32 v89, v90, v91
v_cvt_pk_bf16_f32 v90, v92, v93
v_mfma_f32_16x16x32_bf16 v[156:159], a[124:127], a[156:159], v[156:159]
s_add_u32 s53, s88, 0
v_cvt_pk_bf16_f32 v91, v94, v95
v_cvt_pk_bf16_f32 v96, v96, v97
v_mfma_f32_16x16x32_bf16 v[148:151], a[124:127], a[148:151], v[148:151]
buffer_store_dwordx4 v[40:43], v4, s[24:27], s53 offen offset:1024 sc1
v_mfma_f32_16x16x32_bf16 v[148:151], a[120:123], a[144:147], v[148:151]
v_cvt_pk_bf16_f32 v97, v98, v99
v_cvt_pk_bf16_f32 v98, v100, v101
v_mfma_f32_16x16x32_bf16 v[140:143], a[120:123], a[136:139], v[140:143]
v_cvt_pk_bf16_f32 v99, v102, v103
v_cvt_pk_bf16_f32 v104, v104, v105
v_mfma_f32_16x16x32_bf16 v[140:143], a[124:127], a[140:143], v[140:143]
v_cvt_pk_bf16_f32 v105, v106, v107
v_cvt_pk_bf16_f32 v106, v108, v109
v_mfma_f32_16x16x32_bf16 v[132:135], a[124:127], a[132:135], v[132:135]
v_cvt_pk_bf16_f32 v107, v110, v111
v_cvt_pk_bf16_f32 v112, v112, v113
v_mfma_f32_16x16x32_bf16 v[132:135], a[120:123], a[128:131], v[132:135]
s_waitcnt lgkmcnt(0)
v_cvt_pk_bf16_f32 v113, v114, v115
v_cvt_pk_bf16_f32 v114, v116, v117
v_mfma_f32_16x16x32_bf16 v[160:163], a[160:163], a[64:67], v[160:163]
s_waitcnt vmcnt(16)
v_cvt_pk_bf16_f32 v115, v118, v119
v_cvt_pk_bf16_f32 v120, v120, v121
v_mfma_f32_16x16x32_bf16 v[160:163], a[164:167], a[68:71], v[160:163]
s_barrier
v_mfma_f32_16x16x32_bf16 v[164:167], a[172:175], a[68:71], v[164:167]
ds_read_b64_tr_b16 a[128:129], v11 offset:0
ds_read_b64_tr_b16 a[130:131], v11 offset:512
v_mfma_f32_16x16x32_bf16 v[164:167], a[168:171], a[64:67], v[164:167]
s_add_u32 m0, s77, 49152
s_add_u32 s64, s76, 128
v_cvt_pk_bf16_f32 v121, v122, v123
v_mfma_f32_16x16x32_bf16 v[168:171], a[176:179], a[64:67], v[168:171]
buffer_load_dwordx4 v7, s[20:23], s64 offen lds
v_mfma_f32_16x16x32_bf16 v[168:171], a[180:183], a[68:71], v[168:171]
ds_read_b64_tr_b16 a[132:133], v11 offset:4096
ds_read_b64_tr_b16 a[134:135], v11 offset:4608
v_mfma_f32_16x16x32_bf16 v[172:175], a[188:191], a[68:71], v[172:175]
v_cvt_pk_bf16_f32 v122, v124, v125
v_cvt_pk_bf16_f32 v123, v126, v127
v_mfma_f32_16x16x32_bf16 v[172:175], a[184:187], a[64:67], v[172:175]
v_cvt_pk_bf16_f32 v128, v128, v129
v_cvt_pk_bf16_f32 v129, v130, v131
v_mfma_f32_16x16x32_bf16 v[188:191], a[184:187], a[72:75], v[188:191]
ds_read_b64_tr_b16 a[136:137], v12 offset:0
ds_read_b64_tr_b16 a[138:139], v12 offset:512
v_mfma_f32_16x16x32_bf16 v[188:191], a[188:191], a[76:79], v[188:191]
v_cvt_pk_bf16_f32 v130, v132, v133
v_cvt_pk_bf16_f32 v131, v134, v135
v_mfma_f32_16x16x32_bf16 v[184:187], a[180:183], a[76:79], v[184:187]
v_cvt_pk_bf16_f32 v136, v136, v137
v_cvt_pk_bf16_f32 v137, v138, v139
v_mfma_f32_16x16x32_bf16 v[184:187], a[176:179], a[72:75], v[184:187]
ds_read_b64_tr_b16 a[140:141], v12 offset:4096
ds_read_b64_tr_b16 a[142:143], v12 offset:4608
v_mfma_f32_16x16x32_bf16 v[180:183], a[168:171], a[72:75], v[180:183]
buffer_load_dwordx4 v8, s[20:23], s64 offen offset:1024 lds
v_mfma_f32_16x16x32_bf16 v[180:183], a[172:175], a[76:79], v[180:183]
v_cvt_pk_bf16_f32 v138, v140, v141
v_cvt_pk_bf16_f32 v139, v142, v143
v_mfma_f32_16x16x32_bf16 v[176:179], a[164:167], a[76:79], v[176:179]
v_cvt_pk_bf16_f32 v144, v144, v145
v_cvt_pk_bf16_f32 v145, v146, v147
v_mfma_f32_16x16x32_bf16 v[176:179], a[160:163], a[72:75], v[176:179]
ds_read_b64_tr_b16 a[144:145], v13 offset:0
ds_read_b64_tr_b16 a[146:147], v13 offset:512
v_mfma_f32_16x16x32_bf16 v[192:195], a[160:163], a[80:83], v[192:195]
v_cvt_pk_bf16_f32 v146, v148, v149
v_cvt_pk_bf16_f32 v147, v150, v151
v_mfma_f32_16x16x32_bf16 v[192:195], a[164:167], a[84:87], v[192:195]
v_cvt_pk_bf16_f32 v152, v152, v153
v_cvt_pk_bf16_f32 v153, v154, v155
v_mfma_f32_16x16x32_bf16 v[196:199], a[172:175], a[84:87], v[196:199]
s_add_u32 m0, s80, 49152
s_add_u32 s64, s79, 2048
v_cvt_pk_bf16_f32 v154, v156, v157
v_mfma_f32_16x16x32_bf16 v[196:199], a[168:171], a[80:83], v[196:199]
ds_read_b64_tr_b16 a[148:149], v13 offset:4096
ds_read_b64_tr_b16 a[150:151], v13 offset:4608
v_mfma_f32_16x16x32_bf16 v[200:203], a[176:179], a[80:83], v[200:203]
buffer_load_dwordx4 v4, s[24:27], s64 offen sc1 lds
v_mfma_f32_16x16x32_bf16 v[200:203], a[180:183], a[84:87], v[200:203]
s_xor_b32 s65, s70, 128
s_add_u32 s71, s68, s65
s_add_u32 s72, s69, s65
v_mfma_f32_16x16x32_bf16 v[204:207], a[188:191], a[84:87], v[204:207]
s_add_u32 s53, s88, 0
ds_read_b64_tr_b16 a[152:153], v14 offset:0
ds_read_b64_tr_b16 a[154:155], v14 offset:512
v_mfma_f32_16x16x32_bf16 v[204:207], a[184:187], a[80:83], v[204:207]
buffer_store_dwordx4 v[48:51], v4, s[24:27], s53 offen offset:2048 sc1
v_mfma_f32_16x16x32_bf16 v[220:223], a[184:187], a[88:91], v[220:223]
ds_read_b64_tr_b16 a[156:157], v14 offset:4096
ds_read_b64_tr_b16 a[158:159], v14 offset:4608
v_mfma_f32_16x16x32_bf16 v[220:223], a[188:191], a[92:95], v[220:223]
v_cvt_pk_bf16_f32 v155, v158, v159
v_mul_f32 v160, s91, v160
v_mfma_f32_16x16x32_bf16 v[216:219], a[180:183], a[92:95], v[216:219]
s_add_u32 m0, s73, 32768
s_add_u32 s64, s71, 0
v_mul_f32 v161, s91, v161
v_mfma_f32_16x16x32_bf16 v[216:219], a[176:179], a[88:91], v[216:219]
v_mul_f32 v162, s91, v162
v_mul_f32 v163, s91, v163
v_mfma_f32_16x16x32_bf16 v[212:215], a[168:171], a[88:91], v[212:215]
buffer_load_dwordx4 v5, s[12:15], s64 offen lds
v_mfma_f32_16x16x32_bf16 v[212:215], a[172:175], a[92:95], v[212:215]
ds_read_b128 a[68:71], v4 offset:10240
v_mul_f32 v164, s91, v164
v_mfma_f32_16x16x32_bf16 v[208:211], a[164:167], a[92:95], v[208:211]
v_mul_f32 v165, s91, v165
v_mul_f32 v166, s91, v166
v_mfma_f32_16x16x32_bf16 v[208:211], a[160:163], a[88:91], v[208:211]
ds_read_b128 a[64:67], v4 offset:8192
v_mul_f32 v167, s91, v167
v_mfma_f32_16x16x32_bf16 v[224:227], a[160:163], a[96:99], v[224:227]
v_cvt_pk_bf16_f32 v160, v160, v161
v_cvt_pk_bf16_f32 v161, v162, v163
v_mfma_f32_16x16x32_bf16 v[224:227], a[164:167], a[100:103], v[224:227]
v_cvt_pk_bf16_f32 v162, v164, v165
v_cvt_pk_bf16_f32 v163, v166, v167
v_mfma_f32_16x16x32_bf16 v[228:231], a[172:175], a[100:103], v[228:231]
ds_read_b128 a[76:79], v4 offset:11264
v_mul_f32 v168, s91, v168
v_mfma_f32_16x16x32_bf16 v[228:231], a[168:171], a[96:99], v[228:231]
v_mul_f32 v169, s91, v169
v_mul_f32 v170, s91, v170
v_mfma_f32_16x16x32_bf16 v[232:235], a[176:179], a[96:99], v[232:235]
v_mul_f32 v171, s91, v171
v_mul_f32 v172, s91, v172
v_mfma_f32_16x16x32_bf16 v[232:235], a[180:183], a[100:103], v[232:235]
buffer_load_dwordx4 v6, s[12:15], s64 offen offset:1024 lds
v_mfma_f32_16x16x32_bf16 v[236:239], a[188:191], a[100:103], v[236:239]
ds_read_b128 a[72:75], v4 offset:9216
v_mul_f32 v173, s91, v173
v_mfma_f32_16x16x32_bf16 v[236:239], a[184:187], a[96:99], v[236:239]
v_mul_f32 v174, s91, v174
v_mul_f32 v175, s91, v175
v_mfma_f32_16x16x32_bf16 v[252:255], a[184:187], a[104:107], v[252:255]
v_cvt_pk_bf16_f32 v168, v168, v169
v_cvt_pk_bf16_f32 v169, v170, v171
v_mfma_f32_16x16x32_bf16 v[252:255], a[188:191], a[108:111], v[252:255]
ds_read_b128 a[84:87], v10 offset:0
v_cvt_pk_bf16_f32 v170, v172, v173
v_mfma_f32_16x16x32_bf16 v[248:251], a[180:183], a[108:111], v[248:251]
v_cvt_pk_bf16_f32 v171, v174, v175
v_mul_f32 v176, s91, v176
v_mfma_f32_16x16x32_bf16 v[248:251], a[176:179], a[104:107], v[248:251]
s_add_u32 m0, s73, 34816
s_add_u32 s64, s71, 18432
v_mul_f32 v177, s91, v177
v_mfma_f32_16x16x32_bf16 v[244:247], a[168:171], a[104:107], v[244:247]
ds_read_b128 a[80:83], v9 offset:0
v_mul_f32 v178, s91, v178
v_mfma_f32_16x16x32_bf16 v[244:247], a[172:175], a[108:111], v[244:247]
buffer_load_dwordx4 v5, s[12:15], s64 offen lds
v_mfma_f32_16x16x32_bf16 v[240:243], a[164:167], a[108:111], v[240:243]
v_mul_f32 v179, s91, v179
v_mul_f32 v180, s91, v180
v_mfma_f32_16x16x32_bf16 v[240:243], a[160:163], a[104:107], v[240:243]
s_add_u32 s53, s88, 0
ds_read_b128 a[92:95], v10 offset:2048
v_mul_f32 v181, s91, v181
v_mfma_f32_16x16x32_bf16 a[0:3], a[160:163], a[112:115], a[0:3]
buffer_store_dwordx4 v[56:59], v4, s[24:27], s53 offen offset:3072 sc1
v_mfma_f32_16x16x32_bf16 a[0:3], a[164:167], a[116:119], a[0:3]
v_mul_f32 v182, s91, v182
v_mul_f32 v183, s91, v183
v_mfma_f32_16x16x32_bf16 a[4:7], a[172:175], a[116:119], a[4:7]
ds_read_b128 a[88:91], v9 offset:2048
v_cvt_pk_bf16_f32 v176, v176, v177
v_mfma_f32_16x16x32_bf16 a[4:7], a[168:171], a[112:115], a[4:7]
v_cvt_pk_bf16_f32 v177, v178, v179
v_cvt_pk_bf16_f32 v178, v180, v181
v_mfma_f32_16x16x32_bf16 a[8:11], a[176:179], a[112:115], a[8:11]
v_cvt_pk_bf16_f32 v179, v182, v183
v_mul_f32 v184, s91, v184
v_mfma_f32_16x16x32_bf16 a[8:11], a[180:183], a[116:119], a[8:11]
buffer_load_dwordx4 v6, s[12:15], s64 offen offset:1024 lds
v_mfma_f32_16x16x32_bf16 a[12:15], a[188:191], a[116:119], a[12:15]
v_mul_f32 v185, s91, v185
v_mul_f32 v186, s91, v186
v_mfma_f32_16x16x32_bf16 a[12:15], a[184:187], a[112:115], a[12:15]
v_mul_f32 v187, s91, v187
v_mul_f32 v188, s91, v188
v_mfma_f32_16x16x32_bf16 a[28:31], a[184:187], a[120:123], a[28:31]
v_mul_f32 v189, s91, v189
v_mul_f32 v190, s91, v190
v_mfma_f32_16x16x32_bf16 a[28:31], a[188:191], a[124:127], a[28:31]
v_mul_f32 v191, s91, v191
v_cvt_pk_bf16_f32 v184, v184, v185
v_mfma_f32_16x16x32_bf16 a[24:27], a[180:183], a[124:127], a[24:27]
v_cvt_pk_bf16_f32 v185, v186, v187
v_cvt_pk_bf16_f32 v186, v188, v189
v_mfma_f32_16x16x32_bf16 a[24:27], a[176:179], a[120:123], a[24:27]
v_cvt_pk_bf16_f32 v187, v190, v191
v_mul_f32 v192, s91, v192
v_mfma_f32_16x16x32_bf16 a[20:23], a[168:171], a[120:123], a[20:23]
v_mul_f32 v193, s91, v193
v_mul_f32 v194, s91, v194
v_mfma_f32_16x16x32_bf16 a[20:23], a[172:175], a[124:127], a[20:23]
v_mul_f32 v195, s91, v195
v_mul_f32 v196, s91, v196
v_mfma_f32_16x16x32_bf16 a[16:19], a[164:167], a[124:127], a[16:19]
v_mul_f32 v197, s91, v197
v_mul_f32 v198, s91, v198
v_mfma_f32_16x16x32_bf16 a[16:19], a[160:163], a[120:123], a[16:19]
s_waitcnt lgkmcnt(0)
v_mul_f32 v199, s91, v199
v_cvt_pk_bf16_f32 v192, v192, v193
v_mfma_f32_16x16x32_bf16 v[36:39], a[128:131], a[80:83], 0
s_waitcnt vmcnt(22)
v_cvt_pk_bf16_f32 v193, v194, v195
v_cvt_pk_bf16_f32 v194, v196, v197
v_mfma_f32_16x16x32_bf16 v[36:39], a[132:135], a[84:87], v[36:39]
s_barrier
v_mfma_f32_16x16x32_bf16 v[44:47], a[140:143], a[84:87], 0
ds_read_b128 a[96:99], v9 offset:4096
v_cvt_pk_bf16_f32 v195, v198, v199
v_mfma_f32_16x16x32_bf16 v[44:47], a[136:139], a[80:83], v[44:47]
s_xor_b32 s75, s93, 1
s_lshl_b32 s76, s75, 19
s_add_u32 s76, s76, s74
v_mfma_f32_16x16x32_bf16 v[32:35], a[144:147], a[80:83], 0
s_lshl_b32 s79, s75, 13
s_add_u32 s79, s79, s78
ds_read_b128 a[100:103], v10 offset:4096
v_mfma_f32_16x16x32_bf16 v[32:35], a[148:151], a[84:87], v[32:35]
s_add_u32 m0, s77, 0
s_add_u32 s64, s76, 0
ds_read_b128 a[104:107], v9 offset:6144
v_mfma_f32_16x16x32_bf16 v[52:55], a[156:159], a[84:87], 0
buffer_load_dwordx4 v7, s[20:23], s64 offen lds
v_mfma_f32_16x16x32_bf16 v[52:55], a[152:155], a[80:83], v[52:55]
ds_read_b64_tr_b16 a[160:161], v11 offset:16384
ds_read_b64_tr_b16 a[162:163], v11 offset:16896
v_mfma_f32_16x16x32_bf16 v[60:63], a[64:67], a[80:83], 0
v_mul_f32 v200, s91, v200
v_mul_f32 v201, s91, v201
v_mfma_f32_16x16x32_bf16 v[60:63], a[68:71], a[84:87], v[60:63]
ds_read_b128 a[108:111], v10 offset:6144
v_mul_f32 v202, s91, v202
v_mfma_f32_16x16x32_bf16 v[68:71], a[76:79], a[84:87], 0
buffer_load_dwordx4 v8, s[20:23], s64 offen offset:1024 lds
v_mfma_f32_16x16x32_bf16 v[68:71], a[72:75], a[80:83], v[68:71]
s_add_u32 s53, s88, 262144
ds_read_b64_tr_b16 a[164:165], v11 offset:20480
ds_read_b64_tr_b16 a[166:167], v11 offset:20992
v_mfma_f32_16x16x32_bf16 v[76:79], a[72:75], a[88:91], 0
v_add_u32 v9, -65536, v9
v_add_u32 v10, -65536, v10
v_mfma_f32_16x16x32_bf16 v[76:79], a[76:79], a[92:95], v[76:79]
ds_read_b64_tr_b16 a[168:169], v12 offset:16384
ds_read_b64_tr_b16 a[170:171], v12 offset:16896
v_mfma_f32_16x16x32_bf16 v[84:87], a[68:71], a[92:95], 0
s_add_u32 m0, s80, 0
s_add_u32 s64, s79, 0
v_mul_f32 v203, s91, v203
v_mfma_f32_16x16x32_bf16 v[84:87], a[64:67], a[88:91], v[84:87]
ds_read_b64_tr_b16 a[172:173], v12 offset:20480
ds_read_b64_tr_b16 a[174:175], v12 offset:20992
v_mfma_f32_16x16x32_bf16 v[92:95], a[152:155], a[88:91], 0
buffer_load_dwordx4 v4, s[24:27], s64 offen sc1 lds
v_mfma_f32_16x16x32_bf16 v[92:95], a[156:159], a[92:95], v[92:95]
buffer_store_dwordx4 v[64:67], v4, s[24:27], s53 offen offset:0 sc1
v_mfma_f32_16x16x32_bf16 v[40:43], a[148:151], a[92:95], 0
ds_read_b64_tr_b16 a[176:177], v13 offset:16384
ds_read_b64_tr_b16 a[178:179], v13 offset:16896
v_mfma_f32_16x16x32_bf16 v[40:43], a[144:147], a[88:91], v[40:43]
v_mul_f32 v204, s91, v204
v_mul_f32 v205, s91, v205
v_mfma_f32_16x16x32_bf16 v[100:103], a[136:139], a[88:91], 0
s_add_u32 m0, s73, 36864
s_add_u32 s64, s72, 0
v_mul_f32 v206, s91, v206
v_mfma_f32_16x16x32_bf16 v[100:103], a[140:143], a[92:95], v[100:103]
ds_read_b64_tr_b16 a[180:181], v13 offset:20480
ds_read_b64_tr_b16 a[182:183], v13 offset:20992
v_mfma_f32_16x16x32_bf16 v[108:111], a[132:135], a[92:95], 0
buffer_load_dwordx4 v5, s[12:15], s64 offen lds
v_mfma_f32_16x16x32_bf16 v[108:111], a[128:131], a[88:91], v[108:111]
s_waitcnt lgkmcnt(14)
ds_read_b64_tr_b16 a[184:185], v14 offset:16384
ds_read_b64_tr_b16 a[186:187], v14 offset:16896
v_mfma_f32_16x16x32_bf16 v[116:119], a[128:131], a[96:99], 0
ds_read_b64_tr_b16 a[188:189], v14 offset:20480
ds_read_b64_tr_b16 a[190:191], v14 offset:20992
v_mfma_f32_16x16x32_bf16 v[116:119], a[132:135], a[100:103], v[116:119]
v_mul_f32 v207, s91, v207
v_cvt_pk_bf16_f32 v200, v200, v201
v_mfma_f32_16x16x32_bf16 v[124:127], a[140:143], a[100:103], 0
v_cvt_pk_bf16_f32 v201, v202, v203
v_cvt_pk_bf16_f32 v202, v204, v205
v_mfma_f32_16x16x32_bf16 v[124:127], a[136:139], a[96:99], v[124:127]
ds_read_b128 a[112:115], v4 offset:24576
v_cvt_pk_bf16_f32 v203, v206, v207
v_mfma_f32_16x16x32_bf16 v[132:135], a[144:147], a[96:99], 0
buffer_load_dwordx4 v6, s[12:15], s64 offen offset:1024 lds
v_mfma_f32_16x16x32_bf16 v[132:135], a[148:151], a[100:103], v[132:135]
ds_read_b128 a[116:119], v4 offset:26624
v_mul_f32 v208, s91, v208
v_mfma_f32_16x16x32_bf16 v[140:143], a[156:159], a[100:103], 0
v_mul_f32 v209, s91, v209
v_mul_f32 v210, s91, v210
v_mfma_f32_16x16x32_bf16 v[140:143], a[152:155], a[96:99], v[140:143]
ds_read_b128 a[120:123], v4 offset:25600
v_mul_f32 v211, s91, v211
v_mfma_f32_16x16x32_bf16 v[148:151], a[64:67], a[96:99], 0
s_add_u32 m0, s73, 38912
s_add_u32 s64, s72, 18432
v_mul_f32 v212, s91, v212
v_mfma_f32_16x16x32_bf16 v[148:151], a[68:71], a[100:103], v[148:151]
ds_read_b128 a[124:127], v4 offset:27648
v_mul_f32 v213, s91, v213
v_mfma_f32_16x16x32_bf16 v[48:51], a[76:79], a[100:103], 0
buffer_load_dwordx4 v5, s[12:15], s64 offen lds
v_mfma_f32_16x16x32_bf16 v[48:51], a[72:75], a[96:99], v[48:51]
s_waitcnt lgkmcnt(15)
v_mul_f32 v214, s91, v214
v_mul_f32 v215, s91, v215
v_mfma_f32_16x16x32_bf16 v[156:159], a[72:75], a[104:107], 0
v_cvt_pk_bf16_f32 v208, v208, v209
v_cvt_pk_bf16_f32 v209, v210, v211
v_mfma_f32_16x16x32_bf16 v[156:159], a[76:79], a[108:111], v[156:159]
s_add_u32 s53, s88, 262144
v_cvt_pk_bf16_f32 v210, v212, v213
v_cvt_pk_bf16_f32 v211, v214, v215
v_mfma_f32_16x16x32_bf16 v[164:167], a[68:71], a[108:111], 0
buffer_store_dwordx4 v[72:75], v4, s[24:27], s53 offen offset:1024 sc1
v_mfma_f32_16x16x32_bf16 v[164:167], a[64:67], a[104:107], v[164:167]
v_mul_f32 v216, s91, v216
v_mul_f32 v217, s91, v217
v_mfma_f32_16x16x32_bf16 v[172:175], a[152:155], a[104:107], 0
buffer_load_dwordx4 v6, s[12:15], s64 offen offset:1024 lds
v_mfma_f32_16x16x32_bf16 v[172:175], a[156:159], a[108:111], v[172:175]
v_mul_f32 v218, s91, v218
v_mul_f32 v219, s91, v219
v_mfma_f32_16x16x32_bf16 v[56:59], a[148:151], a[108:111], 0
v_mul_f32 v220, s91, v220
v_mul_f32 v221, s91, v221
v_mfma_f32_16x16x32_bf16 v[56:59], a[144:147], a[104:107], v[56:59]
v_mul_f32 v222, s91, v222
v_mul_f32 v223, s91, v223
v_mfma_f32_16x16x32_bf16 v[180:183], a[136:139], a[104:107], 0
v_cvt_pk_bf16_f32 v216, v216, v217
v_cvt_pk_bf16_f32 v217, v218, v219
v_mfma_f32_16x16x32_bf16 v[180:183], a[140:143], a[108:111], v[180:183]
v_cvt_pk_bf16_f32 v218, v220, v221
v_cvt_pk_bf16_f32 v219, v222, v223
v_mfma_f32_16x16x32_bf16 v[188:191], a[132:135], a[108:111], 0
v_mul_f32 v224, s91, v224
v_mul_f32 v225, s91, v225
v_mfma_f32_16x16x32_bf16 v[188:191], a[128:131], a[104:107], v[188:191]
s_waitcnt lgkmcnt(0)
v_mul_f32 v226, s91, v226
v_mul_f32 v227, s91, v227
v_mfma_f32_16x16x32_bf16 v[196:199], a[160:163], a[80:83], 0
s_waitcnt vmcnt(19)
v_mul_f32 v228, s91, v228
v_mul_f32 v229, s91, v229
v_mfma_f32_16x16x32_bf16 v[196:199], a[164:167], a[84:87], v[196:199]
s_barrier
v_mfma_f32_16x16x32_bf16 v[64:67], a[172:175], a[84:87], 0
ds_read_b64_tr_b16 a[128:129], v11 offset:32768
ds_read_b64_tr_b16 a[130:131], v11 offset:33280
v_mfma_f32_16x16x32_bf16 v[64:67], a[168:171], a[80:83], v[64:67]
s_add_u32 m0, s77, 16384
s_add_u32 s64, s76, 128
v_mul_f32 v230, s91, v230
v_mfma_f32_16x16x32_bf16 v[204:207], a[176:179], a[80:83], 0
buffer_load_dwordx4 v7, s[20:23], s64 offen lds
v_mfma_f32_16x16x32_bf16 v[204:207], a[180:183], a[84:87], v[204:207]
ds_read_b64_tr_b16 a[132:133], v11 offset:36864
ds_read_b64_tr_b16 a[134:135], v11 offset:37376
v_mfma_f32_16x16x32_bf16 v[212:215], a[188:191], a[84:87], 0
ds_read_b64_tr_b16 a[136:137], v12 offset:32768
ds_read_b64_tr_b16 a[138:139], v12 offset:33280
v_mfma_f32_16x16x32_bf16 v[212:215], a[184:187], a[80:83], v[212:215]
ds_read_b64_tr_b16 a[140:141], v12 offset:36864
ds_read_b64_tr_b16 a[142:143], v12 offset:37376
v_mfma_f32_16x16x32_bf16 v[72:75], a[112:115], a[80:83], 0
v_mul_f32 v231, s91, v231
v_cvt_pk_bf16_f32 v224, v224, v225
v_mfma_f32_16x16x32_bf16 v[72:75], a[116:119], a[84:87], v[72:75]
ds_read_b64_tr_b16 a[144:145], v13 offset:32768
ds_read_b64_tr_b16 a[146:147], v13 offset:33280
v_mfma_f32_16x16x32_bf16 v[220:223], a[124:127], a[84:87], 0
buffer_load_dwordx4 v8, s[20:23], s64 offen offset:1024 lds
v_mfma_f32_16x16x32_bf16 v[220:223], a[120:123], a[80:83], v[220:223]
ds_read_b64_tr_b16 a[148:149], v13 offset:36864
ds_read_b64_tr_b16 a[150:151], v13 offset:37376
v_mfma_f32_16x16x32_bf16 a[32:35], a[120:123], a[88:91], 0
v_cvt_pk_bf16_f32 v225, v226, v227
v_cvt_pk_bf16_f32 v226, v228, v229
v_mfma_f32_16x16x32_bf16 a[32:35], a[124:127], a[92:95], a[32:35]
ds_read_b64_tr_b16 a[152:153], v14 offset:32768
ds_read_b64_tr_b16 a[154:155], v14 offset:33280
v_mfma_f32_16x16x32_bf16 a[36:39], a[116:119], a[92:95], 0
s_add_u32 m0, s80, 16384
s_add_u32 s64, s79, 2048
v_cvt_pk_bf16_f32 v227, v230, v231
v_mfma_f32_16x16x32_bf16 a[36:39], a[112:115], a[88:91], a[36:39]
ds_read_b64_tr_b16 a[156:157], v14 offset:36864
ds_read_b64_tr_b16 a[158:159], v14 offset:37376
v_mfma_f32_16x16x32_bf16 v[228:231], a[184:187], a[88:91], 0
buffer_load_dwordx4 v4, s[24:27], s64 offen sc1 lds
v_mfma_f32_16x16x32_bf16 v[228:231], a[188:191], a[92:95], v[228:231]
s_xor_b32 s65, s70, 256
s_add_u32 s71, s68, s65
s_add_u32 s72, s69, s65
v_mfma_f32_16x16x32_bf16 a[40:43], a[180:183], a[92:95], 0
s_add_u32 s53, s88, 262144
ds_read_b128 a[64:67], v4 offset:40960
v_mul_f32 v232, s91, v232
v_mfma_f32_16x16x32_bf16 a[40:43], a[176:179], a[88:91], a[40:43]
buffer_store_dwordx4 v[80:83], v4, s[24:27], s53 offen offset:2048 sc1
v_mfma_f32_16x16x32_bf16 a[44:47], a[168:171], a[88:91], 0
s_add_u32 m0, s73, 65536
s_add_u32 s64, s71, 0
ds_read_b128 a[80:83], v9 offset:0
v_mfma_f32_16x16x32_bf16 a[44:47], a[172:175], a[92:95], a[44:47]
L_PAD4:
s_cbranch_execz L_PAD8
v_mul_f32 v233, s91, v233
v_mul_f32 v234, s91, v234
v_mfma_f32_16x16x32_bf16 v[80:83], a[164:167], a[92:95], 0
buffer_load_dwordx4 v5, s[12:15], s64 offen lds
v_mfma_f32_16x16x32_bf16 v[80:83], a[160:163], a[88:91], v[80:83]
ds_read_b128 a[68:71], v4 offset:43008
v_mul_f32 v235, s91, v235
v_mfma_f32_16x16x32_bf16 a[48:51], a[160:163], a[96:99], 0
ds_read_b128 a[84:87], v10 offset:0
v_mul_f32 v236, s91, v236
v_mfma_f32_16x16x32_bf16 a[48:51], a[164:167], a[100:103], a[48:51]
v_mul_f32 v237, s91, v237
v_mul_f32 v238, s91, v238
v_mfma_f32_16x16x32_bf16 a[52:55], a[172:175], a[100:103], 0
v_mul_f32 v239, s91, v239
v_cvt_pk_bf16_f32 v232, v232, v233
v_mfma_f32_16x16x32_bf16 a[52:55], a[168:171], a[96:99], a[52:55]
ds_read_b128 a[72:75], v4 offset:41984
v_cvt_pk_bf16_f32 v233, v234, v235
v_mfma_f32_16x16x32_bf16 a[56:59], a[176:179], a[96:99], 0
buffer_load_dwordx4 v6, s[12:15], s64 offen offset:1024 lds
v_mfma_f32_16x16x32_bf16 a[56:59], a[180:183], a[100:103], a[56:59]
ds_read_b128 a[88:91], v9 offset:2048
v_cvt_pk_bf16_f32 v234, v236, v237
v_mfma_f32_16x16x32_bf16 a[60:63], a[188:191], a[100:103], 0
v_cvt_pk_bf16_f32 v235, v238, v239
v_mul_f32 v240, s91, v240
v_mfma_f32_16x16x32_bf16 a[60:63], a[184:187], a[96:99], a[60:63]
ds_read_b128 a[76:79], v4 offset:44032
v_mul_f32 v241, s91, v241
v_mfma_f32_16x16x32_bf16 v[236:239], a[112:115], a[96:99], 0
s_add_u32 m0, s73, 67584
s_add_u32 s64, s71, 18432
v_mul_f32 v242, s91, v242
v_mfma_f32_16x16x32_bf16 v[236:239], a[116:119], a[100:103], v[236:239]
ds_read_b128 a[92:95], v10 offset:2048
v_mul_f32 v243, s91, v243
v_mfma_f32_16x16x32_bf16 a[192:195], a[124:127], a[100:103], 0
buffer_load_dwordx4 v5, s[12:15], s64 offen lds
v_mfma_f32_16x16x32_bf16 a[192:195], a[120:123], a[96:99], a[192:195]
v_mul_f32 v244, s91, v244
v_mul_f32 v245, s91, v245
v_mfma_f32_16x16x32_bf16 a[196:199], a[120:123], a[104:107], 0
v_mul_f32 v246, s91, v246
v_mul_f32 v247, s91, v247
v_mfma_f32_16x16x32_bf16 a[196:199], a[124:127], a[108:111], a[196:199]
v_cvt_pk_bf16_f32 v240, v240, v241
v_cvt_pk_bf16_f32 v241, v242, v243
v_mfma_f32_16x16x32_bf16 a[200:203], a[116:119], a[108:111], 0
v_cvt_pk_bf16_f32 v242, v244, v245
v_cvt_pk_bf16_f32 v243, v246, v247
v_mfma_f32_16x16x32_bf16 a[200:203], a[112:115], a[104:107], a[200:203]
v_mul_f32 v248, s91, v248
v_mul_f32 v249, s91, v249
v_mfma_f32_16x16x32_bf16 v[244:247], a[184:187], a[104:107], 0
buffer_load_dwordx4 v6, s[12:15], s64 offen offset:1024 lds
v_mfma_f32_16x16x32_bf16 v[244:247], a[188:191], a[108:111], v[244:247]
v_mul_f32 v250, s91, v250
v_mul_f32 v251, s91, v251
v_mfma_f32_16x16x32_bf16 a[204:207], a[180:183], a[108:111], 0
v_mul_f32 v252, s91, v252
v_mul_f32 v253, s91, v253
v_mfma_f32_16x16x32_bf16 a[204:207], a[176:179], a[104:107], a[204:207]
s_add_u32 s53, s88, 262144
v_mul_f32 v254, s91, v254
v_mul_f32 v255, s91, v255
v_mfma_f32_16x16x32_bf16 a[208:211], a[168:171], a[104:107], 0
buffer_store_dwordx4 v[88:91], v4, s[24:27], s53 offen offset:3072 sc1
v_mfma_f32_16x16x32_bf16 a[208:211], a[172:175], a[108:111], a[208:211]
v_cvt_pk_bf16_f32 v248, v248, v249
v_cvt_pk_bf16_f32 v249, v250, v251
v_mfma_f32_16x16x32_bf16 v[88:91], a[164:167], a[108:111], 0
v_cvt_pk_bf16_f32 v250, v252, v253
v_cvt_pk_bf16_f32 v251, v254, v255
v_mfma_f32_16x16x32_bf16 v[88:91], a[160:163], a[104:107], v[88:91]
s_waitcnt lgkmcnt(0)
v_accvgpr_read_b32 v16, a0
v_accvgpr_read_b32 v17, a1
v_mfma_f32_16x16x32_bf16 v[36:39], a[128:131], a[80:83], v[36:39]
s_waitcnt vmcnt(24)
v_accvgpr_read_b32 v18, a2
v_accvgpr_read_b32 v19, a3
v_mfma_f32_16x16x32_bf16 v[36:39], a[132:135], a[84:87], v[36:39]
s_barrier
v_mfma_f32_16x16x32_bf16 v[44:47], a[140:143], a[84:87], v[44:47]
ds_read_b128 a[96:99], v9 offset:4096
v_accvgpr_read_b32 v20, a4
v_mfma_f32_16x16x32_bf16 v[44:47], a[136:139], a[80:83], v[44:47]
s_xor_b32 s75, s93, 2
s_lshl_b32 s76, s75, 19
s_add_u32 s76, s76, s74
v_mfma_f32_16x16x32_bf16 v[32:35], a[144:147], a[80:83], v[32:35]
s_lshl_b32 s79, s75, 13
s_add_u32 s79, s79, s78
ds_read_b128 a[100:103], v10 offset:4096
v_mfma_f32_16x16x32_bf16 v[32:35], a[148:151], a[84:87], v[32:35]
s_add_u32 m0, s77, 32768
s_add_u32 s64, s76, 0
ds_read_b128 a[104:107], v9 offset:6144
v_mfma_f32_16x16x32_bf16 v[52:55], a[156:159], a[84:87], v[52:55]
buffer_load_dwordx4 v7, s[20:23], s64 offen lds
v_mfma_f32_16x16x32_bf16 v[52:55], a[152:155], a[80:83], v[52:55]
ds_read_b64_tr_b16 a[160:161], v11 offset:49152
ds_read_b64_tr_b16 a[162:163], v11 offset:49664
v_mfma_f32_16x16x32_bf16 v[60:63], a[64:67], a[80:83], v[60:63]
v_accvgpr_read_b32 v21, a5
v_accvgpr_read_b32 v22, a6
v_mfma_f32_16x16x32_bf16 v[60:63], a[68:71], a[84:87], v[60:63]
ds_read_b128 a[108:111], v10 offset:6144
v_accvgpr_read_b32 v23, a7
v_mfma_f32_16x16x32_bf16 v[68:71], a[76:79], a[84:87], v[68:71]
buffer_load_dwordx4 v8, s[20:23], s64 offen offset:1024 lds
v_mfma_f32_16x16x32_bf16 v[68:71], a[72:75], a[80:83], v[68:71]
ds_read_b64_tr_b16 a[164:165], v11 offset:53248
ds_read_b64_tr_b16 a[166:167], v11 offset:53760
v_mfma_f32_16x16x32_bf16 v[76:79], a[72:75], a[88:91], v[76:79]
v_add_u32 v9, 32768, v9
v_add_u32 v10, 32768, v10
v_mfma_f32_16x16x32_bf16 v[76:79], a[76:79], a[92:95], v[76:79]
ds_read_b64_tr_b16 a[168:169], v12 offset:49152
ds_read_b64_tr_b16 a[170:171], v12 offset:49664
v_mfma_f32_16x16x32_bf16 v[84:87], a[68:71], a[92:95], v[84:87]
s_add_u32 m0, s80, 32768
s_add_u32 s64, s79, 0
v_mul_f32 v16, s91, v16
v_mfma_f32_16x16x32_bf16 v[84:87], a[64:67], a[88:91], v[84:87]
ds_read_b64_tr_b16 a[172:173], v12 offset:53248
ds_read_b64_tr_b16 a[174:175], v12 offset:53760
v_mfma_f32_16x16x32_bf16 v[92:95], a[152:155], a[88:91], v[92:95]
buffer_load_dwordx4 v4, s[24:27], s64 offen sc1 lds
v_mfma_f32_16x16x32_bf16 v[92:95], a[156:159], a[92:95], v[92:95]
v_mul_f32 v17, s91, v17
v_mul_f32 v18, s91, v18
v_mfma_f32_16x16x32_bf16 v[40:43], a[148:151], a[92:95], v[40:43]
ds_read_b64_tr_b16 a[176:177], v13 offset:49152
ds_read_b64_tr_b16 a[178:179], v13 offset:49664
v_mfma_f32_16x16x32_bf16 v[40:43], a[144:147], a[88:91], v[40:43]
v_mul_f32 v19, s91, v19
v_mul_f32 v20, s91, v20
v_mfma_f32_16x16x32_bf16 v[100:103], a[136:139], a[88:91], v[100:103]
s_add_u32 m0, s73, 69632
s_add_u32 s64, s72, 0
v_mul_f32 v21, s91, v21
v_mfma_f32_16x16x32_bf16 v[100:103], a[140:143], a[92:95], v[100:103]
ds_read_b64_tr_b16 a[180:181], v13 offset:53248
ds_read_b64_tr_b16 a[182:183], v13 offset:53760
v_mfma_f32_16x16x32_bf16 v[108:111], a[132:135], a[92:95], v[108:111]
buffer_load_dwordx4 v5, s[12:15], s64 offen lds
v_mfma_f32_16x16x32_bf16 v[108:111], a[128:131], a[88:91], v[108:111]
s_waitcnt lgkmcnt(14)
ds_read_b64_tr_b16 a[184:185], v14 offset:49152
ds_read_b64_tr_b16 a[186:187], v14 offset:49664
v_mfma_f32_16x16x32_bf16 v[116:119], a[128:131], a[96:99], v[116:119]
s_add_u32 s53, s87, 0
ds_read_b64_tr_b16 a[188:189], v14 offset:53248
ds_read_b64_tr_b16 a[190:191], v14 offset:53760
v_mfma_f32_16x16x32_bf16 v[116:119], a[132:135], a[100:103], v[116:119]
buffer_store_dwordx4 v[160:163], v4, s[24:27], s53 offen offset:0 sc1
v_mfma_f32_16x16x32_bf16 v[124:127], a[140:143], a[100:103], v[124:127]
v_mul_f32 v22, s91, v22
v_mul_f32 v23, s91, v23
v_mfma_f32_16x16x32_bf16 v[124:127], a[136:139], a[96:99], v[124:127]
ds_read_b128 a[112:115], v4 offset:57344
v_cvt_pk_bf16_f32 v16, v16, v17
v_mfma_f32_16x16x32_bf16 v[132:135], a[144:147], a[96:99], v[132:135]
buffer_load_dwordx4 v6, s[12:15], s64 offen offset:1024 lds
v_mfma_f32_16x16x32_bf16 v[132:135], a[148:151], a[100:103], v[132:135]
ds_read_b128 a[116:119], v4 offset:59392
v_cvt_pk_bf16_f32 v17, v18, v19
v_mfma_f32_16x16x32_bf16 v[140:143], a[156:159], a[100:103], v[140:143]
v_cvt_pk_bf16_f32 v18, v20, v21
v_cvt_pk_bf16_f32 v19, v22, v23
v_mfma_f32_16x16x32_bf16 v[140:143], a[152:155], a[96:99], v[140:143]
ds_read_b128 a[120:123], v4 offset:58368
v_accvgpr_write_b32 a0, v16
v_mfma_f32_16x16x32_bf16 v[148:151], a[64:67], a[96:99], v[148:151]
s_add_u32 m0, s73, 71680
s_add_u32 s64, s72, 18432
v_accvgpr_write_b32 a1, v17
v_mfma_f32_16x16x32_bf16 v[148:151], a[68:71], a[100:103], v[148:151]
ds_read_b128 a[124:127], v4 offset:60416
v_accvgpr_write_b32 a2, v18
v_mfma_f32_16x16x32_bf16 v[48:51], a[76:79], a[100:103], v[48:51]
buffer_load_dwordx4 v5, s[12:15], s64 offen lds
v_mfma_f32_16x16x32_bf16 v[48:51], a[72:75], a[96:99], v[48:51]
s_waitcnt lgkmcnt(15)
v_accvgpr_write_b32 a3, v19
v_accvgpr_read_b32 v16, a8
v_mfma_f32_16x16x32_bf16 v[156:159], a[72:75], a[104:107], v[156:159]
v_accvgpr_read_b32 v17, a9
v_accvgpr_read_b32 v18, a10
v_mfma_f32_16x16x32_bf16 v[156:159], a[76:79], a[108:111], v[156:159]
v_accvgpr_read_b32 v19, a11
v_accvgpr_read_b32 v20, a12
v_mfma_f32_16x16x32_bf16 v[164:167], a[68:71], a[108:111], v[164:167]
v_accvgpr_read_b32 v21, a13
v_accvgpr_read_b32 v22, a14
v_mfma_f32_16x16x32_bf16 v[164:167], a[64:67], a[104:107], v[164:167]
v_accvgpr_read_b32 v23, a15
v_mul_f32 v16, s91, v16
v_mfma_f32_16x16x32_bf16 v[172:175], a[152:155], a[104:107], v[172:175]
buffer_load_dwordx4 v6, s[12:15], s64 offen offset:1024 lds
v_mfma_f32_16x16x32_bf16 v[172:175], a[156:159], a[108:111], v[172:175]
v_mul_f32 v17, s91, v17
v_mul_f32 v18, s91, v18
v_mfma_f32_16x16x32_bf16 v[56:59], a[148:151], a[108:111], v[56:59]
v_mul_f32 v19, s91, v19
v_mul_f32 v20, s91, v20
v_mfma_f32_16x16x32_bf16 v[56:59], a[144:147], a[104:107], v[56:59]
v_mul_f32 v21, s91, v21
v_mul_f32 v22, s91, v22
v_mfma_f32_16x16x32_bf16 v[180:183], a[136:139], a[104:107], v[180:183]
v_mul_f32 v23, s91, v23
v_cvt_pk_bf16_f32 v16, v16, v17
v_mfma_f32_16x16x32_bf16 v[180:183], a[140:143], a[108:111], v[180:183]
v_cvt_pk_bf16_f32 v17, v18, v19
v_cvt_pk_bf16_f32 v18, v20, v21
v_mfma_f32_16x16x32_bf16 v[188:191], a[132:135], a[108:111], v[188:191]
v_cvt_pk_bf16_f32 v19, v22, v23
v_accvgpr_write_b32 a8, v16
v_mfma_f32_16x16x32_bf16 v[188:191], a[128:131], a[104:107], v[188:191]
s_waitcnt lgkmcnt(0)
v_accvgpr_write_b32 a9, v17
v_accvgpr_write_b32 a10, v18
v_mfma_f32_16x16x32_bf16 v[196:199], a[160:163], a[80:83], v[196:199]
s_waitcnt vmcnt(17)
v_accvgpr_write_b32 a11, v19
v_accvgpr_read_b32 v16, a16
v_mfma_f32_16x16x32_bf16 v[196:199], a[164:167], a[84:87], v[196:199]
s_barrier
v_mfma_f32_16x16x32_bf16 v[64:67], a[172:175], a[84:87], v[64:67]
s_add_u32 s53, s87, 0
ds_read_b64_tr_b16 a[128:129], v11 offset:0
ds_read_b64_tr_b16 a[130:131], v11 offset:512
v_mfma_f32_16x16x32_bf16 v[64:67], a[168:171], a[80:83], v[64:67]
s_add_u32 m0, s77, 49152
s_add_u32 s64, s76, 128
v_accvgpr_read_b32 v17, a17
v_mfma_f32_16x16x32_bf16 v[204:207], a[176:179], a[80:83], v[204:207]
buffer_load_dwordx4 v7, s[20:23], s64 offen lds
v_mfma_f32_16x16x32_bf16 v[204:207], a[180:183], a[84:87], v[204:207]
ds_read_b64_tr_b16 a[132:133], v11 offset:4096
ds_read_b64_tr_b16 a[134:135], v11 offset:4608
v_mfma_f32_16x16x32_bf16 v[212:215], a[188:191], a[84:87], v[212:215]
ds_read_b64_tr_b16 a[136:137], v12 offset:0
ds_read_b64_tr_b16 a[138:139], v12 offset:512
v_mfma_f32_16x16x32_bf16 v[212:215], a[184:187], a[80:83], v[212:215]
ds_read_b64_tr_b16 a[140:141], v12 offset:4096
ds_read_b64_tr_b16 a[142:143], v12 offset:4608
v_mfma_f32_16x16x32_bf16 v[72:75], a[112:115], a[80:83], v[72:75]
buffer_store_dwordx4 v[168:171], v4, s[24:27], s53 offen offset:1024 sc1
v_mfma_f32_16x16x32_bf16 v[72:75], a[116:119], a[84:87], v[72:75]
ds_read_b64_tr_b16 a[144:145], v13 offset:0
ds_read_b64_tr_b16 a[146:147], v13 offset:512
v_mfma_f32_16x16x32_bf16 v[220:223], a[124:127], a[84:87], v[220:223]
buffer_load_dwordx4 v8, s[20:23], s64 offen offset:1024 lds
v_mfma_f32_16x16x32_bf16 v[220:223], a[120:123], a[80:83], v[220:223]
ds_read_b64_tr_b16 a[148:149], v13 offset:4096
ds_read_b64_tr_b16 a[150:151], v13 offset:4608
v_mfma_f32_16x16x32_bf16 a[32:35], a[120:123], a[88:91], a[32:35]
v_accvgpr_read_b32 v18, a18
v_accvgpr_read_b32 v19, a19
v_mfma_f32_16x16x32_bf16 a[32:35], a[124:127], a[92:95], a[32:35]
ds_read_b64_tr_b16 a[152:153], v14 offset:0
ds_read_b64_tr_b16 a[154:155], v14 offset:512
v_mfma_f32_16x16x32_bf16 a[36:39], a[116:119], a[92:95], a[36:39]
s_add_u32 m0, s80, 49152
s_add_u32 s64, s79, 2048
v_accvgpr_read_b32 v20, a20
v_mfma_f32_16x16x32_bf16 a[36:39], a[112:115], a[88:91], a[36:39]
ds_read_b64_tr_b16 a[156:157], v14 offset:4096
ds_read_b64_tr_b16 a[158:159], v14 offset:4608
v_mfma_f32_16x16x32_bf16 v[228:231], a[184:187], a[88:91], v[228:231]
buffer_load_dwordx4 v4, s[24:27], s64 offen sc1 lds
v_mfma_f32_16x16x32_bf16 v[228:231], a[188:191], a[92:95], v[228:231]
s_xor_b32 s65, s70, 384
s_add_u32 s71, s68, s65
s_add_u32 s72, s69, s65
v_mfma_f32_16x16x32_bf16 a[40:43], a[180:183], a[92:95], a[40:43]
ds_read_b128 a[64:67], v4 offset:8192
v_accvgpr_read_b32 v21, a21
v_mfma_f32_16x16x32_bf16 a[40:43], a[176:179], a[88:91], a[40:43]
v_accvgpr_read_b32 v22, a22
v_accvgpr_read_b32 v23, a23
v_mfma_f32_16x16x32_bf16 a[44:47], a[168:171], a[88:91], a[44:47]
s_add_u32 m0, s73, 0
s_add_u32 s64, s71, 0
ds_read_b128 a[80:83], v9 offset:0
v_mfma_f32_16x16x32_bf16 a[44:47], a[172:175], a[92:95], a[44:47]
v_mul_f32 v16, s91, v16
v_mul_f32 v17, s91, v17
v_mfma_f32_16x16x32_bf16 v[80:83], a[164:167], a[92:95], v[80:83]
buffer_load_dwordx4 v5, s[12:15], s64 offen lds
v_mfma_f32_16x16x32_bf16 v[80:83], a[160:163], a[88:91], v[80:83]
ds_read_b128 a[68:71], v4 offset:10240
v_mul_f32 v18, s91, v18
v_mfma_f32_16x16x32_bf16 a[48:51], a[160:163], a[96:99], a[48:51]
ds_read_b128 a[84:87], v10 offset:0
v_mul_f32 v19, s91, v19
v_mfma_f32_16x16x32_bf16 a[48:51], a[164:167], a[100:103], a[48:51]
v_mul_f32 v20, s91, v20
v_mul_f32 v21, s91, v21
v_mfma_f32_16x16x32_bf16 a[52:55], a[172:175], a[100:103], a[52:55]
v_mul_f32 v22, s91, v22
v_mul_f32 v23, s91, v23
v_mfma_f32_16x16x32_bf16 a[52:55], a[168:171], a[96:99], a[52:55]
ds_read_b128 a[72:75], v4 offset:9216
v_cvt_pk_bf16_f32 v16, v16, v17
v_mfma_f32_16x16x32_bf16 a[56:59], a[176:179], a[96:99], a[56:59]
buffer_load_dwordx4 v6, s[12:15], s64 offen offset:1024 lds
v_mfma_f32_16x16x32_bf16 a[56:59], a[180:183], a[100:103], a[56:59]
s_add_u32 s53, s87, 4096
ds_read_b128 a[88:91], v9 offset:2048
v_cvt_pk_bf16_f32 v17, v18, v19
v_mfma_f32_16x16x32_bf16 a[60:63], a[188:191], a[100:103], a[60:63]
buffer_store_dwordx4 v[176:179], v4, s[24:27], s53 offen offset:0 sc1
v_mfma_f32_16x16x32_bf16 a[60:63], a[184:187], a[96:99], a[60:63]
ds_read_b128 a[76:79], v4 offset:11264
v_cvt_pk_bf16_f32 v18, v20, v21
v_mfma_f32_16x16x32_bf16 v[236:239], a[112:115], a[96:99], v[236:239]
s_add_u32 m0, s73, 2048
s_add_u32 s64, s71, 18432
v_cvt_pk_bf16_f32 v19, v22, v23
v_mfma_f32_16x16x32_bf16 v[236:239], a[116:119], a[100:103], v[236:239]
ds_read_b128 a[92:95], v10 offset:2048
v_accvgpr_write_b32 a16, v16
v_mfma_f32_16x16x32_bf16 a[192:195], a[124:127], a[100:103], a[192:195]
buffer_load_dwordx4 v5, s[12:15], s64 offen lds
v_mfma_f32_16x16x32_bf16 a[192:195], a[120:123], a[96:99], a[192:195]
v_accvgpr_write_b32 a17, v17
v_accvgpr_write_b32 a18, v18
v_mfma_f32_16x16x32_bf16 a[196:199], a[120:123], a[104:107], a[196:199]
v_accvgpr_write_b32 a19, v19
v_accvgpr_read_b32 v16, a24
v_mfma_f32_16x16x32_bf16 a[196:199], a[124:127], a[108:111], a[196:199]
v_accvgpr_read_b32 v17, a25
v_accvgpr_read_b32 v18, a26
v_mfma_f32_16x16x32_bf16 a[200:203], a[116:119], a[108:111], a[200:203]
v_accvgpr_read_b32 v19, a27
v_accvgpr_read_b32 v20, a28
v_mfma_f32_16x16x32_bf16 a[200:203], a[112:115], a[104:107], a[200:203]
v_accvgpr_read_b32 v21, a29
v_accvgpr_read_b32 v22, a30
v_mfma_f32_16x16x32_bf16 v[244:247], a[184:187], a[104:107], v[244:247]
buffer_load_dwordx4 v6, s[12:15], s64 offen offset:1024 lds
v_mfma_f32_16x16x32_bf16 v[244:247], a[188:191], a[108:111], v[244:247]
v_accvgpr_read_b32 v23, a31
v_mul_f32 v16, s91, v16
v_mfma_f32_16x16x32_bf16 a[204:207], a[180:183], a[108:111], a[204:207]
v_mul_f32 v17, s91, v17
v_mul_f32 v18, s91, v18
v_mfma_f32_16x16x32_bf16 a[204:207], a[176:179], a[104:107], a[204:207]
v_mul_f32 v19, s91, v19
v_mul_f32 v20, s91, v20
v_mfma_f32_16x16x32_bf16 a[208:211], a[168:171], a[104:107], a[208:211]
v_mul_f32 v21, s91, v21
v_mul_f32 v22, s91, v22
v_mfma_f32_16x16x32_bf16 a[208:211], a[172:175], a[108:111], a[208:211]
v_mul_f32 v23, s91, v23
v_cvt_pk_bf16_f32 v16, v16, v17
v_mfma_f32_16x16x32_bf16 v[88:91], a[164:167], a[108:111], v[88:91]
v_cvt_pk_bf16_f32 v17, v18, v19
v_cvt_pk_bf16_f32 v18, v20, v21
v_mfma_f32_16x16x32_bf16 v[88:91], a[160:163], a[104:107], v[88:91]
s_waitcnt lgkmcnt(0)
v_cvt_pk_bf16_f32 v19, v22, v23
v_accvgpr_write_b32 a24, v16
v_mfma_f32_16x16x32_bf16 v[36:39], a[128:131], a[80:83], v[36:39]
s_waitcnt vmcnt(23)
v_accvgpr_write_b32 a25, v17
v_accvgpr_write_b32 a26, v18
v_mfma_f32_16x16x32_bf16 v[36:39], a[132:135], a[84:87], v[36:39]
s_barrier
v_mfma_f32_16x16x32_bf16 v[44:47], a[140:143], a[84:87], v[44:47]
ds_read_b128 a[96:99], v9 offset:4096
v_accvgpr_write_b32 a27, v19
v_mfma_f32_16x16x32_bf16 v[44:47], a[136:139], a[80:83], v[44:47]
s_xor_b32 s75, s93, 3
s_lshl_b32 s76, s75, 19
s_add_u32 s76, s76, s74
v_mfma_f32_16x16x32_bf16 v[32:35], a[144:147], a[80:83], v[32:35]
s_lshl_b32 s79, s75, 13
s_add_u32 s79, s79, s78
ds_read_b128 a[100:103], v10 offset:4096
v_mfma_f32_16x16x32_bf16 v[32:35], a[148:151], a[84:87], v[32:35]
s_add_u32 m0, s77, 0
s_add_u32 s64, s76, 0
ds_read_b128 a[104:107], v9 offset:6144
v_mfma_f32_16x16x32_bf16 v[52:55], a[156:159], a[84:87], v[52:55]
buffer_load_dwordx4 v7, s[20:23], s64 offen lds
v_mfma_f32_16x16x32_bf16 v[52:55], a[152:155], a[80:83], v[52:55]
s_add_u32 s53, s87, 4096
ds_read_b64_tr_b16 a[160:161], v11 offset:16384
ds_read_b64_tr_b16 a[162:163], v11 offset:16896
v_mfma_f32_16x16x32_bf16 v[60:63], a[64:67], a[80:83], v[60:63]
buffer_store_dwordx4 v[184:187], v4, s[24:27], s53 offen offset:1024 sc1
v_mfma_f32_16x16x32_bf16 v[60:63], a[68:71], a[84:87], v[60:63]
ds_read_b128 a[108:111], v10 offset:6144
v_accvgpr_write_b32 a4, v248
v_mfma_f32_16x16x32_bf16 v[68:71], a[76:79], a[84:87], v[68:71]
buffer_load_dwordx4 v8, s[20:23], s64 offen offset:1024 lds
v_mfma_f32_16x16x32_bf16 v[68:71], a[72:75], a[80:83], v[68:71]
ds_read_b64_tr_b16 a[164:165], v11 offset:20480
ds_read_b64_tr_b16 a[166:167], v11 offset:20992
v_mfma_f32_16x16x32_bf16 v[76:79], a[72:75], a[88:91], v[76:79]
v_add_u32 v9, 32768, v9
v_add_u32 v10, 32768, v10
v_mfma_f32_16x16x32_bf16 v[76:79], a[76:79], a[92:95], v[76:79]
ds_read_b64_tr_b16 a[168:169], v12 offset:16384
ds_read_b64_tr_b16 a[170:171], v12 offset:16896
v_mfma_f32_16x16x32_bf16 v[84:87], a[68:71], a[92:95], v[84:87]
s_add_u32 m0, s80, 0
s_add_u32 s64, s79, 0
v_accvgpr_write_b32 a5, v249
v_mfma_f32_16x16x32_bf16 v[84:87], a[64:67], a[88:91], v[84:87]
ds_read_b64_tr_b16 a[172:173], v12 offset:20480
ds_read_b64_tr_b16 a[174:175], v12 offset:20992
v_mfma_f32_16x16x32_bf16 v[92:95], a[152:155], a[88:91], v[92:95]
buffer_load_dwordx4 v4, s[24:27], s64 offen sc1 lds
v_mfma_f32_16x16x32_bf16 v[92:95], a[156:159], a[92:95], v[92:95]
v_accvgpr_write_b32 a6, v250
v_accvgpr_write_b32 a7, v251
v_mfma_f32_16x16x32_bf16 v[40:43], a[148:151], a[92:95], v[40:43]
ds_read_b64_tr_b16 a[176:177], v13 offset:16384
ds_read_b64_tr_b16 a[178:179], v13 offset:16896
v_mfma_f32_16x16x32_bf16 v[40:43], a[144:147], a[88:91], v[40:43]
v_accvgpr_write_b32 a12, v240
v_accvgpr_write_b32 a13, v241
v_mfma_f32_16x16x32_bf16 v[100:103], a[136:139], a[88:91], v[100:103]
s_add_u32 m0, s73, 4096
s_add_u32 s64, s72, 0
v_accvgpr_write_b32 a14, v242
v_mfma_f32_16x16x32_bf16 v[100:103], a[140:143], a[92:95], v[100:103]
ds_read_b64_tr_b16 a[180:181], v13 offset:20480
ds_read_b64_tr_b16 a[182:183], v13 offset:20992
v_mfma_f32_16x16x32_bf16 v[108:111], a[132:135], a[92:95], v[108:111]
buffer_load_dwordx4 v5, s[12:15], s64 offen lds
v_mfma_f32_16x16x32_bf16 v[108:111], a[128:131], a[88:91], v[108:111]
s_waitcnt lgkmcnt(14)
ds_read_b64_tr_b16 a[184:185], v14 offset:16384
ds_read_b64_tr_b16 a[186:187], v14 offset:16896
v_mfma_f32_16x16x32_bf16 v[116:119], a[128:131], a[96:99], v[116:119]
ds_read_b64_tr_b16 a[188:189], v14 offset:20480
ds_read_b64_tr_b16 a[190:191], v14 offset:20992
v_mfma_f32_16x16x32_bf16 v[116:119], a[132:135], a[100:103], v[116:119]
v_accvgpr_write_b32 a15, v243
v_accvgpr_write_b32 a20, v232
v_mfma_f32_16x16x32_bf16 v[124:127], a[140:143], a[100:103], v[124:127]
v_accvgpr_write_b32 a21, v233
v_accvgpr_write_b32 a22, v234
v_mfma_f32_16x16x32_bf16 v[124:127], a[136:139], a[96:99], v[124:127]
ds_read_b128 a[112:115], v4 offset:24576
v_accvgpr_write_b32 a23, v235
v_mfma_f32_16x16x32_bf16 v[132:135], a[144:147], a[96:99], v[132:135]
buffer_load_dwordx4 v6, s[12:15], s64 offen offset:1024 lds
v_mfma_f32_16x16x32_bf16 v[132:135], a[148:151], a[100:103], v[132:135]
ds_read_b128 a[116:119], v4 offset:26624
v_accvgpr_write_b32 a28, v224
v_mfma_f32_16x16x32_bf16 v[140:143], a[156:159], a[100:103], v[140:143]
v_accvgpr_write_b32 a29, v225
v_accvgpr_write_b32 a30, v226
v_mfma_f32_16x16x32_bf16 v[140:143], a[152:155], a[96:99], v[140:143]
ds_read_b128 a[120:123], v4 offset:25600
v_accvgpr_write_b32 a31, v227
v_mfma_f32_16x16x32_bf16 v[148:151], a[64:67], a[96:99], v[148:151]
s_add_u32 m0, s73, 6144
s_add_u32 s64, s72, 18432
v_accvgpr_read_b32 v252, a32
v_mfma_f32_16x16x32_bf16 v[148:151], a[68:71], a[100:103], v[148:151]
ds_read_b128 a[124:127], v4 offset:27648
v_accvgpr_read_b32 v253, a33
v_mfma_f32_16x16x32_bf16 v[48:51], a[76:79], a[100:103], v[48:51]
buffer_load_dwordx4 v5, s[12:15], s64 offen lds
v_mfma_f32_16x16x32_bf16 v[48:51], a[72:75], a[96:99], v[48:51]
s_waitcnt lgkmcnt(15)
s_add_u32 s53, s87, 262144
v_accvgpr_read_b32 v254, a34
v_mfma_f32_16x16x32_bf16 v[156:159], a[72:75], a[104:107], v[156:159]
buffer_store_dwordx4 v[192:195], v4, s[24:27], s53 offen offset:0 sc1
v_mfma_f32_16x16x32_bf16 v[156:159], a[76:79], a[108:111], v[156:159]
v_accvgpr_read_b32 v255, a35
v_accvgpr_read_b32 v160, a36
v_mfma_f32_16x16x32_bf16 v[164:167], a[68:71], a[108:111], v[164:167]
v_accvgpr_read_b32 v161, a37
v_accvgpr_read_b32 v162, a38
v_mfma_f32_16x16x32_bf16 v[164:167], a[64:67], a[104:107], v[164:167]
v_accvgpr_read_b32 v163, a39
v_accvgpr_read_b32 v168, a40
v_mfma_f32_16x16x32_bf16 v[172:175], a[152:155], a[104:107], v[172:175]
buffer_load_dwordx4 v6, s[12:15], s64 offen offset:1024 lds
v_mfma_f32_16x16x32_bf16 v[172:175], a[156:159], a[108:111], v[172:175]
v_accvgpr_read_b32 v169, a41
v_accvgpr_read_b32 v170, a42
v_mfma_f32_16x16x32_bf16 v[56:59], a[148:151], a[108:111], v[56:59]
v_accvgpr_read_b32 v171, a43
v_accvgpr_read_b32 v176, a44
v_mfma_f32_16x16x32_bf16 v[56:59], a[144:147], a[104:107], v[56:59]
v_accvgpr_read_b32 v177, a45
v_accvgpr_read_b32 v178, a46
v_mfma_f32_16x16x32_bf16 v[180:183], a[136:139], a[104:107], v[180:183]
v_accvgpr_read_b32 v179, a47
v_accvgpr_read_b32 v184, a48
v_mfma_f32_16x16x32_bf16 v[180:183], a[140:143], a[108:111], v[180:183]
v_accvgpr_read_b32 v185, a49
v_accvgpr_read_b32 v186, a50
v_mfma_f32_16x16x32_bf16 v[188:191], a[132:135], a[108:111], v[188:191]
v_accvgpr_read_b32 v187, a51
v_accvgpr_read_b32 v248, a52
v_mfma_f32_16x16x32_bf16 v[188:191], a[128:131], a[104:107], v[188:191]
s_waitcnt lgkmcnt(0)
v_accvgpr_read_b32 v249, a53
v_accvgpr_read_b32 v250, a54
v_mfma_f32_16x16x32_bf16 v[196:199], a[160:163], a[80:83], v[196:199]
s_waitcnt vmcnt(18)
v_accvgpr_read_b32 v251, a55
v_accvgpr_read_b32 v240, a56
v_mfma_f32_16x16x32_bf16 v[196:199], a[164:167], a[84:87], v[196:199]
s_barrier
v_mfma_f32_16x16x32_bf16 v[64:67], a[172:175], a[84:87], v[64:67]
ds_read_b64_tr_b16 a[128:129], v11 offset:32768
ds_read_b64_tr_b16 a[130:131], v11 offset:33280
v_mfma_f32_16x16x32_bf16 v[64:67], a[168:171], a[80:83], v[64:67]
s_add_u32 m0, s77, 16384
s_add_u32 s64, s76, 128
v_accvgpr_read_b32 v241, a57
v_mfma_f32_16x16x32_bf16 v[204:207], a[176:179], a[80:83], v[204:207]
buffer_load_dwordx4 v7, s[20:23], s64 offen lds
v_mfma_f32_16x16x32_bf16 v[204:207], a[180:183], a[84:87], v[204:207]
ds_read_b64_tr_b16 a[132:133], v11 offset:36864
ds_read_b64_tr_b16 a[134:135], v11 offset:37376
v_mfma_f32_16x16x32_bf16 v[212:215], a[188:191], a[84:87], v[212:215]
ds_read_b64_tr_b16 a[136:137], v12 offset:32768
ds_read_b64_tr_b16 a[138:139], v12 offset:33280
v_mfma_f32_16x16x32_bf16 v[212:215], a[184:187], a[80:83], v[212:215]
ds_read_b64_tr_b16 a[140:141], v12 offset:36864
ds_read_b64_tr_b16 a[142:143], v12 offset:37376
v_mfma_f32_16x16x32_bf16 v[72:75], a[112:115], a[80:83], v[72:75]
v_accvgpr_read_b32 v242, a58
v_accvgpr_read_b32 v243, a59
v_mfma_f32_16x16x32_bf16 v[72:75], a[116:119], a[84:87], v[72:75]
ds_read_b64_tr_b16 a[144:145], v13 offset:32768
ds_read_b64_tr_b16 a[146:147], v13 offset:33280
v_mfma_f32_16x16x32_bf16 v[220:223], a[124:127], a[84:87], v[220:223]
buffer_load_dwordx4 v8, s[20:23], s64 offen offset:1024 lds
v_mfma_f32_16x16x32_bf16 v[220:223], a[120:123], a[80:83], v[220:223]
ds_read_b64_tr_b16 a[148:149], v13 offset:36864
ds_read_b64_tr_b16 a[150:151], v13 offset:37376
v_mfma_f32_16x16x32_bf16 v[252:255], a[120:123], a[88:91], v[252:255]
v_accvgpr_read_b32 v232, a60
v_accvgpr_read_b32 v233, a61
v_mfma_f32_16x16x32_bf16 v[252:255], a[124:127], a[92:95], v[252:255]
s_add_u32 s53, s87, 262144
ds_read_b64_tr_b16 a[152:153], v14 offset:32768
ds_read_b64_tr_b16 a[154:155], v14 offset:33280
v_mfma_f32_16x16x32_bf16 v[160:163], a[116:119], a[92:95], v[160:163]
s_add_u32 m0, s80, 16384
s_add_u32 s64, s79, 2048
v_accvgpr_read_b32 v234, a62
v_mfma_f32_16x16x32_bf16 v[160:163], a[112:115], a[88:91], v[160:163]
L_PAD5:
s_cbranch_execz L_PAD9
ds_read_b64_tr_b16 a[156:157], v14 offset:36864
ds_read_b64_tr_b16 a[158:159], v14 offset:37376
v_mfma_f32_16x16x32_bf16 v[228:231], a[184:187], a[88:91], v[228:231]
buffer_load_dwordx4 v4, s[24:27], s64 offen sc1 lds
v_mfma_f32_16x16x32_bf16 v[228:231], a[188:191], a[92:95], v[228:231]
s_xor_b32 s65, s70, 512
s_add_u32 s71, s68, s65
s_add_u32 s72, s69, s65
v_mfma_f32_16x16x32_bf16 v[168:171], a[180:183], a[92:95], v[168:171]
ds_read_b128 a[64:67], v4 offset:40960
v_accvgpr_read_b32 v235, a63
v_mfma_f32_16x16x32_bf16 v[168:171], a[176:179], a[88:91], v[168:171]
buffer_store_dwordx4 v[200:203], v4, s[24:27], s53 offen offset:1024 sc1
v_mfma_f32_16x16x32_bf16 v[176:179], a[168:171], a[88:91], v[176:179]
s_add_u32 m0, s73, 32768
s_add_u32 s64, s71, 0
ds_read_b128 a[80:83], v9 offset:0
v_mfma_f32_16x16x32_bf16 v[176:179], a[172:175], a[92:95], v[176:179]
v_accvgpr_read_b32 v224, a192
v_accvgpr_read_b32 v225, a193
v_mfma_f32_16x16x32_bf16 v[80:83], a[164:167], a[92:95], v[80:83]
buffer_load_dwordx4 v5, s[12:15], s64 offen lds
v_mfma_f32_16x16x32_bf16 v[80:83], a[160:163], a[88:91], v[80:83]
ds_read_b128 a[68:71], v4 offset:43008
v_accvgpr_read_b32 v226, a194
v_mfma_f32_16x16x32_bf16 v[184:187], a[160:163], a[96:99], v[184:187]
ds_read_b128 a[84:87], v10 offset:0
v_accvgpr_read_b32 v227, a195
v_mfma_f32_16x16x32_bf16 v[184:187], a[164:167], a[100:103], v[184:187]
v_accvgpr_read_b32 v192, a204
v_accvgpr_read_b32 v193, a205
v_mfma_f32_16x16x32_bf16 v[248:251], a[172:175], a[100:103], v[248:251]
v_accvgpr_read_b32 v194, a206
v_accvgpr_read_b32 v195, a207
v_mfma_f32_16x16x32_bf16 v[248:251], a[168:171], a[96:99], v[248:251]
ds_read_b128 a[72:75], v4 offset:41984
v_accvgpr_read_b32 v200, a208
v_mfma_f32_16x16x32_bf16 v[240:243], a[176:179], a[96:99], v[240:243]
buffer_load_dwordx4 v6, s[12:15], s64 offen offset:1024 lds
v_mfma_f32_16x16x32_bf16 v[240:243], a[180:183], a[100:103], v[240:243]
ds_read_b128 a[88:91], v9 offset:2048
v_accvgpr_read_b32 v201, a209
v_mfma_f32_16x16x32_bf16 v[232:235], a[188:191], a[100:103], v[232:235]
v_accvgpr_read_b32 v202, a210
v_accvgpr_read_b32 v203, a211
v_mfma_f32_16x16x32_bf16 v[232:235], a[184:187], a[96:99], v[232:235]
ds_read_b128 a[76:79], v4 offset:44032
v_and_b32 v28, 31, v1
v_mfma_f32_16x16x32_bf16 v[236:239], a[112:115], a[96:99], v[236:239]
s_add_u32 m0, s73, 34816
s_add_u32 s64, s71, 18432
v_lshlrev_b32 v28, 2, v28
v_mfma_f32_16x16x32_bf16 v[236:239], a[116:119], a[100:103], v[236:239]
ds_read_b128 a[92:95], v10 offset:2048
v_mfma_f32_16x16x32_bf16 v[224:227], a[124:127], a[100:103], v[224:227]
buffer_load_dwordx4 v5, s[12:15], s64 offen lds
v_mfma_f32_16x16x32_bf16 v[224:227], a[120:123], a[96:99], v[224:227]
buffer_load_dword v30, v28, s[40:43], 0 offen sc1
v_mfma_f32_16x16x32_bf16 a[196:199], a[120:123], a[104:107], a[196:199]
v_mfma_f32_16x16x32_bf16 a[196:199], a[124:127], a[108:111], a[196:199]
v_mfma_f32_16x16x32_bf16 a[200:203], a[116:119], a[108:111], a[200:203]
v_mfma_f32_16x16x32_bf16 a[200:203], a[112:115], a[104:107], a[200:203]
v_mfma_f32_16x16x32_bf16 v[244:247], a[184:187], a[104:107], v[244:247]
buffer_load_dwordx4 v6, s[12:15], s64 offen offset:1024 lds
v_mfma_f32_16x16x32_bf16 v[244:247], a[188:191], a[108:111], v[244:247]
s_add_u32 s53, s87, 266240
v_mfma_f32_16x16x32_bf16 v[192:195], a[180:183], a[108:111], v[192:195]
buffer_store_dwordx4 v[208:211], v4, s[24:27], s53 offen offset:0 sc1
v_mfma_f32_16x16x32_bf16 v[192:195], a[176:179], a[104:107], v[192:195]
v_mfma_f32_16x16x32_bf16 v[200:203], a[168:171], a[104:107], v[200:203]
v_mfma_f32_16x16x32_bf16 v[200:203], a[172:175], a[108:111], v[200:203]
v_accvgpr_read_b32 v208, a196
v_accvgpr_read_b32 v209, a197
v_mfma_f32_16x16x32_bf16 v[88:91], a[164:167], a[108:111], v[88:91]
v_accvgpr_read_b32 v210, a198
v_accvgpr_read_b32 v211, a199
v_mfma_f32_16x16x32_bf16 v[88:91], a[160:163], a[104:107], v[88:91]
s_waitcnt lgkmcnt(0)
v_mfma_f32_16x16x32_bf16 v[36:39], a[128:131], a[80:83], v[36:39]
s_waitcnt vmcnt(24)
v_mfma_f32_16x16x32_bf16 v[36:39], a[132:135], a[84:87], v[36:39]
s_barrier
v_mfma_f32_16x16x32_bf16 v[44:47], a[140:143], a[84:87], v[44:47]
ds_read_b128 a[96:99], v9 offset:4096
v_mfma_f32_16x16x32_bf16 v[44:47], a[136:139], a[80:83], v[44:47]
s_xor_b32 s75, s93, 4
s_lshl_b32 s76, s75, 19
s_add_u32 s76, s76, s74
v_mfma_f32_16x16x32_bf16 v[32:35], a[144:147], a[80:83], v[32:35]
s_lshl_b32 s79, s75, 13
s_add_u32 s79, s79, s78
ds_read_b128 a[100:103], v10 offset:4096
v_mfma_f32_16x16x32_bf16 v[32:35], a[148:151], a[84:87], v[32:35]
s_add_u32 m0, s77, 32768
s_add_u32 s64, s76, 0
ds_read_b128 a[104:107], v9 offset:6144
v_mfma_f32_16x16x32_bf16 v[52:55], a[156:159], a[84:87], v[52:55]
buffer_load_dwordx4 v7, s[20:23], s64 offen lds
v_mfma_f32_16x16x32_bf16 v[52:55], a[152:155], a[80:83], v[52:55]
ds_read_b64_tr_b16 a[160:161], v11 offset:49152
ds_read_b64_tr_b16 a[162:163], v11 offset:49664
v_mfma_f32_16x16x32_bf16 v[60:63], a[64:67], a[80:83], v[60:63]
v_mfma_f32_16x16x32_bf16 v[60:63], a[68:71], a[84:87], v[60:63]
ds_read_b128 a[108:111], v10 offset:6144
v_mfma_f32_16x16x32_bf16 v[68:71], a[76:79], a[84:87], v[68:71]
buffer_load_dwordx4 v8, s[20:23], s64 offen offset:1024 lds
v_mfma_f32_16x16x32_bf16 v[68:71], a[72:75], a[80:83], v[68:71]
ds_read_b64_tr_b16 a[164:165], v11 offset:53248
ds_read_b64_tr_b16 a[166:167], v11 offset:53760
v_mfma_f32_16x16x32_bf16 v[76:79], a[72:75], a[88:91], v[76:79]
v_add_u32 v9, -65536, v9
v_add_u32 v10, -65536, v10
v_mfma_f32_16x16x32_bf16 v[76:79], a[76:79], a[92:95], v[76:79]
ds_read_b64_tr_b16 a[168:169], v12 offset:49152
ds_read_b64_tr_b16 a[170:171], v12 offset:49664
v_mfma_f32_16x16x32_bf16 v[84:87], a[68:71], a[92:95], v[84:87]
s_add_u32 m0, s80, 32768
s_add_u32 s64, s79, 0
v_mfma_f32_16x16x32_bf16 v[84:87], a[64:67], a[88:91], v[84:87]
ds_read_b64_tr_b16 a[172:173], v12 offset:53248
ds_read_b64_tr_b16 a[174:175], v12 offset:53760
v_mfma_f32_16x16x32_bf16 v[92:95], a[152:155], a[88:91], v[92:95]
buffer_load_dwordx4 v4, s[24:27], s64 offen sc1 lds
v_mfma_f32_16x16x32_bf16 v[92:95], a[156:159], a[92:95], v[92:95]
v_mfma_f32_16x16x32_bf16 v[40:43], a[148:151], a[92:95], v[40:43]
ds_read_b64_tr_b16 a[176:177], v13 offset:49152
ds_read_b64_tr_b16 a[178:179], v13 offset:49664
v_mfma_f32_16x16x32_bf16 v[40:43], a[144:147], a[88:91], v[40:43]
s_add_u32 s53, s87, 266240
v_mfma_f32_16x16x32_bf16 v[100:103], a[136:139], a[88:91], v[100:103]
s_add_u32 m0, s73, 36864
s_add_u32 s64, s72, 0
v_mfma_f32_16x16x32_bf16 v[100:103], a[140:143], a[92:95], v[100:103]
ds_read_b64_tr_b16 a[180:181], v13 offset:53248
ds_read_b64_tr_b16 a[182:183], v13 offset:53760
v_mfma_f32_16x16x32_bf16 v[108:111], a[132:135], a[92:95], v[108:111]
buffer_load_dwordx4 v5, s[12:15], s64 offen lds
v_mfma_f32_16x16x32_bf16 v[108:111], a[128:131], a[88:91], v[108:111]
s_waitcnt lgkmcnt(14)
ds_read_b64_tr_b16 a[184:185], v14 offset:49152
ds_read_b64_tr_b16 a[186:187], v14 offset:49664
v_mfma_f32_16x16x32_bf16 v[116:119], a[128:131], a[96:99], v[116:119]
s_waitcnt vmcnt(6)
ds_read_b64_tr_b16 a[188:189], v14 offset:53248
ds_read_b64_tr_b16 a[190:191], v14 offset:53760
v_mfma_f32_16x16x32_bf16 v[116:119], a[132:135], a[100:103], v[116:119]
buffer_store_dwordx4 v[216:219], v4, s[24:27], s53 offen offset:1024 sc1
v_mfma_f32_16x16x32_bf16 v[124:127], a[140:143], a[100:103], v[124:127]
v_cmp_gt_u32 vcc, 1, v30
v_mfma_f32_16x16x32_bf16 v[124:127], a[136:139], a[96:99], v[124:127]
ds_read_b128 a[112:115], v4 offset:57344
v_accvgpr_read_b32 v216, a200
v_mfma_f32_16x16x32_bf16 v[132:135], a[144:147], a[96:99], v[132:135]
buffer_load_dwordx4 v6, s[12:15], s64 offen offset:1024 lds
v_mfma_f32_16x16x32_bf16 v[132:135], a[148:151], a[100:103], v[132:135]
ds_read_b128 a[116:119], v4 offset:59392
v_accvgpr_read_b32 v217, a201
v_mfma_f32_16x16x32_bf16 v[140:143], a[156:159], a[100:103], v[140:143]
v_accvgpr_read_b32 v218, a202
v_accvgpr_read_b32 v219, a203
v_mfma_f32_16x16x32_bf16 v[140:143], a[152:155], a[96:99], v[140:143]
s_lshr_b32 s84, s7, 1
s_and_b32 s85, s7, 1
ds_read_b128 a[120:123], v4 offset:58368
v_mfma_f32_16x16x32_bf16 v[148:151], a[64:67], a[96:99], v[148:151]
s_add_u32 m0, s73, 38912
s_add_u32 s64, s72, 18432
s_xor_b32 s52, s5, 0
v_mfma_f32_16x16x32_bf16 v[148:151], a[68:71], a[100:103], v[148:151]
s_lshl1_add_u32 s85, s52, s85
s_and_b32 s86, s6, 3
ds_read_b128 a[124:127], v4 offset:60416
v_mfma_f32_16x16x32_bf16 v[48:51], a[76:79], a[100:103], v[48:51]
buffer_load_dwordx4 v5, s[12:15], s64 offen lds
v_mfma_f32_16x16x32_bf16 v[48:51], a[72:75], a[96:99], v[48:51]
s_waitcnt lgkmcnt(15)
s_lshl_b32 s83, s3, 13
s_add_u32 s83, s83, 131072
v_mfma_f32_16x16x32_bf16 v[156:159], a[72:75], a[104:107], v[156:159]
s_cbranch_vccnz CK_ZA
CK_ZA_R:
v_mfma_f32_16x16x32_bf16 v[156:159], a[76:79], a[108:111], v[156:159]
s_mul_i32 s52, s2, 5462
s_lshr_b32 s52, s52, 16
s_mul_i32 s54, s52, 12
v_mfma_f32_16x16x32_bf16 v[164:167], a[68:71], a[108:111], v[164:167]
s_sub_u32 s54, s2, s54
s_mul_i32 s54, s54, 3
s_add_u32 s54, s54, s3
v_mfma_f32_16x16x32_bf16 v[164:167], a[64:67], a[104:107], v[164:167]
s_mul_i32 s55, s52, 13108
s_lshr_b32 s55, s55, 16
s_mul_i32 s82, s55, 5
v_mfma_f32_16x16x32_bf16 v[172:175], a[152:155], a[104:107], v[172:175]
buffer_load_dwordx4 v6, s[12:15], s64 offen offset:1024 lds
v_mfma_f32_16x16x32_bf16 v[172:175], a[156:159], a[108:111], v[172:175]
s_sub_u32 s52, s52, s82
v_mfma_f32_16x16x32_bf16 v[56:59], a[148:151], a[108:111], v[56:59]
v_lshrrev_b32 v16, 1, v1
v_and_b32 v17, 1, v1
v_mfma_f32_16x16x32_bf16 v[56:59], a[144:147], a[104:107], v[56:59]
v_mul_u32_u24 v18, 1152, v16
v_lshl_add_u32 v18, v17, 4, v18
v_mfma_f32_16x16x32_bf16 v[180:183], a[136:139], a[104:107], v[180:183]
v_mov_b32 v24, v18
v_lshrrev_b32 v18, 4, v16
v_mfma_f32_16x16x32_bf16 v[180:183], a[140:143], a[108:111], v[180:183]
v_bfe_u32 v19, v16, 2, 2
v_and_b32 v16, 3, v16
v_mfma_f32_16x16x32_bf16 v[188:191], a[132:135], a[108:111], v[188:191]
s_add_u32 s53, s88, 524288
v_lshrrev_b32 v20, 1, v19
v_mul_u32_u24 v20, 18, v20
v_mfma_f32_16x16x32_bf16 v[188:191], a[128:131], a[104:107], v[188:191]
s_waitcnt lgkmcnt(0)
v_and_b32 v21, 1, v19
v_lshl_add_u32 v20, v21, 1, v20
v_mfma_f32_16x16x32_bf16 v[196:199], a[160:163], a[80:83], v[196:199]
s_waitcnt vmcnt(18)
v_lshl_add_u32 v20, v16, 2, v20
v_add_u32 v20, v20, v18
v_mfma_f32_16x16x32_bf16 v[196:199], a[164:167], a[84:87], v[196:199]
s_barrier
v_mfma_f32_16x16x32_bf16 v[64:67], a[172:175], a[84:87], v[64:67]
ds_read_b64_tr_b16 a[128:129], v11 offset:0
ds_read_b64_tr_b16 a[130:131], v11 offset:512
v_mfma_f32_16x16x32_bf16 v[64:67], a[168:171], a[80:83], v[64:67]
s_add_u32 m0, s77, 49152
s_add_u32 s64, s76, 128
v_mad_u32_u24 v20, s52, 36, v20
v_mfma_f32_16x16x32_bf16 v[204:207], a[176:179], a[80:83], v[204:207]
buffer_load_dwordx4 v7, s[20:23], s64 offen lds
v_mfma_f32_16x16x32_bf16 v[204:207], a[180:183], a[84:87], v[204:207]
ds_read_b64_tr_b16 a[132:133], v11 offset:4096
ds_read_b64_tr_b16 a[134:135], v11 offset:4608
v_mfma_f32_16x16x32_bf16 v[212:215], a[188:191], a[84:87], v[212:215]
ds_read_b64_tr_b16 a[136:137], v12 offset:0
ds_read_b64_tr_b16 a[138:139], v12 offset:512
v_mfma_f32_16x16x32_bf16 v[212:215], a[184:187], a[80:83], v[212:215]
ds_read_b64_tr_b16 a[140:141], v12 offset:4096
ds_read_b64_tr_b16 a[142:143], v12 offset:4608
v_mfma_f32_16x16x32_bf16 v[72:75], a[112:115], a[80:83], v[72:75]
buffer_store_dwordx4 v[96:99], v4, s[24:27], s53 offen offset:0 sc1
v_mfma_f32_16x16x32_bf16 v[72:75], a[116:119], a[84:87], v[72:75]
ds_read_b64_tr_b16 a[144:145], v13 offset:0
ds_read_b64_tr_b16 a[146:147], v13 offset:512
v_mfma_f32_16x16x32_bf16 v[220:223], a[124:127], a[84:87], v[220:223]
buffer_load_dwordx4 v8, s[20:23], s64 offen offset:1024 lds
v_mfma_f32_16x16x32_bf16 v[220:223], a[120:123], a[80:83], v[220:223]
ds_read_b64_tr_b16 a[148:149], v13 offset:4096
ds_read_b64_tr_b16 a[150:151], v13 offset:4608
v_mfma_f32_16x16x32_bf16 v[252:255], a[120:123], a[88:91], v[252:255]
v_lshlrev_b32 v21, 1, v18
v_lshl_add_u32 v21, v19, 2, v21
v_mfma_f32_16x16x32_bf16 v[252:255], a[124:127], a[92:95], v[252:255]
ds_read_b64_tr_b16 a[152:153], v14 offset:0
ds_read_b64_tr_b16 a[154:155], v14 offset:512
v_mfma_f32_16x16x32_bf16 v[160:163], a[116:119], a[92:95], v[160:163]
s_add_u32 m0, s80, 49152
s_add_u32 s64, s79, 2048
v_lshrrev_b32 v22, 1, v16
v_mfma_f32_16x16x32_bf16 v[160:163], a[112:115], a[88:91], v[160:163]
ds_read_b64_tr_b16 a[156:157], v14 offset:4096
ds_read_b64_tr_b16 a[158:159], v14 offset:4608
v_mfma_f32_16x16x32_bf16 v[228:231], a[184:187], a[88:91], v[228:231]
buffer_load_dwordx4 v4, s[24:27], s64 offen sc1 lds
v_mfma_f32_16x16x32_bf16 v[228:231], a[188:191], a[92:95], v[228:231]
s_xor_b32 s65, s70, 640
s_add_u32 s71, s68, s65
s_add_u32 s72, s69, s65
v_mfma_f32_16x16x32_bf16 v[168:171], a[180:183], a[92:95], v[168:171]
ds_read_b128 a[64:67], v4 offset:8192
v_add_u32 v21, v21, v22
v_mfma_f32_16x16x32_bf16 v[168:171], a[176:179], a[88:91], v[168:171]
v_mul_u32_u24 v21, 18, v21
v_and_b32 v22, 1, v16
v_mfma_f32_16x16x32_bf16 v[176:179], a[168:171], a[88:91], v[176:179]
s_add_u32 m0, s73, 65536
s_add_u32 s64, s71, 0
ds_read_b128 a[80:83], v9 offset:0
v_mfma_f32_16x16x32_bf16 v[176:179], a[172:175], a[92:95], v[176:179]
v_add3_u32 v21, v21, v22, 16
v_cmp_lt_u32 s[96:97], 1, v19
v_mfma_f32_16x16x32_bf16 v[80:83], a[164:167], a[92:95], v[80:83]
buffer_load_dwordx4 v5, s[12:15], s64 offen lds
v_mfma_f32_16x16x32_bf16 v[80:83], a[160:163], a[88:91], v[80:83]
ds_read_b128 a[68:71], v4 offset:10240
v_mov_b32 v22, 0x100000
v_mfma_f32_16x16x32_bf16 v[184:187], a[160:163], a[96:99], v[184:187]
ds_read_b128 a[84:87], v10 offset:0
v_mul_u32_u24 v23, 1, v23
v_mfma_f32_16x16x32_bf16 v[184:187], a[164:167], a[100:103], v[184:187]
s_add_u32 s53, s88, 524288
v_cndmask_b32 v21, v21, v22, s[96:97]
v_mov_b32 v22, s52
v_mfma_f32_16x16x32_bf16 v[248:251], a[172:175], a[100:103], v[248:251]
buffer_store_dwordx4 v[104:107], v4, s[24:27], s53 offen offset:1024 sc1
v_mfma_f32_16x16x32_bf16 v[248:251], a[168:171], a[96:99], v[248:251]
ds_read_b128 a[72:75], v4 offset:9216
v_cmp_eq_u32 s[96:97], 4, v22
v_mfma_f32_16x16x32_bf16 v[240:243], a[176:179], a[96:99], v[240:243]
buffer_load_dwordx4 v6, s[12:15], s64 offen offset:1024 lds
v_mfma_f32_16x16x32_bf16 v[240:243], a[180:183], a[100:103], v[240:243]
ds_read_b128 a[88:91], v9 offset:2048
v_cndmask_b32 v20, v20, v21, s[96:97]
v_mfma_f32_16x16x32_bf16 v[232:235], a[188:191], a[100:103], v[232:235]
v_mul_u32_u24 v20, 1152, v20
v_lshl_add_u32 v20, v17, 4, v20
v_mfma_f32_16x16x32_bf16 v[232:235], a[184:187], a[96:99], v[232:235]
ds_read_b128 a[76:79], v4 offset:11264
v_mov_b32 v25, v20
v_mfma_f32_16x16x32_bf16 v[236:239], a[112:115], a[96:99], v[236:239]
s_add_u32 m0, s73, 67584
s_add_u32 s64, s71, 18432
v_mov_b32 v16, s54
v_mfma_f32_16x16x32_bf16 v[236:239], a[116:119], a[100:103], v[236:239]
ds_read_b128 a[92:95], v10 offset:2048
v_mov_b32 v17, s55
v_mfma_f32_16x16x32_bf16 v[224:227], a[124:127], a[100:103], v[224:227]
buffer_load_dwordx4 v5, s[12:15], s64 offen lds
v_mfma_f32_16x16x32_bf16 v[224:227], a[120:123], a[96:99], v[224:227]
v_add_u32 v18, 32, v22
v_mfma_f32_16x16x32_bf16 v[208:211], a[120:123], a[104:107], v[208:211]
s_mul_i32 s82, s55, 165888
s_lshl_b32 s54, s54, 5
s_add_u32 s82, s82, s54
v_mfma_f32_16x16x32_bf16 v[208:211], a[124:127], a[108:111], v[208:211]
s_and_b32 s52, s2, 1
s_lshr_b32 s54, s3, 1
s_lshl1_add_u32 s52, s52, s54
v_mfma_f32_16x16x32_bf16 v[216:219], a[116:119], a[108:111], v[216:219]
s_mul_i32 s52, s52, 9
s_and_b32 s54, s3, 1
s_mul_i32 s55, s54, 5
v_mfma_f32_16x16x32_bf16 v[216:219], a[112:115], a[104:107], v[216:219]
s_add_u32 s52, s52, s55
s_lshr_b32 s55, s2, 1
s_mul_i32 s81, s55, 1152
v_mfma_f32_16x16x32_bf16 v[244:247], a[184:187], a[104:107], v[244:247]
buffer_load_dwordx4 v6, s[12:15], s64 offen offset:1024 lds
v_mfma_f32_16x16x32_bf16 v[244:247], a[188:191], a[108:111], v[244:247]
s_add_u32 s81, s81, s52
s_lshl_b32 s81, s81, 5
v_mfma_f32_16x16x32_bf16 v[192:195], a[180:183], a[108:111], v[192:195]
v_cmp_gt_u32 s[96:97], 5, v1
v_add_u32 v19, s52, v1
v_mfma_f32_16x16x32_bf16 v[192:195], a[176:179], a[104:107], v[192:195]
v_lshrrev_b32 v20, 5, s55
v_and_b32 v21, 31, s55
v_mfma_f32_16x16x32_bf16 v[200:203], a[168:171], a[104:107], v[200:203]
v_cndmask_b32 v16, v16, v19, s[96:97]
v_cndmask_b32 v17, v17, v20, s[96:97]
v_mfma_f32_16x16x32_bf16 v[200:203], a[172:175], a[108:111], v[200:203]
v_cndmask_b32 v18, v18, v21, s[96:97]
v_mul_u32_u24 v19, 7282, v16
v_mfma_f32_16x16x32_bf16 v[88:91], a[164:167], a[108:111], v[88:91]
v_lshrrev_b32 v19, 16, v19
v_mul_u32_u24 v20, 9, v19
v_mfma_f32_16x16x32_bf16 v[88:91], a[160:163], a[104:107], v[88:91]
s_waitcnt lgkmcnt(0)
v_sub_u32 v16, v16, v20
v_and_b32 v20, 1, v19
v_mfma_f32_16x16x32_bf16 v[36:39], a[128:131], a[80:83], v[36:39]
s_waitcnt vmcnt(24)
v_lshlrev_b32 v20, 2, v20
v_cndmask_b32 v20, 0, v20, s[96:97]
v_mfma_f32_16x16x32_bf16 v[36:39], a[132:135], a[84:87], v[36:39]
s_barrier
v_mfma_f32_16x16x32_bf16 v[44:47], a[140:143], a[84:87], v[44:47]
ds_read_b128 a[96:99], v9 offset:4096
v_xor_b32 v18, v18, v20
v_mfma_f32_16x16x32_bf16 v[44:47], a[136:139], a[80:83], v[44:47]
s_xor_b32 s75, s93, 5
s_lshl_b32 s76, s75, 19
s_add_u32 s76, s76, s74
v_mfma_f32_16x16x32_bf16 v[32:35], a[144:147], a[80:83], v[32:35]
s_lshl_b32 s79, s75, 13
s_add_u32 s79, s79, s78
ds_read_b128 a[100:103], v10 offset:4096
v_mfma_f32_16x16x32_bf16 v[32:35], a[148:151], a[84:87], v[32:35]
s_add_u32 m0, s77, 0
s_add_u32 s64, s76, 0
ds_read_b128 a[104:107], v9 offset:6144
v_mfma_f32_16x16x32_bf16 v[52:55], a[156:159], a[84:87], v[52:55]
buffer_load_dwordx4 v7, s[20:23], s64 offen lds
v_mfma_f32_16x16x32_bf16 v[52:55], a[152:155], a[80:83], v[52:55]
s_add_u32 s53, s88, 524288
ds_read_b64_tr_b16 a[160:161], v11 offset:16384
ds_read_b64_tr_b16 a[162:163], v11 offset:16896
v_mfma_f32_16x16x32_bf16 v[60:63], a[64:67], a[80:83], v[60:63]
buffer_store_dwordx4 v[112:115], v4, s[24:27], s53 offen offset:2048 sc1
v_mfma_f32_16x16x32_bf16 v[60:63], a[68:71], a[84:87], v[60:63]
ds_read_b128 a[108:111], v10 offset:6144
v_lshl_add_u32 v19, v19, 2, v17
v_mfma_f32_16x16x32_bf16 v[68:71], a[76:79], a[84:87], v[68:71]
buffer_load_dwordx4 v8, s[20:23], s64 offen offset:1024 lds
v_mfma_f32_16x16x32_bf16 v[68:71], a[72:75], a[80:83], v[68:71]
ds_read_b64_tr_b16 a[164:165], v11 offset:20480
ds_read_b64_tr_b16 a[166:167], v11 offset:20992
v_mfma_f32_16x16x32_bf16 v[76:79], a[72:75], a[88:91], v[76:79]
v_add_u32 v9, 32768, v9
v_add_u32 v10, 32768, v10
v_mfma_f32_16x16x32_bf16 v[76:79], a[76:79], a[92:95], v[76:79]
ds_read_b64_tr_b16 a[168:169], v12 offset:16384
ds_read_b64_tr_b16 a[170:171], v12 offset:16896
v_mfma_f32_16x16x32_bf16 v[84:87], a[68:71], a[92:95], v[84:87]
s_add_u32 m0, s80, 0
s_add_u32 s64, s79, 0
v_mul_u32_u24 v19, 344064, v19
v_mfma_f32_16x16x32_bf16 v[84:87], a[64:67], a[88:91], v[84:87]
ds_read_b64_tr_b16 a[172:173], v12 offset:20480
ds_read_b64_tr_b16 a[174:175], v12 offset:20992
v_mfma_f32_16x16x32_bf16 v[92:95], a[152:155], a[88:91], v[92:95]
buffer_load_dwordx4 v4, s[24:27], s64 offen sc1 lds
v_mfma_f32_16x16x32_bf16 v[92:95], a[156:159], a[92:95], v[92:95]
v_lshrrev_b32 v20, 1, v16
v_sub_u32 v20, v20, v17
v_mfma_f32_16x16x32_bf16 v[40:43], a[148:151], a[92:95], v[40:43]
ds_read_b64_tr_b16 a[176:177], v13 offset:16384
ds_read_b64_tr_b16 a[178:179], v13 offset:16896
v_mfma_f32_16x16x32_bf16 v[40:43], a[144:147], a[88:91], v[40:43]
v_add_u32 v20, 3, v20
v_and_b32 v20, 3, v20
v_mfma_f32_16x16x32_bf16 v[100:103], a[136:139], a[88:91], v[100:103]
s_add_u32 m0, s73, 69632
s_add_u32 s64, s72, 0
v_cmp_eq_u32 s[96:97], 8, v16
v_mfma_f32_16x16x32_bf16 v[100:103], a[140:143], a[92:95], v[100:103]
ds_read_b64_tr_b16 a[180:181], v13 offset:20480
ds_read_b64_tr_b16 a[182:183], v13 offset:20992
v_mfma_f32_16x16x32_bf16 v[108:111], a[132:135], a[92:95], v[108:111]
buffer_load_dwordx4 v5, s[12:15], s64 offen lds
v_mfma_f32_16x16x32_bf16 v[108:111], a[128:131], a[88:91], v[108:111]
s_waitcnt lgkmcnt(14)
ds_read_b64_tr_b16 a[184:185], v14 offset:16384
ds_read_b64_tr_b16 a[186:187], v14 offset:16896
v_mfma_f32_16x16x32_bf16 v[116:119], a[128:131], a[96:99], v[116:119]
ds_read_b64_tr_b16 a[188:189], v14 offset:20480
ds_read_b64_tr_b16 a[190:191], v14 offset:20992
v_mfma_f32_16x16x32_bf16 v[116:119], a[132:135], a[100:103], v[116:119]
v_and_b32 v16, 1, v16
v_lshl_add_u32 v21, v20, 1, v16
v_mfma_f32_16x16x32_bf16 v[124:127], a[140:143], a[100:103], v[124:127]
v_and_b32 v22, 1, v18
v_lshl_add_u32 v19, v22, 10, v19
v_mfma_f32_16x16x32_bf16 v[124:127], a[136:139], a[96:99], v[124:127]
ds_read_b128 a[112:115], v4 offset:24576
v_and_b32 v18, -2, v18
v_mfma_f32_16x16x32_bf16 v[132:135], a[144:147], a[96:99], v[132:135]
buffer_load_dwordx4 v6, s[12:15], s64 offen offset:1024 lds
v_mfma_f32_16x16x32_bf16 v[132:135], a[148:151], a[100:103], v[132:135]
ds_read_b128 a[116:119], v4 offset:26624
v_add_u32 v21, 1, v21
v_mfma_f32_16x16x32_bf16 v[140:143], a[156:159], a[100:103], v[140:143]
v_cndmask_b32 v21, v21, 0, s[96:97]
v_cndmask_b32 v20, v20, 0, s[96:97]
v_mfma_f32_16x16x32_bf16 v[140:143], a[152:155], a[96:99], v[140:143]
s_add_u32 s53, s88, 524288
ds_read_b128 a[120:123], v4 offset:25600
v_sub_u32 v17, 37, v18
v_mfma_f32_16x16x32_bf16 v[148:151], a[64:67], a[96:99], v[148:151]
s_add_u32 m0, s73, 71680
s_add_u32 s64, s72, 18432
v_min_u32 v17, 2, v17
v_mfma_f32_16x16x32_bf16 v[148:151], a[68:71], a[100:103], v[148:151]
ds_read_b128 a[124:127], v4 offset:27648
v_mul_u32_u24 v21, v21, v17
v_mfma_f32_16x16x32_bf16 v[48:51], a[76:79], a[100:103], v[48:51]
buffer_load_dwordx4 v5, s[12:15], s64 offen lds
v_mfma_f32_16x16x32_bf16 v[48:51], a[72:75], a[96:99], v[48:51]
s_waitcnt lgkmcnt(15)
v_mul_u32_u24 v22, v16, v17
v_min_u32 v23, 8, v18
v_mfma_f32_16x16x32_bf16 v[156:159], a[72:75], a[104:107], v[156:159]
buffer_store_dwordx4 v[120:123], v4, s[24:27], s53 offen offset:3072 sc1
v_mfma_f32_16x16x32_bf16 v[156:159], a[76:79], a[108:111], v[156:159]
v_mad_u32_u24 v21, v18, 5, v21
v_lshl_add_u32 v21, v23, 1, v21
v_mfma_f32_16x16x32_bf16 v[164:167], a[68:71], a[108:111], v[164:167]
v_lshl_add_u32 v22, v18, 1, v22
v_mad_u32_u24 v22, v20, 37, v22
v_mfma_f32_16x16x32_bf16 v[164:167], a[64:67], a[104:107], v[164:167]
v_mad_u32_u24 v22, v20, 37, v22
v_lshl_add_u32 v20, v20, 6, v18
v_mfma_f32_16x16x32_bf16 v[172:175], a[152:155], a[104:107], v[172:175]
buffer_load_dwordx4 v6, s[12:15], s64 offen offset:1024 lds
v_mfma_f32_16x16x32_bf16 v[172:175], a[156:159], a[108:111], v[172:175]
v_mov_b32 v23, 136
v_cmp_gt_u32 s[96:97], v23, v20
v_mfma_f32_16x16x32_bf16 v[56:59], a[148:151], a[108:111], v[56:59]
v_add_u32 v22, 37, v22
v_add_u32 v19, 38797312, v19
v_mfma_f32_16x16x32_bf16 v[56:59], a[144:147], a[104:107], v[56:59]
v_cndmask_b32 v21, v22, v21, s[96:97]
v_lshl_add_u32 v19, v21, 10, v19
v_mfma_f32_16x16x32_bf16 v[180:183], a[136:139], a[104:107], v[180:183]
s_cmp_eq_u32 s54, 1
s_cselect_b32 s96, 16, 0
v_mfma_f32_16x16x32_bf16 v[180:183], a[140:143], a[108:111], v[180:183]
s_cmp_eq_u32 s3, 3
s_cselect_b32 s52, 32, 0
s_or_b32 s96, s96, s52
v_mfma_f32_16x16x32_bf16 v[188:191], a[132:135], a[108:111], v[188:191]
s_cmp_ge_u32 s2, 240
s_cselect_b32 s52, 32, 0
s_or_b32 s96, s96, s52
v_mfma_f32_16x16x32_bf16 v[188:191], a[128:131], a[104:107], v[188:191]
s_waitcnt lgkmcnt(0)
s_mov_b32 s97, 0
v_mfma_f32_16x16x32_bf16 v[196:199], a[160:163], a[80:83], v[196:199]
s_waitcnt vmcnt(18)
v_mov_b32 v20, 2147418112
v_cndmask_b32 v26, v19, v20, s[96:97]
v_mfma_f32_16x16x32_bf16 v[196:199], a[164:167], a[84:87], v[196:199]
s_barrier
v_mfma_f32_16x16x32_bf16 v[64:67], a[172:175], a[84:87], v[64:67]
ds_read_b64_tr_b16 a[128:129], v11 offset:32768
ds_read_b64_tr_b16 a[130:131], v11 offset:33280
v_mfma_f32_16x16x32_bf16 v[64:67], a[168:171], a[80:83], v[64:67]
s_add_u32 m0, s77, 16384
s_add_u32 s64, s76, 128
v_lshlrev_b32 v27, 3, v1
v_mfma_f32_16x16x32_bf16 v[204:207], a[176:179], a[80:83], v[204:207]
buffer_load_dwordx4 v7, s[20:23], s64 offen lds
v_mfma_f32_16x16x32_bf16 v[204:207], a[180:183], a[84:87], v[204:207]
ds_read_b64_tr_b16 a[132:133], v11 offset:36864
ds_read_b64_tr_b16 a[134:135], v11 offset:37376
v_mfma_f32_16x16x32_bf16 v[212:215], a[188:191], a[84:87], v[212:215]
ds_read_b64_tr_b16 a[136:137], v12 offset:32768
ds_read_b64_tr_b16 a[138:139], v12 offset:33280
v_mfma_f32_16x16x32_bf16 v[212:215], a[184:187], a[80:83], v[212:215]
ds_read_b64_tr_b16 a[140:141], v12 offset:36864
ds_read_b64_tr_b16 a[142:143], v12 offset:37376
v_mfma_f32_16x16x32_bf16 v[72:75], a[112:115], a[80:83], v[72:75]
buffer_atomic_add v1, v0, s[24:27], s90 offen offset:4 sc1
v_mfma_f32_16x16x32_bf16 v[72:75], a[116:119], a[84:87], v[72:75]
ds_read_b64_tr_b16 a[144:145], v13 offset:32768
ds_read_b64_tr_b16 a[146:147], v13 offset:33280
v_mfma_f32_16x16x32_bf16 v[220:223], a[124:127], a[84:87], v[220:223]
buffer_load_dwordx4 v8, s[20:23], s64 offen offset:1024 lds
v_mfma_f32_16x16x32_bf16 v[220:223], a[120:123], a[80:83], v[220:223]
s_add_u32 s53, s88, 786432
ds_read_b64_tr_b16 a[148:149], v13 offset:36864
ds_read_b64_tr_b16 a[150:151], v13 offset:37376
v_mfma_f32_16x16x32_bf16 v[252:255], a[120:123], a[88:91], v[252:255]
buffer_store_dwordx4 v[128:131], v4, s[24:27], s53 offen offset:0 sc1
v_mfma_f32_16x16x32_bf16 v[252:255], a[124:127], a[92:95], v[252:255]
ds_read_b64_tr_b16 a[152:153], v14 offset:32768
ds_read_b64_tr_b16 a[154:155], v14 offset:33280
v_mfma_f32_16x16x32_bf16 v[160:163], a[116:119], a[92:95], v[160:163]
s_add_u32 m0, s80, 16384
s_add_u32 s64, s79, 2048
v_add_u32 v27, s83, v27
v_mfma_f32_16x16x32_bf16 v[160:163], a[112:115], a[88:91], v[160:163]
ds_read_b64_tr_b16 a[156:157], v14 offset:36864
ds_read_b64_tr_b16 a[158:159], v14 offset:37376
v_mfma_f32_16x16x32_bf16 v[228:231], a[184:187], a[88:91], v[228:231]
buffer_load_dwordx4 v4, s[24:27], s64 offen sc1 lds
v_mfma_f32_16x16x32_bf16 v[228:231], a[188:191], a[92:95], v[228:231]
s_xor_b32 s65, s70, 768
s_add_u32 s71, s68, s65
s_add_u32 s72, s69, s65
v_mfma_f32_16x16x32_bf16 v[168:171], a[180:183], a[92:95], v[168:171]
ds_read_b128 a[64:67], v4 offset:40960
v_lshrrev_b32 v22, 3, v1
v_mfma_f32_16x16x32_bf16 v[168:171], a[176:179], a[88:91], v[168:171]
v_mul_u32_u24 v22, 1152, v22
v_and_b32 v23, 7, v1
v_mfma_f32_16x16x32_bf16 v[176:179], a[168:171], a[88:91], v[176:179]
s_add_u32 m0, s73, 0
s_add_u32 s64, s71, 0
ds_read_b128 a[80:83], v9 offset:0
v_mfma_f32_16x16x32_bf16 v[176:179], a[172:175], a[92:95], v[176:179]
v_lshl_add_u32 v22, v23, 4, v22
v_lshrrev_b32 v23, 2, v1
v_mfma_f32_16x16x32_bf16 v[80:83], a[164:167], a[92:95], v[80:83]
buffer_load_dwordx4 v5, s[12:15], s64 offen lds
v_mfma_f32_16x16x32_bf16 v[80:83], a[160:163], a[88:91], v[80:83]
L_PAD6:
s_cbranch_execz L_PAD10
ds_read_b128 a[68:71], v4 offset:43008
v_mul_u32_u24 v23, 96, v23
v_mfma_f32_16x16x32_bf16 v[184:187], a[160:163], a[96:99], v[184:187]
ds_read_b128 a[84:87], v10 offset:0
v_add_u32 v23, v23, v27
v_mfma_f32_16x16x32_bf16 v[184:187], a[164:167], a[100:103], v[184:187]
v_and_b32 v16, 3, v1
v_cmp_eq_u32 s[96:97], 0, v16
v_mfma_f32_16x16x32_bf16 v[248:251], a[172:175], a[100:103], v[248:251]
v_mov_b32 v16, 0x3f803f80
v_mfma_f32_16x16x32_bf16 v[248:251], a[168:171], a[96:99], v[248:251]
ds_read_b128 a[72:75], v4 offset:41984
v_cndmask_b32 v16, 0, v16, s[96:97]
v_mfma_f32_16x16x32_bf16 v[240:243], a[176:179], a[96:99], v[240:243]
buffer_load_dwordx4 v6, s[12:15], s64 offen offset:1024 lds
v_mfma_f32_16x16x32_bf16 v[240:243], a[180:183], a[100:103], v[240:243]
ds_read_b128 a[88:91], v9 offset:2048
v_accvgpr_write_b32 a240, v16
v_mfma_f32_16x16x32_bf16 v[232:235], a[188:191], a[100:103], v[232:235]
v_accvgpr_write_b32 a241, v16
v_accvgpr_write_b32 a242, v16
v_mfma_f32_16x16x32_bf16 v[232:235], a[184:187], a[96:99], v[232:235]
ds_read_b128 a[76:79], v4 offset:44032
v_accvgpr_write_b32 a243, v16
v_mfma_f32_16x16x32_bf16 v[236:239], a[112:115], a[96:99], v[236:239]
s_add_u32 m0, s73, 2048
s_add_u32 s64, s71, 18432
v_accvgpr_write_b32 a232, 0
v_mfma_f32_16x16x32_bf16 v[236:239], a[116:119], a[100:103], v[236:239]
ds_read_b128 a[92:95], v10 offset:2048
v_accvgpr_write_b32 a233, 0
v_mfma_f32_16x16x32_bf16 v[224:227], a[124:127], a[100:103], v[224:227]
buffer_load_dwordx4 v5, s[12:15], s64 offen lds
v_mfma_f32_16x16x32_bf16 v[224:227], a[120:123], a[96:99], v[224:227]
v_accvgpr_write_b32 a234, 0
v_accvgpr_write_b32 a235, 0
v_mfma_f32_16x16x32_bf16 v[208:211], a[120:123], a[104:107], v[208:211]
v_accvgpr_write_b32 a236, 0
v_accvgpr_write_b32 a237, 0
v_mfma_f32_16x16x32_bf16 v[208:211], a[124:127], a[108:111], v[208:211]
s_add_u32 s53, s88, 786432
v_accvgpr_write_b32 a238, 0
v_accvgpr_write_b32 a239, 0
v_mfma_f32_16x16x32_bf16 v[216:219], a[116:119], a[108:111], v[216:219]
buffer_store_dwordx4 v[136:139], v4, s[24:27], s53 offen offset:1024 sc1
v_mfma_f32_16x16x32_bf16 v[216:219], a[112:115], a[104:107], v[216:219]
v_lshlrev_b32 v16, 2, v3
v_sub_u32 v16, v2, v16
v_mfma_f32_16x16x32_bf16 v[244:247], a[184:187], a[104:107], v[244:247]
buffer_load_dwordx4 v6, s[12:15], s64 offen offset:1024 lds
v_mfma_f32_16x16x32_bf16 v[244:247], a[188:191], a[108:111], v[244:247]
v_cmp_gt_i32 s[56:57], 0, v16
v_cmp_gt_i32 s[58:59], 1, v16
v_mfma_f32_16x16x32_bf16 v[192:195], a[180:183], a[108:111], v[192:195]
v_cmp_gt_i32 s[60:61], 2, v16
v_cmp_gt_i32 s[62:63], 3, v16
v_mfma_f32_16x16x32_bf16 v[192:195], a[176:179], a[104:107], v[192:195]
v_cmp_eq_u32 s[96:97], 3, v3
v_add_u32 v17, 48, v2
v_mfma_f32_16x16x32_bf16 v[200:203], a[168:171], a[104:107], v[200:203]
v_lshlrev_b32 v17, 2, v17
v_lshlrev_b32 v18, 16, v3
v_mfma_f32_16x16x32_bf16 v[200:203], a[172:175], a[108:111], v[200:203]
v_lshl_add_u32 v18, v2, 4, v18
v_add_u32 v19, 0x8000, v18
v_mfma_f32_16x16x32_bf16 v[88:91], a[164:167], a[108:111], v[88:91]
v_cndmask_b32 v19, v19, v20, s[96:97]
v_cmp_eq_u32 s[96:97], 0, v3
v_mfma_f32_16x16x32_bf16 v[88:91], a[160:163], a[104:107], v[88:91]
s_waitcnt lgkmcnt(0)
v_mfma_f32_16x16x32_bf16 v[36:39], a[128:131], a[80:83], v[36:39]
s_waitcnt vmcnt(24)
v_cndmask_b32 v18, v18, v20, s[96:97]
v_cndmask_b32 v19, v19, v20, s[96:97]
v_mfma_f32_16x16x32_bf16 v[36:39], a[132:135], a[84:87], v[36:39]
s_barrier
v_mfma_f32_16x16x32_bf16 v[44:47], a[140:143], a[84:87], v[44:47]
ds_read_b128 a[96:99], v9 offset:4096
v_mfma_f32_16x16x32_bf16 v[44:47], a[136:139], a[80:83], v[44:47]
s_xor_b32 s75, s93, 6
s_lshl_b32 s76, s75, 19
s_add_u32 s76, s76, s74
v_mfma_f32_16x16x32_bf16 v[32:35], a[144:147], a[80:83], v[32:35]
s_lshl_b32 s79, s75, 13
s_add_u32 s79, s79, s78
ds_read_b128 a[100:103], v10 offset:4096
v_mfma_f32_16x16x32_bf16 v[32:35], a[148:151], a[84:87], v[32:35]
s_add_u32 m0, s77, 32768
s_add_u32 s64, s76, 0
ds_read_b128 a[104:107], v9 offset:6144
v_mfma_f32_16x16x32_bf16 v[52:55], a[156:159], a[84:87], v[52:55]
buffer_load_dwordx4 v7, s[20:23], s64 offen lds
v_mfma_f32_16x16x32_bf16 v[52:55], a[152:155], a[80:83], v[52:55]
ds_read_b64_tr_b16 a[160:161], v11 offset:49152
ds_read_b64_tr_b16 a[162:163], v11 offset:49664
v_mfma_f32_16x16x32_bf16 v[60:63], a[64:67], a[80:83], v[60:63]
v_mfma_f32_16x16x32_bf16 v[60:63], a[68:71], a[84:87], v[60:63]
ds_read_b128 a[108:111], v10 offset:6144
v_mfma_f32_16x16x32_bf16 v[68:71], a[76:79], a[84:87], v[68:71]
buffer_load_dwordx4 v8, s[20:23], s64 offen offset:1024 lds
v_mfma_f32_16x16x32_bf16 v[68:71], a[72:75], a[80:83], v[68:71]
ds_read_b64_tr_b16 a[164:165], v11 offset:53248
ds_read_b64_tr_b16 a[166:167], v11 offset:53760
v_mfma_f32_16x16x32_bf16 v[76:79], a[72:75], a[88:91], v[76:79]
v_add_u32 v9, 32768, v9
v_add_u32 v10, 32768, v10
v_mfma_f32_16x16x32_bf16 v[76:79], a[76:79], a[92:95], v[76:79]
ds_read_b64_tr_b16 a[168:169], v12 offset:49152
ds_read_b64_tr_b16 a[170:171], v12 offset:49664
v_mfma_f32_16x16x32_bf16 v[84:87], a[68:71], a[92:95], v[84:87]
s_add_u32 m0, s80, 32768
s_add_u32 s64, s79, 0
v_mfma_f32_16x16x32_bf16 v[84:87], a[64:67], a[88:91], v[84:87]
ds_read_b64_tr_b16 a[172:173], v12 offset:53248
ds_read_b64_tr_b16 a[174:175], v12 offset:53760
v_mfma_f32_16x16x32_bf16 v[92:95], a[152:155], a[88:91], v[92:95]
buffer_load_dwordx4 v4, s[24:27], s64 offen sc1 lds
v_mfma_f32_16x16x32_bf16 v[92:95], a[156:159], a[92:95], v[92:95]
s_add_u32 s53, s88, 786432
v_mfma_f32_16x16x32_bf16 v[40:43], a[148:151], a[92:95], v[40:43]
ds_read_b64_tr_b16 a[176:177], v13 offset:49152
ds_read_b64_tr_b16 a[178:179], v13 offset:49664
v_mfma_f32_16x16x32_bf16 v[40:43], a[144:147], a[88:91], v[40:43]
buffer_store_dwordx4 v[144:147], v4, s[24:27], s53 offen offset:2048 sc1
v_mfma_f32_16x16x32_bf16 v[100:103], a[136:139], a[88:91], v[100:103]
s_add_u32 m0, s73, 4096
s_add_u32 s64, s72, 0
v_mfma_f32_16x16x32_bf16 v[100:103], a[140:143], a[92:95], v[100:103]
ds_read_b64_tr_b16 a[180:181], v13 offset:53248
ds_read_b64_tr_b16 a[182:183], v13 offset:53760
v_mfma_f32_16x16x32_bf16 v[108:111], a[132:135], a[92:95], v[108:111]
buffer_load_dwordx4 v5, s[12:15], s64 offen lds
v_mfma_f32_16x16x32_bf16 v[108:111], a[128:131], a[88:91], v[108:111]
s_waitcnt lgkmcnt(14)
ds_read_b64_tr_b16 a[184:185], v14 offset:49152
ds_read_b64_tr_b16 a[186:187], v14 offset:49664
v_mfma_f32_16x16x32_bf16 v[116:119], a[128:131], a[96:99], v[116:119]
ds_read_b64_tr_b16 a[188:189], v14 offset:53248
ds_read_b64_tr_b16 a[190:191], v14 offset:53760
v_mfma_f32_16x16x32_bf16 v[116:119], a[132:135], a[100:103], v[116:119]
v_mfma_f32_16x16x32_bf16 v[124:127], a[140:143], a[100:103], v[124:127]
v_mfma_f32_16x16x32_bf16 v[124:127], a[136:139], a[96:99], v[124:127]
ds_read_b128 a[112:115], v4 offset:57344
v_mfma_f32_16x16x32_bf16 v[132:135], a[144:147], a[96:99], v[132:135]
buffer_load_dwordx4 v6, s[12:15], s64 offen offset:1024 lds
v_mfma_f32_16x16x32_bf16 v[132:135], a[148:151], a[100:103], v[132:135]
ds_read_b128 a[116:119], v4 offset:59392
v_mfma_f32_16x16x32_bf16 v[140:143], a[156:159], a[100:103], v[140:143]
v_mfma_f32_16x16x32_bf16 v[140:143], a[152:155], a[96:99], v[140:143]
ds_read_b128 a[120:123], v4 offset:58368
v_mfma_f32_16x16x32_bf16 v[148:151], a[64:67], a[96:99], v[148:151]
s_add_u32 m0, s73, 6144
s_add_u32 s64, s72, 18432
v_mfma_f32_16x16x32_bf16 v[148:151], a[68:71], a[100:103], v[148:151]
ds_read_b128 a[124:127], v4 offset:60416
v_mfma_f32_16x16x32_bf16 v[48:51], a[76:79], a[100:103], v[48:51]
buffer_load_dwordx4 v5, s[12:15], s64 offen lds
v_mfma_f32_16x16x32_bf16 v[48:51], a[72:75], a[96:99], v[48:51]
s_waitcnt lgkmcnt(15)
v_mfma_f32_16x16x32_bf16 v[156:159], a[72:75], a[104:107], v[156:159]
v_mfma_f32_16x16x32_bf16 v[156:159], a[76:79], a[108:111], v[156:159]
v_mfma_f32_16x16x32_bf16 v[164:167], a[68:71], a[108:111], v[164:167]
v_mfma_f32_16x16x32_bf16 v[164:167], a[64:67], a[104:107], v[164:167]
v_mfma_f32_16x16x32_bf16 v[172:175], a[152:155], a[104:107], v[172:175]
buffer_load_dwordx4 v6, s[12:15], s64 offen offset:1024 lds
v_mfma_f32_16x16x32_bf16 v[172:175], a[156:159], a[108:111], v[172:175]
v_mfma_f32_16x16x32_bf16 v[56:59], a[148:151], a[108:111], v[56:59]
v_mfma_f32_16x16x32_bf16 v[56:59], a[144:147], a[104:107], v[56:59]
s_add_u32 s53, s88, 786432
v_mfma_f32_16x16x32_bf16 v[180:183], a[136:139], a[104:107], v[180:183]
buffer_store_dwordx4 v[152:155], v4, s[24:27], s53 offen offset:3072 sc1
v_mfma_f32_16x16x32_bf16 v[180:183], a[140:143], a[108:111], v[180:183]
v_mfma_f32_16x16x32_bf16 v[188:191], a[132:135], a[108:111], v[188:191]
v_mfma_f32_16x16x32_bf16 v[188:191], a[128:131], a[104:107], v[188:191]
s_waitcnt lgkmcnt(0)
v_mov_b32 v96, 0
v_mov_b32 v97, 0
v_mfma_f32_16x16x32_bf16 v[196:199], a[160:163], a[80:83], v[196:199]
s_waitcnt vmcnt(19)
v_mov_b32 v98, 0
v_mov_b32 v99, 0
v_mfma_f32_16x16x32_bf16 v[196:199], a[164:167], a[84:87], v[196:199]
s_barrier
v_mfma_f32_16x16x32_bf16 v[64:67], a[172:175], a[84:87], v[64:67]
ds_read_b64_tr_b16 a[128:129], v11 offset:0
ds_read_b64_tr_b16 a[130:131], v11 offset:512
v_mfma_f32_16x16x32_bf16 v[64:67], a[168:171], a[80:83], v[64:67]
s_add_u32 m0, s77, 49152
s_add_u32 s64, s76, 128
v_mov_b32 v104, 0
v_mfma_f32_16x16x32_bf16 v[204:207], a[176:179], a[80:83], v[204:207]
buffer_load_dwordx4 v7, s[20:23], s64 offen lds
v_mfma_f32_16x16x32_bf16 v[204:207], a[180:183], a[84:87], v[204:207]
ds_read_b64_tr_b16 a[132:133], v11 offset:4096
ds_read_b64_tr_b16 a[134:135], v11 offset:4608
v_mfma_f32_16x16x32_bf16 v[212:215], a[188:191], a[84:87], v[212:215]
ds_read_b64_tr_b16 a[136:137], v12 offset:0
ds_read_b64_tr_b16 a[138:139], v12 offset:512
v_mfma_f32_16x16x32_bf16 v[212:215], a[184:187], a[80:83], v[212:215]
ds_read_b64_tr_b16 a[140:141], v12 offset:4096
ds_read_b64_tr_b16 a[142:143], v12 offset:4608
v_mfma_f32_16x16x32_bf16 v[72:75], a[112:115], a[80:83], v[72:75]
buffer_load_dword v30, v29, s[24:27], s89 offen offset:4 sc1
v_mfma_f32_16x16x32_bf16 v[72:75], a[116:119], a[84:87], v[72:75]
ds_read_b64_tr_b16 a[144:145], v13 offset:0
ds_read_b64_tr_b16 a[146:147], v13 offset:512
v_mfma_f32_16x16x32_bf16 v[220:223], a[124:127], a[84:87], v[220:223]
buffer_load_dwordx4 v8, s[20:23], s64 offen offset:1024 lds
v_mfma_f32_16x16x32_bf16 v[220:223], a[120:123], a[80:83], v[220:223]
ds_read_b64_tr_b16 a[148:149], v13 offset:4096
ds_read_b64_tr_b16 a[150:151], v13 offset:4608
v_mfma_f32_16x16x32_bf16 v[252:255], a[120:123], a[88:91], v[252:255]
v_mov_b32 v105, 0
v_mov_b32 v106, 0
v_mfma_f32_16x16x32_bf16 v[252:255], a[124:127], a[92:95], v[252:255]
ds_read_b64_tr_b16 a[152:153], v14 offset:0
ds_read_b64_tr_b16 a[154:155], v14 offset:512
v_mfma_f32_16x16x32_bf16 v[160:163], a[116:119], a[92:95], v[160:163]
s_add_u32 m0, s80, 49152
s_add_u32 s64, s79, 2048
v_mov_b32 v107, 0
v_mfma_f32_16x16x32_bf16 v[160:163], a[112:115], a[88:91], v[160:163]
ds_read_b64_tr_b16 a[156:157], v14 offset:4096
ds_read_b64_tr_b16 a[158:159], v14 offset:4608
v_mfma_f32_16x16x32_bf16 v[228:231], a[184:187], a[88:91], v[228:231]
buffer_load_dwordx4 v4, s[24:27], s64 offen sc1 lds
v_mfma_f32_16x16x32_bf16 v[228:231], a[188:191], a[92:95], v[228:231]
s_xor_b32 s65, s70, 896
s_add_u32 s71, s68, s65
s_add_u32 s72, s69, s65
v_mfma_f32_16x16x32_bf16 v[168:171], a[180:183], a[92:95], v[168:171]
ds_read_b128 a[64:67], v4 offset:8192
v_mov_b32 v112, 0
v_mfma_f32_16x16x32_bf16 v[168:171], a[176:179], a[88:91], v[168:171]
v_mov_b32 v113, 0
v_mov_b32 v114, 0
v_mfma_f32_16x16x32_bf16 v[176:179], a[168:171], a[88:91], v[176:179]
s_add_u32 m0, s73, 32768
s_add_u32 s64, s71, 0
ds_read_b128 a[80:83], v9 offset:0
v_mfma_f32_16x16x32_bf16 v[176:179], a[172:175], a[92:95], v[176:179]
v_mov_b32 v115, 0
v_mov_b32 v120, 0
v_mfma_f32_16x16x32_bf16 v[80:83], a[164:167], a[92:95], v[80:83]
buffer_load_dwordx4 v5, s[12:15], s64 offen lds
v_mfma_f32_16x16x32_bf16 v[80:83], a[160:163], a[88:91], v[80:83]
s_add_u32 s53, s87, 524288
ds_read_b128 a[68:71], v4 offset:10240
v_mov_b32 v121, 0
v_mfma_f32_16x16x32_bf16 v[184:187], a[160:163], a[96:99], v[184:187]
ds_read_b128 a[84:87], v10 offset:0
v_mov_b32 v122, 0
v_mfma_f32_16x16x32_bf16 v[184:187], a[164:167], a[100:103], v[184:187]
buffer_store_dwordx4 a[28:31], v4, s[24:27], s53 offen offset:0 sc1
v_mfma_f32_16x16x32_bf16 v[248:251], a[172:175], a[100:103], v[248:251]
v_mov_b32 v123, 0
v_mov_b32 v128, 0
v_mfma_f32_16x16x32_bf16 v[248:251], a[168:171], a[96:99], v[248:251]
ds_read_b128 a[72:75], v4 offset:9216
v_mov_b32 v129, 0
v_mfma_f32_16x16x32_bf16 v[240:243], a[176:179], a[96:99], v[240:243]
buffer_load_dwordx4 v6, s[12:15], s64 offen offset:1024 lds
v_mfma_f32_16x16x32_bf16 v[240:243], a[180:183], a[100:103], v[240:243]
ds_read_b128 a[88:91], v9 offset:2048
v_mov_b32 v130, 0
v_mfma_f32_16x16x32_bf16 v[232:235], a[188:191], a[100:103], v[232:235]
v_mov_b32 v131, 0
v_mov_b32 v136, 0
v_mfma_f32_16x16x32_bf16 v[232:235], a[184:187], a[96:99], v[232:235]
ds_read_b128 a[76:79], v4 offset:11264
v_mov_b32 v137, 0
v_mfma_f32_16x16x32_bf16 v[236:239], a[112:115], a[96:99], v[236:239]
s_add_u32 m0, s73, 34816
s_add_u32 s64, s71, 18432
v_mov_b32 v138, 0
v_mfma_f32_16x16x32_bf16 v[236:239], a[116:119], a[100:103], v[236:239]
ds_read_b128 a[92:95], v10 offset:2048
v_mov_b32 v139, 0
v_mfma_f32_16x16x32_bf16 v[224:227], a[124:127], a[100:103], v[224:227]
buffer_load_dwordx4 v5, s[12:15], s64 offen lds
v_mfma_f32_16x16x32_bf16 v[224:227], a[120:123], a[96:99], v[224:227]
v_mov_b32 v144, 0
v_mov_b32 v145, 0
v_mfma_f32_16x16x32_bf16 v[208:211], a[120:123], a[104:107], v[208:211]
v_mov_b32 v146, 0
v_mov_b32 v147, 0
v_mfma_f32_16x16x32_bf16 v[208:211], a[124:127], a[108:111], v[208:211]
v_mov_b32 v152, 0
v_mov_b32 v153, 0
v_mfma_f32_16x16x32_bf16 v[216:219], a[116:119], a[108:111], v[216:219]
v_mov_b32 v154, 0
v_mov_b32 v155, 0
v_mfma_f32_16x16x32_bf16 v[216:219], a[112:115], a[104:107], v[216:219]
v_mfma_f32_16x16x32_bf16 v[244:247], a[184:187], a[104:107], v[244:247]
buffer_load_dwordx4 v6, s[12:15], s64 offen offset:1024 lds
v_mfma_f32_16x16x32_bf16 v[244:247], a[188:191], a[108:111], v[244:247]
v_mfma_f32_16x16x32_bf16 v[192:195], a[180:183], a[108:111], v[192:195]
v_mfma_f32_16x16x32_bf16 v[192:195], a[176:179], a[104:107], v[192:195]
v_mfma_f32_16x16x32_bf16 v[200:203], a[168:171], a[104:107], v[200:203]
v_mfma_f32_16x16x32_bf16 v[200:203], a[172:175], a[108:111], v[200:203]
v_mfma_f32_16x16x32_bf16 v[88:91], a[164:167], a[108:111], v[88:91]
v_mfma_f32_16x16x32_bf16 v[88:91], a[160:163], a[104:107], v[88:91]
s_waitcnt lgkmcnt(0)
v_mfma_f32_16x16x32_bf16 v[36:39], a[128:131], a[80:83], v[36:39]
s_waitcnt vmcnt(23)
v_mfma_f32_16x16x32_bf16 v[36:39], a[132:135], a[84:87], v[36:39]
s_barrier
v_mfma_f32_16x16x32_bf16 v[44:47], a[140:143], a[84:87], v[44:47]
s_add_u32 s53, s87, 524288
ds_read_b128 a[96:99], v9 offset:4096
v_mfma_f32_16x16x32_bf16 v[44:47], a[136:139], a[80:83], v[44:47]
s_xor_b32 s75, s93, 7
s_lshl_b32 s76, s75, 19
s_add_u32 s76, s76, s74
v_mfma_f32_16x16x32_bf16 v[32:35], a[144:147], a[80:83], v[32:35]
s_lshl_b32 s79, s75, 13
s_add_u32 s79, s79, s78
ds_read_b128 a[100:103], v10 offset:4096
v_mfma_f32_16x16x32_bf16 v[32:35], a[148:151], a[84:87], v[32:35]
s_add_u32 m0, s77, 0
s_add_u32 s64, s76, 0
ds_read_b128 a[104:107], v9 offset:6144
v_mfma_f32_16x16x32_bf16 v[52:55], a[156:159], a[84:87], v[52:55]
buffer_load_dwordx4 v7, s[20:23], s64 offen lds
v_mfma_f32_16x16x32_bf16 v[52:55], a[152:155], a[80:83], v[52:55]
ds_read_b64_tr_b16 a[160:161], v11 offset:16384
ds_read_b64_tr_b16 a[162:163], v11 offset:16896
v_mfma_f32_16x16x32_bf16 v[60:63], a[64:67], a[80:83], v[60:63]
buffer_store_dwordx4 a[20:23], v4, s[24:27], s53 offen offset:1024 sc1
v_mfma_f32_16x16x32_bf16 v[60:63], a[68:71], a[84:87], v[60:63]
ds_read_b128 a[108:111], v10 offset:6144
v_mfma_f32_16x16x32_bf16 v[68:71], a[76:79], a[84:87], v[68:71]
buffer_load_dwordx4 v8, s[20:23], s64 offen offset:1024 lds
v_mfma_f32_16x16x32_bf16 v[68:71], a[72:75], a[80:83], v[68:71]
ds_read_b64_tr_b16 a[164:165], v11 offset:20480
ds_read_b64_tr_b16 a[166:167], v11 offset:20992
v_mfma_f32_16x16x32_bf16 v[76:79], a[72:75], a[88:91], v[76:79]
v_add_u32 v9, -65536, v9
v_add_u32 v10, -65536, v10
v_mfma_f32_16x16x32_bf16 v[76:79], a[76:79], a[92:95], v[76:79]
ds_read_b64_tr_b16 a[168:169], v12 offset:16384
ds_read_b64_tr_b16 a[170:171], v12 offset:16896
v_mfma_f32_16x16x32_bf16 v[84:87], a[68:71], a[92:95], v[84:87]
s_add_u32 m0, s80, 0
s_add_u32 s64, s79, 0
v_mfma_f32_16x16x32_bf16 v[84:87], a[64:67], a[88:91], v[84:87]
ds_read_b64_tr_b16 a[172:173], v12 offset:20480
ds_read_b64_tr_b16 a[174:175], v12 offset:20992
v_mfma_f32_16x16x32_bf16 v[92:95], a[152:155], a[88:91], v[92:95]
buffer_load_dwordx4 v4, s[24:27], s64 offen sc1 lds
v_mfma_f32_16x16x32_bf16 v[92:95], a[156:159], a[92:95], v[92:95]
v_mfma_f32_16x16x32_bf16 v[40:43], a[148:151], a[92:95], v[40:43]
ds_read_b64_tr_b16 a[176:177], v13 offset:16384
ds_read_b64_tr_b16 a[178:179], v13 offset:16896
v_mfma_f32_16x16x32_bf16 v[40:43], a[144:147], a[88:91], v[40:43]
v_mfma_f32_16x16x32_bf16 v[100:103], a[136:139], a[88:91], v[100:103]
s_add_u32 m0, s73, 36864
s_add_u32 s64, s72, 0
v_mfma_f32_16x16x32_bf16 v[100:103], a[140:143], a[92:95], v[100:103]
ds_read_b64_tr_b16 a[180:181], v13 offset:20480
ds_read_b64_tr_b16 a[182:183], v13 offset:20992
v_mfma_f32_16x16x32_bf16 v[108:111], a[132:135], a[92:95], v[108:111]
buffer_load_dwordx4 v5, s[12:15], s64 offen lds
v_mfma_f32_16x16x32_bf16 v[108:111], a[128:131], a[88:91], v[108:111]
s_waitcnt lgkmcnt(14)
ds_read_b64_tr_b16 a[184:185], v14 offset:16384
ds_read_b64_tr_b16 a[186:187], v14 offset:16896
v_mfma_f32_16x16x32_bf16 v[116:119], a[128:131], a[96:99], v[116:119]
ds_read_b64_tr_b16 a[188:189], v14 offset:20480
ds_read_b64_tr_b16 a[190:191], v14 offset:20992
v_mfma_f32_16x16x32_bf16 v[116:119], a[132:135], a[100:103], v[116:119]
v_mfma_f32_16x16x32_bf16 v[124:127], a[140:143], a[100:103], v[124:127]
v_mfma_f32_16x16x32_bf16 v[124:127], a[136:139], a[96:99], v[124:127]
ds_read_b128 a[112:115], v4 offset:24576
v_mfma_f32_16x16x32_bf16 v[132:135], a[144:147], a[96:99], v[132:135]
buffer_load_dwordx4 v6, s[12:15], s64 offen offset:1024 lds
v_mfma_f32_16x16x32_bf16 v[132:135], a[148:151], a[100:103], v[132:135]
s_add_u32 s53, s87, 528384
ds_read_b128 a[116:119], v4 offset:26624
v_mfma_f32_16x16x32_bf16 v[140:143], a[156:159], a[100:103], v[140:143]
buffer_store_dwordx4 a[12:15], v4, s[24:27], s53 offen offset:0 sc1
v_mfma_f32_16x16x32_bf16 v[140:143], a[152:155], a[96:99], v[140:143]
ds_read_b128 a[120:123], v4 offset:25600
v_mfma_f32_16x16x32_bf16 v[148:151], a[64:67], a[96:99], v[148:151]
s_add_u32 m0, s73, 38912
s_add_u32 s64, s72, 18432
v_mfma_f32_16x16x32_bf16 v[148:151], a[68:71], a[100:103], v[148:151]
ds_read_b128 a[124:127], v4 offset:27648
v_mfma_f32_16x16x32_bf16 v[48:51], a[76:79], a[100:103], v[48:51]
buffer_load_dwordx4 v5, s[12:15], s64 offen lds
v_mfma_f32_16x16x32_bf16 v[48:51], a[72:75], a[96:99], v[48:51]
s_waitcnt lgkmcnt(15)
v_mfma_f32_16x16x32_bf16 v[156:159], a[72:75], a[104:107], v[156:159]
v_mfma_f32_16x16x32_bf16 v[156:159], a[76:79], a[108:111], v[156:159]
v_mfma_f32_16x16x32_bf16 v[164:167], a[68:71], a[108:111], v[164:167]
v_mfma_f32_16x16x32_bf16 v[164:167], a[64:67], a[104:107], v[164:167]
v_mfma_f32_16x16x32_bf16 v[172:175], a[152:155], a[104:107], v[172:175]
buffer_load_dwordx4 v6, s[12:15], s64 offen offset:1024 lds
v_mfma_f32_16x16x32_bf16 v[172:175], a[156:159], a[108:111], v[172:175]
v_mfma_f32_16x16x32_bf16 v[56:59], a[148:151], a[108:111], v[56:59]
v_mfma_f32_16x16x32_bf16 v[56:59], a[144:147], a[104:107], v[56:59]
v_mfma_f32_16x16x32_bf16 v[180:183], a[136:139], a[104:107], v[180:183]
v_mfma_f32_16x16x32_bf16 v[180:183], a[140:143], a[108:111], v[180:183]
v_mfma_f32_16x16x32_bf16 v[188:191], a[132:135], a[108:111], v[188:191]
v_mfma_f32_16x16x32_bf16 v[188:191], a[128:131], a[104:107], v[188:191]
s_waitcnt lgkmcnt(0)
v_mfma_f32_16x16x32_bf16 v[196:199], a[160:163], a[80:83], v[196:199]
s_waitcnt vmcnt(19)
v_mfma_f32_16x16x32_bf16 v[196:199], a[164:167], a[84:87], v[196:199]
s_barrier
v_mfma_f32_16x16x32_bf16 v[64:67], a[172:175], a[84:87], v[64:67]
ds_read_b64_tr_b16 a[128:129], v11 offset:32768
ds_read_b64_tr_b16 a[130:131], v11 offset:33280
v_mfma_f32_16x16x32_bf16 v[64:67], a[168:171], a[80:83], v[64:67]
s_add_u32 m0, s77, 16384
s_add_u32 s64, s76, 128
v_mfma_f32_16x16x32_bf16 v[204:207], a[176:179], a[80:83], v[204:207]
buffer_load_dwordx4 v7, s[20:23], s64 offen lds
v_mfma_f32_16x16x32_bf16 v[204:207], a[180:183], a[84:87], v[204:207]
ds_read_b64_tr_b16 a[132:133], v11 offset:36864
ds_read_b64_tr_b16 a[134:135], v11 offset:37376
v_mfma_f32_16x16x32_bf16 v[212:215], a[188:191], a[84:87], v[212:215]
ds_read_b64_tr_b16 a[136:137], v12 offset:32768
ds_read_b64_tr_b16 a[138:139], v12 offset:33280
v_mfma_f32_16x16x32_bf16 v[212:215], a[184:187], a[80:83], v[212:215]
s_add_u32 s53, s87, 528384
ds_read_b64_tr_b16 a[140:141], v12 offset:36864
ds_read_b64_tr_b16 a[142:143], v12 offset:37376
v_mfma_f32_16x16x32_bf16 v[72:75], a[112:115], a[80:83], v[72:75]
buffer_load_dwordx4 v8, s[20:23], s64 offen offset:1024 lds
v_mfma_f32_16x16x32_bf16 v[72:75], a[116:119], a[84:87], v[72:75]
ds_read_b64_tr_b16 a[144:145], v13 offset:32768
ds_read_b64_tr_b16 a[146:147], v13 offset:33280
v_mfma_f32_16x16x32_bf16 v[220:223], a[124:127], a[84:87], v[220:223]
buffer_store_dwordx4 a[4:7], v4, s[24:27], s53 offen offset:1024 sc1
v_mfma_f32_16x16x32_bf16 v[220:223], a[120:123], a[80:83], v[220:223]
s_add_u32 m0, s80, 16384
s_add_u32 s64, s79, 2048
v_mfma_f32_16x16x32_bf16 v[252:255], a[120:123], a[88:91], v[252:255]
ds_read_b64_tr_b16 a[148:149], v13 offset:36864
ds_read_b64_tr_b16 a[150:151], v13 offset:37376
v_mfma_f32_16x16x32_bf16 v[252:255], a[124:127], a[92:95], v[252:255]
buffer_load_dwordx4 v4, s[24:27], s64 offen sc1 lds
v_mfma_f32_16x16x32_bf16 v[160:163], a[116:119], a[92:95], v[160:163]
ds_read_b64_tr_b16 a[152:153], v14 offset:32768
ds_read_b64_tr_b16 a[154:155], v14 offset:33280
v_mfma_f32_16x16x32_bf16 v[160:163], a[112:115], a[88:91], v[160:163]
ds_read_b64_tr_b16 a[156:157], v14 offset:36864
ds_read_b64_tr_b16 a[158:159], v14 offset:37376
v_mfma_f32_16x16x32_bf16 v[228:231], a[184:187], a[88:91], v[228:231]
s_add_u32 m0, s83, 0
s_add_u32 s64, s81, 0
v_mfma_f32_16x16x32_bf16 v[228:231], a[188:191], a[92:95], v[228:231]
v_mfma_f32_16x16x32_bf16 v[168:171], a[180:183], a[92:95], v[168:171]
buffer_load_dwordx4 v22, s[32:35], s64 offen lds
v_mfma_f32_16x16x32_bf16 v[168:171], a[176:179], a[88:91], v[168:171]
ds_read_b128 a[64:67], v4 offset:40960
v_mfma_f32_16x16x32_bf16 v[176:179], a[168:171], a[88:91], v[176:179]
s_add_u32 m0, s83, 1024
s_add_u32 s64, s81, 9216
ds_read_b128 a[80:83], v9 offset:0
v_mfma_f32_16x16x32_bf16 v[176:179], a[172:175], a[92:95], v[176:179]
v_mfma_f32_16x16x32_bf16 v[80:83], a[164:167], a[92:95], v[80:83]
buffer_load_dwordx4 v22, s[32:35], s64 offen lds
v_mfma_f32_16x16x32_bf16 v[80:83], a[160:163], a[88:91], v[80:83]
ds_read_b128 a[68:71], v4 offset:43008
v_mfma_f32_16x16x32_bf16 v[184:187], a[160:163], a[96:99], v[184:187]
ds_read_b128 a[84:87], v10 offset:0
v_mfma_f32_16x16x32_bf16 v[184:187], a[164:167], a[100:103], v[184:187]
s_add_u32 m0, s83, 2048
s_add_u32 s64, s81, 18432
v_mfma_f32_16x16x32_bf16 v[248:251], a[172:175], a[100:103], v[248:251]
v_mfma_f32_16x16x32_bf16 v[248:251], a[168:171], a[96:99], v[248:251]
buffer_load_dwordx4 v22, s[32:35], s64 offen lds
v_mfma_f32_16x16x32_bf16 v[240:243], a[176:179], a[96:99], v[240:243]
ds_read_b128 a[72:75], v4 offset:41984
v_mfma_f32_16x16x32_bf16 v[240:243], a[180:183], a[100:103], v[240:243]
ds_read_b128 a[88:91], v9 offset:2048
v_mfma_f32_16x16x32_bf16 v[232:235], a[188:191], a[100:103], v[232:235]
s_add_u32 m0, s83, 3072
s_add_u32 s64, s81, 27648
v_mfma_f32_16x16x32_bf16 v[232:235], a[184:187], a[96:99], v[232:235]
ds_read_b128 a[76:79], v4 offset:44032
v_mfma_f32_16x16x32_bf16 v[236:239], a[112:115], a[96:99], v[236:239]
buffer_load_dwordx4 v22, s[32:35], s64 offen lds
v_mfma_f32_16x16x32_bf16 v[236:239], a[116:119], a[100:103], v[236:239]
ds_read_b128 a[92:95], v10 offset:2048
v_mfma_f32_16x16x32_bf16 v[224:227], a[124:127], a[100:103], v[224:227]
s_add_u32 m0, s83, 4096
s_add_u32 s64, s81, 128
s_add_u32 s53, s87, 786432
v_mfma_f32_16x16x32_bf16 v[224:227], a[120:123], a[96:99], v[224:227]
buffer_store_dwordx4 a[0:3], v4, s[24:27], s53 offen offset:0 sc1
v_mfma_f32_16x16x32_bf16 v[208:211], a[120:123], a[104:107], v[208:211]
buffer_load_dwordx4 v24, s[32:35], s64 offen lds
v_mfma_f32_16x16x32_bf16 v[208:211], a[124:127], a[108:111], v[208:211]
s_waitcnt vmcnt(26)
v_mfma_f32_16x16x32_bf16 v[216:219], a[116:119], a[108:111], v[216:219]
v_cmp_gt_u32 vcc, 8, v30
v_mfma_f32_16x16x32_bf16 v[216:219], a[112:115], a[104:107], v[216:219]
s_add_u32 m0, s83, 5120
s_add_u32 s64, s82, 0
v_mfma_f32_16x16x32_bf16 v[244:247], a[184:187], a[104:107], v[244:247]
v_mfma_f32_16x16x32_bf16 v[244:247], a[188:191], a[108:111], v[244:247]
buffer_load_dwordx4 v25, s[48:51], s64 offen lds
v_mfma_f32_16x16x32_bf16 v[192:195], a[180:183], a[108:111], v[192:195]
v_mfma_f32_16x16x32_bf16 v[192:195], a[176:179], a[104:107], v[192:195]
s_cbranch_vccnz CK_KV
CK_KV_R:
v_mfma_f32_16x16x32_bf16 v[200:203], a[168:171], a[104:107], v[200:203]
v_mfma_f32_16x16x32_bf16 v[200:203], a[172:175], a[108:111], v[200:203]
v_mfma_f32_16x16x32_bf16 v[88:91], a[164:167], a[108:111], v[88:91]
v_mfma_f32_16x16x32_bf16 v[88:91], a[160:163], a[104:107], v[88:91]
s_waitcnt lgkmcnt(0)
v_mfma_f32_16x16x32_bf16 v[36:39], a[128:131], a[80:83], v[36:39]
s_waitcnt vmcnt(25)
v_mov_b32 v6, 0xf149f2ca
v_mfma_f32_16x16x32_bf16 v[36:39], a[132:135], a[84:87], v[36:39]
s_barrier
v_mfma_f32_16x16x32_bf16 v[44:47], a[140:143], a[84:87], v[44:47]
ds_read_b128 a[96:99], v9 offset:4096
v_mfma_f32_16x16x32_bf16 v[44:47], a[136:139], a[80:83], v[44:47]
s_lshl_b32 s70, s3, 12
s_add_u32 s68, s70, s94
ds_read_b128 a[100:103], v10 offset:4096
v_mfma_f32_16x16x32_bf16 v[32:35], a[144:147], a[80:83], v[32:35]
s_add_u32 m0, s70, 32768
s_cmp_lt_u32 s3, 2
s_cselect_b32 s64, s68, 2147418112
v_mfma_f32_16x16x32_bf16 v[32:35], a[148:151], a[84:87], v[32:35]
buffer_load_dwordx4 v4, s[24:27], s64 offen offset:0 sc1 lds
v_mfma_f32_16x16x32_bf16 v[52:55], a[156:159], a[84:87], v[52:55]
ds_read_b128 a[104:107], v9 offset:6144
v_mfma_f32_16x16x32_bf16 v[52:55], a[152:155], a[80:83], v[52:55]
ds_read_b64_tr_b16 a[160:161], v11 offset:49152
ds_read_b64_tr_b16 a[162:163], v11 offset:49664
v_mfma_f32_16x16x32_bf16 v[60:63], a[64:67], a[80:83], v[60:63]
s_cmp_eq_u32 s66, 0
s_cbranch_scc1 D0
D0_R:
v_mfma_f32_16x16x32_bf16 v[60:63], a[68:71], a[84:87], v[60:63]
s_lshl_b32 s52, s4, 18
s_add_u32 s52, s52, 45088768
ds_read_b128 a[108:111], v10 offset:6144
v_mfma_f32_16x16x32_bf16 v[68:71], a[76:79], a[84:87], v[68:71]
s_lshl_b32 s54, s66, 9
v_add_u32 v9, 32768, v9
v_add_u32 v10, 32768, v10
v_mfma_f32_16x16x32_bf16 v[68:71], a[72:75], a[80:83], v[68:71]
s_add_u32 s54, s54, s52
ds_read_b64_tr_b16 a[164:165], v11 offset:53248
ds_read_b64_tr_b16 a[166:167], v11 offset:53760
v_mfma_f32_16x16x32_bf16 v[76:79], a[72:75], a[88:91], v[76:79]
s_lshl_b32 s55, s67, 9
s_add_u32 s55, s55, s52
v_mfma_f32_16x16x32_bf16 v[76:79], a[76:79], a[92:95], v[76:79]
s_add_u32 s53, s87, 786432
ds_read_b64_tr_b16 a[168:169], v12 offset:49152
ds_read_b64_tr_b16 a[170:171], v12 offset:49664
v_mfma_f32_16x16x32_bf16 v[84:87], a[68:71], a[92:95], v[84:87]
buffer_load_dwordx4 v4, s[24:27], s64 offen offset:1024 sc1 lds
v_mfma_f32_16x16x32_bf16 v[84:87], a[64:67], a[88:91], v[84:87]
s_max_u32 s65, s66, 1
ds_read_b64_tr_b16 a[172:173], v12 offset:53248
ds_read_b64_tr_b16 a[174:175], v12 offset:53760
v_mfma_f32_16x16x32_bf16 v[92:95], a[152:155], a[88:91], v[92:95]
L_PAD7:
s_cbranch_execz L_PAD11
buffer_store_dwordx4 a[8:11], v4, s[24:27], s53 offen offset:1024 sc1
v_mfma_f32_16x16x32_bf16 v[92:95], a[156:159], a[92:95], v[92:95]
s_lshl_b32 s65, s65, 9
s_add_u32 s52, s52, s65
s_sub_u32 s65, s55, s52
v_mfma_f32_16x16x32_bf16 v[40:43], a[148:151], a[92:95], v[40:43]
s_sub_u32 s65, s65, 163840
ds_read_b64_tr_b16 a[176:177], v13 offset:49152
ds_read_b64_tr_b16 a[178:179], v13 offset:49664
v_mfma_f32_16x16x32_bf16 v[40:43], a[144:147], a[88:91], v[40:43]
s_add_u32 s52, s52, 65280
v_mfma_f32_16x16x32_bf16 v[100:103], a[136:139], a[88:91], v[100:103]
ds_read_b64_tr_b16 a[180:181], v13 offset:53248
ds_read_b64_tr_b16 a[182:183], v13 offset:53760
v_mfma_f32_16x16x32_bf16 v[100:103], a[140:143], a[92:95], v[100:103]
v_cmp_lt_u32 s[96:97], 0, v3
v_lshlrev_b32 v16, 15, v3
v_mfma_f32_16x16x32_bf16 v[108:111], a[132:135], a[92:95], v[108:111]
ds_read_b64_tr_b16 a[184:185], v14 offset:49152
ds_read_b64_tr_b16 a[186:187], v14 offset:49664
v_mfma_f32_16x16x32_bf16 v[108:111], a[128:131], a[88:91], v[108:111]
s_waitcnt lgkmcnt(15)
v_lshl_add_u32 v16, v2, 4, v16
v_add_u32 v16, s52, v16
v_mfma_f32_16x16x32_bf16 v[116:119], a[128:131], a[96:99], v[116:119]
ds_read_b64_tr_b16 a[188:189], v14 offset:53248
ds_read_b64_tr_b16 a[190:191], v14 offset:53760
v_mfma_f32_16x16x32_bf16 v[116:119], a[132:135], a[100:103], v[116:119]
buffer_load_dwordx4 v4, s[24:27], s64 offen offset:2048 sc1 lds
v_mfma_f32_16x16x32_bf16 v[124:127], a[140:143], a[100:103], v[124:127]
v_accvgpr_write_b32 a244, v16
v_add_u32 v16, 131072, v16
v_mfma_f32_16x16x32_bf16 v[124:127], a[136:139], a[96:99], v[124:127]
ds_read_b128 a[112:115], v4 offset:57344
v_add_u32 v21, s65, v16
v_mfma_f32_16x16x32_bf16 v[132:135], a[144:147], a[96:99], v[132:135]
v_cndmask_b32 v16, v16, v21, s[96:97]
v_accvgpr_write_b32 a248, v16
v_mfma_f32_16x16x32_bf16 v[132:135], a[148:151], a[100:103], v[132:135]
ds_read_b128 a[116:119], v4 offset:59392
v_cmp_lt_u32 s[96:97], 1, v3
v_mfma_f32_16x16x32_bf16 v[140:143], a[156:159], a[100:103], v[140:143]
v_add_u32 v21, 131072, v21
v_mfma_f32_16x16x32_bf16 v[140:143], a[152:155], a[96:99], v[140:143]
ds_read_b128 a[120:123], v4 offset:58368
v_cndmask_b32 v21, v21, v20, s[96:97]
v_mfma_f32_16x16x32_bf16 v[148:151], a[64:67], a[96:99], v[148:151]
v_accvgpr_write_b32 a252, v21
v_mfma_f32_16x16x32_bf16 v[148:151], a[68:71], a[100:103], v[148:151]
ds_read_b128 a[124:127], v4 offset:60416
v_mfma_f32_16x16x32_bf16 v[48:51], a[76:79], a[100:103], v[48:51]
s_waitcnt lgkmcnt(15)
v_mfma_f32_16x16x32_bf16 v[48:51], a[72:75], a[96:99], v[48:51]
buffer_load_dwordx4 v4, s[24:27], s64 offen offset:3072 sc1 lds
v_mfma_f32_16x16x32_bf16 v[156:159], a[72:75], a[104:107], v[156:159]
v_mfma_f32_16x16x32_bf16 v[156:159], a[76:79], a[108:111], v[156:159]
v_mfma_f32_16x16x32_bf16 v[164:167], a[68:71], a[108:111], v[164:167]
v_mfma_f32_16x16x32_bf16 v[164:167], a[64:67], a[104:107], v[164:167]
v_mfma_f32_16x16x32_bf16 v[172:175], a[152:155], a[104:107], v[172:175]
s_add_u32 s53, s87, 790528
v_mfma_f32_16x16x32_bf16 v[172:175], a[156:159], a[108:111], v[172:175]
buffer_store_dwordx4 a[16:19], v4, s[24:27], s53 offen offset:0 sc1
v_mfma_f32_16x16x32_bf16 v[56:59], a[148:151], a[108:111], v[56:59]
v_mfma_f32_16x16x32_bf16 v[56:59], a[144:147], a[104:107], v[56:59]
v_mfma_f32_16x16x32_bf16 v[180:183], a[136:139], a[104:107], v[180:183]
v_mfma_f32_16x16x32_bf16 v[180:183], a[140:143], a[108:111], v[180:183]
v_mfma_f32_16x16x32_bf16 v[188:191], a[132:135], a[108:111], v[188:191]
v_mfma_f32_16x16x32_bf16 v[188:191], a[128:131], a[104:107], v[188:191]
s_waitcnt lgkmcnt(0)
v_mfma_f32_16x16x32_bf16 v[196:199], a[160:163], a[80:83], v[196:199]
s_waitcnt vmcnt(17)
v_mfma_f32_16x16x32_bf16 v[196:199], a[164:167], a[84:87], v[196:199]
s_barrier
v_mfma_f32_16x16x32_bf16 v[64:67], a[172:175], a[84:87], v[64:67]
ds_read_b64_tr_b16 a[128:129], v11 offset:0
ds_read_b64_tr_b16 a[130:131], v11 offset:512
v_mfma_f32_16x16x32_bf16 v[64:67], a[168:171], a[80:83], v[64:67]
s_add_u32 m0, s70, 49152
s_add_u32 s64, s68, 16384
s_waitcnt vmcnt(6)
v_mfma_f32_16x16x32_bf16 v[204:207], a[176:179], a[80:83], v[204:207]
buffer_load_dwordx4 v4, s[24:27], s64 offen offset:0 sc1 lds
v_mfma_f32_16x16x32_bf16 v[204:207], a[180:183], a[84:87], v[204:207]
ds_read_b64_tr_b16 a[132:133], v11 offset:4096
ds_read_b64_tr_b16 a[134:135], v11 offset:4608
v_mfma_f32_16x16x32_bf16 v[212:215], a[188:191], a[84:87], v[212:215]
ds_read_b64_tr_b16 a[136:137], v12 offset:0
ds_read_b64_tr_b16 a[138:139], v12 offset:512
v_mfma_f32_16x16x32_bf16 v[212:215], a[184:187], a[80:83], v[212:215]
ds_read_b64_tr_b16 a[140:141], v12 offset:4096
ds_read_b64_tr_b16 a[142:143], v12 offset:4608
v_mfma_f32_16x16x32_bf16 v[72:75], a[112:115], a[80:83], v[72:75]
ds_read_b64_tr_b16 a[192:193], v23 offset:0
ds_read_b64_tr_b16 a[194:195], v23 offset:2048
v_mfma_f32_16x16x32_bf16 v[72:75], a[116:119], a[84:87], v[72:75]
ds_read_b64_tr_b16 a[144:145], v13 offset:0
ds_read_b64_tr_b16 a[146:147], v13 offset:512
v_mfma_f32_16x16x32_bf16 v[220:223], a[124:127], a[84:87], v[220:223]
ds_read_b64_tr_b16 a[196:197], v23 offset:32
ds_read_b64_tr_b16 a[198:199], v23 offset:2080
v_mfma_f32_16x16x32_bf16 v[220:223], a[120:123], a[80:83], v[220:223]
ds_read_b64_tr_b16 a[148:149], v13 offset:4096
ds_read_b64_tr_b16 a[150:151], v13 offset:4608
v_mfma_f32_16x16x32_bf16 v[252:255], a[120:123], a[88:91], v[252:255]
ds_read_b64_tr_b16 a[200:201], v23 offset:64
ds_read_b64_tr_b16 a[202:203], v23 offset:2112
v_mfma_f32_16x16x32_bf16 v[252:255], a[124:127], a[92:95], v[252:255]
ds_read_b64_tr_b16 a[152:153], v14 offset:0
ds_read_b64_tr_b16 a[154:155], v14 offset:512
v_mfma_f32_16x16x32_bf16 v[160:163], a[116:119], a[92:95], v[160:163]
buffer_load_dwordx4 v4, s[24:27], s64 offen offset:1024 sc1 lds
v_mfma_f32_16x16x32_bf16 v[160:163], a[112:115], a[88:91], v[160:163]
ds_read_b64_tr_b16 a[156:157], v14 offset:4096
ds_read_b64_tr_b16 a[158:159], v14 offset:4608
v_mfma_f32_16x16x32_bf16 v[228:231], a[184:187], a[88:91], v[228:231]
ds_read_b64_tr_b16 a[204:205], v23 offset:96
ds_read_b64_tr_b16 a[206:207], v23 offset:2144
v_mfma_f32_16x16x32_bf16 v[228:231], a[188:191], a[92:95], v[228:231]
ds_read_b64_tr_b16 a[208:209], v27 offset:4096
ds_read_b64_tr_b16 a[210:211], v27 offset:4608
v_mfma_f32_16x16x32_bf16 v[168:171], a[180:183], a[92:95], v[168:171]
ds_read_b128 a[64:67], v4 offset:8192
v_mfma_f32_16x16x32_bf16 v[168:171], a[176:179], a[88:91], v[168:171]
s_add_u32 s53, s87, 790528
ds_read_b64_tr_b16 a[212:213], v27 offset:5120
ds_read_b64_tr_b16 a[214:215], v27 offset:5632
v_mfma_f32_16x16x32_bf16 v[176:179], a[168:171], a[88:91], v[176:179]
ds_read_b128 a[80:83], v9 offset:0
v_readlane_b32 s81, v26, 0
v_mfma_f32_16x16x32_bf16 v[176:179], a[172:175], a[92:95], v[176:179]
buffer_store_dwordx4 a[24:27], v4, s[24:27], s53 offen offset:1024 sc1
v_mfma_f32_16x16x32_bf16 v[80:83], a[164:167], a[92:95], v[80:83]
ds_read_b128 a[68:71], v4 offset:10240
v_readlane_b32 s82, v26, 1
v_mfma_f32_16x16x32_bf16 v[80:83], a[160:163], a[88:91], v[80:83]
v_readlane_b32 s71, v26, 2
v_readlane_b32 s72, v26, 3
v_mfma_f32_16x16x32_bf16 v[184:187], a[160:163], a[96:99], v[184:187]
ds_read_b128 a[84:87], v10 offset:0
v_readlane_b32 s74, v26, 4
v_mfma_f32_16x16x32_bf16 v[184:187], a[164:167], a[100:103], v[184:187]
buffer_load_dwordx4 v4, s[24:27], s64 offen offset:2048 sc1 lds
v_mfma_f32_16x16x32_bf16 v[248:251], a[172:175], a[100:103], v[248:251]
v_readlane_b32 s75, v26, 5
v_mfma_f32_16x16x32_bf16 v[248:251], a[168:171], a[96:99], v[248:251]
ds_read_b128 a[72:75], v4 offset:9216
v_mfma_f32_16x16x32_bf16 v[240:243], a[176:179], a[96:99], v[240:243]
v_mfma_f32_16x16x32_bf16 v[240:243], a[180:183], a[100:103], v[240:243]
ds_read_b128 a[88:91], v9 offset:2048
v_mfma_f32_16x16x32_bf16 v[232:235], a[188:191], a[100:103], v[232:235]
v_mfma_f32_16x16x32_bf16 v[232:235], a[184:187], a[96:99], v[232:235]
ds_read_b128 a[76:79], v4 offset:11264
v_mfma_f32_16x16x32_bf16 v[236:239], a[112:115], a[96:99], v[236:239]
v_mfma_f32_16x16x32_bf16 v[236:239], a[116:119], a[100:103], v[236:239]
ds_read_b128 a[92:95], v10 offset:2048
v_mfma_f32_16x16x32_bf16 v[224:227], a[124:127], a[100:103], v[224:227]
v_mfma_f32_16x16x32_bf16 v[224:227], a[120:123], a[96:99], v[224:227]
buffer_load_dwordx4 v4, s[24:27], s64 offen offset:3072 sc1 lds
v_mfma_f32_16x16x32_bf16 v[208:211], a[120:123], a[104:107], v[208:211]
v_mfma_f32_16x16x32_bf16 v[208:211], a[124:127], a[108:111], v[208:211]
v_mfma_f32_16x16x32_bf16 v[216:219], a[116:119], a[108:111], v[216:219]
v_mfma_f32_16x16x32_bf16 v[216:219], a[112:115], a[104:107], v[216:219]
v_mfma_f32_16x16x32_bf16 v[244:247], a[184:187], a[104:107], v[244:247]
v_mfma_f32_16x16x32_bf16 v[244:247], a[188:191], a[108:111], v[244:247]
v_mfma_f32_16x16x32_bf16 v[192:195], a[180:183], a[108:111], v[192:195]
v_mfma_f32_16x16x32_bf16 v[192:195], a[176:179], a[104:107], v[192:195]
v_mfma_f32_16x16x32_bf16 v[200:203], a[168:171], a[104:107], v[200:203]
v_mfma_f32_16x16x32_bf16 v[200:203], a[172:175], a[108:111], v[200:203]
v_mfma_f32_16x16x32_bf16 v[88:91], a[164:167], a[108:111], v[88:91]
v_mfma_f32_16x16x32_bf16 v[88:91], a[160:163], a[104:107], v[88:91]
s_waitcnt lgkmcnt(0)
v_mfma_f32_16x16x32_bf16 v[36:39], a[128:131], a[80:83], v[36:39]
s_waitcnt vmcnt(18)
v_mfma_f32_16x16x32_bf16 v[36:39], a[132:135], a[84:87], v[36:39]
s_barrier
v_mfma_f32_16x16x32_bf16 v[44:47], a[140:143], a[84:87], v[44:47]
ds_read_b128 a[96:99], v9 offset:4096
v_mfma_f32_16x16x32_bf16 v[44:47], a[136:139], a[80:83], v[44:47]
s_add_u32 m0, s70, 65536
s_add_u32 s64, s68, 32768
ds_read_b128 a[100:103], v10 offset:4096
v_mfma_f32_16x16x32_bf16 v[32:35], a[144:147], a[80:83], v[32:35]
buffer_load_dwordx4 v4, s[24:27], s64 offen offset:0 sc1 lds
v_mfma_f32_16x16x32_bf16 v[32:35], a[148:151], a[84:87], v[32:35]
ds_read_b128 a[104:107], v9 offset:6144
v_mfma_f32_16x16x32_bf16 v[52:55], a[156:159], a[84:87], v[52:55]
ds_read_b64_tr_b16 a[160:161], v11 offset:16384
ds_read_b64_tr_b16 a[162:163], v11 offset:16896
v_mfma_f32_16x16x32_bf16 v[52:55], a[152:155], a[80:83], v[52:55]
buffer_store_dwordx4 a[192:195], v4, s[24:27], s81 offen sc1
v_mfma_f32_16x16x32_bf16 v[60:63], a[64:67], a[80:83], v[60:63]
v_mfma_f32_16x16x32_bf16 v[60:63], a[68:71], a[84:87], v[60:63]
ds_read_b128 a[108:111], v10 offset:6144
v_mfma_f32_16x16x32_bf16 v[68:71], a[76:79], a[84:87], v[68:71]
v_cvt_pk_bf16_f32 v36, v36, v37
v_cvt_pk_bf16_f32 v37, v38, v39
v_mfma_f32_16x16x32_bf16 v[68:71], a[72:75], a[80:83], v[68:71]
ds_read_b64_tr_b16 a[164:165], v11 offset:20480
ds_read_b64_tr_b16 a[166:167], v11 offset:20992
v_mfma_f32_16x16x32_bf16 v[76:79], a[72:75], a[88:91], v[76:79]
buffer_store_dwordx4 a[196:199], v4, s[24:27], s82 offen sc1
v_mfma_f32_16x16x32_bf16 v[76:79], a[76:79], a[92:95], v[76:79]
ds_read_b64_tr_b16 a[168:169], v12 offset:16384
ds_read_b64_tr_b16 a[170:171], v12 offset:16896
v_mfma_f32_16x16x32_bf16 v[84:87], a[68:71], a[92:95], v[84:87]
buffer_load_dwordx4 v4, s[24:27], s64 offen offset:1024 sc1 lds
v_mfma_f32_16x16x32_bf16 v[84:87], a[64:67], a[88:91], v[84:87]
ds_read_b64_tr_b16 a[172:173], v12 offset:20480
ds_read_b64_tr_b16 a[174:175], v12 offset:20992
v_mfma_f32_16x16x32_bf16 v[92:95], a[152:155], a[88:91], v[92:95]
v_cvt_pk_bf16_f32 v38, v44, v45
v_cvt_pk_bf16_f32 v39, v46, v47
v_mfma_f32_16x16x32_bf16 v[92:95], a[156:159], a[92:95], v[92:95]
buffer_store_dwordx4 a[200:203], v4, s[24:27], s71 offen sc1
v_mfma_f32_16x16x32_bf16 v[40:43], a[148:151], a[92:95], v[40:43]
ds_read_b64_tr_b16 a[176:177], v13 offset:16384
ds_read_b64_tr_b16 a[178:179], v13 offset:16896
v_mfma_f32_16x16x32_bf16 v[40:43], a[144:147], a[88:91], v[40:43]
v_accvgpr_write_b32 a32, v36
v_accvgpr_write_b32 a33, v37
v_mfma_f32_16x16x32_bf16 v[100:103], a[136:139], a[88:91], v[100:103]
ds_read_b64_tr_b16 a[180:181], v13 offset:20480
ds_read_b64_tr_b16 a[182:183], v13 offset:20992
v_mfma_f32_16x16x32_bf16 v[100:103], a[140:143], a[92:95], v[100:103]
v_accvgpr_write_b32 a34, v38
v_accvgpr_write_b32 a35, v39
v_mfma_f32_16x16x32_bf16 v[108:111], a[132:135], a[92:95], v[108:111]
ds_read_b64_tr_b16 a[184:185], v14 offset:16384
ds_read_b64_tr_b16 a[186:187], v14 offset:16896
v_mfma_f32_16x16x32_bf16 v[108:111], a[128:131], a[88:91], v[108:111]
s_waitcnt lgkmcnt(15)
v_cvt_pk_bf16_f32 v32, v32, v33
v_cvt_pk_bf16_f32 v33, v34, v35
v_mfma_f32_16x16x32_bf16 v[116:119], a[128:131], a[96:99], v[116:119]
ds_read_b64_tr_b16 a[188:189], v14 offset:20480
ds_read_b64_tr_b16 a[190:191], v14 offset:20992
v_mfma_f32_16x16x32_bf16 v[116:119], a[132:135], a[100:103], v[116:119]
buffer_load_dwordx4 v4, s[24:27], s64 offen offset:2048 sc1 lds
v_mfma_f32_16x16x32_bf16 v[124:127], a[140:143], a[100:103], v[124:127]
buffer_store_dwordx4 a[204:207], v4, s[24:27], s72 offen sc1
v_mfma_f32_16x16x32_bf16 v[124:127], a[136:139], a[96:99], v[124:127]
ds_read_b128 a[112:115], v4 offset:24576
v_cvt_pk_bf16_f32 v34, v52, v53
v_mfma_f32_16x16x32_bf16 v[132:135], a[144:147], a[96:99], v[132:135]
v_cvt_pk_bf16_f32 v35, v54, v55
v_accvgpr_write_b32 a36, v32
v_mfma_f32_16x16x32_bf16 v[132:135], a[148:151], a[100:103], v[132:135]
ds_read_b128 a[116:119], v4 offset:26624
v_accvgpr_write_b32 a37, v33
v_mfma_f32_16x16x32_bf16 v[140:143], a[156:159], a[100:103], v[140:143]
v_accvgpr_write_b32 a38, v34
v_accvgpr_write_b32 a39, v35
v_mfma_f32_16x16x32_bf16 v[140:143], a[152:155], a[96:99], v[140:143]
ds_read_b128 a[120:123], v4 offset:25600
v_cvt_pk_bf16_f32 v40, v40, v41
v_mfma_f32_16x16x32_bf16 v[148:151], a[64:67], a[96:99], v[148:151]
buffer_store_dwordx4 a[208:211], v4, s[24:27], s74 offen sc1
v_mfma_f32_16x16x32_bf16 v[148:151], a[68:71], a[100:103], v[148:151]
ds_read_b128 a[124:127], v4 offset:27648
v_cvt_pk_bf16_f32 v41, v42, v43
v_mfma_f32_16x16x32_bf16 v[48:51], a[76:79], a[100:103], v[48:51]
s_waitcnt lgkmcnt(15)
v_cvt_pk_bf16_f32 v42, v92, v93
v_cvt_pk_bf16_f32 v43, v94, v95
v_mfma_f32_16x16x32_bf16 v[48:51], a[72:75], a[96:99], v[48:51]
buffer_load_dwordx4 v4, s[24:27], s64 offen offset:3072 sc1 lds
v_mfma_f32_16x16x32_bf16 v[156:159], a[72:75], a[104:107], v[156:159]
v_accvgpr_write_b32 a40, v40
v_accvgpr_write_b32 a41, v41
v_mfma_f32_16x16x32_bf16 v[156:159], a[76:79], a[108:111], v[156:159]
buffer_store_dwordx4 a[212:215], v4, s[24:27], s75 offen sc1
v_mfma_f32_16x16x32_bf16 v[164:167], a[68:71], a[108:111], v[164:167]
v_accvgpr_write_b32 a42, v42
v_accvgpr_write_b32 a43, v43
v_mfma_f32_16x16x32_bf16 v[164:167], a[64:67], a[104:107], v[164:167]
v_cvt_pk_bf16_f32 v108, v108, v109
v_cvt_pk_bf16_f32 v109, v110, v111
v_mfma_f32_16x16x32_bf16 v[172:175], a[152:155], a[104:107], v[172:175]
v_cvt_pk_bf16_f32 v110, v100, v101
v_cvt_pk_bf16_f32 v111, v102, v103
v_mfma_f32_16x16x32_bf16 v[172:175], a[156:159], a[108:111], v[172:175]
v_accvgpr_write_b32 a44, v108
v_accvgpr_write_b32 a45, v109
v_mfma_f32_16x16x32_bf16 v[56:59], a[148:151], a[108:111], v[56:59]
v_accvgpr_write_b32 a46, v110
v_accvgpr_write_b32 a47, v111
v_mfma_f32_16x16x32_bf16 v[56:59], a[144:147], a[104:107], v[56:59]
v_cvt_pk_bf16_f32 v116, v116, v117
v_cvt_pk_bf16_f32 v117, v118, v119
v_mfma_f32_16x16x32_bf16 v[180:183], a[136:139], a[104:107], v[180:183]
v_cvt_pk_bf16_f32 v118, v124, v125
v_cvt_pk_bf16_f32 v119, v126, v127
v_mfma_f32_16x16x32_bf16 v[180:183], a[140:143], a[108:111], v[180:183]
v_accvgpr_write_b32 a48, v116
v_accvgpr_write_b32 a49, v117
v_mfma_f32_16x16x32_bf16 v[188:191], a[132:135], a[108:111], v[188:191]
v_accvgpr_write_b32 a50, v118
v_accvgpr_write_b32 a51, v119
v_mfma_f32_16x16x32_bf16 v[188:191], a[128:131], a[104:107], v[188:191]
s_waitcnt lgkmcnt(0)
v_cvt_pk_bf16_f32 v132, v132, v133
v_cvt_pk_bf16_f32 v133, v134, v135
v_mfma_f32_16x16x32_bf16 v[196:199], a[160:163], a[80:83], v[196:199]
s_waitcnt vmcnt(16)
v_cvt_pk_bf16_f32 v134, v140, v141
v_cvt_pk_bf16_f32 v135, v142, v143
v_mfma_f32_16x16x32_bf16 v[196:199], a[164:167], a[84:87], v[196:199]
s_barrier
v_mfma_f32_16x16x32_bf16 v[64:67], a[172:175], a[84:87], v[64:67]
ds_read_b128 a[192:195], v4 offset:32768
v_accvgpr_write_b32 a52, v132
v_mfma_f32_16x16x32_bf16 v[64:67], a[168:171], a[80:83], v[64:67]
s_add_u32 m0, s70, 81920
s_add_u32 s64, s68, 49152
v_accvgpr_write_b32 a53, v133
v_mfma_f32_16x16x32_bf16 v[204:207], a[176:179], a[80:83], v[204:207]
buffer_load_dwordx4 v4, s[24:27], s64 offen offset:0 sc1 lds
v_mfma_f32_16x16x32_bf16 v[204:207], a[180:183], a[84:87], v[204:207]
ds_read_b128 a[196:199], v4 offset:33792
v_accvgpr_write_b32 a54, v134
v_mfma_f32_16x16x32_bf16 v[212:215], a[188:191], a[84:87], v[212:215]
v_accvgpr_write_b32 a55, v135
v_cvt_pk_bf16_f32 v56, v56, v57
v_mfma_f32_16x16x32_bf16 v[212:215], a[184:187], a[80:83], v[212:215]
ds_read_b128 a[200:203], v4 offset:34816
v_cvt_pk_bf16_f32 v57, v58, v59
v_mfma_f32_16x16x32_bf16 v[80:83], a[160:163], a[88:91], v[80:83]
v_cvt_pk_bf16_f32 v58, v172, v173
v_cvt_pk_bf16_f32 v59, v174, v175
v_mfma_f32_16x16x32_bf16 v[80:83], a[164:167], a[92:95], v[80:83]
ds_read_b128 a[204:207], v4 offset:35840
v_accvgpr_write_b32 a56, v56
v_mfma_f32_16x16x32_bf16 v[176:179], a[172:175], a[92:95], v[176:179]
v_accvgpr_write_b32 a57, v57
v_accvgpr_write_b32 a58, v58
v_mfma_f32_16x16x32_bf16 v[176:179], a[168:171], a[88:91], v[176:179]
ds_read_b128 a[208:211], v4 offset:36864
v_accvgpr_write_b32 a59, v59
v_mfma_f32_16x16x32_bf16 v[168:171], a[176:179], a[88:91], v[168:171]
v_cvt_pk_bf16_f32 v188, v188, v189
v_cvt_pk_bf16_f32 v189, v190, v191
v_mfma_f32_16x16x32_bf16 v[168:171], a[180:183], a[92:95], v[168:171]
ds_read_b128 a[212:215], v4 offset:37888
v_cvt_pk_bf16_f32 v190, v180, v181
v_mfma_f32_16x16x32_bf16 v[228:231], a[188:191], a[92:95], v[228:231]
buffer_load_dwordx4 v4, s[24:27], s64 offen offset:1024 sc1 lds
v_mfma_f32_16x16x32_bf16 v[228:231], a[184:187], a[88:91], v[228:231]
ds_read_b128 a[216:219], v4 offset:38912
v_cvt_pk_bf16_f32 v191, v182, v183
v_mfma_f32_16x16x32_bf16 v[184:187], a[160:163], a[96:99], v[184:187]
v_accvgpr_write_b32 a60, v188
v_accvgpr_write_b32 a61, v189
v_mfma_f32_16x16x32_bf16 v[184:187], a[164:167], a[100:103], v[184:187]
ds_read_b128 a[220:223], v4 offset:39936
v_accvgpr_write_b32 a62, v190
v_mfma_f32_16x16x32_bf16 v[248:251], a[172:175], a[100:103], v[248:251]
v_accvgpr_write_b32 a63, v191
v_cvt_pk_bf16_f32 v196, v196, v197
v_mfma_f32_16x16x32_bf16 v[248:251], a[168:171], a[96:99], v[248:251]
v_cvt_pk_bf16_f32 v197, v198, v199
v_cvt_pk_bf16_f32 v198, v64, v65
v_mfma_f32_16x16x32_bf16 v[240:243], a[176:179], a[96:99], v[240:243]
v_cvt_pk_bf16_f32 v199, v66, v67
v_accvgpr_write_b32 a28, v196
v_mfma_f32_16x16x32_bf16 v[240:243], a[180:183], a[100:103], v[240:243]
v_accvgpr_write_b32 a29, v197
v_accvgpr_write_b32 a30, v198
v_mfma_f32_16x16x32_bf16 v[232:235], a[188:191], a[100:103], v[232:235]
v_accvgpr_write_b32 a31, v199
v_cvt_pk_bf16_f32 v204, v204, v205
v_mfma_f32_16x16x32_bf16 v[232:235], a[184:187], a[96:99], v[232:235]
v_cvt_pk_bf16_f32 v205, v206, v207
v_cvt_pk_bf16_f32 v206, v212, v213
v_mfma_f32_16x16x32_bf16 v[88:91], a[160:163], a[104:107], v[88:91]
v_cvt_pk_bf16_f32 v207, v214, v215
v_accvgpr_write_b32 a20, v204
v_mfma_f32_16x16x32_bf16 v[88:91], a[164:167], a[108:111], v[88:91]
buffer_load_dwordx4 v4, s[24:27], s64 offen offset:2048 sc1 lds
v_mfma_f32_16x16x32_bf16 v[200:203], a[172:175], a[108:111], v[200:203]
v_accvgpr_write_b32 a21, v205
v_accvgpr_write_b32 a22, v206
v_mfma_f32_16x16x32_bf16 v[200:203], a[168:171], a[104:107], v[200:203]
v_accvgpr_write_b32 a23, v207
v_cvt_pk_bf16_f32 v80, v80, v81
v_mfma_f32_16x16x32_bf16 v[192:195], a[176:179], a[104:107], v[192:195]
v_cvt_pk_bf16_f32 v81, v82, v83
v_cvt_pk_bf16_f32 v82, v176, v177
v_mfma_f32_16x16x32_bf16 v[192:195], a[180:183], a[108:111], v[192:195]
v_cvt_pk_bf16_f32 v83, v178, v179
v_accvgpr_write_b32 a12, v80
v_mfma_f32_16x16x32_bf16 v[244:247], a[188:191], a[108:111], v[244:247]
v_accvgpr_write_b32 a13, v81
v_accvgpr_write_b32 a14, v82
v_mfma_f32_16x16x32_bf16 v[244:247], a[184:187], a[104:107], v[244:247]
v_accvgpr_write_b32 a15, v83
v_cvt_pk_bf16_f32 v168, v168, v169
v_mfma_f32_16x16x32_bf16 v[72:75], a[112:115], a[80:83], v[72:75]
v_cvt_pk_bf16_f32 v169, v170, v171
v_cvt_pk_bf16_f32 v170, v228, v229
v_mfma_f32_16x16x32_bf16 v[72:75], a[116:119], a[84:87], v[72:75]
v_cvt_pk_bf16_f32 v171, v230, v231
v_accvgpr_write_b32 a4, v168
v_mfma_f32_16x16x32_bf16 v[220:223], a[124:127], a[84:87], v[220:223]
v_accvgpr_write_b32 a5, v169
v_accvgpr_write_b32 a6, v170
v_mfma_f32_16x16x32_bf16 v[220:223], a[120:123], a[80:83], v[220:223]
buffer_load_dwordx4 v4, s[24:27], s64 offen offset:3072 sc1 lds
v_mfma_f32_16x16x32_bf16 v[160:163], a[112:115], a[88:91], v[160:163]
v_accvgpr_write_b32 a7, v171
v_cvt_pk_bf16_f32 v184, v184, v185
v_mfma_f32_16x16x32_bf16 v[160:163], a[116:119], a[92:95], v[160:163]
v_cvt_pk_bf16_f32 v185, v186, v187
v_cvt_pk_bf16_f32 v186, v248, v249
v_mfma_f32_16x16x32_bf16 v[252:255], a[124:127], a[92:95], v[252:255]
v_cvt_pk_bf16_f32 v187, v250, v251
v_accvgpr_write_b32 a0, v184
v_mfma_f32_16x16x32_bf16 v[252:255], a[120:123], a[88:91], v[252:255]
v_accvgpr_write_b32 a1, v185
v_accvgpr_write_b32 a2, v186
v_mfma_f32_16x16x32_bf16 v[236:239], a[112:115], a[96:99], v[236:239]
v_accvgpr_write_b32 a3, v187
v_cvt_pk_bf16_f32 v240, v240, v241
v_mfma_f32_16x16x32_bf16 v[236:239], a[116:119], a[100:103], v[236:239]
v_cvt_pk_bf16_f32 v241, v242, v243
v_cvt_pk_bf16_f32 v242, v232, v233
v_mfma_f32_16x16x32_bf16 v[224:227], a[124:127], a[100:103], v[224:227]
v_cvt_pk_bf16_f32 v243, v234, v235
v_accvgpr_write_b32 a8, v240
v_mfma_f32_16x16x32_bf16 v[224:227], a[120:123], a[96:99], v[224:227]
v_accvgpr_write_b32 a9, v241
v_accvgpr_write_b32 a10, v242
v_mfma_f32_16x16x32_bf16 v[216:219], a[112:115], a[104:107], v[216:219]
v_accvgpr_write_b32 a11, v243
v_cvt_pk_bf16_f32 v88, v88, v89
v_mfma_f32_16x16x32_bf16 v[216:219], a[116:119], a[108:111], v[216:219]
v_cvt_pk_bf16_f32 v89, v90, v91
v_cvt_pk_bf16_f32 v90, v200, v201
v_mfma_f32_16x16x32_bf16 v[208:211], a[124:127], a[108:111], v[208:211]
v_cvt_pk_bf16_f32 v91, v202, v203
v_accvgpr_write_b32 a16, v88
v_mfma_f32_16x16x32_bf16 v[208:211], a[120:123], a[104:107], v[208:211]
s_waitcnt lgkmcnt(0)
v_accvgpr_write_b32 a17, v89
v_accvgpr_write_b32 a18, v90
v_mfma_f32_16x16x32_bf16 v[44:47], a[192:195], a[32:35], v[96:99]
v_accvgpr_write_b32 a19, v91
v_cvt_pk_bf16_f32 v192, v192, v193
v_mfma_f32_16x16x32_bf16 v[44:47], a[196:199], a[36:39], v[44:47]
v_cvt_pk_bf16_f32 v193, v194, v195
v_cvt_pk_bf16_f32 v194, v244, v245
v_mfma_f32_16x16x32_bf16 v[44:47], a[200:203], a[28:31], v[44:47]
v_cvt_pk_bf16_f32 v195, v246, v247
v_accvgpr_write_b32 a24, v192
v_mfma_f32_16x16x32_bf16 v[44:47], a[204:207], a[20:23], v[44:47]
v_accvgpr_write_b32 a25, v193
v_accvgpr_write_b32 a26, v194
v_mfma_f32_16x16x32_bf16 v[52:55], a[192:195], a[44:47], v[104:107]
ds_bpermute_b32 v8, v17, v63
v_accvgpr_write_b32 a27, v195
v_mfma_f32_16x16x32_bf16 v[52:55], a[196:199], a[40:43], v[52:55]
v_cvt_pk_bf16_f32 v60, v60, v61
v_cvt_pk_bf16_f32 v61, v62, v63
v_mfma_f32_16x16x32_bf16 v[52:55], a[200:203], a[12:15], v[52:55]
v_cvt_pk_bf16_f32 v62, v68, v69
v_cvt_pk_bf16_f32 v63, v70, v71
v_mfma_f32_16x16x32_bf16 v[52:55], a[204:207], a[4:7], v[52:55]
v_accvgpr_write_b32 a128, v60
v_accvgpr_write_b32 a129, v61
v_mfma_f32_16x16x32_bf16 v[64:67], a[208:211], a[32:35], v[112:115]
v_accvgpr_write_b32 a130, v62
v_accvgpr_write_b32 a131, v63
v_mfma_f32_16x16x32_bf16 v[64:67], a[212:215], a[36:39], v[64:67]
ds_bpermute_b32 v9, v17, v87
v_cvt_pk_bf16_f32 v84, v84, v85
v_mfma_f32_16x16x32_bf16 v[64:67], a[216:219], a[28:31], v[64:67]
v_cvt_pk_bf16_f32 v85, v86, v87
v_cvt_pk_bf16_f32 v86, v76, v77
v_mfma_f32_16x16x32_bf16 v[64:67], a[220:223], a[20:23], v[64:67]
v_cvt_pk_bf16_f32 v87, v78, v79
v_mfma_f32_16x16x32_bf16 v[212:215], a[208:211], a[44:47], v[120:123]
buffer_store_dwordx4 v[84:87], v18, s[24:27], s54 offen offset:256 sc1
v_mfma_f32_16x16x32_bf16 v[212:215], a[212:215], a[40:43], v[212:215]
v_accvgpr_write_b32 a136, v84
v_accvgpr_write_b32 a137, v85
v_mfma_f32_16x16x32_bf16 v[212:215], a[216:219], a[12:15], v[212:215]
v_accvgpr_write_b32 a138, v86
v_accvgpr_write_b32 a139, v87
v_mfma_f32_16x16x32_bf16 v[212:215], a[220:223], a[4:7], v[212:215]
s_waitcnt vmcnt(15)
ds_bpermute_b32 v10, v17, v151
v_cvt_pk_bf16_f32 v148, v148, v149
v_mfma_f32_16x16x32_bf16 v[100:103], a[192:195], a[48:51], v[128:131]
s_barrier
v_cvt_pk_bf16_f32 v149, v150, v151
v_cvt_pk_bf16_f32 v150, v48, v49
v_mfma_f32_16x16x32_bf16 v[100:103], a[196:199], a[52:55], v[100:103]
v_cvt_pk_bf16_f32 v151, v50, v51
v_accvgpr_write_b32 a144, v148
v_mfma_f32_16x16x32_bf16 v[100:103], a[200:203], a[0:3], v[100:103]
ds_bpermute_b32 v11, v17, v167
v_accvgpr_write_b32 a145, v149
v_mfma_f32_16x16x32_bf16 v[100:103], a[204:207], a[8:11], v[100:103]
v_cvt_pk_bf16_f32 v164, v164, v165
v_cvt_pk_bf16_f32 v165, v166, v167
v_mfma_f32_16x16x32_bf16 v[92:95], a[192:195], a[60:63], v[136:139]
v_cvt_pk_bf16_f32 v166, v156, v157
v_cvt_pk_bf16_f32 v167, v158, v159
v_mfma_f32_16x16x32_bf16 v[92:95], a[196:199], a[56:59], v[92:95]
buffer_store_dwordx4 v[164:167], v18, s[24:27], s55 offen offset:256 sc1
v_mfma_f32_16x16x32_bf16 v[92:95], a[200:203], a[16:19], v[92:95]
v_cvt_pk_bf16_f32 v72, v72, v73
v_cvt_pk_bf16_f32 v73, v74, v75
v_mfma_f32_16x16x32_bf16 v[92:95], a[204:207], a[24:27], v[92:95]
v_cvt_pk_bf16_f32 v74, v220, v221
v_cvt_pk_bf16_f32 v75, v222, v223
v_mfma_f32_16x16x32_bf16 v[176:179], a[208:211], a[48:51], v[144:147]
v_cvt_pk_bf16_f32 v160, v160, v161
v_cvt_pk_bf16_f32 v161, v162, v163
v_mfma_f32_16x16x32_bf16 v[176:179], a[212:215], a[52:55], v[176:179]
L_PAD8:
s_cbranch_execz L_PAD12
v_cvt_pk_bf16_f32 v162, v252, v253
v_cvt_pk_bf16_f32 v163, v254, v255
v_mfma_f32_16x16x32_bf16 v[176:179], a[216:219], a[0:3], v[176:179]
buffer_store_dwordx4 v[160:163], v19, s[24:27], s54 offen offset:256 sc1
v_mfma_f32_16x16x32_bf16 v[176:179], a[220:223], a[8:11], v[176:179]
v_cvt_pk_bf16_f32 v236, v236, v237
v_cvt_pk_bf16_f32 v237, v238, v239
v_mfma_f32_16x16x32_bf16 v[228:231], a[208:211], a[60:63], v[152:155]
v_cvt_pk_bf16_f32 v238, v224, v225
v_cvt_pk_bf16_f32 v239, v226, v227
v_mfma_f32_16x16x32_bf16 v[228:231], a[212:215], a[56:59], v[228:231]
v_cvt_pk_bf16_f32 v216, v216, v217
v_cvt_pk_bf16_f32 v217, v218, v219
v_mfma_f32_16x16x32_bf16 v[228:231], a[216:219], a[16:19], v[228:231]
v_cvt_pk_bf16_f32 v218, v208, v209
v_cvt_pk_bf16_f32 v219, v210, v211
v_mfma_f32_16x16x32_bf16 v[228:231], a[220:223], a[24:27], v[228:231]
buffer_store_dwordx4 v[216:219], v19, s[24:27], s55 offen offset:256 sc1
ds_read_b128 a[64:67], v4 offset:57344
ds_read_b128 a[68:71], v4 offset:58368
ds_read_b128 a[72:75], v4 offset:59392
ds_read_b128 a[76:79], v4 offset:60416
ds_read_b128 a[80:83], v4 offset:61440
ds_read_b128 a[84:87], v4 offset:62464
ds_read_b128 a[88:91], v4 offset:63488
ds_read_b128 a[92:95], v4 offset:64512
s_add_u32 m0, s70, 98304
s_add_u32 s64, s68, 65536
buffer_load_dwordx4 v4, s[24:27], s64 offen offset:0 sc1 lds
v_max3_f32 v24, v44, v45, v46
v_max3_f32 v25, v47, v64, v65
v_max3_f32 v26, v52, v53, v54
v_max3_f32 v27, v55, v212, v213
v_max3_f32 v24, v24, v66, v67
v_max_f32 v24, v24, v25
buffer_load_dwordx4 v4, s[24:27], s64 offen offset:1024 sc1 lds
v_max3_f32 v26, v26, v214, v215
v_max_f32 v26, v26, v27
v_mov_b32 v25, v24
v_mov_b32 v27, v26
s_nop 1
v_permlane32_swap_b32 v25, v24
buffer_load_dwordx4 v4, s[24:27], s64 offen offset:2048 sc1 lds
v_permlane32_swap_b32 v27, v26
s_nop 0
v_max_f32 v24, v24, v25
v_max_f32 v26, v26, v27
v_mov_b32 v25, v24
v_mov_b32 v27, v26
buffer_load_dwordx4 v4, s[24:27], s64 offen offset:3072 sc1 lds
s_nop 1
v_permlane16_swap_b32 v25, v24
v_permlane16_swap_b32 v27, v26
s_nop 0
v_max_f32 v24, v24, v25
v_max_f32 v26, v26, v27
s_add_u32 m0, s70, 114688
s_add_u32 s64, s68, 81920
buffer_load_dwordx4 v4, s[24:27], s64 offen offset:0 sc1 lds
v_pk_add_f32 v[44:45], v[44:45], v[24:25] op_sel_hi:[1,0] neg_lo:[0,1] neg_hi:[0,1]
v_pk_add_f32 v[46:47], v[46:47], v[24:25] op_sel_hi:[1,0] neg_lo:[0,1] neg_hi:[0,1]
v_pk_add_f32 v[52:53], v[52:53], v[26:27] op_sel_hi:[1,0] neg_lo:[0,1] neg_hi:[0,1]
v_pk_add_f32 v[54:55], v[54:55], v[26:27] op_sel_hi:[1,0] neg_lo:[0,1] neg_hi:[0,1]
v_pk_add_f32 v[64:65], v[64:65], v[24:25] op_sel_hi:[1,0] neg_lo:[0,1] neg_hi:[0,1]
v_pk_add_f32 v[66:67], v[66:67], v[24:25] op_sel_hi:[1,0] neg_lo:[0,1] neg_hi:[0,1]
buffer_load_dwordx4 v4, s[24:27], s64 offen offset:1024 sc1 lds
v_pk_add_f32 v[212:213], v[212:213], v[26:27] op_sel_hi:[1,0] neg_lo:[0,1] neg_hi:[0,1]
v_pk_add_f32 v[214:215], v[214:215], v[26:27] op_sel_hi:[1,0] neg_lo:[0,1] neg_hi:[0,1]
v_pk_add_f32 v[96:97], v[96:97], v[24:25] op_sel_hi:[1,0] neg_lo:[0,1] neg_hi:[0,1]
v_pk_add_f32 v[98:99], v[98:99], v[24:25] op_sel_hi:[1,0] neg_lo:[0,1] neg_hi:[0,1]
v_pk_add_f32 v[104:105], v[104:105], v[26:27] op_sel_hi:[1,0] neg_lo:[0,1] neg_hi:[0,1]
v_pk_add_f32 v[106:107], v[106:107], v[26:27] op_sel_hi:[1,0] neg_lo:[0,1] neg_hi:[0,1]
buffer_load_dwordx4 v4, s[24:27], s64 offen offset:2048 sc1 lds
v_pk_add_f32 v[112:113], v[112:113], v[24:25] op_sel_hi:[1,0] neg_lo:[0,1] neg_hi:[0,1]
v_pk_add_f32 v[114:115], v[114:115], v[24:25] op_sel_hi:[1,0] neg_lo:[0,1] neg_hi:[0,1]
v_pk_add_f32 v[120:121], v[120:121], v[26:27] op_sel_hi:[1,0] neg_lo:[0,1] neg_hi:[0,1]
v_pk_add_f32 v[122:123], v[122:123], v[26:27] op_sel_hi:[1,0] neg_lo:[0,1] neg_hi:[0,1]
v_exp_f32 v44, v44
v_exp_f32 v45, v45
buffer_load_dwordx4 v4, s[24:27], s64 offen offset:3072 sc1 lds
v_exp_f32 v46, v46
v_exp_f32 v47, v47
v_cvt_pk_bf16_f32 v124, v44, v45
v_exp_f32 v52, v52
v_exp_f32 v53, v53
v_cvt_pk_bf16_f32 v125, v46, v47
s_add_u32 m0, s70, 131072
s_add_u32 s64, s68, 98304
s_cmp_ge_u32 s3, 1
s_cselect_b32 s64, s64, 2147418112
buffer_load_dwordx4 v4, s[24:27], s64 offen offset:0 sc1 lds
v_exp_f32 v54, v54
v_exp_f32 v55, v55
v_cvt_pk_bf16_f32 v140, v52, v53
v_exp_f32 v64, v64
v_exp_f32 v65, v65
v_cvt_pk_bf16_f32 v141, v54, v55
buffer_load_dwordx4 v4, s[24:27], s64 offen offset:1024 sc1 lds
v_exp_f32 v66, v66
v_exp_f32 v67, v67
v_cvt_pk_bf16_f32 v126, v64, v65
v_exp_f32 v212, v212
v_exp_f32 v213, v213
v_cvt_pk_bf16_f32 v127, v66, v67
buffer_load_dwordx4 v4, s[24:27], s64 offen offset:2048 sc1 lds
v_exp_f32 v214, v214
v_exp_f32 v215, v215
v_cvt_pk_bf16_f32 v142, v212, v213
v_max3_f32 v24, v100, v101, v102
v_cvt_pk_bf16_f32 v143, v214, v215
v_max3_f32 v25, v103, v176, v177
buffer_load_dwordx4 v4, s[24:27], s64 offen offset:3072 sc1 lds
v_max3_f32 v26, v92, v93, v94
v_max3_f32 v27, v95, v228, v229
v_max3_f32 v24, v24, v178, v179
v_max_f32 v24, v24, v25
v_max3_f32 v26, v26, v230, v231
v_max_f32 v26, v26, v27
s_add_u32 m0, s70, 147456
s_add_u32 s64, s68, 114688
s_cmp_ge_u32 s3, 2
s_cselect_b32 s64, s64, 2147418112
buffer_load_dwordx4 v4, s[24:27], s64 offen offset:0 sc1 lds
v_mov_b32 v25, v24
v_mov_b32 v27, v26
s_nop 1
v_permlane32_swap_b32 v25, v24
v_permlane32_swap_b32 v27, v26
s_nop 0
buffer_load_dwordx4 v4, s[24:27], s64 offen offset:1024 sc1 lds
v_max_f32 v24, v24, v25
v_max_f32 v26, v26, v27
v_mov_b32 v25, v24
v_mov_b32 v27, v26
s_nop 1
v_permlane16_swap_b32 v25, v24
buffer_load_dwordx4 v4, s[24:27], s64 offen offset:2048 sc1 lds
v_permlane16_swap_b32 v27, v26
s_nop 0
v_max_f32 v24, v24, v25
v_max_f32 v26, v26, v27
v_pk_add_f32 v[100:101], v[100:101], v[24:25] op_sel_hi:[1,0] neg_lo:[0,1] neg_hi:[0,1]
v_pk_add_f32 v[102:103], v[102:103], v[24:25] op_sel_hi:[1,0] neg_lo:[0,1] neg_hi:[0,1]
buffer_load_dwordx4 v4, s[24:27], s64 offen offset:3072 sc1 lds
v_pk_add_f32 v[92:93], v[92:93], v[26:27] op_sel_hi:[1,0] neg_lo:[0,1] neg_hi:[0,1]
v_pk_add_f32 v[94:95], v[94:95], v[26:27] op_sel_hi:[1,0] neg_lo:[0,1] neg_hi:[0,1]
v_pk_add_f32 v[176:177], v[176:177], v[24:25] op_sel_hi:[1,0] neg_lo:[0,1] neg_hi:[0,1]
v_pk_add_f32 v[178:179], v[178:179], v[24:25] op_sel_hi:[1,0] neg_lo:[0,1] neg_hi:[0,1]
v_pk_add_f32 v[228:229], v[228:229], v[26:27] op_sel_hi:[1,0] neg_lo:[0,1] neg_hi:[0,1]
v_pk_add_f32 v[230:231], v[230:231], v[26:27] op_sel_hi:[1,0] neg_lo:[0,1] neg_hi:[0,1]
s_add_u32 m0, s70, 0
s_add_u32 s64, s68, 131072
s_cmp_ge_u32 s3, 3
s_cselect_b32 s64, s64, 2147418112
buffer_load_dwordx4 v4, s[24:27], s64 offen offset:0 sc1 lds
v_pk_add_f32 v[128:129], v[128:129], v[24:25] op_sel_hi:[1,0] neg_lo:[0,1] neg_hi:[0,1]
v_pk_add_f32 v[130:131], v[130:131], v[24:25] op_sel_hi:[1,0] neg_lo:[0,1] neg_hi:[0,1]
v_pk_add_f32 v[136:137], v[136:137], v[26:27] op_sel_hi:[1,0] neg_lo:[0,1] neg_hi:[0,1]
v_pk_add_f32 v[138:139], v[138:139], v[26:27] op_sel_hi:[1,0] neg_lo:[0,1] neg_hi:[0,1]
v_pk_add_f32 v[144:145], v[144:145], v[24:25] op_sel_hi:[1,0] neg_lo:[0,1] neg_hi:[0,1]
v_pk_add_f32 v[146:147], v[146:147], v[24:25] op_sel_hi:[1,0] neg_lo:[0,1] neg_hi:[0,1]
buffer_load_dwordx4 v4, s[24:27], s64 offen offset:1024 sc1 lds
v_pk_add_f32 v[152:153], v[152:153], v[26:27] op_sel_hi:[1,0] neg_lo:[0,1] neg_hi:[0,1]
v_pk_add_f32 v[154:155], v[154:155], v[26:27] op_sel_hi:[1,0] neg_lo:[0,1] neg_hi:[0,1]
v_accvgpr_write_b32 a146, v150
v_accvgpr_write_b32 a147, v151
v_accvgpr_write_b32 a152, v164
v_accvgpr_write_b32 a153, v165
buffer_load_dwordx4 v4, s[24:27], s64 offen offset:2048 sc1 lds
v_accvgpr_write_b32 a154, v166
v_accvgpr_write_b32 a155, v167
v_accvgpr_write_b32 a132, v72
v_accvgpr_write_b32 a133, v73
v_accvgpr_write_b32 a134, v74
v_accvgpr_write_b32 a135, v75
buffer_load_dwordx4 v4, s[24:27], s64 offen offset:3072 sc1 lds
v_accvgpr_write_b32 a140, v160
v_accvgpr_write_b32 a141, v161
v_accvgpr_write_b32 a142, v162
v_accvgpr_write_b32 a143, v163
v_accvgpr_write_b32 a148, v236
v_accvgpr_write_b32 a149, v237
v_accvgpr_write_b32 a150, v238
v_accvgpr_write_b32 a151, v239
v_accvgpr_write_b32 a156, v216
v_accvgpr_write_b32 a157, v217
v_accvgpr_write_b32 a158, v218
v_accvgpr_write_b32 a159, v219
v_mov_b64 v[60:61], 0
v_mov_b64 v[62:63], 0
v_mov_b64 v[68:69], 0
v_mov_b64 v[70:71], 0
v_mov_b64 v[72:73], 0
v_mov_b64 v[74:75], 0
v_mov_b64 v[220:221], 0
v_mov_b64 v[222:223], 0
v_mov_b64 v[84:85], 0
v_mov_b64 v[86:87], 0
v_mov_b64 v[76:77], 0
v_mov_b64 v[78:79], 0
v_mov_b64 v[160:161], 0
v_mov_b64 v[162:163], 0
v_mov_b64 v[252:253], 0
v_mov_b64 v[254:255], 0
v_mov_b64 v[148:149], 0
v_mov_b64 v[150:151], 0
v_mov_b64 v[48:49], 0
v_mov_b64 v[50:51], 0
v_mov_b64 v[236:237], 0
v_mov_b64 v[238:239], 0
v_mov_b64 v[224:225], 0
v_mov_b64 v[226:227], 0
v_mov_b64 v[164:165], 0
v_mov_b64 v[166:167], 0
v_mov_b64 v[156:157], 0
v_mov_b64 v[158:159], 0
v_mov_b64 v[216:217], 0
v_mov_b64 v[218:219], 0
v_mov_b64 v[208:209], 0
v_mov_b64 v[210:211], 0
ds_read_b128 a[192:195], v4 offset:49152
ds_read_b128 a[196:199], v4 offset:50176
ds_read_b128 a[200:203], v4 offset:51200
ds_read_b128 a[204:207], v4 offset:52224
ds_read_b128 a[208:211], v4 offset:53248
ds_read_b128 a[212:215], v4 offset:54272
ds_read_b128 a[216:219], v4 offset:55296
ds_read_b128 a[220:223], v4 offset:56320
s_waitcnt lgkmcnt(8)
s_lshl2_add_u32 s77, s86, s84
s_mul_i32 s77, s77, 344064
s_mov_b32 s80, s70
s_cmp_lt_u32 s3, 2
s_cselect_b32 s53, 8, -2
s_add_u32 s53, s53, s3
v_mfma_f32_16x16x32_bf16 v[36:39], a[64:67], v[124:127], 0
s_mul_i32 s52, s5, 65536
v_exp_f32 v100, v100
v_mfma_f32_16x16x32_bf16 v[116:119], a[64:67], v[140:143], 0
s_sub_u32 s52, 1064960, s52
v_exp_f32 v101, v101
v_mfma_f32_16x16x32_bf16 v[132:135], a[68:71], v[140:143], 0
s_add_u32 s71, s68, s52
v_exp_f32 v102, v102
v_mfma_f32_16x16x32_bf16 v[32:35], a[68:71], v[124:127], 0
s_add_u32 s77, s77, s80
v_exp_f32 v103, v103
v_mfma_f32_16x16x32_bf16 v[196:199], a[72:75], v[124:127], 0
s_add_u32 s77, s77, 38797312
v_cvt_pk_bf16_f32 v248, v100, v101
v_cvt_pk_bf16_f32 v249, v102, v103
v_mfma_f32_16x16x32_bf16 v[184:187], a[72:75], v[140:143], 0
s_add_u32 s52, s3, 6
v_exp_f32 v92, v92
v_mfma_f32_16x16x32_bf16 v[240:243], a[76:79], v[140:143], 0
s_mul_i32 s52, s52, 16384
v_exp_f32 v93, v93
v_mfma_f32_16x16x32_bf16 v[204:207], a[76:79], v[124:127], 0
s_add_u32 s68, s68, s52
v_exp_f32 v94, v94
v_mfma_f32_16x16x32_bf16 v[108:111], a[80:83], v[124:127], 0
s_lshl_b32 s53, s53, 14
v_exp_f32 v95, v95
v_mfma_f32_16x16x32_bf16 v[188:191], a[80:83], v[140:143], 0
s_add_u32 s70, s70, s53
v_cvt_pk_bf16_f32 v232, v92, v93
v_cvt_pk_bf16_f32 v233, v94, v95
v_mfma_f32_16x16x32_bf16 v[56:59], a[84:87], v[140:143], 0
s_mov_b32 s75, 65536
v_exp_f32 v176, v176
v_mfma_f32_16x16x32_bf16 v[40:43], a[84:87], v[124:127], 0
s_mov_b32 s72, 1
v_exp_f32 v177, v177
v_mfma_f32_16x16x32_bf16 v[80:83], a[88:91], v[124:127], 0
s_mov_b32 s73, 3
v_exp_f32 v178, v178
v_mfma_f32_16x16x32_bf16 v[88:91], a[88:91], v[140:143], 0
s_lshl2_add_u32 s69, s5, 4
v_exp_f32 v179, v179
v_mfma_f32_16x16x32_bf16 v[192:195], a[92:95], v[140:143], 0
s_max_u32 s69, s69, 12
v_cvt_pk_bf16_f32 v250, v176, v177
v_cvt_pk_bf16_f32 v251, v178, v179
v_mfma_f32_16x16x32_bf16 v[168:171], a[92:95], v[124:127], 0
s_min_u32 s74, s73, s66
v_exp_f32 v228, v228
v_mfma_f32_16x16x32_bf16 a[224:227], a[240:243], v[124:127], 0
s_mov_b32 s93, 3
v_mfma_f32_16x16x32_bf16 a[228:231], a[240:243], v[140:143], 0
s_cmp_lt_u32 s66, 2
s_waitcnt vmcnt(24) lgkmcnt(0)
s_cbranch_scc1 L_NE
L_DUAL:
v_mfma_f32_16x16x32_bf16 v[44:47], a[192:195], a[32:35], v[96:99]
s_barrier
v_mfma_f32_16x16x32_bf16 v[44:47], a[196:199], a[36:39], v[44:47]
s_cmp_eq_u32 s68, s71
v_exp_f32 v229, v229
v_mfma_f32_16x16x32_bf16 v[44:47], a[200:203], a[28:31], v[44:47]
s_cselect_b32 s64, s77, s68
v_add_u32 v5, s75, v4
v_cvt_pk_bf16_f32 v234, v228, v229
v_mfma_f32_16x16x32_bf16 v[44:47], a[204:207], a[20:23], v[44:47]
s_mov_b32 m0, s70
v_exp_f32 v230, v230
v_mfma_f32_16x16x32_bf16 v[52:55], a[192:195], a[44:47], v[104:107]
buffer_load_dwordx4 v4, s[24:27], s64 offen offset:0 sc1 lds
v_mfma_f32_16x16x32_bf16 v[52:55], a[196:199], a[40:43], v[52:55]
s_add_u32 s75, s75, 16384
v_exp_f32 v231, v231
v_mfma_f32_16x16x32_bf16 v[52:55], a[200:203], a[12:15], v[52:55]
v_cvt_pk_bf16_f32 v235, v230, v231
v_mfma_f32_16x16x32_bf16 v[52:55], a[204:207], a[4:7], v[52:55]
s_cmp_ge_u32 s75, 163840
v_exp_f32 v44, v44
v_mfma_f32_16x16x32_bf16 v[64:67], a[208:211], a[32:35], v[112:115]
v_mfma_f32_16x16x32_bf16 v[64:67], a[212:215], a[36:39], v[64:67]
s_cselect_b32 s75, 0, s75
v_exp_f32 v45, v45
v_mfma_f32_16x16x32_bf16 v[64:67], a[216:219], a[28:31], v[64:67]
v_cvt_pk_bf16_f32 v124, v44, v45
v_mfma_f32_16x16x32_bf16 v[64:67], a[220:223], a[20:23], v[64:67]
s_add_u32 s68, s64, 16384
v_exp_f32 v46, v46
v_mfma_f32_16x16x32_bf16 v[212:215], a[208:211], a[44:47], v[120:123]
buffer_load_dwordx4 v4, s[24:27], s64 offen offset:1024 sc1 lds
v_mfma_f32_16x16x32_bf16 v[212:215], a[212:215], a[40:43], v[212:215]
s_add_u32 s70, s70, 16384
v_exp_f32 v47, v47
v_mfma_f32_16x16x32_bf16 v[212:215], a[216:219], a[12:15], v[212:215]
v_cvt_pk_bf16_f32 v125, v46, v47
v_mfma_f32_16x16x32_bf16 v[212:215], a[220:223], a[4:7], v[212:215]
v_exp_f32 v52, v52
v_mfma_f32_16x16x32_bf16 v[60:63], a[64:67], v[248:251], v[60:63]
v_mfma_f32_16x16x32_bf16 v[148:151], a[64:67], v[232:235], v[148:151]
s_cmp_ge_u32 s70, 163840
v_exp_f32 v53, v53
v_mfma_f32_16x16x32_bf16 v[48:51], a[68:71], v[232:235], v[48:51]
ds_read_b128 a[64:67], v5 offset:8192
v_cvt_pk_bf16_f32 v140, v52, v53
v_mfma_f32_16x16x32_bf16 v[68:71], a[68:71], v[248:251], v[68:71]
s_cselect_b32 s70, s80, s70
v_exp_f32 v54, v54
v_mfma_f32_16x16x32_bf16 v[72:75], a[72:75], v[248:251], v[72:75]
buffer_load_dwordx4 v4, s[24:27], s64 offen offset:2048 sc1 lds
v_mfma_f32_16x16x32_bf16 v[236:239], a[72:75], v[232:235], v[236:239]
v_exp_f32 v55, v55
v_mfma_f32_16x16x32_bf16 v[224:227], a[76:79], v[232:235], v[224:227]
ds_read_b128 a[68:71], v5 offset:9216
v_cvt_pk_bf16_f32 v141, v54, v55
v_mfma_f32_16x16x32_bf16 v[220:223], a[76:79], v[248:251], v[220:223]
v_exp_f32 v64, v64
v_mfma_f32_16x16x32_bf16 v[84:87], a[80:83], v[248:251], v[84:87]
ds_read_b128 a[72:75], v5 offset:10240
v_mfma_f32_16x16x32_bf16 v[164:167], a[80:83], v[232:235], v[164:167]
v_exp_f32 v65, v65
v_mfma_f32_16x16x32_bf16 v[156:159], a[84:87], v[232:235], v[156:159]
ds_read_b128 a[76:79], v5 offset:11264
v_cvt_pk_bf16_f32 v126, v64, v65
v_mfma_f32_16x16x32_bf16 v[76:79], a[84:87], v[248:251], v[76:79]
v_exp_f32 v66, v66
v_mfma_f32_16x16x32_bf16 v[160:163], a[88:91], v[248:251], v[160:163]
buffer_load_dwordx4 v4, s[24:27], s64 offen offset:3072 sc1 lds
v_mfma_f32_16x16x32_bf16 v[216:219], a[88:91], v[232:235], v[216:219]
v_exp_f32 v67, v67
v_mfma_f32_16x16x32_bf16 v[208:211], a[92:95], v[232:235], v[208:211]
ds_read_b128 a[80:83], v5 offset:12288
v_cvt_pk_bf16_f32 v127, v66, v67
v_mfma_f32_16x16x32_bf16 v[252:255], a[92:95], v[248:251], v[252:255]
v_exp_f32 v212, v212
v_mfma_f32_16x16x32_bf16 a[232:235], a[240:243], v[248:251], a[232:235]
ds_read_b128 a[84:87], v5 offset:13312
v_mfma_f32_16x16x32_bf16 a[236:239], a[240:243], v[232:235], a[236:239]
ds_read_b128 a[88:91], v5 offset:14336
v_mfma_f32_16x16x32_bf16 v[100:103], a[192:195], a[48:51], v[128:131]
ds_read_b128 a[92:95], v5 offset:15360
v_mfma_f32_16x16x32_bf16 v[100:103], a[196:199], a[52:55], v[100:103]
v_exp_f32 v213, v213
v_mfma_f32_16x16x32_bf16 v[100:103], a[200:203], a[0:3], v[100:103]
v_cvt_pk_bf16_f32 v142, v212, v213
v_mfma_f32_16x16x32_bf16 v[100:103], a[204:207], a[8:11], v[100:103]
v_exp_f32 v214, v214
v_mfma_f32_16x16x32_bf16 v[92:95], a[192:195], a[60:63], v[136:139]
s_nop 0
v_mfma_f32_16x16x32_bf16 v[92:95], a[196:199], a[56:59], v[92:95]
v_exp_f32 v215, v215
v_mfma_f32_16x16x32_bf16 v[92:95], a[200:203], a[16:19], v[92:95]
ds_read_b128 a[192:195], v5 offset:0
v_cvt_pk_bf16_f32 v143, v214, v215
v_mfma_f32_16x16x32_bf16 v[92:95], a[204:207], a[24:27], v[92:95]
v_exp_f32 v100, v100
v_mfma_f32_16x16x32_bf16 v[176:179], a[208:211], a[48:51], v[144:147]
ds_read_b128 a[196:199], v5 offset:1024
v_mfma_f32_16x16x32_bf16 v[176:179], a[212:215], a[52:55], v[176:179]
v_exp_f32 v101, v101
v_mfma_f32_16x16x32_bf16 v[176:179], a[216:219], a[0:3], v[176:179]
ds_read_b128 a[200:203], v5 offset:2048
v_cvt_pk_bf16_f32 v248, v100, v101
v_mfma_f32_16x16x32_bf16 v[176:179], a[220:223], a[8:11], v[176:179]
v_exp_f32 v102, v102
v_mfma_f32_16x16x32_bf16 v[228:231], a[208:211], a[60:63], v[152:155]
ds_read_b128 a[204:207], v5 offset:3072
v_mfma_f32_16x16x32_bf16 v[228:231], a[212:215], a[56:59], v[228:231]
v_exp_f32 v103, v103
v_mfma_f32_16x16x32_bf16 v[228:231], a[216:219], a[16:19], v[228:231]
ds_read_b128 a[208:211], v5 offset:4096
v_cvt_pk_bf16_f32 v249, v102, v103
v_mfma_f32_16x16x32_bf16 v[228:231], a[220:223], a[24:27], v[228:231]
s_waitcnt lgkmcnt(5)
v_exp_f32 v92, v92
v_mfma_f32_16x16x32_bf16 v[36:39], a[64:67], v[124:127], v[36:39]
ds_read_b128 a[212:215], v5 offset:5120
v_mfma_f32_16x16x32_bf16 v[116:119], a[64:67], v[140:143], v[116:119]
v_exp_f32 v93, v93
v_mfma_f32_16x16x32_bf16 v[132:135], a[68:71], v[140:143], v[132:135]
ds_read_b128 a[216:219], v5 offset:6144
v_cvt_pk_bf16_f32 v232, v92, v93
v_mfma_f32_16x16x32_bf16 v[32:35], a[68:71], v[124:127], v[32:35]
v_exp_f32 v94, v94
v_mfma_f32_16x16x32_bf16 v[196:199], a[72:75], v[124:127], v[196:199]
ds_read_b128 a[220:223], v5 offset:7168
v_mfma_f32_16x16x32_bf16 v[184:187], a[72:75], v[140:143], v[184:187]
s_add_u32 s72, s72, 1
v_exp_f32 v95, v95
v_mfma_f32_16x16x32_bf16 v[240:243], a[76:79], v[140:143], v[240:243]
v_cvt_pk_bf16_f32 v233, v94, v95
v_mfma_f32_16x16x32_bf16 v[204:207], a[76:79], v[124:127], v[204:207]
v_exp_f32 v176, v176
v_mfma_f32_16x16x32_bf16 v[108:111], a[80:83], v[124:127], v[108:111]
v_mfma_f32_16x16x32_bf16 v[188:191], a[80:83], v[140:143], v[188:191]
v_exp_f32 v177, v177
v_mfma_f32_16x16x32_bf16 v[56:59], a[84:87], v[140:143], v[56:59]
v_cvt_pk_bf16_f32 v250, v176, v177
v_mfma_f32_16x16x32_bf16 v[40:43], a[84:87], v[124:127], v[40:43]
v_exp_f32 v178, v178
v_mfma_f32_16x16x32_bf16 v[80:83], a[88:91], v[124:127], v[80:83]
v_mfma_f32_16x16x32_bf16 v[88:91], a[88:91], v[140:143], v[88:91]
s_cmp_lt_u32 s72, s74
v_exp_f32 v179, v179
v_mfma_f32_16x16x32_bf16 v[192:195], a[92:95], v[140:143], v[192:195]
v_cvt_pk_bf16_f32 v251, v178, v179
v_mfma_f32_16x16x32_bf16 v[168:171], a[92:95], v[124:127], v[168:171]
s_waitcnt vmcnt(8) lgkmcnt(0)
v_exp_f32 v228, v228
v_mfma_f32_16x16x32_bf16 a[224:227], a[240:243], v[124:127], a[224:227]
v_mfma_f32_16x16x32_bf16 a[228:231], a[240:243], v[140:143], a[228:231]
s_cbranch_scc1 L_DUAL
L_DISP:
s_cmp_eq_u32 s72, s93
s_cbranch_scc1 L_STOP
L_NE:
s_mov_b32 s74, s93
s_cmp_gt_u32 s72, s66
s_cbranch_scc1 L_SINGLE
v_cndmask_b32 v96, v96, v6, s[56:57]
v_cndmask_b32 v120, v120, v6, s[56:57]
v_mov_b32 v112, v6
v_cndmask_b32 v97, v97, v6, s[58:59]
v_cndmask_b32 v121, v121, v6, s[58:59]
v_mov_b32 v113, v6
v_cndmask_b32 v98, v98, v6, s[60:61]
v_cndmask_b32 v122, v122, v6, s[60:61]
v_mov_b32 v114, v6
v_cndmask_b32 v99, v99, v6, s[62:63]
v_cndmask_b32 v123, v123, v6, s[62:63]
v_mov_b32 v115, v6
s_mov_b32 s74, 0
s_branch L_DUAL
L_STOP:
s_cmp_eq_u32 s72, 3
s_cbranch_scc1 L_E0
s_cmp_eq_u32 s72, 9
s_cbranch_scc1 L_E1
s_cmp_lg_u32 s72, 11
s_cbranch_scc1 L_SE
v_cmp_gt_u32 vcc, 32, v172
s_mov_b32 s73, 32
s_min_u32 s93, s73, s69
s_min_u32 s74, s93, s66
v_accvgpr_read_b32 v16, a244
v_accvgpr_read_b32 v17, a248
v_accvgpr_read_b32 v18, a252
s_cbranch_vccnz CK_Q
CK_Q_R:
buffer_load_dwordx4 a[244:247], v16, s[24:27], 0 offen sc1
buffer_load_dwordx4 a[248:251], v17, s[24:27], 0 offen sc1
buffer_load_dwordx4 a[252:255], v18, s[24:27], 0 offen sc1
s_add_u32 s53, s77, 163840
buffer_load_dwordx4 a[96:99], v4, s[24:27], s53 offen offset:0 sc1
buffer_load_dwordx4 a[100:103], v4, s[24:27], s53 offen offset:1024 sc1
buffer_load_dwordx4 a[104:107], v4, s[24:27], s53 offen offset:2048 sc1
buffer_load_dwordx4 a[108:111], v4, s[24:27], s53 offen offset:3072 sc1
s_cmp_lt_u32 s72, s66
s_cbranch_scc1 L_DUAL
s_mov_b32 s74, s93
s_cmp_gt_u32 s72, s66
s_cbranch_scc1 L_SINGLE
s_branch L_NE
L_E0:
buffer_atomic_add v1, v0, s[24:27], s89 offen offset:8 sc1
s_mov_b32 s73, 9
s_min_u32 s93, s73, s69
s_min_u32 s74, s93, s66
s_cmp_lt_u32 s72, s66
s_cbranch_scc1 L_DUAL
s_mov_b32 s74, s93
s_cmp_gt_u32 s72, s66
s_cbranch_scc1 L_SINGLE
s_branch L_NE
L_E1:
v_and_b32 v173, 31, v1
v_lshlrev_b32 v173, 10, v173
v_add_u32 v173, 75497992, v173
buffer_load_dword v172, v173, s[24:27], 0 offen sc1
s_mov_b32 s73, 11
s_cmp_lt_u32 s4, 16
s_cselect_b32 s52, s66, s67
s_and_b32 s53, s4, 15
s_lshl4_add_u32 s52, s52, s53
s_mul_i32 s52, s52, 2304
v_lshlrev_b32 v16, 2, v1
buffer_store_dwordx4 v[0:3], v4, s[44:47], s52 offen sc1
buffer_store_dwordx4 v[0:3], v4, s[44:47], s52 offen offset:1024 sc1
buffer_store_dword v0, v16, s[44:47], s52 offen offset:2048 sc1
s_min_u32 s93, s73, s69
s_min_u32 s74, s93, s66
s_cmp_lt_u32 s72, s66
s_cbranch_scc1 L_DUAL
s_mov_b32 s74, s93
s_cmp_gt_u32 s72, s66
s_cbranch_scc1 L_SINGLE
s_branch L_NE
L_SE:
s_lshr_b32 s52, s4, 3
s_mul_i32 s52, s52, 75776
s_add_u32 s52, s52, 54525952
s_and_b32 s53, s4, 7
s_mul_i32 s53, s53, 8192
s_add_u32 s52, s52, s53
s_mul_i32 s78, s66, 303104
s_add_u32 s78, s78, s52
s_mul_i32 s79, s67, 303104
s_add_u32 s79, s79, s52
s_mov_b32 s76, 0
v_mov_b32 v7, 0x5d800000
s_mov_b32 s69, 64
v_accvgpr_read_b32 v180, a224
v_accvgpr_read_b32 v182, a228
v_cmp_nle_f32 vcc, v180, v7
v_cmp_nle_f32 s[96:97], v182, v7
s_nop 3
s_or_b64 vcc, vcc, s[96:97]
s_cbranch_vccnz L_NS
s_add_u32 s53, s77, 180224
buffer_load_dwordx4 a[112:115], v4, s[24:27], s53 offen offset:0 sc1
v_mul_f32 v8, 0x3fb8aa3b, v8
v_mul_f32 v9, 0x3fb8aa3b, v9
v_exp_f32 v8, v8
v_exp_f32 v9, v9
s_nop 0
v_fma_f32 v180, v180, v8, v180
v_fma_f32 v182, v182, v9, v182
v_rcp_f32 v180, v180
v_rcp_f32 v182, v182
s_add_u32 s52, s78, 4096
v_mov_b32 v181, v180
v_mov_b32 v183, v182
v_pk_mul_f32 v[36:37], v[36:37], v[180:181]
v_pk_mul_f32 v[38:39], v[38:39], v[180:181]
v_pk_mul_f32 v[32:33], v[32:33], v[180:181]
v_pk_mul_f32 v[34:35], v[34:35], v[180:181]
v_cvt_pk_bf16_f32 v36, v36, v37
v_cvt_pk_bf16_f32 v37, v38, v39
v_cvt_pk_bf16_f32 v38, v32, v33
v_cvt_pk_bf16_f32 v39, v34, v35
buffer_store_dwordx4 v[36:39], v4, s[24:27], s78 offen offset:0 sc1
buffer_load_dwordx4 a[116:119], v4, s[24:27], s53 offen offset:1024 sc1
v_pk_mul_f32 v[116:117], v[116:117], v[182:183]
v_pk_mul_f32 v[118:119], v[118:119], v[182:183]
v_pk_mul_f32 v[132:133], v[132:133], v[182:183]
v_pk_mul_f32 v[134:135], v[134:135], v[182:183]
v_cvt_pk_bf16_f32 v116, v116, v117
v_cvt_pk_bf16_f32 v117, v118, v119
v_cvt_pk_bf16_f32 v118, v132, v133
v_cvt_pk_bf16_f32 v119, v134, v135
buffer_store_dwordx4 v[116:119], v4, s[24:27], s78 offen offset:1024 sc1
v_pk_mul_f32 v[196:197], v[196:197], v[180:181]
v_pk_mul_f32 v[198:199], v[198:199], v[180:181]
v_pk_mul_f32 v[204:205], v[204:205], v[180:181]
v_pk_mul_f32 v[206:207], v[206:207], v[180:181]
v_cvt_pk_bf16_f32 v196, v196, v197
v_cvt_pk_bf16_f32 v197, v198, v199
v_cvt_pk_bf16_f32 v198, v204, v205
v_cvt_pk_bf16_f32 v199, v206, v207
buffer_store_dwordx4 v[196:199], v4, s[24:27], s78 offen offset:2048 sc1
v_pk_mul_f32 v[184:185], v[184:185], v[182:183]
v_pk_mul_f32 v[186:187], v[186:187], v[182:183]
v_pk_mul_f32 v[240:241], v[240:241], v[182:183]
buffer_load_dwordx4 a[120:123], v4, s[24:27], s53 offen offset:2048 sc1
v_pk_mul_f32 v[242:243], v[242:243], v[182:183]
v_cvt_pk_bf16_f32 v184, v184, v185
v_cvt_pk_bf16_f32 v185, v186, v187
v_cvt_pk_bf16_f32 v186, v240, v241
v_cvt_pk_bf16_f32 v187, v242, v243
buffer_store_dwordx4 v[184:187], v4, s[24:27], s78 offen offset:3072 sc1
v_pk_mul_f32 v[108:109], v[108:109], v[180:181]
v_pk_mul_f32 v[110:111], v[110:111], v[180:181]
v_pk_mul_f32 v[40:41], v[40:41], v[180:181]
v_pk_mul_f32 v[42:43], v[42:43], v[180:181]
v_cvt_pk_bf16_f32 v108, v108, v109
v_cvt_pk_bf16_f32 v109, v110, v111
v_cvt_pk_bf16_f32 v110, v40, v41
v_cvt_pk_bf16_f32 v111, v42, v43
buffer_store_dwordx4 v[108:111], v4, s[24:27], s52 offen offset:0 sc1
v_pk_mul_f32 v[188:189], v[188:189], v[182:183]
v_pk_mul_f32 v[190:191], v[190:191], v[182:183]
v_pk_mul_f32 v[56:57], v[56:57], v[182:183]
v_pk_mul_f32 v[58:59], v[58:59], v[182:183]
v_cvt_pk_bf16_f32 v188, v188, v189
v_cvt_pk_bf16_f32 v189, v190, v191
buffer_load_dwordx4 a[124:127], v4, s[24:27], s53 offen offset:3072 sc1
v_cvt_pk_bf16_f32 v190, v56, v57
v_cvt_pk_bf16_f32 v191, v58, v59
buffer_store_dwordx4 v[188:191], v4, s[24:27], s52 offen offset:1024 sc1
v_pk_mul_f32 v[80:81], v[80:81], v[180:181]
v_pk_mul_f32 v[82:83], v[82:83], v[180:181]
v_pk_mul_f32 v[168:169], v[168:169], v[180:181]
v_pk_mul_f32 v[170:171], v[170:171], v[180:181]
v_cvt_pk_bf16_f32 v80, v80, v81
v_cvt_pk_bf16_f32 v81, v82, v83
v_cvt_pk_bf16_f32 v82, v168, v169
v_cvt_pk_bf16_f32 v83, v170, v171
buffer_store_dwordx4 v[80:83], v4, s[24:27], s52 offen offset:2048 sc1
v_pk_mul_f32 v[88:89], v[88:89], v[182:183]
v_pk_mul_f32 v[90:91], v[90:91], v[182:183]
v_pk_mul_f32 v[192:193], v[192:193], v[182:183]
v_pk_mul_f32 v[194:195], v[194:195], v[182:183]
v_cvt_pk_bf16_f32 v88, v88, v89
v_cvt_pk_bf16_f32 v89, v90, v91
v_cvt_pk_bf16_f32 v90, v192, v193
v_cvt_pk_bf16_f32 v91, v194, v195
buffer_store_dwordx4 v[88:91], v4, s[24:27], s52 offen offset:3072 sc1
L_PAD9:
s_cbranch_execz L_PAD13
s_mov_b32 s76, 1
L_NS:
s_mov_b32 s74, s73
s_mov_b32 s93, s73
s_cmp_eq_u32 s72, 32
s_cbranch_scc1 L_FIN
L_SINGLE:
v_mfma_f32_16x16x32_bf16 v[44:47], a[192:195], a[48:51], v[128:131]
s_barrier
v_mfma_f32_16x16x32_bf16 v[44:47], a[196:199], a[52:55], v[44:47]
s_cmp_eq_u32 s68, s71
v_exp_f32 v229, v229
v_mfma_f32_16x16x32_bf16 v[44:47], a[200:203], a[0:3], v[44:47]
s_cselect_b32 s64, s77, s68
v_add_u32 v5, s75, v4
v_cvt_pk_bf16_f32 v234, v228, v229
v_mfma_f32_16x16x32_bf16 v[44:47], a[204:207], a[8:11], v[44:47]
s_mov_b32 m0, s70
v_exp_f32 v230, v230
v_mfma_f32_16x16x32_bf16 v[52:55], a[192:195], a[60:63], v[136:139]
buffer_load_dwordx4 v4, s[24:27], s64 offen offset:0 sc1 lds
v_mfma_f32_16x16x32_bf16 v[52:55], a[196:199], a[56:59], v[52:55]
s_add_u32 s75, s75, 16384
v_exp_f32 v231, v231
v_mfma_f32_16x16x32_bf16 v[52:55], a[200:203], a[16:19], v[52:55]
ds_read_b128 a[192:195], v5 offset:0
v_cvt_pk_bf16_f32 v235, v230, v231
v_mfma_f32_16x16x32_bf16 v[52:55], a[204:207], a[24:27], v[52:55]
s_cmp_ge_u32 s75, 163840
v_exp_f32 v44, v44
v_mfma_f32_16x16x32_bf16 v[64:67], a[208:211], a[48:51], v[144:147]
ds_read_b128 a[196:199], v5 offset:1024
ds_read_b128 a[200:203], v5 offset:2048
v_mfma_f32_16x16x32_bf16 v[64:67], a[212:215], a[52:55], v[64:67]
s_cselect_b32 s75, 0, s75
v_exp_f32 v45, v45
v_mfma_f32_16x16x32_bf16 v[64:67], a[216:219], a[0:3], v[64:67]
ds_read_b128 a[204:207], v5 offset:3072
v_cvt_pk_bf16_f32 v124, v44, v45
v_mfma_f32_16x16x32_bf16 v[64:67], a[220:223], a[8:11], v[64:67]
s_add_u32 s68, s64, 16384
v_exp_f32 v46, v46
v_mfma_f32_16x16x32_bf16 v[212:215], a[208:211], a[60:63], v[152:155]
buffer_load_dwordx4 v4, s[24:27], s64 offen offset:1024 sc1 lds
v_mfma_f32_16x16x32_bf16 v[212:215], a[212:215], a[56:59], v[212:215]
s_add_u32 s70, s70, 16384
v_exp_f32 v47, v47
v_mfma_f32_16x16x32_bf16 v[212:215], a[216:219], a[16:19], v[212:215]
ds_read_b128 a[208:211], v5 offset:4096
v_cvt_pk_bf16_f32 v125, v46, v47
v_mfma_f32_16x16x32_bf16 v[212:215], a[220:223], a[24:27], v[212:215]
s_waitcnt lgkmcnt(5)
v_exp_f32 v52, v52
v_mfma_f32_16x16x32_bf16 v[60:63], a[64:67], v[248:251], v[60:63]
ds_read_b128 a[212:215], v5 offset:5120
ds_read_b128 a[216:219], v5 offset:6144
v_mfma_f32_16x16x32_bf16 v[148:151], a[64:67], v[232:235], v[148:151]
s_cmp_ge_u32 s70, 163840
v_exp_f32 v53, v53
v_mfma_f32_16x16x32_bf16 v[48:51], a[68:71], v[232:235], v[48:51]
ds_read_b128 a[220:223], v5 offset:7168
v_cvt_pk_bf16_f32 v140, v52, v53
v_mfma_f32_16x16x32_bf16 v[68:71], a[68:71], v[248:251], v[68:71]
s_cselect_b32 s70, s80, s70
v_exp_f32 v54, v54
v_mfma_f32_16x16x32_bf16 v[72:75], a[72:75], v[248:251], v[72:75]
buffer_load_dwordx4 v4, s[24:27], s64 offen offset:2048 sc1 lds
v_mfma_f32_16x16x32_bf16 v[236:239], a[72:75], v[232:235], v[236:239]
v_exp_f32 v55, v55
v_mfma_f32_16x16x32_bf16 v[224:227], a[76:79], v[232:235], v[224:227]
ds_read_b128 a[64:67], v5 offset:8192
v_cvt_pk_bf16_f32 v141, v54, v55
v_mfma_f32_16x16x32_bf16 v[220:223], a[76:79], v[248:251], v[220:223]
v_exp_f32 v64, v64
v_mfma_f32_16x16x32_bf16 v[84:87], a[80:83], v[248:251], v[84:87]
ds_read_b128 a[68:71], v5 offset:9216
ds_read_b128 a[72:75], v5 offset:10240
v_mfma_f32_16x16x32_bf16 v[164:167], a[80:83], v[232:235], v[164:167]
v_exp_f32 v65, v65
v_mfma_f32_16x16x32_bf16 v[156:159], a[84:87], v[232:235], v[156:159]
ds_read_b128 a[76:79], v5 offset:11264
v_cvt_pk_bf16_f32 v126, v64, v65
v_mfma_f32_16x16x32_bf16 v[76:79], a[84:87], v[248:251], v[76:79]
s_cmp_eq_u32 s68, s71
v_exp_f32 v66, v66
v_mfma_f32_16x16x32_bf16 v[160:163], a[88:91], v[248:251], v[160:163]
buffer_load_dwordx4 v4, s[24:27], s64 offen offset:3072 sc1 lds
v_mfma_f32_16x16x32_bf16 v[216:219], a[88:91], v[232:235], v[216:219]
s_cselect_b32 s64, s77, s68
v_exp_f32 v67, v67
v_mfma_f32_16x16x32_bf16 v[208:211], a[92:95], v[232:235], v[208:211]
ds_read_b128 a[80:83], v5 offset:12288
v_cvt_pk_bf16_f32 v127, v66, v67
v_mfma_f32_16x16x32_bf16 v[252:255], a[92:95], v[248:251], v[252:255]
s_waitcnt lgkmcnt(5)
v_exp_f32 v212, v212
v_mfma_f32_16x16x32_bf16 a[232:235], a[240:243], v[248:251], a[232:235]
ds_read_b128 a[84:87], v5 offset:13312
ds_read_b128 a[88:91], v5 offset:14336
v_mfma_f32_16x16x32_bf16 a[236:239], a[240:243], v[232:235], a[236:239]
s_mov_b32 m0, s70
ds_read_b128 a[92:95], v5 offset:15360
v_mfma_f32_16x16x32_bf16 v[100:103], a[192:195], a[48:51], v[128:131]
buffer_load_dwordx4 v4, s[24:27], s64 offen offset:0 sc1 lds
v_mfma_f32_16x16x32_bf16 v[100:103], a[196:199], a[52:55], v[100:103]
v_exp_f32 v213, v213
v_mfma_f32_16x16x32_bf16 v[100:103], a[200:203], a[0:3], v[100:103]
v_add_u32 v5, s75, v4
v_cvt_pk_bf16_f32 v142, v212, v213
v_mfma_f32_16x16x32_bf16 v[100:103], a[204:207], a[8:11], v[100:103]
v_exp_f32 v214, v214
v_mfma_f32_16x16x32_bf16 v[92:95], a[192:195], a[60:63], v[136:139]
buffer_load_dwordx4 v4, s[24:27], s64 offen offset:1024 sc1 lds
v_mfma_f32_16x16x32_bf16 v[92:95], a[196:199], a[56:59], v[92:95]
s_add_u32 s75, s75, 16384
v_exp_f32 v215, v215
v_mfma_f32_16x16x32_bf16 v[92:95], a[200:203], a[16:19], v[92:95]
ds_read_b128 a[192:195], v5 offset:0
v_cvt_pk_bf16_f32 v143, v214, v215
v_mfma_f32_16x16x32_bf16 v[92:95], a[204:207], a[24:27], v[92:95]
s_cmp_ge_u32 s75, 163840
v_exp_f32 v100, v100
v_mfma_f32_16x16x32_bf16 v[176:179], a[208:211], a[48:51], v[144:147]
ds_read_b128 a[196:199], v5 offset:1024
ds_read_b128 a[200:203], v5 offset:2048
v_mfma_f32_16x16x32_bf16 v[176:179], a[212:215], a[52:55], v[176:179]
s_cselect_b32 s75, 0, s75
v_exp_f32 v101, v101
v_mfma_f32_16x16x32_bf16 v[176:179], a[216:219], a[0:3], v[176:179]
ds_read_b128 a[204:207], v5 offset:3072
v_cvt_pk_bf16_f32 v248, v100, v101
v_mfma_f32_16x16x32_bf16 v[176:179], a[220:223], a[8:11], v[176:179]
s_add_u32 s68, s64, 16384
v_exp_f32 v102, v102
v_mfma_f32_16x16x32_bf16 v[228:231], a[208:211], a[60:63], v[152:155]
buffer_load_dwordx4 v4, s[24:27], s64 offen offset:2048 sc1 lds
v_mfma_f32_16x16x32_bf16 v[228:231], a[212:215], a[56:59], v[228:231]
s_add_u32 s70, s70, 16384
v_exp_f32 v103, v103
v_mfma_f32_16x16x32_bf16 v[228:231], a[216:219], a[16:19], v[228:231]
ds_read_b128 a[208:211], v5 offset:4096
v_cvt_pk_bf16_f32 v249, v102, v103
v_mfma_f32_16x16x32_bf16 v[228:231], a[220:223], a[24:27], v[228:231]
s_waitcnt lgkmcnt(5)
v_exp_f32 v92, v92
v_mfma_f32_16x16x32_bf16 v[60:63], a[64:67], v[124:127], v[60:63]
ds_read_b128 a[212:215], v5 offset:5120
ds_read_b128 a[216:219], v5 offset:6144
v_mfma_f32_16x16x32_bf16 v[148:151], a[64:67], v[140:143], v[148:151]
s_cmp_ge_u32 s70, 163840
v_exp_f32 v93, v93
v_mfma_f32_16x16x32_bf16 v[48:51], a[68:71], v[140:143], v[48:51]
ds_read_b128 a[220:223], v5 offset:7168
v_cvt_pk_bf16_f32 v232, v92, v93
v_mfma_f32_16x16x32_bf16 v[68:71], a[68:71], v[124:127], v[68:71]
s_cselect_b32 s70, s80, s70
v_exp_f32 v94, v94
v_mfma_f32_16x16x32_bf16 v[72:75], a[72:75], v[124:127], v[72:75]
buffer_load_dwordx4 v4, s[24:27], s64 offen offset:3072 sc1 lds
v_mfma_f32_16x16x32_bf16 v[236:239], a[72:75], v[140:143], v[236:239]
s_add_u32 s72, s72, 1
v_exp_f32 v95, v95
v_mfma_f32_16x16x32_bf16 v[224:227], a[76:79], v[140:143], v[224:227]
ds_read_b128 a[64:67], v5 offset:8192
v_cvt_pk_bf16_f32 v233, v94, v95
v_mfma_f32_16x16x32_bf16 v[220:223], a[76:79], v[124:127], v[220:223]
v_exp_f32 v176, v176
v_mfma_f32_16x16x32_bf16 v[84:87], a[80:83], v[124:127], v[84:87]
ds_read_b128 a[68:71], v5 offset:9216
ds_read_b128 a[72:75], v5 offset:10240
v_mfma_f32_16x16x32_bf16 v[164:167], a[80:83], v[140:143], v[164:167]
v_exp_f32 v177, v177
v_mfma_f32_16x16x32_bf16 v[156:159], a[84:87], v[140:143], v[156:159]
ds_read_b128 a[76:79], v5 offset:11264
v_cvt_pk_bf16_f32 v250, v176, v177
v_mfma_f32_16x16x32_bf16 v[76:79], a[84:87], v[124:127], v[76:79]
v_exp_f32 v178, v178
v_mfma_f32_16x16x32_bf16 v[160:163], a[88:91], v[124:127], v[160:163]
ds_read_b128 a[80:83], v5 offset:12288
ds_read_b128 a[84:87], v5 offset:13312
v_mfma_f32_16x16x32_bf16 v[216:219], a[88:91], v[140:143], v[216:219]
s_cmp_lt_u32 s72, s74
v_exp_f32 v179, v179
v_mfma_f32_16x16x32_bf16 v[208:211], a[92:95], v[140:143], v[208:211]
ds_read_b128 a[88:91], v5 offset:14336
v_cvt_pk_bf16_f32 v251, v178, v179
v_mfma_f32_16x16x32_bf16 v[252:255], a[92:95], v[124:127], v[252:255]
s_waitcnt vmcnt(8) lgkmcnt(7)
v_exp_f32 v228, v228
v_mfma_f32_16x16x32_bf16 a[232:235], a[240:243], v[124:127], a[232:235]
ds_read_b128 a[92:95], v5 offset:15360
v_mfma_f32_16x16x32_bf16 a[236:239], a[240:243], v[140:143], a[236:239]
s_cbranch_scc1 L_SINGLE
s_cmp_eq_u32 s72, s69
s_cbranch_scc1 L_SE
s_cmp_lt_u32 s72, 32
s_cbranch_scc1 L_STOP
L_FIN:
s_add_u32 s53, s77, 196608
buffer_load_dwordx4 a[160:163], v4, s[24:27], s53 offen offset:0 sc1
v_cndmask_b32 v128, v128, v6, s[56:57]
v_cndmask_b32 v152, v152, v6, s[56:57]
v_mov_b32 v144, v6
buffer_load_dwordx4 a[164:167], v4, s[24:27], s53 offen offset:1024 sc1
v_cndmask_b32 v129, v129, v6, s[58:59]
v_cndmask_b32 v153, v153, v6, s[58:59]
v_mov_b32 v145, v6
buffer_load_dwordx4 a[168:171], v4, s[24:27], s53 offen offset:2048 sc1
v_cndmask_b32 v130, v130, v6, s[60:61]
v_cndmask_b32 v154, v154, v6, s[60:61]
v_mov_b32 v146, v6
buffer_load_dwordx4 a[172:175], v4, s[24:27], s53 offen offset:3072 sc1
v_cndmask_b32 v131, v131, v6, s[62:63]
v_cndmask_b32 v155, v155, v6, s[62:63]
v_mov_b32 v147, v6
s_mov_b32 s83, s75
s_sub_u32 s91, s70, s80
v_mfma_f32_16x16x32_bf16 v[44:47], a[192:195], a[48:51], v[128:131]
s_barrier
v_mfma_f32_16x16x32_bf16 v[44:47], a[196:199], a[52:55], v[44:47]
s_mov_b32 m0, s70
v_exp_f32 v229, v229
v_mfma_f32_16x16x32_bf16 v[44:47], a[200:203], a[0:3], v[44:47]
s_mov_b32 s64, s68
v_add_u32 v5, s75, v4
v_cvt_pk_bf16_f32 v234, v228, v229
v_mfma_f32_16x16x32_bf16 v[44:47], a[204:207], a[8:11], v[44:47]
s_add_u32 s68, s68, 16384
v_exp_f32 v230, v230
v_mfma_f32_16x16x32_bf16 v[52:55], a[192:195], a[60:63], v[136:139]
buffer_load_dwordx4 v4, s[24:27], s64 offen offset:0 sc1 lds
v_mfma_f32_16x16x32_bf16 v[52:55], a[196:199], a[56:59], v[52:55]
s_add_u32 s70, s70, 16384
v_exp_f32 v231, v231
v_mfma_f32_16x16x32_bf16 v[52:55], a[200:203], a[16:19], v[52:55]
v_cvt_pk_bf16_f32 v235, v230, v231
v_mul_f32 v10, 0x3fb8aa3b, v10
v_mfma_f32_16x16x32_bf16 v[52:55], a[204:207], a[24:27], v[52:55]
s_cmp_ge_u32 s70, 163840
v_exp_f32 v44, v44
v_mfma_f32_16x16x32_bf16 v[64:67], a[208:211], a[48:51], v[144:147]
buffer_load_dwordx4 v4, s[24:27], s64 offen offset:1024 sc1 lds
v_mfma_f32_16x16x32_bf16 v[64:67], a[212:215], a[52:55], v[64:67]
s_cselect_b32 s70, s80, s70
v_exp_f32 v45, v45
v_mfma_f32_16x16x32_bf16 v[64:67], a[216:219], a[0:3], v[64:67]
v_cvt_pk_bf16_f32 v124, v44, v45
v_mul_f32 v11, 0x3fb8aa3b, v11
v_mfma_f32_16x16x32_bf16 v[64:67], a[220:223], a[8:11], v[64:67]
v_exp_f32 v46, v46
v_mfma_f32_16x16x32_bf16 v[212:215], a[208:211], a[60:63], v[152:155]
buffer_load_dwordx4 v4, s[24:27], s64 offen offset:2048 sc1 lds
v_mfma_f32_16x16x32_bf16 v[212:215], a[212:215], a[56:59], v[212:215]
v_exp_f32 v47, v47
v_mfma_f32_16x16x32_bf16 v[212:215], a[216:219], a[16:19], v[212:215]
v_cvt_pk_bf16_f32 v125, v46, v47
v_mfma_f32_16x16x32_bf16 v[212:215], a[220:223], a[24:27], v[212:215]
s_waitcnt lgkmcnt(0)
v_exp_f32 v52, v52
v_mfma_f32_16x16x32_bf16 v[60:63], a[64:67], v[248:251], v[60:63]
buffer_load_dwordx4 v4, s[24:27], s64 offen offset:3072 sc1 lds
v_mfma_f32_16x16x32_bf16 v[148:151], a[64:67], v[232:235], v[148:151]
s_mov_b32 m0, s70
v_exp_f32 v53, v53
v_mfma_f32_16x16x32_bf16 v[48:51], a[68:71], v[232:235], v[48:51]
s_mov_b32 s64, s68
ds_read_b128 a[64:67], v5 offset:8192
v_cvt_pk_bf16_f32 v140, v52, v53
v_mfma_f32_16x16x32_bf16 v[68:71], a[68:71], v[248:251], v[68:71]
s_add_u32 s68, s68, 16384
v_exp_f32 v54, v54
v_mfma_f32_16x16x32_bf16 v[72:75], a[72:75], v[248:251], v[72:75]
buffer_load_dwordx4 v4, s[24:27], s64 offen offset:0 sc1 lds
v_mfma_f32_16x16x32_bf16 v[236:239], a[72:75], v[232:235], v[236:239]
s_add_u32 s70, s70, 16384
v_exp_f32 v55, v55
v_mfma_f32_16x16x32_bf16 v[224:227], a[76:79], v[232:235], v[224:227]
ds_read_b128 a[68:71], v5 offset:9216
v_cvt_pk_bf16_f32 v141, v54, v55
v_mfma_f32_16x16x32_bf16 v[220:223], a[76:79], v[248:251], v[220:223]
s_cmp_ge_u32 s70, 163840
v_exp_f32 v64, v64
v_mfma_f32_16x16x32_bf16 v[84:87], a[80:83], v[248:251], v[84:87]
ds_read_b128 a[72:75], v5 offset:10240
v_mfma_f32_16x16x32_bf16 v[164:167], a[80:83], v[232:235], v[164:167]
s_cselect_b32 s70, s80, s70
v_exp_f32 v65, v65
v_mfma_f32_16x16x32_bf16 v[156:159], a[84:87], v[232:235], v[156:159]
ds_read_b128 a[76:79], v5 offset:11264
v_cvt_pk_bf16_f32 v126, v64, v65
v_mfma_f32_16x16x32_bf16 v[76:79], a[84:87], v[248:251], v[76:79]
v_exp_f32 v66, v66
v_mfma_f32_16x16x32_bf16 v[160:163], a[88:91], v[248:251], v[160:163]
buffer_load_dwordx4 v4, s[24:27], s64 offen offset:1024 sc1 lds
v_mfma_f32_16x16x32_bf16 v[216:219], a[88:91], v[232:235], v[216:219]
s_add_u32 s52, s79, 4096
v_exp_f32 v67, v67
v_mfma_f32_16x16x32_bf16 v[208:211], a[92:95], v[232:235], v[208:211]
ds_read_b128 a[80:83], v5 offset:12288
v_cvt_pk_bf16_f32 v127, v66, v67
v_mfma_f32_16x16x32_bf16 v[252:255], a[92:95], v[248:251], v[252:255]
v_exp_f32 v212, v212
v_mfma_f32_16x16x32_bf16 a[232:235], a[240:243], v[248:251], a[232:235]
ds_read_b128 a[84:87], v5 offset:13312
ds_read_b128 a[88:91], v5 offset:14336
v_mfma_f32_16x16x32_bf16 a[236:239], a[240:243], v[232:235], a[236:239]
ds_read_b128 a[92:95], v5 offset:15360
v_exp_f32 v213, v213
v_exp_f32 v214, v214
v_exp_f32 v215, v215
v_exp_f32 v10, v10
v_cvt_pk_bf16_f32 v142, v212, v213
v_cvt_pk_bf16_f32 v143, v214, v215
v_exp_f32 v11, v11
s_waitcnt lgkmcnt(0)
v_mfma_f32_16x16x32_bf16 a[232:235], a[240:243], v[124:127], a[232:235]
buffer_load_dwordx4 v4, s[24:27], s64 offen offset:2048 sc1 lds
v_mfma_f32_16x16x32_bf16 a[236:239], a[240:243], v[140:143], a[236:239]
s_barrier
v_mfma_f32_16x16x32_bf16 v[60:63], a[64:67], v[124:127], v[60:63]
v_cmp_eq_u32 vcc, 0, v3
v_mul_u32_u24 v244, 1536, v3
v_mfma_f32_16x16x32_bf16 v[148:151], a[64:67], v[140:143], v[148:151]
v_mov_b32 v246, 9728
v_cndmask_b32 v244, v244, v246, vcc
v_mfma_f32_16x16x32_bf16 v[48:51], a[68:71], v[140:143], v[48:51]
buffer_load_dwordx4 v4, s[24:27], s64 offen offset:3072 sc1 lds
v_mfma_f32_16x16x32_bf16 v[68:71], a[68:71], v[124:127], v[68:71]
v_lshl_add_u32 v247, v2, 4, s83
v_mov_b32 v246, 10496
v_mfma_f32_16x16x32_bf16 v[72:75], a[72:75], v[124:127], v[72:75]
v_accvgpr_read_b32 v180, a232
v_accvgpr_read_b32 v182, a236
v_mfma_f32_16x16x32_bf16 v[236:239], a[72:75], v[140:143], v[236:239]
v_cmp_nle_f32 vcc, v180, v7
v_cmp_nle_f32 s[96:97], v182, v7
v_mfma_f32_16x16x32_bf16 v[224:227], a[76:79], v[140:143], v[224:227]
v_fma_f32 v180, v180, v10, v180
v_fma_f32 v182, v182, v11, v182
v_mfma_f32_16x16x32_bf16 v[220:223], a[76:79], v[124:127], v[220:223]
v_rcp_f32 v180, v180
v_mfma_f32_16x16x32_bf16 v[84:87], a[80:83], v[124:127], v[84:87]
s_or_b64 vcc, vcc, s[96:97]
v_rcp_f32 v182, v182
v_mfma_f32_16x16x32_bf16 v[164:167], a[80:83], v[140:143], v[164:167]
v_mul_f32 v60, v180, v60
v_mul_f32 v61, v180, v61
v_mfma_f32_16x16x32_bf16 v[156:159], a[84:87], v[140:143], v[156:159]
v_mul_f32 v62, v180, v62
v_mul_f32 v63, v180, v63
v_mfma_f32_16x16x32_bf16 v[76:79], a[84:87], v[124:127], v[76:79]
v_mul_f32 v68, v180, v68
v_mul_f32 v69, v180, v69
v_mfma_f32_16x16x32_bf16 v[160:163], a[88:91], v[124:127], v[160:163]
v_mul_f32 v70, v180, v70
v_mul_f32 v71, v180, v71
v_mfma_f32_16x16x32_bf16 v[216:219], a[88:91], v[140:143], v[216:219]
v_cvt_pk_bf16_f32 v60, v60, v61
v_cvt_pk_bf16_f32 v61, v62, v63
v_mfma_f32_16x16x32_bf16 v[208:211], a[92:95], v[140:143], v[208:211]
v_cvt_pk_bf16_f32 v62, v68, v69
v_cvt_pk_bf16_f32 v63, v70, v71
v_mfma_f32_16x16x32_bf16 v[252:255], a[92:95], v[124:127], v[252:255]
s_cbranch_vccnz SLOW1
L_EP:
buffer_store_dwordx4 v[60:63], v4, s[24:27], s79 offen offset:0 sc1
v_pk_mul_f32 v[148:149], v[148:149], v[182:183] op_sel_hi:[1,0]
v_pk_mul_f32 v[150:151], v[150:151], v[182:183] op_sel_hi:[1,0]
v_pk_mul_f32 v[48:49], v[48:49], v[182:183] op_sel_hi:[1,0]
v_pk_mul_f32 v[50:51], v[50:51], v[182:183] op_sel_hi:[1,0]
v_cvt_pk_bf16_f32 v148, v148, v149
v_cvt_pk_bf16_f32 v149, v150, v151
v_cvt_pk_bf16_f32 v150, v48, v49
v_cvt_pk_bf16_f32 v151, v50, v51
buffer_store_dwordx4 v[148:151], v4, s[24:27], s79 offen offset:1024 sc1
v_pk_mul_f32 v[72:73], v[72:73], v[180:181] op_sel_hi:[1,0]
v_pk_mul_f32 v[74:75], v[74:75], v[180:181] op_sel_hi:[1,0]
v_pk_mul_f32 v[220:221], v[220:221], v[180:181] op_sel_hi:[1,0]
v_pk_mul_f32 v[222:223], v[222:223], v[180:181] op_sel_hi:[1,0]
v_cvt_pk_bf16_f32 v72, v72, v73
v_cvt_pk_bf16_f32 v73, v74, v75
v_cvt_pk_bf16_f32 v74, v220, v221
v_cvt_pk_bf16_f32 v75, v222, v223
buffer_store_dwordx4 v[72:75], v4, s[24:27], s79 offen offset:2048 sc1
v_pk_mul_f32 v[236:237], v[236:237], v[182:183] op_sel_hi:[1,0]
v_pk_mul_f32 v[238:239], v[238:239], v[182:183] op_sel_hi:[1,0]
v_pk_mul_f32 v[224:225], v[224:225], v[182:183] op_sel_hi:[1,0]
v_pk_mul_f32 v[226:227], v[226:227], v[182:183] op_sel_hi:[1,0]
v_cvt_pk_bf16_f32 v236, v236, v237
v_cvt_pk_bf16_f32 v237, v238, v239
v_cvt_pk_bf16_f32 v238, v224, v225
v_cvt_pk_bf16_f32 v239, v226, v227
buffer_store_dwordx4 v[236:239], v4, s[24:27], s79 offen offset:3072 sc1
v_pk_mul_f32 v[84:85], v[84:85], v[180:181] op_sel_hi:[1,0]
v_pk_mul_f32 v[86:87], v[86:87], v[180:181] op_sel_hi:[1,0]
v_pk_mul_f32 v[76:77], v[76:77], v[180:181] op_sel_hi:[1,0]
v_pk_mul_f32 v[78:79], v[78:79], v[180:181] op_sel_hi:[1,0]
v_cvt_pk_bf16_f32 v84, v84, v85
v_cvt_pk_bf16_f32 v85, v86, v87
v_cvt_pk_bf16_f32 v86, v76, v77
v_cvt_pk_bf16_f32 v87, v78, v79
buffer_store_dwordx4 v[84:87], v4, s[24:27], s52 offen offset:0 sc1
v_pk_mul_f32 v[164:165], v[164:165], v[182:183] op_sel_hi:[1,0]
v_pk_mul_f32 v[166:167], v[166:167], v[182:183] op_sel_hi:[1,0]
v_pk_mul_f32 v[156:157], v[156:157], v[182:183] op_sel_hi:[1,0]
v_pk_mul_f32 v[158:159], v[158:159], v[182:183] op_sel_hi:[1,0]
v_cvt_pk_bf16_f32 v164, v164, v165
v_cvt_pk_bf16_f32 v165, v166, v167
v_cvt_pk_bf16_f32 v166, v156, v157
v_cvt_pk_bf16_f32 v167, v158, v159
buffer_store_dwordx4 v[164:167], v4, s[24:27], s52 offen offset:1024 sc1
v_pk_mul_f32 v[160:161], v[160:161], v[180:181] op_sel_hi:[1,0]
v_pk_mul_f32 v[162:163], v[162:163], v[180:181] op_sel_hi:[1,0]
v_pk_mul_f32 v[252:253], v[252:253], v[180:181] op_sel_hi:[1,0]
v_pk_mul_f32 v[254:255], v[254:255], v[180:181] op_sel_hi:[1,0]
v_cvt_pk_bf16_f32 v160, v160, v161
v_cvt_pk_bf16_f32 v161, v162, v163
v_cvt_pk_bf16_f32 v162, v252, v253
v_cvt_pk_bf16_f32 v163, v254, v255
buffer_store_dwordx4 v[160:163], v4, s[24:27], s52 offen offset:2048 sc1
v_pk_mul_f32 v[216:217], v[216:217], v[182:183] op_sel_hi:[1,0]
v_pk_mul_f32 v[218:219], v[218:219], v[182:183] op_sel_hi:[1,0]
v_pk_mul_f32 v[208:209], v[208:209], v[182:183] op_sel_hi:[1,0]
v_pk_mul_f32 v[210:211], v[210:211], v[182:183] op_sel_hi:[1,0]
v_cvt_pk_bf16_f32 v216, v216, v217
v_cvt_pk_bf16_f32 v217, v218, v219
v_cvt_pk_bf16_f32 v218, v208, v209
v_cvt_pk_bf16_f32 v219, v210, v211
buffer_store_dwordx4 v[216:219], v4, s[24:27], s52 offen offset:3072 sc1
v_cmp_eq_u32 vcc, 3, v3
v_mul_u32_u24 v200, 768, v3
v_add_u32 v200, v200, v247
ds_write_b128 v200, a[244:247] offset:0
v_cndmask_b32 v245, v244, v246, vcc
ds_write_b128 v200, a[248:251] offset:3072
v_add_u32 v247, -1280, v247
ds_write_b128 v200, a[252:255] offset:6144
v_add_u32 v244, v244, v247
v_add_u32 v245, v245, v247
ds_write_b128 v244, a[128:131] offset:0
v_cmp_lt_u32 vcc, 31, v1
ds_write_b128 v245, a[132:135] offset:768
v_and_b32 v202, 31, v1
ds_write_b128 v244, a[136:139] offset:256
v_mov_b32 v200, s66
ds_write_b128 v245, a[140:143] offset:1024
v_mov_b32 v203, s67
ds_write_b128 v244, a[144:147] offset:3840
v_cndmask_b32 v200, v200, v203, vcc
ds_write_b128 v245, a[148:151] offset:4608
v_lshl_add_u32 v200, v200, 5, v202
ds_write_b128 v244, a[152:155] offset:4096
v_lshrrev_b32 v201, 5, v1
ds_write_b128 v245, a[156:159] offset:4864
v_mul_u32_u24 v201, 3840, v201
v_lshl_add_u32 v201, v202, 4, v201
v_add_u32 v201, s83, v201
s_cmp_eq_u32 s76, 0
s_cbranch_scc1 L_SE2
L_LA:
v_mov_b32 v5, v200
v_mov_b32 v6, v201
v_mov_b32 v13, 0
s_lshl_b32 s74, s66, 10
s_lshr_b32 s52, s4, 3
s_lshl_b32 s52, s52, 7
s_add_u32 s74, s74, s52
s_add_u32 s74, s74, 75497472
ds_read_b128 v[16:19], v6 offset:8448
ds_read_b128 v[20:23], v6 offset:9216
ds_read_b128 v[96:99], v6 offset:3328
ds_read_b128 v[32:35], v6 offset:256
ds_read_b128 v[36:39], v6 offset:1024
ds_read_b128 v[100:103], v6 offset:3296
ds_read_b128 v[40:43], v6 offset:224
ds_read_b128 v[44:47], v6 offset:992
ds_read_b128 v[104:107], v6 offset:3264
ds_read_b128 v[48:51], v6 offset:192
ds_read_b128 v[52:55], v6 offset:960
ds_read_b128 v[108:111], v6 offset:3232
ds_read_b128 v[56:59], v6 offset:160
ds_read_b128 v[60:63], v6 offset:928
ds_read_b128 v[112:115], v6 offset:3200
ds_read_b128 v[64:67], v6 offset:128
ds_read_b128 v[68:71], v6 offset:896
ds_read_b128 v[116:119], v6 offset:3168
ds_read_b128 v[72:75], v6 offset:96
ds_read_b128 v[76:79], v6 offset:864
ds_read_b128 v[120:123], v6 offset:3136
ds_read_b128 v[80:83], v6 offset:64
ds_read_b128 v[84:87], v6 offset:832
ds_read_b128 v[124:127], v6 offset:3104
ds_read_b128 v[88:91], v6 offset:32
ds_read_b128 v[92:95], v6 offset:800
ds_read_b128 v[128:131], v6 offset:1792
ds_read_b128 v[132:135], v6 offset:2560
s_waitcnt vmcnt(0)
buffer_atomic_add v1, v0, s[24:27], s74 offen offset:0 sc1
ds_read_b128 v[136:139], v6 offset:1760
ds_read_b128 v[140:143], v6 offset:2528
ds_read_b128 v[144:147], v6 offset:1728
ds_read_b128 v[148:151], v6 offset:2496
ds_read_b128 v[152:155], v6 offset:1696
ds_read_b128 v[156:159], v6 offset:2464
ds_read_b128 v[160:163], v6 offset:1664
ds_read_b128 v[164:167], v6 offset:2432
ds_read_b128 v[168:171], v6 offset:1632
ds_read_b128 v[172:175], v6 offset:2400
ds_read_b128 v[176:179], v6 offset:1600
ds_read_b128 v[180:183], v6 offset:2368
ds_read_b128 v[184:187], v6 offset:1568
ds_read_b128 v[188:191], v6 offset:2336
s_lshr_b32 s52, s3, 1
s_lshl1_add_u32 s72, s85, s52
s_lshl3_add_u32 s75, s72, s84
s_lshl_b32 s75, s75, 7
s_add_u32 s75, s75, 75497472
s_and_b32 s82, s86, 1
s_lshl_b32 s82, s82, 13
s_lshr_b32 s53, s4, 3
s_mul_i32 s53, s53, 75776
s_add_u32 s53, s53, 54525952
s_and_b32 s52, s3, 1
s_lshl_b32 s52, s52, 10
s_add_u32 s52, s52, s53
s_sub_u32 s54, 63, s72
s_mul_i32 s77, s72, 303104
s_add_u32 s77, s77, s52
s_mul_i32 s81, s54, 303104
s_add_u32 s81, s81, s52
s_add_u32 s91, s91, 114688
s_sub_u32 s52, s91, 163840
s_cmp_ge_u32 s91, 163840
s_cselect_b32 s91, s52, s91
v_add_u32 v14, 4096, v4
v_add_u32 v7, s91, v4
s_waitcnt lgkmcnt(0)
s_barrier
s_mov_b32 m0, s70
s_mov_b32 s64, s68
s_add_u32 s68, s68, 16384
s_add_u32 s70, s70, 16384
s_cmp_ge_u32 s70, 163840
s_cselect_b32 s70, s80, s70
buffer_load_dwordx4 v4, s[24:27], s64 offen offset:0 sc1 lds
v_and_b32 v9, 0xffff, v97
v_and_b32 v11, 0xffff0000, v97
v_dot2_f32_bf16 v24, v98, v99, 0
v_dot2_f32_bf16 v25, v102, v99, 0
v_dot2_f32_bf16 v26, v106, v99, 0
v_dot2_f32_bf16 v27, v110, v99, 0
v_dot2_f32_bf16 v28, v114, v99, 0
v_dot2_f32_bf16 v29, v118, v99, 0
v_dot2_f32_bf16 v30, v122, v99, 0
v_dot2_f32_bf16 v31, v126, v99, 0
v_dot2c_f32_bf16 v24, v96, v9
v_dot2c_f32_bf16 v25, v100, v9
v_dot2c_f32_bf16 v26, v104, v9
v_dot2c_f32_bf16 v27, v108, v9
v_dot2c_f32_bf16 v28, v112, v9
buffer_load_dwordx4 v4, s[24:27], s64 offen offset:1024 sc1 lds
v_dot2c_f32_bf16 v29, v116, v9
v_dot2c_f32_bf16 v30, v120, v9
v_dot2c_f32_bf16 v31, v124, v9
v_dot2c_f32_bf16 v24, v16, v32
v_dot2c_f32_bf16 v25, v16, v40
v_dot2c_f32_bf16 v26, v16, v48
v_dot2c_f32_bf16 v27, v16, v56
v_dot2c_f32_bf16 v28, v16, v64
v_dot2c_f32_bf16 v29, v16, v72
v_dot2c_f32_bf16 v30, v16, v80
v_dot2c_f32_bf16 v31, v16, v88
v_dot2c_f32_bf16 v24, v17, v33
v_dot2c_f32_bf16 v25, v17, v41
v_dot2c_f32_bf16 v26, v17, v49
v_dot2c_f32_bf16 v27, v17, v57
buffer_load_dwordx4 v4, s[24:27], s64 offen offset:2048 sc1 lds
v_dot2c_f32_bf16 v28, v17, v65
v_dot2c_f32_bf16 v29, v17, v73
v_dot2c_f32_bf16 v30, v17, v81
v_dot2c_f32_bf16 v31, v17, v89
v_dot2c_f32_bf16 v24, v18, v34
v_dot2c_f32_bf16 v25, v18, v42
v_dot2c_f32_bf16 v26, v18, v50
v_dot2c_f32_bf16 v27, v18, v58
v_dot2c_f32_bf16 v28, v18, v66
v_dot2c_f32_bf16 v29, v18, v74
v_dot2c_f32_bf16 v30, v18, v82
v_dot2c_f32_bf16 v31, v18, v90
v_dot2c_f32_bf16 v24, v19, v35
v_dot2c_f32_bf16 v25, v19, v43
v_dot2c_f32_bf16 v26, v19, v51
buffer_load_dwordx4 v4, s[24:27], s64 offen offset:3072 sc1 lds
v_dot2c_f32_bf16 v27, v19, v59
v_dot2c_f32_bf16 v28, v19, v67
v_dot2c_f32_bf16 v29, v19, v75
v_dot2c_f32_bf16 v30, v19, v83
v_dot2c_f32_bf16 v31, v19, v91
v_dot2c_f32_bf16 v24, v20, v36
v_dot2c_f32_bf16 v25, v20, v44
v_dot2c_f32_bf16 v26, v20, v52
v_dot2c_f32_bf16 v27, v20, v60
v_dot2c_f32_bf16 v28, v20, v68
v_dot2c_f32_bf16 v29, v20, v76
v_dot2c_f32_bf16 v30, v20, v84
v_dot2c_f32_bf16 v31, v20, v92
v_dot2c_f32_bf16 v24, v21, v37
v_dot2c_f32_bf16 v25, v21, v45
s_mov_b32 m0, s70
s_mov_b32 s64, s68
s_add_u32 s68, s68, 16384
s_add_u32 s70, s70, 16384
s_cmp_ge_u32 s70, 163840
s_cselect_b32 s70, s80, s70
buffer_load_dwordx4 v4, s[24:27], s64 offen offset:0 sc1 lds
v_dot2c_f32_bf16 v26, v21, v53
v_dot2c_f32_bf16 v27, v21, v61
v_dot2c_f32_bf16 v28, v21, v69
v_dot2c_f32_bf16 v29, v21, v77
v_dot2c_f32_bf16 v30, v21, v85
v_dot2c_f32_bf16 v31, v21, v93
v_dot2c_f32_bf16 v24, v22, v38
v_dot2c_f32_bf16 v25, v22, v46
v_dot2c_f32_bf16 v26, v22, v54
v_dot2c_f32_bf16 v27, v22, v62
v_dot2c_f32_bf16 v28, v22, v70
v_dot2c_f32_bf16 v29, v22, v78
L_PAD10:
s_cbranch_execz L_MAIN
v_dot2c_f32_bf16 v30, v22, v86
v_dot2c_f32_bf16 v31, v22, v94
v_dot2c_f32_bf16 v24, v23, v39
buffer_load_dwordx4 v4, s[24:27], s64 offen offset:1024 sc1 lds
v_dot2c_f32_bf16 v25, v23, v47
v_dot2c_f32_bf16 v26, v23, v55
v_dot2c_f32_bf16 v27, v23, v63
v_dot2c_f32_bf16 v28, v23, v71
v_dot2c_f32_bf16 v29, v23, v79
v_dot2c_f32_bf16 v30, v23, v87
v_dot2c_f32_bf16 v31, v23, v95
v_mov_b32 v9, 0xf149f2ca
v_mul_f32 v11, 0xbfb8aa3b, v11
v_exp_f32 v11, v11
v_cmp_gt_u32 vcc, 2, v5
v_cmp_gt_u32 s[56:57], 4, v5
s_nop 0
v_cndmask_b32 v25, v25, v9, vcc
v_cndmask_b32 v26, v26, v9, s[56:57]
buffer_load_dwordx4 v4, s[24:27], s64 offen offset:2048 sc1 lds
v_cmp_gt_u32 vcc, 6, v5
v_cmp_gt_u32 s[56:57], 8, v5
s_nop 0
v_cndmask_b32 v27, v27, v9, vcc
v_cndmask_b32 v28, v28, v9, s[56:57]
v_cmp_gt_u32 vcc, 10, v5
v_cmp_gt_u32 s[56:57], 12, v5
s_nop 0
v_cndmask_b32 v29, v29, v9, vcc
v_cndmask_b32 v30, v30, v9, s[56:57]
v_cmp_gt_u32 vcc, 14, v5
s_nop 0
s_nop 0
v_cndmask_b32 v31, v31, v9, vcc
v_max3_f32 v10, v24, v25, v26
buffer_load_dwordx4 v4, s[24:27], s64 offen offset:3072 sc1 lds
v_max3_f32 v10, v10, v27, v28
v_max3_f32 v10, v10, v29, v30
v_max_f32 v10, v10, v31
s_mov_b32 s52, 0x3eae1a93
v_sub_f32 v24, v24, v10
v_sub_f32 v25, v25, v10
v_sub_f32 v26, v26, v10
v_sub_f32 v27, v27, v10
v_sub_f32 v28, v28, v10
v_sub_f32 v29, v29, v10
v_sub_f32 v30, v30, v10
v_sub_f32 v31, v31, v10
v_mul_f32 v24, s52, v24
v_mul_f32 v25, s52, v25
v_mul_f32 v26, s52, v26
s_mov_b32 m0, s70
s_mov_b32 s64, s68
s_add_u32 s68, s68, 16384
s_add_u32 s70, s70, 16384
s_cmp_ge_u32 s70, 163840
s_cselect_b32 s70, s80, s70
buffer_load_dwordx4 v4, s[24:27], s64 offen offset:0 sc1 lds
v_mul_f32 v27, s52, v27
v_mul_f32 v28, s52, v28
v_mul_f32 v29, s52, v29
v_mul_f32 v30, s52, v30
v_mul_f32 v31, s52, v31
v_exp_f32 v24, v24
v_exp_f32 v25, v25
v_exp_f32 v26, v26
v_exp_f32 v27, v27
v_exp_f32 v28, v28
v_exp_f32 v29, v29
v_exp_f32 v30, v30
v_exp_f32 v31, v31
v_cvt_pk_bf16_f32 v32, v24, 0
v_cvt_pk_bf16_f32 v40, v25, 0
buffer_load_dwordx4 v4, s[24:27], s64 offen offset:1024 sc1 lds
v_cvt_pk_bf16_f32 v48, v26, 0
v_cvt_pk_bf16_f32 v56, v27, 0
v_cvt_pk_bf16_f32 v64, v28, 0
v_cvt_pk_bf16_f32 v72, v29, 0
v_cvt_pk_bf16_f32 v80, v30, 0
v_cvt_pk_bf16_f32 v88, v31, 0
v_lshlrev_b32 v33, 16, v32
v_lshlrev_b32 v41, 16, v40
v_lshlrev_b32 v49, 16, v48
v_lshlrev_b32 v57, 16, v56
v_lshlrev_b32 v65, 16, v64
v_lshlrev_b32 v73, 16, v72
v_lshlrev_b32 v81, 16, v80
v_lshlrev_b32 v89, 16, v88
v_add_f32 v10, v33, v41
buffer_load_dwordx4 v4, s[24:27], s64 offen offset:2048 sc1 lds
v_add_f32 v10, v10, v49
v_add_f32 v10, v10, v57
v_add_f32 v10, v10, v65
v_add_f32 v10, v10, v73
v_add_f32 v10, v10, v81
v_add_f32 v10, v10, v89
v_fmac_f32 v10, v10, v11
v_rcp_f32 v10, v10
v_dot2_f32_bf16 v192, v128, v32, 0
v_dot2_f32_bf16 v193, v128, v33, 0
v_dot2_f32_bf16 v194, v129, v32, 0
v_dot2_f32_bf16 v195, v129, v33, 0
v_dot2_f32_bf16 v196, v130, v32, 0
v_dot2_f32_bf16 v197, v130, v33, 0
v_dot2_f32_bf16 v198, v131, v32, 0
buffer_load_dwordx4 v4, s[24:27], s64 offen offset:3072 sc1 lds
v_dot2_f32_bf16 v199, v131, v33, 0
v_dot2_f32_bf16 v200, v132, v32, 0
v_dot2_f32_bf16 v201, v132, v33, 0
v_dot2_f32_bf16 v202, v133, v32, 0
v_dot2_f32_bf16 v203, v133, v33, 0
v_dot2_f32_bf16 v204, v134, v32, 0
v_dot2_f32_bf16 v205, v134, v33, 0
v_dot2_f32_bf16 v206, v135, v32, 0
v_dot2_f32_bf16 v207, v135, v33, 0
v_dot2_f32_bf16 v208, v96, v33, 0
v_dot2_f32_bf16 v209, v98, v33, 0
v_dot2c_f32_bf16 v192, v136, v40
v_dot2c_f32_bf16 v193, v136, v41
v_dot2c_f32_bf16 v194, v137, v40
v_dot2c_f32_bf16 v195, v137, v41
s_mov_b32 m0, s70
s_mov_b32 s64, s68
s_add_u32 s68, s68, 16384
s_add_u32 s70, s70, 16384
s_cmp_ge_u32 s70, 163840
s_cselect_b32 s70, s80, s70
buffer_load_dwordx4 v4, s[24:27], s64 offen offset:0 sc1 lds
v_dot2c_f32_bf16 v196, v138, v40
v_dot2c_f32_bf16 v197, v138, v41
v_dot2c_f32_bf16 v198, v139, v40
v_dot2c_f32_bf16 v199, v139, v41
v_dot2c_f32_bf16 v200, v140, v40
v_dot2c_f32_bf16 v201, v140, v41
v_dot2c_f32_bf16 v202, v141, v40
v_dot2c_f32_bf16 v203, v141, v41
v_dot2c_f32_bf16 v204, v142, v40
v_dot2c_f32_bf16 v205, v142, v41
v_dot2c_f32_bf16 v206, v143, v40
v_dot2c_f32_bf16 v207, v143, v41
v_dot2c_f32_bf16 v208, v100, v41
v_dot2c_f32_bf16 v209, v102, v41
v_dot2c_f32_bf16 v192, v144, v48
buffer_load_dwordx4 v4, s[24:27], s64 offen offset:1024 sc1 lds
v_dot2c_f32_bf16 v193, v144, v49
v_dot2c_f32_bf16 v194, v145, v48
v_dot2c_f32_bf16 v195, v145, v49
v_dot2c_f32_bf16 v196, v146, v48
v_dot2c_f32_bf16 v197, v146, v49
v_dot2c_f32_bf16 v198, v147, v48
v_dot2c_f32_bf16 v199, v147, v49
v_dot2c_f32_bf16 v200, v148, v48
v_dot2c_f32_bf16 v201, v148, v49
v_dot2c_f32_bf16 v202, v149, v48
v_dot2c_f32_bf16 v203, v149, v49
v_dot2c_f32_bf16 v204, v150, v48
v_dot2c_f32_bf16 v205, v150, v49
v_dot2c_f32_bf16 v206, v151, v48
v_dot2c_f32_bf16 v207, v151, v49
buffer_load_dwordx4 v4, s[24:27], s64 offen offset:2048 sc1 lds
v_dot2c_f32_bf16 v208, v104, v49
v_dot2c_f32_bf16 v209, v106, v49
v_dot2c_f32_bf16 v192, v152, v56
v_dot2c_f32_bf16 v193, v152, v57
v_dot2c_f32_bf16 v194, v153, v56
v_dot2c_f32_bf16 v195, v153, v57
v_dot2c_f32_bf16 v196, v154, v56
v_dot2c_f32_bf16 v197, v154, v57
v_dot2c_f32_bf16 v198, v155, v56
v_dot2c_f32_bf16 v199, v155, v57
v_dot2c_f32_bf16 v200, v156, v56
v_dot2c_f32_bf16 v201, v156, v57
v_dot2c_f32_bf16 v202, v157, v56
v_dot2c_f32_bf16 v203, v157, v57
v_dot2c_f32_bf16 v204, v158, v56
buffer_load_dword v12, v13, s[24:27], s75 offen sc1
v_dot2c_f32_bf16 v205, v158, v57
v_dot2c_f32_bf16 v206, v159, v56
v_dot2c_f32_bf16 v207, v159, v57
v_dot2c_f32_bf16 v208, v108, v57
v_dot2c_f32_bf16 v209, v110, v57
v_dot2c_f32_bf16 v192, v160, v64
v_dot2c_f32_bf16 v193, v160, v65
v_dot2c_f32_bf16 v194, v161, v64
v_dot2c_f32_bf16 v195, v161, v65
v_dot2c_f32_bf16 v196, v162, v64
v_dot2c_f32_bf16 v197, v162, v65
v_dot2c_f32_bf16 v198, v163, v64
v_dot2c_f32_bf16 v199, v163, v65
v_dot2c_f32_bf16 v200, v164, v64
v_dot2c_f32_bf16 v201, v164, v65
buffer_load_dwordx4 v4, s[24:27], s64 offen offset:3072 sc1 lds
v_dot2c_f32_bf16 v202, v165, v64
v_dot2c_f32_bf16 v203, v165, v65
v_dot2c_f32_bf16 v204, v166, v64
v_dot2c_f32_bf16 v205, v166, v65
v_dot2c_f32_bf16 v206, v167, v64
v_dot2c_f32_bf16 v207, v167, v65
v_dot2c_f32_bf16 v208, v112, v65
v_dot2c_f32_bf16 v209, v114, v65
v_dot2c_f32_bf16 v192, v168, v72
v_dot2c_f32_bf16 v193, v168, v73
v_dot2c_f32_bf16 v194, v169, v72
v_dot2c_f32_bf16 v195, v169, v73
v_dot2c_f32_bf16 v196, v170, v72
v_dot2c_f32_bf16 v197, v170, v73
v_dot2c_f32_bf16 v198, v171, v72
s_mov_b32 m0, s70
s_mov_b32 s64, s68
s_add_u32 s68, s68, 16384
s_add_u32 s70, s70, 16384
s_cmp_ge_u32 s70, 163840
s_cselect_b32 s70, s80, s70
buffer_load_dwordx4 v4, s[24:27], s64 offen offset:0 sc1 lds
v_dot2c_f32_bf16 v199, v171, v73
v_dot2c_f32_bf16 v200, v172, v72
v_dot2c_f32_bf16 v201, v172, v73
v_dot2c_f32_bf16 v202, v173, v72
v_dot2c_f32_bf16 v203, v173, v73
v_dot2c_f32_bf16 v204, v174, v72
v_dot2c_f32_bf16 v205, v174, v73
v_dot2c_f32_bf16 v206, v175, v72
v_dot2c_f32_bf16 v207, v175, v73
v_dot2c_f32_bf16 v208, v116, v73
v_dot2c_f32_bf16 v209, v118, v73
v_dot2c_f32_bf16 v192, v176, v80
v_dot2c_f32_bf16 v193, v176, v81
v_dot2c_f32_bf16 v194, v177, v80
v_dot2c_f32_bf16 v195, v177, v81
buffer_load_dwordx4 v4, s[24:27], s64 offen offset:1024 sc1 lds
v_dot2c_f32_bf16 v196, v178, v80
v_dot2c_f32_bf16 v197, v178, v81
v_dot2c_f32_bf16 v198, v179, v80
v_dot2c_f32_bf16 v199, v179, v81
v_dot2c_f32_bf16 v200, v180, v80
v_dot2c_f32_bf16 v201, v180, v81
v_dot2c_f32_bf16 v202, v181, v80
v_dot2c_f32_bf16 v203, v181, v81
v_dot2c_f32_bf16 v204, v182, v80
v_dot2c_f32_bf16 v205, v182, v81
v_dot2c_f32_bf16 v206, v183, v80
v_dot2c_f32_bf16 v207, v183, v81
v_dot2c_f32_bf16 v208, v120, v81
v_dot2c_f32_bf16 v209, v122, v81
v_dot2c_f32_bf16 v192, v184, v88
buffer_load_dwordx4 v4, s[24:27], s64 offen offset:2048 sc1 lds
v_dot2c_f32_bf16 v193, v184, v89
v_dot2c_f32_bf16 v194, v185, v88
v_dot2c_f32_bf16 v195, v185, v89
v_dot2c_f32_bf16 v196, v186, v88
v_dot2c_f32_bf16 v197, v186, v89
v_dot2c_f32_bf16 v198, v187, v88
v_dot2c_f32_bf16 v199, v187, v89
v_dot2c_f32_bf16 v200, v188, v88
v_dot2c_f32_bf16 v201, v188, v89
v_dot2c_f32_bf16 v202, v189, v88
v_dot2c_f32_bf16 v203, v189, v89
v_dot2c_f32_bf16 v204, v190, v88
v_dot2c_f32_bf16 v205, v190, v89
v_dot2c_f32_bf16 v206, v191, v88
v_dot2c_f32_bf16 v207, v191, v89
buffer_load_dwordx4 v4, s[24:27], s64 offen offset:3072 sc1 lds
v_dot2c_f32_bf16 v208, v124, v89
v_dot2c_f32_bf16 v209, v126, v89
v_lshrrev_b32 v9, 5, v5
v_mul_u32_u24 v9, 303104, v9
v_and_b32 v11, 1, v3
v_lshl_add_u32 v9, v11, 10, v9
v_lshl_add_u32 v9, v2, 4, v9
v_mul_f32 v192, v10, v192
v_mul_f32 v193, v10, v193
v_mul_f32 v194, v10, v194
v_mul_f32 v195, v10, v195
v_mul_f32 v196, v10, v196
v_mul_f32 v197, v10, v197
v_mul_f32 v198, v10, v198
v_mul_f32 v199, v10, v199
v_mul_f32 v200, v10, v200
v_mul_f32 v201, v10, v201
v_mul_f32 v202, v10, v202
v_mul_f32 v203, v10, v203
v_mul_f32 v204, v10, v204
v_mul_f32 v205, v10, v205
v_mul_f32 v206, v10, v206
v_mul_f32 v207, v10, v207
v_mul_f32 v208, v10, v208
v_mul_f32 v209, v10, v209
v_cvt_pk_bf16_f32 v192, v192, v193
v_cvt_pk_bf16_f32 v193, v194, v195
v_cvt_pk_bf16_f32 v194, v196, v197
v_cvt_pk_bf16_f32 v195, v198, v199
v_cvt_pk_bf16_f32 v196, v200, v201
v_cvt_pk_bf16_f32 v197, v202, v203
v_cvt_pk_bf16_f32 v198, v204, v205
v_cvt_pk_bf16_f32 v199, v206, v207
v_cvt_pk_bf16_f32 v200, v208, v209
s_add_u32 s53, s53, 65536
s_bfe_u32 s54, s4, 131073
s_lshl_b32 s54, s54, 11
s_add_u32 s54, s54, s53
s_and_b32 s55, s4, 1
s_lshl_b32 s55, s55, 9
s_add_u32 s54, s54, s55
s_lshl2_add_u32 s52, s85, s86
s_lshl2_add_u32 s69, s52, s3
s_mul_i32 s69, s69, 28672
s_add_u32 s69, s69, 76546048
s_lshr_b32 s73, s52, 1
s_lshl_b32 s73, s73, 10
s_and_b32 s52, s52, 1
s_lshl_b32 s52, s52, 7
s_add_u32 s73, s73, s52
s_lshl2_add_u32 s73, s3, s73
s_add_u32 s73, s73, 75498112
ds_read_b128 v[144:147], v7 offset:0
ds_read_b128 v[148:151], v7 offset:1024
ds_read_b128 v[152:155], v7 offset:2048
ds_read_b128 v[156:159], v7 offset:3072
ds_read_b128 v[160:163], v7 offset:4096
ds_read_b128 v[164:167], v7 offset:5120
ds_read_b128 v[168:171], v7 offset:6144
ds_read_b128 v[172:175], v7 offset:7168
v_mov_b32 v10, 0
s_waitcnt vmcnt(5)
v_cmp_gt_u32 vcc, 8, v12
s_mov_b32 s92, 0
s_nop 3
s_cbranch_vccz L_ZBX
L_ZB:
s_sleep 2
buffer_load_dword v12, v13, s[24:27], s75 offen sc1
s_add_u32 s92, s92, 1
s_waitcnt vmcnt(0)
v_cmp_gt_u32 vcc, 8, v12
s_cmp_gt_u32 s92, 1048576
s_cbranch_scc1 L_ZBX
s_nop 2
s_cbranch_vccnz L_ZB
L_ZBX:
s_xor_b32 s65, s82, 0
s_add_u32 s65, s65, s77
buffer_load_dwordx4 a[0:3], v4, s[24:27], s65 offen offset:0 sc1
buffer_load_dwordx4 a[8:11], v4, s[24:27], s65 offen offset:2048 sc1
s_xor_b32 s93, s82, 0
s_add_u32 s93, s93, s81
buffer_load_dwordx4 a[4:7], v4, s[24:27], s93 offen offset:0 sc1
buffer_load_dwordx4 a[12:15], v4, s[24:27], s93 offen offset:2048 sc1
buffer_load_dwordx4 a[16:19], v14, s[24:27], s65 offen offset:0 sc1
buffer_load_dwordx4 a[24:27], v14, s[24:27], s65 offen offset:2048 sc1
buffer_load_dwordx4 a[20:23], v14, s[24:27], s93 offen offset:0 sc1
buffer_load_dwordx4 a[28:31], v14, s[24:27], s93 offen offset:2048 sc1
buffer_store_dwordx4 v[192:195], v9, s[24:27], s54 offen sc1
buffer_store_dwordx4 v[196:199], v9, s[24:27], s54 offen offset:256 sc1
s_bfe_u32 s55, s4, 65538
s_lshl_b32 s55, s55, 8
s_add_u32 s54, s53, s55
s_and_b32 s55, s4, 3
s_lshl2_add_u32 s54, s55, s54
s_add_u32 s54, s54, 8192
buffer_store_dword v200, v9, s[24:27], s54 offen sc1
s_waitcnt vmcnt(9) lgkmcnt(6)
v_mfma_f32_16x16x32_bf16 v[120:123], v[144:147], a[0:3], 0
s_waitcnt vmcnt(7)
s_add_u32 s91, s91, 16384
ds_read_b128 v[176:179], v7 offset:8192
v_mfma_f32_16x16x32_bf16 v[120:123], v[148:151], a[8:11], v[120:123]
s_xor_b32 s65, s82, 8192
s_add_u32 s65, s65, s77
ds_read_b128 v[180:183], v7 offset:9216
v_mfma_f32_16x16x32_bf16 v[124:127], v[148:151], a[12:15], 0
s_waitcnt lgkmcnt(6)
ds_read_b128 v[184:187], v7 offset:10240
v_mfma_f32_16x16x32_bf16 v[124:127], v[144:147], a[4:7], v[124:127]
buffer_load_dwordx4 a[32:35], v4, s[24:27], s65 offen offset:0 sc1
v_mfma_f32_16x16x32_bf16 v[72:75], v[152:155], a[0:3], 0
s_cmp_ge_u32 s91, 163840
s_cselect_b32 s91, 0, s91
ds_read_b128 v[188:191], v7 offset:11264
v_mfma_f32_16x16x32_bf16 v[72:75], v[156:159], a[8:11], v[72:75]
s_waitcnt lgkmcnt(6)
v_add_u32 v8, s91, v4
v_mfma_f32_16x16x32_bf16 v[76:79], v[156:159], a[12:15], 0
buffer_load_dwordx4 a[40:43], v4, s[24:27], s65 offen offset:2048 sc1
v_mfma_f32_16x16x32_bf16 v[76:79], v[152:155], a[4:7], v[76:79]
s_xor_b32 s93, s82, 8192
s_add_u32 s93, s93, s81
ds_read_b128 v[144:147], v7 offset:12288
v_mfma_f32_16x16x32_bf16 v[80:83], v[160:163], a[0:3], 0
ds_read_b128 v[148:151], v7 offset:13312
v_mfma_f32_16x16x32_bf16 v[80:83], v[164:167], a[8:11], v[80:83]
buffer_load_dwordx4 a[36:39], v4, s[24:27], s93 offen offset:0 sc1
v_mfma_f32_16x16x32_bf16 v[84:87], v[164:167], a[12:15], 0
ds_read_b128 v[152:155], v7 offset:14336
v_mfma_f32_16x16x32_bf16 v[84:87], v[160:163], a[4:7], v[84:87]
s_waitcnt lgkmcnt(7)
v_mfma_f32_16x16x32_bf16 v[88:91], v[168:171], a[0:3], 0
buffer_load_dwordx4 a[44:47], v4, s[24:27], s93 offen offset:2048 sc1
v_mfma_f32_16x16x32_bf16 v[88:91], v[172:175], a[8:11], v[88:91]
ds_read_b128 v[156:159], v7 offset:15360
v_mfma_f32_16x16x32_bf16 v[92:95], v[172:175], a[12:15], 0
s_waitcnt lgkmcnt(6)
s_add_u32 s91, s91, 16384
ds_read_b128 v[160:163], v8 offset:0
v_mfma_f32_16x16x32_bf16 v[92:95], v[168:171], a[4:7], v[92:95]
buffer_load_dwordx4 a[48:51], v14, s[24:27], s65 offen offset:0 sc1
v_mfma_f32_16x16x32_bf16 v[96:99], v[176:179], a[0:3], 0
s_cmp_ge_u32 s91, 163840
s_cselect_b32 s91, 0, s91
ds_read_b128 v[164:167], v8 offset:1024
v_mfma_f32_16x16x32_bf16 v[96:99], v[180:183], a[8:11], v[96:99]
v_add_u32 v7, s91, v4
v_mfma_f32_16x16x32_bf16 v[100:103], v[180:183], a[12:15], 0
buffer_load_dwordx4 a[56:59], v14, s[24:27], s65 offen offset:2048 sc1
v_mfma_f32_16x16x32_bf16 v[100:103], v[176:179], a[4:7], v[100:103]
s_waitcnt lgkmcnt(6)
ds_read_b128 v[168:171], v8 offset:2048
v_mfma_f32_16x16x32_bf16 v[104:107], v[184:187], a[0:3], 0
ds_read_b128 v[172:175], v8 offset:3072
v_mfma_f32_16x16x32_bf16 v[104:107], v[188:191], a[8:11], v[104:107]
v_mfma_f32_16x16x32_bf16 v[108:111], v[188:191], a[12:15], 0
buffer_load_dwordx4 a[52:55], v14, s[24:27], s93 offen offset:0 sc1
v_mfma_f32_16x16x32_bf16 v[108:111], v[184:187], a[4:7], v[108:111]
s_waitcnt lgkmcnt(6)
ds_read_b128 v[176:179], v8 offset:4096
v_mfma_f32_16x16x32_bf16 v[112:115], v[144:147], a[0:3], 0
ds_read_b128 v[180:183], v8 offset:5120
v_mfma_f32_16x16x32_bf16 v[112:115], v[148:151], a[8:11], v[112:115]
v_mfma_f32_16x16x32_bf16 v[116:119], v[148:151], a[12:15], 0
buffer_load_dwordx4 a[60:63], v14, s[24:27], s93 offen offset:2048 sc1
v_mfma_f32_16x16x32_bf16 v[116:119], v[144:147], a[4:7], v[116:119]
s_waitcnt lgkmcnt(6) vmcnt(13)
ds_read_b128 v[184:187], v8 offset:6144
v_mfma_f32_16x16x32_bf16 v[120:123], v[152:155], a[16:19], v[120:123]
ds_read_b128 v[188:191], v8 offset:7168
v_mfma_f32_16x16x32_bf16 v[120:123], v[156:159], a[24:27], v[120:123]
s_waitcnt vmcnt(11)
v_mfma_f32_16x16x32_bf16 v[124:127], v[156:159], a[28:31], v[124:127]
ds_read_b128 v[144:147], v8 offset:8192
v_mfma_f32_16x16x32_bf16 v[124:127], v[152:155], a[20:23], v[124:127]
s_waitcnt lgkmcnt(7)
v_mfma_f32_16x16x32_bf16 v[72:75], v[160:163], a[16:19], v[72:75]
ds_read_b128 v[148:151], v8 offset:9216
v_mfma_f32_16x16x32_bf16 v[72:75], v[164:167], a[24:27], v[72:75]
v_mfma_f32_16x16x32_bf16 v[76:79], v[164:167], a[28:31], v[76:79]
ds_read_b128 v[152:155], v8 offset:10240
v_mfma_f32_16x16x32_bf16 v[76:79], v[160:163], a[20:23], v[76:79]
s_waitcnt lgkmcnt(7)
v_mfma_f32_16x16x32_bf16 v[80:83], v[168:171], a[16:19], v[80:83]
ds_read_b128 v[156:159], v8 offset:11264
v_mfma_f32_16x16x32_bf16 v[80:83], v[172:175], a[24:27], v[80:83]
v_mfma_f32_16x16x32_bf16 v[84:87], v[172:175], a[28:31], v[84:87]
ds_read_b128 v[160:163], v8 offset:12288
v_mfma_f32_16x16x32_bf16 v[84:87], v[168:171], a[20:23], v[84:87]
s_waitcnt lgkmcnt(7)
v_mfma_f32_16x16x32_bf16 v[88:91], v[176:179], a[16:19], v[88:91]
s_xor_b32 s65, s82, 16384
s_add_u32 s65, s65, s77
ds_read_b128 v[164:167], v8 offset:13312
v_mfma_f32_16x16x32_bf16 v[88:91], v[180:183], a[24:27], v[88:91]
v_mfma_f32_16x16x32_bf16 v[92:95], v[180:183], a[28:31], v[92:95]
s_waitcnt lgkmcnt(6)
ds_read_b128 v[168:171], v8 offset:14336
v_add_u32 v11, s70, v4
v_mfma_f32_16x16x32_bf16 v[92:95], v[176:179], a[20:23], v[92:95]
s_add_u32 s70, s70, 16384
s_cmp_ge_u32 s70, 163840
s_cselect_b32 s70, s80, s70
v_mfma_f32_16x16x32_bf16 v[96:99], v[184:187], a[16:19], v[96:99]
buffer_load_dwordx4 a[64:67], v4, s[24:27], s65 offen offset:0 sc1
v_mfma_f32_16x16x32_bf16 v[96:99], v[188:191], a[24:27], v[96:99]
s_barrier
v_mfma_f32_16x16x32_bf16 v[100:103], v[188:191], a[28:31], v[100:103]
s_waitcnt lgkmcnt(5)
ds_read_b128 v[172:175], v8 offset:15360
v_mfma_f32_16x16x32_bf16 v[100:103], v[184:187], a[20:23], v[100:103]
buffer_load_dwordx4 a[72:75], v4, s[24:27], s65 offen offset:2048 sc1
v_mfma_f32_16x16x32_bf16 v[104:107], v[144:147], a[16:19], v[104:107]
ds_write_b64 v11, a[96:97] offset:0
v_mfma_f32_16x16x32_bf16 v[104:107], v[148:151], a[24:27], v[104:107]
s_xor_b32 s93, s82, 16384
s_add_u32 s93, s93, s81
ds_read_b128 v[176:179], v7 offset:0
v_mfma_f32_16x16x32_bf16 v[108:111], v[148:151], a[28:31], v[108:111]
buffer_load_dwordx4 a[68:71], v4, s[24:27], s93 offen offset:0 sc1
v_mfma_f32_16x16x32_bf16 v[108:111], v[144:147], a[20:23], v[108:111]
s_waitcnt lgkmcnt(6)
s_add_u32 s91, s91, 16384
ds_read_b128 v[180:183], v7 offset:1024
v_mfma_f32_16x16x32_bf16 v[112:115], v[152:155], a[16:19], v[112:115]
ds_write_b64 v11, a[98:99] offset:8
v_mfma_f32_16x16x32_bf16 v[112:115], v[156:159], a[24:27], v[112:115]
s_cmp_ge_u32 s91, 163840
s_cselect_b32 s91, 0, s91
ds_read_b128 v[184:187], v7 offset:2048
v_mfma_f32_16x16x32_bf16 v[116:119], v[156:159], a[28:31], v[116:119]
buffer_load_dwordx4 a[76:79], v4, s[24:27], s93 offen offset:2048 sc1
v_mfma_f32_16x16x32_bf16 v[116:119], v[152:155], a[20:23], v[116:119]
s_waitcnt lgkmcnt(7) vmcnt(10)
ds_read_b128 v[188:191], v7 offset:3072
v_add_u32 v8, s91, v4
v_mfma_f32_16x16x32_bf16 v[120:123], v[160:163], a[32:35], v[120:123]
s_waitcnt vmcnt(12)
s_waitcnt vmcnt(8)
ds_read_b128 v[144:147], v7 offset:4096
v_mfma_f32_16x16x32_bf16 v[120:123], v[164:167], a[40:43], v[120:123]
buffer_atomic_add v1, v0, s[24:27], s74 offen offset:4 sc1
v_mfma_f32_16x16x32_bf16 v[124:127], v[164:167], a[44:47], v[124:127]
ds_write_b64 v11, a[100:101] offset:1024
v_mfma_f32_16x16x32_bf16 v[124:127], v[160:163], a[36:39], v[124:127]
s_waitcnt lgkmcnt(8)
ds_read_b128 v[148:151], v7 offset:5120
v_mfma_f32_16x16x32_bf16 v[72:75], v[168:171], a[32:35], v[72:75]
ds_read_b128 v[152:155], v7 offset:6144
v_mfma_f32_16x16x32_bf16 v[72:75], v[172:175], a[40:43], v[72:75]
s_waitcnt lgkmcnt(7)
ds_read_b128 v[156:159], v7 offset:7168
v_mfma_f32_16x16x32_bf16 v[76:79], v[172:175], a[44:47], v[76:79]
ds_write_b64 v11, a[102:103] offset:1032
v_mfma_f32_16x16x32_bf16 v[76:79], v[168:171], a[36:39], v[76:79]
buffer_load_dwordx4 a[80:83], v14, s[24:27], s65 offen offset:0 sc1
v_mfma_f32_16x16x32_bf16 v[80:83], v[176:179], a[32:35], v[80:83]
ds_read_b128 v[160:163], v7 offset:8192
v_mfma_f32_16x16x32_bf16 v[80:83], v[180:183], a[40:43], v[80:83]
s_waitcnt lgkmcnt(7)
ds_read_b128 v[164:167], v7 offset:9216
v_mfma_f32_16x16x32_bf16 v[84:87], v[180:183], a[44:47], v[84:87]
ds_write_b64 v11, a[104:105] offset:2048
v_mfma_f32_16x16x32_bf16 v[84:87], v[176:179], a[36:39], v[84:87]
buffer_load_dwordx4 a[88:91], v14, s[24:27], s65 offen offset:2048 sc1
v_mfma_f32_16x16x32_bf16 v[88:91], v[184:187], a[32:35], v[88:91]
ds_read_b128 v[168:171], v7 offset:10240
v_mfma_f32_16x16x32_bf16 v[88:91], v[188:191], a[40:43], v[88:91]
s_waitcnt lgkmcnt(7)
ds_read_b128 v[172:175], v7 offset:11264
v_mfma_f32_16x16x32_bf16 v[92:95], v[188:191], a[44:47], v[92:95]
ds_write_b64 v11, a[106:107] offset:2056
v_mfma_f32_16x16x32_bf16 v[92:95], v[184:187], a[36:39], v[92:95]
buffer_load_dwordx4 a[84:87], v14, s[24:27], s93 offen offset:0 sc1
v_mfma_f32_16x16x32_bf16 v[96:99], v[144:147], a[32:35], v[96:99]
ds_read_b128 v[176:179], v7 offset:12288
v_mfma_f32_16x16x32_bf16 v[96:99], v[148:151], a[40:43], v[96:99]
s_waitcnt lgkmcnt(8)
ds_read_b128 v[180:183], v7 offset:13312
v_mfma_f32_16x16x32_bf16 v[100:103], v[148:151], a[44:47], v[100:103]
ds_write_b64 v11, a[108:109] offset:3072
v_mfma_f32_16x16x32_bf16 v[100:103], v[144:147], a[36:39], v[100:103]
buffer_load_dwordx4 a[92:95], v14, s[24:27], s93 offen offset:2048 sc1
v_mfma_f32_16x16x32_bf16 v[104:107], v[152:155], a[32:35], v[104:107]
ds_read_b128 v[184:187], v7 offset:14336
v_mfma_f32_16x16x32_bf16 v[104:107], v[156:159], a[40:43], v[104:107]
ds_read_b128 v[188:191], v7 offset:15360
v_mfma_f32_16x16x32_bf16 v[108:111], v[156:159], a[44:47], v[108:111]
ds_write_b64 v11, a[110:111] offset:3080
v_mfma_f32_16x16x32_bf16 v[108:111], v[152:155], a[36:39], v[108:111]
s_waitcnt lgkmcnt(10)
s_add_u32 s91, s91, 16384
ds_read_b128 v[144:147], v8 offset:0
v_mfma_f32_16x16x32_bf16 v[112:115], v[160:163], a[32:35], v[112:115]
s_xor_b32 s65, s82, 24576
s_add_u32 s65, s65, s77
ds_read_b128 v[148:151], v8 offset:1024
v_mfma_f32_16x16x32_bf16 v[112:115], v[164:167], a[40:43], v[112:115]
s_cmp_ge_u32 s91, 163840
s_cselect_b32 s91, 0, s91
v_add_u32 v7, s91, v4
v_mfma_f32_16x16x32_bf16 v[116:119], v[164:167], a[44:47], v[116:119]
buffer_load_dwordx4 a[192:195], v4, s[24:27], s65 offen offset:0 sc1
v_mfma_f32_16x16x32_bf16 v[116:119], v[160:163], a[36:39], v[116:119]
s_waitcnt lgkmcnt(9) vmcnt(12)
ds_read_b128 v[152:155], v8 offset:2048
v_mfma_f32_16x16x32_bf16 v[120:123], v[168:171], a[48:51], v[120:123]
ds_read_b128 v[156:159], v8 offset:3072
v_mfma_f32_16x16x32_bf16 v[120:123], v[172:175], a[56:59], v[120:123]
s_waitcnt vmcnt(10)
v_mfma_f32_16x16x32_bf16 v[124:127], v[172:175], a[60:63], v[124:127]
buffer_load_dwordx4 a[200:203], v4, s[24:27], s65 offen offset:2048 sc1
v_mfma_f32_16x16x32_bf16 v[124:127], v[168:171], a[52:55], v[124:127]
s_waitcnt lgkmcnt(8)
ds_read_b128 v[160:163], v8 offset:4096
v_mfma_f32_16x16x32_bf16 v[72:75], v[176:179], a[48:51], v[72:75]
s_xor_b32 s93, s82, 24576
s_add_u32 s93, s93, s81
ds_read_b128 v[164:167], v8 offset:5120
v_mfma_f32_16x16x32_bf16 v[72:75], v[180:183], a[56:59], v[72:75]
v_mfma_f32_16x16x32_bf16 v[76:79], v[180:183], a[60:63], v[76:79]
buffer_load_dwordx4 a[196:199], v4, s[24:27], s93 offen offset:0 sc1
v_mfma_f32_16x16x32_bf16 v[76:79], v[176:179], a[52:55], v[76:79]
s_waitcnt lgkmcnt(7)
ds_read_b128 v[168:171], v8 offset:6144
v_mfma_f32_16x16x32_bf16 v[80:83], v[184:187], a[48:51], v[80:83]
ds_read_b128 v[172:175], v8 offset:7168
v_mfma_f32_16x16x32_bf16 v[80:83], v[188:191], a[56:59], v[80:83]
v_mfma_f32_16x16x32_bf16 v[84:87], v[188:191], a[60:63], v[84:87]
buffer_load_dwordx4 a[204:207], v4, s[24:27], s93 offen offset:2048 sc1
v_mfma_f32_16x16x32_bf16 v[84:87], v[184:187], a[52:55], v[84:87]
s_waitcnt lgkmcnt(6)
ds_read_b128 v[176:179], v8 offset:8192
v_mfma_f32_16x16x32_bf16 v[88:91], v[144:147], a[48:51], v[88:91]
ds_read_b128 v[180:183], v8 offset:9216
v_mfma_f32_16x16x32_bf16 v[88:91], v[148:151], a[56:59], v[88:91]
v_mfma_f32_16x16x32_bf16 v[92:95], v[148:151], a[60:63], v[92:95]
ds_read_b128 v[184:187], v8 offset:10240
v_mfma_f32_16x16x32_bf16 v[92:95], v[144:147], a[52:55], v[92:95]
s_waitcnt lgkmcnt(7)
v_mfma_f32_16x16x32_bf16 v[96:99], v[152:155], a[48:51], v[96:99]
s_add_u32 s52, s84, 1
ds_read_b128 v[188:191], v8 offset:11264
v_mfma_f32_16x16x32_bf16 v[96:99], v[156:159], a[56:59], v[96:99]
v_mfma_f32_16x16x32_bf16 v[100:103], v[156:159], a[60:63], v[100:103]
buffer_load_dwordx4 a[208:211], v14, s[24:27], s65 offen offset:0 sc1
v_mfma_f32_16x16x32_bf16 v[100:103], v[152:155], a[52:55], v[100:103]
s_and_b32 s52, s52, 3
s_waitcnt lgkmcnt(6)
ds_read_b128 v[144:147], v8 offset:12288
v_mfma_f32_16x16x32_bf16 v[104:107], v[160:163], a[48:51], v[104:107]
ds_read_b128 v[148:151], v8 offset:13312
v_mfma_f32_16x16x32_bf16 v[104:107], v[164:167], a[56:59], v[104:107]
s_waitcnt lgkmcnt(6)
v_mfma_f32_16x16x32_bf16 v[108:111], v[164:167], a[60:63], v[108:111]
s_mul_i32 s52, s52, 6144
ds_read_b128 v[152:155], v8 offset:14336
v_add_u32 v11, s70, v4
v_mfma_f32_16x16x32_bf16 v[108:111], v[160:163], a[52:55], v[108:111]
s_add_u32 s70, s70, 16384
s_cmp_ge_u32 s70, 163840
s_cselect_b32 s70, s80, s70
v_mfma_f32_16x16x32_bf16 v[112:115], v[168:171], a[48:51], v[112:115]
s_waitcnt vmcnt(50)
ds_read_b128 v[156:159], v8 offset:15360
v_mfma_f32_16x16x32_bf16 v[112:115], v[172:175], a[56:59], v[112:115]
s_barrier
v_mfma_f32_16x16x32_bf16 v[116:119], v[172:175], a[60:63], v[116:119]
s_add_u32 s52, s52, s69
s_waitcnt lgkmcnt(6) vmcnt(12)
ds_read_b128 v[160:163], v7 offset:0
v_mfma_f32_16x16x32_bf16 v[116:119], v[168:171], a[52:55], v[116:119]
buffer_load_dwordx4 a[216:219], v14, s[24:27], s65 offen offset:2048 sc1
v_mfma_f32_16x16x32_bf16 v[120:123], v[176:179], a[64:67], v[120:123]
ds_write_b64 v11, a[112:113] offset:0
v_mfma_f32_16x16x32_bf16 v[120:123], v[180:183], a[72:75], v[120:123]
s_add_u32 s52, s52, 0
s_waitcnt vmcnt(11)
ds_read_b128 v[164:167], v7 offset:1024
v_mfma_f32_16x16x32_bf16 v[124:127], v[180:183], a[76:79], v[124:127]
buffer_load_dwordx4 a[212:215], v14, s[24:27], s93 offen offset:0 sc1
v_mfma_f32_16x16x32_bf16 v[124:127], v[176:179], a[68:71], v[124:127]
s_waitcnt lgkmcnt(7)
s_add_u32 s91, s91, 16384
ds_read_b128 v[168:171], v7 offset:2048
v_mfma_f32_16x16x32_bf16 v[72:75], v[184:187], a[64:67], v[72:75]
s_add_u32 s53, s84, 2
ds_read_b128 v[172:175], v7 offset:3072
v_mfma_f32_16x16x32_bf16 v[72:75], v[188:191], a[72:75], v[72:75]
ds_write_b64 v11, a[114:115] offset:8
v_mfma_f32_16x16x32_bf16 v[76:79], v[188:191], a[76:79], v[76:79]
buffer_load_dwordx4 a[220:223], v14, s[24:27], s93 offen offset:2048 sc1
v_mfma_f32_16x16x32_bf16 v[76:79], v[184:187], a[68:71], v[76:79]
s_and_b32 s53, s53, 3
s_waitcnt lgkmcnt(8)
ds_read_b128 v[176:179], v7 offset:4096
v_mfma_f32_16x16x32_bf16 v[80:83], v[144:147], a[64:67], v[80:83]
s_xor_b32 s65, s82, 32768
s_add_u32 s65, s65, s77
ds_read_b128 v[180:183], v7 offset:5120
v_mfma_f32_16x16x32_bf16 v[80:83], v[148:151], a[72:75], v[80:83]
ds_write_b64 v11, a[116:117] offset:1024
v_mfma_f32_16x16x32_bf16 v[84:87], v[148:151], a[76:79], v[84:87]
s_mul_i32 s53, s53, 6144
s_waitcnt lgkmcnt(9)
ds_read_b128 v[184:187], v7 offset:6144
v_mfma_f32_16x16x32_bf16 v[84:87], v[144:147], a[68:71], v[84:87]
buffer_load_dwordx4 a[224:227], v4, s[24:27], s65 offen offset:0 sc1
v_mfma_f32_16x16x32_bf16 v[88:91], v[152:155], a[64:67], v[88:91]
s_cmp_ge_u32 s91, 163840
L_PAD11:
s_cbranch_execz L_MAIN
s_cselect_b32 s91, 0, s91
ds_read_b128 v[188:191], v7 offset:7168
v_mfma_f32_16x16x32_bf16 v[88:91], v[156:159], a[72:75], v[88:91]
s_add_u32 s53, s53, s69
s_waitcnt lgkmcnt(8)
v_add_u32 v8, s91, v4
v_mfma_f32_16x16x32_bf16 v[92:95], v[156:159], a[76:79], v[92:95]
ds_write_b64 v11, a[118:119] offset:1032
v_mfma_f32_16x16x32_bf16 v[92:95], v[152:155], a[68:71], v[92:95]
buffer_load_dwordx4 a[232:235], v4, s[24:27], s65 offen offset:2048 sc1
v_mfma_f32_16x16x32_bf16 v[96:99], v[160:163], a[64:67], v[96:99]
s_add_u32 s53, s53, 2048
s_xor_b32 s93, s82, 32768
s_add_u32 s93, s93, s81
v_mfma_f32_16x16x32_bf16 v[96:99], v[164:167], a[72:75], v[96:99]
ds_read_b128 v[144:147], v7 offset:8192
v_mfma_f32_16x16x32_bf16 v[100:103], v[164:167], a[76:79], v[100:103]
ds_write_b64 v11, a[120:121] offset:2048
v_mfma_f32_16x16x32_bf16 v[100:103], v[160:163], a[68:71], v[100:103]
s_add_u32 s54, s84, 3
s_waitcnt lgkmcnt(9) vmcnt(12)
ds_read_b128 v[148:151], v7 offset:9216
v_mfma_f32_16x16x32_bf16 v[120:123], v[168:171], a[80:83], v[120:123]
buffer_load_dwordx4 a[228:231], v4, s[24:27], s93 offen offset:0 sc1
v_mfma_f32_16x16x32_bf16 v[120:123], v[172:175], a[88:91], v[120:123]
s_waitcnt vmcnt(11)
ds_read_b128 v[152:155], v7 offset:10240
v_mfma_f32_16x16x32_bf16 v[124:127], v[172:175], a[92:95], v[124:127]
s_and_b32 s54, s54, 3
s_waitcnt lgkmcnt(8)
ds_read_b128 v[156:159], v7 offset:11264
v_mfma_f32_16x16x32_bf16 v[124:127], v[168:171], a[84:87], v[124:127]
ds_write_b64 v11, a[122:123] offset:2056
v_mfma_f32_16x16x32_bf16 v[72:75], v[176:179], a[80:83], v[72:75]
buffer_load_dwordx4 a[236:239], v4, s[24:27], s93 offen offset:2048 sc1
v_mfma_f32_16x16x32_bf16 v[72:75], v[180:183], a[88:91], v[72:75]
s_mul_i32 s54, s54, 6144
ds_read_b128 v[160:163], v7 offset:12288
v_mfma_f32_16x16x32_bf16 v[76:79], v[180:183], a[92:95], v[76:79]
s_waitcnt lgkmcnt(8)
ds_read_b128 v[164:167], v7 offset:13312
v_mfma_f32_16x16x32_bf16 v[76:79], v[176:179], a[84:87], v[76:79]
ds_write_b64 v11, a[124:125] offset:3072
v_mfma_f32_16x16x32_bf16 v[80:83], v[184:187], a[80:83], v[80:83]
s_add_u32 s54, s54, s69
ds_read_b128 v[168:171], v7 offset:14336
v_mfma_f32_16x16x32_bf16 v[80:83], v[188:191], a[88:91], v[80:83]
ds_read_b128 v[172:175], v7 offset:15360
v_mfma_f32_16x16x32_bf16 v[84:87], v[188:191], a[92:95], v[84:87]
buffer_load_dwordx4 a[240:243], v14, s[24:27], s65 offen offset:0 sc1
v_mfma_f32_16x16x32_bf16 v[84:87], v[184:187], a[84:87], v[84:87]
s_add_u32 s54, s54, 4096
s_waitcnt lgkmcnt(8)
ds_read_b128 v[176:179], v8 offset:0
v_mfma_f32_16x16x32_bf16 v[88:91], v[144:147], a[80:83], v[88:91]
ds_write_b64 v11, a[126:127] offset:3080
v_mfma_f32_16x16x32_bf16 v[88:91], v[148:151], a[88:91], v[88:91]
s_add_u32 s91, s91, 16384
ds_read_b128 v[180:183], v8 offset:1024
v_add_u32 v11, s70, v4
v_mfma_f32_16x16x32_bf16 v[92:95], v[148:151], a[92:95], v[92:95]
s_sub_u32 s55, s3, s84
s_add_u32 s70, s70, 16384
ds_read_b128 v[184:187], v8 offset:2048
v_mfma_f32_16x16x32_bf16 v[92:95], v[144:147], a[84:87], v[92:95]
s_cmp_ge_u32 s70, 163840
s_cselect_b32 s70, s80, s70
s_waitcnt lgkmcnt(10)
v_mfma_f32_16x16x32_bf16 v[96:99], v[152:155], a[80:83], v[96:99]
buffer_load_dwordx4 a[248:251], v14, s[24:27], s65 offen offset:2048 sc1
v_mfma_f32_16x16x32_bf16 v[96:99], v[156:159], a[88:91], v[96:99]
s_and_b32 s55, s55, 3
s_waitcnt lgkmcnt(7) vmcnt(12)
ds_read_b128 v[188:191], v8 offset:3072
v_mfma_f32_16x16x32_bf16 v[100:103], v[156:159], a[92:95], v[100:103]
ds_write_b64 v11, a[160:161] offset:0
v_mfma_f32_16x16x32_bf16 v[100:103], v[152:155], a[84:87], v[100:103]
buffer_load_dwordx4 a[244:247], v14, s[24:27], s93 offen offset:0 sc1
v_mfma_f32_16x16x32_bf16 v[120:123], v[160:163], a[192:195], v[120:123]
s_lshl_b32 s55, s55, 10
ds_read_b128 v[144:147], v8 offset:4096
v_mfma_f32_16x16x32_bf16 v[120:123], v[164:167], a[200:203], v[120:123]
s_waitcnt vmcnt(11)
ds_read_b128 v[148:151], v8 offset:5120
v_mfma_f32_16x16x32_bf16 v[124:127], v[164:167], a[204:207], v[124:127]
ds_write_b64 v11, a[162:163] offset:8
v_mfma_f32_16x16x32_bf16 v[124:127], v[160:163], a[196:199], v[124:127]
s_add_u32 s55, s55, s69
s_waitcnt lgkmcnt(9)
ds_read_b128 v[152:155], v8 offset:6144
v_mfma_f32_16x16x32_bf16 v[72:75], v[168:171], a[192:195], v[72:75]
buffer_load_dwordx4 a[252:255], v14, s[24:27], s93 offen offset:2048 sc1
v_mfma_f32_16x16x32_bf16 v[72:75], v[172:175], a[200:203], v[72:75]
s_cmp_ge_u32 s91, 163840
s_cselect_b32 s91, 0, s91
ds_read_b128 v[156:159], v8 offset:7168
v_mfma_f32_16x16x32_bf16 v[76:79], v[172:175], a[204:207], v[76:79]
s_add_u32 s55, s55, 23552
s_waitcnt lgkmcnt(8)
ds_read_b128 v[160:163], v8 offset:8192
v_mfma_f32_16x16x32_bf16 v[76:79], v[168:171], a[196:199], v[76:79]
ds_write_b64 v11, a[164:165] offset:1024
v_mfma_f32_16x16x32_bf16 v[80:83], v[176:179], a[192:195], v[80:83]
s_xor_b32 s65, s82, 40960
s_add_u32 s65, s65, s77
ds_read_b128 v[164:167], v8 offset:9216
v_mfma_f32_16x16x32_bf16 v[80:83], v[180:183], a[200:203], v[80:83]
s_add_u32 s71, s69, 24576
s_waitcnt lgkmcnt(9)
v_add_u32 v7, s91, v4
v_mfma_f32_16x16x32_bf16 v[84:87], v[180:183], a[204:207], v[84:87]
buffer_load_dwordx4 a[96:99], v4, s[24:27], s65 offen offset:0 sc1
v_mfma_f32_16x16x32_bf16 v[84:87], v[176:179], a[196:199], v[84:87]
ds_write_b64 v11, a[166:167] offset:1032
v_mfma_f32_16x16x32_bf16 v[88:91], v[184:187], a[192:195], v[88:91]
s_cmp_eq_u32 s3, s84
s_cselect_b32 s55, 2147418112, s55
s_cselect_b32 s71, s71, 2147418112
v_mfma_f32_16x16x32_bf16 v[88:91], v[188:191], a[200:203], v[88:91]
ds_read_b128 v[168:171], v8 offset:10240
v_mfma_f32_16x16x32_bf16 v[92:95], v[188:191], a[204:207], v[92:95]
buffer_load_dwordx4 a[104:107], v4, s[24:27], s65 offen offset:2048 sc1
v_mfma_f32_16x16x32_bf16 v[92:95], v[184:187], a[196:199], v[92:95]
s_mul_i32 s83, s84, 6144
s_waitcnt lgkmcnt(8)
ds_read_b128 v[172:175], v8 offset:11264
v_mfma_f32_16x16x32_bf16 v[96:99], v[144:147], a[192:195], v[96:99]
ds_write_b64 v11, a[168:169] offset:2048
v_mfma_f32_16x16x32_bf16 v[96:99], v[148:151], a[200:203], v[96:99]
s_xor_b32 s93, s82, 40960
s_add_u32 s93, s93, s81
ds_read_b128 v[176:179], v8 offset:12288
v_mfma_f32_16x16x32_bf16 v[100:103], v[148:151], a[204:207], v[100:103]
s_add_u32 s69, s69, s83
s_waitcnt lgkmcnt(8) vmcnt(12)
ds_read_b128 v[180:183], v8 offset:13312
v_mfma_f32_16x16x32_bf16 v[100:103], v[144:147], a[196:199], v[100:103]
buffer_load_dwordx4 a[100:103], v4, s[24:27], s93 offen offset:0 sc1
v_mfma_f32_16x16x32_bf16 v[120:123], v[152:155], a[208:211], v[120:123]
s_waitcnt vmcnt(56)
s_waitcnt vmcnt(11)
ds_read_b128 v[184:187], v8 offset:14336
v_mfma_f32_16x16x32_bf16 v[120:123], v[156:159], a[216:219], v[120:123]
s_barrier
v_mfma_f32_16x16x32_bf16 v[124:127], v[156:159], a[220:223], v[124:127]
s_add_u32 s83, s69, 4096
s_waitcnt lgkmcnt(7)
ds_read_b128 v[188:191], v8 offset:15360
v_mfma_f32_16x16x32_bf16 v[124:127], v[152:155], a[212:215], v[124:127]
ds_write_b64 v11, a[170:171] offset:2056
v_mfma_f32_16x16x32_bf16 v[72:75], v[160:163], a[208:211], v[72:75]
buffer_load_dwordx4 a[108:111], v4, s[24:27], s93 offen offset:2048 sc1
v_mfma_f32_16x16x32_bf16 v[72:75], v[164:167], a[216:219], v[72:75]
s_add_u32 s91, s91, 16384
ds_read_b128 v[144:147], v7 offset:0
v_mfma_f32_16x16x32_bf16 v[76:79], v[164:167], a[220:223], v[76:79]
s_waitcnt lgkmcnt(7)
ds_read_b128 v[148:151], v7 offset:1024
v_mfma_f32_16x16x32_bf16 v[76:79], v[160:163], a[212:215], v[76:79]
ds_write_b64 v11, a[172:173] offset:3072
v_mfma_f32_16x16x32_bf16 v[80:83], v[168:171], a[208:211], v[80:83]
s_cmp_ge_u32 s91, 163840
s_cselect_b32 s91, 0, s91
ds_read_b128 v[152:155], v7 offset:2048
v_mfma_f32_16x16x32_bf16 v[80:83], v[172:175], a[216:219], v[80:83]
s_waitcnt lgkmcnt(7)
ds_read_b128 v[156:159], v7 offset:3072
v_add_u32 v8, s91, v4
v_mfma_f32_16x16x32_bf16 v[84:87], v[172:175], a[220:223], v[84:87]
buffer_load_dwordx4 a[112:115], v14, s[24:27], s65 offen offset:0 sc1
v_mfma_f32_16x16x32_bf16 v[84:87], v[168:171], a[212:215], v[84:87]
ds_write_b64 v11, a[174:175] offset:3080
v_mfma_f32_16x16x32_bf16 v[88:91], v[176:179], a[208:211], v[88:91]
s_add_u32 s68, s68, 49152
ds_read_b128 v[160:163], v7 offset:4096
v_mfma_f32_16x16x32_bf16 v[88:91], v[180:183], a[216:219], v[88:91]
ds_read_b128 v[164:167], v7 offset:5120
v_mfma_f32_16x16x32_bf16 v[92:95], v[180:183], a[220:223], v[92:95]
buffer_load_dwordx4 a[120:123], v14, s[24:27], s65 offen offset:2048 sc1
v_mfma_f32_16x16x32_bf16 v[92:95], v[176:179], a[212:215], v[92:95]
s_waitcnt lgkmcnt(9)
ds_read_b128 v[168:171], v7 offset:6144
v_mfma_f32_16x16x32_bf16 v[96:99], v[184:187], a[208:211], v[96:99]
ds_read_b128 v[172:175], v7 offset:7168
v_mfma_f32_16x16x32_bf16 v[96:99], v[188:191], a[216:219], v[96:99]
v_mfma_f32_16x16x32_bf16 v[100:103], v[188:191], a[220:223], v[100:103]
buffer_load_dwordx4 a[116:119], v14, s[24:27], s93 offen offset:0 sc1
v_mfma_f32_16x16x32_bf16 v[100:103], v[184:187], a[212:215], v[100:103]
s_waitcnt lgkmcnt(8) vmcnt(13)
ds_read_b128 v[176:179], v7 offset:8192
v_mfma_f32_16x16x32_bf16 v[120:123], v[144:147], a[224:227], v[120:123]
ds_read_b128 v[180:183], v7 offset:9216
v_mfma_f32_16x16x32_bf16 v[120:123], v[148:151], a[232:235], v[120:123]
s_waitcnt vmcnt(11)
v_mfma_f32_16x16x32_bf16 v[124:127], v[148:151], a[236:239], v[124:127]
buffer_load_dwordx4 a[124:127], v14, s[24:27], s93 offen offset:2048 sc1
v_mfma_f32_16x16x32_bf16 v[124:127], v[144:147], a[228:231], v[124:127]
s_waitcnt lgkmcnt(7)
ds_read_b128 v[184:187], v7 offset:10240
v_mfma_f32_16x16x32_bf16 v[72:75], v[152:155], a[224:227], v[72:75]
ds_read_b128 v[188:191], v7 offset:11264
v_mfma_f32_16x16x32_bf16 v[72:75], v[156:159], a[232:235], v[72:75]
v_mfma_f32_16x16x32_bf16 v[76:79], v[156:159], a[236:239], v[76:79]
ds_read_b128 v[144:147], v7 offset:12288
v_mfma_f32_16x16x32_bf16 v[76:79], v[152:155], a[228:231], v[76:79]
s_waitcnt lgkmcnt(7)
v_mfma_f32_16x16x32_bf16 v[80:83], v[160:163], a[224:227], v[80:83]
s_xor_b32 s65, s82, 49152
s_add_u32 s65, s65, s77
ds_read_b128 v[148:151], v7 offset:13312
v_mfma_f32_16x16x32_bf16 v[80:83], v[164:167], a[232:235], v[80:83]
v_mov_b32 v13, 0xffff0000
v_mul_u32_u24 v5, 1152, v2
v_mfma_f32_16x16x32_bf16 v[84:87], v[164:167], a[236:239], v[84:87]
buffer_load_dwordx4 a[128:131], v4, s[24:27], s65 offen offset:0 sc1
v_mfma_f32_16x16x32_bf16 v[84:87], v[160:163], a[228:231], v[84:87]
s_waitcnt lgkmcnt(6)
ds_read_b128 v[152:155], v7 offset:14336
v_lshl_add_u32 v6, v3, 3, v5
v_mfma_f32_16x16x32_bf16 v[88:91], v[168:171], a[224:227], v[88:91]
ds_read_b128 v[156:159], v7 offset:15360
v_and_b32 v9, 1, v3
v_mfma_f32_16x16x32_bf16 v[88:91], v[172:175], a[232:235], v[88:91]
s_add_u32 s91, s91, 16384
s_cmp_ge_u32 s91, 163840
s_cselect_b32 s91, 0, s91
v_mfma_f32_16x16x32_bf16 v[92:95], v[172:175], a[236:239], v[92:95]
buffer_load_dwordx4 a[136:139], v4, s[24:27], s65 offen offset:2048 sc1
v_mfma_f32_16x16x32_bf16 v[92:95], v[168:171], a[228:231], v[92:95]
s_waitcnt lgkmcnt(6)
ds_read_b128 v[160:163], v8 offset:0
v_add_u32 v7, s91, v4
v_mfma_f32_16x16x32_bf16 v[96:99], v[176:179], a[224:227], v[96:99]
s_xor_b32 s93, s82, 49152
s_add_u32 s93, s93, s81
ds_read_b128 v[164:167], v8 offset:1024
v_mfma_f32_16x16x32_bf16 v[96:99], v[180:183], a[232:235], v[96:99]
v_lshl_add_u32 v5, v9, 5, v5
v_lshrrev_b32 v9, 1, v3
v_mfma_f32_16x16x32_bf16 v[100:103], v[180:183], a[236:239], v[100:103]
buffer_load_dwordx4 a[132:135], v4, s[24:27], s93 offen offset:0 sc1
v_mfma_f32_16x16x32_bf16 v[100:103], v[176:179], a[228:231], v[100:103]
s_waitcnt lgkmcnt(6) vmcnt(13)
ds_read_b128 v[168:171], v8 offset:2048
v_lshl_add_u32 v5, v9, 4, v5
v_mfma_f32_16x16x32_bf16 v[120:123], v[184:187], a[240:243], v[120:123]
ds_read_b128 v[172:175], v8 offset:3072
v_mfma_f32_16x16x32_bf16 v[120:123], v[188:191], a[248:251], v[120:123]
s_waitcnt vmcnt(11)
v_mfma_f32_16x16x32_bf16 v[124:127], v[188:191], a[252:255], v[124:127]
buffer_load_dwordx4 a[140:143], v4, s[24:27], s93 offen offset:2048 sc1
v_mfma_f32_16x16x32_bf16 v[124:127], v[184:187], a[244:247], v[124:127]
s_waitcnt lgkmcnt(6)
ds_read_b128 v[176:179], v8 offset:4096
v_mfma_f32_16x16x32_bf16 v[72:75], v[144:147], a[240:243], v[72:75]
ds_read_b128 v[180:183], v8 offset:5120
v_mfma_f32_16x16x32_bf16 v[72:75], v[148:151], a[248:251], v[72:75]
v_mfma_f32_16x16x32_bf16 v[76:79], v[148:151], a[252:255], v[76:79]
ds_read_b128 v[184:187], v8 offset:6144
v_mfma_f32_16x16x32_bf16 v[76:79], v[144:147], a[244:247], v[76:79]
s_waitcnt lgkmcnt(7)
v_mfma_f32_16x16x32_bf16 v[80:83], v[152:155], a[240:243], v[80:83]
ds_read_b128 v[188:191], v8 offset:7168
v_mfma_f32_16x16x32_bf16 v[80:83], v[156:159], a[248:251], v[80:83]
s_waitcnt lgkmcnt(6)
v_mfma_f32_16x16x32_bf16 v[84:87], v[156:159], a[252:255], v[84:87]
buffer_load_dword v12, v10, s[24:27], s75 offen offset:4 sc1
v_mfma_f32_16x16x32_bf16 v[84:87], v[152:155], a[244:247], v[84:87]
buffer_load_dwordx4 a[144:147], v14, s[24:27], s65 offen offset:0 sc1
v_mfma_f32_16x16x32_bf16 v[88:91], v[160:163], a[240:243], v[88:91]
ds_read_b128 v[144:147], v8 offset:8192
v_mfma_f32_16x16x32_bf16 v[88:91], v[164:167], a[248:251], v[88:91]
ds_read_b128 v[148:151], v8 offset:9216
v_mfma_f32_16x16x32_bf16 v[92:95], v[164:167], a[252:255], v[92:95]
buffer_load_dwordx4 a[152:155], v14, s[24:27], s65 offen offset:2048 sc1
v_mfma_f32_16x16x32_bf16 v[92:95], v[160:163], a[244:247], v[92:95]
s_waitcnt lgkmcnt(6)
ds_read_b128 v[152:155], v8 offset:10240
v_mfma_f32_16x16x32_bf16 v[96:99], v[168:171], a[240:243], v[96:99]
ds_read_b128 v[156:159], v8 offset:11264
v_mfma_f32_16x16x32_bf16 v[96:99], v[172:175], a[248:251], v[96:99]
v_mfma_f32_16x16x32_bf16 v[100:103], v[172:175], a[252:255], v[100:103]
buffer_load_dwordx4 a[148:151], v14, s[24:27], s93 offen offset:0 sc1
v_mfma_f32_16x16x32_bf16 v[100:103], v[168:171], a[244:247], v[100:103]
s_waitcnt lgkmcnt(6) vmcnt(14)
ds_read_b128 v[160:163], v8 offset:12288
v_mfma_f32_16x16x32_bf16 v[120:123], v[176:179], a[96:99], v[120:123]
ds_read_b128 v[164:167], v8 offset:13312
v_mfma_f32_16x16x32_bf16 v[120:123], v[180:183], a[104:107], v[120:123]
s_waitcnt vmcnt(12)
v_mfma_f32_16x16x32_bf16 v[124:127], v[180:183], a[108:111], v[124:127]
buffer_load_dwordx4 a[156:159], v14, s[24:27], s93 offen offset:2048 sc1
v_mfma_f32_16x16x32_bf16 v[124:127], v[176:179], a[100:103], v[124:127]
s_waitcnt lgkmcnt(6)
ds_read_b128 v[168:171], v8 offset:14336
v_mfma_f32_16x16x32_bf16 v[72:75], v[184:187], a[96:99], v[72:75]
s_waitcnt vmcnt(61)
ds_read_b128 v[172:175], v8 offset:15360
v_mfma_f32_16x16x32_bf16 v[72:75], v[188:191], a[104:107], v[72:75]
s_barrier
v_mfma_f32_16x16x32_bf16 v[76:79], v[188:191], a[108:111], v[76:79]
s_add_u32 s91, s91, 16384
ds_read_b128 v[176:179], v7 offset:0
v_mfma_f32_16x16x32_bf16 v[76:79], v[184:187], a[100:103], v[76:79]
s_waitcnt lgkmcnt(7)
s_cmp_ge_u32 s91, 163840
s_cselect_b32 s91, 0, s91
v_mfma_f32_16x16x32_bf16 v[80:83], v[144:147], a[96:99], v[80:83]
s_xor_b32 s65, s82, 57344
s_add_u32 s65, s65, s77
ds_read_b128 v[180:183], v7 offset:1024
v_mfma_f32_16x16x32_bf16 v[80:83], v[148:151], a[104:107], v[80:83]
v_add_u32 v8, s91, v4
v_mfma_f32_16x16x32_bf16 v[84:87], v[148:151], a[108:111], v[84:87]
buffer_load_dwordx4 a[160:163], v4, s[24:27], s65 offen offset:0 sc1
v_mfma_f32_16x16x32_bf16 v[84:87], v[144:147], a[100:103], v[84:87]
s_waitcnt lgkmcnt(6)
ds_read_b128 v[184:187], v7 offset:2048
v_mfma_f32_16x16x32_bf16 v[88:91], v[152:155], a[96:99], v[88:91]
ds_read_b128 v[188:191], v7 offset:3072
v_mfma_f32_16x16x32_bf16 v[88:91], v[156:159], a[104:107], v[88:91]
v_mfma_f32_16x16x32_bf16 v[92:95], v[156:159], a[108:111], v[92:95]
buffer_load_dwordx4 a[168:171], v4, s[24:27], s65 offen offset:2048 sc1
v_mfma_f32_16x16x32_bf16 v[92:95], v[152:155], a[100:103], v[92:95]
s_waitcnt lgkmcnt(6)
ds_read_b128 v[144:147], v7 offset:4096
v_mfma_f32_16x16x32_bf16 v[96:99], v[160:163], a[96:99], v[96:99]
s_xor_b32 s93, s82, 57344
s_add_u32 s93, s93, s81
ds_read_b128 v[148:151], v7 offset:5120
v_mfma_f32_16x16x32_bf16 v[96:99], v[164:167], a[104:107], v[96:99]
v_mfma_f32_16x16x32_bf16 v[100:103], v[164:167], a[108:111], v[100:103]
buffer_load_dwordx4 a[164:167], v4, s[24:27], s93 offen offset:0 sc1
v_mfma_f32_16x16x32_bf16 v[100:103], v[160:163], a[100:103], v[100:103]
s_waitcnt lgkmcnt(6) vmcnt(14)
ds_read_b128 v[152:155], v7 offset:6144
v_mfma_f32_16x16x32_bf16 v[120:123], v[168:171], a[112:115], v[120:123]
ds_read_b128 v[156:159], v7 offset:7168
v_mfma_f32_16x16x32_bf16 v[120:123], v[172:175], a[120:123], v[120:123]
s_waitcnt vmcnt(12)
v_mfma_f32_16x16x32_bf16 v[124:127], v[172:175], a[124:127], v[124:127]
buffer_load_dwordx4 a[172:175], v4, s[24:27], s93 offen offset:2048 sc1
v_mfma_f32_16x16x32_bf16 v[124:127], v[168:171], a[116:119], v[124:127]
s_waitcnt lgkmcnt(6)
ds_read_b128 v[160:163], v7 offset:8192
v_mfma_f32_16x16x32_bf16 v[72:75], v[176:179], a[112:115], v[72:75]
ds_read_b128 v[164:167], v7 offset:9216
v_mfma_f32_16x16x32_bf16 v[72:75], v[180:183], a[120:123], v[72:75]
v_mfma_f32_16x16x32_bf16 v[76:79], v[180:183], a[124:127], v[76:79]
ds_read_b128 v[168:171], v7 offset:10240
v_mfma_f32_16x16x32_bf16 v[76:79], v[176:179], a[116:119], v[76:79]
s_waitcnt lgkmcnt(7)
v_mfma_f32_16x16x32_bf16 v[80:83], v[184:187], a[112:115], v[80:83]
ds_read_b128 v[172:175], v7 offset:11264
v_mfma_f32_16x16x32_bf16 v[80:83], v[188:191], a[120:123], v[80:83]
v_mfma_f32_16x16x32_bf16 v[84:87], v[188:191], a[124:127], v[84:87]
buffer_load_dwordx4 a[176:179], v14, s[24:27], s65 offen offset:0 sc1
v_mfma_f32_16x16x32_bf16 v[84:87], v[184:187], a[116:119], v[84:87]
s_waitcnt lgkmcnt(6)
ds_read_b128 v[176:179], v7 offset:12288
v_mfma_f32_16x16x32_bf16 v[88:91], v[144:147], a[112:115], v[88:91]
ds_read_b128 v[180:183], v7 offset:13312
v_mfma_f32_16x16x32_bf16 v[88:91], v[148:151], a[120:123], v[88:91]
v_mfma_f32_16x16x32_bf16 v[92:95], v[148:151], a[124:127], v[92:95]
buffer_load_dwordx4 a[184:187], v14, s[24:27], s65 offen offset:2048 sc1
v_mfma_f32_16x16x32_bf16 v[92:95], v[144:147], a[116:119], v[92:95]
s_waitcnt lgkmcnt(6)
ds_read_b128 v[184:187], v7 offset:14336
v_mfma_f32_16x16x32_bf16 v[96:99], v[152:155], a[112:115], v[96:99]
s_waitcnt vmcnt(10)
ds_read_b128 v[188:191], v7 offset:15360
v_mfma_f32_16x16x32_bf16 v[96:99], v[156:159], a[120:123], v[96:99]
s_add_u32 s91, s91, 16384
v_cmp_gt_u32 vcc, 8, v12
v_mfma_f32_16x16x32_bf16 v[100:103], v[156:159], a[124:127], v[100:103]
buffer_load_dwordx4 a[180:183], v14, s[24:27], s93 offen offset:0 sc1
v_mfma_f32_16x16x32_bf16 v[100:103], v[152:155], a[116:119], v[100:103]
s_waitcnt lgkmcnt(6) vmcnt(14)
ds_read_b128 v[144:147], v8 offset:0
v_mfma_f32_16x16x32_bf16 v[120:123], v[160:163], a[128:131], v[120:123]
s_cmp_ge_u32 s91, 163840
s_cselect_b32 s91, 0, s91
ds_read_b128 v[148:151], v8 offset:1024
v_mfma_f32_16x16x32_bf16 v[120:123], v[164:167], a[136:139], v[120:123]
s_waitcnt lgkmcnt(6) vmcnt(12)
v_add_u32 v7, s91, v4
v_mfma_f32_16x16x32_bf16 v[124:127], v[164:167], a[140:143], v[124:127]
s_cbranch_vccnz CK_ZAA
CK_ZAA_R:
v_mfma_f32_16x16x32_bf16 v[124:127], v[160:163], a[132:135], v[124:127]
buffer_load_dwordx4 a[188:191], v14, s[24:27], s93 offen offset:2048 sc1
v_mfma_f32_16x16x32_bf16 v[72:75], v[168:171], a[128:131], v[72:75]
ds_read_b128 v[152:155], v8 offset:2048
v_mfma_f32_16x16x32_bf16 v[72:75], v[172:175], a[136:139], v[72:75]
ds_read_b128 v[156:159], v8 offset:3072
v_mfma_f32_16x16x32_bf16 v[76:79], v[172:175], a[140:143], v[76:79]
ds_read_b128 v[160:163], v8 offset:4096
v_mfma_f32_16x16x32_bf16 v[76:79], v[168:171], a[132:135], v[76:79]
s_waitcnt lgkmcnt(7)
v_mfma_f32_16x16x32_bf16 v[80:83], v[176:179], a[128:131], v[80:83]
s_add_u32 s65, s77, 65536
ds_read_b128 v[164:167], v8 offset:5120
v_mfma_f32_16x16x32_bf16 v[80:83], v[180:183], a[136:139], v[80:83]
v_mfma_f32_16x16x32_bf16 v[84:87], v[180:183], a[140:143], v[84:87]
buffer_load_dwordx4 v[32:35], v4, s[24:27], s65 offen offset:0 sc1
v_mfma_f32_16x16x32_bf16 v[84:87], v[176:179], a[132:135], v[84:87]
s_waitcnt lgkmcnt(6)
ds_read_b128 v[168:171], v8 offset:6144
v_mfma_f32_16x16x32_bf16 v[88:91], v[184:187], a[128:131], v[88:91]
ds_read_b128 v[172:175], v8 offset:7168
v_mfma_f32_16x16x32_bf16 v[88:91], v[188:191], a[136:139], v[88:91]
v_mfma_f32_16x16x32_bf16 v[92:95], v[188:191], a[140:143], v[92:95]
buffer_load_dwordx4 v[40:43], v4, s[24:27], s65 offen offset:2048 sc1
v_mfma_f32_16x16x32_bf16 v[92:95], v[184:187], a[132:135], v[92:95]
s_waitcnt lgkmcnt(6)
ds_read_b128 v[176:179], v8 offset:8192
v_mfma_f32_16x16x32_bf16 v[96:99], v[144:147], a[128:131], v[96:99]
s_add_u32 s93, s81, 65536
ds_read_b128 v[180:183], v8 offset:9216
v_mfma_f32_16x16x32_bf16 v[96:99], v[148:151], a[136:139], v[96:99]
s_waitcnt lgkmcnt(6) vmcnt(12)
v_mfma_f32_16x16x32_bf16 v[100:103], v[148:151], a[140:143], v[100:103]
buffer_load_dwordx4 v[36:39], v4, s[24:27], s93 offen offset:0 sc1
v_mfma_f32_16x16x32_bf16 v[100:103], v[144:147], a[132:135], v[100:103]
s_mov_b32 m0, s70
s_mov_b32 s64, s68
s_add_u32 s68, s68, 16384
v_mfma_f32_16x16x32_bf16 v[120:123], v[152:155], a[144:147], v[120:123]
s_waitcnt vmcnt(11)
ds_read_b128 v[184:187], v8 offset:10240
v_mfma_f32_16x16x32_bf16 v[120:123], v[156:159], a[152:155], v[120:123]
s_add_u32 s70, s70, 16384
s_cmp_ge_u32 s70, 163840
s_cselect_b32 s70, s80, s70
v_mfma_f32_16x16x32_bf16 v[124:127], v[156:159], a[156:159], v[124:127]
buffer_load_dwordx4 v4, s[24:27], s64 offen offset:0 sc1 lds
v_mfma_f32_16x16x32_bf16 v[124:127], v[152:155], a[148:151], v[124:127]
s_waitcnt lgkmcnt(5)
ds_read_b128 v[188:191], v8 offset:11264
v_mfma_f32_16x16x32_bf16 v[72:75], v[160:163], a[144:147], v[72:75]
ds_read_b128 v[144:147], v8 offset:12288
v_mfma_f32_16x16x32_bf16 v[72:75], v[164:167], a[152:155], v[72:75]
buffer_load_dwordx4 v4, s[24:27], s64 offen offset:1024 sc1 lds
v_mfma_f32_16x16x32_bf16 v[76:79], v[164:167], a[156:159], v[76:79]
ds_read_b128 v[148:151], v8 offset:13312
v_mfma_f32_16x16x32_bf16 v[76:79], v[160:163], a[148:151], v[76:79]
s_waitcnt lgkmcnt(6)
ds_read_b128 v[152:155], v8 offset:14336
v_mfma_f32_16x16x32_bf16 v[80:83], v[168:171], a[144:147], v[80:83]
buffer_load_dwordx4 v[44:47], v4, s[24:27], s93 offen offset:2048 sc1
v_mfma_f32_16x16x32_bf16 v[80:83], v[172:175], a[152:155], v[80:83]
s_barrier
v_mfma_f32_16x16x32_bf16 v[84:87], v[172:175], a[156:159], v[84:87]
s_waitcnt lgkmcnt(5)
ds_read_b128 v[156:159], v8 offset:15360
v_mfma_f32_16x16x32_bf16 v[84:87], v[168:171], a[148:151], v[84:87]
buffer_load_dwordx4 v4, s[24:27], s64 offen offset:2048 sc1 lds
v_mfma_f32_16x16x32_bf16 v[88:91], v[176:179], a[144:147], v[88:91]
s_add_u32 s91, s91, 16384
ds_read_b128 v[160:163], v7 offset:0
v_mfma_f32_16x16x32_bf16 v[88:91], v[180:183], a[152:155], v[88:91]
s_cmp_ge_u32 s91, 163840
s_cselect_b32 s91, 0, s91
ds_read_b128 v[164:167], v7 offset:1024
v_mfma_f32_16x16x32_bf16 v[92:95], v[180:183], a[156:159], v[92:95]
buffer_load_dwordx4 v4, s[24:27], s64 offen offset:3072 sc1 lds
v_mfma_f32_16x16x32_bf16 v[92:95], v[176:179], a[148:151], v[92:95]
s_waitcnt lgkmcnt(6)
ds_read_b128 v[168:171], v7 offset:2048
v_add_u32 v8, s91, v4
v_mfma_f32_16x16x32_bf16 v[96:99], v[184:187], a[144:147], v[96:99]
ds_read_b128 v[172:175], v7 offset:3072
v_mfma_f32_16x16x32_bf16 v[96:99], v[188:191], a[152:155], v[96:99]
buffer_load_dwordx4 v[48:51], v14, s[24:27], s65 offen offset:0 sc1
v_mfma_f32_16x16x32_bf16 v[100:103], v[188:191], a[156:159], v[100:103]
ds_read_b128 v[176:179], v7 offset:4096
v_mfma_f32_16x16x32_bf16 v[100:103], v[184:187], a[148:151], v[100:103]
s_waitcnt lgkmcnt(7) vmcnt(15)
v_mfma_f32_16x16x32_bf16 v[120:123], v[144:147], a[160:163], v[120:123]
buffer_load_dwordx4 v[56:59], v14, s[24:27], s65 offen offset:2048 sc1
v_mfma_f32_16x16x32_bf16 v[120:123], v[148:151], a[168:171], v[120:123]
s_waitcnt vmcnt(14)
ds_read_b128 v[180:183], v7 offset:5120
v_mfma_f32_16x16x32_bf16 v[124:127], v[148:151], a[172:175], v[124:127]
s_waitcnt lgkmcnt(6)
ds_read_b128 v[184:187], v7 offset:6144
v_mfma_f32_16x16x32_bf16 v[124:127], v[144:147], a[164:167], v[124:127]
buffer_load_dwordx4 v[52:55], v14, s[24:27], s93 offen offset:0 sc1
v_mfma_f32_16x16x32_bf16 v[72:75], v[152:155], a[160:163], v[72:75]
ds_read_b128 v[188:191], v7 offset:7168
v_mfma_f32_16x16x32_bf16 v[72:75], v[156:159], a[168:171], v[72:75]
v_mfma_f32_16x16x32_bf16 v[76:79], v[156:159], a[172:175], v[76:79]
buffer_load_dwordx4 v[60:63], v14, s[24:27], s93 offen offset:2048 sc1
v_mfma_f32_16x16x32_bf16 v[76:79], v[152:155], a[164:167], v[76:79]
s_waitcnt lgkmcnt(6)
ds_read_b128 v[144:147], v7 offset:8192
v_mfma_f32_16x16x32_bf16 v[80:83], v[160:163], a[160:163], v[80:83]
ds_read_b128 v[148:151], v7 offset:9216
v_mfma_f32_16x16x32_bf16 v[80:83], v[164:167], a[168:171], v[80:83]
v_mfma_f32_16x16x32_bf16 v[84:87], v[164:167], a[172:175], v[84:87]
ds_read_b128 v[152:155], v7 offset:10240
v_mfma_f32_16x16x32_bf16 v[84:87], v[160:163], a[164:167], v[84:87]
s_waitcnt lgkmcnt(7)
v_mfma_f32_16x16x32_bf16 v[88:91], v[168:171], a[160:163], v[88:91]
s_add_u32 s65, s77, 73728
ds_read_b128 v[156:159], v7 offset:11264
v_mfma_f32_16x16x32_bf16 v[88:91], v[172:175], a[168:171], v[88:91]
v_mfma_f32_16x16x32_bf16 v[92:95], v[172:175], a[172:175], v[92:95]
buffer_load_dwordx4 v[64:67], v4, s[24:27], s65 offen offset:0 sc1
v_mfma_f32_16x16x32_bf16 v[92:95], v[168:171], a[164:167], v[92:95]
s_waitcnt lgkmcnt(6)
ds_read_b128 v[160:163], v7 offset:12288
v_mfma_f32_16x16x32_bf16 v[96:99], v[176:179], a[160:163], v[96:99]
ds_read_b128 v[164:167], v7 offset:13312
v_mfma_f32_16x16x32_bf16 v[96:99], v[180:183], a[168:171], v[96:99]
v_mfma_f32_16x16x32_bf16 v[100:103], v[180:183], a[172:175], v[100:103]
ds_read_b128 v[168:171], v7 offset:14336
v_mfma_f32_16x16x32_bf16 v[100:103], v[176:179], a[164:167], v[100:103]
s_add_u32 s93, s81, 73728
s_waitcnt lgkmcnt(7) vmcnt(15)
v_mfma_f32_16x16x32_bf16 v[120:123], v[184:187], a[176:179], v[120:123]
s_waitcnt vmcnt(13)
ds_read_b128 v[172:175], v7 offset:15360
v_mfma_f32_16x16x32_bf16 v[120:123], v[188:191], a[184:187], v[120:123]
buffer_load_dwordx4 v[68:71], v4, s[24:27], s93 offen offset:0 sc1
v_mfma_f32_16x16x32_bf16 v[124:127], v[188:191], a[188:191], v[124:127]
s_add_u32 s91, s91, 16384
ds_read_b128 v[176:179], v8 offset:0
v_mfma_f32_16x16x32_bf16 v[124:127], v[184:187], a[180:183], v[124:127]
s_waitcnt lgkmcnt(7)
s_cmp_ge_u32 s91, 163840
s_cselect_b32 s91, 0, s91
v_mfma_f32_16x16x32_bf16 v[72:75], v[144:147], a[176:179], v[72:75]
ds_read_b128 v[180:183], v8 offset:1024
v_add_u32 v7, s91, v4
v_mfma_f32_16x16x32_bf16 v[72:75], v[148:151], a[184:187], v[72:75]
v_mfma_f32_16x16x32_bf16 v[76:79], v[148:151], a[188:191], v[76:79]
s_mov_b32 m0, s70
s_mov_b32 s64, s68
s_add_u32 s68, s68, 16384
v_mfma_f32_16x16x32_bf16 v[76:79], v[144:147], a[180:183], v[76:79]
s_waitcnt lgkmcnt(6)
ds_read_b128 v[184:187], v8 offset:2048
v_mfma_f32_16x16x32_bf16 v[80:83], v[152:155], a[176:179], v[80:83]
s_add_u32 s70, s70, 16384
s_cmp_ge_u32 s70, 163840
s_cselect_b32 s70, s80, s70
v_mfma_f32_16x16x32_bf16 v[80:83], v[156:159], a[184:187], v[80:83]
buffer_load_dwordx4 v4, s[24:27], s64 offen offset:0 sc1 lds
v_mfma_f32_16x16x32_bf16 v[84:87], v[156:159], a[188:191], v[84:87]
ds_read_b128 v[188:191], v8 offset:3072
v_mfma_f32_16x16x32_bf16 v[84:87], v[152:155], a[180:183], v[84:87]
s_waitcnt lgkmcnt(6)
ds_read_b128 v[144:147], v8 offset:4096
v_mfma_f32_16x16x32_bf16 v[88:91], v[160:163], a[176:179], v[88:91]
buffer_load_dwordx4 v4, s[24:27], s64 offen offset:1024 sc1 lds
v_mfma_f32_16x16x32_bf16 v[88:91], v[164:167], a[184:187], v[88:91]
ds_read_b128 v[148:151], v8 offset:5120
v_mfma_f32_16x16x32_bf16 v[92:95], v[164:167], a[188:191], v[92:95]
s_waitcnt lgkmcnt(6)
ds_read_b128 v[152:155], v8 offset:6144
v_mfma_f32_16x16x32_bf16 v[92:95], v[160:163], a[180:183], v[92:95]
buffer_load_dwordx4 v4, s[24:27], s64 offen offset:2048 sc1 lds
v_mfma_f32_16x16x32_bf16 v[96:99], v[168:171], a[176:179], v[96:99]
ds_read_b128 v[156:159], v8 offset:7168
v_mfma_f32_16x16x32_bf16 v[96:99], v[172:175], a[184:187], v[96:99]
L_PAD12:
s_cbranch_execz L_MAIN
v_mfma_f32_16x16x32_bf16 v[100:103], v[172:175], a[188:191], v[100:103]
buffer_load_dwordx4 v4, s[24:27], s64 offen offset:3072 sc1 lds
v_mfma_f32_16x16x32_bf16 v[100:103], v[168:171], a[180:183], v[100:103]
s_waitcnt lgkmcnt(6) vmcnt(16)
ds_read_b128 v[160:163], v8 offset:8192
v_mfma_f32_16x16x32_bf16 v[120:123], v[176:179], v[32:35], v[120:123]
s_mov_b32 m0, s70
s_mov_b32 s64, s68
s_add_u32 s68, s68, 16384
v_mfma_f32_16x16x32_bf16 v[120:123], v[180:183], v[40:43], v[120:123]
s_waitcnt lgkmcnt(5) vmcnt(12)
ds_read_b128 v[164:167], v8 offset:9216
v_mfma_f32_16x16x32_bf16 v[124:127], v[180:183], v[44:47], v[124:127]
s_add_u32 s70, s70, 16384
s_cmp_ge_u32 s70, 163840
s_cselect_b32 s70, s80, s70
v_mfma_f32_16x16x32_bf16 v[124:127], v[176:179], v[36:39], v[124:127]
buffer_load_dwordx4 v4, s[24:27], s64 offen offset:0 sc1 lds
v_mfma_f32_16x16x32_bf16 v[72:75], v[184:187], v[32:35], v[72:75]
ds_read_b128 v[168:171], v8 offset:10240
v_mfma_f32_16x16x32_bf16 v[72:75], v[188:191], v[40:43], v[72:75]
ds_read_b128 v[172:175], v8 offset:11264
v_mfma_f32_16x16x32_bf16 v[76:79], v[188:191], v[44:47], v[76:79]
buffer_load_dwordx4 v4, s[24:27], s64 offen offset:1024 sc1 lds
v_mfma_f32_16x16x32_bf16 v[76:79], v[184:187], v[36:39], v[76:79]
s_waitcnt lgkmcnt(6)
ds_read_b128 v[176:179], v8 offset:12288
v_mfma_f32_16x16x32_bf16 v[80:83], v[144:147], v[32:35], v[80:83]
ds_read_b128 v[180:183], v8 offset:13312
v_mfma_f32_16x16x32_bf16 v[80:83], v[148:151], v[40:43], v[80:83]
buffer_load_dwordx4 v4, s[24:27], s64 offen offset:2048 sc1 lds
v_mfma_f32_16x16x32_bf16 v[84:87], v[148:151], v[44:47], v[84:87]
ds_read_b128 v[184:187], v8 offset:14336
v_mfma_f32_16x16x32_bf16 v[84:87], v[144:147], v[36:39], v[84:87]
s_waitcnt lgkmcnt(7)
v_mfma_f32_16x16x32_bf16 v[88:91], v[152:155], v[32:35], v[88:91]
s_waitcnt vmcnt(13)
ds_read_b128 v[188:191], v8 offset:15360
v_mfma_f32_16x16x32_bf16 v[88:91], v[156:159], v[40:43], v[88:91]
s_barrier
v_mfma_f32_16x16x32_bf16 v[92:95], v[156:159], v[44:47], v[92:95]
buffer_load_dwordx4 v4, s[24:27], s64 offen offset:3072 sc1 lds
v_mfma_f32_16x16x32_bf16 v[92:95], v[152:155], v[36:39], v[92:95]
s_waitcnt lgkmcnt(6)
s_add_u32 s91, s91, 16384
ds_read_b128 v[144:147], v7 offset:0
v_mfma_f32_16x16x32_bf16 v[96:99], v[160:163], v[32:35], v[96:99]
s_cmp_ge_u32 s91, 163840
s_cselect_b32 s91, 0, s91
ds_read_b128 v[148:151], v7 offset:1024
v_mfma_f32_16x16x32_bf16 v[96:99], v[164:167], v[40:43], v[96:99]
v_add_u32 v8, s91, v4
v_mfma_f32_16x16x32_bf16 v[100:103], v[164:167], v[44:47], v[100:103]
ds_read_b128 v[152:155], v7 offset:2048
v_mfma_f32_16x16x32_bf16 v[100:103], v[160:163], v[36:39], v[100:103]
s_waitcnt lgkmcnt(7) vmcnt(12)
v_mfma_f32_16x16x32_bf16 v[120:123], v[168:171], v[48:51], v[120:123]
ds_read_b128 v[156:159], v7 offset:3072
v_mfma_f32_16x16x32_bf16 v[120:123], v[172:175], v[56:59], v[120:123]
s_waitcnt vmcnt(10)
v_mfma_f32_16x16x32_bf16 v[124:127], v[172:175], v[60:63], v[124:127]
ds_read_b128 v[160:163], v7 offset:4096
v_mfma_f32_16x16x32_bf16 v[124:127], v[168:171], v[52:55], v[124:127]
s_waitcnt lgkmcnt(7)
v_mfma_f32_16x16x32_bf16 v[72:75], v[176:179], v[48:51], v[72:75]
ds_read_b128 v[164:167], v7 offset:5120
v_mfma_f32_16x16x32_bf16 v[72:75], v[180:183], v[56:59], v[72:75]
v_mfma_f32_16x16x32_bf16 v[76:79], v[180:183], v[60:63], v[76:79]
ds_read_b128 v[168:171], v7 offset:6144
v_mfma_f32_16x16x32_bf16 v[76:79], v[176:179], v[52:55], v[76:79]
s_waitcnt lgkmcnt(7)
v_mfma_f32_16x16x32_bf16 v[80:83], v[184:187], v[48:51], v[80:83]
ds_read_b128 v[172:175], v7 offset:7168
v_mfma_f32_16x16x32_bf16 v[80:83], v[188:191], v[56:59], v[80:83]
v_mfma_f32_16x16x32_bf16 v[84:87], v[188:191], v[60:63], v[84:87]
ds_read_b128 v[176:179], v7 offset:8192
v_mfma_f32_16x16x32_bf16 v[84:87], v[184:187], v[52:55], v[84:87]
s_waitcnt lgkmcnt(7)
v_mfma_f32_16x16x32_bf16 v[88:91], v[144:147], v[48:51], v[88:91]
ds_read_b128 v[180:183], v7 offset:9216
v_mfma_f32_16x16x32_bf16 v[88:91], v[148:151], v[56:59], v[88:91]
v_mfma_f32_16x16x32_bf16 v[92:95], v[148:151], v[60:63], v[92:95]
ds_read_b128 v[184:187], v7 offset:10240
v_mfma_f32_16x16x32_bf16 v[92:95], v[144:147], v[52:55], v[92:95]
s_waitcnt lgkmcnt(7)
v_mfma_f32_16x16x32_bf16 v[96:99], v[152:155], v[48:51], v[96:99]
ds_read_b128 v[188:191], v7 offset:11264
v_mfma_f32_16x16x32_bf16 v[96:99], v[156:159], v[56:59], v[96:99]
v_mfma_f32_16x16x32_bf16 v[100:103], v[156:159], v[60:63], v[100:103]
ds_read_b128 v[144:147], v7 offset:12288
v_mfma_f32_16x16x32_bf16 v[100:103], v[152:155], v[52:55], v[100:103]
s_waitcnt lgkmcnt(7) vmcnt(9)
v_mfma_f32_16x16x32_bf16 v[120:123], v[160:163], v[64:67], v[120:123]
s_waitcnt vmcnt(8)
ds_read_b128 v[148:151], v7 offset:13312
v_mfma_f32_16x16x32_bf16 v[124:127], v[160:163], v[68:71], v[124:127]
v_mfma_f32_16x16x32_bf16 v[72:75], v[164:167], v[64:67], v[72:75]
ds_read_b128 v[152:155], v7 offset:14336
v_mfma_f32_16x16x32_bf16 v[76:79], v[164:167], v[68:71], v[76:79]
s_waitcnt lgkmcnt(7)
v_mfma_f32_16x16x32_bf16 v[80:83], v[168:171], v[64:67], v[80:83]
ds_read_b128 v[156:159], v7 offset:15360
v_mfma_f32_16x16x32_bf16 v[84:87], v[168:171], v[68:71], v[84:87]
s_add_u32 s91, s91, 16384
s_cmp_ge_u32 s91, 163840
s_cselect_b32 s91, 0, s91
v_mfma_f32_16x16x32_bf16 v[88:91], v[172:175], v[64:67], v[88:91]
ds_read_b128 v[160:163], v8 offset:0
v_add_u32 v7, s91, v4
v_mfma_f32_16x16x32_bf16 v[92:95], v[172:175], v[68:71], v[92:95]
s_waitcnt lgkmcnt(7)
v_mfma_f32_16x16x32_bf16 v[96:99], v[176:179], v[64:67], v[96:99]
ds_read_b128 v[164:167], v8 offset:1024
v_cvt_pk_bf16_f32 v228, v120, v121
v_mfma_f32_16x16x32_bf16 v[100:103], v[176:179], v[68:71], v[100:103]
v_cvt_pk_bf16_f32 v229, v122, v123
v_mfma_f32_16x16x32_bf16 v[104:107], v[180:183], a[64:67], v[104:107]
s_waitcnt lgkmcnt(6)
ds_read_b128 v[168:171], v8 offset:2048
v_cvt_pk_bf16_f32 v230, v124, v125
v_mfma_f32_16x16x32_bf16 v[104:107], v[184:187], a[72:75], v[104:107]
v_cvt_pk_bf16_f32 v231, v126, v127
v_mfma_f32_16x16x32_bf16 v[108:111], v[184:187], a[76:79], v[108:111]
buffer_store_dwordx4 v[228:231], v4, s[24:27], s55 offen offset:0 sc1
v_mfma_f32_16x16x32_bf16 v[108:111], v[180:183], a[68:71], v[108:111]
ds_read_b128 v[172:175], v8 offset:3072
v_cvt_pk_bf16_f32 v72, v72, v73
v_mfma_f32_16x16x32_bf16 v[112:115], v[188:191], a[64:67], v[112:115]
s_waitcnt lgkmcnt(6)
ds_read_b128 v[176:179], v8 offset:4096
v_cvt_pk_bf16_f32 v73, v74, v75
v_mfma_f32_16x16x32_bf16 v[112:115], v[144:147], a[72:75], v[112:115]
v_cvt_pk_bf16_f32 v74, v80, v81
v_mfma_f32_16x16x32_bf16 v[116:119], v[144:147], a[76:79], v[116:119]
ds_read_b128 v[180:183], v8 offset:5120
v_cvt_pk_bf16_f32 v75, v82, v83
v_mfma_f32_16x16x32_bf16 v[116:119], v[188:191], a[68:71], v[116:119]
buffer_store_dwordx4 v[72:75], v4, s[24:27], s52 offen offset:0 sc1
v_mfma_f32_16x16x32_bf16 v[104:107], v[148:151], a[80:83], v[104:107]
s_waitcnt lgkmcnt(6)
ds_read_b128 v[184:187], v8 offset:6144
v_cvt_pk_bf16_f32 v76, v76, v77
v_mfma_f32_16x16x32_bf16 v[104:107], v[152:155], a[88:91], v[104:107]
v_cvt_pk_bf16_f32 v77, v78, v79
v_mfma_f32_16x16x32_bf16 v[108:111], v[152:155], a[92:95], v[108:111]
ds_read_b128 v[188:191], v8 offset:7168
v_cvt_pk_bf16_f32 v78, v84, v85
v_mfma_f32_16x16x32_bf16 v[108:111], v[148:151], a[84:87], v[108:111]
s_waitcnt lgkmcnt(6)
v_cvt_pk_bf16_f32 v79, v86, v87
v_mfma_f32_16x16x32_bf16 v[112:115], v[156:159], a[80:83], v[112:115]
buffer_store_dwordx4 v[76:79], v4, s[24:27], s52 offen offset:1024 sc1
v_mfma_f32_16x16x32_bf16 v[112:115], v[160:163], a[88:91], v[112:115]
ds_read_b128 v[144:147], v8 offset:8192
v_cvt_pk_bf16_f32 v88, v88, v89
v_mfma_f32_16x16x32_bf16 v[116:119], v[160:163], a[92:95], v[116:119]
ds_read_b128 v[148:151], v8 offset:9216
v_cvt_pk_bf16_f32 v89, v90, v91
v_mfma_f32_16x16x32_bf16 v[116:119], v[156:159], a[84:87], v[116:119]
v_cvt_pk_bf16_f32 v90, v96, v97
v_mfma_f32_16x16x32_bf16 v[104:107], v[164:167], a[192:195], v[104:107]
s_waitcnt lgkmcnt(6)
ds_read_b128 v[152:155], v8 offset:10240
v_cvt_pk_bf16_f32 v91, v98, v99
v_mfma_f32_16x16x32_bf16 v[104:107], v[168:171], a[200:203], v[104:107]
buffer_store_dwordx4 v[88:91], v4, s[24:27], s53 offen offset:0 sc1
v_mfma_f32_16x16x32_bf16 v[108:111], v[168:171], a[204:207], v[108:111]
ds_read_b128 v[156:159], v8 offset:11264
v_cvt_pk_bf16_f32 v92, v92, v93
v_mfma_f32_16x16x32_bf16 v[108:111], v[164:167], a[196:199], v[108:111]
v_cvt_pk_bf16_f32 v93, v94, v95
v_mfma_f32_16x16x32_bf16 v[112:115], v[172:175], a[192:195], v[112:115]
s_waitcnt lgkmcnt(6)
ds_read_b128 v[160:163], v8 offset:12288
v_cvt_pk_bf16_f32 v94, v100, v101
v_mfma_f32_16x16x32_bf16 v[112:115], v[176:179], a[200:203], v[112:115]
s_waitcnt lgkmcnt(5)
v_cvt_pk_bf16_f32 v95, v102, v103
v_mfma_f32_16x16x32_bf16 v[116:119], v[176:179], a[204:207], v[116:119]
buffer_store_dwordx4 v[92:95], v4, s[24:27], s53 offen offset:1024 sc1
v_mfma_f32_16x16x32_bf16 v[116:119], v[172:175], a[196:199], v[116:119]
s_mov_b32 m0, s70
s_mov_b32 s64, s68
s_add_u32 s68, s68, 16384
v_mfma_f32_16x16x32_bf16 v[104:107], v[180:183], a[208:211], v[104:107]
s_add_u32 s70, s70, 16384
s_cmp_ge_u32 s70, 163840
s_cselect_b32 s70, s80, s70
v_mfma_f32_16x16x32_bf16 v[104:107], v[184:187], a[216:219], v[104:107]
buffer_load_dwordx4 v4, s[24:27], s64 offen offset:0 sc1 lds
v_mfma_f32_16x16x32_bf16 v[108:111], v[184:187], a[220:223], v[108:111]
s_waitcnt vmcnt(6) lgkmcnt(3)
ds_read_b128 v[164:167], v8 offset:13312
v_mfma_f32_16x16x32_bf16 v[108:111], v[180:183], a[212:215], v[108:111]
s_barrier
v_mfma_f32_16x16x32_bf16 v[112:115], v[188:191], a[208:211], v[112:115]
buffer_load_dwordx4 v4, s[24:27], s64 offen offset:1024 sc1 lds
v_mfma_f32_16x16x32_bf16 v[112:115], v[144:147], a[216:219], v[112:115]
ds_read_b128 v[168:171], v8 offset:14336
v_mfma_f32_16x16x32_bf16 v[116:119], v[144:147], a[220:223], v[116:119]
ds_read_b128 v[172:175], v8 offset:15360
v_mfma_f32_16x16x32_bf16 v[116:119], v[188:191], a[212:215], v[116:119]
buffer_load_dwordx4 v4, s[24:27], s64 offen offset:2048 sc1 lds
v_mfma_f32_16x16x32_bf16 v[104:107], v[148:151], a[224:227], v[104:107]
s_waitcnt lgkmcnt(4)
s_add_u32 s91, s91, 16384
ds_read_b128 v[176:179], v7 offset:0
v_mfma_f32_16x16x32_bf16 v[104:107], v[152:155], a[232:235], v[104:107]
s_cmp_ge_u32 s91, 163840
s_cselect_b32 s91, 0, s91
ds_read_b128 v[180:183], v7 offset:1024
v_mfma_f32_16x16x32_bf16 v[108:111], v[152:155], a[236:239], v[108:111]
buffer_load_dwordx4 v4, s[24:27], s64 offen offset:3072 sc1 lds
v_mfma_f32_16x16x32_bf16 v[108:111], v[148:151], a[228:231], v[108:111]
s_mov_b32 m0, s70
s_mov_b32 s64, s68
s_add_u32 s68, s68, 16384
v_mfma_f32_16x16x32_bf16 v[112:115], v[156:159], a[224:227], v[112:115]
s_waitcnt lgkmcnt(4)
ds_read_b128 v[184:187], v7 offset:2048
v_add_u32 v8, s91, v4
v_mfma_f32_16x16x32_bf16 v[112:115], v[160:163], a[232:235], v[112:115]
s_add_u32 s70, s70, 16384
s_cmp_ge_u32 s70, 163840
s_cselect_b32 s70, s80, s70
v_mfma_f32_16x16x32_bf16 v[116:119], v[160:163], a[236:239], v[116:119]
buffer_load_dwordx4 v4, s[24:27], s64 offen offset:0 sc1 lds
v_mfma_f32_16x16x32_bf16 v[116:119], v[156:159], a[228:231], v[116:119]
ds_read_b128 v[188:191], v7 offset:3072
v_mfma_f32_16x16x32_bf16 v[104:107], v[164:167], a[240:243], v[104:107]
s_waitcnt lgkmcnt(4)
ds_read_b128 v[144:147], v7 offset:4096
v_mfma_f32_16x16x32_bf16 v[104:107], v[168:171], a[248:251], v[104:107]
buffer_load_dwordx4 v4, s[24:27], s64 offen offset:1024 sc1 lds
v_mfma_f32_16x16x32_bf16 v[108:111], v[168:171], a[252:255], v[108:111]
ds_read_b128 v[148:151], v7 offset:5120
v_mfma_f32_16x16x32_bf16 v[108:111], v[164:167], a[244:247], v[108:111]
s_waitcnt lgkmcnt(4)
ds_read_b128 v[152:155], v7 offset:6144
v_mfma_f32_16x16x32_bf16 v[112:115], v[172:175], a[240:243], v[112:115]
buffer_load_dwordx4 v4, s[24:27], s64 offen offset:2048 sc1 lds
v_mfma_f32_16x16x32_bf16 v[112:115], v[176:179], a[248:251], v[112:115]
ds_read_b128 v[156:159], v7 offset:7168
v_mfma_f32_16x16x32_bf16 v[116:119], v[176:179], a[252:255], v[116:119]
ds_read_b128 v[160:163], v7 offset:8192
v_mfma_f32_16x16x32_bf16 v[116:119], v[172:175], a[244:247], v[116:119]
buffer_load_dwordx4 v4, s[24:27], s64 offen offset:3072 sc1 lds
v_mfma_f32_16x16x32_bf16 v[104:107], v[180:183], a[96:99], v[104:107]
s_waitcnt lgkmcnt(5)
ds_read_b128 v[164:167], v7 offset:9216
v_mfma_f32_16x16x32_bf16 v[104:107], v[184:187], a[104:107], v[104:107]
ds_read_b128 v[168:171], v7 offset:10240
v_mfma_f32_16x16x32_bf16 v[108:111], v[184:187], a[108:111], v[108:111]
ds_read_b128 v[172:175], v7 offset:11264
v_mfma_f32_16x16x32_bf16 v[108:111], v[180:183], a[100:103], v[108:111]
v_mfma_f32_16x16x32_bf16 v[112:115], v[188:191], a[96:99], v[112:115]
s_waitcnt lgkmcnt(6)
ds_read_b128 v[176:179], v7 offset:12288
v_mfma_f32_16x16x32_bf16 v[112:115], v[144:147], a[104:107], v[112:115]
v_mfma_f32_16x16x32_bf16 v[116:119], v[144:147], a[108:111], v[116:119]
ds_read_b128 v[180:183], v7 offset:13312
v_mfma_f32_16x16x32_bf16 v[116:119], v[188:191], a[100:103], v[116:119]
v_mfma_f32_16x16x32_bf16 v[104:107], v[148:151], a[112:115], v[104:107]
s_waitcnt lgkmcnt(6)
ds_read_b128 v[184:187], v7 offset:14336
v_mfma_f32_16x16x32_bf16 v[104:107], v[152:155], a[120:123], v[104:107]
v_mfma_f32_16x16x32_bf16 v[108:111], v[152:155], a[124:127], v[108:111]
ds_read_b128 v[188:191], v7 offset:15360
v_mfma_f32_16x16x32_bf16 v[108:111], v[148:151], a[116:119], v[108:111]
s_add_u32 s91, s91, 16384
s_cmp_ge_u32 s91, 163840
s_cselect_b32 s91, 0, s91
v_mfma_f32_16x16x32_bf16 v[112:115], v[156:159], a[112:115], v[112:115]
s_waitcnt lgkmcnt(6)
ds_read_b128 v[144:147], v8 offset:0
v_add_u32 v7, s91, v4
v_mfma_f32_16x16x32_bf16 v[112:115], v[160:163], a[120:123], v[112:115]
v_mfma_f32_16x16x32_bf16 v[116:119], v[160:163], a[124:127], v[116:119]
ds_read_b128 v[148:151], v8 offset:1024
v_mfma_f32_16x16x32_bf16 v[116:119], v[156:159], a[116:119], v[116:119]
s_waitcnt lgkmcnt(6)
v_mfma_f32_16x16x32_bf16 v[104:107], v[164:167], a[128:131], v[104:107]
s_mov_b32 m0, s70
s_mov_b32 s64, s68
s_add_u32 s68, s68, 16384
v_mfma_f32_16x16x32_bf16 v[104:107], v[168:171], a[136:139], v[104:107]
ds_read_b128 v[152:155], v8 offset:2048
v_mfma_f32_16x16x32_bf16 v[108:111], v[168:171], a[140:143], v[108:111]
s_add_u32 s70, s70, 16384
s_cmp_ge_u32 s70, 163840
s_cselect_b32 s70, s80, s70
v_mfma_f32_16x16x32_bf16 v[108:111], v[164:167], a[132:135], v[108:111]
buffer_load_dwordx4 v4, s[24:27], s64 offen offset:0 sc1 lds
v_mfma_f32_16x16x32_bf16 v[112:115], v[172:175], a[128:131], v[112:115]
s_waitcnt lgkmcnt(5)
ds_read_b128 v[156:159], v8 offset:3072
v_mfma_f32_16x16x32_bf16 v[112:115], v[176:179], a[136:139], v[112:115]
ds_read_b128 v[160:163], v8 offset:4096
v_mfma_f32_16x16x32_bf16 v[116:119], v[176:179], a[140:143], v[116:119]
buffer_load_dwordx4 v4, s[24:27], s64 offen offset:1024 sc1 lds
v_mfma_f32_16x16x32_bf16 v[116:119], v[172:175], a[132:135], v[116:119]
ds_read_b128 v[164:167], v8 offset:5120
v_mfma_f32_16x16x32_bf16 v[104:107], v[180:183], a[144:147], v[104:107]
s_waitcnt vmcnt(10) lgkmcnt(6)
ds_read_b128 v[168:171], v8 offset:6144
v_mfma_f32_16x16x32_bf16 v[104:107], v[184:187], a[152:155], v[104:107]
buffer_atomic_add v1, v0, s[24:27], s73 offen offset:0 sc1
v_mfma_f32_16x16x32_bf16 v[108:111], v[184:187], a[156:159], v[108:111]
buffer_load_dwordx4 v4, s[24:27], s64 offen offset:2048 sc1 lds
v_mfma_f32_16x16x32_bf16 v[108:111], v[180:183], a[148:151], v[108:111]
ds_read_b128 v[172:175], v8 offset:7168
v_mfma_f32_16x16x32_bf16 v[112:115], v[188:191], a[144:147], v[112:115]
s_waitcnt lgkmcnt(6)
ds_read_b128 v[176:179], v8 offset:8192
v_mfma_f32_16x16x32_bf16 v[112:115], v[144:147], a[152:155], v[112:115]
buffer_load_dwordx4 v4, s[24:27], s64 offen offset:3072 sc1 lds
v_mfma_f32_16x16x32_bf16 v[116:119], v[144:147], a[156:159], v[116:119]
s_mov_b32 m0, s70
s_mov_b32 s64, s68
s_add_u32 s68, s68, 16384
v_mfma_f32_16x16x32_bf16 v[116:119], v[188:191], a[148:151], v[116:119]
s_waitcnt lgkmcnt(5)
ds_read_b128 v[180:183], v8 offset:9216
v_mfma_f32_16x16x32_bf16 v[104:107], v[148:151], a[160:163], v[104:107]
s_add_u32 s70, s70, 16384
s_cmp_ge_u32 s70, 163840
s_cselect_b32 s70, s80, s70
v_mfma_f32_16x16x32_bf16 v[104:107], v[152:155], a[168:171], v[104:107]
buffer_load_dwordx4 v4, s[24:27], s64 offen offset:0 sc1 lds
v_mfma_f32_16x16x32_bf16 v[108:111], v[152:155], a[172:175], v[108:111]
ds_read_b128 v[184:187], v8 offset:10240
v_mfma_f32_16x16x32_bf16 v[108:111], v[148:151], a[164:167], v[108:111]
s_waitcnt lgkmcnt(5)
ds_read_b128 v[188:191], v8 offset:11264
v_mfma_f32_16x16x32_bf16 v[112:115], v[156:159], a[160:163], v[112:115]
buffer_load_dwordx4 v4, s[24:27], s64 offen offset:1024 sc1 lds
v_mfma_f32_16x16x32_bf16 v[112:115], v[160:163], a[168:171], v[112:115]
ds_read_b128 v[144:147], v8 offset:12288
v_mfma_f32_16x16x32_bf16 v[116:119], v[160:163], a[172:175], v[116:119]
s_add_u32 s82, s84, 3
ds_read_b128 v[148:151], v8 offset:13312
v_mfma_f32_16x16x32_bf16 v[116:119], v[156:159], a[164:167], v[116:119]
buffer_load_dwordx4 v4, s[24:27], s64 offen offset:2048 sc1 lds
v_mfma_f32_16x16x32_bf16 v[104:107], v[164:167], a[176:179], v[104:107]
s_and_b32 s82, s82, 3
s_waitcnt lgkmcnt(6)
ds_read_b128 v[152:155], v8 offset:14336
v_mfma_f32_16x16x32_bf16 v[104:107], v[168:171], a[184:187], v[104:107]
v_mfma_f32_16x16x32_bf16 v[108:111], v[168:171], a[188:191], v[108:111]
s_waitcnt vmcnt(8)
s_lshl4_add_u32 s82, s82, s73
ds_read_b128 v[156:159], v8 offset:15360
v_mfma_f32_16x16x32_bf16 v[108:111], v[164:167], a[180:183], v[108:111]
s_barrier
v_mfma_f32_16x16x32_bf16 v[112:115], v[172:175], a[176:179], v[112:115]
s_lshl4_add_u32 s75, s84, s73
s_waitcnt lgkmcnt(6)
ds_read_b128 v[160:163], v7 offset:0
v_mfma_f32_16x16x32_bf16 v[112:115], v[176:179], a[184:187], v[112:115]
buffer_load_dwordx4 v4, s[24:27], s64 offen offset:3072 sc1 lds
v_mfma_f32_16x16x32_bf16 v[116:119], v[176:179], a[188:191], v[116:119]
s_add_u32 s91, s91, 16384
ds_read_b128 v[164:167], v7 offset:1024
v_mfma_f32_16x16x32_bf16 v[116:119], v[172:175], a[180:183], v[116:119]
s_cmp_ge_u32 s91, 163840
s_cselect_b32 s91, 0, s91
v_add_u32 v8, s91, v4
v_mfma_f32_16x16x32_bf16 v[104:107], v[180:183], v[32:35], v[104:107]
s_waitcnt lgkmcnt(6)
ds_read_b128 v[168:171], v7 offset:2048
v_mfma_f32_16x16x32_bf16 v[104:107], v[184:187], v[40:43], v[104:107]
v_mfma_f32_16x16x32_bf16 v[108:111], v[184:187], v[44:47], v[108:111]
ds_read_b128 v[172:175], v7 offset:3072
v_mfma_f32_16x16x32_bf16 v[108:111], v[180:183], v[36:39], v[108:111]
v_mfma_f32_16x16x32_bf16 v[112:115], v[188:191], v[32:35], v[112:115]
s_waitcnt lgkmcnt(6)
ds_read_b128 v[176:179], v7 offset:4096
v_mfma_f32_16x16x32_bf16 v[112:115], v[144:147], v[40:43], v[112:115]
v_mfma_f32_16x16x32_bf16 v[116:119], v[144:147], v[44:47], v[116:119]
ds_read_b128 v[180:183], v7 offset:5120
v_mfma_f32_16x16x32_bf16 v[116:119], v[188:191], v[36:39], v[116:119]
v_mfma_f32_16x16x32_bf16 v[104:107], v[148:151], v[48:51], v[104:107]
s_waitcnt lgkmcnt(6)
ds_read_b128 v[184:187], v7 offset:6144
v_mfma_f32_16x16x32_bf16 v[104:107], v[152:155], v[56:59], v[104:107]
v_mfma_f32_16x16x32_bf16 v[108:111], v[152:155], v[60:63], v[108:111]
ds_read_b128 v[188:191], v7 offset:7168
v_mfma_f32_16x16x32_bf16 v[108:111], v[148:151], v[52:55], v[108:111]
v_mfma_f32_16x16x32_bf16 v[112:115], v[156:159], v[48:51], v[112:115]
s_waitcnt lgkmcnt(6)
ds_read_b128 v[144:147], v7 offset:8192
v_mfma_f32_16x16x32_bf16 v[112:115], v[160:163], v[56:59], v[112:115]
v_mfma_f32_16x16x32_bf16 v[116:119], v[160:163], v[60:63], v[116:119]
ds_read_b128 v[148:151], v7 offset:9216
v_mfma_f32_16x16x32_bf16 v[116:119], v[156:159], v[52:55], v[116:119]
v_mfma_f32_16x16x32_bf16 v[104:107], v[164:167], v[64:67], v[104:107]
ds_read_b128 v[152:155], v7 offset:10240
v_mfma_f32_16x16x32_bf16 v[108:111], v[164:167], v[68:71], v[108:111]
s_waitcnt lgkmcnt(7)
v_mfma_f32_16x16x32_bf16 v[112:115], v[168:171], v[64:67], v[112:115]
ds_read_b128 v[156:159], v7 offset:11264
v_mfma_f32_16x16x32_bf16 v[116:119], v[168:171], v[68:71], v[116:119]
v_mfma_f32_16x16x32_bf16 v[128:131], v[172:175], a[0:3], 0
s_waitcnt lgkmcnt(6)
ds_read_b128 v[160:163], v7 offset:12288
v_mfma_f32_16x16x32_bf16 v[128:131], v[176:179], a[8:11], v[128:131]
v_mfma_f32_16x16x32_bf16 v[132:135], v[176:179], a[12:15], 0
ds_read_b128 v[164:167], v7 offset:13312
v_mfma_f32_16x16x32_bf16 v[132:135], v[172:175], a[4:7], v[132:135]
v_mfma_f32_16x16x32_bf16 v[136:139], v[180:183], a[0:3], 0
s_waitcnt lgkmcnt(6)
ds_read_b128 v[168:171], v7 offset:14336
v_mfma_f32_16x16x32_bf16 v[136:139], v[184:187], a[8:11], v[136:139]
v_cvt_pk_bf16_f32 v104, v104, v105
v_mfma_f32_16x16x32_bf16 v[140:143], v[184:187], a[12:15], 0
ds_read_b128 v[172:175], v7 offset:15360
v_cvt_pk_bf16_f32 v105, v106, v107
v_mfma_f32_16x16x32_bf16 v[140:143], v[180:183], a[4:7], v[140:143]
s_add_u32 s91, s91, 16384
v_cvt_pk_bf16_f32 v106, v112, v113
v_mfma_f32_16x16x32_bf16 v[128:131], v[188:191], a[16:19], v[128:131]
s_waitcnt lgkmcnt(6)
ds_read_b128 v[176:179], v8 offset:0
v_cvt_pk_bf16_f32 v107, v114, v115
v_mfma_f32_16x16x32_bf16 v[128:131], v[144:147], a[24:27], v[128:131]
buffer_store_dwordx4 v[104:107], v4, s[24:27], s54 offen offset:0 sc1
v_mfma_f32_16x16x32_bf16 v[132:135], v[144:147], a[28:31], v[132:135]
ds_read_b128 v[180:183], v8 offset:1024
v_cvt_pk_bf16_f32 v108, v108, v109
v_mfma_f32_16x16x32_bf16 v[132:135], v[188:191], a[20:23], v[132:135]
s_cmp_ge_u32 s91, 163840
s_cselect_b32 s91, 0, s91
v_cvt_pk_bf16_f32 v109, v110, v111
v_mfma_f32_16x16x32_bf16 v[136:139], v[148:151], a[16:19], v[136:139]
s_waitcnt lgkmcnt(6)
ds_read_b128 v[184:187], v8 offset:2048
v_cvt_pk_bf16_f32 v110, v116, v117
v_mfma_f32_16x16x32_bf16 v[136:139], v[152:155], a[24:27], v[136:139]
s_waitcnt lgkmcnt(5)
v_cvt_pk_bf16_f32 v111, v118, v119
v_add_u32 v7, s91, v4
v_mfma_f32_16x16x32_bf16 v[140:143], v[152:155], a[28:31], v[140:143]
buffer_store_dwordx4 v[108:111], v4, s[24:27], s54 offen offset:1024 sc1
v_mfma_f32_16x16x32_bf16 v[140:143], v[148:151], a[20:23], v[140:143]
s_mov_b32 m0, s70
s_mov_b32 s64, s68
s_add_u32 s68, s68, 16384
v_mfma_f32_16x16x32_bf16 v[128:131], v[156:159], a[32:35], v[128:131]
s_cmp_lt_u32 s3, 3
s_cselect_b32 s68, s64, 2147418112
ds_read_b128 v[188:191], v8 offset:3072
v_mfma_f32_16x16x32_bf16 v[128:131], v[160:163], a[40:43], v[128:131]
buffer_load_dwordx4 v4, s[24:27], s64 offen offset:0 sc1 lds
v_mfma_f32_16x16x32_bf16 v[132:135], v[160:163], a[44:47], v[132:135]
ds_read_b128 v[144:147], v8 offset:4096
v_mfma_f32_16x16x32_bf16 v[132:135], v[156:159], a[36:39], v[132:135]
s_waitcnt lgkmcnt(5)
ds_read_b128 v[148:151], v8 offset:5120
v_mfma_f32_16x16x32_bf16 v[136:139], v[164:167], a[32:35], v[136:139]
buffer_load_dwordx4 v4, s[24:27], s68 offen offset:1024 sc1 lds
v_mfma_f32_16x16x32_bf16 v[136:139], v[168:171], a[40:43], v[136:139]
ds_read_b128 v[152:155], v8 offset:6144
v_mfma_f32_16x16x32_bf16 v[140:143], v[168:171], a[44:47], v[140:143]
ds_read_b128 v[156:159], v8 offset:7168
v_mfma_f32_16x16x32_bf16 v[140:143], v[164:167], a[36:39], v[140:143]
buffer_load_dwordx4 v4, s[24:27], s68 offen offset:2048 sc1 lds
v_mfma_f32_16x16x32_bf16 v[128:131], v[172:175], a[48:51], v[128:131]
s_waitcnt lgkmcnt(6)
ds_read_b128 v[160:163], v8 offset:8192
v_mfma_f32_16x16x32_bf16 v[128:131], v[176:179], a[56:59], v[128:131]
v_mfma_f32_16x16x32_bf16 v[132:135], v[176:179], a[60:63], v[132:135]
buffer_load_dwordx4 v4, s[24:27], s68 offen offset:3072 sc1 lds
v_mfma_f32_16x16x32_bf16 v[132:135], v[172:175], a[52:55], v[132:135]
buffer_load_dword v12, v10, s[24:27], s73 offen sc1
v_mfma_f32_16x16x32_bf16 v[136:139], v[180:183], a[48:51], v[136:139]
s_waitcnt lgkmcnt(5)
ds_read_b128 v[164:167], v8 offset:9216
v_mfma_f32_16x16x32_bf16 v[136:139], v[184:187], a[56:59], v[136:139]
ds_read_b128 v[168:171], v8 offset:10240
v_mfma_f32_16x16x32_bf16 v[140:143], v[184:187], a[60:63], v[140:143]
ds_read_b128 v[172:175], v8 offset:11264
v_mfma_f32_16x16x32_bf16 v[140:143], v[180:183], a[52:55], v[140:143]
v_mfma_f32_16x16x32_bf16 v[128:131], v[188:191], a[64:67], v[128:131]
s_waitcnt lgkmcnt(6)
ds_read_b128 v[176:179], v8 offset:12288
v_mfma_f32_16x16x32_bf16 v[128:131], v[144:147], a[72:75], v[128:131]
v_mfma_f32_16x16x32_bf16 v[132:135], v[144:147], a[76:79], v[132:135]
ds_read_b128 v[180:183], v8 offset:13312
v_mfma_f32_16x16x32_bf16 v[132:135], v[188:191], a[68:71], v[132:135]
v_mfma_f32_16x16x32_bf16 v[136:139], v[148:151], a[64:67], v[136:139]
s_waitcnt lgkmcnt(6)
ds_read_b128 v[184:187], v8 offset:14336
v_mfma_f32_16x16x32_bf16 v[136:139], v[152:155], a[72:75], v[136:139]
v_mfma_f32_16x16x32_bf16 v[140:143], v[152:155], a[76:79], v[140:143]
s_waitcnt vmcnt(7)
ds_read_b128 v[188:191], v8 offset:15360
v_mfma_f32_16x16x32_bf16 v[140:143], v[148:151], a[68:71], v[140:143]
s_barrier
v_mfma_f32_16x16x32_bf16 v[128:131], v[156:159], a[80:83], v[128:131]
s_waitcnt lgkmcnt(6)
s_add_u32 s91, s91, 16384
ds_read_b128 v[144:147], v7 offset:0
v_mfma_f32_16x16x32_bf16 v[128:131], v[160:163], a[88:91], v[128:131]
s_cmp_ge_u32 s91, 163840
s_cselect_b32 s91, 0, s91
v_add_u32 v8, s91, v4
v_mfma_f32_16x16x32_bf16 v[132:135], v[160:163], a[92:95], v[132:135]
ds_read_b128 v[148:151], v7 offset:1024
v_mfma_f32_16x16x32_bf16 v[132:135], v[156:159], a[84:87], v[132:135]
v_mfma_f32_16x16x32_bf16 v[136:139], v[164:167], a[80:83], v[136:139]
s_waitcnt vmcnt(5) lgkmcnt(6)
ds_read_b128 v[152:155], v7 offset:2048
v_mfma_f32_16x16x32_bf16 v[136:139], v[168:171], a[88:91], v[136:139]
buffer_atomic_add v1, v0, s[24:27], s82 offen offset:16 sc1
v_mfma_f32_16x16x32_bf16 v[140:143], v[168:171], a[92:95], v[140:143]
s_and_b32 s54, s3, 1
ds_read_b128 v[156:159], v7 offset:3072
v_mfma_f32_16x16x32_bf16 v[140:143], v[164:167], a[84:87], v[140:143]
s_mul_i32 s54, s54, 18432
v_mfma_f32_16x16x32_bf16 v[128:131], v[172:175], a[192:195], v[128:131]
s_waitcnt lgkmcnt(6)
s_mul_i32 s55, s86, 288
ds_read_b128 v[160:163], v7 offset:4096
v_mfma_f32_16x16x32_bf16 v[128:131], v[176:179], a[200:203], v[128:131]
s_add_u32 s54, s54, s55
v_mfma_f32_16x16x32_bf16 v[132:135], v[176:179], a[204:207], v[132:135]
s_add_u32 s54, s54, 256
ds_read_b128 v[164:167], v7 offset:5120
v_mfma_f32_16x16x32_bf16 v[132:135], v[172:175], a[196:199], v[132:135]
s_sub_u32 s55, 63, s72
v_mfma_f32_16x16x32_bf16 v[136:139], v[180:183], a[192:195], v[136:139]
s_waitcnt lgkmcnt(6)
s_mul_i32 s55, s55, 36864
ds_read_b128 v[168:171], v7 offset:6144
v_mfma_f32_16x16x32_bf16 v[136:139], v[184:187], a[200:203], v[136:139]
s_waitcnt vmcnt(1)
s_add_u32 s55, s55, s54
v_cmp_gt_u32 vcc, 4, v12
v_mfma_f32_16x16x32_bf16 v[140:143], v[184:187], a[204:207], v[140:143]
s_mul_i32 s52, s72, 36864
ds_read_b128 v[172:175], v7 offset:7168
v_mfma_f32_16x16x32_bf16 v[140:143], v[180:183], a[196:199], v[140:143]
s_waitcnt lgkmcnt(6)
s_add_u32 s54, s54, s52
v_mfma_f32_16x16x32_bf16 v[128:131], v[188:191], a[208:211], v[128:131]
s_cmp_eq_u64 vcc, 0
s_cselect_b32 s81, s69, 2147418112
s_cselect_b32 s93, s71, 2147418112
v_mfma_f32_16x16x32_bf16 v[128:131], v[144:147], a[216:219], v[128:131]
s_lshl_b32 s53, s84, 6
ds_read_b128 v[176:179], v7 offset:8192
v_mfma_f32_16x16x32_bf16 v[132:135], v[144:147], a[220:223], v[132:135]
s_sub_u32 s53, s53, 256
ds_read_b128 v[180:183], v7 offset:9216
v_mfma_f32_16x16x32_bf16 v[132:135], v[188:191], a[212:215], v[132:135]
buffer_load_dwordx4 v[192:195], v4, s[24:27], s81 offen offset:0 sc1
v_mfma_f32_16x16x32_bf16 v[136:139], v[148:151], a[208:211], v[136:139]
s_waitcnt lgkmcnt(6)
s_add_u32 s52, s54, s53
ds_read_b128 v[184:187], v7 offset:10240
v_mfma_f32_16x16x32_bf16 v[136:139], v[152:155], a[216:219], v[136:139]
s_add_u32 s53, s55, s53
v_mfma_f32_16x16x32_bf16 v[140:143], v[152:155], a[220:223], v[140:143]
buffer_load_dwordx4 v[196:199], v4, s[24:27], s81 offen offset:1024 sc1
v_mfma_f32_16x16x32_bf16 v[140:143], v[148:151], a[212:215], v[140:143]
ds_read_b128 v[188:191], v7 offset:11264
v_mfma_f32_16x16x32_bf16 v[128:131], v[156:159], a[224:227], v[128:131]
s_waitcnt lgkmcnt(6)
ds_read_b128 v[144:147], v7 offset:12288
v_mfma_f32_16x16x32_bf16 v[128:131], v[160:163], a[232:235], v[128:131]
buffer_load_dwordx4 v[200:203], v4, s[24:27], s81 offen offset:2048 sc1
v_mfma_f32_16x16x32_bf16 v[132:135], v[160:163], a[236:239], v[132:135]
L_PAD13:
s_cbranch_execz L_MAIN
ds_read_b128 v[148:151], v7 offset:13312
v_mfma_f32_16x16x32_bf16 v[132:135], v[156:159], a[228:231], v[132:135]
s_waitcnt lgkmcnt(6)
v_mfma_f32_16x16x32_bf16 v[136:139], v[164:167], a[224:227], v[136:139]
buffer_load_dwordx4 v[204:207], v4, s[24:27], s81 offen offset:3072 sc1
v_mfma_f32_16x16x32_bf16 v[136:139], v[168:171], a[232:235], v[136:139]
ds_read_b128 v[152:155], v7 offset:14336
v_mfma_f32_16x16x32_bf16 v[140:143], v[168:171], a[236:239], v[140:143]
ds_read_b128 v[156:159], v7 offset:15360
v_mfma_f32_16x16x32_bf16 v[140:143], v[164:167], a[228:231], v[140:143]
buffer_load_dwordx4 v[208:211], v4, s[24:27], s93 offen offset:0 sc1
v_mfma_f32_16x16x32_bf16 v[128:131], v[172:175], a[240:243], v[128:131]
s_waitcnt lgkmcnt(6)
s_add_u32 s91, s91, 16384
ds_read_b128 v[160:163], v8 offset:0
v_mfma_f32_16x16x32_bf16 v[128:131], v[176:179], a[248:251], v[128:131]
s_cmp_ge_u32 s91, 163840
s_cselect_b32 s91, 0, s91
v_add_u32 v7, s91, v4
v_mfma_f32_16x16x32_bf16 v[132:135], v[176:179], a[252:255], v[132:135]
buffer_load_dwordx4 v[212:215], v4, s[24:27], s93 offen offset:1024 sc1
v_mfma_f32_16x16x32_bf16 v[132:135], v[172:175], a[244:247], v[132:135]
ds_read_b128 v[164:167], v8 offset:1024
v_mfma_f32_16x16x32_bf16 v[136:139], v[180:183], a[240:243], v[136:139]
s_waitcnt lgkmcnt(6)
ds_read_b128 v[168:171], v8 offset:2048
v_mfma_f32_16x16x32_bf16 v[136:139], v[184:187], a[248:251], v[136:139]
buffer_load_dwordx4 v[216:219], v4, s[24:27], s93 offen offset:2048 sc1
v_mfma_f32_16x16x32_bf16 v[140:143], v[184:187], a[252:255], v[140:143]
ds_read_b128 v[172:175], v8 offset:3072
v_mfma_f32_16x16x32_bf16 v[140:143], v[180:183], a[244:247], v[140:143]
v_mfma_f32_16x16x32_bf16 v[128:131], v[188:191], a[96:99], v[128:131]
s_waitcnt lgkmcnt(6)
ds_read_b128 v[176:179], v8 offset:4096
v_mfma_f32_16x16x32_bf16 v[128:131], v[144:147], a[104:107], v[128:131]
v_mfma_f32_16x16x32_bf16 v[132:135], v[144:147], a[108:111], v[132:135]
ds_read_b128 v[180:183], v8 offset:5120
v_mfma_f32_16x16x32_bf16 v[132:135], v[188:191], a[100:103], v[132:135]
v_mfma_f32_16x16x32_bf16 v[136:139], v[148:151], a[96:99], v[136:139]
s_waitcnt lgkmcnt(6)
ds_read_b128 v[184:187], v8 offset:6144
v_mfma_f32_16x16x32_bf16 v[136:139], v[152:155], a[104:107], v[136:139]
v_mfma_f32_16x16x32_bf16 v[140:143], v[152:155], a[108:111], v[140:143]
ds_read_b128 v[188:191], v8 offset:7168
v_mfma_f32_16x16x32_bf16 v[140:143], v[148:151], a[100:103], v[140:143]
v_mfma_f32_16x16x32_bf16 v[128:131], v[156:159], a[112:115], v[128:131]
s_waitcnt lgkmcnt(6)
ds_read_b128 v[144:147], v8 offset:8192
v_mfma_f32_16x16x32_bf16 v[128:131], v[160:163], a[120:123], v[128:131]
v_mfma_f32_16x16x32_bf16 v[132:135], v[160:163], a[124:127], v[132:135]
ds_read_b128 v[148:151], v8 offset:9216
v_mfma_f32_16x16x32_bf16 v[132:135], v[156:159], a[116:119], v[132:135]
s_waitcnt lgkmcnt(6)
v_mfma_f32_16x16x32_bf16 v[136:139], v[164:167], a[112:115], v[136:139]
buffer_load_dword v12, v10, s[24:27], s75 offen offset:16 sc1
v_mfma_f32_16x16x32_bf16 v[136:139], v[168:171], a[120:123], v[136:139]
ds_read_b128 v[152:155], v8 offset:10240
v_mfma_f32_16x16x32_bf16 v[140:143], v[168:171], a[124:127], v[140:143]
ds_read_b128 v[156:159], v8 offset:11264
v_mfma_f32_16x16x32_bf16 v[140:143], v[164:167], a[116:119], v[140:143]
v_mfma_f32_16x16x32_bf16 v[128:131], v[172:175], a[128:131], v[128:131]
s_waitcnt lgkmcnt(6)
ds_read_b128 v[160:163], v8 offset:12288
v_mfma_f32_16x16x32_bf16 v[128:131], v[176:179], a[136:139], v[128:131]
v_mfma_f32_16x16x32_bf16 v[132:135], v[176:179], a[140:143], v[132:135]
ds_read_b128 v[164:167], v8 offset:13312
v_mfma_f32_16x16x32_bf16 v[132:135], v[172:175], a[132:135], v[132:135]
v_mfma_f32_16x16x32_bf16 v[136:139], v[180:183], a[128:131], v[136:139]
s_waitcnt lgkmcnt(6)
ds_read_b128 v[168:171], v8 offset:14336
v_mfma_f32_16x16x32_bf16 v[136:139], v[184:187], a[136:139], v[136:139]
v_mfma_f32_16x16x32_bf16 v[140:143], v[184:187], a[140:143], v[140:143]
s_waitcnt vmcnt(10)
ds_read_b128 v[172:175], v8 offset:15360
v_mfma_f32_16x16x32_bf16 v[140:143], v[180:183], a[132:135], v[140:143]
s_barrier
v_mfma_f32_16x16x32_bf16 v[128:131], v[188:191], a[144:147], v[128:131]
s_waitcnt lgkmcnt(6)
ds_read_b128 v[176:179], v7 offset:0
v_mfma_f32_16x16x32_bf16 v[128:131], v[144:147], a[152:155], v[128:131]
v_mfma_f32_16x16x32_bf16 v[132:135], v[144:147], a[156:159], v[132:135]
ds_read_b128 v[180:183], v7 offset:1024
v_mfma_f32_16x16x32_bf16 v[132:135], v[188:191], a[148:151], v[132:135]
v_mfma_f32_16x16x32_bf16 v[136:139], v[148:151], a[144:147], v[136:139]
s_waitcnt lgkmcnt(6)
ds_read_b128 v[184:187], v7 offset:2048
v_mfma_f32_16x16x32_bf16 v[136:139], v[152:155], a[152:155], v[136:139]
v_mfma_f32_16x16x32_bf16 v[140:143], v[152:155], a[156:159], v[140:143]
ds_read_b128 v[188:191], v7 offset:3072
v_mfma_f32_16x16x32_bf16 v[140:143], v[148:151], a[148:151], v[140:143]
v_mfma_f32_16x16x32_bf16 v[128:131], v[156:159], a[160:163], v[128:131]
s_waitcnt lgkmcnt(6)
ds_read_b128 v[144:147], v7 offset:4096
v_mfma_f32_16x16x32_bf16 v[128:131], v[160:163], a[168:171], v[128:131]
v_mfma_f32_16x16x32_bf16 v[132:135], v[160:163], a[172:175], v[132:135]
ds_read_b128 v[148:151], v7 offset:5120
v_mfma_f32_16x16x32_bf16 v[132:135], v[156:159], a[164:167], v[132:135]
v_mfma_f32_16x16x32_bf16 v[136:139], v[164:167], a[160:163], v[136:139]
s_waitcnt lgkmcnt(6)
ds_read_b128 v[152:155], v7 offset:6144
v_mfma_f32_16x16x32_bf16 v[136:139], v[168:171], a[168:171], v[136:139]
v_mfma_f32_16x16x32_bf16 v[140:143], v[168:171], a[172:175], v[140:143]
s_waitcnt vmcnt(0)
ds_read_b128 v[156:159], v7 offset:7168
v_cmp_gt_u32 vcc, 1, v12
v_mfma_f32_16x16x32_bf16 v[140:143], v[164:167], a[164:167], v[140:143]
v_lshlrev_b32 v72, 16, v192
v_and_b32 v73, v13, v192
v_mfma_f32_16x16x32_bf16 v[128:131], v[172:175], a[176:179], v[128:131]
s_waitcnt lgkmcnt(6)
ds_read_b128 v[160:163], v7 offset:8192
v_lshlrev_b32 v74, 16, v193
v_mfma_f32_16x16x32_bf16 v[128:131], v[176:179], a[184:187], v[128:131]
s_cmp_eq_u64 vcc, 0
s_cselect_b32 s77, s83, 2147418112
v_and_b32 v75, v13, v193
v_mfma_f32_16x16x32_bf16 v[132:135], v[176:179], a[188:191], v[132:135]
buffer_load_dwordx4 v[220:223], v4, s[24:27], s77 offen offset:0 sc1
v_mfma_f32_16x16x32_bf16 v[132:135], v[172:175], a[180:183], v[132:135]
s_waitcnt lgkmcnt(5)
ds_read_b128 v[164:167], v7 offset:9216
v_lshlrev_b32 v80, 16, v194
v_mfma_f32_16x16x32_bf16 v[136:139], v[180:183], a[176:179], v[136:139]
buffer_load_dwordx4 v[224:227], v4, s[24:27], s77 offen offset:1024 sc1
v_mfma_f32_16x16x32_bf16 v[136:139], v[184:187], a[184:187], v[136:139]
ds_read_b128 v[168:171], v7 offset:10240
v_and_b32 v81, v13, v194
v_mfma_f32_16x16x32_bf16 v[140:143], v[184:187], a[188:191], v[140:143]
ds_read_b128 v[172:175], v7 offset:11264
v_lshlrev_b32 v82, 16, v195
v_mfma_f32_16x16x32_bf16 v[140:143], v[180:183], a[180:183], v[140:143]
s_waitcnt lgkmcnt(6)
v_and_b32 v83, v13, v195
v_lshlrev_b32 v76, 16, v196
v_mfma_f32_16x16x32_bf16 v[128:131], v[188:191], v[32:35], v[128:131]
buffer_load_dword v11, v10, s[24:27], s73 offen sc1
v_mfma_f32_16x16x32_bf16 v[128:131], v[144:147], v[40:43], v[128:131]
ds_read_b128 v[176:179], v7 offset:12288
v_and_b32 v77, v13, v196
v_mfma_f32_16x16x32_bf16 v[132:135], v[144:147], v[44:47], v[132:135]
buffer_load_dword v12, v10, s[24:27], s75 offen offset:16 sc1
v_mfma_f32_16x16x32_bf16 v[132:135], v[188:191], v[36:39], v[132:135]
v_lshlrev_b32 v78, 16, v197
v_and_b32 v79, v13, v197
v_mfma_f32_16x16x32_bf16 v[136:139], v[148:151], v[32:35], v[136:139]
s_waitcnt lgkmcnt(5)
v_lshlrev_b32 v84, 16, v198
v_and_b32 v85, v13, v198
v_mfma_f32_16x16x32_bf16 v[136:139], v[152:155], v[40:43], v[136:139]
v_lshlrev_b32 v86, 16, v199
v_and_b32 v87, v13, v199
v_mfma_f32_16x16x32_bf16 v[140:143], v[152:155], v[44:47], v[140:143]
v_lshlrev_b32 v88, 16, v200
v_and_b32 v89, v13, v200
v_mfma_f32_16x16x32_bf16 v[140:143], v[148:151], v[36:39], v[140:143]
v_lshlrev_b32 v90, 16, v201
v_and_b32 v91, v13, v201
v_mfma_f32_16x16x32_bf16 v[128:131], v[156:159], v[48:51], v[128:131]
s_waitcnt lgkmcnt(3)
v_lshlrev_b32 v96, 16, v202
v_and_b32 v97, v13, v202
v_mfma_f32_16x16x32_bf16 v[128:131], v[160:163], v[56:59], v[128:131]
v_lshlrev_b32 v98, 16, v203
v_and_b32 v99, v13, v203
v_mfma_f32_16x16x32_bf16 v[132:135], v[160:163], v[60:63], v[132:135]
v_lshlrev_b32 v92, 16, v204
v_and_b32 v93, v13, v204
v_mfma_f32_16x16x32_bf16 v[132:135], v[156:159], v[52:55], v[132:135]
v_lshlrev_b32 v94, 16, v205
v_and_b32 v95, v13, v205
v_mfma_f32_16x16x32_bf16 v[136:139], v[164:167], v[48:51], v[136:139]
s_waitcnt lgkmcnt(1)
v_lshlrev_b32 v100, 16, v206
v_and_b32 v101, v13, v206
v_mfma_f32_16x16x32_bf16 v[136:139], v[168:171], v[56:59], v[136:139]
v_lshlrev_b32 v102, 16, v207
v_and_b32 v103, v13, v207
v_mfma_f32_16x16x32_bf16 v[140:143], v[168:171], v[60:63], v[140:143]
v_mfma_f32_16x16x32_bf16 v[140:143], v[164:167], v[52:55], v[140:143]
v_mfma_f32_16x16x32_bf16 v[128:131], v[172:175], v[64:67], v[128:131]
v_mfma_f32_16x16x32_bf16 v[132:135], v[172:175], v[68:71], v[132:135]
s_waitcnt lgkmcnt(0)
v_mfma_f32_16x16x32_bf16 v[136:139], v[176:179], v[64:67], v[136:139]
v_mfma_f32_16x16x32_bf16 v[140:143], v[176:179], v[68:71], v[140:143]
s_max_u32 s92, s81, s77
s_cmp_lt_u32 s92, 2147418112
s_cbranch_scc1 L_P1
s_mov_b32 s92, 0
s_branch L_S1
L_S0:
buffer_load_dword v11, v10, s[24:27], s73 offen sc1
buffer_load_dword v12, v10, s[24:27], s75 offen offset:16 sc1
L_S1:
s_add_u32 s92, s92, 1
s_waitcnt vmcnt(0)
v_lshrrev_b32 v11, 2, v11
v_min_u32 v11, v11, v12
v_cmp_gt_u32 vcc, 1, v11
s_cmp_gt_u32 s92, 1048576
s_cbranch_scc1 L_S2
s_nop 2
s_cbranch_vccnz L_S0
L_S2:
buffer_load_dwordx4 v[220:223], v4, s[24:27], s83 offen offset:0 sc1
buffer_load_dwordx4 v[224:227], v4, s[24:27], s83 offen offset:1024 sc1
s_cmp_eq_u32 s81, s69
s_cbranch_scc1 L_P1
buffer_load_dwordx4 v[192:195], v4, s[24:27], s69 offen offset:0 sc1
buffer_load_dwordx4 v[196:199], v4, s[24:27], s69 offen offset:1024 sc1
buffer_load_dwordx4 v[200:203], v4, s[24:27], s69 offen offset:2048 sc1
buffer_load_dwordx4 v[204:207], v4, s[24:27], s69 offen offset:3072 sc1
buffer_load_dwordx4 v[208:211], v4, s[24:27], s71 offen offset:0 sc1
buffer_load_dwordx4 v[212:215], v4, s[24:27], s71 offen offset:1024 sc1
buffer_load_dwordx4 v[216:219], v4, s[24:27], s71 offen offset:2048 sc1
s_waitcnt vmcnt(3)
v_lshlrev_b32 v72, 16, v192
v_and_b32 v73, v13, v192
v_lshlrev_b32 v74, 16, v193
v_and_b32 v75, v13, v193
v_lshlrev_b32 v80, 16, v194
v_and_b32 v81, v13, v194
v_lshlrev_b32 v82, 16, v195
v_and_b32 v83, v13, v195
v_lshlrev_b32 v76, 16, v196
v_and_b32 v77, v13, v196
v_lshlrev_b32 v78, 16, v197
v_and_b32 v79, v13, v197
v_lshlrev_b32 v84, 16, v198
v_and_b32 v85, v13, v198
v_lshlrev_b32 v86, 16, v199
v_and_b32 v87, v13, v199
v_lshlrev_b32 v88, 16, v200
v_and_b32 v89, v13, v200
v_lshlrev_b32 v90, 16, v201
v_and_b32 v91, v13, v201
v_lshlrev_b32 v96, 16, v202
v_and_b32 v97, v13, v202
v_lshlrev_b32 v98, 16, v203
v_and_b32 v99, v13, v203
v_lshlrev_b32 v92, 16, v204
v_and_b32 v93, v13, v204
v_lshlrev_b32 v94, 16, v205
v_and_b32 v95, v13, v205
v_lshlrev_b32 v100, 16, v206
v_and_b32 v101, v13, v206
v_lshlrev_b32 v102, 16, v207
v_and_b32 v103, v13, v207
s_waitcnt vmcnt(0)
L_P1:
s_nop 1
v_pk_add_f32 v[72:73], v[72:73], v[88:89]
v_pk_add_f32 v[74:75], v[74:75], v[90:91]
v_pk_add_f32 v[76:77], v[76:77], v[92:93]
v_pk_add_f32 v[78:79], v[78:79], v[94:95]
v_pk_add_f32 v[80:81], v[80:81], v[96:97]
v_pk_add_f32 v[82:83], v[82:83], v[98:99]
v_pk_add_f32 v[84:85], v[84:85], v[100:101]
v_pk_add_f32 v[86:87], v[86:87], v[102:103]
v_pk_add_f32 v[128:129], v[128:129], v[72:73]
v_pk_add_f32 v[130:131], v[130:131], v[74:75]
v_pk_add_f32 v[132:133], v[132:133], v[76:77]
v_pk_add_f32 v[134:135], v[134:135], v[78:79]
v_pk_add_f32 v[136:137], v[136:137], v[80:81]
v_pk_add_f32 v[138:139], v[138:139], v[82:83]
v_pk_add_f32 v[140:141], v[140:141], v[84:85]
v_pk_add_f32 v[142:143], v[142:143], v[86:87]
s_cmp_lg_u32 s3, s84
s_cbranch_scc1 L_NO9
v_lshlrev_b32 v16, 16, v208
v_and_b32 v17, v13, v208
v_lshlrev_b32 v18, 16, v209
v_and_b32 v19, v13, v209
v_lshlrev_b32 v20, 16, v210
v_and_b32 v21, v13, v210
v_lshlrev_b32 v22, 16, v211
v_and_b32 v23, v13, v211
v_pk_add_f32 v[120:121], v[120:121], v[16:17]
v_pk_add_f32 v[122:123], v[122:123], v[18:19]
v_pk_add_f32 v[124:125], v[124:125], v[20:21]
v_pk_add_f32 v[126:127], v[126:127], v[22:23]
v_lshlrev_b32 v16, 16, v212
v_and_b32 v17, v13, v212
v_lshlrev_b32 v18, 16, v213
v_and_b32 v19, v13, v213
v_lshlrev_b32 v20, 16, v214
v_and_b32 v21, v13, v214
v_lshlrev_b32 v22, 16, v215
v_and_b32 v23, v13, v215
v_pk_add_f32 v[120:121], v[120:121], v[16:17]
v_pk_add_f32 v[122:123], v[122:123], v[18:19]
v_pk_add_f32 v[124:125], v[124:125], v[20:21]
v_pk_add_f32 v[126:127], v[126:127], v[22:23]
v_lshlrev_b32 v16, 16, v216
v_and_b32 v17, v13, v216
v_lshlrev_b32 v18, 16, v217
v_and_b32 v19, v13, v217
v_lshlrev_b32 v20, 16, v218
v_and_b32 v21, v13, v218
v_lshlrev_b32 v22, 16, v219
v_and_b32 v23, v13, v219
v_pk_add_f32 v[120:121], v[120:121], v[16:17]
v_pk_add_f32 v[122:123], v[122:123], v[18:19]
v_pk_add_f32 v[124:125], v[124:125], v[20:21]
v_pk_add_f32 v[126:127], v[126:127], v[22:23]
v_cvt_pk_bf16_f32 v228, v120, v121
v_cvt_pk_bf16_f32 v229, v122, v123
v_cvt_pk_bf16_f32 v230, v124, v125
v_cvt_pk_bf16_f32 v231, v126, v127
s_waitcnt vmcnt(0)
buffer_store_dwordx2 v[228:229], v6, s[44:47], s54 offen sc1
buffer_store_dwordx2 v[230:231], v6, s[44:47], s55 offen sc1
s_branch L_9D
L_NO9:
s_waitcnt vmcnt(0)
L_9D:
v_lshlrev_b32 v16, 16, v220
v_and_b32 v17, v13, v220
v_lshlrev_b32 v18, 16, v221
v_and_b32 v19, v13, v221
v_lshlrev_b32 v20, 16, v222
v_and_b32 v21, v13, v222
v_lshlrev_b32 v22, 16, v223
v_and_b32 v23, v13, v223
v_pk_add_f32 v[128:129], v[128:129], v[16:17]
v_pk_add_f32 v[130:131], v[130:131], v[18:19]
v_pk_add_f32 v[136:137], v[136:137], v[20:21]
v_pk_add_f32 v[138:139], v[138:139], v[22:23]
v_cvt_pk_bf16_f32 v128, v128, v129
v_cvt_pk_bf16_f32 v129, v130, v131
v_cvt_pk_bf16_f32 v130, v136, v137
v_cvt_pk_bf16_f32 v131, v138, v139
s_nop 1
v_permlane16_swap_b32 v128, v130
v_permlane16_swap_b32 v129, v131
buffer_store_dwordx4 v[128:131], v5, s[44:47], s52 offen sc1
v_lshlrev_b32 v16, 16, v224
v_and_b32 v17, v13, v224
v_lshlrev_b32 v18, 16, v225
v_and_b32 v19, v13, v225
v_lshlrev_b32 v20, 16, v226
v_and_b32 v21, v13, v226
v_lshlrev_b32 v22, 16, v227
v_and_b32 v23, v13, v227
v_pk_add_f32 v[132:133], v[132:133], v[16:17]
v_pk_add_f32 v[134:135], v[134:135], v[18:19]
v_pk_add_f32 v[140:141], v[140:141], v[20:21]
v_pk_add_f32 v[142:143], v[142:143], v[22:23]
v_cvt_pk_bf16_f32 v132, v132, v133
v_cvt_pk_bf16_f32 v133, v134, v135
v_cvt_pk_bf16_f32 v134, v140, v141
v_cvt_pk_bf16_f32 v135, v142, v143
s_nop 1
v_permlane16_swap_b32 v132, v134
v_permlane16_swap_b32 v133, v135
buffer_store_dwordx4 v[132:135], v5, s[44:47], s53 offen sc1
L_END:
s_endpgm
L_SE2:
v_accvgpr_read_b32 v180, a224
v_accvgpr_read_b32 v182, a228
v_cmp_nle_f32 vcc, v180, v7
v_cmp_nle_f32 s[96:97], v182, v7
s_nop 3
s_or_b64 vcc, vcc, s[96:97]
s_cbranch_vccnz SLOW0
SLOW0_R:
s_add_u32 s53, s77, 180224
buffer_load_dwordx4 a[112:115], v4, s[24:27], s53 offen offset:0 sc1
v_mul_f32 v8, 0x3fb8aa3b, v8
v_mul_f32 v9, 0x3fb8aa3b, v9
v_exp_f32 v8, v8
v_exp_f32 v9, v9
s_nop 0
v_fma_f32 v180, v180, v8, v180
v_fma_f32 v182, v182, v9, v182
v_rcp_f32 v180, v180
v_rcp_f32 v182, v182
s_add_u32 s52, s78, 4096
v_mov_b32 v181, v180
v_mov_b32 v183, v182
v_pk_mul_f32 v[36:37], v[36:37], v[180:181]
v_pk_mul_f32 v[38:39], v[38:39], v[180:181]
v_pk_mul_f32 v[32:33], v[32:33], v[180:181]
v_pk_mul_f32 v[34:35], v[34:35], v[180:181]
v_cvt_pk_bf16_f32 v36, v36, v37
v_cvt_pk_bf16_f32 v37, v38, v39
v_cvt_pk_bf16_f32 v38, v32, v33
v_cvt_pk_bf16_f32 v39, v34, v35
buffer_store_dwordx4 v[36:39], v4, s[24:27], s78 offen offset:0 sc1
buffer_load_dwordx4 a[116:119], v4, s[24:27], s53 offen offset:1024 sc1
v_pk_mul_f32 v[116:117], v[116:117], v[182:183]
v_pk_mul_f32 v[118:119], v[118:119], v[182:183]
v_pk_mul_f32 v[132:133], v[132:133], v[182:183]
v_pk_mul_f32 v[134:135], v[134:135], v[182:183]
v_cvt_pk_bf16_f32 v116, v116, v117
v_cvt_pk_bf16_f32 v117, v118, v119
v_cvt_pk_bf16_f32 v118, v132, v133
v_cvt_pk_bf16_f32 v119, v134, v135
buffer_store_dwordx4 v[116:119], v4, s[24:27], s78 offen offset:1024 sc1
v_pk_mul_f32 v[196:197], v[196:197], v[180:181]
v_pk_mul_f32 v[198:199], v[198:199], v[180:181]
v_pk_mul_f32 v[204:205], v[204:205], v[180:181]
v_pk_mul_f32 v[206:207], v[206:207], v[180:181]
v_cvt_pk_bf16_f32 v196, v196, v197
v_cvt_pk_bf16_f32 v197, v198, v199
v_cvt_pk_bf16_f32 v198, v204, v205
v_cvt_pk_bf16_f32 v199, v206, v207
buffer_store_dwordx4 v[196:199], v4, s[24:27], s78 offen offset:2048 sc1
v_pk_mul_f32 v[184:185], v[184:185], v[182:183]
v_pk_mul_f32 v[186:187], v[186:187], v[182:183]
v_pk_mul_f32 v[240:241], v[240:241], v[182:183]
buffer_load_dwordx4 a[120:123], v4, s[24:27], s53 offen offset:2048 sc1
v_pk_mul_f32 v[242:243], v[242:243], v[182:183]
v_cvt_pk_bf16_f32 v184, v184, v185
v_cvt_pk_bf16_f32 v185, v186, v187
v_cvt_pk_bf16_f32 v186, v240, v241
v_cvt_pk_bf16_f32 v187, v242, v243
buffer_store_dwordx4 v[184:187], v4, s[24:27], s78 offen offset:3072 sc1
v_pk_mul_f32 v[108:109], v[108:109], v[180:181]
v_pk_mul_f32 v[110:111], v[110:111], v[180:181]
v_pk_mul_f32 v[40:41], v[40:41], v[180:181]
v_pk_mul_f32 v[42:43], v[42:43], v[180:181]
v_cvt_pk_bf16_f32 v108, v108, v109
v_cvt_pk_bf16_f32 v109, v110, v111
v_cvt_pk_bf16_f32 v110, v40, v41
v_cvt_pk_bf16_f32 v111, v42, v43
buffer_store_dwordx4 v[108:111], v4, s[24:27], s52 offen offset:0 sc1
v_pk_mul_f32 v[188:189], v[188:189], v[182:183]
v_pk_mul_f32 v[190:191], v[190:191], v[182:183]
v_pk_mul_f32 v[56:57], v[56:57], v[182:183]
v_pk_mul_f32 v[58:59], v[58:59], v[182:183]
v_cvt_pk_bf16_f32 v188, v188, v189
v_cvt_pk_bf16_f32 v189, v190, v191
buffer_load_dwordx4 a[124:127], v4, s[24:27], s53 offen offset:3072 sc1
v_cvt_pk_bf16_f32 v190, v56, v57
v_cvt_pk_bf16_f32 v191, v58, v59
buffer_store_dwordx4 v[188:191], v4, s[24:27], s52 offen offset:1024 sc1
v_pk_mul_f32 v[80:81], v[80:81], v[180:181]
v_pk_mul_f32 v[82:83], v[82:83], v[180:181]
v_pk_mul_f32 v[168:169], v[168:169], v[180:181]
v_pk_mul_f32 v[170:171], v[170:171], v[180:181]
v_cvt_pk_bf16_f32 v80, v80, v81
v_cvt_pk_bf16_f32 v81, v82, v83
v_cvt_pk_bf16_f32 v82, v168, v169
v_cvt_pk_bf16_f32 v83, v170, v171
buffer_store_dwordx4 v[80:83], v4, s[24:27], s52 offen offset:2048 sc1
v_pk_mul_f32 v[88:89], v[88:89], v[182:183]
v_pk_mul_f32 v[90:91], v[90:91], v[182:183]
v_pk_mul_f32 v[192:193], v[192:193], v[182:183]
v_pk_mul_f32 v[194:195], v[194:195], v[182:183]
v_cvt_pk_bf16_f32 v88, v88, v89
v_cvt_pk_bf16_f32 v89, v90, v91
v_cvt_pk_bf16_f32 v90, v192, v193
v_cvt_pk_bf16_f32 v91, v194, v195
buffer_store_dwordx4 v[88:91], v4, s[24:27], s52 offen offset:3072 sc1
s_branch L_LA
CK_Z:
s_mov_b32 s92, 0
CK_Z_L:
s_sleep 1
buffer_load_dword v23, v22, s[40:43], 0 offen sc1
s_add_u32 s92, s92, 1
s_waitcnt vmcnt(0)
v_cmp_gt_u32 vcc, 1, v23
s_cmp_gt_u32 s92, 1048576
s_cbranch_scc1 CK_Z_R
s_nop 3
s_cbranch_vccnz CK_Z_L
s_branch CK_Z_R
CK_WA:
s_mov_b32 s92, 0
CK_WA_L:
s_sleep 1
buffer_load_dword v30, v29, s[24:27], s89 offen sc1
s_add_u32 s92, s92, 1
s_waitcnt vmcnt(0)
v_cmp_gt_u32 vcc, 18, v30
s_cmp_gt_u32 s92, 1048576
s_cbranch_scc1 CK_WA_R
s_nop 3
s_cbranch_vccnz CK_WA_L
s_branch CK_WA_R
CK_ZA:
s_mov_b32 s92, 0
CK_ZA_L:
s_sleep 1
buffer_load_dword v30, v28, s[40:43], 0 offen sc1
s_add_u32 s92, s92, 1
s_waitcnt vmcnt(0)
v_cmp_gt_u32 vcc, 1, v30
s_cmp_gt_u32 s92, 1048576
s_cbranch_scc1 CK_ZA_R
s_nop 3
s_cbranch_vccnz CK_ZA_L
s_branch CK_ZA_R
CK_KV:
s_mov_b32 s92, 0
CK_KV_L:
s_sleep 1
buffer_load_dword v30, v29, s[24:27], s89 offen offset:4 sc1
s_add_u32 s92, s92, 1
s_waitcnt vmcnt(0)
v_cmp_gt_u32 vcc, 8, v30
s_cmp_gt_u32 s92, 1048576
s_cbranch_scc1 CK_KV_R
s_nop 3
s_cbranch_vccnz CK_KV_L
s_branch CK_KV_R
D0:
v_cndmask_b32 v96, v96, v6, s[56:57]
v_cndmask_b32 v120, v120, v6, s[56:57]
v_mov_b32 v112, v6
v_cndmask_b32 v97, v97, v6, s[58:59]
v_cndmask_b32 v121, v121, v6, s[58:59]
v_mov_b32 v113, v6
v_cndmask_b32 v98, v98, v6, s[60:61]
v_cndmask_b32 v122, v122, v6, s[60:61]
v_mov_b32 v114, v6
v_cndmask_b32 v99, v99, v6, s[62:63]
v_cndmask_b32 v123, v123, v6, s[62:63]
v_mov_b32 v115, v6
s_branch D0_R
CK_Q:
s_mov_b32 s92, 0
CK_Q_L:
s_sleep 1
buffer_load_dword v172, v173, s[24:27], 0 offen sc1
s_add_u32 s92, s92, 1
s_waitcnt vmcnt(0)
v_cmp_gt_u32 vcc, 32, v172
s_cmp_gt_u32 s92, 1048576
s_cbranch_scc1 CK_Q_R
s_nop 3
s_cbranch_vccnz CK_Q_L
s_branch CK_Q_R
CK_ZAA:
s_mov_b32 s92, 0
CK_ZAA_L:
s_sleep 1
buffer_load_dword v12, v10, s[24:27], s75 offen offset:4 sc1
s_add_u32 s92, s92, 1
s_waitcnt vmcnt(0)
v_cmp_gt_u32 vcc, 8, v12
s_cmp_gt_u32 s92, 1048576
s_cbranch_scc1 CK_ZAA_R
s_nop 3
s_cbranch_vccnz CK_ZAA_L
s_branch CK_ZAA_R
SLOW0:
v_add_u32 v20, 4096, v4
s_mov_b32 s54, 0
v_mov_b32 v16, v6
v_mov_b32 v18, v6
SLOW0_P:
s_mov_b32 s53, 0
s_mov_b32 s52, s94
SLOW0_T:
s_add_u32 s55, s52, 24576
buffer_load_dwordx4 a[192:195], v4, s[24:27], s52 offen offset:0 sc1
buffer_load_dwordx4 a[196:199], v4, s[24:27], s52 offen offset:1024 sc1
buffer_load_dwordx4 a[200:203], v4, s[24:27], s52 offen offset:2048 sc1
buffer_load_dwordx4 a[204:207], v4, s[24:27], s52 offen offset:3072 sc1
buffer_load_dwordx4 a[208:211], v20, s[24:27], s52 offen offset:0 sc1
buffer_load_dwordx4 a[212:215], v20, s[24:27], s52 offen offset:1024 sc1
buffer_load_dwordx4 a[216:219], v20, s[24:27], s52 offen offset:2048 sc1
buffer_load_dwordx4 a[220:223], v20, s[24:27], s52 offen offset:3072 sc1
buffer_load_dwordx4 a[64:67], v4, s[24:27], s55 offen offset:0 sc1
buffer_load_dwordx4 a[68:71], v4, s[24:27], s55 offen offset:1024 sc1
buffer_load_dwordx4 a[72:75], v4, s[24:27], s55 offen offset:2048 sc1
buffer_load_dwordx4 a[76:79], v4, s[24:27], s55 offen offset:3072 sc1
buffer_load_dwordx4 a[80:83], v20, s[24:27], s55 offen offset:0 sc1
buffer_load_dwordx4 a[84:87], v20, s[24:27], s55 offen offset:1024 sc1
buffer_load_dwordx4 a[88:91], v20, s[24:27], s55 offen offset:2048 sc1
buffer_load_dwordx4 a[92:95], v20, s[24:27], s55 offen offset:3072 sc1
s_waitcnt vmcnt(0)
v_mfma_f32_16x16x32_bf16 v[44:47], a[192:195], a[32:35], 0
v_mfma_f32_16x16x32_bf16 v[44:47], a[196:199], a[36:39], v[44:47]
v_mfma_f32_16x16x32_bf16 v[44:47], a[200:203], a[28:31], v[44:47]
v_mfma_f32_16x16x32_bf16 v[44:47], a[204:207], a[20:23], v[44:47]
v_mfma_f32_16x16x32_bf16 v[52:55], a[192:195], a[44:47], 0
v_mfma_f32_16x16x32_bf16 v[52:55], a[196:199], a[40:43], v[52:55]
v_mfma_f32_16x16x32_bf16 v[52:55], a[200:203], a[12:15], v[52:55]
v_mfma_f32_16x16x32_bf16 v[52:55], a[204:207], a[4:7], v[52:55]
v_mfma_f32_16x16x32_bf16 v[64:67], a[208:211], a[32:35], 0
v_mfma_f32_16x16x32_bf16 v[64:67], a[212:215], a[36:39], v[64:67]
v_mfma_f32_16x16x32_bf16 v[64:67], a[216:219], a[28:31], v[64:67]
v_mfma_f32_16x16x32_bf16 v[64:67], a[220:223], a[20:23], v[64:67]
v_mfma_f32_16x16x32_bf16 v[212:215], a[208:211], a[44:47], 0
v_mfma_f32_16x16x32_bf16 v[212:215], a[212:215], a[40:43], v[212:215]
v_mfma_f32_16x16x32_bf16 v[212:215], a[216:219], a[12:15], v[212:215]
v_mfma_f32_16x16x32_bf16 v[212:215], a[220:223], a[4:7], v[212:215]
s_nop 7
s_cmp_lg_u32 s53, s66
s_cbranch_scc1 SLOW0_U
v_cndmask_b32 v44, v44, v6, s[56:57]
v_cndmask_b32 v212, v212, v6, s[56:57]
v_mov_b32 v64, v6
v_cndmask_b32 v45, v45, v6, s[58:59]
v_cndmask_b32 v213, v213, v6, s[58:59]
v_mov_b32 v65, v6
v_cndmask_b32 v46, v46, v6, s[60:61]
v_cndmask_b32 v214, v214, v6, s[60:61]
v_mov_b32 v66, v6
v_cndmask_b32 v47, v47, v6, s[62:63]
v_cndmask_b32 v215, v215, v6, s[62:63]
v_mov_b32 v67, v6
SLOW0_U:
s_cmp_lg_u32 s54, 0
s_cbranch_scc1 SLOW0_A
v_max3_f32 v16, v16, v44, v45
v_max3_f32 v16, v16, v46, v47
v_max3_f32 v18, v18, v52, v53
v_max3_f32 v18, v18, v54, v55
v_max3_f32 v16, v16, v64, v65
v_max3_f32 v16, v16, v66, v67
v_max3_f32 v18, v18, v212, v213
v_max3_f32 v18, v18, v214, v215
s_branch SLOW0_N
SLOW0_A:
v_sub_f32 v44, v44, v16
v_sub_f32 v45, v45, v16
v_sub_f32 v46, v46, v16
v_sub_f32 v47, v47, v16
v_sub_f32 v52, v52, v18
v_sub_f32 v53, v53, v18
v_sub_f32 v54, v54, v18
v_sub_f32 v55, v55, v18
v_sub_f32 v64, v64, v16
v_sub_f32 v65, v65, v16
v_sub_f32 v66, v66, v16
v_sub_f32 v67, v67, v16
v_sub_f32 v212, v212, v18
v_sub_f32 v213, v213, v18
v_sub_f32 v214, v214, v18
v_sub_f32 v215, v215, v18
v_exp_f32 v44, v44
v_exp_f32 v45, v45
v_exp_f32 v46, v46
v_exp_f32 v47, v47
v_exp_f32 v52, v52
v_exp_f32 v53, v53
v_exp_f32 v54, v54
v_exp_f32 v55, v55
v_exp_f32 v64, v64
v_exp_f32 v65, v65
v_exp_f32 v66, v66
v_exp_f32 v67, v67
v_exp_f32 v212, v212
v_exp_f32 v213, v213
v_exp_f32 v214, v214
v_exp_f32 v215, v215
s_nop 0
v_cvt_pk_bf16_f32 v124, v44, v45
v_cvt_pk_bf16_f32 v125, v46, v47
v_cvt_pk_bf16_f32 v140, v52, v53
v_cvt_pk_bf16_f32 v141, v54, v55
v_cvt_pk_bf16_f32 v126, v64, v65
v_cvt_pk_bf16_f32 v127, v66, v67
v_cvt_pk_bf16_f32 v142, v212, v213
v_cvt_pk_bf16_f32 v143, v214, v215
s_nop 1
v_mfma_f32_16x16x32_bf16 v[36:39], a[64:67], v[124:127], v[36:39]
v_mfma_f32_16x16x32_bf16 v[116:119], a[64:67], v[140:143], v[116:119]
v_mfma_f32_16x16x32_bf16 v[132:135], a[68:71], v[140:143], v[132:135]
v_mfma_f32_16x16x32_bf16 v[32:35], a[68:71], v[124:127], v[32:35]
v_mfma_f32_16x16x32_bf16 v[196:199], a[72:75], v[124:127], v[196:199]
v_mfma_f32_16x16x32_bf16 v[184:187], a[72:75], v[140:143], v[184:187]
v_mfma_f32_16x16x32_bf16 v[240:243], a[76:79], v[140:143], v[240:243]
v_mfma_f32_16x16x32_bf16 v[204:207], a[76:79], v[124:127], v[204:207]
v_mfma_f32_16x16x32_bf16 v[108:111], a[80:83], v[124:127], v[108:111]
v_mfma_f32_16x16x32_bf16 v[188:191], a[80:83], v[140:143], v[188:191]
v_mfma_f32_16x16x32_bf16 v[56:59], a[84:87], v[140:143], v[56:59]
v_mfma_f32_16x16x32_bf16 v[40:43], a[84:87], v[124:127], v[40:43]
v_mfma_f32_16x16x32_bf16 v[80:83], a[88:91], v[124:127], v[80:83]
v_mfma_f32_16x16x32_bf16 v[88:91], a[88:91], v[140:143], v[88:91]
v_mfma_f32_16x16x32_bf16 v[192:195], a[92:95], v[140:143], v[192:195]
v_mfma_f32_16x16x32_bf16 v[168:171], a[92:95], v[124:127], v[168:171]
v_mfma_f32_16x16x32_bf16 a[224:227], a[240:243], v[124:127], a[224:227]
v_mfma_f32_16x16x32_bf16 a[228:231], a[240:243], v[140:143], a[228:231]
SLOW0_N:
s_add_u32 s52, s52, 16384
s_add_u32 s53, s53, 1
s_cmp_le_u32 s53, s66
s_cbranch_scc1 SLOW0_T
s_cmp_lg_u32 s54, 0
s_cbranch_scc1 SLOW0_E
v_mov_b32 v17, v16
v_mov_b32 v19, v18
s_nop 1
v_permlane32_swap_b32 v17, v16
v_permlane32_swap_b32 v19, v18
s_nop 1
v_max_f32 v16, v16, v17
v_max_f32 v18, v18, v19
v_mov_b32 v17, v16
v_mov_b32 v19, v18
s_nop 1
v_permlane16_swap_b32 v17, v16
v_permlane16_swap_b32 v19, v18
s_nop 1
v_max_f32 v16, v16, v17
v_max_f32 v18, v18, v19
v_mov_b32 v36, 0
v_mov_b32 v37, 0
v_mov_b32 v38, 0
v_mov_b32 v39, 0
v_mov_b32 v32, 0
v_mov_b32 v33, 0
v_mov_b32 v34, 0
v_mov_b32 v35, 0
v_mov_b32 v196, 0
v_mov_b32 v197, 0
v_mov_b32 v198, 0
v_mov_b32 v199, 0
v_mov_b32 v204, 0
v_mov_b32 v205, 0
v_mov_b32 v206, 0
v_mov_b32 v207, 0
v_mov_b32 v108, 0
v_mov_b32 v109, 0
v_mov_b32 v110, 0
v_mov_b32 v111, 0
v_mov_b32 v40, 0
v_mov_b32 v41, 0
v_mov_b32 v42, 0
v_mov_b32 v43, 0
v_mov_b32 v80, 0
v_mov_b32 v81, 0
v_mov_b32 v82, 0
v_mov_b32 v83, 0
v_mov_b32 v168, 0
v_mov_b32 v169, 0
v_mov_b32 v170, 0
v_mov_b32 v171, 0
v_mov_b32 v116, 0
v_mov_b32 v117, 0
v_mov_b32 v118, 0
v_mov_b32 v119, 0
v_mov_b32 v132, 0
v_mov_b32 v133, 0
v_mov_b32 v134, 0
v_mov_b32 v135, 0
v_mov_b32 v184, 0
v_mov_b32 v185, 0
v_mov_b32 v186, 0
v_mov_b32 v187, 0
v_mov_b32 v240, 0
v_mov_b32 v241, 0
v_mov_b32 v242, 0
v_mov_b32 v243, 0
v_mov_b32 v188, 0
v_mov_b32 v189, 0
v_mov_b32 v190, 0
v_mov_b32 v191, 0
v_mov_b32 v56, 0
v_mov_b32 v57, 0
v_mov_b32 v58, 0
v_mov_b32 v59, 0
v_mov_b32 v88, 0
v_mov_b32 v89, 0
v_mov_b32 v90, 0
v_mov_b32 v91, 0
v_mov_b32 v192, 0
v_mov_b32 v193, 0
v_mov_b32 v194, 0
v_mov_b32 v195, 0
v_accvgpr_write_b32 a224, 0
v_accvgpr_write_b32 a225, 0
v_accvgpr_write_b32 a226, 0
v_accvgpr_write_b32 a227, 0
v_accvgpr_write_b32 a228, 0
v_accvgpr_write_b32 a229, 0
v_accvgpr_write_b32 a230, 0
v_accvgpr_write_b32 a231, 0
s_mov_b32 s54, 1
s_branch SLOW0_P
SLOW0_E:
s_nop 7
v_accvgpr_read_b32 v180, a224
v_accvgpr_read_b32 v182, a228
s_branch SLOW0_R
SLOW1:
v_add_u32 v20, 4096, v4
s_mov_b32 s54, 0
v_mov_b32 v16, v6
v_mov_b32 v18, v6
SLOW1_P:
s_mov_b32 s53, 0
s_mov_b32 s52, s94
SLOW1_T:
s_add_u32 s55, s52, 24576
buffer_load_dwordx4 a[192:195], v4, s[24:27], s52 offen offset:0 sc1
buffer_load_dwordx4 a[196:199], v4, s[24:27], s52 offen offset:1024 sc1
buffer_load_dwordx4 a[200:203], v4, s[24:27], s52 offen offset:2048 sc1
buffer_load_dwordx4 a[204:207], v4, s[24:27], s52 offen offset:3072 sc1
buffer_load_dwordx4 a[208:211], v20, s[24:27], s52 offen offset:0 sc1
buffer_load_dwordx4 a[212:215], v20, s[24:27], s52 offen offset:1024 sc1
buffer_load_dwordx4 a[216:219], v20, s[24:27], s52 offen offset:2048 sc1
buffer_load_dwordx4 a[220:223], v20, s[24:27], s52 offen offset:3072 sc1
buffer_load_dwordx4 a[64:67], v4, s[24:27], s55 offen offset:0 sc1
buffer_load_dwordx4 a[68:71], v4, s[24:27], s55 offen offset:1024 sc1
buffer_load_dwordx4 a[72:75], v4, s[24:27], s55 offen offset:2048 sc1
buffer_load_dwordx4 a[76:79], v4, s[24:27], s55 offen offset:3072 sc1
buffer_load_dwordx4 a[80:83], v20, s[24:27], s55 offen offset:0 sc1
buffer_load_dwordx4 a[84:87], v20, s[24:27], s55 offen offset:1024 sc1
buffer_load_dwordx4 a[88:91], v20, s[24:27], s55 offen offset:2048 sc1
buffer_load_dwordx4 a[92:95], v20, s[24:27], s55 offen offset:3072 sc1
s_waitcnt vmcnt(0)
v_mfma_f32_16x16x32_bf16 v[44:47], a[192:195], a[48:51], 0
v_mfma_f32_16x16x32_bf16 v[44:47], a[196:199], a[52:55], v[44:47]
v_mfma_f32_16x16x32_bf16 v[44:47], a[200:203], a[0:3], v[44:47]
v_mfma_f32_16x16x32_bf16 v[44:47], a[204:207], a[8:11], v[44:47]
v_mfma_f32_16x16x32_bf16 v[52:55], a[192:195], a[60:63], 0
v_mfma_f32_16x16x32_bf16 v[52:55], a[196:199], a[56:59], v[52:55]
v_mfma_f32_16x16x32_bf16 v[52:55], a[200:203], a[16:19], v[52:55]
v_mfma_f32_16x16x32_bf16 v[52:55], a[204:207], a[24:27], v[52:55]
v_mfma_f32_16x16x32_bf16 v[64:67], a[208:211], a[48:51], 0
v_mfma_f32_16x16x32_bf16 v[64:67], a[212:215], a[52:55], v[64:67]
v_mfma_f32_16x16x32_bf16 v[64:67], a[216:219], a[0:3], v[64:67]
v_mfma_f32_16x16x32_bf16 v[64:67], a[220:223], a[8:11], v[64:67]
v_mfma_f32_16x16x32_bf16 v[212:215], a[208:211], a[60:63], 0
v_mfma_f32_16x16x32_bf16 v[212:215], a[212:215], a[56:59], v[212:215]
v_mfma_f32_16x16x32_bf16 v[212:215], a[216:219], a[16:19], v[212:215]
v_mfma_f32_16x16x32_bf16 v[212:215], a[220:223], a[24:27], v[212:215]
s_nop 7
s_cmp_lg_u32 s53, s67
s_cbranch_scc1 SLOW1_U
v_cndmask_b32 v44, v44, v6, s[56:57]
v_cndmask_b32 v212, v212, v6, s[56:57]
v_mov_b32 v64, v6
v_cndmask_b32 v45, v45, v6, s[58:59]
v_cndmask_b32 v213, v213, v6, s[58:59]
v_mov_b32 v65, v6
v_cndmask_b32 v46, v46, v6, s[60:61]
v_cndmask_b32 v214, v214, v6, s[60:61]
v_mov_b32 v66, v6
v_cndmask_b32 v47, v47, v6, s[62:63]
v_cndmask_b32 v215, v215, v6, s[62:63]
v_mov_b32 v67, v6
SLOW1_U:
s_cmp_lg_u32 s54, 0
s_cbranch_scc1 SLOW1_A
v_max3_f32 v16, v16, v44, v45
v_max3_f32 v16, v16, v46, v47
v_max3_f32 v18, v18, v52, v53
v_max3_f32 v18, v18, v54, v55
v_max3_f32 v16, v16, v64, v65
v_max3_f32 v16, v16, v66, v67
v_max3_f32 v18, v18, v212, v213
v_max3_f32 v18, v18, v214, v215
s_branch SLOW1_N
SLOW1_A:
v_sub_f32 v44, v44, v16
v_sub_f32 v45, v45, v16
v_sub_f32 v46, v46, v16
v_sub_f32 v47, v47, v16
v_sub_f32 v52, v52, v18
v_sub_f32 v53, v53, v18
v_sub_f32 v54, v54, v18
v_sub_f32 v55, v55, v18
v_sub_f32 v64, v64, v16
v_sub_f32 v65, v65, v16
v_sub_f32 v66, v66, v16
v_sub_f32 v67, v67, v16
v_sub_f32 v212, v212, v18
v_sub_f32 v213, v213, v18
v_sub_f32 v214, v214, v18
v_sub_f32 v215, v215, v18
v_exp_f32 v44, v44
v_exp_f32 v45, v45
v_exp_f32 v46, v46
v_exp_f32 v47, v47
v_exp_f32 v52, v52
v_exp_f32 v53, v53
v_exp_f32 v54, v54
v_exp_f32 v55, v55
v_exp_f32 v64, v64
v_exp_f32 v65, v65
v_exp_f32 v66, v66
v_exp_f32 v67, v67
v_exp_f32 v212, v212
v_exp_f32 v213, v213
v_exp_f32 v214, v214
v_exp_f32 v215, v215
s_nop 0
v_cvt_pk_bf16_f32 v124, v44, v45
v_cvt_pk_bf16_f32 v125, v46, v47
v_cvt_pk_bf16_f32 v140, v52, v53
v_cvt_pk_bf16_f32 v141, v54, v55
v_cvt_pk_bf16_f32 v126, v64, v65
v_cvt_pk_bf16_f32 v127, v66, v67
v_cvt_pk_bf16_f32 v142, v212, v213
v_cvt_pk_bf16_f32 v143, v214, v215
s_nop 1
v_mfma_f32_16x16x32_bf16 v[60:63], a[64:67], v[124:127], v[60:63]
v_mfma_f32_16x16x32_bf16 v[148:151], a[64:67], v[140:143], v[148:151]
v_mfma_f32_16x16x32_bf16 v[48:51], a[68:71], v[140:143], v[48:51]
v_mfma_f32_16x16x32_bf16 v[68:71], a[68:71], v[124:127], v[68:71]
v_mfma_f32_16x16x32_bf16 v[72:75], a[72:75], v[124:127], v[72:75]
v_mfma_f32_16x16x32_bf16 v[236:239], a[72:75], v[140:143], v[236:239]
v_mfma_f32_16x16x32_bf16 v[224:227], a[76:79], v[140:143], v[224:227]
v_mfma_f32_16x16x32_bf16 v[220:223], a[76:79], v[124:127], v[220:223]
v_mfma_f32_16x16x32_bf16 v[84:87], a[80:83], v[124:127], v[84:87]
v_mfma_f32_16x16x32_bf16 v[164:167], a[80:83], v[140:143], v[164:167]
v_mfma_f32_16x16x32_bf16 v[156:159], a[84:87], v[140:143], v[156:159]
v_mfma_f32_16x16x32_bf16 v[76:79], a[84:87], v[124:127], v[76:79]
v_mfma_f32_16x16x32_bf16 v[160:163], a[88:91], v[124:127], v[160:163]
v_mfma_f32_16x16x32_bf16 v[216:219], a[88:91], v[140:143], v[216:219]
v_mfma_f32_16x16x32_bf16 v[208:211], a[92:95], v[140:143], v[208:211]
v_mfma_f32_16x16x32_bf16 v[252:255], a[92:95], v[124:127], v[252:255]
v_mfma_f32_16x16x32_bf16 a[232:235], a[240:243], v[124:127], a[232:235]
v_mfma_f32_16x16x32_bf16 a[236:239], a[240:243], v[140:143], a[236:239]
SLOW1_N:
s_add_u32 s52, s52, 16384
s_add_u32 s53, s53, 1
s_cmp_le_u32 s53, s67
s_cbranch_scc1 SLOW1_T
s_cmp_lg_u32 s54, 0
s_cbranch_scc1 SLOW1_E
v_mov_b32 v17, v16
v_mov_b32 v19, v18
s_nop 1
v_permlane32_swap_b32 v17, v16
v_permlane32_swap_b32 v19, v18
s_nop 1
v_max_f32 v16, v16, v17
v_max_f32 v18, v18, v19
v_mov_b32 v17, v16
v_mov_b32 v19, v18
s_nop 1
v_permlane16_swap_b32 v17, v16
v_permlane16_swap_b32 v19, v18
s_nop 1
v_max_f32 v16, v16, v17
v_max_f32 v18, v18, v19
v_mov_b32 v60, 0
v_mov_b32 v61, 0
v_mov_b32 v62, 0
v_mov_b32 v63, 0
v_mov_b32 v68, 0
v_mov_b32 v69, 0
v_mov_b32 v70, 0
v_mov_b32 v71, 0
v_mov_b32 v72, 0
v_mov_b32 v73, 0
v_mov_b32 v74, 0
v_mov_b32 v75, 0
v_mov_b32 v220, 0
v_mov_b32 v221, 0
v_mov_b32 v222, 0
v_mov_b32 v223, 0
v_mov_b32 v84, 0
v_mov_b32 v85, 0
v_mov_b32 v86, 0
v_mov_b32 v87, 0
v_mov_b32 v76, 0
v_mov_b32 v77, 0
v_mov_b32 v78, 0
v_mov_b32 v79, 0
v_mov_b32 v160, 0
v_mov_b32 v161, 0
v_mov_b32 v162, 0
v_mov_b32 v163, 0
v_mov_b32 v252, 0
v_mov_b32 v253, 0
v_mov_b32 v254, 0
v_mov_b32 v255, 0
v_mov_b32 v148, 0
v_mov_b32 v149, 0
v_mov_b32 v150, 0
v_mov_b32 v151, 0
v_mov_b32 v48, 0
v_mov_b32 v49, 0
v_mov_b32 v50, 0
v_mov_b32 v51, 0
v_mov_b32 v236, 0
v_mov_b32 v237, 0
v_mov_b32 v238, 0
v_mov_b32 v239, 0
v_mov_b32 v224, 0
v_mov_b32 v225, 0
v_mov_b32 v226, 0
v_mov_b32 v227, 0
v_mov_b32 v164, 0
v_mov_b32 v165, 0
v_mov_b32 v166, 0
v_mov_b32 v167, 0
v_mov_b32 v156, 0
v_mov_b32 v157, 0
v_mov_b32 v158, 0
v_mov_b32 v159, 0
v_mov_b32 v216, 0
v_mov_b32 v217, 0
v_mov_b32 v218, 0
v_mov_b32 v219, 0
v_mov_b32 v208, 0
v_mov_b32 v209, 0
v_mov_b32 v210, 0
v_mov_b32 v211, 0
v_accvgpr_write_b32 a232, 0
v_accvgpr_write_b32 a233, 0
v_accvgpr_write_b32 a234, 0
v_accvgpr_write_b32 a235, 0
v_accvgpr_write_b32 a236, 0
v_accvgpr_write_b32 a237, 0
v_accvgpr_write_b32 a238, 0
v_accvgpr_write_b32 a239, 0
s_mov_b32 s54, 1
s_branch SLOW1_P
SLOW1_E:
s_nop 7
v_accvgpr_read_b32 v180, a232
v_accvgpr_read_b32 v182, a236
s_add_u32 s52, s79, 4096
v_fma_f32 v180, v180, v10, v180
v_fma_f32 v182, v182, v11, v182
v_rcp_f32 v180, v180
v_rcp_f32 v182, v182
s_nop 0
v_pk_mul_f32 v[60:61], v[60:61], v[180:181] op_sel_hi:[1,0]
v_pk_mul_f32 v[62:63], v[62:63], v[180:181] op_sel_hi:[1,0]
v_pk_mul_f32 v[68:69], v[68:69], v[180:181] op_sel_hi:[1,0]
v_pk_mul_f32 v[70:71], v[70:71], v[180:181] op_sel_hi:[1,0]
v_cvt_pk_bf16_f32 v60, v60, v61
v_cvt_pk_bf16_f32 v61, v62, v63
v_cvt_pk_bf16_f32 v62, v68, v69
v_cvt_pk_bf16_f32 v63, v70, v71
s_branch L_EP
.section .rodata,"a"
.p2align 6
.amdhsa_kernel gated_mix__sliding_local_dilated__compressed_kv_cla__prompt_kernel
  .amdhsa_next_free_vgpr 512
  .amdhsa_next_free_sgpr 102
  .amdhsa_accum_offset 256
  .amdhsa_group_segment_fixed_size 0
  .amdhsa_kernarg_size 104
  .amdhsa_user_sgpr_count 2
  .amdhsa_user_sgpr_kernarg_segment_ptr 1
  .amdhsa_system_sgpr_workgroup_id_x 1
.end_amdhsa_kernel
```

```asm
; @launch grid=(256,1,1) block=(256,1,1) lds=163840
.amdgcn_target "amdgcn-amd-amdhsa--gfx950"
.text

.globl gated_mix__sliding_local_dilated__compressed_kv_cla__prompt_kernel
.p2align 8
.type gated_mix__sliding_local_dilated__compressed_kv_cla__prompt_kernel,@function
gated_mix__sliding_local_dilated__compressed_kv_cla__prompt_kernel:
s_cmp_ge_u32 s2, 256
s_cbranch_scc1 L_END
s_load_dwordx2 s[8:9], s[0:1], 32
s_load_dwordx2 s[56:57], s[0:1], 56
s_load_dwordx2 s[16:17], s[0:1], 48
s_load_dwordx2 s[24:25], s[0:1], 96
s_load_dwordx2 s[12:13], s[0:1], 0
s_load_dwordx2 s[20:21], s[0:1], 40
s_load_dwordx2 s[28:29], s[0:1], 8
s_load_dwordx2 s[48:49], s[0:1], 16
s_load_dwordx2 s[32:33], s[0:1], 64
s_load_dwordx2 s[36:37], s[0:1], 72
s_load_dwordx2 s[40:41], s[0:1], 88
s_load_dwordx2 s[44:45], s[0:1], 80
s_getpc_b64 s[96:97]
L_PC:
s_lshr_b32 s6, s2, 3
s_lshl_b32 s98, s6, 11
s_add_u32 s98, s98, L_MAIN-L_PC
s_add_u32 s96, s96, s98
s_addc_u32 s97, s97, 0
v_lshlrev_b32 v16, 3, v0
v_mov_b32 v17, s97
v_add_co_u32 v16, vcc, s96, v16
v_lshrrev_b32 v5, 6, v0
v_and_b32 v1, 63, v0
v_addc_co_u32 v17, vcc, 0, v17, vcc
v_readfirstlane_b32 s3, v5
global_load_dwordx2 a[252:253], v[16:17], off
v_and_b32 v2, 15, v0
v_lshrrev_b32 v3, 4, v1
v_lshlrev_b32 v4, 4, v1
s_and_b32 s7, s2, 7
s_and_b32 s65, s6, 3
s_lshl2_add_u32 s4, s7, s65
s_lshr_b32 s5, s6, 2
s_lshl2_add_u32 s66, s5, s3
s_sub_u32 s67, 63, s66
v_lshrrev_b32 v16, 3, v1
v_and_b32 v17, 7, v1
v_xor_b32 v18, v17, v3
v_lshlrev_b32 v19, 10, v16
v_lshl_add_u32 v5, v18, 4, v19
v_xor_b32 v18, 4, v18
v_lshl_add_u32 v6, v18, 4, v19
v_add_u32 v6, 7168, v6
v_and_b32 v18, 1, v3
v_lshlrev_b32 v18, 1, v18
v_xor_b32 v18, v17, v18
v_lshlrev_b32 v19, 13, v16
v_lshl_add_u32 v7, v18, 4, v19
v_xor_b32 v18, 4, v18
v_lshl_add_u32 v8, v18, 4, v19
v_add_u32 v8, 64512, v8
s_add_u32 s69, s65, s5
s_and_b32 s69, s69, 1
s_mul_i32 s64, s7, 2
s_and_b32 s64, s64, 7
s_or_b32 s69, s69, s64
s_add_u32 s93, s65, s5
s_and_b32 s93, s93, 0
s_mul_i32 s64, s7, 1
s_and_b32 s64, s64, 7
s_or_b32 s93, s93, s64
s_lshl_b32 s70, s69, 7
s_lshl_b32 s75, s69, 19
s_lshr_b32 s54, s3, 1
s_and_b32 s55, s3, 1
s_lshl3_add_u32 s87, s54, s5
s_lshl_b32 s64, s55, 5
s_add_u32 s68, s87, s64
s_lshl_b32 s68, s68, 15
s_lshl_b32 s73, s3, 13
s_add_u32 s73, s73, 65536
s_lshl1_add_u32 s74, s4, s55
s_lshl_b32 s74, s74, 7
s_lshl_b32 s64, s54, 18
s_add_u32 s74, s74, s64
s_lshl_b32 s77, s3, 12
s_add_u32 s71, s68, s70
s_add_u32 s76, s74, s75
s_mov_b32 s10, 2097152
s_mov_b32 s11, 0x20000
s_mov_b32 s58, 4194304
s_mov_b32 s59, 0x20000
s_waitcnt lgkmcnt(0)
s_add_u32 m0, s73, 0
s_add_u32 s64, s71, 0
buffer_load_dwordx4 v5, s[8:11], s64 offen lds
buffer_load_dwordx4 v6, s[8:11], s64 offen offset:1024 lds
s_add_u32 m0, s73, 2048
s_add_u32 s64, s71, 16384
buffer_load_dwordx4 v5, s[8:11], s64 offen lds
buffer_load_dwordx4 v6, s[8:11], s64 offen offset:1024 lds
s_add_u32 m0, s77, 0
s_add_u32 s64, s76, 0
buffer_load_dwordx4 v7, s[56:59], s64 offen lds
buffer_load_dwordx4 v8, s[56:59], s64 offen offset:1024 lds
s_add_u32 m0, s77, 2048
s_add_u32 s64, s76, 131072
buffer_load_dwordx4 v7, s[56:59], s64 offen lds
buffer_load_dwordx4 v8, s[56:59], s64 offen offset:1024 lds
s_add_u32 m0, s73, 4096
s_add_u32 s64, s71, 524288
buffer_load_dwordx4 v5, s[8:11], s64 offen lds
buffer_load_dwordx4 v6, s[8:11], s64 offen offset:1024 lds
s_add_u32 m0, s73, 6144
s_add_u32 s64, s71, 540672
buffer_load_dwordx4 v5, s[8:11], s64 offen lds
buffer_load_dwordx4 v6, s[8:11], s64 offen offset:1024 lds
s_mov_b32 s18, 4194304
s_mov_b32 s19, 0x20000
s_lshl_b32 s65, s54, 7
s_lshl_b32 s53, s55, 12
v_lshrrev_b32 v16, 1, v2
v_xor_b32 v16, v16, v3
v_add_u32 v17, s65, v2
v_lshlrev_b32 v17, 7, v17
v_add_u32 v17, 65536, v17
v_lshl_add_u32 v9, v16, 4, v17
v_xor_b32 v10, 64, v9
v_bfe_u32 v16, v1, 2, 2
v_lshl_add_u32 v17, v3, 3, v16
v_lshlrev_b32 v17, 7, v17
v_and_b32 v18, 3, v1
v_lshl_add_u32 v17, v18, 3, v17
v_add_u32 v17, s53, v17
v_lshrrev_b32 v16, 1, v16
v_and_b32 v18, 1, v3
v_lshl_add_u32 v16, v18, 1, v16
v_xor_b32 v18, 0, v16
v_lshl_add_u32 v11, v18, 5, v17
v_xor_b32 v18, 1, v16
v_lshl_add_u32 v12, v18, 5, v17
v_xor_b32 v18, 2, v16
v_lshl_add_u32 v13, v18, 5, v17
v_xor_b32 v18, 3, v16
v_lshl_add_u32 v14, v18, 5, v17
s_add_u32 m0, s77, 16384
s_add_u32 s64, s76, 0
buffer_load_dwordx4 v7, s[16:19], s64 offen lds
buffer_load_dwordx4 v8, s[16:19], s64 offen offset:1024 lds
s_add_u32 m0, s77, 18432
s_add_u32 s64, s76, 131072
buffer_load_dwordx4 v7, s[16:19], s64 offen lds
buffer_load_dwordx4 v8, s[16:19], s64 offen offset:1024 lds
s_mov_b64 exec, 0
s_cmp_eq_u32 s3, 0
s_cbranch_scc1 L_PAD0
s_cmp_eq_u32 s3, 1
s_cbranch_scc1 L_PAD1
s_cmp_eq_u32 s3, 2
s_cbranch_scc1 L_PAD2
s_branch L_PAD3
.p2align 12
.fill 586, 4, 0xbf800000
L_MAIN:
s_mov_b64 exec, -1
s_xor_b32 s71, s70, 128
s_add_u32 s71, s68, s71
s_add_u32 m0, s73, 32768
s_add_u32 s64, s71, 0
buffer_load_dwordx4 v5, s[8:11], s64 offen lds
buffer_load_dwordx4 v6, s[8:11], s64 offen offset:1024 lds
s_add_u32 m0, s73, 34816
s_add_u32 s64, s71, 16384
buffer_load_dwordx4 v5, s[8:11], s64 offen lds
buffer_load_dwordx4 v6, s[8:11], s64 offen offset:1024 lds
s_add_u32 m0, s73, 36864
s_add_u32 s64, s71, 524288
buffer_load_dwordx4 v5, s[8:11], s64 offen lds
buffer_load_dwordx4 v6, s[8:11], s64 offen offset:1024 lds
s_add_u32 m0, s73, 38912
s_add_u32 s64, s71, 540672
buffer_load_dwordx4 v5, s[8:11], s64 offen lds
buffer_load_dwordx4 v6, s[8:11], s64 offen offset:1024 lds
s_waitcnt vmcnt(12)
s_barrier
ds_read_b128 a[64:67], v9 offset:0
ds_read_b128 a[68:71], v10 offset:0
ds_read_b64_tr_b16 a[128:129], v11 offset:0
ds_read_b64_tr_b16 a[130:131], v11 offset:512
ds_read_b64_tr_b16 a[132:133], v11 offset:8192
ds_read_b64_tr_b16 a[134:135], v11 offset:8704
ds_read_b64_tr_b16 a[136:137], v12 offset:0
ds_read_b64_tr_b16 a[138:139], v12 offset:512
ds_read_b64_tr_b16 a[140:141], v12 offset:8192
ds_read_b64_tr_b16 a[142:143], v12 offset:8704
ds_read_b64_tr_b16 a[144:145], v13 offset:0
ds_read_b64_tr_b16 a[146:147], v13 offset:512
ds_read_b64_tr_b16 a[148:149], v13 offset:8192
ds_read_b64_tr_b16 a[150:151], v13 offset:8704
ds_read_b64_tr_b16 a[152:153], v14 offset:0
ds_read_b64_tr_b16 a[154:155], v14 offset:512
ds_read_b64_tr_b16 a[156:157], v14 offset:8192
ds_read_b64_tr_b16 a[158:159], v14 offset:8704
ds_read_b128 a[72:75], v9 offset:2048
ds_read_b128 a[76:79], v10 offset:2048
ds_read_b128 a[80:83], v9 offset:4096
ds_read_b128 a[84:87], v10 offset:4096
ds_read_b128 a[88:91], v9 offset:6144
ds_read_b128 a[92:95], v10 offset:6144
s_waitcnt lgkmcnt(0)
v_mfma_f32_16x16x32_bf16 v[32:35], a[64:67], a[128:131], 0
s_waitcnt vmcnt(8)
v_mfma_f32_16x16x32_bf16 v[32:35], a[68:71], a[132:135], v[32:35]
s_barrier
v_mfma_f32_16x16x32_bf16 v[40:43], a[68:71], a[140:143], 0
s_mov_b32 s26, 268435456
s_mov_b32 s27, 0x20000
ds_read_b128 a[96:99], v9 offset:8192
v_mfma_f32_16x16x32_bf16 v[40:43], a[64:67], a[136:139], v[40:43]
s_xor_b32 s76, s75, 524288
s_add_u32 s76, s74, s76
s_mov_b32 s14, 2359296
v_mfma_f32_16x16x32_bf16 v[48:51], a[64:67], a[144:147], 0
s_add_u32 m0, s77, 32768
s_add_u32 s64, s76, 0
s_mov_b32 s15, 0x20000
v_mfma_f32_16x16x32_bf16 v[48:51], a[68:71], a[148:151], v[48:51]
buffer_load_dwordx4 v7, s[56:59], s64 offen lds
v_mfma_f32_16x16x32_bf16 v[56:59], a[68:71], a[156:159], 0
s_mov_b32 s22, 4718592
s_mov_b32 s23, 0x20000
ds_read_b128 a[100:103], v10 offset:8192
v_mfma_f32_16x16x32_bf16 v[56:59], a[64:67], a[152:155], v[56:59]
buffer_load_dwordx4 v8, s[56:59], s64 offen offset:1024 lds
v_mfma_f32_16x16x32_bf16 v[60:63], a[72:75], a[152:155], 0
s_add_u32 m0, s77, 34816
s_add_u32 s64, s76, 131072
ds_read_b128 a[104:107], v9 offset:10240
v_mfma_f32_16x16x32_bf16 v[60:63], a[76:79], a[156:159], v[60:63]
s_mov_b32 s30, 1990656
s_mov_b32 s31, 0x20000
s_mov_b32 s34, 4718592
v_mfma_f32_16x16x32_bf16 v[52:55], a[76:79], a[148:151], 0
buffer_load_dwordx4 v7, s[56:59], s64 offen lds
v_mfma_f32_16x16x32_bf16 v[52:55], a[72:75], a[144:147], v[52:55]
s_mov_b32 s35, 0x20000
ds_read_b64_tr_b16 a[160:161], v11 offset:16384
ds_read_b64_tr_b16 a[162:163], v11 offset:16896
v_mfma_f32_16x16x32_bf16 v[44:47], a[72:75], a[136:139], 0
s_mov_b32 s38, 1152
s_mov_b32 s39, 0x20000
s_mov_b32 s42, 256
v_mfma_f32_16x16x32_bf16 v[44:47], a[76:79], a[140:143], v[44:47]
buffer_load_dwordx4 v8, s[56:59], s64 offen offset:1024 lds
v_mfma_f32_16x16x32_bf16 v[36:39], a[76:79], a[132:135], 0
s_mov_b32 s43, 0x20000
s_mov_b32 s46, 2359296
s_mov_b32 s47, 0x20000
v_mfma_f32_16x16x32_bf16 v[36:39], a[72:75], a[128:131], v[36:39]
s_add_u32 m0, s77, 49152
s_add_u32 s64, s76, 0
ds_read_b128 a[108:111], v10 offset:10240
v_mfma_f32_16x16x32_bf16 v[64:67], a[80:83], a[128:131], 0
s_mov_b32 s50, 663552
s_mov_b32 s51, 0x20000
s_lshl_b32 s89, s4, 10
v_mfma_f32_16x16x32_bf16 v[64:67], a[84:87], a[132:135], v[64:67]
buffer_load_dwordx4 v7, s[16:19], s64 offen lds
v_mfma_f32_16x16x32_bf16 v[72:75], a[84:87], a[140:143], 0
s_add_u32 s89, s89, 75497472
ds_read_b64_tr_b16 a[164:165], v11 offset:24576
ds_read_b64_tr_b16 a[166:167], v11 offset:25088
v_mfma_f32_16x16x32_bf16 v[72:75], a[80:83], a[136:139], v[72:75]
s_mul_i32 s94, s4, 1064960
s_cmp_eq_u32 s66, 0
s_cselect_b32 s52, s89, 2147418112
v_mfma_f32_16x16x32_bf16 v[80:83], a[80:83], a[144:147], 0
buffer_load_dwordx4 v8, s[16:19], s64 offen offset:1024 lds
v_mfma_f32_16x16x32_bf16 v[80:83], a[84:87], a[148:151], v[80:83]
s_add_u32 m0, s77, 51200
s_add_u32 s64, s76, 131072
ds_read_b128 a[112:115], v9 offset:12288
v_mfma_f32_16x16x32_bf16 v[88:91], a[84:87], a[156:159], 0
s_lshl_b32 s53, s5, 10
s_add_u32 s53, s53, s94
s_add_u32 s53, s53, 1048576
v_mfma_f32_16x16x32_bf16 v[88:91], a[80:83], a[152:155], v[88:91]
buffer_load_dwordx4 v7, s[16:19], s64 offen lds
v_mfma_f32_16x16x32_bf16 v[92:95], a[88:91], a[152:155], 0
ds_read_b64_tr_b16 a[168:169], v12 offset:16384
ds_read_b64_tr_b16 a[170:171], v12 offset:16896
v_mfma_f32_16x16x32_bf16 v[92:95], a[92:95], a[156:159], v[92:95]
s_cmp_eq_u32 s3, 1
s_cselect_b32 s52, s53, s52
s_mul_i32 s53, s2, 74
v_mfma_f32_16x16x32_bf16 v[84:87], a[92:95], a[148:151], 0
buffer_load_dwordx4 v8, s[16:19], s64 offen offset:1024 lds
v_mfma_f32_16x16x32_bf16 v[84:87], a[88:91], a[144:147], v[84:87]
s_add_u32 s53, s53, s55
s_lshl_b32 s53, s53, 10
s_add_u32 s53, s53, 54599680
v_mfma_f32_16x16x32_bf16 v[76:79], a[88:91], a[136:139], 0
s_cmp_ge_u32 s3, 2
s_cselect_b32 s52, s53, s52
ds_read_b128 a[116:119], v10 offset:12288
v_mfma_f32_16x16x32_bf16 v[76:79], a[92:95], a[140:143], v[76:79]
v_mov_b32 v16, 0
v_mov_b32 v17, 0
v_mfma_f32_16x16x32_bf16 v[68:71], a[92:95], a[132:135], 0
v_mov_b32 v18, 0
v_mov_b32 v19, 0
v_mfma_f32_16x16x32_bf16 v[68:71], a[88:91], a[128:131], v[68:71]
s_waitcnt lgkmcnt(6)
ds_read_b64_tr_b16 a[172:173], v12 offset:24576
ds_read_b64_tr_b16 a[174:175], v12 offset:25088
v_mfma_f32_16x16x32_bf16 v[96:99], a[96:99], a[128:131], 0
v_mfma_f32_16x16x32_bf16 v[96:99], a[100:103], a[132:135], v[96:99]
v_mfma_f32_16x16x32_bf16 v[104:107], a[100:103], a[140:143], 0
ds_read_b128 a[120:123], v9 offset:14336
v_mfma_f32_16x16x32_bf16 v[104:107], a[96:99], a[136:139], v[104:107]
v_mfma_f32_16x16x32_bf16 v[112:115], a[96:99], a[144:147], 0
v_mfma_f32_16x16x32_bf16 v[112:115], a[100:103], a[148:151], v[112:115]
ds_read_b64_tr_b16 a[176:177], v13 offset:16384
ds_read_b64_tr_b16 a[178:179], v13 offset:16896
v_mfma_f32_16x16x32_bf16 v[120:123], a[100:103], a[156:159], 0
v_mfma_f32_16x16x32_bf16 v[120:123], a[96:99], a[152:155], v[120:123]
v_mfma_f32_16x16x32_bf16 v[124:127], a[104:107], a[152:155], 0
v_mfma_f32_16x16x32_bf16 v[124:127], a[108:111], a[156:159], v[124:127]
ds_read_b128 a[124:127], v10 offset:14336
v_mfma_f32_16x16x32_bf16 v[116:119], a[108:111], a[148:151], 0
v_add_u32 v9, 32768, v9
v_add_u32 v10, 32768, v10
v_mfma_f32_16x16x32_bf16 v[116:119], a[104:107], a[144:147], v[116:119]
v_mfma_f32_16x16x32_bf16 v[108:111], a[104:107], a[136:139], 0
ds_read_b64_tr_b16 a[180:181], v13 offset:24576
ds_read_b64_tr_b16 a[182:183], v13 offset:25088
v_mfma_f32_16x16x32_bf16 v[108:111], a[108:111], a[140:143], v[108:111]
v_mfma_f32_16x16x32_bf16 v[100:103], a[108:111], a[132:135], 0
v_mfma_f32_16x16x32_bf16 v[100:103], a[104:107], a[128:131], v[100:103]
s_waitcnt lgkmcnt(2)
ds_read_b64_tr_b16 a[184:185], v14 offset:16384
ds_read_b64_tr_b16 a[186:187], v14 offset:16896
v_mfma_f32_16x16x32_bf16 v[128:131], a[112:115], a[128:131], 0
v_mfma_f32_16x16x32_bf16 v[128:131], a[116:119], a[132:135], v[128:131]
v_mfma_f32_16x16x32_bf16 v[136:139], a[116:119], a[140:143], 0
ds_read_b64_tr_b16 a[188:189], v14 offset:24576
ds_read_b64_tr_b16 a[190:191], v14 offset:25088
v_mfma_f32_16x16x32_bf16 v[136:139], a[112:115], a[136:139], v[136:139]
v_mfma_f32_16x16x32_bf16 v[144:147], a[112:115], a[144:147], 0
v_mfma_f32_16x16x32_bf16 v[144:147], a[116:119], a[148:151], v[144:147]
v_mfma_f32_16x16x32_bf16 v[152:155], a[116:119], a[156:159], 0
v_mfma_f32_16x16x32_bf16 v[152:155], a[112:115], a[152:155], v[152:155]
v_mfma_f32_16x16x32_bf16 v[156:159], a[120:123], a[152:155], 0
v_mfma_f32_16x16x32_bf16 v[156:159], a[124:127], a[156:159], v[156:159]
v_mfma_f32_16x16x32_bf16 v[148:151], a[124:127], a[148:151], 0
v_mfma_f32_16x16x32_bf16 v[148:151], a[120:123], a[144:147], v[148:151]
v_mfma_f32_16x16x32_bf16 v[140:143], a[120:123], a[136:139], 0
v_mfma_f32_16x16x32_bf16 v[140:143], a[124:127], a[140:143], v[140:143]
v_mfma_f32_16x16x32_bf16 v[132:135], a[124:127], a[132:135], 0
v_mfma_f32_16x16x32_bf16 v[132:135], a[120:123], a[128:131], v[132:135]
s_waitcnt lgkmcnt(0)
v_mfma_f32_16x16x32_bf16 v[160:163], a[160:163], a[64:67], 0
s_waitcnt vmcnt(4)
v_mfma_f32_16x16x32_bf16 v[160:163], a[164:167], a[68:71], v[160:163]
s_barrier
v_mfma_f32_16x16x32_bf16 v[164:167], a[172:175], a[68:71], 0
ds_read_b64_tr_b16 a[128:129], v11 offset:32768
ds_read_b64_tr_b16 a[130:131], v11 offset:33280
v_mfma_f32_16x16x32_bf16 v[164:167], a[168:171], a[64:67], v[164:167]
s_xor_b32 s71, s70, 256
s_add_u32 s71, s68, s71
v_mfma_f32_16x16x32_bf16 v[168:171], a[176:179], a[64:67], 0
s_add_u32 m0, s73, 65536
s_add_u32 s64, s71, 0
v_mfma_f32_16x16x32_bf16 v[168:171], a[180:183], a[68:71], v[168:171]
buffer_load_dwordx4 v5, s[8:11], s64 offen lds
v_mfma_f32_16x16x32_bf16 v[172:175], a[188:191], a[68:71], 0
v_mfma_f32_16x16x32_bf16 v[172:175], a[184:187], a[64:67], v[172:175]
ds_read_b128 a[64:67], v9 offset:0
v_mfma_f32_16x16x32_bf16 v[188:191], a[184:187], a[72:75], 0
buffer_load_dwordx4 v6, s[8:11], s64 offen offset:1024 lds
v_mfma_f32_16x16x32_bf16 v[188:191], a[188:191], a[76:79], v[188:191]
ds_read_b64_tr_b16 a[132:133], v11 offset:40960
ds_read_b64_tr_b16 a[134:135], v11 offset:41472
v_mfma_f32_16x16x32_bf16 v[184:187], a[180:183], a[76:79], 0
v_mfma_f32_16x16x32_bf16 v[184:187], a[176:179], a[72:75], v[184:187]
s_add_u32 m0, s73, 67584
s_add_u32 s64, s71, 16384
ds_read_b128 a[68:71], v10 offset:0
v_mfma_f32_16x16x32_bf16 v[180:183], a[168:171], a[72:75], 0
v_mfma_f32_16x16x32_bf16 v[180:183], a[172:175], a[76:79], v[180:183]
buffer_load_dwordx4 v5, s[8:11], s64 offen lds
v_mfma_f32_16x16x32_bf16 v[176:179], a[164:167], a[76:79], 0
v_mfma_f32_16x16x32_bf16 v[176:179], a[160:163], a[72:75], v[176:179]
ds_read_b64_tr_b16 a[136:137], v12 offset:32768
ds_read_b64_tr_b16 a[138:139], v12 offset:33280
v_mfma_f32_16x16x32_bf16 v[192:195], a[160:163], a[80:83], 0
v_mfma_f32_16x16x32_bf16 v[192:195], a[164:167], a[84:87], v[192:195]
v_mfma_f32_16x16x32_bf16 v[196:199], a[172:175], a[84:87], 0
buffer_load_dwordx4 v6, s[8:11], s64 offen offset:1024 lds
v_mfma_f32_16x16x32_bf16 v[196:199], a[168:171], a[80:83], v[196:199]
s_xor_b32 s76, s75, 1048576
s_add_u32 s76, s74, s76
ds_read_b128 a[72:75], v9 offset:2048
v_mfma_f32_16x16x32_bf16 v[200:203], a[176:179], a[80:83], 0
L_PAD0:
s_cbranch_execz L_PAD4
v_mfma_f32_16x16x32_bf16 v[200:203], a[180:183], a[84:87], v[200:203]
s_add_u32 m0, s77, 0
s_add_u32 s64, s76, 0
v_mfma_f32_16x16x32_bf16 v[204:207], a[188:191], a[84:87], 0
ds_read_b64_tr_b16 a[140:141], v12 offset:40960
ds_read_b64_tr_b16 a[142:143], v12 offset:41472
v_mfma_f32_16x16x32_bf16 v[204:207], a[184:187], a[80:83], v[204:207]
buffer_load_dwordx4 v7, s[56:59], s64 offen lds
v_mfma_f32_16x16x32_bf16 v[220:223], a[184:187], a[88:91], 0
ds_read_b128 a[76:79], v10 offset:2048
v_mfma_f32_16x16x32_bf16 v[220:223], a[188:191], a[92:95], v[220:223]
v_mfma_f32_16x16x32_bf16 v[216:219], a[180:183], a[92:95], 0
v_mfma_f32_16x16x32_bf16 v[216:219], a[176:179], a[88:91], v[216:219]
v_mfma_f32_16x16x32_bf16 v[212:215], a[168:171], a[88:91], 0
buffer_load_dwordx4 v8, s[56:59], s64 offen offset:1024 lds
v_mfma_f32_16x16x32_bf16 v[212:215], a[172:175], a[92:95], v[212:215]
ds_read_b64_tr_b16 a[144:145], v13 offset:32768
ds_read_b64_tr_b16 a[146:147], v13 offset:33280
v_mfma_f32_16x16x32_bf16 v[208:211], a[164:167], a[92:95], 0
v_mfma_f32_16x16x32_bf16 v[208:211], a[160:163], a[88:91], v[208:211]
s_add_u32 m0, s77, 2048
s_add_u32 s64, s76, 131072
ds_read_b128 a[80:83], v9 offset:4096
v_mfma_f32_16x16x32_bf16 v[224:227], a[160:163], a[96:99], 0
v_mfma_f32_16x16x32_bf16 v[224:227], a[164:167], a[100:103], v[224:227]
buffer_load_dwordx4 v7, s[56:59], s64 offen lds
v_mfma_f32_16x16x32_bf16 v[228:231], a[172:175], a[100:103], 0
ds_read_b64_tr_b16 a[148:149], v13 offset:40960
ds_read_b64_tr_b16 a[150:151], v13 offset:41472
v_mfma_f32_16x16x32_bf16 v[228:231], a[168:171], a[96:99], v[228:231]
v_mfma_f32_16x16x32_bf16 v[232:235], a[176:179], a[96:99], 0
buffer_store_dwordx4 v[16:19], v4, s[24:27], s52 offen sc1
v_mfma_f32_16x16x32_bf16 v[232:235], a[180:183], a[100:103], v[232:235]
buffer_load_dwordx4 v8, s[56:59], s64 offen offset:1024 lds
v_mfma_f32_16x16x32_bf16 v[236:239], a[188:191], a[100:103], 0
s_add_u32 s89, s89, 512
ds_read_b128 a[84:87], v10 offset:4096
v_mfma_f32_16x16x32_bf16 v[236:239], a[184:187], a[96:99], v[236:239]
s_cmp_eq_u32 s3, 0
s_cselect_b32 s90, s89, 2147418112
v_mov_b32 v24, 2147418112
v_mfma_f32_16x16x32_bf16 v[252:255], a[184:187], a[104:107], 0
s_add_u32 m0, s73, 69632
s_add_u32 s64, s71, 524288
v_cmp_eq_u32 vcc, 1, v1
v_mfma_f32_16x16x32_bf16 v[252:255], a[188:191], a[108:111], v[252:255]
s_lshl_b32 s53, s55, 12
ds_read_b64_tr_b16 a[152:153], v14 offset:32768
ds_read_b64_tr_b16 a[154:155], v14 offset:33280
v_mfma_f32_16x16x32_bf16 v[248:251], a[180:183], a[108:111], 0
buffer_load_dwordx4 v5, s[8:11], s64 offen lds
v_mfma_f32_16x16x32_bf16 v[248:251], a[176:179], a[104:107], v[248:251]
v_cndmask_b32 v0, v24, 0, vcc
v_mfma_f32_16x16x32_bf16 v[244:247], a[168:171], a[104:107], 0
s_mul_i32 s87, s87, 16384
s_add_u32 s87, s87, s94
ds_read_b128 a[88:91], v9 offset:6144
v_mfma_f32_16x16x32_bf16 v[244:247], a[172:175], a[108:111], v[244:247]
s_add_u32 s88, s87, s53
s_add_u32 s88, s88, 24576
s_lshr_b32 s53, s53, 1
v_mfma_f32_16x16x32_bf16 v[240:243], a[164:167], a[108:111], 0
s_add_u32 s87, s87, s53
s_lshl_b32 s80, s3, 10
s_mul_i32 s78, s4, 18
v_mfma_f32_16x16x32_bf16 v[240:243], a[160:163], a[104:107], v[240:243]
buffer_load_dwordx4 v6, s[8:11], s64 offen offset:1024 lds
v_mfma_f32_16x16x32_bf16 a[0:3], a[160:163], a[112:115], 0
s_add_u32 s78, s78, s54
ds_read_b64_tr_b16 a[156:157], v14 offset:40960
ds_read_b64_tr_b16 a[158:159], v14 offset:41472
v_mfma_f32_16x16x32_bf16 a[0:3], a[164:167], a[116:119], a[0:3]
s_lshl2_add_u32 s78, s78, s55
s_lshl_b32 s78, s78, 10
s_add_u32 s78, s78, 35651584
v_mfma_f32_16x16x32_bf16 a[4:7], a[172:175], a[116:119], 0
s_add_u32 m0, s73, 71680
s_add_u32 s64, s71, 540672
ds_read_b128 a[92:95], v10 offset:6144
v_mfma_f32_16x16x32_bf16 a[4:7], a[168:171], a[112:115], a[4:7]
s_add_u32 s80, s80, 8192
s_mov_b32 s91, 0x3e0293ee
s_mov_b32 s85, 0x05040100
v_mfma_f32_16x16x32_bf16 a[8:11], a[176:179], a[112:115], 0
buffer_load_dwordx4 v5, s[8:11], s64 offen lds
v_mfma_f32_16x16x32_bf16 a[8:11], a[180:183], a[116:119], a[8:11]
s_mov_b32 s86, 0x07060302
s_lshl2_add_u32 s52, s7, s3
s_and_b32 s65, s6, 3
v_mfma_f32_16x16x32_bf16 a[12:15], a[188:191], a[116:119], 0
s_max_u32 s95, s65, 1
s_mul_i32 s92, s5, 3
s_add_u32 s95, s95, s92
v_mfma_f32_16x16x32_bf16 a[12:15], a[184:187], a[112:115], a[12:15]
s_sub_u32 s95, 24, s95
s_cmp_eq_u32 s65, 1
s_cselect_b32 s95, 63, s95
v_mfma_f32_16x16x32_bf16 a[28:31], a[184:187], a[120:123], 0
s_mov_b32 s92, s95
s_mul_i32 s81, s92, 110592
s_mul_i32 s65, s52, 36
v_mfma_f32_16x16x32_bf16 a[28:31], a[188:191], a[124:127], a[28:31]
buffer_load_dwordx4 v6, s[8:11], s64 offen offset:1024 lds
v_mfma_f32_16x16x32_bf16 a[24:27], a[180:183], a[124:127], 0
s_add_u32 s81, s81, s65
s_mul_i32 s82, s52, 18
s_add_u32 s82, s82, s92
v_mfma_f32_16x16x32_bf16 a[24:27], a[176:179], a[120:123], a[24:27]
s_lshl_b32 s82, s82, 12
s_add_u32 s82, s82, 35651584
s_lshl_b32 s83, s92, 6
v_mfma_f32_16x16x32_bf16 a[20:23], a[168:171], a[120:123], 0
s_lshl_b32 s84, s52, 10
s_add_u32 s84, s84, 75497984
v_mfma_f32_16x16x32_bf16 a[20:23], a[172:175], a[124:127], a[20:23]
s_cmp_lt_u32 s92, 18
s_cselect_b32 s82, s82, 2147418112
s_cselect_b32 s84, s84, 2147418112
v_mfma_f32_16x16x32_bf16 a[16:19], a[164:167], a[124:127], 0
v_lshrrev_b32 v18, 2, v2
v_and_b32 v19, 3, v2
v_mfma_f32_16x16x32_bf16 a[16:19], a[160:163], a[120:123], a[16:19]
s_waitcnt lgkmcnt(0)
v_mul_u32_u24 v20, 1152, v18
v_cmp_eq_u32 vcc, 2, v19
v_mfma_f32_16x16x32_bf16 v[32:35], a[64:67], a[128:131], v[32:35]
s_waitcnt vmcnt(13)
v_lshl_add_u32 v20, v19, 3, v20
v_add_u32 v21, 1, v19
v_mfma_f32_16x16x32_bf16 v[32:35], a[68:71], a[132:135], v[32:35]
s_barrier
v_mfma_f32_16x16x32_bf16 v[40:43], a[68:71], a[140:143], v[40:43]
ds_read_b128 a[96:99], v9 offset:8192
v_cndmask_b32 v21, v21, 0, vcc
v_mfma_f32_16x16x32_bf16 v[40:43], a[64:67], a[136:139], v[40:43]
s_add_u32 m0, s77, 16384
s_add_u32 s64, s76, 0
v_cmp_eq_u32 vcc, 3, v18
v_mfma_f32_16x16x32_bf16 v[48:51], a[64:67], a[144:147], v[48:51]
buffer_load_dwordx4 v7, s[16:19], s64 offen lds
v_mfma_f32_16x16x32_bf16 v[48:51], a[68:71], a[148:151], v[48:51]
ds_read_b128 a[100:103], v10 offset:8192
v_mul_u32_u24 v21, 1152, v21
v_mfma_f32_16x16x32_bf16 v[56:59], a[68:71], a[156:159], v[56:59]
v_add_u32 v21, 32, v21
v_cndmask_b32 v20, v20, v21, vcc
v_mfma_f32_16x16x32_bf16 v[56:59], a[64:67], a[152:155], v[56:59]
v_cmp_eq_u32 vcc, 15, v2
v_mul_u32_u24 v21, 27648, v3
v_mfma_f32_16x16x32_bf16 v[60:63], a[72:75], a[152:155], v[60:63]
buffer_load_dwordx4 v8, s[16:19], s64 offen offset:1024 lds
v_mfma_f32_16x16x32_bf16 v[60:63], a[76:79], a[156:159], v[60:63]
ds_read_b128 a[104:107], v9 offset:10240
v_add_u32 v20, v20, v21
v_mfma_f32_16x16x32_bf16 v[52:55], a[76:79], a[148:151], v[52:55]
v_lshlrev_b32 v21, 4, v3
v_cndmask_b32 v26, v20, v24, vcc
v_mfma_f32_16x16x32_bf16 v[52:55], a[72:75], a[144:147], v[52:55]
s_add_u32 m0, s77, 18432
s_add_u32 s64, s76, 131072
v_cndmask_b32 v27, v24, v21, vcc
v_mfma_f32_16x16x32_bf16 v[44:47], a[72:75], a[136:139], v[44:47]
ds_read_b64_tr_b16 a[160:161], v11 offset:49152
ds_read_b64_tr_b16 a[162:163], v11 offset:49664
v_mfma_f32_16x16x32_bf16 v[44:47], a[76:79], a[140:143], v[44:47]
buffer_load_dwordx4 v7, s[16:19], s64 offen lds
v_mfma_f32_16x16x32_bf16 v[36:39], a[76:79], a[132:135], v[36:39]
v_and_b32 v18, 7, v1
v_cmp_gt_u32 vcc, 48, v1
v_mfma_f32_16x16x32_bf16 v[36:39], a[72:75], a[128:131], v[36:39]
ds_read_b128 a[108:111], v10 offset:10240
v_mul_u32_u24 v18, 3456, v18
v_mfma_f32_16x16x32_bf16 v[64:67], a[80:83], a[128:131], v[64:67]
v_mul_u32_u24 v19, 1152, v3
v_bfe_u32 v20, v1, 3, 1
v_mfma_f32_16x16x32_bf16 v[64:67], a[84:87], a[132:135], v[64:67]
v_mul_u32_u24 v20, 140, v20
v_add3_u32 v18, v18, v19, v20
v_mfma_f32_16x16x32_bf16 v[72:75], a[84:87], a[140:143], v[72:75]
buffer_load_dwordx4 v8, s[16:19], s64 offen offset:1024 lds
v_mfma_f32_16x16x32_bf16 v[72:75], a[80:83], a[136:139], v[72:75]
s_xor_b32 s71, s70, 384
s_add_u32 s71, s68, s71
v_cndmask_b32 v28, v24, v18, vcc
v_mfma_f32_16x16x32_bf16 v[80:83], a[80:83], a[144:147], v[80:83]
s_lshl_b32 s52, s4, 2
ds_read_b64_tr_b16 a[164:165], v11 offset:57344
ds_read_b64_tr_b16 a[166:167], v11 offset:57856
v_mfma_f32_16x16x32_bf16 v[80:83], a[84:87], a[148:151], v[80:83]
s_add_u32 m0, s73, 0
s_add_u32 s64, s71, 0
ds_read_b128 a[112:115], v9 offset:12288
v_mfma_f32_16x16x32_bf16 v[88:91], a[84:87], a[156:159], v[88:91]
s_cmp_eq_u32 s66, 0
s_cselect_b32 s52, s52, 2147418112
v_mfma_f32_16x16x32_bf16 v[88:91], a[80:83], a[152:155], v[88:91]
buffer_load_dwordx4 v5, s[8:11], s64 offen lds
v_mfma_f32_16x16x32_bf16 v[92:95], a[88:91], a[152:155], v[92:95]
ds_read_b64_tr_b16 a[168:169], v12 offset:49152
ds_read_b64_tr_b16 a[170:171], v12 offset:49664
v_mfma_f32_16x16x32_bf16 v[92:95], a[92:95], a[156:159], v[92:95]
v_mfma_f32_16x16x32_bf16 v[84:87], a[92:95], a[148:151], v[84:87]
v_mfma_f32_16x16x32_bf16 v[84:87], a[88:91], a[144:147], v[84:87]
v_mfma_f32_16x16x32_bf16 v[76:79], a[88:91], a[136:139], v[76:79]
buffer_load_dwordx4 v6, s[8:11], s64 offen offset:1024 lds
v_mfma_f32_16x16x32_bf16 v[76:79], a[92:95], a[140:143], v[76:79]
ds_read_b128 a[116:119], v10 offset:12288
v_mfma_f32_16x16x32_bf16 v[68:71], a[92:95], a[132:135], v[68:71]
v_mfma_f32_16x16x32_bf16 v[68:71], a[88:91], a[128:131], v[68:71]
s_add_u32 m0, s73, 2048
s_add_u32 s64, s71, 16384
s_waitcnt lgkmcnt(6)
v_mfma_f32_16x16x32_bf16 v[96:99], a[96:99], a[128:131], v[96:99]
ds_read_b64_tr_b16 a[172:173], v12 offset:57344
ds_read_b64_tr_b16 a[174:175], v12 offset:57856
v_mfma_f32_16x16x32_bf16 v[96:99], a[100:103], a[132:135], v[96:99]
buffer_load_dwordx4 v5, s[8:11], s64 offen lds
v_mfma_f32_16x16x32_bf16 v[104:107], a[100:103], a[140:143], v[104:107]
ds_read_b128 a[120:123], v9 offset:14336
v_mfma_f32_16x16x32_bf16 v[104:107], a[96:99], a[136:139], v[104:107]
v_mfma_f32_16x16x32_bf16 v[112:115], a[96:99], a[144:147], v[112:115]
v_mfma_f32_16x16x32_bf16 v[112:115], a[100:103], a[148:151], v[112:115]
buffer_load_dwordx4 v6, s[8:11], s64 offen offset:1024 lds
v_mfma_f32_16x16x32_bf16 v[120:123], a[100:103], a[156:159], v[120:123]
s_xor_b32 s76, s75, 1572864
s_add_u32 s76, s74, s76
v_mfma_f32_16x16x32_bf16 v[120:123], a[96:99], a[152:155], v[120:123]
ds_read_b64_tr_b16 a[176:177], v13 offset:49152
ds_read_b64_tr_b16 a[178:179], v13 offset:49664
v_mfma_f32_16x16x32_bf16 v[124:127], a[104:107], a[152:155], v[124:127]
s_add_u32 m0, s77, 32768
s_add_u32 s64, s76, 0
v_mfma_f32_16x16x32_bf16 v[124:127], a[108:111], a[156:159], v[124:127]
ds_read_b128 a[124:127], v10 offset:14336
v_mfma_f32_16x16x32_bf16 v[116:119], a[108:111], a[148:151], v[116:119]
buffer_load_dwordx4 v7, s[56:59], s64 offen lds
v_mfma_f32_16x16x32_bf16 v[116:119], a[104:107], a[144:147], v[116:119]
s_waitcnt vmcnt(14)
v_add_u32 v9, 32768, v9
v_add_u32 v10, 32768, v10
v_mfma_f32_16x16x32_bf16 v[108:111], a[104:107], a[136:139], v[108:111]
ds_read_b64_tr_b16 a[180:181], v13 offset:57344
ds_read_b64_tr_b16 a[182:183], v13 offset:57856
v_mfma_f32_16x16x32_bf16 v[108:111], a[108:111], a[140:143], v[108:111]
buffer_store_dword v1, v0, s[40:43], s52 offen sc1
v_mfma_f32_16x16x32_bf16 v[100:103], a[108:111], a[132:135], v[100:103]
s_waitcnt lgkmcnt(2)
v_mfma_f32_16x16x32_bf16 v[100:103], a[104:107], a[128:131], v[100:103]
buffer_load_dwordx4 v8, s[56:59], s64 offen offset:1024 lds
v_mfma_f32_16x16x32_bf16 v[128:131], a[112:115], a[128:131], v[128:131]
ds_read_b64_tr_b16 a[184:185], v14 offset:49152
ds_read_b64_tr_b16 a[186:187], v14 offset:49664
v_mfma_f32_16x16x32_bf16 v[128:131], a[116:119], a[132:135], v[128:131]
v_mfma_f32_16x16x32_bf16 v[136:139], a[116:119], a[140:143], v[136:139]
s_add_u32 m0, s77, 34816
s_add_u32 s64, s76, 131072
v_mfma_f32_16x16x32_bf16 v[136:139], a[112:115], a[136:139], v[136:139]
ds_read_b64_tr_b16 a[188:189], v14 offset:57344
ds_read_b64_tr_b16 a[190:191], v14 offset:57856
v_mfma_f32_16x16x32_bf16 v[144:147], a[112:115], a[144:147], v[144:147]
buffer_load_dwordx4 v7, s[56:59], s64 offen lds
v_mfma_f32_16x16x32_bf16 v[144:147], a[116:119], a[148:151], v[144:147]
v_mfma_f32_16x16x32_bf16 v[152:155], a[116:119], a[156:159], v[152:155]
v_mfma_f32_16x16x32_bf16 v[152:155], a[112:115], a[152:155], v[152:155]
v_mfma_f32_16x16x32_bf16 v[156:159], a[120:123], a[152:155], v[156:159]
v_mfma_f32_16x16x32_bf16 v[156:159], a[124:127], a[156:159], v[156:159]
buffer_load_dwordx4 v8, s[56:59], s64 offen offset:1024 lds
v_mfma_f32_16x16x32_bf16 v[148:151], a[124:127], a[148:151], v[148:151]
v_mfma_f32_16x16x32_bf16 v[148:151], a[120:123], a[144:147], v[148:151]
v_mfma_f32_16x16x32_bf16 v[140:143], a[120:123], a[136:139], v[140:143]
v_mfma_f32_16x16x32_bf16 v[140:143], a[124:127], a[140:143], v[140:143]
v_mfma_f32_16x16x32_bf16 v[132:135], a[124:127], a[132:135], v[132:135]
v_mfma_f32_16x16x32_bf16 v[132:135], a[120:123], a[128:131], v[132:135]
s_waitcnt lgkmcnt(0)
v_mfma_f32_16x16x32_bf16 v[160:163], a[160:163], a[64:67], v[160:163]
s_waitcnt vmcnt(13)
v_mfma_f32_16x16x32_bf16 v[160:163], a[164:167], a[68:71], v[160:163]
s_barrier
v_mfma_f32_16x16x32_bf16 v[164:167], a[172:175], a[68:71], v[164:167]
s_add_u32 s52, s81, 0
ds_read_b64_tr_b16 a[128:129], v11 offset:0
ds_read_b64_tr_b16 a[130:131], v11 offset:512
v_mfma_f32_16x16x32_bf16 v[164:167], a[168:171], a[64:67], v[164:167]
s_add_u32 m0, s73, 4096
s_add_u32 s64, s71, 524288
v_mfma_f32_16x16x32_bf16 v[168:171], a[176:179], a[64:67], v[168:171]
buffer_load_dwordx4 v5, s[8:11], s64 offen lds
v_mfma_f32_16x16x32_bf16 v[168:171], a[180:183], a[68:71], v[168:171]
buffer_load_dwordx2 a[192:193], v26, s[28:31], s52 offen
v_mfma_f32_16x16x32_bf16 v[172:175], a[188:191], a[68:71], v[172:175]
v_mfma_f32_16x16x32_bf16 v[172:175], a[184:187], a[64:67], v[172:175]
ds_read_b128 a[64:67], v9 offset:0
v_mfma_f32_16x16x32_bf16 v[188:191], a[184:187], a[72:75], v[188:191]
buffer_load_dwordx4 v6, s[8:11], s64 offen offset:1024 lds
v_mfma_f32_16x16x32_bf16 v[188:191], a[188:191], a[76:79], v[188:191]
ds_read_b64_tr_b16 a[132:133], v11 offset:8192
ds_read_b64_tr_b16 a[134:135], v11 offset:8704
v_mfma_f32_16x16x32_bf16 v[184:187], a[180:183], a[76:79], v[184:187]
v_mfma_f32_16x16x32_bf16 v[184:187], a[176:179], a[72:75], v[184:187]
s_add_u32 m0, s73, 6144
s_add_u32 s64, s71, 540672
ds_read_b128 a[68:71], v10 offset:0
v_mfma_f32_16x16x32_bf16 v[180:183], a[168:171], a[72:75], v[180:183]
v_mfma_f32_16x16x32_bf16 v[180:183], a[172:175], a[76:79], v[180:183]
buffer_load_dwordx4 v5, s[8:11], s64 offen lds
v_mfma_f32_16x16x32_bf16 v[176:179], a[164:167], a[76:79], v[176:179]
s_add_u32 s52, s81, 3456
v_mfma_f32_16x16x32_bf16 v[176:179], a[160:163], a[72:75], v[176:179]
ds_read_b64_tr_b16 a[136:137], v12 offset:0
ds_read_b64_tr_b16 a[138:139], v12 offset:512
v_mfma_f32_16x16x32_bf16 v[192:195], a[160:163], a[80:83], v[192:195]
buffer_load_dwordx2 a[194:195], v26, s[28:31], s52 offen
v_mfma_f32_16x16x32_bf16 v[192:195], a[164:167], a[84:87], v[192:195]
v_mfma_f32_16x16x32_bf16 v[196:199], a[172:175], a[84:87], v[196:199]
buffer_load_dwordx4 v6, s[8:11], s64 offen offset:1024 lds
v_mfma_f32_16x16x32_bf16 v[196:199], a[168:171], a[80:83], v[196:199]
ds_read_b128 a[72:75], v9 offset:2048
v_mfma_f32_16x16x32_bf16 v[200:203], a[176:179], a[80:83], v[200:203]
v_mfma_f32_16x16x32_bf16 v[200:203], a[180:183], a[84:87], v[200:203]
s_add_u32 m0, s77, 49152
s_add_u32 s64, s76, 0
v_mfma_f32_16x16x32_bf16 v[204:207], a[188:191], a[84:87], v[204:207]
ds_read_b64_tr_b16 a[140:141], v12 offset:8192
ds_read_b64_tr_b16 a[142:143], v12 offset:8704
v_mfma_f32_16x16x32_bf16 v[204:207], a[184:187], a[80:83], v[204:207]
buffer_load_dwordx4 v7, s[16:19], s64 offen lds
v_mfma_f32_16x16x32_bf16 v[220:223], a[184:187], a[88:91], v[220:223]
ds_read_b128 a[76:79], v10 offset:2048
v_mfma_f32_16x16x32_bf16 v[220:223], a[188:191], a[92:95], v[220:223]
s_add_u32 s52, s81, 6912
v_mfma_f32_16x16x32_bf16 v[216:219], a[180:183], a[92:95], v[216:219]
buffer_load_dwordx2 a[196:197], v26, s[28:31], s52 offen
v_mfma_f32_16x16x32_bf16 v[216:219], a[176:179], a[88:91], v[216:219]
v_mfma_f32_16x16x32_bf16 v[212:215], a[168:171], a[88:91], v[212:215]
buffer_load_dwordx4 v8, s[16:19], s64 offen offset:1024 lds
v_mfma_f32_16x16x32_bf16 v[212:215], a[172:175], a[92:95], v[212:215]
ds_read_b64_tr_b16 a[144:145], v13 offset:0
ds_read_b64_tr_b16 a[146:147], v13 offset:512
v_mfma_f32_16x16x32_bf16 v[208:211], a[164:167], a[92:95], v[208:211]
v_mfma_f32_16x16x32_bf16 v[208:211], a[160:163], a[88:91], v[208:211]
s_add_u32 m0, s77, 51200
s_add_u32 s64, s76, 131072
ds_read_b128 a[80:83], v9 offset:4096
v_mfma_f32_16x16x32_bf16 v[224:227], a[160:163], a[96:99], v[224:227]
v_mfma_f32_16x16x32_bf16 v[224:227], a[164:167], a[100:103], v[224:227]
buffer_load_dwordx4 v7, s[16:19], s64 offen lds
v_mfma_f32_16x16x32_bf16 v[228:231], a[172:175], a[100:103], v[228:231]
ds_read_b64_tr_b16 a[148:149], v13 offset:8192
ds_read_b64_tr_b16 a[150:151], v13 offset:8704
v_mfma_f32_16x16x32_bf16 v[228:231], a[168:171], a[96:99], v[228:231]
s_add_u32 s52, s81, 10368
v_mfma_f32_16x16x32_bf16 v[232:235], a[176:179], a[96:99], v[232:235]
buffer_load_dwordx2 a[198:199], v26, s[28:31], s52 offen
v_mfma_f32_16x16x32_bf16 v[232:235], a[180:183], a[100:103], v[232:235]
buffer_load_dwordx4 v8, s[16:19], s64 offen offset:1024 lds
v_mfma_f32_16x16x32_bf16 v[236:239], a[188:191], a[100:103], v[236:239]
s_xor_b32 s71, s70, 512
s_add_u32 s71, s68, s71
ds_read_b128 a[84:87], v10 offset:4096
v_mfma_f32_16x16x32_bf16 v[236:239], a[184:187], a[96:99], v[236:239]
v_mfma_f32_16x16x32_bf16 v[252:255], a[184:187], a[104:107], v[252:255]
s_add_u32 m0, s73, 32768
s_add_u32 s64, s71, 0
v_mfma_f32_16x16x32_bf16 v[252:255], a[188:191], a[108:111], v[252:255]
ds_read_b64_tr_b16 a[152:153], v14 offset:0
ds_read_b64_tr_b16 a[154:155], v14 offset:512
v_mfma_f32_16x16x32_bf16 v[248:251], a[180:183], a[108:111], v[248:251]
buffer_load_dwordx4 v5, s[8:11], s64 offen lds
v_mfma_f32_16x16x32_bf16 v[248:251], a[176:179], a[104:107], v[248:251]
v_mfma_f32_16x16x32_bf16 v[244:247], a[168:171], a[104:107], v[244:247]
ds_read_b128 a[88:91], v9 offset:6144
v_mfma_f32_16x16x32_bf16 v[244:247], a[172:175], a[108:111], v[244:247]
s_add_u32 s52, s81, 13824
v_mfma_f32_16x16x32_bf16 v[240:243], a[164:167], a[108:111], v[240:243]
buffer_load_dwordx2 a[200:201], v26, s[28:31], s52 offen
v_mfma_f32_16x16x32_bf16 v[240:243], a[160:163], a[104:107], v[240:243]
buffer_load_dwordx4 v6, s[8:11], s64 offen offset:1024 lds
v_mfma_f32_16x16x32_bf16 a[0:3], a[160:163], a[112:115], a[0:3]
ds_read_b64_tr_b16 a[156:157], v14 offset:8192
ds_read_b64_tr_b16 a[158:159], v14 offset:8704
v_mfma_f32_16x16x32_bf16 a[0:3], a[164:167], a[116:119], a[0:3]
v_mfma_f32_16x16x32_bf16 a[4:7], a[172:175], a[116:119], a[4:7]
s_add_u32 m0, s73, 34816
s_add_u32 s64, s71, 16384
ds_read_b128 a[92:95], v10 offset:6144
v_mfma_f32_16x16x32_bf16 a[4:7], a[168:171], a[112:115], a[4:7]
v_mfma_f32_16x16x32_bf16 a[8:11], a[176:179], a[112:115], a[8:11]
buffer_load_dwordx4 v5, s[8:11], s64 offen lds
v_mfma_f32_16x16x32_bf16 a[8:11], a[180:183], a[116:119], a[8:11]
v_mfma_f32_16x16x32_bf16 a[12:15], a[188:191], a[116:119], a[12:15]
v_mfma_f32_16x16x32_bf16 a[12:15], a[184:187], a[112:115], a[12:15]
s_add_u32 s52, s81, 17280
v_mfma_f32_16x16x32_bf16 a[28:31], a[184:187], a[120:123], a[28:31]
buffer_load_dwordx2 a[202:203], v26, s[28:31], s52 offen
v_mfma_f32_16x16x32_bf16 a[28:31], a[188:191], a[124:127], a[28:31]
buffer_load_dwordx4 v6, s[8:11], s64 offen offset:1024 lds
v_mfma_f32_16x16x32_bf16 a[24:27], a[180:183], a[124:127], a[24:27]
v_mfma_f32_16x16x32_bf16 a[24:27], a[176:179], a[120:123], a[24:27]
v_mfma_f32_16x16x32_bf16 a[20:23], a[168:171], a[120:123], a[20:23]
v_mfma_f32_16x16x32_bf16 a[20:23], a[172:175], a[124:127], a[20:23]
v_mfma_f32_16x16x32_bf16 a[16:19], a[164:167], a[124:127], a[16:19]
v_mfma_f32_16x16x32_bf16 a[16:19], a[160:163], a[120:123], a[16:19]
s_waitcnt lgkmcnt(0)
v_mfma_f32_16x16x32_bf16 v[32:35], a[64:67], a[128:131], v[32:35]
s_waitcnt vmcnt(27)
v_mfma_f32_16x16x32_bf16 v[32:35], a[68:71], a[132:135], v[32:35]
s_barrier
v_mfma_f32_16x16x32_bf16 v[40:43], a[68:71], a[140:143], v[40:43]
s_add_u32 s52, s81, 20736
ds_read_b128 a[96:99], v9 offset:8192
v_mfma_f32_16x16x32_bf16 v[40:43], a[64:67], a[136:139], v[40:43]
s_xor_b32 s76, s75, 2097152
s_add_u32 s76, s74, s76
v_mfma_f32_16x16x32_bf16 v[48:51], a[64:67], a[144:147], v[48:51]
s_add_u32 m0, s77, 0
s_add_u32 s64, s76, 0
v_mfma_f32_16x16x32_bf16 v[48:51], a[68:71], a[148:151], v[48:51]
buffer_load_dwordx4 v7, s[56:59], s64 offen lds
v_mfma_f32_16x16x32_bf16 v[56:59], a[68:71], a[156:159], v[56:59]
ds_read_b128 a[100:103], v10 offset:8192
v_mfma_f32_16x16x32_bf16 v[56:59], a[64:67], a[152:155], v[56:59]
buffer_load_dwordx2 a[204:205], v26, s[28:31], s52 offen
v_mfma_f32_16x16x32_bf16 v[60:63], a[72:75], a[152:155], v[60:63]
ds_read_b128 a[104:107], v9 offset:10240
v_mfma_f32_16x16x32_bf16 v[60:63], a[76:79], a[156:159], v[60:63]
v_mfma_f32_16x16x32_bf16 v[52:55], a[76:79], a[148:151], v[52:55]
v_mfma_f32_16x16x32_bf16 v[52:55], a[72:75], a[144:147], v[52:55]
buffer_load_dwordx4 v8, s[56:59], s64 offen offset:1024 lds
v_mfma_f32_16x16x32_bf16 v[44:47], a[72:75], a[136:139], v[44:47]
ds_read_b64_tr_b16 a[160:161], v11 offset:16384
ds_read_b64_tr_b16 a[162:163], v11 offset:16896
v_mfma_f32_16x16x32_bf16 v[44:47], a[76:79], a[140:143], v[44:47]
v_mfma_f32_16x16x32_bf16 v[36:39], a[76:79], a[132:135], v[36:39]
v_mfma_f32_16x16x32_bf16 v[36:39], a[72:75], a[128:131], v[36:39]
ds_read_b128 a[108:111], v10 offset:10240
v_mfma_f32_16x16x32_bf16 v[64:67], a[80:83], a[128:131], v[64:67]
s_add_u32 m0, s77, 2048
s_add_u32 s64, s76, 131072
s_add_u32 s52, s81, 24192
v_mfma_f32_16x16x32_bf16 v[64:67], a[84:87], a[132:135], v[64:67]
buffer_load_dwordx2 a[206:207], v26, s[28:31], s52 offen
v_mfma_f32_16x16x32_bf16 v[72:75], a[84:87], a[140:143], v[72:75]
buffer_load_dwordx4 v7, s[56:59], s64 offen lds
v_mfma_f32_16x16x32_bf16 v[72:75], a[80:83], a[136:139], v[72:75]
ds_read_b64_tr_b16 a[164:165], v11 offset:24576
ds_read_b64_tr_b16 a[166:167], v11 offset:25088
v_mfma_f32_16x16x32_bf16 v[80:83], a[80:83], a[144:147], v[80:83]
v_mfma_f32_16x16x32_bf16 v[80:83], a[84:87], a[148:151], v[80:83]
ds_read_b128 a[112:115], v9 offset:12288
v_mfma_f32_16x16x32_bf16 v[88:91], a[84:87], a[156:159], v[88:91]
v_mfma_f32_16x16x32_bf16 v[88:91], a[80:83], a[152:155], v[88:91]
v_mfma_f32_16x16x32_bf16 v[92:95], a[88:91], a[152:155], v[92:95]
ds_read_b64_tr_b16 a[168:169], v12 offset:16384
ds_read_b64_tr_b16 a[170:171], v12 offset:16896
v_mfma_f32_16x16x32_bf16 v[92:95], a[92:95], a[156:159], v[92:95]
buffer_load_dwordx4 v8, s[56:59], s64 offen offset:1024 lds
v_mfma_f32_16x16x32_bf16 v[84:87], a[92:95], a[148:151], v[84:87]
buffer_load_dwordx4 a[208:211], v27, s[36:39], s83 offen
v_mfma_f32_16x16x32_bf16 v[84:87], a[88:91], a[144:147], v[84:87]
v_mfma_f32_16x16x32_bf16 v[76:79], a[88:91], a[136:139], v[76:79]
ds_read_b128 a[116:119], v10 offset:12288
v_mfma_f32_16x16x32_bf16 v[76:79], a[92:95], a[140:143], v[76:79]
v_mfma_f32_16x16x32_bf16 v[68:71], a[92:95], a[132:135], v[68:71]
v_mfma_f32_16x16x32_bf16 v[68:71], a[88:91], a[128:131], v[68:71]
s_add_u32 m0, s73, 36864
s_add_u32 s64, s71, 524288
s_waitcnt lgkmcnt(6)
v_mfma_f32_16x16x32_bf16 v[96:99], a[96:99], a[128:131], v[96:99]
ds_read_b64_tr_b16 a[172:173], v12 offset:24576
ds_read_b64_tr_b16 a[174:175], v12 offset:25088
v_mfma_f32_16x16x32_bf16 v[96:99], a[100:103], a[132:135], v[96:99]
buffer_load_dwordx4 v5, s[8:11], s64 offen lds
v_mfma_f32_16x16x32_bf16 v[104:107], a[100:103], a[140:143], v[104:107]
ds_read_b128 a[120:123], v9 offset:14336
v_mfma_f32_16x16x32_bf16 v[104:107], a[96:99], a[136:139], v[104:107]
v_mfma_f32_16x16x32_bf16 v[112:115], a[96:99], a[144:147], v[112:115]
v_mfma_f32_16x16x32_bf16 v[112:115], a[100:103], a[148:151], v[112:115]
ds_read_b64_tr_b16 a[176:177], v13 offset:16384
ds_read_b64_tr_b16 a[178:179], v13 offset:16896
v_mfma_f32_16x16x32_bf16 v[120:123], a[100:103], a[156:159], v[120:123]
v_mfma_f32_16x16x32_bf16 v[120:123], a[96:99], a[152:155], v[120:123]
v_mfma_f32_16x16x32_bf16 v[124:127], a[104:107], a[152:155], v[124:127]
buffer_load_dwordx4 v6, s[8:11], s64 offen offset:1024 lds
v_mfma_f32_16x16x32_bf16 v[124:127], a[108:111], a[156:159], v[124:127]
ds_read_b128 a[124:127], v10 offset:14336
v_mfma_f32_16x16x32_bf16 v[116:119], a[108:111], a[148:151], v[116:119]
v_add_u32 v9, -65536, v9
v_add_u32 v10, -65536, v10
v_mfma_f32_16x16x32_bf16 v[116:119], a[104:107], a[144:147], v[116:119]
v_mfma_f32_16x16x32_bf16 v[108:111], a[104:107], a[136:139], v[108:111]
ds_read_b64_tr_b16 a[180:181], v13 offset:24576
ds_read_b64_tr_b16 a[182:183], v13 offset:25088
v_mfma_f32_16x16x32_bf16 v[108:111], a[108:111], a[140:143], v[108:111]
s_add_u32 m0, s73, 38912
s_add_u32 s64, s71, 540672
v_mfma_f32_16x16x32_bf16 v[100:103], a[108:111], a[132:135], v[100:103]
s_waitcnt lgkmcnt(2)
v_mfma_f32_16x16x32_bf16 v[100:103], a[104:107], a[128:131], v[100:103]
buffer_load_dwordx4 v5, s[8:11], s64 offen lds
v_mfma_f32_16x16x32_bf16 v[128:131], a[112:115], a[128:131], v[128:131]
ds_read_b64_tr_b16 a[184:185], v14 offset:16384
ds_read_b64_tr_b16 a[186:187], v14 offset:16896
v_mfma_f32_16x16x32_bf16 v[128:131], a[116:119], a[132:135], v[128:131]
v_mfma_f32_16x16x32_bf16 v[136:139], a[116:119], a[140:143], v[136:139]
ds_read_b64_tr_b16 a[188:189], v14 offset:24576
ds_read_b64_tr_b16 a[190:191], v14 offset:25088
v_mfma_f32_16x16x32_bf16 v[136:139], a[112:115], a[136:139], v[136:139]
v_mfma_f32_16x16x32_bf16 v[144:147], a[112:115], a[144:147], v[144:147]
v_mfma_f32_16x16x32_bf16 v[144:147], a[116:119], a[148:151], v[144:147]
v_mfma_f32_16x16x32_bf16 v[152:155], a[116:119], a[156:159], v[152:155]
buffer_load_dwordx4 v6, s[8:11], s64 offen offset:1024 lds
v_mfma_f32_16x16x32_bf16 v[152:155], a[112:115], a[152:155], v[152:155]
v_mfma_f32_16x16x32_bf16 v[156:159], a[120:123], a[152:155], v[156:159]
v_mfma_f32_16x16x32_bf16 v[156:159], a[124:127], a[156:159], v[156:159]
v_mfma_f32_16x16x32_bf16 v[148:151], a[124:127], a[148:151], v[148:151]
v_mfma_f32_16x16x32_bf16 v[148:151], a[120:123], a[144:147], v[148:151]
v_mfma_f32_16x16x32_bf16 v[140:143], a[120:123], a[136:139], v[140:143]
v_mfma_f32_16x16x32_bf16 v[140:143], a[124:127], a[140:143], v[140:143]
v_mfma_f32_16x16x32_bf16 v[132:135], a[124:127], a[132:135], v[132:135]
v_mfma_f32_16x16x32_bf16 v[132:135], a[120:123], a[128:131], v[132:135]
s_waitcnt lgkmcnt(0)
v_mfma_f32_16x16x32_bf16 v[160:163], a[160:163], a[64:67], v[160:163]
s_waitcnt vmcnt(23)
v_mfma_f32_16x16x32_bf16 v[160:163], a[164:167], a[68:71], v[160:163]
s_barrier
v_mfma_f32_16x16x32_bf16 v[164:167], a[172:175], a[68:71], v[164:167]
s_waitcnt vmcnt(4)
ds_read_b64_tr_b16 a[128:129], v11 offset:32768
ds_read_b64_tr_b16 a[130:131], v11 offset:33280
v_mfma_f32_16x16x32_bf16 v[164:167], a[168:171], a[64:67], v[164:167]
s_add_u32 m0, s77, 16384
s_add_u32 s64, s76, 0
v_accvgpr_read_b32 v16, a192
v_mfma_f32_16x16x32_bf16 v[168:171], a[176:179], a[64:67], v[168:171]
buffer_load_dwordx4 v7, s[16:19], s64 offen lds
v_mfma_f32_16x16x32_bf16 v[168:171], a[180:183], a[68:71], v[168:171]
v_accvgpr_read_b32 v17, a194
v_accvgpr_read_b32 v18, a196
v_mfma_f32_16x16x32_bf16 v[172:175], a[188:191], a[68:71], v[172:175]
v_accvgpr_read_b32 v19, a198
v_accvgpr_read_b32 v20, a200
v_mfma_f32_16x16x32_bf16 v[172:175], a[184:187], a[64:67], v[172:175]
ds_read_b128 a[64:67], v9 offset:0
v_accvgpr_read_b32 v21, a202
v_mfma_f32_16x16x32_bf16 v[188:191], a[184:187], a[72:75], v[188:191]
ds_read_b64_tr_b16 a[132:133], v11 offset:40960
ds_read_b64_tr_b16 a[134:135], v11 offset:41472
v_mfma_f32_16x16x32_bf16 v[188:191], a[188:191], a[76:79], v[188:191]
L_PAD1:
s_cbranch_execz L_PAD5
v_accvgpr_read_b32 v22, a204
v_accvgpr_read_b32 v23, a206
v_mfma_f32_16x16x32_bf16 v[184:187], a[180:183], a[76:79], v[184:187]
v_mfma_f32_16x16x32_bf16 v[184:187], a[176:179], a[72:75], v[184:187]
buffer_load_dwordx4 v8, s[16:19], s64 offen offset:1024 lds
v_mfma_f32_16x16x32_bf16 v[180:183], a[168:171], a[72:75], v[180:183]
ds_read_b128 a[68:71], v10 offset:0
v_perm_b32 v24, v17, v16, s85
v_mfma_f32_16x16x32_bf16 v[180:183], a[172:175], a[76:79], v[180:183]
v_perm_b32 v25, v19, v18, s85
v_perm_b32 v26, v21, v20, s85
v_mfma_f32_16x16x32_bf16 v[176:179], a[164:167], a[76:79], v[176:179]
v_perm_b32 v27, v23, v22, s85
v_perm_b32 v28, v17, v16, s86
v_mfma_f32_16x16x32_bf16 v[176:179], a[160:163], a[72:75], v[176:179]
ds_read_b64_tr_b16 a[136:137], v12 offset:32768
ds_read_b64_tr_b16 a[138:139], v12 offset:33280
v_mfma_f32_16x16x32_bf16 v[192:195], a[160:163], a[80:83], v[192:195]
s_add_u32 m0, s77, 18432
s_add_u32 s64, s76, 131072
v_perm_b32 v29, v19, v18, s86
v_mfma_f32_16x16x32_bf16 v[192:195], a[164:167], a[84:87], v[192:195]
v_perm_b32 v30, v21, v20, s86
v_perm_b32 v31, v23, v22, s86
v_mfma_f32_16x16x32_bf16 v[196:199], a[172:175], a[84:87], v[196:199]
buffer_load_dwordx4 v7, s[16:19], s64 offen lds
v_mfma_f32_16x16x32_bf16 v[196:199], a[168:171], a[80:83], v[196:199]
ds_read_b128 a[72:75], v9 offset:2048
v_accvgpr_read_b32 v16, a208
v_mfma_f32_16x16x32_bf16 v[200:203], a[176:179], a[80:83], v[200:203]
v_accvgpr_read_b32 v17, a209
v_accvgpr_read_b32 v18, a210
v_mfma_f32_16x16x32_bf16 v[200:203], a[180:183], a[84:87], v[200:203]
ds_read_b64_tr_b16 a[140:141], v12 offset:40960
ds_read_b64_tr_b16 a[142:143], v12 offset:41472
v_mfma_f32_16x16x32_bf16 v[204:207], a[188:191], a[84:87], v[204:207]
v_accvgpr_read_b32 v19, a211
v_or_b32 v24, v24, v16
v_mfma_f32_16x16x32_bf16 v[204:207], a[184:187], a[80:83], v[204:207]
v_or_b32 v25, v25, v17
v_or_b32 v26, v26, v18
v_mfma_f32_16x16x32_bf16 v[220:223], a[184:187], a[88:91], v[220:223]
ds_read_b128 a[76:79], v10 offset:2048
v_or_b32 v27, v27, v19
v_mfma_f32_16x16x32_bf16 v[220:223], a[188:191], a[92:95], v[220:223]
buffer_load_dwordx4 v8, s[16:19], s64 offen offset:1024 lds
v_mfma_f32_16x16x32_bf16 v[216:219], a[180:183], a[92:95], v[216:219]
s_xor_b32 s71, s70, 640
s_add_u32 s71, s68, s71
v_mfma_f32_16x16x32_bf16 v[216:219], a[176:179], a[88:91], v[216:219]
buffer_store_dwordx4 v[24:27], v4, s[24:27], s82 offen offset:0 sc1
v_mfma_f32_16x16x32_bf16 v[212:215], a[168:171], a[88:91], v[212:215]
ds_read_b64_tr_b16 a[144:145], v13 offset:32768
ds_read_b64_tr_b16 a[146:147], v13 offset:33280
v_mfma_f32_16x16x32_bf16 v[212:215], a[172:175], a[92:95], v[212:215]
v_mfma_f32_16x16x32_bf16 v[208:211], a[164:167], a[92:95], v[208:211]
v_mfma_f32_16x16x32_bf16 v[208:211], a[160:163], a[88:91], v[208:211]
s_add_u32 m0, s73, 65536
s_add_u32 s64, s71, 0
ds_read_b128 a[80:83], v9 offset:4096
v_mfma_f32_16x16x32_bf16 v[224:227], a[160:163], a[96:99], v[224:227]
v_mfma_f32_16x16x32_bf16 v[224:227], a[164:167], a[100:103], v[224:227]
buffer_load_dwordx4 v5, s[8:11], s64 offen lds
v_mfma_f32_16x16x32_bf16 v[228:231], a[172:175], a[100:103], v[228:231]
ds_read_b64_tr_b16 a[148:149], v13 offset:40960
ds_read_b64_tr_b16 a[150:151], v13 offset:41472
v_mfma_f32_16x16x32_bf16 v[228:231], a[168:171], a[96:99], v[228:231]
v_mfma_f32_16x16x32_bf16 v[232:235], a[176:179], a[96:99], v[232:235]
v_mfma_f32_16x16x32_bf16 v[232:235], a[180:183], a[100:103], v[232:235]
ds_read_b128 a[84:87], v10 offset:4096
v_mfma_f32_16x16x32_bf16 v[236:239], a[188:191], a[100:103], v[236:239]
buffer_store_dwordx4 v[28:31], v4, s[24:27], s82 offen offset:1024 sc1
v_mfma_f32_16x16x32_bf16 v[236:239], a[184:187], a[96:99], v[236:239]
v_accvgpr_read_b32 v16, a193
v_accvgpr_read_b32 v17, a195
v_mfma_f32_16x16x32_bf16 v[252:255], a[184:187], a[104:107], v[252:255]
buffer_load_dwordx4 v6, s[8:11], s64 offen offset:1024 lds
v_mfma_f32_16x16x32_bf16 v[252:255], a[188:191], a[108:111], v[252:255]
ds_read_b64_tr_b16 a[152:153], v14 offset:32768
ds_read_b64_tr_b16 a[154:155], v14 offset:33280
v_mfma_f32_16x16x32_bf16 v[248:251], a[180:183], a[108:111], v[248:251]
v_accvgpr_read_b32 v18, a197
v_accvgpr_read_b32 v19, a199
v_mfma_f32_16x16x32_bf16 v[248:251], a[176:179], a[104:107], v[248:251]
v_accvgpr_read_b32 v20, a201
v_accvgpr_read_b32 v21, a203
v_mfma_f32_16x16x32_bf16 v[244:247], a[168:171], a[104:107], v[244:247]
ds_read_b128 a[88:91], v9 offset:6144
v_accvgpr_read_b32 v22, a205
v_mfma_f32_16x16x32_bf16 v[244:247], a[172:175], a[108:111], v[244:247]
s_add_u32 m0, s73, 67584
s_add_u32 s64, s71, 16384
v_accvgpr_read_b32 v23, a207
v_mfma_f32_16x16x32_bf16 v[240:243], a[164:167], a[108:111], v[240:243]
v_mfma_f32_16x16x32_bf16 v[240:243], a[160:163], a[104:107], v[240:243]
buffer_load_dwordx4 v5, s[8:11], s64 offen lds
v_mfma_f32_16x16x32_bf16 a[0:3], a[160:163], a[112:115], a[0:3]
ds_read_b64_tr_b16 a[156:157], v14 offset:40960
ds_read_b64_tr_b16 a[158:159], v14 offset:41472
v_mfma_f32_16x16x32_bf16 a[0:3], a[164:167], a[116:119], a[0:3]
v_perm_b32 v24, v17, v16, s85
v_perm_b32 v25, v19, v18, s85
v_mfma_f32_16x16x32_bf16 a[4:7], a[172:175], a[116:119], a[4:7]
ds_read_b128 a[92:95], v10 offset:6144
v_perm_b32 v26, v21, v20, s85
v_mfma_f32_16x16x32_bf16 a[4:7], a[168:171], a[112:115], a[4:7]
v_perm_b32 v27, v23, v22, s85
v_perm_b32 v28, v17, v16, s86
v_mfma_f32_16x16x32_bf16 a[8:11], a[176:179], a[112:115], a[8:11]
v_perm_b32 v29, v19, v18, s86
v_perm_b32 v30, v21, v20, s86
v_mfma_f32_16x16x32_bf16 a[8:11], a[180:183], a[116:119], a[8:11]
v_perm_b32 v31, v23, v22, s86
v_mfma_f32_16x16x32_bf16 a[12:15], a[188:191], a[116:119], a[12:15]
buffer_load_dwordx4 v6, s[8:11], s64 offen offset:1024 lds
v_mfma_f32_16x16x32_bf16 a[12:15], a[184:187], a[112:115], a[12:15]
buffer_store_dwordx4 v[24:27], v4, s[24:27], s82 offen offset:2048 sc1
v_mfma_f32_16x16x32_bf16 a[28:31], a[184:187], a[120:123], a[28:31]
v_mfma_f32_16x16x32_bf16 a[28:31], a[188:191], a[124:127], a[28:31]
v_mfma_f32_16x16x32_bf16 a[24:27], a[180:183], a[124:127], a[24:27]
v_mfma_f32_16x16x32_bf16 a[24:27], a[176:179], a[120:123], a[24:27]
v_mfma_f32_16x16x32_bf16 a[20:23], a[168:171], a[120:123], a[20:23]
v_mfma_f32_16x16x32_bf16 a[20:23], a[172:175], a[124:127], a[20:23]
v_mfma_f32_16x16x32_bf16 a[16:19], a[164:167], a[124:127], a[16:19]
v_mfma_f32_16x16x32_bf16 a[16:19], a[160:163], a[120:123], a[16:19]
s_waitcnt lgkmcnt(0)
v_mfma_f32_16x16x32_bf16 v[32:35], a[64:67], a[128:131], v[32:35]
s_waitcnt vmcnt(28)
v_mfma_f32_16x16x32_bf16 v[32:35], a[68:71], a[132:135], v[32:35]
s_barrier
v_mfma_f32_16x16x32_bf16 v[40:43], a[68:71], a[140:143], v[40:43]
ds_read_b128 a[96:99], v9 offset:8192
v_mfma_f32_16x16x32_bf16 v[40:43], a[64:67], a[136:139], v[40:43]
s_xor_b32 s76, s75, 2621440
s_add_u32 s76, s74, s76
v_mfma_f32_16x16x32_bf16 v[48:51], a[64:67], a[144:147], v[48:51]
s_add_u32 m0, s77, 32768
s_add_u32 s64, s76, 0
v_mfma_f32_16x16x32_bf16 v[48:51], a[68:71], a[148:151], v[48:51]
buffer_load_dwordx4 v7, s[56:59], s64 offen lds
v_mfma_f32_16x16x32_bf16 v[56:59], a[68:71], a[156:159], v[56:59]
ds_read_b128 a[100:103], v10 offset:8192
v_mfma_f32_16x16x32_bf16 v[56:59], a[64:67], a[152:155], v[56:59]
buffer_store_dwordx4 v[28:31], v4, s[24:27], s82 offen offset:3072 sc1
v_mfma_f32_16x16x32_bf16 v[60:63], a[72:75], a[152:155], v[60:63]
s_lshl_b32 s52, s7, 4
ds_read_b128 a[104:107], v9 offset:10240
v_and_b32 v22, 3, v1
v_mfma_f32_16x16x32_bf16 v[60:63], a[76:79], a[156:159], v[60:63]
v_lshl_add_u32 v22, v22, 2, s52
v_mfma_f32_16x16x32_bf16 v[52:55], a[76:79], a[148:151], v[52:55]
buffer_load_dword v23, v22, s[40:43], 0 offen sc1
v_mfma_f32_16x16x32_bf16 v[52:55], a[72:75], a[144:147], v[52:55]
buffer_load_dwordx4 v8, s[56:59], s64 offen offset:1024 lds
v_mfma_f32_16x16x32_bf16 v[44:47], a[72:75], a[136:139], v[44:47]
ds_read_b64_tr_b16 a[160:161], v11 offset:49152
ds_read_b64_tr_b16 a[162:163], v11 offset:49664
v_mfma_f32_16x16x32_bf16 v[44:47], a[76:79], a[140:143], v[44:47]
v_mfma_f32_16x16x32_bf16 v[36:39], a[76:79], a[132:135], v[36:39]
v_mfma_f32_16x16x32_bf16 v[36:39], a[72:75], a[128:131], v[36:39]
ds_read_b128 a[108:111], v10 offset:10240
v_mfma_f32_16x16x32_bf16 v[64:67], a[80:83], a[128:131], v[64:67]
s_add_u32 m0, s77, 34816
s_add_u32 s64, s76, 131072
v_mfma_f32_16x16x32_bf16 v[64:67], a[84:87], a[132:135], v[64:67]
v_mfma_f32_16x16x32_bf16 v[72:75], a[84:87], a[140:143], v[72:75]
buffer_load_dwordx4 v7, s[56:59], s64 offen lds
v_mfma_f32_16x16x32_bf16 v[72:75], a[80:83], a[136:139], v[72:75]
ds_read_b64_tr_b16 a[164:165], v11 offset:57344
ds_read_b64_tr_b16 a[166:167], v11 offset:57856
v_mfma_f32_16x16x32_bf16 v[80:83], a[80:83], a[144:147], v[80:83]
v_mfma_f32_16x16x32_bf16 v[80:83], a[84:87], a[148:151], v[80:83]
ds_read_b128 a[112:115], v9 offset:12288
v_mfma_f32_16x16x32_bf16 v[88:91], a[84:87], a[156:159], v[88:91]
v_mfma_f32_16x16x32_bf16 v[88:91], a[80:83], a[152:155], v[88:91]
v_mfma_f32_16x16x32_bf16 v[92:95], a[88:91], a[152:155], v[92:95]
ds_read_b64_tr_b16 a[168:169], v12 offset:49152
ds_read_b64_tr_b16 a[170:171], v12 offset:49664
v_mfma_f32_16x16x32_bf16 v[92:95], a[92:95], a[156:159], v[92:95]
buffer_load_dwordx4 v8, s[56:59], s64 offen offset:1024 lds
v_mfma_f32_16x16x32_bf16 v[84:87], a[92:95], a[148:151], v[84:87]
v_mfma_f32_16x16x32_bf16 v[84:87], a[88:91], a[144:147], v[84:87]
v_mfma_f32_16x16x32_bf16 v[76:79], a[88:91], a[136:139], v[76:79]
ds_read_b128 a[116:119], v10 offset:12288
v_mfma_f32_16x16x32_bf16 v[76:79], a[92:95], a[140:143], v[76:79]
v_mfma_f32_16x16x32_bf16 v[68:71], a[92:95], a[132:135], v[68:71]
v_mfma_f32_16x16x32_bf16 v[68:71], a[88:91], a[128:131], v[68:71]
s_add_u32 m0, s73, 69632
s_add_u32 s64, s71, 524288
s_waitcnt lgkmcnt(6)
v_mfma_f32_16x16x32_bf16 v[96:99], a[96:99], a[128:131], v[96:99]
ds_read_b64_tr_b16 a[172:173], v12 offset:57344
ds_read_b64_tr_b16 a[174:175], v12 offset:57856
v_mfma_f32_16x16x32_bf16 v[96:99], a[100:103], a[132:135], v[96:99]
buffer_load_dwordx4 v5, s[8:11], s64 offen lds
v_mfma_f32_16x16x32_bf16 v[104:107], a[100:103], a[140:143], v[104:107]
ds_read_b128 a[120:123], v9 offset:14336
v_mfma_f32_16x16x32_bf16 v[104:107], a[96:99], a[136:139], v[104:107]
v_mfma_f32_16x16x32_bf16 v[112:115], a[96:99], a[144:147], v[112:115]
v_mfma_f32_16x16x32_bf16 v[112:115], a[100:103], a[148:151], v[112:115]
ds_read_b64_tr_b16 a[176:177], v13 offset:49152
ds_read_b64_tr_b16 a[178:179], v13 offset:49664
v_mfma_f32_16x16x32_bf16 v[120:123], a[100:103], a[156:159], v[120:123]
v_mfma_f32_16x16x32_bf16 v[120:123], a[96:99], a[152:155], v[120:123]
v_mfma_f32_16x16x32_bf16 v[124:127], a[104:107], a[152:155], v[124:127]
buffer_load_dwordx4 v6, s[8:11], s64 offen offset:1024 lds
v_mfma_f32_16x16x32_bf16 v[124:127], a[108:111], a[156:159], v[124:127]
ds_read_b128 a[124:127], v10 offset:14336
v_mfma_f32_16x16x32_bf16 v[116:119], a[108:111], a[148:151], v[116:119]
v_add_u32 v9, 32768, v9
v_add_u32 v10, 32768, v10
v_mfma_f32_16x16x32_bf16 v[116:119], a[104:107], a[144:147], v[116:119]
v_mfma_f32_16x16x32_bf16 v[108:111], a[104:107], a[136:139], v[108:111]
ds_read_b64_tr_b16 a[180:181], v13 offset:57344
ds_read_b64_tr_b16 a[182:183], v13 offset:57856
v_mfma_f32_16x16x32_bf16 v[108:111], a[108:111], a[140:143], v[108:111]
s_add_u32 m0, s73, 71680
s_add_u32 s64, s71, 540672
v_mfma_f32_16x16x32_bf16 v[100:103], a[108:111], a[132:135], v[100:103]
s_waitcnt lgkmcnt(2)
v_mfma_f32_16x16x32_bf16 v[100:103], a[104:107], a[128:131], v[100:103]
buffer_load_dwordx4 v5, s[8:11], s64 offen lds
v_mfma_f32_16x16x32_bf16 v[128:131], a[112:115], a[128:131], v[128:131]
ds_read_b64_tr_b16 a[184:185], v14 offset:49152
ds_read_b64_tr_b16 a[186:187], v14 offset:49664
v_mfma_f32_16x16x32_bf16 v[128:131], a[116:119], a[132:135], v[128:131]
v_mfma_f32_16x16x32_bf16 v[136:139], a[116:119], a[140:143], v[136:139]
ds_read_b64_tr_b16 a[188:189], v14 offset:57344
ds_read_b64_tr_b16 a[190:191], v14 offset:57856
v_mfma_f32_16x16x32_bf16 v[136:139], a[112:115], a[136:139], v[136:139]
v_mfma_f32_16x16x32_bf16 v[144:147], a[112:115], a[144:147], v[144:147]
v_mfma_f32_16x16x32_bf16 v[144:147], a[116:119], a[148:151], v[144:147]
v_mfma_f32_16x16x32_bf16 v[152:155], a[116:119], a[156:159], v[152:155]
buffer_load_dwordx4 v6, s[8:11], s64 offen offset:1024 lds
v_mfma_f32_16x16x32_bf16 v[152:155], a[112:115], a[152:155], v[152:155]
v_mfma_f32_16x16x32_bf16 v[156:159], a[120:123], a[152:155], v[156:159]
v_mfma_f32_16x16x32_bf16 v[156:159], a[124:127], a[156:159], v[156:159]
v_mfma_f32_16x16x32_bf16 v[148:151], a[124:127], a[148:151], v[148:151]
v_mfma_f32_16x16x32_bf16 v[148:151], a[120:123], a[144:147], v[148:151]
s_waitcnt vmcnt(7)
v_mfma_f32_16x16x32_bf16 v[140:143], a[120:123], a[136:139], v[140:143]
v_cmp_gt_u32 vcc, 1, v23
v_mfma_f32_16x16x32_bf16 v[140:143], a[124:127], a[140:143], v[140:143]
v_mfma_f32_16x16x32_bf16 v[132:135], a[124:127], a[132:135], v[132:135]
v_mfma_f32_16x16x32_bf16 v[132:135], a[120:123], a[128:131], v[132:135]
s_waitcnt lgkmcnt(0)
v_mfma_f32_16x16x32_bf16 v[160:163], a[160:163], a[64:67], v[160:163]
s_waitcnt vmcnt(21)
v_mfma_f32_16x16x32_bf16 v[160:163], a[164:167], a[68:71], v[160:163]
s_barrier
v_mfma_f32_16x16x32_bf16 v[164:167], a[172:175], a[68:71], v[164:167]
ds_read_b64_tr_b16 a[128:129], v11 offset:0
ds_read_b64_tr_b16 a[130:131], v11 offset:512
v_mfma_f32_16x16x32_bf16 v[164:167], a[168:171], a[64:67], v[164:167]
s_add_u32 m0, s77, 49152
s_add_u32 s64, s76, 0
v_mfma_f32_16x16x32_bf16 v[168:171], a[176:179], a[64:67], v[168:171]
buffer_load_dwordx4 v7, s[16:19], s64 offen lds
v_mfma_f32_16x16x32_bf16 v[168:171], a[180:183], a[68:71], v[168:171]
s_cbranch_vccnz CK_Z
CK_Z_R:
v_mfma_f32_16x16x32_bf16 v[172:175], a[188:191], a[68:71], v[172:175]
buffer_atomic_add v1, v0, s[24:27], s84 offen offset:0 sc1
v_mfma_f32_16x16x32_bf16 v[172:175], a[184:187], a[64:67], v[172:175]
s_lshl2_add_u32 s52, s95, s3
s_lshl3_add_u32 s54, s52, s7
ds_read_b128 a[64:67], v9 offset:0
v_mfma_f32_16x16x32_bf16 v[188:191], a[184:187], a[72:75], v[188:191]
s_mul_i32 s53, s54, 3072
ds_read_b64_tr_b16 a[132:133], v11 offset:8192
ds_read_b64_tr_b16 a[134:135], v11 offset:8704
v_mfma_f32_16x16x32_bf16 v[188:191], a[188:191], a[76:79], v[188:191]
s_mul_i32 s52, s52, 48
s_add_u32 s52, s52, s7
s_lshl_b32 s52, s52, 10
v_mfma_f32_16x16x32_bf16 v[184:187], a[180:183], a[76:79], v[184:187]
v_min_u32 v18, 23, v1
v_lshrrev_b32 v16, 3, v18
v_mfma_f32_16x16x32_bf16 v[184:187], a[176:179], a[72:75], v[184:187]
buffer_load_dwordx4 v8, s[16:19], s64 offen offset:1024 lds
v_mfma_f32_16x16x32_bf16 v[180:183], a[168:171], a[72:75], v[180:183]
ds_read_b128 a[68:71], v10 offset:0
v_and_b32 v17, 7, v18
v_mfma_f32_16x16x32_bf16 v[180:183], a[172:175], a[76:79], v[180:183]
v_lshlrev_b32 v16, 13, v16
v_lshl_add_u32 v16, v17, 7, v16
v_mfma_f32_16x16x32_bf16 v[176:179], a[164:167], a[76:79], v[176:179]
v_lshlrev_b32 v18, 7, v18
v_min_u32 v17, 6, v1
v_mfma_f32_16x16x32_bf16 v[176:179], a[160:163], a[72:75], v[176:179]
ds_read_b64_tr_b16 a[136:137], v12 offset:0
ds_read_b64_tr_b16 a[138:139], v12 offset:512
v_mfma_f32_16x16x32_bf16 v[192:195], a[160:163], a[80:83], v[192:195]
s_add_u32 m0, s77, 51200
s_add_u32 s64, s76, 131072
v_lshlrev_b32 v17, 7, v17
v_mfma_f32_16x16x32_bf16 v[192:195], a[164:167], a[84:87], v[192:195]
v_mov_b32 v29, 0
v_mfma_f32_16x16x32_bf16 v[196:199], a[172:175], a[84:87], v[196:199]
buffer_load_dwordx4 v7, s[16:19], s64 offen lds
v_mfma_f32_16x16x32_bf16 v[196:199], a[168:171], a[80:83], v[196:199]
ds_read_b128 a[72:75], v9 offset:2048
v_mfma_f32_16x16x32_bf16 v[200:203], a[176:179], a[80:83], v[200:203]
buffer_load_dword a253, v18, s[12:15], s53 offen
v_mfma_f32_16x16x32_bf16 v[200:203], a[180:183], a[84:87], v[200:203]
ds_read_b64_tr_b16 a[140:141], v12 offset:8192
ds_read_b64_tr_b16 a[142:143], v12 offset:8704
v_mfma_f32_16x16x32_bf16 v[204:207], a[188:191], a[84:87], v[204:207]
v_mfma_f32_16x16x32_bf16 v[204:207], a[184:187], a[80:83], v[204:207]
v_mfma_f32_16x16x32_bf16 v[220:223], a[184:187], a[88:91], v[220:223]
ds_read_b128 a[76:79], v10 offset:2048
v_mfma_f32_16x16x32_bf16 v[220:223], a[188:191], a[92:95], v[220:223]
buffer_load_dwordx4 v8, s[16:19], s64 offen offset:1024 lds
v_mfma_f32_16x16x32_bf16 v[216:219], a[180:183], a[92:95], v[216:219]
s_xor_b32 s71, s70, 768
s_add_u32 s71, s68, s71
v_mfma_f32_16x16x32_bf16 v[216:219], a[176:179], a[88:91], v[216:219]
v_mfma_f32_16x16x32_bf16 v[212:215], a[168:171], a[88:91], v[212:215]
ds_read_b64_tr_b16 a[144:145], v13 offset:0
ds_read_b64_tr_b16 a[146:147], v13 offset:512
v_mfma_f32_16x16x32_bf16 v[212:215], a[172:175], a[92:95], v[212:215]
v_mfma_f32_16x16x32_bf16 v[208:211], a[164:167], a[92:95], v[208:211]
v_mfma_f32_16x16x32_bf16 v[208:211], a[160:163], a[88:91], v[208:211]
s_add_u32 m0, s73, 0
s_add_u32 s64, s71, 0
ds_read_b128 a[80:83], v9 offset:4096
v_mfma_f32_16x16x32_bf16 v[224:227], a[160:163], a[96:99], v[224:227]
v_mfma_f32_16x16x32_bf16 v[224:227], a[164:167], a[100:103], v[224:227]
buffer_load_dwordx4 v5, s[8:11], s64 offen lds
v_mfma_f32_16x16x32_bf16 v[228:231], a[172:175], a[100:103], v[228:231]
ds_read_b64_tr_b16 a[148:149], v13 offset:8192
ds_read_b64_tr_b16 a[150:151], v13 offset:8704
v_mfma_f32_16x16x32_bf16 v[228:231], a[168:171], a[96:99], v[228:231]
v_mfma_f32_16x16x32_bf16 v[232:235], a[176:179], a[96:99], v[232:235]
v_mfma_f32_16x16x32_bf16 v[232:235], a[180:183], a[100:103], v[232:235]
ds_read_b128 a[84:87], v10 offset:4096
v_mfma_f32_16x16x32_bf16 v[236:239], a[188:191], a[100:103], v[236:239]
v_mfma_f32_16x16x32_bf16 v[236:239], a[184:187], a[96:99], v[236:239]
v_mfma_f32_16x16x32_bf16 v[252:255], a[184:187], a[104:107], v[252:255]
buffer_load_dwordx4 v6, s[8:11], s64 offen offset:1024 lds
v_mfma_f32_16x16x32_bf16 v[252:255], a[188:191], a[108:111], v[252:255]
ds_read_b64_tr_b16 a[152:153], v14 offset:0
ds_read_b64_tr_b16 a[154:155], v14 offset:512
v_mfma_f32_16x16x32_bf16 v[248:251], a[180:183], a[108:111], v[248:251]
v_mfma_f32_16x16x32_bf16 v[248:251], a[176:179], a[104:107], v[248:251]
v_mfma_f32_16x16x32_bf16 v[244:247], a[168:171], a[104:107], v[244:247]
ds_read_b128 a[88:91], v9 offset:6144
v_mfma_f32_16x16x32_bf16 v[244:247], a[172:175], a[108:111], v[244:247]
s_add_u32 m0, s73, 2048
s_add_u32 s64, s71, 16384
v_mfma_f32_16x16x32_bf16 v[240:243], a[164:167], a[108:111], v[240:243]
v_mfma_f32_16x16x32_bf16 v[240:243], a[160:163], a[104:107], v[240:243]
buffer_load_dwordx4 v5, s[8:11], s64 offen lds
v_mfma_f32_16x16x32_bf16 a[0:3], a[160:163], a[112:115], a[0:3]
ds_read_b64_tr_b16 a[156:157], v14 offset:8192
ds_read_b64_tr_b16 a[158:159], v14 offset:8704
v_mfma_f32_16x16x32_bf16 a[0:3], a[164:167], a[116:119], a[0:3]
v_mfma_f32_16x16x32_bf16 a[4:7], a[172:175], a[116:119], a[4:7]
ds_read_b128 a[92:95], v10 offset:6144
v_mfma_f32_16x16x32_bf16 a[4:7], a[168:171], a[112:115], a[4:7]
v_mfma_f32_16x16x32_bf16 a[8:11], a[176:179], a[112:115], a[8:11]
v_mfma_f32_16x16x32_bf16 a[8:11], a[180:183], a[116:119], a[8:11]
v_mfma_f32_16x16x32_bf16 a[12:15], a[188:191], a[116:119], a[12:15]
buffer_load_dwordx4 v6, s[8:11], s64 offen offset:1024 lds
v_mfma_f32_16x16x32_bf16 a[12:15], a[184:187], a[112:115], a[12:15]
v_mfma_f32_16x16x32_bf16 a[28:31], a[184:187], a[120:123], a[28:31]
v_mfma_f32_16x16x32_bf16 a[28:31], a[188:191], a[124:127], a[28:31]
v_mfma_f32_16x16x32_bf16 a[24:27], a[180:183], a[124:127], a[24:27]
v_mfma_f32_16x16x32_bf16 a[24:27], a[176:179], a[120:123], a[24:27]
v_mfma_f32_16x16x32_bf16 a[20:23], a[168:171], a[120:123], a[20:23]
v_mfma_f32_16x16x32_bf16 a[20:23], a[172:175], a[124:127], a[20:23]
v_mfma_f32_16x16x32_bf16 a[16:19], a[164:167], a[124:127], a[16:19]
v_mfma_f32_16x16x32_bf16 a[16:19], a[160:163], a[120:123], a[16:19]
s_waitcnt lgkmcnt(0)
v_mfma_f32_16x16x32_bf16 v[32:35], a[64:67], a[128:131], v[32:35]
s_waitcnt vmcnt(27)
v_mfma_f32_16x16x32_bf16 v[32:35], a[68:71], a[132:135], v[32:35]
s_barrier
v_mfma_f32_16x16x32_bf16 v[40:43], a[68:71], a[140:143], v[40:43]
ds_read_b128 a[96:99], v9 offset:8192
v_mfma_f32_16x16x32_bf16 v[40:43], a[64:67], a[136:139], v[40:43]
s_xor_b32 s76, s75, 3145728
s_add_u32 s76, s74, s76
v_mfma_f32_16x16x32_bf16 v[48:51], a[64:67], a[144:147], v[48:51]
s_add_u32 m0, s77, 0
s_add_u32 s64, s76, 0
v_mfma_f32_16x16x32_bf16 v[48:51], a[68:71], a[148:151], v[48:51]
buffer_load_dwordx4 v7, s[56:59], s64 offen lds
v_mfma_f32_16x16x32_bf16 v[56:59], a[68:71], a[156:159], v[56:59]
ds_read_b128 a[100:103], v10 offset:8192
v_mfma_f32_16x16x32_bf16 v[56:59], a[64:67], a[152:155], v[56:59]
buffer_load_dword a252, v16, s[20:23], s52 offen
v_mfma_f32_16x16x32_bf16 v[60:63], a[72:75], a[152:155], v[60:63]
ds_read_b128 a[104:107], v9 offset:10240
v_mfma_f32_16x16x32_bf16 v[60:63], a[76:79], a[156:159], v[60:63]
s_add_u32 s52, s52, 24576
s_lshl_b32 s53, s53, 1
s_mul_i32 s54, s54, 896
v_mfma_f32_16x16x32_bf16 v[52:55], a[76:79], a[148:151], v[52:55]
v_mfma_f32_16x16x32_bf16 v[52:55], a[72:75], a[144:147], v[52:55]
buffer_load_dwordx4 v8, s[56:59], s64 offen offset:1024 lds
v_mfma_f32_16x16x32_bf16 v[44:47], a[72:75], a[136:139], v[44:47]
ds_read_b64_tr_b16 a[160:161], v11 offset:16384
ds_read_b64_tr_b16 a[162:163], v11 offset:16896
v_mfma_f32_16x16x32_bf16 v[44:47], a[76:79], a[140:143], v[44:47]
v_mfma_f32_16x16x32_bf16 v[36:39], a[76:79], a[132:135], v[36:39]
v_mfma_f32_16x16x32_bf16 v[36:39], a[72:75], a[128:131], v[36:39]
ds_read_b128 a[108:111], v10 offset:10240
v_mfma_f32_16x16x32_bf16 v[64:67], a[80:83], a[128:131], v[64:67]
s_add_u32 m0, s77, 2048
s_add_u32 s64, s76, 131072
v_mfma_f32_16x16x32_bf16 v[64:67], a[84:87], a[132:135], v[64:67]
v_mfma_f32_16x16x32_bf16 v[72:75], a[84:87], a[140:143], v[72:75]
buffer_load_dwordx4 v7, s[56:59], s64 offen lds
v_mfma_f32_16x16x32_bf16 v[72:75], a[80:83], a[136:139], v[72:75]
ds_read_b64_tr_b16 a[164:165], v11 offset:24576
ds_read_b64_tr_b16 a[166:167], v11 offset:25088
v_mfma_f32_16x16x32_bf16 v[80:83], a[80:83], a[144:147], v[80:83]
v_mfma_f32_16x16x32_bf16 v[80:83], a[84:87], a[148:151], v[80:83]
ds_read_b128 a[112:115], v9 offset:12288
v_mfma_f32_16x16x32_bf16 v[88:91], a[84:87], a[156:159], v[88:91]
v_mfma_f32_16x16x32_bf16 v[88:91], a[80:83], a[152:155], v[88:91]
v_mfma_f32_16x16x32_bf16 v[92:95], a[88:91], a[152:155], v[92:95]
ds_read_b64_tr_b16 a[168:169], v12 offset:16384
ds_read_b64_tr_b16 a[170:171], v12 offset:16896
v_mfma_f32_16x16x32_bf16 v[92:95], a[92:95], a[156:159], v[92:95]
buffer_load_dwordx4 v8, s[56:59], s64 offen offset:1024 lds
v_mfma_f32_16x16x32_bf16 v[84:87], a[92:95], a[148:151], v[84:87]
v_mfma_f32_16x16x32_bf16 v[84:87], a[88:91], a[144:147], v[84:87]
v_mfma_f32_16x16x32_bf16 v[76:79], a[88:91], a[136:139], v[76:79]
ds_read_b128 a[116:119], v10 offset:12288
v_mfma_f32_16x16x32_bf16 v[76:79], a[92:95], a[140:143], v[76:79]
v_mfma_f32_16x16x32_bf16 v[68:71], a[92:95], a[132:135], v[68:71]
v_mfma_f32_16x16x32_bf16 v[68:71], a[88:91], a[128:131], v[68:71]
s_add_u32 m0, s73, 4096
s_add_u32 s64, s71, 524288
s_waitcnt lgkmcnt(6)
v_mfma_f32_16x16x32_bf16 v[96:99], a[96:99], a[128:131], v[96:99]
ds_read_b64_tr_b16 a[172:173], v12 offset:24576
ds_read_b64_tr_b16 a[174:175], v12 offset:25088
v_mfma_f32_16x16x32_bf16 v[96:99], a[100:103], a[132:135], v[96:99]
buffer_load_dwordx4 v5, s[8:11], s64 offen lds
v_mfma_f32_16x16x32_bf16 v[104:107], a[100:103], a[140:143], v[104:107]
ds_read_b128 a[120:123], v9 offset:14336
v_mfma_f32_16x16x32_bf16 v[104:107], a[96:99], a[136:139], v[104:107]
v_mfma_f32_16x16x32_bf16 v[112:115], a[96:99], a[144:147], v[112:115]
v_mfma_f32_16x16x32_bf16 v[112:115], a[100:103], a[148:151], v[112:115]
ds_read_b64_tr_b16 a[176:177], v13 offset:16384
ds_read_b64_tr_b16 a[178:179], v13 offset:16896
v_mfma_f32_16x16x32_bf16 v[120:123], a[100:103], a[156:159], v[120:123]
v_mfma_f32_16x16x32_bf16 v[120:123], a[96:99], a[152:155], v[120:123]
v_mfma_f32_16x16x32_bf16 v[124:127], a[104:107], a[152:155], v[124:127]
buffer_load_dwordx4 v6, s[8:11], s64 offen offset:1024 lds
v_mfma_f32_16x16x32_bf16 v[124:127], a[108:111], a[156:159], v[124:127]
ds_read_b128 a[124:127], v10 offset:14336
v_mfma_f32_16x16x32_bf16 v[116:119], a[108:111], a[148:151], v[116:119]
v_add_u32 v9, 32768, v9
v_add_u32 v10, 32768, v10
v_mfma_f32_16x16x32_bf16 v[116:119], a[104:107], a[144:147], v[116:119]
v_mfma_f32_16x16x32_bf16 v[108:111], a[104:107], a[136:139], v[108:111]
ds_read_b64_tr_b16 a[180:181], v13 offset:24576
ds_read_b64_tr_b16 a[182:183], v13 offset:25088
v_mfma_f32_16x16x32_bf16 v[108:111], a[108:111], a[140:143], v[108:111]
s_add_u32 m0, s73, 6144
s_add_u32 s64, s71, 540672
v_mfma_f32_16x16x32_bf16 v[100:103], a[108:111], a[132:135], v[100:103]
s_waitcnt lgkmcnt(2)
v_mfma_f32_16x16x32_bf16 v[100:103], a[104:107], a[128:131], v[100:103]
buffer_load_dwordx4 v5, s[8:11], s64 offen lds
v_mfma_f32_16x16x32_bf16 v[128:131], a[112:115], a[128:131], v[128:131]
ds_read_b64_tr_b16 a[184:185], v14 offset:16384
ds_read_b64_tr_b16 a[186:187], v14 offset:16896
v_mfma_f32_16x16x32_bf16 v[128:131], a[116:119], a[132:135], v[128:131]
v_mfma_f32_16x16x32_bf16 v[136:139], a[116:119], a[140:143], v[136:139]
ds_read_b64_tr_b16 a[188:189], v14 offset:24576
ds_read_b64_tr_b16 a[190:191], v14 offset:25088
v_mfma_f32_16x16x32_bf16 v[136:139], a[112:115], a[136:139], v[136:139]
v_mfma_f32_16x16x32_bf16 v[144:147], a[112:115], a[144:147], v[144:147]
v_mfma_f32_16x16x32_bf16 v[144:147], a[116:119], a[148:151], v[144:147]
v_mfma_f32_16x16x32_bf16 v[152:155], a[116:119], a[156:159], v[152:155]
buffer_load_dwordx4 v6, s[8:11], s64 offen offset:1024 lds
v_mfma_f32_16x16x32_bf16 v[152:155], a[112:115], a[152:155], v[152:155]
v_mfma_f32_16x16x32_bf16 v[156:159], a[120:123], a[152:155], v[156:159]
v_mfma_f32_16x16x32_bf16 v[156:159], a[124:127], a[156:159], v[156:159]
v_mfma_f32_16x16x32_bf16 v[148:151], a[124:127], a[148:151], v[148:151]
v_mfma_f32_16x16x32_bf16 v[148:151], a[120:123], a[144:147], v[148:151]
v_mfma_f32_16x16x32_bf16 v[140:143], a[120:123], a[136:139], v[140:143]
v_mfma_f32_16x16x32_bf16 v[140:143], a[124:127], a[140:143], v[140:143]
v_mfma_f32_16x16x32_bf16 v[132:135], a[124:127], a[132:135], v[132:135]
v_mfma_f32_16x16x32_bf16 v[132:135], a[120:123], a[128:131], v[132:135]
s_waitcnt lgkmcnt(0)
v_mfma_f32_16x16x32_bf16 v[160:163], a[160:163], a[64:67], v[160:163]
s_waitcnt vmcnt(19)
v_mfma_f32_16x16x32_bf16 v[160:163], a[164:167], a[68:71], v[160:163]
s_barrier
v_mfma_f32_16x16x32_bf16 v[164:167], a[172:175], a[68:71], v[164:167]
ds_read_b64_tr_b16 a[128:129], v11 offset:32768
ds_read_b64_tr_b16 a[130:131], v11 offset:33280
v_mfma_f32_16x16x32_bf16 v[164:167], a[168:171], a[64:67], v[164:167]
s_add_u32 m0, s77, 16384
s_add_u32 s64, s76, 0
v_mfma_f32_16x16x32_bf16 v[168:171], a[176:179], a[64:67], v[168:171]
buffer_load_dwordx4 v7, s[16:19], s64 offen lds
v_mfma_f32_16x16x32_bf16 v[168:171], a[180:183], a[68:71], v[168:171]
v_mfma_f32_16x16x32_bf16 v[172:175], a[188:191], a[68:71], v[172:175]
v_mfma_f32_16x16x32_bf16 v[172:175], a[184:187], a[64:67], v[172:175]
ds_read_b128 a[64:67], v9 offset:0
v_mfma_f32_16x16x32_bf16 v[188:191], a[184:187], a[72:75], v[188:191]
ds_read_b64_tr_b16 a[132:133], v11 offset:40960
ds_read_b64_tr_b16 a[134:135], v11 offset:41472
v_mfma_f32_16x16x32_bf16 v[188:191], a[188:191], a[76:79], v[188:191]
v_mfma_f32_16x16x32_bf16 v[184:187], a[180:183], a[76:79], v[184:187]
v_mfma_f32_16x16x32_bf16 v[184:187], a[176:179], a[72:75], v[184:187]
buffer_load_dwordx4 v8, s[16:19], s64 offen offset:1024 lds
v_mfma_f32_16x16x32_bf16 v[180:183], a[168:171], a[72:75], v[180:183]
ds_read_b128 a[68:71], v10 offset:0
v_mfma_f32_16x16x32_bf16 v[180:183], a[172:175], a[76:79], v[180:183]
v_mfma_f32_16x16x32_bf16 v[176:179], a[164:167], a[76:79], v[176:179]
v_mfma_f32_16x16x32_bf16 v[176:179], a[160:163], a[72:75], v[176:179]
ds_read_b64_tr_b16 a[136:137], v12 offset:32768
ds_read_b64_tr_b16 a[138:139], v12 offset:33280
v_mfma_f32_16x16x32_bf16 v[192:195], a[160:163], a[80:83], v[192:195]
s_add_u32 m0, s77, 18432
s_add_u32 s64, s76, 131072
v_mfma_f32_16x16x32_bf16 v[192:195], a[164:167], a[84:87], v[192:195]
v_mfma_f32_16x16x32_bf16 v[196:199], a[172:175], a[84:87], v[196:199]
buffer_load_dwordx4 v7, s[16:19], s64 offen lds
v_mfma_f32_16x16x32_bf16 v[196:199], a[168:171], a[80:83], v[196:199]
ds_read_b128 a[72:75], v9 offset:2048
v_mfma_f32_16x16x32_bf16 v[200:203], a[176:179], a[80:83], v[200:203]
v_mfma_f32_16x16x32_bf16 v[200:203], a[180:183], a[84:87], v[200:203]
ds_read_b64_tr_b16 a[140:141], v12 offset:40960
ds_read_b64_tr_b16 a[142:143], v12 offset:41472
v_mfma_f32_16x16x32_bf16 v[204:207], a[188:191], a[84:87], v[204:207]
v_mfma_f32_16x16x32_bf16 v[204:207], a[184:187], a[80:83], v[204:207]
v_mfma_f32_16x16x32_bf16 v[220:223], a[184:187], a[88:91], v[220:223]
L_PAD2:
s_cbranch_execz L_PAD6
ds_read_b128 a[76:79], v10 offset:2048
v_mfma_f32_16x16x32_bf16 v[220:223], a[188:191], a[92:95], v[220:223]
buffer_load_dwordx4 v8, s[16:19], s64 offen offset:1024 lds
v_mfma_f32_16x16x32_bf16 v[216:219], a[180:183], a[92:95], v[216:219]
s_xor_b32 s71, s70, 896
s_add_u32 s71, s68, s71
v_mfma_f32_16x16x32_bf16 v[216:219], a[176:179], a[88:91], v[216:219]
v_mfma_f32_16x16x32_bf16 v[212:215], a[168:171], a[88:91], v[212:215]
ds_read_b64_tr_b16 a[144:145], v13 offset:32768
ds_read_b64_tr_b16 a[146:147], v13 offset:33280
v_mfma_f32_16x16x32_bf16 v[212:215], a[172:175], a[92:95], v[212:215]
v_mfma_f32_16x16x32_bf16 v[208:211], a[164:167], a[92:95], v[208:211]
v_mfma_f32_16x16x32_bf16 v[208:211], a[160:163], a[88:91], v[208:211]
s_add_u32 m0, s73, 32768
s_add_u32 s64, s71, 0
ds_read_b128 a[80:83], v9 offset:4096
v_mfma_f32_16x16x32_bf16 v[224:227], a[160:163], a[96:99], v[224:227]
v_mfma_f32_16x16x32_bf16 v[224:227], a[164:167], a[100:103], v[224:227]
buffer_load_dwordx4 v5, s[8:11], s64 offen lds
v_mfma_f32_16x16x32_bf16 v[228:231], a[172:175], a[100:103], v[228:231]
ds_read_b64_tr_b16 a[148:149], v13 offset:40960
ds_read_b64_tr_b16 a[150:151], v13 offset:41472
v_mfma_f32_16x16x32_bf16 v[228:231], a[168:171], a[96:99], v[228:231]
v_mfma_f32_16x16x32_bf16 v[232:235], a[176:179], a[96:99], v[232:235]
v_mfma_f32_16x16x32_bf16 v[232:235], a[180:183], a[100:103], v[232:235]
ds_read_b128 a[84:87], v10 offset:4096
v_mfma_f32_16x16x32_bf16 v[236:239], a[188:191], a[100:103], v[236:239]
v_mfma_f32_16x16x32_bf16 v[236:239], a[184:187], a[96:99], v[236:239]
v_mfma_f32_16x16x32_bf16 v[252:255], a[184:187], a[104:107], v[252:255]
buffer_load_dwordx4 v6, s[8:11], s64 offen offset:1024 lds
v_mfma_f32_16x16x32_bf16 v[252:255], a[188:191], a[108:111], v[252:255]
ds_read_b64_tr_b16 a[152:153], v14 offset:32768
ds_read_b64_tr_b16 a[154:155], v14 offset:33280
v_mfma_f32_16x16x32_bf16 v[248:251], a[180:183], a[108:111], v[248:251]
v_mfma_f32_16x16x32_bf16 v[248:251], a[176:179], a[104:107], v[248:251]
v_mfma_f32_16x16x32_bf16 v[244:247], a[168:171], a[104:107], v[244:247]
ds_read_b128 a[88:91], v9 offset:6144
v_mfma_f32_16x16x32_bf16 v[244:247], a[172:175], a[108:111], v[244:247]
s_add_u32 m0, s73, 34816
s_add_u32 s64, s71, 16384
v_mfma_f32_16x16x32_bf16 v[240:243], a[164:167], a[108:111], v[240:243]
v_mfma_f32_16x16x32_bf16 v[240:243], a[160:163], a[104:107], v[240:243]
buffer_load_dwordx4 v5, s[8:11], s64 offen lds
v_mfma_f32_16x16x32_bf16 a[0:3], a[160:163], a[112:115], a[0:3]
ds_read_b64_tr_b16 a[156:157], v14 offset:40960
ds_read_b64_tr_b16 a[158:159], v14 offset:41472
v_mfma_f32_16x16x32_bf16 a[0:3], a[164:167], a[116:119], a[0:3]
v_mfma_f32_16x16x32_bf16 a[4:7], a[172:175], a[116:119], a[4:7]
ds_read_b128 a[92:95], v10 offset:6144
v_mfma_f32_16x16x32_bf16 a[4:7], a[168:171], a[112:115], a[4:7]
v_mfma_f32_16x16x32_bf16 a[8:11], a[176:179], a[112:115], a[8:11]
v_mfma_f32_16x16x32_bf16 a[8:11], a[180:183], a[116:119], a[8:11]
v_mfma_f32_16x16x32_bf16 a[12:15], a[188:191], a[116:119], a[12:15]
buffer_load_dwordx4 v6, s[8:11], s64 offen offset:1024 lds
v_mfma_f32_16x16x32_bf16 a[12:15], a[184:187], a[112:115], a[12:15]
v_mfma_f32_16x16x32_bf16 a[28:31], a[184:187], a[120:123], a[28:31]
v_mfma_f32_16x16x32_bf16 a[28:31], a[188:191], a[124:127], a[28:31]
v_mfma_f32_16x16x32_bf16 a[24:27], a[180:183], a[124:127], a[24:27]
v_mfma_f32_16x16x32_bf16 a[24:27], a[176:179], a[120:123], a[24:27]
v_mfma_f32_16x16x32_bf16 a[20:23], a[168:171], a[120:123], a[20:23]
v_mfma_f32_16x16x32_bf16 a[20:23], a[172:175], a[124:127], a[20:23]
v_mfma_f32_16x16x32_bf16 a[16:19], a[164:167], a[124:127], a[16:19]
v_mfma_f32_16x16x32_bf16 a[16:19], a[160:163], a[120:123], a[16:19]
s_waitcnt lgkmcnt(0)
v_mfma_f32_16x16x32_bf16 v[32:35], a[64:67], a[128:131], v[32:35]
s_waitcnt vmcnt(21)
v_mfma_f32_16x16x32_bf16 v[32:35], a[68:71], a[132:135], v[32:35]
s_barrier
v_mfma_f32_16x16x32_bf16 v[40:43], a[68:71], a[140:143], v[40:43]
ds_read_b128 a[96:99], v9 offset:8192
v_mfma_f32_16x16x32_bf16 v[40:43], a[64:67], a[136:139], v[40:43]
s_xor_b32 s76, s75, 3670016
s_add_u32 s76, s74, s76
v_mfma_f32_16x16x32_bf16 v[48:51], a[64:67], a[144:147], v[48:51]
s_add_u32 m0, s77, 32768
s_add_u32 s64, s76, 0
v_mfma_f32_16x16x32_bf16 v[48:51], a[68:71], a[148:151], v[48:51]
buffer_load_dwordx4 v7, s[56:59], s64 offen lds
v_mfma_f32_16x16x32_bf16 v[56:59], a[68:71], a[156:159], v[56:59]
ds_read_b128 a[100:103], v10 offset:8192
v_mfma_f32_16x16x32_bf16 v[56:59], a[64:67], a[152:155], v[56:59]
buffer_load_dword a252, v16, s[20:23], s52 offen
v_mfma_f32_16x16x32_bf16 v[60:63], a[72:75], a[152:155], v[60:63]
s_lshr_b32 s52, s2, 1
s_lshl2_add_u32 s52, s52, s3
ds_read_b128 a[104:107], v9 offset:10240
v_mfma_f32_16x16x32_bf16 v[60:63], a[76:79], a[156:159], v[60:63]
s_mul_i32 s52, s52, 9216
s_and_b32 s53, s2, 1
s_lshl_b32 s53, s53, 9
v_mfma_f32_16x16x32_bf16 v[52:55], a[76:79], a[148:151], v[52:55]
s_add_u32 s52, s52, s53
v_min_u32 v18, 39, v1
v_and_b32 v16, 7, v18
v_mfma_f32_16x16x32_bf16 v[52:55], a[72:75], a[144:147], v[52:55]
buffer_load_dwordx4 v8, s[56:59], s64 offen offset:1024 lds
v_mfma_f32_16x16x32_bf16 v[44:47], a[72:75], a[136:139], v[44:47]
ds_read_b64_tr_b16 a[160:161], v11 offset:49152
ds_read_b64_tr_b16 a[162:163], v11 offset:49664
v_mfma_f32_16x16x32_bf16 v[44:47], a[76:79], a[140:143], v[44:47]
v_mul_u32_u24 v16, 1152, v16
v_lshrrev_b32 v18, 3, v18
v_mfma_f32_16x16x32_bf16 v[36:39], a[76:79], a[132:135], v[36:39]
v_lshl_add_u32 v16, v18, 7, v16
v_mfma_f32_16x16x32_bf16 v[36:39], a[72:75], a[128:131], v[36:39]
ds_read_b128 a[108:111], v10 offset:10240
v_mfma_f32_16x16x32_bf16 v[64:67], a[80:83], a[128:131], v[64:67]
s_add_u32 m0, s77, 34816
s_add_u32 s64, s76, 131072
v_mfma_f32_16x16x32_bf16 v[64:67], a[84:87], a[132:135], v[64:67]
v_mfma_f32_16x16x32_bf16 v[72:75], a[84:87], a[140:143], v[72:75]
buffer_load_dwordx4 v7, s[56:59], s64 offen lds
v_mfma_f32_16x16x32_bf16 v[72:75], a[80:83], a[136:139], v[72:75]
ds_read_b64_tr_b16 a[164:165], v11 offset:57344
ds_read_b64_tr_b16 a[166:167], v11 offset:57856
v_mfma_f32_16x16x32_bf16 v[80:83], a[80:83], a[144:147], v[80:83]
v_mfma_f32_16x16x32_bf16 v[80:83], a[84:87], a[148:151], v[80:83]
ds_read_b128 a[112:115], v9 offset:12288
v_mfma_f32_16x16x32_bf16 v[88:91], a[84:87], a[156:159], v[88:91]
v_mfma_f32_16x16x32_bf16 v[88:91], a[80:83], a[152:155], v[88:91]
v_mfma_f32_16x16x32_bf16 v[92:95], a[88:91], a[152:155], v[92:95]
ds_read_b64_tr_b16 a[168:169], v12 offset:49152
ds_read_b64_tr_b16 a[170:171], v12 offset:49664
v_mfma_f32_16x16x32_bf16 v[92:95], a[92:95], a[156:159], v[92:95]
buffer_load_dwordx4 v8, s[56:59], s64 offen offset:1024 lds
v_mfma_f32_16x16x32_bf16 v[84:87], a[92:95], a[148:151], v[84:87]
v_mfma_f32_16x16x32_bf16 v[84:87], a[88:91], a[144:147], v[84:87]
v_mfma_f32_16x16x32_bf16 v[76:79], a[88:91], a[136:139], v[76:79]
ds_read_b128 a[116:119], v10 offset:12288
v_mfma_f32_16x16x32_bf16 v[76:79], a[92:95], a[140:143], v[76:79]
v_mfma_f32_16x16x32_bf16 v[68:71], a[92:95], a[132:135], v[68:71]
v_mfma_f32_16x16x32_bf16 v[68:71], a[88:91], a[128:131], v[68:71]
s_add_u32 m0, s73, 36864
s_add_u32 s64, s71, 524288
s_waitcnt lgkmcnt(6)
v_mfma_f32_16x16x32_bf16 v[96:99], a[96:99], a[128:131], v[96:99]
ds_read_b64_tr_b16 a[172:173], v12 offset:57344
ds_read_b64_tr_b16 a[174:175], v12 offset:57856
v_mfma_f32_16x16x32_bf16 v[96:99], a[100:103], a[132:135], v[96:99]
buffer_load_dwordx4 v5, s[8:11], s64 offen lds
v_mfma_f32_16x16x32_bf16 v[104:107], a[100:103], a[140:143], v[104:107]
ds_read_b128 a[120:123], v9 offset:14336
v_mfma_f32_16x16x32_bf16 v[104:107], a[96:99], a[136:139], v[104:107]
v_mfma_f32_16x16x32_bf16 v[112:115], a[96:99], a[144:147], v[112:115]
v_mfma_f32_16x16x32_bf16 v[112:115], a[100:103], a[148:151], v[112:115]
ds_read_b64_tr_b16 a[176:177], v13 offset:49152
ds_read_b64_tr_b16 a[178:179], v13 offset:49664
v_mfma_f32_16x16x32_bf16 v[120:123], a[100:103], a[156:159], v[120:123]
v_mfma_f32_16x16x32_bf16 v[120:123], a[96:99], a[152:155], v[120:123]
v_mfma_f32_16x16x32_bf16 v[124:127], a[104:107], a[152:155], v[124:127]
buffer_load_dwordx4 v6, s[8:11], s64 offen offset:1024 lds
v_mfma_f32_16x16x32_bf16 v[124:127], a[108:111], a[156:159], v[124:127]
ds_read_b128 a[124:127], v10 offset:14336
v_mfma_f32_16x16x32_bf16 v[116:119], a[108:111], a[148:151], v[116:119]
v_add_u32 v9, -65536, v9
v_add_u32 v10, -65536, v10
v_mfma_f32_16x16x32_bf16 v[116:119], a[104:107], a[144:147], v[116:119]
buffer_load_dword v30, v29, s[24:27], s89 offen sc1
v_mfma_f32_16x16x32_bf16 v[108:111], a[104:107], a[136:139], v[108:111]
ds_read_b64_tr_b16 a[180:181], v13 offset:57344
ds_read_b64_tr_b16 a[182:183], v13 offset:57856
v_mfma_f32_16x16x32_bf16 v[108:111], a[108:111], a[140:143], v[108:111]
s_add_u32 m0, s73, 38912
s_add_u32 s64, s71, 540672
v_mfma_f32_16x16x32_bf16 v[100:103], a[108:111], a[132:135], v[100:103]
s_waitcnt lgkmcnt(2)
v_mfma_f32_16x16x32_bf16 v[100:103], a[104:107], a[128:131], v[100:103]
buffer_load_dwordx4 v5, s[8:11], s64 offen lds
v_mfma_f32_16x16x32_bf16 v[128:131], a[112:115], a[128:131], v[128:131]
ds_read_b64_tr_b16 a[184:185], v14 offset:49152
ds_read_b64_tr_b16 a[186:187], v14 offset:49664
v_mfma_f32_16x16x32_bf16 v[128:131], a[116:119], a[132:135], v[128:131]
v_mfma_f32_16x16x32_bf16 v[136:139], a[116:119], a[140:143], v[136:139]
ds_read_b64_tr_b16 a[188:189], v14 offset:57344
ds_read_b64_tr_b16 a[190:191], v14 offset:57856
v_mfma_f32_16x16x32_bf16 v[136:139], a[112:115], a[136:139], v[136:139]
v_mfma_f32_16x16x32_bf16 v[144:147], a[112:115], a[144:147], v[144:147]
v_mfma_f32_16x16x32_bf16 v[144:147], a[116:119], a[148:151], v[144:147]
v_mfma_f32_16x16x32_bf16 v[152:155], a[116:119], a[156:159], v[152:155]
buffer_load_dwordx4 v6, s[8:11], s64 offen offset:1024 lds
v_mfma_f32_16x16x32_bf16 v[152:155], a[112:115], a[152:155], v[152:155]
v_mfma_f32_16x16x32_bf16 v[156:159], a[120:123], a[152:155], v[156:159]
v_mfma_f32_16x16x32_bf16 v[156:159], a[124:127], a[156:159], v[156:159]
v_mfma_f32_16x16x32_bf16 v[148:151], a[124:127], a[148:151], v[148:151]
v_mfma_f32_16x16x32_bf16 v[148:151], a[120:123], a[144:147], v[148:151]
v_mfma_f32_16x16x32_bf16 v[140:143], a[120:123], a[136:139], v[140:143]
v_mfma_f32_16x16x32_bf16 v[140:143], a[124:127], a[140:143], v[140:143]
v_mfma_f32_16x16x32_bf16 v[132:135], a[124:127], a[132:135], v[132:135]
v_mfma_f32_16x16x32_bf16 v[132:135], a[120:123], a[128:131], v[132:135]
s_waitcnt lgkmcnt(0)
v_mfma_f32_16x16x32_bf16 v[160:163], a[160:163], a[64:67], v[160:163]
s_waitcnt vmcnt(18)
v_mfma_f32_16x16x32_bf16 v[160:163], a[164:167], a[68:71], v[160:163]
s_barrier
v_mfma_f32_16x16x32_bf16 v[164:167], a[172:175], a[68:71], v[164:167]
ds_read_b64_tr_b16 a[128:129], v11 offset:0
ds_read_b64_tr_b16 a[130:131], v11 offset:512
v_mfma_f32_16x16x32_bf16 v[164:167], a[168:171], a[64:67], v[164:167]
s_add_u32 m0, s77, 49152
s_add_u32 s64, s76, 0
v_mfma_f32_16x16x32_bf16 v[168:171], a[176:179], a[64:67], v[168:171]
buffer_load_dwordx4 v7, s[16:19], s64 offen lds
v_mfma_f32_16x16x32_bf16 v[168:171], a[180:183], a[68:71], v[168:171]
v_mfma_f32_16x16x32_bf16 v[172:175], a[188:191], a[68:71], v[172:175]
v_mfma_f32_16x16x32_bf16 v[172:175], a[184:187], a[64:67], v[172:175]
ds_read_b128 a[64:67], v9 offset:0
v_mfma_f32_16x16x32_bf16 v[188:191], a[184:187], a[72:75], v[188:191]
ds_read_b64_tr_b16 a[132:133], v11 offset:8192
ds_read_b64_tr_b16 a[134:135], v11 offset:8704
v_mfma_f32_16x16x32_bf16 v[188:191], a[188:191], a[76:79], v[188:191]
v_mfma_f32_16x16x32_bf16 v[184:187], a[180:183], a[76:79], v[184:187]
v_mfma_f32_16x16x32_bf16 v[184:187], a[176:179], a[72:75], v[184:187]
buffer_load_dwordx4 v8, s[16:19], s64 offen offset:1024 lds
v_mfma_f32_16x16x32_bf16 v[180:183], a[168:171], a[72:75], v[180:183]
ds_read_b128 a[68:71], v10 offset:0
v_mfma_f32_16x16x32_bf16 v[180:183], a[172:175], a[76:79], v[180:183]
v_mfma_f32_16x16x32_bf16 v[176:179], a[164:167], a[76:79], v[176:179]
v_mfma_f32_16x16x32_bf16 v[176:179], a[160:163], a[72:75], v[176:179]
ds_read_b64_tr_b16 a[136:137], v12 offset:0
ds_read_b64_tr_b16 a[138:139], v12 offset:512
v_mfma_f32_16x16x32_bf16 v[192:195], a[160:163], a[80:83], v[192:195]
s_add_u32 m0, s77, 51200
s_add_u32 s64, s76, 131072
v_mfma_f32_16x16x32_bf16 v[192:195], a[164:167], a[84:87], v[192:195]
v_mfma_f32_16x16x32_bf16 v[196:199], a[172:175], a[84:87], v[196:199]
buffer_load_dwordx4 v7, s[16:19], s64 offen lds
v_mfma_f32_16x16x32_bf16 v[196:199], a[168:171], a[80:83], v[196:199]
ds_read_b128 a[72:75], v9 offset:2048
v_mfma_f32_16x16x32_bf16 v[200:203], a[176:179], a[80:83], v[200:203]
v_mfma_f32_16x16x32_bf16 v[200:203], a[180:183], a[84:87], v[200:203]
ds_read_b64_tr_b16 a[140:141], v12 offset:8192
ds_read_b64_tr_b16 a[142:143], v12 offset:8704
v_mfma_f32_16x16x32_bf16 v[204:207], a[188:191], a[84:87], v[204:207]
v_mfma_f32_16x16x32_bf16 v[204:207], a[184:187], a[80:83], v[204:207]
v_mfma_f32_16x16x32_bf16 v[220:223], a[184:187], a[88:91], v[220:223]
ds_read_b128 a[76:79], v10 offset:2048
v_mfma_f32_16x16x32_bf16 v[220:223], a[188:191], a[92:95], v[220:223]
buffer_load_dwordx4 v8, s[16:19], s64 offen offset:1024 lds
v_mfma_f32_16x16x32_bf16 v[216:219], a[180:183], a[92:95], v[216:219]
s_lshl_b32 s70, s93, 7
s_mul_i32 s68, s66, 36864
s_mul_i32 s69, s67, 36864
v_mfma_f32_16x16x32_bf16 v[216:219], a[176:179], a[88:91], v[216:219]
v_lshrrev_b32 v31, 3, v1
v_lshl_add_u32 v5, v31, 7, v5
v_mfma_f32_16x16x32_bf16 v[212:215], a[168:171], a[88:91], v[212:215]
v_lshl_add_u32 v6, v31, 7, v6
v_add_u32 v6, 1024, v6
v_mfma_f32_16x16x32_bf16 v[212:215], a[172:175], a[92:95], v[212:215]
s_mov_b32 s65, 1024
s_add_u32 s71, s68, s65
s_add_u32 s72, s69, s65
v_mfma_f32_16x16x32_bf16 v[208:211], a[164:167], a[92:95], v[208:211]
ds_read_b64_tr_b16 a[144:145], v13 offset:0
ds_read_b64_tr_b16 a[146:147], v13 offset:512
v_mfma_f32_16x16x32_bf16 v[208:211], a[160:163], a[88:91], v[208:211]
s_add_u32 m0, s73, 65536
s_add_u32 s64, s71, 0
ds_read_b128 a[80:83], v9 offset:4096
v_mfma_f32_16x16x32_bf16 v[224:227], a[160:163], a[96:99], v[224:227]
v_mfma_f32_16x16x32_bf16 v[224:227], a[164:167], a[100:103], v[224:227]
buffer_load_dwordx4 v5, s[12:15], s64 offen lds
v_mfma_f32_16x16x32_bf16 v[228:231], a[172:175], a[100:103], v[228:231]
ds_read_b64_tr_b16 a[148:149], v13 offset:8192
ds_read_b64_tr_b16 a[150:151], v13 offset:8704
v_mfma_f32_16x16x32_bf16 v[228:231], a[168:171], a[96:99], v[228:231]
v_mfma_f32_16x16x32_bf16 v[232:235], a[176:179], a[96:99], v[232:235]
v_mfma_f32_16x16x32_bf16 v[232:235], a[180:183], a[100:103], v[232:235]
ds_read_b128 a[84:87], v10 offset:4096
v_mfma_f32_16x16x32_bf16 v[236:239], a[188:191], a[100:103], v[236:239]
v_mfma_f32_16x16x32_bf16 v[236:239], a[184:187], a[96:99], v[236:239]
v_mfma_f32_16x16x32_bf16 v[252:255], a[184:187], a[104:107], v[252:255]
buffer_load_dwordx4 v6, s[12:15], s64 offen offset:1024 lds
v_mfma_f32_16x16x32_bf16 v[252:255], a[188:191], a[108:111], v[252:255]
ds_read_b64_tr_b16 a[152:153], v14 offset:0
ds_read_b64_tr_b16 a[154:155], v14 offset:512
v_mfma_f32_16x16x32_bf16 v[248:251], a[180:183], a[108:111], v[248:251]
v_mfma_f32_16x16x32_bf16 v[248:251], a[176:179], a[104:107], v[248:251]
v_mfma_f32_16x16x32_bf16 v[244:247], a[168:171], a[104:107], v[244:247]
ds_read_b128 a[88:91], v9 offset:6144
v_mfma_f32_16x16x32_bf16 v[244:247], a[172:175], a[108:111], v[244:247]
s_add_u32 m0, s73, 67584
s_add_u32 s64, s71, 18432
v_mfma_f32_16x16x32_bf16 v[240:243], a[164:167], a[108:111], v[240:243]
v_mfma_f32_16x16x32_bf16 v[240:243], a[160:163], a[104:107], v[240:243]
buffer_load_dwordx4 v5, s[12:15], s64 offen lds
v_mfma_f32_16x16x32_bf16 a[0:3], a[160:163], a[112:115], a[0:3]
ds_read_b64_tr_b16 a[156:157], v14 offset:8192
ds_read_b64_tr_b16 a[158:159], v14 offset:8704
v_mfma_f32_16x16x32_bf16 a[0:3], a[164:167], a[116:119], a[0:3]
v_mfma_f32_16x16x32_bf16 a[4:7], a[172:175], a[116:119], a[4:7]
s_waitcnt vmcnt(9)
ds_read_b128 a[92:95], v10 offset:6144
v_mfma_f32_16x16x32_bf16 a[4:7], a[168:171], a[112:115], a[4:7]
v_cmp_gt_u32 vcc, 18, v30
v_mfma_f32_16x16x32_bf16 a[8:11], a[176:179], a[112:115], a[8:11]
v_mfma_f32_16x16x32_bf16 a[8:11], a[180:183], a[116:119], a[8:11]
v_mfma_f32_16x16x32_bf16 a[12:15], a[188:191], a[116:119], a[12:15]
buffer_load_dwordx4 v6, s[12:15], s64 offen offset:1024 lds
v_mfma_f32_16x16x32_bf16 a[12:15], a[184:187], a[112:115], a[12:15]
v_mfma_f32_16x16x32_bf16 a[28:31], a[184:187], a[120:123], a[28:31]
s_cbranch_vccnz CK_WA
CK_WA_R:
v_mfma_f32_16x16x32_bf16 a[28:31], a[188:191], a[124:127], a[28:31]
v_mfma_f32_16x16x32_bf16 a[24:27], a[180:183], a[124:127], a[24:27]
v_mfma_f32_16x16x32_bf16 a[24:27], a[176:179], a[120:123], a[24:27]
v_mfma_f32_16x16x32_bf16 a[20:23], a[168:171], a[120:123], a[20:23]
v_mfma_f32_16x16x32_bf16 a[20:23], a[172:175], a[124:127], a[20:23]
v_mfma_f32_16x16x32_bf16 a[16:19], a[164:167], a[124:127], a[16:19]
v_mfma_f32_16x16x32_bf16 a[16:19], a[160:163], a[120:123], a[16:19]
s_waitcnt lgkmcnt(0)
v_mfma_f32_16x16x32_bf16 v[32:35], a[64:67], a[128:131], v[32:35]
s_waitcnt vmcnt(22)
v_mfma_f32_16x16x32_bf16 v[32:35], a[68:71], a[132:135], v[32:35]
s_barrier
v_mfma_f32_16x16x32_bf16 v[40:43], a[68:71], a[140:143], v[40:43]
ds_read_b128 a[96:99], v9 offset:8192
v_mfma_f32_16x16x32_bf16 v[40:43], a[64:67], a[136:139], v[40:43]
s_lshl_b32 s77, s3, 11
s_lshl_b32 s74, s3, 9
s_add_u32 s74, s74, s4
v_mfma_f32_16x16x32_bf16 v[48:51], a[64:67], a[144:147], v[48:51]
s_lshl_b32 s74, s74, 8
v_mfma_f32_16x16x32_bf16 v[48:51], a[68:71], a[148:151], v[48:51]
s_mov_b32 s75, 8
s_lshl_b32 s76, s75, 19
s_add_u32 s76, s76, s74
v_mfma_f32_16x16x32_bf16 v[56:59], a[68:71], a[156:159], v[56:59]
s_lshl_b32 s79, s75, 13
s_add_u32 s79, s79, s78
ds_read_b128 a[100:103], v10 offset:8192
v_mfma_f32_16x16x32_bf16 v[56:59], a[64:67], a[152:155], v[56:59]
s_add_u32 m0, s77, 0
s_add_u32 s64, s76, 0
v_mfma_f32_16x16x32_bf16 v[60:63], a[72:75], a[152:155], v[60:63]
buffer_load_dwordx4 v7, s[20:23], s64 offen lds
v_mfma_f32_16x16x32_bf16 v[60:63], a[76:79], a[156:159], v[60:63]
ds_read_b128 a[104:107], v9 offset:10240
v_mfma_f32_16x16x32_bf16 v[52:55], a[76:79], a[148:151], v[52:55]
buffer_load_dword a252, v16, s[32:35], s52 offen
v_mfma_f32_16x16x32_bf16 v[52:55], a[72:75], a[144:147], v[52:55]
ds_read_b64_tr_b16 a[160:161], v11 offset:16384
ds_read_b64_tr_b16 a[162:163], v11 offset:16896
v_mfma_f32_16x16x32_bf16 v[44:47], a[72:75], a[136:139], v[44:47]
buffer_load_dwordx4 v8, s[20:23], s64 offen offset:1024 lds
v_mfma_f32_16x16x32_bf16 v[44:47], a[76:79], a[140:143], v[44:47]
buffer_load_dword a253, v17, s[48:51], s54 offen
v_mfma_f32_16x16x32_bf16 v[36:39], a[76:79], a[132:135], v[36:39]
v_mfma_f32_16x16x32_bf16 v[36:39], a[72:75], a[128:131], v[36:39]
ds_read_b128 a[108:111], v10 offset:10240
v_mfma_f32_16x16x32_bf16 v[64:67], a[80:83], a[128:131], v[64:67]
v_mfma_f32_16x16x32_bf16 v[64:67], a[84:87], a[132:135], v[64:67]
v_mfma_f32_16x16x32_bf16 v[72:75], a[84:87], a[140:143], v[72:75]
s_add_u32 m0, s80, 0
s_add_u32 s64, s79, 0
v_mfma_f32_16x16x32_bf16 v[72:75], a[80:83], a[136:139], v[72:75]
ds_read_b64_tr_b16 a[164:165], v11 offset:24576
ds_read_b64_tr_b16 a[166:167], v11 offset:25088
v_mfma_f32_16x16x32_bf16 v[80:83], a[80:83], a[144:147], v[80:83]
buffer_load_dwordx4 v4, s[24:27], s64 offen sc1 lds
v_mfma_f32_16x16x32_bf16 v[80:83], a[84:87], a[148:151], v[80:83]
ds_read_b128 a[112:115], v9 offset:12288
v_mfma_f32_16x16x32_bf16 v[88:91], a[84:87], a[156:159], v[88:91]
v_mfma_f32_16x16x32_bf16 v[88:91], a[80:83], a[152:155], v[88:91]
v_mfma_f32_16x16x32_bf16 v[92:95], a[88:91], a[152:155], v[92:95]
ds_read_b64_tr_b16 a[168:169], v12 offset:16384
ds_read_b64_tr_b16 a[170:171], v12 offset:16896
v_mfma_f32_16x16x32_bf16 v[92:95], a[92:95], a[156:159], v[92:95]
v_mfma_f32_16x16x32_bf16 v[84:87], a[92:95], a[148:151], v[84:87]
s_add_u32 m0, s73, 69632
s_add_u32 s64, s72, 0
v_mfma_f32_16x16x32_bf16 v[84:87], a[88:91], a[144:147], v[84:87]
v_mfma_f32_16x16x32_bf16 v[76:79], a[88:91], a[136:139], v[76:79]
buffer_load_dwordx4 v5, s[12:15], s64 offen lds
v_mfma_f32_16x16x32_bf16 v[76:79], a[92:95], a[140:143], v[76:79]
ds_read_b128 a[116:119], v10 offset:12288
v_mfma_f32_16x16x32_bf16 v[68:71], a[92:95], a[132:135], v[68:71]
v_mfma_f32_16x16x32_bf16 v[68:71], a[88:91], a[128:131], v[68:71]
s_waitcnt lgkmcnt(6)
ds_read_b64_tr_b16 a[172:173], v12 offset:24576
ds_read_b64_tr_b16 a[174:175], v12 offset:25088
v_mfma_f32_16x16x32_bf16 v[96:99], a[96:99], a[128:131], v[96:99]
v_mfma_f32_16x16x32_bf16 v[96:99], a[100:103], a[132:135], v[96:99]
v_mfma_f32_16x16x32_bf16 v[104:107], a[100:103], a[140:143], v[104:107]
ds_read_b128 a[120:123], v9 offset:14336
v_mfma_f32_16x16x32_bf16 v[104:107], a[96:99], a[136:139], v[104:107]
v_mfma_f32_16x16x32_bf16 v[112:115], a[96:99], a[144:147], v[112:115]
v_mfma_f32_16x16x32_bf16 v[112:115], a[100:103], a[148:151], v[112:115]
buffer_load_dwordx4 v6, s[12:15], s64 offen offset:1024 lds
v_mfma_f32_16x16x32_bf16 v[120:123], a[100:103], a[156:159], v[120:123]
ds_read_b64_tr_b16 a[176:177], v13 offset:16384
ds_read_b64_tr_b16 a[178:179], v13 offset:16896
v_mfma_f32_16x16x32_bf16 v[120:123], a[96:99], a[152:155], v[120:123]
v_mfma_f32_16x16x32_bf16 v[124:127], a[104:107], a[152:155], v[124:127]
v_mfma_f32_16x16x32_bf16 v[124:127], a[108:111], a[156:159], v[124:127]
ds_read_b128 a[124:127], v10 offset:14336
v_mfma_f32_16x16x32_bf16 v[116:119], a[108:111], a[148:151], v[116:119]
v_add_u32 v9, 32768, v9
v_add_u32 v10, 32768, v10
v_mfma_f32_16x16x32_bf16 v[116:119], a[104:107], a[144:147], v[116:119]
s_add_u32 m0, s73, 71680
s_add_u32 s64, s72, 18432
v_mfma_f32_16x16x32_bf16 v[108:111], a[104:107], a[136:139], v[108:111]
ds_read_b64_tr_b16 a[180:181], v13 offset:24576
ds_read_b64_tr_b16 a[182:183], v13 offset:25088
v_mfma_f32_16x16x32_bf16 v[108:111], a[108:111], a[140:143], v[108:111]
buffer_load_dwordx4 v5, s[12:15], s64 offen lds
v_mfma_f32_16x16x32_bf16 v[100:103], a[108:111], a[132:135], v[100:103]
v_mfma_f32_16x16x32_bf16 v[100:103], a[104:107], a[128:131], v[100:103]
s_waitcnt lgkmcnt(2)
ds_read_b64_tr_b16 a[184:185], v14 offset:16384
ds_read_b64_tr_b16 a[186:187], v14 offset:16896
v_mfma_f32_16x16x32_bf16 v[128:131], a[112:115], a[128:131], v[128:131]
v_mfma_f32_16x16x32_bf16 v[128:131], a[116:119], a[132:135], v[128:131]
v_mfma_f32_16x16x32_bf16 v[136:139], a[116:119], a[140:143], v[136:139]
ds_read_b64_tr_b16 a[188:189], v14 offset:24576
ds_read_b64_tr_b16 a[190:191], v14 offset:25088
v_mfma_f32_16x16x32_bf16 v[136:139], a[112:115], a[136:139], v[136:139]
v_mfma_f32_16x16x32_bf16 v[144:147], a[112:115], a[144:147], v[144:147]
v_mfma_f32_16x16x32_bf16 v[144:147], a[116:119], a[148:151], v[144:147]
buffer_load_dwordx4 v6, s[12:15], s64 offen offset:1024 lds
v_mfma_f32_16x16x32_bf16 v[152:155], a[116:119], a[156:159], v[152:155]
v_mfma_f32_16x16x32_bf16 v[152:155], a[112:115], a[152:155], v[152:155]
v_mfma_f32_16x16x32_bf16 v[156:159], a[120:123], a[152:155], v[156:159]
v_mfma_f32_16x16x32_bf16 v[156:159], a[124:127], a[156:159], v[156:159]
v_mfma_f32_16x16x32_bf16 v[148:151], a[124:127], a[148:151], v[148:151]
v_mfma_f32_16x16x32_bf16 v[148:151], a[120:123], a[144:147], v[148:151]
v_mfma_f32_16x16x32_bf16 v[140:143], a[120:123], a[136:139], v[140:143]
v_mfma_f32_16x16x32_bf16 v[140:143], a[124:127], a[140:143], v[140:143]
v_mfma_f32_16x16x32_bf16 v[132:135], a[124:127], a[132:135], v[132:135]
v_mfma_f32_16x16x32_bf16 v[132:135], a[120:123], a[128:131], v[132:135]
s_waitcnt lgkmcnt(0)
v_mfma_f32_16x16x32_bf16 v[160:163], a[160:163], a[64:67], v[160:163]
s_waitcnt vmcnt(17)
v_mfma_f32_16x16x32_bf16 v[160:163], a[164:167], a[68:71], v[160:163]
s_barrier
v_mfma_f32_16x16x32_bf16 v[164:167], a[172:175], a[68:71], v[164:167]
ds_read_b64_tr_b16 a[128:129], v11 offset:32768
ds_read_b64_tr_b16 a[130:131], v11 offset:33280
v_mfma_f32_16x16x32_bf16 v[164:167], a[168:171], a[64:67], v[164:167]
s_add_u32 m0, s77, 16384
s_add_u32 s64, s76, 128
v_mfma_f32_16x16x32_bf16 v[168:171], a[176:179], a[64:67], v[168:171]
buffer_load_dwordx4 v7, s[20:23], s64 offen lds
v_mfma_f32_16x16x32_bf16 v[168:171], a[180:183], a[68:71], v[168:171]
v_mfma_f32_16x16x32_bf16 v[172:175], a[188:191], a[68:71], v[172:175]
v_mfma_f32_16x16x32_bf16 v[172:175], a[184:187], a[64:67], v[172:175]
ds_read_b128 a[64:67], v9 offset:0
v_mfma_f32_16x16x32_bf16 v[188:191], a[184:187], a[72:75], v[188:191]
ds_read_b64_tr_b16 a[132:133], v11 offset:40960
ds_read_b64_tr_b16 a[134:135], v11 offset:41472
v_mfma_f32_16x16x32_bf16 v[188:191], a[188:191], a[76:79], v[188:191]
v_mfma_f32_16x16x32_bf16 v[184:187], a[180:183], a[76:79], v[184:187]
v_mfma_f32_16x16x32_bf16 v[184:187], a[176:179], a[72:75], v[184:187]
ds_read_b128 a[68:71], v10 offset:0
v_mfma_f32_16x16x32_bf16 v[180:183], a[168:171], a[72:75], v[180:183]
buffer_load_dwordx4 v8, s[20:23], s64 offen offset:1024 lds
v_mfma_f32_16x16x32_bf16 v[180:183], a[172:175], a[76:79], v[180:183]
v_mfma_f32_16x16x32_bf16 v[176:179], a[164:167], a[76:79], v[176:179]
v_mfma_f32_16x16x32_bf16 v[176:179], a[160:163], a[72:75], v[176:179]
ds_read_b64_tr_b16 a[136:137], v12 offset:32768
ds_read_b64_tr_b16 a[138:139], v12 offset:33280
v_mfma_f32_16x16x32_bf16 v[192:195], a[160:163], a[80:83], v[192:195]
v_mfma_f32_16x16x32_bf16 v[192:195], a[164:167], a[84:87], v[192:195]
v_mfma_f32_16x16x32_bf16 v[196:199], a[172:175], a[84:87], v[196:199]
s_add_u32 m0, s80, 16384
s_add_u32 s64, s79, 2048
ds_read_b128 a[72:75], v9 offset:2048
v_mfma_f32_16x16x32_bf16 v[196:199], a[168:171], a[80:83], v[196:199]
v_mfma_f32_16x16x32_bf16 v[200:203], a[176:179], a[80:83], v[200:203]
buffer_load_dwordx4 v4, s[24:27], s64 offen sc1 lds
v_mfma_f32_16x16x32_bf16 v[200:203], a[180:183], a[84:87], v[200:203]
s_xor_b32 s65, s70, 0
s_add_u32 s71, s68, s65
s_add_u32 s72, s69, s65
v_mfma_f32_16x16x32_bf16 v[204:207], a[188:191], a[84:87], v[204:207]
ds_read_b64_tr_b16 a[140:141], v12 offset:40960
ds_read_b64_tr_b16 a[142:143], v12 offset:41472
v_mfma_f32_16x16x32_bf16 v[204:207], a[184:187], a[80:83], v[204:207]
v_mfma_f32_16x16x32_bf16 v[220:223], a[184:187], a[88:91], v[220:223]
ds_read_b128 a[76:79], v10 offset:2048
v_mfma_f32_16x16x32_bf16 v[220:223], a[188:191], a[92:95], v[220:223]
v_mfma_f32_16x16x32_bf16 v[216:219], a[180:183], a[92:95], v[216:219]
s_add_u32 m0, s73, 0
s_add_u32 s64, s71, 0
v_mfma_f32_16x16x32_bf16 v[216:219], a[176:179], a[88:91], v[216:219]
v_mfma_f32_16x16x32_bf16 v[212:215], a[168:171], a[88:91], v[212:215]
buffer_load_dwordx4 v5, s[12:15], s64 offen lds
v_mfma_f32_16x16x32_bf16 v[212:215], a[172:175], a[92:95], v[212:215]
ds_read_b64_tr_b16 a[144:145], v13 offset:32768
ds_read_b64_tr_b16 a[146:147], v13 offset:33280
v_mfma_f32_16x16x32_bf16 v[208:211], a[164:167], a[92:95], v[208:211]
v_mfma_f32_16x16x32_bf16 v[208:211], a[160:163], a[88:91], v[208:211]
ds_read_b128 a[80:83], v9 offset:4096
v_mfma_f32_16x16x32_bf16 v[224:227], a[160:163], a[96:99], v[224:227]
v_mfma_f32_16x16x32_bf16 v[224:227], a[164:167], a[100:103], v[224:227]
v_mfma_f32_16x16x32_bf16 v[228:231], a[172:175], a[100:103], v[228:231]
ds_read_b64_tr_b16 a[148:149], v13 offset:40960
ds_read_b64_tr_b16 a[150:151], v13 offset:41472
v_mfma_f32_16x16x32_bf16 v[228:231], a[168:171], a[96:99], v[228:231]
v_mfma_f32_16x16x32_bf16 v[232:235], a[176:179], a[96:99], v[232:235]
v_mfma_f32_16x16x32_bf16 v[232:235], a[180:183], a[100:103], v[232:235]
buffer_load_dwordx4 v6, s[12:15], s64 offen offset:1024 lds
v_mfma_f32_16x16x32_bf16 v[236:239], a[188:191], a[100:103], v[236:239]
ds_read_b128 a[84:87], v10 offset:4096
v_mfma_f32_16x16x32_bf16 v[236:239], a[184:187], a[96:99], v[236:239]
v_mfma_f32_16x16x32_bf16 v[252:255], a[184:187], a[104:107], v[252:255]
v_mfma_f32_16x16x32_bf16 v[252:255], a[188:191], a[108:111], v[252:255]
ds_read_b64_tr_b16 a[152:153], v14 offset:32768
ds_read_b64_tr_b16 a[154:155], v14 offset:33280
v_mfma_f32_16x16x32_bf16 v[248:251], a[180:183], a[108:111], v[248:251]
v_mfma_f32_16x16x32_bf16 v[248:251], a[176:179], a[104:107], v[248:251]
s_add_u32 m0, s73, 2048
s_add_u32 s64, s71, 18432
v_mfma_f32_16x16x32_bf16 v[244:247], a[168:171], a[104:107], v[244:247]
ds_read_b128 a[88:91], v9 offset:6144
v_mfma_f32_16x16x32_bf16 v[244:247], a[172:175], a[108:111], v[244:247]
buffer_load_dwordx4 v5, s[12:15], s64 offen lds
v_mfma_f32_16x16x32_bf16 v[240:243], a[164:167], a[108:111], v[240:243]
v_mfma_f32_16x16x32_bf16 v[240:243], a[160:163], a[104:107], v[240:243]
ds_read_b64_tr_b16 a[156:157], v14 offset:40960
ds_read_b64_tr_b16 a[158:159], v14 offset:41472
v_mfma_f32_16x16x32_bf16 a[0:3], a[160:163], a[112:115], a[0:3]
v_mfma_f32_16x16x32_bf16 a[0:3], a[164:167], a[116:119], a[0:3]
v_mfma_f32_16x16x32_bf16 a[4:7], a[172:175], a[116:119], a[4:7]
ds_read_b128 a[92:95], v10 offset:6144
v_mfma_f32_16x16x32_bf16 a[4:7], a[168:171], a[112:115], a[4:7]
v_mfma_f32_16x16x32_bf16 a[8:11], a[176:179], a[112:115], a[8:11]
v_mfma_f32_16x16x32_bf16 a[8:11], a[180:183], a[116:119], a[8:11]
buffer_load_dwordx4 v6, s[12:15], s64 offen offset:1024 lds
v_mfma_f32_16x16x32_bf16 a[12:15], a[188:191], a[116:119], a[12:15]
v_mfma_f32_16x16x32_bf16 a[12:15], a[184:187], a[112:115], a[12:15]
v_mfma_f32_16x16x32_bf16 a[28:31], a[184:187], a[120:123], a[28:31]
v_mfma_f32_16x16x32_bf16 a[28:31], a[188:191], a[124:127], a[28:31]
v_mfma_f32_16x16x32_bf16 a[24:27], a[180:183], a[124:127], a[24:27]
v_mfma_f32_16x16x32_bf16 a[24:27], a[176:179], a[120:123], a[24:27]
v_mfma_f32_16x16x32_bf16 a[20:23], a[168:171], a[120:123], a[20:23]
v_mfma_f32_16x16x32_bf16 a[20:23], a[172:175], a[124:127], a[20:23]
v_mfma_f32_16x16x32_bf16 a[16:19], a[164:167], a[124:127], a[16:19]
v_mfma_f32_16x16x32_bf16 a[16:19], a[160:163], a[120:123], a[16:19]
s_waitcnt lgkmcnt(0)
v_mfma_f32_16x16x32_bf16 v[32:35], a[64:67], a[128:131], v[32:35]
s_waitcnt vmcnt(20)
v_mfma_f32_16x16x32_bf16 v[32:35], a[68:71], a[132:135], v[32:35]
s_barrier
v_mfma_f32_16x16x32_bf16 v[40:43], a[68:71], a[140:143], v[40:43]
L_PAD3:
s_cbranch_execz L_PAD7
ds_read_b128 a[96:99], v9 offset:8192
v_mfma_f32_16x16x32_bf16 v[40:43], a[64:67], a[136:139], v[40:43]
s_xor_b32 s75, s93, 0
s_lshl_b32 s76, s75, 19
s_add_u32 s76, s76, s74
v_mfma_f32_16x16x32_bf16 v[48:51], a[64:67], a[144:147], v[48:51]
s_lshl_b32 s79, s75, 13
s_add_u32 s79, s79, s78
v_mfma_f32_16x16x32_bf16 v[48:51], a[68:71], a[148:151], v[48:51]
s_add_u32 m0, s77, 32768
s_add_u32 s64, s76, 0
ds_read_b128 a[100:103], v10 offset:8192
v_mfma_f32_16x16x32_bf16 v[56:59], a[68:71], a[156:159], v[56:59]
buffer_load_dwordx4 v7, s[20:23], s64 offen lds
v_mfma_f32_16x16x32_bf16 v[56:59], a[64:67], a[152:155], v[56:59]
v_mfma_f32_16x16x32_bf16 v[60:63], a[72:75], a[152:155], v[60:63]
ds_read_b128 a[104:107], v9 offset:10240
v_mfma_f32_16x16x32_bf16 v[60:63], a[76:79], a[156:159], v[60:63]
v_mfma_f32_16x16x32_bf16 v[52:55], a[76:79], a[148:151], v[52:55]
v_mfma_f32_16x16x32_bf16 v[52:55], a[72:75], a[144:147], v[52:55]
ds_read_b64_tr_b16 a[160:161], v11 offset:49152
ds_read_b64_tr_b16 a[162:163], v11 offset:49664
v_mfma_f32_16x16x32_bf16 v[44:47], a[72:75], a[136:139], v[44:47]
buffer_load_dwordx4 v8, s[20:23], s64 offen offset:1024 lds
v_mfma_f32_16x16x32_bf16 v[44:47], a[76:79], a[140:143], v[44:47]
v_mfma_f32_16x16x32_bf16 v[36:39], a[76:79], a[132:135], v[36:39]
v_mfma_f32_16x16x32_bf16 v[36:39], a[72:75], a[128:131], v[36:39]
ds_read_b128 a[108:111], v10 offset:10240
v_mfma_f32_16x16x32_bf16 v[64:67], a[80:83], a[128:131], v[64:67]
v_mfma_f32_16x16x32_bf16 v[64:67], a[84:87], a[132:135], v[64:67]
v_mfma_f32_16x16x32_bf16 v[72:75], a[84:87], a[140:143], v[72:75]
s_add_u32 m0, s80, 32768
s_add_u32 s64, s79, 0
v_mfma_f32_16x16x32_bf16 v[72:75], a[80:83], a[136:139], v[72:75]
ds_read_b64_tr_b16 a[164:165], v11 offset:57344
ds_read_b64_tr_b16 a[166:167], v11 offset:57856
v_mfma_f32_16x16x32_bf16 v[80:83], a[80:83], a[144:147], v[80:83]
buffer_load_dwordx4 v4, s[24:27], s64 offen sc1 lds
v_mfma_f32_16x16x32_bf16 v[80:83], a[84:87], a[148:151], v[80:83]
ds_read_b128 a[112:115], v9 offset:12288
v_mfma_f32_16x16x32_bf16 v[88:91], a[84:87], a[156:159], v[88:91]
v_cvt_pk_bf16_f32 v32, v32, v33
v_cvt_pk_bf16_f32 v33, v34, v35
v_mfma_f32_16x16x32_bf16 v[88:91], a[80:83], a[152:155], v[88:91]
v_cvt_pk_bf16_f32 v34, v36, v37
v_cvt_pk_bf16_f32 v35, v38, v39
v_mfma_f32_16x16x32_bf16 v[92:95], a[88:91], a[152:155], v[92:95]
ds_read_b64_tr_b16 a[168:169], v12 offset:49152
ds_read_b64_tr_b16 a[170:171], v12 offset:49664
v_mfma_f32_16x16x32_bf16 v[92:95], a[92:95], a[156:159], v[92:95]
v_cvt_pk_bf16_f32 v40, v40, v41
v_cvt_pk_bf16_f32 v41, v42, v43
v_mfma_f32_16x16x32_bf16 v[84:87], a[92:95], a[148:151], v[84:87]
s_add_u32 m0, s73, 4096
s_add_u32 s64, s72, 0
s_lshr_b32 s55, s3, 1
v_mfma_f32_16x16x32_bf16 v[84:87], a[88:91], a[144:147], v[84:87]
s_lshl_b32 s55, s55, 14
s_lshl_b32 s54, s3, 13
s_sub_u32 s55, s54, s55
v_mfma_f32_16x16x32_bf16 v[76:79], a[88:91], a[136:139], v[76:79]
buffer_load_dwordx4 v5, s[12:15], s64 offen lds
v_mfma_f32_16x16x32_bf16 v[76:79], a[92:95], a[140:143], v[76:79]
s_and_b32 s54, s3, 1
s_lshl_b32 s54, s54, 12
ds_read_b128 a[116:119], v10 offset:12288
v_mfma_f32_16x16x32_bf16 v[68:71], a[92:95], a[132:135], v[68:71]
s_add_u32 s53, s88, 0
v_cvt_pk_bf16_f32 v42, v44, v45
v_cvt_pk_bf16_f32 v43, v46, v47
v_mfma_f32_16x16x32_bf16 v[68:71], a[88:91], a[128:131], v[68:71]
s_waitcnt lgkmcnt(6)
ds_read_b64_tr_b16 a[172:173], v12 offset:57344
ds_read_b64_tr_b16 a[174:175], v12 offset:57856
v_mfma_f32_16x16x32_bf16 v[96:99], a[96:99], a[128:131], v[96:99]
buffer_store_dwordx4 v[32:35], v4, s[24:27], s53 offen offset:0 sc1
v_mfma_f32_16x16x32_bf16 v[96:99], a[100:103], a[132:135], v[96:99]
v_cvt_pk_bf16_f32 v48, v48, v49
v_cvt_pk_bf16_f32 v49, v50, v51
v_mfma_f32_16x16x32_bf16 v[104:107], a[100:103], a[140:143], v[104:107]
ds_read_b128 a[120:123], v9 offset:14336
v_cvt_pk_bf16_f32 v50, v52, v53
v_mfma_f32_16x16x32_bf16 v[104:107], a[96:99], a[136:139], v[104:107]
v_cvt_pk_bf16_f32 v51, v54, v55
v_cvt_pk_bf16_f32 v56, v56, v57
v_mfma_f32_16x16x32_bf16 v[112:115], a[96:99], a[144:147], v[112:115]
v_cvt_pk_bf16_f32 v57, v58, v59
v_cvt_pk_bf16_f32 v58, v60, v61
v_mfma_f32_16x16x32_bf16 v[112:115], a[100:103], a[148:151], v[112:115]
buffer_load_dwordx4 v6, s[12:15], s64 offen offset:1024 lds
v_mfma_f32_16x16x32_bf16 v[120:123], a[100:103], a[156:159], v[120:123]
ds_read_b64_tr_b16 a[176:177], v13 offset:49152
ds_read_b64_tr_b16 a[178:179], v13 offset:49664
v_mfma_f32_16x16x32_bf16 v[120:123], a[96:99], a[152:155], v[120:123]
v_cvt_pk_bf16_f32 v59, v62, v63
v_cvt_pk_bf16_f32 v64, v64, v65
v_mfma_f32_16x16x32_bf16 v[124:127], a[104:107], a[152:155], v[124:127]
v_cvt_pk_bf16_f32 v65, v66, v67
v_cvt_pk_bf16_f32 v66, v68, v69
v_mfma_f32_16x16x32_bf16 v[124:127], a[108:111], a[156:159], v[124:127]
ds_read_b128 a[124:127], v10 offset:14336
v_cvt_pk_bf16_f32 v67, v70, v71
v_mfma_f32_16x16x32_bf16 v[116:119], a[108:111], a[148:151], v[116:119]
v_add_u32 v9, 32768, v9
v_add_u32 v10, 32768, v10
v_mfma_f32_16x16x32_bf16 v[116:119], a[104:107], a[144:147], v[116:119]
s_add_u32 m0, s73, 6144
s_add_u32 s64, s72, 18432
v_cvt_pk_bf16_f32 v72, v72, v73
v_mfma_f32_16x16x32_bf16 v[108:111], a[104:107], a[136:139], v[108:111]
ds_read_b64_tr_b16 a[180:181], v13 offset:57344
ds_read_b64_tr_b16 a[182:183], v13 offset:57856
v_mfma_f32_16x16x32_bf16 v[108:111], a[108:111], a[140:143], v[108:111]
buffer_load_dwordx4 v5, s[12:15], s64 offen lds
v_mfma_f32_16x16x32_bf16 v[100:103], a[108:111], a[132:135], v[100:103]
v_cvt_pk_bf16_f32 v73, v74, v75
v_cvt_pk_bf16_f32 v74, v76, v77
v_mfma_f32_16x16x32_bf16 v[100:103], a[104:107], a[128:131], v[100:103]
s_waitcnt lgkmcnt(2)
ds_read_b64_tr_b16 a[184:185], v14 offset:49152
ds_read_b64_tr_b16 a[186:187], v14 offset:49664
v_mfma_f32_16x16x32_bf16 v[128:131], a[112:115], a[128:131], v[128:131]
v_cvt_pk_bf16_f32 v75, v78, v79
v_cvt_pk_bf16_f32 v80, v80, v81
v_mfma_f32_16x16x32_bf16 v[128:131], a[116:119], a[132:135], v[128:131]
v_cvt_pk_bf16_f32 v81, v82, v83
v_cvt_pk_bf16_f32 v82, v84, v85
v_mfma_f32_16x16x32_bf16 v[136:139], a[116:119], a[140:143], v[136:139]
ds_read_b64_tr_b16 a[188:189], v14 offset:57344
ds_read_b64_tr_b16 a[190:191], v14 offset:57856
v_mfma_f32_16x16x32_bf16 v[136:139], a[112:115], a[136:139], v[136:139]
v_add_u32 v9, s55, v9
v_add_u32 v10, s55, v10
v_mfma_f32_16x16x32_bf16 v[144:147], a[112:115], a[144:147], v[144:147]
v_subrev_u32 v11, s54, v11
v_subrev_u32 v12, s54, v12
v_mfma_f32_16x16x32_bf16 v[144:147], a[116:119], a[148:151], v[144:147]
buffer_load_dwordx4 v6, s[12:15], s64 offen offset:1024 lds
v_mfma_f32_16x16x32_bf16 v[152:155], a[116:119], a[156:159], v[152:155]
v_subrev_u32 v13, s54, v13
v_subrev_u32 v14, s54, v14
v_mfma_f32_16x16x32_bf16 v[152:155], a[112:115], a[152:155], v[152:155]
v_cvt_pk_bf16_f32 v83, v86, v87
v_cvt_pk_bf16_f32 v88, v88, v89
v_mfma_f32_16x16x32_bf16 v[156:159], a[120:123], a[152:155], v[156:159]
v_cvt_pk_bf16_f32 v89, v90, v91
v_cvt_pk_bf16_f32 v90, v92, v93
v_mfma_f32_16x16x32_bf16 v[156:159], a[124:127], a[156:159], v[156:159]
s_add_u32 s53, s88, 0
v_cvt_pk_bf16_f32 v91, v94, v95
v_cvt_pk_bf16_f32 v96, v96, v97
v_mfma_f32_16x16x32_bf16 v[148:151], a[124:127], a[148:151], v[148:151]
buffer_store_dwordx4 v[40:43], v4, s[24:27], s53 offen offset:1024 sc1
v_mfma_f32_16x16x32_bf16 v[148:151], a[120:123], a[144:147], v[148:151]
v_cvt_pk_bf16_f32 v97, v98, v99
v_cvt_pk_bf16_f32 v98, v100, v101
v_mfma_f32_16x16x32_bf16 v[140:143], a[120:123], a[136:139], v[140:143]
v_cvt_pk_bf16_f32 v99, v102, v103
v_cvt_pk_bf16_f32 v104, v104, v105
v_mfma_f32_16x16x32_bf16 v[140:143], a[124:127], a[140:143], v[140:143]
v_cvt_pk_bf16_f32 v105, v106, v107
v_cvt_pk_bf16_f32 v106, v108, v109
v_mfma_f32_16x16x32_bf16 v[132:135], a[124:127], a[132:135], v[132:135]
v_cvt_pk_bf16_f32 v107, v110, v111
v_cvt_pk_bf16_f32 v112, v112, v113
v_mfma_f32_16x16x32_bf16 v[132:135], a[120:123], a[128:131], v[132:135]
s_waitcnt lgkmcnt(0)
v_cvt_pk_bf16_f32 v113, v114, v115
v_cvt_pk_bf16_f32 v114, v116, v117
v_mfma_f32_16x16x32_bf16 v[160:163], a[160:163], a[64:67], v[160:163]
s_waitcnt vmcnt(16)
v_cvt_pk_bf16_f32 v115, v118, v119
v_cvt_pk_bf16_f32 v120, v120, v121
v_mfma_f32_16x16x32_bf16 v[160:163], a[164:167], a[68:71], v[160:163]
s_barrier
v_mfma_f32_16x16x32_bf16 v[164:167], a[172:175], a[68:71], v[164:167]
ds_read_b64_tr_b16 a[128:129], v11 offset:0
ds_read_b64_tr_b16 a[130:131], v11 offset:512
v_mfma_f32_16x16x32_bf16 v[164:167], a[168:171], a[64:67], v[164:167]
s_add_u32 m0, s77, 49152
s_add_u32 s64, s76, 128
v_cvt_pk_bf16_f32 v121, v122, v123
v_mfma_f32_16x16x32_bf16 v[168:171], a[176:179], a[64:67], v[168:171]
buffer_load_dwordx4 v7, s[20:23], s64 offen lds
v_mfma_f32_16x16x32_bf16 v[168:171], a[180:183], a[68:71], v[168:171]
ds_read_b64_tr_b16 a[132:133], v11 offset:4096
ds_read_b64_tr_b16 a[134:135], v11 offset:4608
v_mfma_f32_16x16x32_bf16 v[172:175], a[188:191], a[68:71], v[172:175]
v_cvt_pk_bf16_f32 v122, v124, v125
v_cvt_pk_bf16_f32 v123, v126, v127
v_mfma_f32_16x16x32_bf16 v[172:175], a[184:187], a[64:67], v[172:175]
v_cvt_pk_bf16_f32 v128, v128, v129
v_cvt_pk_bf16_f32 v129, v130, v131
v_mfma_f32_16x16x32_bf16 v[188:191], a[184:187], a[72:75], v[188:191]
ds_read_b64_tr_b16 a[136:137], v12 offset:0
ds_read_b64_tr_b16 a[138:139], v12 offset:512
v_mfma_f32_16x16x32_bf16 v[188:191], a[188:191], a[76:79], v[188:191]
v_cvt_pk_bf16_f32 v130, v132, v133
v_cvt_pk_bf16_f32 v131, v134, v135
v_mfma_f32_16x16x32_bf16 v[184:187], a[180:183], a[76:79], v[184:187]
v_cvt_pk_bf16_f32 v136, v136, v137
v_cvt_pk_bf16_f32 v137, v138, v139
v_mfma_f32_16x16x32_bf16 v[184:187], a[176:179], a[72:75], v[184:187]
ds_read_b64_tr_b16 a[140:141], v12 offset:4096
ds_read_b64_tr_b16 a[142:143], v12 offset:4608
v_mfma_f32_16x16x32_bf16 v[180:183], a[168:171], a[72:75], v[180:183]
buffer_load_dwordx4 v8, s[20:23], s64 offen offset:1024 lds
v_mfma_f32_16x16x32_bf16 v[180:183], a[172:175], a[76:79], v[180:183]
v_cvt_pk_bf16_f32 v138, v140, v141
v_cvt_pk_bf16_f32 v139, v142, v143
v_mfma_f32_16x16x32_bf16 v[176:179], a[164:167], a[76:79], v[176:179]
v_cvt_pk_bf16_f32 v144, v144, v145
v_cvt_pk_bf16_f32 v145, v146, v147
v_mfma_f32_16x16x32_bf16 v[176:179], a[160:163], a[72:75], v[176:179]
ds_read_b64_tr_b16 a[144:145], v13 offset:0
ds_read_b64_tr_b16 a[146:147], v13 offset:512
v_mfma_f32_16x16x32_bf16 v[192:195], a[160:163], a[80:83], v[192:195]
v_cvt_pk_bf16_f32 v146, v148, v149
v_cvt_pk_bf16_f32 v147, v150, v151
v_mfma_f32_16x16x32_bf16 v[192:195], a[164:167], a[84:87], v[192:195]
v_cvt_pk_bf16_f32 v152, v152, v153
v_cvt_pk_bf16_f32 v153, v154, v155
v_mfma_f32_16x16x32_bf16 v[196:199], a[172:175], a[84:87], v[196:199]
s_add_u32 m0, s80, 49152
s_add_u32 s64, s79, 2048
v_cvt_pk_bf16_f32 v154, v156, v157
v_mfma_f32_16x16x32_bf16 v[196:199], a[168:171], a[80:83], v[196:199]
ds_read_b64_tr_b16 a[148:149], v13 offset:4096
ds_read_b64_tr_b16 a[150:151], v13 offset:4608
v_mfma_f32_16x16x32_bf16 v[200:203], a[176:179], a[80:83], v[200:203]
buffer_load_dwordx4 v4, s[24:27], s64 offen sc1 lds
v_mfma_f32_16x16x32_bf16 v[200:203], a[180:183], a[84:87], v[200:203]
s_xor_b32 s65, s70, 128
s_add_u32 s71, s68, s65
s_add_u32 s72, s69, s65
v_mfma_f32_16x16x32_bf16 v[204:207], a[188:191], a[84:87], v[204:207]
s_add_u32 s53, s88, 0
ds_read_b64_tr_b16 a[152:153], v14 offset:0
ds_read_b64_tr_b16 a[154:155], v14 offset:512
v_mfma_f32_16x16x32_bf16 v[204:207], a[184:187], a[80:83], v[204:207]
buffer_store_dwordx4 v[48:51], v4, s[24:27], s53 offen offset:2048 sc1
v_mfma_f32_16x16x32_bf16 v[220:223], a[184:187], a[88:91], v[220:223]
ds_read_b64_tr_b16 a[156:157], v14 offset:4096
ds_read_b64_tr_b16 a[158:159], v14 offset:4608
v_mfma_f32_16x16x32_bf16 v[220:223], a[188:191], a[92:95], v[220:223]
v_cvt_pk_bf16_f32 v155, v158, v159
v_mul_f32 v160, s91, v160
v_mfma_f32_16x16x32_bf16 v[216:219], a[180:183], a[92:95], v[216:219]
s_add_u32 m0, s73, 32768
s_add_u32 s64, s71, 0
v_mul_f32 v161, s91, v161
v_mfma_f32_16x16x32_bf16 v[216:219], a[176:179], a[88:91], v[216:219]
v_mul_f32 v162, s91, v162
v_mul_f32 v163, s91, v163
v_mfma_f32_16x16x32_bf16 v[212:215], a[168:171], a[88:91], v[212:215]
buffer_load_dwordx4 v5, s[12:15], s64 offen lds
v_mfma_f32_16x16x32_bf16 v[212:215], a[172:175], a[92:95], v[212:215]
ds_read_b128 a[68:71], v4 offset:10240
v_mul_f32 v164, s91, v164
v_mfma_f32_16x16x32_bf16 v[208:211], a[164:167], a[92:95], v[208:211]
v_mul_f32 v165, s91, v165
v_mul_f32 v166, s91, v166
v_mfma_f32_16x16x32_bf16 v[208:211], a[160:163], a[88:91], v[208:211]
ds_read_b128 a[64:67], v4 offset:8192
v_mul_f32 v167, s91, v167
v_mfma_f32_16x16x32_bf16 v[224:227], a[160:163], a[96:99], v[224:227]
v_cvt_pk_bf16_f32 v160, v160, v161
v_cvt_pk_bf16_f32 v161, v162, v163
v_mfma_f32_16x16x32_bf16 v[224:227], a[164:167], a[100:103], v[224:227]
v_cvt_pk_bf16_f32 v162, v164, v165
v_cvt_pk_bf16_f32 v163, v166, v167
v_mfma_f32_16x16x32_bf16 v[228:231], a[172:175], a[100:103], v[228:231]
ds_read_b128 a[76:79], v4 offset:11264
v_mul_f32 v168, s91, v168
v_mfma_f32_16x16x32_bf16 v[228:231], a[168:171], a[96:99], v[228:231]
v_mul_f32 v169, s91, v169
v_mul_f32 v170, s91, v170
v_mfma_f32_16x16x32_bf16 v[232:235], a[176:179], a[96:99], v[232:235]
v_mul_f32 v171, s91, v171
v_mul_f32 v172, s91, v172
v_mfma_f32_16x16x32_bf16 v[232:235], a[180:183], a[100:103], v[232:235]
buffer_load_dwordx4 v6, s[12:15], s64 offen offset:1024 lds
v_mfma_f32_16x16x32_bf16 v[236:239], a[188:191], a[100:103], v[236:239]
ds_read_b128 a[72:75], v4 offset:9216
v_mul_f32 v173, s91, v173
v_mfma_f32_16x16x32_bf16 v[236:239], a[184:187], a[96:99], v[236:239]
v_mul_f32 v174, s91, v174
v_mul_f32 v175, s91, v175
v_mfma_f32_16x16x32_bf16 v[252:255], a[184:187], a[104:107], v[252:255]
v_cvt_pk_bf16_f32 v168, v168, v169
v_cvt_pk_bf16_f32 v169, v170, v171
v_mfma_f32_16x16x32_bf16 v[252:255], a[188:191], a[108:111], v[252:255]
ds_read_b128 a[84:87], v10 offset:0
v_cvt_pk_bf16_f32 v170, v172, v173
v_mfma_f32_16x16x32_bf16 v[248:251], a[180:183], a[108:111], v[248:251]
v_cvt_pk_bf16_f32 v171, v174, v175
v_mul_f32 v176, s91, v176
v_mfma_f32_16x16x32_bf16 v[248:251], a[176:179], a[104:107], v[248:251]
s_add_u32 m0, s73, 34816
s_add_u32 s64, s71, 18432
v_mul_f32 v177, s91, v177
v_mfma_f32_16x16x32_bf16 v[244:247], a[168:171], a[104:107], v[244:247]
ds_read_b128 a[80:83], v9 offset:0
v_mul_f32 v178, s91, v178
v_mfma_f32_16x16x32_bf16 v[244:247], a[172:175], a[108:111], v[244:247]
buffer_load_dwordx4 v5, s[12:15], s64 offen lds
v_mfma_f32_16x16x32_bf16 v[240:243], a[164:167], a[108:111], v[240:243]
v_mul_f32 v179, s91, v179
v_mul_f32 v180, s91, v180
v_mfma_f32_16x16x32_bf16 v[240:243], a[160:163], a[104:107], v[240:243]
s_add_u32 s53, s88, 0
ds_read_b128 a[92:95], v10 offset:2048
v_mul_f32 v181, s91, v181
v_mfma_f32_16x16x32_bf16 a[0:3], a[160:163], a[112:115], a[0:3]
buffer_store_dwordx4 v[56:59], v4, s[24:27], s53 offen offset:3072 sc1
v_mfma_f32_16x16x32_bf16 a[0:3], a[164:167], a[116:119], a[0:3]
v_mul_f32 v182, s91, v182
v_mul_f32 v183, s91, v183
v_mfma_f32_16x16x32_bf16 a[4:7], a[172:175], a[116:119], a[4:7]
ds_read_b128 a[88:91], v9 offset:2048
v_cvt_pk_bf16_f32 v176, v176, v177
v_mfma_f32_16x16x32_bf16 a[4:7], a[168:171], a[112:115], a[4:7]
v_cvt_pk_bf16_f32 v177, v178, v179
v_cvt_pk_bf16_f32 v178, v180, v181
v_mfma_f32_16x16x32_bf16 a[8:11], a[176:179], a[112:115], a[8:11]
v_cvt_pk_bf16_f32 v179, v182, v183
v_mul_f32 v184, s91, v184
v_mfma_f32_16x16x32_bf16 a[8:11], a[180:183], a[116:119], a[8:11]
buffer_load_dwordx4 v6, s[12:15], s64 offen offset:1024 lds
v_mfma_f32_16x16x32_bf16 a[12:15], a[188:191], a[116:119], a[12:15]
v_mul_f32 v185, s91, v185
v_mul_f32 v186, s91, v186
v_mfma_f32_16x16x32_bf16 a[12:15], a[184:187], a[112:115], a[12:15]
v_mul_f32 v187, s91, v187
v_mul_f32 v188, s91, v188
v_mfma_f32_16x16x32_bf16 a[28:31], a[184:187], a[120:123], a[28:31]
v_mul_f32 v189, s91, v189
v_mul_f32 v190, s91, v190
v_mfma_f32_16x16x32_bf16 a[28:31], a[188:191], a[124:127], a[28:31]
v_mul_f32 v191, s91, v191
v_cvt_pk_bf16_f32 v184, v184, v185
v_mfma_f32_16x16x32_bf16 a[24:27], a[180:183], a[124:127], a[24:27]
v_cvt_pk_bf16_f32 v185, v186, v187
v_cvt_pk_bf16_f32 v186, v188, v189
v_mfma_f32_16x16x32_bf16 a[24:27], a[176:179], a[120:123], a[24:27]
v_cvt_pk_bf16_f32 v187, v190, v191
v_mul_f32 v192, s91, v192
v_mfma_f32_16x16x32_bf16 a[20:23], a[168:171], a[120:123], a[20:23]
v_mul_f32 v193, s91, v193
v_mul_f32 v194, s91, v194
v_mfma_f32_16x16x32_bf16 a[20:23], a[172:175], a[124:127], a[20:23]
v_mul_f32 v195, s91, v195
v_mul_f32 v196, s91, v196
v_mfma_f32_16x16x32_bf16 a[16:19], a[164:167], a[124:127], a[16:19]
v_mul_f32 v197, s91, v197
v_mul_f32 v198, s91, v198
v_mfma_f32_16x16x32_bf16 a[16:19], a[160:163], a[120:123], a[16:19]
s_waitcnt lgkmcnt(0)
v_mul_f32 v199, s91, v199
v_cvt_pk_bf16_f32 v192, v192, v193
v_mfma_f32_16x16x32_bf16 v[36:39], a[128:131], a[80:83], 0
s_waitcnt vmcnt(22)
v_cvt_pk_bf16_f32 v193, v194, v195
v_cvt_pk_bf16_f32 v194, v196, v197
v_mfma_f32_16x16x32_bf16 v[36:39], a[132:135], a[84:87], v[36:39]
s_barrier
v_mfma_f32_16x16x32_bf16 v[44:47], a[140:143], a[84:87], 0
ds_read_b128 a[96:99], v9 offset:4096
v_cvt_pk_bf16_f32 v195, v198, v199
v_mfma_f32_16x16x32_bf16 v[44:47], a[136:139], a[80:83], v[44:47]
s_xor_b32 s75, s93, 1
s_lshl_b32 s76, s75, 19
s_add_u32 s76, s76, s74
v_mfma_f32_16x16x32_bf16 v[32:35], a[144:147], a[80:83], 0
s_lshl_b32 s79, s75, 13
s_add_u32 s79, s79, s78
ds_read_b128 a[100:103], v10 offset:4096
v_mfma_f32_16x16x32_bf16 v[32:35], a[148:151], a[84:87], v[32:35]
s_add_u32 m0, s77, 0
s_add_u32 s64, s76, 0
ds_read_b128 a[104:107], v9 offset:6144
v_mfma_f32_16x16x32_bf16 v[52:55], a[156:159], a[84:87], 0
buffer_load_dwordx4 v7, s[20:23], s64 offen lds
v_mfma_f32_16x16x32_bf16 v[52:55], a[152:155], a[80:83], v[52:55]
ds_read_b64_tr_b16 a[160:161], v11 offset:16384
ds_read_b64_tr_b16 a[162:163], v11 offset:16896
v_mfma_f32_16x16x32_bf16 v[60:63], a[64:67], a[80:83], 0
v_mul_f32 v200, s91, v200
v_mul_f32 v201, s91, v201
v_mfma_f32_16x16x32_bf16 v[60:63], a[68:71], a[84:87], v[60:63]
ds_read_b128 a[108:111], v10 offset:6144
v_mul_f32 v202, s91, v202
v_mfma_f32_16x16x32_bf16 v[68:71], a[76:79], a[84:87], 0
buffer_load_dwordx4 v8, s[20:23], s64 offen offset:1024 lds
v_mfma_f32_16x16x32_bf16 v[68:71], a[72:75], a[80:83], v[68:71]
s_add_u32 s53, s88, 262144
ds_read_b64_tr_b16 a[164:165], v11 offset:20480
ds_read_b64_tr_b16 a[166:167], v11 offset:20992
v_mfma_f32_16x16x32_bf16 v[76:79], a[72:75], a[88:91], 0
v_add_u32 v9, -65536, v9
v_add_u32 v10, -65536, v10
v_mfma_f32_16x16x32_bf16 v[76:79], a[76:79], a[92:95], v[76:79]
ds_read_b64_tr_b16 a[168:169], v12 offset:16384
ds_read_b64_tr_b16 a[170:171], v12 offset:16896
v_mfma_f32_16x16x32_bf16 v[84:87], a[68:71], a[92:95], 0
s_add_u32 m0, s80, 0
s_add_u32 s64, s79, 0
v_mul_f32 v203, s91, v203
v_mfma_f32_16x16x32_bf16 v[84:87], a[64:67], a[88:91], v[84:87]
ds_read_b64_tr_b16 a[172:173], v12 offset:20480
ds_read_b64_tr_b16 a[174:175], v12 offset:20992
v_mfma_f32_16x16x32_bf16 v[92:95], a[152:155], a[88:91], 0
buffer_load_dwordx4 v4, s[24:27], s64 offen sc1 lds
v_mfma_f32_16x16x32_bf16 v[92:95], a[156:159], a[92:95], v[92:95]
buffer_store_dwordx4 v[64:67], v4, s[24:27], s53 offen offset:0 sc1
v_mfma_f32_16x16x32_bf16 v[40:43], a[148:151], a[92:95], 0
ds_read_b64_tr_b16 a[176:177], v13 offset:16384
ds_read_b64_tr_b16 a[178:179], v13 offset:16896
v_mfma_f32_16x16x32_bf16 v[40:43], a[144:147], a[88:91], v[40:43]
v_mul_f32 v204, s91, v204
v_mul_f32 v205, s91, v205
v_mfma_f32_16x16x32_bf16 v[100:103], a[136:139], a[88:91], 0
s_add_u32 m0, s73, 36864
s_add_u32 s64, s72, 0
v_mul_f32 v206, s91, v206
v_mfma_f32_16x16x32_bf16 v[100:103], a[140:143], a[92:95], v[100:103]
ds_read_b64_tr_b16 a[180:181], v13 offset:20480
ds_read_b64_tr_b16 a[182:183], v13 offset:20992
v_mfma_f32_16x16x32_bf16 v[108:111], a[132:135], a[92:95], 0
buffer_load_dwordx4 v5, s[12:15], s64 offen lds
v_mfma_f32_16x16x32_bf16 v[108:111], a[128:131], a[88:91], v[108:111]
s_waitcnt lgkmcnt(14)
ds_read_b64_tr_b16 a[184:185], v14 offset:16384
ds_read_b64_tr_b16 a[186:187], v14 offset:16896
v_mfma_f32_16x16x32_bf16 v[116:119], a[128:131], a[96:99], 0
ds_read_b64_tr_b16 a[188:189], v14 offset:20480
ds_read_b64_tr_b16 a[190:191], v14 offset:20992
v_mfma_f32_16x16x32_bf16 v[116:119], a[132:135], a[100:103], v[116:119]
v_mul_f32 v207, s91, v207
v_cvt_pk_bf16_f32 v200, v200, v201
v_mfma_f32_16x16x32_bf16 v[124:127], a[140:143], a[100:103], 0
v_cvt_pk_bf16_f32 v201, v202, v203
v_cvt_pk_bf16_f32 v202, v204, v205
v_mfma_f32_16x16x32_bf16 v[124:127], a[136:139], a[96:99], v[124:127]
ds_read_b128 a[112:115], v4 offset:24576
v_cvt_pk_bf16_f32 v203, v206, v207
v_mfma_f32_16x16x32_bf16 v[132:135], a[144:147], a[96:99], 0
buffer_load_dwordx4 v6, s[12:15], s64 offen offset:1024 lds
v_mfma_f32_16x16x32_bf16 v[132:135], a[148:151], a[100:103], v[132:135]
ds_read_b128 a[116:119], v4 offset:26624
v_mul_f32 v208, s91, v208
v_mfma_f32_16x16x32_bf16 v[140:143], a[156:159], a[100:103], 0
v_mul_f32 v209, s91, v209
v_mul_f32 v210, s91, v210
v_mfma_f32_16x16x32_bf16 v[140:143], a[152:155], a[96:99], v[140:143]
ds_read_b128 a[120:123], v4 offset:25600
v_mul_f32 v211, s91, v211
v_mfma_f32_16x16x32_bf16 v[148:151], a[64:67], a[96:99], 0
s_add_u32 m0, s73, 38912
s_add_u32 s64, s72, 18432
v_mul_f32 v212, s91, v212
v_mfma_f32_16x16x32_bf16 v[148:151], a[68:71], a[100:103], v[148:151]
ds_read_b128 a[124:127], v4 offset:27648
v_mul_f32 v213, s91, v213
v_mfma_f32_16x16x32_bf16 v[48:51], a[76:79], a[100:103], 0
buffer_load_dwordx4 v5, s[12:15], s64 offen lds
v_mfma_f32_16x16x32_bf16 v[48:51], a[72:75], a[96:99], v[48:51]
s_waitcnt lgkmcnt(15)
v_mul_f32 v214, s91, v214
v_mul_f32 v215, s91, v215
v_mfma_f32_16x16x32_bf16 v[156:159], a[72:75], a[104:107], 0
v_cvt_pk_bf16_f32 v208, v208, v209
v_cvt_pk_bf16_f32 v209, v210, v211
v_mfma_f32_16x16x32_bf16 v[156:159], a[76:79], a[108:111], v[156:159]
s_add_u32 s53, s88, 262144
v_cvt_pk_bf16_f32 v210, v212, v213
v_cvt_pk_bf16_f32 v211, v214, v215
v_mfma_f32_16x16x32_bf16 v[164:167], a[68:71], a[108:111], 0
buffer_store_dwordx4 v[72:75], v4, s[24:27], s53 offen offset:1024 sc1
v_mfma_f32_16x16x32_bf16 v[164:167], a[64:67], a[104:107], v[164:167]
v_mul_f32 v216, s91, v216
v_mul_f32 v217, s91, v217
v_mfma_f32_16x16x32_bf16 v[172:175], a[152:155], a[104:107], 0
buffer_load_dwordx4 v6, s[12:15], s64 offen offset:1024 lds
v_mfma_f32_16x16x32_bf16 v[172:175], a[156:159], a[108:111], v[172:175]
v_mul_f32 v218, s91, v218
v_mul_f32 v219, s91, v219
v_mfma_f32_16x16x32_bf16 v[56:59], a[148:151], a[108:111], 0
v_mul_f32 v220, s91, v220
v_mul_f32 v221, s91, v221
v_mfma_f32_16x16x32_bf16 v[56:59], a[144:147], a[104:107], v[56:59]
v_mul_f32 v222, s91, v222
v_mul_f32 v223, s91, v223
v_mfma_f32_16x16x32_bf16 v[180:183], a[136:139], a[104:107], 0
v_cvt_pk_bf16_f32 v216, v216, v217
v_cvt_pk_bf16_f32 v217, v218, v219
v_mfma_f32_16x16x32_bf16 v[180:183], a[140:143], a[108:111], v[180:183]
v_cvt_pk_bf16_f32 v218, v220, v221
v_cvt_pk_bf16_f32 v219, v222, v223
v_mfma_f32_16x16x32_bf16 v[188:191], a[132:135], a[108:111], 0
v_mul_f32 v224, s91, v224
v_mul_f32 v225, s91, v225
v_mfma_f32_16x16x32_bf16 v[188:191], a[128:131], a[104:107], v[188:191]
s_waitcnt lgkmcnt(0)
v_mul_f32 v226, s91, v226
v_mul_f32 v227, s91, v227
v_mfma_f32_16x16x32_bf16 v[196:199], a[160:163], a[80:83], 0
s_waitcnt vmcnt(19)
v_mul_f32 v228, s91, v228
v_mul_f32 v229, s91, v229
v_mfma_f32_16x16x32_bf16 v[196:199], a[164:167], a[84:87], v[196:199]
s_barrier
v_mfma_f32_16x16x32_bf16 v[64:67], a[172:175], a[84:87], 0
ds_read_b64_tr_b16 a[128:129], v11 offset:32768
ds_read_b64_tr_b16 a[130:131], v11 offset:33280
v_mfma_f32_16x16x32_bf16 v[64:67], a[168:171], a[80:83], v[64:67]
s_add_u32 m0, s77, 16384
s_add_u32 s64, s76, 128
v_mul_f32 v230, s91, v230
v_mfma_f32_16x16x32_bf16 v[204:207], a[176:179], a[80:83], 0
buffer_load_dwordx4 v7, s[20:23], s64 offen lds
v_mfma_f32_16x16x32_bf16 v[204:207], a[180:183], a[84:87], v[204:207]
ds_read_b64_tr_b16 a[132:133], v11 offset:36864
ds_read_b64_tr_b16 a[134:135], v11 offset:37376
v_mfma_f32_16x16x32_bf16 v[212:215], a[188:191], a[84:87], 0
ds_read_b64_tr_b16 a[136:137], v12 offset:32768
ds_read_b64_tr_b16 a[138:139], v12 offset:33280
v_mfma_f32_16x16x32_bf16 v[212:215], a[184:187], a[80:83], v[212:215]
ds_read_b64_tr_b16 a[140:141], v12 offset:36864
ds_read_b64_tr_b16 a[142:143], v12 offset:37376
v_mfma_f32_16x16x32_bf16 v[72:75], a[112:115], a[80:83], 0
v_mul_f32 v231, s91, v231
v_cvt_pk_bf16_f32 v224, v224, v225
v_mfma_f32_16x16x32_bf16 v[72:75], a[116:119], a[84:87], v[72:75]
ds_read_b64_tr_b16 a[144:145], v13 offset:32768
ds_read_b64_tr_b16 a[146:147], v13 offset:33280
v_mfma_f32_16x16x32_bf16 v[220:223], a[124:127], a[84:87], 0
buffer_load_dwordx4 v8, s[20:23], s64 offen offset:1024 lds
v_mfma_f32_16x16x32_bf16 v[220:223], a[120:123], a[80:83], v[220:223]
ds_read_b64_tr_b16 a[148:149], v13 offset:36864
ds_read_b64_tr_b16 a[150:151], v13 offset:37376
v_mfma_f32_16x16x32_bf16 a[32:35], a[120:123], a[88:91], 0
v_cvt_pk_bf16_f32 v225, v226, v227
v_cvt_pk_bf16_f32 v226, v228, v229
v_mfma_f32_16x16x32_bf16 a[32:35], a[124:127], a[92:95], a[32:35]
ds_read_b64_tr_b16 a[152:153], v14 offset:32768
ds_read_b64_tr_b16 a[154:155], v14 offset:33280
v_mfma_f32_16x16x32_bf16 a[36:39], a[116:119], a[92:95], 0
s_add_u32 m0, s80, 16384
s_add_u32 s64, s79, 2048
v_cvt_pk_bf16_f32 v227, v230, v231
v_mfma_f32_16x16x32_bf16 a[36:39], a[112:115], a[88:91], a[36:39]
ds_read_b64_tr_b16 a[156:157], v14 offset:36864
ds_read_b64_tr_b16 a[158:159], v14 offset:37376
v_mfma_f32_16x16x32_bf16 v[228:231], a[184:187], a[88:91], 0
buffer_load_dwordx4 v4, s[24:27], s64 offen sc1 lds
v_mfma_f32_16x16x32_bf16 v[228:231], a[188:191], a[92:95], v[228:231]
s_xor_b32 s65, s70, 256
s_add_u32 s71, s68, s65
s_add_u32 s72, s69, s65
v_mfma_f32_16x16x32_bf16 a[40:43], a[180:183], a[92:95], 0
s_add_u32 s53, s88, 262144
ds_read_b128 a[64:67], v4 offset:40960
v_mul_f32 v232, s91, v232
v_mfma_f32_16x16x32_bf16 a[40:43], a[176:179], a[88:91], a[40:43]
buffer_store_dwordx4 v[80:83], v4, s[24:27], s53 offen offset:2048 sc1
v_mfma_f32_16x16x32_bf16 a[44:47], a[168:171], a[88:91], 0
s_add_u32 m0, s73, 65536
s_add_u32 s64, s71, 0
ds_read_b128 a[80:83], v9 offset:0
v_mfma_f32_16x16x32_bf16 a[44:47], a[172:175], a[92:95], a[44:47]
L_PAD4:
s_cbranch_execz L_PAD8
v_mul_f32 v233, s91, v233
v_mul_f32 v234, s91, v234
v_mfma_f32_16x16x32_bf16 v[80:83], a[164:167], a[92:95], 0
buffer_load_dwordx4 v5, s[12:15], s64 offen lds
v_mfma_f32_16x16x32_bf16 v[80:83], a[160:163], a[88:91], v[80:83]
ds_read_b128 a[68:71], v4 offset:43008
v_mul_f32 v235, s91, v235
v_mfma_f32_16x16x32_bf16 a[48:51], a[160:163], a[96:99], 0
ds_read_b128 a[84:87], v10 offset:0
v_mul_f32 v236, s91, v236
v_mfma_f32_16x16x32_bf16 a[48:51], a[164:167], a[100:103], a[48:51]
v_mul_f32 v237, s91, v237
v_mul_f32 v238, s91, v238
v_mfma_f32_16x16x32_bf16 a[52:55], a[172:175], a[100:103], 0
v_mul_f32 v239, s91, v239
v_cvt_pk_bf16_f32 v232, v232, v233
v_mfma_f32_16x16x32_bf16 a[52:55], a[168:171], a[96:99], a[52:55]
ds_read_b128 a[72:75], v4 offset:41984
v_cvt_pk_bf16_f32 v233, v234, v235
v_mfma_f32_16x16x32_bf16 a[56:59], a[176:179], a[96:99], 0
buffer_load_dwordx4 v6, s[12:15], s64 offen offset:1024 lds
v_mfma_f32_16x16x32_bf16 a[56:59], a[180:183], a[100:103], a[56:59]
ds_read_b128 a[88:91], v9 offset:2048
v_cvt_pk_bf16_f32 v234, v236, v237
v_mfma_f32_16x16x32_bf16 a[60:63], a[188:191], a[100:103], 0
v_cvt_pk_bf16_f32 v235, v238, v239
v_mul_f32 v240, s91, v240
v_mfma_f32_16x16x32_bf16 a[60:63], a[184:187], a[96:99], a[60:63]
ds_read_b128 a[76:79], v4 offset:44032
v_mul_f32 v241, s91, v241
v_mfma_f32_16x16x32_bf16 v[236:239], a[112:115], a[96:99], 0
s_add_u32 m0, s73, 67584
s_add_u32 s64, s71, 18432
v_mul_f32 v242, s91, v242
v_mfma_f32_16x16x32_bf16 v[236:239], a[116:119], a[100:103], v[236:239]
ds_read_b128 a[92:95], v10 offset:2048
v_mul_f32 v243, s91, v243
v_mfma_f32_16x16x32_bf16 a[192:195], a[124:127], a[100:103], 0
buffer_load_dwordx4 v5, s[12:15], s64 offen lds
v_mfma_f32_16x16x32_bf16 a[192:195], a[120:123], a[96:99], a[192:195]
v_mul_f32 v244, s91, v244
v_mul_f32 v245, s91, v245
v_mfma_f32_16x16x32_bf16 a[196:199], a[120:123], a[104:107], 0
v_mul_f32 v246, s91, v246
v_mul_f32 v247, s91, v247
v_mfma_f32_16x16x32_bf16 a[196:199], a[124:127], a[108:111], a[196:199]
v_cvt_pk_bf16_f32 v240, v240, v241
v_cvt_pk_bf16_f32 v241, v242, v243
v_mfma_f32_16x16x32_bf16 a[200:203], a[116:119], a[108:111], 0
v_cvt_pk_bf16_f32 v242, v244, v245
v_cvt_pk_bf16_f32 v243, v246, v247
v_mfma_f32_16x16x32_bf16 a[200:203], a[112:115], a[104:107], a[200:203]
v_mul_f32 v248, s91, v248
v_mul_f32 v249, s91, v249
v_mfma_f32_16x16x32_bf16 v[244:247], a[184:187], a[104:107], 0
buffer_load_dwordx4 v6, s[12:15], s64 offen offset:1024 lds
v_mfma_f32_16x16x32_bf16 v[244:247], a[188:191], a[108:111], v[244:247]
v_mul_f32 v250, s91, v250
v_mul_f32 v251, s91, v251
v_mfma_f32_16x16x32_bf16 a[204:207], a[180:183], a[108:111], 0
v_mul_f32 v252, s91, v252
v_mul_f32 v253, s91, v253
v_mfma_f32_16x16x32_bf16 a[204:207], a[176:179], a[104:107], a[204:207]
s_add_u32 s53, s88, 262144
v_mul_f32 v254, s91, v254
v_mul_f32 v255, s91, v255
v_mfma_f32_16x16x32_bf16 a[208:211], a[168:171], a[104:107], 0
buffer_store_dwordx4 v[88:91], v4, s[24:27], s53 offen offset:3072 sc1
v_mfma_f32_16x16x32_bf16 a[208:211], a[172:175], a[108:111], a[208:211]
v_cvt_pk_bf16_f32 v248, v248, v249
v_cvt_pk_bf16_f32 v249, v250, v251
v_mfma_f32_16x16x32_bf16 v[88:91], a[164:167], a[108:111], 0
v_cvt_pk_bf16_f32 v250, v252, v253
v_cvt_pk_bf16_f32 v251, v254, v255
v_mfma_f32_16x16x32_bf16 v[88:91], a[160:163], a[104:107], v[88:91]
s_waitcnt lgkmcnt(0)
v_accvgpr_read_b32 v16, a0
v_accvgpr_read_b32 v17, a1
v_mfma_f32_16x16x32_bf16 v[36:39], a[128:131], a[80:83], v[36:39]
s_waitcnt vmcnt(24)
v_accvgpr_read_b32 v18, a2
v_accvgpr_read_b32 v19, a3
v_mfma_f32_16x16x32_bf16 v[36:39], a[132:135], a[84:87], v[36:39]
s_barrier
v_mfma_f32_16x16x32_bf16 v[44:47], a[140:143], a[84:87], v[44:47]
ds_read_b128 a[96:99], v9 offset:4096
v_accvgpr_read_b32 v20, a4
v_mfma_f32_16x16x32_bf16 v[44:47], a[136:139], a[80:83], v[44:47]
s_xor_b32 s75, s93, 2
s_lshl_b32 s76, s75, 19
s_add_u32 s76, s76, s74
v_mfma_f32_16x16x32_bf16 v[32:35], a[144:147], a[80:83], v[32:35]
s_lshl_b32 s79, s75, 13
s_add_u32 s79, s79, s78
ds_read_b128 a[100:103], v10 offset:4096
v_mfma_f32_16x16x32_bf16 v[32:35], a[148:151], a[84:87], v[32:35]
s_add_u32 m0, s77, 32768
s_add_u32 s64, s76, 0
ds_read_b128 a[104:107], v9 offset:6144
v_mfma_f32_16x16x32_bf16 v[52:55], a[156:159], a[84:87], v[52:55]
buffer_load_dwordx4 v7, s[20:23], s64 offen lds
v_mfma_f32_16x16x32_bf16 v[52:55], a[152:155], a[80:83], v[52:55]
ds_read_b64_tr_b16 a[160:161], v11 offset:49152
ds_read_b64_tr_b16 a[162:163], v11 offset:49664
v_mfma_f32_16x16x32_bf16 v[60:63], a[64:67], a[80:83], v[60:63]
v_accvgpr_read_b32 v21, a5
v_accvgpr_read_b32 v22, a6
v_mfma_f32_16x16x32_bf16 v[60:63], a[68:71], a[84:87], v[60:63]
ds_read_b128 a[108:111], v10 offset:6144
v_accvgpr_read_b32 v23, a7
v_mfma_f32_16x16x32_bf16 v[68:71], a[76:79], a[84:87], v[68:71]
buffer_load_dwordx4 v8, s[20:23], s64 offen offset:1024 lds
v_mfma_f32_16x16x32_bf16 v[68:71], a[72:75], a[80:83], v[68:71]
ds_read_b64_tr_b16 a[164:165], v11 offset:53248
ds_read_b64_tr_b16 a[166:167], v11 offset:53760
v_mfma_f32_16x16x32_bf16 v[76:79], a[72:75], a[88:91], v[76:79]
v_add_u32 v9, 32768, v9
v_add_u32 v10, 32768, v10
v_mfma_f32_16x16x32_bf16 v[76:79], a[76:79], a[92:95], v[76:79]
ds_read_b64_tr_b16 a[168:169], v12 offset:49152
ds_read_b64_tr_b16 a[170:171], v12 offset:49664
v_mfma_f32_16x16x32_bf16 v[84:87], a[68:71], a[92:95], v[84:87]
s_add_u32 m0, s80, 32768
s_add_u32 s64, s79, 0
v_mul_f32 v16, s91, v16
v_mfma_f32_16x16x32_bf16 v[84:87], a[64:67], a[88:91], v[84:87]
ds_read_b64_tr_b16 a[172:173], v12 offset:53248
ds_read_b64_tr_b16 a[174:175], v12 offset:53760
v_mfma_f32_16x16x32_bf16 v[92:95], a[152:155], a[88:91], v[92:95]
buffer_load_dwordx4 v4, s[24:27], s64 offen sc1 lds
v_mfma_f32_16x16x32_bf16 v[92:95], a[156:159], a[92:95], v[92:95]
v_mul_f32 v17, s91, v17
v_mul_f32 v18, s91, v18
v_mfma_f32_16x16x32_bf16 v[40:43], a[148:151], a[92:95], v[40:43]
ds_read_b64_tr_b16 a[176:177], v13 offset:49152
ds_read_b64_tr_b16 a[178:179], v13 offset:49664
v_mfma_f32_16x16x32_bf16 v[40:43], a[144:147], a[88:91], v[40:43]
v_mul_f32 v19, s91, v19
v_mul_f32 v20, s91, v20
v_mfma_f32_16x16x32_bf16 v[100:103], a[136:139], a[88:91], v[100:103]
s_add_u32 m0, s73, 69632
s_add_u32 s64, s72, 0
v_mul_f32 v21, s91, v21
v_mfma_f32_16x16x32_bf16 v[100:103], a[140:143], a[92:95], v[100:103]
ds_read_b64_tr_b16 a[180:181], v13 offset:53248
ds_read_b64_tr_b16 a[182:183], v13 offset:53760
v_mfma_f32_16x16x32_bf16 v[108:111], a[132:135], a[92:95], v[108:111]
buffer_load_dwordx4 v5, s[12:15], s64 offen lds
v_mfma_f32_16x16x32_bf16 v[108:111], a[128:131], a[88:91], v[108:111]
s_waitcnt lgkmcnt(14)
ds_read_b64_tr_b16 a[184:185], v14 offset:49152
ds_read_b64_tr_b16 a[186:187], v14 offset:49664
v_mfma_f32_16x16x32_bf16 v[116:119], a[128:131], a[96:99], v[116:119]
s_add_u32 s53, s87, 0
ds_read_b64_tr_b16 a[188:189], v14 offset:53248
ds_read_b64_tr_b16 a[190:191], v14 offset:53760
v_mfma_f32_16x16x32_bf16 v[116:119], a[132:135], a[100:103], v[116:119]
buffer_store_dwordx4 v[160:163], v4, s[24:27], s53 offen offset:0 sc1
v_mfma_f32_16x16x32_bf16 v[124:127], a[140:143], a[100:103], v[124:127]
v_mul_f32 v22, s91, v22
v_mul_f32 v23, s91, v23
v_mfma_f32_16x16x32_bf16 v[124:127], a[136:139], a[96:99], v[124:127]
ds_read_b128 a[112:115], v4 offset:57344
v_cvt_pk_bf16_f32 v16, v16, v17
v_mfma_f32_16x16x32_bf16 v[132:135], a[144:147], a[96:99], v[132:135]
buffer_load_dwordx4 v6, s[12:15], s64 offen offset:1024 lds
v_mfma_f32_16x16x32_bf16 v[132:135], a[148:151], a[100:103], v[132:135]
ds_read_b128 a[116:119], v4 offset:59392
v_cvt_pk_bf16_f32 v17, v18, v19
v_mfma_f32_16x16x32_bf16 v[140:143], a[156:159], a[100:103], v[140:143]
v_cvt_pk_bf16_f32 v18, v20, v21
v_cvt_pk_bf16_f32 v19, v22, v23
v_mfma_f32_16x16x32_bf16 v[140:143], a[152:155], a[96:99], v[140:143]
ds_read_b128 a[120:123], v4 offset:58368
v_accvgpr_write_b32 a0, v16
v_mfma_f32_16x16x32_bf16 v[148:151], a[64:67], a[96:99], v[148:151]
s_add_u32 m0, s73, 71680
s_add_u32 s64, s72, 18432
v_accvgpr_write_b32 a1, v17
v_mfma_f32_16x16x32_bf16 v[148:151], a[68:71], a[100:103], v[148:151]
ds_read_b128 a[124:127], v4 offset:60416
v_accvgpr_write_b32 a2, v18
v_mfma_f32_16x16x32_bf16 v[48:51], a[76:79], a[100:103], v[48:51]
buffer_load_dwordx4 v5, s[12:15], s64 offen lds
v_mfma_f32_16x16x32_bf16 v[48:51], a[72:75], a[96:99], v[48:51]
s_waitcnt lgkmcnt(15)
v_accvgpr_write_b32 a3, v19
v_accvgpr_read_b32 v16, a8
v_mfma_f32_16x16x32_bf16 v[156:159], a[72:75], a[104:107], v[156:159]
v_accvgpr_read_b32 v17, a9
v_accvgpr_read_b32 v18, a10
v_mfma_f32_16x16x32_bf16 v[156:159], a[76:79], a[108:111], v[156:159]
v_accvgpr_read_b32 v19, a11
v_accvgpr_read_b32 v20, a12
v_mfma_f32_16x16x32_bf16 v[164:167], a[68:71], a[108:111], v[164:167]
v_accvgpr_read_b32 v21, a13
v_accvgpr_read_b32 v22, a14
v_mfma_f32_16x16x32_bf16 v[164:167], a[64:67], a[104:107], v[164:167]
v_accvgpr_read_b32 v23, a15
v_mul_f32 v16, s91, v16
v_mfma_f32_16x16x32_bf16 v[172:175], a[152:155], a[104:107], v[172:175]
buffer_load_dwordx4 v6, s[12:15], s64 offen offset:1024 lds
v_mfma_f32_16x16x32_bf16 v[172:175], a[156:159], a[108:111], v[172:175]
v_mul_f32 v17, s91, v17
v_mul_f32 v18, s91, v18
v_mfma_f32_16x16x32_bf16 v[56:59], a[148:151], a[108:111], v[56:59]
v_mul_f32 v19, s91, v19
v_mul_f32 v20, s91, v20
v_mfma_f32_16x16x32_bf16 v[56:59], a[144:147], a[104:107], v[56:59]
v_mul_f32 v21, s91, v21
v_mul_f32 v22, s91, v22
v_mfma_f32_16x16x32_bf16 v[180:183], a[136:139], a[104:107], v[180:183]
v_mul_f32 v23, s91, v23
v_cvt_pk_bf16_f32 v16, v16, v17
v_mfma_f32_16x16x32_bf16 v[180:183], a[140:143], a[108:111], v[180:183]
v_cvt_pk_bf16_f32 v17, v18, v19
v_cvt_pk_bf16_f32 v18, v20, v21
v_mfma_f32_16x16x32_bf16 v[188:191], a[132:135], a[108:111], v[188:191]
v_cvt_pk_bf16_f32 v19, v22, v23
v_accvgpr_write_b32 a8, v16
v_mfma_f32_16x16x32_bf16 v[188:191], a[128:131], a[104:107], v[188:191]
s_waitcnt lgkmcnt(0)
v_accvgpr_write_b32 a9, v17
v_accvgpr_write_b32 a10, v18
v_mfma_f32_16x16x32_bf16 v[196:199], a[160:163], a[80:83], v[196:199]
s_waitcnt vmcnt(17)
v_accvgpr_write_b32 a11, v19
v_accvgpr_read_b32 v16, a16
v_mfma_f32_16x16x32_bf16 v[196:199], a[164:167], a[84:87], v[196:199]
s_barrier
v_mfma_f32_16x16x32_bf16 v[64:67], a[172:175], a[84:87], v[64:67]
s_add_u32 s53, s87, 0
ds_read_b64_tr_b16 a[128:129], v11 offset:0
ds_read_b64_tr_b16 a[130:131], v11 offset:512
v_mfma_f32_16x16x32_bf16 v[64:67], a[168:171], a[80:83], v[64:67]
s_add_u32 m0, s77, 49152
s_add_u32 s64, s76, 128
v_accvgpr_read_b32 v17, a17
v_mfma_f32_16x16x32_bf16 v[204:207], a[176:179], a[80:83], v[204:207]
buffer_load_dwordx4 v7, s[20:23], s64 offen lds
v_mfma_f32_16x16x32_bf16 v[204:207], a[180:183], a[84:87], v[204:207]
ds_read_b64_tr_b16 a[132:133], v11 offset:4096
ds_read_b64_tr_b16 a[134:135], v11 offset:4608
v_mfma_f32_16x16x32_bf16 v[212:215], a[188:191], a[84:87], v[212:215]
ds_read_b64_tr_b16 a[136:137], v12 offset:0
ds_read_b64_tr_b16 a[138:139], v12 offset:512
v_mfma_f32_16x16x32_bf16 v[212:215], a[184:187], a[80:83], v[212:215]
ds_read_b64_tr_b16 a[140:141], v12 offset:4096
ds_read_b64_tr_b16 a[142:143], v12 offset:4608
v_mfma_f32_16x16x32_bf16 v[72:75], a[112:115], a[80:83], v[72:75]
buffer_store_dwordx4 v[168:171], v4, s[24:27], s53 offen offset:1024 sc1
v_mfma_f32_16x16x32_bf16 v[72:75], a[116:119], a[84:87], v[72:75]
ds_read_b64_tr_b16 a[144:145], v13 offset:0
ds_read_b64_tr_b16 a[146:147], v13 offset:512
v_mfma_f32_16x16x32_bf16 v[220:223], a[124:127], a[84:87], v[220:223]
buffer_load_dwordx4 v8, s[20:23], s64 offen offset:1024 lds
v_mfma_f32_16x16x32_bf16 v[220:223], a[120:123], a[80:83], v[220:223]
ds_read_b64_tr_b16 a[148:149], v13 offset:4096
ds_read_b64_tr_b16 a[150:151], v13 offset:4608
v_mfma_f32_16x16x32_bf16 a[32:35], a[120:123], a[88:91], a[32:35]
v_accvgpr_read_b32 v18, a18
v_accvgpr_read_b32 v19, a19
v_mfma_f32_16x16x32_bf16 a[32:35], a[124:127], a[92:95], a[32:35]
ds_read_b64_tr_b16 a[152:153], v14 offset:0
ds_read_b64_tr_b16 a[154:155], v14 offset:512
v_mfma_f32_16x16x32_bf16 a[36:39], a[116:119], a[92:95], a[36:39]
s_add_u32 m0, s80, 49152
s_add_u32 s64, s79, 2048
v_accvgpr_read_b32 v20, a20
v_mfma_f32_16x16x32_bf16 a[36:39], a[112:115], a[88:91], a[36:39]
ds_read_b64_tr_b16 a[156:157], v14 offset:4096
ds_read_b64_tr_b16 a[158:159], v14 offset:4608
v_mfma_f32_16x16x32_bf16 v[228:231], a[184:187], a[88:91], v[228:231]
buffer_load_dwordx4 v4, s[24:27], s64 offen sc1 lds
v_mfma_f32_16x16x32_bf16 v[228:231], a[188:191], a[92:95], v[228:231]
s_xor_b32 s65, s70, 384
s_add_u32 s71, s68, s65
s_add_u32 s72, s69, s65
v_mfma_f32_16x16x32_bf16 a[40:43], a[180:183], a[92:95], a[40:43]
ds_read_b128 a[64:67], v4 offset:8192
v_accvgpr_read_b32 v21, a21
v_mfma_f32_16x16x32_bf16 a[40:43], a[176:179], a[88:91], a[40:43]
v_accvgpr_read_b32 v22, a22
v_accvgpr_read_b32 v23, a23
v_mfma_f32_16x16x32_bf16 a[44:47], a[168:171], a[88:91], a[44:47]
s_add_u32 m0, s73, 0
s_add_u32 s64, s71, 0
ds_read_b128 a[80:83], v9 offset:0
v_mfma_f32_16x16x32_bf16 a[44:47], a[172:175], a[92:95], a[44:47]
v_mul_f32 v16, s91, v16
v_mul_f32 v17, s91, v17
v_mfma_f32_16x16x32_bf16 v[80:83], a[164:167], a[92:95], v[80:83]
buffer_load_dwordx4 v5, s[12:15], s64 offen lds
v_mfma_f32_16x16x32_bf16 v[80:83], a[160:163], a[88:91], v[80:83]
ds_read_b128 a[68:71], v4 offset:10240
v_mul_f32 v18, s91, v18
v_mfma_f32_16x16x32_bf16 a[48:51], a[160:163], a[96:99], a[48:51]
ds_read_b128 a[84:87], v10 offset:0
v_mul_f32 v19, s91, v19
v_mfma_f32_16x16x32_bf16 a[48:51], a[164:167], a[100:103], a[48:51]
v_mul_f32 v20, s91, v20
v_mul_f32 v21, s91, v21
v_mfma_f32_16x16x32_bf16 a[52:55], a[172:175], a[100:103], a[52:55]
v_mul_f32 v22, s91, v22
v_mul_f32 v23, s91, v23
v_mfma_f32_16x16x32_bf16 a[52:55], a[168:171], a[96:99], a[52:55]
ds_read_b128 a[72:75], v4 offset:9216
v_cvt_pk_bf16_f32 v16, v16, v17
v_mfma_f32_16x16x32_bf16 a[56:59], a[176:179], a[96:99], a[56:59]
buffer_load_dwordx4 v6, s[12:15], s64 offen offset:1024 lds
v_mfma_f32_16x16x32_bf16 a[56:59], a[180:183], a[100:103], a[56:59]
s_add_u32 s53, s87, 4096
ds_read_b128 a[88:91], v9 offset:2048
v_cvt_pk_bf16_f32 v17, v18, v19
v_mfma_f32_16x16x32_bf16 a[60:63], a[188:191], a[100:103], a[60:63]
buffer_store_dwordx4 v[176:179], v4, s[24:27], s53 offen offset:0 sc1
v_mfma_f32_16x16x32_bf16 a[60:63], a[184:187], a[96:99], a[60:63]
ds_read_b128 a[76:79], v4 offset:11264
v_cvt_pk_bf16_f32 v18, v20, v21
v_mfma_f32_16x16x32_bf16 v[236:239], a[112:115], a[96:99], v[236:239]
s_add_u32 m0, s73, 2048
s_add_u32 s64, s71, 18432
v_cvt_pk_bf16_f32 v19, v22, v23
v_mfma_f32_16x16x32_bf16 v[236:239], a[116:119], a[100:103], v[236:239]
ds_read_b128 a[92:95], v10 offset:2048
v_accvgpr_write_b32 a16, v16
v_mfma_f32_16x16x32_bf16 a[192:195], a[124:127], a[100:103], a[192:195]
buffer_load_dwordx4 v5, s[12:15], s64 offen lds
v_mfma_f32_16x16x32_bf16 a[192:195], a[120:123], a[96:99], a[192:195]
v_accvgpr_write_b32 a17, v17
v_accvgpr_write_b32 a18, v18
v_mfma_f32_16x16x32_bf16 a[196:199], a[120:123], a[104:107], a[196:199]
v_accvgpr_write_b32 a19, v19
v_accvgpr_read_b32 v16, a24
v_mfma_f32_16x16x32_bf16 a[196:199], a[124:127], a[108:111], a[196:199]
v_accvgpr_read_b32 v17, a25
v_accvgpr_read_b32 v18, a26
v_mfma_f32_16x16x32_bf16 a[200:203], a[116:119], a[108:111], a[200:203]
v_accvgpr_read_b32 v19, a27
v_accvgpr_read_b32 v20, a28
v_mfma_f32_16x16x32_bf16 a[200:203], a[112:115], a[104:107], a[200:203]
v_accvgpr_read_b32 v21, a29
v_accvgpr_read_b32 v22, a30
v_mfma_f32_16x16x32_bf16 v[244:247], a[184:187], a[104:107], v[244:247]
buffer_load_dwordx4 v6, s[12:15], s64 offen offset:1024 lds
v_mfma_f32_16x16x32_bf16 v[244:247], a[188:191], a[108:111], v[244:247]
v_accvgpr_read_b32 v23, a31
v_mul_f32 v16, s91, v16
v_mfma_f32_16x16x32_bf16 a[204:207], a[180:183], a[108:111], a[204:207]
v_mul_f32 v17, s91, v17
v_mul_f32 v18, s91, v18
v_mfma_f32_16x16x32_bf16 a[204:207], a[176:179], a[104:107], a[204:207]
v_mul_f32 v19, s91, v19
v_mul_f32 v20, s91, v20
v_mfma_f32_16x16x32_bf16 a[208:211], a[168:171], a[104:107], a[208:211]
v_mul_f32 v21, s91, v21
v_mul_f32 v22, s91, v22
v_mfma_f32_16x16x32_bf16 a[208:211], a[172:175], a[108:111], a[208:211]
v_mul_f32 v23, s91, v23
v_cvt_pk_bf16_f32 v16, v16, v17
v_mfma_f32_16x16x32_bf16 v[88:91], a[164:167], a[108:111], v[88:91]
v_cvt_pk_bf16_f32 v17, v18, v19
v_cvt_pk_bf16_f32 v18, v20, v21
v_mfma_f32_16x16x32_bf16 v[88:91], a[160:163], a[104:107], v[88:91]
s_waitcnt lgkmcnt(0)
v_cvt_pk_bf16_f32 v19, v22, v23
v_accvgpr_write_b32 a24, v16
v_mfma_f32_16x16x32_bf16 v[36:39], a[128:131], a[80:83], v[36:39]
s_waitcnt vmcnt(23)
v_accvgpr_write_b32 a25, v17
v_accvgpr_write_b32 a26, v18
v_mfma_f32_16x16x32_bf16 v[36:39], a[132:135], a[84:87], v[36:39]
s_barrier
v_mfma_f32_16x16x32_bf16 v[44:47], a[140:143], a[84:87], v[44:47]
ds_read_b128 a[96:99], v9 offset:4096
v_accvgpr_write_b32 a27, v19
v_mfma_f32_16x16x32_bf16 v[44:47], a[136:139], a[80:83], v[44:47]
s_xor_b32 s75, s93, 3
s_lshl_b32 s76, s75, 19
s_add_u32 s76, s76, s74
v_mfma_f32_16x16x32_bf16 v[32:35], a[144:147], a[80:83], v[32:35]
s_lshl_b32 s79, s75, 13
s_add_u32 s79, s79, s78
ds_read_b128 a[100:103], v10 offset:4096
v_mfma_f32_16x16x32_bf16 v[32:35], a[148:151], a[84:87], v[32:35]
s_add_u32 m0, s77, 0
s_add_u32 s64, s76, 0
ds_read_b128 a[104:107], v9 offset:6144
v_mfma_f32_16x16x32_bf16 v[52:55], a[156:159], a[84:87], v[52:55]
buffer_load_dwordx4 v7, s[20:23], s64 offen lds
v_mfma_f32_16x16x32_bf16 v[52:55], a[152:155], a[80:83], v[52:55]
s_add_u32 s53, s87, 4096
ds_read_b64_tr_b16 a[160:161], v11 offset:16384
ds_read_b64_tr_b16 a[162:163], v11 offset:16896
v_mfma_f32_16x16x32_bf16 v[60:63], a[64:67], a[80:83], v[60:63]
buffer_store_dwordx4 v[184:187], v4, s[24:27], s53 offen offset:1024 sc1
v_mfma_f32_16x16x32_bf16 v[60:63], a[68:71], a[84:87], v[60:63]
ds_read_b128 a[108:111], v10 offset:6144
v_accvgpr_write_b32 a4, v248
v_mfma_f32_16x16x32_bf16 v[68:71], a[76:79], a[84:87], v[68:71]
buffer_load_dwordx4 v8, s[20:23], s64 offen offset:1024 lds
v_mfma_f32_16x16x32_bf16 v[68:71], a[72:75], a[80:83], v[68:71]
ds_read_b64_tr_b16 a[164:165], v11 offset:20480
ds_read_b64_tr_b16 a[166:167], v11 offset:20992
v_mfma_f32_16x16x32_bf16 v[76:79], a[72:75], a[88:91], v[76:79]
v_add_u32 v9, 32768, v9
v_add_u32 v10, 32768, v10
v_mfma_f32_16x16x32_bf16 v[76:79], a[76:79], a[92:95], v[76:79]
ds_read_b64_tr_b16 a[168:169], v12 offset:16384
ds_read_b64_tr_b16 a[170:171], v12 offset:16896
v_mfma_f32_16x16x32_bf16 v[84:87], a[68:71], a[92:95], v[84:87]
s_add_u32 m0, s80, 0
s_add_u32 s64, s79, 0
v_accvgpr_write_b32 a5, v249
v_mfma_f32_16x16x32_bf16 v[84:87], a[64:67], a[88:91], v[84:87]
ds_read_b64_tr_b16 a[172:173], v12 offset:20480
ds_read_b64_tr_b16 a[174:175], v12 offset:20992
v_mfma_f32_16x16x32_bf16 v[92:95], a[152:155], a[88:91], v[92:95]
buffer_load_dwordx4 v4, s[24:27], s64 offen sc1 lds
v_mfma_f32_16x16x32_bf16 v[92:95], a[156:159], a[92:95], v[92:95]
v_accvgpr_write_b32 a6, v250
v_accvgpr_write_b32 a7, v251
v_mfma_f32_16x16x32_bf16 v[40:43], a[148:151], a[92:95], v[40:43]
ds_read_b64_tr_b16 a[176:177], v13 offset:16384
ds_read_b64_tr_b16 a[178:179], v13 offset:16896
v_mfma_f32_16x16x32_bf16 v[40:43], a[144:147], a[88:91], v[40:43]
v_accvgpr_write_b32 a12, v240
v_accvgpr_write_b32 a13, v241
v_mfma_f32_16x16x32_bf16 v[100:103], a[136:139], a[88:91], v[100:103]
s_add_u32 m0, s73, 4096
s_add_u32 s64, s72, 0
v_accvgpr_write_b32 a14, v242
v_mfma_f32_16x16x32_bf16 v[100:103], a[140:143], a[92:95], v[100:103]
ds_read_b64_tr_b16 a[180:181], v13 offset:20480
ds_read_b64_tr_b16 a[182:183], v13 offset:20992
v_mfma_f32_16x16x32_bf16 v[108:111], a[132:135], a[92:95], v[108:111]
buffer_load_dwordx4 v5, s[12:15], s64 offen lds
v_mfma_f32_16x16x32_bf16 v[108:111], a[128:131], a[88:91], v[108:111]
s_waitcnt lgkmcnt(14)
ds_read_b64_tr_b16 a[184:185], v14 offset:16384
ds_read_b64_tr_b16 a[186:187], v14 offset:16896
v_mfma_f32_16x16x32_bf16 v[116:119], a[128:131], a[96:99], v[116:119]
ds_read_b64_tr_b16 a[188:189], v14 offset:20480
ds_read_b64_tr_b16 a[190:191], v14 offset:20992
v_mfma_f32_16x16x32_bf16 v[116:119], a[132:135], a[100:103], v[116:119]
v_accvgpr_write_b32 a15, v243
v_accvgpr_write_b32 a20, v232
v_mfma_f32_16x16x32_bf16 v[124:127], a[140:143], a[100:103], v[124:127]
v_accvgpr_write_b32 a21, v233
v_accvgpr_write_b32 a22, v234
v_mfma_f32_16x16x32_bf16 v[124:127], a[136:139], a[96:99], v[124:127]
ds_read_b128 a[112:115], v4 offset:24576
v_accvgpr_write_b32 a23, v235
v_mfma_f32_16x16x32_bf16 v[132:135], a[144:147], a[96:99], v[132:135]
buffer_load_dwordx4 v6, s[12:15], s64 offen offset:1024 lds
v_mfma_f32_16x16x32_bf16 v[132:135], a[148:151], a[100:103], v[132:135]
ds_read_b128 a[116:119], v4 offset:26624
v_accvgpr_write_b32 a28, v224
v_mfma_f32_16x16x32_bf16 v[140:143], a[156:159], a[100:103], v[140:143]
v_accvgpr_write_b32 a29, v225
v_accvgpr_write_b32 a30, v226
v_mfma_f32_16x16x32_bf16 v[140:143], a[152:155], a[96:99], v[140:143]
ds_read_b128 a[120:123], v4 offset:25600
v_accvgpr_write_b32 a31, v227
v_mfma_f32_16x16x32_bf16 v[148:151], a[64:67], a[96:99], v[148:151]
s_add_u32 m0, s73, 6144
s_add_u32 s64, s72, 18432
v_accvgpr_read_b32 v252, a32
v_mfma_f32_16x16x32_bf16 v[148:151], a[68:71], a[100:103], v[148:151]
ds_read_b128 a[124:127], v4 offset:27648
v_accvgpr_read_b32 v253, a33
v_mfma_f32_16x16x32_bf16 v[48:51], a[76:79], a[100:103], v[48:51]
buffer_load_dwordx4 v5, s[12:15], s64 offen lds
v_mfma_f32_16x16x32_bf16 v[48:51], a[72:75], a[96:99], v[48:51]
s_waitcnt lgkmcnt(15)
s_add_u32 s53, s87, 262144
v_accvgpr_read_b32 v254, a34
v_mfma_f32_16x16x32_bf16 v[156:159], a[72:75], a[104:107], v[156:159]
buffer_store_dwordx4 v[192:195], v4, s[24:27], s53 offen offset:0 sc1
v_mfma_f32_16x16x32_bf16 v[156:159], a[76:79], a[108:111], v[156:159]
v_accvgpr_read_b32 v255, a35
v_accvgpr_read_b32 v160, a36
v_mfma_f32_16x16x32_bf16 v[164:167], a[68:71], a[108:111], v[164:167]
v_accvgpr_read_b32 v161, a37
v_accvgpr_read_b32 v162, a38
v_mfma_f32_16x16x32_bf16 v[164:167], a[64:67], a[104:107], v[164:167]
v_accvgpr_read_b32 v163, a39
v_accvgpr_read_b32 v168, a40
v_mfma_f32_16x16x32_bf16 v[172:175], a[152:155], a[104:107], v[172:175]
buffer_load_dwordx4 v6, s[12:15], s64 offen offset:1024 lds
v_mfma_f32_16x16x32_bf16 v[172:175], a[156:159], a[108:111], v[172:175]
v_accvgpr_read_b32 v169, a41
v_accvgpr_read_b32 v170, a42
v_mfma_f32_16x16x32_bf16 v[56:59], a[148:151], a[108:111], v[56:59]
v_accvgpr_read_b32 v171, a43
v_accvgpr_read_b32 v176, a44
v_mfma_f32_16x16x32_bf16 v[56:59], a[144:147], a[104:107], v[56:59]
v_accvgpr_read_b32 v177, a45
v_accvgpr_read_b32 v178, a46
v_mfma_f32_16x16x32_bf16 v[180:183], a[136:139], a[104:107], v[180:183]
v_accvgpr_read_b32 v179, a47
v_accvgpr_read_b32 v184, a48
v_mfma_f32_16x16x32_bf16 v[180:183], a[140:143], a[108:111], v[180:183]
v_accvgpr_read_b32 v185, a49
v_accvgpr_read_b32 v186, a50
v_mfma_f32_16x16x32_bf16 v[188:191], a[132:135], a[108:111], v[188:191]
v_accvgpr_read_b32 v187, a51
v_accvgpr_read_b32 v248, a52
v_mfma_f32_16x16x32_bf16 v[188:191], a[128:131], a[104:107], v[188:191]
s_waitcnt lgkmcnt(0)
v_accvgpr_read_b32 v249, a53
v_accvgpr_read_b32 v250, a54
v_mfma_f32_16x16x32_bf16 v[196:199], a[160:163], a[80:83], v[196:199]
s_waitcnt vmcnt(18)
v_accvgpr_read_b32 v251, a55
v_accvgpr_read_b32 v240, a56
v_mfma_f32_16x16x32_bf16 v[196:199], a[164:167], a[84:87], v[196:199]
s_barrier
v_mfma_f32_16x16x32_bf16 v[64:67], a[172:175], a[84:87], v[64:67]
ds_read_b64_tr_b16 a[128:129], v11 offset:32768
ds_read_b64_tr_b16 a[130:131], v11 offset:33280
v_mfma_f32_16x16x32_bf16 v[64:67], a[168:171], a[80:83], v[64:67]
s_add_u32 m0, s77, 16384
s_add_u32 s64, s76, 128
v_accvgpr_read_b32 v241, a57
v_mfma_f32_16x16x32_bf16 v[204:207], a[176:179], a[80:83], v[204:207]
buffer_load_dwordx4 v7, s[20:23], s64 offen lds
v_mfma_f32_16x16x32_bf16 v[204:207], a[180:183], a[84:87], v[204:207]
ds_read_b64_tr_b16 a[132:133], v11 offset:36864
ds_read_b64_tr_b16 a[134:135], v11 offset:37376
v_mfma_f32_16x16x32_bf16 v[212:215], a[188:191], a[84:87], v[212:215]
ds_read_b64_tr_b16 a[136:137], v12 offset:32768
ds_read_b64_tr_b16 a[138:139], v12 offset:33280
v_mfma_f32_16x16x32_bf16 v[212:215], a[184:187], a[80:83], v[212:215]
ds_read_b64_tr_b16 a[140:141], v12 offset:36864
ds_read_b64_tr_b16 a[142:143], v12 offset:37376
v_mfma_f32_16x16x32_bf16 v[72:75], a[112:115], a[80:83], v[72:75]
v_accvgpr_read_b32 v242, a58
v_accvgpr_read_b32 v243, a59
v_mfma_f32_16x16x32_bf16 v[72:75], a[116:119], a[84:87], v[72:75]
ds_read_b64_tr_b16 a[144:145], v13 offset:32768
ds_read_b64_tr_b16 a[146:147], v13 offset:33280
v_mfma_f32_16x16x32_bf16 v[220:223], a[124:127], a[84:87], v[220:223]
buffer_load_dwordx4 v8, s[20:23], s64 offen offset:1024 lds
v_mfma_f32_16x16x32_bf16 v[220:223], a[120:123], a[80:83], v[220:223]
ds_read_b64_tr_b16 a[148:149], v13 offset:36864
ds_read_b64_tr_b16 a[150:151], v13 offset:37376
v_mfma_f32_16x16x32_bf16 v[252:255], a[120:123], a[88:91], v[252:255]
v_accvgpr_read_b32 v232, a60
v_accvgpr_read_b32 v233, a61
v_mfma_f32_16x16x32_bf16 v[252:255], a[124:127], a[92:95], v[252:255]
s_add_u32 s53, s87, 262144
ds_read_b64_tr_b16 a[152:153], v14 offset:32768
ds_read_b64_tr_b16 a[154:155], v14 offset:33280
v_mfma_f32_16x16x32_bf16 v[160:163], a[116:119], a[92:95], v[160:163]
s_add_u32 m0, s80, 16384
s_add_u32 s64, s79, 2048
v_accvgpr_read_b32 v234, a62
v_mfma_f32_16x16x32_bf16 v[160:163], a[112:115], a[88:91], v[160:163]
L_PAD5:
s_cbranch_execz L_PAD9
ds_read_b64_tr_b16 a[156:157], v14 offset:36864
ds_read_b64_tr_b16 a[158:159], v14 offset:37376
v_mfma_f32_16x16x32_bf16 v[228:231], a[184:187], a[88:91], v[228:231]
buffer_load_dwordx4 v4, s[24:27], s64 offen sc1 lds
v_mfma_f32_16x16x32_bf16 v[228:231], a[188:191], a[92:95], v[228:231]
s_xor_b32 s65, s70, 512
s_add_u32 s71, s68, s65
s_add_u32 s72, s69, s65
v_mfma_f32_16x16x32_bf16 v[168:171], a[180:183], a[92:95], v[168:171]
ds_read_b128 a[64:67], v4 offset:40960
v_accvgpr_read_b32 v235, a63
v_mfma_f32_16x16x32_bf16 v[168:171], a[176:179], a[88:91], v[168:171]
buffer_store_dwordx4 v[200:203], v4, s[24:27], s53 offen offset:1024 sc1
v_mfma_f32_16x16x32_bf16 v[176:179], a[168:171], a[88:91], v[176:179]
s_add_u32 m0, s73, 32768
s_add_u32 s64, s71, 0
ds_read_b128 a[80:83], v9 offset:0
v_mfma_f32_16x16x32_bf16 v[176:179], a[172:175], a[92:95], v[176:179]
v_accvgpr_read_b32 v224, a192
v_accvgpr_read_b32 v225, a193
v_mfma_f32_16x16x32_bf16 v[80:83], a[164:167], a[92:95], v[80:83]
buffer_load_dwordx4 v5, s[12:15], s64 offen lds
v_mfma_f32_16x16x32_bf16 v[80:83], a[160:163], a[88:91], v[80:83]
ds_read_b128 a[68:71], v4 offset:43008
v_accvgpr_read_b32 v226, a194
v_mfma_f32_16x16x32_bf16 v[184:187], a[160:163], a[96:99], v[184:187]
ds_read_b128 a[84:87], v10 offset:0
v_accvgpr_read_b32 v227, a195
v_mfma_f32_16x16x32_bf16 v[184:187], a[164:167], a[100:103], v[184:187]
v_accvgpr_read_b32 v192, a204
v_accvgpr_read_b32 v193, a205
v_mfma_f32_16x16x32_bf16 v[248:251], a[172:175], a[100:103], v[248:251]
v_accvgpr_read_b32 v194, a206
v_accvgpr_read_b32 v195, a207
v_mfma_f32_16x16x32_bf16 v[248:251], a[168:171], a[96:99], v[248:251]
ds_read_b128 a[72:75], v4 offset:41984
v_accvgpr_read_b32 v200, a208
v_mfma_f32_16x16x32_bf16 v[240:243], a[176:179], a[96:99], v[240:243]
buffer_load_dwordx4 v6, s[12:15], s64 offen offset:1024 lds
v_mfma_f32_16x16x32_bf16 v[240:243], a[180:183], a[100:103], v[240:243]
ds_read_b128 a[88:91], v9 offset:2048
v_accvgpr_read_b32 v201, a209
v_mfma_f32_16x16x32_bf16 v[232:235], a[188:191], a[100:103], v[232:235]
v_accvgpr_read_b32 v202, a210
v_accvgpr_read_b32 v203, a211
v_mfma_f32_16x16x32_bf16 v[232:235], a[184:187], a[96:99], v[232:235]
ds_read_b128 a[76:79], v4 offset:44032
v_and_b32 v28, 31, v1
v_mfma_f32_16x16x32_bf16 v[236:239], a[112:115], a[96:99], v[236:239]
s_add_u32 m0, s73, 34816
s_add_u32 s64, s71, 18432
v_lshlrev_b32 v28, 2, v28
v_mfma_f32_16x16x32_bf16 v[236:239], a[116:119], a[100:103], v[236:239]
ds_read_b128 a[92:95], v10 offset:2048
v_mfma_f32_16x16x32_bf16 v[224:227], a[124:127], a[100:103], v[224:227]
buffer_load_dwordx4 v5, s[12:15], s64 offen lds
v_mfma_f32_16x16x32_bf16 v[224:227], a[120:123], a[96:99], v[224:227]
buffer_load_dword v30, v28, s[40:43], 0 offen sc1
v_mfma_f32_16x16x32_bf16 a[196:199], a[120:123], a[104:107], a[196:199]
v_mfma_f32_16x16x32_bf16 a[196:199], a[124:127], a[108:111], a[196:199]
v_mfma_f32_16x16x32_bf16 a[200:203], a[116:119], a[108:111], a[200:203]
v_mfma_f32_16x16x32_bf16 a[200:203], a[112:115], a[104:107], a[200:203]
v_mfma_f32_16x16x32_bf16 v[244:247], a[184:187], a[104:107], v[244:247]
buffer_load_dwordx4 v6, s[12:15], s64 offen offset:1024 lds
v_mfma_f32_16x16x32_bf16 v[244:247], a[188:191], a[108:111], v[244:247]
s_add_u32 s53, s87, 266240
v_mfma_f32_16x16x32_bf16 v[192:195], a[180:183], a[108:111], v[192:195]
buffer_store_dwordx4 v[208:211], v4, s[24:27], s53 offen offset:0 sc1
v_mfma_f32_16x16x32_bf16 v[192:195], a[176:179], a[104:107], v[192:195]
v_mfma_f32_16x16x32_bf16 v[200:203], a[168:171], a[104:107], v[200:203]
v_mfma_f32_16x16x32_bf16 v[200:203], a[172:175], a[108:111], v[200:203]
v_accvgpr_read_b32 v208, a196
v_accvgpr_read_b32 v209, a197
v_mfma_f32_16x16x32_bf16 v[88:91], a[164:167], a[108:111], v[88:91]
v_accvgpr_read_b32 v210, a198
v_accvgpr_read_b32 v211, a199
v_mfma_f32_16x16x32_bf16 v[88:91], a[160:163], a[104:107], v[88:91]
s_waitcnt lgkmcnt(0)
v_mfma_f32_16x16x32_bf16 v[36:39], a[128:131], a[80:83], v[36:39]
s_waitcnt vmcnt(24)
v_mfma_f32_16x16x32_bf16 v[36:39], a[132:135], a[84:87], v[36:39]
s_barrier
v_mfma_f32_16x16x32_bf16 v[44:47], a[140:143], a[84:87], v[44:47]
ds_read_b128 a[96:99], v9 offset:4096
v_mfma_f32_16x16x32_bf16 v[44:47], a[136:139], a[80:83], v[44:47]
s_xor_b32 s75, s93, 4
s_lshl_b32 s76, s75, 19
s_add_u32 s76, s76, s74
v_mfma_f32_16x16x32_bf16 v[32:35], a[144:147], a[80:83], v[32:35]
s_lshl_b32 s79, s75, 13
s_add_u32 s79, s79, s78
ds_read_b128 a[100:103], v10 offset:4096
v_mfma_f32_16x16x32_bf16 v[32:35], a[148:151], a[84:87], v[32:35]
s_add_u32 m0, s77, 32768
s_add_u32 s64, s76, 0
ds_read_b128 a[104:107], v9 offset:6144
v_mfma_f32_16x16x32_bf16 v[52:55], a[156:159], a[84:87], v[52:55]
buffer_load_dwordx4 v7, s[20:23], s64 offen lds
v_mfma_f32_16x16x32_bf16 v[52:55], a[152:155], a[80:83], v[52:55]
ds_read_b64_tr_b16 a[160:161], v11 offset:49152
ds_read_b64_tr_b16 a[162:163], v11 offset:49664
v_mfma_f32_16x16x32_bf16 v[60:63], a[64:67], a[80:83], v[60:63]
v_mfma_f32_16x16x32_bf16 v[60:63], a[68:71], a[84:87], v[60:63]
ds_read_b128 a[108:111], v10 offset:6144
v_mfma_f32_16x16x32_bf16 v[68:71], a[76:79], a[84:87], v[68:71]
buffer_load_dwordx4 v8, s[20:23], s64 offen offset:1024 lds
v_mfma_f32_16x16x32_bf16 v[68:71], a[72:75], a[80:83], v[68:71]
ds_read_b64_tr_b16 a[164:165], v11 offset:53248
ds_read_b64_tr_b16 a[166:167], v11 offset:53760
v_mfma_f32_16x16x32_bf16 v[76:79], a[72:75], a[88:91], v[76:79]
v_add_u32 v9, -65536, v9
v_add_u32 v10, -65536, v10
v_mfma_f32_16x16x32_bf16 v[76:79], a[76:79], a[92:95], v[76:79]
ds_read_b64_tr_b16 a[168:169], v12 offset:49152
ds_read_b64_tr_b16 a[170:171], v12 offset:49664
v_mfma_f32_16x16x32_bf16 v[84:87], a[68:71], a[92:95], v[84:87]
s_add_u32 m0, s80, 32768
s_add_u32 s64, s79, 0
v_mfma_f32_16x16x32_bf16 v[84:87], a[64:67], a[88:91], v[84:87]
ds_read_b64_tr_b16 a[172:173], v12 offset:53248
ds_read_b64_tr_b16 a[174:175], v12 offset:53760
v_mfma_f32_16x16x32_bf16 v[92:95], a[152:155], a[88:91], v[92:95]
buffer_load_dwordx4 v4, s[24:27], s64 offen sc1 lds
v_mfma_f32_16x16x32_bf16 v[92:95], a[156:159], a[92:95], v[92:95]
v_mfma_f32_16x16x32_bf16 v[40:43], a[148:151], a[92:95], v[40:43]
ds_read_b64_tr_b16 a[176:177], v13 offset:49152
ds_read_b64_tr_b16 a[178:179], v13 offset:49664
v_mfma_f32_16x16x32_bf16 v[40:43], a[144:147], a[88:91], v[40:43]
s_add_u32 s53, s87, 266240
v_mfma_f32_16x16x32_bf16 v[100:103], a[136:139], a[88:91], v[100:103]
s_add_u32 m0, s73, 36864
s_add_u32 s64, s72, 0
v_mfma_f32_16x16x32_bf16 v[100:103], a[140:143], a[92:95], v[100:103]
ds_read_b64_tr_b16 a[180:181], v13 offset:53248
ds_read_b64_tr_b16 a[182:183], v13 offset:53760
v_mfma_f32_16x16x32_bf16 v[108:111], a[132:135], a[92:95], v[108:111]
buffer_load_dwordx4 v5, s[12:15], s64 offen lds
v_mfma_f32_16x16x32_bf16 v[108:111], a[128:131], a[88:91], v[108:111]
s_waitcnt lgkmcnt(14)
ds_read_b64_tr_b16 a[184:185], v14 offset:49152
ds_read_b64_tr_b16 a[186:187], v14 offset:49664
v_mfma_f32_16x16x32_bf16 v[116:119], a[128:131], a[96:99], v[116:119]
s_waitcnt vmcnt(6)
ds_read_b64_tr_b16 a[188:189], v14 offset:53248
ds_read_b64_tr_b16 a[190:191], v14 offset:53760
v_mfma_f32_16x16x32_bf16 v[116:119], a[132:135], a[100:103], v[116:119]
buffer_store_dwordx4 v[216:219], v4, s[24:27], s53 offen offset:1024 sc1
v_mfma_f32_16x16x32_bf16 v[124:127], a[140:143], a[100:103], v[124:127]
v_cmp_gt_u32 vcc, 1, v30
v_mfma_f32_16x16x32_bf16 v[124:127], a[136:139], a[96:99], v[124:127]
ds_read_b128 a[112:115], v4 offset:57344
v_accvgpr_read_b32 v216, a200
v_mfma_f32_16x16x32_bf16 v[132:135], a[144:147], a[96:99], v[132:135]
buffer_load_dwordx4 v6, s[12:15], s64 offen offset:1024 lds
v_mfma_f32_16x16x32_bf16 v[132:135], a[148:151], a[100:103], v[132:135]
ds_read_b128 a[116:119], v4 offset:59392
v_accvgpr_read_b32 v217, a201
v_mfma_f32_16x16x32_bf16 v[140:143], a[156:159], a[100:103], v[140:143]
v_accvgpr_read_b32 v218, a202
v_accvgpr_read_b32 v219, a203
v_mfma_f32_16x16x32_bf16 v[140:143], a[152:155], a[96:99], v[140:143]
s_lshr_b32 s84, s7, 1
s_and_b32 s85, s7, 1
ds_read_b128 a[120:123], v4 offset:58368
v_mfma_f32_16x16x32_bf16 v[148:151], a[64:67], a[96:99], v[148:151]
s_add_u32 m0, s73, 38912
s_add_u32 s64, s72, 18432
s_xor_b32 s52, s5, 0
v_mfma_f32_16x16x32_bf16 v[148:151], a[68:71], a[100:103], v[148:151]
s_lshl1_add_u32 s85, s52, s85
s_and_b32 s86, s6, 3
ds_read_b128 a[124:127], v4 offset:60416
v_mfma_f32_16x16x32_bf16 v[48:51], a[76:79], a[100:103], v[48:51]
buffer_load_dwordx4 v5, s[12:15], s64 offen lds
v_mfma_f32_16x16x32_bf16 v[48:51], a[72:75], a[96:99], v[48:51]
s_waitcnt lgkmcnt(15)
s_lshl_b32 s83, s3, 13
s_add_u32 s83, s83, 131072
v_mfma_f32_16x16x32_bf16 v[156:159], a[72:75], a[104:107], v[156:159]
s_cbranch_vccnz CK_ZA
CK_ZA_R:
v_mfma_f32_16x16x32_bf16 v[156:159], a[76:79], a[108:111], v[156:159]
s_mul_i32 s52, s2, 5462
s_lshr_b32 s52, s52, 16
s_mul_i32 s54, s52, 12
v_mfma_f32_16x16x32_bf16 v[164:167], a[68:71], a[108:111], v[164:167]
s_sub_u32 s54, s2, s54
s_mul_i32 s54, s54, 3
s_add_u32 s54, s54, s3
v_mfma_f32_16x16x32_bf16 v[164:167], a[64:67], a[104:107], v[164:167]
s_mul_i32 s55, s52, 13108
s_lshr_b32 s55, s55, 16
s_mul_i32 s82, s55, 5
v_mfma_f32_16x16x32_bf16 v[172:175], a[152:155], a[104:107], v[172:175]
buffer_load_dwordx4 v6, s[12:15], s64 offen offset:1024 lds
v_mfma_f32_16x16x32_bf16 v[172:175], a[156:159], a[108:111], v[172:175]
s_sub_u32 s52, s52, s82
v_mfma_f32_16x16x32_bf16 v[56:59], a[148:151], a[108:111], v[56:59]
v_lshrrev_b32 v16, 1, v1
v_and_b32 v17, 1, v1
v_mfma_f32_16x16x32_bf16 v[56:59], a[144:147], a[104:107], v[56:59]
v_mul_u32_u24 v18, 1152, v16
v_lshl_add_u32 v18, v17, 4, v18
v_mfma_f32_16x16x32_bf16 v[180:183], a[136:139], a[104:107], v[180:183]
v_mov_b32 v24, v18
v_lshrrev_b32 v18, 4, v16
v_mfma_f32_16x16x32_bf16 v[180:183], a[140:143], a[108:111], v[180:183]
v_bfe_u32 v19, v16, 2, 2
v_and_b32 v16, 3, v16
v_mfma_f32_16x16x32_bf16 v[188:191], a[132:135], a[108:111], v[188:191]
s_add_u32 s53, s88, 524288
v_lshrrev_b32 v20, 1, v19
v_mul_u32_u24 v20, 18, v20
v_mfma_f32_16x16x32_bf16 v[188:191], a[128:131], a[104:107], v[188:191]
s_waitcnt lgkmcnt(0)
v_and_b32 v21, 1, v19
v_lshl_add_u32 v20, v21, 1, v20
v_mfma_f32_16x16x32_bf16 v[196:199], a[160:163], a[80:83], v[196:199]
s_waitcnt vmcnt(18)
v_lshl_add_u32 v20, v16, 2, v20
v_add_u32 v20, v20, v18
v_mfma_f32_16x16x32_bf16 v[196:199], a[164:167], a[84:87], v[196:199]
s_barrier
v_mfma_f32_16x16x32_bf16 v[64:67], a[172:175], a[84:87], v[64:67]
ds_read_b64_tr_b16 a[128:129], v11 offset:0
ds_read_b64_tr_b16 a[130:131], v11 offset:512
v_mfma_f32_16x16x32_bf16 v[64:67], a[168:171], a[80:83], v[64:67]
s_add_u32 m0, s77, 49152
s_add_u32 s64, s76, 128
v_mad_u32_u24 v20, s52, 36, v20
v_mfma_f32_16x16x32_bf16 v[204:207], a[176:179], a[80:83], v[204:207]
buffer_load_dwordx4 v7, s[20:23], s64 offen lds
v_mfma_f32_16x16x32_bf16 v[204:207], a[180:183], a[84:87], v[204:207]
ds_read_b64_tr_b16 a[132:133], v11 offset:4096
ds_read_b64_tr_b16 a[134:135], v11 offset:4608
v_mfma_f32_16x16x32_bf16 v[212:215], a[188:191], a[84:87], v[212:215]
ds_read_b64_tr_b16 a[136:137], v12 offset:0
ds_read_b64_tr_b16 a[138:139], v12 offset:512
v_mfma_f32_16x16x32_bf16 v[212:215], a[184:187], a[80:83], v[212:215]
ds_read_b64_tr_b16 a[140:141], v12 offset:4096
ds_read_b64_tr_b16 a[142:143], v12 offset:4608
v_mfma_f32_16x16x32_bf16 v[72:75], a[112:115], a[80:83], v[72:75]
buffer_store_dwordx4 v[96:99], v4, s[24:27], s53 offen offset:0 sc1
v_mfma_f32_16x16x32_bf16 v[72:75], a[116:119], a[84:87], v[72:75]
ds_read_b64_tr_b16 a[144:145], v13 offset:0
ds_read_b64_tr_b16 a[146:147], v13 offset:512
v_mfma_f32_16x16x32_bf16 v[220:223], a[124:127], a[84:87], v[220:223]
buffer_load_dwordx4 v8, s[20:23], s64 offen offset:1024 lds
v_mfma_f32_16x16x32_bf16 v[220:223], a[120:123], a[80:83], v[220:223]
ds_read_b64_tr_b16 a[148:149], v13 offset:4096
ds_read_b64_tr_b16 a[150:151], v13 offset:4608
v_mfma_f32_16x16x32_bf16 v[252:255], a[120:123], a[88:91], v[252:255]
v_lshlrev_b32 v21, 1, v18
v_lshl_add_u32 v21, v19, 2, v21
v_mfma_f32_16x16x32_bf16 v[252:255], a[124:127], a[92:95], v[252:255]
ds_read_b64_tr_b16 a[152:153], v14 offset:0
ds_read_b64_tr_b16 a[154:155], v14 offset:512
v_mfma_f32_16x16x32_bf16 v[160:163], a[116:119], a[92:95], v[160:163]
s_add_u32 m0, s80, 49152
s_add_u32 s64, s79, 2048
v_lshrrev_b32 v22, 1, v16
v_mfma_f32_16x16x32_bf16 v[160:163], a[112:115], a[88:91], v[160:163]
ds_read_b64_tr_b16 a[156:157], v14 offset:4096
ds_read_b64_tr_b16 a[158:159], v14 offset:4608
v_mfma_f32_16x16x32_bf16 v[228:231], a[184:187], a[88:91], v[228:231]
buffer_load_dwordx4 v4, s[24:27], s64 offen sc1 lds
v_mfma_f32_16x16x32_bf16 v[228:231], a[188:191], a[92:95], v[228:231]
s_xor_b32 s65, s70, 640
s_add_u32 s71, s68, s65
s_add_u32 s72, s69, s65
v_mfma_f32_16x16x32_bf16 v[168:171], a[180:183], a[92:95], v[168:171]
ds_read_b128 a[64:67], v4 offset:8192
v_add_u32 v21, v21, v22
v_mfma_f32_16x16x32_bf16 v[168:171], a[176:179], a[88:91], v[168:171]
v_mul_u32_u24 v21, 18, v21
v_and_b32 v22, 1, v16
v_mfma_f32_16x16x32_bf16 v[176:179], a[168:171], a[88:91], v[176:179]
s_add_u32 m0, s73, 65536
s_add_u32 s64, s71, 0
ds_read_b128 a[80:83], v9 offset:0
v_mfma_f32_16x16x32_bf16 v[176:179], a[172:175], a[92:95], v[176:179]
v_add3_u32 v21, v21, v22, 16
v_cmp_lt_u32 s[96:97], 1, v19
v_mfma_f32_16x16x32_bf16 v[80:83], a[164:167], a[92:95], v[80:83]
buffer_load_dwordx4 v5, s[12:15], s64 offen lds
v_mfma_f32_16x16x32_bf16 v[80:83], a[160:163], a[88:91], v[80:83]
ds_read_b128 a[68:71], v4 offset:10240
v_mov_b32 v22, 0x100000
v_mfma_f32_16x16x32_bf16 v[184:187], a[160:163], a[96:99], v[184:187]
ds_read_b128 a[84:87], v10 offset:0
v_mul_u32_u24 v23, 1, v23
v_mfma_f32_16x16x32_bf16 v[184:187], a[164:167], a[100:103], v[184:187]
s_add_u32 s53, s88, 524288
v_cndmask_b32 v21, v21, v22, s[96:97]
v_mov_b32 v22, s52
v_mfma_f32_16x16x32_bf16 v[248:251], a[172:175], a[100:103], v[248:251]
buffer_store_dwordx4 v[104:107], v4, s[24:27], s53 offen offset:1024 sc1
v_mfma_f32_16x16x32_bf16 v[248:251], a[168:171], a[96:99], v[248:251]
ds_read_b128 a[72:75], v4 offset:9216
v_cmp_eq_u32 s[96:97], 4, v22
v_mfma_f32_16x16x32_bf16 v[240:243], a[176:179], a[96:99], v[240:243]
buffer_load_dwordx4 v6, s[12:15], s64 offen offset:1024 lds
v_mfma_f32_16x16x32_bf16 v[240:243], a[180:183], a[100:103], v[240:243]
ds_read_b128 a[88:91], v9 offset:2048
v_cndmask_b32 v20, v20, v21, s[96:97]
v_mfma_f32_16x16x32_bf16 v[232:235], a[188:191], a[100:103], v[232:235]
v_mul_u32_u24 v20, 1152, v20
v_lshl_add_u32 v20, v17, 4, v20
v_mfma_f32_16x16x32_bf16 v[232:235], a[184:187], a[96:99], v[232:235]
ds_read_b128 a[76:79], v4 offset:11264
v_mov_b32 v25, v20
v_mfma_f32_16x16x32_bf16 v[236:239], a[112:115], a[96:99], v[236:239]
s_add_u32 m0, s73, 67584
s_add_u32 s64, s71, 18432
v_mov_b32 v16, s54
v_mfma_f32_16x16x32_bf16 v[236:239], a[116:119], a[100:103], v[236:239]
ds_read_b128 a[92:95], v10 offset:2048
v_mov_b32 v17, s55
v_mfma_f32_16x16x32_bf16 v[224:227], a[124:127], a[100:103], v[224:227]
buffer_load_dwordx4 v5, s[12:15], s64 offen lds
v_mfma_f32_16x16x32_bf16 v[224:227], a[120:123], a[96:99], v[224:227]
v_add_u32 v18, 32, v22
v_mfma_f32_16x16x32_bf16 v[208:211], a[120:123], a[104:107], v[208:211]
s_mul_i32 s82, s55, 165888
s_lshl_b32 s54, s54, 5
s_add_u32 s82, s82, s54
v_mfma_f32_16x16x32_bf16 v[208:211], a[124:127], a[108:111], v[208:211]
s_and_b32 s52, s2, 1
s_lshr_b32 s54, s3, 1
s_lshl1_add_u32 s52, s52, s54
v_mfma_f32_16x16x32_bf16 v[216:219], a[116:119], a[108:111], v[216:219]
s_mul_i32 s52, s52, 9
s_and_b32 s54, s3, 1
s_mul_i32 s55, s54, 5
v_mfma_f32_16x16x32_bf16 v[216:219], a[112:115], a[104:107], v[216:219]
s_add_u32 s52, s52, s55
s_lshr_b32 s55, s2, 1
s_mul_i32 s81, s55, 1152
v_mfma_f32_16x16x32_bf16 v[244:247], a[184:187], a[104:107], v[244:247]
buffer_load_dwordx4 v6, s[12:15], s64 offen offset:1024 lds
v_mfma_f32_16x16x32_bf16 v[244:247], a[188:191], a[108:111], v[244:247]
s_add_u32 s81, s81, s52
s_lshl_b32 s81, s81, 5
v_mfma_f32_16x16x32_bf16 v[192:195], a[180:183], a[108:111], v[192:195]
v_cmp_gt_u32 s[96:97], 5, v1
v_add_u32 v19, s52, v1
v_mfma_f32_16x16x32_bf16 v[192:195], a[176:179], a[104:107], v[192:195]
v_lshrrev_b32 v20, 5, s55
v_and_b32 v21, 31, s55
v_mfma_f32_16x16x32_bf16 v[200:203], a[168:171], a[104:107], v[200:203]
v_cndmask_b32 v16, v16, v19, s[96:97]
v_cndmask_b32 v17, v17, v20, s[96:97]
v_mfma_f32_16x16x32_bf16 v[200:203], a[172:175], a[108:111], v[200:203]
v_cndmask_b32 v18, v18, v21, s[96:97]
v_mul_u32_u24 v19, 7282, v16
v_mfma_f32_16x16x32_bf16 v[88:91], a[164:167], a[108:111], v[88:91]
v_lshrrev_b32 v19, 16, v19
v_mul_u32_u24 v20, 9, v19
v_mfma_f32_16x16x32_bf16 v[88:91], a[160:163], a[104:107], v[88:91]
s_waitcnt lgkmcnt(0)
v_sub_u32 v16, v16, v20
v_and_b32 v20, 1, v19
v_mfma_f32_16x16x32_bf16 v[36:39], a[128:131], a[80:83], v[36:39]
s_waitcnt vmcnt(24)
v_lshlrev_b32 v20, 2, v20
v_cndmask_b32 v20, 0, v20, s[96:97]
v_mfma_f32_16x16x32_bf16 v[36:39], a[132:135], a[84:87], v[36:39]
s_barrier
v_mfma_f32_16x16x32_bf16 v[44:47], a[140:143], a[84:87], v[44:47]
ds_read_b128 a[96:99], v9 offset:4096
v_xor_b32 v18, v18, v20
v_mfma_f32_16x16x32_bf16 v[44:47], a[136:139], a[80:83], v[44:47]
s_xor_b32 s75, s93, 5
s_lshl_b32 s76, s75, 19
s_add_u32 s76, s76, s74
v_mfma_f32_16x16x32_bf16 v[32:35], a[144:147], a[80:83], v[32:35]
s_lshl_b32 s79, s75, 13
s_add_u32 s79, s79, s78
ds_read_b128 a[100:103], v10 offset:4096
v_mfma_f32_16x16x32_bf16 v[32:35], a[148:151], a[84:87], v[32:35]
s_add_u32 m0, s77, 0
s_add_u32 s64, s76, 0
ds_read_b128 a[104:107], v9 offset:6144
v_mfma_f32_16x16x32_bf16 v[52:55], a[156:159], a[84:87], v[52:55]
buffer_load_dwordx4 v7, s[20:23], s64 offen lds
v_mfma_f32_16x16x32_bf16 v[52:55], a[152:155], a[80:83], v[52:55]
s_add_u32 s53, s88, 524288
ds_read_b64_tr_b16 a[160:161], v11 offset:16384
ds_read_b64_tr_b16 a[162:163], v11 offset:16896
v_mfma_f32_16x16x32_bf16 v[60:63], a[64:67], a[80:83], v[60:63]
buffer_store_dwordx4 v[112:115], v4, s[24:27], s53 offen offset:2048 sc1
v_mfma_f32_16x16x32_bf16 v[60:63], a[68:71], a[84:87], v[60:63]
ds_read_b128 a[108:111], v10 offset:6144
v_lshl_add_u32 v19, v19, 2, v17
v_mfma_f32_16x16x32_bf16 v[68:71], a[76:79], a[84:87], v[68:71]
buffer_load_dwordx4 v8, s[20:23], s64 offen offset:1024 lds
v_mfma_f32_16x16x32_bf16 v[68:71], a[72:75], a[80:83], v[68:71]
ds_read_b64_tr_b16 a[164:165], v11 offset:20480
ds_read_b64_tr_b16 a[166:167], v11 offset:20992
v_mfma_f32_16x16x32_bf16 v[76:79], a[72:75], a[88:91], v[76:79]
v_add_u32 v9, 32768, v9
v_add_u32 v10, 32768, v10
v_mfma_f32_16x16x32_bf16 v[76:79], a[76:79], a[92:95], v[76:79]
ds_read_b64_tr_b16 a[168:169], v12 offset:16384
ds_read_b64_tr_b16 a[170:171], v12 offset:16896
v_mfma_f32_16x16x32_bf16 v[84:87], a[68:71], a[92:95], v[84:87]
s_add_u32 m0, s80, 0
s_add_u32 s64, s79, 0
v_mul_u32_u24 v19, 344064, v19
v_mfma_f32_16x16x32_bf16 v[84:87], a[64:67], a[88:91], v[84:87]
ds_read_b64_tr_b16 a[172:173], v12 offset:20480
ds_read_b64_tr_b16 a[174:175], v12 offset:20992
v_mfma_f32_16x16x32_bf16 v[92:95], a[152:155], a[88:91], v[92:95]
buffer_load_dwordx4 v4, s[24:27], s64 offen sc1 lds
v_mfma_f32_16x16x32_bf16 v[92:95], a[156:159], a[92:95], v[92:95]
v_lshrrev_b32 v20, 1, v16
v_sub_u32 v20, v20, v17
v_mfma_f32_16x16x32_bf16 v[40:43], a[148:151], a[92:95], v[40:43]
ds_read_b64_tr_b16 a[176:177], v13 offset:16384
ds_read_b64_tr_b16 a[178:179], v13 offset:16896
v_mfma_f32_16x16x32_bf16 v[40:43], a[144:147], a[88:91], v[40:43]
v_add_u32 v20, 3, v20
v_and_b32 v20, 3, v20
v_mfma_f32_16x16x32_bf16 v[100:103], a[136:139], a[88:91], v[100:103]
s_add_u32 m0, s73, 69632
s_add_u32 s64, s72, 0
v_cmp_eq_u32 s[96:97], 8, v16
v_mfma_f32_16x16x32_bf16 v[100:103], a[140:143], a[92:95], v[100:103]
ds_read_b64_tr_b16 a[180:181], v13 offset:20480
ds_read_b64_tr_b16 a[182:183], v13 offset:20992
v_mfma_f32_16x16x32_bf16 v[108:111], a[132:135], a[92:95], v[108:111]
buffer_load_dwordx4 v5, s[12:15], s64 offen lds
v_mfma_f32_16x16x32_bf16 v[108:111], a[128:131], a[88:91], v[108:111]
s_waitcnt lgkmcnt(14)
ds_read_b64_tr_b16 a[184:185], v14 offset:16384
ds_read_b64_tr_b16 a[186:187], v14 offset:16896
v_mfma_f32_16x16x32_bf16 v[116:119], a[128:131], a[96:99], v[116:119]
ds_read_b64_tr_b16 a[188:189], v14 offset:20480
ds_read_b64_tr_b16 a[190:191], v14 offset:20992
v_mfma_f32_16x16x32_bf16 v[116:119], a[132:135], a[100:103], v[116:119]
v_and_b32 v16, 1, v16
v_lshl_add_u32 v21, v20, 1, v16
v_mfma_f32_16x16x32_bf16 v[124:127], a[140:143], a[100:103], v[124:127]
v_and_b32 v22, 1, v18
v_lshl_add_u32 v19, v22, 10, v19
v_mfma_f32_16x16x32_bf16 v[124:127], a[136:139], a[96:99], v[124:127]
ds_read_b128 a[112:115], v4 offset:24576
v_and_b32 v18, -2, v18
v_mfma_f32_16x16x32_bf16 v[132:135], a[144:147], a[96:99], v[132:135]
buffer_load_dwordx4 v6, s[12:15], s64 offen offset:1024 lds
v_mfma_f32_16x16x32_bf16 v[132:135], a[148:151], a[100:103], v[132:135]
ds_read_b128 a[116:119], v4 offset:26624
v_add_u32 v21, 1, v21
v_mfma_f32_16x16x32_bf16 v[140:143], a[156:159], a[100:103], v[140:143]
v_cndmask_b32 v21, v21, 0, s[96:97]
v_cndmask_b32 v20, v20, 0, s[96:97]
v_mfma_f32_16x16x32_bf16 v[140:143], a[152:155], a[96:99], v[140:143]
s_add_u32 s53, s88, 524288
ds_read_b128 a[120:123], v4 offset:25600
v_sub_u32 v17, 37, v18
v_mfma_f32_16x16x32_bf16 v[148:151], a[64:67], a[96:99], v[148:151]
s_add_u32 m0, s73, 71680
s_add_u32 s64, s72, 18432
v_min_u32 v17, 2, v17
v_mfma_f32_16x16x32_bf16 v[148:151], a[68:71], a[100:103], v[148:151]
ds_read_b128 a[124:127], v4 offset:27648
v_mul_u32_u24 v21, v21, v17
v_mfma_f32_16x16x32_bf16 v[48:51], a[76:79], a[100:103], v[48:51]
buffer_load_dwordx4 v5, s[12:15], s64 offen lds
v_mfma_f32_16x16x32_bf16 v[48:51], a[72:75], a[96:99], v[48:51]
s_waitcnt lgkmcnt(15)
v_mul_u32_u24 v22, v16, v17
v_min_u32 v23, 8, v18
v_mfma_f32_16x16x32_bf16 v[156:159], a[72:75], a[104:107], v[156:159]
buffer_store_dwordx4 v[120:123], v4, s[24:27], s53 offen offset:3072 sc1
v_mfma_f32_16x16x32_bf16 v[156:159], a[76:79], a[108:111], v[156:159]
v_mad_u32_u24 v21, v18, 5, v21
v_lshl_add_u32 v21, v23, 1, v21
v_mfma_f32_16x16x32_bf16 v[164:167], a[68:71], a[108:111], v[164:167]
v_lshl_add_u32 v22, v18, 1, v22
v_mad_u32_u24 v22, v20, 37, v22
v_mfma_f32_16x16x32_bf16 v[164:167], a[64:67], a[104:107], v[164:167]
v_mad_u32_u24 v22, v20, 37, v22
v_lshl_add_u32 v20, v20, 6, v18
v_mfma_f32_16x16x32_bf16 v[172:175], a[152:155], a[104:107], v[172:175]
buffer_load_dwordx4 v6, s[12:15], s64 offen offset:1024 lds
v_mfma_f32_16x16x32_bf16 v[172:175], a[156:159], a[108:111], v[172:175]
v_mov_b32 v23, 136
v_cmp_gt_u32 s[96:97], v23, v20
v_mfma_f32_16x16x32_bf16 v[56:59], a[148:151], a[108:111], v[56:59]
v_add_u32 v22, 37, v22
v_add_u32 v19, 38797312, v19
v_mfma_f32_16x16x32_bf16 v[56:59], a[144:147], a[104:107], v[56:59]
v_cndmask_b32 v21, v22, v21, s[96:97]
v_lshl_add_u32 v19, v21, 10, v19
v_mfma_f32_16x16x32_bf16 v[180:183], a[136:139], a[104:107], v[180:183]
s_cmp_eq_u32 s54, 1
s_cselect_b32 s96, 16, 0
v_mfma_f32_16x16x32_bf16 v[180:183], a[140:143], a[108:111], v[180:183]
s_cmp_eq_u32 s3, 3
s_cselect_b32 s52, 32, 0
s_or_b32 s96, s96, s52
v_mfma_f32_16x16x32_bf16 v[188:191], a[132:135], a[108:111], v[188:191]
s_cmp_ge_u32 s2, 240
s_cselect_b32 s52, 32, 0
s_or_b32 s96, s96, s52
v_mfma_f32_16x16x32_bf16 v[188:191], a[128:131], a[104:107], v[188:191]
s_waitcnt lgkmcnt(0)
s_mov_b32 s97, 0
v_mfma_f32_16x16x32_bf16 v[196:199], a[160:163], a[80:83], v[196:199]
s_waitcnt vmcnt(18)
v_mov_b32 v20, 2147418112
v_cndmask_b32 v26, v19, v20, s[96:97]
v_mfma_f32_16x16x32_bf16 v[196:199], a[164:167], a[84:87], v[196:199]
s_barrier
v_mfma_f32_16x16x32_bf16 v[64:67], a[172:175], a[84:87], v[64:67]
ds_read_b64_tr_b16 a[128:129], v11 offset:32768
ds_read_b64_tr_b16 a[130:131], v11 offset:33280
v_mfma_f32_16x16x32_bf16 v[64:67], a[168:171], a[80:83], v[64:67]
s_add_u32 m0, s77, 16384
s_add_u32 s64, s76, 128
v_lshlrev_b32 v27, 3, v1
v_mfma_f32_16x16x32_bf16 v[204:207], a[176:179], a[80:83], v[204:207]
buffer_load_dwordx4 v7, s[20:23], s64 offen lds
v_mfma_f32_16x16x32_bf16 v[204:207], a[180:183], a[84:87], v[204:207]
ds_read_b64_tr_b16 a[132:133], v11 offset:36864
ds_read_b64_tr_b16 a[134:135], v11 offset:37376
v_mfma_f32_16x16x32_bf16 v[212:215], a[188:191], a[84:87], v[212:215]
ds_read_b64_tr_b16 a[136:137], v12 offset:32768
ds_read_b64_tr_b16 a[138:139], v12 offset:33280
v_mfma_f32_16x16x32_bf16 v[212:215], a[184:187], a[80:83], v[212:215]
ds_read_b64_tr_b16 a[140:141], v12 offset:36864
ds_read_b64_tr_b16 a[142:143], v12 offset:37376
v_mfma_f32_16x16x32_bf16 v[72:75], a[112:115], a[80:83], v[72:75]
buffer_atomic_add v1, v0, s[24:27], s90 offen offset:4 sc1
v_mfma_f32_16x16x32_bf16 v[72:75], a[116:119], a[84:87], v[72:75]
ds_read_b64_tr_b16 a[144:145], v13 offset:32768
ds_read_b64_tr_b16 a[146:147], v13 offset:33280
v_mfma_f32_16x16x32_bf16 v[220:223], a[124:127], a[84:87], v[220:223]
buffer_load_dwordx4 v8, s[20:23], s64 offen offset:1024 lds
v_mfma_f32_16x16x32_bf16 v[220:223], a[120:123], a[80:83], v[220:223]
s_add_u32 s53, s88, 786432
ds_read_b64_tr_b16 a[148:149], v13 offset:36864
ds_read_b64_tr_b16 a[150:151], v13 offset:37376
v_mfma_f32_16x16x32_bf16 v[252:255], a[120:123], a[88:91], v[252:255]
buffer_store_dwordx4 v[128:131], v4, s[24:27], s53 offen offset:0 sc1
v_mfma_f32_16x16x32_bf16 v[252:255], a[124:127], a[92:95], v[252:255]
ds_read_b64_tr_b16 a[152:153], v14 offset:32768
ds_read_b64_tr_b16 a[154:155], v14 offset:33280
v_mfma_f32_16x16x32_bf16 v[160:163], a[116:119], a[92:95], v[160:163]
s_add_u32 m0, s80, 16384
s_add_u32 s64, s79, 2048
v_add_u32 v27, s83, v27
v_mfma_f32_16x16x32_bf16 v[160:163], a[112:115], a[88:91], v[160:163]
ds_read_b64_tr_b16 a[156:157], v14 offset:36864
ds_read_b64_tr_b16 a[158:159], v14 offset:37376
v_mfma_f32_16x16x32_bf16 v[228:231], a[184:187], a[88:91], v[228:231]
buffer_load_dwordx4 v4, s[24:27], s64 offen sc1 lds
v_mfma_f32_16x16x32_bf16 v[228:231], a[188:191], a[92:95], v[228:231]
s_xor_b32 s65, s70, 768
s_add_u32 s71, s68, s65
s_add_u32 s72, s69, s65
v_mfma_f32_16x16x32_bf16 v[168:171], a[180:183], a[92:95], v[168:171]
ds_read_b128 a[64:67], v4 offset:40960
v_lshrrev_b32 v22, 3, v1
v_mfma_f32_16x16x32_bf16 v[168:171], a[176:179], a[88:91], v[168:171]
v_mul_u32_u24 v22, 1152, v22
v_and_b32 v23, 7, v1
v_mfma_f32_16x16x32_bf16 v[176:179], a[168:171], a[88:91], v[176:179]
s_add_u32 m0, s73, 0
s_add_u32 s64, s71, 0
ds_read_b128 a[80:83], v9 offset:0
v_mfma_f32_16x16x32_bf16 v[176:179], a[172:175], a[92:95], v[176:179]
v_lshl_add_u32 v22, v23, 4, v22
v_lshrrev_b32 v23, 2, v1
v_mfma_f32_16x16x32_bf16 v[80:83], a[164:167], a[92:95], v[80:83]
buffer_load_dwordx4 v5, s[12:15], s64 offen lds
v_mfma_f32_16x16x32_bf16 v[80:83], a[160:163], a[88:91], v[80:83]
L_PAD6:
s_cbranch_execz L_PAD10
ds_read_b128 a[68:71], v4 offset:43008
v_mul_u32_u24 v23, 96, v23
v_mfma_f32_16x16x32_bf16 v[184:187], a[160:163], a[96:99], v[184:187]
ds_read_b128 a[84:87], v10 offset:0
v_add_u32 v23, v23, v27
v_mfma_f32_16x16x32_bf16 v[184:187], a[164:167], a[100:103], v[184:187]
v_and_b32 v16, 3, v1
v_cmp_eq_u32 s[96:97], 0, v16
v_mfma_f32_16x16x32_bf16 v[248:251], a[172:175], a[100:103], v[248:251]
v_mov_b32 v16, 0x3f803f80
v_mfma_f32_16x16x32_bf16 v[248:251], a[168:171], a[96:99], v[248:251]
ds_read_b128 a[72:75], v4 offset:41984
v_cndmask_b32 v16, 0, v16, s[96:97]
v_mfma_f32_16x16x32_bf16 v[240:243], a[176:179], a[96:99], v[240:243]
buffer_load_dwordx4 v6, s[12:15], s64 offen offset:1024 lds
v_mfma_f32_16x16x32_bf16 v[240:243], a[180:183], a[100:103], v[240:243]
ds_read_b128 a[88:91], v9 offset:2048
v_accvgpr_write_b32 a240, v16
v_mfma_f32_16x16x32_bf16 v[232:235], a[188:191], a[100:103], v[232:235]
v_accvgpr_write_b32 a241, v16
v_accvgpr_write_b32 a242, v16
v_mfma_f32_16x16x32_bf16 v[232:235], a[184:187], a[96:99], v[232:235]
ds_read_b128 a[76:79], v4 offset:44032
v_accvgpr_write_b32 a243, v16
v_mfma_f32_16x16x32_bf16 v[236:239], a[112:115], a[96:99], v[236:239]
s_add_u32 m0, s73, 2048
s_add_u32 s64, s71, 18432
v_accvgpr_write_b32 a232, 0
v_mfma_f32_16x16x32_bf16 v[236:239], a[116:119], a[100:103], v[236:239]
ds_read_b128 a[92:95], v10 offset:2048
v_accvgpr_write_b32 a233, 0
v_mfma_f32_16x16x32_bf16 v[224:227], a[124:127], a[100:103], v[224:227]
buffer_load_dwordx4 v5, s[12:15], s64 offen lds
v_mfma_f32_16x16x32_bf16 v[224:227], a[120:123], a[96:99], v[224:227]
v_accvgpr_write_b32 a234, 0
v_accvgpr_write_b32 a235, 0
v_mfma_f32_16x16x32_bf16 v[208:211], a[120:123], a[104:107], v[208:211]
v_accvgpr_write_b32 a236, 0
v_accvgpr_write_b32 a237, 0
v_mfma_f32_16x16x32_bf16 v[208:211], a[124:127], a[108:111], v[208:211]
s_add_u32 s53, s88, 786432
v_accvgpr_write_b32 a238, 0
v_accvgpr_write_b32 a239, 0
v_mfma_f32_16x16x32_bf16 v[216:219], a[116:119], a[108:111], v[216:219]
buffer_store_dwordx4 v[136:139], v4, s[24:27], s53 offen offset:1024 sc1
v_mfma_f32_16x16x32_bf16 v[216:219], a[112:115], a[104:107], v[216:219]
v_lshlrev_b32 v16, 2, v3
v_sub_u32 v16, v2, v16
v_mfma_f32_16x16x32_bf16 v[244:247], a[184:187], a[104:107], v[244:247]
buffer_load_dwordx4 v6, s[12:15], s64 offen offset:1024 lds
v_mfma_f32_16x16x32_bf16 v[244:247], a[188:191], a[108:111], v[244:247]
v_cmp_gt_i32 s[56:57], 0, v16
v_cmp_gt_i32 s[58:59], 1, v16
v_mfma_f32_16x16x32_bf16 v[192:195], a[180:183], a[108:111], v[192:195]
v_cmp_gt_i32 s[60:61], 2, v16
v_cmp_gt_i32 s[62:63], 3, v16
v_mfma_f32_16x16x32_bf16 v[192:195], a[176:179], a[104:107], v[192:195]
v_cmp_eq_u32 s[96:97], 3, v3
v_add_u32 v17, 48, v2
v_mfma_f32_16x16x32_bf16 v[200:203], a[168:171], a[104:107], v[200:203]
v_lshlrev_b32 v17, 2, v17
v_lshlrev_b32 v18, 16, v3
v_mfma_f32_16x16x32_bf16 v[200:203], a[172:175], a[108:111], v[200:203]
v_lshl_add_u32 v18, v2, 4, v18
v_add_u32 v19, 0x8000, v18
v_mfma_f32_16x16x32_bf16 v[88:91], a[164:167], a[108:111], v[88:91]
v_cndmask_b32 v19, v19, v20, s[96:97]
v_cmp_eq_u32 s[96:97], 0, v3
v_mfma_f32_16x16x32_bf16 v[88:91], a[160:163], a[104:107], v[88:91]
s_waitcnt lgkmcnt(0)
v_mfma_f32_16x16x32_bf16 v[36:39], a[128:131], a[80:83], v[36:39]
s_waitcnt vmcnt(24)
v_cndmask_b32 v18, v18, v20, s[96:97]
v_cndmask_b32 v19, v19, v20, s[96:97]
v_mfma_f32_16x16x32_bf16 v[36:39], a[132:135], a[84:87], v[36:39]
s_barrier
v_mfma_f32_16x16x32_bf16 v[44:47], a[140:143], a[84:87], v[44:47]
ds_read_b128 a[96:99], v9 offset:4096
v_mfma_f32_16x16x32_bf16 v[44:47], a[136:139], a[80:83], v[44:47]
s_xor_b32 s75, s93, 6
s_lshl_b32 s76, s75, 19
s_add_u32 s76, s76, s74
v_mfma_f32_16x16x32_bf16 v[32:35], a[144:147], a[80:83], v[32:35]
s_lshl_b32 s79, s75, 13
s_add_u32 s79, s79, s78
ds_read_b128 a[100:103], v10 offset:4096
v_mfma_f32_16x16x32_bf16 v[32:35], a[148:151], a[84:87], v[32:35]
s_add_u32 m0, s77, 32768
s_add_u32 s64, s76, 0
ds_read_b128 a[104:107], v9 offset:6144
v_mfma_f32_16x16x32_bf16 v[52:55], a[156:159], a[84:87], v[52:55]
buffer_load_dwordx4 v7, s[20:23], s64 offen lds
v_mfma_f32_16x16x32_bf16 v[52:55], a[152:155], a[80:83], v[52:55]
ds_read_b64_tr_b16 a[160:161], v11 offset:49152
ds_read_b64_tr_b16 a[162:163], v11 offset:49664
v_mfma_f32_16x16x32_bf16 v[60:63], a[64:67], a[80:83], v[60:63]
v_mfma_f32_16x16x32_bf16 v[60:63], a[68:71], a[84:87], v[60:63]
ds_read_b128 a[108:111], v10 offset:6144
v_mfma_f32_16x16x32_bf16 v[68:71], a[76:79], a[84:87], v[68:71]
buffer_load_dwordx4 v8, s[20:23], s64 offen offset:1024 lds
v_mfma_f32_16x16x32_bf16 v[68:71], a[72:75], a[80:83], v[68:71]
ds_read_b64_tr_b16 a[164:165], v11 offset:53248
ds_read_b64_tr_b16 a[166:167], v11 offset:53760
v_mfma_f32_16x16x32_bf16 v[76:79], a[72:75], a[88:91], v[76:79]
v_add_u32 v9, 32768, v9
v_add_u32 v10, 32768, v10
v_mfma_f32_16x16x32_bf16 v[76:79], a[76:79], a[92:95], v[76:79]
ds_read_b64_tr_b16 a[168:169], v12 offset:49152
ds_read_b64_tr_b16 a[170:171], v12 offset:49664
v_mfma_f32_16x16x32_bf16 v[84:87], a[68:71], a[92:95], v[84:87]
s_add_u32 m0, s80, 32768
s_add_u32 s64, s79, 0
v_mfma_f32_16x16x32_bf16 v[84:87], a[64:67], a[88:91], v[84:87]
ds_read_b64_tr_b16 a[172:173], v12 offset:53248
ds_read_b64_tr_b16 a[174:175], v12 offset:53760
v_mfma_f32_16x16x32_bf16 v[92:95], a[152:155], a[88:91], v[92:95]
buffer_load_dwordx4 v4, s[24:27], s64 offen sc1 lds
v_mfma_f32_16x16x32_bf16 v[92:95], a[156:159], a[92:95], v[92:95]
s_add_u32 s53, s88, 786432
v_mfma_f32_16x16x32_bf16 v[40:43], a[148:151], a[92:95], v[40:43]
ds_read_b64_tr_b16 a[176:177], v13 offset:49152
ds_read_b64_tr_b16 a[178:179], v13 offset:49664
v_mfma_f32_16x16x32_bf16 v[40:43], a[144:147], a[88:91], v[40:43]
buffer_store_dwordx4 v[144:147], v4, s[24:27], s53 offen offset:2048 sc1
v_mfma_f32_16x16x32_bf16 v[100:103], a[136:139], a[88:91], v[100:103]
s_add_u32 m0, s73, 4096
s_add_u32 s64, s72, 0
v_mfma_f32_16x16x32_bf16 v[100:103], a[140:143], a[92:95], v[100:103]
ds_read_b64_tr_b16 a[180:181], v13 offset:53248
ds_read_b64_tr_b16 a[182:183], v13 offset:53760
v_mfma_f32_16x16x32_bf16 v[108:111], a[132:135], a[92:95], v[108:111]
buffer_load_dwordx4 v5, s[12:15], s64 offen lds
v_mfma_f32_16x16x32_bf16 v[108:111], a[128:131], a[88:91], v[108:111]
s_waitcnt lgkmcnt(14)
ds_read_b64_tr_b16 a[184:185], v14 offset:49152
ds_read_b64_tr_b16 a[186:187], v14 offset:49664
v_mfma_f32_16x16x32_bf16 v[116:119], a[128:131], a[96:99], v[116:119]
ds_read_b64_tr_b16 a[188:189], v14 offset:53248
ds_read_b64_tr_b16 a[190:191], v14 offset:53760
v_mfma_f32_16x16x32_bf16 v[116:119], a[132:135], a[100:103], v[116:119]
v_mfma_f32_16x16x32_bf16 v[124:127], a[140:143], a[100:103], v[124:127]
v_mfma_f32_16x16x32_bf16 v[124:127], a[136:139], a[96:99], v[124:127]
ds_read_b128 a[112:115], v4 offset:57344
v_mfma_f32_16x16x32_bf16 v[132:135], a[144:147], a[96:99], v[132:135]
buffer_load_dwordx4 v6, s[12:15], s64 offen offset:1024 lds
v_mfma_f32_16x16x32_bf16 v[132:135], a[148:151], a[100:103], v[132:135]
ds_read_b128 a[116:119], v4 offset:59392
v_mfma_f32_16x16x32_bf16 v[140:143], a[156:159], a[100:103], v[140:143]
v_mfma_f32_16x16x32_bf16 v[140:143], a[152:155], a[96:99], v[140:143]
ds_read_b128 a[120:123], v4 offset:58368
v_mfma_f32_16x16x32_bf16 v[148:151], a[64:67], a[96:99], v[148:151]
s_add_u32 m0, s73, 6144
s_add_u32 s64, s72, 18432
v_mfma_f32_16x16x32_bf16 v[148:151], a[68:71], a[100:103], v[148:151]
ds_read_b128 a[124:127], v4 offset:60416
v_mfma_f32_16x16x32_bf16 v[48:51], a[76:79], a[100:103], v[48:51]
buffer_load_dwordx4 v5, s[12:15], s64 offen lds
v_mfma_f32_16x16x32_bf16 v[48:51], a[72:75], a[96:99], v[48:51]
s_waitcnt lgkmcnt(15)
v_mfma_f32_16x16x32_bf16 v[156:159], a[72:75], a[104:107], v[156:159]
v_mfma_f32_16x16x32_bf16 v[156:159], a[76:79], a[108:111], v[156:159]
v_mfma_f32_16x16x32_bf16 v[164:167], a[68:71], a[108:111], v[164:167]
v_mfma_f32_16x16x32_bf16 v[164:167], a[64:67], a[104:107], v[164:167]
v_mfma_f32_16x16x32_bf16 v[172:175], a[152:155], a[104:107], v[172:175]
buffer_load_dwordx4 v6, s[12:15], s64 offen offset:1024 lds
v_mfma_f32_16x16x32_bf16 v[172:175], a[156:159], a[108:111], v[172:175]
v_mfma_f32_16x16x32_bf16 v[56:59], a[148:151], a[108:111], v[56:59]
v_mfma_f32_16x16x32_bf16 v[56:59], a[144:147], a[104:107], v[56:59]
s_add_u32 s53, s88, 786432
v_mfma_f32_16x16x32_bf16 v[180:183], a[136:139], a[104:107], v[180:183]
buffer_store_dwordx4 v[152:155], v4, s[24:27], s53 offen offset:3072 sc1
v_mfma_f32_16x16x32_bf16 v[180:183], a[140:143], a[108:111], v[180:183]
v_mfma_f32_16x16x32_bf16 v[188:191], a[132:135], a[108:111], v[188:191]
v_mfma_f32_16x16x32_bf16 v[188:191], a[128:131], a[104:107], v[188:191]
s_waitcnt lgkmcnt(0)
v_mov_b32 v96, 0
v_mov_b32 v97, 0
v_mfma_f32_16x16x32_bf16 v[196:199], a[160:163], a[80:83], v[196:199]
s_waitcnt vmcnt(19)
v_mov_b32 v98, 0
v_mov_b32 v99, 0
v_mfma_f32_16x16x32_bf16 v[196:199], a[164:167], a[84:87], v[196:199]
s_barrier
v_mfma_f32_16x16x32_bf16 v[64:67], a[172:175], a[84:87], v[64:67]
ds_read_b64_tr_b16 a[128:129], v11 offset:0
ds_read_b64_tr_b16 a[130:131], v11 offset:512
v_mfma_f32_16x16x32_bf16 v[64:67], a[168:171], a[80:83], v[64:67]
s_add_u32 m0, s77, 49152
s_add_u32 s64, s76, 128
v_mov_b32 v104, 0
v_mfma_f32_16x16x32_bf16 v[204:207], a[176:179], a[80:83], v[204:207]
buffer_load_dwordx4 v7, s[20:23], s64 offen lds
v_mfma_f32_16x16x32_bf16 v[204:207], a[180:183], a[84:87], v[204:207]
ds_read_b64_tr_b16 a[132:133], v11 offset:4096
ds_read_b64_tr_b16 a[134:135], v11 offset:4608
v_mfma_f32_16x16x32_bf16 v[212:215], a[188:191], a[84:87], v[212:215]
ds_read_b64_tr_b16 a[136:137], v12 offset:0
ds_read_b64_tr_b16 a[138:139], v12 offset:512
v_mfma_f32_16x16x32_bf16 v[212:215], a[184:187], a[80:83], v[212:215]
ds_read_b64_tr_b16 a[140:141], v12 offset:4096
ds_read_b64_tr_b16 a[142:143], v12 offset:4608
v_mfma_f32_16x16x32_bf16 v[72:75], a[112:115], a[80:83], v[72:75]
buffer_load_dword v30, v29, s[24:27], s89 offen offset:4 sc1
v_mfma_f32_16x16x32_bf16 v[72:75], a[116:119], a[84:87], v[72:75]
ds_read_b64_tr_b16 a[144:145], v13 offset:0
ds_read_b64_tr_b16 a[146:147], v13 offset:512
v_mfma_f32_16x16x32_bf16 v[220:223], a[124:127], a[84:87], v[220:223]
buffer_load_dwordx4 v8, s[20:23], s64 offen offset:1024 lds
v_mfma_f32_16x16x32_bf16 v[220:223], a[120:123], a[80:83], v[220:223]
ds_read_b64_tr_b16 a[148:149], v13 offset:4096
ds_read_b64_tr_b16 a[150:151], v13 offset:4608
v_mfma_f32_16x16x32_bf16 v[252:255], a[120:123], a[88:91], v[252:255]
v_mov_b32 v105, 0
v_mov_b32 v106, 0
v_mfma_f32_16x16x32_bf16 v[252:255], a[124:127], a[92:95], v[252:255]
ds_read_b64_tr_b16 a[152:153], v14 offset:0
ds_read_b64_tr_b16 a[154:155], v14 offset:512
v_mfma_f32_16x16x32_bf16 v[160:163], a[116:119], a[92:95], v[160:163]
s_add_u32 m0, s80, 49152
s_add_u32 s64, s79, 2048
v_mov_b32 v107, 0
v_mfma_f32_16x16x32_bf16 v[160:163], a[112:115], a[88:91], v[160:163]
ds_read_b64_tr_b16 a[156:157], v14 offset:4096
ds_read_b64_tr_b16 a[158:159], v14 offset:4608
v_mfma_f32_16x16x32_bf16 v[228:231], a[184:187], a[88:91], v[228:231]
buffer_load_dwordx4 v4, s[24:27], s64 offen sc1 lds
v_mfma_f32_16x16x32_bf16 v[228:231], a[188:191], a[92:95], v[228:231]
s_xor_b32 s65, s70, 896
s_add_u32 s71, s68, s65
s_add_u32 s72, s69, s65
v_mfma_f32_16x16x32_bf16 v[168:171], a[180:183], a[92:95], v[168:171]
ds_read_b128 a[64:67], v4 offset:8192
v_mov_b32 v112, 0
v_mfma_f32_16x16x32_bf16 v[168:171], a[176:179], a[88:91], v[168:171]
v_mov_b32 v113, 0
v_mov_b32 v114, 0
v_mfma_f32_16x16x32_bf16 v[176:179], a[168:171], a[88:91], v[176:179]
s_add_u32 m0, s73, 32768
s_add_u32 s64, s71, 0
ds_read_b128 a[80:83], v9 offset:0
v_mfma_f32_16x16x32_bf16 v[176:179], a[172:175], a[92:95], v[176:179]
v_mov_b32 v115, 0
v_mov_b32 v120, 0
v_mfma_f32_16x16x32_bf16 v[80:83], a[164:167], a[92:95], v[80:83]
buffer_load_dwordx4 v5, s[12:15], s64 offen lds
v_mfma_f32_16x16x32_bf16 v[80:83], a[160:163], a[88:91], v[80:83]
s_add_u32 s53, s87, 524288
ds_read_b128 a[68:71], v4 offset:10240
v_mov_b32 v121, 0
v_mfma_f32_16x16x32_bf16 v[184:187], a[160:163], a[96:99], v[184:187]
ds_read_b128 a[84:87], v10 offset:0
v_mov_b32 v122, 0
v_mfma_f32_16x16x32_bf16 v[184:187], a[164:167], a[100:103], v[184:187]
buffer_store_dwordx4 a[28:31], v4, s[24:27], s53 offen offset:0 sc1
v_mfma_f32_16x16x32_bf16 v[248:251], a[172:175], a[100:103], v[248:251]
v_mov_b32 v123, 0
v_mov_b32 v128, 0
v_mfma_f32_16x16x32_bf16 v[248:251], a[168:171], a[96:99], v[248:251]
ds_read_b128 a[72:75], v4 offset:9216
v_mov_b32 v129, 0
v_mfma_f32_16x16x32_bf16 v[240:243], a[176:179], a[96:99], v[240:243]
buffer_load_dwordx4 v6, s[12:15], s64 offen offset:1024 lds
v_mfma_f32_16x16x32_bf16 v[240:243], a[180:183], a[100:103], v[240:243]
ds_read_b128 a[88:91], v9 offset:2048
v_mov_b32 v130, 0
v_mfma_f32_16x16x32_bf16 v[232:235], a[188:191], a[100:103], v[232:235]
v_mov_b32 v131, 0
v_mov_b32 v136, 0
v_mfma_f32_16x16x32_bf16 v[232:235], a[184:187], a[96:99], v[232:235]
ds_read_b128 a[76:79], v4 offset:11264
v_mov_b32 v137, 0
v_mfma_f32_16x16x32_bf16 v[236:239], a[112:115], a[96:99], v[236:239]
s_add_u32 m0, s73, 34816
s_add_u32 s64, s71, 18432
v_mov_b32 v138, 0
v_mfma_f32_16x16x32_bf16 v[236:239], a[116:119], a[100:103], v[236:239]
ds_read_b128 a[92:95], v10 offset:2048
v_mov_b32 v139, 0
v_mfma_f32_16x16x32_bf16 v[224:227], a[124:127], a[100:103], v[224:227]
buffer_load_dwordx4 v5, s[12:15], s64 offen lds
v_mfma_f32_16x16x32_bf16 v[224:227], a[120:123], a[96:99], v[224:227]
v_mov_b32 v144, 0
v_mov_b32 v145, 0
v_mfma_f32_16x16x32_bf16 v[208:211], a[120:123], a[104:107], v[208:211]
v_mov_b32 v146, 0
v_mov_b32 v147, 0
v_mfma_f32_16x16x32_bf16 v[208:211], a[124:127], a[108:111], v[208:211]
v_mov_b32 v152, 0
v_mov_b32 v153, 0
v_mfma_f32_16x16x32_bf16 v[216:219], a[116:119], a[108:111], v[216:219]
v_mov_b32 v154, 0
v_mov_b32 v155, 0
v_mfma_f32_16x16x32_bf16 v[216:219], a[112:115], a[104:107], v[216:219]
v_mfma_f32_16x16x32_bf16 v[244:247], a[184:187], a[104:107], v[244:247]
buffer_load_dwordx4 v6, s[12:15], s64 offen offset:1024 lds
v_mfma_f32_16x16x32_bf16 v[244:247], a[188:191], a[108:111], v[244:247]
v_mfma_f32_16x16x32_bf16 v[192:195], a[180:183], a[108:111], v[192:195]
v_mfma_f32_16x16x32_bf16 v[192:195], a[176:179], a[104:107], v[192:195]
v_mfma_f32_16x16x32_bf16 v[200:203], a[168:171], a[104:107], v[200:203]
v_mfma_f32_16x16x32_bf16 v[200:203], a[172:175], a[108:111], v[200:203]
v_mfma_f32_16x16x32_bf16 v[88:91], a[164:167], a[108:111], v[88:91]
v_mfma_f32_16x16x32_bf16 v[88:91], a[160:163], a[104:107], v[88:91]
s_waitcnt lgkmcnt(0)
v_mfma_f32_16x16x32_bf16 v[36:39], a[128:131], a[80:83], v[36:39]
s_waitcnt vmcnt(23)
v_mfma_f32_16x16x32_bf16 v[36:39], a[132:135], a[84:87], v[36:39]
s_barrier
v_mfma_f32_16x16x32_bf16 v[44:47], a[140:143], a[84:87], v[44:47]
s_add_u32 s53, s87, 524288
ds_read_b128 a[96:99], v9 offset:4096
v_mfma_f32_16x16x32_bf16 v[44:47], a[136:139], a[80:83], v[44:47]
s_xor_b32 s75, s93, 7
s_lshl_b32 s76, s75, 19
s_add_u32 s76, s76, s74
v_mfma_f32_16x16x32_bf16 v[32:35], a[144:147], a[80:83], v[32:35]
s_lshl_b32 s79, s75, 13
s_add_u32 s79, s79, s78
ds_read_b128 a[100:103], v10 offset:4096
v_mfma_f32_16x16x32_bf16 v[32:35], a[148:151], a[84:87], v[32:35]
s_add_u32 m0, s77, 0
s_add_u32 s64, s76, 0
ds_read_b128 a[104:107], v9 offset:6144
v_mfma_f32_16x16x32_bf16 v[52:55], a[156:159], a[84:87], v[52:55]
buffer_load_dwordx4 v7, s[20:23], s64 offen lds
v_mfma_f32_16x16x32_bf16 v[52:55], a[152:155], a[80:83], v[52:55]
ds_read_b64_tr_b16 a[160:161], v11 offset:16384
ds_read_b64_tr_b16 a[162:163], v11 offset:16896
v_mfma_f32_16x16x32_bf16 v[60:63], a[64:67], a[80:83], v[60:63]
buffer_store_dwordx4 a[20:23], v4, s[24:27], s53 offen offset:1024 sc1
v_mfma_f32_16x16x32_bf16 v[60:63], a[68:71], a[84:87], v[60:63]
ds_read_b128 a[108:111], v10 offset:6144
v_mfma_f32_16x16x32_bf16 v[68:71], a[76:79], a[84:87], v[68:71]
buffer_load_dwordx4 v8, s[20:23], s64 offen offset:1024 lds
v_mfma_f32_16x16x32_bf16 v[68:71], a[72:75], a[80:83], v[68:71]
ds_read_b64_tr_b16 a[164:165], v11 offset:20480
ds_read_b64_tr_b16 a[166:167], v11 offset:20992
v_mfma_f32_16x16x32_bf16 v[76:79], a[72:75], a[88:91], v[76:79]
v_add_u32 v9, -65536, v9
v_add_u32 v10, -65536, v10
v_mfma_f32_16x16x32_bf16 v[76:79], a[76:79], a[92:95], v[76:79]
ds_read_b64_tr_b16 a[168:169], v12 offset:16384
ds_read_b64_tr_b16 a[170:171], v12 offset:16896
v_mfma_f32_16x16x32_bf16 v[84:87], a[68:71], a[92:95], v[84:87]
s_add_u32 m0, s80, 0
s_add_u32 s64, s79, 0
v_mfma_f32_16x16x32_bf16 v[84:87], a[64:67], a[88:91], v[84:87]
ds_read_b64_tr_b16 a[172:173], v12 offset:20480
ds_read_b64_tr_b16 a[174:175], v12 offset:20992
v_mfma_f32_16x16x32_bf16 v[92:95], a[152:155], a[88:91], v[92:95]
buffer_load_dwordx4 v4, s[24:27], s64 offen sc1 lds
v_mfma_f32_16x16x32_bf16 v[92:95], a[156:159], a[92:95], v[92:95]
v_mfma_f32_16x16x32_bf16 v[40:43], a[148:151], a[92:95], v[40:43]
ds_read_b64_tr_b16 a[176:177], v13 offset:16384
ds_read_b64_tr_b16 a[178:179], v13 offset:16896
v_mfma_f32_16x16x32_bf16 v[40:43], a[144:147], a[88:91], v[40:43]
v_mfma_f32_16x16x32_bf16 v[100:103], a[136:139], a[88:91], v[100:103]
s_add_u32 m0, s73, 36864
s_add_u32 s64, s72, 0
v_mfma_f32_16x16x32_bf16 v[100:103], a[140:143], a[92:95], v[100:103]
ds_read_b64_tr_b16 a[180:181], v13 offset:20480
ds_read_b64_tr_b16 a[182:183], v13 offset:20992
v_mfma_f32_16x16x32_bf16 v[108:111], a[132:135], a[92:95], v[108:111]
buffer_load_dwordx4 v5, s[12:15], s64 offen lds
v_mfma_f32_16x16x32_bf16 v[108:111], a[128:131], a[88:91], v[108:111]
s_waitcnt lgkmcnt(14)
ds_read_b64_tr_b16 a[184:185], v14 offset:16384
ds_read_b64_tr_b16 a[186:187], v14 offset:16896
v_mfma_f32_16x16x32_bf16 v[116:119], a[128:131], a[96:99], v[116:119]
ds_read_b64_tr_b16 a[188:189], v14 offset:20480
ds_read_b64_tr_b16 a[190:191], v14 offset:20992
v_mfma_f32_16x16x32_bf16 v[116:119], a[132:135], a[100:103], v[116:119]
v_mfma_f32_16x16x32_bf16 v[124:127], a[140:143], a[100:103], v[124:127]
v_mfma_f32_16x16x32_bf16 v[124:127], a[136:139], a[96:99], v[124:127]
ds_read_b128 a[112:115], v4 offset:24576
v_mfma_f32_16x16x32_bf16 v[132:135], a[144:147], a[96:99], v[132:135]
buffer_load_dwordx4 v6, s[12:15], s64 offen offset:1024 lds
v_mfma_f32_16x16x32_bf16 v[132:135], a[148:151], a[100:103], v[132:135]
s_add_u32 s53, s87, 528384
ds_read_b128 a[116:119], v4 offset:26624
v_mfma_f32_16x16x32_bf16 v[140:143], a[156:159], a[100:103], v[140:143]
buffer_store_dwordx4 a[12:15], v4, s[24:27], s53 offen offset:0 sc1
v_mfma_f32_16x16x32_bf16 v[140:143], a[152:155], a[96:99], v[140:143]
ds_read_b128 a[120:123], v4 offset:25600
v_mfma_f32_16x16x32_bf16 v[148:151], a[64:67], a[96:99], v[148:151]
s_add_u32 m0, s73, 38912
s_add_u32 s64, s72, 18432
v_mfma_f32_16x16x32_bf16 v[148:151], a[68:71], a[100:103], v[148:151]
ds_read_b128 a[124:127], v4 offset:27648
v_mfma_f32_16x16x32_bf16 v[48:51], a[76:79], a[100:103], v[48:51]
buffer_load_dwordx4 v5, s[12:15], s64 offen lds
v_mfma_f32_16x16x32_bf16 v[48:51], a[72:75], a[96:99], v[48:51]
s_waitcnt lgkmcnt(15)
v_mfma_f32_16x16x32_bf16 v[156:159], a[72:75], a[104:107], v[156:159]
v_mfma_f32_16x16x32_bf16 v[156:159], a[76:79], a[108:111], v[156:159]
v_mfma_f32_16x16x32_bf16 v[164:167], a[68:71], a[108:111], v[164:167]
v_mfma_f32_16x16x32_bf16 v[164:167], a[64:67], a[104:107], v[164:167]
v_mfma_f32_16x16x32_bf16 v[172:175], a[152:155], a[104:107], v[172:175]
buffer_load_dwordx4 v6, s[12:15], s64 offen offset:1024 lds
v_mfma_f32_16x16x32_bf16 v[172:175], a[156:159], a[108:111], v[172:175]
v_mfma_f32_16x16x32_bf16 v[56:59], a[148:151], a[108:111], v[56:59]
v_mfma_f32_16x16x32_bf16 v[56:59], a[144:147], a[104:107], v[56:59]
v_mfma_f32_16x16x32_bf16 v[180:183], a[136:139], a[104:107], v[180:183]
v_mfma_f32_16x16x32_bf16 v[180:183], a[140:143], a[108:111], v[180:183]
v_mfma_f32_16x16x32_bf16 v[188:191], a[132:135], a[108:111], v[188:191]
v_mfma_f32_16x16x32_bf16 v[188:191], a[128:131], a[104:107], v[188:191]
s_waitcnt lgkmcnt(0)
v_mfma_f32_16x16x32_bf16 v[196:199], a[160:163], a[80:83], v[196:199]
s_waitcnt vmcnt(19)
v_mfma_f32_16x16x32_bf16 v[196:199], a[164:167], a[84:87], v[196:199]
s_barrier
v_mfma_f32_16x16x32_bf16 v[64:67], a[172:175], a[84:87], v[64:67]
ds_read_b64_tr_b16 a[128:129], v11 offset:32768
ds_read_b64_tr_b16 a[130:131], v11 offset:33280
v_mfma_f32_16x16x32_bf16 v[64:67], a[168:171], a[80:83], v[64:67]
s_add_u32 m0, s77, 16384
s_add_u32 s64, s76, 128
v_mfma_f32_16x16x32_bf16 v[204:207], a[176:179], a[80:83], v[204:207]
buffer_load_dwordx4 v7, s[20:23], s64 offen lds
v_mfma_f32_16x16x32_bf16 v[204:207], a[180:183], a[84:87], v[204:207]
ds_read_b64_tr_b16 a[132:133], v11 offset:36864
ds_read_b64_tr_b16 a[134:135], v11 offset:37376
v_mfma_f32_16x16x32_bf16 v[212:215], a[188:191], a[84:87], v[212:215]
ds_read_b64_tr_b16 a[136:137], v12 offset:32768
ds_read_b64_tr_b16 a[138:139], v12 offset:33280
v_mfma_f32_16x16x32_bf16 v[212:215], a[184:187], a[80:83], v[212:215]
s_add_u32 s53, s87, 528384
ds_read_b64_tr_b16 a[140:141], v12 offset:36864
ds_read_b64_tr_b16 a[142:143], v12 offset:37376
v_mfma_f32_16x16x32_bf16 v[72:75], a[112:115], a[80:83], v[72:75]
buffer_load_dwordx4 v8, s[20:23], s64 offen offset:1024 lds
v_mfma_f32_16x16x32_bf16 v[72:75], a[116:119], a[84:87], v[72:75]
ds_read_b64_tr_b16 a[144:145], v13 offset:32768
ds_read_b64_tr_b16 a[146:147], v13 offset:33280
v_mfma_f32_16x16x32_bf16 v[220:223], a[124:127], a[84:87], v[220:223]
buffer_store_dwordx4 a[4:7], v4, s[24:27], s53 offen offset:1024 sc1
v_mfma_f32_16x16x32_bf16 v[220:223], a[120:123], a[80:83], v[220:223]
s_add_u32 m0, s80, 16384
s_add_u32 s64, s79, 2048
v_mfma_f32_16x16x32_bf16 v[252:255], a[120:123], a[88:91], v[252:255]
ds_read_b64_tr_b16 a[148:149], v13 offset:36864
ds_read_b64_tr_b16 a[150:151], v13 offset:37376
v_mfma_f32_16x16x32_bf16 v[252:255], a[124:127], a[92:95], v[252:255]
buffer_load_dwordx4 v4, s[24:27], s64 offen sc1 lds
v_mfma_f32_16x16x32_bf16 v[160:163], a[116:119], a[92:95], v[160:163]
ds_read_b64_tr_b16 a[152:153], v14 offset:32768
ds_read_b64_tr_b16 a[154:155], v14 offset:33280
v_mfma_f32_16x16x32_bf16 v[160:163], a[112:115], a[88:91], v[160:163]
ds_read_b64_tr_b16 a[156:157], v14 offset:36864
ds_read_b64_tr_b16 a[158:159], v14 offset:37376
v_mfma_f32_16x16x32_bf16 v[228:231], a[184:187], a[88:91], v[228:231]
s_add_u32 m0, s83, 0
s_add_u32 s64, s81, 0
v_mfma_f32_16x16x32_bf16 v[228:231], a[188:191], a[92:95], v[228:231]
v_mfma_f32_16x16x32_bf16 v[168:171], a[180:183], a[92:95], v[168:171]
buffer_load_dwordx4 v22, s[32:35], s64 offen lds
v_mfma_f32_16x16x32_bf16 v[168:171], a[176:179], a[88:91], v[168:171]
ds_read_b128 a[64:67], v4 offset:40960
v_mfma_f32_16x16x32_bf16 v[176:179], a[168:171], a[88:91], v[176:179]
s_add_u32 m0, s83, 1024
s_add_u32 s64, s81, 9216
ds_read_b128 a[80:83], v9 offset:0
v_mfma_f32_16x16x32_bf16 v[176:179], a[172:175], a[92:95], v[176:179]
v_mfma_f32_16x16x32_bf16 v[80:83], a[164:167], a[92:95], v[80:83]
buffer_load_dwordx4 v22, s[32:35], s64 offen lds
v_mfma_f32_16x16x32_bf16 v[80:83], a[160:163], a[88:91], v[80:83]
ds_read_b128 a[68:71], v4 offset:43008
v_mfma_f32_16x16x32_bf16 v[184:187], a[160:163], a[96:99], v[184:187]
ds_read_b128 a[84:87], v10 offset:0
v_mfma_f32_16x16x32_bf16 v[184:187], a[164:167], a[100:103], v[184:187]
s_add_u32 m0, s83, 2048
s_add_u32 s64, s81, 18432
v_mfma_f32_16x16x32_bf16 v[248:251], a[172:175], a[100:103], v[248:251]
v_mfma_f32_16x16x32_bf16 v[248:251], a[168:171], a[96:99], v[248:251]
buffer_load_dwordx4 v22, s[32:35], s64 offen lds
v_mfma_f32_16x16x32_bf16 v[240:243], a[176:179], a[96:99], v[240:243]
ds_read_b128 a[72:75], v4 offset:41984
v_mfma_f32_16x16x32_bf16 v[240:243], a[180:183], a[100:103], v[240:243]
ds_read_b128 a[88:91], v9 offset:2048
v_mfma_f32_16x16x32_bf16 v[232:235], a[188:191], a[100:103], v[232:235]
s_add_u32 m0, s83, 3072
s_add_u32 s64, s81, 27648
v_mfma_f32_16x16x32_bf16 v[232:235], a[184:187], a[96:99], v[232:235]
ds_read_b128 a[76:79], v4 offset:44032
v_mfma_f32_16x16x32_bf16 v[236:239], a[112:115], a[96:99], v[236:239]
buffer_load_dwordx4 v22, s[32:35], s64 offen lds
v_mfma_f32_16x16x32_bf16 v[236:239], a[116:119], a[100:103], v[236:239]
ds_read_b128 a[92:95], v10 offset:2048
v_mfma_f32_16x16x32_bf16 v[224:227], a[124:127], a[100:103], v[224:227]
s_add_u32 m0, s83, 4096
s_add_u32 s64, s81, 128
s_add_u32 s53, s87, 786432
v_mfma_f32_16x16x32_bf16 v[224:227], a[120:123], a[96:99], v[224:227]
buffer_store_dwordx4 a[0:3], v4, s[24:27], s53 offen offset:0 sc1
v_mfma_f32_16x16x32_bf16 v[208:211], a[120:123], a[104:107], v[208:211]
buffer_load_dwordx4 v24, s[32:35], s64 offen lds
v_mfma_f32_16x16x32_bf16 v[208:211], a[124:127], a[108:111], v[208:211]
s_waitcnt vmcnt(26)
v_mfma_f32_16x16x32_bf16 v[216:219], a[116:119], a[108:111], v[216:219]
v_cmp_gt_u32 vcc, 8, v30
v_mfma_f32_16x16x32_bf16 v[216:219], a[112:115], a[104:107], v[216:219]
s_add_u32 m0, s83, 5120
s_add_u32 s64, s82, 0
v_mfma_f32_16x16x32_bf16 v[244:247], a[184:187], a[104:107], v[244:247]
v_mfma_f32_16x16x32_bf16 v[244:247], a[188:191], a[108:111], v[244:247]
buffer_load_dwordx4 v25, s[48:51], s64 offen lds
v_mfma_f32_16x16x32_bf16 v[192:195], a[180:183], a[108:111], v[192:195]
v_mfma_f32_16x16x32_bf16 v[192:195], a[176:179], a[104:107], v[192:195]
s_cbranch_vccnz CK_KV
CK_KV_R:
v_mfma_f32_16x16x32_bf16 v[200:203], a[168:171], a[104:107], v[200:203]
v_mfma_f32_16x16x32_bf16 v[200:203], a[172:175], a[108:111], v[200:203]
v_mfma_f32_16x16x32_bf16 v[88:91], a[164:167], a[108:111], v[88:91]
v_mfma_f32_16x16x32_bf16 v[88:91], a[160:163], a[104:107], v[88:91]
s_waitcnt lgkmcnt(0)
v_mfma_f32_16x16x32_bf16 v[36:39], a[128:131], a[80:83], v[36:39]
s_waitcnt vmcnt(25)
v_mov_b32 v6, 0xf149f2ca
v_mfma_f32_16x16x32_bf16 v[36:39], a[132:135], a[84:87], v[36:39]
s_barrier
v_mfma_f32_16x16x32_bf16 v[44:47], a[140:143], a[84:87], v[44:47]
ds_read_b128 a[96:99], v9 offset:4096
v_mfma_f32_16x16x32_bf16 v[44:47], a[136:139], a[80:83], v[44:47]
s_lshl_b32 s70, s3, 12
s_add_u32 s68, s70, s94
ds_read_b128 a[100:103], v10 offset:4096
v_mfma_f32_16x16x32_bf16 v[32:35], a[144:147], a[80:83], v[32:35]
s_add_u32 m0, s70, 32768
s_cmp_lt_u32 s3, 2
s_cselect_b32 s64, s68, 2147418112
v_mfma_f32_16x16x32_bf16 v[32:35], a[148:151], a[84:87], v[32:35]
buffer_load_dwordx4 v4, s[24:27], s64 offen offset:0 sc1 lds
v_mfma_f32_16x16x32_bf16 v[52:55], a[156:159], a[84:87], v[52:55]
ds_read_b128 a[104:107], v9 offset:6144
v_mfma_f32_16x16x32_bf16 v[52:55], a[152:155], a[80:83], v[52:55]
ds_read_b64_tr_b16 a[160:161], v11 offset:49152
ds_read_b64_tr_b16 a[162:163], v11 offset:49664
v_mfma_f32_16x16x32_bf16 v[60:63], a[64:67], a[80:83], v[60:63]
s_cmp_eq_u32 s66, 0
s_cbranch_scc1 D0
D0_R:
v_mfma_f32_16x16x32_bf16 v[60:63], a[68:71], a[84:87], v[60:63]
s_lshl_b32 s52, s4, 18
s_add_u32 s52, s52, 45088768
ds_read_b128 a[108:111], v10 offset:6144
v_mfma_f32_16x16x32_bf16 v[68:71], a[76:79], a[84:87], v[68:71]
s_lshl_b32 s54, s66, 9
v_add_u32 v9, 32768, v9
v_add_u32 v10, 32768, v10
v_mfma_f32_16x16x32_bf16 v[68:71], a[72:75], a[80:83], v[68:71]
s_add_u32 s54, s54, s52
ds_read_b64_tr_b16 a[164:165], v11 offset:53248
ds_read_b64_tr_b16 a[166:167], v11 offset:53760
v_mfma_f32_16x16x32_bf16 v[76:79], a[72:75], a[88:91], v[76:79]
s_lshl_b32 s55, s67, 9
s_add_u32 s55, s55, s52
v_mfma_f32_16x16x32_bf16 v[76:79], a[76:79], a[92:95], v[76:79]
s_add_u32 s53, s87, 786432
ds_read_b64_tr_b16 a[168:169], v12 offset:49152
ds_read_b64_tr_b16 a[170:171], v12 offset:49664
v_mfma_f32_16x16x32_bf16 v[84:87], a[68:71], a[92:95], v[84:87]
buffer_load_dwordx4 v4, s[24:27], s64 offen offset:1024 sc1 lds
v_mfma_f32_16x16x32_bf16 v[84:87], a[64:67], a[88:91], v[84:87]
s_max_u32 s65, s66, 1
ds_read_b64_tr_b16 a[172:173], v12 offset:53248
ds_read_b64_tr_b16 a[174:175], v12 offset:53760
L_PAD7:
s_cbranch_execz L_PAD11
v_mfma_f32_16x16x32_bf16 v[92:95], a[152:155], a[88:91], v[92:95]
buffer_store_dwordx4 a[8:11], v4, s[24:27], s53 offen offset:1024 sc1
v_mfma_f32_16x16x32_bf16 v[92:95], a[156:159], a[92:95], v[92:95]
s_lshl_b32 s65, s65, 9
s_add_u32 s52, s52, s65
s_sub_u32 s65, s55, s52
v_mfma_f32_16x16x32_bf16 v[40:43], a[148:151], a[92:95], v[40:43]
s_sub_u32 s65, s65, 163840
ds_read_b64_tr_b16 a[176:177], v13 offset:49152
ds_read_b64_tr_b16 a[178:179], v13 offset:49664
v_mfma_f32_16x16x32_bf16 v[40:43], a[144:147], a[88:91], v[40:43]
s_add_u32 s52, s52, 65280
v_mfma_f32_16x16x32_bf16 v[100:103], a[136:139], a[88:91], v[100:103]
ds_read_b64_tr_b16 a[180:181], v13 offset:53248
ds_read_b64_tr_b16 a[182:183], v13 offset:53760
v_mfma_f32_16x16x32_bf16 v[100:103], a[140:143], a[92:95], v[100:103]
v_cmp_lt_u32 s[96:97], 0, v3
v_lshlrev_b32 v16, 15, v3
v_mfma_f32_16x16x32_bf16 v[108:111], a[132:135], a[92:95], v[108:111]
ds_read_b64_tr_b16 a[184:185], v14 offset:49152
ds_read_b64_tr_b16 a[186:187], v14 offset:49664
v_mfma_f32_16x16x32_bf16 v[108:111], a[128:131], a[88:91], v[108:111]
s_waitcnt lgkmcnt(15)
v_lshl_add_u32 v16, v2, 4, v16
v_add_u32 v16, s52, v16
v_mfma_f32_16x16x32_bf16 v[116:119], a[128:131], a[96:99], v[116:119]
ds_read_b64_tr_b16 a[188:189], v14 offset:53248
ds_read_b64_tr_b16 a[190:191], v14 offset:53760
v_mfma_f32_16x16x32_bf16 v[116:119], a[132:135], a[100:103], v[116:119]
buffer_load_dwordx4 v4, s[24:27], s64 offen offset:2048 sc1 lds
v_mfma_f32_16x16x32_bf16 v[124:127], a[140:143], a[100:103], v[124:127]
v_accvgpr_write_b32 a244, v16
v_add_u32 v16, 131072, v16
v_mfma_f32_16x16x32_bf16 v[124:127], a[136:139], a[96:99], v[124:127]
ds_read_b128 a[112:115], v4 offset:57344
v_add_u32 v21, s65, v16
v_mfma_f32_16x16x32_bf16 v[132:135], a[144:147], a[96:99], v[132:135]
v_cndmask_b32 v16, v16, v21, s[96:97]
v_accvgpr_write_b32 a248, v16
v_mfma_f32_16x16x32_bf16 v[132:135], a[148:151], a[100:103], v[132:135]
ds_read_b128 a[116:119], v4 offset:59392
v_cmp_lt_u32 s[96:97], 1, v3
v_mfma_f32_16x16x32_bf16 v[140:143], a[156:159], a[100:103], v[140:143]
v_add_u32 v21, 131072, v21
v_mfma_f32_16x16x32_bf16 v[140:143], a[152:155], a[96:99], v[140:143]
ds_read_b128 a[120:123], v4 offset:58368
v_cndmask_b32 v21, v21, v20, s[96:97]
v_mfma_f32_16x16x32_bf16 v[148:151], a[64:67], a[96:99], v[148:151]
v_accvgpr_write_b32 a252, v21
v_mfma_f32_16x16x32_bf16 v[148:151], a[68:71], a[100:103], v[148:151]
ds_read_b128 a[124:127], v4 offset:60416
v_mfma_f32_16x16x32_bf16 v[48:51], a[76:79], a[100:103], v[48:51]
s_waitcnt lgkmcnt(15)
v_mfma_f32_16x16x32_bf16 v[48:51], a[72:75], a[96:99], v[48:51]
buffer_load_dwordx4 v4, s[24:27], s64 offen offset:3072 sc1 lds
v_mfma_f32_16x16x32_bf16 v[156:159], a[72:75], a[104:107], v[156:159]
v_mfma_f32_16x16x32_bf16 v[156:159], a[76:79], a[108:111], v[156:159]
v_mfma_f32_16x16x32_bf16 v[164:167], a[68:71], a[108:111], v[164:167]
v_mfma_f32_16x16x32_bf16 v[164:167], a[64:67], a[104:107], v[164:167]
v_mfma_f32_16x16x32_bf16 v[172:175], a[152:155], a[104:107], v[172:175]
s_add_u32 s53, s87, 790528
v_mfma_f32_16x16x32_bf16 v[172:175], a[156:159], a[108:111], v[172:175]
buffer_store_dwordx4 a[16:19], v4, s[24:27], s53 offen offset:0 sc1
v_mfma_f32_16x16x32_bf16 v[56:59], a[148:151], a[108:111], v[56:59]
v_mfma_f32_16x16x32_bf16 v[56:59], a[144:147], a[104:107], v[56:59]
v_mfma_f32_16x16x32_bf16 v[180:183], a[136:139], a[104:107], v[180:183]
v_mfma_f32_16x16x32_bf16 v[180:183], a[140:143], a[108:111], v[180:183]
v_mfma_f32_16x16x32_bf16 v[188:191], a[132:135], a[108:111], v[188:191]
v_mfma_f32_16x16x32_bf16 v[188:191], a[128:131], a[104:107], v[188:191]
s_waitcnt lgkmcnt(0)
v_mfma_f32_16x16x32_bf16 v[196:199], a[160:163], a[80:83], v[196:199]
s_waitcnt vmcnt(17)
v_mfma_f32_16x16x32_bf16 v[196:199], a[164:167], a[84:87], v[196:199]
s_barrier
v_mfma_f32_16x16x32_bf16 v[64:67], a[172:175], a[84:87], v[64:67]
ds_read_b64_tr_b16 a[128:129], v11 offset:0
ds_read_b64_tr_b16 a[130:131], v11 offset:512
v_mfma_f32_16x16x32_bf16 v[64:67], a[168:171], a[80:83], v[64:67]
s_add_u32 m0, s70, 49152
s_add_u32 s64, s68, 16384
s_waitcnt vmcnt(6)
v_mfma_f32_16x16x32_bf16 v[204:207], a[176:179], a[80:83], v[204:207]
buffer_load_dwordx4 v4, s[24:27], s64 offen offset:0 sc1 lds
v_mfma_f32_16x16x32_bf16 v[204:207], a[180:183], a[84:87], v[204:207]
ds_read_b64_tr_b16 a[132:133], v11 offset:4096
ds_read_b64_tr_b16 a[134:135], v11 offset:4608
v_mfma_f32_16x16x32_bf16 v[212:215], a[188:191], a[84:87], v[212:215]
ds_read_b64_tr_b16 a[136:137], v12 offset:0
ds_read_b64_tr_b16 a[138:139], v12 offset:512
v_mfma_f32_16x16x32_bf16 v[212:215], a[184:187], a[80:83], v[212:215]
ds_read_b64_tr_b16 a[140:141], v12 offset:4096
ds_read_b64_tr_b16 a[142:143], v12 offset:4608
v_mfma_f32_16x16x32_bf16 v[72:75], a[112:115], a[80:83], v[72:75]
ds_read_b64_tr_b16 a[192:193], v23 offset:0
ds_read_b64_tr_b16 a[194:195], v23 offset:2048
v_mfma_f32_16x16x32_bf16 v[72:75], a[116:119], a[84:87], v[72:75]
ds_read_b64_tr_b16 a[144:145], v13 offset:0
ds_read_b64_tr_b16 a[146:147], v13 offset:512
v_mfma_f32_16x16x32_bf16 v[220:223], a[124:127], a[84:87], v[220:223]
ds_read_b64_tr_b16 a[196:197], v23 offset:32
ds_read_b64_tr_b16 a[198:199], v23 offset:2080
v_mfma_f32_16x16x32_bf16 v[220:223], a[120:123], a[80:83], v[220:223]
ds_read_b64_tr_b16 a[148:149], v13 offset:4096
ds_read_b64_tr_b16 a[150:151], v13 offset:4608
v_mfma_f32_16x16x32_bf16 v[252:255], a[120:123], a[88:91], v[252:255]
ds_read_b64_tr_b16 a[200:201], v23 offset:64
ds_read_b64_tr_b16 a[202:203], v23 offset:2112
v_mfma_f32_16x16x32_bf16 v[252:255], a[124:127], a[92:95], v[252:255]
ds_read_b64_tr_b16 a[152:153], v14 offset:0
ds_read_b64_tr_b16 a[154:155], v14 offset:512
v_mfma_f32_16x16x32_bf16 v[160:163], a[116:119], a[92:95], v[160:163]
buffer_load_dwordx4 v4, s[24:27], s64 offen offset:1024 sc1 lds
v_mfma_f32_16x16x32_bf16 v[160:163], a[112:115], a[88:91], v[160:163]
ds_read_b64_tr_b16 a[156:157], v14 offset:4096
ds_read_b64_tr_b16 a[158:159], v14 offset:4608
v_mfma_f32_16x16x32_bf16 v[228:231], a[184:187], a[88:91], v[228:231]
ds_read_b64_tr_b16 a[204:205], v23 offset:96
ds_read_b64_tr_b16 a[206:207], v23 offset:2144
v_mfma_f32_16x16x32_bf16 v[228:231], a[188:191], a[92:95], v[228:231]
ds_read_b64_tr_b16 a[208:209], v27 offset:4096
ds_read_b64_tr_b16 a[210:211], v27 offset:4608
v_mfma_f32_16x16x32_bf16 v[168:171], a[180:183], a[92:95], v[168:171]
ds_read_b128 a[64:67], v4 offset:8192
v_mfma_f32_16x16x32_bf16 v[168:171], a[176:179], a[88:91], v[168:171]
s_add_u32 s53, s87, 790528
ds_read_b64_tr_b16 a[212:213], v27 offset:5120
ds_read_b64_tr_b16 a[214:215], v27 offset:5632
v_mfma_f32_16x16x32_bf16 v[176:179], a[168:171], a[88:91], v[176:179]
ds_read_b128 a[80:83], v9 offset:0
v_readlane_b32 s81, v26, 0
v_mfma_f32_16x16x32_bf16 v[176:179], a[172:175], a[92:95], v[176:179]
buffer_store_dwordx4 a[24:27], v4, s[24:27], s53 offen offset:1024 sc1
v_mfma_f32_16x16x32_bf16 v[80:83], a[164:167], a[92:95], v[80:83]
ds_read_b128 a[68:71], v4 offset:10240
v_readlane_b32 s82, v26, 1
v_mfma_f32_16x16x32_bf16 v[80:83], a[160:163], a[88:91], v[80:83]
v_readlane_b32 s71, v26, 2
v_readlane_b32 s72, v26, 3
v_mfma_f32_16x16x32_bf16 v[184:187], a[160:163], a[96:99], v[184:187]
ds_read_b128 a[84:87], v10 offset:0
v_readlane_b32 s74, v26, 4
v_mfma_f32_16x16x32_bf16 v[184:187], a[164:167], a[100:103], v[184:187]
buffer_load_dwordx4 v4, s[24:27], s64 offen offset:2048 sc1 lds
v_mfma_f32_16x16x32_bf16 v[248:251], a[172:175], a[100:103], v[248:251]
v_readlane_b32 s75, v26, 5
v_mfma_f32_16x16x32_bf16 v[248:251], a[168:171], a[96:99], v[248:251]
ds_read_b128 a[72:75], v4 offset:9216
v_mfma_f32_16x16x32_bf16 v[240:243], a[176:179], a[96:99], v[240:243]
v_mfma_f32_16x16x32_bf16 v[240:243], a[180:183], a[100:103], v[240:243]
ds_read_b128 a[88:91], v9 offset:2048
v_mfma_f32_16x16x32_bf16 v[232:235], a[188:191], a[100:103], v[232:235]
v_mfma_f32_16x16x32_bf16 v[232:235], a[184:187], a[96:99], v[232:235]
ds_read_b128 a[76:79], v4 offset:11264
v_mfma_f32_16x16x32_bf16 v[236:239], a[112:115], a[96:99], v[236:239]
v_mfma_f32_16x16x32_bf16 v[236:239], a[116:119], a[100:103], v[236:239]
ds_read_b128 a[92:95], v10 offset:2048
v_mfma_f32_16x16x32_bf16 v[224:227], a[124:127], a[100:103], v[224:227]
v_mfma_f32_16x16x32_bf16 v[224:227], a[120:123], a[96:99], v[224:227]
buffer_load_dwordx4 v4, s[24:27], s64 offen offset:3072 sc1 lds
v_mfma_f32_16x16x32_bf16 v[208:211], a[120:123], a[104:107], v[208:211]
v_mfma_f32_16x16x32_bf16 v[208:211], a[124:127], a[108:111], v[208:211]
v_mfma_f32_16x16x32_bf16 v[216:219], a[116:119], a[108:111], v[216:219]
v_mfma_f32_16x16x32_bf16 v[216:219], a[112:115], a[104:107], v[216:219]
v_mfma_f32_16x16x32_bf16 v[244:247], a[184:187], a[104:107], v[244:247]
v_mfma_f32_16x16x32_bf16 v[244:247], a[188:191], a[108:111], v[244:247]
v_mfma_f32_16x16x32_bf16 v[192:195], a[180:183], a[108:111], v[192:195]
v_mfma_f32_16x16x32_bf16 v[192:195], a[176:179], a[104:107], v[192:195]
v_mfma_f32_16x16x32_bf16 v[200:203], a[168:171], a[104:107], v[200:203]
v_mfma_f32_16x16x32_bf16 v[200:203], a[172:175], a[108:111], v[200:203]
v_mfma_f32_16x16x32_bf16 v[88:91], a[164:167], a[108:111], v[88:91]
v_mfma_f32_16x16x32_bf16 v[88:91], a[160:163], a[104:107], v[88:91]
s_waitcnt lgkmcnt(0)
v_mfma_f32_16x16x32_bf16 v[36:39], a[128:131], a[80:83], v[36:39]
s_waitcnt vmcnt(18)
v_mfma_f32_16x16x32_bf16 v[36:39], a[132:135], a[84:87], v[36:39]
s_barrier
v_mfma_f32_16x16x32_bf16 v[44:47], a[140:143], a[84:87], v[44:47]
ds_read_b128 a[96:99], v9 offset:4096
v_mfma_f32_16x16x32_bf16 v[44:47], a[136:139], a[80:83], v[44:47]
s_add_u32 m0, s70, 65536
s_add_u32 s64, s68, 32768
ds_read_b128 a[100:103], v10 offset:4096
v_mfma_f32_16x16x32_bf16 v[32:35], a[144:147], a[80:83], v[32:35]
buffer_load_dwordx4 v4, s[24:27], s64 offen offset:0 sc1 lds
v_mfma_f32_16x16x32_bf16 v[32:35], a[148:151], a[84:87], v[32:35]
ds_read_b128 a[104:107], v9 offset:6144
v_mfma_f32_16x16x32_bf16 v[52:55], a[156:159], a[84:87], v[52:55]
ds_read_b64_tr_b16 a[160:161], v11 offset:16384
ds_read_b64_tr_b16 a[162:163], v11 offset:16896
v_mfma_f32_16x16x32_bf16 v[52:55], a[152:155], a[80:83], v[52:55]
buffer_store_dwordx4 a[192:195], v4, s[24:27], s81 offen sc1
v_mfma_f32_16x16x32_bf16 v[60:63], a[64:67], a[80:83], v[60:63]
v_mfma_f32_16x16x32_bf16 v[60:63], a[68:71], a[84:87], v[60:63]
ds_read_b128 a[108:111], v10 offset:6144
v_mfma_f32_16x16x32_bf16 v[68:71], a[76:79], a[84:87], v[68:71]
v_cvt_pk_bf16_f32 v36, v36, v37
v_cvt_pk_bf16_f32 v37, v38, v39
v_mfma_f32_16x16x32_bf16 v[68:71], a[72:75], a[80:83], v[68:71]
ds_read_b64_tr_b16 a[164:165], v11 offset:20480
ds_read_b64_tr_b16 a[166:167], v11 offset:20992
v_mfma_f32_16x16x32_bf16 v[76:79], a[72:75], a[88:91], v[76:79]
buffer_store_dwordx4 a[196:199], v4, s[24:27], s82 offen sc1
v_mfma_f32_16x16x32_bf16 v[76:79], a[76:79], a[92:95], v[76:79]
ds_read_b64_tr_b16 a[168:169], v12 offset:16384
ds_read_b64_tr_b16 a[170:171], v12 offset:16896
v_mfma_f32_16x16x32_bf16 v[84:87], a[68:71], a[92:95], v[84:87]
buffer_load_dwordx4 v4, s[24:27], s64 offen offset:1024 sc1 lds
v_mfma_f32_16x16x32_bf16 v[84:87], a[64:67], a[88:91], v[84:87]
ds_read_b64_tr_b16 a[172:173], v12 offset:20480
ds_read_b64_tr_b16 a[174:175], v12 offset:20992
v_mfma_f32_16x16x32_bf16 v[92:95], a[152:155], a[88:91], v[92:95]
v_cvt_pk_bf16_f32 v38, v44, v45
v_cvt_pk_bf16_f32 v39, v46, v47
v_mfma_f32_16x16x32_bf16 v[92:95], a[156:159], a[92:95], v[92:95]
buffer_store_dwordx4 a[200:203], v4, s[24:27], s71 offen sc1
v_mfma_f32_16x16x32_bf16 v[40:43], a[148:151], a[92:95], v[40:43]
ds_read_b64_tr_b16 a[176:177], v13 offset:16384
ds_read_b64_tr_b16 a[178:179], v13 offset:16896
v_mfma_f32_16x16x32_bf16 v[40:43], a[144:147], a[88:91], v[40:43]
v_accvgpr_write_b32 a32, v36
v_accvgpr_write_b32 a33, v37
v_mfma_f32_16x16x32_bf16 v[100:103], a[136:139], a[88:91], v[100:103]
ds_read_b64_tr_b16 a[180:181], v13 offset:20480
ds_read_b64_tr_b16 a[182:183], v13 offset:20992
v_mfma_f32_16x16x32_bf16 v[100:103], a[140:143], a[92:95], v[100:103]
v_accvgpr_write_b32 a34, v38
v_accvgpr_write_b32 a35, v39
v_mfma_f32_16x16x32_bf16 v[108:111], a[132:135], a[92:95], v[108:111]
ds_read_b64_tr_b16 a[184:185], v14 offset:16384
ds_read_b64_tr_b16 a[186:187], v14 offset:16896
v_mfma_f32_16x16x32_bf16 v[108:111], a[128:131], a[88:91], v[108:111]
s_waitcnt lgkmcnt(15)
v_cvt_pk_bf16_f32 v32, v32, v33
v_cvt_pk_bf16_f32 v33, v34, v35
v_mfma_f32_16x16x32_bf16 v[116:119], a[128:131], a[96:99], v[116:119]
ds_read_b64_tr_b16 a[188:189], v14 offset:20480
ds_read_b64_tr_b16 a[190:191], v14 offset:20992
v_mfma_f32_16x16x32_bf16 v[116:119], a[132:135], a[100:103], v[116:119]
buffer_load_dwordx4 v4, s[24:27], s64 offen offset:2048 sc1 lds
v_mfma_f32_16x16x32_bf16 v[124:127], a[140:143], a[100:103], v[124:127]
buffer_store_dwordx4 a[204:207], v4, s[24:27], s72 offen sc1
v_mfma_f32_16x16x32_bf16 v[124:127], a[136:139], a[96:99], v[124:127]
ds_read_b128 a[112:115], v4 offset:24576
v_cvt_pk_bf16_f32 v34, v52, v53
v_mfma_f32_16x16x32_bf16 v[132:135], a[144:147], a[96:99], v[132:135]
v_cvt_pk_bf16_f32 v35, v54, v55
v_accvgpr_write_b32 a36, v32
v_mfma_f32_16x16x32_bf16 v[132:135], a[148:151], a[100:103], v[132:135]
ds_read_b128 a[116:119], v4 offset:26624
v_accvgpr_write_b32 a37, v33
v_mfma_f32_16x16x32_bf16 v[140:143], a[156:159], a[100:103], v[140:143]
v_accvgpr_write_b32 a38, v34
v_accvgpr_write_b32 a39, v35
v_mfma_f32_16x16x32_bf16 v[140:143], a[152:155], a[96:99], v[140:143]
ds_read_b128 a[120:123], v4 offset:25600
v_cvt_pk_bf16_f32 v40, v40, v41
v_mfma_f32_16x16x32_bf16 v[148:151], a[64:67], a[96:99], v[148:151]
buffer_store_dwordx4 a[208:211], v4, s[24:27], s74 offen sc1
v_mfma_f32_16x16x32_bf16 v[148:151], a[68:71], a[100:103], v[148:151]
ds_read_b128 a[124:127], v4 offset:27648
v_cvt_pk_bf16_f32 v41, v42, v43
v_mfma_f32_16x16x32_bf16 v[48:51], a[76:79], a[100:103], v[48:51]
s_waitcnt lgkmcnt(15)
v_cvt_pk_bf16_f32 v42, v92, v93
v_cvt_pk_bf16_f32 v43, v94, v95
v_mfma_f32_16x16x32_bf16 v[48:51], a[72:75], a[96:99], v[48:51]
buffer_load_dwordx4 v4, s[24:27], s64 offen offset:3072 sc1 lds
v_mfma_f32_16x16x32_bf16 v[156:159], a[72:75], a[104:107], v[156:159]
v_accvgpr_write_b32 a40, v40
v_accvgpr_write_b32 a41, v41
v_mfma_f32_16x16x32_bf16 v[156:159], a[76:79], a[108:111], v[156:159]
buffer_store_dwordx4 a[212:215], v4, s[24:27], s75 offen sc1
v_mfma_f32_16x16x32_bf16 v[164:167], a[68:71], a[108:111], v[164:167]
v_accvgpr_write_b32 a42, v42
v_accvgpr_write_b32 a43, v43
v_mfma_f32_16x16x32_bf16 v[164:167], a[64:67], a[104:107], v[164:167]
v_cvt_pk_bf16_f32 v108, v108, v109
v_cvt_pk_bf16_f32 v109, v110, v111
v_mfma_f32_16x16x32_bf16 v[172:175], a[152:155], a[104:107], v[172:175]
v_cvt_pk_bf16_f32 v110, v100, v101
v_cvt_pk_bf16_f32 v111, v102, v103
v_mfma_f32_16x16x32_bf16 v[172:175], a[156:159], a[108:111], v[172:175]
v_accvgpr_write_b32 a44, v108
v_accvgpr_write_b32 a45, v109
v_mfma_f32_16x16x32_bf16 v[56:59], a[148:151], a[108:111], v[56:59]
v_accvgpr_write_b32 a46, v110
v_accvgpr_write_b32 a47, v111
v_mfma_f32_16x16x32_bf16 v[56:59], a[144:147], a[104:107], v[56:59]
v_cvt_pk_bf16_f32 v116, v116, v117
v_cvt_pk_bf16_f32 v117, v118, v119
v_mfma_f32_16x16x32_bf16 v[180:183], a[136:139], a[104:107], v[180:183]
v_cvt_pk_bf16_f32 v118, v124, v125
v_cvt_pk_bf16_f32 v119, v126, v127
v_mfma_f32_16x16x32_bf16 v[180:183], a[140:143], a[108:111], v[180:183]
v_accvgpr_write_b32 a48, v116
v_accvgpr_write_b32 a49, v117
v_mfma_f32_16x16x32_bf16 v[188:191], a[132:135], a[108:111], v[188:191]
v_accvgpr_write_b32 a50, v118
v_accvgpr_write_b32 a51, v119
v_mfma_f32_16x16x32_bf16 v[188:191], a[128:131], a[104:107], v[188:191]
s_waitcnt lgkmcnt(0)
v_cvt_pk_bf16_f32 v132, v132, v133
v_cvt_pk_bf16_f32 v133, v134, v135
v_mfma_f32_16x16x32_bf16 v[196:199], a[160:163], a[80:83], v[196:199]
s_waitcnt vmcnt(16)
v_cvt_pk_bf16_f32 v134, v140, v141
v_cvt_pk_bf16_f32 v135, v142, v143
v_mfma_f32_16x16x32_bf16 v[196:199], a[164:167], a[84:87], v[196:199]
s_barrier
v_mfma_f32_16x16x32_bf16 v[64:67], a[172:175], a[84:87], v[64:67]
ds_read_b128 a[192:195], v4 offset:32768
v_accvgpr_write_b32 a52, v132
v_mfma_f32_16x16x32_bf16 v[64:67], a[168:171], a[80:83], v[64:67]
s_add_u32 m0, s70, 81920
s_add_u32 s64, s68, 49152
v_accvgpr_write_b32 a53, v133
v_mfma_f32_16x16x32_bf16 v[204:207], a[176:179], a[80:83], v[204:207]
buffer_load_dwordx4 v4, s[24:27], s64 offen offset:0 sc1 lds
v_mfma_f32_16x16x32_bf16 v[204:207], a[180:183], a[84:87], v[204:207]
ds_read_b128 a[196:199], v4 offset:33792
v_accvgpr_write_b32 a54, v134
v_mfma_f32_16x16x32_bf16 v[212:215], a[188:191], a[84:87], v[212:215]
v_accvgpr_write_b32 a55, v135
v_cvt_pk_bf16_f32 v56, v56, v57
v_mfma_f32_16x16x32_bf16 v[212:215], a[184:187], a[80:83], v[212:215]
ds_read_b128 a[200:203], v4 offset:34816
v_cvt_pk_bf16_f32 v57, v58, v59
v_mfma_f32_16x16x32_bf16 v[80:83], a[160:163], a[88:91], v[80:83]
v_cvt_pk_bf16_f32 v58, v172, v173
v_cvt_pk_bf16_f32 v59, v174, v175
v_mfma_f32_16x16x32_bf16 v[80:83], a[164:167], a[92:95], v[80:83]
ds_read_b128 a[204:207], v4 offset:35840
v_accvgpr_write_b32 a56, v56
v_mfma_f32_16x16x32_bf16 v[176:179], a[172:175], a[92:95], v[176:179]
v_accvgpr_write_b32 a57, v57
v_accvgpr_write_b32 a58, v58
v_mfma_f32_16x16x32_bf16 v[176:179], a[168:171], a[88:91], v[176:179]
ds_read_b128 a[208:211], v4 offset:36864
v_accvgpr_write_b32 a59, v59
v_mfma_f32_16x16x32_bf16 v[168:171], a[176:179], a[88:91], v[168:171]
v_cvt_pk_bf16_f32 v188, v188, v189
v_cvt_pk_bf16_f32 v189, v190, v191
v_mfma_f32_16x16x32_bf16 v[168:171], a[180:183], a[92:95], v[168:171]
ds_read_b128 a[212:215], v4 offset:37888
v_cvt_pk_bf16_f32 v190, v180, v181
v_mfma_f32_16x16x32_bf16 v[228:231], a[188:191], a[92:95], v[228:231]
buffer_load_dwordx4 v4, s[24:27], s64 offen offset:1024 sc1 lds
v_mfma_f32_16x16x32_bf16 v[228:231], a[184:187], a[88:91], v[228:231]
ds_read_b128 a[216:219], v4 offset:38912
v_cvt_pk_bf16_f32 v191, v182, v183
v_mfma_f32_16x16x32_bf16 v[184:187], a[160:163], a[96:99], v[184:187]
v_accvgpr_write_b32 a60, v188
v_accvgpr_write_b32 a61, v189
v_mfma_f32_16x16x32_bf16 v[184:187], a[164:167], a[100:103], v[184:187]
ds_read_b128 a[220:223], v4 offset:39936
v_accvgpr_write_b32 a62, v190
v_mfma_f32_16x16x32_bf16 v[248:251], a[172:175], a[100:103], v[248:251]
v_accvgpr_write_b32 a63, v191
v_cvt_pk_bf16_f32 v196, v196, v197
v_mfma_f32_16x16x32_bf16 v[248:251], a[168:171], a[96:99], v[248:251]
v_cvt_pk_bf16_f32 v197, v198, v199
v_cvt_pk_bf16_f32 v198, v64, v65
v_mfma_f32_16x16x32_bf16 v[240:243], a[176:179], a[96:99], v[240:243]
v_cvt_pk_bf16_f32 v199, v66, v67
v_accvgpr_write_b32 a28, v196
v_mfma_f32_16x16x32_bf16 v[240:243], a[180:183], a[100:103], v[240:243]
v_accvgpr_write_b32 a29, v197
v_accvgpr_write_b32 a30, v198
v_mfma_f32_16x16x32_bf16 v[232:235], a[188:191], a[100:103], v[232:235]
v_accvgpr_write_b32 a31, v199
v_cvt_pk_bf16_f32 v204, v204, v205
v_mfma_f32_16x16x32_bf16 v[232:235], a[184:187], a[96:99], v[232:235]
v_cvt_pk_bf16_f32 v205, v206, v207
v_cvt_pk_bf16_f32 v206, v212, v213
v_mfma_f32_16x16x32_bf16 v[88:91], a[160:163], a[104:107], v[88:91]
v_cvt_pk_bf16_f32 v207, v214, v215
v_accvgpr_write_b32 a20, v204
v_mfma_f32_16x16x32_bf16 v[88:91], a[164:167], a[108:111], v[88:91]
buffer_load_dwordx4 v4, s[24:27], s64 offen offset:2048 sc1 lds
v_mfma_f32_16x16x32_bf16 v[200:203], a[172:175], a[108:111], v[200:203]
v_accvgpr_write_b32 a21, v205
v_accvgpr_write_b32 a22, v206
v_mfma_f32_16x16x32_bf16 v[200:203], a[168:171], a[104:107], v[200:203]
v_accvgpr_write_b32 a23, v207
v_cvt_pk_bf16_f32 v80, v80, v81
v_mfma_f32_16x16x32_bf16 v[192:195], a[176:179], a[104:107], v[192:195]
v_cvt_pk_bf16_f32 v81, v82, v83
v_cvt_pk_bf16_f32 v82, v176, v177
v_mfma_f32_16x16x32_bf16 v[192:195], a[180:183], a[108:111], v[192:195]
v_cvt_pk_bf16_f32 v83, v178, v179
v_accvgpr_write_b32 a12, v80
v_mfma_f32_16x16x32_bf16 v[244:247], a[188:191], a[108:111], v[244:247]
v_accvgpr_write_b32 a13, v81
v_accvgpr_write_b32 a14, v82
v_mfma_f32_16x16x32_bf16 v[244:247], a[184:187], a[104:107], v[244:247]
v_accvgpr_write_b32 a15, v83
v_cvt_pk_bf16_f32 v168, v168, v169
v_mfma_f32_16x16x32_bf16 v[72:75], a[112:115], a[80:83], v[72:75]
v_cvt_pk_bf16_f32 v169, v170, v171
v_cvt_pk_bf16_f32 v170, v228, v229
v_mfma_f32_16x16x32_bf16 v[72:75], a[116:119], a[84:87], v[72:75]
v_cvt_pk_bf16_f32 v171, v230, v231
v_accvgpr_write_b32 a4, v168
v_mfma_f32_16x16x32_bf16 v[220:223], a[124:127], a[84:87], v[220:223]
v_accvgpr_write_b32 a5, v169
v_accvgpr_write_b32 a6, v170
v_mfma_f32_16x16x32_bf16 v[220:223], a[120:123], a[80:83], v[220:223]
buffer_load_dwordx4 v4, s[24:27], s64 offen offset:3072 sc1 lds
v_mfma_f32_16x16x32_bf16 v[160:163], a[112:115], a[88:91], v[160:163]
v_accvgpr_write_b32 a7, v171
v_cvt_pk_bf16_f32 v184, v184, v185
v_mfma_f32_16x16x32_bf16 v[160:163], a[116:119], a[92:95], v[160:163]
v_cvt_pk_bf16_f32 v185, v186, v187
v_cvt_pk_bf16_f32 v186, v248, v249
v_mfma_f32_16x16x32_bf16 v[252:255], a[124:127], a[92:95], v[252:255]
v_cvt_pk_bf16_f32 v187, v250, v251
v_accvgpr_write_b32 a0, v184
v_mfma_f32_16x16x32_bf16 v[252:255], a[120:123], a[88:91], v[252:255]
v_accvgpr_write_b32 a1, v185
v_accvgpr_write_b32 a2, v186
v_mfma_f32_16x16x32_bf16 v[236:239], a[112:115], a[96:99], v[236:239]
v_accvgpr_write_b32 a3, v187
v_cvt_pk_bf16_f32 v240, v240, v241
v_mfma_f32_16x16x32_bf16 v[236:239], a[116:119], a[100:103], v[236:239]
v_cvt_pk_bf16_f32 v241, v242, v243
v_cvt_pk_bf16_f32 v242, v232, v233
v_mfma_f32_16x16x32_bf16 v[224:227], a[124:127], a[100:103], v[224:227]
v_cvt_pk_bf16_f32 v243, v234, v235
v_accvgpr_write_b32 a8, v240
v_mfma_f32_16x16x32_bf16 v[224:227], a[120:123], a[96:99], v[224:227]
v_accvgpr_write_b32 a9, v241
v_accvgpr_write_b32 a10, v242
v_mfma_f32_16x16x32_bf16 v[216:219], a[112:115], a[104:107], v[216:219]
v_accvgpr_write_b32 a11, v243
v_cvt_pk_bf16_f32 v88, v88, v89
v_mfma_f32_16x16x32_bf16 v[216:219], a[116:119], a[108:111], v[216:219]
v_cvt_pk_bf16_f32 v89, v90, v91
v_cvt_pk_bf16_f32 v90, v200, v201
v_mfma_f32_16x16x32_bf16 v[208:211], a[124:127], a[108:111], v[208:211]
v_cvt_pk_bf16_f32 v91, v202, v203
v_accvgpr_write_b32 a16, v88
v_mfma_f32_16x16x32_bf16 v[208:211], a[120:123], a[104:107], v[208:211]
s_waitcnt lgkmcnt(0)
v_accvgpr_write_b32 a17, v89
v_accvgpr_write_b32 a18, v90
v_mfma_f32_16x16x32_bf16 v[44:47], a[192:195], a[32:35], v[96:99]
v_accvgpr_write_b32 a19, v91
v_cvt_pk_bf16_f32 v192, v192, v193
v_mfma_f32_16x16x32_bf16 v[44:47], a[196:199], a[36:39], v[44:47]
v_cvt_pk_bf16_f32 v193, v194, v195
v_cvt_pk_bf16_f32 v194, v244, v245
v_mfma_f32_16x16x32_bf16 v[44:47], a[200:203], a[28:31], v[44:47]
v_cvt_pk_bf16_f32 v195, v246, v247
v_accvgpr_write_b32 a24, v192
v_mfma_f32_16x16x32_bf16 v[44:47], a[204:207], a[20:23], v[44:47]
v_accvgpr_write_b32 a25, v193
v_accvgpr_write_b32 a26, v194
v_mfma_f32_16x16x32_bf16 v[52:55], a[192:195], a[44:47], v[104:107]
ds_bpermute_b32 v8, v17, v63
v_accvgpr_write_b32 a27, v195
v_mfma_f32_16x16x32_bf16 v[52:55], a[196:199], a[40:43], v[52:55]
v_cvt_pk_bf16_f32 v60, v60, v61
v_cvt_pk_bf16_f32 v61, v62, v63
v_mfma_f32_16x16x32_bf16 v[52:55], a[200:203], a[12:15], v[52:55]
v_cvt_pk_bf16_f32 v62, v68, v69
v_cvt_pk_bf16_f32 v63, v70, v71
v_mfma_f32_16x16x32_bf16 v[52:55], a[204:207], a[4:7], v[52:55]
v_accvgpr_write_b32 a128, v60
v_accvgpr_write_b32 a129, v61
v_mfma_f32_16x16x32_bf16 v[64:67], a[208:211], a[32:35], v[112:115]
v_accvgpr_write_b32 a130, v62
v_accvgpr_write_b32 a131, v63
v_mfma_f32_16x16x32_bf16 v[64:67], a[212:215], a[36:39], v[64:67]
ds_bpermute_b32 v9, v17, v87
v_cvt_pk_bf16_f32 v84, v84, v85
v_mfma_f32_16x16x32_bf16 v[64:67], a[216:219], a[28:31], v[64:67]
v_cvt_pk_bf16_f32 v85, v86, v87
v_cvt_pk_bf16_f32 v86, v76, v77
v_mfma_f32_16x16x32_bf16 v[64:67], a[220:223], a[20:23], v[64:67]
v_cvt_pk_bf16_f32 v87, v78, v79
v_mfma_f32_16x16x32_bf16 v[212:215], a[208:211], a[44:47], v[120:123]
buffer_store_dwordx4 v[84:87], v18, s[24:27], s54 offen offset:256 sc1
v_mfma_f32_16x16x32_bf16 v[212:215], a[212:215], a[40:43], v[212:215]
v_accvgpr_write_b32 a136, v84
v_accvgpr_write_b32 a137, v85
v_mfma_f32_16x16x32_bf16 v[212:215], a[216:219], a[12:15], v[212:215]
v_accvgpr_write_b32 a138, v86
v_accvgpr_write_b32 a139, v87
v_mfma_f32_16x16x32_bf16 v[212:215], a[220:223], a[4:7], v[212:215]
s_waitcnt vmcnt(15)
ds_bpermute_b32 v10, v17, v151
v_cvt_pk_bf16_f32 v148, v148, v149
v_mfma_f32_16x16x32_bf16 v[100:103], a[192:195], a[48:51], v[128:131]
s_barrier
v_cvt_pk_bf16_f32 v149, v150, v151
v_cvt_pk_bf16_f32 v150, v48, v49
v_mfma_f32_16x16x32_bf16 v[100:103], a[196:199], a[52:55], v[100:103]
v_cvt_pk_bf16_f32 v151, v50, v51
v_accvgpr_write_b32 a144, v148
v_mfma_f32_16x16x32_bf16 v[100:103], a[200:203], a[0:3], v[100:103]
ds_bpermute_b32 v11, v17, v167
v_accvgpr_write_b32 a145, v149
v_mfma_f32_16x16x32_bf16 v[100:103], a[204:207], a[8:11], v[100:103]
v_cvt_pk_bf16_f32 v164, v164, v165
v_cvt_pk_bf16_f32 v165, v166, v167
v_mfma_f32_16x16x32_bf16 v[92:95], a[192:195], a[60:63], v[136:139]
v_cvt_pk_bf16_f32 v166, v156, v157
v_cvt_pk_bf16_f32 v167, v158, v159
v_mfma_f32_16x16x32_bf16 v[92:95], a[196:199], a[56:59], v[92:95]
buffer_store_dwordx4 v[164:167], v18, s[24:27], s55 offen offset:256 sc1
v_mfma_f32_16x16x32_bf16 v[92:95], a[200:203], a[16:19], v[92:95]
v_cvt_pk_bf16_f32 v72, v72, v73
v_cvt_pk_bf16_f32 v73, v74, v75
v_mfma_f32_16x16x32_bf16 v[92:95], a[204:207], a[24:27], v[92:95]
v_cvt_pk_bf16_f32 v74, v220, v221
v_cvt_pk_bf16_f32 v75, v222, v223
v_mfma_f32_16x16x32_bf16 v[176:179], a[208:211], a[48:51], v[144:147]
v_cvt_pk_bf16_f32 v160, v160, v161
v_cvt_pk_bf16_f32 v161, v162, v163
v_mfma_f32_16x16x32_bf16 v[176:179], a[212:215], a[52:55], v[176:179]
L_PAD8:
s_cbranch_execz L_PAD12
v_cvt_pk_bf16_f32 v162, v252, v253
v_cvt_pk_bf16_f32 v163, v254, v255
v_mfma_f32_16x16x32_bf16 v[176:179], a[216:219], a[0:3], v[176:179]
buffer_store_dwordx4 v[160:163], v19, s[24:27], s54 offen offset:256 sc1
v_mfma_f32_16x16x32_bf16 v[176:179], a[220:223], a[8:11], v[176:179]
v_cvt_pk_bf16_f32 v236, v236, v237
v_cvt_pk_bf16_f32 v237, v238, v239
v_mfma_f32_16x16x32_bf16 v[228:231], a[208:211], a[60:63], v[152:155]
v_cvt_pk_bf16_f32 v238, v224, v225
v_cvt_pk_bf16_f32 v239, v226, v227
v_mfma_f32_16x16x32_bf16 v[228:231], a[212:215], a[56:59], v[228:231]
v_cvt_pk_bf16_f32 v216, v216, v217
v_cvt_pk_bf16_f32 v217, v218, v219
v_mfma_f32_16x16x32_bf16 v[228:231], a[216:219], a[16:19], v[228:231]
v_cvt_pk_bf16_f32 v218, v208, v209
v_cvt_pk_bf16_f32 v219, v210, v211
v_mfma_f32_16x16x32_bf16 v[228:231], a[220:223], a[24:27], v[228:231]
buffer_store_dwordx4 v[216:219], v19, s[24:27], s55 offen offset:256 sc1
ds_read_b128 a[64:67], v4 offset:57344
ds_read_b128 a[68:71], v4 offset:58368
ds_read_b128 a[72:75], v4 offset:59392
ds_read_b128 a[76:79], v4 offset:60416
ds_read_b128 a[80:83], v4 offset:61440
ds_read_b128 a[84:87], v4 offset:62464
ds_read_b128 a[88:91], v4 offset:63488
ds_read_b128 a[92:95], v4 offset:64512
s_add_u32 m0, s70, 98304
s_add_u32 s64, s68, 65536
buffer_load_dwordx4 v4, s[24:27], s64 offen offset:0 sc1 lds
v_max3_f32 v24, v44, v45, v46
v_max3_f32 v25, v47, v64, v65
v_max3_f32 v26, v52, v53, v54
v_max3_f32 v27, v55, v212, v213
v_max3_f32 v24, v24, v66, v67
v_max_f32 v24, v24, v25
v_max3_f32 v26, v26, v214, v215
v_max_f32 v26, v26, v27
v_mov_b32 v25, v24
buffer_load_dwordx4 v4, s[24:27], s64 offen offset:1024 sc1 lds
v_mov_b32 v27, v26
s_nop 1
v_permlane32_swap_b32 v25, v24
v_permlane32_swap_b32 v27, v26
s_nop 0
v_max_f32 v24, v24, v25
v_max_f32 v26, v26, v27
v_mov_b32 v25, v24
v_mov_b32 v27, v26
buffer_load_dwordx4 v4, s[24:27], s64 offen offset:2048 sc1 lds
s_nop 1
v_permlane16_swap_b32 v25, v24
v_permlane16_swap_b32 v27, v26
s_nop 0
v_max_f32 v24, v24, v25
v_max_f32 v26, v26, v27
v_pk_add_f32 v[44:45], v[44:45], v[24:25] op_sel_hi:[1,0] neg_lo:[0,1] neg_hi:[0,1]
v_pk_add_f32 v[46:47], v[46:47], v[24:25] op_sel_hi:[1,0] neg_lo:[0,1] neg_hi:[0,1]
v_pk_add_f32 v[52:53], v[52:53], v[26:27] op_sel_hi:[1,0] neg_lo:[0,1] neg_hi:[0,1]
buffer_load_dwordx4 v4, s[24:27], s64 offen offset:3072 sc1 lds
v_pk_add_f32 v[54:55], v[54:55], v[26:27] op_sel_hi:[1,0] neg_lo:[0,1] neg_hi:[0,1]
v_pk_add_f32 v[64:65], v[64:65], v[24:25] op_sel_hi:[1,0] neg_lo:[0,1] neg_hi:[0,1]
v_pk_add_f32 v[66:67], v[66:67], v[24:25] op_sel_hi:[1,0] neg_lo:[0,1] neg_hi:[0,1]
v_pk_add_f32 v[212:213], v[212:213], v[26:27] op_sel_hi:[1,0] neg_lo:[0,1] neg_hi:[0,1]
v_pk_add_f32 v[214:215], v[214:215], v[26:27] op_sel_hi:[1,0] neg_lo:[0,1] neg_hi:[0,1]
v_pk_add_f32 v[96:97], v[96:97], v[24:25] op_sel_hi:[1,0] neg_lo:[0,1] neg_hi:[0,1]
v_pk_add_f32 v[98:99], v[98:99], v[24:25] op_sel_hi:[1,0] neg_lo:[0,1] neg_hi:[0,1]
v_pk_add_f32 v[104:105], v[104:105], v[26:27] op_sel_hi:[1,0] neg_lo:[0,1] neg_hi:[0,1]
v_pk_add_f32 v[106:107], v[106:107], v[26:27] op_sel_hi:[1,0] neg_lo:[0,1] neg_hi:[0,1]
s_add_u32 m0, s70, 114688
s_add_u32 s64, s68, 81920
buffer_load_dwordx4 v4, s[24:27], s64 offen offset:0 sc1 lds
v_pk_add_f32 v[112:113], v[112:113], v[24:25] op_sel_hi:[1,0] neg_lo:[0,1] neg_hi:[0,1]
v_pk_add_f32 v[114:115], v[114:115], v[24:25] op_sel_hi:[1,0] neg_lo:[0,1] neg_hi:[0,1]
v_pk_add_f32 v[120:121], v[120:121], v[26:27] op_sel_hi:[1,0] neg_lo:[0,1] neg_hi:[0,1]
v_pk_add_f32 v[122:123], v[122:123], v[26:27] op_sel_hi:[1,0] neg_lo:[0,1] neg_hi:[0,1]
v_exp_f32 v44, v44
v_exp_f32 v45, v45
v_exp_f32 v46, v46
v_exp_f32 v47, v47
v_cvt_pk_bf16_f32 v124, v44, v45
buffer_load_dwordx4 v4, s[24:27], s64 offen offset:1024 sc1 lds
v_exp_f32 v52, v52
v_exp_f32 v53, v53
v_cvt_pk_bf16_f32 v125, v46, v47
v_exp_f32 v54, v54
v_exp_f32 v55, v55
v_cvt_pk_bf16_f32 v140, v52, v53
v_exp_f32 v64, v64
v_exp_f32 v65, v65
v_cvt_pk_bf16_f32 v141, v54, v55
buffer_load_dwordx4 v4, s[24:27], s64 offen offset:2048 sc1 lds
v_exp_f32 v66, v66
v_exp_f32 v67, v67
v_cvt_pk_bf16_f32 v126, v64, v65
v_exp_f32 v212, v212
v_exp_f32 v213, v213
v_cvt_pk_bf16_f32 v127, v66, v67
v_exp_f32 v214, v214
v_exp_f32 v215, v215
v_cvt_pk_bf16_f32 v142, v212, v213
buffer_load_dwordx4 v4, s[24:27], s64 offen offset:3072 sc1 lds
v_max3_f32 v24, v100, v101, v102
v_cvt_pk_bf16_f32 v143, v214, v215
v_max3_f32 v25, v103, v176, v177
v_max3_f32 v26, v92, v93, v94
v_max3_f32 v27, v95, v228, v229
v_max3_f32 v24, v24, v178, v179
v_max_f32 v24, v24, v25
v_max3_f32 v26, v26, v230, v231
v_max_f32 v26, v26, v27
v_mov_b32 v25, v24
v_mov_b32 v27, v26
s_nop 1
v_permlane32_swap_b32 v25, v24
v_permlane32_swap_b32 v27, v26
s_nop 0
v_max_f32 v24, v24, v25
s_cmp_lt_u32 s3, 1
s_cbranch_scc1 L_SK5
s_add_u32 m0, s70, 131072
s_add_u32 s64, s68, 98304
buffer_load_dwordx4 v4, s[24:27], s64 offen offset:0 sc1 lds
buffer_load_dwordx4 v4, s[24:27], s64 offen offset:1024 sc1 lds
buffer_load_dwordx4 v4, s[24:27], s64 offen offset:2048 sc1 lds
buffer_load_dwordx4 v4, s[24:27], s64 offen offset:3072 sc1 lds
L_SK5:
v_max_f32 v26, v26, v27
v_mov_b32 v25, v24
v_mov_b32 v27, v26
s_nop 1
v_permlane16_swap_b32 v25, v24
v_permlane16_swap_b32 v27, v26
s_nop 0
v_max_f32 v24, v24, v25
v_max_f32 v26, v26, v27
v_pk_add_f32 v[100:101], v[100:101], v[24:25] op_sel_hi:[1,0] neg_lo:[0,1] neg_hi:[0,1]
v_pk_add_f32 v[102:103], v[102:103], v[24:25] op_sel_hi:[1,0] neg_lo:[0,1] neg_hi:[0,1]
v_pk_add_f32 v[92:93], v[92:93], v[26:27] op_sel_hi:[1,0] neg_lo:[0,1] neg_hi:[0,1]
v_pk_add_f32 v[94:95], v[94:95], v[26:27] op_sel_hi:[1,0] neg_lo:[0,1] neg_hi:[0,1]
v_pk_add_f32 v[176:177], v[176:177], v[24:25] op_sel_hi:[1,0] neg_lo:[0,1] neg_hi:[0,1]
v_pk_add_f32 v[178:179], v[178:179], v[24:25] op_sel_hi:[1,0] neg_lo:[0,1] neg_hi:[0,1]
v_pk_add_f32 v[228:229], v[228:229], v[26:27] op_sel_hi:[1,0] neg_lo:[0,1] neg_hi:[0,1]
v_pk_add_f32 v[230:231], v[230:231], v[26:27] op_sel_hi:[1,0] neg_lo:[0,1] neg_hi:[0,1]
v_pk_add_f32 v[128:129], v[128:129], v[24:25] op_sel_hi:[1,0] neg_lo:[0,1] neg_hi:[0,1]
v_pk_add_f32 v[130:131], v[130:131], v[24:25] op_sel_hi:[1,0] neg_lo:[0,1] neg_hi:[0,1]
v_pk_add_f32 v[136:137], v[136:137], v[26:27] op_sel_hi:[1,0] neg_lo:[0,1] neg_hi:[0,1]
v_pk_add_f32 v[138:139], v[138:139], v[26:27] op_sel_hi:[1,0] neg_lo:[0,1] neg_hi:[0,1]
v_pk_add_f32 v[144:145], v[144:145], v[24:25] op_sel_hi:[1,0] neg_lo:[0,1] neg_hi:[0,1]
v_pk_add_f32 v[146:147], v[146:147], v[24:25] op_sel_hi:[1,0] neg_lo:[0,1] neg_hi:[0,1]
v_pk_add_f32 v[152:153], v[152:153], v[26:27] op_sel_hi:[1,0] neg_lo:[0,1] neg_hi:[0,1]
v_pk_add_f32 v[154:155], v[154:155], v[26:27] op_sel_hi:[1,0] neg_lo:[0,1] neg_hi:[0,1]
v_accvgpr_write_b32 a146, v150
s_cmp_lt_u32 s3, 2
s_cbranch_scc1 L_SK6
s_add_u32 m0, s70, 147456
s_add_u32 s64, s68, 114688
buffer_load_dwordx4 v4, s[24:27], s64 offen offset:0 sc1 lds
buffer_load_dwordx4 v4, s[24:27], s64 offen offset:1024 sc1 lds
buffer_load_dwordx4 v4, s[24:27], s64 offen offset:2048 sc1 lds
buffer_load_dwordx4 v4, s[24:27], s64 offen offset:3072 sc1 lds
L_SK6:
v_accvgpr_write_b32 a147, v151
v_accvgpr_write_b32 a152, v164
v_accvgpr_write_b32 a153, v165
v_accvgpr_write_b32 a154, v166
v_accvgpr_write_b32 a155, v167
v_accvgpr_write_b32 a132, v72
v_accvgpr_write_b32 a133, v73
v_accvgpr_write_b32 a134, v74
v_accvgpr_write_b32 a135, v75
v_accvgpr_write_b32 a140, v160
v_accvgpr_write_b32 a141, v161
v_accvgpr_write_b32 a142, v162
v_accvgpr_write_b32 a143, v163
v_accvgpr_write_b32 a148, v236
v_accvgpr_write_b32 a149, v237
v_accvgpr_write_b32 a150, v238
v_accvgpr_write_b32 a151, v239
v_accvgpr_write_b32 a156, v216
v_accvgpr_write_b32 a157, v217
v_accvgpr_write_b32 a158, v218
v_accvgpr_write_b32 a159, v219
v_mov_b64 v[60:61], 0
v_mov_b64 v[62:63], 0
v_mov_b64 v[68:69], 0
v_mov_b64 v[70:71], 0
v_mov_b64 v[72:73], 0
s_cmp_lt_u32 s3, 3
s_cbranch_scc1 L_SK7
s_add_u32 m0, s70, 0
s_add_u32 s64, s68, 131072
buffer_load_dwordx4 v4, s[24:27], s64 offen offset:0 sc1 lds
buffer_load_dwordx4 v4, s[24:27], s64 offen offset:1024 sc1 lds
buffer_load_dwordx4 v4, s[24:27], s64 offen offset:2048 sc1 lds
buffer_load_dwordx4 v4, s[24:27], s64 offen offset:3072 sc1 lds
L_SK7:
v_mov_b64 v[74:75], 0
v_mov_b64 v[220:221], 0
v_mov_b64 v[222:223], 0
v_mov_b64 v[84:85], 0
v_mov_b64 v[86:87], 0
v_mov_b64 v[76:77], 0
v_mov_b64 v[78:79], 0
v_mov_b64 v[160:161], 0
v_mov_b64 v[162:163], 0
v_mov_b64 v[252:253], 0
v_mov_b64 v[254:255], 0
v_mov_b64 v[148:149], 0
v_mov_b64 v[150:151], 0
v_mov_b64 v[48:49], 0
v_mov_b64 v[50:51], 0
v_mov_b64 v[236:237], 0
v_mov_b64 v[238:239], 0
v_mov_b64 v[224:225], 0
v_mov_b64 v[226:227], 0
v_mov_b64 v[164:165], 0
v_mov_b64 v[166:167], 0
v_mov_b64 v[156:157], 0
v_mov_b64 v[158:159], 0
v_mov_b64 v[216:217], 0
v_mov_b64 v[218:219], 0
v_mov_b64 v[208:209], 0
v_mov_b64 v[210:211], 0
ds_read_b128 a[192:195], v4 offset:49152
ds_read_b128 a[196:199], v4 offset:50176
ds_read_b128 a[200:203], v4 offset:51200
ds_read_b128 a[204:207], v4 offset:52224
ds_read_b128 a[208:211], v4 offset:53248
ds_read_b128 a[212:215], v4 offset:54272
ds_read_b128 a[216:219], v4 offset:55296
ds_read_b128 a[220:223], v4 offset:56320
s_waitcnt lgkmcnt(8)
s_lshl2_add_u32 s77, s86, s84
s_mul_i32 s77, s77, 344064
s_mov_b32 s80, s70
s_cmp_lt_u32 s3, 2
s_cselect_b32 s53, 8, -2
s_add_u32 s53, s53, s3
v_mfma_f32_16x16x32_bf16 v[36:39], a[64:67], v[124:127], 0
s_mul_i32 s52, s5, 65536
v_exp_f32 v100, v100
v_mfma_f32_16x16x32_bf16 v[116:119], a[64:67], v[140:143], 0
s_sub_u32 s52, 1064960, s52
v_exp_f32 v101, v101
v_mfma_f32_16x16x32_bf16 v[132:135], a[68:71], v[140:143], 0
s_add_u32 s71, s68, s52
v_exp_f32 v102, v102
v_mfma_f32_16x16x32_bf16 v[32:35], a[68:71], v[124:127], 0
s_add_u32 s77, s77, s80
v_exp_f32 v103, v103
v_mfma_f32_16x16x32_bf16 v[196:199], a[72:75], v[124:127], 0
s_add_u32 s77, s77, 38797312
v_cvt_pk_bf16_f32 v248, v100, v101
v_cvt_pk_bf16_f32 v249, v102, v103
v_mfma_f32_16x16x32_bf16 v[184:187], a[72:75], v[140:143], 0
s_add_u32 s52, s3, 6
v_exp_f32 v92, v92
v_mfma_f32_16x16x32_bf16 v[240:243], a[76:79], v[140:143], 0
s_mul_i32 s52, s52, 16384
v_exp_f32 v93, v93
v_mfma_f32_16x16x32_bf16 v[204:207], a[76:79], v[124:127], 0
s_add_u32 s68, s68, s52
v_exp_f32 v94, v94
v_mfma_f32_16x16x32_bf16 v[108:111], a[80:83], v[124:127], 0
s_lshl_b32 s53, s53, 14
v_exp_f32 v95, v95
v_mfma_f32_16x16x32_bf16 v[188:191], a[80:83], v[140:143], 0
s_add_u32 s70, s70, s53
v_cvt_pk_bf16_f32 v232, v92, v93
v_cvt_pk_bf16_f32 v233, v94, v95
v_mfma_f32_16x16x32_bf16 v[56:59], a[84:87], v[140:143], 0
s_mov_b32 s75, 65536
v_exp_f32 v176, v176
v_mfma_f32_16x16x32_bf16 v[40:43], a[84:87], v[124:127], 0
s_mov_b32 s72, 1
v_exp_f32 v177, v177
v_mfma_f32_16x16x32_bf16 v[80:83], a[88:91], v[124:127], 0
s_mov_b32 s73, 9
v_exp_f32 v178, v178
v_mfma_f32_16x16x32_bf16 v[88:91], a[88:91], v[140:143], 0
s_lshl2_add_u32 s69, s5, 4
v_exp_f32 v179, v179
v_mfma_f32_16x16x32_bf16 v[192:195], a[92:95], v[140:143], 0
s_max_u32 s69, s69, 12
v_cvt_pk_bf16_f32 v250, v176, v177
v_cvt_pk_bf16_f32 v251, v178, v179
v_mfma_f32_16x16x32_bf16 v[168:171], a[92:95], v[124:127], 0
s_min_u32 s74, s73, s66
v_exp_f32 v228, v228
v_mfma_f32_16x16x32_bf16 a[224:227], a[240:243], v[124:127], 0
s_mov_b32 s93, 9
s_waitcnt vmcnt(8) lgkmcnt(0)
v_mfma_f32_16x16x32_bf16 a[228:231], a[240:243], v[140:143], 0
s_cmp_lt_u32 s66, 2
buffer_atomic_add v1, v0, s[24:27], s89 offen offset:8 sc1
s_cbranch_scc1 L_NE
L_DUAL:
v_mfma_f32_16x16x32_bf16 v[44:47], a[192:195], a[32:35], v[96:99]
s_barrier
v_mfma_f32_16x16x32_bf16 v[44:47], a[196:199], a[36:39], v[44:47]
s_cmp_eq_u32 s68, s71
v_exp_f32 v229, v229
v_mfma_f32_16x16x32_bf16 v[44:47], a[200:203], a[28:31], v[44:47]
s_cselect_b32 s64, s77, s68
v_add_u32 v5, s75, v4
v_cvt_pk_bf16_f32 v234, v228, v229
v_mfma_f32_16x16x32_bf16 v[44:47], a[204:207], a[20:23], v[44:47]
s_mov_b32 m0, s70
v_exp_f32 v230, v230
v_mfma_f32_16x16x32_bf16 v[52:55], a[192:195], a[44:47], v[104:107]
buffer_load_dwordx4 v4, s[24:27], s64 offen offset:0 sc1 lds
v_mfma_f32_16x16x32_bf16 v[52:55], a[196:199], a[40:43], v[52:55]
s_add_u32 s75, s75, 16384
v_exp_f32 v231, v231
v_mfma_f32_16x16x32_bf16 v[52:55], a[200:203], a[12:15], v[52:55]
v_cvt_pk_bf16_f32 v235, v230, v231
v_mfma_f32_16x16x32_bf16 v[52:55], a[204:207], a[4:7], v[52:55]
s_cmp_ge_u32 s75, 163840
v_exp_f32 v44, v44
v_mfma_f32_16x16x32_bf16 v[64:67], a[208:211], a[32:35], v[112:115]
v_mfma_f32_16x16x32_bf16 v[64:67], a[212:215], a[36:39], v[64:67]
s_cselect_b32 s75, 0, s75
v_exp_f32 v45, v45
v_mfma_f32_16x16x32_bf16 v[64:67], a[216:219], a[28:31], v[64:67]
v_cvt_pk_bf16_f32 v124, v44, v45
v_mfma_f32_16x16x32_bf16 v[64:67], a[220:223], a[20:23], v[64:67]
s_add_u32 s68, s64, 16384
v_exp_f32 v46, v46
v_mfma_f32_16x16x32_bf16 v[212:215], a[208:211], a[44:47], v[120:123]
buffer_load_dwordx4 v4, s[24:27], s64 offen offset:1024 sc1 lds
v_mfma_f32_16x16x32_bf16 v[212:215], a[212:215], a[40:43], v[212:215]
s_add_u32 s70, s70, 16384
v_exp_f32 v47, v47
v_mfma_f32_16x16x32_bf16 v[212:215], a[216:219], a[12:15], v[212:215]
v_cvt_pk_bf16_f32 v125, v46, v47
v_mfma_f32_16x16x32_bf16 v[212:215], a[220:223], a[4:7], v[212:215]
v_exp_f32 v52, v52
v_mfma_f32_16x16x32_bf16 v[60:63], a[64:67], v[248:251], v[60:63]
v_mfma_f32_16x16x32_bf16 v[148:151], a[64:67], v[232:235], v[148:151]
s_cmp_ge_u32 s70, 163840
v_exp_f32 v53, v53
v_mfma_f32_16x16x32_bf16 v[48:51], a[68:71], v[232:235], v[48:51]
ds_read_b128 a[64:67], v5 offset:8192
v_cvt_pk_bf16_f32 v140, v52, v53
v_mfma_f32_16x16x32_bf16 v[68:71], a[68:71], v[248:251], v[68:71]
s_cselect_b32 s70, s80, s70
v_exp_f32 v54, v54
v_mfma_f32_16x16x32_bf16 v[72:75], a[72:75], v[248:251], v[72:75]
buffer_load_dwordx4 v4, s[24:27], s64 offen offset:2048 sc1 lds
v_mfma_f32_16x16x32_bf16 v[236:239], a[72:75], v[232:235], v[236:239]
v_exp_f32 v55, v55
v_mfma_f32_16x16x32_bf16 v[224:227], a[76:79], v[232:235], v[224:227]
ds_read_b128 a[68:71], v5 offset:9216
v_cvt_pk_bf16_f32 v141, v54, v55
v_mfma_f32_16x16x32_bf16 v[220:223], a[76:79], v[248:251], v[220:223]
v_exp_f32 v64, v64
v_mfma_f32_16x16x32_bf16 v[84:87], a[80:83], v[248:251], v[84:87]
ds_read_b128 a[72:75], v5 offset:10240
v_mfma_f32_16x16x32_bf16 v[164:167], a[80:83], v[232:235], v[164:167]
v_exp_f32 v65, v65
v_mfma_f32_16x16x32_bf16 v[156:159], a[84:87], v[232:235], v[156:159]
ds_read_b128 a[76:79], v5 offset:11264
v_cvt_pk_bf16_f32 v126, v64, v65
v_mfma_f32_16x16x32_bf16 v[76:79], a[84:87], v[248:251], v[76:79]
v_exp_f32 v66, v66
v_mfma_f32_16x16x32_bf16 v[160:163], a[88:91], v[248:251], v[160:163]
buffer_load_dwordx4 v4, s[24:27], s64 offen offset:3072 sc1 lds
v_mfma_f32_16x16x32_bf16 v[216:219], a[88:91], v[232:235], v[216:219]
v_exp_f32 v67, v67
v_mfma_f32_16x16x32_bf16 v[208:211], a[92:95], v[232:235], v[208:211]
ds_read_b128 a[80:83], v5 offset:12288
v_cvt_pk_bf16_f32 v127, v66, v67
v_mfma_f32_16x16x32_bf16 v[252:255], a[92:95], v[248:251], v[252:255]
v_exp_f32 v212, v212
v_mfma_f32_16x16x32_bf16 a[232:235], a[240:243], v[248:251], a[232:235]
ds_read_b128 a[84:87], v5 offset:13312
v_mfma_f32_16x16x32_bf16 a[236:239], a[240:243], v[232:235], a[236:239]
ds_read_b128 a[88:91], v5 offset:14336
v_mfma_f32_16x16x32_bf16 v[100:103], a[192:195], a[48:51], v[128:131]
ds_read_b128 a[92:95], v5 offset:15360
v_mfma_f32_16x16x32_bf16 v[100:103], a[196:199], a[52:55], v[100:103]
v_exp_f32 v213, v213
v_mfma_f32_16x16x32_bf16 v[100:103], a[200:203], a[0:3], v[100:103]
v_cvt_pk_bf16_f32 v142, v212, v213
v_mfma_f32_16x16x32_bf16 v[100:103], a[204:207], a[8:11], v[100:103]
v_exp_f32 v214, v214
v_mfma_f32_16x16x32_bf16 v[92:95], a[192:195], a[60:63], v[136:139]
s_nop 0
v_mfma_f32_16x16x32_bf16 v[92:95], a[196:199], a[56:59], v[92:95]
v_exp_f32 v215, v215
v_mfma_f32_16x16x32_bf16 v[92:95], a[200:203], a[16:19], v[92:95]
ds_read_b128 a[192:195], v5 offset:0
v_cvt_pk_bf16_f32 v143, v214, v215
v_mfma_f32_16x16x32_bf16 v[92:95], a[204:207], a[24:27], v[92:95]
v_exp_f32 v100, v100
v_mfma_f32_16x16x32_bf16 v[176:179], a[208:211], a[48:51], v[144:147]
ds_read_b128 a[196:199], v5 offset:1024
v_mfma_f32_16x16x32_bf16 v[176:179], a[212:215], a[52:55], v[176:179]
v_exp_f32 v101, v101
v_mfma_f32_16x16x32_bf16 v[176:179], a[216:219], a[0:3], v[176:179]
ds_read_b128 a[200:203], v5 offset:2048
v_cvt_pk_bf16_f32 v248, v100, v101
v_mfma_f32_16x16x32_bf16 v[176:179], a[220:223], a[8:11], v[176:179]
v_exp_f32 v102, v102
v_mfma_f32_16x16x32_bf16 v[228:231], a[208:211], a[60:63], v[152:155]
ds_read_b128 a[204:207], v5 offset:3072
v_mfma_f32_16x16x32_bf16 v[228:231], a[212:215], a[56:59], v[228:231]
v_exp_f32 v103, v103
v_mfma_f32_16x16x32_bf16 v[228:231], a[216:219], a[16:19], v[228:231]
ds_read_b128 a[208:211], v5 offset:4096
v_cvt_pk_bf16_f32 v249, v102, v103
v_mfma_f32_16x16x32_bf16 v[228:231], a[220:223], a[24:27], v[228:231]
s_waitcnt lgkmcnt(5)
v_exp_f32 v92, v92
v_mfma_f32_16x16x32_bf16 v[36:39], a[64:67], v[124:127], v[36:39]
ds_read_b128 a[212:215], v5 offset:5120
v_mfma_f32_16x16x32_bf16 v[116:119], a[64:67], v[140:143], v[116:119]
v_exp_f32 v93, v93
v_mfma_f32_16x16x32_bf16 v[132:135], a[68:71], v[140:143], v[132:135]
ds_read_b128 a[216:219], v5 offset:6144
v_cvt_pk_bf16_f32 v232, v92, v93
v_mfma_f32_16x16x32_bf16 v[32:35], a[68:71], v[124:127], v[32:35]
v_exp_f32 v94, v94
v_mfma_f32_16x16x32_bf16 v[196:199], a[72:75], v[124:127], v[196:199]
ds_read_b128 a[220:223], v5 offset:7168
v_mfma_f32_16x16x32_bf16 v[184:187], a[72:75], v[140:143], v[184:187]
s_add_u32 s72, s72, 1
v_exp_f32 v95, v95
v_mfma_f32_16x16x32_bf16 v[240:243], a[76:79], v[140:143], v[240:243]
v_cvt_pk_bf16_f32 v233, v94, v95
v_mfma_f32_16x16x32_bf16 v[204:207], a[76:79], v[124:127], v[204:207]
v_exp_f32 v176, v176
v_mfma_f32_16x16x32_bf16 v[108:111], a[80:83], v[124:127], v[108:111]
v_mfma_f32_16x16x32_bf16 v[188:191], a[80:83], v[140:143], v[188:191]
v_exp_f32 v177, v177
v_mfma_f32_16x16x32_bf16 v[56:59], a[84:87], v[140:143], v[56:59]
v_cvt_pk_bf16_f32 v250, v176, v177
v_mfma_f32_16x16x32_bf16 v[40:43], a[84:87], v[124:127], v[40:43]
v_exp_f32 v178, v178
v_mfma_f32_16x16x32_bf16 v[80:83], a[88:91], v[124:127], v[80:83]
v_mfma_f32_16x16x32_bf16 v[88:91], a[88:91], v[140:143], v[88:91]
s_cmp_lt_u32 s72, s74
v_exp_f32 v179, v179
v_mfma_f32_16x16x32_bf16 v[192:195], a[92:95], v[140:143], v[192:195]
v_cvt_pk_bf16_f32 v251, v178, v179
v_mfma_f32_16x16x32_bf16 v[168:171], a[92:95], v[124:127], v[168:171]
s_waitcnt vmcnt(8) lgkmcnt(0)
v_exp_f32 v228, v228
v_mfma_f32_16x16x32_bf16 a[224:227], a[240:243], v[124:127], a[224:227]
v_mfma_f32_16x16x32_bf16 a[228:231], a[240:243], v[140:143], a[228:231]
s_cbranch_scc1 L_DUAL
L_DISP:
s_cmp_eq_u32 s72, s93
s_cbranch_scc1 L_STOP
L_NE:
s_mov_b32 s74, s93
s_cmp_gt_u32 s72, s66
s_cbranch_scc1 L_SINGLE
v_cndmask_b32 v96, v96, v6, s[56:57]
v_cndmask_b32 v120, v120, v6, s[56:57]
v_mov_b32 v112, v6
v_cndmask_b32 v97, v97, v6, s[58:59]
v_cndmask_b32 v121, v121, v6, s[58:59]
v_mov_b32 v113, v6
v_cndmask_b32 v98, v98, v6, s[60:61]
v_cndmask_b32 v122, v122, v6, s[60:61]
v_mov_b32 v114, v6
v_cndmask_b32 v99, v99, v6, s[62:63]
v_cndmask_b32 v123, v123, v6, s[62:63]
v_mov_b32 v115, v6
s_mov_b32 s74, 0
s_branch L_DUAL
L_STOP:
s_cmp_eq_u32 s72, 3
s_cbranch_scc1 L_E0
s_cmp_eq_u32 s72, 9
s_cbranch_scc1 L_E1
s_cmp_lg_u32 s72, 11
s_cbranch_scc1 L_SE
v_cmp_gt_u32 vcc, 32, v172
s_mov_b32 s73, 32
s_min_u32 s93, s73, s69
s_min_u32 s74, s93, s66
v_accvgpr_read_b32 v16, a244
v_accvgpr_read_b32 v17, a248
v_accvgpr_read_b32 v18, a252
s_cbranch_vccnz CK_Q
CK_Q_R:
buffer_load_dwordx4 a[244:247], v16, s[24:27], 0 offen sc1
buffer_load_dwordx4 a[248:251], v17, s[24:27], 0 offen sc1
buffer_load_dwordx4 a[252:255], v18, s[24:27], 0 offen sc1
s_add_u32 s53, s77, 163840
buffer_load_dwordx4 a[96:99], v4, s[24:27], s53 offen offset:0 sc1
buffer_load_dwordx4 a[100:103], v4, s[24:27], s53 offen offset:1024 sc1
buffer_load_dwordx4 a[104:107], v4, s[24:27], s53 offen offset:2048 sc1
buffer_load_dwordx4 a[108:111], v4, s[24:27], s53 offen offset:3072 sc1
s_cmp_lt_u32 s72, s66
s_cbranch_scc1 L_DUAL
s_mov_b32 s74, s93
s_cmp_gt_u32 s72, s66
s_cbranch_scc1 L_SINGLE
s_branch L_NE
L_E0:
buffer_atomic_add v1, v0, s[24:27], s89 offen offset:8 sc1
s_mov_b32 s73, 9
s_min_u32 s93, s73, s69
s_min_u32 s74, s93, s66
s_cmp_lt_u32 s72, s66
s_cbranch_scc1 L_DUAL
s_mov_b32 s74, s93
s_cmp_gt_u32 s72, s66
s_cbranch_scc1 L_SINGLE
s_branch L_NE
L_E1:
v_and_b32 v173, 31, v1
v_lshlrev_b32 v173, 10, v173
v_add_u32 v173, 75497992, v173
buffer_load_dword v172, v173, s[24:27], 0 offen sc1
s_mov_b32 s73, 11
s_cmp_lt_u32 s4, 16
s_cselect_b32 s52, s66, s67
s_and_b32 s53, s4, 15
s_lshl4_add_u32 s52, s52, s53
s_mul_i32 s52, s52, 2304
v_lshlrev_b32 v16, 2, v1
buffer_store_dwordx4 v[0:3], v4, s[44:47], s52 offen sc1
buffer_store_dwordx4 v[0:3], v4, s[44:47], s52 offen offset:1024 sc1
buffer_store_dword v0, v16, s[44:47], s52 offen offset:2048 sc1
s_min_u32 s93, s73, s69
s_min_u32 s74, s93, s66
s_cmp_lt_u32 s72, s66
s_cbranch_scc1 L_DUAL
s_mov_b32 s74, s93
s_cmp_gt_u32 s72, s66
s_cbranch_scc1 L_SINGLE
s_branch L_NE
L_SE:
s_lshr_b32 s52, s4, 3
s_mul_i32 s52, s52, 75776
s_add_u32 s52, s52, 54525952
s_and_b32 s53, s4, 7
s_mul_i32 s53, s53, 8192
s_add_u32 s52, s52, s53
s_mul_i32 s78, s66, 303104
s_add_u32 s78, s78, s52
s_mul_i32 s79, s67, 303104
s_add_u32 s79, s79, s52
s_mov_b32 s76, 0
v_mov_b32 v7, 0x5d800000
s_mov_b32 s69, 64
v_accvgpr_read_b32 v180, a224
v_accvgpr_read_b32 v182, a228
v_cmp_nle_f32 vcc, v180, v7
v_cmp_nle_f32 s[96:97], v182, v7
s_nop 3
s_or_b64 vcc, vcc, s[96:97]
s_cbranch_vccnz L_NS
s_add_u32 s53, s77, 180224
buffer_load_dwordx4 a[112:115], v4, s[24:27], s53 offen offset:0 sc1
v_mul_f32 v8, 0x3fb8aa3b, v8
v_mul_f32 v9, 0x3fb8aa3b, v9
v_exp_f32 v8, v8
v_exp_f32 v9, v9
s_nop 0
v_fma_f32 v180, v180, v8, v180
v_fma_f32 v182, v182, v9, v182
v_rcp_f32 v180, v180
v_rcp_f32 v182, v182
s_add_u32 s52, s78, 4096
v_mov_b32 v181, v180
v_mov_b32 v183, v182
v_pk_mul_f32 v[36:37], v[36:37], v[180:181]
v_pk_mul_f32 v[38:39], v[38:39], v[180:181]
v_pk_mul_f32 v[32:33], v[32:33], v[180:181]
v_pk_mul_f32 v[34:35], v[34:35], v[180:181]
v_cvt_pk_bf16_f32 v36, v36, v37
v_cvt_pk_bf16_f32 v37, v38, v39
v_cvt_pk_bf16_f32 v38, v32, v33
v_cvt_pk_bf16_f32 v39, v34, v35
buffer_store_dwordx4 v[36:39], v4, s[24:27], s78 offen offset:0 sc1
buffer_load_dwordx4 a[116:119], v4, s[24:27], s53 offen offset:1024 sc1
v_pk_mul_f32 v[116:117], v[116:117], v[182:183]
v_pk_mul_f32 v[118:119], v[118:119], v[182:183]
v_pk_mul_f32 v[132:133], v[132:133], v[182:183]
v_pk_mul_f32 v[134:135], v[134:135], v[182:183]
v_cvt_pk_bf16_f32 v116, v116, v117
v_cvt_pk_bf16_f32 v117, v118, v119
v_cvt_pk_bf16_f32 v118, v132, v133
v_cvt_pk_bf16_f32 v119, v134, v135
buffer_store_dwordx4 v[116:119], v4, s[24:27], s78 offen offset:1024 sc1
v_pk_mul_f32 v[196:197], v[196:197], v[180:181]
v_pk_mul_f32 v[198:199], v[198:199], v[180:181]
v_pk_mul_f32 v[204:205], v[204:205], v[180:181]
v_pk_mul_f32 v[206:207], v[206:207], v[180:181]
v_cvt_pk_bf16_f32 v196, v196, v197
v_cvt_pk_bf16_f32 v197, v198, v199
v_cvt_pk_bf16_f32 v198, v204, v205
v_cvt_pk_bf16_f32 v199, v206, v207
buffer_store_dwordx4 v[196:199], v4, s[24:27], s78 offen offset:2048 sc1
v_pk_mul_f32 v[184:185], v[184:185], v[182:183]
v_pk_mul_f32 v[186:187], v[186:187], v[182:183]
v_pk_mul_f32 v[240:241], v[240:241], v[182:183]
buffer_load_dwordx4 a[120:123], v4, s[24:27], s53 offen offset:2048 sc1
v_pk_mul_f32 v[242:243], v[242:243], v[182:183]
v_cvt_pk_bf16_f32 v184, v184, v185
v_cvt_pk_bf16_f32 v185, v186, v187
v_cvt_pk_bf16_f32 v186, v240, v241
v_cvt_pk_bf16_f32 v187, v242, v243
buffer_store_dwordx4 v[184:187], v4, s[24:27], s78 offen offset:3072 sc1
v_pk_mul_f32 v[108:109], v[108:109], v[180:181]
v_pk_mul_f32 v[110:111], v[110:111], v[180:181]
v_pk_mul_f32 v[40:41], v[40:41], v[180:181]
v_pk_mul_f32 v[42:43], v[42:43], v[180:181]
v_cvt_pk_bf16_f32 v108, v108, v109
v_cvt_pk_bf16_f32 v109, v110, v111
v_cvt_pk_bf16_f32 v110, v40, v41
v_cvt_pk_bf16_f32 v111, v42, v43
buffer_store_dwordx4 v[108:111], v4, s[24:27], s52 offen offset:0 sc1
v_pk_mul_f32 v[188:189], v[188:189], v[182:183]
v_pk_mul_f32 v[190:191], v[190:191], v[182:183]
v_pk_mul_f32 v[56:57], v[56:57], v[182:183]
v_pk_mul_f32 v[58:59], v[58:59], v[182:183]
v_cvt_pk_bf16_f32 v188, v188, v189
v_cvt_pk_bf16_f32 v189, v190, v191
buffer_load_dwordx4 a[124:127], v4, s[24:27], s53 offen offset:3072 sc1
v_cvt_pk_bf16_f32 v190, v56, v57
v_cvt_pk_bf16_f32 v191, v58, v59
buffer_store_dwordx4 v[188:191], v4, s[24:27], s52 offen offset:1024 sc1
v_pk_mul_f32 v[80:81], v[80:81], v[180:181]
v_pk_mul_f32 v[82:83], v[82:83], v[180:181]
v_pk_mul_f32 v[168:169], v[168:169], v[180:181]
v_pk_mul_f32 v[170:171], v[170:171], v[180:181]
v_cvt_pk_bf16_f32 v80, v80, v81
v_cvt_pk_bf16_f32 v81, v82, v83
v_cvt_pk_bf16_f32 v82, v168, v169
v_cvt_pk_bf16_f32 v83, v170, v171
buffer_store_dwordx4 v[80:83], v4, s[24:27], s52 offen offset:2048 sc1
v_pk_mul_f32 v[88:89], v[88:89], v[182:183]
v_pk_mul_f32 v[90:91], v[90:91], v[182:183]
v_pk_mul_f32 v[192:193], v[192:193], v[182:183]
v_pk_mul_f32 v[194:195], v[194:195], v[182:183]
v_cvt_pk_bf16_f32 v88, v88, v89
v_cvt_pk_bf16_f32 v89, v90, v91
v_cvt_pk_bf16_f32 v90, v192, v193
v_cvt_pk_bf16_f32 v91, v194, v195
buffer_store_dwordx4 v[88:91], v4, s[24:27], s52 offen offset:3072 sc1
L_PAD9:
s_cbranch_execz L_PAD13
s_mov_b32 s76, 1
L_NS:
s_mov_b32 s74, s73
s_mov_b32 s93, s73
s_cmp_eq_u32 s72, 32
s_cbranch_scc1 L_FIN
L_SINGLE:
v_mfma_f32_16x16x32_bf16 v[44:47], a[192:195], a[48:51], v[128:131]
s_barrier
v_mfma_f32_16x16x32_bf16 v[44:47], a[196:199], a[52:55], v[44:47]
s_cmp_eq_u32 s68, s71
v_exp_f32 v229, v229
v_mfma_f32_16x16x32_bf16 v[44:47], a[200:203], a[0:3], v[44:47]
s_cselect_b32 s64, s77, s68
v_add_u32 v5, s75, v4
v_cvt_pk_bf16_f32 v234, v228, v229
v_mfma_f32_16x16x32_bf16 v[44:47], a[204:207], a[8:11], v[44:47]
s_mov_b32 m0, s70
v_exp_f32 v230, v230
v_mfma_f32_16x16x32_bf16 v[52:55], a[192:195], a[60:63], v[136:139]
buffer_load_dwordx4 v4, s[24:27], s64 offen offset:0 sc1 lds
v_mfma_f32_16x16x32_bf16 v[52:55], a[196:199], a[56:59], v[52:55]
s_add_u32 s75, s75, 16384
v_exp_f32 v231, v231
v_mfma_f32_16x16x32_bf16 v[52:55], a[200:203], a[16:19], v[52:55]
ds_read_b128 a[192:195], v5 offset:0
v_cvt_pk_bf16_f32 v235, v230, v231
v_mfma_f32_16x16x32_bf16 v[52:55], a[204:207], a[24:27], v[52:55]
s_cmp_ge_u32 s75, 163840
v_exp_f32 v44, v44
v_mfma_f32_16x16x32_bf16 v[64:67], a[208:211], a[48:51], v[144:147]
ds_read_b128 a[196:199], v5 offset:1024
ds_read_b128 a[200:203], v5 offset:2048
v_mfma_f32_16x16x32_bf16 v[64:67], a[212:215], a[52:55], v[64:67]
s_cselect_b32 s75, 0, s75
v_exp_f32 v45, v45
v_mfma_f32_16x16x32_bf16 v[64:67], a[216:219], a[0:3], v[64:67]
ds_read_b128 a[204:207], v5 offset:3072
v_cvt_pk_bf16_f32 v124, v44, v45
v_mfma_f32_16x16x32_bf16 v[64:67], a[220:223], a[8:11], v[64:67]
s_add_u32 s68, s64, 16384
v_exp_f32 v46, v46
v_mfma_f32_16x16x32_bf16 v[212:215], a[208:211], a[60:63], v[152:155]
buffer_load_dwordx4 v4, s[24:27], s64 offen offset:1024 sc1 lds
v_mfma_f32_16x16x32_bf16 v[212:215], a[212:215], a[56:59], v[212:215]
s_add_u32 s70, s70, 16384
v_exp_f32 v47, v47
v_mfma_f32_16x16x32_bf16 v[212:215], a[216:219], a[16:19], v[212:215]
ds_read_b128 a[208:211], v5 offset:4096
v_cvt_pk_bf16_f32 v125, v46, v47
v_mfma_f32_16x16x32_bf16 v[212:215], a[220:223], a[24:27], v[212:215]
s_waitcnt lgkmcnt(5)
v_exp_f32 v52, v52
v_mfma_f32_16x16x32_bf16 v[60:63], a[64:67], v[248:251], v[60:63]
ds_read_b128 a[212:215], v5 offset:5120
ds_read_b128 a[216:219], v5 offset:6144
v_mfma_f32_16x16x32_bf16 v[148:151], a[64:67], v[232:235], v[148:151]
s_cmp_ge_u32 s70, 163840
v_exp_f32 v53, v53
v_mfma_f32_16x16x32_bf16 v[48:51], a[68:71], v[232:235], v[48:51]
ds_read_b128 a[220:223], v5 offset:7168
v_cvt_pk_bf16_f32 v140, v52, v53
v_mfma_f32_16x16x32_bf16 v[68:71], a[68:71], v[248:251], v[68:71]
s_cselect_b32 s70, s80, s70
v_exp_f32 v54, v54
v_mfma_f32_16x16x32_bf16 v[72:75], a[72:75], v[248:251], v[72:75]
buffer_load_dwordx4 v4, s[24:27], s64 offen offset:2048 sc1 lds
v_mfma_f32_16x16x32_bf16 v[236:239], a[72:75], v[232:235], v[236:239]
v_exp_f32 v55, v55
v_mfma_f32_16x16x32_bf16 v[224:227], a[76:79], v[232:235], v[224:227]
ds_read_b128 a[64:67], v5 offset:8192
v_cvt_pk_bf16_f32 v141, v54, v55
v_mfma_f32_16x16x32_bf16 v[220:223], a[76:79], v[248:251], v[220:223]
v_exp_f32 v64, v64
v_mfma_f32_16x16x32_bf16 v[84:87], a[80:83], v[248:251], v[84:87]
ds_read_b128 a[68:71], v5 offset:9216
ds_read_b128 a[72:75], v5 offset:10240
v_mfma_f32_16x16x32_bf16 v[164:167], a[80:83], v[232:235], v[164:167]
v_exp_f32 v65, v65
v_mfma_f32_16x16x32_bf16 v[156:159], a[84:87], v[232:235], v[156:159]
ds_read_b128 a[76:79], v5 offset:11264
v_cvt_pk_bf16_f32 v126, v64, v65
v_mfma_f32_16x16x32_bf16 v[76:79], a[84:87], v[248:251], v[76:79]
s_cmp_eq_u32 s68, s71
v_exp_f32 v66, v66
v_mfma_f32_16x16x32_bf16 v[160:163], a[88:91], v[248:251], v[160:163]
buffer_load_dwordx4 v4, s[24:27], s64 offen offset:3072 sc1 lds
v_mfma_f32_16x16x32_bf16 v[216:219], a[88:91], v[232:235], v[216:219]
s_cselect_b32 s64, s77, s68
v_exp_f32 v67, v67
v_mfma_f32_16x16x32_bf16 v[208:211], a[92:95], v[232:235], v[208:211]
ds_read_b128 a[80:83], v5 offset:12288
v_cvt_pk_bf16_f32 v127, v66, v67
v_mfma_f32_16x16x32_bf16 v[252:255], a[92:95], v[248:251], v[252:255]
s_waitcnt lgkmcnt(5)
v_exp_f32 v212, v212
v_mfma_f32_16x16x32_bf16 a[232:235], a[240:243], v[248:251], a[232:235]
ds_read_b128 a[84:87], v5 offset:13312
ds_read_b128 a[88:91], v5 offset:14336
v_mfma_f32_16x16x32_bf16 a[236:239], a[240:243], v[232:235], a[236:239]
s_mov_b32 m0, s70
ds_read_b128 a[92:95], v5 offset:15360
v_mfma_f32_16x16x32_bf16 v[100:103], a[192:195], a[48:51], v[128:131]
buffer_load_dwordx4 v4, s[24:27], s64 offen offset:0 sc1 lds
v_mfma_f32_16x16x32_bf16 v[100:103], a[196:199], a[52:55], v[100:103]
v_exp_f32 v213, v213
v_mfma_f32_16x16x32_bf16 v[100:103], a[200:203], a[0:3], v[100:103]
v_add_u32 v5, s75, v4
v_cvt_pk_bf16_f32 v142, v212, v213
v_mfma_f32_16x16x32_bf16 v[100:103], a[204:207], a[8:11], v[100:103]
v_exp_f32 v214, v214
v_mfma_f32_16x16x32_bf16 v[92:95], a[192:195], a[60:63], v[136:139]
buffer_load_dwordx4 v4, s[24:27], s64 offen offset:1024 sc1 lds
v_mfma_f32_16x16x32_bf16 v[92:95], a[196:199], a[56:59], v[92:95]
s_add_u32 s75, s75, 16384
v_exp_f32 v215, v215
v_mfma_f32_16x16x32_bf16 v[92:95], a[200:203], a[16:19], v[92:95]
ds_read_b128 a[192:195], v5 offset:0
v_cvt_pk_bf16_f32 v143, v214, v215
v_mfma_f32_16x16x32_bf16 v[92:95], a[204:207], a[24:27], v[92:95]
s_cmp_ge_u32 s75, 163840
v_exp_f32 v100, v100
v_mfma_f32_16x16x32_bf16 v[176:179], a[208:211], a[48:51], v[144:147]
ds_read_b128 a[196:199], v5 offset:1024
ds_read_b128 a[200:203], v5 offset:2048
v_mfma_f32_16x16x32_bf16 v[176:179], a[212:215], a[52:55], v[176:179]
s_cselect_b32 s75, 0, s75
v_exp_f32 v101, v101
v_mfma_f32_16x16x32_bf16 v[176:179], a[216:219], a[0:3], v[176:179]
ds_read_b128 a[204:207], v5 offset:3072
v_cvt_pk_bf16_f32 v248, v100, v101
v_mfma_f32_16x16x32_bf16 v[176:179], a[220:223], a[8:11], v[176:179]
s_add_u32 s68, s64, 16384
v_exp_f32 v102, v102
v_mfma_f32_16x16x32_bf16 v[228:231], a[208:211], a[60:63], v[152:155]
buffer_load_dwordx4 v4, s[24:27], s64 offen offset:2048 sc1 lds
v_mfma_f32_16x16x32_bf16 v[228:231], a[212:215], a[56:59], v[228:231]
s_add_u32 s70, s70, 16384
v_exp_f32 v103, v103
v_mfma_f32_16x16x32_bf16 v[228:231], a[216:219], a[16:19], v[228:231]
ds_read_b128 a[208:211], v5 offset:4096
v_cvt_pk_bf16_f32 v249, v102, v103
v_mfma_f32_16x16x32_bf16 v[228:231], a[220:223], a[24:27], v[228:231]
s_waitcnt lgkmcnt(5)
v_exp_f32 v92, v92
v_mfma_f32_16x16x32_bf16 v[60:63], a[64:67], v[124:127], v[60:63]
ds_read_b128 a[212:215], v5 offset:5120
ds_read_b128 a[216:219], v5 offset:6144
v_mfma_f32_16x16x32_bf16 v[148:151], a[64:67], v[140:143], v[148:151]
s_cmp_ge_u32 s70, 163840
v_exp_f32 v93, v93
v_mfma_f32_16x16x32_bf16 v[48:51], a[68:71], v[140:143], v[48:51]
ds_read_b128 a[220:223], v5 offset:7168
v_cvt_pk_bf16_f32 v232, v92, v93
v_mfma_f32_16x16x32_bf16 v[68:71], a[68:71], v[124:127], v[68:71]
s_cselect_b32 s70, s80, s70
v_exp_f32 v94, v94
v_mfma_f32_16x16x32_bf16 v[72:75], a[72:75], v[124:127], v[72:75]
buffer_load_dwordx4 v4, s[24:27], s64 offen offset:3072 sc1 lds
v_mfma_f32_16x16x32_bf16 v[236:239], a[72:75], v[140:143], v[236:239]
s_add_u32 s72, s72, 1
v_exp_f32 v95, v95
v_mfma_f32_16x16x32_bf16 v[224:227], a[76:79], v[140:143], v[224:227]
ds_read_b128 a[64:67], v5 offset:8192
v_cvt_pk_bf16_f32 v233, v94, v95
v_mfma_f32_16x16x32_bf16 v[220:223], a[76:79], v[124:127], v[220:223]
v_exp_f32 v176, v176
v_mfma_f32_16x16x32_bf16 v[84:87], a[80:83], v[124:127], v[84:87]
ds_read_b128 a[68:71], v5 offset:9216
ds_read_b128 a[72:75], v5 offset:10240
v_mfma_f32_16x16x32_bf16 v[164:167], a[80:83], v[140:143], v[164:167]
v_exp_f32 v177, v177
v_mfma_f32_16x16x32_bf16 v[156:159], a[84:87], v[140:143], v[156:159]
ds_read_b128 a[76:79], v5 offset:11264
v_cvt_pk_bf16_f32 v250, v176, v177
v_mfma_f32_16x16x32_bf16 v[76:79], a[84:87], v[124:127], v[76:79]
v_exp_f32 v178, v178
v_mfma_f32_16x16x32_bf16 v[160:163], a[88:91], v[124:127], v[160:163]
ds_read_b128 a[80:83], v5 offset:12288
ds_read_b128 a[84:87], v5 offset:13312
v_mfma_f32_16x16x32_bf16 v[216:219], a[88:91], v[140:143], v[216:219]
s_cmp_lt_u32 s72, s74
v_exp_f32 v179, v179
v_mfma_f32_16x16x32_bf16 v[208:211], a[92:95], v[140:143], v[208:211]
ds_read_b128 a[88:91], v5 offset:14336
v_cvt_pk_bf16_f32 v251, v178, v179
v_mfma_f32_16x16x32_bf16 v[252:255], a[92:95], v[124:127], v[252:255]
s_waitcnt vmcnt(8) lgkmcnt(7)
v_exp_f32 v228, v228
v_mfma_f32_16x16x32_bf16 a[232:235], a[240:243], v[124:127], a[232:235]
ds_read_b128 a[92:95], v5 offset:15360
v_mfma_f32_16x16x32_bf16 a[236:239], a[240:243], v[140:143], a[236:239]
s_cbranch_scc1 L_SINGLE
s_cmp_eq_u32 s72, s69
s_cbranch_scc1 L_SE
s_cmp_lt_u32 s72, 32
s_cbranch_scc1 L_STOP
L_FIN:
s_add_u32 s53, s77, 196608
buffer_load_dwordx4 a[160:163], v4, s[24:27], s53 offen offset:0 sc1
v_cndmask_b32 v128, v128, v6, s[56:57]
v_cndmask_b32 v152, v152, v6, s[56:57]
v_mov_b32 v144, v6
buffer_load_dwordx4 a[164:167], v4, s[24:27], s53 offen offset:1024 sc1
v_cndmask_b32 v129, v129, v6, s[58:59]
v_cndmask_b32 v153, v153, v6, s[58:59]
v_mov_b32 v145, v6
buffer_load_dwordx4 a[168:171], v4, s[24:27], s53 offen offset:2048 sc1
v_cndmask_b32 v130, v130, v6, s[60:61]
v_cndmask_b32 v154, v154, v6, s[60:61]
v_mov_b32 v146, v6
buffer_load_dwordx4 a[172:175], v4, s[24:27], s53 offen offset:3072 sc1
v_cndmask_b32 v131, v131, v6, s[62:63]
v_cndmask_b32 v155, v155, v6, s[62:63]
v_mov_b32 v147, v6
s_mov_b32 s83, s75
s_sub_u32 s91, s70, s80
v_mfma_f32_16x16x32_bf16 v[44:47], a[192:195], a[48:51], v[128:131]
s_barrier
v_mfma_f32_16x16x32_bf16 v[44:47], a[196:199], a[52:55], v[44:47]
s_mov_b32 m0, s70
v_exp_f32 v229, v229
v_mfma_f32_16x16x32_bf16 v[44:47], a[200:203], a[0:3], v[44:47]
s_mov_b32 s64, s68
v_add_u32 v5, s75, v4
v_cvt_pk_bf16_f32 v234, v228, v229
v_mfma_f32_16x16x32_bf16 v[44:47], a[204:207], a[8:11], v[44:47]
s_add_u32 s68, s68, 16384
v_exp_f32 v230, v230
v_mfma_f32_16x16x32_bf16 v[52:55], a[192:195], a[60:63], v[136:139]
buffer_load_dwordx4 v4, s[24:27], s64 offen offset:0 sc1 lds
v_mfma_f32_16x16x32_bf16 v[52:55], a[196:199], a[56:59], v[52:55]
s_add_u32 s70, s70, 16384
v_exp_f32 v231, v231
v_mfma_f32_16x16x32_bf16 v[52:55], a[200:203], a[16:19], v[52:55]
v_cvt_pk_bf16_f32 v235, v230, v231
v_mul_f32 v10, 0x3fb8aa3b, v10
v_mfma_f32_16x16x32_bf16 v[52:55], a[204:207], a[24:27], v[52:55]
s_cmp_ge_u32 s70, 163840
v_exp_f32 v44, v44
v_mfma_f32_16x16x32_bf16 v[64:67], a[208:211], a[48:51], v[144:147]
buffer_load_dwordx4 v4, s[24:27], s64 offen offset:1024 sc1 lds
v_mfma_f32_16x16x32_bf16 v[64:67], a[212:215], a[52:55], v[64:67]
s_cselect_b32 s70, s80, s70
v_exp_f32 v45, v45
v_mfma_f32_16x16x32_bf16 v[64:67], a[216:219], a[0:3], v[64:67]
v_cvt_pk_bf16_f32 v124, v44, v45
v_mul_f32 v11, 0x3fb8aa3b, v11
v_mfma_f32_16x16x32_bf16 v[64:67], a[220:223], a[8:11], v[64:67]
v_exp_f32 v46, v46
v_mfma_f32_16x16x32_bf16 v[212:215], a[208:211], a[60:63], v[152:155]
buffer_load_dwordx4 v4, s[24:27], s64 offen offset:2048 sc1 lds
v_mfma_f32_16x16x32_bf16 v[212:215], a[212:215], a[56:59], v[212:215]
v_exp_f32 v47, v47
v_mfma_f32_16x16x32_bf16 v[212:215], a[216:219], a[16:19], v[212:215]
v_cvt_pk_bf16_f32 v125, v46, v47
v_mfma_f32_16x16x32_bf16 v[212:215], a[220:223], a[24:27], v[212:215]
s_waitcnt lgkmcnt(0)
v_exp_f32 v52, v52
v_mfma_f32_16x16x32_bf16 v[60:63], a[64:67], v[248:251], v[60:63]
buffer_load_dwordx4 v4, s[24:27], s64 offen offset:3072 sc1 lds
v_mfma_f32_16x16x32_bf16 v[148:151], a[64:67], v[232:235], v[148:151]
s_mov_b32 m0, s70
v_exp_f32 v53, v53
v_mfma_f32_16x16x32_bf16 v[48:51], a[68:71], v[232:235], v[48:51]
s_mov_b32 s64, s68
ds_read_b128 a[64:67], v5 offset:8192
v_cvt_pk_bf16_f32 v140, v52, v53
v_mfma_f32_16x16x32_bf16 v[68:71], a[68:71], v[248:251], v[68:71]
s_add_u32 s68, s68, 16384
v_exp_f32 v54, v54
v_mfma_f32_16x16x32_bf16 v[72:75], a[72:75], v[248:251], v[72:75]
buffer_load_dwordx4 v4, s[24:27], s64 offen offset:0 sc1 lds
v_mfma_f32_16x16x32_bf16 v[236:239], a[72:75], v[232:235], v[236:239]
s_add_u32 s70, s70, 16384
v_exp_f32 v55, v55
v_mfma_f32_16x16x32_bf16 v[224:227], a[76:79], v[232:235], v[224:227]
ds_read_b128 a[68:71], v5 offset:9216
v_cvt_pk_bf16_f32 v141, v54, v55
v_mfma_f32_16x16x32_bf16 v[220:223], a[76:79], v[248:251], v[220:223]
s_cmp_ge_u32 s70, 163840
v_exp_f32 v64, v64
v_mfma_f32_16x16x32_bf16 v[84:87], a[80:83], v[248:251], v[84:87]
ds_read_b128 a[72:75], v5 offset:10240
v_mfma_f32_16x16x32_bf16 v[164:167], a[80:83], v[232:235], v[164:167]
s_cselect_b32 s70, s80, s70
v_exp_f32 v65, v65
v_mfma_f32_16x16x32_bf16 v[156:159], a[84:87], v[232:235], v[156:159]
ds_read_b128 a[76:79], v5 offset:11264
v_cvt_pk_bf16_f32 v126, v64, v65
v_mfma_f32_16x16x32_bf16 v[76:79], a[84:87], v[248:251], v[76:79]
v_exp_f32 v66, v66
v_mfma_f32_16x16x32_bf16 v[160:163], a[88:91], v[248:251], v[160:163]
buffer_load_dwordx4 v4, s[24:27], s64 offen offset:1024 sc1 lds
v_mfma_f32_16x16x32_bf16 v[216:219], a[88:91], v[232:235], v[216:219]
s_add_u32 s52, s79, 4096
v_exp_f32 v67, v67
v_mfma_f32_16x16x32_bf16 v[208:211], a[92:95], v[232:235], v[208:211]
ds_read_b128 a[80:83], v5 offset:12288
v_cvt_pk_bf16_f32 v127, v66, v67
v_mfma_f32_16x16x32_bf16 v[252:255], a[92:95], v[248:251], v[252:255]
v_exp_f32 v212, v212
v_mfma_f32_16x16x32_bf16 a[232:235], a[240:243], v[248:251], a[232:235]
ds_read_b128 a[84:87], v5 offset:13312
ds_read_b128 a[88:91], v5 offset:14336
v_mfma_f32_16x16x32_bf16 a[236:239], a[240:243], v[232:235], a[236:239]
ds_read_b128 a[92:95], v5 offset:15360
v_exp_f32 v213, v213
v_exp_f32 v214, v214
v_exp_f32 v215, v215
v_exp_f32 v10, v10
v_cvt_pk_bf16_f32 v142, v212, v213
v_cvt_pk_bf16_f32 v143, v214, v215
v_exp_f32 v11, v11
s_waitcnt lgkmcnt(0)
v_mfma_f32_16x16x32_bf16 a[232:235], a[240:243], v[124:127], a[232:235]
buffer_load_dwordx4 v4, s[24:27], s64 offen offset:2048 sc1 lds
v_mfma_f32_16x16x32_bf16 a[236:239], a[240:243], v[140:143], a[236:239]
s_barrier
v_mfma_f32_16x16x32_bf16 v[60:63], a[64:67], v[124:127], v[60:63]
v_cmp_eq_u32 vcc, 0, v3
v_mul_u32_u24 v244, 1536, v3
v_mfma_f32_16x16x32_bf16 v[148:151], a[64:67], v[140:143], v[148:151]
v_mov_b32 v246, 9728
v_cndmask_b32 v244, v244, v246, vcc
v_mfma_f32_16x16x32_bf16 v[48:51], a[68:71], v[140:143], v[48:51]
buffer_load_dwordx4 v4, s[24:27], s64 offen offset:3072 sc1 lds
v_mfma_f32_16x16x32_bf16 v[68:71], a[68:71], v[124:127], v[68:71]
v_lshl_add_u32 v247, v2, 4, s83
v_mov_b32 v246, 10496
v_mfma_f32_16x16x32_bf16 v[72:75], a[72:75], v[124:127], v[72:75]
v_accvgpr_read_b32 v180, a232
v_accvgpr_read_b32 v182, a236
v_mfma_f32_16x16x32_bf16 v[236:239], a[72:75], v[140:143], v[236:239]
v_cmp_nle_f32 vcc, v180, v7
v_cmp_nle_f32 s[96:97], v182, v7
v_mfma_f32_16x16x32_bf16 v[224:227], a[76:79], v[140:143], v[224:227]
v_fma_f32 v180, v180, v10, v180
v_fma_f32 v182, v182, v11, v182
v_mfma_f32_16x16x32_bf16 v[220:223], a[76:79], v[124:127], v[220:223]
v_rcp_f32 v180, v180
v_mfma_f32_16x16x32_bf16 v[84:87], a[80:83], v[124:127], v[84:87]
s_or_b64 vcc, vcc, s[96:97]
v_rcp_f32 v182, v182
v_mfma_f32_16x16x32_bf16 v[164:167], a[80:83], v[140:143], v[164:167]
v_mul_f32 v60, v180, v60
v_mul_f32 v61, v180, v61
v_mfma_f32_16x16x32_bf16 v[156:159], a[84:87], v[140:143], v[156:159]
v_mul_f32 v62, v180, v62
v_mul_f32 v63, v180, v63
v_mfma_f32_16x16x32_bf16 v[76:79], a[84:87], v[124:127], v[76:79]
v_mul_f32 v68, v180, v68
v_mul_f32 v69, v180, v69
v_mfma_f32_16x16x32_bf16 v[160:163], a[88:91], v[124:127], v[160:163]
v_mul_f32 v70, v180, v70
v_mul_f32 v71, v180, v71
v_mfma_f32_16x16x32_bf16 v[216:219], a[88:91], v[140:143], v[216:219]
v_cvt_pk_bf16_f32 v60, v60, v61
v_cvt_pk_bf16_f32 v61, v62, v63
v_mfma_f32_16x16x32_bf16 v[208:211], a[92:95], v[140:143], v[208:211]
v_cvt_pk_bf16_f32 v62, v68, v69
v_cvt_pk_bf16_f32 v63, v70, v71
v_mfma_f32_16x16x32_bf16 v[252:255], a[92:95], v[124:127], v[252:255]
s_cbranch_vccnz SLOW1
L_EP:
buffer_store_dwordx4 v[60:63], v4, s[24:27], s79 offen offset:0 sc1
v_pk_mul_f32 v[148:149], v[148:149], v[182:183] op_sel_hi:[1,0]
v_pk_mul_f32 v[150:151], v[150:151], v[182:183] op_sel_hi:[1,0]
v_pk_mul_f32 v[48:49], v[48:49], v[182:183] op_sel_hi:[1,0]
v_pk_mul_f32 v[50:51], v[50:51], v[182:183] op_sel_hi:[1,0]
v_cvt_pk_bf16_f32 v148, v148, v149
v_cvt_pk_bf16_f32 v149, v150, v151
v_cvt_pk_bf16_f32 v150, v48, v49
v_cvt_pk_bf16_f32 v151, v50, v51
buffer_store_dwordx4 v[148:151], v4, s[24:27], s79 offen offset:1024 sc1
v_pk_mul_f32 v[72:73], v[72:73], v[180:181] op_sel_hi:[1,0]
v_pk_mul_f32 v[74:75], v[74:75], v[180:181] op_sel_hi:[1,0]
v_pk_mul_f32 v[220:221], v[220:221], v[180:181] op_sel_hi:[1,0]
v_pk_mul_f32 v[222:223], v[222:223], v[180:181] op_sel_hi:[1,0]
v_cvt_pk_bf16_f32 v72, v72, v73
v_cvt_pk_bf16_f32 v73, v74, v75
v_cvt_pk_bf16_f32 v74, v220, v221
v_cvt_pk_bf16_f32 v75, v222, v223
buffer_store_dwordx4 v[72:75], v4, s[24:27], s79 offen offset:2048 sc1
v_pk_mul_f32 v[236:237], v[236:237], v[182:183] op_sel_hi:[1,0]
v_pk_mul_f32 v[238:239], v[238:239], v[182:183] op_sel_hi:[1,0]
v_pk_mul_f32 v[224:225], v[224:225], v[182:183] op_sel_hi:[1,0]
v_pk_mul_f32 v[226:227], v[226:227], v[182:183] op_sel_hi:[1,0]
v_cvt_pk_bf16_f32 v236, v236, v237
v_cvt_pk_bf16_f32 v237, v238, v239
v_cvt_pk_bf16_f32 v238, v224, v225
v_cvt_pk_bf16_f32 v239, v226, v227
buffer_store_dwordx4 v[236:239], v4, s[24:27], s79 offen offset:3072 sc1
v_pk_mul_f32 v[84:85], v[84:85], v[180:181] op_sel_hi:[1,0]
v_pk_mul_f32 v[86:87], v[86:87], v[180:181] op_sel_hi:[1,0]
v_pk_mul_f32 v[76:77], v[76:77], v[180:181] op_sel_hi:[1,0]
v_pk_mul_f32 v[78:79], v[78:79], v[180:181] op_sel_hi:[1,0]
v_cvt_pk_bf16_f32 v84, v84, v85
v_cvt_pk_bf16_f32 v85, v86, v87
v_cvt_pk_bf16_f32 v86, v76, v77
v_cvt_pk_bf16_f32 v87, v78, v79
buffer_store_dwordx4 v[84:87], v4, s[24:27], s52 offen offset:0 sc1
v_pk_mul_f32 v[164:165], v[164:165], v[182:183] op_sel_hi:[1,0]
v_pk_mul_f32 v[166:167], v[166:167], v[182:183] op_sel_hi:[1,0]
v_pk_mul_f32 v[156:157], v[156:157], v[182:183] op_sel_hi:[1,0]
v_pk_mul_f32 v[158:159], v[158:159], v[182:183] op_sel_hi:[1,0]
v_cvt_pk_bf16_f32 v164, v164, v165
v_cvt_pk_bf16_f32 v165, v166, v167
v_cvt_pk_bf16_f32 v166, v156, v157
v_cvt_pk_bf16_f32 v167, v158, v159
buffer_store_dwordx4 v[164:167], v4, s[24:27], s52 offen offset:1024 sc1
v_pk_mul_f32 v[160:161], v[160:161], v[180:181] op_sel_hi:[1,0]
v_pk_mul_f32 v[162:163], v[162:163], v[180:181] op_sel_hi:[1,0]
v_pk_mul_f32 v[252:253], v[252:253], v[180:181] op_sel_hi:[1,0]
v_pk_mul_f32 v[254:255], v[254:255], v[180:181] op_sel_hi:[1,0]
v_cvt_pk_bf16_f32 v160, v160, v161
v_cvt_pk_bf16_f32 v161, v162, v163
v_cvt_pk_bf16_f32 v162, v252, v253
v_cvt_pk_bf16_f32 v163, v254, v255
buffer_store_dwordx4 v[160:163], v4, s[24:27], s52 offen offset:2048 sc1
v_pk_mul_f32 v[216:217], v[216:217], v[182:183] op_sel_hi:[1,0]
v_pk_mul_f32 v[218:219], v[218:219], v[182:183] op_sel_hi:[1,0]
v_pk_mul_f32 v[208:209], v[208:209], v[182:183] op_sel_hi:[1,0]
v_pk_mul_f32 v[210:211], v[210:211], v[182:183] op_sel_hi:[1,0]
v_cvt_pk_bf16_f32 v216, v216, v217
v_cvt_pk_bf16_f32 v217, v218, v219
v_cvt_pk_bf16_f32 v218, v208, v209
v_cvt_pk_bf16_f32 v219, v210, v211
buffer_store_dwordx4 v[216:219], v4, s[24:27], s52 offen offset:3072 sc1
v_cmp_eq_u32 vcc, 3, v3
v_mul_u32_u24 v200, 768, v3
v_add_u32 v200, v200, v247
ds_write_b128 v200, a[244:247] offset:0
v_cndmask_b32 v245, v244, v246, vcc
ds_write_b128 v200, a[248:251] offset:3072
v_add_u32 v247, -1280, v247
ds_write_b128 v200, a[252:255] offset:6144
v_add_u32 v244, v244, v247
v_add_u32 v245, v245, v247
ds_write_b128 v244, a[128:131] offset:0
v_cmp_lt_u32 vcc, 31, v1
ds_write_b128 v245, a[132:135] offset:768
v_and_b32 v202, 31, v1
ds_write_b128 v244, a[136:139] offset:256
v_mov_b32 v200, s66
ds_write_b128 v245, a[140:143] offset:1024
v_mov_b32 v203, s67
ds_write_b128 v244, a[144:147] offset:3840
v_cndmask_b32 v200, v200, v203, vcc
ds_write_b128 v245, a[148:151] offset:4608
v_lshl_add_u32 v200, v200, 5, v202
ds_write_b128 v244, a[152:155] offset:4096
v_lshrrev_b32 v201, 5, v1
ds_write_b128 v245, a[156:159] offset:4864
v_mul_u32_u24 v201, 3840, v201
v_lshl_add_u32 v201, v202, 4, v201
v_add_u32 v201, s83, v201
s_cmp_eq_u32 s76, 0
s_cbranch_scc1 L_SE2
L_LA:
v_mov_b32 v5, v200
v_mov_b32 v6, v201
v_mov_b32 v13, 0
s_lshl_b32 s74, s66, 10
s_lshr_b32 s52, s4, 3
s_lshl_b32 s52, s52, 7
s_add_u32 s74, s74, s52
s_add_u32 s74, s74, 75497472
ds_read_b128 v[16:19], v6 offset:8448
ds_read_b128 v[20:23], v6 offset:9216
ds_read_b128 v[96:99], v6 offset:3328
ds_read_b128 v[32:35], v6 offset:256
ds_read_b128 v[36:39], v6 offset:1024
ds_read_b128 v[100:103], v6 offset:3296
ds_read_b128 v[40:43], v6 offset:224
ds_read_b128 v[44:47], v6 offset:992
ds_read_b128 v[104:107], v6 offset:3264
ds_read_b128 v[48:51], v6 offset:192
ds_read_b128 v[52:55], v6 offset:960
ds_read_b128 v[108:111], v6 offset:3232
ds_read_b128 v[56:59], v6 offset:160
ds_read_b128 v[60:63], v6 offset:928
ds_read_b128 v[112:115], v6 offset:3200
ds_read_b128 v[64:67], v6 offset:128
ds_read_b128 v[68:71], v6 offset:896
ds_read_b128 v[116:119], v6 offset:3168
ds_read_b128 v[72:75], v6 offset:96
ds_read_b128 v[76:79], v6 offset:864
ds_read_b128 v[120:123], v6 offset:3136
ds_read_b128 v[80:83], v6 offset:64
ds_read_b128 v[84:87], v6 offset:832
ds_read_b128 v[124:127], v6 offset:3104
ds_read_b128 v[88:91], v6 offset:32
ds_read_b128 v[92:95], v6 offset:800
ds_read_b128 v[128:131], v6 offset:1792
ds_read_b128 v[132:135], v6 offset:2560
s_waitcnt vmcnt(0)
buffer_atomic_add v1, v0, s[24:27], s74 offen offset:0 sc1
ds_read_b128 v[136:139], v6 offset:1760
ds_read_b128 v[140:143], v6 offset:2528
ds_read_b128 v[144:147], v6 offset:1728
ds_read_b128 v[148:151], v6 offset:2496
ds_read_b128 v[152:155], v6 offset:1696
ds_read_b128 v[156:159], v6 offset:2464
ds_read_b128 v[160:163], v6 offset:1664
ds_read_b128 v[164:167], v6 offset:2432
ds_read_b128 v[168:171], v6 offset:1632
ds_read_b128 v[172:175], v6 offset:2400
ds_read_b128 v[176:179], v6 offset:1600
ds_read_b128 v[180:183], v6 offset:2368
ds_read_b128 v[184:187], v6 offset:1568
ds_read_b128 v[188:191], v6 offset:2336
s_lshr_b32 s52, s3, 1
s_lshl1_add_u32 s72, s85, s52
s_lshl3_add_u32 s75, s72, s84
s_lshl_b32 s75, s75, 7
s_add_u32 s75, s75, 75497472
s_and_b32 s82, s86, 1
s_lshl_b32 s82, s82, 13
s_lshr_b32 s53, s4, 3
s_mul_i32 s53, s53, 75776
s_add_u32 s53, s53, 54525952
s_and_b32 s52, s3, 1
s_lshl_b32 s52, s52, 10
s_add_u32 s52, s52, s53
s_sub_u32 s54, 63, s72
s_mul_i32 s77, s72, 303104
s_add_u32 s77, s77, s52
s_mul_i32 s81, s54, 303104
s_add_u32 s81, s81, s52
s_add_u32 s91, s91, 114688
s_sub_u32 s52, s91, 163840
s_cmp_ge_u32 s91, 163840
s_cselect_b32 s91, s52, s91
v_add_u32 v14, 4096, v4
v_add_u32 v7, s91, v4
s_waitcnt lgkmcnt(0)
s_barrier
s_mov_b32 m0, s70
s_mov_b32 s64, s68
s_add_u32 s68, s68, 16384
s_add_u32 s70, s70, 16384
s_cmp_ge_u32 s70, 163840
s_cselect_b32 s70, s80, s70
buffer_load_dwordx4 v4, s[24:27], s64 offen offset:0 sc1 lds
v_and_b32 v9, 0xffff, v97
v_and_b32 v11, 0xffff0000, v97
v_dot2_f32_bf16 v24, v98, v99, 0
v_dot2_f32_bf16 v25, v102, v99, 0
v_dot2_f32_bf16 v26, v106, v99, 0
v_dot2_f32_bf16 v27, v110, v99, 0
v_dot2_f32_bf16 v28, v114, v99, 0
v_dot2_f32_bf16 v29, v118, v99, 0
v_dot2_f32_bf16 v30, v122, v99, 0
v_dot2_f32_bf16 v31, v126, v99, 0
v_dot2c_f32_bf16 v24, v96, v9
v_dot2c_f32_bf16 v25, v100, v9
v_dot2c_f32_bf16 v26, v104, v9
v_dot2c_f32_bf16 v27, v108, v9
v_dot2c_f32_bf16 v28, v112, v9
buffer_load_dwordx4 v4, s[24:27], s64 offen offset:1024 sc1 lds
v_dot2c_f32_bf16 v29, v116, v9
v_dot2c_f32_bf16 v30, v120, v9
v_dot2c_f32_bf16 v31, v124, v9
v_dot2c_f32_bf16 v24, v16, v32
v_dot2c_f32_bf16 v25, v16, v40
v_dot2c_f32_bf16 v26, v16, v48
v_dot2c_f32_bf16 v27, v16, v56
v_dot2c_f32_bf16 v28, v16, v64
v_dot2c_f32_bf16 v29, v16, v72
v_dot2c_f32_bf16 v30, v16, v80
v_dot2c_f32_bf16 v31, v16, v88
v_dot2c_f32_bf16 v24, v17, v33
v_dot2c_f32_bf16 v25, v17, v41
v_dot2c_f32_bf16 v26, v17, v49
v_dot2c_f32_bf16 v27, v17, v57
buffer_load_dwordx4 v4, s[24:27], s64 offen offset:2048 sc1 lds
v_dot2c_f32_bf16 v28, v17, v65
v_dot2c_f32_bf16 v29, v17, v73
v_dot2c_f32_bf16 v30, v17, v81
v_dot2c_f32_bf16 v31, v17, v89
v_dot2c_f32_bf16 v24, v18, v34
v_dot2c_f32_bf16 v25, v18, v42
v_dot2c_f32_bf16 v26, v18, v50
v_dot2c_f32_bf16 v27, v18, v58
v_dot2c_f32_bf16 v28, v18, v66
v_dot2c_f32_bf16 v29, v18, v74
v_dot2c_f32_bf16 v30, v18, v82
v_dot2c_f32_bf16 v31, v18, v90
v_dot2c_f32_bf16 v24, v19, v35
v_dot2c_f32_bf16 v25, v19, v43
v_dot2c_f32_bf16 v26, v19, v51
buffer_load_dwordx4 v4, s[24:27], s64 offen offset:3072 sc1 lds
v_dot2c_f32_bf16 v27, v19, v59
v_dot2c_f32_bf16 v28, v19, v67
v_dot2c_f32_bf16 v29, v19, v75
v_dot2c_f32_bf16 v30, v19, v83
v_dot2c_f32_bf16 v31, v19, v91
v_dot2c_f32_bf16 v24, v20, v36
v_dot2c_f32_bf16 v25, v20, v44
v_dot2c_f32_bf16 v26, v20, v52
v_dot2c_f32_bf16 v27, v20, v60
v_dot2c_f32_bf16 v28, v20, v68
v_dot2c_f32_bf16 v29, v20, v76
v_dot2c_f32_bf16 v30, v20, v84
v_dot2c_f32_bf16 v31, v20, v92
v_dot2c_f32_bf16 v24, v21, v37
v_dot2c_f32_bf16 v25, v21, v45
s_mov_b32 m0, s70
s_mov_b32 s64, s68
s_add_u32 s68, s68, 16384
s_add_u32 s70, s70, 16384
s_cmp_ge_u32 s70, 163840
s_cselect_b32 s70, s80, s70
buffer_load_dwordx4 v4, s[24:27], s64 offen offset:0 sc1 lds
v_dot2c_f32_bf16 v26, v21, v53
v_dot2c_f32_bf16 v27, v21, v61
v_dot2c_f32_bf16 v28, v21, v69
v_dot2c_f32_bf16 v29, v21, v77
v_dot2c_f32_bf16 v30, v21, v85
v_dot2c_f32_bf16 v31, v21, v93
v_dot2c_f32_bf16 v24, v22, v38
v_dot2c_f32_bf16 v25, v22, v46
v_dot2c_f32_bf16 v26, v22, v54
v_dot2c_f32_bf16 v27, v22, v62
v_dot2c_f32_bf16 v28, v22, v70
v_dot2c_f32_bf16 v29, v22, v78
L_PAD10:
s_cbranch_execz L_MAIN
v_dot2c_f32_bf16 v30, v22, v86
v_dot2c_f32_bf16 v31, v22, v94
v_dot2c_f32_bf16 v24, v23, v39
buffer_load_dwordx4 v4, s[24:27], s64 offen offset:1024 sc1 lds
v_dot2c_f32_bf16 v25, v23, v47
v_dot2c_f32_bf16 v26, v23, v55
v_dot2c_f32_bf16 v27, v23, v63
v_dot2c_f32_bf16 v28, v23, v71
v_dot2c_f32_bf16 v29, v23, v79
v_dot2c_f32_bf16 v30, v23, v87
v_dot2c_f32_bf16 v31, v23, v95
v_mov_b32 v9, 0xf149f2ca
v_mul_f32 v11, 0xbfb8aa3b, v11
v_exp_f32 v11, v11
v_cmp_gt_u32 vcc, 2, v5
v_cmp_gt_u32 s[56:57], 4, v5
s_nop 0
v_cndmask_b32 v25, v25, v9, vcc
v_cndmask_b32 v26, v26, v9, s[56:57]
buffer_load_dwordx4 v4, s[24:27], s64 offen offset:2048 sc1 lds
v_cmp_gt_u32 vcc, 6, v5
v_cmp_gt_u32 s[56:57], 8, v5
s_nop 0
v_cndmask_b32 v27, v27, v9, vcc
v_cndmask_b32 v28, v28, v9, s[56:57]
v_cmp_gt_u32 vcc, 10, v5
v_cmp_gt_u32 s[56:57], 12, v5
s_nop 0
v_cndmask_b32 v29, v29, v9, vcc
v_cndmask_b32 v30, v30, v9, s[56:57]
v_cmp_gt_u32 vcc, 14, v5
s_nop 0
s_nop 0
v_cndmask_b32 v31, v31, v9, vcc
v_max3_f32 v10, v24, v25, v26
buffer_load_dwordx4 v4, s[24:27], s64 offen offset:3072 sc1 lds
v_max3_f32 v10, v10, v27, v28
v_max3_f32 v10, v10, v29, v30
v_max_f32 v10, v10, v31
s_mov_b32 s52, 0x3eae1a93
v_sub_f32 v24, v24, v10
v_sub_f32 v25, v25, v10
v_sub_f32 v26, v26, v10
v_sub_f32 v27, v27, v10
v_sub_f32 v28, v28, v10
v_sub_f32 v29, v29, v10
v_sub_f32 v30, v30, v10
v_sub_f32 v31, v31, v10
v_mul_f32 v24, s52, v24
v_mul_f32 v25, s52, v25
v_mul_f32 v26, s52, v26
s_mov_b32 m0, s70
s_mov_b32 s64, s68
s_add_u32 s68, s68, 16384
s_add_u32 s70, s70, 16384
s_cmp_ge_u32 s70, 163840
s_cselect_b32 s70, s80, s70
buffer_load_dwordx4 v4, s[24:27], s64 offen offset:0 sc1 lds
v_mul_f32 v27, s52, v27
v_mul_f32 v28, s52, v28
v_mul_f32 v29, s52, v29
v_mul_f32 v30, s52, v30
v_mul_f32 v31, s52, v31
v_exp_f32 v24, v24
v_exp_f32 v25, v25
v_exp_f32 v26, v26
v_exp_f32 v27, v27
v_exp_f32 v28, v28
v_exp_f32 v29, v29
v_exp_f32 v30, v30
v_exp_f32 v31, v31
v_cvt_pk_bf16_f32 v32, v24, 0
v_cvt_pk_bf16_f32 v40, v25, 0
buffer_load_dwordx4 v4, s[24:27], s64 offen offset:1024 sc1 lds
v_cvt_pk_bf16_f32 v48, v26, 0
v_cvt_pk_bf16_f32 v56, v27, 0
v_cvt_pk_bf16_f32 v64, v28, 0
v_cvt_pk_bf16_f32 v72, v29, 0
v_cvt_pk_bf16_f32 v80, v30, 0
v_cvt_pk_bf16_f32 v88, v31, 0
v_lshlrev_b32 v33, 16, v32
v_lshlrev_b32 v41, 16, v40
v_lshlrev_b32 v49, 16, v48
v_lshlrev_b32 v57, 16, v56
v_lshlrev_b32 v65, 16, v64
v_lshlrev_b32 v73, 16, v72
v_lshlrev_b32 v81, 16, v80
v_lshlrev_b32 v89, 16, v88
v_add_f32 v10, v33, v41
buffer_load_dwordx4 v4, s[24:27], s64 offen offset:2048 sc1 lds
v_add_f32 v10, v10, v49
v_add_f32 v10, v10, v57
v_add_f32 v10, v10, v65
v_add_f32 v10, v10, v73
v_add_f32 v10, v10, v81
v_add_f32 v10, v10, v89
v_fmac_f32 v10, v10, v11
v_rcp_f32 v10, v10
v_dot2_f32_bf16 v192, v128, v32, 0
v_dot2_f32_bf16 v193, v128, v33, 0
v_dot2_f32_bf16 v194, v129, v32, 0
v_dot2_f32_bf16 v195, v129, v33, 0
v_dot2_f32_bf16 v196, v130, v32, 0
v_dot2_f32_bf16 v197, v130, v33, 0
v_dot2_f32_bf16 v198, v131, v32, 0
buffer_load_dwordx4 v4, s[24:27], s64 offen offset:3072 sc1 lds
v_dot2_f32_bf16 v199, v131, v33, 0
v_dot2_f32_bf16 v200, v132, v32, 0
v_dot2_f32_bf16 v201, v132, v33, 0
v_dot2_f32_bf16 v202, v133, v32, 0
v_dot2_f32_bf16 v203, v133, v33, 0
v_dot2_f32_bf16 v204, v134, v32, 0
v_dot2_f32_bf16 v205, v134, v33, 0
v_dot2_f32_bf16 v206, v135, v32, 0
v_dot2_f32_bf16 v207, v135, v33, 0
v_dot2_f32_bf16 v208, v96, v33, 0
v_dot2_f32_bf16 v209, v98, v33, 0
v_dot2c_f32_bf16 v192, v136, v40
v_dot2c_f32_bf16 v193, v136, v41
v_dot2c_f32_bf16 v194, v137, v40
v_dot2c_f32_bf16 v195, v137, v41
s_mov_b32 m0, s70
s_mov_b32 s64, s68
s_add_u32 s68, s68, 16384
s_add_u32 s70, s70, 16384
s_cmp_ge_u32 s70, 163840
s_cselect_b32 s70, s80, s70
buffer_load_dwordx4 v4, s[24:27], s64 offen offset:0 sc1 lds
v_dot2c_f32_bf16 v196, v138, v40
v_dot2c_f32_bf16 v197, v138, v41
v_dot2c_f32_bf16 v198, v139, v40
v_dot2c_f32_bf16 v199, v139, v41
v_dot2c_f32_bf16 v200, v140, v40
v_dot2c_f32_bf16 v201, v140, v41
v_dot2c_f32_bf16 v202, v141, v40
v_dot2c_f32_bf16 v203, v141, v41
v_dot2c_f32_bf16 v204, v142, v40
v_dot2c_f32_bf16 v205, v142, v41
v_dot2c_f32_bf16 v206, v143, v40
v_dot2c_f32_bf16 v207, v143, v41
v_dot2c_f32_bf16 v208, v100, v41
v_dot2c_f32_bf16 v209, v102, v41
v_dot2c_f32_bf16 v192, v144, v48
buffer_load_dwordx4 v4, s[24:27], s64 offen offset:1024 sc1 lds
v_dot2c_f32_bf16 v193, v144, v49
v_dot2c_f32_bf16 v194, v145, v48
v_dot2c_f32_bf16 v195, v145, v49
v_dot2c_f32_bf16 v196, v146, v48
v_dot2c_f32_bf16 v197, v146, v49
v_dot2c_f32_bf16 v198, v147, v48
v_dot2c_f32_bf16 v199, v147, v49
v_dot2c_f32_bf16 v200, v148, v48
v_dot2c_f32_bf16 v201, v148, v49
v_dot2c_f32_bf16 v202, v149, v48
v_dot2c_f32_bf16 v203, v149, v49
v_dot2c_f32_bf16 v204, v150, v48
v_dot2c_f32_bf16 v205, v150, v49
v_dot2c_f32_bf16 v206, v151, v48
v_dot2c_f32_bf16 v207, v151, v49
buffer_load_dwordx4 v4, s[24:27], s64 offen offset:2048 sc1 lds
v_dot2c_f32_bf16 v208, v104, v49
v_dot2c_f32_bf16 v209, v106, v49
v_dot2c_f32_bf16 v192, v152, v56
v_dot2c_f32_bf16 v193, v152, v57
v_dot2c_f32_bf16 v194, v153, v56
v_dot2c_f32_bf16 v195, v153, v57
v_dot2c_f32_bf16 v196, v154, v56
v_dot2c_f32_bf16 v197, v154, v57
v_dot2c_f32_bf16 v198, v155, v56
v_dot2c_f32_bf16 v199, v155, v57
v_dot2c_f32_bf16 v200, v156, v56
v_dot2c_f32_bf16 v201, v156, v57
v_dot2c_f32_bf16 v202, v157, v56
v_dot2c_f32_bf16 v203, v157, v57
v_dot2c_f32_bf16 v204, v158, v56
buffer_load_dword v12, v13, s[24:27], s75 offen sc1
v_dot2c_f32_bf16 v205, v158, v57
v_dot2c_f32_bf16 v206, v159, v56
v_dot2c_f32_bf16 v207, v159, v57
v_dot2c_f32_bf16 v208, v108, v57
v_dot2c_f32_bf16 v209, v110, v57
v_dot2c_f32_bf16 v192, v160, v64
v_dot2c_f32_bf16 v193, v160, v65
v_dot2c_f32_bf16 v194, v161, v64
v_dot2c_f32_bf16 v195, v161, v65
v_dot2c_f32_bf16 v196, v162, v64
v_dot2c_f32_bf16 v197, v162, v65
v_dot2c_f32_bf16 v198, v163, v64
v_dot2c_f32_bf16 v199, v163, v65
v_dot2c_f32_bf16 v200, v164, v64
v_dot2c_f32_bf16 v201, v164, v65
buffer_load_dwordx4 v4, s[24:27], s64 offen offset:3072 sc1 lds
v_dot2c_f32_bf16 v202, v165, v64
v_dot2c_f32_bf16 v203, v165, v65
v_dot2c_f32_bf16 v204, v166, v64
v_dot2c_f32_bf16 v205, v166, v65
v_dot2c_f32_bf16 v206, v167, v64
v_dot2c_f32_bf16 v207, v167, v65
v_dot2c_f32_bf16 v208, v112, v65
v_dot2c_f32_bf16 v209, v114, v65
v_dot2c_f32_bf16 v192, v168, v72
v_dot2c_f32_bf16 v193, v168, v73
v_dot2c_f32_bf16 v194, v169, v72
v_dot2c_f32_bf16 v195, v169, v73
v_dot2c_f32_bf16 v196, v170, v72
v_dot2c_f32_bf16 v197, v170, v73
v_dot2c_f32_bf16 v198, v171, v72
s_mov_b32 m0, s70
s_mov_b32 s64, s68
s_add_u32 s68, s68, 16384
s_add_u32 s70, s70, 16384
s_cmp_ge_u32 s70, 163840
s_cselect_b32 s70, s80, s70
buffer_load_dwordx4 v4, s[24:27], s64 offen offset:0 sc1 lds
v_dot2c_f32_bf16 v199, v171, v73
v_dot2c_f32_bf16 v200, v172, v72
v_dot2c_f32_bf16 v201, v172, v73
v_dot2c_f32_bf16 v202, v173, v72
v_dot2c_f32_bf16 v203, v173, v73
v_dot2c_f32_bf16 v204, v174, v72
v_dot2c_f32_bf16 v205, v174, v73
v_dot2c_f32_bf16 v206, v175, v72
v_dot2c_f32_bf16 v207, v175, v73
v_dot2c_f32_bf16 v208, v116, v73
v_dot2c_f32_bf16 v209, v118, v73
v_dot2c_f32_bf16 v192, v176, v80
v_dot2c_f32_bf16 v193, v176, v81
v_dot2c_f32_bf16 v194, v177, v80
v_dot2c_f32_bf16 v195, v177, v81
buffer_load_dwordx4 v4, s[24:27], s64 offen offset:1024 sc1 lds
v_dot2c_f32_bf16 v196, v178, v80
v_dot2c_f32_bf16 v197, v178, v81
v_dot2c_f32_bf16 v198, v179, v80
v_dot2c_f32_bf16 v199, v179, v81
v_dot2c_f32_bf16 v200, v180, v80
v_dot2c_f32_bf16 v201, v180, v81
v_dot2c_f32_bf16 v202, v181, v80
v_dot2c_f32_bf16 v203, v181, v81
v_dot2c_f32_bf16 v204, v182, v80
v_dot2c_f32_bf16 v205, v182, v81
v_dot2c_f32_bf16 v206, v183, v80
v_dot2c_f32_bf16 v207, v183, v81
v_dot2c_f32_bf16 v208, v120, v81
v_dot2c_f32_bf16 v209, v122, v81
v_dot2c_f32_bf16 v192, v184, v88
buffer_load_dwordx4 v4, s[24:27], s64 offen offset:2048 sc1 lds
v_dot2c_f32_bf16 v193, v184, v89
v_dot2c_f32_bf16 v194, v185, v88
v_dot2c_f32_bf16 v195, v185, v89
v_dot2c_f32_bf16 v196, v186, v88
v_dot2c_f32_bf16 v197, v186, v89
v_dot2c_f32_bf16 v198, v187, v88
v_dot2c_f32_bf16 v199, v187, v89
v_dot2c_f32_bf16 v200, v188, v88
v_dot2c_f32_bf16 v201, v188, v89
v_dot2c_f32_bf16 v202, v189, v88
v_dot2c_f32_bf16 v203, v189, v89
v_dot2c_f32_bf16 v204, v190, v88
v_dot2c_f32_bf16 v205, v190, v89
v_dot2c_f32_bf16 v206, v191, v88
v_dot2c_f32_bf16 v207, v191, v89
buffer_load_dwordx4 v4, s[24:27], s64 offen offset:3072 sc1 lds
v_dot2c_f32_bf16 v208, v124, v89
v_dot2c_f32_bf16 v209, v126, v89
v_lshrrev_b32 v9, 5, v5
v_mul_u32_u24 v9, 303104, v9
v_and_b32 v11, 1, v3
v_lshl_add_u32 v9, v11, 10, v9
v_lshl_add_u32 v9, v2, 4, v9
v_mul_f32 v192, v10, v192
v_mul_f32 v193, v10, v193
v_mul_f32 v194, v10, v194
v_mul_f32 v195, v10, v195
v_mul_f32 v196, v10, v196
v_mul_f32 v197, v10, v197
v_mul_f32 v198, v10, v198
v_mul_f32 v199, v10, v199
v_mul_f32 v200, v10, v200
v_mul_f32 v201, v10, v201
v_mul_f32 v202, v10, v202
v_mul_f32 v203, v10, v203
v_mul_f32 v204, v10, v204
v_mul_f32 v205, v10, v205
v_mul_f32 v206, v10, v206
v_mul_f32 v207, v10, v207
v_mul_f32 v208, v10, v208
v_mul_f32 v209, v10, v209
v_cvt_pk_bf16_f32 v192, v192, v193
v_cvt_pk_bf16_f32 v193, v194, v195
v_cvt_pk_bf16_f32 v194, v196, v197
v_cvt_pk_bf16_f32 v195, v198, v199
v_cvt_pk_bf16_f32 v196, v200, v201
v_cvt_pk_bf16_f32 v197, v202, v203
v_cvt_pk_bf16_f32 v198, v204, v205
v_cvt_pk_bf16_f32 v199, v206, v207
v_cvt_pk_bf16_f32 v200, v208, v209
s_add_u32 s53, s53, 65536
s_bfe_u32 s54, s4, 131073
s_lshl_b32 s54, s54, 11
s_add_u32 s54, s54, s53
s_and_b32 s55, s4, 1
s_lshl_b32 s55, s55, 9
s_add_u32 s54, s54, s55
s_lshl2_add_u32 s52, s85, s86
s_lshl2_add_u32 s69, s52, s3
s_mul_i32 s69, s69, 28672
s_add_u32 s69, s69, 76546048
s_lshr_b32 s73, s52, 1
s_lshl_b32 s73, s73, 10
s_and_b32 s52, s52, 1
s_lshl_b32 s52, s52, 7
s_add_u32 s73, s73, s52
s_lshl2_add_u32 s73, s3, s73
s_add_u32 s73, s73, 75498112
ds_read_b128 v[144:147], v7 offset:0
ds_read_b128 v[148:151], v7 offset:1024
ds_read_b128 v[152:155], v7 offset:2048
ds_read_b128 v[156:159], v7 offset:3072
ds_read_b128 v[160:163], v7 offset:4096
ds_read_b128 v[164:167], v7 offset:5120
ds_read_b128 v[168:171], v7 offset:6144
ds_read_b128 v[172:175], v7 offset:7168
v_mov_b32 v10, 0
s_waitcnt vmcnt(5)
v_cmp_gt_u32 vcc, 8, v12
s_mov_b32 s92, 0
s_nop 3
s_cbranch_vccz L_ZBX
L_ZB:
s_sleep 2
buffer_load_dword v12, v13, s[24:27], s75 offen sc1
s_add_u32 s92, s92, 1
s_waitcnt vmcnt(0)
v_cmp_gt_u32 vcc, 8, v12
s_cmp_gt_u32 s92, 1048576
s_cbranch_scc1 L_ZBX
s_nop 2
s_cbranch_vccnz L_ZB
L_ZBX:
s_xor_b32 s65, s82, 0
s_add_u32 s65, s65, s77
buffer_load_dwordx4 a[0:3], v4, s[24:27], s65 offen offset:0 sc1
buffer_load_dwordx4 a[8:11], v4, s[24:27], s65 offen offset:2048 sc1
s_xor_b32 s93, s82, 0
s_add_u32 s93, s93, s81
buffer_load_dwordx4 a[4:7], v4, s[24:27], s93 offen offset:0 sc1
buffer_load_dwordx4 a[12:15], v4, s[24:27], s93 offen offset:2048 sc1
buffer_load_dwordx4 a[16:19], v14, s[24:27], s65 offen offset:0 sc1
buffer_load_dwordx4 a[24:27], v14, s[24:27], s65 offen offset:2048 sc1
buffer_load_dwordx4 a[20:23], v14, s[24:27], s93 offen offset:0 sc1
buffer_load_dwordx4 a[28:31], v14, s[24:27], s93 offen offset:2048 sc1
buffer_store_dwordx4 v[192:195], v9, s[24:27], s54 offen sc1
buffer_store_dwordx4 v[196:199], v9, s[24:27], s54 offen offset:256 sc1
s_bfe_u32 s55, s4, 65538
s_lshl_b32 s55, s55, 8
s_add_u32 s54, s53, s55
s_and_b32 s55, s4, 3
s_lshl2_add_u32 s54, s55, s54
s_add_u32 s54, s54, 8192
buffer_store_dword v200, v9, s[24:27], s54 offen sc1
s_waitcnt vmcnt(9) lgkmcnt(6)
v_mfma_f32_16x16x32_bf16 v[120:123], v[144:147], a[0:3], 0
s_waitcnt vmcnt(7)
s_add_u32 s91, s91, 16384
ds_read_b128 v[176:179], v7 offset:8192
v_mfma_f32_16x16x32_bf16 v[120:123], v[148:151], a[8:11], v[120:123]
s_xor_b32 s65, s82, 8192
s_add_u32 s65, s65, s77
ds_read_b128 v[180:183], v7 offset:9216
v_mfma_f32_16x16x32_bf16 v[124:127], v[148:151], a[12:15], 0
s_waitcnt lgkmcnt(6)
ds_read_b128 v[184:187], v7 offset:10240
v_mfma_f32_16x16x32_bf16 v[124:127], v[144:147], a[4:7], v[124:127]
buffer_load_dwordx4 a[32:35], v4, s[24:27], s65 offen offset:0 sc1
v_mfma_f32_16x16x32_bf16 v[72:75], v[152:155], a[0:3], 0
s_cmp_ge_u32 s91, 163840
s_cselect_b32 s91, 0, s91
ds_read_b128 v[188:191], v7 offset:11264
v_mfma_f32_16x16x32_bf16 v[72:75], v[156:159], a[8:11], v[72:75]
s_waitcnt lgkmcnt(6)
v_add_u32 v8, s91, v4
v_mfma_f32_16x16x32_bf16 v[76:79], v[156:159], a[12:15], 0
buffer_load_dwordx4 a[40:43], v4, s[24:27], s65 offen offset:2048 sc1
v_mfma_f32_16x16x32_bf16 v[76:79], v[152:155], a[4:7], v[76:79]
s_xor_b32 s93, s82, 8192
s_add_u32 s93, s93, s81
ds_read_b128 v[144:147], v7 offset:12288
v_mfma_f32_16x16x32_bf16 v[80:83], v[160:163], a[0:3], 0
ds_read_b128 v[148:151], v7 offset:13312
v_mfma_f32_16x16x32_bf16 v[80:83], v[164:167], a[8:11], v[80:83]
buffer_load_dwordx4 a[36:39], v4, s[24:27], s93 offen offset:0 sc1
v_mfma_f32_16x16x32_bf16 v[84:87], v[164:167], a[12:15], 0
ds_read_b128 v[152:155], v7 offset:14336
v_mfma_f32_16x16x32_bf16 v[84:87], v[160:163], a[4:7], v[84:87]
s_waitcnt lgkmcnt(7)
v_mfma_f32_16x16x32_bf16 v[88:91], v[168:171], a[0:3], 0
buffer_load_dwordx4 a[44:47], v4, s[24:27], s93 offen offset:2048 sc1
v_mfma_f32_16x16x32_bf16 v[88:91], v[172:175], a[8:11], v[88:91]
ds_read_b128 v[156:159], v7 offset:15360
v_mfma_f32_16x16x32_bf16 v[92:95], v[172:175], a[12:15], 0
s_waitcnt lgkmcnt(6)
s_add_u32 s91, s91, 16384
ds_read_b128 v[160:163], v8 offset:0
v_mfma_f32_16x16x32_bf16 v[92:95], v[168:171], a[4:7], v[92:95]
buffer_load_dwordx4 a[48:51], v14, s[24:27], s65 offen offset:0 sc1
v_mfma_f32_16x16x32_bf16 v[96:99], v[176:179], a[0:3], 0
s_cmp_ge_u32 s91, 163840
s_cselect_b32 s91, 0, s91
ds_read_b128 v[164:167], v8 offset:1024
v_mfma_f32_16x16x32_bf16 v[96:99], v[180:183], a[8:11], v[96:99]
v_add_u32 v7, s91, v4
v_mfma_f32_16x16x32_bf16 v[100:103], v[180:183], a[12:15], 0
buffer_load_dwordx4 a[56:59], v14, s[24:27], s65 offen offset:2048 sc1
v_mfma_f32_16x16x32_bf16 v[100:103], v[176:179], a[4:7], v[100:103]
s_waitcnt lgkmcnt(6)
ds_read_b128 v[168:171], v8 offset:2048
v_mfma_f32_16x16x32_bf16 v[104:107], v[184:187], a[0:3], 0
ds_read_b128 v[172:175], v8 offset:3072
v_mfma_f32_16x16x32_bf16 v[104:107], v[188:191], a[8:11], v[104:107]
v_mfma_f32_16x16x32_bf16 v[108:111], v[188:191], a[12:15], 0
buffer_load_dwordx4 a[52:55], v14, s[24:27], s93 offen offset:0 sc1
v_mfma_f32_16x16x32_bf16 v[108:111], v[184:187], a[4:7], v[108:111]
s_waitcnt lgkmcnt(6)
ds_read_b128 v[176:179], v8 offset:4096
v_mfma_f32_16x16x32_bf16 v[112:115], v[144:147], a[0:3], 0
ds_read_b128 v[180:183], v8 offset:5120
v_mfma_f32_16x16x32_bf16 v[112:115], v[148:151], a[8:11], v[112:115]
v_mfma_f32_16x16x32_bf16 v[116:119], v[148:151], a[12:15], 0
buffer_load_dwordx4 a[60:63], v14, s[24:27], s93 offen offset:2048 sc1
v_mfma_f32_16x16x32_bf16 v[116:119], v[144:147], a[4:7], v[116:119]
s_waitcnt lgkmcnt(6) vmcnt(13)
ds_read_b128 v[184:187], v8 offset:6144
v_mfma_f32_16x16x32_bf16 v[120:123], v[152:155], a[16:19], v[120:123]
ds_read_b128 v[188:191], v8 offset:7168
v_mfma_f32_16x16x32_bf16 v[120:123], v[156:159], a[24:27], v[120:123]
s_waitcnt vmcnt(11)
v_mfma_f32_16x16x32_bf16 v[124:127], v[156:159], a[28:31], v[124:127]
ds_read_b128 v[144:147], v8 offset:8192
v_mfma_f32_16x16x32_bf16 v[124:127], v[152:155], a[20:23], v[124:127]
s_waitcnt lgkmcnt(7)
v_mfma_f32_16x16x32_bf16 v[72:75], v[160:163], a[16:19], v[72:75]
ds_read_b128 v[148:151], v8 offset:9216
v_mfma_f32_16x16x32_bf16 v[72:75], v[164:167], a[24:27], v[72:75]
v_mfma_f32_16x16x32_bf16 v[76:79], v[164:167], a[28:31], v[76:79]
ds_read_b128 v[152:155], v8 offset:10240
v_mfma_f32_16x16x32_bf16 v[76:79], v[160:163], a[20:23], v[76:79]
s_waitcnt lgkmcnt(7)
v_mfma_f32_16x16x32_bf16 v[80:83], v[168:171], a[16:19], v[80:83]
ds_read_b128 v[156:159], v8 offset:11264
v_mfma_f32_16x16x32_bf16 v[80:83], v[172:175], a[24:27], v[80:83]
v_mfma_f32_16x16x32_bf16 v[84:87], v[172:175], a[28:31], v[84:87]
ds_read_b128 v[160:163], v8 offset:12288
v_mfma_f32_16x16x32_bf16 v[84:87], v[168:171], a[20:23], v[84:87]
s_waitcnt lgkmcnt(7)
v_mfma_f32_16x16x32_bf16 v[88:91], v[176:179], a[16:19], v[88:91]
s_xor_b32 s65, s82, 16384
s_add_u32 s65, s65, s77
ds_read_b128 v[164:167], v8 offset:13312
v_mfma_f32_16x16x32_bf16 v[88:91], v[180:183], a[24:27], v[88:91]
v_mfma_f32_16x16x32_bf16 v[92:95], v[180:183], a[28:31], v[92:95]
s_waitcnt lgkmcnt(6)
ds_read_b128 v[168:171], v8 offset:14336
v_add_u32 v11, s70, v4
v_mfma_f32_16x16x32_bf16 v[92:95], v[176:179], a[20:23], v[92:95]
s_add_u32 s70, s70, 16384
s_cmp_ge_u32 s70, 163840
s_cselect_b32 s70, s80, s70
v_mfma_f32_16x16x32_bf16 v[96:99], v[184:187], a[16:19], v[96:99]
buffer_load_dwordx4 a[64:67], v4, s[24:27], s65 offen offset:0 sc1
v_mfma_f32_16x16x32_bf16 v[96:99], v[188:191], a[24:27], v[96:99]
s_barrier
v_mfma_f32_16x16x32_bf16 v[100:103], v[188:191], a[28:31], v[100:103]
s_waitcnt lgkmcnt(5)
ds_read_b128 v[172:175], v8 offset:15360
v_mfma_f32_16x16x32_bf16 v[100:103], v[184:187], a[20:23], v[100:103]
buffer_load_dwordx4 a[72:75], v4, s[24:27], s65 offen offset:2048 sc1
v_mfma_f32_16x16x32_bf16 v[104:107], v[144:147], a[16:19], v[104:107]
ds_write_b64 v11, a[96:97] offset:0
v_mfma_f32_16x16x32_bf16 v[104:107], v[148:151], a[24:27], v[104:107]
s_xor_b32 s93, s82, 16384
s_add_u32 s93, s93, s81
ds_read_b128 v[176:179], v7 offset:0
v_mfma_f32_16x16x32_bf16 v[108:111], v[148:151], a[28:31], v[108:111]
buffer_load_dwordx4 a[68:71], v4, s[24:27], s93 offen offset:0 sc1
v_mfma_f32_16x16x32_bf16 v[108:111], v[144:147], a[20:23], v[108:111]
s_waitcnt lgkmcnt(6)
s_add_u32 s91, s91, 16384
ds_read_b128 v[180:183], v7 offset:1024
v_mfma_f32_16x16x32_bf16 v[112:115], v[152:155], a[16:19], v[112:115]
ds_write_b64 v11, a[98:99] offset:8
v_mfma_f32_16x16x32_bf16 v[112:115], v[156:159], a[24:27], v[112:115]
s_cmp_ge_u32 s91, 163840
s_cselect_b32 s91, 0, s91
ds_read_b128 v[184:187], v7 offset:2048
v_mfma_f32_16x16x32_bf16 v[116:119], v[156:159], a[28:31], v[116:119]
buffer_load_dwordx4 a[76:79], v4, s[24:27], s93 offen offset:2048 sc1
v_mfma_f32_16x16x32_bf16 v[116:119], v[152:155], a[20:23], v[116:119]
s_waitcnt lgkmcnt(7) vmcnt(10)
ds_read_b128 v[188:191], v7 offset:3072
v_add_u32 v8, s91, v4
v_mfma_f32_16x16x32_bf16 v[120:123], v[160:163], a[32:35], v[120:123]
s_waitcnt vmcnt(12)
s_waitcnt vmcnt(8)
ds_read_b128 v[144:147], v7 offset:4096
v_mfma_f32_16x16x32_bf16 v[120:123], v[164:167], a[40:43], v[120:123]
buffer_atomic_add v1, v0, s[24:27], s74 offen offset:4 sc1
v_mfma_f32_16x16x32_bf16 v[124:127], v[164:167], a[44:47], v[124:127]
ds_write_b64 v11, a[100:101] offset:1024
v_mfma_f32_16x16x32_bf16 v[124:127], v[160:163], a[36:39], v[124:127]
s_waitcnt lgkmcnt(8)
ds_read_b128 v[148:151], v7 offset:5120
v_mfma_f32_16x16x32_bf16 v[72:75], v[168:171], a[32:35], v[72:75]
ds_read_b128 v[152:155], v7 offset:6144
v_mfma_f32_16x16x32_bf16 v[72:75], v[172:175], a[40:43], v[72:75]
s_waitcnt lgkmcnt(7)
ds_read_b128 v[156:159], v7 offset:7168
v_mfma_f32_16x16x32_bf16 v[76:79], v[172:175], a[44:47], v[76:79]
ds_write_b64 v11, a[102:103] offset:1032
v_mfma_f32_16x16x32_bf16 v[76:79], v[168:171], a[36:39], v[76:79]
buffer_load_dwordx4 a[80:83], v14, s[24:27], s65 offen offset:0 sc1
v_mfma_f32_16x16x32_bf16 v[80:83], v[176:179], a[32:35], v[80:83]
ds_read_b128 v[160:163], v7 offset:8192
v_mfma_f32_16x16x32_bf16 v[80:83], v[180:183], a[40:43], v[80:83]
s_waitcnt lgkmcnt(7)
ds_read_b128 v[164:167], v7 offset:9216
v_mfma_f32_16x16x32_bf16 v[84:87], v[180:183], a[44:47], v[84:87]
ds_write_b64 v11, a[104:105] offset:2048
v_mfma_f32_16x16x32_bf16 v[84:87], v[176:179], a[36:39], v[84:87]
buffer_load_dwordx4 a[88:91], v14, s[24:27], s65 offen offset:2048 sc1
v_mfma_f32_16x16x32_bf16 v[88:91], v[184:187], a[32:35], v[88:91]
ds_read_b128 v[168:171], v7 offset:10240
v_mfma_f32_16x16x32_bf16 v[88:91], v[188:191], a[40:43], v[88:91]
s_waitcnt lgkmcnt(7)
ds_read_b128 v[172:175], v7 offset:11264
v_mfma_f32_16x16x32_bf16 v[92:95], v[188:191], a[44:47], v[92:95]
ds_write_b64 v11, a[106:107] offset:2056
v_mfma_f32_16x16x32_bf16 v[92:95], v[184:187], a[36:39], v[92:95]
buffer_load_dwordx4 a[84:87], v14, s[24:27], s93 offen offset:0 sc1
v_mfma_f32_16x16x32_bf16 v[96:99], v[144:147], a[32:35], v[96:99]
ds_read_b128 v[176:179], v7 offset:12288
v_mfma_f32_16x16x32_bf16 v[96:99], v[148:151], a[40:43], v[96:99]
s_waitcnt lgkmcnt(8)
ds_read_b128 v[180:183], v7 offset:13312
v_mfma_f32_16x16x32_bf16 v[100:103], v[148:151], a[44:47], v[100:103]
ds_write_b64 v11, a[108:109] offset:3072
v_mfma_f32_16x16x32_bf16 v[100:103], v[144:147], a[36:39], v[100:103]
buffer_load_dwordx4 a[92:95], v14, s[24:27], s93 offen offset:2048 sc1
v_mfma_f32_16x16x32_bf16 v[104:107], v[152:155], a[32:35], v[104:107]
ds_read_b128 v[184:187], v7 offset:14336
v_mfma_f32_16x16x32_bf16 v[104:107], v[156:159], a[40:43], v[104:107]
ds_read_b128 v[188:191], v7 offset:15360
v_mfma_f32_16x16x32_bf16 v[108:111], v[156:159], a[44:47], v[108:111]
ds_write_b64 v11, a[110:111] offset:3080
v_mfma_f32_16x16x32_bf16 v[108:111], v[152:155], a[36:39], v[108:111]
s_waitcnt lgkmcnt(10)
s_add_u32 s91, s91, 16384
ds_read_b128 v[144:147], v8 offset:0
v_mfma_f32_16x16x32_bf16 v[112:115], v[160:163], a[32:35], v[112:115]
s_xor_b32 s65, s82, 24576
s_add_u32 s65, s65, s77
ds_read_b128 v[148:151], v8 offset:1024
v_mfma_f32_16x16x32_bf16 v[112:115], v[164:167], a[40:43], v[112:115]
s_cmp_ge_u32 s91, 163840
s_cselect_b32 s91, 0, s91
v_add_u32 v7, s91, v4
v_mfma_f32_16x16x32_bf16 v[116:119], v[164:167], a[44:47], v[116:119]
buffer_load_dwordx4 a[192:195], v4, s[24:27], s65 offen offset:0 sc1
v_mfma_f32_16x16x32_bf16 v[116:119], v[160:163], a[36:39], v[116:119]
s_waitcnt lgkmcnt(9) vmcnt(12)
ds_read_b128 v[152:155], v8 offset:2048
v_mfma_f32_16x16x32_bf16 v[120:123], v[168:171], a[48:51], v[120:123]
ds_read_b128 v[156:159], v8 offset:3072
v_mfma_f32_16x16x32_bf16 v[120:123], v[172:175], a[56:59], v[120:123]
s_waitcnt vmcnt(10)
v_mfma_f32_16x16x32_bf16 v[124:127], v[172:175], a[60:63], v[124:127]
buffer_load_dwordx4 a[200:203], v4, s[24:27], s65 offen offset:2048 sc1
v_mfma_f32_16x16x32_bf16 v[124:127], v[168:171], a[52:55], v[124:127]
s_waitcnt lgkmcnt(8)
ds_read_b128 v[160:163], v8 offset:4096
v_mfma_f32_16x16x32_bf16 v[72:75], v[176:179], a[48:51], v[72:75]
s_xor_b32 s93, s82, 24576
s_add_u32 s93, s93, s81
ds_read_b128 v[164:167], v8 offset:5120
v_mfma_f32_16x16x32_bf16 v[72:75], v[180:183], a[56:59], v[72:75]
v_mfma_f32_16x16x32_bf16 v[76:79], v[180:183], a[60:63], v[76:79]
buffer_load_dwordx4 a[196:199], v4, s[24:27], s93 offen offset:0 sc1
v_mfma_f32_16x16x32_bf16 v[76:79], v[176:179], a[52:55], v[76:79]
s_waitcnt lgkmcnt(7)
ds_read_b128 v[168:171], v8 offset:6144
v_mfma_f32_16x16x32_bf16 v[80:83], v[184:187], a[48:51], v[80:83]
ds_read_b128 v[172:175], v8 offset:7168
v_mfma_f32_16x16x32_bf16 v[80:83], v[188:191], a[56:59], v[80:83]
v_mfma_f32_16x16x32_bf16 v[84:87], v[188:191], a[60:63], v[84:87]
buffer_load_dwordx4 a[204:207], v4, s[24:27], s93 offen offset:2048 sc1
v_mfma_f32_16x16x32_bf16 v[84:87], v[184:187], a[52:55], v[84:87]
s_waitcnt lgkmcnt(6)
ds_read_b128 v[176:179], v8 offset:8192
v_mfma_f32_16x16x32_bf16 v[88:91], v[144:147], a[48:51], v[88:91]
ds_read_b128 v[180:183], v8 offset:9216
v_mfma_f32_16x16x32_bf16 v[88:91], v[148:151], a[56:59], v[88:91]
v_mfma_f32_16x16x32_bf16 v[92:95], v[148:151], a[60:63], v[92:95]
ds_read_b128 v[184:187], v8 offset:10240
v_mfma_f32_16x16x32_bf16 v[92:95], v[144:147], a[52:55], v[92:95]
s_waitcnt lgkmcnt(7)
v_mfma_f32_16x16x32_bf16 v[96:99], v[152:155], a[48:51], v[96:99]
s_add_u32 s52, s84, 1
ds_read_b128 v[188:191], v8 offset:11264
v_mfma_f32_16x16x32_bf16 v[96:99], v[156:159], a[56:59], v[96:99]
v_mfma_f32_16x16x32_bf16 v[100:103], v[156:159], a[60:63], v[100:103]
buffer_load_dwordx4 a[208:211], v14, s[24:27], s65 offen offset:0 sc1
v_mfma_f32_16x16x32_bf16 v[100:103], v[152:155], a[52:55], v[100:103]
s_and_b32 s52, s52, 3
s_waitcnt lgkmcnt(6)
ds_read_b128 v[144:147], v8 offset:12288
v_mfma_f32_16x16x32_bf16 v[104:107], v[160:163], a[48:51], v[104:107]
ds_read_b128 v[148:151], v8 offset:13312
v_mfma_f32_16x16x32_bf16 v[104:107], v[164:167], a[56:59], v[104:107]
s_waitcnt lgkmcnt(6)
v_mfma_f32_16x16x32_bf16 v[108:111], v[164:167], a[60:63], v[108:111]
s_mul_i32 s52, s52, 6144
ds_read_b128 v[152:155], v8 offset:14336
v_add_u32 v11, s70, v4
v_mfma_f32_16x16x32_bf16 v[108:111], v[160:163], a[52:55], v[108:111]
s_add_u32 s70, s70, 16384
s_cmp_ge_u32 s70, 163840
s_cselect_b32 s70, s80, s70
v_mfma_f32_16x16x32_bf16 v[112:115], v[168:171], a[48:51], v[112:115]
s_waitcnt vmcnt(50)
ds_read_b128 v[156:159], v8 offset:15360
v_mfma_f32_16x16x32_bf16 v[112:115], v[172:175], a[56:59], v[112:115]
s_barrier
v_mfma_f32_16x16x32_bf16 v[116:119], v[172:175], a[60:63], v[116:119]
s_add_u32 s52, s52, s69
s_waitcnt lgkmcnt(6) vmcnt(12)
ds_read_b128 v[160:163], v7 offset:0
v_mfma_f32_16x16x32_bf16 v[116:119], v[168:171], a[52:55], v[116:119]
buffer_load_dwordx4 a[216:219], v14, s[24:27], s65 offen offset:2048 sc1
v_mfma_f32_16x16x32_bf16 v[120:123], v[176:179], a[64:67], v[120:123]
ds_write_b64 v11, a[112:113] offset:0
v_mfma_f32_16x16x32_bf16 v[120:123], v[180:183], a[72:75], v[120:123]
s_add_u32 s52, s52, 0
s_waitcnt vmcnt(11)
ds_read_b128 v[164:167], v7 offset:1024
v_mfma_f32_16x16x32_bf16 v[124:127], v[180:183], a[76:79], v[124:127]
buffer_load_dwordx4 a[212:215], v14, s[24:27], s93 offen offset:0 sc1
v_mfma_f32_16x16x32_bf16 v[124:127], v[176:179], a[68:71], v[124:127]
s_waitcnt lgkmcnt(7)
s_add_u32 s91, s91, 16384
ds_read_b128 v[168:171], v7 offset:2048
v_mfma_f32_16x16x32_bf16 v[72:75], v[184:187], a[64:67], v[72:75]
s_add_u32 s53, s84, 2
ds_read_b128 v[172:175], v7 offset:3072
v_mfma_f32_16x16x32_bf16 v[72:75], v[188:191], a[72:75], v[72:75]
ds_write_b64 v11, a[114:115] offset:8
v_mfma_f32_16x16x32_bf16 v[76:79], v[188:191], a[76:79], v[76:79]
buffer_load_dwordx4 a[220:223], v14, s[24:27], s93 offen offset:2048 sc1
v_mfma_f32_16x16x32_bf16 v[76:79], v[184:187], a[68:71], v[76:79]
s_and_b32 s53, s53, 3
s_waitcnt lgkmcnt(8)
ds_read_b128 v[176:179], v7 offset:4096
v_mfma_f32_16x16x32_bf16 v[80:83], v[144:147], a[64:67], v[80:83]
s_xor_b32 s65, s82, 32768
s_add_u32 s65, s65, s77
ds_read_b128 v[180:183], v7 offset:5120
v_mfma_f32_16x16x32_bf16 v[80:83], v[148:151], a[72:75], v[80:83]
ds_write_b64 v11, a[116:117] offset:1024
v_mfma_f32_16x16x32_bf16 v[84:87], v[148:151], a[76:79], v[84:87]
s_mul_i32 s53, s53, 6144
s_waitcnt lgkmcnt(9)
ds_read_b128 v[184:187], v7 offset:6144
v_mfma_f32_16x16x32_bf16 v[84:87], v[144:147], a[68:71], v[84:87]
buffer_load_dwordx4 a[224:227], v4, s[24:27], s65 offen offset:0 sc1
v_mfma_f32_16x16x32_bf16 v[88:91], v[152:155], a[64:67], v[88:91]
s_cmp_ge_u32 s91, 163840
L_PAD11:
s_cbranch_execz L_MAIN
s_cselect_b32 s91, 0, s91
ds_read_b128 v[188:191], v7 offset:7168
v_mfma_f32_16x16x32_bf16 v[88:91], v[156:159], a[72:75], v[88:91]
s_add_u32 s53, s53, s69
s_waitcnt lgkmcnt(8)
v_add_u32 v8, s91, v4
v_mfma_f32_16x16x32_bf16 v[92:95], v[156:159], a[76:79], v[92:95]
ds_write_b64 v11, a[118:119] offset:1032
v_mfma_f32_16x16x32_bf16 v[92:95], v[152:155], a[68:71], v[92:95]
buffer_load_dwordx4 a[232:235], v4, s[24:27], s65 offen offset:2048 sc1
v_mfma_f32_16x16x32_bf16 v[96:99], v[160:163], a[64:67], v[96:99]
s_add_u32 s53, s53, 2048
s_xor_b32 s93, s82, 32768
s_add_u32 s93, s93, s81
v_mfma_f32_16x16x32_bf16 v[96:99], v[164:167], a[72:75], v[96:99]
ds_read_b128 v[144:147], v7 offset:8192
v_mfma_f32_16x16x32_bf16 v[100:103], v[164:167], a[76:79], v[100:103]
ds_write_b64 v11, a[120:121] offset:2048
v_mfma_f32_16x16x32_bf16 v[100:103], v[160:163], a[68:71], v[100:103]
s_add_u32 s54, s84, 3
s_waitcnt lgkmcnt(9) vmcnt(12)
ds_read_b128 v[148:151], v7 offset:9216
v_mfma_f32_16x16x32_bf16 v[120:123], v[168:171], a[80:83], v[120:123]
buffer_load_dwordx4 a[228:231], v4, s[24:27], s93 offen offset:0 sc1
v_mfma_f32_16x16x32_bf16 v[120:123], v[172:175], a[88:91], v[120:123]
s_waitcnt vmcnt(11)
ds_read_b128 v[152:155], v7 offset:10240
v_mfma_f32_16x16x32_bf16 v[124:127], v[172:175], a[92:95], v[124:127]
s_and_b32 s54, s54, 3
s_waitcnt lgkmcnt(8)
ds_read_b128 v[156:159], v7 offset:11264
v_mfma_f32_16x16x32_bf16 v[124:127], v[168:171], a[84:87], v[124:127]
ds_write_b64 v11, a[122:123] offset:2056
v_mfma_f32_16x16x32_bf16 v[72:75], v[176:179], a[80:83], v[72:75]
buffer_load_dwordx4 a[236:239], v4, s[24:27], s93 offen offset:2048 sc1
v_mfma_f32_16x16x32_bf16 v[72:75], v[180:183], a[88:91], v[72:75]
s_mul_i32 s54, s54, 6144
ds_read_b128 v[160:163], v7 offset:12288
v_mfma_f32_16x16x32_bf16 v[76:79], v[180:183], a[92:95], v[76:79]
s_waitcnt lgkmcnt(8)
ds_read_b128 v[164:167], v7 offset:13312
v_mfma_f32_16x16x32_bf16 v[76:79], v[176:179], a[84:87], v[76:79]
ds_write_b64 v11, a[124:125] offset:3072
v_mfma_f32_16x16x32_bf16 v[80:83], v[184:187], a[80:83], v[80:83]
s_add_u32 s54, s54, s69
ds_read_b128 v[168:171], v7 offset:14336
v_mfma_f32_16x16x32_bf16 v[80:83], v[188:191], a[88:91], v[80:83]
ds_read_b128 v[172:175], v7 offset:15360
v_mfma_f32_16x16x32_bf16 v[84:87], v[188:191], a[92:95], v[84:87]
buffer_load_dwordx4 a[240:243], v14, s[24:27], s65 offen offset:0 sc1
v_mfma_f32_16x16x32_bf16 v[84:87], v[184:187], a[84:87], v[84:87]
s_add_u32 s54, s54, 4096
s_waitcnt lgkmcnt(8)
ds_read_b128 v[176:179], v8 offset:0
v_mfma_f32_16x16x32_bf16 v[88:91], v[144:147], a[80:83], v[88:91]
ds_write_b64 v11, a[126:127] offset:3080
v_mfma_f32_16x16x32_bf16 v[88:91], v[148:151], a[88:91], v[88:91]
s_add_u32 s91, s91, 16384
ds_read_b128 v[180:183], v8 offset:1024
v_add_u32 v11, s70, v4
v_mfma_f32_16x16x32_bf16 v[92:95], v[148:151], a[92:95], v[92:95]
s_sub_u32 s55, s3, s84
s_add_u32 s70, s70, 16384
ds_read_b128 v[184:187], v8 offset:2048
v_mfma_f32_16x16x32_bf16 v[92:95], v[144:147], a[84:87], v[92:95]
s_cmp_ge_u32 s70, 163840
s_cselect_b32 s70, s80, s70
s_waitcnt lgkmcnt(10)
v_mfma_f32_16x16x32_bf16 v[96:99], v[152:155], a[80:83], v[96:99]
buffer_load_dwordx4 a[248:251], v14, s[24:27], s65 offen offset:2048 sc1
v_mfma_f32_16x16x32_bf16 v[96:99], v[156:159], a[88:91], v[96:99]
s_and_b32 s55, s55, 3
s_waitcnt lgkmcnt(7) vmcnt(12)
ds_read_b128 v[188:191], v8 offset:3072
v_mfma_f32_16x16x32_bf16 v[100:103], v[156:159], a[92:95], v[100:103]
ds_write_b64 v11, a[160:161] offset:0
v_mfma_f32_16x16x32_bf16 v[100:103], v[152:155], a[84:87], v[100:103]
buffer_load_dwordx4 a[244:247], v14, s[24:27], s93 offen offset:0 sc1
v_mfma_f32_16x16x32_bf16 v[120:123], v[160:163], a[192:195], v[120:123]
s_lshl_b32 s55, s55, 10
ds_read_b128 v[144:147], v8 offset:4096
v_mfma_f32_16x16x32_bf16 v[120:123], v[164:167], a[200:203], v[120:123]
s_waitcnt vmcnt(11)
ds_read_b128 v[148:151], v8 offset:5120
v_mfma_f32_16x16x32_bf16 v[124:127], v[164:167], a[204:207], v[124:127]
ds_write_b64 v11, a[162:163] offset:8
v_mfma_f32_16x16x32_bf16 v[124:127], v[160:163], a[196:199], v[124:127]
s_add_u32 s55, s55, s69
s_waitcnt lgkmcnt(9)
ds_read_b128 v[152:155], v8 offset:6144
v_mfma_f32_16x16x32_bf16 v[72:75], v[168:171], a[192:195], v[72:75]
buffer_load_dwordx4 a[252:255], v14, s[24:27], s93 offen offset:2048 sc1
v_mfma_f32_16x16x32_bf16 v[72:75], v[172:175], a[200:203], v[72:75]
s_cmp_ge_u32 s91, 163840
s_cselect_b32 s91, 0, s91
ds_read_b128 v[156:159], v8 offset:7168
v_mfma_f32_16x16x32_bf16 v[76:79], v[172:175], a[204:207], v[76:79]
s_add_u32 s55, s55, 23552
s_waitcnt lgkmcnt(8)
ds_read_b128 v[160:163], v8 offset:8192
v_mfma_f32_16x16x32_bf16 v[76:79], v[168:171], a[196:199], v[76:79]
ds_write_b64 v11, a[164:165] offset:1024
v_mfma_f32_16x16x32_bf16 v[80:83], v[176:179], a[192:195], v[80:83]
s_xor_b32 s65, s82, 40960
s_add_u32 s65, s65, s77
ds_read_b128 v[164:167], v8 offset:9216
v_mfma_f32_16x16x32_bf16 v[80:83], v[180:183], a[200:203], v[80:83]
s_add_u32 s71, s69, 24576
s_waitcnt lgkmcnt(9)
v_add_u32 v7, s91, v4
v_mfma_f32_16x16x32_bf16 v[84:87], v[180:183], a[204:207], v[84:87]
buffer_load_dwordx4 a[96:99], v4, s[24:27], s65 offen offset:0 sc1
v_mfma_f32_16x16x32_bf16 v[84:87], v[176:179], a[196:199], v[84:87]
ds_write_b64 v11, a[166:167] offset:1032
v_mfma_f32_16x16x32_bf16 v[88:91], v[184:187], a[192:195], v[88:91]
s_cmp_eq_u32 s3, s84
s_cselect_b32 s55, 2147418112, s55
s_cselect_b32 s71, s71, 2147418112
v_mfma_f32_16x16x32_bf16 v[88:91], v[188:191], a[200:203], v[88:91]
ds_read_b128 v[168:171], v8 offset:10240
v_mfma_f32_16x16x32_bf16 v[92:95], v[188:191], a[204:207], v[92:95]
buffer_load_dwordx4 a[104:107], v4, s[24:27], s65 offen offset:2048 sc1
v_mfma_f32_16x16x32_bf16 v[92:95], v[184:187], a[196:199], v[92:95]
s_mul_i32 s83, s84, 6144
s_waitcnt lgkmcnt(8)
ds_read_b128 v[172:175], v8 offset:11264
v_mfma_f32_16x16x32_bf16 v[96:99], v[144:147], a[192:195], v[96:99]
ds_write_b64 v11, a[168:169] offset:2048
v_mfma_f32_16x16x32_bf16 v[96:99], v[148:151], a[200:203], v[96:99]
s_xor_b32 s93, s82, 40960
s_add_u32 s93, s93, s81
ds_read_b128 v[176:179], v8 offset:12288
v_mfma_f32_16x16x32_bf16 v[100:103], v[148:151], a[204:207], v[100:103]
s_add_u32 s69, s69, s83
s_waitcnt lgkmcnt(8) vmcnt(12)
ds_read_b128 v[180:183], v8 offset:13312
v_mfma_f32_16x16x32_bf16 v[100:103], v[144:147], a[196:199], v[100:103]
buffer_load_dwordx4 a[100:103], v4, s[24:27], s93 offen offset:0 sc1
v_mfma_f32_16x16x32_bf16 v[120:123], v[152:155], a[208:211], v[120:123]
s_waitcnt vmcnt(56)
s_waitcnt vmcnt(11)
ds_read_b128 v[184:187], v8 offset:14336
v_mfma_f32_16x16x32_bf16 v[120:123], v[156:159], a[216:219], v[120:123]
s_barrier
v_mfma_f32_16x16x32_bf16 v[124:127], v[156:159], a[220:223], v[124:127]
s_add_u32 s83, s69, 4096
s_waitcnt lgkmcnt(7)
ds_read_b128 v[188:191], v8 offset:15360
v_mfma_f32_16x16x32_bf16 v[124:127], v[152:155], a[212:215], v[124:127]
ds_write_b64 v11, a[170:171] offset:2056
v_mfma_f32_16x16x32_bf16 v[72:75], v[160:163], a[208:211], v[72:75]
buffer_load_dwordx4 a[108:111], v4, s[24:27], s93 offen offset:2048 sc1
v_mfma_f32_16x16x32_bf16 v[72:75], v[164:167], a[216:219], v[72:75]
s_add_u32 s91, s91, 16384
ds_read_b128 v[144:147], v7 offset:0
v_mfma_f32_16x16x32_bf16 v[76:79], v[164:167], a[220:223], v[76:79]
s_waitcnt lgkmcnt(7)
ds_read_b128 v[148:151], v7 offset:1024
v_mfma_f32_16x16x32_bf16 v[76:79], v[160:163], a[212:215], v[76:79]
ds_write_b64 v11, a[172:173] offset:3072
v_mfma_f32_16x16x32_bf16 v[80:83], v[168:171], a[208:211], v[80:83]
s_cmp_ge_u32 s91, 163840
s_cselect_b32 s91, 0, s91
ds_read_b128 v[152:155], v7 offset:2048
v_mfma_f32_16x16x32_bf16 v[80:83], v[172:175], a[216:219], v[80:83]
s_waitcnt lgkmcnt(7)
ds_read_b128 v[156:159], v7 offset:3072
v_add_u32 v8, s91, v4
v_mfma_f32_16x16x32_bf16 v[84:87], v[172:175], a[220:223], v[84:87]
buffer_load_dwordx4 a[112:115], v14, s[24:27], s65 offen offset:0 sc1
v_mfma_f32_16x16x32_bf16 v[84:87], v[168:171], a[212:215], v[84:87]
ds_write_b64 v11, a[174:175] offset:3080
v_mfma_f32_16x16x32_bf16 v[88:91], v[176:179], a[208:211], v[88:91]
s_add_u32 s68, s68, 49152
ds_read_b128 v[160:163], v7 offset:4096
v_mfma_f32_16x16x32_bf16 v[88:91], v[180:183], a[216:219], v[88:91]
ds_read_b128 v[164:167], v7 offset:5120
v_mfma_f32_16x16x32_bf16 v[92:95], v[180:183], a[220:223], v[92:95]
buffer_load_dwordx4 a[120:123], v14, s[24:27], s65 offen offset:2048 sc1
v_mfma_f32_16x16x32_bf16 v[92:95], v[176:179], a[212:215], v[92:95]
s_waitcnt lgkmcnt(9)
ds_read_b128 v[168:171], v7 offset:6144
v_mfma_f32_16x16x32_bf16 v[96:99], v[184:187], a[208:211], v[96:99]
ds_read_b128 v[172:175], v7 offset:7168
v_mfma_f32_16x16x32_bf16 v[96:99], v[188:191], a[216:219], v[96:99]
v_mfma_f32_16x16x32_bf16 v[100:103], v[188:191], a[220:223], v[100:103]
buffer_load_dwordx4 a[116:119], v14, s[24:27], s93 offen offset:0 sc1
v_mfma_f32_16x16x32_bf16 v[100:103], v[184:187], a[212:215], v[100:103]
s_waitcnt lgkmcnt(8) vmcnt(13)
ds_read_b128 v[176:179], v7 offset:8192
v_mfma_f32_16x16x32_bf16 v[120:123], v[144:147], a[224:227], v[120:123]
ds_read_b128 v[180:183], v7 offset:9216
v_mfma_f32_16x16x32_bf16 v[120:123], v[148:151], a[232:235], v[120:123]
s_waitcnt vmcnt(11)
v_mfma_f32_16x16x32_bf16 v[124:127], v[148:151], a[236:239], v[124:127]
buffer_load_dwordx4 a[124:127], v14, s[24:27], s93 offen offset:2048 sc1
v_mfma_f32_16x16x32_bf16 v[124:127], v[144:147], a[228:231], v[124:127]
s_waitcnt lgkmcnt(7)
ds_read_b128 v[184:187], v7 offset:10240
v_mfma_f32_16x16x32_bf16 v[72:75], v[152:155], a[224:227], v[72:75]
ds_read_b128 v[188:191], v7 offset:11264
v_mfma_f32_16x16x32_bf16 v[72:75], v[156:159], a[232:235], v[72:75]
v_mfma_f32_16x16x32_bf16 v[76:79], v[156:159], a[236:239], v[76:79]
ds_read_b128 v[144:147], v7 offset:12288
v_mfma_f32_16x16x32_bf16 v[76:79], v[152:155], a[228:231], v[76:79]
s_waitcnt lgkmcnt(7)
v_mfma_f32_16x16x32_bf16 v[80:83], v[160:163], a[224:227], v[80:83]
s_xor_b32 s65, s82, 49152
s_add_u32 s65, s65, s77
ds_read_b128 v[148:151], v7 offset:13312
v_mfma_f32_16x16x32_bf16 v[80:83], v[164:167], a[232:235], v[80:83]
v_mov_b32 v13, 0xffff0000
v_mul_u32_u24 v5, 1152, v2
v_mfma_f32_16x16x32_bf16 v[84:87], v[164:167], a[236:239], v[84:87]
buffer_load_dwordx4 a[128:131], v4, s[24:27], s65 offen offset:0 sc1
v_mfma_f32_16x16x32_bf16 v[84:87], v[160:163], a[228:231], v[84:87]
s_waitcnt lgkmcnt(6)
ds_read_b128 v[152:155], v7 offset:14336
v_lshl_add_u32 v6, v3, 3, v5
v_mfma_f32_16x16x32_bf16 v[88:91], v[168:171], a[224:227], v[88:91]
ds_read_b128 v[156:159], v7 offset:15360
v_and_b32 v9, 1, v3
v_mfma_f32_16x16x32_bf16 v[88:91], v[172:175], a[232:235], v[88:91]
s_add_u32 s91, s91, 16384
s_cmp_ge_u32 s91, 163840
s_cselect_b32 s91, 0, s91
v_mfma_f32_16x16x32_bf16 v[92:95], v[172:175], a[236:239], v[92:95]
buffer_load_dwordx4 a[136:139], v4, s[24:27], s65 offen offset:2048 sc1
v_mfma_f32_16x16x32_bf16 v[92:95], v[168:171], a[228:231], v[92:95]
s_waitcnt lgkmcnt(6)
ds_read_b128 v[160:163], v8 offset:0
v_add_u32 v7, s91, v4
v_mfma_f32_16x16x32_bf16 v[96:99], v[176:179], a[224:227], v[96:99]
s_xor_b32 s93, s82, 49152
s_add_u32 s93, s93, s81
ds_read_b128 v[164:167], v8 offset:1024
v_mfma_f32_16x16x32_bf16 v[96:99], v[180:183], a[232:235], v[96:99]
v_lshl_add_u32 v5, v9, 5, v5
v_lshrrev_b32 v9, 1, v3
v_mfma_f32_16x16x32_bf16 v[100:103], v[180:183], a[236:239], v[100:103]
buffer_load_dwordx4 a[132:135], v4, s[24:27], s93 offen offset:0 sc1
v_mfma_f32_16x16x32_bf16 v[100:103], v[176:179], a[228:231], v[100:103]
s_waitcnt lgkmcnt(6) vmcnt(13)
ds_read_b128 v[168:171], v8 offset:2048
v_lshl_add_u32 v5, v9, 4, v5
v_mfma_f32_16x16x32_bf16 v[120:123], v[184:187], a[240:243], v[120:123]
ds_read_b128 v[172:175], v8 offset:3072
v_mfma_f32_16x16x32_bf16 v[120:123], v[188:191], a[248:251], v[120:123]
s_waitcnt vmcnt(11)
v_mfma_f32_16x16x32_bf16 v[124:127], v[188:191], a[252:255], v[124:127]
buffer_load_dwordx4 a[140:143], v4, s[24:27], s93 offen offset:2048 sc1
v_mfma_f32_16x16x32_bf16 v[124:127], v[184:187], a[244:247], v[124:127]
s_waitcnt lgkmcnt(6)
ds_read_b128 v[176:179], v8 offset:4096
v_mfma_f32_16x16x32_bf16 v[72:75], v[144:147], a[240:243], v[72:75]
ds_read_b128 v[180:183], v8 offset:5120
v_mfma_f32_16x16x32_bf16 v[72:75], v[148:151], a[248:251], v[72:75]
v_mfma_f32_16x16x32_bf16 v[76:79], v[148:151], a[252:255], v[76:79]
ds_read_b128 v[184:187], v8 offset:6144
v_mfma_f32_16x16x32_bf16 v[76:79], v[144:147], a[244:247], v[76:79]
s_waitcnt lgkmcnt(7)
v_mfma_f32_16x16x32_bf16 v[80:83], v[152:155], a[240:243], v[80:83]
ds_read_b128 v[188:191], v8 offset:7168
v_mfma_f32_16x16x32_bf16 v[80:83], v[156:159], a[248:251], v[80:83]
s_waitcnt lgkmcnt(6)
v_mfma_f32_16x16x32_bf16 v[84:87], v[156:159], a[252:255], v[84:87]
buffer_load_dword v12, v10, s[24:27], s75 offen offset:4 sc1
v_mfma_f32_16x16x32_bf16 v[84:87], v[152:155], a[244:247], v[84:87]
buffer_load_dwordx4 a[144:147], v14, s[24:27], s65 offen offset:0 sc1
v_mfma_f32_16x16x32_bf16 v[88:91], v[160:163], a[240:243], v[88:91]
ds_read_b128 v[144:147], v8 offset:8192
v_mfma_f32_16x16x32_bf16 v[88:91], v[164:167], a[248:251], v[88:91]
ds_read_b128 v[148:151], v8 offset:9216
v_mfma_f32_16x16x32_bf16 v[92:95], v[164:167], a[252:255], v[92:95]
buffer_load_dwordx4 a[152:155], v14, s[24:27], s65 offen offset:2048 sc1
v_mfma_f32_16x16x32_bf16 v[92:95], v[160:163], a[244:247], v[92:95]
s_waitcnt lgkmcnt(6)
ds_read_b128 v[152:155], v8 offset:10240
v_mfma_f32_16x16x32_bf16 v[96:99], v[168:171], a[240:243], v[96:99]
ds_read_b128 v[156:159], v8 offset:11264
v_mfma_f32_16x16x32_bf16 v[96:99], v[172:175], a[248:251], v[96:99]
v_mfma_f32_16x16x32_bf16 v[100:103], v[172:175], a[252:255], v[100:103]
buffer_load_dwordx4 a[148:151], v14, s[24:27], s93 offen offset:0 sc1
v_mfma_f32_16x16x32_bf16 v[100:103], v[168:171], a[244:247], v[100:103]
s_waitcnt lgkmcnt(6) vmcnt(14)
ds_read_b128 v[160:163], v8 offset:12288
v_mfma_f32_16x16x32_bf16 v[120:123], v[176:179], a[96:99], v[120:123]
ds_read_b128 v[164:167], v8 offset:13312
v_mfma_f32_16x16x32_bf16 v[120:123], v[180:183], a[104:107], v[120:123]
s_waitcnt vmcnt(12)
v_mfma_f32_16x16x32_bf16 v[124:127], v[180:183], a[108:111], v[124:127]
buffer_load_dwordx4 a[156:159], v14, s[24:27], s93 offen offset:2048 sc1
v_mfma_f32_16x16x32_bf16 v[124:127], v[176:179], a[100:103], v[124:127]
s_waitcnt lgkmcnt(6)
ds_read_b128 v[168:171], v8 offset:14336
v_mfma_f32_16x16x32_bf16 v[72:75], v[184:187], a[96:99], v[72:75]
s_waitcnt vmcnt(61)
ds_read_b128 v[172:175], v8 offset:15360
v_mfma_f32_16x16x32_bf16 v[72:75], v[188:191], a[104:107], v[72:75]
s_barrier
v_mfma_f32_16x16x32_bf16 v[76:79], v[188:191], a[108:111], v[76:79]
s_add_u32 s91, s91, 16384
ds_read_b128 v[176:179], v7 offset:0
v_mfma_f32_16x16x32_bf16 v[76:79], v[184:187], a[100:103], v[76:79]
s_waitcnt lgkmcnt(7)
s_cmp_ge_u32 s91, 163840
s_cselect_b32 s91, 0, s91
v_mfma_f32_16x16x32_bf16 v[80:83], v[144:147], a[96:99], v[80:83]
s_xor_b32 s65, s82, 57344
s_add_u32 s65, s65, s77
ds_read_b128 v[180:183], v7 offset:1024
v_mfma_f32_16x16x32_bf16 v[80:83], v[148:151], a[104:107], v[80:83]
v_add_u32 v8, s91, v4
v_mfma_f32_16x16x32_bf16 v[84:87], v[148:151], a[108:111], v[84:87]
buffer_load_dwordx4 a[160:163], v4, s[24:27], s65 offen offset:0 sc1
v_mfma_f32_16x16x32_bf16 v[84:87], v[144:147], a[100:103], v[84:87]
s_waitcnt lgkmcnt(6)
ds_read_b128 v[184:187], v7 offset:2048
v_mfma_f32_16x16x32_bf16 v[88:91], v[152:155], a[96:99], v[88:91]
ds_read_b128 v[188:191], v7 offset:3072
v_mfma_f32_16x16x32_bf16 v[88:91], v[156:159], a[104:107], v[88:91]
v_mfma_f32_16x16x32_bf16 v[92:95], v[156:159], a[108:111], v[92:95]
buffer_load_dwordx4 a[168:171], v4, s[24:27], s65 offen offset:2048 sc1
v_mfma_f32_16x16x32_bf16 v[92:95], v[152:155], a[100:103], v[92:95]
s_waitcnt lgkmcnt(6)
ds_read_b128 v[144:147], v7 offset:4096
v_mfma_f32_16x16x32_bf16 v[96:99], v[160:163], a[96:99], v[96:99]
s_xor_b32 s93, s82, 57344
s_add_u32 s93, s93, s81
ds_read_b128 v[148:151], v7 offset:5120
v_mfma_f32_16x16x32_bf16 v[96:99], v[164:167], a[104:107], v[96:99]
v_mfma_f32_16x16x32_bf16 v[100:103], v[164:167], a[108:111], v[100:103]
buffer_load_dwordx4 a[164:167], v4, s[24:27], s93 offen offset:0 sc1
v_mfma_f32_16x16x32_bf16 v[100:103], v[160:163], a[100:103], v[100:103]
s_waitcnt lgkmcnt(6) vmcnt(14)
ds_read_b128 v[152:155], v7 offset:6144
v_mfma_f32_16x16x32_bf16 v[120:123], v[168:171], a[112:115], v[120:123]
ds_read_b128 v[156:159], v7 offset:7168
v_mfma_f32_16x16x32_bf16 v[120:123], v[172:175], a[120:123], v[120:123]
s_waitcnt vmcnt(12)
v_mfma_f32_16x16x32_bf16 v[124:127], v[172:175], a[124:127], v[124:127]
buffer_load_dwordx4 a[172:175], v4, s[24:27], s93 offen offset:2048 sc1
v_mfma_f32_16x16x32_bf16 v[124:127], v[168:171], a[116:119], v[124:127]
s_waitcnt lgkmcnt(6)
ds_read_b128 v[160:163], v7 offset:8192
v_mfma_f32_16x16x32_bf16 v[72:75], v[176:179], a[112:115], v[72:75]
ds_read_b128 v[164:167], v7 offset:9216
v_mfma_f32_16x16x32_bf16 v[72:75], v[180:183], a[120:123], v[72:75]
v_mfma_f32_16x16x32_bf16 v[76:79], v[180:183], a[124:127], v[76:79]
ds_read_b128 v[168:171], v7 offset:10240
v_mfma_f32_16x16x32_bf16 v[76:79], v[176:179], a[116:119], v[76:79]
s_waitcnt lgkmcnt(7)
v_mfma_f32_16x16x32_bf16 v[80:83], v[184:187], a[112:115], v[80:83]
ds_read_b128 v[172:175], v7 offset:11264
v_mfma_f32_16x16x32_bf16 v[80:83], v[188:191], a[120:123], v[80:83]
v_mfma_f32_16x16x32_bf16 v[84:87], v[188:191], a[124:127], v[84:87]
buffer_load_dwordx4 a[176:179], v14, s[24:27], s65 offen offset:0 sc1
v_mfma_f32_16x16x32_bf16 v[84:87], v[184:187], a[116:119], v[84:87]
s_waitcnt lgkmcnt(6)
ds_read_b128 v[176:179], v7 offset:12288
v_mfma_f32_16x16x32_bf16 v[88:91], v[144:147], a[112:115], v[88:91]
ds_read_b128 v[180:183], v7 offset:13312
v_mfma_f32_16x16x32_bf16 v[88:91], v[148:151], a[120:123], v[88:91]
v_mfma_f32_16x16x32_bf16 v[92:95], v[148:151], a[124:127], v[92:95]
buffer_load_dwordx4 a[184:187], v14, s[24:27], s65 offen offset:2048 sc1
v_mfma_f32_16x16x32_bf16 v[92:95], v[144:147], a[116:119], v[92:95]
s_waitcnt lgkmcnt(6)
ds_read_b128 v[184:187], v7 offset:14336
v_mfma_f32_16x16x32_bf16 v[96:99], v[152:155], a[112:115], v[96:99]
s_waitcnt vmcnt(10)
ds_read_b128 v[188:191], v7 offset:15360
v_mfma_f32_16x16x32_bf16 v[96:99], v[156:159], a[120:123], v[96:99]
s_add_u32 s91, s91, 16384
v_cmp_gt_u32 vcc, 8, v12
v_mfma_f32_16x16x32_bf16 v[100:103], v[156:159], a[124:127], v[100:103]
buffer_load_dwordx4 a[180:183], v14, s[24:27], s93 offen offset:0 sc1
v_mfma_f32_16x16x32_bf16 v[100:103], v[152:155], a[116:119], v[100:103]
s_waitcnt lgkmcnt(6) vmcnt(14)
ds_read_b128 v[144:147], v8 offset:0
v_mfma_f32_16x16x32_bf16 v[120:123], v[160:163], a[128:131], v[120:123]
s_cmp_ge_u32 s91, 163840
s_cselect_b32 s91, 0, s91
ds_read_b128 v[148:151], v8 offset:1024
v_mfma_f32_16x16x32_bf16 v[120:123], v[164:167], a[136:139], v[120:123]
s_waitcnt lgkmcnt(6) vmcnt(12)
v_add_u32 v7, s91, v4
v_mfma_f32_16x16x32_bf16 v[124:127], v[164:167], a[140:143], v[124:127]
s_cbranch_vccnz CK_ZAA
CK_ZAA_R:
v_mfma_f32_16x16x32_bf16 v[124:127], v[160:163], a[132:135], v[124:127]
buffer_load_dwordx4 a[188:191], v14, s[24:27], s93 offen offset:2048 sc1
v_mfma_f32_16x16x32_bf16 v[72:75], v[168:171], a[128:131], v[72:75]
ds_read_b128 v[152:155], v8 offset:2048
v_mfma_f32_16x16x32_bf16 v[72:75], v[172:175], a[136:139], v[72:75]
ds_read_b128 v[156:159], v8 offset:3072
v_mfma_f32_16x16x32_bf16 v[76:79], v[172:175], a[140:143], v[76:79]
ds_read_b128 v[160:163], v8 offset:4096
v_mfma_f32_16x16x32_bf16 v[76:79], v[168:171], a[132:135], v[76:79]
s_waitcnt lgkmcnt(7)
v_mfma_f32_16x16x32_bf16 v[80:83], v[176:179], a[128:131], v[80:83]
s_add_u32 s65, s77, 65536
ds_read_b128 v[164:167], v8 offset:5120
v_mfma_f32_16x16x32_bf16 v[80:83], v[180:183], a[136:139], v[80:83]
v_mfma_f32_16x16x32_bf16 v[84:87], v[180:183], a[140:143], v[84:87]
buffer_load_dwordx4 v[32:35], v4, s[24:27], s65 offen offset:0 sc1
v_mfma_f32_16x16x32_bf16 v[84:87], v[176:179], a[132:135], v[84:87]
s_waitcnt lgkmcnt(6)
ds_read_b128 v[168:171], v8 offset:6144
v_mfma_f32_16x16x32_bf16 v[88:91], v[184:187], a[128:131], v[88:91]
ds_read_b128 v[172:175], v8 offset:7168
v_mfma_f32_16x16x32_bf16 v[88:91], v[188:191], a[136:139], v[88:91]
v_mfma_f32_16x16x32_bf16 v[92:95], v[188:191], a[140:143], v[92:95]
buffer_load_dwordx4 v[40:43], v4, s[24:27], s65 offen offset:2048 sc1
v_mfma_f32_16x16x32_bf16 v[92:95], v[184:187], a[132:135], v[92:95]
s_waitcnt lgkmcnt(6)
ds_read_b128 v[176:179], v8 offset:8192
v_mfma_f32_16x16x32_bf16 v[96:99], v[144:147], a[128:131], v[96:99]
s_add_u32 s93, s81, 65536
ds_read_b128 v[180:183], v8 offset:9216
v_mfma_f32_16x16x32_bf16 v[96:99], v[148:151], a[136:139], v[96:99]
s_waitcnt lgkmcnt(6) vmcnt(12)
v_mfma_f32_16x16x32_bf16 v[100:103], v[148:151], a[140:143], v[100:103]
buffer_load_dwordx4 v[36:39], v4, s[24:27], s93 offen offset:0 sc1
v_mfma_f32_16x16x32_bf16 v[100:103], v[144:147], a[132:135], v[100:103]
s_mov_b32 m0, s70
s_mov_b32 s64, s68
s_add_u32 s68, s68, 16384
v_mfma_f32_16x16x32_bf16 v[120:123], v[152:155], a[144:147], v[120:123]
s_waitcnt vmcnt(11)
ds_read_b128 v[184:187], v8 offset:10240
v_mfma_f32_16x16x32_bf16 v[120:123], v[156:159], a[152:155], v[120:123]
s_add_u32 s70, s70, 16384
s_cmp_ge_u32 s70, 163840
s_cselect_b32 s70, s80, s70
v_mfma_f32_16x16x32_bf16 v[124:127], v[156:159], a[156:159], v[124:127]
buffer_load_dwordx4 v4, s[24:27], s64 offen offset:0 sc1 lds
v_mfma_f32_16x16x32_bf16 v[124:127], v[152:155], a[148:151], v[124:127]
s_waitcnt lgkmcnt(5)
ds_read_b128 v[188:191], v8 offset:11264
v_mfma_f32_16x16x32_bf16 v[72:75], v[160:163], a[144:147], v[72:75]
ds_read_b128 v[144:147], v8 offset:12288
v_mfma_f32_16x16x32_bf16 v[72:75], v[164:167], a[152:155], v[72:75]
buffer_load_dwordx4 v4, s[24:27], s64 offen offset:1024 sc1 lds
v_mfma_f32_16x16x32_bf16 v[76:79], v[164:167], a[156:159], v[76:79]
ds_read_b128 v[148:151], v8 offset:13312
v_mfma_f32_16x16x32_bf16 v[76:79], v[160:163], a[148:151], v[76:79]
s_waitcnt lgkmcnt(6)
ds_read_b128 v[152:155], v8 offset:14336
v_mfma_f32_16x16x32_bf16 v[80:83], v[168:171], a[144:147], v[80:83]
buffer_load_dwordx4 v[44:47], v4, s[24:27], s93 offen offset:2048 sc1
v_mfma_f32_16x16x32_bf16 v[80:83], v[172:175], a[152:155], v[80:83]
s_barrier
v_mfma_f32_16x16x32_bf16 v[84:87], v[172:175], a[156:159], v[84:87]
s_waitcnt lgkmcnt(5)
ds_read_b128 v[156:159], v8 offset:15360
v_mfma_f32_16x16x32_bf16 v[84:87], v[168:171], a[148:151], v[84:87]
buffer_load_dwordx4 v4, s[24:27], s64 offen offset:2048 sc1 lds
v_mfma_f32_16x16x32_bf16 v[88:91], v[176:179], a[144:147], v[88:91]
s_add_u32 s91, s91, 16384
ds_read_b128 v[160:163], v7 offset:0
v_mfma_f32_16x16x32_bf16 v[88:91], v[180:183], a[152:155], v[88:91]
s_cmp_ge_u32 s91, 163840
s_cselect_b32 s91, 0, s91
ds_read_b128 v[164:167], v7 offset:1024
v_mfma_f32_16x16x32_bf16 v[92:95], v[180:183], a[156:159], v[92:95]
buffer_load_dwordx4 v4, s[24:27], s64 offen offset:3072 sc1 lds
v_mfma_f32_16x16x32_bf16 v[92:95], v[176:179], a[148:151], v[92:95]
s_waitcnt lgkmcnt(6)
ds_read_b128 v[168:171], v7 offset:2048
v_add_u32 v8, s91, v4
v_mfma_f32_16x16x32_bf16 v[96:99], v[184:187], a[144:147], v[96:99]
ds_read_b128 v[172:175], v7 offset:3072
v_mfma_f32_16x16x32_bf16 v[96:99], v[188:191], a[152:155], v[96:99]
buffer_load_dwordx4 v[48:51], v14, s[24:27], s65 offen offset:0 sc1
v_mfma_f32_16x16x32_bf16 v[100:103], v[188:191], a[156:159], v[100:103]
ds_read_b128 v[176:179], v7 offset:4096
v_mfma_f32_16x16x32_bf16 v[100:103], v[184:187], a[148:151], v[100:103]
s_waitcnt lgkmcnt(7) vmcnt(15)
v_mfma_f32_16x16x32_bf16 v[120:123], v[144:147], a[160:163], v[120:123]
buffer_load_dwordx4 v[56:59], v14, s[24:27], s65 offen offset:2048 sc1
v_mfma_f32_16x16x32_bf16 v[120:123], v[148:151], a[168:171], v[120:123]
s_waitcnt vmcnt(14)
ds_read_b128 v[180:183], v7 offset:5120
v_mfma_f32_16x16x32_bf16 v[124:127], v[148:151], a[172:175], v[124:127]
s_waitcnt lgkmcnt(6)
ds_read_b128 v[184:187], v7 offset:6144
v_mfma_f32_16x16x32_bf16 v[124:127], v[144:147], a[164:167], v[124:127]
buffer_load_dwordx4 v[52:55], v14, s[24:27], s93 offen offset:0 sc1
v_mfma_f32_16x16x32_bf16 v[72:75], v[152:155], a[160:163], v[72:75]
ds_read_b128 v[188:191], v7 offset:7168
v_mfma_f32_16x16x32_bf16 v[72:75], v[156:159], a[168:171], v[72:75]
v_mfma_f32_16x16x32_bf16 v[76:79], v[156:159], a[172:175], v[76:79]
buffer_load_dwordx4 v[60:63], v14, s[24:27], s93 offen offset:2048 sc1
v_mfma_f32_16x16x32_bf16 v[76:79], v[152:155], a[164:167], v[76:79]
s_waitcnt lgkmcnt(6)
ds_read_b128 v[144:147], v7 offset:8192
v_mfma_f32_16x16x32_bf16 v[80:83], v[160:163], a[160:163], v[80:83]
ds_read_b128 v[148:151], v7 offset:9216
v_mfma_f32_16x16x32_bf16 v[80:83], v[164:167], a[168:171], v[80:83]
v_mfma_f32_16x16x32_bf16 v[84:87], v[164:167], a[172:175], v[84:87]
ds_read_b128 v[152:155], v7 offset:10240
v_mfma_f32_16x16x32_bf16 v[84:87], v[160:163], a[164:167], v[84:87]
s_waitcnt lgkmcnt(7)
v_mfma_f32_16x16x32_bf16 v[88:91], v[168:171], a[160:163], v[88:91]
s_add_u32 s65, s77, 73728
ds_read_b128 v[156:159], v7 offset:11264
v_mfma_f32_16x16x32_bf16 v[88:91], v[172:175], a[168:171], v[88:91]
v_mfma_f32_16x16x32_bf16 v[92:95], v[172:175], a[172:175], v[92:95]
buffer_load_dwordx4 v[64:67], v4, s[24:27], s65 offen offset:0 sc1
v_mfma_f32_16x16x32_bf16 v[92:95], v[168:171], a[164:167], v[92:95]
s_waitcnt lgkmcnt(6)
ds_read_b128 v[160:163], v7 offset:12288
v_mfma_f32_16x16x32_bf16 v[96:99], v[176:179], a[160:163], v[96:99]
ds_read_b128 v[164:167], v7 offset:13312
v_mfma_f32_16x16x32_bf16 v[96:99], v[180:183], a[168:171], v[96:99]
v_mfma_f32_16x16x32_bf16 v[100:103], v[180:183], a[172:175], v[100:103]
ds_read_b128 v[168:171], v7 offset:14336
v_mfma_f32_16x16x32_bf16 v[100:103], v[176:179], a[164:167], v[100:103]
s_add_u32 s93, s81, 73728
s_waitcnt lgkmcnt(7) vmcnt(15)
v_mfma_f32_16x16x32_bf16 v[120:123], v[184:187], a[176:179], v[120:123]
s_waitcnt vmcnt(13)
ds_read_b128 v[172:175], v7 offset:15360
v_mfma_f32_16x16x32_bf16 v[120:123], v[188:191], a[184:187], v[120:123]
buffer_load_dwordx4 v[68:71], v4, s[24:27], s93 offen offset:0 sc1
v_mfma_f32_16x16x32_bf16 v[124:127], v[188:191], a[188:191], v[124:127]
s_add_u32 s91, s91, 16384
ds_read_b128 v[176:179], v8 offset:0
v_mfma_f32_16x16x32_bf16 v[124:127], v[184:187], a[180:183], v[124:127]
s_waitcnt lgkmcnt(7)
s_cmp_ge_u32 s91, 163840
s_cselect_b32 s91, 0, s91
v_mfma_f32_16x16x32_bf16 v[72:75], v[144:147], a[176:179], v[72:75]
ds_read_b128 v[180:183], v8 offset:1024
v_add_u32 v7, s91, v4
v_mfma_f32_16x16x32_bf16 v[72:75], v[148:151], a[184:187], v[72:75]
v_mfma_f32_16x16x32_bf16 v[76:79], v[148:151], a[188:191], v[76:79]
s_mov_b32 m0, s70
s_mov_b32 s64, s68
s_add_u32 s68, s68, 16384
v_mfma_f32_16x16x32_bf16 v[76:79], v[144:147], a[180:183], v[76:79]
s_waitcnt lgkmcnt(6)
ds_read_b128 v[184:187], v8 offset:2048
v_mfma_f32_16x16x32_bf16 v[80:83], v[152:155], a[176:179], v[80:83]
s_add_u32 s70, s70, 16384
s_cmp_ge_u32 s70, 163840
s_cselect_b32 s70, s80, s70
v_mfma_f32_16x16x32_bf16 v[80:83], v[156:159], a[184:187], v[80:83]
buffer_load_dwordx4 v4, s[24:27], s64 offen offset:0 sc1 lds
v_mfma_f32_16x16x32_bf16 v[84:87], v[156:159], a[188:191], v[84:87]
ds_read_b128 v[188:191], v8 offset:3072
v_mfma_f32_16x16x32_bf16 v[84:87], v[152:155], a[180:183], v[84:87]
s_waitcnt lgkmcnt(6)
ds_read_b128 v[144:147], v8 offset:4096
v_mfma_f32_16x16x32_bf16 v[88:91], v[160:163], a[176:179], v[88:91]
buffer_load_dwordx4 v4, s[24:27], s64 offen offset:1024 sc1 lds
v_mfma_f32_16x16x32_bf16 v[88:91], v[164:167], a[184:187], v[88:91]
ds_read_b128 v[148:151], v8 offset:5120
v_mfma_f32_16x16x32_bf16 v[92:95], v[164:167], a[188:191], v[92:95]
s_waitcnt lgkmcnt(6)
ds_read_b128 v[152:155], v8 offset:6144
v_mfma_f32_16x16x32_bf16 v[92:95], v[160:163], a[180:183], v[92:95]
buffer_load_dwordx4 v4, s[24:27], s64 offen offset:2048 sc1 lds
v_mfma_f32_16x16x32_bf16 v[96:99], v[168:171], a[176:179], v[96:99]
ds_read_b128 v[156:159], v8 offset:7168
v_mfma_f32_16x16x32_bf16 v[96:99], v[172:175], a[184:187], v[96:99]
L_PAD12:
s_cbranch_execz L_MAIN
v_mfma_f32_16x16x32_bf16 v[100:103], v[172:175], a[188:191], v[100:103]
buffer_load_dwordx4 v4, s[24:27], s64 offen offset:3072 sc1 lds
v_mfma_f32_16x16x32_bf16 v[100:103], v[168:171], a[180:183], v[100:103]
s_waitcnt lgkmcnt(6) vmcnt(16)
ds_read_b128 v[160:163], v8 offset:8192
v_mfma_f32_16x16x32_bf16 v[120:123], v[176:179], v[32:35], v[120:123]
s_mov_b32 m0, s70
s_mov_b32 s64, s68
s_add_u32 s68, s68, 16384
v_mfma_f32_16x16x32_bf16 v[120:123], v[180:183], v[40:43], v[120:123]
s_waitcnt lgkmcnt(5) vmcnt(12)
ds_read_b128 v[164:167], v8 offset:9216
v_mfma_f32_16x16x32_bf16 v[124:127], v[180:183], v[44:47], v[124:127]
s_add_u32 s70, s70, 16384
s_cmp_ge_u32 s70, 163840
s_cselect_b32 s70, s80, s70
v_mfma_f32_16x16x32_bf16 v[124:127], v[176:179], v[36:39], v[124:127]
buffer_load_dwordx4 v4, s[24:27], s64 offen offset:0 sc1 lds
v_mfma_f32_16x16x32_bf16 v[72:75], v[184:187], v[32:35], v[72:75]
ds_read_b128 v[168:171], v8 offset:10240
v_mfma_f32_16x16x32_bf16 v[72:75], v[188:191], v[40:43], v[72:75]
ds_read_b128 v[172:175], v8 offset:11264
v_mfma_f32_16x16x32_bf16 v[76:79], v[188:191], v[44:47], v[76:79]
buffer_load_dwordx4 v4, s[24:27], s64 offen offset:1024 sc1 lds
v_mfma_f32_16x16x32_bf16 v[76:79], v[184:187], v[36:39], v[76:79]
s_waitcnt lgkmcnt(6)
ds_read_b128 v[176:179], v8 offset:12288
v_mfma_f32_16x16x32_bf16 v[80:83], v[144:147], v[32:35], v[80:83]
ds_read_b128 v[180:183], v8 offset:13312
v_mfma_f32_16x16x32_bf16 v[80:83], v[148:151], v[40:43], v[80:83]
buffer_load_dwordx4 v4, s[24:27], s64 offen offset:2048 sc1 lds
v_mfma_f32_16x16x32_bf16 v[84:87], v[148:151], v[44:47], v[84:87]
ds_read_b128 v[184:187], v8 offset:14336
v_mfma_f32_16x16x32_bf16 v[84:87], v[144:147], v[36:39], v[84:87]
s_waitcnt lgkmcnt(7)
v_mfma_f32_16x16x32_bf16 v[88:91], v[152:155], v[32:35], v[88:91]
s_waitcnt vmcnt(13)
ds_read_b128 v[188:191], v8 offset:15360
v_mfma_f32_16x16x32_bf16 v[88:91], v[156:159], v[40:43], v[88:91]
s_barrier
v_mfma_f32_16x16x32_bf16 v[92:95], v[156:159], v[44:47], v[92:95]
buffer_load_dwordx4 v4, s[24:27], s64 offen offset:3072 sc1 lds
v_mfma_f32_16x16x32_bf16 v[92:95], v[152:155], v[36:39], v[92:95]
s_waitcnt lgkmcnt(6)
s_add_u32 s91, s91, 16384
ds_read_b128 v[144:147], v7 offset:0
v_mfma_f32_16x16x32_bf16 v[96:99], v[160:163], v[32:35], v[96:99]
s_cmp_ge_u32 s91, 163840
s_cselect_b32 s91, 0, s91
ds_read_b128 v[148:151], v7 offset:1024
v_mfma_f32_16x16x32_bf16 v[96:99], v[164:167], v[40:43], v[96:99]
v_add_u32 v8, s91, v4
v_mfma_f32_16x16x32_bf16 v[100:103], v[164:167], v[44:47], v[100:103]
ds_read_b128 v[152:155], v7 offset:2048
v_mfma_f32_16x16x32_bf16 v[100:103], v[160:163], v[36:39], v[100:103]
s_waitcnt lgkmcnt(7) vmcnt(12)
v_mfma_f32_16x16x32_bf16 v[120:123], v[168:171], v[48:51], v[120:123]
ds_read_b128 v[156:159], v7 offset:3072
v_mfma_f32_16x16x32_bf16 v[120:123], v[172:175], v[56:59], v[120:123]
s_waitcnt vmcnt(10)
v_mfma_f32_16x16x32_bf16 v[124:127], v[172:175], v[60:63], v[124:127]
ds_read_b128 v[160:163], v7 offset:4096
v_mfma_f32_16x16x32_bf16 v[124:127], v[168:171], v[52:55], v[124:127]
s_waitcnt lgkmcnt(7)
v_mfma_f32_16x16x32_bf16 v[72:75], v[176:179], v[48:51], v[72:75]
ds_read_b128 v[164:167], v7 offset:5120
v_mfma_f32_16x16x32_bf16 v[72:75], v[180:183], v[56:59], v[72:75]
v_mfma_f32_16x16x32_bf16 v[76:79], v[180:183], v[60:63], v[76:79]
ds_read_b128 v[168:171], v7 offset:6144
v_mfma_f32_16x16x32_bf16 v[76:79], v[176:179], v[52:55], v[76:79]
s_waitcnt lgkmcnt(7)
v_mfma_f32_16x16x32_bf16 v[80:83], v[184:187], v[48:51], v[80:83]
ds_read_b128 v[172:175], v7 offset:7168
v_mfma_f32_16x16x32_bf16 v[80:83], v[188:191], v[56:59], v[80:83]
v_mfma_f32_16x16x32_bf16 v[84:87], v[188:191], v[60:63], v[84:87]
ds_read_b128 v[176:179], v7 offset:8192
v_mfma_f32_16x16x32_bf16 v[84:87], v[184:187], v[52:55], v[84:87]
s_waitcnt lgkmcnt(7)
v_mfma_f32_16x16x32_bf16 v[88:91], v[144:147], v[48:51], v[88:91]
ds_read_b128 v[180:183], v7 offset:9216
v_mfma_f32_16x16x32_bf16 v[88:91], v[148:151], v[56:59], v[88:91]
v_mfma_f32_16x16x32_bf16 v[92:95], v[148:151], v[60:63], v[92:95]
ds_read_b128 v[184:187], v7 offset:10240
v_mfma_f32_16x16x32_bf16 v[92:95], v[144:147], v[52:55], v[92:95]
s_waitcnt lgkmcnt(7)
v_mfma_f32_16x16x32_bf16 v[96:99], v[152:155], v[48:51], v[96:99]
ds_read_b128 v[188:191], v7 offset:11264
v_mfma_f32_16x16x32_bf16 v[96:99], v[156:159], v[56:59], v[96:99]
v_mfma_f32_16x16x32_bf16 v[100:103], v[156:159], v[60:63], v[100:103]
ds_read_b128 v[144:147], v7 offset:12288
v_mfma_f32_16x16x32_bf16 v[100:103], v[152:155], v[52:55], v[100:103]
s_waitcnt lgkmcnt(7) vmcnt(9)
v_mfma_f32_16x16x32_bf16 v[120:123], v[160:163], v[64:67], v[120:123]
s_waitcnt vmcnt(8)
ds_read_b128 v[148:151], v7 offset:13312
v_mfma_f32_16x16x32_bf16 v[124:127], v[160:163], v[68:71], v[124:127]
v_mfma_f32_16x16x32_bf16 v[72:75], v[164:167], v[64:67], v[72:75]
ds_read_b128 v[152:155], v7 offset:14336
v_mfma_f32_16x16x32_bf16 v[76:79], v[164:167], v[68:71], v[76:79]
s_waitcnt lgkmcnt(7)
v_mfma_f32_16x16x32_bf16 v[80:83], v[168:171], v[64:67], v[80:83]
ds_read_b128 v[156:159], v7 offset:15360
v_mfma_f32_16x16x32_bf16 v[84:87], v[168:171], v[68:71], v[84:87]
s_add_u32 s91, s91, 16384
s_cmp_ge_u32 s91, 163840
s_cselect_b32 s91, 0, s91
v_mfma_f32_16x16x32_bf16 v[88:91], v[172:175], v[64:67], v[88:91]
ds_read_b128 v[160:163], v8 offset:0
v_add_u32 v7, s91, v4
v_mfma_f32_16x16x32_bf16 v[92:95], v[172:175], v[68:71], v[92:95]
s_waitcnt lgkmcnt(7)
v_mfma_f32_16x16x32_bf16 v[96:99], v[176:179], v[64:67], v[96:99]
ds_read_b128 v[164:167], v8 offset:1024
v_cvt_pk_bf16_f32 v228, v120, v121
v_mfma_f32_16x16x32_bf16 v[100:103], v[176:179], v[68:71], v[100:103]
v_cvt_pk_bf16_f32 v229, v122, v123
v_mfma_f32_16x16x32_bf16 v[104:107], v[180:183], a[64:67], v[104:107]
s_waitcnt lgkmcnt(6)
ds_read_b128 v[168:171], v8 offset:2048
v_cvt_pk_bf16_f32 v230, v124, v125
v_mfma_f32_16x16x32_bf16 v[104:107], v[184:187], a[72:75], v[104:107]
v_cvt_pk_bf16_f32 v231, v126, v127
v_mfma_f32_16x16x32_bf16 v[108:111], v[184:187], a[76:79], v[108:111]
buffer_store_dwordx4 v[228:231], v4, s[24:27], s55 offen offset:0 sc1
v_mfma_f32_16x16x32_bf16 v[108:111], v[180:183], a[68:71], v[108:111]
ds_read_b128 v[172:175], v8 offset:3072
v_cvt_pk_bf16_f32 v72, v72, v73
v_mfma_f32_16x16x32_bf16 v[112:115], v[188:191], a[64:67], v[112:115]
s_waitcnt lgkmcnt(6)
ds_read_b128 v[176:179], v8 offset:4096
v_cvt_pk_bf16_f32 v73, v74, v75
v_mfma_f32_16x16x32_bf16 v[112:115], v[144:147], a[72:75], v[112:115]
v_cvt_pk_bf16_f32 v74, v80, v81
v_mfma_f32_16x16x32_bf16 v[116:119], v[144:147], a[76:79], v[116:119]
ds_read_b128 v[180:183], v8 offset:5120
v_cvt_pk_bf16_f32 v75, v82, v83
v_mfma_f32_16x16x32_bf16 v[116:119], v[188:191], a[68:71], v[116:119]
buffer_store_dwordx4 v[72:75], v4, s[24:27], s52 offen offset:0 sc1
v_mfma_f32_16x16x32_bf16 v[104:107], v[148:151], a[80:83], v[104:107]
s_waitcnt lgkmcnt(6)
ds_read_b128 v[184:187], v8 offset:6144
v_cvt_pk_bf16_f32 v76, v76, v77
v_mfma_f32_16x16x32_bf16 v[104:107], v[152:155], a[88:91], v[104:107]
v_cvt_pk_bf16_f32 v77, v78, v79
v_mfma_f32_16x16x32_bf16 v[108:111], v[152:155], a[92:95], v[108:111]
ds_read_b128 v[188:191], v8 offset:7168
v_cvt_pk_bf16_f32 v78, v84, v85
v_mfma_f32_16x16x32_bf16 v[108:111], v[148:151], a[84:87], v[108:111]
s_waitcnt lgkmcnt(6)
v_cvt_pk_bf16_f32 v79, v86, v87
v_mfma_f32_16x16x32_bf16 v[112:115], v[156:159], a[80:83], v[112:115]
buffer_store_dwordx4 v[76:79], v4, s[24:27], s52 offen offset:1024 sc1
v_mfma_f32_16x16x32_bf16 v[112:115], v[160:163], a[88:91], v[112:115]
ds_read_b128 v[144:147], v8 offset:8192
v_cvt_pk_bf16_f32 v88, v88, v89
v_mfma_f32_16x16x32_bf16 v[116:119], v[160:163], a[92:95], v[116:119]
ds_read_b128 v[148:151], v8 offset:9216
v_cvt_pk_bf16_f32 v89, v90, v91
v_mfma_f32_16x16x32_bf16 v[116:119], v[156:159], a[84:87], v[116:119]
v_cvt_pk_bf16_f32 v90, v96, v97
v_mfma_f32_16x16x32_bf16 v[104:107], v[164:167], a[192:195], v[104:107]
s_waitcnt lgkmcnt(6)
ds_read_b128 v[152:155], v8 offset:10240
v_cvt_pk_bf16_f32 v91, v98, v99
v_mfma_f32_16x16x32_bf16 v[104:107], v[168:171], a[200:203], v[104:107]
buffer_store_dwordx4 v[88:91], v4, s[24:27], s53 offen offset:0 sc1
v_mfma_f32_16x16x32_bf16 v[108:111], v[168:171], a[204:207], v[108:111]
ds_read_b128 v[156:159], v8 offset:11264
v_cvt_pk_bf16_f32 v92, v92, v93
v_mfma_f32_16x16x32_bf16 v[108:111], v[164:167], a[196:199], v[108:111]
v_cvt_pk_bf16_f32 v93, v94, v95
v_mfma_f32_16x16x32_bf16 v[112:115], v[172:175], a[192:195], v[112:115]
s_waitcnt lgkmcnt(6)
ds_read_b128 v[160:163], v8 offset:12288
v_cvt_pk_bf16_f32 v94, v100, v101
v_mfma_f32_16x16x32_bf16 v[112:115], v[176:179], a[200:203], v[112:115]
s_waitcnt lgkmcnt(5)
v_cvt_pk_bf16_f32 v95, v102, v103
v_mfma_f32_16x16x32_bf16 v[116:119], v[176:179], a[204:207], v[116:119]
buffer_store_dwordx4 v[92:95], v4, s[24:27], s53 offen offset:1024 sc1
v_mfma_f32_16x16x32_bf16 v[116:119], v[172:175], a[196:199], v[116:119]
s_mov_b32 m0, s70
s_mov_b32 s64, s68
s_add_u32 s68, s68, 16384
v_mfma_f32_16x16x32_bf16 v[104:107], v[180:183], a[208:211], v[104:107]
s_add_u32 s70, s70, 16384
s_cmp_ge_u32 s70, 163840
s_cselect_b32 s70, s80, s70
v_mfma_f32_16x16x32_bf16 v[104:107], v[184:187], a[216:219], v[104:107]
buffer_load_dwordx4 v4, s[24:27], s64 offen offset:0 sc1 lds
v_mfma_f32_16x16x32_bf16 v[108:111], v[184:187], a[220:223], v[108:111]
s_waitcnt vmcnt(6) lgkmcnt(3)
ds_read_b128 v[164:167], v8 offset:13312
v_mfma_f32_16x16x32_bf16 v[108:111], v[180:183], a[212:215], v[108:111]
s_barrier
v_mfma_f32_16x16x32_bf16 v[112:115], v[188:191], a[208:211], v[112:115]
buffer_load_dwordx4 v4, s[24:27], s64 offen offset:1024 sc1 lds
v_mfma_f32_16x16x32_bf16 v[112:115], v[144:147], a[216:219], v[112:115]
ds_read_b128 v[168:171], v8 offset:14336
v_mfma_f32_16x16x32_bf16 v[116:119], v[144:147], a[220:223], v[116:119]
ds_read_b128 v[172:175], v8 offset:15360
v_mfma_f32_16x16x32_bf16 v[116:119], v[188:191], a[212:215], v[116:119]
buffer_load_dwordx4 v4, s[24:27], s64 offen offset:2048 sc1 lds
v_mfma_f32_16x16x32_bf16 v[104:107], v[148:151], a[224:227], v[104:107]
s_waitcnt lgkmcnt(4)
s_add_u32 s91, s91, 16384
ds_read_b128 v[176:179], v7 offset:0
v_mfma_f32_16x16x32_bf16 v[104:107], v[152:155], a[232:235], v[104:107]
s_cmp_ge_u32 s91, 163840
s_cselect_b32 s91, 0, s91
ds_read_b128 v[180:183], v7 offset:1024
v_mfma_f32_16x16x32_bf16 v[108:111], v[152:155], a[236:239], v[108:111]
buffer_load_dwordx4 v4, s[24:27], s64 offen offset:3072 sc1 lds
v_mfma_f32_16x16x32_bf16 v[108:111], v[148:151], a[228:231], v[108:111]
s_mov_b32 m0, s70
s_mov_b32 s64, s68
s_add_u32 s68, s68, 16384
v_mfma_f32_16x16x32_bf16 v[112:115], v[156:159], a[224:227], v[112:115]
s_waitcnt lgkmcnt(4)
ds_read_b128 v[184:187], v7 offset:2048
v_add_u32 v8, s91, v4
v_mfma_f32_16x16x32_bf16 v[112:115], v[160:163], a[232:235], v[112:115]
s_add_u32 s70, s70, 16384
s_cmp_ge_u32 s70, 163840
s_cselect_b32 s70, s80, s70
v_mfma_f32_16x16x32_bf16 v[116:119], v[160:163], a[236:239], v[116:119]
buffer_load_dwordx4 v4, s[24:27], s64 offen offset:0 sc1 lds
v_mfma_f32_16x16x32_bf16 v[116:119], v[156:159], a[228:231], v[116:119]
ds_read_b128 v[188:191], v7 offset:3072
v_mfma_f32_16x16x32_bf16 v[104:107], v[164:167], a[240:243], v[104:107]
s_waitcnt lgkmcnt(4)
ds_read_b128 v[144:147], v7 offset:4096
v_mfma_f32_16x16x32_bf16 v[104:107], v[168:171], a[248:251], v[104:107]
buffer_load_dwordx4 v4, s[24:27], s64 offen offset:1024 sc1 lds
v_mfma_f32_16x16x32_bf16 v[108:111], v[168:171], a[252:255], v[108:111]
ds_read_b128 v[148:151], v7 offset:5120
v_mfma_f32_16x16x32_bf16 v[108:111], v[164:167], a[244:247], v[108:111]
s_waitcnt lgkmcnt(4)
ds_read_b128 v[152:155], v7 offset:6144
v_mfma_f32_16x16x32_bf16 v[112:115], v[172:175], a[240:243], v[112:115]
buffer_load_dwordx4 v4, s[24:27], s64 offen offset:2048 sc1 lds
v_mfma_f32_16x16x32_bf16 v[112:115], v[176:179], a[248:251], v[112:115]
ds_read_b128 v[156:159], v7 offset:7168
v_mfma_f32_16x16x32_bf16 v[116:119], v[176:179], a[252:255], v[116:119]
ds_read_b128 v[160:163], v7 offset:8192
v_mfma_f32_16x16x32_bf16 v[116:119], v[172:175], a[244:247], v[116:119]
buffer_load_dwordx4 v4, s[24:27], s64 offen offset:3072 sc1 lds
v_mfma_f32_16x16x32_bf16 v[104:107], v[180:183], a[96:99], v[104:107]
s_waitcnt lgkmcnt(5)
ds_read_b128 v[164:167], v7 offset:9216
v_mfma_f32_16x16x32_bf16 v[104:107], v[184:187], a[104:107], v[104:107]
ds_read_b128 v[168:171], v7 offset:10240
v_mfma_f32_16x16x32_bf16 v[108:111], v[184:187], a[108:111], v[108:111]
ds_read_b128 v[172:175], v7 offset:11264
v_mfma_f32_16x16x32_bf16 v[108:111], v[180:183], a[100:103], v[108:111]
v_mfma_f32_16x16x32_bf16 v[112:115], v[188:191], a[96:99], v[112:115]
s_waitcnt lgkmcnt(6)
ds_read_b128 v[176:179], v7 offset:12288
v_mfma_f32_16x16x32_bf16 v[112:115], v[144:147], a[104:107], v[112:115]
v_mfma_f32_16x16x32_bf16 v[116:119], v[144:147], a[108:111], v[116:119]
ds_read_b128 v[180:183], v7 offset:13312
v_mfma_f32_16x16x32_bf16 v[116:119], v[188:191], a[100:103], v[116:119]
v_mfma_f32_16x16x32_bf16 v[104:107], v[148:151], a[112:115], v[104:107]
s_waitcnt lgkmcnt(6)
ds_read_b128 v[184:187], v7 offset:14336
v_mfma_f32_16x16x32_bf16 v[104:107], v[152:155], a[120:123], v[104:107]
v_mfma_f32_16x16x32_bf16 v[108:111], v[152:155], a[124:127], v[108:111]
ds_read_b128 v[188:191], v7 offset:15360
v_mfma_f32_16x16x32_bf16 v[108:111], v[148:151], a[116:119], v[108:111]
s_add_u32 s91, s91, 16384
s_cmp_ge_u32 s91, 163840
s_cselect_b32 s91, 0, s91
v_mfma_f32_16x16x32_bf16 v[112:115], v[156:159], a[112:115], v[112:115]
s_waitcnt lgkmcnt(6)
ds_read_b128 v[144:147], v8 offset:0
v_add_u32 v7, s91, v4
v_mfma_f32_16x16x32_bf16 v[112:115], v[160:163], a[120:123], v[112:115]
v_mfma_f32_16x16x32_bf16 v[116:119], v[160:163], a[124:127], v[116:119]
ds_read_b128 v[148:151], v8 offset:1024
v_mfma_f32_16x16x32_bf16 v[116:119], v[156:159], a[116:119], v[116:119]
s_waitcnt lgkmcnt(6)
v_mfma_f32_16x16x32_bf16 v[104:107], v[164:167], a[128:131], v[104:107]
s_mov_b32 m0, s70
s_mov_b32 s64, s68
s_add_u32 s68, s68, 16384
v_mfma_f32_16x16x32_bf16 v[104:107], v[168:171], a[136:139], v[104:107]
ds_read_b128 v[152:155], v8 offset:2048
v_mfma_f32_16x16x32_bf16 v[108:111], v[168:171], a[140:143], v[108:111]
s_add_u32 s70, s70, 16384
s_cmp_ge_u32 s70, 163840
s_cselect_b32 s70, s80, s70
v_mfma_f32_16x16x32_bf16 v[108:111], v[164:167], a[132:135], v[108:111]
buffer_load_dwordx4 v4, s[24:27], s64 offen offset:0 sc1 lds
v_mfma_f32_16x16x32_bf16 v[112:115], v[172:175], a[128:131], v[112:115]
s_waitcnt lgkmcnt(5)
ds_read_b128 v[156:159], v8 offset:3072
v_mfma_f32_16x16x32_bf16 v[112:115], v[176:179], a[136:139], v[112:115]
ds_read_b128 v[160:163], v8 offset:4096
v_mfma_f32_16x16x32_bf16 v[116:119], v[176:179], a[140:143], v[116:119]
buffer_load_dwordx4 v4, s[24:27], s64 offen offset:1024 sc1 lds
v_mfma_f32_16x16x32_bf16 v[116:119], v[172:175], a[132:135], v[116:119]
ds_read_b128 v[164:167], v8 offset:5120
v_mfma_f32_16x16x32_bf16 v[104:107], v[180:183], a[144:147], v[104:107]
s_waitcnt vmcnt(10) lgkmcnt(6)
ds_read_b128 v[168:171], v8 offset:6144
v_mfma_f32_16x16x32_bf16 v[104:107], v[184:187], a[152:155], v[104:107]
buffer_atomic_add v1, v0, s[24:27], s73 offen offset:0 sc1
v_mfma_f32_16x16x32_bf16 v[108:111], v[184:187], a[156:159], v[108:111]
buffer_load_dwordx4 v4, s[24:27], s64 offen offset:2048 sc1 lds
v_mfma_f32_16x16x32_bf16 v[108:111], v[180:183], a[148:151], v[108:111]
ds_read_b128 v[172:175], v8 offset:7168
v_mfma_f32_16x16x32_bf16 v[112:115], v[188:191], a[144:147], v[112:115]
s_waitcnt lgkmcnt(6)
ds_read_b128 v[176:179], v8 offset:8192
v_mfma_f32_16x16x32_bf16 v[112:115], v[144:147], a[152:155], v[112:115]
buffer_load_dwordx4 v4, s[24:27], s64 offen offset:3072 sc1 lds
v_mfma_f32_16x16x32_bf16 v[116:119], v[144:147], a[156:159], v[116:119]
s_mov_b32 m0, s70
s_mov_b32 s64, s68
s_add_u32 s68, s68, 16384
v_mfma_f32_16x16x32_bf16 v[116:119], v[188:191], a[148:151], v[116:119]
s_waitcnt lgkmcnt(5)
ds_read_b128 v[180:183], v8 offset:9216
v_mfma_f32_16x16x32_bf16 v[104:107], v[148:151], a[160:163], v[104:107]
s_add_u32 s70, s70, 16384
s_cmp_ge_u32 s70, 163840
s_cselect_b32 s70, s80, s70
v_mfma_f32_16x16x32_bf16 v[104:107], v[152:155], a[168:171], v[104:107]
buffer_load_dwordx4 v4, s[24:27], s64 offen offset:0 sc1 lds
v_mfma_f32_16x16x32_bf16 v[108:111], v[152:155], a[172:175], v[108:111]
ds_read_b128 v[184:187], v8 offset:10240
v_mfma_f32_16x16x32_bf16 v[108:111], v[148:151], a[164:167], v[108:111]
s_waitcnt lgkmcnt(5)
ds_read_b128 v[188:191], v8 offset:11264
v_mfma_f32_16x16x32_bf16 v[112:115], v[156:159], a[160:163], v[112:115]
buffer_load_dwordx4 v4, s[24:27], s64 offen offset:1024 sc1 lds
v_mfma_f32_16x16x32_bf16 v[112:115], v[160:163], a[168:171], v[112:115]
ds_read_b128 v[144:147], v8 offset:12288
v_mfma_f32_16x16x32_bf16 v[116:119], v[160:163], a[172:175], v[116:119]
s_add_u32 s82, s84, 3
ds_read_b128 v[148:151], v8 offset:13312
v_mfma_f32_16x16x32_bf16 v[116:119], v[156:159], a[164:167], v[116:119]
buffer_load_dwordx4 v4, s[24:27], s64 offen offset:2048 sc1 lds
v_mfma_f32_16x16x32_bf16 v[104:107], v[164:167], a[176:179], v[104:107]
s_and_b32 s82, s82, 3
s_waitcnt lgkmcnt(6)
ds_read_b128 v[152:155], v8 offset:14336
v_mfma_f32_16x16x32_bf16 v[104:107], v[168:171], a[184:187], v[104:107]
v_mfma_f32_16x16x32_bf16 v[108:111], v[168:171], a[188:191], v[108:111]
s_waitcnt vmcnt(8)
s_lshl4_add_u32 s82, s82, s73
ds_read_b128 v[156:159], v8 offset:15360
v_mfma_f32_16x16x32_bf16 v[108:111], v[164:167], a[180:183], v[108:111]
s_barrier
v_mfma_f32_16x16x32_bf16 v[112:115], v[172:175], a[176:179], v[112:115]
s_lshl4_add_u32 s75, s84, s73
s_waitcnt lgkmcnt(6)
ds_read_b128 v[160:163], v7 offset:0
v_mfma_f32_16x16x32_bf16 v[112:115], v[176:179], a[184:187], v[112:115]
buffer_load_dwordx4 v4, s[24:27], s64 offen offset:3072 sc1 lds
v_mfma_f32_16x16x32_bf16 v[116:119], v[176:179], a[188:191], v[116:119]
s_add_u32 s91, s91, 16384
ds_read_b128 v[164:167], v7 offset:1024
v_mfma_f32_16x16x32_bf16 v[116:119], v[172:175], a[180:183], v[116:119]
s_cmp_ge_u32 s91, 163840
s_cselect_b32 s91, 0, s91
v_add_u32 v8, s91, v4
v_mfma_f32_16x16x32_bf16 v[104:107], v[180:183], v[32:35], v[104:107]
s_waitcnt lgkmcnt(6)
ds_read_b128 v[168:171], v7 offset:2048
v_mfma_f32_16x16x32_bf16 v[104:107], v[184:187], v[40:43], v[104:107]
v_mfma_f32_16x16x32_bf16 v[108:111], v[184:187], v[44:47], v[108:111]
ds_read_b128 v[172:175], v7 offset:3072
v_mfma_f32_16x16x32_bf16 v[108:111], v[180:183], v[36:39], v[108:111]
v_mfma_f32_16x16x32_bf16 v[112:115], v[188:191], v[32:35], v[112:115]
s_waitcnt lgkmcnt(6)
ds_read_b128 v[176:179], v7 offset:4096
v_mfma_f32_16x16x32_bf16 v[112:115], v[144:147], v[40:43], v[112:115]
v_mfma_f32_16x16x32_bf16 v[116:119], v[144:147], v[44:47], v[116:119]
ds_read_b128 v[180:183], v7 offset:5120
v_mfma_f32_16x16x32_bf16 v[116:119], v[188:191], v[36:39], v[116:119]
v_mfma_f32_16x16x32_bf16 v[104:107], v[148:151], v[48:51], v[104:107]
s_waitcnt lgkmcnt(6)
ds_read_b128 v[184:187], v7 offset:6144
v_mfma_f32_16x16x32_bf16 v[104:107], v[152:155], v[56:59], v[104:107]
v_mfma_f32_16x16x32_bf16 v[108:111], v[152:155], v[60:63], v[108:111]
ds_read_b128 v[188:191], v7 offset:7168
v_mfma_f32_16x16x32_bf16 v[108:111], v[148:151], v[52:55], v[108:111]
v_mfma_f32_16x16x32_bf16 v[112:115], v[156:159], v[48:51], v[112:115]
s_waitcnt lgkmcnt(6)
ds_read_b128 v[144:147], v7 offset:8192
v_mfma_f32_16x16x32_bf16 v[112:115], v[160:163], v[56:59], v[112:115]
v_mfma_f32_16x16x32_bf16 v[116:119], v[160:163], v[60:63], v[116:119]
ds_read_b128 v[148:151], v7 offset:9216
v_mfma_f32_16x16x32_bf16 v[116:119], v[156:159], v[52:55], v[116:119]
v_mfma_f32_16x16x32_bf16 v[104:107], v[164:167], v[64:67], v[104:107]
ds_read_b128 v[152:155], v7 offset:10240
v_mfma_f32_16x16x32_bf16 v[108:111], v[164:167], v[68:71], v[108:111]
s_waitcnt lgkmcnt(7)
v_mfma_f32_16x16x32_bf16 v[112:115], v[168:171], v[64:67], v[112:115]
ds_read_b128 v[156:159], v7 offset:11264
v_mfma_f32_16x16x32_bf16 v[116:119], v[168:171], v[68:71], v[116:119]
v_mfma_f32_16x16x32_bf16 v[128:131], v[172:175], a[0:3], 0
s_waitcnt lgkmcnt(6)
ds_read_b128 v[160:163], v7 offset:12288
v_mfma_f32_16x16x32_bf16 v[128:131], v[176:179], a[8:11], v[128:131]
v_mfma_f32_16x16x32_bf16 v[132:135], v[176:179], a[12:15], 0
ds_read_b128 v[164:167], v7 offset:13312
v_mfma_f32_16x16x32_bf16 v[132:135], v[172:175], a[4:7], v[132:135]
v_mfma_f32_16x16x32_bf16 v[136:139], v[180:183], a[0:3], 0
s_waitcnt lgkmcnt(6)
ds_read_b128 v[168:171], v7 offset:14336
v_mfma_f32_16x16x32_bf16 v[136:139], v[184:187], a[8:11], v[136:139]
v_cvt_pk_bf16_f32 v104, v104, v105
v_mfma_f32_16x16x32_bf16 v[140:143], v[184:187], a[12:15], 0
ds_read_b128 v[172:175], v7 offset:15360
v_cvt_pk_bf16_f32 v105, v106, v107
v_mfma_f32_16x16x32_bf16 v[140:143], v[180:183], a[4:7], v[140:143]
s_add_u32 s91, s91, 16384
v_cvt_pk_bf16_f32 v106, v112, v113
v_mfma_f32_16x16x32_bf16 v[128:131], v[188:191], a[16:19], v[128:131]
s_waitcnt lgkmcnt(6)
ds_read_b128 v[176:179], v8 offset:0
v_cvt_pk_bf16_f32 v107, v114, v115
v_mfma_f32_16x16x32_bf16 v[128:131], v[144:147], a[24:27], v[128:131]
buffer_store_dwordx4 v[104:107], v4, s[24:27], s54 offen offset:0 sc1
v_mfma_f32_16x16x32_bf16 v[132:135], v[144:147], a[28:31], v[132:135]
ds_read_b128 v[180:183], v8 offset:1024
v_cvt_pk_bf16_f32 v108, v108, v109
v_mfma_f32_16x16x32_bf16 v[132:135], v[188:191], a[20:23], v[132:135]
s_cmp_ge_u32 s91, 163840
s_cselect_b32 s91, 0, s91
v_cvt_pk_bf16_f32 v109, v110, v111
v_mfma_f32_16x16x32_bf16 v[136:139], v[148:151], a[16:19], v[136:139]
s_waitcnt lgkmcnt(6)
ds_read_b128 v[184:187], v8 offset:2048
v_cvt_pk_bf16_f32 v110, v116, v117
v_mfma_f32_16x16x32_bf16 v[136:139], v[152:155], a[24:27], v[136:139]
s_waitcnt lgkmcnt(5)
v_cvt_pk_bf16_f32 v111, v118, v119
v_add_u32 v7, s91, v4
v_mfma_f32_16x16x32_bf16 v[140:143], v[152:155], a[28:31], v[140:143]
buffer_store_dwordx4 v[108:111], v4, s[24:27], s54 offen offset:1024 sc1
v_mfma_f32_16x16x32_bf16 v[140:143], v[148:151], a[20:23], v[140:143]
s_mov_b32 m0, s70
s_mov_b32 s64, s68
s_add_u32 s68, s68, 16384
v_mfma_f32_16x16x32_bf16 v[128:131], v[156:159], a[32:35], v[128:131]
s_cmp_lt_u32 s3, 3
s_cselect_b32 s68, s64, 2147418112
ds_read_b128 v[188:191], v8 offset:3072
v_mfma_f32_16x16x32_bf16 v[128:131], v[160:163], a[40:43], v[128:131]
buffer_load_dwordx4 v4, s[24:27], s64 offen offset:0 sc1 lds
v_mfma_f32_16x16x32_bf16 v[132:135], v[160:163], a[44:47], v[132:135]
ds_read_b128 v[144:147], v8 offset:4096
v_mfma_f32_16x16x32_bf16 v[132:135], v[156:159], a[36:39], v[132:135]
s_waitcnt lgkmcnt(5)
ds_read_b128 v[148:151], v8 offset:5120
v_mfma_f32_16x16x32_bf16 v[136:139], v[164:167], a[32:35], v[136:139]
buffer_load_dwordx4 v4, s[24:27], s68 offen offset:1024 sc1 lds
v_mfma_f32_16x16x32_bf16 v[136:139], v[168:171], a[40:43], v[136:139]
ds_read_b128 v[152:155], v8 offset:6144
v_mfma_f32_16x16x32_bf16 v[140:143], v[168:171], a[44:47], v[140:143]
ds_read_b128 v[156:159], v8 offset:7168
v_mfma_f32_16x16x32_bf16 v[140:143], v[164:167], a[36:39], v[140:143]
buffer_load_dwordx4 v4, s[24:27], s68 offen offset:2048 sc1 lds
v_mfma_f32_16x16x32_bf16 v[128:131], v[172:175], a[48:51], v[128:131]
s_waitcnt lgkmcnt(6)
ds_read_b128 v[160:163], v8 offset:8192
v_mfma_f32_16x16x32_bf16 v[128:131], v[176:179], a[56:59], v[128:131]
v_mfma_f32_16x16x32_bf16 v[132:135], v[176:179], a[60:63], v[132:135]
buffer_load_dwordx4 v4, s[24:27], s68 offen offset:3072 sc1 lds
v_mfma_f32_16x16x32_bf16 v[132:135], v[172:175], a[52:55], v[132:135]
buffer_load_dword v12, v10, s[24:27], s73 offen sc1
v_mfma_f32_16x16x32_bf16 v[136:139], v[180:183], a[48:51], v[136:139]
s_waitcnt lgkmcnt(5)
ds_read_b128 v[164:167], v8 offset:9216
v_mfma_f32_16x16x32_bf16 v[136:139], v[184:187], a[56:59], v[136:139]
ds_read_b128 v[168:171], v8 offset:10240
v_mfma_f32_16x16x32_bf16 v[140:143], v[184:187], a[60:63], v[140:143]
ds_read_b128 v[172:175], v8 offset:11264
v_mfma_f32_16x16x32_bf16 v[140:143], v[180:183], a[52:55], v[140:143]
v_mfma_f32_16x16x32_bf16 v[128:131], v[188:191], a[64:67], v[128:131]
s_waitcnt lgkmcnt(6)
ds_read_b128 v[176:179], v8 offset:12288
v_mfma_f32_16x16x32_bf16 v[128:131], v[144:147], a[72:75], v[128:131]
v_mfma_f32_16x16x32_bf16 v[132:135], v[144:147], a[76:79], v[132:135]
ds_read_b128 v[180:183], v8 offset:13312
v_mfma_f32_16x16x32_bf16 v[132:135], v[188:191], a[68:71], v[132:135]
v_mfma_f32_16x16x32_bf16 v[136:139], v[148:151], a[64:67], v[136:139]
s_waitcnt lgkmcnt(6)
ds_read_b128 v[184:187], v8 offset:14336
v_mfma_f32_16x16x32_bf16 v[136:139], v[152:155], a[72:75], v[136:139]
v_mfma_f32_16x16x32_bf16 v[140:143], v[152:155], a[76:79], v[140:143]
s_waitcnt vmcnt(7)
ds_read_b128 v[188:191], v8 offset:15360
v_mfma_f32_16x16x32_bf16 v[140:143], v[148:151], a[68:71], v[140:143]
s_barrier
v_mfma_f32_16x16x32_bf16 v[128:131], v[156:159], a[80:83], v[128:131]
s_waitcnt lgkmcnt(6)
s_add_u32 s91, s91, 16384
ds_read_b128 v[144:147], v7 offset:0
v_mfma_f32_16x16x32_bf16 v[128:131], v[160:163], a[88:91], v[128:131]
s_cmp_ge_u32 s91, 163840
s_cselect_b32 s91, 0, s91
v_add_u32 v8, s91, v4
v_mfma_f32_16x16x32_bf16 v[132:135], v[160:163], a[92:95], v[132:135]
ds_read_b128 v[148:151], v7 offset:1024
v_mfma_f32_16x16x32_bf16 v[132:135], v[156:159], a[84:87], v[132:135]
v_mfma_f32_16x16x32_bf16 v[136:139], v[164:167], a[80:83], v[136:139]
s_waitcnt vmcnt(5) lgkmcnt(6)
ds_read_b128 v[152:155], v7 offset:2048
v_mfma_f32_16x16x32_bf16 v[136:139], v[168:171], a[88:91], v[136:139]
buffer_atomic_add v1, v0, s[24:27], s82 offen offset:16 sc1
v_mfma_f32_16x16x32_bf16 v[140:143], v[168:171], a[92:95], v[140:143]
s_and_b32 s54, s3, 1
ds_read_b128 v[156:159], v7 offset:3072
v_mfma_f32_16x16x32_bf16 v[140:143], v[164:167], a[84:87], v[140:143]
s_mul_i32 s54, s54, 18432
v_mfma_f32_16x16x32_bf16 v[128:131], v[172:175], a[192:195], v[128:131]
s_waitcnt lgkmcnt(6)
s_mul_i32 s55, s86, 288
ds_read_b128 v[160:163], v7 offset:4096
v_mfma_f32_16x16x32_bf16 v[128:131], v[176:179], a[200:203], v[128:131]
s_add_u32 s54, s54, s55
v_mfma_f32_16x16x32_bf16 v[132:135], v[176:179], a[204:207], v[132:135]
s_add_u32 s54, s54, 256
ds_read_b128 v[164:167], v7 offset:5120
v_mfma_f32_16x16x32_bf16 v[132:135], v[172:175], a[196:199], v[132:135]
s_sub_u32 s55, 63, s72
v_mfma_f32_16x16x32_bf16 v[136:139], v[180:183], a[192:195], v[136:139]
s_waitcnt lgkmcnt(6)
s_mul_i32 s55, s55, 36864
ds_read_b128 v[168:171], v7 offset:6144
v_mfma_f32_16x16x32_bf16 v[136:139], v[184:187], a[200:203], v[136:139]
s_waitcnt vmcnt(1)
s_add_u32 s55, s55, s54
v_cmp_gt_u32 vcc, 4, v12
v_mfma_f32_16x16x32_bf16 v[140:143], v[184:187], a[204:207], v[140:143]
s_mul_i32 s52, s72, 36864
ds_read_b128 v[172:175], v7 offset:7168
v_mfma_f32_16x16x32_bf16 v[140:143], v[180:183], a[196:199], v[140:143]
s_waitcnt lgkmcnt(6)
s_add_u32 s54, s54, s52
v_mfma_f32_16x16x32_bf16 v[128:131], v[188:191], a[208:211], v[128:131]
s_cmp_eq_u64 vcc, 0
s_cselect_b32 s81, s69, 2147418112
s_cselect_b32 s93, s71, 2147418112
v_mfma_f32_16x16x32_bf16 v[128:131], v[144:147], a[216:219], v[128:131]
s_lshl_b32 s53, s84, 6
ds_read_b128 v[176:179], v7 offset:8192
v_mfma_f32_16x16x32_bf16 v[132:135], v[144:147], a[220:223], v[132:135]
s_sub_u32 s53, s53, 256
ds_read_b128 v[180:183], v7 offset:9216
v_mfma_f32_16x16x32_bf16 v[132:135], v[188:191], a[212:215], v[132:135]
buffer_load_dwordx4 v[192:195], v4, s[24:27], s81 offen offset:0 sc1
v_mfma_f32_16x16x32_bf16 v[136:139], v[148:151], a[208:211], v[136:139]
s_waitcnt lgkmcnt(6)
s_add_u32 s52, s54, s53
ds_read_b128 v[184:187], v7 offset:10240
v_mfma_f32_16x16x32_bf16 v[136:139], v[152:155], a[216:219], v[136:139]
s_add_u32 s53, s55, s53
v_mfma_f32_16x16x32_bf16 v[140:143], v[152:155], a[220:223], v[140:143]
buffer_load_dwordx4 v[196:199], v4, s[24:27], s81 offen offset:1024 sc1
v_mfma_f32_16x16x32_bf16 v[140:143], v[148:151], a[212:215], v[140:143]
ds_read_b128 v[188:191], v7 offset:11264
v_mfma_f32_16x16x32_bf16 v[128:131], v[156:159], a[224:227], v[128:131]
s_waitcnt lgkmcnt(6)
ds_read_b128 v[144:147], v7 offset:12288
v_mfma_f32_16x16x32_bf16 v[128:131], v[160:163], a[232:235], v[128:131]
buffer_load_dwordx4 v[200:203], v4, s[24:27], s81 offen offset:2048 sc1
v_mfma_f32_16x16x32_bf16 v[132:135], v[160:163], a[236:239], v[132:135]
L_PAD13:
s_cbranch_execz L_MAIN
ds_read_b128 v[148:151], v7 offset:13312
v_mfma_f32_16x16x32_bf16 v[132:135], v[156:159], a[228:231], v[132:135]
s_waitcnt lgkmcnt(6)
v_mfma_f32_16x16x32_bf16 v[136:139], v[164:167], a[224:227], v[136:139]
buffer_load_dwordx4 v[204:207], v4, s[24:27], s81 offen offset:3072 sc1
v_mfma_f32_16x16x32_bf16 v[136:139], v[168:171], a[232:235], v[136:139]
ds_read_b128 v[152:155], v7 offset:14336
v_mfma_f32_16x16x32_bf16 v[140:143], v[168:171], a[236:239], v[140:143]
ds_read_b128 v[156:159], v7 offset:15360
v_mfma_f32_16x16x32_bf16 v[140:143], v[164:167], a[228:231], v[140:143]
buffer_load_dwordx4 v[208:211], v4, s[24:27], s93 offen offset:0 sc1
v_mfma_f32_16x16x32_bf16 v[128:131], v[172:175], a[240:243], v[128:131]
s_waitcnt lgkmcnt(6)
s_add_u32 s91, s91, 16384
ds_read_b128 v[160:163], v8 offset:0
v_mfma_f32_16x16x32_bf16 v[128:131], v[176:179], a[248:251], v[128:131]
s_cmp_ge_u32 s91, 163840
s_cselect_b32 s91, 0, s91
v_add_u32 v7, s91, v4
v_mfma_f32_16x16x32_bf16 v[132:135], v[176:179], a[252:255], v[132:135]
buffer_load_dwordx4 v[212:215], v4, s[24:27], s93 offen offset:1024 sc1
v_mfma_f32_16x16x32_bf16 v[132:135], v[172:175], a[244:247], v[132:135]
ds_read_b128 v[164:167], v8 offset:1024
v_mfma_f32_16x16x32_bf16 v[136:139], v[180:183], a[240:243], v[136:139]
s_waitcnt lgkmcnt(6)
ds_read_b128 v[168:171], v8 offset:2048
v_mfma_f32_16x16x32_bf16 v[136:139], v[184:187], a[248:251], v[136:139]
buffer_load_dwordx4 v[216:219], v4, s[24:27], s93 offen offset:2048 sc1
v_mfma_f32_16x16x32_bf16 v[140:143], v[184:187], a[252:255], v[140:143]
ds_read_b128 v[172:175], v8 offset:3072
v_mfma_f32_16x16x32_bf16 v[140:143], v[180:183], a[244:247], v[140:143]
v_mfma_f32_16x16x32_bf16 v[128:131], v[188:191], a[96:99], v[128:131]
s_waitcnt lgkmcnt(6)
ds_read_b128 v[176:179], v8 offset:4096
v_mfma_f32_16x16x32_bf16 v[128:131], v[144:147], a[104:107], v[128:131]
v_mfma_f32_16x16x32_bf16 v[132:135], v[144:147], a[108:111], v[132:135]
ds_read_b128 v[180:183], v8 offset:5120
v_mfma_f32_16x16x32_bf16 v[132:135], v[188:191], a[100:103], v[132:135]
v_mfma_f32_16x16x32_bf16 v[136:139], v[148:151], a[96:99], v[136:139]
s_waitcnt lgkmcnt(6)
ds_read_b128 v[184:187], v8 offset:6144
v_mfma_f32_16x16x32_bf16 v[136:139], v[152:155], a[104:107], v[136:139]
v_mfma_f32_16x16x32_bf16 v[140:143], v[152:155], a[108:111], v[140:143]
ds_read_b128 v[188:191], v8 offset:7168
v_mfma_f32_16x16x32_bf16 v[140:143], v[148:151], a[100:103], v[140:143]
v_mfma_f32_16x16x32_bf16 v[128:131], v[156:159], a[112:115], v[128:131]
s_waitcnt lgkmcnt(6)
ds_read_b128 v[144:147], v8 offset:8192
v_mfma_f32_16x16x32_bf16 v[128:131], v[160:163], a[120:123], v[128:131]
v_mfma_f32_16x16x32_bf16 v[132:135], v[160:163], a[124:127], v[132:135]
ds_read_b128 v[148:151], v8 offset:9216
v_mfma_f32_16x16x32_bf16 v[132:135], v[156:159], a[116:119], v[132:135]
s_waitcnt lgkmcnt(6)
v_mfma_f32_16x16x32_bf16 v[136:139], v[164:167], a[112:115], v[136:139]
buffer_load_dword v12, v10, s[24:27], s75 offen offset:16 sc1
v_mfma_f32_16x16x32_bf16 v[136:139], v[168:171], a[120:123], v[136:139]
ds_read_b128 v[152:155], v8 offset:10240
v_mfma_f32_16x16x32_bf16 v[140:143], v[168:171], a[124:127], v[140:143]
ds_read_b128 v[156:159], v8 offset:11264
v_mfma_f32_16x16x32_bf16 v[140:143], v[164:167], a[116:119], v[140:143]
v_mfma_f32_16x16x32_bf16 v[128:131], v[172:175], a[128:131], v[128:131]
s_waitcnt lgkmcnt(6)
ds_read_b128 v[160:163], v8 offset:12288
v_mfma_f32_16x16x32_bf16 v[128:131], v[176:179], a[136:139], v[128:131]
v_mfma_f32_16x16x32_bf16 v[132:135], v[176:179], a[140:143], v[132:135]
ds_read_b128 v[164:167], v8 offset:13312
v_mfma_f32_16x16x32_bf16 v[132:135], v[172:175], a[132:135], v[132:135]
v_mfma_f32_16x16x32_bf16 v[136:139], v[180:183], a[128:131], v[136:139]
s_waitcnt lgkmcnt(6)
ds_read_b128 v[168:171], v8 offset:14336
v_mfma_f32_16x16x32_bf16 v[136:139], v[184:187], a[136:139], v[136:139]
v_mfma_f32_16x16x32_bf16 v[140:143], v[184:187], a[140:143], v[140:143]
s_waitcnt vmcnt(10)
ds_read_b128 v[172:175], v8 offset:15360
v_mfma_f32_16x16x32_bf16 v[140:143], v[180:183], a[132:135], v[140:143]
s_barrier
v_mfma_f32_16x16x32_bf16 v[128:131], v[188:191], a[144:147], v[128:131]
s_waitcnt lgkmcnt(6)
ds_read_b128 v[176:179], v7 offset:0
v_mfma_f32_16x16x32_bf16 v[128:131], v[144:147], a[152:155], v[128:131]
v_mfma_f32_16x16x32_bf16 v[132:135], v[144:147], a[156:159], v[132:135]
ds_read_b128 v[180:183], v7 offset:1024
v_mfma_f32_16x16x32_bf16 v[132:135], v[188:191], a[148:151], v[132:135]
v_mfma_f32_16x16x32_bf16 v[136:139], v[148:151], a[144:147], v[136:139]
s_waitcnt lgkmcnt(6)
ds_read_b128 v[184:187], v7 offset:2048
v_mfma_f32_16x16x32_bf16 v[136:139], v[152:155], a[152:155], v[136:139]
v_mfma_f32_16x16x32_bf16 v[140:143], v[152:155], a[156:159], v[140:143]
ds_read_b128 v[188:191], v7 offset:3072
v_mfma_f32_16x16x32_bf16 v[140:143], v[148:151], a[148:151], v[140:143]
v_mfma_f32_16x16x32_bf16 v[128:131], v[156:159], a[160:163], v[128:131]
s_waitcnt lgkmcnt(6)
ds_read_b128 v[144:147], v7 offset:4096
v_mfma_f32_16x16x32_bf16 v[128:131], v[160:163], a[168:171], v[128:131]
v_mfma_f32_16x16x32_bf16 v[132:135], v[160:163], a[172:175], v[132:135]
ds_read_b128 v[148:151], v7 offset:5120
v_mfma_f32_16x16x32_bf16 v[132:135], v[156:159], a[164:167], v[132:135]
v_mfma_f32_16x16x32_bf16 v[136:139], v[164:167], a[160:163], v[136:139]
s_waitcnt lgkmcnt(6)
ds_read_b128 v[152:155], v7 offset:6144
v_mfma_f32_16x16x32_bf16 v[136:139], v[168:171], a[168:171], v[136:139]
v_mfma_f32_16x16x32_bf16 v[140:143], v[168:171], a[172:175], v[140:143]
s_waitcnt vmcnt(0)
ds_read_b128 v[156:159], v7 offset:7168
v_cmp_gt_u32 vcc, 1, v12
v_mfma_f32_16x16x32_bf16 v[140:143], v[164:167], a[164:167], v[140:143]
v_lshlrev_b32 v72, 16, v192
v_and_b32 v73, v13, v192
v_mfma_f32_16x16x32_bf16 v[128:131], v[172:175], a[176:179], v[128:131]
s_waitcnt lgkmcnt(6)
ds_read_b128 v[160:163], v7 offset:8192
v_lshlrev_b32 v74, 16, v193
v_mfma_f32_16x16x32_bf16 v[128:131], v[176:179], a[184:187], v[128:131]
s_cmp_eq_u64 vcc, 0
s_cselect_b32 s77, s83, 2147418112
v_and_b32 v75, v13, v193
v_mfma_f32_16x16x32_bf16 v[132:135], v[176:179], a[188:191], v[132:135]
buffer_load_dwordx4 v[220:223], v4, s[24:27], s77 offen offset:0 sc1
v_mfma_f32_16x16x32_bf16 v[132:135], v[172:175], a[180:183], v[132:135]
s_waitcnt lgkmcnt(5)
ds_read_b128 v[164:167], v7 offset:9216
v_lshlrev_b32 v80, 16, v194
v_mfma_f32_16x16x32_bf16 v[136:139], v[180:183], a[176:179], v[136:139]
buffer_load_dwordx4 v[224:227], v4, s[24:27], s77 offen offset:1024 sc1
v_mfma_f32_16x16x32_bf16 v[136:139], v[184:187], a[184:187], v[136:139]
ds_read_b128 v[168:171], v7 offset:10240
v_and_b32 v81, v13, v194
v_mfma_f32_16x16x32_bf16 v[140:143], v[184:187], a[188:191], v[140:143]
ds_read_b128 v[172:175], v7 offset:11264
v_lshlrev_b32 v82, 16, v195
v_mfma_f32_16x16x32_bf16 v[140:143], v[180:183], a[180:183], v[140:143]
s_waitcnt lgkmcnt(6)
v_and_b32 v83, v13, v195
v_lshlrev_b32 v76, 16, v196
v_mfma_f32_16x16x32_bf16 v[128:131], v[188:191], v[32:35], v[128:131]
buffer_load_dword v11, v10, s[24:27], s73 offen sc1
v_mfma_f32_16x16x32_bf16 v[128:131], v[144:147], v[40:43], v[128:131]
ds_read_b128 v[176:179], v7 offset:12288
v_and_b32 v77, v13, v196
v_mfma_f32_16x16x32_bf16 v[132:135], v[144:147], v[44:47], v[132:135]
buffer_load_dword v12, v10, s[24:27], s75 offen offset:16 sc1
v_mfma_f32_16x16x32_bf16 v[132:135], v[188:191], v[36:39], v[132:135]
v_lshlrev_b32 v78, 16, v197
v_and_b32 v79, v13, v197
v_mfma_f32_16x16x32_bf16 v[136:139], v[148:151], v[32:35], v[136:139]
s_waitcnt lgkmcnt(5)
v_lshlrev_b32 v84, 16, v198
v_and_b32 v85, v13, v198
v_mfma_f32_16x16x32_bf16 v[136:139], v[152:155], v[40:43], v[136:139]
v_lshlrev_b32 v86, 16, v199
v_and_b32 v87, v13, v199
v_mfma_f32_16x16x32_bf16 v[140:143], v[152:155], v[44:47], v[140:143]
v_lshlrev_b32 v88, 16, v200
v_and_b32 v89, v13, v200
v_mfma_f32_16x16x32_bf16 v[140:143], v[148:151], v[36:39], v[140:143]
v_lshlrev_b32 v90, 16, v201
v_and_b32 v91, v13, v201
v_mfma_f32_16x16x32_bf16 v[128:131], v[156:159], v[48:51], v[128:131]
s_waitcnt lgkmcnt(3)
v_lshlrev_b32 v96, 16, v202
v_and_b32 v97, v13, v202
v_mfma_f32_16x16x32_bf16 v[128:131], v[160:163], v[56:59], v[128:131]
v_lshlrev_b32 v98, 16, v203
v_and_b32 v99, v13, v203
v_mfma_f32_16x16x32_bf16 v[132:135], v[160:163], v[60:63], v[132:135]
v_lshlrev_b32 v92, 16, v204
v_and_b32 v93, v13, v204
v_mfma_f32_16x16x32_bf16 v[132:135], v[156:159], v[52:55], v[132:135]
v_lshlrev_b32 v94, 16, v205
v_and_b32 v95, v13, v205
v_mfma_f32_16x16x32_bf16 v[136:139], v[164:167], v[48:51], v[136:139]
s_waitcnt lgkmcnt(1)
v_lshlrev_b32 v100, 16, v206
v_and_b32 v101, v13, v206
v_mfma_f32_16x16x32_bf16 v[136:139], v[168:171], v[56:59], v[136:139]
v_lshlrev_b32 v102, 16, v207
v_and_b32 v103, v13, v207
v_mfma_f32_16x16x32_bf16 v[140:143], v[168:171], v[60:63], v[140:143]
v_mfma_f32_16x16x32_bf16 v[140:143], v[164:167], v[52:55], v[140:143]
v_mfma_f32_16x16x32_bf16 v[128:131], v[172:175], v[64:67], v[128:131]
v_mfma_f32_16x16x32_bf16 v[132:135], v[172:175], v[68:71], v[132:135]
s_waitcnt lgkmcnt(0)
v_mfma_f32_16x16x32_bf16 v[136:139], v[176:179], v[64:67], v[136:139]
v_mfma_f32_16x16x32_bf16 v[140:143], v[176:179], v[68:71], v[140:143]
s_max_u32 s92, s81, s77
s_cmp_lt_u32 s92, 2147418112
s_cbranch_scc1 L_P1
s_mov_b32 s92, 0
s_branch L_S1
L_S0:
buffer_load_dword v11, v10, s[24:27], s73 offen sc1
buffer_load_dword v12, v10, s[24:27], s75 offen offset:16 sc1
L_S1:
s_add_u32 s92, s92, 1
s_waitcnt vmcnt(0)
v_lshrrev_b32 v11, 2, v11
v_min_u32 v11, v11, v12
v_cmp_gt_u32 vcc, 1, v11
s_cmp_gt_u32 s92, 1048576
s_cbranch_scc1 L_S2
s_nop 2
s_cbranch_vccnz L_S0
L_S2:
buffer_load_dwordx4 v[220:223], v4, s[24:27], s83 offen offset:0 sc1
buffer_load_dwordx4 v[224:227], v4, s[24:27], s83 offen offset:1024 sc1
s_cmp_eq_u32 s81, s69
s_cbranch_scc1 L_P1
buffer_load_dwordx4 v[192:195], v4, s[24:27], s69 offen offset:0 sc1
buffer_load_dwordx4 v[196:199], v4, s[24:27], s69 offen offset:1024 sc1
buffer_load_dwordx4 v[200:203], v4, s[24:27], s69 offen offset:2048 sc1
buffer_load_dwordx4 v[204:207], v4, s[24:27], s69 offen offset:3072 sc1
buffer_load_dwordx4 v[208:211], v4, s[24:27], s71 offen offset:0 sc1
buffer_load_dwordx4 v[212:215], v4, s[24:27], s71 offen offset:1024 sc1
buffer_load_dwordx4 v[216:219], v4, s[24:27], s71 offen offset:2048 sc1
s_waitcnt vmcnt(3)
v_lshlrev_b32 v72, 16, v192
v_and_b32 v73, v13, v192
v_lshlrev_b32 v74, 16, v193
v_and_b32 v75, v13, v193
v_lshlrev_b32 v80, 16, v194
v_and_b32 v81, v13, v194
v_lshlrev_b32 v82, 16, v195
v_and_b32 v83, v13, v195
v_lshlrev_b32 v76, 16, v196
v_and_b32 v77, v13, v196
v_lshlrev_b32 v78, 16, v197
v_and_b32 v79, v13, v197
v_lshlrev_b32 v84, 16, v198
v_and_b32 v85, v13, v198
v_lshlrev_b32 v86, 16, v199
v_and_b32 v87, v13, v199
v_lshlrev_b32 v88, 16, v200
v_and_b32 v89, v13, v200
v_lshlrev_b32 v90, 16, v201
v_and_b32 v91, v13, v201
v_lshlrev_b32 v96, 16, v202
v_and_b32 v97, v13, v202
v_lshlrev_b32 v98, 16, v203
v_and_b32 v99, v13, v203
v_lshlrev_b32 v92, 16, v204
v_and_b32 v93, v13, v204
v_lshlrev_b32 v94, 16, v205
v_and_b32 v95, v13, v205
v_lshlrev_b32 v100, 16, v206
v_and_b32 v101, v13, v206
v_lshlrev_b32 v102, 16, v207
v_and_b32 v103, v13, v207
s_waitcnt vmcnt(0)
L_P1:
s_nop 1
v_pk_add_f32 v[72:73], v[72:73], v[88:89]
v_pk_add_f32 v[74:75], v[74:75], v[90:91]
v_pk_add_f32 v[76:77], v[76:77], v[92:93]
v_pk_add_f32 v[78:79], v[78:79], v[94:95]
v_pk_add_f32 v[80:81], v[80:81], v[96:97]
v_pk_add_f32 v[82:83], v[82:83], v[98:99]
v_pk_add_f32 v[84:85], v[84:85], v[100:101]
v_pk_add_f32 v[86:87], v[86:87], v[102:103]
v_pk_add_f32 v[128:129], v[128:129], v[72:73]
v_pk_add_f32 v[130:131], v[130:131], v[74:75]
v_pk_add_f32 v[132:133], v[132:133], v[76:77]
v_pk_add_f32 v[134:135], v[134:135], v[78:79]
v_pk_add_f32 v[136:137], v[136:137], v[80:81]
v_pk_add_f32 v[138:139], v[138:139], v[82:83]
v_pk_add_f32 v[140:141], v[140:141], v[84:85]
v_pk_add_f32 v[142:143], v[142:143], v[86:87]
s_cmp_lg_u32 s3, s84
s_cbranch_scc1 L_NO9
v_lshlrev_b32 v16, 16, v208
v_and_b32 v17, v13, v208
v_lshlrev_b32 v18, 16, v209
v_and_b32 v19, v13, v209
v_lshlrev_b32 v20, 16, v210
v_and_b32 v21, v13, v210
v_lshlrev_b32 v22, 16, v211
v_and_b32 v23, v13, v211
v_pk_add_f32 v[120:121], v[120:121], v[16:17]
v_pk_add_f32 v[122:123], v[122:123], v[18:19]
v_pk_add_f32 v[124:125], v[124:125], v[20:21]
v_pk_add_f32 v[126:127], v[126:127], v[22:23]
v_lshlrev_b32 v16, 16, v212
v_and_b32 v17, v13, v212
v_lshlrev_b32 v18, 16, v213
v_and_b32 v19, v13, v213
v_lshlrev_b32 v20, 16, v214
v_and_b32 v21, v13, v214
v_lshlrev_b32 v22, 16, v215
v_and_b32 v23, v13, v215
v_pk_add_f32 v[120:121], v[120:121], v[16:17]
v_pk_add_f32 v[122:123], v[122:123], v[18:19]
v_pk_add_f32 v[124:125], v[124:125], v[20:21]
v_pk_add_f32 v[126:127], v[126:127], v[22:23]
v_lshlrev_b32 v16, 16, v216
v_and_b32 v17, v13, v216
v_lshlrev_b32 v18, 16, v217
v_and_b32 v19, v13, v217
v_lshlrev_b32 v20, 16, v218
v_and_b32 v21, v13, v218
v_lshlrev_b32 v22, 16, v219
v_and_b32 v23, v13, v219
v_pk_add_f32 v[120:121], v[120:121], v[16:17]
v_pk_add_f32 v[122:123], v[122:123], v[18:19]
v_pk_add_f32 v[124:125], v[124:125], v[20:21]
v_pk_add_f32 v[126:127], v[126:127], v[22:23]
v_cvt_pk_bf16_f32 v228, v120, v121
v_cvt_pk_bf16_f32 v229, v122, v123
v_cvt_pk_bf16_f32 v230, v124, v125
v_cvt_pk_bf16_f32 v231, v126, v127
s_waitcnt vmcnt(0)
buffer_store_dwordx2 v[228:229], v6, s[44:47], s54 offen sc1
buffer_store_dwordx2 v[230:231], v6, s[44:47], s55 offen sc1
s_branch L_9D
L_NO9:
s_waitcnt vmcnt(0)
L_9D:
v_lshlrev_b32 v16, 16, v220
v_and_b32 v17, v13, v220
v_lshlrev_b32 v18, 16, v221
v_and_b32 v19, v13, v221
v_lshlrev_b32 v20, 16, v222
v_and_b32 v21, v13, v222
v_lshlrev_b32 v22, 16, v223
v_and_b32 v23, v13, v223
v_pk_add_f32 v[128:129], v[128:129], v[16:17]
v_pk_add_f32 v[130:131], v[130:131], v[18:19]
v_pk_add_f32 v[136:137], v[136:137], v[20:21]
v_pk_add_f32 v[138:139], v[138:139], v[22:23]
v_cvt_pk_bf16_f32 v128, v128, v129
v_cvt_pk_bf16_f32 v129, v130, v131
v_cvt_pk_bf16_f32 v130, v136, v137
v_cvt_pk_bf16_f32 v131, v138, v139
s_nop 1
v_permlane16_swap_b32 v128, v130
v_permlane16_swap_b32 v129, v131
buffer_store_dwordx4 v[128:131], v5, s[44:47], s52 offen sc1
v_lshlrev_b32 v16, 16, v224
v_and_b32 v17, v13, v224
v_lshlrev_b32 v18, 16, v225
v_and_b32 v19, v13, v225
v_lshlrev_b32 v20, 16, v226
v_and_b32 v21, v13, v226
v_lshlrev_b32 v22, 16, v227
v_and_b32 v23, v13, v227
v_pk_add_f32 v[132:133], v[132:133], v[16:17]
v_pk_add_f32 v[134:135], v[134:135], v[18:19]
v_pk_add_f32 v[140:141], v[140:141], v[20:21]
v_pk_add_f32 v[142:143], v[142:143], v[22:23]
v_cvt_pk_bf16_f32 v132, v132, v133
v_cvt_pk_bf16_f32 v133, v134, v135
v_cvt_pk_bf16_f32 v134, v140, v141
v_cvt_pk_bf16_f32 v135, v142, v143
s_nop 1
v_permlane16_swap_b32 v132, v134
v_permlane16_swap_b32 v133, v135
buffer_store_dwordx4 v[132:135], v5, s[44:47], s53 offen sc1
L_END:
s_endpgm
L_SE2:
v_accvgpr_read_b32 v180, a224
v_accvgpr_read_b32 v182, a228
v_cmp_nle_f32 vcc, v180, v7
v_cmp_nle_f32 s[96:97], v182, v7
s_nop 3
s_or_b64 vcc, vcc, s[96:97]
s_cbranch_vccnz SLOW0
SLOW0_R:
s_add_u32 s53, s77, 180224
buffer_load_dwordx4 a[112:115], v4, s[24:27], s53 offen offset:0 sc1
v_mul_f32 v8, 0x3fb8aa3b, v8
v_mul_f32 v9, 0x3fb8aa3b, v9
v_exp_f32 v8, v8
v_exp_f32 v9, v9
s_nop 0
v_fma_f32 v180, v180, v8, v180
v_fma_f32 v182, v182, v9, v182
v_rcp_f32 v180, v180
v_rcp_f32 v182, v182
s_add_u32 s52, s78, 4096
v_mov_b32 v181, v180
v_mov_b32 v183, v182
v_pk_mul_f32 v[36:37], v[36:37], v[180:181]
v_pk_mul_f32 v[38:39], v[38:39], v[180:181]
v_pk_mul_f32 v[32:33], v[32:33], v[180:181]
v_pk_mul_f32 v[34:35], v[34:35], v[180:181]
v_cvt_pk_bf16_f32 v36, v36, v37
v_cvt_pk_bf16_f32 v37, v38, v39
v_cvt_pk_bf16_f32 v38, v32, v33
v_cvt_pk_bf16_f32 v39, v34, v35
buffer_store_dwordx4 v[36:39], v4, s[24:27], s78 offen offset:0 sc1
buffer_load_dwordx4 a[116:119], v4, s[24:27], s53 offen offset:1024 sc1
v_pk_mul_f32 v[116:117], v[116:117], v[182:183]
v_pk_mul_f32 v[118:119], v[118:119], v[182:183]
v_pk_mul_f32 v[132:133], v[132:133], v[182:183]
v_pk_mul_f32 v[134:135], v[134:135], v[182:183]
v_cvt_pk_bf16_f32 v116, v116, v117
v_cvt_pk_bf16_f32 v117, v118, v119
v_cvt_pk_bf16_f32 v118, v132, v133
v_cvt_pk_bf16_f32 v119, v134, v135
buffer_store_dwordx4 v[116:119], v4, s[24:27], s78 offen offset:1024 sc1
v_pk_mul_f32 v[196:197], v[196:197], v[180:181]
v_pk_mul_f32 v[198:199], v[198:199], v[180:181]
v_pk_mul_f32 v[204:205], v[204:205], v[180:181]
v_pk_mul_f32 v[206:207], v[206:207], v[180:181]
v_cvt_pk_bf16_f32 v196, v196, v197
v_cvt_pk_bf16_f32 v197, v198, v199
v_cvt_pk_bf16_f32 v198, v204, v205
v_cvt_pk_bf16_f32 v199, v206, v207
buffer_store_dwordx4 v[196:199], v4, s[24:27], s78 offen offset:2048 sc1
v_pk_mul_f32 v[184:185], v[184:185], v[182:183]
v_pk_mul_f32 v[186:187], v[186:187], v[182:183]
v_pk_mul_f32 v[240:241], v[240:241], v[182:183]
buffer_load_dwordx4 a[120:123], v4, s[24:27], s53 offen offset:2048 sc1
v_pk_mul_f32 v[242:243], v[242:243], v[182:183]
v_cvt_pk_bf16_f32 v184, v184, v185
v_cvt_pk_bf16_f32 v185, v186, v187
v_cvt_pk_bf16_f32 v186, v240, v241
v_cvt_pk_bf16_f32 v187, v242, v243
buffer_store_dwordx4 v[184:187], v4, s[24:27], s78 offen offset:3072 sc1
v_pk_mul_f32 v[108:109], v[108:109], v[180:181]
v_pk_mul_f32 v[110:111], v[110:111], v[180:181]
v_pk_mul_f32 v[40:41], v[40:41], v[180:181]
v_pk_mul_f32 v[42:43], v[42:43], v[180:181]
v_cvt_pk_bf16_f32 v108, v108, v109
v_cvt_pk_bf16_f32 v109, v110, v111
v_cvt_pk_bf16_f32 v110, v40, v41
v_cvt_pk_bf16_f32 v111, v42, v43
buffer_store_dwordx4 v[108:111], v4, s[24:27], s52 offen offset:0 sc1
v_pk_mul_f32 v[188:189], v[188:189], v[182:183]
v_pk_mul_f32 v[190:191], v[190:191], v[182:183]
v_pk_mul_f32 v[56:57], v[56:57], v[182:183]
v_pk_mul_f32 v[58:59], v[58:59], v[182:183]
v_cvt_pk_bf16_f32 v188, v188, v189
v_cvt_pk_bf16_f32 v189, v190, v191
buffer_load_dwordx4 a[124:127], v4, s[24:27], s53 offen offset:3072 sc1
v_cvt_pk_bf16_f32 v190, v56, v57
v_cvt_pk_bf16_f32 v191, v58, v59
buffer_store_dwordx4 v[188:191], v4, s[24:27], s52 offen offset:1024 sc1
v_pk_mul_f32 v[80:81], v[80:81], v[180:181]
v_pk_mul_f32 v[82:83], v[82:83], v[180:181]
v_pk_mul_f32 v[168:169], v[168:169], v[180:181]
v_pk_mul_f32 v[170:171], v[170:171], v[180:181]
v_cvt_pk_bf16_f32 v80, v80, v81
v_cvt_pk_bf16_f32 v81, v82, v83
v_cvt_pk_bf16_f32 v82, v168, v169
v_cvt_pk_bf16_f32 v83, v170, v171
buffer_store_dwordx4 v[80:83], v4, s[24:27], s52 offen offset:2048 sc1
v_pk_mul_f32 v[88:89], v[88:89], v[182:183]
v_pk_mul_f32 v[90:91], v[90:91], v[182:183]
v_pk_mul_f32 v[192:193], v[192:193], v[182:183]
v_pk_mul_f32 v[194:195], v[194:195], v[182:183]
v_cvt_pk_bf16_f32 v88, v88, v89
v_cvt_pk_bf16_f32 v89, v90, v91
v_cvt_pk_bf16_f32 v90, v192, v193
v_cvt_pk_bf16_f32 v91, v194, v195
buffer_store_dwordx4 v[88:91], v4, s[24:27], s52 offen offset:3072 sc1
s_branch L_LA
CK_Z:
s_mov_b32 s92, 0
CK_Z_L:
s_sleep 1
buffer_load_dword v23, v22, s[40:43], 0 offen sc1
s_add_u32 s92, s92, 1
s_waitcnt vmcnt(0)
v_cmp_gt_u32 vcc, 1, v23
s_cmp_gt_u32 s92, 1048576
s_cbranch_scc1 CK_Z_R
s_nop 3
s_cbranch_vccnz CK_Z_L
s_branch CK_Z_R
CK_WA:
s_mov_b32 s92, 0
CK_WA_L:
s_sleep 1
buffer_load_dword v30, v29, s[24:27], s89 offen sc1
s_add_u32 s92, s92, 1
s_waitcnt vmcnt(0)
v_cmp_gt_u32 vcc, 18, v30
s_cmp_gt_u32 s92, 1048576
s_cbranch_scc1 CK_WA_R
s_nop 3
s_cbranch_vccnz CK_WA_L
s_branch CK_WA_R
CK_ZA:
s_mov_b32 s92, 0
CK_ZA_L:
s_sleep 1
buffer_load_dword v30, v28, s[40:43], 0 offen sc1
s_add_u32 s92, s92, 1
s_waitcnt vmcnt(0)
v_cmp_gt_u32 vcc, 1, v30
s_cmp_gt_u32 s92, 1048576
s_cbranch_scc1 CK_ZA_R
s_nop 3
s_cbranch_vccnz CK_ZA_L
s_branch CK_ZA_R
CK_KV:
s_mov_b32 s92, 0
CK_KV_L:
s_sleep 1
buffer_load_dword v30, v29, s[24:27], s89 offen offset:4 sc1
s_add_u32 s92, s92, 1
s_waitcnt vmcnt(0)
v_cmp_gt_u32 vcc, 8, v30
s_cmp_gt_u32 s92, 1048576
s_cbranch_scc1 CK_KV_R
s_nop 3
s_cbranch_vccnz CK_KV_L
s_branch CK_KV_R
D0:
v_cndmask_b32 v96, v96, v6, s[56:57]
v_cndmask_b32 v120, v120, v6, s[56:57]
v_mov_b32 v112, v6
v_cndmask_b32 v97, v97, v6, s[58:59]
v_cndmask_b32 v121, v121, v6, s[58:59]
v_mov_b32 v113, v6
v_cndmask_b32 v98, v98, v6, s[60:61]
v_cndmask_b32 v122, v122, v6, s[60:61]
v_mov_b32 v114, v6
v_cndmask_b32 v99, v99, v6, s[62:63]
v_cndmask_b32 v123, v123, v6, s[62:63]
v_mov_b32 v115, v6
s_branch D0_R
CK_Q:
s_mov_b32 s92, 0
CK_Q_L:
s_sleep 1
buffer_load_dword v172, v173, s[24:27], 0 offen sc1
s_add_u32 s92, s92, 1
s_waitcnt vmcnt(0)
v_cmp_gt_u32 vcc, 32, v172
s_cmp_gt_u32 s92, 1048576
s_cbranch_scc1 CK_Q_R
s_nop 3
s_cbranch_vccnz CK_Q_L
s_branch CK_Q_R
CK_ZAA:
s_mov_b32 s92, 0
CK_ZAA_L:
s_sleep 1
buffer_load_dword v12, v10, s[24:27], s75 offen offset:4 sc1
s_add_u32 s92, s92, 1
s_waitcnt vmcnt(0)
v_cmp_gt_u32 vcc, 8, v12
s_cmp_gt_u32 s92, 1048576
s_cbranch_scc1 CK_ZAA_R
s_nop 3
s_cbranch_vccnz CK_ZAA_L
s_branch CK_ZAA_R
SLOW0:
v_add_u32 v20, 4096, v4
s_mov_b32 s54, 0
v_mov_b32 v16, v6
v_mov_b32 v18, v6
SLOW0_P:
s_mov_b32 s53, 0
s_mov_b32 s52, s94
SLOW0_T:
s_add_u32 s55, s52, 24576
buffer_load_dwordx4 a[192:195], v4, s[24:27], s52 offen offset:0 sc1
buffer_load_dwordx4 a[196:199], v4, s[24:27], s52 offen offset:1024 sc1
buffer_load_dwordx4 a[200:203], v4, s[24:27], s52 offen offset:2048 sc1
buffer_load_dwordx4 a[204:207], v4, s[24:27], s52 offen offset:3072 sc1
buffer_load_dwordx4 a[208:211], v20, s[24:27], s52 offen offset:0 sc1
buffer_load_dwordx4 a[212:215], v20, s[24:27], s52 offen offset:1024 sc1
buffer_load_dwordx4 a[216:219], v20, s[24:27], s52 offen offset:2048 sc1
buffer_load_dwordx4 a[220:223], v20, s[24:27], s52 offen offset:3072 sc1
buffer_load_dwordx4 a[64:67], v4, s[24:27], s55 offen offset:0 sc1
buffer_load_dwordx4 a[68:71], v4, s[24:27], s55 offen offset:1024 sc1
buffer_load_dwordx4 a[72:75], v4, s[24:27], s55 offen offset:2048 sc1
buffer_load_dwordx4 a[76:79], v4, s[24:27], s55 offen offset:3072 sc1
buffer_load_dwordx4 a[80:83], v20, s[24:27], s55 offen offset:0 sc1
buffer_load_dwordx4 a[84:87], v20, s[24:27], s55 offen offset:1024 sc1
buffer_load_dwordx4 a[88:91], v20, s[24:27], s55 offen offset:2048 sc1
buffer_load_dwordx4 a[92:95], v20, s[24:27], s55 offen offset:3072 sc1
s_waitcnt vmcnt(0)
v_mfma_f32_16x16x32_bf16 v[44:47], a[192:195], a[32:35], 0
v_mfma_f32_16x16x32_bf16 v[44:47], a[196:199], a[36:39], v[44:47]
v_mfma_f32_16x16x32_bf16 v[44:47], a[200:203], a[28:31], v[44:47]
v_mfma_f32_16x16x32_bf16 v[44:47], a[204:207], a[20:23], v[44:47]
v_mfma_f32_16x16x32_bf16 v[52:55], a[192:195], a[44:47], 0
v_mfma_f32_16x16x32_bf16 v[52:55], a[196:199], a[40:43], v[52:55]
v_mfma_f32_16x16x32_bf16 v[52:55], a[200:203], a[12:15], v[52:55]
v_mfma_f32_16x16x32_bf16 v[52:55], a[204:207], a[4:7], v[52:55]
v_mfma_f32_16x16x32_bf16 v[64:67], a[208:211], a[32:35], 0
v_mfma_f32_16x16x32_bf16 v[64:67], a[212:215], a[36:39], v[64:67]
v_mfma_f32_16x16x32_bf16 v[64:67], a[216:219], a[28:31], v[64:67]
v_mfma_f32_16x16x32_bf16 v[64:67], a[220:223], a[20:23], v[64:67]
v_mfma_f32_16x16x32_bf16 v[212:215], a[208:211], a[44:47], 0
v_mfma_f32_16x16x32_bf16 v[212:215], a[212:215], a[40:43], v[212:215]
v_mfma_f32_16x16x32_bf16 v[212:215], a[216:219], a[12:15], v[212:215]
v_mfma_f32_16x16x32_bf16 v[212:215], a[220:223], a[4:7], v[212:215]
s_nop 7
s_cmp_lg_u32 s53, s66
s_cbranch_scc1 SLOW0_U
v_cndmask_b32 v44, v44, v6, s[56:57]
v_cndmask_b32 v212, v212, v6, s[56:57]
v_mov_b32 v64, v6
v_cndmask_b32 v45, v45, v6, s[58:59]
v_cndmask_b32 v213, v213, v6, s[58:59]
v_mov_b32 v65, v6
v_cndmask_b32 v46, v46, v6, s[60:61]
v_cndmask_b32 v214, v214, v6, s[60:61]
v_mov_b32 v66, v6
v_cndmask_b32 v47, v47, v6, s[62:63]
v_cndmask_b32 v215, v215, v6, s[62:63]
v_mov_b32 v67, v6
SLOW0_U:
s_cmp_lg_u32 s54, 0
s_cbranch_scc1 SLOW0_A
v_max3_f32 v16, v16, v44, v45
v_max3_f32 v16, v16, v46, v47
v_max3_f32 v18, v18, v52, v53
v_max3_f32 v18, v18, v54, v55
v_max3_f32 v16, v16, v64, v65
v_max3_f32 v16, v16, v66, v67
v_max3_f32 v18, v18, v212, v213
v_max3_f32 v18, v18, v214, v215
s_branch SLOW0_N
SLOW0_A:
v_sub_f32 v44, v44, v16
v_sub_f32 v45, v45, v16
v_sub_f32 v46, v46, v16
v_sub_f32 v47, v47, v16
v_sub_f32 v52, v52, v18
v_sub_f32 v53, v53, v18
v_sub_f32 v54, v54, v18
v_sub_f32 v55, v55, v18
v_sub_f32 v64, v64, v16
v_sub_f32 v65, v65, v16
v_sub_f32 v66, v66, v16
v_sub_f32 v67, v67, v16
v_sub_f32 v212, v212, v18
v_sub_f32 v213, v213, v18
v_sub_f32 v214, v214, v18
v_sub_f32 v215, v215, v18
v_exp_f32 v44, v44
v_exp_f32 v45, v45
v_exp_f32 v46, v46
v_exp_f32 v47, v47
v_exp_f32 v52, v52
v_exp_f32 v53, v53
v_exp_f32 v54, v54
v_exp_f32 v55, v55
v_exp_f32 v64, v64
v_exp_f32 v65, v65
v_exp_f32 v66, v66
v_exp_f32 v67, v67
v_exp_f32 v212, v212
v_exp_f32 v213, v213
v_exp_f32 v214, v214
v_exp_f32 v215, v215
s_nop 0
v_cvt_pk_bf16_f32 v124, v44, v45
v_cvt_pk_bf16_f32 v125, v46, v47
v_cvt_pk_bf16_f32 v140, v52, v53
v_cvt_pk_bf16_f32 v141, v54, v55
v_cvt_pk_bf16_f32 v126, v64, v65
v_cvt_pk_bf16_f32 v127, v66, v67
v_cvt_pk_bf16_f32 v142, v212, v213
v_cvt_pk_bf16_f32 v143, v214, v215
s_nop 1
v_mfma_f32_16x16x32_bf16 v[36:39], a[64:67], v[124:127], v[36:39]
v_mfma_f32_16x16x32_bf16 v[116:119], a[64:67], v[140:143], v[116:119]
v_mfma_f32_16x16x32_bf16 v[132:135], a[68:71], v[140:143], v[132:135]
v_mfma_f32_16x16x32_bf16 v[32:35], a[68:71], v[124:127], v[32:35]
v_mfma_f32_16x16x32_bf16 v[196:199], a[72:75], v[124:127], v[196:199]
v_mfma_f32_16x16x32_bf16 v[184:187], a[72:75], v[140:143], v[184:187]
v_mfma_f32_16x16x32_bf16 v[240:243], a[76:79], v[140:143], v[240:243]
v_mfma_f32_16x16x32_bf16 v[204:207], a[76:79], v[124:127], v[204:207]
v_mfma_f32_16x16x32_bf16 v[108:111], a[80:83], v[124:127], v[108:111]
v_mfma_f32_16x16x32_bf16 v[188:191], a[80:83], v[140:143], v[188:191]
v_mfma_f32_16x16x32_bf16 v[56:59], a[84:87], v[140:143], v[56:59]
v_mfma_f32_16x16x32_bf16 v[40:43], a[84:87], v[124:127], v[40:43]
v_mfma_f32_16x16x32_bf16 v[80:83], a[88:91], v[124:127], v[80:83]
v_mfma_f32_16x16x32_bf16 v[88:91], a[88:91], v[140:143], v[88:91]
v_mfma_f32_16x16x32_bf16 v[192:195], a[92:95], v[140:143], v[192:195]
v_mfma_f32_16x16x32_bf16 v[168:171], a[92:95], v[124:127], v[168:171]
v_mfma_f32_16x16x32_bf16 a[224:227], a[240:243], v[124:127], a[224:227]
v_mfma_f32_16x16x32_bf16 a[228:231], a[240:243], v[140:143], a[228:231]
SLOW0_N:
s_add_u32 s52, s52, 16384
s_add_u32 s53, s53, 1
s_cmp_le_u32 s53, s66
s_cbranch_scc1 SLOW0_T
s_cmp_lg_u32 s54, 0
s_cbranch_scc1 SLOW0_E
v_mov_b32 v17, v16
v_mov_b32 v19, v18
s_nop 1
v_permlane32_swap_b32 v17, v16
v_permlane32_swap_b32 v19, v18
s_nop 1
v_max_f32 v16, v16, v17
v_max_f32 v18, v18, v19
v_mov_b32 v17, v16
v_mov_b32 v19, v18
s_nop 1
v_permlane16_swap_b32 v17, v16
v_permlane16_swap_b32 v19, v18
s_nop 1
v_max_f32 v16, v16, v17
v_max_f32 v18, v18, v19
v_mov_b32 v36, 0
v_mov_b32 v37, 0
v_mov_b32 v38, 0
v_mov_b32 v39, 0
v_mov_b32 v32, 0
v_mov_b32 v33, 0
v_mov_b32 v34, 0
v_mov_b32 v35, 0
v_mov_b32 v196, 0
v_mov_b32 v197, 0
v_mov_b32 v198, 0
v_mov_b32 v199, 0
v_mov_b32 v204, 0
v_mov_b32 v205, 0
v_mov_b32 v206, 0
v_mov_b32 v207, 0
v_mov_b32 v108, 0
v_mov_b32 v109, 0
v_mov_b32 v110, 0
v_mov_b32 v111, 0
v_mov_b32 v40, 0
v_mov_b32 v41, 0
v_mov_b32 v42, 0
v_mov_b32 v43, 0
v_mov_b32 v80, 0
v_mov_b32 v81, 0
v_mov_b32 v82, 0
v_mov_b32 v83, 0
v_mov_b32 v168, 0
v_mov_b32 v169, 0
v_mov_b32 v170, 0
v_mov_b32 v171, 0
v_mov_b32 v116, 0
v_mov_b32 v117, 0
v_mov_b32 v118, 0
v_mov_b32 v119, 0
v_mov_b32 v132, 0
v_mov_b32 v133, 0
v_mov_b32 v134, 0
v_mov_b32 v135, 0
v_mov_b32 v184, 0
v_mov_b32 v185, 0
v_mov_b32 v186, 0
v_mov_b32 v187, 0
v_mov_b32 v240, 0
v_mov_b32 v241, 0
v_mov_b32 v242, 0
v_mov_b32 v243, 0
v_mov_b32 v188, 0
v_mov_b32 v189, 0
v_mov_b32 v190, 0
v_mov_b32 v191, 0
v_mov_b32 v56, 0
v_mov_b32 v57, 0
v_mov_b32 v58, 0
v_mov_b32 v59, 0
v_mov_b32 v88, 0
v_mov_b32 v89, 0
v_mov_b32 v90, 0
v_mov_b32 v91, 0
v_mov_b32 v192, 0
v_mov_b32 v193, 0
v_mov_b32 v194, 0
v_mov_b32 v195, 0
v_accvgpr_write_b32 a224, 0
v_accvgpr_write_b32 a225, 0
v_accvgpr_write_b32 a226, 0
v_accvgpr_write_b32 a227, 0
v_accvgpr_write_b32 a228, 0
v_accvgpr_write_b32 a229, 0
v_accvgpr_write_b32 a230, 0
v_accvgpr_write_b32 a231, 0
s_mov_b32 s54, 1
s_branch SLOW0_P
SLOW0_E:
s_nop 7
v_accvgpr_read_b32 v180, a224
v_accvgpr_read_b32 v182, a228
s_branch SLOW0_R
SLOW1:
v_add_u32 v20, 4096, v4
s_mov_b32 s54, 0
v_mov_b32 v16, v6
v_mov_b32 v18, v6
SLOW1_P:
s_mov_b32 s53, 0
s_mov_b32 s52, s94
SLOW1_T:
s_add_u32 s55, s52, 24576
buffer_load_dwordx4 a[192:195], v4, s[24:27], s52 offen offset:0 sc1
buffer_load_dwordx4 a[196:199], v4, s[24:27], s52 offen offset:1024 sc1
buffer_load_dwordx4 a[200:203], v4, s[24:27], s52 offen offset:2048 sc1
buffer_load_dwordx4 a[204:207], v4, s[24:27], s52 offen offset:3072 sc1
buffer_load_dwordx4 a[208:211], v20, s[24:27], s52 offen offset:0 sc1
buffer_load_dwordx4 a[212:215], v20, s[24:27], s52 offen offset:1024 sc1
buffer_load_dwordx4 a[216:219], v20, s[24:27], s52 offen offset:2048 sc1
buffer_load_dwordx4 a[220:223], v20, s[24:27], s52 offen offset:3072 sc1
buffer_load_dwordx4 a[64:67], v4, s[24:27], s55 offen offset:0 sc1
buffer_load_dwordx4 a[68:71], v4, s[24:27], s55 offen offset:1024 sc1
buffer_load_dwordx4 a[72:75], v4, s[24:27], s55 offen offset:2048 sc1
buffer_load_dwordx4 a[76:79], v4, s[24:27], s55 offen offset:3072 sc1
buffer_load_dwordx4 a[80:83], v20, s[24:27], s55 offen offset:0 sc1
buffer_load_dwordx4 a[84:87], v20, s[24:27], s55 offen offset:1024 sc1
buffer_load_dwordx4 a[88:91], v20, s[24:27], s55 offen offset:2048 sc1
buffer_load_dwordx4 a[92:95], v20, s[24:27], s55 offen offset:3072 sc1
s_waitcnt vmcnt(0)
v_mfma_f32_16x16x32_bf16 v[44:47], a[192:195], a[48:51], 0
v_mfma_f32_16x16x32_bf16 v[44:47], a[196:199], a[52:55], v[44:47]
v_mfma_f32_16x16x32_bf16 v[44:47], a[200:203], a[0:3], v[44:47]
v_mfma_f32_16x16x32_bf16 v[44:47], a[204:207], a[8:11], v[44:47]
v_mfma_f32_16x16x32_bf16 v[52:55], a[192:195], a[60:63], 0
v_mfma_f32_16x16x32_bf16 v[52:55], a[196:199], a[56:59], v[52:55]
v_mfma_f32_16x16x32_bf16 v[52:55], a[200:203], a[16:19], v[52:55]
v_mfma_f32_16x16x32_bf16 v[52:55], a[204:207], a[24:27], v[52:55]
v_mfma_f32_16x16x32_bf16 v[64:67], a[208:211], a[48:51], 0
v_mfma_f32_16x16x32_bf16 v[64:67], a[212:215], a[52:55], v[64:67]
v_mfma_f32_16x16x32_bf16 v[64:67], a[216:219], a[0:3], v[64:67]
v_mfma_f32_16x16x32_bf16 v[64:67], a[220:223], a[8:11], v[64:67]
v_mfma_f32_16x16x32_bf16 v[212:215], a[208:211], a[60:63], 0
v_mfma_f32_16x16x32_bf16 v[212:215], a[212:215], a[56:59], v[212:215]
v_mfma_f32_16x16x32_bf16 v[212:215], a[216:219], a[16:19], v[212:215]
v_mfma_f32_16x16x32_bf16 v[212:215], a[220:223], a[24:27], v[212:215]
s_nop 7
s_cmp_lg_u32 s53, s67
s_cbranch_scc1 SLOW1_U
v_cndmask_b32 v44, v44, v6, s[56:57]
v_cndmask_b32 v212, v212, v6, s[56:57]
v_mov_b32 v64, v6
v_cndmask_b32 v45, v45, v6, s[58:59]
v_cndmask_b32 v213, v213, v6, s[58:59]
v_mov_b32 v65, v6
v_cndmask_b32 v46, v46, v6, s[60:61]
v_cndmask_b32 v214, v214, v6, s[60:61]
v_mov_b32 v66, v6
v_cndmask_b32 v47, v47, v6, s[62:63]
v_cndmask_b32 v215, v215, v6, s[62:63]
v_mov_b32 v67, v6
SLOW1_U:
s_cmp_lg_u32 s54, 0
s_cbranch_scc1 SLOW1_A
v_max3_f32 v16, v16, v44, v45
v_max3_f32 v16, v16, v46, v47
v_max3_f32 v18, v18, v52, v53
v_max3_f32 v18, v18, v54, v55
v_max3_f32 v16, v16, v64, v65
v_max3_f32 v16, v16, v66, v67
v_max3_f32 v18, v18, v212, v213
v_max3_f32 v18, v18, v214, v215
s_branch SLOW1_N
SLOW1_A:
v_sub_f32 v44, v44, v16
v_sub_f32 v45, v45, v16
v_sub_f32 v46, v46, v16
v_sub_f32 v47, v47, v16
v_sub_f32 v52, v52, v18
v_sub_f32 v53, v53, v18
v_sub_f32 v54, v54, v18
v_sub_f32 v55, v55, v18
v_sub_f32 v64, v64, v16
v_sub_f32 v65, v65, v16
v_sub_f32 v66, v66, v16
v_sub_f32 v67, v67, v16
v_sub_f32 v212, v212, v18
v_sub_f32 v213, v213, v18
v_sub_f32 v214, v214, v18
v_sub_f32 v215, v215, v18
v_exp_f32 v44, v44
v_exp_f32 v45, v45
v_exp_f32 v46, v46
v_exp_f32 v47, v47
v_exp_f32 v52, v52
v_exp_f32 v53, v53
v_exp_f32 v54, v54
v_exp_f32 v55, v55
v_exp_f32 v64, v64
v_exp_f32 v65, v65
v_exp_f32 v66, v66
v_exp_f32 v67, v67
v_exp_f32 v212, v212
v_exp_f32 v213, v213
v_exp_f32 v214, v214
v_exp_f32 v215, v215
s_nop 0
v_cvt_pk_bf16_f32 v124, v44, v45
v_cvt_pk_bf16_f32 v125, v46, v47
v_cvt_pk_bf16_f32 v140, v52, v53
v_cvt_pk_bf16_f32 v141, v54, v55
v_cvt_pk_bf16_f32 v126, v64, v65
v_cvt_pk_bf16_f32 v127, v66, v67
v_cvt_pk_bf16_f32 v142, v212, v213
v_cvt_pk_bf16_f32 v143, v214, v215
s_nop 1
v_mfma_f32_16x16x32_bf16 v[60:63], a[64:67], v[124:127], v[60:63]
v_mfma_f32_16x16x32_bf16 v[148:151], a[64:67], v[140:143], v[148:151]
v_mfma_f32_16x16x32_bf16 v[48:51], a[68:71], v[140:143], v[48:51]
v_mfma_f32_16x16x32_bf16 v[68:71], a[68:71], v[124:127], v[68:71]
v_mfma_f32_16x16x32_bf16 v[72:75], a[72:75], v[124:127], v[72:75]
v_mfma_f32_16x16x32_bf16 v[236:239], a[72:75], v[140:143], v[236:239]
v_mfma_f32_16x16x32_bf16 v[224:227], a[76:79], v[140:143], v[224:227]
v_mfma_f32_16x16x32_bf16 v[220:223], a[76:79], v[124:127], v[220:223]
v_mfma_f32_16x16x32_bf16 v[84:87], a[80:83], v[124:127], v[84:87]
v_mfma_f32_16x16x32_bf16 v[164:167], a[80:83], v[140:143], v[164:167]
v_mfma_f32_16x16x32_bf16 v[156:159], a[84:87], v[140:143], v[156:159]
v_mfma_f32_16x16x32_bf16 v[76:79], a[84:87], v[124:127], v[76:79]
v_mfma_f32_16x16x32_bf16 v[160:163], a[88:91], v[124:127], v[160:163]
v_mfma_f32_16x16x32_bf16 v[216:219], a[88:91], v[140:143], v[216:219]
v_mfma_f32_16x16x32_bf16 v[208:211], a[92:95], v[140:143], v[208:211]
v_mfma_f32_16x16x32_bf16 v[252:255], a[92:95], v[124:127], v[252:255]
v_mfma_f32_16x16x32_bf16 a[232:235], a[240:243], v[124:127], a[232:235]
v_mfma_f32_16x16x32_bf16 a[236:239], a[240:243], v[140:143], a[236:239]
SLOW1_N:
s_add_u32 s52, s52, 16384
s_add_u32 s53, s53, 1
s_cmp_le_u32 s53, s67
s_cbranch_scc1 SLOW1_T
s_cmp_lg_u32 s54, 0
s_cbranch_scc1 SLOW1_E
v_mov_b32 v17, v16
v_mov_b32 v19, v18
s_nop 1
v_permlane32_swap_b32 v17, v16
v_permlane32_swap_b32 v19, v18
s_nop 1
v_max_f32 v16, v16, v17
v_max_f32 v18, v18, v19
v_mov_b32 v17, v16
v_mov_b32 v19, v18
s_nop 1
v_permlane16_swap_b32 v17, v16
v_permlane16_swap_b32 v19, v18
s_nop 1
v_max_f32 v16, v16, v17
v_max_f32 v18, v18, v19
v_mov_b32 v60, 0
v_mov_b32 v61, 0
v_mov_b32 v62, 0
v_mov_b32 v63, 0
v_mov_b32 v68, 0
v_mov_b32 v69, 0
v_mov_b32 v70, 0
v_mov_b32 v71, 0
v_mov_b32 v72, 0
v_mov_b32 v73, 0
v_mov_b32 v74, 0
v_mov_b32 v75, 0
v_mov_b32 v220, 0
v_mov_b32 v221, 0
v_mov_b32 v222, 0
v_mov_b32 v223, 0
v_mov_b32 v84, 0
v_mov_b32 v85, 0
v_mov_b32 v86, 0
v_mov_b32 v87, 0
v_mov_b32 v76, 0
v_mov_b32 v77, 0
v_mov_b32 v78, 0
v_mov_b32 v79, 0
v_mov_b32 v160, 0
v_mov_b32 v161, 0
v_mov_b32 v162, 0
v_mov_b32 v163, 0
v_mov_b32 v252, 0
v_mov_b32 v253, 0
v_mov_b32 v254, 0
v_mov_b32 v255, 0
v_mov_b32 v148, 0
v_mov_b32 v149, 0
v_mov_b32 v150, 0
v_mov_b32 v151, 0
v_mov_b32 v48, 0
v_mov_b32 v49, 0
v_mov_b32 v50, 0
v_mov_b32 v51, 0
v_mov_b32 v236, 0
v_mov_b32 v237, 0
v_mov_b32 v238, 0
v_mov_b32 v239, 0
v_mov_b32 v224, 0
v_mov_b32 v225, 0
v_mov_b32 v226, 0
v_mov_b32 v227, 0
v_mov_b32 v164, 0
v_mov_b32 v165, 0
v_mov_b32 v166, 0
v_mov_b32 v167, 0
v_mov_b32 v156, 0
v_mov_b32 v157, 0
v_mov_b32 v158, 0
v_mov_b32 v159, 0
v_mov_b32 v216, 0
v_mov_b32 v217, 0
v_mov_b32 v218, 0
v_mov_b32 v219, 0
v_mov_b32 v208, 0
v_mov_b32 v209, 0
v_mov_b32 v210, 0
v_mov_b32 v211, 0
v_accvgpr_write_b32 a232, 0
v_accvgpr_write_b32 a233, 0
v_accvgpr_write_b32 a234, 0
v_accvgpr_write_b32 a235, 0
v_accvgpr_write_b32 a236, 0
v_accvgpr_write_b32 a237, 0
v_accvgpr_write_b32 a238, 0
v_accvgpr_write_b32 a239, 0
s_mov_b32 s54, 1
s_branch SLOW1_P
SLOW1_E:
s_nop 7
v_accvgpr_read_b32 v180, a232
v_accvgpr_read_b32 v182, a236
s_add_u32 s52, s79, 4096
v_fma_f32 v180, v180, v10, v180
v_fma_f32 v182, v182, v11, v182
v_rcp_f32 v180, v180
v_rcp_f32 v182, v182
s_nop 0
v_pk_mul_f32 v[60:61], v[60:61], v[180:181] op_sel_hi:[1,0]
v_pk_mul_f32 v[62:63], v[62:63], v[180:181] op_sel_hi:[1,0]
v_pk_mul_f32 v[68:69], v[68:69], v[180:181] op_sel_hi:[1,0]
v_pk_mul_f32 v[70:71], v[70:71], v[180:181] op_sel_hi:[1,0]
v_cvt_pk_bf16_f32 v60, v60, v61
v_cvt_pk_bf16_f32 v61, v62, v63
v_cvt_pk_bf16_f32 v62, v68, v69
v_cvt_pk_bf16_f32 v63, v70, v71
s_branch L_EP
.section .rodata,"a"
.p2align 6
.amdhsa_kernel gated_mix__sliding_local_dilated__compressed_kv_cla__prompt_kernel
  .amdhsa_next_free_vgpr 512
  .amdhsa_next_free_sgpr 102
  .amdhsa_accum_offset 256
  .amdhsa_group_segment_fixed_size 0
  .amdhsa_kernarg_size 104
  .amdhsa_user_sgpr_count 2
  .amdhsa_user_sgpr_kernarg_segment_ptr 1
  .amdhsa_system_sgpr_workgroup_id_x 1
.end_amdhsa_kernel
```

```asm
; @launch grid=(256,1,1) block=(256,1,1) lds=163840
.amdgcn_target "amdgcn-amd-amdhsa--gfx950"
.text

.globl gated_mix__sliding_local_dilated__compressed_kv_cla__prompt_kernel
.p2align 8
.type gated_mix__sliding_local_dilated__compressed_kv_cla__prompt_kernel,@function
gated_mix__sliding_local_dilated__compressed_kv_cla__prompt_kernel:
s_cmp_ge_u32 s2, 256
s_cbranch_scc1 L_END
s_load_dwordx2 s[8:9], s[0:1], 32
s_load_dwordx2 s[56:57], s[0:1], 56
s_load_dwordx2 s[16:17], s[0:1], 48
s_load_dwordx2 s[24:25], s[0:1], 96
s_load_dwordx2 s[12:13], s[0:1], 0
s_load_dwordx2 s[20:21], s[0:1], 40
s_load_dwordx2 s[28:29], s[0:1], 8
s_load_dwordx2 s[48:49], s[0:1], 16
s_load_dwordx2 s[32:33], s[0:1], 64
s_load_dwordx2 s[36:37], s[0:1], 72
s_load_dwordx2 s[40:41], s[0:1], 88
s_load_dwordx2 s[44:45], s[0:1], 80
s_getpc_b64 s[96:97]
L_PC:
s_lshr_b32 s6, s2, 3
s_lshl_b32 s98, s6, 11
s_add_u32 s98, s98, L_MAIN-L_PC
s_add_u32 s96, s96, s98
s_addc_u32 s97, s97, 0
v_lshlrev_b32 v16, 3, v0
v_mov_b32 v17, s97
v_add_co_u32 v16, vcc, s96, v16
v_lshrrev_b32 v5, 6, v0
v_and_b32 v1, 63, v0
v_addc_co_u32 v17, vcc, 0, v17, vcc
v_readfirstlane_b32 s3, v5
global_load_dwordx2 a[252:253], v[16:17], off
v_and_b32 v2, 15, v0
v_lshrrev_b32 v3, 4, v1
v_lshlrev_b32 v4, 4, v1
s_and_b32 s7, s2, 7
s_and_b32 s65, s6, 3
s_lshl2_add_u32 s4, s7, s65
s_lshr_b32 s5, s6, 2
s_lshl2_add_u32 s66, s5, s3
s_sub_u32 s67, 63, s66
v_lshrrev_b32 v16, 3, v1
v_and_b32 v17, 7, v1
v_xor_b32 v18, v17, v3
v_lshlrev_b32 v19, 10, v16
v_lshl_add_u32 v5, v18, 4, v19
v_xor_b32 v18, 4, v18
v_lshl_add_u32 v6, v18, 4, v19
v_add_u32 v6, 7168, v6
v_and_b32 v18, 1, v3
v_lshlrev_b32 v18, 1, v18
v_xor_b32 v18, v17, v18
v_lshlrev_b32 v19, 13, v16
v_lshl_add_u32 v7, v18, 4, v19
v_xor_b32 v18, 4, v18
v_lshl_add_u32 v8, v18, 4, v19
v_add_u32 v8, 64512, v8
s_add_u32 s69, s65, s5
s_and_b32 s69, s69, 1
s_mul_i32 s64, s7, 2
s_and_b32 s64, s64, 7
s_or_b32 s69, s69, s64
s_add_u32 s93, s65, s5
s_and_b32 s93, s93, 0
s_mul_i32 s64, s7, 1
s_and_b32 s64, s64, 7
s_or_b32 s93, s93, s64
s_lshl_b32 s70, s69, 7
s_lshl_b32 s75, s69, 19
s_lshr_b32 s54, s3, 1
s_and_b32 s55, s3, 1
s_lshl3_add_u32 s87, s54, s5
s_lshl_b32 s64, s55, 5
s_add_u32 s68, s87, s64
s_lshl_b32 s68, s68, 15
s_lshl_b32 s73, s3, 13
s_add_u32 s73, s73, 65536
s_lshl1_add_u32 s74, s4, s55
s_lshl_b32 s74, s74, 7
s_lshl_b32 s64, s54, 18
s_add_u32 s74, s74, s64
s_lshl_b32 s77, s3, 12
s_add_u32 s71, s68, s70
s_add_u32 s76, s74, s75
s_mov_b32 s10, 2097152
s_mov_b32 s11, 0x20000
s_mov_b32 s58, 4194304
s_mov_b32 s59, 0x20000
s_waitcnt lgkmcnt(0)
s_add_u32 m0, s73, 0
s_add_u32 s64, s71, 0
buffer_load_dwordx4 v5, s[8:11], s64 offen lds
buffer_load_dwordx4 v6, s[8:11], s64 offen offset:1024 lds
s_add_u32 m0, s73, 2048
s_add_u32 s64, s71, 16384
buffer_load_dwordx4 v5, s[8:11], s64 offen lds
buffer_load_dwordx4 v6, s[8:11], s64 offen offset:1024 lds
s_add_u32 m0, s77, 0
s_add_u32 s64, s76, 0
buffer_load_dwordx4 v7, s[56:59], s64 offen lds
buffer_load_dwordx4 v8, s[56:59], s64 offen offset:1024 lds
s_add_u32 m0, s77, 2048
s_add_u32 s64, s76, 131072
buffer_load_dwordx4 v7, s[56:59], s64 offen lds
buffer_load_dwordx4 v8, s[56:59], s64 offen offset:1024 lds
s_add_u32 m0, s73, 4096
s_add_u32 s64, s71, 524288
buffer_load_dwordx4 v5, s[8:11], s64 offen lds
buffer_load_dwordx4 v6, s[8:11], s64 offen offset:1024 lds
s_add_u32 m0, s73, 6144
s_add_u32 s64, s71, 540672
buffer_load_dwordx4 v5, s[8:11], s64 offen lds
buffer_load_dwordx4 v6, s[8:11], s64 offen offset:1024 lds
s_mov_b32 s18, 4194304
s_mov_b32 s19, 0x20000
s_lshl_b32 s65, s54, 7
s_lshl_b32 s53, s55, 12
v_lshrrev_b32 v16, 1, v2
v_xor_b32 v16, v16, v3
v_add_u32 v17, s65, v2
v_lshlrev_b32 v17, 7, v17
v_add_u32 v17, 65536, v17
v_lshl_add_u32 v9, v16, 4, v17
v_xor_b32 v10, 64, v9
v_bfe_u32 v16, v1, 2, 2
v_lshl_add_u32 v17, v3, 3, v16
v_lshlrev_b32 v17, 7, v17
v_and_b32 v18, 3, v1
v_lshl_add_u32 v17, v18, 3, v17
v_add_u32 v17, s53, v17
v_lshrrev_b32 v16, 1, v16
v_and_b32 v18, 1, v3
v_lshl_add_u32 v16, v18, 1, v16
v_xor_b32 v18, 0, v16
v_lshl_add_u32 v11, v18, 5, v17
v_xor_b32 v18, 1, v16
v_lshl_add_u32 v12, v18, 5, v17
v_xor_b32 v18, 2, v16
v_lshl_add_u32 v13, v18, 5, v17
v_xor_b32 v18, 3, v16
v_lshl_add_u32 v14, v18, 5, v17
s_add_u32 m0, s77, 16384
s_add_u32 s64, s76, 0
buffer_load_dwordx4 v7, s[16:19], s64 offen lds
buffer_load_dwordx4 v8, s[16:19], s64 offen offset:1024 lds
s_add_u32 m0, s77, 18432
s_add_u32 s64, s76, 131072
buffer_load_dwordx4 v7, s[16:19], s64 offen lds
buffer_load_dwordx4 v8, s[16:19], s64 offen offset:1024 lds
s_mov_b64 exec, 0
s_cmp_eq_u32 s3, 0
s_cbranch_scc1 L_PAD0
s_cmp_eq_u32 s3, 1
s_cbranch_scc1 L_PAD1
s_cmp_eq_u32 s3, 2
s_cbranch_scc1 L_PAD2
s_branch L_PAD3
.p2align 12
.fill 576, 4, 0xbf800000
L_MAIN:
s_mov_b64 exec, -1
s_xor_b32 s71, s70, 128
s_add_u32 s71, s68, s71
s_add_u32 m0, s73, 32768
s_add_u32 s64, s71, 0
buffer_load_dwordx4 v5, s[8:11], s64 offen lds
buffer_load_dwordx4 v6, s[8:11], s64 offen offset:1024 lds
s_add_u32 m0, s73, 34816
s_add_u32 s64, s71, 16384
buffer_load_dwordx4 v5, s[8:11], s64 offen lds
buffer_load_dwordx4 v6, s[8:11], s64 offen offset:1024 lds
s_add_u32 m0, s73, 36864
s_add_u32 s64, s71, 524288
buffer_load_dwordx4 v5, s[8:11], s64 offen lds
buffer_load_dwordx4 v6, s[8:11], s64 offen offset:1024 lds
s_add_u32 m0, s73, 38912
s_add_u32 s64, s71, 540672
buffer_load_dwordx4 v5, s[8:11], s64 offen lds
buffer_load_dwordx4 v6, s[8:11], s64 offen offset:1024 lds
s_waitcnt vmcnt(12)
s_barrier
ds_read_b128 a[64:67], v9 offset:0
ds_read_b128 a[68:71], v10 offset:0
ds_read_b64_tr_b16 a[128:129], v11 offset:0
ds_read_b64_tr_b16 a[130:131], v11 offset:512
ds_read_b64_tr_b16 a[132:133], v11 offset:8192
ds_read_b64_tr_b16 a[134:135], v11 offset:8704
ds_read_b64_tr_b16 a[136:137], v12 offset:0
ds_read_b64_tr_b16 a[138:139], v12 offset:512
ds_read_b64_tr_b16 a[140:141], v12 offset:8192
ds_read_b64_tr_b16 a[142:143], v12 offset:8704
ds_read_b64_tr_b16 a[144:145], v13 offset:0
ds_read_b64_tr_b16 a[146:147], v13 offset:512
ds_read_b64_tr_b16 a[148:149], v13 offset:8192
ds_read_b64_tr_b16 a[150:151], v13 offset:8704
ds_read_b64_tr_b16 a[152:153], v14 offset:0
ds_read_b64_tr_b16 a[154:155], v14 offset:512
ds_read_b64_tr_b16 a[156:157], v14 offset:8192
ds_read_b64_tr_b16 a[158:159], v14 offset:8704
ds_read_b128 a[72:75], v9 offset:2048
ds_read_b128 a[76:79], v10 offset:2048
ds_read_b128 a[80:83], v9 offset:4096
ds_read_b128 a[84:87], v10 offset:4096
ds_read_b128 a[88:91], v9 offset:6144
ds_read_b128 a[92:95], v10 offset:6144
s_waitcnt lgkmcnt(0)
v_mfma_f32_16x16x32_bf16 v[32:35], a[64:67], a[128:131], 0
s_waitcnt vmcnt(8)
v_mfma_f32_16x16x32_bf16 v[32:35], a[68:71], a[132:135], v[32:35]
s_barrier
v_mfma_f32_16x16x32_bf16 v[40:43], a[68:71], a[140:143], 0
s_mov_b32 s26, 268435456
s_mov_b32 s27, 0x20000
ds_read_b128 a[96:99], v9 offset:8192
v_mfma_f32_16x16x32_bf16 v[40:43], a[64:67], a[136:139], v[40:43]
s_xor_b32 s76, s75, 524288
s_add_u32 s76, s74, s76
s_mov_b32 s14, 2359296
v_mfma_f32_16x16x32_bf16 v[48:51], a[64:67], a[144:147], 0
s_add_u32 m0, s77, 32768
s_add_u32 s64, s76, 0
s_mov_b32 s15, 0x20000
v_mfma_f32_16x16x32_bf16 v[48:51], a[68:71], a[148:151], v[48:51]
buffer_load_dwordx4 v7, s[56:59], s64 offen lds
v_mfma_f32_16x16x32_bf16 v[56:59], a[68:71], a[156:159], 0
s_mov_b32 s22, 4718592
s_mov_b32 s23, 0x20000
ds_read_b128 a[100:103], v10 offset:8192
v_mfma_f32_16x16x32_bf16 v[56:59], a[64:67], a[152:155], v[56:59]
buffer_load_dwordx4 v8, s[56:59], s64 offen offset:1024 lds
v_mfma_f32_16x16x32_bf16 v[60:63], a[72:75], a[152:155], 0
s_add_u32 m0, s77, 34816
s_add_u32 s64, s76, 131072
ds_read_b128 a[104:107], v9 offset:10240
v_mfma_f32_16x16x32_bf16 v[60:63], a[76:79], a[156:159], v[60:63]
s_mov_b32 s30, 1990656
s_mov_b32 s31, 0x20000
s_mov_b32 s34, 4718592
v_mfma_f32_16x16x32_bf16 v[52:55], a[76:79], a[148:151], 0
buffer_load_dwordx4 v7, s[56:59], s64 offen lds
v_mfma_f32_16x16x32_bf16 v[52:55], a[72:75], a[144:147], v[52:55]
s_mov_b32 s35, 0x20000
ds_read_b64_tr_b16 a[160:161], v11 offset:16384
ds_read_b64_tr_b16 a[162:163], v11 offset:16896
v_mfma_f32_16x16x32_bf16 v[44:47], a[72:75], a[136:139], 0
s_mov_b32 s38, 1152
s_mov_b32 s39, 0x20000
s_mov_b32 s42, 256
v_mfma_f32_16x16x32_bf16 v[44:47], a[76:79], a[140:143], v[44:47]
buffer_load_dwordx4 v8, s[56:59], s64 offen offset:1024 lds
v_mfma_f32_16x16x32_bf16 v[36:39], a[76:79], a[132:135], 0
s_mov_b32 s43, 0x20000
s_mov_b32 s46, 2359296
s_mov_b32 s47, 0x20000
v_mfma_f32_16x16x32_bf16 v[36:39], a[72:75], a[128:131], v[36:39]
s_add_u32 m0, s77, 49152
s_add_u32 s64, s76, 0
ds_read_b128 a[108:111], v10 offset:10240
v_mfma_f32_16x16x32_bf16 v[64:67], a[80:83], a[128:131], 0
s_mov_b32 s50, 663552
s_mov_b32 s51, 0x20000
s_lshl_b32 s89, s4, 10
v_mfma_f32_16x16x32_bf16 v[64:67], a[84:87], a[132:135], v[64:67]
buffer_load_dwordx4 v7, s[16:19], s64 offen lds
v_mfma_f32_16x16x32_bf16 v[72:75], a[84:87], a[140:143], 0
s_add_u32 s89, s89, 75497472
ds_read_b64_tr_b16 a[164:165], v11 offset:24576
ds_read_b64_tr_b16 a[166:167], v11 offset:25088
v_mfma_f32_16x16x32_bf16 v[72:75], a[80:83], a[136:139], v[72:75]
s_mul_i32 s94, s4, 1064960
s_cmp_eq_u32 s66, 0
s_cselect_b32 s52, s89, 2147418112
v_mfma_f32_16x16x32_bf16 v[80:83], a[80:83], a[144:147], 0
buffer_load_dwordx4 v8, s[16:19], s64 offen offset:1024 lds
v_mfma_f32_16x16x32_bf16 v[80:83], a[84:87], a[148:151], v[80:83]
s_add_u32 m0, s77, 51200
s_add_u32 s64, s76, 131072
ds_read_b128 a[112:115], v9 offset:12288
v_mfma_f32_16x16x32_bf16 v[88:91], a[84:87], a[156:159], 0
s_lshl_b32 s53, s5, 10
s_add_u32 s53, s53, s94
s_add_u32 s53, s53, 1048576
v_mfma_f32_16x16x32_bf16 v[88:91], a[80:83], a[152:155], v[88:91]
buffer_load_dwordx4 v7, s[16:19], s64 offen lds
v_mfma_f32_16x16x32_bf16 v[92:95], a[88:91], a[152:155], 0
ds_read_b64_tr_b16 a[168:169], v12 offset:16384
ds_read_b64_tr_b16 a[170:171], v12 offset:16896
v_mfma_f32_16x16x32_bf16 v[92:95], a[92:95], a[156:159], v[92:95]
s_cmp_eq_u32 s3, 1
s_cselect_b32 s52, s53, s52
s_mul_i32 s53, s2, 74
v_mfma_f32_16x16x32_bf16 v[84:87], a[92:95], a[148:151], 0
buffer_load_dwordx4 v8, s[16:19], s64 offen offset:1024 lds
v_mfma_f32_16x16x32_bf16 v[84:87], a[88:91], a[144:147], v[84:87]
s_add_u32 s53, s53, s55
s_lshl_b32 s53, s53, 10
s_add_u32 s53, s53, 54599680
v_mfma_f32_16x16x32_bf16 v[76:79], a[88:91], a[136:139], 0
s_cmp_ge_u32 s3, 2
s_cselect_b32 s52, s53, s52
ds_read_b128 a[116:119], v10 offset:12288
v_mfma_f32_16x16x32_bf16 v[76:79], a[92:95], a[140:143], v[76:79]
v_mov_b32 v16, 0
v_mov_b32 v17, 0
v_mfma_f32_16x16x32_bf16 v[68:71], a[92:95], a[132:135], 0
v_mov_b32 v18, 0
v_mov_b32 v19, 0
v_mfma_f32_16x16x32_bf16 v[68:71], a[88:91], a[128:131], v[68:71]
s_waitcnt lgkmcnt(6)
ds_read_b64_tr_b16 a[172:173], v12 offset:24576
ds_read_b64_tr_b16 a[174:175], v12 offset:25088
v_mfma_f32_16x16x32_bf16 v[96:99], a[96:99], a[128:131], 0
v_lshrrev_b32 v20, 3, v1
v_cmp_eq_u32 vcc, 3, v20
v_mfma_f32_16x16x32_bf16 v[96:99], a[100:103], a[132:135], v[96:99]
v_add_u32 v20, 100663168, v4
v_mov_b32 v21, s3
v_mfma_f32_16x16x32_bf16 v[104:107], a[100:103], a[140:143], 0
ds_read_b128 a[120:123], v9 offset:14336
v_cndmask_b32 v15, v4, v20, vcc
v_mfma_f32_16x16x32_bf16 v[104:107], a[96:99], a[136:139], v[104:107]
v_cmp_eq_u32 vcc, 0, v21
v_mov_b32 v21, 0
v_mfma_f32_16x16x32_bf16 v[112:115], a[96:99], a[144:147], 0
v_mov_b32 v21, 0
v_cndmask_b32 v20, v15, v4, vcc
v_mfma_f32_16x16x32_bf16 v[112:115], a[100:103], a[148:151], v[112:115]
ds_read_b64_tr_b16 a[176:177], v13 offset:16384
ds_read_b64_tr_b16 a[178:179], v13 offset:16896
v_mfma_f32_16x16x32_bf16 v[120:123], a[100:103], a[156:159], 0
v_mfma_f32_16x16x32_bf16 v[120:123], a[96:99], a[152:155], v[120:123]
v_mfma_f32_16x16x32_bf16 v[124:127], a[104:107], a[152:155], 0
v_mfma_f32_16x16x32_bf16 v[124:127], a[108:111], a[156:159], v[124:127]
ds_read_b128 a[124:127], v10 offset:14336
v_mfma_f32_16x16x32_bf16 v[116:119], a[108:111], a[148:151], 0
v_add_u32 v9, 32768, v9
v_add_u32 v10, 32768, v10
v_mfma_f32_16x16x32_bf16 v[116:119], a[104:107], a[144:147], v[116:119]
v_mfma_f32_16x16x32_bf16 v[108:111], a[104:107], a[136:139], 0
ds_read_b64_tr_b16 a[180:181], v13 offset:24576
ds_read_b64_tr_b16 a[182:183], v13 offset:25088
v_mfma_f32_16x16x32_bf16 v[108:111], a[108:111], a[140:143], v[108:111]
v_mfma_f32_16x16x32_bf16 v[100:103], a[108:111], a[132:135], 0
v_mfma_f32_16x16x32_bf16 v[100:103], a[104:107], a[128:131], v[100:103]
s_waitcnt lgkmcnt(2)
ds_read_b64_tr_b16 a[184:185], v14 offset:16384
ds_read_b64_tr_b16 a[186:187], v14 offset:16896
v_mfma_f32_16x16x32_bf16 v[128:131], a[112:115], a[128:131], 0
v_mfma_f32_16x16x32_bf16 v[128:131], a[116:119], a[132:135], v[128:131]
v_mfma_f32_16x16x32_bf16 v[136:139], a[116:119], a[140:143], 0
ds_read_b64_tr_b16 a[188:189], v14 offset:24576
ds_read_b64_tr_b16 a[190:191], v14 offset:25088
v_mfma_f32_16x16x32_bf16 v[136:139], a[112:115], a[136:139], v[136:139]
v_mfma_f32_16x16x32_bf16 v[144:147], a[112:115], a[144:147], 0
v_mfma_f32_16x16x32_bf16 v[144:147], a[116:119], a[148:151], v[144:147]
v_mfma_f32_16x16x32_bf16 v[152:155], a[116:119], a[156:159], 0
v_mfma_f32_16x16x32_bf16 v[152:155], a[112:115], a[152:155], v[152:155]
v_mfma_f32_16x16x32_bf16 v[156:159], a[120:123], a[152:155], 0
v_mfma_f32_16x16x32_bf16 v[156:159], a[124:127], a[156:159], v[156:159]
v_mfma_f32_16x16x32_bf16 v[148:151], a[124:127], a[148:151], 0
v_mfma_f32_16x16x32_bf16 v[148:151], a[120:123], a[144:147], v[148:151]
v_mfma_f32_16x16x32_bf16 v[140:143], a[120:123], a[136:139], 0
v_mfma_f32_16x16x32_bf16 v[140:143], a[124:127], a[140:143], v[140:143]
v_mfma_f32_16x16x32_bf16 v[132:135], a[124:127], a[132:135], 0
v_mfma_f32_16x16x32_bf16 v[132:135], a[120:123], a[128:131], v[132:135]
s_waitcnt lgkmcnt(0)
v_mfma_f32_16x16x32_bf16 v[160:163], a[160:163], a[64:67], 0
s_waitcnt vmcnt(4)
v_mfma_f32_16x16x32_bf16 v[160:163], a[164:167], a[68:71], v[160:163]
s_barrier
v_mfma_f32_16x16x32_bf16 v[164:167], a[172:175], a[68:71], 0
ds_read_b64_tr_b16 a[128:129], v11 offset:32768
ds_read_b64_tr_b16 a[130:131], v11 offset:33280
v_mfma_f32_16x16x32_bf16 v[164:167], a[168:171], a[64:67], v[164:167]
s_xor_b32 s71, s70, 256
s_add_u32 s71, s68, s71
v_mfma_f32_16x16x32_bf16 v[168:171], a[176:179], a[64:67], 0
s_add_u32 m0, s73, 65536
s_add_u32 s64, s71, 0
v_mfma_f32_16x16x32_bf16 v[168:171], a[180:183], a[68:71], v[168:171]
buffer_load_dwordx4 v5, s[8:11], s64 offen lds
v_mfma_f32_16x16x32_bf16 v[172:175], a[188:191], a[68:71], 0
v_mfma_f32_16x16x32_bf16 v[172:175], a[184:187], a[64:67], v[172:175]
ds_read_b128 a[64:67], v9 offset:0
v_mfma_f32_16x16x32_bf16 v[188:191], a[184:187], a[72:75], 0
buffer_load_dwordx4 v6, s[8:11], s64 offen offset:1024 lds
v_mfma_f32_16x16x32_bf16 v[188:191], a[188:191], a[76:79], v[188:191]
ds_read_b64_tr_b16 a[132:133], v11 offset:40960
ds_read_b64_tr_b16 a[134:135], v11 offset:41472
v_mfma_f32_16x16x32_bf16 v[184:187], a[180:183], a[76:79], 0
v_mfma_f32_16x16x32_bf16 v[184:187], a[176:179], a[72:75], v[184:187]
s_add_u32 m0, s73, 67584
s_add_u32 s64, s71, 16384
ds_read_b128 a[68:71], v10 offset:0
v_mfma_f32_16x16x32_bf16 v[180:183], a[168:171], a[72:75], 0
v_mfma_f32_16x16x32_bf16 v[180:183], a[172:175], a[76:79], v[180:183]
buffer_load_dwordx4 v5, s[8:11], s64 offen lds
v_mfma_f32_16x16x32_bf16 v[176:179], a[164:167], a[76:79], 0
v_mfma_f32_16x16x32_bf16 v[176:179], a[160:163], a[72:75], v[176:179]
ds_read_b64_tr_b16 a[136:137], v12 offset:32768
ds_read_b64_tr_b16 a[138:139], v12 offset:33280
v_mfma_f32_16x16x32_bf16 v[192:195], a[160:163], a[80:83], 0
v_mfma_f32_16x16x32_bf16 v[192:195], a[164:167], a[84:87], v[192:195]
v_mfma_f32_16x16x32_bf16 v[196:199], a[172:175], a[84:87], 0
buffer_load_dwordx4 v6, s[8:11], s64 offen offset:1024 lds
v_mfma_f32_16x16x32_bf16 v[196:199], a[168:171], a[80:83], v[196:199]
s_xor_b32 s76, s75, 1048576
s_add_u32 s76, s74, s76
ds_read_b128 a[72:75], v9 offset:2048
v_mfma_f32_16x16x32_bf16 v[200:203], a[176:179], a[80:83], 0
L_PAD0:
s_cbranch_execz L_PAD4
v_mfma_f32_16x16x32_bf16 v[200:203], a[180:183], a[84:87], v[200:203]
s_add_u32 m0, s77, 0
s_add_u32 s64, s76, 0
v_mfma_f32_16x16x32_bf16 v[204:207], a[188:191], a[84:87], 0
ds_read_b64_tr_b16 a[140:141], v12 offset:40960
ds_read_b64_tr_b16 a[142:143], v12 offset:41472
v_mfma_f32_16x16x32_bf16 v[204:207], a[184:187], a[80:83], v[204:207]
buffer_load_dwordx4 v7, s[56:59], s64 offen lds
v_mfma_f32_16x16x32_bf16 v[220:223], a[184:187], a[88:91], 0
ds_read_b128 a[76:79], v10 offset:2048
v_mfma_f32_16x16x32_bf16 v[220:223], a[188:191], a[92:95], v[220:223]
v_mfma_f32_16x16x32_bf16 v[216:219], a[180:183], a[92:95], 0
v_mfma_f32_16x16x32_bf16 v[216:219], a[176:179], a[88:91], v[216:219]
v_mfma_f32_16x16x32_bf16 v[212:215], a[168:171], a[88:91], 0
buffer_load_dwordx4 v8, s[56:59], s64 offen offset:1024 lds
v_mfma_f32_16x16x32_bf16 v[212:215], a[172:175], a[92:95], v[212:215]
ds_read_b64_tr_b16 a[144:145], v13 offset:32768
ds_read_b64_tr_b16 a[146:147], v13 offset:33280
v_mfma_f32_16x16x32_bf16 v[208:211], a[164:167], a[92:95], 0
v_mfma_f32_16x16x32_bf16 v[208:211], a[160:163], a[88:91], v[208:211]
s_add_u32 m0, s77, 2048
s_add_u32 s64, s76, 131072
ds_read_b128 a[80:83], v9 offset:4096
v_mfma_f32_16x16x32_bf16 v[224:227], a[160:163], a[96:99], 0
v_mfma_f32_16x16x32_bf16 v[224:227], a[164:167], a[100:103], v[224:227]
buffer_load_dwordx4 v7, s[56:59], s64 offen lds
v_mfma_f32_16x16x32_bf16 v[228:231], a[172:175], a[100:103], 0
ds_read_b64_tr_b16 a[148:149], v13 offset:40960
ds_read_b64_tr_b16 a[150:151], v13 offset:41472
v_mfma_f32_16x16x32_bf16 v[228:231], a[168:171], a[96:99], v[228:231]
v_mfma_f32_16x16x32_bf16 v[232:235], a[176:179], a[96:99], 0
buffer_store_dwordx4 v[16:19], v20, s[24:27], s52 offen sc1
v_mfma_f32_16x16x32_bf16 v[232:235], a[180:183], a[100:103], v[232:235]
buffer_load_dwordx4 v8, s[56:59], s64 offen offset:1024 lds
v_mfma_f32_16x16x32_bf16 v[236:239], a[188:191], a[100:103], 0
s_add_u32 s89, s89, 512
ds_read_b128 a[84:87], v10 offset:4096
v_mfma_f32_16x16x32_bf16 v[236:239], a[184:187], a[96:99], v[236:239]
s_cmp_eq_u32 s3, 0
s_cselect_b32 s90, s89, 2147418112
v_mov_b32 v24, 2147418112
v_mfma_f32_16x16x32_bf16 v[252:255], a[184:187], a[104:107], 0
s_add_u32 m0, s73, 69632
s_add_u32 s64, s71, 524288
v_cmp_eq_u32 vcc, 1, v1
v_mfma_f32_16x16x32_bf16 v[252:255], a[188:191], a[108:111], v[252:255]
s_lshl_b32 s53, s55, 12
ds_read_b64_tr_b16 a[152:153], v14 offset:32768
ds_read_b64_tr_b16 a[154:155], v14 offset:33280
v_mfma_f32_16x16x32_bf16 v[248:251], a[180:183], a[108:111], 0
buffer_load_dwordx4 v5, s[8:11], s64 offen lds
v_mfma_f32_16x16x32_bf16 v[248:251], a[176:179], a[104:107], v[248:251]
v_cndmask_b32 v0, v24, 0, vcc
v_mfma_f32_16x16x32_bf16 v[244:247], a[168:171], a[104:107], 0
s_mul_i32 s87, s87, 16384
s_add_u32 s87, s87, s94
ds_read_b128 a[88:91], v9 offset:6144
v_mfma_f32_16x16x32_bf16 v[244:247], a[172:175], a[108:111], v[244:247]
s_add_u32 s88, s87, s53
s_add_u32 s88, s88, 24576
s_lshr_b32 s53, s53, 1
v_mfma_f32_16x16x32_bf16 v[240:243], a[164:167], a[108:111], 0
s_add_u32 s87, s87, s53
s_lshl_b32 s80, s3, 10
s_mul_i32 s78, s4, 18
v_mfma_f32_16x16x32_bf16 v[240:243], a[160:163], a[104:107], v[240:243]
buffer_load_dwordx4 v6, s[8:11], s64 offen offset:1024 lds
v_mfma_f32_16x16x32_bf16 a[0:3], a[160:163], a[112:115], 0
s_add_u32 s78, s78, s54
ds_read_b64_tr_b16 a[156:157], v14 offset:40960
ds_read_b64_tr_b16 a[158:159], v14 offset:41472
v_mfma_f32_16x16x32_bf16 a[0:3], a[164:167], a[116:119], a[0:3]
s_lshl2_add_u32 s78, s78, s55
s_lshl_b32 s78, s78, 10
s_add_u32 s78, s78, 35651584
v_mfma_f32_16x16x32_bf16 a[4:7], a[172:175], a[116:119], 0
s_add_u32 m0, s73, 71680
s_add_u32 s64, s71, 540672
ds_read_b128 a[92:95], v10 offset:6144
v_mfma_f32_16x16x32_bf16 a[4:7], a[168:171], a[112:115], a[4:7]
s_add_u32 s80, s80, 8192
s_mov_b32 s91, 0x3e0293ee
s_mov_b32 s85, 0x05040100
v_mfma_f32_16x16x32_bf16 a[8:11], a[176:179], a[112:115], 0
buffer_load_dwordx4 v5, s[8:11], s64 offen lds
v_mfma_f32_16x16x32_bf16 a[8:11], a[180:183], a[116:119], a[8:11]
s_mov_b32 s86, 0x07060302
s_lshl2_add_u32 s52, s7, s3
s_and_b32 s65, s6, 3
v_mfma_f32_16x16x32_bf16 a[12:15], a[188:191], a[116:119], 0
s_max_u32 s95, s65, 1
s_mul_i32 s92, s5, 3
s_add_u32 s95, s95, s92
v_mfma_f32_16x16x32_bf16 a[12:15], a[184:187], a[112:115], a[12:15]
s_sub_u32 s95, 24, s95
s_cmp_eq_u32 s65, 1
s_cselect_b32 s95, 63, s95
v_mfma_f32_16x16x32_bf16 a[28:31], a[184:187], a[120:123], 0
s_mov_b32 s92, s95
s_mul_i32 s81, s92, 110592
s_mul_i32 s65, s52, 36
v_mfma_f32_16x16x32_bf16 a[28:31], a[188:191], a[124:127], a[28:31]
buffer_load_dwordx4 v6, s[8:11], s64 offen offset:1024 lds
v_mfma_f32_16x16x32_bf16 a[24:27], a[180:183], a[124:127], 0
s_add_u32 s81, s81, s65
s_mul_i32 s82, s52, 18
s_add_u32 s82, s82, s92
v_mfma_f32_16x16x32_bf16 a[24:27], a[176:179], a[120:123], a[24:27]
s_lshl_b32 s82, s82, 12
s_add_u32 s82, s82, 35651584
s_lshl_b32 s83, s92, 6
v_mfma_f32_16x16x32_bf16 a[20:23], a[168:171], a[120:123], 0
s_lshl_b32 s84, s52, 10
s_add_u32 s84, s84, 75497984
v_mfma_f32_16x16x32_bf16 a[20:23], a[172:175], a[124:127], a[20:23]
s_cmp_lt_u32 s92, 18
s_cselect_b32 s82, s82, 2147418112
s_cselect_b32 s84, s84, 2147418112
v_mfma_f32_16x16x32_bf16 a[16:19], a[164:167], a[124:127], 0
v_lshrrev_b32 v18, 2, v2
v_and_b32 v19, 3, v2
v_mfma_f32_16x16x32_bf16 a[16:19], a[160:163], a[120:123], a[16:19]
s_waitcnt lgkmcnt(0)
v_mul_u32_u24 v20, 1152, v18
v_cmp_eq_u32 vcc, 2, v19
v_mfma_f32_16x16x32_bf16 v[32:35], a[64:67], a[128:131], v[32:35]
s_waitcnt vmcnt(13)
v_lshl_add_u32 v20, v19, 3, v20
v_add_u32 v21, 1, v19
v_mfma_f32_16x16x32_bf16 v[32:35], a[68:71], a[132:135], v[32:35]
s_barrier
v_mfma_f32_16x16x32_bf16 v[40:43], a[68:71], a[140:143], v[40:43]
ds_read_b128 a[96:99], v9 offset:8192
v_cndmask_b32 v21, v21, 0, vcc
v_mfma_f32_16x16x32_bf16 v[40:43], a[64:67], a[136:139], v[40:43]
s_add_u32 m0, s77, 16384
s_add_u32 s64, s76, 0
v_cmp_eq_u32 vcc, 3, v18
v_mfma_f32_16x16x32_bf16 v[48:51], a[64:67], a[144:147], v[48:51]
buffer_load_dwordx4 v7, s[16:19], s64 offen lds
v_mfma_f32_16x16x32_bf16 v[48:51], a[68:71], a[148:151], v[48:51]
ds_read_b128 a[100:103], v10 offset:8192
v_mul_u32_u24 v21, 1152, v21
v_mfma_f32_16x16x32_bf16 v[56:59], a[68:71], a[156:159], v[56:59]
v_add_u32 v21, 32, v21
v_cndmask_b32 v20, v20, v21, vcc
v_mfma_f32_16x16x32_bf16 v[56:59], a[64:67], a[152:155], v[56:59]
v_cmp_eq_u32 vcc, 15, v2
v_mul_u32_u24 v21, 27648, v3
v_mfma_f32_16x16x32_bf16 v[60:63], a[72:75], a[152:155], v[60:63]
buffer_load_dwordx4 v8, s[16:19], s64 offen offset:1024 lds
v_mfma_f32_16x16x32_bf16 v[60:63], a[76:79], a[156:159], v[60:63]
ds_read_b128 a[104:107], v9 offset:10240
v_add_u32 v20, v20, v21
v_mfma_f32_16x16x32_bf16 v[52:55], a[76:79], a[148:151], v[52:55]
v_lshlrev_b32 v21, 4, v3
v_cndmask_b32 v26, v20, v24, vcc
v_mfma_f32_16x16x32_bf16 v[52:55], a[72:75], a[144:147], v[52:55]
s_add_u32 m0, s77, 18432
s_add_u32 s64, s76, 131072
v_cndmask_b32 v27, v24, v21, vcc
v_mfma_f32_16x16x32_bf16 v[44:47], a[72:75], a[136:139], v[44:47]
ds_read_b64_tr_b16 a[160:161], v11 offset:49152
ds_read_b64_tr_b16 a[162:163], v11 offset:49664
v_mfma_f32_16x16x32_bf16 v[44:47], a[76:79], a[140:143], v[44:47]
buffer_load_dwordx4 v7, s[16:19], s64 offen lds
v_mfma_f32_16x16x32_bf16 v[36:39], a[76:79], a[132:135], v[36:39]
v_and_b32 v18, 7, v1
v_cmp_gt_u32 vcc, 48, v1
v_mfma_f32_16x16x32_bf16 v[36:39], a[72:75], a[128:131], v[36:39]
ds_read_b128 a[108:111], v10 offset:10240
v_mul_u32_u24 v18, 3456, v18
v_mfma_f32_16x16x32_bf16 v[64:67], a[80:83], a[128:131], v[64:67]
v_mul_u32_u24 v19, 1152, v3
v_bfe_u32 v20, v1, 3, 1
v_mfma_f32_16x16x32_bf16 v[64:67], a[84:87], a[132:135], v[64:67]
v_mul_u32_u24 v20, 140, v20
v_add3_u32 v18, v18, v19, v20
v_mfma_f32_16x16x32_bf16 v[72:75], a[84:87], a[140:143], v[72:75]
buffer_load_dwordx4 v8, s[16:19], s64 offen offset:1024 lds
v_mfma_f32_16x16x32_bf16 v[72:75], a[80:83], a[136:139], v[72:75]
s_xor_b32 s71, s70, 384
s_add_u32 s71, s68, s71
v_cndmask_b32 v28, v24, v18, vcc
v_mfma_f32_16x16x32_bf16 v[80:83], a[80:83], a[144:147], v[80:83]
s_lshl_b32 s52, s4, 2
ds_read_b64_tr_b16 a[164:165], v11 offset:57344
ds_read_b64_tr_b16 a[166:167], v11 offset:57856
v_mfma_f32_16x16x32_bf16 v[80:83], a[84:87], a[148:151], v[80:83]
s_add_u32 m0, s73, 0
s_add_u32 s64, s71, 0
ds_read_b128 a[112:115], v9 offset:12288
v_mfma_f32_16x16x32_bf16 v[88:91], a[84:87], a[156:159], v[88:91]
s_cmp_eq_u32 s66, 0
s_cselect_b32 s52, s52, 2147418112
v_mfma_f32_16x16x32_bf16 v[88:91], a[80:83], a[152:155], v[88:91]
buffer_load_dwordx4 v5, s[8:11], s64 offen lds
v_mfma_f32_16x16x32_bf16 v[92:95], a[88:91], a[152:155], v[92:95]
ds_read_b64_tr_b16 a[168:169], v12 offset:49152
ds_read_b64_tr_b16 a[170:171], v12 offset:49664
v_mfma_f32_16x16x32_bf16 v[92:95], a[92:95], a[156:159], v[92:95]
v_mfma_f32_16x16x32_bf16 v[84:87], a[92:95], a[148:151], v[84:87]
v_mfma_f32_16x16x32_bf16 v[84:87], a[88:91], a[144:147], v[84:87]
v_mfma_f32_16x16x32_bf16 v[76:79], a[88:91], a[136:139], v[76:79]
buffer_load_dwordx4 v6, s[8:11], s64 offen offset:1024 lds
v_mfma_f32_16x16x32_bf16 v[76:79], a[92:95], a[140:143], v[76:79]
ds_read_b128 a[116:119], v10 offset:12288
v_mfma_f32_16x16x32_bf16 v[68:71], a[92:95], a[132:135], v[68:71]
v_mfma_f32_16x16x32_bf16 v[68:71], a[88:91], a[128:131], v[68:71]
s_add_u32 m0, s73, 2048
s_add_u32 s64, s71, 16384
s_waitcnt lgkmcnt(6)
v_mfma_f32_16x16x32_bf16 v[96:99], a[96:99], a[128:131], v[96:99]
ds_read_b64_tr_b16 a[172:173], v12 offset:57344
ds_read_b64_tr_b16 a[174:175], v12 offset:57856
v_mfma_f32_16x16x32_bf16 v[96:99], a[100:103], a[132:135], v[96:99]
buffer_load_dwordx4 v5, s[8:11], s64 offen lds
v_mfma_f32_16x16x32_bf16 v[104:107], a[100:103], a[140:143], v[104:107]
ds_read_b128 a[120:123], v9 offset:14336
v_mfma_f32_16x16x32_bf16 v[104:107], a[96:99], a[136:139], v[104:107]
v_mfma_f32_16x16x32_bf16 v[112:115], a[96:99], a[144:147], v[112:115]
v_mfma_f32_16x16x32_bf16 v[112:115], a[100:103], a[148:151], v[112:115]
buffer_load_dwordx4 v6, s[8:11], s64 offen offset:1024 lds
v_mfma_f32_16x16x32_bf16 v[120:123], a[100:103], a[156:159], v[120:123]
s_xor_b32 s76, s75, 1572864
s_add_u32 s76, s74, s76
v_mfma_f32_16x16x32_bf16 v[120:123], a[96:99], a[152:155], v[120:123]
ds_read_b64_tr_b16 a[176:177], v13 offset:49152
ds_read_b64_tr_b16 a[178:179], v13 offset:49664
v_mfma_f32_16x16x32_bf16 v[124:127], a[104:107], a[152:155], v[124:127]
s_add_u32 m0, s77, 32768
s_add_u32 s64, s76, 0
v_mfma_f32_16x16x32_bf16 v[124:127], a[108:111], a[156:159], v[124:127]
ds_read_b128 a[124:127], v10 offset:14336
v_mfma_f32_16x16x32_bf16 v[116:119], a[108:111], a[148:151], v[116:119]
buffer_load_dwordx4 v7, s[56:59], s64 offen lds
v_mfma_f32_16x16x32_bf16 v[116:119], a[104:107], a[144:147], v[116:119]
s_waitcnt vmcnt(14)
v_add_u32 v9, 32768, v9
v_add_u32 v10, 32768, v10
v_mfma_f32_16x16x32_bf16 v[108:111], a[104:107], a[136:139], v[108:111]
ds_read_b64_tr_b16 a[180:181], v13 offset:57344
ds_read_b64_tr_b16 a[182:183], v13 offset:57856
v_mfma_f32_16x16x32_bf16 v[108:111], a[108:111], a[140:143], v[108:111]
buffer_store_dword v1, v0, s[40:43], s52 offen sc1
v_mfma_f32_16x16x32_bf16 v[100:103], a[108:111], a[132:135], v[100:103]
s_waitcnt lgkmcnt(2)
v_mfma_f32_16x16x32_bf16 v[100:103], a[104:107], a[128:131], v[100:103]
buffer_load_dwordx4 v8, s[56:59], s64 offen offset:1024 lds
v_mfma_f32_16x16x32_bf16 v[128:131], a[112:115], a[128:131], v[128:131]
ds_read_b64_tr_b16 a[184:185], v14 offset:49152
ds_read_b64_tr_b16 a[186:187], v14 offset:49664
v_mfma_f32_16x16x32_bf16 v[128:131], a[116:119], a[132:135], v[128:131]
v_mfma_f32_16x16x32_bf16 v[136:139], a[116:119], a[140:143], v[136:139]
s_add_u32 m0, s77, 34816
s_add_u32 s64, s76, 131072
v_mfma_f32_16x16x32_bf16 v[136:139], a[112:115], a[136:139], v[136:139]
ds_read_b64_tr_b16 a[188:189], v14 offset:57344
ds_read_b64_tr_b16 a[190:191], v14 offset:57856
v_mfma_f32_16x16x32_bf16 v[144:147], a[112:115], a[144:147], v[144:147]
buffer_load_dwordx4 v7, s[56:59], s64 offen lds
v_mfma_f32_16x16x32_bf16 v[144:147], a[116:119], a[148:151], v[144:147]
v_mfma_f32_16x16x32_bf16 v[152:155], a[116:119], a[156:159], v[152:155]
v_mfma_f32_16x16x32_bf16 v[152:155], a[112:115], a[152:155], v[152:155]
v_mfma_f32_16x16x32_bf16 v[156:159], a[120:123], a[152:155], v[156:159]
v_mfma_f32_16x16x32_bf16 v[156:159], a[124:127], a[156:159], v[156:159]
buffer_load_dwordx4 v8, s[56:59], s64 offen offset:1024 lds
v_mfma_f32_16x16x32_bf16 v[148:151], a[124:127], a[148:151], v[148:151]
v_mfma_f32_16x16x32_bf16 v[148:151], a[120:123], a[144:147], v[148:151]
v_mfma_f32_16x16x32_bf16 v[140:143], a[120:123], a[136:139], v[140:143]
v_mfma_f32_16x16x32_bf16 v[140:143], a[124:127], a[140:143], v[140:143]
v_mfma_f32_16x16x32_bf16 v[132:135], a[124:127], a[132:135], v[132:135]
v_mfma_f32_16x16x32_bf16 v[132:135], a[120:123], a[128:131], v[132:135]
s_waitcnt lgkmcnt(0)
v_mfma_f32_16x16x32_bf16 v[160:163], a[160:163], a[64:67], v[160:163]
s_waitcnt vmcnt(13)
v_mfma_f32_16x16x32_bf16 v[160:163], a[164:167], a[68:71], v[160:163]
s_barrier
v_mfma_f32_16x16x32_bf16 v[164:167], a[172:175], a[68:71], v[164:167]
s_add_u32 s52, s81, 0
ds_read_b64_tr_b16 a[128:129], v11 offset:0
ds_read_b64_tr_b16 a[130:131], v11 offset:512
v_mfma_f32_16x16x32_bf16 v[164:167], a[168:171], a[64:67], v[164:167]
s_add_u32 m0, s73, 4096
s_add_u32 s64, s71, 524288
v_mfma_f32_16x16x32_bf16 v[168:171], a[176:179], a[64:67], v[168:171]
buffer_load_dwordx4 v5, s[8:11], s64 offen lds
v_mfma_f32_16x16x32_bf16 v[168:171], a[180:183], a[68:71], v[168:171]
buffer_load_dwordx2 a[192:193], v26, s[28:31], s52 offen
v_mfma_f32_16x16x32_bf16 v[172:175], a[188:191], a[68:71], v[172:175]
v_mfma_f32_16x16x32_bf16 v[172:175], a[184:187], a[64:67], v[172:175]
ds_read_b128 a[64:67], v9 offset:0
v_mfma_f32_16x16x32_bf16 v[188:191], a[184:187], a[72:75], v[188:191]
buffer_load_dwordx4 v6, s[8:11], s64 offen offset:1024 lds
v_mfma_f32_16x16x32_bf16 v[188:191], a[188:191], a[76:79], v[188:191]
ds_read_b64_tr_b16 a[132:133], v11 offset:8192
ds_read_b64_tr_b16 a[134:135], v11 offset:8704
v_mfma_f32_16x16x32_bf16 v[184:187], a[180:183], a[76:79], v[184:187]
v_mfma_f32_16x16x32_bf16 v[184:187], a[176:179], a[72:75], v[184:187]
s_add_u32 m0, s73, 6144
s_add_u32 s64, s71, 540672
ds_read_b128 a[68:71], v10 offset:0
v_mfma_f32_16x16x32_bf16 v[180:183], a[168:171], a[72:75], v[180:183]
v_mfma_f32_16x16x32_bf16 v[180:183], a[172:175], a[76:79], v[180:183]
buffer_load_dwordx4 v5, s[8:11], s64 offen lds
v_mfma_f32_16x16x32_bf16 v[176:179], a[164:167], a[76:79], v[176:179]
s_add_u32 s52, s81, 3456
v_mfma_f32_16x16x32_bf16 v[176:179], a[160:163], a[72:75], v[176:179]
ds_read_b64_tr_b16 a[136:137], v12 offset:0
ds_read_b64_tr_b16 a[138:139], v12 offset:512
v_mfma_f32_16x16x32_bf16 v[192:195], a[160:163], a[80:83], v[192:195]
buffer_load_dwordx2 a[194:195], v26, s[28:31], s52 offen
v_mfma_f32_16x16x32_bf16 v[192:195], a[164:167], a[84:87], v[192:195]
v_mfma_f32_16x16x32_bf16 v[196:199], a[172:175], a[84:87], v[196:199]
buffer_load_dwordx4 v6, s[8:11], s64 offen offset:1024 lds
v_mfma_f32_16x16x32_bf16 v[196:199], a[168:171], a[80:83], v[196:199]
ds_read_b128 a[72:75], v9 offset:2048
v_mfma_f32_16x16x32_bf16 v[200:203], a[176:179], a[80:83], v[200:203]
v_mfma_f32_16x16x32_bf16 v[200:203], a[180:183], a[84:87], v[200:203]
s_add_u32 m0, s77, 49152
s_add_u32 s64, s76, 0
v_mfma_f32_16x16x32_bf16 v[204:207], a[188:191], a[84:87], v[204:207]
ds_read_b64_tr_b16 a[140:141], v12 offset:8192
ds_read_b64_tr_b16 a[142:143], v12 offset:8704
v_mfma_f32_16x16x32_bf16 v[204:207], a[184:187], a[80:83], v[204:207]
buffer_load_dwordx4 v7, s[16:19], s64 offen lds
v_mfma_f32_16x16x32_bf16 v[220:223], a[184:187], a[88:91], v[220:223]
ds_read_b128 a[76:79], v10 offset:2048
v_mfma_f32_16x16x32_bf16 v[220:223], a[188:191], a[92:95], v[220:223]
s_add_u32 s52, s81, 6912
v_mfma_f32_16x16x32_bf16 v[216:219], a[180:183], a[92:95], v[216:219]
buffer_load_dwordx2 a[196:197], v26, s[28:31], s52 offen
v_mfma_f32_16x16x32_bf16 v[216:219], a[176:179], a[88:91], v[216:219]
v_mfma_f32_16x16x32_bf16 v[212:215], a[168:171], a[88:91], v[212:215]
buffer_load_dwordx4 v8, s[16:19], s64 offen offset:1024 lds
v_mfma_f32_16x16x32_bf16 v[212:215], a[172:175], a[92:95], v[212:215]
ds_read_b64_tr_b16 a[144:145], v13 offset:0
ds_read_b64_tr_b16 a[146:147], v13 offset:512
v_mfma_f32_16x16x32_bf16 v[208:211], a[164:167], a[92:95], v[208:211]
v_mfma_f32_16x16x32_bf16 v[208:211], a[160:163], a[88:91], v[208:211]
s_add_u32 m0, s77, 51200
s_add_u32 s64, s76, 131072
ds_read_b128 a[80:83], v9 offset:4096
v_mfma_f32_16x16x32_bf16 v[224:227], a[160:163], a[96:99], v[224:227]
v_mfma_f32_16x16x32_bf16 v[224:227], a[164:167], a[100:103], v[224:227]
buffer_load_dwordx4 v7, s[16:19], s64 offen lds
v_mfma_f32_16x16x32_bf16 v[228:231], a[172:175], a[100:103], v[228:231]
ds_read_b64_tr_b16 a[148:149], v13 offset:8192
ds_read_b64_tr_b16 a[150:151], v13 offset:8704
v_mfma_f32_16x16x32_bf16 v[228:231], a[168:171], a[96:99], v[228:231]
s_add_u32 s52, s81, 10368
v_mfma_f32_16x16x32_bf16 v[232:235], a[176:179], a[96:99], v[232:235]
buffer_load_dwordx2 a[198:199], v26, s[28:31], s52 offen
v_mfma_f32_16x16x32_bf16 v[232:235], a[180:183], a[100:103], v[232:235]
buffer_load_dwordx4 v8, s[16:19], s64 offen offset:1024 lds
v_mfma_f32_16x16x32_bf16 v[236:239], a[188:191], a[100:103], v[236:239]
s_xor_b32 s71, s70, 512
s_add_u32 s71, s68, s71
ds_read_b128 a[84:87], v10 offset:4096
v_mfma_f32_16x16x32_bf16 v[236:239], a[184:187], a[96:99], v[236:239]
v_mfma_f32_16x16x32_bf16 v[252:255], a[184:187], a[104:107], v[252:255]
s_add_u32 m0, s73, 32768
s_add_u32 s64, s71, 0
v_mfma_f32_16x16x32_bf16 v[252:255], a[188:191], a[108:111], v[252:255]
ds_read_b64_tr_b16 a[152:153], v14 offset:0
ds_read_b64_tr_b16 a[154:155], v14 offset:512
v_mfma_f32_16x16x32_bf16 v[248:251], a[180:183], a[108:111], v[248:251]
buffer_load_dwordx4 v5, s[8:11], s64 offen lds
v_mfma_f32_16x16x32_bf16 v[248:251], a[176:179], a[104:107], v[248:251]
v_mfma_f32_16x16x32_bf16 v[244:247], a[168:171], a[104:107], v[244:247]
ds_read_b128 a[88:91], v9 offset:6144
v_mfma_f32_16x16x32_bf16 v[244:247], a[172:175], a[108:111], v[244:247]
s_add_u32 s52, s81, 13824
v_mfma_f32_16x16x32_bf16 v[240:243], a[164:167], a[108:111], v[240:243]
buffer_load_dwordx2 a[200:201], v26, s[28:31], s52 offen
v_mfma_f32_16x16x32_bf16 v[240:243], a[160:163], a[104:107], v[240:243]
buffer_load_dwordx4 v6, s[8:11], s64 offen offset:1024 lds
v_mfma_f32_16x16x32_bf16 a[0:3], a[160:163], a[112:115], a[0:3]
ds_read_b64_tr_b16 a[156:157], v14 offset:8192
ds_read_b64_tr_b16 a[158:159], v14 offset:8704
v_mfma_f32_16x16x32_bf16 a[0:3], a[164:167], a[116:119], a[0:3]
v_mfma_f32_16x16x32_bf16 a[4:7], a[172:175], a[116:119], a[4:7]
s_add_u32 m0, s73, 34816
s_add_u32 s64, s71, 16384
ds_read_b128 a[92:95], v10 offset:6144
v_mfma_f32_16x16x32_bf16 a[4:7], a[168:171], a[112:115], a[4:7]
v_mfma_f32_16x16x32_bf16 a[8:11], a[176:179], a[112:115], a[8:11]
buffer_load_dwordx4 v5, s[8:11], s64 offen lds
v_mfma_f32_16x16x32_bf16 a[8:11], a[180:183], a[116:119], a[8:11]
v_mfma_f32_16x16x32_bf16 a[12:15], a[188:191], a[116:119], a[12:15]
v_mfma_f32_16x16x32_bf16 a[12:15], a[184:187], a[112:115], a[12:15]
s_add_u32 s52, s81, 17280
v_mfma_f32_16x16x32_bf16 a[28:31], a[184:187], a[120:123], a[28:31]
buffer_load_dwordx2 a[202:203], v26, s[28:31], s52 offen
v_mfma_f32_16x16x32_bf16 a[28:31], a[188:191], a[124:127], a[28:31]
buffer_load_dwordx4 v6, s[8:11], s64 offen offset:1024 lds
v_mfma_f32_16x16x32_bf16 a[24:27], a[180:183], a[124:127], a[24:27]
v_mfma_f32_16x16x32_bf16 a[24:27], a[176:179], a[120:123], a[24:27]
v_mfma_f32_16x16x32_bf16 a[20:23], a[168:171], a[120:123], a[20:23]
v_mfma_f32_16x16x32_bf16 a[20:23], a[172:175], a[124:127], a[20:23]
v_mfma_f32_16x16x32_bf16 a[16:19], a[164:167], a[124:127], a[16:19]
v_mfma_f32_16x16x32_bf16 a[16:19], a[160:163], a[120:123], a[16:19]
s_waitcnt lgkmcnt(0)
v_mfma_f32_16x16x32_bf16 v[32:35], a[64:67], a[128:131], v[32:35]
s_waitcnt vmcnt(27)
v_mfma_f32_16x16x32_bf16 v[32:35], a[68:71], a[132:135], v[32:35]
s_barrier
v_mfma_f32_16x16x32_bf16 v[40:43], a[68:71], a[140:143], v[40:43]
s_add_u32 s52, s81, 20736
ds_read_b128 a[96:99], v9 offset:8192
v_mfma_f32_16x16x32_bf16 v[40:43], a[64:67], a[136:139], v[40:43]
s_xor_b32 s76, s75, 2097152
s_add_u32 s76, s74, s76
v_mfma_f32_16x16x32_bf16 v[48:51], a[64:67], a[144:147], v[48:51]
s_add_u32 m0, s77, 0
s_add_u32 s64, s76, 0
v_mfma_f32_16x16x32_bf16 v[48:51], a[68:71], a[148:151], v[48:51]
buffer_load_dwordx4 v7, s[56:59], s64 offen lds
v_mfma_f32_16x16x32_bf16 v[56:59], a[68:71], a[156:159], v[56:59]
ds_read_b128 a[100:103], v10 offset:8192
v_mfma_f32_16x16x32_bf16 v[56:59], a[64:67], a[152:155], v[56:59]
buffer_load_dwordx2 a[204:205], v26, s[28:31], s52 offen
v_mfma_f32_16x16x32_bf16 v[60:63], a[72:75], a[152:155], v[60:63]
ds_read_b128 a[104:107], v9 offset:10240
v_mfma_f32_16x16x32_bf16 v[60:63], a[76:79], a[156:159], v[60:63]
v_mfma_f32_16x16x32_bf16 v[52:55], a[76:79], a[148:151], v[52:55]
v_mfma_f32_16x16x32_bf16 v[52:55], a[72:75], a[144:147], v[52:55]
buffer_load_dwordx4 v8, s[56:59], s64 offen offset:1024 lds
v_mfma_f32_16x16x32_bf16 v[44:47], a[72:75], a[136:139], v[44:47]
ds_read_b64_tr_b16 a[160:161], v11 offset:16384
ds_read_b64_tr_b16 a[162:163], v11 offset:16896
v_mfma_f32_16x16x32_bf16 v[44:47], a[76:79], a[140:143], v[44:47]
v_mfma_f32_16x16x32_bf16 v[36:39], a[76:79], a[132:135], v[36:39]
v_mfma_f32_16x16x32_bf16 v[36:39], a[72:75], a[128:131], v[36:39]
ds_read_b128 a[108:111], v10 offset:10240
v_mfma_f32_16x16x32_bf16 v[64:67], a[80:83], a[128:131], v[64:67]
s_add_u32 m0, s77, 2048
s_add_u32 s64, s76, 131072
s_add_u32 s52, s81, 24192
v_mfma_f32_16x16x32_bf16 v[64:67], a[84:87], a[132:135], v[64:67]
buffer_load_dwordx2 a[206:207], v26, s[28:31], s52 offen
v_mfma_f32_16x16x32_bf16 v[72:75], a[84:87], a[140:143], v[72:75]
buffer_load_dwordx4 v7, s[56:59], s64 offen lds
v_mfma_f32_16x16x32_bf16 v[72:75], a[80:83], a[136:139], v[72:75]
ds_read_b64_tr_b16 a[164:165], v11 offset:24576
ds_read_b64_tr_b16 a[166:167], v11 offset:25088
v_mfma_f32_16x16x32_bf16 v[80:83], a[80:83], a[144:147], v[80:83]
v_mfma_f32_16x16x32_bf16 v[80:83], a[84:87], a[148:151], v[80:83]
ds_read_b128 a[112:115], v9 offset:12288
v_mfma_f32_16x16x32_bf16 v[88:91], a[84:87], a[156:159], v[88:91]
v_mfma_f32_16x16x32_bf16 v[88:91], a[80:83], a[152:155], v[88:91]
v_mfma_f32_16x16x32_bf16 v[92:95], a[88:91], a[152:155], v[92:95]
ds_read_b64_tr_b16 a[168:169], v12 offset:16384
ds_read_b64_tr_b16 a[170:171], v12 offset:16896
v_mfma_f32_16x16x32_bf16 v[92:95], a[92:95], a[156:159], v[92:95]
buffer_load_dwordx4 v8, s[56:59], s64 offen offset:1024 lds
v_mfma_f32_16x16x32_bf16 v[84:87], a[92:95], a[148:151], v[84:87]
buffer_load_dwordx4 a[208:211], v27, s[36:39], s83 offen
v_mfma_f32_16x16x32_bf16 v[84:87], a[88:91], a[144:147], v[84:87]
v_mfma_f32_16x16x32_bf16 v[76:79], a[88:91], a[136:139], v[76:79]
ds_read_b128 a[116:119], v10 offset:12288
v_mfma_f32_16x16x32_bf16 v[76:79], a[92:95], a[140:143], v[76:79]
v_mfma_f32_16x16x32_bf16 v[68:71], a[92:95], a[132:135], v[68:71]
v_mfma_f32_16x16x32_bf16 v[68:71], a[88:91], a[128:131], v[68:71]
s_add_u32 m0, s73, 36864
s_add_u32 s64, s71, 524288
s_waitcnt lgkmcnt(6)
v_mfma_f32_16x16x32_bf16 v[96:99], a[96:99], a[128:131], v[96:99]
ds_read_b64_tr_b16 a[172:173], v12 offset:24576
ds_read_b64_tr_b16 a[174:175], v12 offset:25088
v_mfma_f32_16x16x32_bf16 v[96:99], a[100:103], a[132:135], v[96:99]
buffer_load_dwordx4 v5, s[8:11], s64 offen lds
v_mfma_f32_16x16x32_bf16 v[104:107], a[100:103], a[140:143], v[104:107]
ds_read_b128 a[120:123], v9 offset:14336
v_mfma_f32_16x16x32_bf16 v[104:107], a[96:99], a[136:139], v[104:107]
v_mfma_f32_16x16x32_bf16 v[112:115], a[96:99], a[144:147], v[112:115]
v_mfma_f32_16x16x32_bf16 v[112:115], a[100:103], a[148:151], v[112:115]
ds_read_b64_tr_b16 a[176:177], v13 offset:16384
ds_read_b64_tr_b16 a[178:179], v13 offset:16896
v_mfma_f32_16x16x32_bf16 v[120:123], a[100:103], a[156:159], v[120:123]
v_mfma_f32_16x16x32_bf16 v[120:123], a[96:99], a[152:155], v[120:123]
v_mfma_f32_16x16x32_bf16 v[124:127], a[104:107], a[152:155], v[124:127]
buffer_load_dwordx4 v6, s[8:11], s64 offen offset:1024 lds
v_mfma_f32_16x16x32_bf16 v[124:127], a[108:111], a[156:159], v[124:127]
ds_read_b128 a[124:127], v10 offset:14336
v_mfma_f32_16x16x32_bf16 v[116:119], a[108:111], a[148:151], v[116:119]
v_add_u32 v9, -65536, v9
v_add_u32 v10, -65536, v10
v_mfma_f32_16x16x32_bf16 v[116:119], a[104:107], a[144:147], v[116:119]
v_mfma_f32_16x16x32_bf16 v[108:111], a[104:107], a[136:139], v[108:111]
ds_read_b64_tr_b16 a[180:181], v13 offset:24576
ds_read_b64_tr_b16 a[182:183], v13 offset:25088
v_mfma_f32_16x16x32_bf16 v[108:111], a[108:111], a[140:143], v[108:111]
s_add_u32 m0, s73, 38912
s_add_u32 s64, s71, 540672
v_mfma_f32_16x16x32_bf16 v[100:103], a[108:111], a[132:135], v[100:103]
s_waitcnt lgkmcnt(2)
v_mfma_f32_16x16x32_bf16 v[100:103], a[104:107], a[128:131], v[100:103]
buffer_load_dwordx4 v5, s[8:11], s64 offen lds
v_mfma_f32_16x16x32_bf16 v[128:131], a[112:115], a[128:131], v[128:131]
ds_read_b64_tr_b16 a[184:185], v14 offset:16384
ds_read_b64_tr_b16 a[186:187], v14 offset:16896
v_mfma_f32_16x16x32_bf16 v[128:131], a[116:119], a[132:135], v[128:131]
v_mfma_f32_16x16x32_bf16 v[136:139], a[116:119], a[140:143], v[136:139]
ds_read_b64_tr_b16 a[188:189], v14 offset:24576
ds_read_b64_tr_b16 a[190:191], v14 offset:25088
v_mfma_f32_16x16x32_bf16 v[136:139], a[112:115], a[136:139], v[136:139]
v_mfma_f32_16x16x32_bf16 v[144:147], a[112:115], a[144:147], v[144:147]
v_mfma_f32_16x16x32_bf16 v[144:147], a[116:119], a[148:151], v[144:147]
v_mfma_f32_16x16x32_bf16 v[152:155], a[116:119], a[156:159], v[152:155]
buffer_load_dwordx4 v6, s[8:11], s64 offen offset:1024 lds
v_mfma_f32_16x16x32_bf16 v[152:155], a[112:115], a[152:155], v[152:155]
v_mfma_f32_16x16x32_bf16 v[156:159], a[120:123], a[152:155], v[156:159]
v_mfma_f32_16x16x32_bf16 v[156:159], a[124:127], a[156:159], v[156:159]
v_mfma_f32_16x16x32_bf16 v[148:151], a[124:127], a[148:151], v[148:151]
v_mfma_f32_16x16x32_bf16 v[148:151], a[120:123], a[144:147], v[148:151]
v_mfma_f32_16x16x32_bf16 v[140:143], a[120:123], a[136:139], v[140:143]
v_mfma_f32_16x16x32_bf16 v[140:143], a[124:127], a[140:143], v[140:143]
v_mfma_f32_16x16x32_bf16 v[132:135], a[124:127], a[132:135], v[132:135]
v_mfma_f32_16x16x32_bf16 v[132:135], a[120:123], a[128:131], v[132:135]
s_waitcnt lgkmcnt(0)
v_mfma_f32_16x16x32_bf16 v[160:163], a[160:163], a[64:67], v[160:163]
s_waitcnt vmcnt(23)
v_mfma_f32_16x16x32_bf16 v[160:163], a[164:167], a[68:71], v[160:163]
s_barrier
v_mfma_f32_16x16x32_bf16 v[164:167], a[172:175], a[68:71], v[164:167]
s_waitcnt vmcnt(4)
ds_read_b64_tr_b16 a[128:129], v11 offset:32768
ds_read_b64_tr_b16 a[130:131], v11 offset:33280
v_mfma_f32_16x16x32_bf16 v[164:167], a[168:171], a[64:67], v[164:167]
s_add_u32 m0, s77, 16384
s_add_u32 s64, s76, 0
v_accvgpr_read_b32 v16, a192
v_mfma_f32_16x16x32_bf16 v[168:171], a[176:179], a[64:67], v[168:171]
buffer_load_dwordx4 v7, s[16:19], s64 offen lds
v_mfma_f32_16x16x32_bf16 v[168:171], a[180:183], a[68:71], v[168:171]
v_accvgpr_read_b32 v17, a194
v_accvgpr_read_b32 v18, a196
v_mfma_f32_16x16x32_bf16 v[172:175], a[188:191], a[68:71], v[172:175]
v_accvgpr_read_b32 v19, a198
v_accvgpr_read_b32 v20, a200
v_mfma_f32_16x16x32_bf16 v[172:175], a[184:187], a[64:67], v[172:175]
ds_read_b128 a[64:67], v9 offset:0
v_accvgpr_read_b32 v21, a202
v_mfma_f32_16x16x32_bf16 v[188:191], a[184:187], a[72:75], v[188:191]
ds_read_b64_tr_b16 a[132:133], v11 offset:40960
ds_read_b64_tr_b16 a[134:135], v11 offset:41472
v_mfma_f32_16x16x32_bf16 v[188:191], a[188:191], a[76:79], v[188:191]
L_PAD1:
s_cbranch_execz L_PAD5
v_accvgpr_read_b32 v22, a204
v_accvgpr_read_b32 v23, a206
v_mfma_f32_16x16x32_bf16 v[184:187], a[180:183], a[76:79], v[184:187]
v_mfma_f32_16x16x32_bf16 v[184:187], a[176:179], a[72:75], v[184:187]
buffer_load_dwordx4 v8, s[16:19], s64 offen offset:1024 lds
v_mfma_f32_16x16x32_bf16 v[180:183], a[168:171], a[72:75], v[180:183]
ds_read_b128 a[68:71], v10 offset:0
v_perm_b32 v24, v17, v16, s85
v_mfma_f32_16x16x32_bf16 v[180:183], a[172:175], a[76:79], v[180:183]
v_perm_b32 v25, v19, v18, s85
v_perm_b32 v26, v21, v20, s85
v_mfma_f32_16x16x32_bf16 v[176:179], a[164:167], a[76:79], v[176:179]
v_perm_b32 v27, v23, v22, s85
v_perm_b32 v28, v17, v16, s86
v_mfma_f32_16x16x32_bf16 v[176:179], a[160:163], a[72:75], v[176:179]
ds_read_b64_tr_b16 a[136:137], v12 offset:32768
ds_read_b64_tr_b16 a[138:139], v12 offset:33280
v_mfma_f32_16x16x32_bf16 v[192:195], a[160:163], a[80:83], v[192:195]
s_add_u32 m0, s77, 18432
s_add_u32 s64, s76, 131072
v_perm_b32 v29, v19, v18, s86
v_mfma_f32_16x16x32_bf16 v[192:195], a[164:167], a[84:87], v[192:195]
v_perm_b32 v30, v21, v20, s86
v_perm_b32 v31, v23, v22, s86
v_mfma_f32_16x16x32_bf16 v[196:199], a[172:175], a[84:87], v[196:199]
buffer_load_dwordx4 v7, s[16:19], s64 offen lds
v_mfma_f32_16x16x32_bf16 v[196:199], a[168:171], a[80:83], v[196:199]
ds_read_b128 a[72:75], v9 offset:2048
v_accvgpr_read_b32 v16, a208
v_mfma_f32_16x16x32_bf16 v[200:203], a[176:179], a[80:83], v[200:203]
v_accvgpr_read_b32 v17, a209
v_accvgpr_read_b32 v18, a210
v_mfma_f32_16x16x32_bf16 v[200:203], a[180:183], a[84:87], v[200:203]
ds_read_b64_tr_b16 a[140:141], v12 offset:40960
ds_read_b64_tr_b16 a[142:143], v12 offset:41472
v_mfma_f32_16x16x32_bf16 v[204:207], a[188:191], a[84:87], v[204:207]
v_accvgpr_read_b32 v19, a211
v_or_b32 v24, v24, v16
v_mfma_f32_16x16x32_bf16 v[204:207], a[184:187], a[80:83], v[204:207]
v_or_b32 v25, v25, v17
v_or_b32 v26, v26, v18
v_mfma_f32_16x16x32_bf16 v[220:223], a[184:187], a[88:91], v[220:223]
ds_read_b128 a[76:79], v10 offset:2048
v_or_b32 v27, v27, v19
v_mfma_f32_16x16x32_bf16 v[220:223], a[188:191], a[92:95], v[220:223]
buffer_load_dwordx4 v8, s[16:19], s64 offen offset:1024 lds
v_mfma_f32_16x16x32_bf16 v[216:219], a[180:183], a[92:95], v[216:219]
s_xor_b32 s71, s70, 640
s_add_u32 s71, s68, s71
v_mfma_f32_16x16x32_bf16 v[216:219], a[176:179], a[88:91], v[216:219]
buffer_store_dwordx4 v[24:27], v15, s[24:27], s82 offen offset:0 sc1
v_mfma_f32_16x16x32_bf16 v[212:215], a[168:171], a[88:91], v[212:215]
ds_read_b64_tr_b16 a[144:145], v13 offset:32768
ds_read_b64_tr_b16 a[146:147], v13 offset:33280
v_mfma_f32_16x16x32_bf16 v[212:215], a[172:175], a[92:95], v[212:215]
v_mfma_f32_16x16x32_bf16 v[208:211], a[164:167], a[92:95], v[208:211]
v_mfma_f32_16x16x32_bf16 v[208:211], a[160:163], a[88:91], v[208:211]
s_add_u32 m0, s73, 65536
s_add_u32 s64, s71, 0
ds_read_b128 a[80:83], v9 offset:4096
v_mfma_f32_16x16x32_bf16 v[224:227], a[160:163], a[96:99], v[224:227]
v_mfma_f32_16x16x32_bf16 v[224:227], a[164:167], a[100:103], v[224:227]
buffer_load_dwordx4 v5, s[8:11], s64 offen lds
v_mfma_f32_16x16x32_bf16 v[228:231], a[172:175], a[100:103], v[228:231]
ds_read_b64_tr_b16 a[148:149], v13 offset:40960
ds_read_b64_tr_b16 a[150:151], v13 offset:41472
v_mfma_f32_16x16x32_bf16 v[228:231], a[168:171], a[96:99], v[228:231]
v_mfma_f32_16x16x32_bf16 v[232:235], a[176:179], a[96:99], v[232:235]
v_mfma_f32_16x16x32_bf16 v[232:235], a[180:183], a[100:103], v[232:235]
ds_read_b128 a[84:87], v10 offset:4096
v_mfma_f32_16x16x32_bf16 v[236:239], a[188:191], a[100:103], v[236:239]
buffer_store_dwordx4 v[28:31], v15, s[24:27], s82 offen offset:1024 sc1
v_mfma_f32_16x16x32_bf16 v[236:239], a[184:187], a[96:99], v[236:239]
v_accvgpr_read_b32 v16, a193
v_accvgpr_read_b32 v17, a195
v_mfma_f32_16x16x32_bf16 v[252:255], a[184:187], a[104:107], v[252:255]
buffer_load_dwordx4 v6, s[8:11], s64 offen offset:1024 lds
v_mfma_f32_16x16x32_bf16 v[252:255], a[188:191], a[108:111], v[252:255]
ds_read_b64_tr_b16 a[152:153], v14 offset:32768
ds_read_b64_tr_b16 a[154:155], v14 offset:33280
v_mfma_f32_16x16x32_bf16 v[248:251], a[180:183], a[108:111], v[248:251]
v_accvgpr_read_b32 v18, a197
v_accvgpr_read_b32 v19, a199
v_mfma_f32_16x16x32_bf16 v[248:251], a[176:179], a[104:107], v[248:251]
v_accvgpr_read_b32 v20, a201
v_accvgpr_read_b32 v21, a203
v_mfma_f32_16x16x32_bf16 v[244:247], a[168:171], a[104:107], v[244:247]
ds_read_b128 a[88:91], v9 offset:6144
v_accvgpr_read_b32 v22, a205
v_mfma_f32_16x16x32_bf16 v[244:247], a[172:175], a[108:111], v[244:247]
s_add_u32 m0, s73, 67584
s_add_u32 s64, s71, 16384
v_accvgpr_read_b32 v23, a207
v_mfma_f32_16x16x32_bf16 v[240:243], a[164:167], a[108:111], v[240:243]
v_mfma_f32_16x16x32_bf16 v[240:243], a[160:163], a[104:107], v[240:243]
buffer_load_dwordx4 v5, s[8:11], s64 offen lds
v_mfma_f32_16x16x32_bf16 a[0:3], a[160:163], a[112:115], a[0:3]
ds_read_b64_tr_b16 a[156:157], v14 offset:40960
ds_read_b64_tr_b16 a[158:159], v14 offset:41472
v_mfma_f32_16x16x32_bf16 a[0:3], a[164:167], a[116:119], a[0:3]
v_perm_b32 v24, v17, v16, s85
v_perm_b32 v25, v19, v18, s85
v_mfma_f32_16x16x32_bf16 a[4:7], a[172:175], a[116:119], a[4:7]
ds_read_b128 a[92:95], v10 offset:6144
v_perm_b32 v26, v21, v20, s85
v_mfma_f32_16x16x32_bf16 a[4:7], a[168:171], a[112:115], a[4:7]
v_perm_b32 v27, v23, v22, s85
v_perm_b32 v28, v17, v16, s86
v_mfma_f32_16x16x32_bf16 a[8:11], a[176:179], a[112:115], a[8:11]
v_perm_b32 v29, v19, v18, s86
v_perm_b32 v30, v21, v20, s86
v_mfma_f32_16x16x32_bf16 a[8:11], a[180:183], a[116:119], a[8:11]
v_perm_b32 v31, v23, v22, s86
v_mfma_f32_16x16x32_bf16 a[12:15], a[188:191], a[116:119], a[12:15]
buffer_load_dwordx4 v6, s[8:11], s64 offen offset:1024 lds
v_mfma_f32_16x16x32_bf16 a[12:15], a[184:187], a[112:115], a[12:15]
buffer_store_dwordx4 v[24:27], v15, s[24:27], s82 offen offset:2048 sc1
v_mfma_f32_16x16x32_bf16 a[28:31], a[184:187], a[120:123], a[28:31]
v_mfma_f32_16x16x32_bf16 a[28:31], a[188:191], a[124:127], a[28:31]
v_mfma_f32_16x16x32_bf16 a[24:27], a[180:183], a[124:127], a[24:27]
v_mfma_f32_16x16x32_bf16 a[24:27], a[176:179], a[120:123], a[24:27]
v_mfma_f32_16x16x32_bf16 a[20:23], a[168:171], a[120:123], a[20:23]
v_mfma_f32_16x16x32_bf16 a[20:23], a[172:175], a[124:127], a[20:23]
v_mfma_f32_16x16x32_bf16 a[16:19], a[164:167], a[124:127], a[16:19]
v_mfma_f32_16x16x32_bf16 a[16:19], a[160:163], a[120:123], a[16:19]
s_waitcnt lgkmcnt(0)
v_mfma_f32_16x16x32_bf16 v[32:35], a[64:67], a[128:131], v[32:35]
s_waitcnt vmcnt(28)
v_mfma_f32_16x16x32_bf16 v[32:35], a[68:71], a[132:135], v[32:35]
s_barrier
v_mfma_f32_16x16x32_bf16 v[40:43], a[68:71], a[140:143], v[40:43]
ds_read_b128 a[96:99], v9 offset:8192
v_mfma_f32_16x16x32_bf16 v[40:43], a[64:67], a[136:139], v[40:43]
s_xor_b32 s76, s75, 2621440
s_add_u32 s76, s74, s76
v_mfma_f32_16x16x32_bf16 v[48:51], a[64:67], a[144:147], v[48:51]
s_add_u32 m0, s77, 32768
s_add_u32 s64, s76, 0
v_mfma_f32_16x16x32_bf16 v[48:51], a[68:71], a[148:151], v[48:51]
buffer_load_dwordx4 v7, s[56:59], s64 offen lds
v_mfma_f32_16x16x32_bf16 v[56:59], a[68:71], a[156:159], v[56:59]
ds_read_b128 a[100:103], v10 offset:8192
v_mfma_f32_16x16x32_bf16 v[56:59], a[64:67], a[152:155], v[56:59]
buffer_store_dwordx4 v[28:31], v15, s[24:27], s82 offen offset:3072 sc1
v_mfma_f32_16x16x32_bf16 v[60:63], a[72:75], a[152:155], v[60:63]
s_lshl_b32 s52, s7, 4
ds_read_b128 a[104:107], v9 offset:10240
v_and_b32 v22, 3, v1
v_mfma_f32_16x16x32_bf16 v[60:63], a[76:79], a[156:159], v[60:63]
v_lshl_add_u32 v22, v22, 2, s52
v_mfma_f32_16x16x32_bf16 v[52:55], a[76:79], a[148:151], v[52:55]
buffer_load_dword v23, v22, s[40:43], 0 offen sc1
v_mfma_f32_16x16x32_bf16 v[52:55], a[72:75], a[144:147], v[52:55]
buffer_load_dwordx4 v8, s[56:59], s64 offen offset:1024 lds
v_mfma_f32_16x16x32_bf16 v[44:47], a[72:75], a[136:139], v[44:47]
ds_read_b64_tr_b16 a[160:161], v11 offset:49152
ds_read_b64_tr_b16 a[162:163], v11 offset:49664
v_mfma_f32_16x16x32_bf16 v[44:47], a[76:79], a[140:143], v[44:47]
v_mfma_f32_16x16x32_bf16 v[36:39], a[76:79], a[132:135], v[36:39]
v_mfma_f32_16x16x32_bf16 v[36:39], a[72:75], a[128:131], v[36:39]
ds_read_b128 a[108:111], v10 offset:10240
v_mfma_f32_16x16x32_bf16 v[64:67], a[80:83], a[128:131], v[64:67]
s_add_u32 m0, s77, 34816
s_add_u32 s64, s76, 131072
v_mfma_f32_16x16x32_bf16 v[64:67], a[84:87], a[132:135], v[64:67]
v_mfma_f32_16x16x32_bf16 v[72:75], a[84:87], a[140:143], v[72:75]
buffer_load_dwordx4 v7, s[56:59], s64 offen lds
v_mfma_f32_16x16x32_bf16 v[72:75], a[80:83], a[136:139], v[72:75]
ds_read_b64_tr_b16 a[164:165], v11 offset:57344
ds_read_b64_tr_b16 a[166:167], v11 offset:57856
v_mfma_f32_16x16x32_bf16 v[80:83], a[80:83], a[144:147], v[80:83]
v_mfma_f32_16x16x32_bf16 v[80:83], a[84:87], a[148:151], v[80:83]
ds_read_b128 a[112:115], v9 offset:12288
v_mfma_f32_16x16x32_bf16 v[88:91], a[84:87], a[156:159], v[88:91]
v_mfma_f32_16x16x32_bf16 v[88:91], a[80:83], a[152:155], v[88:91]
v_mfma_f32_16x16x32_bf16 v[92:95], a[88:91], a[152:155], v[92:95]
ds_read_b64_tr_b16 a[168:169], v12 offset:49152
ds_read_b64_tr_b16 a[170:171], v12 offset:49664
v_mfma_f32_16x16x32_bf16 v[92:95], a[92:95], a[156:159], v[92:95]
buffer_load_dwordx4 v8, s[56:59], s64 offen offset:1024 lds
v_mfma_f32_16x16x32_bf16 v[84:87], a[92:95], a[148:151], v[84:87]
v_mfma_f32_16x16x32_bf16 v[84:87], a[88:91], a[144:147], v[84:87]
v_mfma_f32_16x16x32_bf16 v[76:79], a[88:91], a[136:139], v[76:79]
ds_read_b128 a[116:119], v10 offset:12288
v_mfma_f32_16x16x32_bf16 v[76:79], a[92:95], a[140:143], v[76:79]
v_mfma_f32_16x16x32_bf16 v[68:71], a[92:95], a[132:135], v[68:71]
v_mfma_f32_16x16x32_bf16 v[68:71], a[88:91], a[128:131], v[68:71]
s_add_u32 m0, s73, 69632
s_add_u32 s64, s71, 524288
s_waitcnt lgkmcnt(6)
v_mfma_f32_16x16x32_bf16 v[96:99], a[96:99], a[128:131], v[96:99]
ds_read_b64_tr_b16 a[172:173], v12 offset:57344
ds_read_b64_tr_b16 a[174:175], v12 offset:57856
v_mfma_f32_16x16x32_bf16 v[96:99], a[100:103], a[132:135], v[96:99]
buffer_load_dwordx4 v5, s[8:11], s64 offen lds
v_mfma_f32_16x16x32_bf16 v[104:107], a[100:103], a[140:143], v[104:107]
ds_read_b128 a[120:123], v9 offset:14336
v_mfma_f32_16x16x32_bf16 v[104:107], a[96:99], a[136:139], v[104:107]
v_mfma_f32_16x16x32_bf16 v[112:115], a[96:99], a[144:147], v[112:115]
v_mfma_f32_16x16x32_bf16 v[112:115], a[100:103], a[148:151], v[112:115]
ds_read_b64_tr_b16 a[176:177], v13 offset:49152
ds_read_b64_tr_b16 a[178:179], v13 offset:49664
v_mfma_f32_16x16x32_bf16 v[120:123], a[100:103], a[156:159], v[120:123]
v_mfma_f32_16x16x32_bf16 v[120:123], a[96:99], a[152:155], v[120:123]
v_mfma_f32_16x16x32_bf16 v[124:127], a[104:107], a[152:155], v[124:127]
buffer_load_dwordx4 v6, s[8:11], s64 offen offset:1024 lds
v_mfma_f32_16x16x32_bf16 v[124:127], a[108:111], a[156:159], v[124:127]
ds_read_b128 a[124:127], v10 offset:14336
v_mfma_f32_16x16x32_bf16 v[116:119], a[108:111], a[148:151], v[116:119]
v_add_u32 v9, 32768, v9
v_add_u32 v10, 32768, v10
v_mfma_f32_16x16x32_bf16 v[116:119], a[104:107], a[144:147], v[116:119]
v_mfma_f32_16x16x32_bf16 v[108:111], a[104:107], a[136:139], v[108:111]
ds_read_b64_tr_b16 a[180:181], v13 offset:57344
ds_read_b64_tr_b16 a[182:183], v13 offset:57856
v_mfma_f32_16x16x32_bf16 v[108:111], a[108:111], a[140:143], v[108:111]
s_add_u32 m0, s73, 71680
s_add_u32 s64, s71, 540672
v_mfma_f32_16x16x32_bf16 v[100:103], a[108:111], a[132:135], v[100:103]
s_waitcnt lgkmcnt(2)
v_mfma_f32_16x16x32_bf16 v[100:103], a[104:107], a[128:131], v[100:103]
buffer_load_dwordx4 v5, s[8:11], s64 offen lds
v_mfma_f32_16x16x32_bf16 v[128:131], a[112:115], a[128:131], v[128:131]
ds_read_b64_tr_b16 a[184:185], v14 offset:49152
ds_read_b64_tr_b16 a[186:187], v14 offset:49664
v_mfma_f32_16x16x32_bf16 v[128:131], a[116:119], a[132:135], v[128:131]
v_mfma_f32_16x16x32_bf16 v[136:139], a[116:119], a[140:143], v[136:139]
ds_read_b64_tr_b16 a[188:189], v14 offset:57344
ds_read_b64_tr_b16 a[190:191], v14 offset:57856
v_mfma_f32_16x16x32_bf16 v[136:139], a[112:115], a[136:139], v[136:139]
v_mfma_f32_16x16x32_bf16 v[144:147], a[112:115], a[144:147], v[144:147]
v_mfma_f32_16x16x32_bf16 v[144:147], a[116:119], a[148:151], v[144:147]
v_mfma_f32_16x16x32_bf16 v[152:155], a[116:119], a[156:159], v[152:155]
buffer_load_dwordx4 v6, s[8:11], s64 offen offset:1024 lds
v_mfma_f32_16x16x32_bf16 v[152:155], a[112:115], a[152:155], v[152:155]
v_mfma_f32_16x16x32_bf16 v[156:159], a[120:123], a[152:155], v[156:159]
v_mfma_f32_16x16x32_bf16 v[156:159], a[124:127], a[156:159], v[156:159]
v_mfma_f32_16x16x32_bf16 v[148:151], a[124:127], a[148:151], v[148:151]
v_mfma_f32_16x16x32_bf16 v[148:151], a[120:123], a[144:147], v[148:151]
s_waitcnt vmcnt(7)
v_mfma_f32_16x16x32_bf16 v[140:143], a[120:123], a[136:139], v[140:143]
v_cmp_gt_u32 vcc, 1, v23
v_mfma_f32_16x16x32_bf16 v[140:143], a[124:127], a[140:143], v[140:143]
v_mfma_f32_16x16x32_bf16 v[132:135], a[124:127], a[132:135], v[132:135]
v_mfma_f32_16x16x32_bf16 v[132:135], a[120:123], a[128:131], v[132:135]
s_waitcnt lgkmcnt(0)
v_mfma_f32_16x16x32_bf16 v[160:163], a[160:163], a[64:67], v[160:163]
s_waitcnt vmcnt(21)
v_mfma_f32_16x16x32_bf16 v[160:163], a[164:167], a[68:71], v[160:163]
s_barrier
v_mfma_f32_16x16x32_bf16 v[164:167], a[172:175], a[68:71], v[164:167]
ds_read_b64_tr_b16 a[128:129], v11 offset:0
ds_read_b64_tr_b16 a[130:131], v11 offset:512
v_mfma_f32_16x16x32_bf16 v[164:167], a[168:171], a[64:67], v[164:167]
s_add_u32 m0, s77, 49152
s_add_u32 s64, s76, 0
v_mfma_f32_16x16x32_bf16 v[168:171], a[176:179], a[64:67], v[168:171]
buffer_load_dwordx4 v7, s[16:19], s64 offen lds
v_mfma_f32_16x16x32_bf16 v[168:171], a[180:183], a[68:71], v[168:171]
s_cbranch_vccnz CK_Z
CK_Z_R:
v_mfma_f32_16x16x32_bf16 v[172:175], a[188:191], a[68:71], v[172:175]
buffer_atomic_add v1, v0, s[24:27], s84 offen offset:0 sc1
v_mfma_f32_16x16x32_bf16 v[172:175], a[184:187], a[64:67], v[172:175]
s_lshl2_add_u32 s52, s95, s3
s_lshl3_add_u32 s54, s52, s7
ds_read_b128 a[64:67], v9 offset:0
v_mfma_f32_16x16x32_bf16 v[188:191], a[184:187], a[72:75], v[188:191]
s_mul_i32 s53, s54, 3072
ds_read_b64_tr_b16 a[132:133], v11 offset:8192
ds_read_b64_tr_b16 a[134:135], v11 offset:8704
v_mfma_f32_16x16x32_bf16 v[188:191], a[188:191], a[76:79], v[188:191]
s_mul_i32 s52, s52, 48
s_add_u32 s52, s52, s7
s_lshl_b32 s52, s52, 10
v_mfma_f32_16x16x32_bf16 v[184:187], a[180:183], a[76:79], v[184:187]
v_min_u32 v18, 23, v1
v_lshrrev_b32 v16, 3, v18
v_mfma_f32_16x16x32_bf16 v[184:187], a[176:179], a[72:75], v[184:187]
buffer_load_dwordx4 v8, s[16:19], s64 offen offset:1024 lds
v_mfma_f32_16x16x32_bf16 v[180:183], a[168:171], a[72:75], v[180:183]
ds_read_b128 a[68:71], v10 offset:0
v_and_b32 v17, 7, v18
v_mfma_f32_16x16x32_bf16 v[180:183], a[172:175], a[76:79], v[180:183]
v_lshlrev_b32 v16, 13, v16
v_lshl_add_u32 v16, v17, 7, v16
v_mfma_f32_16x16x32_bf16 v[176:179], a[164:167], a[76:79], v[176:179]
v_lshlrev_b32 v18, 7, v18
v_min_u32 v17, 6, v1
v_mfma_f32_16x16x32_bf16 v[176:179], a[160:163], a[72:75], v[176:179]
ds_read_b64_tr_b16 a[136:137], v12 offset:0
ds_read_b64_tr_b16 a[138:139], v12 offset:512
v_mfma_f32_16x16x32_bf16 v[192:195], a[160:163], a[80:83], v[192:195]
s_add_u32 m0, s77, 51200
s_add_u32 s64, s76, 131072
v_lshlrev_b32 v17, 7, v17
v_mfma_f32_16x16x32_bf16 v[192:195], a[164:167], a[84:87], v[192:195]
v_mov_b32 v29, 0
v_mfma_f32_16x16x32_bf16 v[196:199], a[172:175], a[84:87], v[196:199]
buffer_load_dwordx4 v7, s[16:19], s64 offen lds
v_mfma_f32_16x16x32_bf16 v[196:199], a[168:171], a[80:83], v[196:199]
ds_read_b128 a[72:75], v9 offset:2048
v_mfma_f32_16x16x32_bf16 v[200:203], a[176:179], a[80:83], v[200:203]
buffer_load_dword a253, v18, s[12:15], s53 offen
v_mfma_f32_16x16x32_bf16 v[200:203], a[180:183], a[84:87], v[200:203]
ds_read_b64_tr_b16 a[140:141], v12 offset:8192
ds_read_b64_tr_b16 a[142:143], v12 offset:8704
v_mfma_f32_16x16x32_bf16 v[204:207], a[188:191], a[84:87], v[204:207]
v_mfma_f32_16x16x32_bf16 v[204:207], a[184:187], a[80:83], v[204:207]
v_mfma_f32_16x16x32_bf16 v[220:223], a[184:187], a[88:91], v[220:223]
ds_read_b128 a[76:79], v10 offset:2048
v_mfma_f32_16x16x32_bf16 v[220:223], a[188:191], a[92:95], v[220:223]
buffer_load_dwordx4 v8, s[16:19], s64 offen offset:1024 lds
v_mfma_f32_16x16x32_bf16 v[216:219], a[180:183], a[92:95], v[216:219]
s_xor_b32 s71, s70, 768
s_add_u32 s71, s68, s71
v_mfma_f32_16x16x32_bf16 v[216:219], a[176:179], a[88:91], v[216:219]
v_mfma_f32_16x16x32_bf16 v[212:215], a[168:171], a[88:91], v[212:215]
ds_read_b64_tr_b16 a[144:145], v13 offset:0
ds_read_b64_tr_b16 a[146:147], v13 offset:512
v_mfma_f32_16x16x32_bf16 v[212:215], a[172:175], a[92:95], v[212:215]
v_mfma_f32_16x16x32_bf16 v[208:211], a[164:167], a[92:95], v[208:211]
v_mfma_f32_16x16x32_bf16 v[208:211], a[160:163], a[88:91], v[208:211]
s_add_u32 m0, s73, 0
s_add_u32 s64, s71, 0
ds_read_b128 a[80:83], v9 offset:4096
v_mfma_f32_16x16x32_bf16 v[224:227], a[160:163], a[96:99], v[224:227]
v_mfma_f32_16x16x32_bf16 v[224:227], a[164:167], a[100:103], v[224:227]
buffer_load_dwordx4 v5, s[8:11], s64 offen lds
v_mfma_f32_16x16x32_bf16 v[228:231], a[172:175], a[100:103], v[228:231]
ds_read_b64_tr_b16 a[148:149], v13 offset:8192
ds_read_b64_tr_b16 a[150:151], v13 offset:8704
v_mfma_f32_16x16x32_bf16 v[228:231], a[168:171], a[96:99], v[228:231]
v_mfma_f32_16x16x32_bf16 v[232:235], a[176:179], a[96:99], v[232:235]
v_mfma_f32_16x16x32_bf16 v[232:235], a[180:183], a[100:103], v[232:235]
ds_read_b128 a[84:87], v10 offset:4096
v_mfma_f32_16x16x32_bf16 v[236:239], a[188:191], a[100:103], v[236:239]
v_mfma_f32_16x16x32_bf16 v[236:239], a[184:187], a[96:99], v[236:239]
v_mfma_f32_16x16x32_bf16 v[252:255], a[184:187], a[104:107], v[252:255]
buffer_load_dwordx4 v6, s[8:11], s64 offen offset:1024 lds
v_mfma_f32_16x16x32_bf16 v[252:255], a[188:191], a[108:111], v[252:255]
ds_read_b64_tr_b16 a[152:153], v14 offset:0
ds_read_b64_tr_b16 a[154:155], v14 offset:512
v_mfma_f32_16x16x32_bf16 v[248:251], a[180:183], a[108:111], v[248:251]
v_mfma_f32_16x16x32_bf16 v[248:251], a[176:179], a[104:107], v[248:251]
v_mfma_f32_16x16x32_bf16 v[244:247], a[168:171], a[104:107], v[244:247]
ds_read_b128 a[88:91], v9 offset:6144
v_mfma_f32_16x16x32_bf16 v[244:247], a[172:175], a[108:111], v[244:247]
s_add_u32 m0, s73, 2048
s_add_u32 s64, s71, 16384
v_mfma_f32_16x16x32_bf16 v[240:243], a[164:167], a[108:111], v[240:243]
v_mfma_f32_16x16x32_bf16 v[240:243], a[160:163], a[104:107], v[240:243]
buffer_load_dwordx4 v5, s[8:11], s64 offen lds
v_mfma_f32_16x16x32_bf16 a[0:3], a[160:163], a[112:115], a[0:3]
ds_read_b64_tr_b16 a[156:157], v14 offset:8192
ds_read_b64_tr_b16 a[158:159], v14 offset:8704
v_mfma_f32_16x16x32_bf16 a[0:3], a[164:167], a[116:119], a[0:3]
v_mfma_f32_16x16x32_bf16 a[4:7], a[172:175], a[116:119], a[4:7]
ds_read_b128 a[92:95], v10 offset:6144
v_mfma_f32_16x16x32_bf16 a[4:7], a[168:171], a[112:115], a[4:7]
v_mfma_f32_16x16x32_bf16 a[8:11], a[176:179], a[112:115], a[8:11]
v_mfma_f32_16x16x32_bf16 a[8:11], a[180:183], a[116:119], a[8:11]
v_mfma_f32_16x16x32_bf16 a[12:15], a[188:191], a[116:119], a[12:15]
buffer_load_dwordx4 v6, s[8:11], s64 offen offset:1024 lds
v_mfma_f32_16x16x32_bf16 a[12:15], a[184:187], a[112:115], a[12:15]
v_mfma_f32_16x16x32_bf16 a[28:31], a[184:187], a[120:123], a[28:31]
v_mfma_f32_16x16x32_bf16 a[28:31], a[188:191], a[124:127], a[28:31]
v_mfma_f32_16x16x32_bf16 a[24:27], a[180:183], a[124:127], a[24:27]
v_mfma_f32_16x16x32_bf16 a[24:27], a[176:179], a[120:123], a[24:27]
v_mfma_f32_16x16x32_bf16 a[20:23], a[168:171], a[120:123], a[20:23]
v_mfma_f32_16x16x32_bf16 a[20:23], a[172:175], a[124:127], a[20:23]
v_mfma_f32_16x16x32_bf16 a[16:19], a[164:167], a[124:127], a[16:19]
v_mfma_f32_16x16x32_bf16 a[16:19], a[160:163], a[120:123], a[16:19]
s_waitcnt lgkmcnt(0)
v_mfma_f32_16x16x32_bf16 v[32:35], a[64:67], a[128:131], v[32:35]
s_waitcnt vmcnt(27)
v_mfma_f32_16x16x32_bf16 v[32:35], a[68:71], a[132:135], v[32:35]
s_barrier
v_mfma_f32_16x16x32_bf16 v[40:43], a[68:71], a[140:143], v[40:43]
ds_read_b128 a[96:99], v9 offset:8192
v_mfma_f32_16x16x32_bf16 v[40:43], a[64:67], a[136:139], v[40:43]
s_xor_b32 s76, s75, 3145728
s_add_u32 s76, s74, s76
v_mfma_f32_16x16x32_bf16 v[48:51], a[64:67], a[144:147], v[48:51]
s_add_u32 m0, s77, 0
s_add_u32 s64, s76, 0
v_mfma_f32_16x16x32_bf16 v[48:51], a[68:71], a[148:151], v[48:51]
buffer_load_dwordx4 v7, s[56:59], s64 offen lds
v_mfma_f32_16x16x32_bf16 v[56:59], a[68:71], a[156:159], v[56:59]
ds_read_b128 a[100:103], v10 offset:8192
v_mfma_f32_16x16x32_bf16 v[56:59], a[64:67], a[152:155], v[56:59]
buffer_load_dword a252, v16, s[20:23], s52 offen
v_mfma_f32_16x16x32_bf16 v[60:63], a[72:75], a[152:155], v[60:63]
ds_read_b128 a[104:107], v9 offset:10240
v_mfma_f32_16x16x32_bf16 v[60:63], a[76:79], a[156:159], v[60:63]
s_add_u32 s52, s52, 24576
s_lshl_b32 s53, s53, 1
s_mul_i32 s54, s54, 896
v_mfma_f32_16x16x32_bf16 v[52:55], a[76:79], a[148:151], v[52:55]
v_mfma_f32_16x16x32_bf16 v[52:55], a[72:75], a[144:147], v[52:55]
buffer_load_dwordx4 v8, s[56:59], s64 offen offset:1024 lds
v_mfma_f32_16x16x32_bf16 v[44:47], a[72:75], a[136:139], v[44:47]
ds_read_b64_tr_b16 a[160:161], v11 offset:16384
ds_read_b64_tr_b16 a[162:163], v11 offset:16896
v_mfma_f32_16x16x32_bf16 v[44:47], a[76:79], a[140:143], v[44:47]
v_mfma_f32_16x16x32_bf16 v[36:39], a[76:79], a[132:135], v[36:39]
v_mfma_f32_16x16x32_bf16 v[36:39], a[72:75], a[128:131], v[36:39]
ds_read_b128 a[108:111], v10 offset:10240
v_mfma_f32_16x16x32_bf16 v[64:67], a[80:83], a[128:131], v[64:67]
s_add_u32 m0, s77, 2048
s_add_u32 s64, s76, 131072
v_mfma_f32_16x16x32_bf16 v[64:67], a[84:87], a[132:135], v[64:67]
v_mfma_f32_16x16x32_bf16 v[72:75], a[84:87], a[140:143], v[72:75]
buffer_load_dwordx4 v7, s[56:59], s64 offen lds
v_mfma_f32_16x16x32_bf16 v[72:75], a[80:83], a[136:139], v[72:75]
ds_read_b64_tr_b16 a[164:165], v11 offset:24576
ds_read_b64_tr_b16 a[166:167], v11 offset:25088
v_mfma_f32_16x16x32_bf16 v[80:83], a[80:83], a[144:147], v[80:83]
v_mfma_f32_16x16x32_bf16 v[80:83], a[84:87], a[148:151], v[80:83]
ds_read_b128 a[112:115], v9 offset:12288
v_mfma_f32_16x16x32_bf16 v[88:91], a[84:87], a[156:159], v[88:91]
v_mfma_f32_16x16x32_bf16 v[88:91], a[80:83], a[152:155], v[88:91]
v_mfma_f32_16x16x32_bf16 v[92:95], a[88:91], a[152:155], v[92:95]
ds_read_b64_tr_b16 a[168:169], v12 offset:16384
ds_read_b64_tr_b16 a[170:171], v12 offset:16896
v_mfma_f32_16x16x32_bf16 v[92:95], a[92:95], a[156:159], v[92:95]
buffer_load_dwordx4 v8, s[56:59], s64 offen offset:1024 lds
v_mfma_f32_16x16x32_bf16 v[84:87], a[92:95], a[148:151], v[84:87]
v_mfma_f32_16x16x32_bf16 v[84:87], a[88:91], a[144:147], v[84:87]
v_mfma_f32_16x16x32_bf16 v[76:79], a[88:91], a[136:139], v[76:79]
ds_read_b128 a[116:119], v10 offset:12288
v_mfma_f32_16x16x32_bf16 v[76:79], a[92:95], a[140:143], v[76:79]
v_mfma_f32_16x16x32_bf16 v[68:71], a[92:95], a[132:135], v[68:71]
v_mfma_f32_16x16x32_bf16 v[68:71], a[88:91], a[128:131], v[68:71]
s_add_u32 m0, s73, 4096
s_add_u32 s64, s71, 524288
s_waitcnt lgkmcnt(6)
v_mfma_f32_16x16x32_bf16 v[96:99], a[96:99], a[128:131], v[96:99]
ds_read_b64_tr_b16 a[172:173], v12 offset:24576
ds_read_b64_tr_b16 a[174:175], v12 offset:25088
v_mfma_f32_16x16x32_bf16 v[96:99], a[100:103], a[132:135], v[96:99]
buffer_load_dwordx4 v5, s[8:11], s64 offen lds
v_mfma_f32_16x16x32_bf16 v[104:107], a[100:103], a[140:143], v[104:107]
ds_read_b128 a[120:123], v9 offset:14336
v_mfma_f32_16x16x32_bf16 v[104:107], a[96:99], a[136:139], v[104:107]
v_mfma_f32_16x16x32_bf16 v[112:115], a[96:99], a[144:147], v[112:115]
v_mfma_f32_16x16x32_bf16 v[112:115], a[100:103], a[148:151], v[112:115]
ds_read_b64_tr_b16 a[176:177], v13 offset:16384
ds_read_b64_tr_b16 a[178:179], v13 offset:16896
v_mfma_f32_16x16x32_bf16 v[120:123], a[100:103], a[156:159], v[120:123]
v_mfma_f32_16x16x32_bf16 v[120:123], a[96:99], a[152:155], v[120:123]
v_mfma_f32_16x16x32_bf16 v[124:127], a[104:107], a[152:155], v[124:127]
buffer_load_dwordx4 v6, s[8:11], s64 offen offset:1024 lds
v_mfma_f32_16x16x32_bf16 v[124:127], a[108:111], a[156:159], v[124:127]
ds_read_b128 a[124:127], v10 offset:14336
v_mfma_f32_16x16x32_bf16 v[116:119], a[108:111], a[148:151], v[116:119]
v_add_u32 v9, 32768, v9
v_add_u32 v10, 32768, v10
v_mfma_f32_16x16x32_bf16 v[116:119], a[104:107], a[144:147], v[116:119]
v_mfma_f32_16x16x32_bf16 v[108:111], a[104:107], a[136:139], v[108:111]
ds_read_b64_tr_b16 a[180:181], v13 offset:24576
ds_read_b64_tr_b16 a[182:183], v13 offset:25088
v_mfma_f32_16x16x32_bf16 v[108:111], a[108:111], a[140:143], v[108:111]
s_add_u32 m0, s73, 6144
s_add_u32 s64, s71, 540672
v_mfma_f32_16x16x32_bf16 v[100:103], a[108:111], a[132:135], v[100:103]
s_waitcnt lgkmcnt(2)
v_mfma_f32_16x16x32_bf16 v[100:103], a[104:107], a[128:131], v[100:103]
buffer_load_dwordx4 v5, s[8:11], s64 offen lds
v_mfma_f32_16x16x32_bf16 v[128:131], a[112:115], a[128:131], v[128:131]
ds_read_b64_tr_b16 a[184:185], v14 offset:16384
ds_read_b64_tr_b16 a[186:187], v14 offset:16896
v_mfma_f32_16x16x32_bf16 v[128:131], a[116:119], a[132:135], v[128:131]
v_mfma_f32_16x16x32_bf16 v[136:139], a[116:119], a[140:143], v[136:139]
ds_read_b64_tr_b16 a[188:189], v14 offset:24576
ds_read_b64_tr_b16 a[190:191], v14 offset:25088
v_mfma_f32_16x16x32_bf16 v[136:139], a[112:115], a[136:139], v[136:139]
v_mfma_f32_16x16x32_bf16 v[144:147], a[112:115], a[144:147], v[144:147]
v_mfma_f32_16x16x32_bf16 v[144:147], a[116:119], a[148:151], v[144:147]
v_mfma_f32_16x16x32_bf16 v[152:155], a[116:119], a[156:159], v[152:155]
buffer_load_dwordx4 v6, s[8:11], s64 offen offset:1024 lds
v_mfma_f32_16x16x32_bf16 v[152:155], a[112:115], a[152:155], v[152:155]
v_mfma_f32_16x16x32_bf16 v[156:159], a[120:123], a[152:155], v[156:159]
v_mfma_f32_16x16x32_bf16 v[156:159], a[124:127], a[156:159], v[156:159]
v_mfma_f32_16x16x32_bf16 v[148:151], a[124:127], a[148:151], v[148:151]
v_mfma_f32_16x16x32_bf16 v[148:151], a[120:123], a[144:147], v[148:151]
v_mfma_f32_16x16x32_bf16 v[140:143], a[120:123], a[136:139], v[140:143]
v_mfma_f32_16x16x32_bf16 v[140:143], a[124:127], a[140:143], v[140:143]
v_mfma_f32_16x16x32_bf16 v[132:135], a[124:127], a[132:135], v[132:135]
v_mfma_f32_16x16x32_bf16 v[132:135], a[120:123], a[128:131], v[132:135]
s_waitcnt lgkmcnt(0)
v_mfma_f32_16x16x32_bf16 v[160:163], a[160:163], a[64:67], v[160:163]
s_waitcnt vmcnt(19)
v_mfma_f32_16x16x32_bf16 v[160:163], a[164:167], a[68:71], v[160:163]
s_barrier
v_mfma_f32_16x16x32_bf16 v[164:167], a[172:175], a[68:71], v[164:167]
ds_read_b64_tr_b16 a[128:129], v11 offset:32768
ds_read_b64_tr_b16 a[130:131], v11 offset:33280
v_mfma_f32_16x16x32_bf16 v[164:167], a[168:171], a[64:67], v[164:167]
s_add_u32 m0, s77, 16384
s_add_u32 s64, s76, 0
v_mfma_f32_16x16x32_bf16 v[168:171], a[176:179], a[64:67], v[168:171]
buffer_load_dwordx4 v7, s[16:19], s64 offen lds
v_mfma_f32_16x16x32_bf16 v[168:171], a[180:183], a[68:71], v[168:171]
v_mfma_f32_16x16x32_bf16 v[172:175], a[188:191], a[68:71], v[172:175]
v_mfma_f32_16x16x32_bf16 v[172:175], a[184:187], a[64:67], v[172:175]
ds_read_b128 a[64:67], v9 offset:0
v_mfma_f32_16x16x32_bf16 v[188:191], a[184:187], a[72:75], v[188:191]
ds_read_b64_tr_b16 a[132:133], v11 offset:40960
ds_read_b64_tr_b16 a[134:135], v11 offset:41472
v_mfma_f32_16x16x32_bf16 v[188:191], a[188:191], a[76:79], v[188:191]
v_mfma_f32_16x16x32_bf16 v[184:187], a[180:183], a[76:79], v[184:187]
v_mfma_f32_16x16x32_bf16 v[184:187], a[176:179], a[72:75], v[184:187]
buffer_load_dwordx4 v8, s[16:19], s64 offen offset:1024 lds
v_mfma_f32_16x16x32_bf16 v[180:183], a[168:171], a[72:75], v[180:183]
ds_read_b128 a[68:71], v10 offset:0
v_mfma_f32_16x16x32_bf16 v[180:183], a[172:175], a[76:79], v[180:183]
v_mfma_f32_16x16x32_bf16 v[176:179], a[164:167], a[76:79], v[176:179]
v_mfma_f32_16x16x32_bf16 v[176:179], a[160:163], a[72:75], v[176:179]
ds_read_b64_tr_b16 a[136:137], v12 offset:32768
ds_read_b64_tr_b16 a[138:139], v12 offset:33280
v_mfma_f32_16x16x32_bf16 v[192:195], a[160:163], a[80:83], v[192:195]
s_add_u32 m0, s77, 18432
s_add_u32 s64, s76, 131072
v_mfma_f32_16x16x32_bf16 v[192:195], a[164:167], a[84:87], v[192:195]
v_mfma_f32_16x16x32_bf16 v[196:199], a[172:175], a[84:87], v[196:199]
buffer_load_dwordx4 v7, s[16:19], s64 offen lds
v_mfma_f32_16x16x32_bf16 v[196:199], a[168:171], a[80:83], v[196:199]
ds_read_b128 a[72:75], v9 offset:2048
v_mfma_f32_16x16x32_bf16 v[200:203], a[176:179], a[80:83], v[200:203]
v_mfma_f32_16x16x32_bf16 v[200:203], a[180:183], a[84:87], v[200:203]
ds_read_b64_tr_b16 a[140:141], v12 offset:40960
ds_read_b64_tr_b16 a[142:143], v12 offset:41472
v_mfma_f32_16x16x32_bf16 v[204:207], a[188:191], a[84:87], v[204:207]
v_mfma_f32_16x16x32_bf16 v[204:207], a[184:187], a[80:83], v[204:207]
v_mfma_f32_16x16x32_bf16 v[220:223], a[184:187], a[88:91], v[220:223]
L_PAD2:
s_cbranch_execz L_PAD6
ds_read_b128 a[76:79], v10 offset:2048
v_mfma_f32_16x16x32_bf16 v[220:223], a[188:191], a[92:95], v[220:223]
buffer_load_dwordx4 v8, s[16:19], s64 offen offset:1024 lds
v_mfma_f32_16x16x32_bf16 v[216:219], a[180:183], a[92:95], v[216:219]
s_xor_b32 s71, s70, 896
s_add_u32 s71, s68, s71
v_mfma_f32_16x16x32_bf16 v[216:219], a[176:179], a[88:91], v[216:219]
v_mfma_f32_16x16x32_bf16 v[212:215], a[168:171], a[88:91], v[212:215]
ds_read_b64_tr_b16 a[144:145], v13 offset:32768
ds_read_b64_tr_b16 a[146:147], v13 offset:33280
v_mfma_f32_16x16x32_bf16 v[212:215], a[172:175], a[92:95], v[212:215]
v_mfma_f32_16x16x32_bf16 v[208:211], a[164:167], a[92:95], v[208:211]
v_mfma_f32_16x16x32_bf16 v[208:211], a[160:163], a[88:91], v[208:211]
s_add_u32 m0, s73, 32768
s_add_u32 s64, s71, 0
ds_read_b128 a[80:83], v9 offset:4096
v_mfma_f32_16x16x32_bf16 v[224:227], a[160:163], a[96:99], v[224:227]
v_mfma_f32_16x16x32_bf16 v[224:227], a[164:167], a[100:103], v[224:227]
buffer_load_dwordx4 v5, s[8:11], s64 offen lds
v_mfma_f32_16x16x32_bf16 v[228:231], a[172:175], a[100:103], v[228:231]
ds_read_b64_tr_b16 a[148:149], v13 offset:40960
ds_read_b64_tr_b16 a[150:151], v13 offset:41472
v_mfma_f32_16x16x32_bf16 v[228:231], a[168:171], a[96:99], v[228:231]
v_mfma_f32_16x16x32_bf16 v[232:235], a[176:179], a[96:99], v[232:235]
v_mfma_f32_16x16x32_bf16 v[232:235], a[180:183], a[100:103], v[232:235]
ds_read_b128 a[84:87], v10 offset:4096
v_mfma_f32_16x16x32_bf16 v[236:239], a[188:191], a[100:103], v[236:239]
v_mfma_f32_16x16x32_bf16 v[236:239], a[184:187], a[96:99], v[236:239]
v_mfma_f32_16x16x32_bf16 v[252:255], a[184:187], a[104:107], v[252:255]
buffer_load_dwordx4 v6, s[8:11], s64 offen offset:1024 lds
v_mfma_f32_16x16x32_bf16 v[252:255], a[188:191], a[108:111], v[252:255]
ds_read_b64_tr_b16 a[152:153], v14 offset:32768
ds_read_b64_tr_b16 a[154:155], v14 offset:33280
v_mfma_f32_16x16x32_bf16 v[248:251], a[180:183], a[108:111], v[248:251]
v_mfma_f32_16x16x32_bf16 v[248:251], a[176:179], a[104:107], v[248:251]
v_mfma_f32_16x16x32_bf16 v[244:247], a[168:171], a[104:107], v[244:247]
ds_read_b128 a[88:91], v9 offset:6144
v_mfma_f32_16x16x32_bf16 v[244:247], a[172:175], a[108:111], v[244:247]
s_add_u32 m0, s73, 34816
s_add_u32 s64, s71, 16384
v_mfma_f32_16x16x32_bf16 v[240:243], a[164:167], a[108:111], v[240:243]
v_mfma_f32_16x16x32_bf16 v[240:243], a[160:163], a[104:107], v[240:243]
buffer_load_dwordx4 v5, s[8:11], s64 offen lds
v_mfma_f32_16x16x32_bf16 a[0:3], a[160:163], a[112:115], a[0:3]
ds_read_b64_tr_b16 a[156:157], v14 offset:40960
ds_read_b64_tr_b16 a[158:159], v14 offset:41472
v_mfma_f32_16x16x32_bf16 a[0:3], a[164:167], a[116:119], a[0:3]
v_mfma_f32_16x16x32_bf16 a[4:7], a[172:175], a[116:119], a[4:7]
ds_read_b128 a[92:95], v10 offset:6144
v_mfma_f32_16x16x32_bf16 a[4:7], a[168:171], a[112:115], a[4:7]
v_mfma_f32_16x16x32_bf16 a[8:11], a[176:179], a[112:115], a[8:11]
v_mfma_f32_16x16x32_bf16 a[8:11], a[180:183], a[116:119], a[8:11]
v_mfma_f32_16x16x32_bf16 a[12:15], a[188:191], a[116:119], a[12:15]
buffer_load_dwordx4 v6, s[8:11], s64 offen offset:1024 lds
v_mfma_f32_16x16x32_bf16 a[12:15], a[184:187], a[112:115], a[12:15]
v_mfma_f32_16x16x32_bf16 a[28:31], a[184:187], a[120:123], a[28:31]
v_mfma_f32_16x16x32_bf16 a[28:31], a[188:191], a[124:127], a[28:31]
v_mfma_f32_16x16x32_bf16 a[24:27], a[180:183], a[124:127], a[24:27]
v_mfma_f32_16x16x32_bf16 a[24:27], a[176:179], a[120:123], a[24:27]
v_mfma_f32_16x16x32_bf16 a[20:23], a[168:171], a[120:123], a[20:23]
v_mfma_f32_16x16x32_bf16 a[20:23], a[172:175], a[124:127], a[20:23]
v_mfma_f32_16x16x32_bf16 a[16:19], a[164:167], a[124:127], a[16:19]
v_mfma_f32_16x16x32_bf16 a[16:19], a[160:163], a[120:123], a[16:19]
s_waitcnt lgkmcnt(0)
v_mfma_f32_16x16x32_bf16 v[32:35], a[64:67], a[128:131], v[32:35]
s_waitcnt vmcnt(21)
v_mfma_f32_16x16x32_bf16 v[32:35], a[68:71], a[132:135], v[32:35]
s_barrier
v_mfma_f32_16x16x32_bf16 v[40:43], a[68:71], a[140:143], v[40:43]
ds_read_b128 a[96:99], v9 offset:8192
v_mfma_f32_16x16x32_bf16 v[40:43], a[64:67], a[136:139], v[40:43]
s_xor_b32 s76, s75, 3670016
s_add_u32 s76, s74, s76
v_mfma_f32_16x16x32_bf16 v[48:51], a[64:67], a[144:147], v[48:51]
s_add_u32 m0, s77, 32768
s_add_u32 s64, s76, 0
v_mfma_f32_16x16x32_bf16 v[48:51], a[68:71], a[148:151], v[48:51]
buffer_load_dwordx4 v7, s[56:59], s64 offen lds
v_mfma_f32_16x16x32_bf16 v[56:59], a[68:71], a[156:159], v[56:59]
ds_read_b128 a[100:103], v10 offset:8192
v_mfma_f32_16x16x32_bf16 v[56:59], a[64:67], a[152:155], v[56:59]
buffer_load_dword a252, v16, s[20:23], s52 offen
v_mfma_f32_16x16x32_bf16 v[60:63], a[72:75], a[152:155], v[60:63]
s_lshr_b32 s52, s2, 1
s_lshl2_add_u32 s52, s52, s3
ds_read_b128 a[104:107], v9 offset:10240
v_mfma_f32_16x16x32_bf16 v[60:63], a[76:79], a[156:159], v[60:63]
s_mul_i32 s52, s52, 9216
s_and_b32 s53, s2, 1
s_lshl_b32 s53, s53, 9
v_mfma_f32_16x16x32_bf16 v[52:55], a[76:79], a[148:151], v[52:55]
s_add_u32 s52, s52, s53
v_min_u32 v18, 39, v1
v_and_b32 v16, 7, v18
v_mfma_f32_16x16x32_bf16 v[52:55], a[72:75], a[144:147], v[52:55]
buffer_load_dwordx4 v8, s[56:59], s64 offen offset:1024 lds
v_mfma_f32_16x16x32_bf16 v[44:47], a[72:75], a[136:139], v[44:47]
ds_read_b64_tr_b16 a[160:161], v11 offset:49152
ds_read_b64_tr_b16 a[162:163], v11 offset:49664
v_mfma_f32_16x16x32_bf16 v[44:47], a[76:79], a[140:143], v[44:47]
v_mul_u32_u24 v16, 1152, v16
v_lshrrev_b32 v18, 3, v18
v_mfma_f32_16x16x32_bf16 v[36:39], a[76:79], a[132:135], v[36:39]
v_lshl_add_u32 v16, v18, 7, v16
v_mfma_f32_16x16x32_bf16 v[36:39], a[72:75], a[128:131], v[36:39]
ds_read_b128 a[108:111], v10 offset:10240
v_mfma_f32_16x16x32_bf16 v[64:67], a[80:83], a[128:131], v[64:67]
s_add_u32 m0, s77, 34816
s_add_u32 s64, s76, 131072
v_mfma_f32_16x16x32_bf16 v[64:67], a[84:87], a[132:135], v[64:67]
v_mfma_f32_16x16x32_bf16 v[72:75], a[84:87], a[140:143], v[72:75]
buffer_load_dwordx4 v7, s[56:59], s64 offen lds
v_mfma_f32_16x16x32_bf16 v[72:75], a[80:83], a[136:139], v[72:75]
ds_read_b64_tr_b16 a[164:165], v11 offset:57344
ds_read_b64_tr_b16 a[166:167], v11 offset:57856
v_mfma_f32_16x16x32_bf16 v[80:83], a[80:83], a[144:147], v[80:83]
v_mfma_f32_16x16x32_bf16 v[80:83], a[84:87], a[148:151], v[80:83]
ds_read_b128 a[112:115], v9 offset:12288
v_mfma_f32_16x16x32_bf16 v[88:91], a[84:87], a[156:159], v[88:91]
v_mfma_f32_16x16x32_bf16 v[88:91], a[80:83], a[152:155], v[88:91]
v_mfma_f32_16x16x32_bf16 v[92:95], a[88:91], a[152:155], v[92:95]
ds_read_b64_tr_b16 a[168:169], v12 offset:49152
ds_read_b64_tr_b16 a[170:171], v12 offset:49664
v_mfma_f32_16x16x32_bf16 v[92:95], a[92:95], a[156:159], v[92:95]
buffer_load_dwordx4 v8, s[56:59], s64 offen offset:1024 lds
v_mfma_f32_16x16x32_bf16 v[84:87], a[92:95], a[148:151], v[84:87]
v_mfma_f32_16x16x32_bf16 v[84:87], a[88:91], a[144:147], v[84:87]
v_mfma_f32_16x16x32_bf16 v[76:79], a[88:91], a[136:139], v[76:79]
ds_read_b128 a[116:119], v10 offset:12288
v_mfma_f32_16x16x32_bf16 v[76:79], a[92:95], a[140:143], v[76:79]
v_mfma_f32_16x16x32_bf16 v[68:71], a[92:95], a[132:135], v[68:71]
v_mfma_f32_16x16x32_bf16 v[68:71], a[88:91], a[128:131], v[68:71]
s_add_u32 m0, s73, 36864
s_add_u32 s64, s71, 524288
s_waitcnt lgkmcnt(6)
v_mfma_f32_16x16x32_bf16 v[96:99], a[96:99], a[128:131], v[96:99]
ds_read_b64_tr_b16 a[172:173], v12 offset:57344
ds_read_b64_tr_b16 a[174:175], v12 offset:57856
v_mfma_f32_16x16x32_bf16 v[96:99], a[100:103], a[132:135], v[96:99]
buffer_load_dwordx4 v5, s[8:11], s64 offen lds
v_mfma_f32_16x16x32_bf16 v[104:107], a[100:103], a[140:143], v[104:107]
ds_read_b128 a[120:123], v9 offset:14336
v_mfma_f32_16x16x32_bf16 v[104:107], a[96:99], a[136:139], v[104:107]
v_mfma_f32_16x16x32_bf16 v[112:115], a[96:99], a[144:147], v[112:115]
v_mfma_f32_16x16x32_bf16 v[112:115], a[100:103], a[148:151], v[112:115]
ds_read_b64_tr_b16 a[176:177], v13 offset:49152
ds_read_b64_tr_b16 a[178:179], v13 offset:49664
v_mfma_f32_16x16x32_bf16 v[120:123], a[100:103], a[156:159], v[120:123]
v_mfma_f32_16x16x32_bf16 v[120:123], a[96:99], a[152:155], v[120:123]
v_mfma_f32_16x16x32_bf16 v[124:127], a[104:107], a[152:155], v[124:127]
buffer_load_dwordx4 v6, s[8:11], s64 offen offset:1024 lds
v_mfma_f32_16x16x32_bf16 v[124:127], a[108:111], a[156:159], v[124:127]
ds_read_b128 a[124:127], v10 offset:14336
v_mfma_f32_16x16x32_bf16 v[116:119], a[108:111], a[148:151], v[116:119]
v_add_u32 v9, -65536, v9
v_add_u32 v10, -65536, v10
v_mfma_f32_16x16x32_bf16 v[116:119], a[104:107], a[144:147], v[116:119]
buffer_load_dword v30, v29, s[24:27], s89 offen sc1
v_mfma_f32_16x16x32_bf16 v[108:111], a[104:107], a[136:139], v[108:111]
ds_read_b64_tr_b16 a[180:181], v13 offset:57344
ds_read_b64_tr_b16 a[182:183], v13 offset:57856
v_mfma_f32_16x16x32_bf16 v[108:111], a[108:111], a[140:143], v[108:111]
s_add_u32 m0, s73, 38912
s_add_u32 s64, s71, 540672
v_mfma_f32_16x16x32_bf16 v[100:103], a[108:111], a[132:135], v[100:103]
s_waitcnt lgkmcnt(2)
v_mfma_f32_16x16x32_bf16 v[100:103], a[104:107], a[128:131], v[100:103]
buffer_load_dwordx4 v5, s[8:11], s64 offen lds
v_mfma_f32_16x16x32_bf16 v[128:131], a[112:115], a[128:131], v[128:131]
ds_read_b64_tr_b16 a[184:185], v14 offset:49152
ds_read_b64_tr_b16 a[186:187], v14 offset:49664
v_mfma_f32_16x16x32_bf16 v[128:131], a[116:119], a[132:135], v[128:131]
v_mfma_f32_16x16x32_bf16 v[136:139], a[116:119], a[140:143], v[136:139]
ds_read_b64_tr_b16 a[188:189], v14 offset:57344
ds_read_b64_tr_b16 a[190:191], v14 offset:57856
v_mfma_f32_16x16x32_bf16 v[136:139], a[112:115], a[136:139], v[136:139]
v_mfma_f32_16x16x32_bf16 v[144:147], a[112:115], a[144:147], v[144:147]
v_mfma_f32_16x16x32_bf16 v[144:147], a[116:119], a[148:151], v[144:147]
v_mfma_f32_16x16x32_bf16 v[152:155], a[116:119], a[156:159], v[152:155]
buffer_load_dwordx4 v6, s[8:11], s64 offen offset:1024 lds
v_mfma_f32_16x16x32_bf16 v[152:155], a[112:115], a[152:155], v[152:155]
v_mfma_f32_16x16x32_bf16 v[156:159], a[120:123], a[152:155], v[156:159]
v_mfma_f32_16x16x32_bf16 v[156:159], a[124:127], a[156:159], v[156:159]
v_mfma_f32_16x16x32_bf16 v[148:151], a[124:127], a[148:151], v[148:151]
v_mfma_f32_16x16x32_bf16 v[148:151], a[120:123], a[144:147], v[148:151]
v_mfma_f32_16x16x32_bf16 v[140:143], a[120:123], a[136:139], v[140:143]
v_mfma_f32_16x16x32_bf16 v[140:143], a[124:127], a[140:143], v[140:143]
v_mfma_f32_16x16x32_bf16 v[132:135], a[124:127], a[132:135], v[132:135]
v_mfma_f32_16x16x32_bf16 v[132:135], a[120:123], a[128:131], v[132:135]
s_waitcnt lgkmcnt(0)
v_mfma_f32_16x16x32_bf16 v[160:163], a[160:163], a[64:67], v[160:163]
s_waitcnt vmcnt(18)
v_mfma_f32_16x16x32_bf16 v[160:163], a[164:167], a[68:71], v[160:163]
s_barrier
v_mfma_f32_16x16x32_bf16 v[164:167], a[172:175], a[68:71], v[164:167]
ds_read_b64_tr_b16 a[128:129], v11 offset:0
ds_read_b64_tr_b16 a[130:131], v11 offset:512
v_mfma_f32_16x16x32_bf16 v[164:167], a[168:171], a[64:67], v[164:167]
s_add_u32 m0, s77, 49152
s_add_u32 s64, s76, 0
v_mfma_f32_16x16x32_bf16 v[168:171], a[176:179], a[64:67], v[168:171]
buffer_load_dwordx4 v7, s[16:19], s64 offen lds
v_mfma_f32_16x16x32_bf16 v[168:171], a[180:183], a[68:71], v[168:171]
v_mfma_f32_16x16x32_bf16 v[172:175], a[188:191], a[68:71], v[172:175]
v_mfma_f32_16x16x32_bf16 v[172:175], a[184:187], a[64:67], v[172:175]
ds_read_b128 a[64:67], v9 offset:0
v_mfma_f32_16x16x32_bf16 v[188:191], a[184:187], a[72:75], v[188:191]
ds_read_b64_tr_b16 a[132:133], v11 offset:8192
ds_read_b64_tr_b16 a[134:135], v11 offset:8704
v_mfma_f32_16x16x32_bf16 v[188:191], a[188:191], a[76:79], v[188:191]
v_mfma_f32_16x16x32_bf16 v[184:187], a[180:183], a[76:79], v[184:187]
v_mfma_f32_16x16x32_bf16 v[184:187], a[176:179], a[72:75], v[184:187]
buffer_load_dwordx4 v8, s[16:19], s64 offen offset:1024 lds
v_mfma_f32_16x16x32_bf16 v[180:183], a[168:171], a[72:75], v[180:183]
ds_read_b128 a[68:71], v10 offset:0
v_mfma_f32_16x16x32_bf16 v[180:183], a[172:175], a[76:79], v[180:183]
v_mfma_f32_16x16x32_bf16 v[176:179], a[164:167], a[76:79], v[176:179]
v_mfma_f32_16x16x32_bf16 v[176:179], a[160:163], a[72:75], v[176:179]
ds_read_b64_tr_b16 a[136:137], v12 offset:0
ds_read_b64_tr_b16 a[138:139], v12 offset:512
v_mfma_f32_16x16x32_bf16 v[192:195], a[160:163], a[80:83], v[192:195]
s_add_u32 m0, s77, 51200
s_add_u32 s64, s76, 131072
v_mfma_f32_16x16x32_bf16 v[192:195], a[164:167], a[84:87], v[192:195]
v_mfma_f32_16x16x32_bf16 v[196:199], a[172:175], a[84:87], v[196:199]
buffer_load_dwordx4 v7, s[16:19], s64 offen lds
v_mfma_f32_16x16x32_bf16 v[196:199], a[168:171], a[80:83], v[196:199]
ds_read_b128 a[72:75], v9 offset:2048
v_mfma_f32_16x16x32_bf16 v[200:203], a[176:179], a[80:83], v[200:203]
v_mfma_f32_16x16x32_bf16 v[200:203], a[180:183], a[84:87], v[200:203]
ds_read_b64_tr_b16 a[140:141], v12 offset:8192
ds_read_b64_tr_b16 a[142:143], v12 offset:8704
v_mfma_f32_16x16x32_bf16 v[204:207], a[188:191], a[84:87], v[204:207]
v_mfma_f32_16x16x32_bf16 v[204:207], a[184:187], a[80:83], v[204:207]
v_mfma_f32_16x16x32_bf16 v[220:223], a[184:187], a[88:91], v[220:223]
ds_read_b128 a[76:79], v10 offset:2048
v_mfma_f32_16x16x32_bf16 v[220:223], a[188:191], a[92:95], v[220:223]
buffer_load_dwordx4 v8, s[16:19], s64 offen offset:1024 lds
v_mfma_f32_16x16x32_bf16 v[216:219], a[180:183], a[92:95], v[216:219]
s_lshl_b32 s70, s93, 7
s_mul_i32 s68, s66, 36864
s_mul_i32 s69, s67, 36864
v_mfma_f32_16x16x32_bf16 v[216:219], a[176:179], a[88:91], v[216:219]
v_lshrrev_b32 v31, 3, v1
v_lshl_add_u32 v5, v31, 7, v5
v_mfma_f32_16x16x32_bf16 v[212:215], a[168:171], a[88:91], v[212:215]
v_lshl_add_u32 v6, v31, 7, v6
v_add_u32 v6, 1024, v6
v_mfma_f32_16x16x32_bf16 v[212:215], a[172:175], a[92:95], v[212:215]
s_mov_b32 s65, 1024
s_add_u32 s71, s68, s65
s_add_u32 s72, s69, s65
v_mfma_f32_16x16x32_bf16 v[208:211], a[164:167], a[92:95], v[208:211]
ds_read_b64_tr_b16 a[144:145], v13 offset:0
ds_read_b64_tr_b16 a[146:147], v13 offset:512
v_mfma_f32_16x16x32_bf16 v[208:211], a[160:163], a[88:91], v[208:211]
s_add_u32 m0, s73, 65536
s_add_u32 s64, s71, 0
ds_read_b128 a[80:83], v9 offset:4096
v_mfma_f32_16x16x32_bf16 v[224:227], a[160:163], a[96:99], v[224:227]
v_mfma_f32_16x16x32_bf16 v[224:227], a[164:167], a[100:103], v[224:227]
buffer_load_dwordx4 v5, s[12:15], s64 offen lds
v_mfma_f32_16x16x32_bf16 v[228:231], a[172:175], a[100:103], v[228:231]
ds_read_b64_tr_b16 a[148:149], v13 offset:8192
ds_read_b64_tr_b16 a[150:151], v13 offset:8704
v_mfma_f32_16x16x32_bf16 v[228:231], a[168:171], a[96:99], v[228:231]
v_mfma_f32_16x16x32_bf16 v[232:235], a[176:179], a[96:99], v[232:235]
v_mfma_f32_16x16x32_bf16 v[232:235], a[180:183], a[100:103], v[232:235]
ds_read_b128 a[84:87], v10 offset:4096
v_mfma_f32_16x16x32_bf16 v[236:239], a[188:191], a[100:103], v[236:239]
v_mfma_f32_16x16x32_bf16 v[236:239], a[184:187], a[96:99], v[236:239]
v_mfma_f32_16x16x32_bf16 v[252:255], a[184:187], a[104:107], v[252:255]
buffer_load_dwordx4 v6, s[12:15], s64 offen offset:1024 lds
v_mfma_f32_16x16x32_bf16 v[252:255], a[188:191], a[108:111], v[252:255]
ds_read_b64_tr_b16 a[152:153], v14 offset:0
ds_read_b64_tr_b16 a[154:155], v14 offset:512
v_mfma_f32_16x16x32_bf16 v[248:251], a[180:183], a[108:111], v[248:251]
v_mfma_f32_16x16x32_bf16 v[248:251], a[176:179], a[104:107], v[248:251]
v_mfma_f32_16x16x32_bf16 v[244:247], a[168:171], a[104:107], v[244:247]
ds_read_b128 a[88:91], v9 offset:6144
v_mfma_f32_16x16x32_bf16 v[244:247], a[172:175], a[108:111], v[244:247]
s_add_u32 m0, s73, 67584
s_add_u32 s64, s71, 18432
v_mfma_f32_16x16x32_bf16 v[240:243], a[164:167], a[108:111], v[240:243]
v_mfma_f32_16x16x32_bf16 v[240:243], a[160:163], a[104:107], v[240:243]
buffer_load_dwordx4 v5, s[12:15], s64 offen lds
v_mfma_f32_16x16x32_bf16 a[0:3], a[160:163], a[112:115], a[0:3]
ds_read_b64_tr_b16 a[156:157], v14 offset:8192
ds_read_b64_tr_b16 a[158:159], v14 offset:8704
v_mfma_f32_16x16x32_bf16 a[0:3], a[164:167], a[116:119], a[0:3]
v_mfma_f32_16x16x32_bf16 a[4:7], a[172:175], a[116:119], a[4:7]
s_waitcnt vmcnt(9)
ds_read_b128 a[92:95], v10 offset:6144
v_mfma_f32_16x16x32_bf16 a[4:7], a[168:171], a[112:115], a[4:7]
v_cmp_gt_u32 vcc, 18, v30
v_mfma_f32_16x16x32_bf16 a[8:11], a[176:179], a[112:115], a[8:11]
v_mfma_f32_16x16x32_bf16 a[8:11], a[180:183], a[116:119], a[8:11]
v_mfma_f32_16x16x32_bf16 a[12:15], a[188:191], a[116:119], a[12:15]
buffer_load_dwordx4 v6, s[12:15], s64 offen offset:1024 lds
v_mfma_f32_16x16x32_bf16 a[12:15], a[184:187], a[112:115], a[12:15]
v_mfma_f32_16x16x32_bf16 a[28:31], a[184:187], a[120:123], a[28:31]
s_cbranch_vccnz CK_WA
CK_WA_R:
v_mfma_f32_16x16x32_bf16 a[28:31], a[188:191], a[124:127], a[28:31]
v_mfma_f32_16x16x32_bf16 a[24:27], a[180:183], a[124:127], a[24:27]
v_mfma_f32_16x16x32_bf16 a[24:27], a[176:179], a[120:123], a[24:27]
v_mfma_f32_16x16x32_bf16 a[20:23], a[168:171], a[120:123], a[20:23]
v_mfma_f32_16x16x32_bf16 a[20:23], a[172:175], a[124:127], a[20:23]
v_mfma_f32_16x16x32_bf16 a[16:19], a[164:167], a[124:127], a[16:19]
v_mfma_f32_16x16x32_bf16 a[16:19], a[160:163], a[120:123], a[16:19]
s_waitcnt lgkmcnt(0)
v_mfma_f32_16x16x32_bf16 v[32:35], a[64:67], a[128:131], v[32:35]
s_waitcnt vmcnt(22)
v_mfma_f32_16x16x32_bf16 v[32:35], a[68:71], a[132:135], v[32:35]
s_barrier
v_mfma_f32_16x16x32_bf16 v[40:43], a[68:71], a[140:143], v[40:43]
ds_read_b128 a[96:99], v9 offset:8192
v_mfma_f32_16x16x32_bf16 v[40:43], a[64:67], a[136:139], v[40:43]
s_lshl_b32 s77, s3, 11
s_lshl_b32 s74, s3, 9
s_add_u32 s74, s74, s4
v_mfma_f32_16x16x32_bf16 v[48:51], a[64:67], a[144:147], v[48:51]
s_lshl_b32 s74, s74, 8
v_mfma_f32_16x16x32_bf16 v[48:51], a[68:71], a[148:151], v[48:51]
s_mov_b32 s75, 8
s_lshl_b32 s76, s75, 19
s_add_u32 s76, s76, s74
v_mfma_f32_16x16x32_bf16 v[56:59], a[68:71], a[156:159], v[56:59]
s_lshl_b32 s79, s75, 13
s_add_u32 s79, s79, s78
ds_read_b128 a[100:103], v10 offset:8192
v_mfma_f32_16x16x32_bf16 v[56:59], a[64:67], a[152:155], v[56:59]
s_add_u32 m0, s77, 0
s_add_u32 s64, s76, 0
v_mfma_f32_16x16x32_bf16 v[60:63], a[72:75], a[152:155], v[60:63]
buffer_load_dwordx4 v7, s[20:23], s64 offen lds
v_mfma_f32_16x16x32_bf16 v[60:63], a[76:79], a[156:159], v[60:63]
ds_read_b128 a[104:107], v9 offset:10240
v_mfma_f32_16x16x32_bf16 v[52:55], a[76:79], a[148:151], v[52:55]
buffer_load_dword a252, v16, s[32:35], s52 offen
v_mfma_f32_16x16x32_bf16 v[52:55], a[72:75], a[144:147], v[52:55]
ds_read_b64_tr_b16 a[160:161], v11 offset:16384
ds_read_b64_tr_b16 a[162:163], v11 offset:16896
v_mfma_f32_16x16x32_bf16 v[44:47], a[72:75], a[136:139], v[44:47]
buffer_load_dwordx4 v8, s[20:23], s64 offen offset:1024 lds
v_mfma_f32_16x16x32_bf16 v[44:47], a[76:79], a[140:143], v[44:47]
buffer_load_dword a253, v17, s[48:51], s54 offen
v_mfma_f32_16x16x32_bf16 v[36:39], a[76:79], a[132:135], v[36:39]
v_mfma_f32_16x16x32_bf16 v[36:39], a[72:75], a[128:131], v[36:39]
ds_read_b128 a[108:111], v10 offset:10240
v_mfma_f32_16x16x32_bf16 v[64:67], a[80:83], a[128:131], v[64:67]
v_mfma_f32_16x16x32_bf16 v[64:67], a[84:87], a[132:135], v[64:67]
v_mfma_f32_16x16x32_bf16 v[72:75], a[84:87], a[140:143], v[72:75]
s_add_u32 m0, s80, 0
s_add_u32 s64, s79, 0
v_mfma_f32_16x16x32_bf16 v[72:75], a[80:83], a[136:139], v[72:75]
ds_read_b64_tr_b16 a[164:165], v11 offset:24576
ds_read_b64_tr_b16 a[166:167], v11 offset:25088
v_mfma_f32_16x16x32_bf16 v[80:83], a[80:83], a[144:147], v[80:83]
buffer_load_dwordx4 v15, s[24:27], s64 offen sc1 lds
v_mfma_f32_16x16x32_bf16 v[80:83], a[84:87], a[148:151], v[80:83]
ds_read_b128 a[112:115], v9 offset:12288
v_mfma_f32_16x16x32_bf16 v[88:91], a[84:87], a[156:159], v[88:91]
v_mfma_f32_16x16x32_bf16 v[88:91], a[80:83], a[152:155], v[88:91]
v_mfma_f32_16x16x32_bf16 v[92:95], a[88:91], a[152:155], v[92:95]
ds_read_b64_tr_b16 a[168:169], v12 offset:16384
ds_read_b64_tr_b16 a[170:171], v12 offset:16896
v_mfma_f32_16x16x32_bf16 v[92:95], a[92:95], a[156:159], v[92:95]
v_mfma_f32_16x16x32_bf16 v[84:87], a[92:95], a[148:151], v[84:87]
s_add_u32 m0, s73, 69632
s_add_u32 s64, s72, 0
v_mfma_f32_16x16x32_bf16 v[84:87], a[88:91], a[144:147], v[84:87]
v_mfma_f32_16x16x32_bf16 v[76:79], a[88:91], a[136:139], v[76:79]
buffer_load_dwordx4 v5, s[12:15], s64 offen lds
v_mfma_f32_16x16x32_bf16 v[76:79], a[92:95], a[140:143], v[76:79]
ds_read_b128 a[116:119], v10 offset:12288
v_mfma_f32_16x16x32_bf16 v[68:71], a[92:95], a[132:135], v[68:71]
v_mfma_f32_16x16x32_bf16 v[68:71], a[88:91], a[128:131], v[68:71]
s_waitcnt lgkmcnt(6)
ds_read_b64_tr_b16 a[172:173], v12 offset:24576
ds_read_b64_tr_b16 a[174:175], v12 offset:25088
v_mfma_f32_16x16x32_bf16 v[96:99], a[96:99], a[128:131], v[96:99]
v_mfma_f32_16x16x32_bf16 v[96:99], a[100:103], a[132:135], v[96:99]
v_mfma_f32_16x16x32_bf16 v[104:107], a[100:103], a[140:143], v[104:107]
ds_read_b128 a[120:123], v9 offset:14336
v_mfma_f32_16x16x32_bf16 v[104:107], a[96:99], a[136:139], v[104:107]
v_mfma_f32_16x16x32_bf16 v[112:115], a[96:99], a[144:147], v[112:115]
v_mfma_f32_16x16x32_bf16 v[112:115], a[100:103], a[148:151], v[112:115]
buffer_load_dwordx4 v6, s[12:15], s64 offen offset:1024 lds
v_mfma_f32_16x16x32_bf16 v[120:123], a[100:103], a[156:159], v[120:123]
ds_read_b64_tr_b16 a[176:177], v13 offset:16384
ds_read_b64_tr_b16 a[178:179], v13 offset:16896
v_mfma_f32_16x16x32_bf16 v[120:123], a[96:99], a[152:155], v[120:123]
v_mfma_f32_16x16x32_bf16 v[124:127], a[104:107], a[152:155], v[124:127]
v_mfma_f32_16x16x32_bf16 v[124:127], a[108:111], a[156:159], v[124:127]
ds_read_b128 a[124:127], v10 offset:14336
v_mfma_f32_16x16x32_bf16 v[116:119], a[108:111], a[148:151], v[116:119]
v_add_u32 v9, 32768, v9
v_add_u32 v10, 32768, v10
v_mfma_f32_16x16x32_bf16 v[116:119], a[104:107], a[144:147], v[116:119]
s_add_u32 m0, s73, 71680
s_add_u32 s64, s72, 18432
v_mfma_f32_16x16x32_bf16 v[108:111], a[104:107], a[136:139], v[108:111]
ds_read_b64_tr_b16 a[180:181], v13 offset:24576
ds_read_b64_tr_b16 a[182:183], v13 offset:25088
v_mfma_f32_16x16x32_bf16 v[108:111], a[108:111], a[140:143], v[108:111]
buffer_load_dwordx4 v5, s[12:15], s64 offen lds
v_mfma_f32_16x16x32_bf16 v[100:103], a[108:111], a[132:135], v[100:103]
v_mfma_f32_16x16x32_bf16 v[100:103], a[104:107], a[128:131], v[100:103]
s_waitcnt lgkmcnt(2)
ds_read_b64_tr_b16 a[184:185], v14 offset:16384
ds_read_b64_tr_b16 a[186:187], v14 offset:16896
v_mfma_f32_16x16x32_bf16 v[128:131], a[112:115], a[128:131], v[128:131]
v_mfma_f32_16x16x32_bf16 v[128:131], a[116:119], a[132:135], v[128:131]
v_mfma_f32_16x16x32_bf16 v[136:139], a[116:119], a[140:143], v[136:139]
ds_read_b64_tr_b16 a[188:189], v14 offset:24576
ds_read_b64_tr_b16 a[190:191], v14 offset:25088
v_mfma_f32_16x16x32_bf16 v[136:139], a[112:115], a[136:139], v[136:139]
v_mfma_f32_16x16x32_bf16 v[144:147], a[112:115], a[144:147], v[144:147]
v_mfma_f32_16x16x32_bf16 v[144:147], a[116:119], a[148:151], v[144:147]
buffer_load_dwordx4 v6, s[12:15], s64 offen offset:1024 lds
v_mfma_f32_16x16x32_bf16 v[152:155], a[116:119], a[156:159], v[152:155]
v_mfma_f32_16x16x32_bf16 v[152:155], a[112:115], a[152:155], v[152:155]
v_mfma_f32_16x16x32_bf16 v[156:159], a[120:123], a[152:155], v[156:159]
v_mfma_f32_16x16x32_bf16 v[156:159], a[124:127], a[156:159], v[156:159]
v_mfma_f32_16x16x32_bf16 v[148:151], a[124:127], a[148:151], v[148:151]
v_mfma_f32_16x16x32_bf16 v[148:151], a[120:123], a[144:147], v[148:151]
v_mfma_f32_16x16x32_bf16 v[140:143], a[120:123], a[136:139], v[140:143]
v_mfma_f32_16x16x32_bf16 v[140:143], a[124:127], a[140:143], v[140:143]
v_mfma_f32_16x16x32_bf16 v[132:135], a[124:127], a[132:135], v[132:135]
v_mfma_f32_16x16x32_bf16 v[132:135], a[120:123], a[128:131], v[132:135]
s_waitcnt lgkmcnt(0)
v_mfma_f32_16x16x32_bf16 v[160:163], a[160:163], a[64:67], v[160:163]
s_waitcnt vmcnt(17)
v_mfma_f32_16x16x32_bf16 v[160:163], a[164:167], a[68:71], v[160:163]
s_barrier
v_mfma_f32_16x16x32_bf16 v[164:167], a[172:175], a[68:71], v[164:167]
ds_read_b64_tr_b16 a[128:129], v11 offset:32768
ds_read_b64_tr_b16 a[130:131], v11 offset:33280
v_mfma_f32_16x16x32_bf16 v[164:167], a[168:171], a[64:67], v[164:167]
s_add_u32 m0, s77, 16384
s_add_u32 s64, s76, 128
v_mfma_f32_16x16x32_bf16 v[168:171], a[176:179], a[64:67], v[168:171]
buffer_load_dwordx4 v7, s[20:23], s64 offen lds
v_mfma_f32_16x16x32_bf16 v[168:171], a[180:183], a[68:71], v[168:171]
v_mfma_f32_16x16x32_bf16 v[172:175], a[188:191], a[68:71], v[172:175]
v_mfma_f32_16x16x32_bf16 v[172:175], a[184:187], a[64:67], v[172:175]
ds_read_b128 a[64:67], v9 offset:0
v_mfma_f32_16x16x32_bf16 v[188:191], a[184:187], a[72:75], v[188:191]
ds_read_b64_tr_b16 a[132:133], v11 offset:40960
ds_read_b64_tr_b16 a[134:135], v11 offset:41472
v_mfma_f32_16x16x32_bf16 v[188:191], a[188:191], a[76:79], v[188:191]
v_mfma_f32_16x16x32_bf16 v[184:187], a[180:183], a[76:79], v[184:187]
v_mfma_f32_16x16x32_bf16 v[184:187], a[176:179], a[72:75], v[184:187]
ds_read_b128 a[68:71], v10 offset:0
v_mfma_f32_16x16x32_bf16 v[180:183], a[168:171], a[72:75], v[180:183]
buffer_load_dwordx4 v8, s[20:23], s64 offen offset:1024 lds
v_mfma_f32_16x16x32_bf16 v[180:183], a[172:175], a[76:79], v[180:183]
v_mfma_f32_16x16x32_bf16 v[176:179], a[164:167], a[76:79], v[176:179]
v_mfma_f32_16x16x32_bf16 v[176:179], a[160:163], a[72:75], v[176:179]
ds_read_b64_tr_b16 a[136:137], v12 offset:32768
ds_read_b64_tr_b16 a[138:139], v12 offset:33280
v_mfma_f32_16x16x32_bf16 v[192:195], a[160:163], a[80:83], v[192:195]
v_mfma_f32_16x16x32_bf16 v[192:195], a[164:167], a[84:87], v[192:195]
v_mfma_f32_16x16x32_bf16 v[196:199], a[172:175], a[84:87], v[196:199]
s_add_u32 m0, s80, 16384
s_add_u32 s64, s79, 2048
ds_read_b128 a[72:75], v9 offset:2048
v_mfma_f32_16x16x32_bf16 v[196:199], a[168:171], a[80:83], v[196:199]
v_mfma_f32_16x16x32_bf16 v[200:203], a[176:179], a[80:83], v[200:203]
buffer_load_dwordx4 v15, s[24:27], s64 offen sc1 lds
v_mfma_f32_16x16x32_bf16 v[200:203], a[180:183], a[84:87], v[200:203]
s_xor_b32 s65, s70, 0
s_add_u32 s71, s68, s65
s_add_u32 s72, s69, s65
v_mfma_f32_16x16x32_bf16 v[204:207], a[188:191], a[84:87], v[204:207]
ds_read_b64_tr_b16 a[140:141], v12 offset:40960
ds_read_b64_tr_b16 a[142:143], v12 offset:41472
v_mfma_f32_16x16x32_bf16 v[204:207], a[184:187], a[80:83], v[204:207]
v_mfma_f32_16x16x32_bf16 v[220:223], a[184:187], a[88:91], v[220:223]
ds_read_b128 a[76:79], v10 offset:2048
v_mfma_f32_16x16x32_bf16 v[220:223], a[188:191], a[92:95], v[220:223]
v_mfma_f32_16x16x32_bf16 v[216:219], a[180:183], a[92:95], v[216:219]
s_add_u32 m0, s73, 0
s_add_u32 s64, s71, 0
v_mfma_f32_16x16x32_bf16 v[216:219], a[176:179], a[88:91], v[216:219]
v_mfma_f32_16x16x32_bf16 v[212:215], a[168:171], a[88:91], v[212:215]
buffer_load_dwordx4 v5, s[12:15], s64 offen lds
v_mfma_f32_16x16x32_bf16 v[212:215], a[172:175], a[92:95], v[212:215]
ds_read_b64_tr_b16 a[144:145], v13 offset:32768
ds_read_b64_tr_b16 a[146:147], v13 offset:33280
v_mfma_f32_16x16x32_bf16 v[208:211], a[164:167], a[92:95], v[208:211]
v_mfma_f32_16x16x32_bf16 v[208:211], a[160:163], a[88:91], v[208:211]
ds_read_b128 a[80:83], v9 offset:4096
v_mfma_f32_16x16x32_bf16 v[224:227], a[160:163], a[96:99], v[224:227]
v_mfma_f32_16x16x32_bf16 v[224:227], a[164:167], a[100:103], v[224:227]
v_mfma_f32_16x16x32_bf16 v[228:231], a[172:175], a[100:103], v[228:231]
ds_read_b64_tr_b16 a[148:149], v13 offset:40960
ds_read_b64_tr_b16 a[150:151], v13 offset:41472
v_mfma_f32_16x16x32_bf16 v[228:231], a[168:171], a[96:99], v[228:231]
v_mfma_f32_16x16x32_bf16 v[232:235], a[176:179], a[96:99], v[232:235]
v_mfma_f32_16x16x32_bf16 v[232:235], a[180:183], a[100:103], v[232:235]
buffer_load_dwordx4 v6, s[12:15], s64 offen offset:1024 lds
v_mfma_f32_16x16x32_bf16 v[236:239], a[188:191], a[100:103], v[236:239]
ds_read_b128 a[84:87], v10 offset:4096
v_mfma_f32_16x16x32_bf16 v[236:239], a[184:187], a[96:99], v[236:239]
v_mfma_f32_16x16x32_bf16 v[252:255], a[184:187], a[104:107], v[252:255]
v_mfma_f32_16x16x32_bf16 v[252:255], a[188:191], a[108:111], v[252:255]
ds_read_b64_tr_b16 a[152:153], v14 offset:32768
ds_read_b64_tr_b16 a[154:155], v14 offset:33280
v_mfma_f32_16x16x32_bf16 v[248:251], a[180:183], a[108:111], v[248:251]
v_mfma_f32_16x16x32_bf16 v[248:251], a[176:179], a[104:107], v[248:251]
s_add_u32 m0, s73, 2048
s_add_u32 s64, s71, 18432
v_mfma_f32_16x16x32_bf16 v[244:247], a[168:171], a[104:107], v[244:247]
ds_read_b128 a[88:91], v9 offset:6144
v_mfma_f32_16x16x32_bf16 v[244:247], a[172:175], a[108:111], v[244:247]
buffer_load_dwordx4 v5, s[12:15], s64 offen lds
v_mfma_f32_16x16x32_bf16 v[240:243], a[164:167], a[108:111], v[240:243]
v_mfma_f32_16x16x32_bf16 v[240:243], a[160:163], a[104:107], v[240:243]
ds_read_b64_tr_b16 a[156:157], v14 offset:40960
ds_read_b64_tr_b16 a[158:159], v14 offset:41472
v_mfma_f32_16x16x32_bf16 a[0:3], a[160:163], a[112:115], a[0:3]
v_mfma_f32_16x16x32_bf16 a[0:3], a[164:167], a[116:119], a[0:3]
v_mfma_f32_16x16x32_bf16 a[4:7], a[172:175], a[116:119], a[4:7]
ds_read_b128 a[92:95], v10 offset:6144
v_mfma_f32_16x16x32_bf16 a[4:7], a[168:171], a[112:115], a[4:7]
v_mfma_f32_16x16x32_bf16 a[8:11], a[176:179], a[112:115], a[8:11]
v_mfma_f32_16x16x32_bf16 a[8:11], a[180:183], a[116:119], a[8:11]
buffer_load_dwordx4 v6, s[12:15], s64 offen offset:1024 lds
v_mfma_f32_16x16x32_bf16 a[12:15], a[188:191], a[116:119], a[12:15]
v_mfma_f32_16x16x32_bf16 a[12:15], a[184:187], a[112:115], a[12:15]
v_mfma_f32_16x16x32_bf16 a[28:31], a[184:187], a[120:123], a[28:31]
v_mfma_f32_16x16x32_bf16 a[28:31], a[188:191], a[124:127], a[28:31]
v_mfma_f32_16x16x32_bf16 a[24:27], a[180:183], a[124:127], a[24:27]
v_mfma_f32_16x16x32_bf16 a[24:27], a[176:179], a[120:123], a[24:27]
v_mfma_f32_16x16x32_bf16 a[20:23], a[168:171], a[120:123], a[20:23]
v_mfma_f32_16x16x32_bf16 a[20:23], a[172:175], a[124:127], a[20:23]
v_mfma_f32_16x16x32_bf16 a[16:19], a[164:167], a[124:127], a[16:19]
v_mfma_f32_16x16x32_bf16 a[16:19], a[160:163], a[120:123], a[16:19]
s_waitcnt lgkmcnt(0)
v_mfma_f32_16x16x32_bf16 v[32:35], a[64:67], a[128:131], v[32:35]
s_waitcnt vmcnt(20)
v_mfma_f32_16x16x32_bf16 v[32:35], a[68:71], a[132:135], v[32:35]
s_barrier
v_mfma_f32_16x16x32_bf16 v[40:43], a[68:71], a[140:143], v[40:43]
L_PAD3:
s_cbranch_execz L_PAD7
ds_read_b128 a[96:99], v9 offset:8192
v_mfma_f32_16x16x32_bf16 v[40:43], a[64:67], a[136:139], v[40:43]
s_xor_b32 s75, s93, 0
s_lshl_b32 s76, s75, 19
s_add_u32 s76, s76, s74
v_mfma_f32_16x16x32_bf16 v[48:51], a[64:67], a[144:147], v[48:51]
s_lshl_b32 s79, s75, 13
s_add_u32 s79, s79, s78
v_mfma_f32_16x16x32_bf16 v[48:51], a[68:71], a[148:151], v[48:51]
s_add_u32 m0, s77, 32768
s_add_u32 s64, s76, 0
ds_read_b128 a[100:103], v10 offset:8192
v_mfma_f32_16x16x32_bf16 v[56:59], a[68:71], a[156:159], v[56:59]
buffer_load_dwordx4 v7, s[20:23], s64 offen lds
v_mfma_f32_16x16x32_bf16 v[56:59], a[64:67], a[152:155], v[56:59]
v_mfma_f32_16x16x32_bf16 v[60:63], a[72:75], a[152:155], v[60:63]
ds_read_b128 a[104:107], v9 offset:10240
v_mfma_f32_16x16x32_bf16 v[60:63], a[76:79], a[156:159], v[60:63]
v_mfma_f32_16x16x32_bf16 v[52:55], a[76:79], a[148:151], v[52:55]
v_mfma_f32_16x16x32_bf16 v[52:55], a[72:75], a[144:147], v[52:55]
ds_read_b64_tr_b16 a[160:161], v11 offset:49152
ds_read_b64_tr_b16 a[162:163], v11 offset:49664
v_mfma_f32_16x16x32_bf16 v[44:47], a[72:75], a[136:139], v[44:47]
buffer_load_dwordx4 v8, s[20:23], s64 offen offset:1024 lds
v_mfma_f32_16x16x32_bf16 v[44:47], a[76:79], a[140:143], v[44:47]
v_mfma_f32_16x16x32_bf16 v[36:39], a[76:79], a[132:135], v[36:39]
v_mfma_f32_16x16x32_bf16 v[36:39], a[72:75], a[128:131], v[36:39]
ds_read_b128 a[108:111], v10 offset:10240
v_mfma_f32_16x16x32_bf16 v[64:67], a[80:83], a[128:131], v[64:67]
v_mfma_f32_16x16x32_bf16 v[64:67], a[84:87], a[132:135], v[64:67]
v_mfma_f32_16x16x32_bf16 v[72:75], a[84:87], a[140:143], v[72:75]
s_add_u32 m0, s80, 32768
s_add_u32 s64, s79, 0
v_mfma_f32_16x16x32_bf16 v[72:75], a[80:83], a[136:139], v[72:75]
ds_read_b64_tr_b16 a[164:165], v11 offset:57344
ds_read_b64_tr_b16 a[166:167], v11 offset:57856
v_mfma_f32_16x16x32_bf16 v[80:83], a[80:83], a[144:147], v[80:83]
buffer_load_dwordx4 v15, s[24:27], s64 offen sc1 lds
v_mfma_f32_16x16x32_bf16 v[80:83], a[84:87], a[148:151], v[80:83]
ds_read_b128 a[112:115], v9 offset:12288
v_mfma_f32_16x16x32_bf16 v[88:91], a[84:87], a[156:159], v[88:91]
v_cvt_pk_bf16_f32 v32, v32, v33
v_cvt_pk_bf16_f32 v33, v34, v35
v_mfma_f32_16x16x32_bf16 v[88:91], a[80:83], a[152:155], v[88:91]
v_cvt_pk_bf16_f32 v34, v36, v37
v_cvt_pk_bf16_f32 v35, v38, v39
v_mfma_f32_16x16x32_bf16 v[92:95], a[88:91], a[152:155], v[92:95]
ds_read_b64_tr_b16 a[168:169], v12 offset:49152
ds_read_b64_tr_b16 a[170:171], v12 offset:49664
v_mfma_f32_16x16x32_bf16 v[92:95], a[92:95], a[156:159], v[92:95]
v_cvt_pk_bf16_f32 v40, v40, v41
v_cvt_pk_bf16_f32 v41, v42, v43
v_mfma_f32_16x16x32_bf16 v[84:87], a[92:95], a[148:151], v[84:87]
s_add_u32 m0, s73, 4096
s_add_u32 s64, s72, 0
s_lshr_b32 s55, s3, 1
v_mfma_f32_16x16x32_bf16 v[84:87], a[88:91], a[144:147], v[84:87]
s_lshl_b32 s55, s55, 14
s_lshl_b32 s54, s3, 13
s_sub_u32 s55, s54, s55
v_mfma_f32_16x16x32_bf16 v[76:79], a[88:91], a[136:139], v[76:79]
buffer_load_dwordx4 v5, s[12:15], s64 offen lds
v_mfma_f32_16x16x32_bf16 v[76:79], a[92:95], a[140:143], v[76:79]
s_and_b32 s54, s3, 1
s_lshl_b32 s54, s54, 12
ds_read_b128 a[116:119], v10 offset:12288
v_mfma_f32_16x16x32_bf16 v[68:71], a[92:95], a[132:135], v[68:71]
s_add_u32 s53, s88, 0
v_cvt_pk_bf16_f32 v42, v44, v45
v_cvt_pk_bf16_f32 v43, v46, v47
v_mfma_f32_16x16x32_bf16 v[68:71], a[88:91], a[128:131], v[68:71]
s_waitcnt lgkmcnt(6)
ds_read_b64_tr_b16 a[172:173], v12 offset:57344
ds_read_b64_tr_b16 a[174:175], v12 offset:57856
v_mfma_f32_16x16x32_bf16 v[96:99], a[96:99], a[128:131], v[96:99]
buffer_store_dwordx4 v[32:35], v15, s[24:27], s53 offen offset:0 sc1
v_mfma_f32_16x16x32_bf16 v[96:99], a[100:103], a[132:135], v[96:99]
v_cvt_pk_bf16_f32 v48, v48, v49
v_cvt_pk_bf16_f32 v49, v50, v51
v_mfma_f32_16x16x32_bf16 v[104:107], a[100:103], a[140:143], v[104:107]
ds_read_b128 a[120:123], v9 offset:14336
v_cvt_pk_bf16_f32 v50, v52, v53
v_mfma_f32_16x16x32_bf16 v[104:107], a[96:99], a[136:139], v[104:107]
v_cvt_pk_bf16_f32 v51, v54, v55
v_cvt_pk_bf16_f32 v56, v56, v57
v_mfma_f32_16x16x32_bf16 v[112:115], a[96:99], a[144:147], v[112:115]
v_cvt_pk_bf16_f32 v57, v58, v59
v_cvt_pk_bf16_f32 v58, v60, v61
v_mfma_f32_16x16x32_bf16 v[112:115], a[100:103], a[148:151], v[112:115]
buffer_load_dwordx4 v6, s[12:15], s64 offen offset:1024 lds
v_mfma_f32_16x16x32_bf16 v[120:123], a[100:103], a[156:159], v[120:123]
ds_read_b64_tr_b16 a[176:177], v13 offset:49152
ds_read_b64_tr_b16 a[178:179], v13 offset:49664
v_mfma_f32_16x16x32_bf16 v[120:123], a[96:99], a[152:155], v[120:123]
v_cvt_pk_bf16_f32 v59, v62, v63
v_cvt_pk_bf16_f32 v64, v64, v65
v_mfma_f32_16x16x32_bf16 v[124:127], a[104:107], a[152:155], v[124:127]
v_cvt_pk_bf16_f32 v65, v66, v67
v_cvt_pk_bf16_f32 v66, v68, v69
v_mfma_f32_16x16x32_bf16 v[124:127], a[108:111], a[156:159], v[124:127]
ds_read_b128 a[124:127], v10 offset:14336
v_cvt_pk_bf16_f32 v67, v70, v71
v_mfma_f32_16x16x32_bf16 v[116:119], a[108:111], a[148:151], v[116:119]
v_add_u32 v9, 32768, v9
v_add_u32 v10, 32768, v10
v_mfma_f32_16x16x32_bf16 v[116:119], a[104:107], a[144:147], v[116:119]
s_add_u32 m0, s73, 6144
s_add_u32 s64, s72, 18432
v_cvt_pk_bf16_f32 v72, v72, v73
v_mfma_f32_16x16x32_bf16 v[108:111], a[104:107], a[136:139], v[108:111]
ds_read_b64_tr_b16 a[180:181], v13 offset:57344
ds_read_b64_tr_b16 a[182:183], v13 offset:57856
v_mfma_f32_16x16x32_bf16 v[108:111], a[108:111], a[140:143], v[108:111]
buffer_load_dwordx4 v5, s[12:15], s64 offen lds
v_mfma_f32_16x16x32_bf16 v[100:103], a[108:111], a[132:135], v[100:103]
v_cvt_pk_bf16_f32 v73, v74, v75
v_cvt_pk_bf16_f32 v74, v76, v77
v_mfma_f32_16x16x32_bf16 v[100:103], a[104:107], a[128:131], v[100:103]
s_waitcnt lgkmcnt(2)
ds_read_b64_tr_b16 a[184:185], v14 offset:49152
ds_read_b64_tr_b16 a[186:187], v14 offset:49664
v_mfma_f32_16x16x32_bf16 v[128:131], a[112:115], a[128:131], v[128:131]
v_cvt_pk_bf16_f32 v75, v78, v79
v_cvt_pk_bf16_f32 v80, v80, v81
v_mfma_f32_16x16x32_bf16 v[128:131], a[116:119], a[132:135], v[128:131]
v_cvt_pk_bf16_f32 v81, v82, v83
v_cvt_pk_bf16_f32 v82, v84, v85
v_mfma_f32_16x16x32_bf16 v[136:139], a[116:119], a[140:143], v[136:139]
ds_read_b64_tr_b16 a[188:189], v14 offset:57344
ds_read_b64_tr_b16 a[190:191], v14 offset:57856
v_mfma_f32_16x16x32_bf16 v[136:139], a[112:115], a[136:139], v[136:139]
v_add_u32 v9, s55, v9
v_add_u32 v10, s55, v10
v_mfma_f32_16x16x32_bf16 v[144:147], a[112:115], a[144:147], v[144:147]
v_subrev_u32 v11, s54, v11
v_subrev_u32 v12, s54, v12
v_mfma_f32_16x16x32_bf16 v[144:147], a[116:119], a[148:151], v[144:147]
buffer_load_dwordx4 v6, s[12:15], s64 offen offset:1024 lds
v_mfma_f32_16x16x32_bf16 v[152:155], a[116:119], a[156:159], v[152:155]
v_subrev_u32 v13, s54, v13
v_subrev_u32 v14, s54, v14
v_mfma_f32_16x16x32_bf16 v[152:155], a[112:115], a[152:155], v[152:155]
v_cvt_pk_bf16_f32 v83, v86, v87
v_cvt_pk_bf16_f32 v88, v88, v89
v_mfma_f32_16x16x32_bf16 v[156:159], a[120:123], a[152:155], v[156:159]
v_cvt_pk_bf16_f32 v89, v90, v91
v_cvt_pk_bf16_f32 v90, v92, v93
v_mfma_f32_16x16x32_bf16 v[156:159], a[124:127], a[156:159], v[156:159]
s_add_u32 s53, s88, 0
v_cvt_pk_bf16_f32 v91, v94, v95
v_cvt_pk_bf16_f32 v96, v96, v97
v_mfma_f32_16x16x32_bf16 v[148:151], a[124:127], a[148:151], v[148:151]
buffer_store_dwordx4 v[40:43], v15, s[24:27], s53 offen offset:1024 sc1
v_mfma_f32_16x16x32_bf16 v[148:151], a[120:123], a[144:147], v[148:151]
v_cvt_pk_bf16_f32 v97, v98, v99
v_cvt_pk_bf16_f32 v98, v100, v101
v_mfma_f32_16x16x32_bf16 v[140:143], a[120:123], a[136:139], v[140:143]
v_cvt_pk_bf16_f32 v99, v102, v103
v_cvt_pk_bf16_f32 v104, v104, v105
v_mfma_f32_16x16x32_bf16 v[140:143], a[124:127], a[140:143], v[140:143]
v_cvt_pk_bf16_f32 v105, v106, v107
v_cvt_pk_bf16_f32 v106, v108, v109
v_mfma_f32_16x16x32_bf16 v[132:135], a[124:127], a[132:135], v[132:135]
v_cvt_pk_bf16_f32 v107, v110, v111
v_cvt_pk_bf16_f32 v112, v112, v113
v_mfma_f32_16x16x32_bf16 v[132:135], a[120:123], a[128:131], v[132:135]
s_waitcnt lgkmcnt(0)
v_cvt_pk_bf16_f32 v113, v114, v115
v_cvt_pk_bf16_f32 v114, v116, v117
v_mfma_f32_16x16x32_bf16 v[160:163], a[160:163], a[64:67], v[160:163]
s_waitcnt vmcnt(16)
v_cvt_pk_bf16_f32 v115, v118, v119
v_cvt_pk_bf16_f32 v120, v120, v121
v_mfma_f32_16x16x32_bf16 v[160:163], a[164:167], a[68:71], v[160:163]
s_barrier
v_mfma_f32_16x16x32_bf16 v[164:167], a[172:175], a[68:71], v[164:167]
ds_read_b64_tr_b16 a[128:129], v11 offset:0
ds_read_b64_tr_b16 a[130:131], v11 offset:512
v_mfma_f32_16x16x32_bf16 v[164:167], a[168:171], a[64:67], v[164:167]
s_add_u32 m0, s77, 49152
s_add_u32 s64, s76, 128
v_cvt_pk_bf16_f32 v121, v122, v123
v_mfma_f32_16x16x32_bf16 v[168:171], a[176:179], a[64:67], v[168:171]
buffer_load_dwordx4 v7, s[20:23], s64 offen lds
v_mfma_f32_16x16x32_bf16 v[168:171], a[180:183], a[68:71], v[168:171]
ds_read_b64_tr_b16 a[132:133], v11 offset:4096
ds_read_b64_tr_b16 a[134:135], v11 offset:4608
v_mfma_f32_16x16x32_bf16 v[172:175], a[188:191], a[68:71], v[172:175]
v_cvt_pk_bf16_f32 v122, v124, v125
v_cvt_pk_bf16_f32 v123, v126, v127
v_mfma_f32_16x16x32_bf16 v[172:175], a[184:187], a[64:67], v[172:175]
v_cvt_pk_bf16_f32 v128, v128, v129
v_cvt_pk_bf16_f32 v129, v130, v131
v_mfma_f32_16x16x32_bf16 v[188:191], a[184:187], a[72:75], v[188:191]
ds_read_b64_tr_b16 a[136:137], v12 offset:0
ds_read_b64_tr_b16 a[138:139], v12 offset:512
v_mfma_f32_16x16x32_bf16 v[188:191], a[188:191], a[76:79], v[188:191]
v_cvt_pk_bf16_f32 v130, v132, v133
v_cvt_pk_bf16_f32 v131, v134, v135
v_mfma_f32_16x16x32_bf16 v[184:187], a[180:183], a[76:79], v[184:187]
v_cvt_pk_bf16_f32 v136, v136, v137
v_cvt_pk_bf16_f32 v137, v138, v139
v_mfma_f32_16x16x32_bf16 v[184:187], a[176:179], a[72:75], v[184:187]
ds_read_b64_tr_b16 a[140:141], v12 offset:4096
ds_read_b64_tr_b16 a[142:143], v12 offset:4608
v_mfma_f32_16x16x32_bf16 v[180:183], a[168:171], a[72:75], v[180:183]
buffer_load_dwordx4 v8, s[20:23], s64 offen offset:1024 lds
v_mfma_f32_16x16x32_bf16 v[180:183], a[172:175], a[76:79], v[180:183]
v_cvt_pk_bf16_f32 v138, v140, v141
v_cvt_pk_bf16_f32 v139, v142, v143
v_mfma_f32_16x16x32_bf16 v[176:179], a[164:167], a[76:79], v[176:179]
v_cvt_pk_bf16_f32 v144, v144, v145
v_cvt_pk_bf16_f32 v145, v146, v147
v_mfma_f32_16x16x32_bf16 v[176:179], a[160:163], a[72:75], v[176:179]
ds_read_b64_tr_b16 a[144:145], v13 offset:0
ds_read_b64_tr_b16 a[146:147], v13 offset:512
v_mfma_f32_16x16x32_bf16 v[192:195], a[160:163], a[80:83], v[192:195]
v_cvt_pk_bf16_f32 v146, v148, v149
v_cvt_pk_bf16_f32 v147, v150, v151
v_mfma_f32_16x16x32_bf16 v[192:195], a[164:167], a[84:87], v[192:195]
v_cvt_pk_bf16_f32 v152, v152, v153
v_cvt_pk_bf16_f32 v153, v154, v155
v_mfma_f32_16x16x32_bf16 v[196:199], a[172:175], a[84:87], v[196:199]
s_add_u32 m0, s80, 49152
s_add_u32 s64, s79, 2048
v_cvt_pk_bf16_f32 v154, v156, v157
v_mfma_f32_16x16x32_bf16 v[196:199], a[168:171], a[80:83], v[196:199]
ds_read_b64_tr_b16 a[148:149], v13 offset:4096
ds_read_b64_tr_b16 a[150:151], v13 offset:4608
v_mfma_f32_16x16x32_bf16 v[200:203], a[176:179], a[80:83], v[200:203]
buffer_load_dwordx4 v15, s[24:27], s64 offen sc1 lds
v_mfma_f32_16x16x32_bf16 v[200:203], a[180:183], a[84:87], v[200:203]
s_xor_b32 s65, s70, 128
s_add_u32 s71, s68, s65
s_add_u32 s72, s69, s65
v_mfma_f32_16x16x32_bf16 v[204:207], a[188:191], a[84:87], v[204:207]
s_add_u32 s53, s88, 0
ds_read_b64_tr_b16 a[152:153], v14 offset:0
ds_read_b64_tr_b16 a[154:155], v14 offset:512
v_mfma_f32_16x16x32_bf16 v[204:207], a[184:187], a[80:83], v[204:207]
buffer_store_dwordx4 v[48:51], v15, s[24:27], s53 offen offset:2048 sc1
v_mfma_f32_16x16x32_bf16 v[220:223], a[184:187], a[88:91], v[220:223]
ds_read_b64_tr_b16 a[156:157], v14 offset:4096
ds_read_b64_tr_b16 a[158:159], v14 offset:4608
v_mfma_f32_16x16x32_bf16 v[220:223], a[188:191], a[92:95], v[220:223]
v_cvt_pk_bf16_f32 v155, v158, v159
v_mul_f32 v160, s91, v160
v_mfma_f32_16x16x32_bf16 v[216:219], a[180:183], a[92:95], v[216:219]
s_add_u32 m0, s73, 32768
s_add_u32 s64, s71, 0
v_mul_f32 v161, s91, v161
v_mfma_f32_16x16x32_bf16 v[216:219], a[176:179], a[88:91], v[216:219]
v_mul_f32 v162, s91, v162
v_mul_f32 v163, s91, v163
v_mfma_f32_16x16x32_bf16 v[212:215], a[168:171], a[88:91], v[212:215]
buffer_load_dwordx4 v5, s[12:15], s64 offen lds
v_mfma_f32_16x16x32_bf16 v[212:215], a[172:175], a[92:95], v[212:215]
ds_read_b128 a[68:71], v4 offset:10240
v_mul_f32 v164, s91, v164
v_mfma_f32_16x16x32_bf16 v[208:211], a[164:167], a[92:95], v[208:211]
v_mul_f32 v165, s91, v165
v_mul_f32 v166, s91, v166
v_mfma_f32_16x16x32_bf16 v[208:211], a[160:163], a[88:91], v[208:211]
ds_read_b128 a[64:67], v4 offset:8192
v_mul_f32 v167, s91, v167
v_mfma_f32_16x16x32_bf16 v[224:227], a[160:163], a[96:99], v[224:227]
v_cvt_pk_bf16_f32 v160, v160, v161
v_cvt_pk_bf16_f32 v161, v162, v163
v_mfma_f32_16x16x32_bf16 v[224:227], a[164:167], a[100:103], v[224:227]
v_cvt_pk_bf16_f32 v162, v164, v165
v_cvt_pk_bf16_f32 v163, v166, v167
v_mfma_f32_16x16x32_bf16 v[228:231], a[172:175], a[100:103], v[228:231]
ds_read_b128 a[76:79], v4 offset:11264
v_mul_f32 v168, s91, v168
v_mfma_f32_16x16x32_bf16 v[228:231], a[168:171], a[96:99], v[228:231]
v_mul_f32 v169, s91, v169
v_mul_f32 v170, s91, v170
v_mfma_f32_16x16x32_bf16 v[232:235], a[176:179], a[96:99], v[232:235]
v_mul_f32 v171, s91, v171
v_mul_f32 v172, s91, v172
v_mfma_f32_16x16x32_bf16 v[232:235], a[180:183], a[100:103], v[232:235]
buffer_load_dwordx4 v6, s[12:15], s64 offen offset:1024 lds
v_mfma_f32_16x16x32_bf16 v[236:239], a[188:191], a[100:103], v[236:239]
ds_read_b128 a[72:75], v4 offset:9216
v_mul_f32 v173, s91, v173
v_mfma_f32_16x16x32_bf16 v[236:239], a[184:187], a[96:99], v[236:239]
v_mul_f32 v174, s91, v174
v_mul_f32 v175, s91, v175
v_mfma_f32_16x16x32_bf16 v[252:255], a[184:187], a[104:107], v[252:255]
v_cvt_pk_bf16_f32 v168, v168, v169
v_cvt_pk_bf16_f32 v169, v170, v171
v_mfma_f32_16x16x32_bf16 v[252:255], a[188:191], a[108:111], v[252:255]
ds_read_b128 a[84:87], v10 offset:0
v_cvt_pk_bf16_f32 v170, v172, v173
v_mfma_f32_16x16x32_bf16 v[248:251], a[180:183], a[108:111], v[248:251]
v_cvt_pk_bf16_f32 v171, v174, v175
v_mul_f32 v176, s91, v176
v_mfma_f32_16x16x32_bf16 v[248:251], a[176:179], a[104:107], v[248:251]
s_add_u32 m0, s73, 34816
s_add_u32 s64, s71, 18432
v_mul_f32 v177, s91, v177
v_mfma_f32_16x16x32_bf16 v[244:247], a[168:171], a[104:107], v[244:247]
ds_read_b128 a[80:83], v9 offset:0
v_mul_f32 v178, s91, v178
v_mfma_f32_16x16x32_bf16 v[244:247], a[172:175], a[108:111], v[244:247]
buffer_load_dwordx4 v5, s[12:15], s64 offen lds
v_mfma_f32_16x16x32_bf16 v[240:243], a[164:167], a[108:111], v[240:243]
v_mul_f32 v179, s91, v179
v_mul_f32 v180, s91, v180
v_mfma_f32_16x16x32_bf16 v[240:243], a[160:163], a[104:107], v[240:243]
s_add_u32 s53, s88, 0
ds_read_b128 a[92:95], v10 offset:2048
v_mul_f32 v181, s91, v181
v_mfma_f32_16x16x32_bf16 a[0:3], a[160:163], a[112:115], a[0:3]
buffer_store_dwordx4 v[56:59], v15, s[24:27], s53 offen offset:3072 sc1
v_mfma_f32_16x16x32_bf16 a[0:3], a[164:167], a[116:119], a[0:3]
v_mul_f32 v182, s91, v182
v_mul_f32 v183, s91, v183
v_mfma_f32_16x16x32_bf16 a[4:7], a[172:175], a[116:119], a[4:7]
ds_read_b128 a[88:91], v9 offset:2048
v_cvt_pk_bf16_f32 v176, v176, v177
v_mfma_f32_16x16x32_bf16 a[4:7], a[168:171], a[112:115], a[4:7]
v_cvt_pk_bf16_f32 v177, v178, v179
v_cvt_pk_bf16_f32 v178, v180, v181
v_mfma_f32_16x16x32_bf16 a[8:11], a[176:179], a[112:115], a[8:11]
v_cvt_pk_bf16_f32 v179, v182, v183
v_mul_f32 v184, s91, v184
v_mfma_f32_16x16x32_bf16 a[8:11], a[180:183], a[116:119], a[8:11]
buffer_load_dwordx4 v6, s[12:15], s64 offen offset:1024 lds
v_mfma_f32_16x16x32_bf16 a[12:15], a[188:191], a[116:119], a[12:15]
v_mul_f32 v185, s91, v185
v_mul_f32 v186, s91, v186
v_mfma_f32_16x16x32_bf16 a[12:15], a[184:187], a[112:115], a[12:15]
v_mul_f32 v187, s91, v187
v_mul_f32 v188, s91, v188
v_mfma_f32_16x16x32_bf16 a[28:31], a[184:187], a[120:123], a[28:31]
v_mul_f32 v189, s91, v189
v_mul_f32 v190, s91, v190
v_mfma_f32_16x16x32_bf16 a[28:31], a[188:191], a[124:127], a[28:31]
v_mul_f32 v191, s91, v191
v_cvt_pk_bf16_f32 v184, v184, v185
v_mfma_f32_16x16x32_bf16 a[24:27], a[180:183], a[124:127], a[24:27]
v_cvt_pk_bf16_f32 v185, v186, v187
v_cvt_pk_bf16_f32 v186, v188, v189
v_mfma_f32_16x16x32_bf16 a[24:27], a[176:179], a[120:123], a[24:27]
v_cvt_pk_bf16_f32 v187, v190, v191
v_mul_f32 v192, s91, v192
v_mfma_f32_16x16x32_bf16 a[20:23], a[168:171], a[120:123], a[20:23]
v_mul_f32 v193, s91, v193
v_mul_f32 v194, s91, v194
v_mfma_f32_16x16x32_bf16 a[20:23], a[172:175], a[124:127], a[20:23]
v_mul_f32 v195, s91, v195
v_mul_f32 v196, s91, v196
v_mfma_f32_16x16x32_bf16 a[16:19], a[164:167], a[124:127], a[16:19]
v_mul_f32 v197, s91, v197
v_mul_f32 v198, s91, v198
v_mfma_f32_16x16x32_bf16 a[16:19], a[160:163], a[120:123], a[16:19]
s_waitcnt lgkmcnt(0)
v_mul_f32 v199, s91, v199
v_cvt_pk_bf16_f32 v192, v192, v193
v_mfma_f32_16x16x32_bf16 v[36:39], a[128:131], a[80:83], 0
s_waitcnt vmcnt(22)
v_cvt_pk_bf16_f32 v193, v194, v195
v_cvt_pk_bf16_f32 v194, v196, v197
v_mfma_f32_16x16x32_bf16 v[36:39], a[132:135], a[84:87], v[36:39]
s_barrier
v_mfma_f32_16x16x32_bf16 v[44:47], a[140:143], a[84:87], 0
ds_read_b128 a[96:99], v9 offset:4096
v_cvt_pk_bf16_f32 v195, v198, v199
v_mfma_f32_16x16x32_bf16 v[44:47], a[136:139], a[80:83], v[44:47]
s_xor_b32 s75, s93, 1
s_lshl_b32 s76, s75, 19
s_add_u32 s76, s76, s74
v_mfma_f32_16x16x32_bf16 v[32:35], a[144:147], a[80:83], 0
s_lshl_b32 s79, s75, 13
s_add_u32 s79, s79, s78
ds_read_b128 a[100:103], v10 offset:4096
v_mfma_f32_16x16x32_bf16 v[32:35], a[148:151], a[84:87], v[32:35]
s_add_u32 m0, s77, 0
s_add_u32 s64, s76, 0
ds_read_b128 a[104:107], v9 offset:6144
v_mfma_f32_16x16x32_bf16 v[52:55], a[156:159], a[84:87], 0
buffer_load_dwordx4 v7, s[20:23], s64 offen lds
v_mfma_f32_16x16x32_bf16 v[52:55], a[152:155], a[80:83], v[52:55]
ds_read_b64_tr_b16 a[160:161], v11 offset:16384
ds_read_b64_tr_b16 a[162:163], v11 offset:16896
v_mfma_f32_16x16x32_bf16 v[60:63], a[64:67], a[80:83], 0
v_mul_f32 v200, s91, v200
v_mul_f32 v201, s91, v201
v_mfma_f32_16x16x32_bf16 v[60:63], a[68:71], a[84:87], v[60:63]
ds_read_b128 a[108:111], v10 offset:6144
v_mul_f32 v202, s91, v202
v_mfma_f32_16x16x32_bf16 v[68:71], a[76:79], a[84:87], 0
buffer_load_dwordx4 v8, s[20:23], s64 offen offset:1024 lds
v_mfma_f32_16x16x32_bf16 v[68:71], a[72:75], a[80:83], v[68:71]
s_add_u32 s53, s88, 262144
ds_read_b64_tr_b16 a[164:165], v11 offset:20480
ds_read_b64_tr_b16 a[166:167], v11 offset:20992
v_mfma_f32_16x16x32_bf16 v[76:79], a[72:75], a[88:91], 0
v_add_u32 v9, -65536, v9
v_add_u32 v10, -65536, v10
v_mfma_f32_16x16x32_bf16 v[76:79], a[76:79], a[92:95], v[76:79]
ds_read_b64_tr_b16 a[168:169], v12 offset:16384
ds_read_b64_tr_b16 a[170:171], v12 offset:16896
v_mfma_f32_16x16x32_bf16 v[84:87], a[68:71], a[92:95], 0
s_add_u32 m0, s80, 0
s_add_u32 s64, s79, 0
v_mul_f32 v203, s91, v203
v_mfma_f32_16x16x32_bf16 v[84:87], a[64:67], a[88:91], v[84:87]
ds_read_b64_tr_b16 a[172:173], v12 offset:20480
ds_read_b64_tr_b16 a[174:175], v12 offset:20992
v_mfma_f32_16x16x32_bf16 v[92:95], a[152:155], a[88:91], 0
buffer_load_dwordx4 v15, s[24:27], s64 offen sc1 lds
v_mfma_f32_16x16x32_bf16 v[92:95], a[156:159], a[92:95], v[92:95]
buffer_store_dwordx4 v[64:67], v15, s[24:27], s53 offen offset:0 sc1
v_mfma_f32_16x16x32_bf16 v[40:43], a[148:151], a[92:95], 0
ds_read_b64_tr_b16 a[176:177], v13 offset:16384
ds_read_b64_tr_b16 a[178:179], v13 offset:16896
v_mfma_f32_16x16x32_bf16 v[40:43], a[144:147], a[88:91], v[40:43]
v_mul_f32 v204, s91, v204
v_mul_f32 v205, s91, v205
v_mfma_f32_16x16x32_bf16 v[100:103], a[136:139], a[88:91], 0
s_add_u32 m0, s73, 36864
s_add_u32 s64, s72, 0
v_mul_f32 v206, s91, v206
v_mfma_f32_16x16x32_bf16 v[100:103], a[140:143], a[92:95], v[100:103]
ds_read_b64_tr_b16 a[180:181], v13 offset:20480
ds_read_b64_tr_b16 a[182:183], v13 offset:20992
v_mfma_f32_16x16x32_bf16 v[108:111], a[132:135], a[92:95], 0
buffer_load_dwordx4 v5, s[12:15], s64 offen lds
v_mfma_f32_16x16x32_bf16 v[108:111], a[128:131], a[88:91], v[108:111]
s_waitcnt lgkmcnt(14)
ds_read_b64_tr_b16 a[184:185], v14 offset:16384
ds_read_b64_tr_b16 a[186:187], v14 offset:16896
v_mfma_f32_16x16x32_bf16 v[116:119], a[128:131], a[96:99], 0
ds_read_b64_tr_b16 a[188:189], v14 offset:20480
ds_read_b64_tr_b16 a[190:191], v14 offset:20992
v_mfma_f32_16x16x32_bf16 v[116:119], a[132:135], a[100:103], v[116:119]
v_mul_f32 v207, s91, v207
v_cvt_pk_bf16_f32 v200, v200, v201
v_mfma_f32_16x16x32_bf16 v[124:127], a[140:143], a[100:103], 0
v_cvt_pk_bf16_f32 v201, v202, v203
v_cvt_pk_bf16_f32 v202, v204, v205
v_mfma_f32_16x16x32_bf16 v[124:127], a[136:139], a[96:99], v[124:127]
ds_read_b128 a[112:115], v4 offset:24576
v_cvt_pk_bf16_f32 v203, v206, v207
v_mfma_f32_16x16x32_bf16 v[132:135], a[144:147], a[96:99], 0
buffer_load_dwordx4 v6, s[12:15], s64 offen offset:1024 lds
v_mfma_f32_16x16x32_bf16 v[132:135], a[148:151], a[100:103], v[132:135]
ds_read_b128 a[116:119], v4 offset:26624
v_mul_f32 v208, s91, v208
v_mfma_f32_16x16x32_bf16 v[140:143], a[156:159], a[100:103], 0
v_mul_f32 v209, s91, v209
v_mul_f32 v210, s91, v210
v_mfma_f32_16x16x32_bf16 v[140:143], a[152:155], a[96:99], v[140:143]
ds_read_b128 a[120:123], v4 offset:25600
v_mul_f32 v211, s91, v211
v_mfma_f32_16x16x32_bf16 v[148:151], a[64:67], a[96:99], 0
s_add_u32 m0, s73, 38912
s_add_u32 s64, s72, 18432
v_mul_f32 v212, s91, v212
v_mfma_f32_16x16x32_bf16 v[148:151], a[68:71], a[100:103], v[148:151]
ds_read_b128 a[124:127], v4 offset:27648
v_mul_f32 v213, s91, v213
v_mfma_f32_16x16x32_bf16 v[48:51], a[76:79], a[100:103], 0
buffer_load_dwordx4 v5, s[12:15], s64 offen lds
v_mfma_f32_16x16x32_bf16 v[48:51], a[72:75], a[96:99], v[48:51]
s_waitcnt lgkmcnt(15)
v_mul_f32 v214, s91, v214
v_mul_f32 v215, s91, v215
v_mfma_f32_16x16x32_bf16 v[156:159], a[72:75], a[104:107], 0
v_cvt_pk_bf16_f32 v208, v208, v209
v_cvt_pk_bf16_f32 v209, v210, v211
v_mfma_f32_16x16x32_bf16 v[156:159], a[76:79], a[108:111], v[156:159]
s_add_u32 s53, s88, 262144
v_cvt_pk_bf16_f32 v210, v212, v213
v_cvt_pk_bf16_f32 v211, v214, v215
v_mfma_f32_16x16x32_bf16 v[164:167], a[68:71], a[108:111], 0
buffer_store_dwordx4 v[72:75], v15, s[24:27], s53 offen offset:1024 sc1
v_mfma_f32_16x16x32_bf16 v[164:167], a[64:67], a[104:107], v[164:167]
v_mul_f32 v216, s91, v216
v_mul_f32 v217, s91, v217
v_mfma_f32_16x16x32_bf16 v[172:175], a[152:155], a[104:107], 0
buffer_load_dwordx4 v6, s[12:15], s64 offen offset:1024 lds
v_mfma_f32_16x16x32_bf16 v[172:175], a[156:159], a[108:111], v[172:175]
v_mul_f32 v218, s91, v218
v_mul_f32 v219, s91, v219
v_mfma_f32_16x16x32_bf16 v[56:59], a[148:151], a[108:111], 0
v_mul_f32 v220, s91, v220
v_mul_f32 v221, s91, v221
v_mfma_f32_16x16x32_bf16 v[56:59], a[144:147], a[104:107], v[56:59]
v_mul_f32 v222, s91, v222
v_mul_f32 v223, s91, v223
v_mfma_f32_16x16x32_bf16 v[180:183], a[136:139], a[104:107], 0
v_cvt_pk_bf16_f32 v216, v216, v217
v_cvt_pk_bf16_f32 v217, v218, v219
v_mfma_f32_16x16x32_bf16 v[180:183], a[140:143], a[108:111], v[180:183]
v_cvt_pk_bf16_f32 v218, v220, v221
v_cvt_pk_bf16_f32 v219, v222, v223
v_mfma_f32_16x16x32_bf16 v[188:191], a[132:135], a[108:111], 0
v_mul_f32 v224, s91, v224
v_mul_f32 v225, s91, v225
v_mfma_f32_16x16x32_bf16 v[188:191], a[128:131], a[104:107], v[188:191]
s_waitcnt lgkmcnt(0)
v_mul_f32 v226, s91, v226
v_mul_f32 v227, s91, v227
v_mfma_f32_16x16x32_bf16 v[196:199], a[160:163], a[80:83], 0
s_waitcnt vmcnt(19)
v_mul_f32 v228, s91, v228
v_mul_f32 v229, s91, v229
v_mfma_f32_16x16x32_bf16 v[196:199], a[164:167], a[84:87], v[196:199]
s_barrier
v_mfma_f32_16x16x32_bf16 v[64:67], a[172:175], a[84:87], 0
ds_read_b64_tr_b16 a[128:129], v11 offset:32768
ds_read_b64_tr_b16 a[130:131], v11 offset:33280
v_mfma_f32_16x16x32_bf16 v[64:67], a[168:171], a[80:83], v[64:67]
s_add_u32 m0, s77, 16384
s_add_u32 s64, s76, 128
v_mul_f32 v230, s91, v230
v_mfma_f32_16x16x32_bf16 v[204:207], a[176:179], a[80:83], 0
buffer_load_dwordx4 v7, s[20:23], s64 offen lds
v_mfma_f32_16x16x32_bf16 v[204:207], a[180:183], a[84:87], v[204:207]
ds_read_b64_tr_b16 a[132:133], v11 offset:36864
ds_read_b64_tr_b16 a[134:135], v11 offset:37376
v_mfma_f32_16x16x32_bf16 v[212:215], a[188:191], a[84:87], 0
ds_read_b64_tr_b16 a[136:137], v12 offset:32768
ds_read_b64_tr_b16 a[138:139], v12 offset:33280
v_mfma_f32_16x16x32_bf16 v[212:215], a[184:187], a[80:83], v[212:215]
ds_read_b64_tr_b16 a[140:141], v12 offset:36864
ds_read_b64_tr_b16 a[142:143], v12 offset:37376
v_mfma_f32_16x16x32_bf16 v[72:75], a[112:115], a[80:83], 0
v_mul_f32 v231, s91, v231
v_cvt_pk_bf16_f32 v224, v224, v225
v_mfma_f32_16x16x32_bf16 v[72:75], a[116:119], a[84:87], v[72:75]
ds_read_b64_tr_b16 a[144:145], v13 offset:32768
ds_read_b64_tr_b16 a[146:147], v13 offset:33280
v_mfma_f32_16x16x32_bf16 v[220:223], a[124:127], a[84:87], 0
buffer_load_dwordx4 v8, s[20:23], s64 offen offset:1024 lds
v_mfma_f32_16x16x32_bf16 v[220:223], a[120:123], a[80:83], v[220:223]
ds_read_b64_tr_b16 a[148:149], v13 offset:36864
ds_read_b64_tr_b16 a[150:151], v13 offset:37376
v_mfma_f32_16x16x32_bf16 a[32:35], a[120:123], a[88:91], 0
v_cvt_pk_bf16_f32 v225, v226, v227
v_cvt_pk_bf16_f32 v226, v228, v229
v_mfma_f32_16x16x32_bf16 a[32:35], a[124:127], a[92:95], a[32:35]
ds_read_b64_tr_b16 a[152:153], v14 offset:32768
ds_read_b64_tr_b16 a[154:155], v14 offset:33280
v_mfma_f32_16x16x32_bf16 a[36:39], a[116:119], a[92:95], 0
s_add_u32 m0, s80, 16384
s_add_u32 s64, s79, 2048
v_cvt_pk_bf16_f32 v227, v230, v231
v_mfma_f32_16x16x32_bf16 a[36:39], a[112:115], a[88:91], a[36:39]
ds_read_b64_tr_b16 a[156:157], v14 offset:36864
ds_read_b64_tr_b16 a[158:159], v14 offset:37376
v_mfma_f32_16x16x32_bf16 v[228:231], a[184:187], a[88:91], 0
buffer_load_dwordx4 v15, s[24:27], s64 offen sc1 lds
v_mfma_f32_16x16x32_bf16 v[228:231], a[188:191], a[92:95], v[228:231]
s_xor_b32 s65, s70, 256
s_add_u32 s71, s68, s65
s_add_u32 s72, s69, s65
v_mfma_f32_16x16x32_bf16 a[40:43], a[180:183], a[92:95], 0
s_add_u32 s53, s88, 262144
ds_read_b128 a[64:67], v4 offset:40960
v_mul_f32 v232, s91, v232
v_mfma_f32_16x16x32_bf16 a[40:43], a[176:179], a[88:91], a[40:43]
buffer_store_dwordx4 v[80:83], v15, s[24:27], s53 offen offset:2048 sc1
v_mfma_f32_16x16x32_bf16 a[44:47], a[168:171], a[88:91], 0
s_add_u32 m0, s73, 65536
s_add_u32 s64, s71, 0
ds_read_b128 a[80:83], v9 offset:0
v_mfma_f32_16x16x32_bf16 a[44:47], a[172:175], a[92:95], a[44:47]
L_PAD4:
s_cbranch_execz L_PAD8
v_mul_f32 v233, s91, v233
v_mul_f32 v234, s91, v234
v_mfma_f32_16x16x32_bf16 v[80:83], a[164:167], a[92:95], 0
buffer_load_dwordx4 v5, s[12:15], s64 offen lds
v_mfma_f32_16x16x32_bf16 v[80:83], a[160:163], a[88:91], v[80:83]
ds_read_b128 a[68:71], v4 offset:43008
v_mul_f32 v235, s91, v235
v_mfma_f32_16x16x32_bf16 a[48:51], a[160:163], a[96:99], 0
ds_read_b128 a[84:87], v10 offset:0
v_mul_f32 v236, s91, v236
v_mfma_f32_16x16x32_bf16 a[48:51], a[164:167], a[100:103], a[48:51]
v_mul_f32 v237, s91, v237
v_mul_f32 v238, s91, v238
v_mfma_f32_16x16x32_bf16 a[52:55], a[172:175], a[100:103], 0
v_mul_f32 v239, s91, v239
v_cvt_pk_bf16_f32 v232, v232, v233
v_mfma_f32_16x16x32_bf16 a[52:55], a[168:171], a[96:99], a[52:55]
ds_read_b128 a[72:75], v4 offset:41984
v_cvt_pk_bf16_f32 v233, v234, v235
v_mfma_f32_16x16x32_bf16 a[56:59], a[176:179], a[96:99], 0
buffer_load_dwordx4 v6, s[12:15], s64 offen offset:1024 lds
v_mfma_f32_16x16x32_bf16 a[56:59], a[180:183], a[100:103], a[56:59]
ds_read_b128 a[88:91], v9 offset:2048
v_cvt_pk_bf16_f32 v234, v236, v237
v_mfma_f32_16x16x32_bf16 a[60:63], a[188:191], a[100:103], 0
v_cvt_pk_bf16_f32 v235, v238, v239
v_mul_f32 v240, s91, v240
v_mfma_f32_16x16x32_bf16 a[60:63], a[184:187], a[96:99], a[60:63]
ds_read_b128 a[76:79], v4 offset:44032
v_mul_f32 v241, s91, v241
v_mfma_f32_16x16x32_bf16 v[236:239], a[112:115], a[96:99], 0
s_add_u32 m0, s73, 67584
s_add_u32 s64, s71, 18432
v_mul_f32 v242, s91, v242
v_mfma_f32_16x16x32_bf16 v[236:239], a[116:119], a[100:103], v[236:239]
ds_read_b128 a[92:95], v10 offset:2048
v_mul_f32 v243, s91, v243
v_mfma_f32_16x16x32_bf16 a[192:195], a[124:127], a[100:103], 0
buffer_load_dwordx4 v5, s[12:15], s64 offen lds
v_mfma_f32_16x16x32_bf16 a[192:195], a[120:123], a[96:99], a[192:195]
v_mul_f32 v244, s91, v244
v_mul_f32 v245, s91, v245
v_mfma_f32_16x16x32_bf16 a[196:199], a[120:123], a[104:107], 0
v_mul_f32 v246, s91, v246
v_mul_f32 v247, s91, v247
v_mfma_f32_16x16x32_bf16 a[196:199], a[124:127], a[108:111], a[196:199]
v_cvt_pk_bf16_f32 v240, v240, v241
v_cvt_pk_bf16_f32 v241, v242, v243
v_mfma_f32_16x16x32_bf16 a[200:203], a[116:119], a[108:111], 0
v_cvt_pk_bf16_f32 v242, v244, v245
v_cvt_pk_bf16_f32 v243, v246, v247
v_mfma_f32_16x16x32_bf16 a[200:203], a[112:115], a[104:107], a[200:203]
v_mul_f32 v248, s91, v248
v_mul_f32 v249, s91, v249
v_mfma_f32_16x16x32_bf16 v[244:247], a[184:187], a[104:107], 0
buffer_load_dwordx4 v6, s[12:15], s64 offen offset:1024 lds
v_mfma_f32_16x16x32_bf16 v[244:247], a[188:191], a[108:111], v[244:247]
v_mul_f32 v250, s91, v250
v_mul_f32 v251, s91, v251
v_mfma_f32_16x16x32_bf16 a[204:207], a[180:183], a[108:111], 0
v_mul_f32 v252, s91, v252
v_mul_f32 v253, s91, v253
v_mfma_f32_16x16x32_bf16 a[204:207], a[176:179], a[104:107], a[204:207]
s_add_u32 s53, s88, 262144
v_mul_f32 v254, s91, v254
v_mul_f32 v255, s91, v255
v_mfma_f32_16x16x32_bf16 a[208:211], a[168:171], a[104:107], 0
buffer_store_dwordx4 v[88:91], v15, s[24:27], s53 offen offset:3072 sc1
v_mfma_f32_16x16x32_bf16 a[208:211], a[172:175], a[108:111], a[208:211]
v_cvt_pk_bf16_f32 v248, v248, v249
v_cvt_pk_bf16_f32 v249, v250, v251
v_mfma_f32_16x16x32_bf16 v[88:91], a[164:167], a[108:111], 0
v_cvt_pk_bf16_f32 v250, v252, v253
v_cvt_pk_bf16_f32 v251, v254, v255
v_mfma_f32_16x16x32_bf16 v[88:91], a[160:163], a[104:107], v[88:91]
s_waitcnt lgkmcnt(0)
v_accvgpr_read_b32 v16, a0
v_accvgpr_read_b32 v17, a1
v_mfma_f32_16x16x32_bf16 v[36:39], a[128:131], a[80:83], v[36:39]
s_waitcnt vmcnt(24)
v_accvgpr_read_b32 v18, a2
v_accvgpr_read_b32 v19, a3
v_mfma_f32_16x16x32_bf16 v[36:39], a[132:135], a[84:87], v[36:39]
s_barrier
v_mfma_f32_16x16x32_bf16 v[44:47], a[140:143], a[84:87], v[44:47]
ds_read_b128 a[96:99], v9 offset:4096
v_accvgpr_read_b32 v20, a4
v_mfma_f32_16x16x32_bf16 v[44:47], a[136:139], a[80:83], v[44:47]
s_xor_b32 s75, s93, 2
s_lshl_b32 s76, s75, 19
s_add_u32 s76, s76, s74
v_mfma_f32_16x16x32_bf16 v[32:35], a[144:147], a[80:83], v[32:35]
s_lshl_b32 s79, s75, 13
s_add_u32 s79, s79, s78
ds_read_b128 a[100:103], v10 offset:4096
v_mfma_f32_16x16x32_bf16 v[32:35], a[148:151], a[84:87], v[32:35]
s_add_u32 m0, s77, 32768
s_add_u32 s64, s76, 0
ds_read_b128 a[104:107], v9 offset:6144
v_mfma_f32_16x16x32_bf16 v[52:55], a[156:159], a[84:87], v[52:55]
buffer_load_dwordx4 v7, s[20:23], s64 offen lds
v_mfma_f32_16x16x32_bf16 v[52:55], a[152:155], a[80:83], v[52:55]
ds_read_b64_tr_b16 a[160:161], v11 offset:49152
ds_read_b64_tr_b16 a[162:163], v11 offset:49664
v_mfma_f32_16x16x32_bf16 v[60:63], a[64:67], a[80:83], v[60:63]
v_accvgpr_read_b32 v21, a5
v_accvgpr_read_b32 v22, a6
v_mfma_f32_16x16x32_bf16 v[60:63], a[68:71], a[84:87], v[60:63]
ds_read_b128 a[108:111], v10 offset:6144
v_accvgpr_read_b32 v23, a7
v_mfma_f32_16x16x32_bf16 v[68:71], a[76:79], a[84:87], v[68:71]
buffer_load_dwordx4 v8, s[20:23], s64 offen offset:1024 lds
v_mfma_f32_16x16x32_bf16 v[68:71], a[72:75], a[80:83], v[68:71]
ds_read_b64_tr_b16 a[164:165], v11 offset:53248
ds_read_b64_tr_b16 a[166:167], v11 offset:53760
v_mfma_f32_16x16x32_bf16 v[76:79], a[72:75], a[88:91], v[76:79]
v_add_u32 v9, 32768, v9
v_add_u32 v10, 32768, v10
v_mfma_f32_16x16x32_bf16 v[76:79], a[76:79], a[92:95], v[76:79]
ds_read_b64_tr_b16 a[168:169], v12 offset:49152
ds_read_b64_tr_b16 a[170:171], v12 offset:49664
v_mfma_f32_16x16x32_bf16 v[84:87], a[68:71], a[92:95], v[84:87]
s_add_u32 m0, s80, 32768
s_add_u32 s64, s79, 0
v_mul_f32 v16, s91, v16
v_mfma_f32_16x16x32_bf16 v[84:87], a[64:67], a[88:91], v[84:87]
ds_read_b64_tr_b16 a[172:173], v12 offset:53248
ds_read_b64_tr_b16 a[174:175], v12 offset:53760
v_mfma_f32_16x16x32_bf16 v[92:95], a[152:155], a[88:91], v[92:95]
buffer_load_dwordx4 v15, s[24:27], s64 offen sc1 lds
v_mfma_f32_16x16x32_bf16 v[92:95], a[156:159], a[92:95], v[92:95]
v_mul_f32 v17, s91, v17
v_mul_f32 v18, s91, v18
v_mfma_f32_16x16x32_bf16 v[40:43], a[148:151], a[92:95], v[40:43]
ds_read_b64_tr_b16 a[176:177], v13 offset:49152
ds_read_b64_tr_b16 a[178:179], v13 offset:49664
v_mfma_f32_16x16x32_bf16 v[40:43], a[144:147], a[88:91], v[40:43]
v_mul_f32 v19, s91, v19
v_mul_f32 v20, s91, v20
v_mfma_f32_16x16x32_bf16 v[100:103], a[136:139], a[88:91], v[100:103]
s_add_u32 m0, s73, 69632
s_add_u32 s64, s72, 0
v_mul_f32 v21, s91, v21
v_mfma_f32_16x16x32_bf16 v[100:103], a[140:143], a[92:95], v[100:103]
ds_read_b64_tr_b16 a[180:181], v13 offset:53248
ds_read_b64_tr_b16 a[182:183], v13 offset:53760
v_mfma_f32_16x16x32_bf16 v[108:111], a[132:135], a[92:95], v[108:111]
buffer_load_dwordx4 v5, s[12:15], s64 offen lds
v_mfma_f32_16x16x32_bf16 v[108:111], a[128:131], a[88:91], v[108:111]
s_waitcnt lgkmcnt(14)
ds_read_b64_tr_b16 a[184:185], v14 offset:49152
ds_read_b64_tr_b16 a[186:187], v14 offset:49664
v_mfma_f32_16x16x32_bf16 v[116:119], a[128:131], a[96:99], v[116:119]
s_add_u32 s53, s87, 0
ds_read_b64_tr_b16 a[188:189], v14 offset:53248
ds_read_b64_tr_b16 a[190:191], v14 offset:53760
v_mfma_f32_16x16x32_bf16 v[116:119], a[132:135], a[100:103], v[116:119]
buffer_store_dwordx4 v[160:163], v15, s[24:27], s53 offen offset:0 sc1
v_mfma_f32_16x16x32_bf16 v[124:127], a[140:143], a[100:103], v[124:127]
v_mul_f32 v22, s91, v22
v_mul_f32 v23, s91, v23
v_mfma_f32_16x16x32_bf16 v[124:127], a[136:139], a[96:99], v[124:127]
ds_read_b128 a[112:115], v4 offset:57344
v_cvt_pk_bf16_f32 v16, v16, v17
v_mfma_f32_16x16x32_bf16 v[132:135], a[144:147], a[96:99], v[132:135]
buffer_load_dwordx4 v6, s[12:15], s64 offen offset:1024 lds
v_mfma_f32_16x16x32_bf16 v[132:135], a[148:151], a[100:103], v[132:135]
ds_read_b128 a[116:119], v4 offset:59392
v_cvt_pk_bf16_f32 v17, v18, v19
v_mfma_f32_16x16x32_bf16 v[140:143], a[156:159], a[100:103], v[140:143]
v_cvt_pk_bf16_f32 v18, v20, v21
v_cvt_pk_bf16_f32 v19, v22, v23
v_mfma_f32_16x16x32_bf16 v[140:143], a[152:155], a[96:99], v[140:143]
ds_read_b128 a[120:123], v4 offset:58368
v_accvgpr_write_b32 a0, v16
v_mfma_f32_16x16x32_bf16 v[148:151], a[64:67], a[96:99], v[148:151]
s_add_u32 m0, s73, 71680
s_add_u32 s64, s72, 18432
v_accvgpr_write_b32 a1, v17
v_mfma_f32_16x16x32_bf16 v[148:151], a[68:71], a[100:103], v[148:151]
ds_read_b128 a[124:127], v4 offset:60416
v_accvgpr_write_b32 a2, v18
v_mfma_f32_16x16x32_bf16 v[48:51], a[76:79], a[100:103], v[48:51]
buffer_load_dwordx4 v5, s[12:15], s64 offen lds
v_mfma_f32_16x16x32_bf16 v[48:51], a[72:75], a[96:99], v[48:51]
s_waitcnt lgkmcnt(15)
v_accvgpr_write_b32 a3, v19
v_accvgpr_read_b32 v16, a8
v_mfma_f32_16x16x32_bf16 v[156:159], a[72:75], a[104:107], v[156:159]
v_accvgpr_read_b32 v17, a9
v_accvgpr_read_b32 v18, a10
v_mfma_f32_16x16x32_bf16 v[156:159], a[76:79], a[108:111], v[156:159]
v_accvgpr_read_b32 v19, a11
v_accvgpr_read_b32 v20, a12
v_mfma_f32_16x16x32_bf16 v[164:167], a[68:71], a[108:111], v[164:167]
v_accvgpr_read_b32 v21, a13
v_accvgpr_read_b32 v22, a14
v_mfma_f32_16x16x32_bf16 v[164:167], a[64:67], a[104:107], v[164:167]
v_accvgpr_read_b32 v23, a15
v_mul_f32 v16, s91, v16
v_mfma_f32_16x16x32_bf16 v[172:175], a[152:155], a[104:107], v[172:175]
buffer_load_dwordx4 v6, s[12:15], s64 offen offset:1024 lds
v_mfma_f32_16x16x32_bf16 v[172:175], a[156:159], a[108:111], v[172:175]
v_mul_f32 v17, s91, v17
v_mul_f32 v18, s91, v18
v_mfma_f32_16x16x32_bf16 v[56:59], a[148:151], a[108:111], v[56:59]
v_mul_f32 v19, s91, v19
v_mul_f32 v20, s91, v20
v_mfma_f32_16x16x32_bf16 v[56:59], a[144:147], a[104:107], v[56:59]
v_mul_f32 v21, s91, v21
v_mul_f32 v22, s91, v22
v_mfma_f32_16x16x32_bf16 v[180:183], a[136:139], a[104:107], v[180:183]
v_mul_f32 v23, s91, v23
v_cvt_pk_bf16_f32 v16, v16, v17
v_mfma_f32_16x16x32_bf16 v[180:183], a[140:143], a[108:111], v[180:183]
v_cvt_pk_bf16_f32 v17, v18, v19
v_cvt_pk_bf16_f32 v18, v20, v21
v_mfma_f32_16x16x32_bf16 v[188:191], a[132:135], a[108:111], v[188:191]
v_cvt_pk_bf16_f32 v19, v22, v23
v_accvgpr_write_b32 a8, v16
v_mfma_f32_16x16x32_bf16 v[188:191], a[128:131], a[104:107], v[188:191]
s_waitcnt lgkmcnt(0)
v_accvgpr_write_b32 a9, v17
v_accvgpr_write_b32 a10, v18
v_mfma_f32_16x16x32_bf16 v[196:199], a[160:163], a[80:83], v[196:199]
s_waitcnt vmcnt(17)
v_accvgpr_write_b32 a11, v19
v_accvgpr_read_b32 v16, a16
v_mfma_f32_16x16x32_bf16 v[196:199], a[164:167], a[84:87], v[196:199]
s_barrier
v_mfma_f32_16x16x32_bf16 v[64:67], a[172:175], a[84:87], v[64:67]
s_add_u32 s53, s87, 0
ds_read_b64_tr_b16 a[128:129], v11 offset:0
ds_read_b64_tr_b16 a[130:131], v11 offset:512
v_mfma_f32_16x16x32_bf16 v[64:67], a[168:171], a[80:83], v[64:67]
s_add_u32 m0, s77, 49152
s_add_u32 s64, s76, 128
v_accvgpr_read_b32 v17, a17
v_mfma_f32_16x16x32_bf16 v[204:207], a[176:179], a[80:83], v[204:207]
buffer_load_dwordx4 v7, s[20:23], s64 offen lds
v_mfma_f32_16x16x32_bf16 v[204:207], a[180:183], a[84:87], v[204:207]
ds_read_b64_tr_b16 a[132:133], v11 offset:4096
ds_read_b64_tr_b16 a[134:135], v11 offset:4608
v_mfma_f32_16x16x32_bf16 v[212:215], a[188:191], a[84:87], v[212:215]
ds_read_b64_tr_b16 a[136:137], v12 offset:0
ds_read_b64_tr_b16 a[138:139], v12 offset:512
v_mfma_f32_16x16x32_bf16 v[212:215], a[184:187], a[80:83], v[212:215]
ds_read_b64_tr_b16 a[140:141], v12 offset:4096
ds_read_b64_tr_b16 a[142:143], v12 offset:4608
v_mfma_f32_16x16x32_bf16 v[72:75], a[112:115], a[80:83], v[72:75]
buffer_store_dwordx4 v[168:171], v15, s[24:27], s53 offen offset:1024 sc1
v_mfma_f32_16x16x32_bf16 v[72:75], a[116:119], a[84:87], v[72:75]
ds_read_b64_tr_b16 a[144:145], v13 offset:0
ds_read_b64_tr_b16 a[146:147], v13 offset:512
v_mfma_f32_16x16x32_bf16 v[220:223], a[124:127], a[84:87], v[220:223]
buffer_load_dwordx4 v8, s[20:23], s64 offen offset:1024 lds
v_mfma_f32_16x16x32_bf16 v[220:223], a[120:123], a[80:83], v[220:223]
ds_read_b64_tr_b16 a[148:149], v13 offset:4096
ds_read_b64_tr_b16 a[150:151], v13 offset:4608
v_mfma_f32_16x16x32_bf16 a[32:35], a[120:123], a[88:91], a[32:35]
v_accvgpr_read_b32 v18, a18
v_accvgpr_read_b32 v19, a19
v_mfma_f32_16x16x32_bf16 a[32:35], a[124:127], a[92:95], a[32:35]
ds_read_b64_tr_b16 a[152:153], v14 offset:0
ds_read_b64_tr_b16 a[154:155], v14 offset:512
v_mfma_f32_16x16x32_bf16 a[36:39], a[116:119], a[92:95], a[36:39]
s_add_u32 m0, s80, 49152
s_add_u32 s64, s79, 2048
v_accvgpr_read_b32 v20, a20
v_mfma_f32_16x16x32_bf16 a[36:39], a[112:115], a[88:91], a[36:39]
ds_read_b64_tr_b16 a[156:157], v14 offset:4096
ds_read_b64_tr_b16 a[158:159], v14 offset:4608
v_mfma_f32_16x16x32_bf16 v[228:231], a[184:187], a[88:91], v[228:231]
buffer_load_dwordx4 v15, s[24:27], s64 offen sc1 lds
v_mfma_f32_16x16x32_bf16 v[228:231], a[188:191], a[92:95], v[228:231]
s_xor_b32 s65, s70, 384
s_add_u32 s71, s68, s65
s_add_u32 s72, s69, s65
v_mfma_f32_16x16x32_bf16 a[40:43], a[180:183], a[92:95], a[40:43]
ds_read_b128 a[64:67], v4 offset:8192
v_accvgpr_read_b32 v21, a21
v_mfma_f32_16x16x32_bf16 a[40:43], a[176:179], a[88:91], a[40:43]
v_accvgpr_read_b32 v22, a22
v_accvgpr_read_b32 v23, a23
v_mfma_f32_16x16x32_bf16 a[44:47], a[168:171], a[88:91], a[44:47]
s_add_u32 m0, s73, 0
s_add_u32 s64, s71, 0
ds_read_b128 a[80:83], v9 offset:0
v_mfma_f32_16x16x32_bf16 a[44:47], a[172:175], a[92:95], a[44:47]
v_mul_f32 v16, s91, v16
v_mul_f32 v17, s91, v17
v_mfma_f32_16x16x32_bf16 v[80:83], a[164:167], a[92:95], v[80:83]
buffer_load_dwordx4 v5, s[12:15], s64 offen lds
v_mfma_f32_16x16x32_bf16 v[80:83], a[160:163], a[88:91], v[80:83]
ds_read_b128 a[68:71], v4 offset:10240
v_mul_f32 v18, s91, v18
v_mfma_f32_16x16x32_bf16 a[48:51], a[160:163], a[96:99], a[48:51]
ds_read_b128 a[84:87], v10 offset:0
v_mul_f32 v19, s91, v19
v_mfma_f32_16x16x32_bf16 a[48:51], a[164:167], a[100:103], a[48:51]
v_mul_f32 v20, s91, v20
v_mul_f32 v21, s91, v21
v_mfma_f32_16x16x32_bf16 a[52:55], a[172:175], a[100:103], a[52:55]
v_mul_f32 v22, s91, v22
v_mul_f32 v23, s91, v23
v_mfma_f32_16x16x32_bf16 a[52:55], a[168:171], a[96:99], a[52:55]
ds_read_b128 a[72:75], v4 offset:9216
v_cvt_pk_bf16_f32 v16, v16, v17
v_mfma_f32_16x16x32_bf16 a[56:59], a[176:179], a[96:99], a[56:59]
buffer_load_dwordx4 v6, s[12:15], s64 offen offset:1024 lds
v_mfma_f32_16x16x32_bf16 a[56:59], a[180:183], a[100:103], a[56:59]
s_add_u32 s53, s87, 4096
ds_read_b128 a[88:91], v9 offset:2048
v_cvt_pk_bf16_f32 v17, v18, v19
v_mfma_f32_16x16x32_bf16 a[60:63], a[188:191], a[100:103], a[60:63]
buffer_store_dwordx4 v[176:179], v15, s[24:27], s53 offen offset:0 sc1
v_mfma_f32_16x16x32_bf16 a[60:63], a[184:187], a[96:99], a[60:63]
ds_read_b128 a[76:79], v4 offset:11264
v_cvt_pk_bf16_f32 v18, v20, v21
v_mfma_f32_16x16x32_bf16 v[236:239], a[112:115], a[96:99], v[236:239]
s_add_u32 m0, s73, 2048
s_add_u32 s64, s71, 18432
v_cvt_pk_bf16_f32 v19, v22, v23
v_mfma_f32_16x16x32_bf16 v[236:239], a[116:119], a[100:103], v[236:239]
ds_read_b128 a[92:95], v10 offset:2048
v_accvgpr_write_b32 a16, v16
v_mfma_f32_16x16x32_bf16 a[192:195], a[124:127], a[100:103], a[192:195]
buffer_load_dwordx4 v5, s[12:15], s64 offen lds
v_mfma_f32_16x16x32_bf16 a[192:195], a[120:123], a[96:99], a[192:195]
v_accvgpr_write_b32 a17, v17
v_accvgpr_write_b32 a18, v18
v_mfma_f32_16x16x32_bf16 a[196:199], a[120:123], a[104:107], a[196:199]
v_accvgpr_write_b32 a19, v19
v_accvgpr_read_b32 v16, a24
v_mfma_f32_16x16x32_bf16 a[196:199], a[124:127], a[108:111], a[196:199]
v_accvgpr_read_b32 v17, a25
v_accvgpr_read_b32 v18, a26
v_mfma_f32_16x16x32_bf16 a[200:203], a[116:119], a[108:111], a[200:203]
v_accvgpr_read_b32 v19, a27
v_accvgpr_read_b32 v20, a28
v_mfma_f32_16x16x32_bf16 a[200:203], a[112:115], a[104:107], a[200:203]
v_accvgpr_read_b32 v21, a29
v_accvgpr_read_b32 v22, a30
v_mfma_f32_16x16x32_bf16 v[244:247], a[184:187], a[104:107], v[244:247]
buffer_load_dwordx4 v6, s[12:15], s64 offen offset:1024 lds
v_mfma_f32_16x16x32_bf16 v[244:247], a[188:191], a[108:111], v[244:247]
v_accvgpr_read_b32 v23, a31
v_mul_f32 v16, s91, v16
v_mfma_f32_16x16x32_bf16 a[204:207], a[180:183], a[108:111], a[204:207]
v_mul_f32 v17, s91, v17
v_mul_f32 v18, s91, v18
v_mfma_f32_16x16x32_bf16 a[204:207], a[176:179], a[104:107], a[204:207]
v_mul_f32 v19, s91, v19
v_mul_f32 v20, s91, v20
v_mfma_f32_16x16x32_bf16 a[208:211], a[168:171], a[104:107], a[208:211]
v_mul_f32 v21, s91, v21
v_mul_f32 v22, s91, v22
v_mfma_f32_16x16x32_bf16 a[208:211], a[172:175], a[108:111], a[208:211]
v_mul_f32 v23, s91, v23
v_cvt_pk_bf16_f32 v16, v16, v17
v_mfma_f32_16x16x32_bf16 v[88:91], a[164:167], a[108:111], v[88:91]
v_cvt_pk_bf16_f32 v17, v18, v19
v_cvt_pk_bf16_f32 v18, v20, v21
v_mfma_f32_16x16x32_bf16 v[88:91], a[160:163], a[104:107], v[88:91]
s_waitcnt lgkmcnt(0)
v_cvt_pk_bf16_f32 v19, v22, v23
v_accvgpr_write_b32 a24, v16
v_mfma_f32_16x16x32_bf16 v[36:39], a[128:131], a[80:83], v[36:39]
s_waitcnt vmcnt(23)
v_accvgpr_write_b32 a25, v17
v_accvgpr_write_b32 a26, v18
v_mfma_f32_16x16x32_bf16 v[36:39], a[132:135], a[84:87], v[36:39]
s_barrier
v_mfma_f32_16x16x32_bf16 v[44:47], a[140:143], a[84:87], v[44:47]
ds_read_b128 a[96:99], v9 offset:4096
v_accvgpr_write_b32 a27, v19
v_mfma_f32_16x16x32_bf16 v[44:47], a[136:139], a[80:83], v[44:47]
s_xor_b32 s75, s93, 3
s_lshl_b32 s76, s75, 19
s_add_u32 s76, s76, s74
v_mfma_f32_16x16x32_bf16 v[32:35], a[144:147], a[80:83], v[32:35]
s_lshl_b32 s79, s75, 13
s_add_u32 s79, s79, s78
ds_read_b128 a[100:103], v10 offset:4096
v_mfma_f32_16x16x32_bf16 v[32:35], a[148:151], a[84:87], v[32:35]
s_add_u32 m0, s77, 0
s_add_u32 s64, s76, 0
ds_read_b128 a[104:107], v9 offset:6144
v_mfma_f32_16x16x32_bf16 v[52:55], a[156:159], a[84:87], v[52:55]
buffer_load_dwordx4 v7, s[20:23], s64 offen lds
v_mfma_f32_16x16x32_bf16 v[52:55], a[152:155], a[80:83], v[52:55]
s_add_u32 s53, s87, 4096
ds_read_b64_tr_b16 a[160:161], v11 offset:16384
ds_read_b64_tr_b16 a[162:163], v11 offset:16896
v_mfma_f32_16x16x32_bf16 v[60:63], a[64:67], a[80:83], v[60:63]
buffer_store_dwordx4 v[184:187], v15, s[24:27], s53 offen offset:1024 sc1
v_mfma_f32_16x16x32_bf16 v[60:63], a[68:71], a[84:87], v[60:63]
ds_read_b128 a[108:111], v10 offset:6144
v_accvgpr_write_b32 a4, v248
v_mfma_f32_16x16x32_bf16 v[68:71], a[76:79], a[84:87], v[68:71]
buffer_load_dwordx4 v8, s[20:23], s64 offen offset:1024 lds
v_mfma_f32_16x16x32_bf16 v[68:71], a[72:75], a[80:83], v[68:71]
ds_read_b64_tr_b16 a[164:165], v11 offset:20480
ds_read_b64_tr_b16 a[166:167], v11 offset:20992
v_mfma_f32_16x16x32_bf16 v[76:79], a[72:75], a[88:91], v[76:79]
v_add_u32 v9, 32768, v9
v_add_u32 v10, 32768, v10
v_mfma_f32_16x16x32_bf16 v[76:79], a[76:79], a[92:95], v[76:79]
ds_read_b64_tr_b16 a[168:169], v12 offset:16384
ds_read_b64_tr_b16 a[170:171], v12 offset:16896
v_mfma_f32_16x16x32_bf16 v[84:87], a[68:71], a[92:95], v[84:87]
s_add_u32 m0, s80, 0
s_add_u32 s64, s79, 0
v_accvgpr_write_b32 a5, v249
v_mfma_f32_16x16x32_bf16 v[84:87], a[64:67], a[88:91], v[84:87]
ds_read_b64_tr_b16 a[172:173], v12 offset:20480
ds_read_b64_tr_b16 a[174:175], v12 offset:20992
v_mfma_f32_16x16x32_bf16 v[92:95], a[152:155], a[88:91], v[92:95]
buffer_load_dwordx4 v15, s[24:27], s64 offen sc1 lds
v_mfma_f32_16x16x32_bf16 v[92:95], a[156:159], a[92:95], v[92:95]
v_accvgpr_write_b32 a6, v250
v_accvgpr_write_b32 a7, v251
v_mfma_f32_16x16x32_bf16 v[40:43], a[148:151], a[92:95], v[40:43]
ds_read_b64_tr_b16 a[176:177], v13 offset:16384
ds_read_b64_tr_b16 a[178:179], v13 offset:16896
v_mfma_f32_16x16x32_bf16 v[40:43], a[144:147], a[88:91], v[40:43]
v_accvgpr_write_b32 a12, v240
v_accvgpr_write_b32 a13, v241
v_mfma_f32_16x16x32_bf16 v[100:103], a[136:139], a[88:91], v[100:103]
s_add_u32 m0, s73, 4096
s_add_u32 s64, s72, 0
v_accvgpr_write_b32 a14, v242
v_mfma_f32_16x16x32_bf16 v[100:103], a[140:143], a[92:95], v[100:103]
ds_read_b64_tr_b16 a[180:181], v13 offset:20480
ds_read_b64_tr_b16 a[182:183], v13 offset:20992
v_mfma_f32_16x16x32_bf16 v[108:111], a[132:135], a[92:95], v[108:111]
buffer_load_dwordx4 v5, s[12:15], s64 offen lds
v_mfma_f32_16x16x32_bf16 v[108:111], a[128:131], a[88:91], v[108:111]
s_waitcnt lgkmcnt(14)
ds_read_b64_tr_b16 a[184:185], v14 offset:16384
ds_read_b64_tr_b16 a[186:187], v14 offset:16896
v_mfma_f32_16x16x32_bf16 v[116:119], a[128:131], a[96:99], v[116:119]
ds_read_b64_tr_b16 a[188:189], v14 offset:20480
ds_read_b64_tr_b16 a[190:191], v14 offset:20992
v_mfma_f32_16x16x32_bf16 v[116:119], a[132:135], a[100:103], v[116:119]
v_accvgpr_write_b32 a15, v243
v_accvgpr_write_b32 a20, v232
v_mfma_f32_16x16x32_bf16 v[124:127], a[140:143], a[100:103], v[124:127]
v_accvgpr_write_b32 a21, v233
v_accvgpr_write_b32 a22, v234
v_mfma_f32_16x16x32_bf16 v[124:127], a[136:139], a[96:99], v[124:127]
ds_read_b128 a[112:115], v4 offset:24576
v_accvgpr_write_b32 a23, v235
v_mfma_f32_16x16x32_bf16 v[132:135], a[144:147], a[96:99], v[132:135]
buffer_load_dwordx4 v6, s[12:15], s64 offen offset:1024 lds
v_mfma_f32_16x16x32_bf16 v[132:135], a[148:151], a[100:103], v[132:135]
ds_read_b128 a[116:119], v4 offset:26624
v_accvgpr_write_b32 a28, v224
v_mfma_f32_16x16x32_bf16 v[140:143], a[156:159], a[100:103], v[140:143]
v_accvgpr_write_b32 a29, v225
v_accvgpr_write_b32 a30, v226
v_mfma_f32_16x16x32_bf16 v[140:143], a[152:155], a[96:99], v[140:143]
ds_read_b128 a[120:123], v4 offset:25600
v_accvgpr_write_b32 a31, v227
v_mfma_f32_16x16x32_bf16 v[148:151], a[64:67], a[96:99], v[148:151]
s_add_u32 m0, s73, 6144
s_add_u32 s64, s72, 18432
v_accvgpr_read_b32 v252, a32
v_mfma_f32_16x16x32_bf16 v[148:151], a[68:71], a[100:103], v[148:151]
ds_read_b128 a[124:127], v4 offset:27648
v_accvgpr_read_b32 v253, a33
v_mfma_f32_16x16x32_bf16 v[48:51], a[76:79], a[100:103], v[48:51]
buffer_load_dwordx4 v5, s[12:15], s64 offen lds
v_mfma_f32_16x16x32_bf16 v[48:51], a[72:75], a[96:99], v[48:51]
s_waitcnt lgkmcnt(15)
s_add_u32 s53, s87, 262144
v_accvgpr_read_b32 v254, a34
v_mfma_f32_16x16x32_bf16 v[156:159], a[72:75], a[104:107], v[156:159]
buffer_store_dwordx4 v[192:195], v15, s[24:27], s53 offen offset:0 sc1
v_mfma_f32_16x16x32_bf16 v[156:159], a[76:79], a[108:111], v[156:159]
v_accvgpr_read_b32 v255, a35
v_accvgpr_read_b32 v160, a36
v_mfma_f32_16x16x32_bf16 v[164:167], a[68:71], a[108:111], v[164:167]
v_accvgpr_read_b32 v161, a37
v_accvgpr_read_b32 v162, a38
v_mfma_f32_16x16x32_bf16 v[164:167], a[64:67], a[104:107], v[164:167]
v_accvgpr_read_b32 v163, a39
v_accvgpr_read_b32 v168, a40
v_mfma_f32_16x16x32_bf16 v[172:175], a[152:155], a[104:107], v[172:175]
buffer_load_dwordx4 v6, s[12:15], s64 offen offset:1024 lds
v_mfma_f32_16x16x32_bf16 v[172:175], a[156:159], a[108:111], v[172:175]
v_accvgpr_read_b32 v169, a41
v_accvgpr_read_b32 v170, a42
v_mfma_f32_16x16x32_bf16 v[56:59], a[148:151], a[108:111], v[56:59]
v_accvgpr_read_b32 v171, a43
v_accvgpr_read_b32 v176, a44
v_mfma_f32_16x16x32_bf16 v[56:59], a[144:147], a[104:107], v[56:59]
v_accvgpr_read_b32 v177, a45
v_accvgpr_read_b32 v178, a46
v_mfma_f32_16x16x32_bf16 v[180:183], a[136:139], a[104:107], v[180:183]
v_accvgpr_read_b32 v179, a47
v_accvgpr_read_b32 v184, a48
v_mfma_f32_16x16x32_bf16 v[180:183], a[140:143], a[108:111], v[180:183]
v_accvgpr_read_b32 v185, a49
v_accvgpr_read_b32 v186, a50
v_mfma_f32_16x16x32_bf16 v[188:191], a[132:135], a[108:111], v[188:191]
v_accvgpr_read_b32 v187, a51
v_accvgpr_read_b32 v248, a52
v_mfma_f32_16x16x32_bf16 v[188:191], a[128:131], a[104:107], v[188:191]
s_waitcnt lgkmcnt(0)
v_accvgpr_read_b32 v249, a53
v_accvgpr_read_b32 v250, a54
v_mfma_f32_16x16x32_bf16 v[196:199], a[160:163], a[80:83], v[196:199]
s_waitcnt vmcnt(18)
v_accvgpr_read_b32 v251, a55
v_accvgpr_read_b32 v240, a56
v_mfma_f32_16x16x32_bf16 v[196:199], a[164:167], a[84:87], v[196:199]
s_barrier
v_mfma_f32_16x16x32_bf16 v[64:67], a[172:175], a[84:87], v[64:67]
ds_read_b64_tr_b16 a[128:129], v11 offset:32768
ds_read_b64_tr_b16 a[130:131], v11 offset:33280
v_mfma_f32_16x16x32_bf16 v[64:67], a[168:171], a[80:83], v[64:67]
s_add_u32 m0, s77, 16384
s_add_u32 s64, s76, 128
v_accvgpr_read_b32 v241, a57
v_mfma_f32_16x16x32_bf16 v[204:207], a[176:179], a[80:83], v[204:207]
buffer_load_dwordx4 v7, s[20:23], s64 offen lds
v_mfma_f32_16x16x32_bf16 v[204:207], a[180:183], a[84:87], v[204:207]
ds_read_b64_tr_b16 a[132:133], v11 offset:36864
ds_read_b64_tr_b16 a[134:135], v11 offset:37376
v_mfma_f32_16x16x32_bf16 v[212:215], a[188:191], a[84:87], v[212:215]
ds_read_b64_tr_b16 a[136:137], v12 offset:32768
ds_read_b64_tr_b16 a[138:139], v12 offset:33280
v_mfma_f32_16x16x32_bf16 v[212:215], a[184:187], a[80:83], v[212:215]
ds_read_b64_tr_b16 a[140:141], v12 offset:36864
ds_read_b64_tr_b16 a[142:143], v12 offset:37376
v_mfma_f32_16x16x32_bf16 v[72:75], a[112:115], a[80:83], v[72:75]
v_accvgpr_read_b32 v242, a58
v_accvgpr_read_b32 v243, a59
v_mfma_f32_16x16x32_bf16 v[72:75], a[116:119], a[84:87], v[72:75]
ds_read_b64_tr_b16 a[144:145], v13 offset:32768
ds_read_b64_tr_b16 a[146:147], v13 offset:33280
v_mfma_f32_16x16x32_bf16 v[220:223], a[124:127], a[84:87], v[220:223]
buffer_load_dwordx4 v8, s[20:23], s64 offen offset:1024 lds
v_mfma_f32_16x16x32_bf16 v[220:223], a[120:123], a[80:83], v[220:223]
ds_read_b64_tr_b16 a[148:149], v13 offset:36864
ds_read_b64_tr_b16 a[150:151], v13 offset:37376
v_mfma_f32_16x16x32_bf16 v[252:255], a[120:123], a[88:91], v[252:255]
v_accvgpr_read_b32 v232, a60
v_accvgpr_read_b32 v233, a61
v_mfma_f32_16x16x32_bf16 v[252:255], a[124:127], a[92:95], v[252:255]
s_add_u32 s53, s87, 262144
ds_read_b64_tr_b16 a[152:153], v14 offset:32768
ds_read_b64_tr_b16 a[154:155], v14 offset:33280
v_mfma_f32_16x16x32_bf16 v[160:163], a[116:119], a[92:95], v[160:163]
s_add_u32 m0, s80, 16384
s_add_u32 s64, s79, 2048
v_accvgpr_read_b32 v234, a62
v_mfma_f32_16x16x32_bf16 v[160:163], a[112:115], a[88:91], v[160:163]
L_PAD5:
s_cbranch_execz L_PAD9
ds_read_b64_tr_b16 a[156:157], v14 offset:36864
ds_read_b64_tr_b16 a[158:159], v14 offset:37376
v_mfma_f32_16x16x32_bf16 v[228:231], a[184:187], a[88:91], v[228:231]
buffer_load_dwordx4 v15, s[24:27], s64 offen sc1 lds
v_mfma_f32_16x16x32_bf16 v[228:231], a[188:191], a[92:95], v[228:231]
s_xor_b32 s65, s70, 512
s_add_u32 s71, s68, s65
s_add_u32 s72, s69, s65
v_mfma_f32_16x16x32_bf16 v[168:171], a[180:183], a[92:95], v[168:171]
ds_read_b128 a[64:67], v4 offset:40960
v_accvgpr_read_b32 v235, a63
v_mfma_f32_16x16x32_bf16 v[168:171], a[176:179], a[88:91], v[168:171]
buffer_store_dwordx4 v[200:203], v15, s[24:27], s53 offen offset:1024 sc1
v_mfma_f32_16x16x32_bf16 v[176:179], a[168:171], a[88:91], v[176:179]
s_add_u32 m0, s73, 32768
s_add_u32 s64, s71, 0
ds_read_b128 a[80:83], v9 offset:0
v_mfma_f32_16x16x32_bf16 v[176:179], a[172:175], a[92:95], v[176:179]
v_accvgpr_read_b32 v224, a192
v_accvgpr_read_b32 v225, a193
v_mfma_f32_16x16x32_bf16 v[80:83], a[164:167], a[92:95], v[80:83]
buffer_load_dwordx4 v5, s[12:15], s64 offen lds
v_mfma_f32_16x16x32_bf16 v[80:83], a[160:163], a[88:91], v[80:83]
ds_read_b128 a[68:71], v4 offset:43008
v_accvgpr_read_b32 v226, a194
v_mfma_f32_16x16x32_bf16 v[184:187], a[160:163], a[96:99], v[184:187]
ds_read_b128 a[84:87], v10 offset:0
v_accvgpr_read_b32 v227, a195
v_mfma_f32_16x16x32_bf16 v[184:187], a[164:167], a[100:103], v[184:187]
v_accvgpr_read_b32 v192, a204
v_accvgpr_read_b32 v193, a205
v_mfma_f32_16x16x32_bf16 v[248:251], a[172:175], a[100:103], v[248:251]
v_accvgpr_read_b32 v194, a206
v_accvgpr_read_b32 v195, a207
v_mfma_f32_16x16x32_bf16 v[248:251], a[168:171], a[96:99], v[248:251]
ds_read_b128 a[72:75], v4 offset:41984
v_accvgpr_read_b32 v200, a208
v_mfma_f32_16x16x32_bf16 v[240:243], a[176:179], a[96:99], v[240:243]
buffer_load_dwordx4 v6, s[12:15], s64 offen offset:1024 lds
v_mfma_f32_16x16x32_bf16 v[240:243], a[180:183], a[100:103], v[240:243]
ds_read_b128 a[88:91], v9 offset:2048
v_accvgpr_read_b32 v201, a209
v_mfma_f32_16x16x32_bf16 v[232:235], a[188:191], a[100:103], v[232:235]
v_accvgpr_read_b32 v202, a210
v_accvgpr_read_b32 v203, a211
v_mfma_f32_16x16x32_bf16 v[232:235], a[184:187], a[96:99], v[232:235]
ds_read_b128 a[76:79], v4 offset:44032
v_and_b32 v28, 31, v1
v_mfma_f32_16x16x32_bf16 v[236:239], a[112:115], a[96:99], v[236:239]
s_add_u32 m0, s73, 34816
s_add_u32 s64, s71, 18432
v_lshlrev_b32 v28, 2, v28
v_mfma_f32_16x16x32_bf16 v[236:239], a[116:119], a[100:103], v[236:239]
ds_read_b128 a[92:95], v10 offset:2048
v_mfma_f32_16x16x32_bf16 v[224:227], a[124:127], a[100:103], v[224:227]
buffer_load_dwordx4 v5, s[12:15], s64 offen lds
v_mfma_f32_16x16x32_bf16 v[224:227], a[120:123], a[96:99], v[224:227]
buffer_load_dword v30, v28, s[40:43], 0 offen sc1
v_mfma_f32_16x16x32_bf16 a[196:199], a[120:123], a[104:107], a[196:199]
v_mfma_f32_16x16x32_bf16 a[196:199], a[124:127], a[108:111], a[196:199]
v_mfma_f32_16x16x32_bf16 a[200:203], a[116:119], a[108:111], a[200:203]
v_mfma_f32_16x16x32_bf16 a[200:203], a[112:115], a[104:107], a[200:203]
v_mfma_f32_16x16x32_bf16 v[244:247], a[184:187], a[104:107], v[244:247]
buffer_load_dwordx4 v6, s[12:15], s64 offen offset:1024 lds
v_mfma_f32_16x16x32_bf16 v[244:247], a[188:191], a[108:111], v[244:247]
s_add_u32 s53, s87, 266240
v_mfma_f32_16x16x32_bf16 v[192:195], a[180:183], a[108:111], v[192:195]
buffer_store_dwordx4 v[208:211], v15, s[24:27], s53 offen offset:0 sc1
v_mfma_f32_16x16x32_bf16 v[192:195], a[176:179], a[104:107], v[192:195]
v_mfma_f32_16x16x32_bf16 v[200:203], a[168:171], a[104:107], v[200:203]
v_mfma_f32_16x16x32_bf16 v[200:203], a[172:175], a[108:111], v[200:203]
v_accvgpr_read_b32 v208, a196
v_accvgpr_read_b32 v209, a197
v_mfma_f32_16x16x32_bf16 v[88:91], a[164:167], a[108:111], v[88:91]
v_accvgpr_read_b32 v210, a198
v_accvgpr_read_b32 v211, a199
v_mfma_f32_16x16x32_bf16 v[88:91], a[160:163], a[104:107], v[88:91]
s_waitcnt lgkmcnt(0)
v_mfma_f32_16x16x32_bf16 v[36:39], a[128:131], a[80:83], v[36:39]
s_waitcnt vmcnt(24)
v_mfma_f32_16x16x32_bf16 v[36:39], a[132:135], a[84:87], v[36:39]
s_barrier
v_mfma_f32_16x16x32_bf16 v[44:47], a[140:143], a[84:87], v[44:47]
ds_read_b128 a[96:99], v9 offset:4096
v_mfma_f32_16x16x32_bf16 v[44:47], a[136:139], a[80:83], v[44:47]
s_xor_b32 s75, s93, 4
s_lshl_b32 s76, s75, 19
s_add_u32 s76, s76, s74
v_mfma_f32_16x16x32_bf16 v[32:35], a[144:147], a[80:83], v[32:35]
s_lshl_b32 s79, s75, 13
s_add_u32 s79, s79, s78
ds_read_b128 a[100:103], v10 offset:4096
v_mfma_f32_16x16x32_bf16 v[32:35], a[148:151], a[84:87], v[32:35]
s_add_u32 m0, s77, 32768
s_add_u32 s64, s76, 0
ds_read_b128 a[104:107], v9 offset:6144
v_mfma_f32_16x16x32_bf16 v[52:55], a[156:159], a[84:87], v[52:55]
buffer_load_dwordx4 v7, s[20:23], s64 offen lds
v_mfma_f32_16x16x32_bf16 v[52:55], a[152:155], a[80:83], v[52:55]
ds_read_b64_tr_b16 a[160:161], v11 offset:49152
ds_read_b64_tr_b16 a[162:163], v11 offset:49664
v_mfma_f32_16x16x32_bf16 v[60:63], a[64:67], a[80:83], v[60:63]
v_mfma_f32_16x16x32_bf16 v[60:63], a[68:71], a[84:87], v[60:63]
ds_read_b128 a[108:111], v10 offset:6144
v_mfma_f32_16x16x32_bf16 v[68:71], a[76:79], a[84:87], v[68:71]
buffer_load_dwordx4 v8, s[20:23], s64 offen offset:1024 lds
v_mfma_f32_16x16x32_bf16 v[68:71], a[72:75], a[80:83], v[68:71]
ds_read_b64_tr_b16 a[164:165], v11 offset:53248
ds_read_b64_tr_b16 a[166:167], v11 offset:53760
v_mfma_f32_16x16x32_bf16 v[76:79], a[72:75], a[88:91], v[76:79]
v_add_u32 v9, -65536, v9
v_add_u32 v10, -65536, v10
v_mfma_f32_16x16x32_bf16 v[76:79], a[76:79], a[92:95], v[76:79]
ds_read_b64_tr_b16 a[168:169], v12 offset:49152
ds_read_b64_tr_b16 a[170:171], v12 offset:49664
v_mfma_f32_16x16x32_bf16 v[84:87], a[68:71], a[92:95], v[84:87]
s_add_u32 m0, s80, 32768
s_add_u32 s64, s79, 0
v_mfma_f32_16x16x32_bf16 v[84:87], a[64:67], a[88:91], v[84:87]
ds_read_b64_tr_b16 a[172:173], v12 offset:53248
ds_read_b64_tr_b16 a[174:175], v12 offset:53760
v_mfma_f32_16x16x32_bf16 v[92:95], a[152:155], a[88:91], v[92:95]
buffer_load_dwordx4 v15, s[24:27], s64 offen sc1 lds
v_mfma_f32_16x16x32_bf16 v[92:95], a[156:159], a[92:95], v[92:95]
v_mfma_f32_16x16x32_bf16 v[40:43], a[148:151], a[92:95], v[40:43]
ds_read_b64_tr_b16 a[176:177], v13 offset:49152
ds_read_b64_tr_b16 a[178:179], v13 offset:49664
v_mfma_f32_16x16x32_bf16 v[40:43], a[144:147], a[88:91], v[40:43]
s_add_u32 s53, s87, 266240
v_mfma_f32_16x16x32_bf16 v[100:103], a[136:139], a[88:91], v[100:103]
s_add_u32 m0, s73, 36864
s_add_u32 s64, s72, 0
v_mfma_f32_16x16x32_bf16 v[100:103], a[140:143], a[92:95], v[100:103]
ds_read_b64_tr_b16 a[180:181], v13 offset:53248
ds_read_b64_tr_b16 a[182:183], v13 offset:53760
v_mfma_f32_16x16x32_bf16 v[108:111], a[132:135], a[92:95], v[108:111]
buffer_load_dwordx4 v5, s[12:15], s64 offen lds
v_mfma_f32_16x16x32_bf16 v[108:111], a[128:131], a[88:91], v[108:111]
s_waitcnt lgkmcnt(14)
ds_read_b64_tr_b16 a[184:185], v14 offset:49152
ds_read_b64_tr_b16 a[186:187], v14 offset:49664
v_mfma_f32_16x16x32_bf16 v[116:119], a[128:131], a[96:99], v[116:119]
s_waitcnt vmcnt(6)
ds_read_b64_tr_b16 a[188:189], v14 offset:53248
ds_read_b64_tr_b16 a[190:191], v14 offset:53760
v_mfma_f32_16x16x32_bf16 v[116:119], a[132:135], a[100:103], v[116:119]
buffer_store_dwordx4 v[216:219], v15, s[24:27], s53 offen offset:1024 sc1
v_mfma_f32_16x16x32_bf16 v[124:127], a[140:143], a[100:103], v[124:127]
v_cmp_gt_u32 vcc, 1, v30
v_mfma_f32_16x16x32_bf16 v[124:127], a[136:139], a[96:99], v[124:127]
ds_read_b128 a[112:115], v4 offset:57344
v_accvgpr_read_b32 v216, a200
v_mfma_f32_16x16x32_bf16 v[132:135], a[144:147], a[96:99], v[132:135]
buffer_load_dwordx4 v6, s[12:15], s64 offen offset:1024 lds
v_mfma_f32_16x16x32_bf16 v[132:135], a[148:151], a[100:103], v[132:135]
ds_read_b128 a[116:119], v4 offset:59392
v_accvgpr_read_b32 v217, a201
v_mfma_f32_16x16x32_bf16 v[140:143], a[156:159], a[100:103], v[140:143]
v_accvgpr_read_b32 v218, a202
v_accvgpr_read_b32 v219, a203
v_mfma_f32_16x16x32_bf16 v[140:143], a[152:155], a[96:99], v[140:143]
s_lshr_b32 s84, s7, 1
s_and_b32 s85, s7, 1
ds_read_b128 a[120:123], v4 offset:58368
v_mfma_f32_16x16x32_bf16 v[148:151], a[64:67], a[96:99], v[148:151]
s_add_u32 m0, s73, 38912
s_add_u32 s64, s72, 18432
s_xor_b32 s52, s5, 0
v_mfma_f32_16x16x32_bf16 v[148:151], a[68:71], a[100:103], v[148:151]
s_lshl1_add_u32 s85, s52, s85
s_and_b32 s86, s6, 3
ds_read_b128 a[124:127], v4 offset:60416
v_mfma_f32_16x16x32_bf16 v[48:51], a[76:79], a[100:103], v[48:51]
buffer_load_dwordx4 v5, s[12:15], s64 offen lds
v_mfma_f32_16x16x32_bf16 v[48:51], a[72:75], a[96:99], v[48:51]
s_waitcnt lgkmcnt(15)
s_lshl_b32 s83, s3, 13
s_add_u32 s83, s83, 131072
v_mfma_f32_16x16x32_bf16 v[156:159], a[72:75], a[104:107], v[156:159]
s_cbranch_vccnz CK_ZA
CK_ZA_R:
v_mfma_f32_16x16x32_bf16 v[156:159], a[76:79], a[108:111], v[156:159]
s_mul_i32 s52, s2, 5462
s_lshr_b32 s52, s52, 16
s_mul_i32 s54, s52, 12
v_mfma_f32_16x16x32_bf16 v[164:167], a[68:71], a[108:111], v[164:167]
s_sub_u32 s54, s2, s54
s_mul_i32 s54, s54, 3
s_add_u32 s54, s54, s3
v_mfma_f32_16x16x32_bf16 v[164:167], a[64:67], a[104:107], v[164:167]
s_mul_i32 s55, s52, 13108
s_lshr_b32 s55, s55, 16
s_mul_i32 s82, s55, 5
v_mfma_f32_16x16x32_bf16 v[172:175], a[152:155], a[104:107], v[172:175]
buffer_load_dwordx4 v6, s[12:15], s64 offen offset:1024 lds
v_mfma_f32_16x16x32_bf16 v[172:175], a[156:159], a[108:111], v[172:175]
s_sub_u32 s52, s52, s82
v_mfma_f32_16x16x32_bf16 v[56:59], a[148:151], a[108:111], v[56:59]
v_lshrrev_b32 v16, 1, v1
v_and_b32 v17, 1, v1
v_mfma_f32_16x16x32_bf16 v[56:59], a[144:147], a[104:107], v[56:59]
v_mul_u32_u24 v18, 1152, v16
v_lshl_add_u32 v18, v17, 4, v18
v_mfma_f32_16x16x32_bf16 v[180:183], a[136:139], a[104:107], v[180:183]
v_mov_b32 v24, v18
v_lshrrev_b32 v18, 4, v16
v_mfma_f32_16x16x32_bf16 v[180:183], a[140:143], a[108:111], v[180:183]
v_bfe_u32 v19, v16, 2, 2
v_and_b32 v16, 3, v16
v_mfma_f32_16x16x32_bf16 v[188:191], a[132:135], a[108:111], v[188:191]
s_add_u32 s53, s88, 524288
v_lshrrev_b32 v20, 1, v19
v_mul_u32_u24 v20, 18, v20
v_mfma_f32_16x16x32_bf16 v[188:191], a[128:131], a[104:107], v[188:191]
s_waitcnt lgkmcnt(0)
v_and_b32 v21, 1, v19
v_lshl_add_u32 v20, v21, 1, v20
v_mfma_f32_16x16x32_bf16 v[196:199], a[160:163], a[80:83], v[196:199]
s_waitcnt vmcnt(18)
v_lshl_add_u32 v20, v16, 2, v20
v_add_u32 v20, v20, v18
v_mfma_f32_16x16x32_bf16 v[196:199], a[164:167], a[84:87], v[196:199]
s_barrier
v_mfma_f32_16x16x32_bf16 v[64:67], a[172:175], a[84:87], v[64:67]
ds_read_b64_tr_b16 a[128:129], v11 offset:0
ds_read_b64_tr_b16 a[130:131], v11 offset:512
v_mfma_f32_16x16x32_bf16 v[64:67], a[168:171], a[80:83], v[64:67]
s_add_u32 m0, s77, 49152
s_add_u32 s64, s76, 128
v_mad_u32_u24 v20, s52, 36, v20
v_mfma_f32_16x16x32_bf16 v[204:207], a[176:179], a[80:83], v[204:207]
buffer_load_dwordx4 v7, s[20:23], s64 offen lds
v_mfma_f32_16x16x32_bf16 v[204:207], a[180:183], a[84:87], v[204:207]
ds_read_b64_tr_b16 a[132:133], v11 offset:4096
ds_read_b64_tr_b16 a[134:135], v11 offset:4608
v_mfma_f32_16x16x32_bf16 v[212:215], a[188:191], a[84:87], v[212:215]
ds_read_b64_tr_b16 a[136:137], v12 offset:0
ds_read_b64_tr_b16 a[138:139], v12 offset:512
v_mfma_f32_16x16x32_bf16 v[212:215], a[184:187], a[80:83], v[212:215]
ds_read_b64_tr_b16 a[140:141], v12 offset:4096
ds_read_b64_tr_b16 a[142:143], v12 offset:4608
v_mfma_f32_16x16x32_bf16 v[72:75], a[112:115], a[80:83], v[72:75]
buffer_store_dwordx4 v[96:99], v15, s[24:27], s53 offen offset:0 sc1
v_mfma_f32_16x16x32_bf16 v[72:75], a[116:119], a[84:87], v[72:75]
ds_read_b64_tr_b16 a[144:145], v13 offset:0
ds_read_b64_tr_b16 a[146:147], v13 offset:512
v_mfma_f32_16x16x32_bf16 v[220:223], a[124:127], a[84:87], v[220:223]
buffer_load_dwordx4 v8, s[20:23], s64 offen offset:1024 lds
v_mfma_f32_16x16x32_bf16 v[220:223], a[120:123], a[80:83], v[220:223]
ds_read_b64_tr_b16 a[148:149], v13 offset:4096
ds_read_b64_tr_b16 a[150:151], v13 offset:4608
v_mfma_f32_16x16x32_bf16 v[252:255], a[120:123], a[88:91], v[252:255]
v_lshlrev_b32 v21, 1, v18
v_lshl_add_u32 v21, v19, 2, v21
v_mfma_f32_16x16x32_bf16 v[252:255], a[124:127], a[92:95], v[252:255]
ds_read_b64_tr_b16 a[152:153], v14 offset:0
ds_read_b64_tr_b16 a[154:155], v14 offset:512
v_mfma_f32_16x16x32_bf16 v[160:163], a[116:119], a[92:95], v[160:163]
s_add_u32 m0, s80, 49152
s_add_u32 s64, s79, 2048
v_lshrrev_b32 v22, 1, v16
v_mfma_f32_16x16x32_bf16 v[160:163], a[112:115], a[88:91], v[160:163]
ds_read_b64_tr_b16 a[156:157], v14 offset:4096
ds_read_b64_tr_b16 a[158:159], v14 offset:4608
v_mfma_f32_16x16x32_bf16 v[228:231], a[184:187], a[88:91], v[228:231]
buffer_load_dwordx4 v15, s[24:27], s64 offen sc1 lds
v_mfma_f32_16x16x32_bf16 v[228:231], a[188:191], a[92:95], v[228:231]
s_xor_b32 s65, s70, 640
s_add_u32 s71, s68, s65
s_add_u32 s72, s69, s65
v_mfma_f32_16x16x32_bf16 v[168:171], a[180:183], a[92:95], v[168:171]
ds_read_b128 a[64:67], v4 offset:8192
v_add_u32 v21, v21, v22
v_mfma_f32_16x16x32_bf16 v[168:171], a[176:179], a[88:91], v[168:171]
v_mul_u32_u24 v21, 18, v21
v_and_b32 v22, 1, v16
v_mfma_f32_16x16x32_bf16 v[176:179], a[168:171], a[88:91], v[176:179]
s_add_u32 m0, s73, 65536
s_add_u32 s64, s71, 0
ds_read_b128 a[80:83], v9 offset:0
v_mfma_f32_16x16x32_bf16 v[176:179], a[172:175], a[92:95], v[176:179]
v_add3_u32 v21, v21, v22, 16
v_cmp_lt_u32 s[96:97], 1, v19
v_mfma_f32_16x16x32_bf16 v[80:83], a[164:167], a[92:95], v[80:83]
buffer_load_dwordx4 v5, s[12:15], s64 offen lds
v_mfma_f32_16x16x32_bf16 v[80:83], a[160:163], a[88:91], v[80:83]
ds_read_b128 a[68:71], v4 offset:10240
v_mov_b32 v22, 0x100000
v_mfma_f32_16x16x32_bf16 v[184:187], a[160:163], a[96:99], v[184:187]
ds_read_b128 a[84:87], v10 offset:0
v_mul_u32_u24 v23, 1, v23
v_mfma_f32_16x16x32_bf16 v[184:187], a[164:167], a[100:103], v[184:187]
s_add_u32 s53, s88, 524288
v_cndmask_b32 v21, v21, v22, s[96:97]
v_mov_b32 v22, s52
v_mfma_f32_16x16x32_bf16 v[248:251], a[172:175], a[100:103], v[248:251]
buffer_store_dwordx4 v[104:107], v15, s[24:27], s53 offen offset:1024 sc1
v_mfma_f32_16x16x32_bf16 v[248:251], a[168:171], a[96:99], v[248:251]
ds_read_b128 a[72:75], v4 offset:9216
v_cmp_eq_u32 s[96:97], 4, v22
v_mfma_f32_16x16x32_bf16 v[240:243], a[176:179], a[96:99], v[240:243]
buffer_load_dwordx4 v6, s[12:15], s64 offen offset:1024 lds
v_mfma_f32_16x16x32_bf16 v[240:243], a[180:183], a[100:103], v[240:243]
ds_read_b128 a[88:91], v9 offset:2048
v_cndmask_b32 v20, v20, v21, s[96:97]
v_mfma_f32_16x16x32_bf16 v[232:235], a[188:191], a[100:103], v[232:235]
v_mul_u32_u24 v20, 1152, v20
v_lshl_add_u32 v20, v17, 4, v20
v_mfma_f32_16x16x32_bf16 v[232:235], a[184:187], a[96:99], v[232:235]
ds_read_b128 a[76:79], v4 offset:11264
v_mov_b32 v25, v20
v_mfma_f32_16x16x32_bf16 v[236:239], a[112:115], a[96:99], v[236:239]
s_add_u32 m0, s73, 67584
s_add_u32 s64, s71, 18432
v_mov_b32 v16, s54
v_mfma_f32_16x16x32_bf16 v[236:239], a[116:119], a[100:103], v[236:239]
ds_read_b128 a[92:95], v10 offset:2048
v_mov_b32 v17, s55
v_mfma_f32_16x16x32_bf16 v[224:227], a[124:127], a[100:103], v[224:227]
buffer_load_dwordx4 v5, s[12:15], s64 offen lds
v_mfma_f32_16x16x32_bf16 v[224:227], a[120:123], a[96:99], v[224:227]
v_add_u32 v18, 32, v22
v_mfma_f32_16x16x32_bf16 v[208:211], a[120:123], a[104:107], v[208:211]
s_mul_i32 s82, s55, 165888
s_lshl_b32 s54, s54, 5
s_add_u32 s82, s82, s54
v_mfma_f32_16x16x32_bf16 v[208:211], a[124:127], a[108:111], v[208:211]
s_and_b32 s52, s2, 1
s_lshr_b32 s54, s3, 1
s_lshl1_add_u32 s52, s52, s54
v_mfma_f32_16x16x32_bf16 v[216:219], a[116:119], a[108:111], v[216:219]
s_mul_i32 s52, s52, 9
s_and_b32 s54, s3, 1
s_mul_i32 s55, s54, 5
v_mfma_f32_16x16x32_bf16 v[216:219], a[112:115], a[104:107], v[216:219]
s_add_u32 s52, s52, s55
s_lshr_b32 s55, s2, 1
s_mul_i32 s81, s55, 1152
v_mfma_f32_16x16x32_bf16 v[244:247], a[184:187], a[104:107], v[244:247]
buffer_load_dwordx4 v6, s[12:15], s64 offen offset:1024 lds
v_mfma_f32_16x16x32_bf16 v[244:247], a[188:191], a[108:111], v[244:247]
s_add_u32 s81, s81, s52
s_lshl_b32 s81, s81, 5
v_mfma_f32_16x16x32_bf16 v[192:195], a[180:183], a[108:111], v[192:195]
v_cmp_gt_u32 s[96:97], 5, v1
v_add_u32 v19, s52, v1
v_mfma_f32_16x16x32_bf16 v[192:195], a[176:179], a[104:107], v[192:195]
v_lshrrev_b32 v20, 5, s55
v_and_b32 v21, 31, s55
v_mfma_f32_16x16x32_bf16 v[200:203], a[168:171], a[104:107], v[200:203]
v_cndmask_b32 v16, v16, v19, s[96:97]
v_cndmask_b32 v17, v17, v20, s[96:97]
v_mfma_f32_16x16x32_bf16 v[200:203], a[172:175], a[108:111], v[200:203]
v_cndmask_b32 v18, v18, v21, s[96:97]
v_mul_u32_u24 v19, 7282, v16
v_mfma_f32_16x16x32_bf16 v[88:91], a[164:167], a[108:111], v[88:91]
v_lshrrev_b32 v19, 16, v19
v_mul_u32_u24 v20, 9, v19
v_mfma_f32_16x16x32_bf16 v[88:91], a[160:163], a[104:107], v[88:91]
s_waitcnt lgkmcnt(0)
v_sub_u32 v16, v16, v20
v_and_b32 v20, 1, v19
v_mfma_f32_16x16x32_bf16 v[36:39], a[128:131], a[80:83], v[36:39]
s_waitcnt vmcnt(24)
v_lshlrev_b32 v20, 2, v20
v_cndmask_b32 v20, 0, v20, s[96:97]
v_mfma_f32_16x16x32_bf16 v[36:39], a[132:135], a[84:87], v[36:39]
s_barrier
v_mfma_f32_16x16x32_bf16 v[44:47], a[140:143], a[84:87], v[44:47]
ds_read_b128 a[96:99], v9 offset:4096
v_xor_b32 v18, v18, v20
v_mfma_f32_16x16x32_bf16 v[44:47], a[136:139], a[80:83], v[44:47]
s_xor_b32 s75, s93, 5
s_lshl_b32 s76, s75, 19
s_add_u32 s76, s76, s74
v_mfma_f32_16x16x32_bf16 v[32:35], a[144:147], a[80:83], v[32:35]
s_lshl_b32 s79, s75, 13
s_add_u32 s79, s79, s78
ds_read_b128 a[100:103], v10 offset:4096
v_mfma_f32_16x16x32_bf16 v[32:35], a[148:151], a[84:87], v[32:35]
s_add_u32 m0, s77, 0
s_add_u32 s64, s76, 0
ds_read_b128 a[104:107], v9 offset:6144
v_mfma_f32_16x16x32_bf16 v[52:55], a[156:159], a[84:87], v[52:55]
buffer_load_dwordx4 v7, s[20:23], s64 offen lds
v_mfma_f32_16x16x32_bf16 v[52:55], a[152:155], a[80:83], v[52:55]
s_add_u32 s53, s88, 524288
ds_read_b64_tr_b16 a[160:161], v11 offset:16384
ds_read_b64_tr_b16 a[162:163], v11 offset:16896
v_mfma_f32_16x16x32_bf16 v[60:63], a[64:67], a[80:83], v[60:63]
buffer_store_dwordx4 v[112:115], v15, s[24:27], s53 offen offset:2048 sc1
v_mfma_f32_16x16x32_bf16 v[60:63], a[68:71], a[84:87], v[60:63]
ds_read_b128 a[108:111], v10 offset:6144
v_lshl_add_u32 v19, v19, 2, v17
v_mfma_f32_16x16x32_bf16 v[68:71], a[76:79], a[84:87], v[68:71]
buffer_load_dwordx4 v8, s[20:23], s64 offen offset:1024 lds
v_mfma_f32_16x16x32_bf16 v[68:71], a[72:75], a[80:83], v[68:71]
ds_read_b64_tr_b16 a[164:165], v11 offset:20480
ds_read_b64_tr_b16 a[166:167], v11 offset:20992
v_mfma_f32_16x16x32_bf16 v[76:79], a[72:75], a[88:91], v[76:79]
v_add_u32 v9, 32768, v9
v_add_u32 v10, 32768, v10
v_mfma_f32_16x16x32_bf16 v[76:79], a[76:79], a[92:95], v[76:79]
ds_read_b64_tr_b16 a[168:169], v12 offset:16384
ds_read_b64_tr_b16 a[170:171], v12 offset:16896
v_mfma_f32_16x16x32_bf16 v[84:87], a[68:71], a[92:95], v[84:87]
s_add_u32 m0, s80, 0
s_add_u32 s64, s79, 0
v_mul_u32_u24 v19, 344064, v19
v_mfma_f32_16x16x32_bf16 v[84:87], a[64:67], a[88:91], v[84:87]
ds_read_b64_tr_b16 a[172:173], v12 offset:20480
ds_read_b64_tr_b16 a[174:175], v12 offset:20992
v_mfma_f32_16x16x32_bf16 v[92:95], a[152:155], a[88:91], v[92:95]
buffer_load_dwordx4 v15, s[24:27], s64 offen sc1 lds
v_mfma_f32_16x16x32_bf16 v[92:95], a[156:159], a[92:95], v[92:95]
v_lshrrev_b32 v20, 1, v16
v_sub_u32 v20, v20, v17
v_mfma_f32_16x16x32_bf16 v[40:43], a[148:151], a[92:95], v[40:43]
ds_read_b64_tr_b16 a[176:177], v13 offset:16384
ds_read_b64_tr_b16 a[178:179], v13 offset:16896
v_mfma_f32_16x16x32_bf16 v[40:43], a[144:147], a[88:91], v[40:43]
v_add_u32 v20, 3, v20
v_and_b32 v20, 3, v20
v_mfma_f32_16x16x32_bf16 v[100:103], a[136:139], a[88:91], v[100:103]
s_add_u32 m0, s73, 69632
s_add_u32 s64, s72, 0
v_cmp_eq_u32 s[96:97], 8, v16
v_mfma_f32_16x16x32_bf16 v[100:103], a[140:143], a[92:95], v[100:103]
ds_read_b64_tr_b16 a[180:181], v13 offset:20480
ds_read_b64_tr_b16 a[182:183], v13 offset:20992
v_mfma_f32_16x16x32_bf16 v[108:111], a[132:135], a[92:95], v[108:111]
buffer_load_dwordx4 v5, s[12:15], s64 offen lds
v_mfma_f32_16x16x32_bf16 v[108:111], a[128:131], a[88:91], v[108:111]
s_waitcnt lgkmcnt(14)
ds_read_b64_tr_b16 a[184:185], v14 offset:16384
ds_read_b64_tr_b16 a[186:187], v14 offset:16896
v_mfma_f32_16x16x32_bf16 v[116:119], a[128:131], a[96:99], v[116:119]
ds_read_b64_tr_b16 a[188:189], v14 offset:20480
ds_read_b64_tr_b16 a[190:191], v14 offset:20992
v_mfma_f32_16x16x32_bf16 v[116:119], a[132:135], a[100:103], v[116:119]
v_and_b32 v16, 1, v16
v_lshl_add_u32 v21, v20, 1, v16
v_mfma_f32_16x16x32_bf16 v[124:127], a[140:143], a[100:103], v[124:127]
v_and_b32 v22, 1, v18
v_lshl_add_u32 v19, v22, 10, v19
v_mfma_f32_16x16x32_bf16 v[124:127], a[136:139], a[96:99], v[124:127]
ds_read_b128 a[112:115], v4 offset:24576
v_and_b32 v18, -2, v18
v_mfma_f32_16x16x32_bf16 v[132:135], a[144:147], a[96:99], v[132:135]
buffer_load_dwordx4 v6, s[12:15], s64 offen offset:1024 lds
v_mfma_f32_16x16x32_bf16 v[132:135], a[148:151], a[100:103], v[132:135]
ds_read_b128 a[116:119], v4 offset:26624
v_add_u32 v21, 1, v21
v_mfma_f32_16x16x32_bf16 v[140:143], a[156:159], a[100:103], v[140:143]
v_cndmask_b32 v21, v21, 0, s[96:97]
v_cndmask_b32 v20, v20, 0, s[96:97]
v_mfma_f32_16x16x32_bf16 v[140:143], a[152:155], a[96:99], v[140:143]
s_add_u32 s53, s88, 524288
ds_read_b128 a[120:123], v4 offset:25600
v_sub_u32 v17, 37, v18
v_mfma_f32_16x16x32_bf16 v[148:151], a[64:67], a[96:99], v[148:151]
s_add_u32 m0, s73, 71680
s_add_u32 s64, s72, 18432
v_min_u32 v17, 2, v17
v_mfma_f32_16x16x32_bf16 v[148:151], a[68:71], a[100:103], v[148:151]
ds_read_b128 a[124:127], v4 offset:27648
v_mul_u32_u24 v21, v21, v17
v_mfma_f32_16x16x32_bf16 v[48:51], a[76:79], a[100:103], v[48:51]
buffer_load_dwordx4 v5, s[12:15], s64 offen lds
v_mfma_f32_16x16x32_bf16 v[48:51], a[72:75], a[96:99], v[48:51]
s_waitcnt lgkmcnt(15)
v_mul_u32_u24 v22, v16, v17
v_min_u32 v23, 8, v18
v_mfma_f32_16x16x32_bf16 v[156:159], a[72:75], a[104:107], v[156:159]
buffer_store_dwordx4 v[120:123], v15, s[24:27], s53 offen offset:3072 sc1
v_mfma_f32_16x16x32_bf16 v[156:159], a[76:79], a[108:111], v[156:159]
v_mad_u32_u24 v21, v18, 5, v21
v_lshl_add_u32 v21, v23, 1, v21
v_mfma_f32_16x16x32_bf16 v[164:167], a[68:71], a[108:111], v[164:167]
v_lshl_add_u32 v22, v18, 1, v22
v_mad_u32_u24 v22, v20, 37, v22
v_mfma_f32_16x16x32_bf16 v[164:167], a[64:67], a[104:107], v[164:167]
v_mad_u32_u24 v22, v20, 37, v22
v_lshl_add_u32 v20, v20, 6, v18
v_mfma_f32_16x16x32_bf16 v[172:175], a[152:155], a[104:107], v[172:175]
buffer_load_dwordx4 v6, s[12:15], s64 offen offset:1024 lds
v_mfma_f32_16x16x32_bf16 v[172:175], a[156:159], a[108:111], v[172:175]
v_mov_b32 v23, 136
v_cmp_gt_u32 s[96:97], v23, v20
v_mfma_f32_16x16x32_bf16 v[56:59], a[148:151], a[108:111], v[56:59]
v_add_u32 v22, 37, v22
v_add_u32 v19, 38797312, v19
v_mfma_f32_16x16x32_bf16 v[56:59], a[144:147], a[104:107], v[56:59]
v_cndmask_b32 v21, v22, v21, s[96:97]
v_lshl_add_u32 v19, v21, 10, v19
v_mfma_f32_16x16x32_bf16 v[180:183], a[136:139], a[104:107], v[180:183]
s_cmp_eq_u32 s54, 1
s_cselect_b32 s96, 16, 0
v_mfma_f32_16x16x32_bf16 v[180:183], a[140:143], a[108:111], v[180:183]
s_cmp_eq_u32 s3, 3
s_cselect_b32 s52, 32, 0
s_or_b32 s96, s96, s52
v_mfma_f32_16x16x32_bf16 v[188:191], a[132:135], a[108:111], v[188:191]
s_cmp_ge_u32 s2, 240
s_cselect_b32 s52, 32, 0
s_or_b32 s96, s96, s52
v_mfma_f32_16x16x32_bf16 v[188:191], a[128:131], a[104:107], v[188:191]
s_waitcnt lgkmcnt(0)
s_mov_b32 s97, 0
v_mfma_f32_16x16x32_bf16 v[196:199], a[160:163], a[80:83], v[196:199]
s_waitcnt vmcnt(18)
v_mov_b32 v20, 2147418112
v_cndmask_b32 v26, v19, v20, s[96:97]
v_mfma_f32_16x16x32_bf16 v[196:199], a[164:167], a[84:87], v[196:199]
s_barrier
v_mfma_f32_16x16x32_bf16 v[64:67], a[172:175], a[84:87], v[64:67]
ds_read_b64_tr_b16 a[128:129], v11 offset:32768
ds_read_b64_tr_b16 a[130:131], v11 offset:33280
v_mfma_f32_16x16x32_bf16 v[64:67], a[168:171], a[80:83], v[64:67]
s_add_u32 m0, s77, 16384
s_add_u32 s64, s76, 128
v_lshlrev_b32 v27, 3, v1
v_mfma_f32_16x16x32_bf16 v[204:207], a[176:179], a[80:83], v[204:207]
buffer_load_dwordx4 v7, s[20:23], s64 offen lds
v_mfma_f32_16x16x32_bf16 v[204:207], a[180:183], a[84:87], v[204:207]
ds_read_b64_tr_b16 a[132:133], v11 offset:36864
ds_read_b64_tr_b16 a[134:135], v11 offset:37376
v_mfma_f32_16x16x32_bf16 v[212:215], a[188:191], a[84:87], v[212:215]
ds_read_b64_tr_b16 a[136:137], v12 offset:32768
ds_read_b64_tr_b16 a[138:139], v12 offset:33280
v_mfma_f32_16x16x32_bf16 v[212:215], a[184:187], a[80:83], v[212:215]
ds_read_b64_tr_b16 a[140:141], v12 offset:36864
ds_read_b64_tr_b16 a[142:143], v12 offset:37376
v_mfma_f32_16x16x32_bf16 v[72:75], a[112:115], a[80:83], v[72:75]
buffer_atomic_add v1, v0, s[24:27], s90 offen offset:4 sc1
v_mfma_f32_16x16x32_bf16 v[72:75], a[116:119], a[84:87], v[72:75]
ds_read_b64_tr_b16 a[144:145], v13 offset:32768
ds_read_b64_tr_b16 a[146:147], v13 offset:33280
v_mfma_f32_16x16x32_bf16 v[220:223], a[124:127], a[84:87], v[220:223]
buffer_load_dwordx4 v8, s[20:23], s64 offen offset:1024 lds
v_mfma_f32_16x16x32_bf16 v[220:223], a[120:123], a[80:83], v[220:223]
s_add_u32 s53, s88, 786432
ds_read_b64_tr_b16 a[148:149], v13 offset:36864
ds_read_b64_tr_b16 a[150:151], v13 offset:37376
v_mfma_f32_16x16x32_bf16 v[252:255], a[120:123], a[88:91], v[252:255]
buffer_store_dwordx4 v[128:131], v15, s[24:27], s53 offen offset:0 sc1
v_mfma_f32_16x16x32_bf16 v[252:255], a[124:127], a[92:95], v[252:255]
ds_read_b64_tr_b16 a[152:153], v14 offset:32768
ds_read_b64_tr_b16 a[154:155], v14 offset:33280
v_mfma_f32_16x16x32_bf16 v[160:163], a[116:119], a[92:95], v[160:163]
s_add_u32 m0, s80, 16384
s_add_u32 s64, s79, 2048
v_add_u32 v27, s83, v27
v_mfma_f32_16x16x32_bf16 v[160:163], a[112:115], a[88:91], v[160:163]
ds_read_b64_tr_b16 a[156:157], v14 offset:36864
ds_read_b64_tr_b16 a[158:159], v14 offset:37376
v_mfma_f32_16x16x32_bf16 v[228:231], a[184:187], a[88:91], v[228:231]
buffer_load_dwordx4 v15, s[24:27], s64 offen sc1 lds
v_mfma_f32_16x16x32_bf16 v[228:231], a[188:191], a[92:95], v[228:231]
s_xor_b32 s65, s70, 768
s_add_u32 s71, s68, s65
s_add_u32 s72, s69, s65
v_mfma_f32_16x16x32_bf16 v[168:171], a[180:183], a[92:95], v[168:171]
ds_read_b128 a[64:67], v4 offset:40960
v_lshrrev_b32 v22, 3, v1
v_mfma_f32_16x16x32_bf16 v[168:171], a[176:179], a[88:91], v[168:171]
v_mul_u32_u24 v22, 1152, v22
v_and_b32 v23, 7, v1
v_mfma_f32_16x16x32_bf16 v[176:179], a[168:171], a[88:91], v[176:179]
s_add_u32 m0, s73, 0
s_add_u32 s64, s71, 0
ds_read_b128 a[80:83], v9 offset:0
v_mfma_f32_16x16x32_bf16 v[176:179], a[172:175], a[92:95], v[176:179]
v_lshl_add_u32 v22, v23, 4, v22
v_lshrrev_b32 v23, 2, v1
v_mfma_f32_16x16x32_bf16 v[80:83], a[164:167], a[92:95], v[80:83]
buffer_load_dwordx4 v5, s[12:15], s64 offen lds
v_mfma_f32_16x16x32_bf16 v[80:83], a[160:163], a[88:91], v[80:83]
L_PAD6:
s_cbranch_execz L_PAD10
ds_read_b128 a[68:71], v4 offset:43008
v_mul_u32_u24 v23, 96, v23
v_mfma_f32_16x16x32_bf16 v[184:187], a[160:163], a[96:99], v[184:187]
ds_read_b128 a[84:87], v10 offset:0
v_add_u32 v23, v23, v27
v_mfma_f32_16x16x32_bf16 v[184:187], a[164:167], a[100:103], v[184:187]
v_and_b32 v16, 3, v1
v_cmp_eq_u32 s[96:97], 0, v16
v_mfma_f32_16x16x32_bf16 v[248:251], a[172:175], a[100:103], v[248:251]
v_mov_b32 v16, 0x3f803f80
v_mfma_f32_16x16x32_bf16 v[248:251], a[168:171], a[96:99], v[248:251]
ds_read_b128 a[72:75], v4 offset:41984
v_cndmask_b32 v16, 0, v16, s[96:97]
v_mfma_f32_16x16x32_bf16 v[240:243], a[176:179], a[96:99], v[240:243]
buffer_load_dwordx4 v6, s[12:15], s64 offen offset:1024 lds
v_mfma_f32_16x16x32_bf16 v[240:243], a[180:183], a[100:103], v[240:243]
ds_read_b128 a[88:91], v9 offset:2048
v_accvgpr_write_b32 a240, v16
v_mfma_f32_16x16x32_bf16 v[232:235], a[188:191], a[100:103], v[232:235]
v_accvgpr_write_b32 a241, v16
v_accvgpr_write_b32 a242, v16
v_mfma_f32_16x16x32_bf16 v[232:235], a[184:187], a[96:99], v[232:235]
ds_read_b128 a[76:79], v4 offset:44032
v_accvgpr_write_b32 a243, v16
v_mfma_f32_16x16x32_bf16 v[236:239], a[112:115], a[96:99], v[236:239]
s_add_u32 m0, s73, 2048
s_add_u32 s64, s71, 18432
v_accvgpr_write_b32 a232, 0
v_mfma_f32_16x16x32_bf16 v[236:239], a[116:119], a[100:103], v[236:239]
ds_read_b128 a[92:95], v10 offset:2048
v_accvgpr_write_b32 a233, 0
v_mfma_f32_16x16x32_bf16 v[224:227], a[124:127], a[100:103], v[224:227]
buffer_load_dwordx4 v5, s[12:15], s64 offen lds
v_mfma_f32_16x16x32_bf16 v[224:227], a[120:123], a[96:99], v[224:227]
v_accvgpr_write_b32 a234, 0
v_accvgpr_write_b32 a235, 0
v_mfma_f32_16x16x32_bf16 v[208:211], a[120:123], a[104:107], v[208:211]
v_accvgpr_write_b32 a236, 0
v_accvgpr_write_b32 a237, 0
v_mfma_f32_16x16x32_bf16 v[208:211], a[124:127], a[108:111], v[208:211]
s_add_u32 s53, s88, 786432
v_accvgpr_write_b32 a238, 0
v_accvgpr_write_b32 a239, 0
v_mfma_f32_16x16x32_bf16 v[216:219], a[116:119], a[108:111], v[216:219]
buffer_store_dwordx4 v[136:139], v15, s[24:27], s53 offen offset:1024 sc1
v_mfma_f32_16x16x32_bf16 v[216:219], a[112:115], a[104:107], v[216:219]
v_lshlrev_b32 v16, 2, v3
v_sub_u32 v16, v2, v16
v_mfma_f32_16x16x32_bf16 v[244:247], a[184:187], a[104:107], v[244:247]
buffer_load_dwordx4 v6, s[12:15], s64 offen offset:1024 lds
v_mfma_f32_16x16x32_bf16 v[244:247], a[188:191], a[108:111], v[244:247]
v_cmp_gt_i32 s[56:57], 0, v16
v_cmp_gt_i32 s[58:59], 1, v16
v_mfma_f32_16x16x32_bf16 v[192:195], a[180:183], a[108:111], v[192:195]
v_cmp_gt_i32 s[60:61], 2, v16
v_cmp_gt_i32 s[62:63], 3, v16
v_mfma_f32_16x16x32_bf16 v[192:195], a[176:179], a[104:107], v[192:195]
v_cmp_eq_u32 s[96:97], 3, v3
v_add_u32 v17, 48, v2
v_mfma_f32_16x16x32_bf16 v[200:203], a[168:171], a[104:107], v[200:203]
v_lshlrev_b32 v17, 2, v17
v_lshlrev_b32 v18, 16, v3
v_mfma_f32_16x16x32_bf16 v[200:203], a[172:175], a[108:111], v[200:203]
v_lshl_add_u32 v18, v2, 4, v18
v_add_u32 v19, 0x8000, v18
v_mfma_f32_16x16x32_bf16 v[88:91], a[164:167], a[108:111], v[88:91]
v_cndmask_b32 v19, v19, v20, s[96:97]
v_cmp_eq_u32 s[96:97], 0, v3
v_mfma_f32_16x16x32_bf16 v[88:91], a[160:163], a[104:107], v[88:91]
s_waitcnt lgkmcnt(0)
v_mfma_f32_16x16x32_bf16 v[36:39], a[128:131], a[80:83], v[36:39]
s_waitcnt vmcnt(24)
v_cndmask_b32 v18, v18, v20, s[96:97]
v_cndmask_b32 v19, v19, v20, s[96:97]
v_mfma_f32_16x16x32_bf16 v[36:39], a[132:135], a[84:87], v[36:39]
s_barrier
v_mfma_f32_16x16x32_bf16 v[44:47], a[140:143], a[84:87], v[44:47]
ds_read_b128 a[96:99], v9 offset:4096
v_mfma_f32_16x16x32_bf16 v[44:47], a[136:139], a[80:83], v[44:47]
s_xor_b32 s75, s93, 6
s_lshl_b32 s76, s75, 19
s_add_u32 s76, s76, s74
v_mfma_f32_16x16x32_bf16 v[32:35], a[144:147], a[80:83], v[32:35]
s_lshl_b32 s79, s75, 13
s_add_u32 s79, s79, s78
ds_read_b128 a[100:103], v10 offset:4096
v_mfma_f32_16x16x32_bf16 v[32:35], a[148:151], a[84:87], v[32:35]
s_add_u32 m0, s77, 32768
s_add_u32 s64, s76, 0
ds_read_b128 a[104:107], v9 offset:6144
v_mfma_f32_16x16x32_bf16 v[52:55], a[156:159], a[84:87], v[52:55]
buffer_load_dwordx4 v7, s[20:23], s64 offen lds
v_mfma_f32_16x16x32_bf16 v[52:55], a[152:155], a[80:83], v[52:55]
ds_read_b64_tr_b16 a[160:161], v11 offset:49152
ds_read_b64_tr_b16 a[162:163], v11 offset:49664
v_mfma_f32_16x16x32_bf16 v[60:63], a[64:67], a[80:83], v[60:63]
v_mfma_f32_16x16x32_bf16 v[60:63], a[68:71], a[84:87], v[60:63]
ds_read_b128 a[108:111], v10 offset:6144
v_mfma_f32_16x16x32_bf16 v[68:71], a[76:79], a[84:87], v[68:71]
buffer_load_dwordx4 v8, s[20:23], s64 offen offset:1024 lds
v_mfma_f32_16x16x32_bf16 v[68:71], a[72:75], a[80:83], v[68:71]
ds_read_b64_tr_b16 a[164:165], v11 offset:53248
ds_read_b64_tr_b16 a[166:167], v11 offset:53760
v_mfma_f32_16x16x32_bf16 v[76:79], a[72:75], a[88:91], v[76:79]
v_add_u32 v9, 32768, v9
v_add_u32 v10, 32768, v10
v_mfma_f32_16x16x32_bf16 v[76:79], a[76:79], a[92:95], v[76:79]
ds_read_b64_tr_b16 a[168:169], v12 offset:49152
ds_read_b64_tr_b16 a[170:171], v12 offset:49664
v_mfma_f32_16x16x32_bf16 v[84:87], a[68:71], a[92:95], v[84:87]
s_add_u32 m0, s80, 32768
s_add_u32 s64, s79, 0
v_mfma_f32_16x16x32_bf16 v[84:87], a[64:67], a[88:91], v[84:87]
ds_read_b64_tr_b16 a[172:173], v12 offset:53248
ds_read_b64_tr_b16 a[174:175], v12 offset:53760
v_mfma_f32_16x16x32_bf16 v[92:95], a[152:155], a[88:91], v[92:95]
buffer_load_dwordx4 v15, s[24:27], s64 offen sc1 lds
v_mfma_f32_16x16x32_bf16 v[92:95], a[156:159], a[92:95], v[92:95]
s_add_u32 s53, s88, 786432
v_mfma_f32_16x16x32_bf16 v[40:43], a[148:151], a[92:95], v[40:43]
ds_read_b64_tr_b16 a[176:177], v13 offset:49152
ds_read_b64_tr_b16 a[178:179], v13 offset:49664
v_mfma_f32_16x16x32_bf16 v[40:43], a[144:147], a[88:91], v[40:43]
buffer_store_dwordx4 v[144:147], v15, s[24:27], s53 offen offset:2048 sc1
v_mfma_f32_16x16x32_bf16 v[100:103], a[136:139], a[88:91], v[100:103]
s_add_u32 m0, s73, 4096
s_add_u32 s64, s72, 0
v_mfma_f32_16x16x32_bf16 v[100:103], a[140:143], a[92:95], v[100:103]
ds_read_b64_tr_b16 a[180:181], v13 offset:53248
ds_read_b64_tr_b16 a[182:183], v13 offset:53760
v_mfma_f32_16x16x32_bf16 v[108:111], a[132:135], a[92:95], v[108:111]
buffer_load_dwordx4 v5, s[12:15], s64 offen lds
v_mfma_f32_16x16x32_bf16 v[108:111], a[128:131], a[88:91], v[108:111]
s_waitcnt lgkmcnt(14)
ds_read_b64_tr_b16 a[184:185], v14 offset:49152
ds_read_b64_tr_b16 a[186:187], v14 offset:49664
v_mfma_f32_16x16x32_bf16 v[116:119], a[128:131], a[96:99], v[116:119]
ds_read_b64_tr_b16 a[188:189], v14 offset:53248
ds_read_b64_tr_b16 a[190:191], v14 offset:53760
v_mfma_f32_16x16x32_bf16 v[116:119], a[132:135], a[100:103], v[116:119]
v_mfma_f32_16x16x32_bf16 v[124:127], a[140:143], a[100:103], v[124:127]
v_mfma_f32_16x16x32_bf16 v[124:127], a[136:139], a[96:99], v[124:127]
ds_read_b128 a[112:115], v4 offset:57344
v_mfma_f32_16x16x32_bf16 v[132:135], a[144:147], a[96:99], v[132:135]
buffer_load_dwordx4 v6, s[12:15], s64 offen offset:1024 lds
v_mfma_f32_16x16x32_bf16 v[132:135], a[148:151], a[100:103], v[132:135]
ds_read_b128 a[116:119], v4 offset:59392
v_mfma_f32_16x16x32_bf16 v[140:143], a[156:159], a[100:103], v[140:143]
v_mfma_f32_16x16x32_bf16 v[140:143], a[152:155], a[96:99], v[140:143]
ds_read_b128 a[120:123], v4 offset:58368
v_mfma_f32_16x16x32_bf16 v[148:151], a[64:67], a[96:99], v[148:151]
s_add_u32 m0, s73, 6144
s_add_u32 s64, s72, 18432
v_mfma_f32_16x16x32_bf16 v[148:151], a[68:71], a[100:103], v[148:151]
ds_read_b128 a[124:127], v4 offset:60416
v_mfma_f32_16x16x32_bf16 v[48:51], a[76:79], a[100:103], v[48:51]
buffer_load_dwordx4 v5, s[12:15], s64 offen lds
v_mfma_f32_16x16x32_bf16 v[48:51], a[72:75], a[96:99], v[48:51]
s_waitcnt lgkmcnt(15)
v_mfma_f32_16x16x32_bf16 v[156:159], a[72:75], a[104:107], v[156:159]
v_mfma_f32_16x16x32_bf16 v[156:159], a[76:79], a[108:111], v[156:159]
v_mfma_f32_16x16x32_bf16 v[164:167], a[68:71], a[108:111], v[164:167]
v_mfma_f32_16x16x32_bf16 v[164:167], a[64:67], a[104:107], v[164:167]
v_mfma_f32_16x16x32_bf16 v[172:175], a[152:155], a[104:107], v[172:175]
buffer_load_dwordx4 v6, s[12:15], s64 offen offset:1024 lds
v_mfma_f32_16x16x32_bf16 v[172:175], a[156:159], a[108:111], v[172:175]
v_mfma_f32_16x16x32_bf16 v[56:59], a[148:151], a[108:111], v[56:59]
v_mfma_f32_16x16x32_bf16 v[56:59], a[144:147], a[104:107], v[56:59]
s_add_u32 s53, s88, 786432
v_mfma_f32_16x16x32_bf16 v[180:183], a[136:139], a[104:107], v[180:183]
buffer_store_dwordx4 v[152:155], v15, s[24:27], s53 offen offset:3072 sc1
v_mfma_f32_16x16x32_bf16 v[180:183], a[140:143], a[108:111], v[180:183]
v_mfma_f32_16x16x32_bf16 v[188:191], a[132:135], a[108:111], v[188:191]
v_mfma_f32_16x16x32_bf16 v[188:191], a[128:131], a[104:107], v[188:191]
s_waitcnt lgkmcnt(0)
v_mov_b32 v96, 0
v_mov_b32 v97, 0
v_mfma_f32_16x16x32_bf16 v[196:199], a[160:163], a[80:83], v[196:199]
s_waitcnt vmcnt(19)
v_mov_b32 v98, 0
v_mov_b32 v99, 0
v_mfma_f32_16x16x32_bf16 v[196:199], a[164:167], a[84:87], v[196:199]
s_barrier
v_mfma_f32_16x16x32_bf16 v[64:67], a[172:175], a[84:87], v[64:67]
ds_read_b64_tr_b16 a[128:129], v11 offset:0
ds_read_b64_tr_b16 a[130:131], v11 offset:512
v_mfma_f32_16x16x32_bf16 v[64:67], a[168:171], a[80:83], v[64:67]
s_add_u32 m0, s77, 49152
s_add_u32 s64, s76, 128
v_mov_b32 v104, 0
v_mfma_f32_16x16x32_bf16 v[204:207], a[176:179], a[80:83], v[204:207]
buffer_load_dwordx4 v7, s[20:23], s64 offen lds
v_mfma_f32_16x16x32_bf16 v[204:207], a[180:183], a[84:87], v[204:207]
ds_read_b64_tr_b16 a[132:133], v11 offset:4096
ds_read_b64_tr_b16 a[134:135], v11 offset:4608
v_mfma_f32_16x16x32_bf16 v[212:215], a[188:191], a[84:87], v[212:215]
ds_read_b64_tr_b16 a[136:137], v12 offset:0
ds_read_b64_tr_b16 a[138:139], v12 offset:512
v_mfma_f32_16x16x32_bf16 v[212:215], a[184:187], a[80:83], v[212:215]
ds_read_b64_tr_b16 a[140:141], v12 offset:4096
ds_read_b64_tr_b16 a[142:143], v12 offset:4608
v_mfma_f32_16x16x32_bf16 v[72:75], a[112:115], a[80:83], v[72:75]
buffer_load_dword v30, v29, s[24:27], s89 offen offset:4 sc1
v_mfma_f32_16x16x32_bf16 v[72:75], a[116:119], a[84:87], v[72:75]
ds_read_b64_tr_b16 a[144:145], v13 offset:0
ds_read_b64_tr_b16 a[146:147], v13 offset:512
v_mfma_f32_16x16x32_bf16 v[220:223], a[124:127], a[84:87], v[220:223]
buffer_load_dwordx4 v8, s[20:23], s64 offen offset:1024 lds
v_mfma_f32_16x16x32_bf16 v[220:223], a[120:123], a[80:83], v[220:223]
ds_read_b64_tr_b16 a[148:149], v13 offset:4096
ds_read_b64_tr_b16 a[150:151], v13 offset:4608
v_mfma_f32_16x16x32_bf16 v[252:255], a[120:123], a[88:91], v[252:255]
v_mov_b32 v105, 0
v_mov_b32 v106, 0
v_mfma_f32_16x16x32_bf16 v[252:255], a[124:127], a[92:95], v[252:255]
ds_read_b64_tr_b16 a[152:153], v14 offset:0
ds_read_b64_tr_b16 a[154:155], v14 offset:512
v_mfma_f32_16x16x32_bf16 v[160:163], a[116:119], a[92:95], v[160:163]
s_add_u32 m0, s80, 49152
s_add_u32 s64, s79, 2048
v_mov_b32 v107, 0
v_mfma_f32_16x16x32_bf16 v[160:163], a[112:115], a[88:91], v[160:163]
ds_read_b64_tr_b16 a[156:157], v14 offset:4096
ds_read_b64_tr_b16 a[158:159], v14 offset:4608
v_mfma_f32_16x16x32_bf16 v[228:231], a[184:187], a[88:91], v[228:231]
buffer_load_dwordx4 v15, s[24:27], s64 offen sc1 lds
v_mfma_f32_16x16x32_bf16 v[228:231], a[188:191], a[92:95], v[228:231]
s_xor_b32 s65, s70, 896
s_add_u32 s71, s68, s65
s_add_u32 s72, s69, s65
v_mfma_f32_16x16x32_bf16 v[168:171], a[180:183], a[92:95], v[168:171]
ds_read_b128 a[64:67], v4 offset:8192
v_mov_b32 v112, 0
v_mfma_f32_16x16x32_bf16 v[168:171], a[176:179], a[88:91], v[168:171]
v_mov_b32 v113, 0
v_mov_b32 v114, 0
v_mfma_f32_16x16x32_bf16 v[176:179], a[168:171], a[88:91], v[176:179]
s_add_u32 m0, s73, 32768
s_add_u32 s64, s71, 0
ds_read_b128 a[80:83], v9 offset:0
v_mfma_f32_16x16x32_bf16 v[176:179], a[172:175], a[92:95], v[176:179]
v_mov_b32 v115, 0
v_mov_b32 v120, 0
v_mfma_f32_16x16x32_bf16 v[80:83], a[164:167], a[92:95], v[80:83]
buffer_load_dwordx4 v5, s[12:15], s64 offen lds
v_mfma_f32_16x16x32_bf16 v[80:83], a[160:163], a[88:91], v[80:83]
s_add_u32 s53, s87, 524288
ds_read_b128 a[68:71], v4 offset:10240
v_mov_b32 v121, 0
v_mfma_f32_16x16x32_bf16 v[184:187], a[160:163], a[96:99], v[184:187]
ds_read_b128 a[84:87], v10 offset:0
v_mov_b32 v122, 0
v_mfma_f32_16x16x32_bf16 v[184:187], a[164:167], a[100:103], v[184:187]
buffer_store_dwordx4 a[28:31], v15, s[24:27], s53 offen offset:0 sc1
v_mfma_f32_16x16x32_bf16 v[248:251], a[172:175], a[100:103], v[248:251]
v_mov_b32 v123, 0
v_mov_b32 v128, 0
v_mfma_f32_16x16x32_bf16 v[248:251], a[168:171], a[96:99], v[248:251]
ds_read_b128 a[72:75], v4 offset:9216
v_mov_b32 v129, 0
v_mfma_f32_16x16x32_bf16 v[240:243], a[176:179], a[96:99], v[240:243]
buffer_load_dwordx4 v6, s[12:15], s64 offen offset:1024 lds
v_mfma_f32_16x16x32_bf16 v[240:243], a[180:183], a[100:103], v[240:243]
ds_read_b128 a[88:91], v9 offset:2048
v_mov_b32 v130, 0
v_mfma_f32_16x16x32_bf16 v[232:235], a[188:191], a[100:103], v[232:235]
v_mov_b32 v131, 0
v_mov_b32 v136, 0
v_mfma_f32_16x16x32_bf16 v[232:235], a[184:187], a[96:99], v[232:235]
ds_read_b128 a[76:79], v4 offset:11264
v_mov_b32 v137, 0
v_mfma_f32_16x16x32_bf16 v[236:239], a[112:115], a[96:99], v[236:239]
s_add_u32 m0, s73, 34816
s_add_u32 s64, s71, 18432
v_mov_b32 v138, 0
v_mfma_f32_16x16x32_bf16 v[236:239], a[116:119], a[100:103], v[236:239]
ds_read_b128 a[92:95], v10 offset:2048
v_mov_b32 v139, 0
v_mfma_f32_16x16x32_bf16 v[224:227], a[124:127], a[100:103], v[224:227]
buffer_load_dwordx4 v5, s[12:15], s64 offen lds
v_mfma_f32_16x16x32_bf16 v[224:227], a[120:123], a[96:99], v[224:227]
v_mov_b32 v144, 0
v_mov_b32 v145, 0
v_mfma_f32_16x16x32_bf16 v[208:211], a[120:123], a[104:107], v[208:211]
v_mov_b32 v146, 0
v_mov_b32 v147, 0
v_mfma_f32_16x16x32_bf16 v[208:211], a[124:127], a[108:111], v[208:211]
v_mov_b32 v152, 0
v_mov_b32 v153, 0
v_mfma_f32_16x16x32_bf16 v[216:219], a[116:119], a[108:111], v[216:219]
v_mov_b32 v154, 0
v_mov_b32 v155, 0
v_mfma_f32_16x16x32_bf16 v[216:219], a[112:115], a[104:107], v[216:219]
v_mfma_f32_16x16x32_bf16 v[244:247], a[184:187], a[104:107], v[244:247]
buffer_load_dwordx4 v6, s[12:15], s64 offen offset:1024 lds
v_mfma_f32_16x16x32_bf16 v[244:247], a[188:191], a[108:111], v[244:247]
v_mfma_f32_16x16x32_bf16 v[192:195], a[180:183], a[108:111], v[192:195]
v_mfma_f32_16x16x32_bf16 v[192:195], a[176:179], a[104:107], v[192:195]
v_mfma_f32_16x16x32_bf16 v[200:203], a[168:171], a[104:107], v[200:203]
v_mfma_f32_16x16x32_bf16 v[200:203], a[172:175], a[108:111], v[200:203]
v_mfma_f32_16x16x32_bf16 v[88:91], a[164:167], a[108:111], v[88:91]
v_mfma_f32_16x16x32_bf16 v[88:91], a[160:163], a[104:107], v[88:91]
s_waitcnt lgkmcnt(0)
v_mfma_f32_16x16x32_bf16 v[36:39], a[128:131], a[80:83], v[36:39]
s_waitcnt vmcnt(23)
v_mfma_f32_16x16x32_bf16 v[36:39], a[132:135], a[84:87], v[36:39]
s_barrier
v_mfma_f32_16x16x32_bf16 v[44:47], a[140:143], a[84:87], v[44:47]
s_add_u32 s53, s87, 524288
ds_read_b128 a[96:99], v9 offset:4096
v_mfma_f32_16x16x32_bf16 v[44:47], a[136:139], a[80:83], v[44:47]
s_xor_b32 s75, s93, 7
s_lshl_b32 s76, s75, 19
s_add_u32 s76, s76, s74
v_mfma_f32_16x16x32_bf16 v[32:35], a[144:147], a[80:83], v[32:35]
s_lshl_b32 s79, s75, 13
s_add_u32 s79, s79, s78
ds_read_b128 a[100:103], v10 offset:4096
v_mfma_f32_16x16x32_bf16 v[32:35], a[148:151], a[84:87], v[32:35]
s_add_u32 m0, s77, 0
s_add_u32 s64, s76, 0
ds_read_b128 a[104:107], v9 offset:6144
v_mfma_f32_16x16x32_bf16 v[52:55], a[156:159], a[84:87], v[52:55]
buffer_load_dwordx4 v7, s[20:23], s64 offen lds
v_mfma_f32_16x16x32_bf16 v[52:55], a[152:155], a[80:83], v[52:55]
ds_read_b64_tr_b16 a[160:161], v11 offset:16384
ds_read_b64_tr_b16 a[162:163], v11 offset:16896
v_mfma_f32_16x16x32_bf16 v[60:63], a[64:67], a[80:83], v[60:63]
buffer_store_dwordx4 a[20:23], v15, s[24:27], s53 offen offset:1024 sc1
v_mfma_f32_16x16x32_bf16 v[60:63], a[68:71], a[84:87], v[60:63]
ds_read_b128 a[108:111], v10 offset:6144
v_mfma_f32_16x16x32_bf16 v[68:71], a[76:79], a[84:87], v[68:71]
buffer_load_dwordx4 v8, s[20:23], s64 offen offset:1024 lds
v_mfma_f32_16x16x32_bf16 v[68:71], a[72:75], a[80:83], v[68:71]
ds_read_b64_tr_b16 a[164:165], v11 offset:20480
ds_read_b64_tr_b16 a[166:167], v11 offset:20992
v_mfma_f32_16x16x32_bf16 v[76:79], a[72:75], a[88:91], v[76:79]
v_add_u32 v9, -65536, v9
v_add_u32 v10, -65536, v10
v_mfma_f32_16x16x32_bf16 v[76:79], a[76:79], a[92:95], v[76:79]
ds_read_b64_tr_b16 a[168:169], v12 offset:16384
ds_read_b64_tr_b16 a[170:171], v12 offset:16896
v_mfma_f32_16x16x32_bf16 v[84:87], a[68:71], a[92:95], v[84:87]
s_add_u32 m0, s80, 0
s_add_u32 s64, s79, 0
v_mfma_f32_16x16x32_bf16 v[84:87], a[64:67], a[88:91], v[84:87]
ds_read_b64_tr_b16 a[172:173], v12 offset:20480
ds_read_b64_tr_b16 a[174:175], v12 offset:20992
v_mfma_f32_16x16x32_bf16 v[92:95], a[152:155], a[88:91], v[92:95]
buffer_load_dwordx4 v15, s[24:27], s64 offen sc1 lds
v_mfma_f32_16x16x32_bf16 v[92:95], a[156:159], a[92:95], v[92:95]
v_mfma_f32_16x16x32_bf16 v[40:43], a[148:151], a[92:95], v[40:43]
ds_read_b64_tr_b16 a[176:177], v13 offset:16384
ds_read_b64_tr_b16 a[178:179], v13 offset:16896
v_mfma_f32_16x16x32_bf16 v[40:43], a[144:147], a[88:91], v[40:43]
v_mfma_f32_16x16x32_bf16 v[100:103], a[136:139], a[88:91], v[100:103]
s_add_u32 m0, s73, 36864
s_add_u32 s64, s72, 0
v_mfma_f32_16x16x32_bf16 v[100:103], a[140:143], a[92:95], v[100:103]
ds_read_b64_tr_b16 a[180:181], v13 offset:20480
ds_read_b64_tr_b16 a[182:183], v13 offset:20992
v_mfma_f32_16x16x32_bf16 v[108:111], a[132:135], a[92:95], v[108:111]
buffer_load_dwordx4 v5, s[12:15], s64 offen lds
v_mfma_f32_16x16x32_bf16 v[108:111], a[128:131], a[88:91], v[108:111]
s_waitcnt lgkmcnt(14)
ds_read_b64_tr_b16 a[184:185], v14 offset:16384
ds_read_b64_tr_b16 a[186:187], v14 offset:16896
v_mfma_f32_16x16x32_bf16 v[116:119], a[128:131], a[96:99], v[116:119]
ds_read_b64_tr_b16 a[188:189], v14 offset:20480
ds_read_b64_tr_b16 a[190:191], v14 offset:20992
v_mfma_f32_16x16x32_bf16 v[116:119], a[132:135], a[100:103], v[116:119]
v_mfma_f32_16x16x32_bf16 v[124:127], a[140:143], a[100:103], v[124:127]
v_mfma_f32_16x16x32_bf16 v[124:127], a[136:139], a[96:99], v[124:127]
ds_read_b128 a[112:115], v4 offset:24576
v_mfma_f32_16x16x32_bf16 v[132:135], a[144:147], a[96:99], v[132:135]
buffer_load_dwordx4 v6, s[12:15], s64 offen offset:1024 lds
v_mfma_f32_16x16x32_bf16 v[132:135], a[148:151], a[100:103], v[132:135]
s_add_u32 s53, s87, 528384
ds_read_b128 a[116:119], v4 offset:26624
v_mfma_f32_16x16x32_bf16 v[140:143], a[156:159], a[100:103], v[140:143]
buffer_store_dwordx4 a[12:15], v15, s[24:27], s53 offen offset:0 sc1
v_mfma_f32_16x16x32_bf16 v[140:143], a[152:155], a[96:99], v[140:143]
ds_read_b128 a[120:123], v4 offset:25600
v_mfma_f32_16x16x32_bf16 v[148:151], a[64:67], a[96:99], v[148:151]
s_add_u32 m0, s73, 38912
s_add_u32 s64, s72, 18432
v_mfma_f32_16x16x32_bf16 v[148:151], a[68:71], a[100:103], v[148:151]
ds_read_b128 a[124:127], v4 offset:27648
v_mfma_f32_16x16x32_bf16 v[48:51], a[76:79], a[100:103], v[48:51]
buffer_load_dwordx4 v5, s[12:15], s64 offen lds
v_mfma_f32_16x16x32_bf16 v[48:51], a[72:75], a[96:99], v[48:51]
s_waitcnt lgkmcnt(15)
v_mfma_f32_16x16x32_bf16 v[156:159], a[72:75], a[104:107], v[156:159]
v_mfma_f32_16x16x32_bf16 v[156:159], a[76:79], a[108:111], v[156:159]
v_mfma_f32_16x16x32_bf16 v[164:167], a[68:71], a[108:111], v[164:167]
v_mfma_f32_16x16x32_bf16 v[164:167], a[64:67], a[104:107], v[164:167]
v_mfma_f32_16x16x32_bf16 v[172:175], a[152:155], a[104:107], v[172:175]
buffer_load_dwordx4 v6, s[12:15], s64 offen offset:1024 lds
v_mfma_f32_16x16x32_bf16 v[172:175], a[156:159], a[108:111], v[172:175]
v_mfma_f32_16x16x32_bf16 v[56:59], a[148:151], a[108:111], v[56:59]
v_mfma_f32_16x16x32_bf16 v[56:59], a[144:147], a[104:107], v[56:59]
v_mfma_f32_16x16x32_bf16 v[180:183], a[136:139], a[104:107], v[180:183]
v_mfma_f32_16x16x32_bf16 v[180:183], a[140:143], a[108:111], v[180:183]
v_mfma_f32_16x16x32_bf16 v[188:191], a[132:135], a[108:111], v[188:191]
v_mfma_f32_16x16x32_bf16 v[188:191], a[128:131], a[104:107], v[188:191]
s_waitcnt lgkmcnt(0)
v_mfma_f32_16x16x32_bf16 v[196:199], a[160:163], a[80:83], v[196:199]
s_waitcnt vmcnt(19)
v_mfma_f32_16x16x32_bf16 v[196:199], a[164:167], a[84:87], v[196:199]
s_barrier
v_mfma_f32_16x16x32_bf16 v[64:67], a[172:175], a[84:87], v[64:67]
ds_read_b64_tr_b16 a[128:129], v11 offset:32768
ds_read_b64_tr_b16 a[130:131], v11 offset:33280
v_mfma_f32_16x16x32_bf16 v[64:67], a[168:171], a[80:83], v[64:67]
s_add_u32 m0, s77, 16384
s_add_u32 s64, s76, 128
v_mfma_f32_16x16x32_bf16 v[204:207], a[176:179], a[80:83], v[204:207]
buffer_load_dwordx4 v7, s[20:23], s64 offen lds
v_mfma_f32_16x16x32_bf16 v[204:207], a[180:183], a[84:87], v[204:207]
ds_read_b64_tr_b16 a[132:133], v11 offset:36864
ds_read_b64_tr_b16 a[134:135], v11 offset:37376
v_mfma_f32_16x16x32_bf16 v[212:215], a[188:191], a[84:87], v[212:215]
ds_read_b64_tr_b16 a[136:137], v12 offset:32768
ds_read_b64_tr_b16 a[138:139], v12 offset:33280
v_mfma_f32_16x16x32_bf16 v[212:215], a[184:187], a[80:83], v[212:215]
s_add_u32 s53, s87, 528384
ds_read_b64_tr_b16 a[140:141], v12 offset:36864
ds_read_b64_tr_b16 a[142:143], v12 offset:37376
v_mfma_f32_16x16x32_bf16 v[72:75], a[112:115], a[80:83], v[72:75]
buffer_load_dwordx4 v8, s[20:23], s64 offen offset:1024 lds
v_mfma_f32_16x16x32_bf16 v[72:75], a[116:119], a[84:87], v[72:75]
ds_read_b64_tr_b16 a[144:145], v13 offset:32768
ds_read_b64_tr_b16 a[146:147], v13 offset:33280
v_mfma_f32_16x16x32_bf16 v[220:223], a[124:127], a[84:87], v[220:223]
buffer_store_dwordx4 a[4:7], v15, s[24:27], s53 offen offset:1024 sc1
v_mfma_f32_16x16x32_bf16 v[220:223], a[120:123], a[80:83], v[220:223]
s_add_u32 m0, s80, 16384
s_add_u32 s64, s79, 2048
v_mfma_f32_16x16x32_bf16 v[252:255], a[120:123], a[88:91], v[252:255]
ds_read_b64_tr_b16 a[148:149], v13 offset:36864
ds_read_b64_tr_b16 a[150:151], v13 offset:37376
v_mfma_f32_16x16x32_bf16 v[252:255], a[124:127], a[92:95], v[252:255]
buffer_load_dwordx4 v15, s[24:27], s64 offen sc1 lds
v_mfma_f32_16x16x32_bf16 v[160:163], a[116:119], a[92:95], v[160:163]
ds_read_b64_tr_b16 a[152:153], v14 offset:32768
ds_read_b64_tr_b16 a[154:155], v14 offset:33280
v_mfma_f32_16x16x32_bf16 v[160:163], a[112:115], a[88:91], v[160:163]
ds_read_b64_tr_b16 a[156:157], v14 offset:36864
ds_read_b64_tr_b16 a[158:159], v14 offset:37376
v_mfma_f32_16x16x32_bf16 v[228:231], a[184:187], a[88:91], v[228:231]
s_add_u32 m0, s83, 0
s_add_u32 s64, s81, 0
v_mfma_f32_16x16x32_bf16 v[228:231], a[188:191], a[92:95], v[228:231]
v_mfma_f32_16x16x32_bf16 v[168:171], a[180:183], a[92:95], v[168:171]
buffer_load_dwordx4 v22, s[32:35], s64 offen lds
v_mfma_f32_16x16x32_bf16 v[168:171], a[176:179], a[88:91], v[168:171]
ds_read_b128 a[64:67], v4 offset:40960
v_mfma_f32_16x16x32_bf16 v[176:179], a[168:171], a[88:91], v[176:179]
s_add_u32 m0, s83, 1024
s_add_u32 s64, s81, 9216
ds_read_b128 a[80:83], v9 offset:0
v_mfma_f32_16x16x32_bf16 v[176:179], a[172:175], a[92:95], v[176:179]
v_mfma_f32_16x16x32_bf16 v[80:83], a[164:167], a[92:95], v[80:83]
buffer_load_dwordx4 v22, s[32:35], s64 offen lds
v_mfma_f32_16x16x32_bf16 v[80:83], a[160:163], a[88:91], v[80:83]
ds_read_b128 a[68:71], v4 offset:43008
v_mfma_f32_16x16x32_bf16 v[184:187], a[160:163], a[96:99], v[184:187]
ds_read_b128 a[84:87], v10 offset:0
v_mfma_f32_16x16x32_bf16 v[184:187], a[164:167], a[100:103], v[184:187]
s_add_u32 m0, s83, 2048
s_add_u32 s64, s81, 18432
v_mfma_f32_16x16x32_bf16 v[248:251], a[172:175], a[100:103], v[248:251]
v_mfma_f32_16x16x32_bf16 v[248:251], a[168:171], a[96:99], v[248:251]
buffer_load_dwordx4 v22, s[32:35], s64 offen lds
v_mfma_f32_16x16x32_bf16 v[240:243], a[176:179], a[96:99], v[240:243]
ds_read_b128 a[72:75], v4 offset:41984
v_mfma_f32_16x16x32_bf16 v[240:243], a[180:183], a[100:103], v[240:243]
ds_read_b128 a[88:91], v9 offset:2048
v_mfma_f32_16x16x32_bf16 v[232:235], a[188:191], a[100:103], v[232:235]
s_add_u32 m0, s83, 3072
s_add_u32 s64, s81, 27648
v_mfma_f32_16x16x32_bf16 v[232:235], a[184:187], a[96:99], v[232:235]
ds_read_b128 a[76:79], v4 offset:44032
v_mfma_f32_16x16x32_bf16 v[236:239], a[112:115], a[96:99], v[236:239]
buffer_load_dwordx4 v22, s[32:35], s64 offen lds
v_mfma_f32_16x16x32_bf16 v[236:239], a[116:119], a[100:103], v[236:239]
ds_read_b128 a[92:95], v10 offset:2048
v_mfma_f32_16x16x32_bf16 v[224:227], a[124:127], a[100:103], v[224:227]
s_add_u32 m0, s83, 4096
s_add_u32 s64, s81, 128
s_add_u32 s53, s87, 786432
v_mfma_f32_16x16x32_bf16 v[224:227], a[120:123], a[96:99], v[224:227]
buffer_store_dwordx4 a[0:3], v15, s[24:27], s53 offen offset:0 sc1
v_mfma_f32_16x16x32_bf16 v[208:211], a[120:123], a[104:107], v[208:211]
buffer_load_dwordx4 v24, s[32:35], s64 offen lds
v_mfma_f32_16x16x32_bf16 v[208:211], a[124:127], a[108:111], v[208:211]
s_waitcnt vmcnt(26)
v_mfma_f32_16x16x32_bf16 v[216:219], a[116:119], a[108:111], v[216:219]
v_cmp_gt_u32 vcc, 8, v30
v_mfma_f32_16x16x32_bf16 v[216:219], a[112:115], a[104:107], v[216:219]
s_add_u32 m0, s83, 5120
s_add_u32 s64, s82, 0
v_mfma_f32_16x16x32_bf16 v[244:247], a[184:187], a[104:107], v[244:247]
v_mfma_f32_16x16x32_bf16 v[244:247], a[188:191], a[108:111], v[244:247]
buffer_load_dwordx4 v25, s[48:51], s64 offen lds
v_mfma_f32_16x16x32_bf16 v[192:195], a[180:183], a[108:111], v[192:195]
v_mfma_f32_16x16x32_bf16 v[192:195], a[176:179], a[104:107], v[192:195]
s_cbranch_vccnz CK_KV
CK_KV_R:
v_mfma_f32_16x16x32_bf16 v[200:203], a[168:171], a[104:107], v[200:203]
v_mfma_f32_16x16x32_bf16 v[200:203], a[172:175], a[108:111], v[200:203]
v_mfma_f32_16x16x32_bf16 v[88:91], a[164:167], a[108:111], v[88:91]
v_mfma_f32_16x16x32_bf16 v[88:91], a[160:163], a[104:107], v[88:91]
s_waitcnt lgkmcnt(0)
v_mfma_f32_16x16x32_bf16 v[36:39], a[128:131], a[80:83], v[36:39]
s_waitcnt vmcnt(25)
v_mov_b32 v6, 0xf149f2ca
v_mfma_f32_16x16x32_bf16 v[36:39], a[132:135], a[84:87], v[36:39]
s_barrier
v_mfma_f32_16x16x32_bf16 v[44:47], a[140:143], a[84:87], v[44:47]
ds_read_b128 a[96:99], v9 offset:4096
v_mfma_f32_16x16x32_bf16 v[44:47], a[136:139], a[80:83], v[44:47]
s_lshl_b32 s70, s3, 12
s_add_u32 s68, s70, s94
ds_read_b128 a[100:103], v10 offset:4096
v_mfma_f32_16x16x32_bf16 v[32:35], a[144:147], a[80:83], v[32:35]
s_add_u32 m0, s70, 32768
s_cmp_lt_u32 s3, 2
s_cselect_b32 s64, s68, 2147418112
v_mfma_f32_16x16x32_bf16 v[32:35], a[148:151], a[84:87], v[32:35]
buffer_load_dwordx4 v15, s[24:27], s64 offen offset:0 sc1 lds
v_mfma_f32_16x16x32_bf16 v[52:55], a[156:159], a[84:87], v[52:55]
ds_read_b128 a[104:107], v9 offset:6144
v_mfma_f32_16x16x32_bf16 v[52:55], a[152:155], a[80:83], v[52:55]
ds_read_b64_tr_b16 a[160:161], v11 offset:49152
ds_read_b64_tr_b16 a[162:163], v11 offset:49664
v_mfma_f32_16x16x32_bf16 v[60:63], a[64:67], a[80:83], v[60:63]
s_cmp_eq_u32 s66, 0
s_cbranch_scc1 D0
D0_R:
v_mfma_f32_16x16x32_bf16 v[60:63], a[68:71], a[84:87], v[60:63]
s_lshl_b32 s52, s4, 18
s_add_u32 s52, s52, 45088768
ds_read_b128 a[108:111], v10 offset:6144
v_mfma_f32_16x16x32_bf16 v[68:71], a[76:79], a[84:87], v[68:71]
s_lshl_b32 s54, s66, 9
v_add_u32 v9, 32768, v9
v_add_u32 v10, 32768, v10
v_mfma_f32_16x16x32_bf16 v[68:71], a[72:75], a[80:83], v[68:71]
s_add_u32 s54, s54, s52
ds_read_b64_tr_b16 a[164:165], v11 offset:53248
ds_read_b64_tr_b16 a[166:167], v11 offset:53760
v_mfma_f32_16x16x32_bf16 v[76:79], a[72:75], a[88:91], v[76:79]
s_lshl_b32 s55, s67, 9
s_add_u32 s55, s55, s52
v_mfma_f32_16x16x32_bf16 v[76:79], a[76:79], a[92:95], v[76:79]
s_add_u32 s53, s87, 786432
ds_read_b64_tr_b16 a[168:169], v12 offset:49152
ds_read_b64_tr_b16 a[170:171], v12 offset:49664
v_mfma_f32_16x16x32_bf16 v[84:87], a[68:71], a[92:95], v[84:87]
buffer_load_dwordx4 v15, s[24:27], s64 offen offset:1024 sc1 lds
v_mfma_f32_16x16x32_bf16 v[84:87], a[64:67], a[88:91], v[84:87]
s_max_u32 s65, s66, 1
ds_read_b64_tr_b16 a[172:173], v12 offset:53248
ds_read_b64_tr_b16 a[174:175], v12 offset:53760
L_PAD7:
s_cbranch_execz L_PAD11
v_mfma_f32_16x16x32_bf16 v[92:95], a[152:155], a[88:91], v[92:95]
buffer_store_dwordx4 a[8:11], v15, s[24:27], s53 offen offset:1024 sc1
v_mfma_f32_16x16x32_bf16 v[92:95], a[156:159], a[92:95], v[92:95]
s_lshl_b32 s65, s65, 9
s_add_u32 s52, s52, s65
s_sub_u32 s65, s55, s52
v_mfma_f32_16x16x32_bf16 v[40:43], a[148:151], a[92:95], v[40:43]
s_sub_u32 s65, s65, 163840
ds_read_b64_tr_b16 a[176:177], v13 offset:49152
ds_read_b64_tr_b16 a[178:179], v13 offset:49664
v_mfma_f32_16x16x32_bf16 v[40:43], a[144:147], a[88:91], v[40:43]
s_add_u32 s52, s52, 65280
v_mfma_f32_16x16x32_bf16 v[100:103], a[136:139], a[88:91], v[100:103]
ds_read_b64_tr_b16 a[180:181], v13 offset:53248
ds_read_b64_tr_b16 a[182:183], v13 offset:53760
v_mfma_f32_16x16x32_bf16 v[100:103], a[140:143], a[92:95], v[100:103]
v_cmp_lt_u32 s[96:97], 0, v3
v_lshlrev_b32 v16, 15, v3
v_mfma_f32_16x16x32_bf16 v[108:111], a[132:135], a[92:95], v[108:111]
ds_read_b64_tr_b16 a[184:185], v14 offset:49152
ds_read_b64_tr_b16 a[186:187], v14 offset:49664
v_mfma_f32_16x16x32_bf16 v[108:111], a[128:131], a[88:91], v[108:111]
s_waitcnt lgkmcnt(15)
v_lshl_add_u32 v16, v2, 4, v16
v_add_u32 v16, s52, v16
v_mfma_f32_16x16x32_bf16 v[116:119], a[128:131], a[96:99], v[116:119]
ds_read_b64_tr_b16 a[188:189], v14 offset:53248
ds_read_b64_tr_b16 a[190:191], v14 offset:53760
v_mfma_f32_16x16x32_bf16 v[116:119], a[132:135], a[100:103], v[116:119]
buffer_load_dwordx4 v15, s[24:27], s64 offen offset:2048 sc1 lds
v_mfma_f32_16x16x32_bf16 v[124:127], a[140:143], a[100:103], v[124:127]
v_accvgpr_write_b32 a244, v16
v_add_u32 v16, 131072, v16
v_mfma_f32_16x16x32_bf16 v[124:127], a[136:139], a[96:99], v[124:127]
ds_read_b128 a[112:115], v4 offset:57344
v_add_u32 v21, s65, v16
v_mfma_f32_16x16x32_bf16 v[132:135], a[144:147], a[96:99], v[132:135]
v_cndmask_b32 v16, v16, v21, s[96:97]
v_accvgpr_write_b32 a248, v16
v_mfma_f32_16x16x32_bf16 v[132:135], a[148:151], a[100:103], v[132:135]
ds_read_b128 a[116:119], v4 offset:59392
v_cmp_lt_u32 s[96:97], 1, v3
v_mfma_f32_16x16x32_bf16 v[140:143], a[156:159], a[100:103], v[140:143]
v_add_u32 v21, 131072, v21
v_mfma_f32_16x16x32_bf16 v[140:143], a[152:155], a[96:99], v[140:143]
ds_read_b128 a[120:123], v4 offset:58368
v_cndmask_b32 v21, v21, v20, s[96:97]
v_mfma_f32_16x16x32_bf16 v[148:151], a[64:67], a[96:99], v[148:151]
v_accvgpr_write_b32 a252, v21
v_mfma_f32_16x16x32_bf16 v[148:151], a[68:71], a[100:103], v[148:151]
ds_read_b128 a[124:127], v4 offset:60416
v_mfma_f32_16x16x32_bf16 v[48:51], a[76:79], a[100:103], v[48:51]
s_waitcnt lgkmcnt(15)
v_mfma_f32_16x16x32_bf16 v[48:51], a[72:75], a[96:99], v[48:51]
buffer_load_dwordx4 v15, s[24:27], s64 offen offset:3072 sc1 lds
v_mfma_f32_16x16x32_bf16 v[156:159], a[72:75], a[104:107], v[156:159]
v_mfma_f32_16x16x32_bf16 v[156:159], a[76:79], a[108:111], v[156:159]
v_mfma_f32_16x16x32_bf16 v[164:167], a[68:71], a[108:111], v[164:167]
v_mfma_f32_16x16x32_bf16 v[164:167], a[64:67], a[104:107], v[164:167]
v_mfma_f32_16x16x32_bf16 v[172:175], a[152:155], a[104:107], v[172:175]
s_add_u32 s53, s87, 790528
v_mfma_f32_16x16x32_bf16 v[172:175], a[156:159], a[108:111], v[172:175]
buffer_store_dwordx4 a[16:19], v15, s[24:27], s53 offen offset:0 sc1
v_mfma_f32_16x16x32_bf16 v[56:59], a[148:151], a[108:111], v[56:59]
v_mfma_f32_16x16x32_bf16 v[56:59], a[144:147], a[104:107], v[56:59]
v_mfma_f32_16x16x32_bf16 v[180:183], a[136:139], a[104:107], v[180:183]
v_mfma_f32_16x16x32_bf16 v[180:183], a[140:143], a[108:111], v[180:183]
v_mfma_f32_16x16x32_bf16 v[188:191], a[132:135], a[108:111], v[188:191]
v_mfma_f32_16x16x32_bf16 v[188:191], a[128:131], a[104:107], v[188:191]
s_waitcnt lgkmcnt(0)
v_mfma_f32_16x16x32_bf16 v[196:199], a[160:163], a[80:83], v[196:199]
s_waitcnt vmcnt(17)
v_mfma_f32_16x16x32_bf16 v[196:199], a[164:167], a[84:87], v[196:199]
s_barrier
v_mfma_f32_16x16x32_bf16 v[64:67], a[172:175], a[84:87], v[64:67]
ds_read_b64_tr_b16 a[128:129], v11 offset:0
ds_read_b64_tr_b16 a[130:131], v11 offset:512
v_mfma_f32_16x16x32_bf16 v[64:67], a[168:171], a[80:83], v[64:67]
s_add_u32 m0, s70, 49152
s_add_u32 s64, s68, 16384
s_waitcnt vmcnt(6)
v_mfma_f32_16x16x32_bf16 v[204:207], a[176:179], a[80:83], v[204:207]
buffer_load_dwordx4 v15, s[24:27], s64 offen offset:0 sc1 lds
v_mfma_f32_16x16x32_bf16 v[204:207], a[180:183], a[84:87], v[204:207]
ds_read_b64_tr_b16 a[132:133], v11 offset:4096
ds_read_b64_tr_b16 a[134:135], v11 offset:4608
v_mfma_f32_16x16x32_bf16 v[212:215], a[188:191], a[84:87], v[212:215]
ds_read_b64_tr_b16 a[136:137], v12 offset:0
ds_read_b64_tr_b16 a[138:139], v12 offset:512
v_mfma_f32_16x16x32_bf16 v[212:215], a[184:187], a[80:83], v[212:215]
ds_read_b64_tr_b16 a[140:141], v12 offset:4096
ds_read_b64_tr_b16 a[142:143], v12 offset:4608
v_mfma_f32_16x16x32_bf16 v[72:75], a[112:115], a[80:83], v[72:75]
ds_read_b64_tr_b16 a[192:193], v23 offset:0
ds_read_b64_tr_b16 a[194:195], v23 offset:2048
v_mfma_f32_16x16x32_bf16 v[72:75], a[116:119], a[84:87], v[72:75]
ds_read_b64_tr_b16 a[144:145], v13 offset:0
ds_read_b64_tr_b16 a[146:147], v13 offset:512
v_mfma_f32_16x16x32_bf16 v[220:223], a[124:127], a[84:87], v[220:223]
ds_read_b64_tr_b16 a[196:197], v23 offset:32
ds_read_b64_tr_b16 a[198:199], v23 offset:2080
v_mfma_f32_16x16x32_bf16 v[220:223], a[120:123], a[80:83], v[220:223]
ds_read_b64_tr_b16 a[148:149], v13 offset:4096
ds_read_b64_tr_b16 a[150:151], v13 offset:4608
v_mfma_f32_16x16x32_bf16 v[252:255], a[120:123], a[88:91], v[252:255]
ds_read_b64_tr_b16 a[200:201], v23 offset:64
ds_read_b64_tr_b16 a[202:203], v23 offset:2112
v_mfma_f32_16x16x32_bf16 v[252:255], a[124:127], a[92:95], v[252:255]
ds_read_b64_tr_b16 a[152:153], v14 offset:0
ds_read_b64_tr_b16 a[154:155], v14 offset:512
v_mfma_f32_16x16x32_bf16 v[160:163], a[116:119], a[92:95], v[160:163]
buffer_load_dwordx4 v15, s[24:27], s64 offen offset:1024 sc1 lds
v_mfma_f32_16x16x32_bf16 v[160:163], a[112:115], a[88:91], v[160:163]
ds_read_b64_tr_b16 a[156:157], v14 offset:4096
ds_read_b64_tr_b16 a[158:159], v14 offset:4608
v_mfma_f32_16x16x32_bf16 v[228:231], a[184:187], a[88:91], v[228:231]
ds_read_b64_tr_b16 a[204:205], v23 offset:96
ds_read_b64_tr_b16 a[206:207], v23 offset:2144
v_mfma_f32_16x16x32_bf16 v[228:231], a[188:191], a[92:95], v[228:231]
ds_read_b64_tr_b16 a[208:209], v27 offset:4096
ds_read_b64_tr_b16 a[210:211], v27 offset:4608
v_mfma_f32_16x16x32_bf16 v[168:171], a[180:183], a[92:95], v[168:171]
ds_read_b128 a[64:67], v4 offset:8192
v_mfma_f32_16x16x32_bf16 v[168:171], a[176:179], a[88:91], v[168:171]
s_add_u32 s53, s87, 790528
ds_read_b64_tr_b16 a[212:213], v27 offset:5120
ds_read_b64_tr_b16 a[214:215], v27 offset:5632
v_mfma_f32_16x16x32_bf16 v[176:179], a[168:171], a[88:91], v[176:179]
ds_read_b128 a[80:83], v9 offset:0
v_readlane_b32 s81, v26, 0
v_mfma_f32_16x16x32_bf16 v[176:179], a[172:175], a[92:95], v[176:179]
buffer_store_dwordx4 a[24:27], v15, s[24:27], s53 offen offset:1024 sc1
v_mfma_f32_16x16x32_bf16 v[80:83], a[164:167], a[92:95], v[80:83]
ds_read_b128 a[68:71], v4 offset:10240
v_readlane_b32 s82, v26, 1
v_mfma_f32_16x16x32_bf16 v[80:83], a[160:163], a[88:91], v[80:83]
v_readlane_b32 s71, v26, 2
v_readlane_b32 s72, v26, 3
v_mfma_f32_16x16x32_bf16 v[184:187], a[160:163], a[96:99], v[184:187]
ds_read_b128 a[84:87], v10 offset:0
v_readlane_b32 s74, v26, 4
v_mfma_f32_16x16x32_bf16 v[184:187], a[164:167], a[100:103], v[184:187]
buffer_load_dwordx4 v15, s[24:27], s64 offen offset:2048 sc1 lds
v_mfma_f32_16x16x32_bf16 v[248:251], a[172:175], a[100:103], v[248:251]
v_readlane_b32 s75, v26, 5
v_mfma_f32_16x16x32_bf16 v[248:251], a[168:171], a[96:99], v[248:251]
ds_read_b128 a[72:75], v4 offset:9216
v_mfma_f32_16x16x32_bf16 v[240:243], a[176:179], a[96:99], v[240:243]
v_mfma_f32_16x16x32_bf16 v[240:243], a[180:183], a[100:103], v[240:243]
ds_read_b128 a[88:91], v9 offset:2048
v_mfma_f32_16x16x32_bf16 v[232:235], a[188:191], a[100:103], v[232:235]
v_mfma_f32_16x16x32_bf16 v[232:235], a[184:187], a[96:99], v[232:235]
ds_read_b128 a[76:79], v4 offset:11264
v_mfma_f32_16x16x32_bf16 v[236:239], a[112:115], a[96:99], v[236:239]
v_mfma_f32_16x16x32_bf16 v[236:239], a[116:119], a[100:103], v[236:239]
ds_read_b128 a[92:95], v10 offset:2048
v_mfma_f32_16x16x32_bf16 v[224:227], a[124:127], a[100:103], v[224:227]
v_mfma_f32_16x16x32_bf16 v[224:227], a[120:123], a[96:99], v[224:227]
buffer_load_dwordx4 v15, s[24:27], s64 offen offset:3072 sc1 lds
v_mfma_f32_16x16x32_bf16 v[208:211], a[120:123], a[104:107], v[208:211]
v_mfma_f32_16x16x32_bf16 v[208:211], a[124:127], a[108:111], v[208:211]
v_mfma_f32_16x16x32_bf16 v[216:219], a[116:119], a[108:111], v[216:219]
v_mfma_f32_16x16x32_bf16 v[216:219], a[112:115], a[104:107], v[216:219]
v_mfma_f32_16x16x32_bf16 v[244:247], a[184:187], a[104:107], v[244:247]
v_mfma_f32_16x16x32_bf16 v[244:247], a[188:191], a[108:111], v[244:247]
v_mfma_f32_16x16x32_bf16 v[192:195], a[180:183], a[108:111], v[192:195]
v_mfma_f32_16x16x32_bf16 v[192:195], a[176:179], a[104:107], v[192:195]
v_mfma_f32_16x16x32_bf16 v[200:203], a[168:171], a[104:107], v[200:203]
v_mfma_f32_16x16x32_bf16 v[200:203], a[172:175], a[108:111], v[200:203]
v_mfma_f32_16x16x32_bf16 v[88:91], a[164:167], a[108:111], v[88:91]
v_mfma_f32_16x16x32_bf16 v[88:91], a[160:163], a[104:107], v[88:91]
s_waitcnt lgkmcnt(0)
v_mfma_f32_16x16x32_bf16 v[36:39], a[128:131], a[80:83], v[36:39]
s_waitcnt vmcnt(18)
v_mfma_f32_16x16x32_bf16 v[36:39], a[132:135], a[84:87], v[36:39]
s_barrier
v_mfma_f32_16x16x32_bf16 v[44:47], a[140:143], a[84:87], v[44:47]
ds_read_b128 a[96:99], v9 offset:4096
v_mfma_f32_16x16x32_bf16 v[44:47], a[136:139], a[80:83], v[44:47]
s_add_u32 m0, s70, 65536
s_add_u32 s64, s68, 32768
ds_read_b128 a[100:103], v10 offset:4096
v_mfma_f32_16x16x32_bf16 v[32:35], a[144:147], a[80:83], v[32:35]
buffer_load_dwordx4 v15, s[24:27], s64 offen offset:0 sc1 lds
v_mfma_f32_16x16x32_bf16 v[32:35], a[148:151], a[84:87], v[32:35]
ds_read_b128 a[104:107], v9 offset:6144
v_mfma_f32_16x16x32_bf16 v[52:55], a[156:159], a[84:87], v[52:55]
ds_read_b64_tr_b16 a[160:161], v11 offset:16384
ds_read_b64_tr_b16 a[162:163], v11 offset:16896
v_mfma_f32_16x16x32_bf16 v[52:55], a[152:155], a[80:83], v[52:55]
buffer_store_dwordx4 a[192:195], v15, s[24:27], s81 offen sc1
v_mfma_f32_16x16x32_bf16 v[60:63], a[64:67], a[80:83], v[60:63]
v_mfma_f32_16x16x32_bf16 v[60:63], a[68:71], a[84:87], v[60:63]
ds_read_b128 a[108:111], v10 offset:6144
v_mfma_f32_16x16x32_bf16 v[68:71], a[76:79], a[84:87], v[68:71]
v_cvt_pk_bf16_f32 v36, v36, v37
v_cvt_pk_bf16_f32 v37, v38, v39
v_mfma_f32_16x16x32_bf16 v[68:71], a[72:75], a[80:83], v[68:71]
ds_read_b64_tr_b16 a[164:165], v11 offset:20480
ds_read_b64_tr_b16 a[166:167], v11 offset:20992
v_mfma_f32_16x16x32_bf16 v[76:79], a[72:75], a[88:91], v[76:79]
buffer_store_dwordx4 a[196:199], v15, s[24:27], s82 offen sc1
v_mfma_f32_16x16x32_bf16 v[76:79], a[76:79], a[92:95], v[76:79]
ds_read_b64_tr_b16 a[168:169], v12 offset:16384
ds_read_b64_tr_b16 a[170:171], v12 offset:16896
v_mfma_f32_16x16x32_bf16 v[84:87], a[68:71], a[92:95], v[84:87]
buffer_load_dwordx4 v15, s[24:27], s64 offen offset:1024 sc1 lds
v_mfma_f32_16x16x32_bf16 v[84:87], a[64:67], a[88:91], v[84:87]
ds_read_b64_tr_b16 a[172:173], v12 offset:20480
ds_read_b64_tr_b16 a[174:175], v12 offset:20992
v_mfma_f32_16x16x32_bf16 v[92:95], a[152:155], a[88:91], v[92:95]
v_cvt_pk_bf16_f32 v38, v44, v45
v_cvt_pk_bf16_f32 v39, v46, v47
v_mfma_f32_16x16x32_bf16 v[92:95], a[156:159], a[92:95], v[92:95]
buffer_store_dwordx4 a[200:203], v15, s[24:27], s71 offen sc1
v_mfma_f32_16x16x32_bf16 v[40:43], a[148:151], a[92:95], v[40:43]
ds_read_b64_tr_b16 a[176:177], v13 offset:16384
ds_read_b64_tr_b16 a[178:179], v13 offset:16896
v_mfma_f32_16x16x32_bf16 v[40:43], a[144:147], a[88:91], v[40:43]
v_accvgpr_write_b32 a32, v36
v_accvgpr_write_b32 a33, v37
v_mfma_f32_16x16x32_bf16 v[100:103], a[136:139], a[88:91], v[100:103]
ds_read_b64_tr_b16 a[180:181], v13 offset:20480
ds_read_b64_tr_b16 a[182:183], v13 offset:20992
v_mfma_f32_16x16x32_bf16 v[100:103], a[140:143], a[92:95], v[100:103]
v_accvgpr_write_b32 a34, v38
v_accvgpr_write_b32 a35, v39
v_mfma_f32_16x16x32_bf16 v[108:111], a[132:135], a[92:95], v[108:111]
ds_read_b64_tr_b16 a[184:185], v14 offset:16384
ds_read_b64_tr_b16 a[186:187], v14 offset:16896
v_mfma_f32_16x16x32_bf16 v[108:111], a[128:131], a[88:91], v[108:111]
s_waitcnt lgkmcnt(15)
v_cvt_pk_bf16_f32 v32, v32, v33
v_cvt_pk_bf16_f32 v33, v34, v35
v_mfma_f32_16x16x32_bf16 v[116:119], a[128:131], a[96:99], v[116:119]
ds_read_b64_tr_b16 a[188:189], v14 offset:20480
ds_read_b64_tr_b16 a[190:191], v14 offset:20992
v_mfma_f32_16x16x32_bf16 v[116:119], a[132:135], a[100:103], v[116:119]
buffer_load_dwordx4 v15, s[24:27], s64 offen offset:2048 sc1 lds
v_mfma_f32_16x16x32_bf16 v[124:127], a[140:143], a[100:103], v[124:127]
buffer_store_dwordx4 a[204:207], v15, s[24:27], s72 offen sc1
v_mfma_f32_16x16x32_bf16 v[124:127], a[136:139], a[96:99], v[124:127]
ds_read_b128 a[112:115], v4 offset:24576
v_cvt_pk_bf16_f32 v34, v52, v53
v_mfma_f32_16x16x32_bf16 v[132:135], a[144:147], a[96:99], v[132:135]
v_cvt_pk_bf16_f32 v35, v54, v55
v_accvgpr_write_b32 a36, v32
v_mfma_f32_16x16x32_bf16 v[132:135], a[148:151], a[100:103], v[132:135]
ds_read_b128 a[116:119], v4 offset:26624
v_accvgpr_write_b32 a37, v33
v_mfma_f32_16x16x32_bf16 v[140:143], a[156:159], a[100:103], v[140:143]
v_accvgpr_write_b32 a38, v34
v_accvgpr_write_b32 a39, v35
v_mfma_f32_16x16x32_bf16 v[140:143], a[152:155], a[96:99], v[140:143]
ds_read_b128 a[120:123], v4 offset:25600
v_cvt_pk_bf16_f32 v40, v40, v41
v_mfma_f32_16x16x32_bf16 v[148:151], a[64:67], a[96:99], v[148:151]
buffer_store_dwordx4 a[208:211], v15, s[24:27], s74 offen sc1
v_mfma_f32_16x16x32_bf16 v[148:151], a[68:71], a[100:103], v[148:151]
ds_read_b128 a[124:127], v4 offset:27648
v_cvt_pk_bf16_f32 v41, v42, v43
v_mfma_f32_16x16x32_bf16 v[48:51], a[76:79], a[100:103], v[48:51]
s_waitcnt lgkmcnt(15)
v_cvt_pk_bf16_f32 v42, v92, v93
v_cvt_pk_bf16_f32 v43, v94, v95
v_mfma_f32_16x16x32_bf16 v[48:51], a[72:75], a[96:99], v[48:51]
buffer_load_dwordx4 v15, s[24:27], s64 offen offset:3072 sc1 lds
v_mfma_f32_16x16x32_bf16 v[156:159], a[72:75], a[104:107], v[156:159]
v_accvgpr_write_b32 a40, v40
v_accvgpr_write_b32 a41, v41
v_mfma_f32_16x16x32_bf16 v[156:159], a[76:79], a[108:111], v[156:159]
buffer_store_dwordx4 a[212:215], v15, s[24:27], s75 offen sc1
v_mfma_f32_16x16x32_bf16 v[164:167], a[68:71], a[108:111], v[164:167]
v_accvgpr_write_b32 a42, v42
v_accvgpr_write_b32 a43, v43
v_mfma_f32_16x16x32_bf16 v[164:167], a[64:67], a[104:107], v[164:167]
v_cvt_pk_bf16_f32 v108, v108, v109
v_cvt_pk_bf16_f32 v109, v110, v111
v_mfma_f32_16x16x32_bf16 v[172:175], a[152:155], a[104:107], v[172:175]
v_cvt_pk_bf16_f32 v110, v100, v101
v_cvt_pk_bf16_f32 v111, v102, v103
v_mfma_f32_16x16x32_bf16 v[172:175], a[156:159], a[108:111], v[172:175]
v_accvgpr_write_b32 a44, v108
v_accvgpr_write_b32 a45, v109
v_mfma_f32_16x16x32_bf16 v[56:59], a[148:151], a[108:111], v[56:59]
v_accvgpr_write_b32 a46, v110
v_accvgpr_write_b32 a47, v111
v_mfma_f32_16x16x32_bf16 v[56:59], a[144:147], a[104:107], v[56:59]
v_cvt_pk_bf16_f32 v116, v116, v117
v_cvt_pk_bf16_f32 v117, v118, v119
v_mfma_f32_16x16x32_bf16 v[180:183], a[136:139], a[104:107], v[180:183]
v_cvt_pk_bf16_f32 v118, v124, v125
v_cvt_pk_bf16_f32 v119, v126, v127
v_mfma_f32_16x16x32_bf16 v[180:183], a[140:143], a[108:111], v[180:183]
v_accvgpr_write_b32 a48, v116
v_accvgpr_write_b32 a49, v117
v_mfma_f32_16x16x32_bf16 v[188:191], a[132:135], a[108:111], v[188:191]
v_accvgpr_write_b32 a50, v118
v_accvgpr_write_b32 a51, v119
v_mfma_f32_16x16x32_bf16 v[188:191], a[128:131], a[104:107], v[188:191]
s_waitcnt lgkmcnt(0)
v_cvt_pk_bf16_f32 v132, v132, v133
v_cvt_pk_bf16_f32 v133, v134, v135
v_mfma_f32_16x16x32_bf16 v[196:199], a[160:163], a[80:83], v[196:199]
s_waitcnt vmcnt(16)
v_cvt_pk_bf16_f32 v134, v140, v141
v_cvt_pk_bf16_f32 v135, v142, v143
v_mfma_f32_16x16x32_bf16 v[196:199], a[164:167], a[84:87], v[196:199]
s_barrier
v_mfma_f32_16x16x32_bf16 v[64:67], a[172:175], a[84:87], v[64:67]
ds_read_b128 a[192:195], v4 offset:32768
v_accvgpr_write_b32 a52, v132
v_mfma_f32_16x16x32_bf16 v[64:67], a[168:171], a[80:83], v[64:67]
s_add_u32 m0, s70, 81920
s_add_u32 s64, s68, 49152
v_accvgpr_write_b32 a53, v133
v_mfma_f32_16x16x32_bf16 v[204:207], a[176:179], a[80:83], v[204:207]
buffer_load_dwordx4 v15, s[24:27], s64 offen offset:0 sc1 lds
v_mfma_f32_16x16x32_bf16 v[204:207], a[180:183], a[84:87], v[204:207]
ds_read_b128 a[196:199], v4 offset:33792
v_accvgpr_write_b32 a54, v134
v_mfma_f32_16x16x32_bf16 v[212:215], a[188:191], a[84:87], v[212:215]
v_accvgpr_write_b32 a55, v135
v_cvt_pk_bf16_f32 v56, v56, v57
v_mfma_f32_16x16x32_bf16 v[212:215], a[184:187], a[80:83], v[212:215]
ds_read_b128 a[200:203], v4 offset:34816
v_cvt_pk_bf16_f32 v57, v58, v59
v_mfma_f32_16x16x32_bf16 v[80:83], a[160:163], a[88:91], v[80:83]
v_cvt_pk_bf16_f32 v58, v172, v173
v_cvt_pk_bf16_f32 v59, v174, v175
v_mfma_f32_16x16x32_bf16 v[80:83], a[164:167], a[92:95], v[80:83]
ds_read_b128 a[204:207], v4 offset:35840
v_accvgpr_write_b32 a56, v56
v_mfma_f32_16x16x32_bf16 v[176:179], a[172:175], a[92:95], v[176:179]
v_accvgpr_write_b32 a57, v57
v_accvgpr_write_b32 a58, v58
v_mfma_f32_16x16x32_bf16 v[176:179], a[168:171], a[88:91], v[176:179]
ds_read_b128 a[208:211], v4 offset:36864
v_accvgpr_write_b32 a59, v59
v_mfma_f32_16x16x32_bf16 v[168:171], a[176:179], a[88:91], v[168:171]
v_cvt_pk_bf16_f32 v188, v188, v189
v_cvt_pk_bf16_f32 v189, v190, v191
v_mfma_f32_16x16x32_bf16 v[168:171], a[180:183], a[92:95], v[168:171]
ds_read_b128 a[212:215], v4 offset:37888
v_cvt_pk_bf16_f32 v190, v180, v181
v_mfma_f32_16x16x32_bf16 v[228:231], a[188:191], a[92:95], v[228:231]
buffer_load_dwordx4 v15, s[24:27], s64 offen offset:1024 sc1 lds
v_mfma_f32_16x16x32_bf16 v[228:231], a[184:187], a[88:91], v[228:231]
ds_read_b128 a[216:219], v4 offset:38912
v_cvt_pk_bf16_f32 v191, v182, v183
v_mfma_f32_16x16x32_bf16 v[184:187], a[160:163], a[96:99], v[184:187]
v_accvgpr_write_b32 a60, v188
v_accvgpr_write_b32 a61, v189
v_mfma_f32_16x16x32_bf16 v[184:187], a[164:167], a[100:103], v[184:187]
ds_read_b128 a[220:223], v4 offset:39936
v_accvgpr_write_b32 a62, v190
v_mfma_f32_16x16x32_bf16 v[248:251], a[172:175], a[100:103], v[248:251]
v_accvgpr_write_b32 a63, v191
v_cvt_pk_bf16_f32 v196, v196, v197
v_mfma_f32_16x16x32_bf16 v[248:251], a[168:171], a[96:99], v[248:251]
v_cvt_pk_bf16_f32 v197, v198, v199
v_cvt_pk_bf16_f32 v198, v64, v65
v_mfma_f32_16x16x32_bf16 v[240:243], a[176:179], a[96:99], v[240:243]
v_cvt_pk_bf16_f32 v199, v66, v67
v_accvgpr_write_b32 a28, v196
v_mfma_f32_16x16x32_bf16 v[240:243], a[180:183], a[100:103], v[240:243]
v_accvgpr_write_b32 a29, v197
v_accvgpr_write_b32 a30, v198
v_mfma_f32_16x16x32_bf16 v[232:235], a[188:191], a[100:103], v[232:235]
v_accvgpr_write_b32 a31, v199
v_cvt_pk_bf16_f32 v204, v204, v205
v_mfma_f32_16x16x32_bf16 v[232:235], a[184:187], a[96:99], v[232:235]
v_cvt_pk_bf16_f32 v205, v206, v207
v_cvt_pk_bf16_f32 v206, v212, v213
v_mfma_f32_16x16x32_bf16 v[88:91], a[160:163], a[104:107], v[88:91]
v_cvt_pk_bf16_f32 v207, v214, v215
v_accvgpr_write_b32 a20, v204
v_mfma_f32_16x16x32_bf16 v[88:91], a[164:167], a[108:111], v[88:91]
buffer_load_dwordx4 v15, s[24:27], s64 offen offset:2048 sc1 lds
v_mfma_f32_16x16x32_bf16 v[200:203], a[172:175], a[108:111], v[200:203]
v_accvgpr_write_b32 a21, v205
v_accvgpr_write_b32 a22, v206
v_mfma_f32_16x16x32_bf16 v[200:203], a[168:171], a[104:107], v[200:203]
v_accvgpr_write_b32 a23, v207
v_cvt_pk_bf16_f32 v80, v80, v81
v_mfma_f32_16x16x32_bf16 v[192:195], a[176:179], a[104:107], v[192:195]
v_cvt_pk_bf16_f32 v81, v82, v83
v_cvt_pk_bf16_f32 v82, v176, v177
v_mfma_f32_16x16x32_bf16 v[192:195], a[180:183], a[108:111], v[192:195]
v_cvt_pk_bf16_f32 v83, v178, v179
v_accvgpr_write_b32 a12, v80
v_mfma_f32_16x16x32_bf16 v[244:247], a[188:191], a[108:111], v[244:247]
v_accvgpr_write_b32 a13, v81
v_accvgpr_write_b32 a14, v82
v_mfma_f32_16x16x32_bf16 v[244:247], a[184:187], a[104:107], v[244:247]
v_accvgpr_write_b32 a15, v83
v_cvt_pk_bf16_f32 v168, v168, v169
v_mfma_f32_16x16x32_bf16 v[72:75], a[112:115], a[80:83], v[72:75]
v_cvt_pk_bf16_f32 v169, v170, v171
v_cvt_pk_bf16_f32 v170, v228, v229
v_mfma_f32_16x16x32_bf16 v[72:75], a[116:119], a[84:87], v[72:75]
v_cvt_pk_bf16_f32 v171, v230, v231
v_accvgpr_write_b32 a4, v168
v_mfma_f32_16x16x32_bf16 v[220:223], a[124:127], a[84:87], v[220:223]
v_accvgpr_write_b32 a5, v169
v_accvgpr_write_b32 a6, v170
v_mfma_f32_16x16x32_bf16 v[220:223], a[120:123], a[80:83], v[220:223]
buffer_load_dwordx4 v15, s[24:27], s64 offen offset:3072 sc1 lds
v_mfma_f32_16x16x32_bf16 v[160:163], a[112:115], a[88:91], v[160:163]
v_accvgpr_write_b32 a7, v171
v_cvt_pk_bf16_f32 v184, v184, v185
v_mfma_f32_16x16x32_bf16 v[160:163], a[116:119], a[92:95], v[160:163]
v_cvt_pk_bf16_f32 v185, v186, v187
v_cvt_pk_bf16_f32 v186, v248, v249
v_mfma_f32_16x16x32_bf16 v[252:255], a[124:127], a[92:95], v[252:255]
v_cvt_pk_bf16_f32 v187, v250, v251
v_accvgpr_write_b32 a0, v184
v_mfma_f32_16x16x32_bf16 v[252:255], a[120:123], a[88:91], v[252:255]
v_accvgpr_write_b32 a1, v185
v_accvgpr_write_b32 a2, v186
v_mfma_f32_16x16x32_bf16 v[236:239], a[112:115], a[96:99], v[236:239]
v_accvgpr_write_b32 a3, v187
v_cvt_pk_bf16_f32 v240, v240, v241
v_mfma_f32_16x16x32_bf16 v[236:239], a[116:119], a[100:103], v[236:239]
v_cvt_pk_bf16_f32 v241, v242, v243
v_cvt_pk_bf16_f32 v242, v232, v233
v_mfma_f32_16x16x32_bf16 v[224:227], a[124:127], a[100:103], v[224:227]
v_cvt_pk_bf16_f32 v243, v234, v235
v_accvgpr_write_b32 a8, v240
v_mfma_f32_16x16x32_bf16 v[224:227], a[120:123], a[96:99], v[224:227]
v_accvgpr_write_b32 a9, v241
v_accvgpr_write_b32 a10, v242
v_mfma_f32_16x16x32_bf16 v[216:219], a[112:115], a[104:107], v[216:219]
v_accvgpr_write_b32 a11, v243
v_cvt_pk_bf16_f32 v88, v88, v89
v_mfma_f32_16x16x32_bf16 v[216:219], a[116:119], a[108:111], v[216:219]
v_cvt_pk_bf16_f32 v89, v90, v91
v_cvt_pk_bf16_f32 v90, v200, v201
v_mfma_f32_16x16x32_bf16 v[208:211], a[124:127], a[108:111], v[208:211]
v_cvt_pk_bf16_f32 v91, v202, v203
v_accvgpr_write_b32 a16, v88
v_mfma_f32_16x16x32_bf16 v[208:211], a[120:123], a[104:107], v[208:211]
s_waitcnt lgkmcnt(0)
v_accvgpr_write_b32 a17, v89
v_accvgpr_write_b32 a18, v90
v_mfma_f32_16x16x32_bf16 v[44:47], a[192:195], a[32:35], v[96:99]
v_accvgpr_write_b32 a19, v91
v_cvt_pk_bf16_f32 v192, v192, v193
v_mfma_f32_16x16x32_bf16 v[44:47], a[196:199], a[36:39], v[44:47]
v_cvt_pk_bf16_f32 v193, v194, v195
v_cvt_pk_bf16_f32 v194, v244, v245
v_mfma_f32_16x16x32_bf16 v[44:47], a[200:203], a[28:31], v[44:47]
v_cvt_pk_bf16_f32 v195, v246, v247
v_accvgpr_write_b32 a24, v192
v_mfma_f32_16x16x32_bf16 v[44:47], a[204:207], a[20:23], v[44:47]
v_accvgpr_write_b32 a25, v193
v_accvgpr_write_b32 a26, v194
v_mfma_f32_16x16x32_bf16 v[52:55], a[192:195], a[44:47], v[104:107]
ds_bpermute_b32 v8, v17, v63
v_accvgpr_write_b32 a27, v195
v_mfma_f32_16x16x32_bf16 v[52:55], a[196:199], a[40:43], v[52:55]
v_cvt_pk_bf16_f32 v60, v60, v61
v_cvt_pk_bf16_f32 v61, v62, v63
v_mfma_f32_16x16x32_bf16 v[52:55], a[200:203], a[12:15], v[52:55]
v_cvt_pk_bf16_f32 v62, v68, v69
v_cvt_pk_bf16_f32 v63, v70, v71
v_mfma_f32_16x16x32_bf16 v[52:55], a[204:207], a[4:7], v[52:55]
v_accvgpr_write_b32 a128, v60
v_accvgpr_write_b32 a129, v61
v_mfma_f32_16x16x32_bf16 v[64:67], a[208:211], a[32:35], v[112:115]
v_accvgpr_write_b32 a130, v62
v_accvgpr_write_b32 a131, v63
v_mfma_f32_16x16x32_bf16 v[64:67], a[212:215], a[36:39], v[64:67]
ds_bpermute_b32 v9, v17, v87
v_cvt_pk_bf16_f32 v84, v84, v85
v_mfma_f32_16x16x32_bf16 v[64:67], a[216:219], a[28:31], v[64:67]
v_cvt_pk_bf16_f32 v85, v86, v87
v_cvt_pk_bf16_f32 v86, v76, v77
v_mfma_f32_16x16x32_bf16 v[64:67], a[220:223], a[20:23], v[64:67]
v_cvt_pk_bf16_f32 v87, v78, v79
v_mfma_f32_16x16x32_bf16 v[212:215], a[208:211], a[44:47], v[120:123]
buffer_store_dwordx4 v[84:87], v18, s[24:27], s54 offen offset:256 sc1
v_mfma_f32_16x16x32_bf16 v[212:215], a[212:215], a[40:43], v[212:215]
v_accvgpr_write_b32 a136, v84
v_accvgpr_write_b32 a137, v85
v_mfma_f32_16x16x32_bf16 v[212:215], a[216:219], a[12:15], v[212:215]
v_accvgpr_write_b32 a138, v86
v_accvgpr_write_b32 a139, v87
v_mfma_f32_16x16x32_bf16 v[212:215], a[220:223], a[4:7], v[212:215]
s_waitcnt vmcnt(15)
ds_bpermute_b32 v10, v17, v151
v_cvt_pk_bf16_f32 v148, v148, v149
v_mfma_f32_16x16x32_bf16 v[100:103], a[192:195], a[48:51], v[128:131]
s_barrier
v_cvt_pk_bf16_f32 v149, v150, v151
v_cvt_pk_bf16_f32 v150, v48, v49
v_mfma_f32_16x16x32_bf16 v[100:103], a[196:199], a[52:55], v[100:103]
v_cvt_pk_bf16_f32 v151, v50, v51
v_accvgpr_write_b32 a144, v148
v_mfma_f32_16x16x32_bf16 v[100:103], a[200:203], a[0:3], v[100:103]
ds_bpermute_b32 v11, v17, v167
v_accvgpr_write_b32 a145, v149
v_mfma_f32_16x16x32_bf16 v[100:103], a[204:207], a[8:11], v[100:103]
v_cvt_pk_bf16_f32 v164, v164, v165
v_cvt_pk_bf16_f32 v165, v166, v167
v_mfma_f32_16x16x32_bf16 v[92:95], a[192:195], a[60:63], v[136:139]
v_cvt_pk_bf16_f32 v166, v156, v157
v_cvt_pk_bf16_f32 v167, v158, v159
v_mfma_f32_16x16x32_bf16 v[92:95], a[196:199], a[56:59], v[92:95]
buffer_store_dwordx4 v[164:167], v18, s[24:27], s55 offen offset:256 sc1
v_mfma_f32_16x16x32_bf16 v[92:95], a[200:203], a[16:19], v[92:95]
v_cvt_pk_bf16_f32 v72, v72, v73
v_cvt_pk_bf16_f32 v73, v74, v75
v_mfma_f32_16x16x32_bf16 v[92:95], a[204:207], a[24:27], v[92:95]
v_cvt_pk_bf16_f32 v74, v220, v221
v_cvt_pk_bf16_f32 v75, v222, v223
v_mfma_f32_16x16x32_bf16 v[176:179], a[208:211], a[48:51], v[144:147]
v_cvt_pk_bf16_f32 v160, v160, v161
v_cvt_pk_bf16_f32 v161, v162, v163
v_mfma_f32_16x16x32_bf16 v[176:179], a[212:215], a[52:55], v[176:179]
L_PAD8:
s_cbranch_execz L_PAD12
v_cvt_pk_bf16_f32 v162, v252, v253
v_cvt_pk_bf16_f32 v163, v254, v255
v_mfma_f32_16x16x32_bf16 v[176:179], a[216:219], a[0:3], v[176:179]
buffer_store_dwordx4 v[160:163], v19, s[24:27], s54 offen offset:256 sc1
v_mfma_f32_16x16x32_bf16 v[176:179], a[220:223], a[8:11], v[176:179]
v_cvt_pk_bf16_f32 v236, v236, v237
v_cvt_pk_bf16_f32 v237, v238, v239
v_mfma_f32_16x16x32_bf16 v[228:231], a[208:211], a[60:63], v[152:155]
v_cvt_pk_bf16_f32 v238, v224, v225
v_cvt_pk_bf16_f32 v239, v226, v227
v_mfma_f32_16x16x32_bf16 v[228:231], a[212:215], a[56:59], v[228:231]
v_cvt_pk_bf16_f32 v216, v216, v217
v_cvt_pk_bf16_f32 v217, v218, v219
v_mfma_f32_16x16x32_bf16 v[228:231], a[216:219], a[16:19], v[228:231]
v_cvt_pk_bf16_f32 v218, v208, v209
v_cvt_pk_bf16_f32 v219, v210, v211
v_mfma_f32_16x16x32_bf16 v[228:231], a[220:223], a[24:27], v[228:231]
buffer_store_dwordx4 v[216:219], v19, s[24:27], s55 offen offset:256 sc1
ds_read_b128 a[64:67], v4 offset:57344
ds_read_b128 a[68:71], v4 offset:58368
ds_read_b128 a[72:75], v4 offset:59392
ds_read_b128 a[76:79], v4 offset:60416
ds_read_b128 a[80:83], v4 offset:61440
ds_read_b128 a[84:87], v4 offset:62464
ds_read_b128 a[88:91], v4 offset:63488
ds_read_b128 a[92:95], v4 offset:64512
s_add_u32 m0, s70, 98304
s_add_u32 s64, s68, 65536
buffer_load_dwordx4 v15, s[24:27], s64 offen offset:0 sc1 lds
v_max3_f32 v24, v44, v45, v46
v_max3_f32 v25, v47, v64, v65
v_max3_f32 v26, v52, v53, v54
v_max3_f32 v27, v55, v212, v213
v_max3_f32 v24, v24, v66, v67
v_max_f32 v24, v24, v25
v_max3_f32 v26, v26, v214, v215
v_max_f32 v26, v26, v27
v_mov_b32 v25, v24
buffer_load_dwordx4 v15, s[24:27], s64 offen offset:1024 sc1 lds
v_mov_b32 v27, v26
s_nop 1
v_permlane32_swap_b32 v25, v24
v_permlane32_swap_b32 v27, v26
s_nop 0
v_max_f32 v24, v24, v25
v_max_f32 v26, v26, v27
v_mov_b32 v25, v24
v_mov_b32 v27, v26
buffer_load_dwordx4 v15, s[24:27], s64 offen offset:2048 sc1 lds
s_nop 1
v_permlane16_swap_b32 v25, v24
v_permlane16_swap_b32 v27, v26
s_nop 0
v_max_f32 v24, v24, v25
v_max_f32 v26, v26, v27
v_pk_add_f32 v[44:45], v[44:45], v[24:25] op_sel_hi:[1,0] neg_lo:[0,1] neg_hi:[0,1]
v_pk_add_f32 v[46:47], v[46:47], v[24:25] op_sel_hi:[1,0] neg_lo:[0,1] neg_hi:[0,1]
v_pk_add_f32 v[52:53], v[52:53], v[26:27] op_sel_hi:[1,0] neg_lo:[0,1] neg_hi:[0,1]
buffer_load_dwordx4 v15, s[24:27], s64 offen offset:3072 sc1 lds
v_pk_add_f32 v[54:55], v[54:55], v[26:27] op_sel_hi:[1,0] neg_lo:[0,1] neg_hi:[0,1]
v_pk_add_f32 v[64:65], v[64:65], v[24:25] op_sel_hi:[1,0] neg_lo:[0,1] neg_hi:[0,1]
v_pk_add_f32 v[66:67], v[66:67], v[24:25] op_sel_hi:[1,0] neg_lo:[0,1] neg_hi:[0,1]
v_pk_add_f32 v[212:213], v[212:213], v[26:27] op_sel_hi:[1,0] neg_lo:[0,1] neg_hi:[0,1]
v_pk_add_f32 v[214:215], v[214:215], v[26:27] op_sel_hi:[1,0] neg_lo:[0,1] neg_hi:[0,1]
v_pk_add_f32 v[96:97], v[96:97], v[24:25] op_sel_hi:[1,0] neg_lo:[0,1] neg_hi:[0,1]
v_pk_add_f32 v[98:99], v[98:99], v[24:25] op_sel_hi:[1,0] neg_lo:[0,1] neg_hi:[0,1]
v_pk_add_f32 v[104:105], v[104:105], v[26:27] op_sel_hi:[1,0] neg_lo:[0,1] neg_hi:[0,1]
v_pk_add_f32 v[106:107], v[106:107], v[26:27] op_sel_hi:[1,0] neg_lo:[0,1] neg_hi:[0,1]
s_add_u32 m0, s70, 114688
s_add_u32 s64, s68, 81920
buffer_load_dwordx4 v15, s[24:27], s64 offen offset:0 sc1 lds
v_pk_add_f32 v[112:113], v[112:113], v[24:25] op_sel_hi:[1,0] neg_lo:[0,1] neg_hi:[0,1]
v_pk_add_f32 v[114:115], v[114:115], v[24:25] op_sel_hi:[1,0] neg_lo:[0,1] neg_hi:[0,1]
v_pk_add_f32 v[120:121], v[120:121], v[26:27] op_sel_hi:[1,0] neg_lo:[0,1] neg_hi:[0,1]
v_pk_add_f32 v[122:123], v[122:123], v[26:27] op_sel_hi:[1,0] neg_lo:[0,1] neg_hi:[0,1]
v_exp_f32 v44, v44
v_exp_f32 v45, v45
v_exp_f32 v46, v46
v_exp_f32 v47, v47
v_cvt_pk_bf16_f32 v124, v44, v45
buffer_load_dwordx4 v15, s[24:27], s64 offen offset:1024 sc1 lds
v_exp_f32 v52, v52
v_exp_f32 v53, v53
v_cvt_pk_bf16_f32 v125, v46, v47
v_exp_f32 v54, v54
v_exp_f32 v55, v55
v_cvt_pk_bf16_f32 v140, v52, v53
v_exp_f32 v64, v64
v_exp_f32 v65, v65
v_cvt_pk_bf16_f32 v141, v54, v55
buffer_load_dwordx4 v15, s[24:27], s64 offen offset:2048 sc1 lds
v_exp_f32 v66, v66
v_exp_f32 v67, v67
v_cvt_pk_bf16_f32 v126, v64, v65
v_exp_f32 v212, v212
v_exp_f32 v213, v213
v_cvt_pk_bf16_f32 v127, v66, v67
v_exp_f32 v214, v214
v_exp_f32 v215, v215
v_cvt_pk_bf16_f32 v142, v212, v213
buffer_load_dwordx4 v15, s[24:27], s64 offen offset:3072 sc1 lds
v_max3_f32 v24, v100, v101, v102
v_cvt_pk_bf16_f32 v143, v214, v215
v_max3_f32 v25, v103, v176, v177
v_max3_f32 v26, v92, v93, v94
v_max3_f32 v27, v95, v228, v229
v_max3_f32 v24, v24, v178, v179
v_max_f32 v24, v24, v25
v_max3_f32 v26, v26, v230, v231
v_max_f32 v26, v26, v27
v_mov_b32 v25, v24
v_mov_b32 v27, v26
s_nop 1
v_permlane32_swap_b32 v25, v24
v_permlane32_swap_b32 v27, v26
s_nop 0
v_max_f32 v24, v24, v25
s_cmp_lt_u32 s3, 1
s_cbranch_scc1 L_SK5
s_add_u32 m0, s70, 131072
s_add_u32 s64, s68, 98304
buffer_load_dwordx4 v15, s[24:27], s64 offen offset:0 sc1 lds
buffer_load_dwordx4 v15, s[24:27], s64 offen offset:1024 sc1 lds
buffer_load_dwordx4 v15, s[24:27], s64 offen offset:2048 sc1 lds
buffer_load_dwordx4 v15, s[24:27], s64 offen offset:3072 sc1 lds
L_SK5:
v_max_f32 v26, v26, v27
v_mov_b32 v25, v24
v_mov_b32 v27, v26
s_nop 1
v_permlane16_swap_b32 v25, v24
v_permlane16_swap_b32 v27, v26
s_nop 0
v_max_f32 v24, v24, v25
v_max_f32 v26, v26, v27
v_pk_add_f32 v[100:101], v[100:101], v[24:25] op_sel_hi:[1,0] neg_lo:[0,1] neg_hi:[0,1]
v_pk_add_f32 v[102:103], v[102:103], v[24:25] op_sel_hi:[1,0] neg_lo:[0,1] neg_hi:[0,1]
v_pk_add_f32 v[92:93], v[92:93], v[26:27] op_sel_hi:[1,0] neg_lo:[0,1] neg_hi:[0,1]
v_pk_add_f32 v[94:95], v[94:95], v[26:27] op_sel_hi:[1,0] neg_lo:[0,1] neg_hi:[0,1]
v_pk_add_f32 v[176:177], v[176:177], v[24:25] op_sel_hi:[1,0] neg_lo:[0,1] neg_hi:[0,1]
v_pk_add_f32 v[178:179], v[178:179], v[24:25] op_sel_hi:[1,0] neg_lo:[0,1] neg_hi:[0,1]
v_pk_add_f32 v[228:229], v[228:229], v[26:27] op_sel_hi:[1,0] neg_lo:[0,1] neg_hi:[0,1]
v_pk_add_f32 v[230:231], v[230:231], v[26:27] op_sel_hi:[1,0] neg_lo:[0,1] neg_hi:[0,1]
v_pk_add_f32 v[128:129], v[128:129], v[24:25] op_sel_hi:[1,0] neg_lo:[0,1] neg_hi:[0,1]
v_pk_add_f32 v[130:131], v[130:131], v[24:25] op_sel_hi:[1,0] neg_lo:[0,1] neg_hi:[0,1]
v_pk_add_f32 v[136:137], v[136:137], v[26:27] op_sel_hi:[1,0] neg_lo:[0,1] neg_hi:[0,1]
v_pk_add_f32 v[138:139], v[138:139], v[26:27] op_sel_hi:[1,0] neg_lo:[0,1] neg_hi:[0,1]
v_pk_add_f32 v[144:145], v[144:145], v[24:25] op_sel_hi:[1,0] neg_lo:[0,1] neg_hi:[0,1]
v_pk_add_f32 v[146:147], v[146:147], v[24:25] op_sel_hi:[1,0] neg_lo:[0,1] neg_hi:[0,1]
v_pk_add_f32 v[152:153], v[152:153], v[26:27] op_sel_hi:[1,0] neg_lo:[0,1] neg_hi:[0,1]
v_pk_add_f32 v[154:155], v[154:155], v[26:27] op_sel_hi:[1,0] neg_lo:[0,1] neg_hi:[0,1]
v_accvgpr_write_b32 a146, v150
s_cmp_lt_u32 s3, 2
s_cbranch_scc1 L_SK6
s_add_u32 m0, s70, 147456
s_add_u32 s64, s68, 114688
buffer_load_dwordx4 v15, s[24:27], s64 offen offset:0 sc1 lds
buffer_load_dwordx4 v15, s[24:27], s64 offen offset:1024 sc1 lds
buffer_load_dwordx4 v15, s[24:27], s64 offen offset:2048 sc1 lds
buffer_load_dwordx4 v15, s[24:27], s64 offen offset:3072 sc1 lds
L_SK6:
v_accvgpr_write_b32 a147, v151
v_accvgpr_write_b32 a152, v164
v_accvgpr_write_b32 a153, v165
v_accvgpr_write_b32 a154, v166
v_accvgpr_write_b32 a155, v167
v_accvgpr_write_b32 a132, v72
v_accvgpr_write_b32 a133, v73
v_accvgpr_write_b32 a134, v74
v_accvgpr_write_b32 a135, v75
v_accvgpr_write_b32 a140, v160
v_accvgpr_write_b32 a141, v161
v_accvgpr_write_b32 a142, v162
v_accvgpr_write_b32 a143, v163
v_accvgpr_write_b32 a148, v236
v_accvgpr_write_b32 a149, v237
v_accvgpr_write_b32 a150, v238
v_accvgpr_write_b32 a151, v239
v_accvgpr_write_b32 a156, v216
v_accvgpr_write_b32 a157, v217
v_accvgpr_write_b32 a158, v218
v_accvgpr_write_b32 a159, v219
v_mov_b64 v[60:61], 0
v_mov_b64 v[62:63], 0
v_mov_b64 v[68:69], 0
v_mov_b64 v[70:71], 0
v_mov_b64 v[72:73], 0
s_cmp_lt_u32 s3, 3
s_cbranch_scc1 L_SK7
s_add_u32 m0, s70, 0
s_add_u32 s64, s68, 131072
buffer_load_dwordx4 v15, s[24:27], s64 offen offset:0 sc1 lds
buffer_load_dwordx4 v15, s[24:27], s64 offen offset:1024 sc1 lds
buffer_load_dwordx4 v15, s[24:27], s64 offen offset:2048 sc1 lds
buffer_load_dwordx4 v15, s[24:27], s64 offen offset:3072 sc1 lds
L_SK7:
v_mov_b64 v[74:75], 0
v_mov_b64 v[220:221], 0
v_mov_b64 v[222:223], 0
v_mov_b64 v[84:85], 0
v_mov_b64 v[86:87], 0
v_mov_b64 v[76:77], 0
v_mov_b64 v[78:79], 0
v_mov_b64 v[160:161], 0
v_mov_b64 v[162:163], 0
v_mov_b64 v[252:253], 0
v_mov_b64 v[254:255], 0
v_mov_b64 v[148:149], 0
v_mov_b64 v[150:151], 0
v_mov_b64 v[48:49], 0
v_mov_b64 v[50:51], 0
v_mov_b64 v[236:237], 0
v_mov_b64 v[238:239], 0
v_mov_b64 v[224:225], 0
v_mov_b64 v[226:227], 0
v_mov_b64 v[164:165], 0
v_mov_b64 v[166:167], 0
v_mov_b64 v[156:157], 0
v_mov_b64 v[158:159], 0
v_mov_b64 v[216:217], 0
v_mov_b64 v[218:219], 0
v_mov_b64 v[208:209], 0
v_mov_b64 v[210:211], 0
ds_read_b128 a[192:195], v4 offset:49152
ds_read_b128 a[196:199], v4 offset:50176
ds_read_b128 a[200:203], v4 offset:51200
ds_read_b128 a[204:207], v4 offset:52224
ds_read_b128 a[208:211], v4 offset:53248
ds_read_b128 a[212:215], v4 offset:54272
ds_read_b128 a[216:219], v4 offset:55296
ds_read_b128 a[220:223], v4 offset:56320
s_waitcnt lgkmcnt(8)
s_lshl2_add_u32 s77, s86, s84
s_mul_i32 s77, s77, 344064
s_mov_b32 s80, s70
s_cmp_lt_u32 s3, 2
s_cselect_b32 s53, 8, -2
s_add_u32 s53, s53, s3
v_mfma_f32_16x16x32_bf16 v[36:39], a[64:67], v[124:127], 0
s_mul_i32 s52, s5, 65536
v_exp_f32 v100, v100
v_mfma_f32_16x16x32_bf16 v[116:119], a[64:67], v[140:143], 0
s_sub_u32 s52, 1064960, s52
v_exp_f32 v101, v101
v_mfma_f32_16x16x32_bf16 v[132:135], a[68:71], v[140:143], 0
s_add_u32 s71, s68, s52
v_exp_f32 v102, v102
v_mfma_f32_16x16x32_bf16 v[32:35], a[68:71], v[124:127], 0
s_add_u32 s77, s77, s80
v_exp_f32 v103, v103
v_mfma_f32_16x16x32_bf16 v[196:199], a[72:75], v[124:127], 0
s_add_u32 s77, s77, 38797312
v_cvt_pk_bf16_f32 v248, v100, v101
v_cvt_pk_bf16_f32 v249, v102, v103
v_mfma_f32_16x16x32_bf16 v[184:187], a[72:75], v[140:143], 0
s_add_u32 s52, s3, 6
v_exp_f32 v92, v92
v_mfma_f32_16x16x32_bf16 v[240:243], a[76:79], v[140:143], 0
s_mul_i32 s52, s52, 16384
v_exp_f32 v93, v93
v_mfma_f32_16x16x32_bf16 v[204:207], a[76:79], v[124:127], 0
s_add_u32 s68, s68, s52
v_exp_f32 v94, v94
v_mfma_f32_16x16x32_bf16 v[108:111], a[80:83], v[124:127], 0
s_lshl_b32 s53, s53, 14
v_exp_f32 v95, v95
v_mfma_f32_16x16x32_bf16 v[188:191], a[80:83], v[140:143], 0
s_add_u32 s70, s70, s53
v_cvt_pk_bf16_f32 v232, v92, v93
v_cvt_pk_bf16_f32 v233, v94, v95
v_mfma_f32_16x16x32_bf16 v[56:59], a[84:87], v[140:143], 0
s_mov_b32 s75, 65536
v_exp_f32 v176, v176
v_mfma_f32_16x16x32_bf16 v[40:43], a[84:87], v[124:127], 0
s_mov_b32 s72, 1
v_exp_f32 v177, v177
v_mfma_f32_16x16x32_bf16 v[80:83], a[88:91], v[124:127], 0
s_mov_b32 s73, 9
v_exp_f32 v178, v178
v_mfma_f32_16x16x32_bf16 v[88:91], a[88:91], v[140:143], 0
s_lshl2_add_u32 s69, s5, 4
v_exp_f32 v179, v179
v_mfma_f32_16x16x32_bf16 v[192:195], a[92:95], v[140:143], 0
s_max_u32 s69, s69, 12
v_cvt_pk_bf16_f32 v250, v176, v177
v_cvt_pk_bf16_f32 v251, v178, v179
v_mfma_f32_16x16x32_bf16 v[168:171], a[92:95], v[124:127], 0
s_min_u32 s74, s73, s66
v_exp_f32 v228, v228
v_mfma_f32_16x16x32_bf16 a[224:227], a[240:243], v[124:127], 0
s_mov_b32 s93, 9
s_waitcnt vmcnt(8) lgkmcnt(0)
v_mfma_f32_16x16x32_bf16 a[228:231], a[240:243], v[140:143], 0
s_cmp_lt_u32 s66, 2
buffer_atomic_add v1, v0, s[24:27], s89 offen offset:8 sc1
s_cbranch_scc1 L_NE
L_DUAL:
v_mfma_f32_16x16x32_bf16 v[44:47], a[192:195], a[32:35], v[96:99]
s_barrier
v_mfma_f32_16x16x32_bf16 v[44:47], a[196:199], a[36:39], v[44:47]
s_cmp_eq_u32 s68, s71
v_exp_f32 v229, v229
v_mfma_f32_16x16x32_bf16 v[44:47], a[200:203], a[28:31], v[44:47]
s_cselect_b32 s64, s77, s68
v_add_u32 v5, s75, v4
v_cvt_pk_bf16_f32 v234, v228, v229
v_mfma_f32_16x16x32_bf16 v[44:47], a[204:207], a[20:23], v[44:47]
s_mov_b32 m0, s70
v_exp_f32 v230, v230
v_mfma_f32_16x16x32_bf16 v[52:55], a[192:195], a[44:47], v[104:107]
buffer_load_dwordx4 v15, s[24:27], s64 offen offset:0 sc1 lds
v_mfma_f32_16x16x32_bf16 v[52:55], a[196:199], a[40:43], v[52:55]
s_add_u32 s75, s75, 16384
v_exp_f32 v231, v231
v_mfma_f32_16x16x32_bf16 v[52:55], a[200:203], a[12:15], v[52:55]
v_cvt_pk_bf16_f32 v235, v230, v231
v_mfma_f32_16x16x32_bf16 v[52:55], a[204:207], a[4:7], v[52:55]
s_cmp_ge_u32 s75, 163840
v_exp_f32 v44, v44
v_mfma_f32_16x16x32_bf16 v[64:67], a[208:211], a[32:35], v[112:115]
v_mfma_f32_16x16x32_bf16 v[64:67], a[212:215], a[36:39], v[64:67]
s_cselect_b32 s75, 0, s75
v_exp_f32 v45, v45
v_mfma_f32_16x16x32_bf16 v[64:67], a[216:219], a[28:31], v[64:67]
v_cvt_pk_bf16_f32 v124, v44, v45
v_mfma_f32_16x16x32_bf16 v[64:67], a[220:223], a[20:23], v[64:67]
s_add_u32 s68, s64, 16384
v_exp_f32 v46, v46
v_mfma_f32_16x16x32_bf16 v[212:215], a[208:211], a[44:47], v[120:123]
buffer_load_dwordx4 v15, s[24:27], s64 offen offset:1024 sc1 lds
v_mfma_f32_16x16x32_bf16 v[212:215], a[212:215], a[40:43], v[212:215]
s_add_u32 s70, s70, 16384
v_exp_f32 v47, v47
v_mfma_f32_16x16x32_bf16 v[212:215], a[216:219], a[12:15], v[212:215]
v_cvt_pk_bf16_f32 v125, v46, v47
v_mfma_f32_16x16x32_bf16 v[212:215], a[220:223], a[4:7], v[212:215]
v_exp_f32 v52, v52
v_mfma_f32_16x16x32_bf16 v[60:63], a[64:67], v[248:251], v[60:63]
v_mfma_f32_16x16x32_bf16 v[148:151], a[64:67], v[232:235], v[148:151]
s_cmp_ge_u32 s70, 163840
v_exp_f32 v53, v53
v_mfma_f32_16x16x32_bf16 v[48:51], a[68:71], v[232:235], v[48:51]
ds_read_b128 a[64:67], v5 offset:8192
v_cvt_pk_bf16_f32 v140, v52, v53
v_mfma_f32_16x16x32_bf16 v[68:71], a[68:71], v[248:251], v[68:71]
s_cselect_b32 s70, s80, s70
v_exp_f32 v54, v54
v_mfma_f32_16x16x32_bf16 v[72:75], a[72:75], v[248:251], v[72:75]
buffer_load_dwordx4 v15, s[24:27], s64 offen offset:2048 sc1 lds
v_mfma_f32_16x16x32_bf16 v[236:239], a[72:75], v[232:235], v[236:239]
v_exp_f32 v55, v55
v_mfma_f32_16x16x32_bf16 v[224:227], a[76:79], v[232:235], v[224:227]
ds_read_b128 a[68:71], v5 offset:9216
v_cvt_pk_bf16_f32 v141, v54, v55
v_mfma_f32_16x16x32_bf16 v[220:223], a[76:79], v[248:251], v[220:223]
v_exp_f32 v64, v64
v_mfma_f32_16x16x32_bf16 v[84:87], a[80:83], v[248:251], v[84:87]
ds_read_b128 a[72:75], v5 offset:10240
v_mfma_f32_16x16x32_bf16 v[164:167], a[80:83], v[232:235], v[164:167]
v_exp_f32 v65, v65
v_mfma_f32_16x16x32_bf16 v[156:159], a[84:87], v[232:235], v[156:159]
ds_read_b128 a[76:79], v5 offset:11264
v_cvt_pk_bf16_f32 v126, v64, v65
v_mfma_f32_16x16x32_bf16 v[76:79], a[84:87], v[248:251], v[76:79]
v_exp_f32 v66, v66
v_mfma_f32_16x16x32_bf16 v[160:163], a[88:91], v[248:251], v[160:163]
buffer_load_dwordx4 v15, s[24:27], s64 offen offset:3072 sc1 lds
v_mfma_f32_16x16x32_bf16 v[216:219], a[88:91], v[232:235], v[216:219]
v_exp_f32 v67, v67
v_mfma_f32_16x16x32_bf16 v[208:211], a[92:95], v[232:235], v[208:211]
ds_read_b128 a[80:83], v5 offset:12288
v_cvt_pk_bf16_f32 v127, v66, v67
v_mfma_f32_16x16x32_bf16 v[252:255], a[92:95], v[248:251], v[252:255]
v_exp_f32 v212, v212
v_mfma_f32_16x16x32_bf16 a[232:235], a[240:243], v[248:251], a[232:235]
ds_read_b128 a[84:87], v5 offset:13312
v_mfma_f32_16x16x32_bf16 a[236:239], a[240:243], v[232:235], a[236:239]
ds_read_b128 a[88:91], v5 offset:14336
v_mfma_f32_16x16x32_bf16 v[100:103], a[192:195], a[48:51], v[128:131]
ds_read_b128 a[92:95], v5 offset:15360
v_mfma_f32_16x16x32_bf16 v[100:103], a[196:199], a[52:55], v[100:103]
v_exp_f32 v213, v213
v_mfma_f32_16x16x32_bf16 v[100:103], a[200:203], a[0:3], v[100:103]
v_cvt_pk_bf16_f32 v142, v212, v213
v_mfma_f32_16x16x32_bf16 v[100:103], a[204:207], a[8:11], v[100:103]
v_exp_f32 v214, v214
v_mfma_f32_16x16x32_bf16 v[92:95], a[192:195], a[60:63], v[136:139]
s_nop 0
v_mfma_f32_16x16x32_bf16 v[92:95], a[196:199], a[56:59], v[92:95]
v_exp_f32 v215, v215
v_mfma_f32_16x16x32_bf16 v[92:95], a[200:203], a[16:19], v[92:95]
ds_read_b128 a[192:195], v5 offset:0
v_cvt_pk_bf16_f32 v143, v214, v215
v_mfma_f32_16x16x32_bf16 v[92:95], a[204:207], a[24:27], v[92:95]
v_exp_f32 v100, v100
v_mfma_f32_16x16x32_bf16 v[176:179], a[208:211], a[48:51], v[144:147]
ds_read_b128 a[196:199], v5 offset:1024
v_mfma_f32_16x16x32_bf16 v[176:179], a[212:215], a[52:55], v[176:179]
v_exp_f32 v101, v101
v_mfma_f32_16x16x32_bf16 v[176:179], a[216:219], a[0:3], v[176:179]
ds_read_b128 a[200:203], v5 offset:2048
v_cvt_pk_bf16_f32 v248, v100, v101
v_mfma_f32_16x16x32_bf16 v[176:179], a[220:223], a[8:11], v[176:179]
v_exp_f32 v102, v102
v_mfma_f32_16x16x32_bf16 v[228:231], a[208:211], a[60:63], v[152:155]
ds_read_b128 a[204:207], v5 offset:3072
v_mfma_f32_16x16x32_bf16 v[228:231], a[212:215], a[56:59], v[228:231]
v_exp_f32 v103, v103
v_mfma_f32_16x16x32_bf16 v[228:231], a[216:219], a[16:19], v[228:231]
ds_read_b128 a[208:211], v5 offset:4096
v_cvt_pk_bf16_f32 v249, v102, v103
v_mfma_f32_16x16x32_bf16 v[228:231], a[220:223], a[24:27], v[228:231]
s_waitcnt lgkmcnt(5)
v_exp_f32 v92, v92
v_mfma_f32_16x16x32_bf16 v[36:39], a[64:67], v[124:127], v[36:39]
ds_read_b128 a[212:215], v5 offset:5120
v_mfma_f32_16x16x32_bf16 v[116:119], a[64:67], v[140:143], v[116:119]
v_exp_f32 v93, v93
v_mfma_f32_16x16x32_bf16 v[132:135], a[68:71], v[140:143], v[132:135]
ds_read_b128 a[216:219], v5 offset:6144
v_cvt_pk_bf16_f32 v232, v92, v93
v_mfma_f32_16x16x32_bf16 v[32:35], a[68:71], v[124:127], v[32:35]
v_exp_f32 v94, v94
v_mfma_f32_16x16x32_bf16 v[196:199], a[72:75], v[124:127], v[196:199]
ds_read_b128 a[220:223], v5 offset:7168
v_mfma_f32_16x16x32_bf16 v[184:187], a[72:75], v[140:143], v[184:187]
s_add_u32 s72, s72, 1
v_exp_f32 v95, v95
v_mfma_f32_16x16x32_bf16 v[240:243], a[76:79], v[140:143], v[240:243]
v_cvt_pk_bf16_f32 v233, v94, v95
v_mfma_f32_16x16x32_bf16 v[204:207], a[76:79], v[124:127], v[204:207]
v_exp_f32 v176, v176
v_mfma_f32_16x16x32_bf16 v[108:111], a[80:83], v[124:127], v[108:111]
v_mfma_f32_16x16x32_bf16 v[188:191], a[80:83], v[140:143], v[188:191]
v_exp_f32 v177, v177
v_mfma_f32_16x16x32_bf16 v[56:59], a[84:87], v[140:143], v[56:59]
v_cvt_pk_bf16_f32 v250, v176, v177
v_mfma_f32_16x16x32_bf16 v[40:43], a[84:87], v[124:127], v[40:43]
v_exp_f32 v178, v178
v_mfma_f32_16x16x32_bf16 v[80:83], a[88:91], v[124:127], v[80:83]
v_mfma_f32_16x16x32_bf16 v[88:91], a[88:91], v[140:143], v[88:91]
s_cmp_lt_u32 s72, s74
v_exp_f32 v179, v179
v_mfma_f32_16x16x32_bf16 v[192:195], a[92:95], v[140:143], v[192:195]
v_cvt_pk_bf16_f32 v251, v178, v179
v_mfma_f32_16x16x32_bf16 v[168:171], a[92:95], v[124:127], v[168:171]
s_waitcnt vmcnt(8) lgkmcnt(0)
v_exp_f32 v228, v228
v_mfma_f32_16x16x32_bf16 a[224:227], a[240:243], v[124:127], a[224:227]
v_mfma_f32_16x16x32_bf16 a[228:231], a[240:243], v[140:143], a[228:231]
s_cbranch_scc1 L_DUAL
L_DISP:
s_cmp_eq_u32 s72, s93
s_cbranch_scc1 L_STOP
L_NE:
s_mov_b32 s74, s93
s_cmp_gt_u32 s72, s66
s_cbranch_scc1 L_SINGLE
v_cndmask_b32 v96, v96, v6, s[56:57]
v_cndmask_b32 v120, v120, v6, s[56:57]
v_mov_b32 v112, v6
v_cndmask_b32 v97, v97, v6, s[58:59]
v_cndmask_b32 v121, v121, v6, s[58:59]
v_mov_b32 v113, v6
v_cndmask_b32 v98, v98, v6, s[60:61]
v_cndmask_b32 v122, v122, v6, s[60:61]
v_mov_b32 v114, v6
v_cndmask_b32 v99, v99, v6, s[62:63]
v_cndmask_b32 v123, v123, v6, s[62:63]
v_mov_b32 v115, v6
s_mov_b32 s74, 0
s_branch L_DUAL
L_STOP:
s_cmp_eq_u32 s72, 3
s_cbranch_scc1 L_E0
s_cmp_eq_u32 s72, 9
s_cbranch_scc1 L_E1
s_cmp_lg_u32 s72, 11
s_cbranch_scc1 L_SE
v_cmp_gt_u32 vcc, 32, v172
s_mov_b32 s73, 32
s_min_u32 s93, s73, s69
s_min_u32 s74, s93, s66
v_accvgpr_read_b32 v16, a244
v_accvgpr_read_b32 v17, a248
v_accvgpr_read_b32 v18, a252
s_cbranch_vccnz CK_Q
CK_Q_R:
buffer_load_dwordx4 a[244:247], v16, s[24:27], 0 offen sc1
buffer_load_dwordx4 a[248:251], v17, s[24:27], 0 offen sc1
buffer_load_dwordx4 a[252:255], v18, s[24:27], 0 offen sc1
s_add_u32 s53, s77, 163840
buffer_load_dwordx4 a[96:99], v15, s[24:27], s53 offen offset:0 sc1
buffer_load_dwordx4 a[100:103], v15, s[24:27], s53 offen offset:1024 sc1
buffer_load_dwordx4 a[104:107], v15, s[24:27], s53 offen offset:2048 sc1
buffer_load_dwordx4 a[108:111], v15, s[24:27], s53 offen offset:3072 sc1
s_cmp_lt_u32 s72, s66
s_cbranch_scc1 L_DUAL
s_mov_b32 s74, s93
s_cmp_gt_u32 s72, s66
s_cbranch_scc1 L_SINGLE
s_branch L_NE
L_E0:
buffer_atomic_add v1, v0, s[24:27], s89 offen offset:8 sc1
s_mov_b32 s73, 9
s_min_u32 s93, s73, s69
s_min_u32 s74, s93, s66
s_cmp_lt_u32 s72, s66
s_cbranch_scc1 L_DUAL
s_mov_b32 s74, s93
s_cmp_gt_u32 s72, s66
s_cbranch_scc1 L_SINGLE
s_branch L_NE
L_E1:
v_and_b32 v173, 31, v1
v_lshlrev_b32 v173, 10, v173
v_add_u32 v173, 75497992, v173
buffer_load_dword v172, v173, s[24:27], 0 offen sc1
s_mov_b32 s73, 11
s_cmp_lt_u32 s4, 16
s_cselect_b32 s52, s66, s67
s_and_b32 s53, s4, 15
s_lshl4_add_u32 s52, s52, s53
s_mul_i32 s52, s52, 2304
v_lshlrev_b32 v16, 2, v1
buffer_store_dwordx4 v[0:3], v4, s[44:47], s52 offen sc1
buffer_store_dwordx4 v[0:3], v4, s[44:47], s52 offen offset:1024 sc1
buffer_store_dword v0, v16, s[44:47], s52 offen offset:2048 sc1
s_min_u32 s93, s73, s69
s_min_u32 s74, s93, s66
s_cmp_lt_u32 s72, s66
s_cbranch_scc1 L_DUAL
s_mov_b32 s74, s93
s_cmp_gt_u32 s72, s66
s_cbranch_scc1 L_SINGLE
s_branch L_NE
L_SE:
s_lshr_b32 s52, s4, 3
s_mul_i32 s52, s52, 75776
s_add_u32 s52, s52, 54525952
s_and_b32 s53, s4, 7
s_mul_i32 s53, s53, 8192
s_add_u32 s52, s52, s53
s_mul_i32 s78, s66, 303104
s_add_u32 s78, s78, s52
s_mul_i32 s79, s67, 303104
s_add_u32 s79, s79, s52
s_mov_b32 s76, 0
v_mov_b32 v7, 0x5d800000
s_mov_b32 s69, 64
v_accvgpr_read_b32 v180, a224
v_accvgpr_read_b32 v182, a228
v_cmp_nle_f32 vcc, v180, v7
v_cmp_nle_f32 s[96:97], v182, v7
s_nop 3
s_or_b64 vcc, vcc, s[96:97]
s_cbranch_vccnz L_NS
s_add_u32 s53, s77, 180224
buffer_load_dwordx4 a[112:115], v15, s[24:27], s53 offen offset:0 sc1
v_mul_f32 v8, 0x3fb8aa3b, v8
v_mul_f32 v9, 0x3fb8aa3b, v9
v_exp_f32 v8, v8
v_exp_f32 v9, v9
s_nop 0
v_fma_f32 v180, v180, v8, v180
v_fma_f32 v182, v182, v9, v182
v_rcp_f32 v180, v180
v_rcp_f32 v182, v182
s_add_u32 s52, s78, 4096
v_mov_b32 v181, v180
v_mov_b32 v183, v182
v_pk_mul_f32 v[36:37], v[36:37], v[180:181]
v_pk_mul_f32 v[38:39], v[38:39], v[180:181]
v_pk_mul_f32 v[32:33], v[32:33], v[180:181]
v_pk_mul_f32 v[34:35], v[34:35], v[180:181]
v_cvt_pk_bf16_f32 v36, v36, v37
v_cvt_pk_bf16_f32 v37, v38, v39
v_cvt_pk_bf16_f32 v38, v32, v33
v_cvt_pk_bf16_f32 v39, v34, v35
buffer_store_dwordx4 v[36:39], v15, s[24:27], s78 offen offset:0 sc1
buffer_load_dwordx4 a[116:119], v15, s[24:27], s53 offen offset:1024 sc1
v_pk_mul_f32 v[116:117], v[116:117], v[182:183]
v_pk_mul_f32 v[118:119], v[118:119], v[182:183]
v_pk_mul_f32 v[132:133], v[132:133], v[182:183]
v_pk_mul_f32 v[134:135], v[134:135], v[182:183]
v_cvt_pk_bf16_f32 v116, v116, v117
v_cvt_pk_bf16_f32 v117, v118, v119
v_cvt_pk_bf16_f32 v118, v132, v133
v_cvt_pk_bf16_f32 v119, v134, v135
buffer_store_dwordx4 v[116:119], v15, s[24:27], s78 offen offset:1024 sc1
v_pk_mul_f32 v[196:197], v[196:197], v[180:181]
v_pk_mul_f32 v[198:199], v[198:199], v[180:181]
v_pk_mul_f32 v[204:205], v[204:205], v[180:181]
v_pk_mul_f32 v[206:207], v[206:207], v[180:181]
v_cvt_pk_bf16_f32 v196, v196, v197
v_cvt_pk_bf16_f32 v197, v198, v199
v_cvt_pk_bf16_f32 v198, v204, v205
v_cvt_pk_bf16_f32 v199, v206, v207
buffer_store_dwordx4 v[196:199], v15, s[24:27], s78 offen offset:2048 sc1
v_pk_mul_f32 v[184:185], v[184:185], v[182:183]
v_pk_mul_f32 v[186:187], v[186:187], v[182:183]
v_pk_mul_f32 v[240:241], v[240:241], v[182:183]
buffer_load_dwordx4 a[120:123], v15, s[24:27], s53 offen offset:2048 sc1
v_pk_mul_f32 v[242:243], v[242:243], v[182:183]
v_cvt_pk_bf16_f32 v184, v184, v185
v_cvt_pk_bf16_f32 v185, v186, v187
v_cvt_pk_bf16_f32 v186, v240, v241
v_cvt_pk_bf16_f32 v187, v242, v243
buffer_store_dwordx4 v[184:187], v15, s[24:27], s78 offen offset:3072 sc1
v_pk_mul_f32 v[108:109], v[108:109], v[180:181]
v_pk_mul_f32 v[110:111], v[110:111], v[180:181]
v_pk_mul_f32 v[40:41], v[40:41], v[180:181]
v_pk_mul_f32 v[42:43], v[42:43], v[180:181]
v_cvt_pk_bf16_f32 v108, v108, v109
v_cvt_pk_bf16_f32 v109, v110, v111
v_cvt_pk_bf16_f32 v110, v40, v41
v_cvt_pk_bf16_f32 v111, v42, v43
buffer_store_dwordx4 v[108:111], v15, s[24:27], s52 offen offset:0 sc1
v_pk_mul_f32 v[188:189], v[188:189], v[182:183]
v_pk_mul_f32 v[190:191], v[190:191], v[182:183]
v_pk_mul_f32 v[56:57], v[56:57], v[182:183]
v_pk_mul_f32 v[58:59], v[58:59], v[182:183]
v_cvt_pk_bf16_f32 v188, v188, v189
v_cvt_pk_bf16_f32 v189, v190, v191
buffer_load_dwordx4 a[124:127], v15, s[24:27], s53 offen offset:3072 sc1
v_cvt_pk_bf16_f32 v190, v56, v57
v_cvt_pk_bf16_f32 v191, v58, v59
buffer_store_dwordx4 v[188:191], v15, s[24:27], s52 offen offset:1024 sc1
v_pk_mul_f32 v[80:81], v[80:81], v[180:181]
v_pk_mul_f32 v[82:83], v[82:83], v[180:181]
v_pk_mul_f32 v[168:169], v[168:169], v[180:181]
v_pk_mul_f32 v[170:171], v[170:171], v[180:181]
v_cvt_pk_bf16_f32 v80, v80, v81
v_cvt_pk_bf16_f32 v81, v82, v83
v_cvt_pk_bf16_f32 v82, v168, v169
v_cvt_pk_bf16_f32 v83, v170, v171
buffer_store_dwordx4 v[80:83], v15, s[24:27], s52 offen offset:2048 sc1
v_pk_mul_f32 v[88:89], v[88:89], v[182:183]
v_pk_mul_f32 v[90:91], v[90:91], v[182:183]
v_pk_mul_f32 v[192:193], v[192:193], v[182:183]
v_pk_mul_f32 v[194:195], v[194:195], v[182:183]
v_cvt_pk_bf16_f32 v88, v88, v89
v_cvt_pk_bf16_f32 v89, v90, v91
v_cvt_pk_bf16_f32 v90, v192, v193
v_cvt_pk_bf16_f32 v91, v194, v195
buffer_store_dwordx4 v[88:91], v15, s[24:27], s52 offen offset:3072 sc1
L_PAD9:
s_cbranch_execz L_PAD13
s_mov_b32 s76, 1
L_NS:
s_mov_b32 s74, s73
s_mov_b32 s93, s73
s_cmp_eq_u32 s72, 32
s_cbranch_scc1 L_FIN
L_SINGLE:
v_mfma_f32_16x16x32_bf16 v[44:47], a[192:195], a[48:51], v[128:131]
s_barrier
v_mfma_f32_16x16x32_bf16 v[44:47], a[196:199], a[52:55], v[44:47]
s_cmp_eq_u32 s68, s71
v_exp_f32 v229, v229
v_mfma_f32_16x16x32_bf16 v[44:47], a[200:203], a[0:3], v[44:47]
s_cselect_b32 s64, s77, s68
v_add_u32 v5, s75, v4
v_cvt_pk_bf16_f32 v234, v228, v229
v_mfma_f32_16x16x32_bf16 v[44:47], a[204:207], a[8:11], v[44:47]
s_mov_b32 m0, s70
v_exp_f32 v230, v230
v_mfma_f32_16x16x32_bf16 v[52:55], a[192:195], a[60:63], v[136:139]
buffer_load_dwordx4 v15, s[24:27], s64 offen offset:0 sc1 lds
v_mfma_f32_16x16x32_bf16 v[52:55], a[196:199], a[56:59], v[52:55]
s_add_u32 s75, s75, 16384
v_exp_f32 v231, v231
v_mfma_f32_16x16x32_bf16 v[52:55], a[200:203], a[16:19], v[52:55]
ds_read_b128 a[192:195], v5 offset:0
v_cvt_pk_bf16_f32 v235, v230, v231
v_mfma_f32_16x16x32_bf16 v[52:55], a[204:207], a[24:27], v[52:55]
s_cmp_ge_u32 s75, 163840
v_exp_f32 v44, v44
v_mfma_f32_16x16x32_bf16 v[64:67], a[208:211], a[48:51], v[144:147]
ds_read_b128 a[196:199], v5 offset:1024
ds_read_b128 a[200:203], v5 offset:2048
v_mfma_f32_16x16x32_bf16 v[64:67], a[212:215], a[52:55], v[64:67]
s_cselect_b32 s75, 0, s75
v_exp_f32 v45, v45
v_mfma_f32_16x16x32_bf16 v[64:67], a[216:219], a[0:3], v[64:67]
ds_read_b128 a[204:207], v5 offset:3072
v_cvt_pk_bf16_f32 v124, v44, v45
v_mfma_f32_16x16x32_bf16 v[64:67], a[220:223], a[8:11], v[64:67]
s_add_u32 s68, s64, 16384
v_exp_f32 v46, v46
v_mfma_f32_16x16x32_bf16 v[212:215], a[208:211], a[60:63], v[152:155]
buffer_load_dwordx4 v15, s[24:27], s64 offen offset:1024 sc1 lds
v_mfma_f32_16x16x32_bf16 v[212:215], a[212:215], a[56:59], v[212:215]
s_add_u32 s70, s70, 16384
v_exp_f32 v47, v47
v_mfma_f32_16x16x32_bf16 v[212:215], a[216:219], a[16:19], v[212:215]
ds_read_b128 a[208:211], v5 offset:4096
v_cvt_pk_bf16_f32 v125, v46, v47
v_mfma_f32_16x16x32_bf16 v[212:215], a[220:223], a[24:27], v[212:215]
s_waitcnt lgkmcnt(5)
v_exp_f32 v52, v52
v_mfma_f32_16x16x32_bf16 v[60:63], a[64:67], v[248:251], v[60:63]
ds_read_b128 a[212:215], v5 offset:5120
ds_read_b128 a[216:219], v5 offset:6144
v_mfma_f32_16x16x32_bf16 v[148:151], a[64:67], v[232:235], v[148:151]
s_cmp_ge_u32 s70, 163840
v_exp_f32 v53, v53
v_mfma_f32_16x16x32_bf16 v[48:51], a[68:71], v[232:235], v[48:51]
ds_read_b128 a[220:223], v5 offset:7168
v_cvt_pk_bf16_f32 v140, v52, v53
v_mfma_f32_16x16x32_bf16 v[68:71], a[68:71], v[248:251], v[68:71]
s_cselect_b32 s70, s80, s70
v_exp_f32 v54, v54
v_mfma_f32_16x16x32_bf16 v[72:75], a[72:75], v[248:251], v[72:75]
buffer_load_dwordx4 v15, s[24:27], s64 offen offset:2048 sc1 lds
v_mfma_f32_16x16x32_bf16 v[236:239], a[72:75], v[232:235], v[236:239]
v_exp_f32 v55, v55
v_mfma_f32_16x16x32_bf16 v[224:227], a[76:79], v[232:235], v[224:227]
ds_read_b128 a[64:67], v5 offset:8192
v_cvt_pk_bf16_f32 v141, v54, v55
v_mfma_f32_16x16x32_bf16 v[220:223], a[76:79], v[248:251], v[220:223]
v_exp_f32 v64, v64
v_mfma_f32_16x16x32_bf16 v[84:87], a[80:83], v[248:251], v[84:87]
ds_read_b128 a[68:71], v5 offset:9216
ds_read_b128 a[72:75], v5 offset:10240
v_mfma_f32_16x16x32_bf16 v[164:167], a[80:83], v[232:235], v[164:167]
v_exp_f32 v65, v65
v_mfma_f32_16x16x32_bf16 v[156:159], a[84:87], v[232:235], v[156:159]
ds_read_b128 a[76:79], v5 offset:11264
v_cvt_pk_bf16_f32 v126, v64, v65
v_mfma_f32_16x16x32_bf16 v[76:79], a[84:87], v[248:251], v[76:79]
s_cmp_eq_u32 s68, s71
v_exp_f32 v66, v66
v_mfma_f32_16x16x32_bf16 v[160:163], a[88:91], v[248:251], v[160:163]
buffer_load_dwordx4 v15, s[24:27], s64 offen offset:3072 sc1 lds
v_mfma_f32_16x16x32_bf16 v[216:219], a[88:91], v[232:235], v[216:219]
s_cselect_b32 s64, s77, s68
v_exp_f32 v67, v67
v_mfma_f32_16x16x32_bf16 v[208:211], a[92:95], v[232:235], v[208:211]
ds_read_b128 a[80:83], v5 offset:12288
v_cvt_pk_bf16_f32 v127, v66, v67
v_mfma_f32_16x16x32_bf16 v[252:255], a[92:95], v[248:251], v[252:255]
s_waitcnt lgkmcnt(5)
v_exp_f32 v212, v212
v_mfma_f32_16x16x32_bf16 a[232:235], a[240:243], v[248:251], a[232:235]
ds_read_b128 a[84:87], v5 offset:13312
ds_read_b128 a[88:91], v5 offset:14336
v_mfma_f32_16x16x32_bf16 a[236:239], a[240:243], v[232:235], a[236:239]
s_mov_b32 m0, s70
ds_read_b128 a[92:95], v5 offset:15360
v_mfma_f32_16x16x32_bf16 v[100:103], a[192:195], a[48:51], v[128:131]
buffer_load_dwordx4 v15, s[24:27], s64 offen offset:0 sc1 lds
v_mfma_f32_16x16x32_bf16 v[100:103], a[196:199], a[52:55], v[100:103]
v_exp_f32 v213, v213
v_mfma_f32_16x16x32_bf16 v[100:103], a[200:203], a[0:3], v[100:103]
v_add_u32 v5, s75, v4
v_cvt_pk_bf16_f32 v142, v212, v213
v_mfma_f32_16x16x32_bf16 v[100:103], a[204:207], a[8:11], v[100:103]
v_exp_f32 v214, v214
v_mfma_f32_16x16x32_bf16 v[92:95], a[192:195], a[60:63], v[136:139]
buffer_load_dwordx4 v15, s[24:27], s64 offen offset:1024 sc1 lds
v_mfma_f32_16x16x32_bf16 v[92:95], a[196:199], a[56:59], v[92:95]
s_add_u32 s75, s75, 16384
v_exp_f32 v215, v215
v_mfma_f32_16x16x32_bf16 v[92:95], a[200:203], a[16:19], v[92:95]
ds_read_b128 a[192:195], v5 offset:0
v_cvt_pk_bf16_f32 v143, v214, v215
v_mfma_f32_16x16x32_bf16 v[92:95], a[204:207], a[24:27], v[92:95]
s_cmp_ge_u32 s75, 163840
v_exp_f32 v100, v100
v_mfma_f32_16x16x32_bf16 v[176:179], a[208:211], a[48:51], v[144:147]
ds_read_b128 a[196:199], v5 offset:1024
ds_read_b128 a[200:203], v5 offset:2048
v_mfma_f32_16x16x32_bf16 v[176:179], a[212:215], a[52:55], v[176:179]
s_cselect_b32 s75, 0, s75
v_exp_f32 v101, v101
v_mfma_f32_16x16x32_bf16 v[176:179], a[216:219], a[0:3], v[176:179]
ds_read_b128 a[204:207], v5 offset:3072
v_cvt_pk_bf16_f32 v248, v100, v101
v_mfma_f32_16x16x32_bf16 v[176:179], a[220:223], a[8:11], v[176:179]
s_add_u32 s68, s64, 16384
v_exp_f32 v102, v102
v_mfma_f32_16x16x32_bf16 v[228:231], a[208:211], a[60:63], v[152:155]
buffer_load_dwordx4 v15, s[24:27], s64 offen offset:2048 sc1 lds
v_mfma_f32_16x16x32_bf16 v[228:231], a[212:215], a[56:59], v[228:231]
s_add_u32 s70, s70, 16384
v_exp_f32 v103, v103
v_mfma_f32_16x16x32_bf16 v[228:231], a[216:219], a[16:19], v[228:231]
ds_read_b128 a[208:211], v5 offset:4096
v_cvt_pk_bf16_f32 v249, v102, v103
v_mfma_f32_16x16x32_bf16 v[228:231], a[220:223], a[24:27], v[228:231]
s_waitcnt lgkmcnt(5)
v_exp_f32 v92, v92
v_mfma_f32_16x16x32_bf16 v[60:63], a[64:67], v[124:127], v[60:63]
ds_read_b128 a[212:215], v5 offset:5120
ds_read_b128 a[216:219], v5 offset:6144
v_mfma_f32_16x16x32_bf16 v[148:151], a[64:67], v[140:143], v[148:151]
s_cmp_ge_u32 s70, 163840
v_exp_f32 v93, v93
v_mfma_f32_16x16x32_bf16 v[48:51], a[68:71], v[140:143], v[48:51]
ds_read_b128 a[220:223], v5 offset:7168
v_cvt_pk_bf16_f32 v232, v92, v93
v_mfma_f32_16x16x32_bf16 v[68:71], a[68:71], v[124:127], v[68:71]
s_cselect_b32 s70, s80, s70
v_exp_f32 v94, v94
v_mfma_f32_16x16x32_bf16 v[72:75], a[72:75], v[124:127], v[72:75]
buffer_load_dwordx4 v15, s[24:27], s64 offen offset:3072 sc1 lds
v_mfma_f32_16x16x32_bf16 v[236:239], a[72:75], v[140:143], v[236:239]
s_add_u32 s72, s72, 1
v_exp_f32 v95, v95
v_mfma_f32_16x16x32_bf16 v[224:227], a[76:79], v[140:143], v[224:227]
ds_read_b128 a[64:67], v5 offset:8192
v_cvt_pk_bf16_f32 v233, v94, v95
v_mfma_f32_16x16x32_bf16 v[220:223], a[76:79], v[124:127], v[220:223]
v_exp_f32 v176, v176
v_mfma_f32_16x16x32_bf16 v[84:87], a[80:83], v[124:127], v[84:87]
ds_read_b128 a[68:71], v5 offset:9216
ds_read_b128 a[72:75], v5 offset:10240
v_mfma_f32_16x16x32_bf16 v[164:167], a[80:83], v[140:143], v[164:167]
v_exp_f32 v177, v177
v_mfma_f32_16x16x32_bf16 v[156:159], a[84:87], v[140:143], v[156:159]
ds_read_b128 a[76:79], v5 offset:11264
v_cvt_pk_bf16_f32 v250, v176, v177
v_mfma_f32_16x16x32_bf16 v[76:79], a[84:87], v[124:127], v[76:79]
v_exp_f32 v178, v178
v_mfma_f32_16x16x32_bf16 v[160:163], a[88:91], v[124:127], v[160:163]
ds_read_b128 a[80:83], v5 offset:12288
ds_read_b128 a[84:87], v5 offset:13312
v_mfma_f32_16x16x32_bf16 v[216:219], a[88:91], v[140:143], v[216:219]
s_cmp_lt_u32 s72, s74
v_exp_f32 v179, v179
v_mfma_f32_16x16x32_bf16 v[208:211], a[92:95], v[140:143], v[208:211]
ds_read_b128 a[88:91], v5 offset:14336
v_cvt_pk_bf16_f32 v251, v178, v179
v_mfma_f32_16x16x32_bf16 v[252:255], a[92:95], v[124:127], v[252:255]
s_waitcnt vmcnt(8) lgkmcnt(7)
v_exp_f32 v228, v228
v_mfma_f32_16x16x32_bf16 a[232:235], a[240:243], v[124:127], a[232:235]
ds_read_b128 a[92:95], v5 offset:15360
v_mfma_f32_16x16x32_bf16 a[236:239], a[240:243], v[140:143], a[236:239]
s_cbranch_scc1 L_SINGLE
s_cmp_eq_u32 s72, s69
s_cbranch_scc1 L_SE
s_cmp_lt_u32 s72, 32
s_cbranch_scc1 L_STOP
L_FIN:
s_add_u32 s53, s77, 196608
buffer_load_dwordx4 a[160:163], v15, s[24:27], s53 offen offset:0 sc1
v_cndmask_b32 v128, v128, v6, s[56:57]
v_cndmask_b32 v152, v152, v6, s[56:57]
v_mov_b32 v144, v6
buffer_load_dwordx4 a[164:167], v15, s[24:27], s53 offen offset:1024 sc1
v_cndmask_b32 v129, v129, v6, s[58:59]
v_cndmask_b32 v153, v153, v6, s[58:59]
v_mov_b32 v145, v6
buffer_load_dwordx4 a[168:171], v15, s[24:27], s53 offen offset:2048 sc1
v_cndmask_b32 v130, v130, v6, s[60:61]
v_cndmask_b32 v154, v154, v6, s[60:61]
v_mov_b32 v146, v6
buffer_load_dwordx4 a[172:175], v15, s[24:27], s53 offen offset:3072 sc1
v_cndmask_b32 v131, v131, v6, s[62:63]
v_cndmask_b32 v155, v155, v6, s[62:63]
v_mov_b32 v147, v6
s_mov_b32 s83, s75
s_sub_u32 s91, s70, s80
v_mfma_f32_16x16x32_bf16 v[44:47], a[192:195], a[48:51], v[128:131]
s_barrier
v_mfma_f32_16x16x32_bf16 v[44:47], a[196:199], a[52:55], v[44:47]
s_mov_b32 m0, s70
v_exp_f32 v229, v229
v_mfma_f32_16x16x32_bf16 v[44:47], a[200:203], a[0:3], v[44:47]
s_mov_b32 s64, s68
v_add_u32 v5, s75, v4
v_cvt_pk_bf16_f32 v234, v228, v229
v_mfma_f32_16x16x32_bf16 v[44:47], a[204:207], a[8:11], v[44:47]
s_add_u32 s68, s68, 16384
v_exp_f32 v230, v230
v_mfma_f32_16x16x32_bf16 v[52:55], a[192:195], a[60:63], v[136:139]
buffer_load_dwordx4 v15, s[24:27], s64 offen offset:0 sc1 lds
v_mfma_f32_16x16x32_bf16 v[52:55], a[196:199], a[56:59], v[52:55]
s_add_u32 s70, s70, 16384
v_exp_f32 v231, v231
v_mfma_f32_16x16x32_bf16 v[52:55], a[200:203], a[16:19], v[52:55]
v_cvt_pk_bf16_f32 v235, v230, v231
v_mul_f32 v10, 0x3fb8aa3b, v10
v_mfma_f32_16x16x32_bf16 v[52:55], a[204:207], a[24:27], v[52:55]
s_cmp_ge_u32 s70, 163840
v_exp_f32 v44, v44
v_mfma_f32_16x16x32_bf16 v[64:67], a[208:211], a[48:51], v[144:147]
buffer_load_dwordx4 v15, s[24:27], s64 offen offset:1024 sc1 lds
v_mfma_f32_16x16x32_bf16 v[64:67], a[212:215], a[52:55], v[64:67]
s_cselect_b32 s70, s80, s70
v_exp_f32 v45, v45
v_mfma_f32_16x16x32_bf16 v[64:67], a[216:219], a[0:3], v[64:67]
v_cvt_pk_bf16_f32 v124, v44, v45
v_mul_f32 v11, 0x3fb8aa3b, v11
v_mfma_f32_16x16x32_bf16 v[64:67], a[220:223], a[8:11], v[64:67]
v_exp_f32 v46, v46
v_mfma_f32_16x16x32_bf16 v[212:215], a[208:211], a[60:63], v[152:155]
buffer_load_dwordx4 v15, s[24:27], s64 offen offset:2048 sc1 lds
v_mfma_f32_16x16x32_bf16 v[212:215], a[212:215], a[56:59], v[212:215]
v_exp_f32 v47, v47
v_mfma_f32_16x16x32_bf16 v[212:215], a[216:219], a[16:19], v[212:215]
v_cvt_pk_bf16_f32 v125, v46, v47
v_mfma_f32_16x16x32_bf16 v[212:215], a[220:223], a[24:27], v[212:215]
s_waitcnt lgkmcnt(0)
v_exp_f32 v52, v52
v_mfma_f32_16x16x32_bf16 v[60:63], a[64:67], v[248:251], v[60:63]
buffer_load_dwordx4 v15, s[24:27], s64 offen offset:3072 sc1 lds
v_mfma_f32_16x16x32_bf16 v[148:151], a[64:67], v[232:235], v[148:151]
s_mov_b32 m0, s70
v_exp_f32 v53, v53
v_mfma_f32_16x16x32_bf16 v[48:51], a[68:71], v[232:235], v[48:51]
s_mov_b32 s64, s68
ds_read_b128 a[64:67], v5 offset:8192
v_cvt_pk_bf16_f32 v140, v52, v53
v_mfma_f32_16x16x32_bf16 v[68:71], a[68:71], v[248:251], v[68:71]
s_add_u32 s68, s68, 16384
v_exp_f32 v54, v54
v_mfma_f32_16x16x32_bf16 v[72:75], a[72:75], v[248:251], v[72:75]
buffer_load_dwordx4 v15, s[24:27], s64 offen offset:0 sc1 lds
v_mfma_f32_16x16x32_bf16 v[236:239], a[72:75], v[232:235], v[236:239]
s_add_u32 s70, s70, 16384
v_exp_f32 v55, v55
v_mfma_f32_16x16x32_bf16 v[224:227], a[76:79], v[232:235], v[224:227]
ds_read_b128 a[68:71], v5 offset:9216
v_cvt_pk_bf16_f32 v141, v54, v55
v_mfma_f32_16x16x32_bf16 v[220:223], a[76:79], v[248:251], v[220:223]
s_cmp_ge_u32 s70, 163840
v_exp_f32 v64, v64
v_mfma_f32_16x16x32_bf16 v[84:87], a[80:83], v[248:251], v[84:87]
ds_read_b128 a[72:75], v5 offset:10240
v_mfma_f32_16x16x32_bf16 v[164:167], a[80:83], v[232:235], v[164:167]
s_cselect_b32 s70, s80, s70
v_exp_f32 v65, v65
v_mfma_f32_16x16x32_bf16 v[156:159], a[84:87], v[232:235], v[156:159]
ds_read_b128 a[76:79], v5 offset:11264
v_cvt_pk_bf16_f32 v126, v64, v65
v_mfma_f32_16x16x32_bf16 v[76:79], a[84:87], v[248:251], v[76:79]
v_exp_f32 v66, v66
v_mfma_f32_16x16x32_bf16 v[160:163], a[88:91], v[248:251], v[160:163]
buffer_load_dwordx4 v15, s[24:27], s64 offen offset:1024 sc1 lds
v_mfma_f32_16x16x32_bf16 v[216:219], a[88:91], v[232:235], v[216:219]
s_add_u32 s52, s79, 4096
v_exp_f32 v67, v67
v_mfma_f32_16x16x32_bf16 v[208:211], a[92:95], v[232:235], v[208:211]
ds_read_b128 a[80:83], v5 offset:12288
v_cvt_pk_bf16_f32 v127, v66, v67
v_mfma_f32_16x16x32_bf16 v[252:255], a[92:95], v[248:251], v[252:255]
v_exp_f32 v212, v212
v_mfma_f32_16x16x32_bf16 a[232:235], a[240:243], v[248:251], a[232:235]
ds_read_b128 a[84:87], v5 offset:13312
ds_read_b128 a[88:91], v5 offset:14336
v_mfma_f32_16x16x32_bf16 a[236:239], a[240:243], v[232:235], a[236:239]
ds_read_b128 a[92:95], v5 offset:15360
v_exp_f32 v213, v213
v_exp_f32 v214, v214
v_exp_f32 v215, v215
v_exp_f32 v10, v10
v_cvt_pk_bf16_f32 v142, v212, v213
v_cvt_pk_bf16_f32 v143, v214, v215
v_exp_f32 v11, v11
s_waitcnt lgkmcnt(0)
v_mfma_f32_16x16x32_bf16 a[232:235], a[240:243], v[124:127], a[232:235]
buffer_load_dwordx4 v15, s[24:27], s64 offen offset:2048 sc1 lds
v_mfma_f32_16x16x32_bf16 a[236:239], a[240:243], v[140:143], a[236:239]
s_barrier
v_mfma_f32_16x16x32_bf16 v[60:63], a[64:67], v[124:127], v[60:63]
v_cmp_eq_u32 vcc, 0, v3
v_mul_u32_u24 v244, 1536, v3
v_mfma_f32_16x16x32_bf16 v[148:151], a[64:67], v[140:143], v[148:151]
v_mov_b32 v246, 9728
v_cndmask_b32 v244, v244, v246, vcc
v_mfma_f32_16x16x32_bf16 v[48:51], a[68:71], v[140:143], v[48:51]
buffer_load_dwordx4 v15, s[24:27], s64 offen offset:3072 sc1 lds
v_mfma_f32_16x16x32_bf16 v[68:71], a[68:71], v[124:127], v[68:71]
v_lshl_add_u32 v247, v2, 4, s83
v_mov_b32 v246, 10496
v_mfma_f32_16x16x32_bf16 v[72:75], a[72:75], v[124:127], v[72:75]
v_accvgpr_read_b32 v180, a232
v_accvgpr_read_b32 v182, a236
v_mfma_f32_16x16x32_bf16 v[236:239], a[72:75], v[140:143], v[236:239]
v_cmp_nle_f32 vcc, v180, v7
v_cmp_nle_f32 s[96:97], v182, v7
v_mfma_f32_16x16x32_bf16 v[224:227], a[76:79], v[140:143], v[224:227]
v_fma_f32 v180, v180, v10, v180
v_fma_f32 v182, v182, v11, v182
v_mfma_f32_16x16x32_bf16 v[220:223], a[76:79], v[124:127], v[220:223]
v_rcp_f32 v180, v180
v_mfma_f32_16x16x32_bf16 v[84:87], a[80:83], v[124:127], v[84:87]
s_or_b64 vcc, vcc, s[96:97]
v_rcp_f32 v182, v182
v_mfma_f32_16x16x32_bf16 v[164:167], a[80:83], v[140:143], v[164:167]
v_mul_f32 v60, v180, v60
v_mul_f32 v61, v180, v61
v_mfma_f32_16x16x32_bf16 v[156:159], a[84:87], v[140:143], v[156:159]
v_mul_f32 v62, v180, v62
v_mul_f32 v63, v180, v63
v_mfma_f32_16x16x32_bf16 v[76:79], a[84:87], v[124:127], v[76:79]
v_mul_f32 v68, v180, v68
v_mul_f32 v69, v180, v69
v_mfma_f32_16x16x32_bf16 v[160:163], a[88:91], v[124:127], v[160:163]
v_mul_f32 v70, v180, v70
v_mul_f32 v71, v180, v71
v_mfma_f32_16x16x32_bf16 v[216:219], a[88:91], v[140:143], v[216:219]
v_cvt_pk_bf16_f32 v60, v60, v61
v_cvt_pk_bf16_f32 v61, v62, v63
v_mfma_f32_16x16x32_bf16 v[208:211], a[92:95], v[140:143], v[208:211]
v_cvt_pk_bf16_f32 v62, v68, v69
v_cvt_pk_bf16_f32 v63, v70, v71
v_mfma_f32_16x16x32_bf16 v[252:255], a[92:95], v[124:127], v[252:255]
s_cbranch_vccnz SLOW1
L_EP:
buffer_store_dwordx4 v[60:63], v15, s[24:27], s79 offen offset:0 sc1
v_pk_mul_f32 v[148:149], v[148:149], v[182:183] op_sel_hi:[1,0]
v_pk_mul_f32 v[150:151], v[150:151], v[182:183] op_sel_hi:[1,0]
v_pk_mul_f32 v[48:49], v[48:49], v[182:183] op_sel_hi:[1,0]
v_pk_mul_f32 v[50:51], v[50:51], v[182:183] op_sel_hi:[1,0]
v_cvt_pk_bf16_f32 v148, v148, v149
v_cvt_pk_bf16_f32 v149, v150, v151
v_cvt_pk_bf16_f32 v150, v48, v49
v_cvt_pk_bf16_f32 v151, v50, v51
buffer_store_dwordx4 v[148:151], v15, s[24:27], s79 offen offset:1024 sc1
v_pk_mul_f32 v[72:73], v[72:73], v[180:181] op_sel_hi:[1,0]
v_pk_mul_f32 v[74:75], v[74:75], v[180:181] op_sel_hi:[1,0]
v_pk_mul_f32 v[220:221], v[220:221], v[180:181] op_sel_hi:[1,0]
v_pk_mul_f32 v[222:223], v[222:223], v[180:181] op_sel_hi:[1,0]
v_cvt_pk_bf16_f32 v72, v72, v73
v_cvt_pk_bf16_f32 v73, v74, v75
v_cvt_pk_bf16_f32 v74, v220, v221
v_cvt_pk_bf16_f32 v75, v222, v223
buffer_store_dwordx4 v[72:75], v15, s[24:27], s79 offen offset:2048 sc1
v_pk_mul_f32 v[236:237], v[236:237], v[182:183] op_sel_hi:[1,0]
v_pk_mul_f32 v[238:239], v[238:239], v[182:183] op_sel_hi:[1,0]
v_pk_mul_f32 v[224:225], v[224:225], v[182:183] op_sel_hi:[1,0]
v_pk_mul_f32 v[226:227], v[226:227], v[182:183] op_sel_hi:[1,0]
v_cvt_pk_bf16_f32 v236, v236, v237
v_cvt_pk_bf16_f32 v237, v238, v239
v_cvt_pk_bf16_f32 v238, v224, v225
v_cvt_pk_bf16_f32 v239, v226, v227
buffer_store_dwordx4 v[236:239], v15, s[24:27], s79 offen offset:3072 sc1
v_pk_mul_f32 v[84:85], v[84:85], v[180:181] op_sel_hi:[1,0]
v_pk_mul_f32 v[86:87], v[86:87], v[180:181] op_sel_hi:[1,0]
v_pk_mul_f32 v[76:77], v[76:77], v[180:181] op_sel_hi:[1,0]
v_pk_mul_f32 v[78:79], v[78:79], v[180:181] op_sel_hi:[1,0]
v_cvt_pk_bf16_f32 v84, v84, v85
v_cvt_pk_bf16_f32 v85, v86, v87
v_cvt_pk_bf16_f32 v86, v76, v77
v_cvt_pk_bf16_f32 v87, v78, v79
buffer_store_dwordx4 v[84:87], v15, s[24:27], s52 offen offset:0 sc1
v_pk_mul_f32 v[164:165], v[164:165], v[182:183] op_sel_hi:[1,0]
v_pk_mul_f32 v[166:167], v[166:167], v[182:183] op_sel_hi:[1,0]
v_pk_mul_f32 v[156:157], v[156:157], v[182:183] op_sel_hi:[1,0]
v_pk_mul_f32 v[158:159], v[158:159], v[182:183] op_sel_hi:[1,0]
v_cvt_pk_bf16_f32 v164, v164, v165
v_cvt_pk_bf16_f32 v165, v166, v167
v_cvt_pk_bf16_f32 v166, v156, v157
v_cvt_pk_bf16_f32 v167, v158, v159
buffer_store_dwordx4 v[164:167], v15, s[24:27], s52 offen offset:1024 sc1
v_pk_mul_f32 v[160:161], v[160:161], v[180:181] op_sel_hi:[1,0]
v_pk_mul_f32 v[162:163], v[162:163], v[180:181] op_sel_hi:[1,0]
v_pk_mul_f32 v[252:253], v[252:253], v[180:181] op_sel_hi:[1,0]
v_pk_mul_f32 v[254:255], v[254:255], v[180:181] op_sel_hi:[1,0]
v_cvt_pk_bf16_f32 v160, v160, v161
v_cvt_pk_bf16_f32 v161, v162, v163
v_cvt_pk_bf16_f32 v162, v252, v253
v_cvt_pk_bf16_f32 v163, v254, v255
buffer_store_dwordx4 v[160:163], v15, s[24:27], s52 offen offset:2048 sc1
v_pk_mul_f32 v[216:217], v[216:217], v[182:183] op_sel_hi:[1,0]
v_pk_mul_f32 v[218:219], v[218:219], v[182:183] op_sel_hi:[1,0]
v_pk_mul_f32 v[208:209], v[208:209], v[182:183] op_sel_hi:[1,0]
v_pk_mul_f32 v[210:211], v[210:211], v[182:183] op_sel_hi:[1,0]
v_cvt_pk_bf16_f32 v216, v216, v217
v_cvt_pk_bf16_f32 v217, v218, v219
v_cvt_pk_bf16_f32 v218, v208, v209
v_cvt_pk_bf16_f32 v219, v210, v211
buffer_store_dwordx4 v[216:219], v15, s[24:27], s52 offen offset:3072 sc1
v_cmp_eq_u32 vcc, 3, v3
v_mul_u32_u24 v200, 768, v3
v_add_u32 v200, v200, v247
ds_write_b128 v200, a[244:247] offset:0
v_cndmask_b32 v245, v244, v246, vcc
ds_write_b128 v200, a[248:251] offset:3072
v_add_u32 v247, -1280, v247
ds_write_b128 v200, a[252:255] offset:6144
v_add_u32 v244, v244, v247
v_add_u32 v245, v245, v247
ds_write_b128 v244, a[128:131] offset:0
v_cmp_lt_u32 vcc, 31, v1
ds_write_b128 v245, a[132:135] offset:768
v_and_b32 v202, 31, v1
ds_write_b128 v244, a[136:139] offset:256
v_mov_b32 v200, s66
ds_write_b128 v245, a[140:143] offset:1024
v_mov_b32 v203, s67
ds_write_b128 v244, a[144:147] offset:3840
v_cndmask_b32 v200, v200, v203, vcc
ds_write_b128 v245, a[148:151] offset:4608
v_lshl_add_u32 v200, v200, 5, v202
ds_write_b128 v244, a[152:155] offset:4096
v_lshrrev_b32 v201, 5, v1
ds_write_b128 v245, a[156:159] offset:4864
v_mul_u32_u24 v201, 3840, v201
v_lshl_add_u32 v201, v202, 4, v201
v_add_u32 v201, s83, v201
s_cmp_eq_u32 s76, 0
s_cbranch_scc1 L_SE2
L_LA:
v_mov_b32 v5, v200
v_mov_b32 v6, v201
v_mov_b32 v13, 0
s_lshl_b32 s74, s66, 10
s_lshr_b32 s52, s4, 3
s_lshl_b32 s52, s52, 7
s_add_u32 s74, s74, s52
s_add_u32 s74, s74, 75497472
ds_read_b128 v[16:19], v6 offset:8448
ds_read_b128 v[20:23], v6 offset:9216
ds_read_b128 v[96:99], v6 offset:3328
ds_read_b128 v[32:35], v6 offset:256
ds_read_b128 v[36:39], v6 offset:1024
ds_read_b128 v[100:103], v6 offset:3296
ds_read_b128 v[40:43], v6 offset:224
ds_read_b128 v[44:47], v6 offset:992
ds_read_b128 v[104:107], v6 offset:3264
ds_read_b128 v[48:51], v6 offset:192
ds_read_b128 v[52:55], v6 offset:960
ds_read_b128 v[108:111], v6 offset:3232
ds_read_b128 v[56:59], v6 offset:160
ds_read_b128 v[60:63], v6 offset:928
ds_read_b128 v[112:115], v6 offset:3200
ds_read_b128 v[64:67], v6 offset:128
ds_read_b128 v[68:71], v6 offset:896
ds_read_b128 v[116:119], v6 offset:3168
ds_read_b128 v[72:75], v6 offset:96
ds_read_b128 v[76:79], v6 offset:864
ds_read_b128 v[120:123], v6 offset:3136
ds_read_b128 v[80:83], v6 offset:64
ds_read_b128 v[84:87], v6 offset:832
ds_read_b128 v[124:127], v6 offset:3104
ds_read_b128 v[88:91], v6 offset:32
ds_read_b128 v[92:95], v6 offset:800
ds_read_b128 v[128:131], v6 offset:1792
ds_read_b128 v[132:135], v6 offset:2560
s_waitcnt vmcnt(0)
buffer_atomic_add v1, v0, s[24:27], s74 offen offset:0 sc1
ds_read_b128 v[136:139], v6 offset:1760
ds_read_b128 v[140:143], v6 offset:2528
ds_read_b128 v[144:147], v6 offset:1728
ds_read_b128 v[148:151], v6 offset:2496
ds_read_b128 v[152:155], v6 offset:1696
ds_read_b128 v[156:159], v6 offset:2464
ds_read_b128 v[160:163], v6 offset:1664
ds_read_b128 v[164:167], v6 offset:2432
ds_read_b128 v[168:171], v6 offset:1632
ds_read_b128 v[172:175], v6 offset:2400
ds_read_b128 v[176:179], v6 offset:1600
ds_read_b128 v[180:183], v6 offset:2368
ds_read_b128 v[184:187], v6 offset:1568
ds_read_b128 v[188:191], v6 offset:2336
s_lshr_b32 s52, s3, 1
s_lshl1_add_u32 s72, s85, s52
s_lshl3_add_u32 s75, s72, s84
s_lshl_b32 s75, s75, 7
s_add_u32 s75, s75, 75497472
s_and_b32 s82, s86, 1
s_lshl_b32 s82, s82, 13
s_lshr_b32 s53, s4, 3
s_mul_i32 s53, s53, 75776
s_add_u32 s53, s53, 54525952
s_and_b32 s52, s3, 1
s_lshl_b32 s52, s52, 10
s_add_u32 s52, s52, s53
s_sub_u32 s54, 63, s72
s_mul_i32 s77, s72, 303104
s_add_u32 s77, s77, s52
s_mul_i32 s81, s54, 303104
s_add_u32 s81, s81, s52
s_add_u32 s91, s91, 114688
s_sub_u32 s52, s91, 163840
s_cmp_ge_u32 s91, 163840
s_cselect_b32 s91, s52, s91
v_add_u32 v14, 4096, v15
v_add_u32 v7, s91, v4
s_waitcnt lgkmcnt(0)
s_barrier
s_mov_b32 m0, s70
s_mov_b32 s64, s68
s_add_u32 s68, s68, 16384
s_add_u32 s70, s70, 16384
s_cmp_ge_u32 s70, 163840
s_cselect_b32 s70, s80, s70
buffer_load_dwordx4 v15, s[24:27], s64 offen offset:0 sc1 lds
v_and_b32 v9, 0xffff, v97
v_and_b32 v11, 0xffff0000, v97
v_dot2_f32_bf16 v24, v98, v99, 0
v_dot2_f32_bf16 v25, v102, v99, 0
v_dot2_f32_bf16 v26, v106, v99, 0
v_dot2_f32_bf16 v27, v110, v99, 0
v_dot2_f32_bf16 v28, v114, v99, 0
v_dot2_f32_bf16 v29, v118, v99, 0
v_dot2_f32_bf16 v30, v122, v99, 0
v_dot2_f32_bf16 v31, v126, v99, 0
v_dot2c_f32_bf16 v24, v96, v9
v_dot2c_f32_bf16 v25, v100, v9
v_dot2c_f32_bf16 v26, v104, v9
v_dot2c_f32_bf16 v27, v108, v9
v_dot2c_f32_bf16 v28, v112, v9
v_dot2c_f32_bf16 v29, v116, v9
buffer_load_dwordx4 v15, s[24:27], s64 offen offset:1024 sc1 lds
v_dot2c_f32_bf16 v30, v120, v9
v_dot2c_f32_bf16 v31, v124, v9
v_dot2c_f32_bf16 v24, v16, v32
v_dot2c_f32_bf16 v25, v16, v40
v_dot2c_f32_bf16 v26, v16, v48
v_dot2c_f32_bf16 v27, v16, v56
v_dot2c_f32_bf16 v28, v16, v64
v_dot2c_f32_bf16 v29, v16, v72
v_dot2c_f32_bf16 v30, v16, v80
v_dot2c_f32_bf16 v31, v16, v88
v_dot2c_f32_bf16 v24, v17, v33
v_dot2c_f32_bf16 v25, v17, v41
v_dot2c_f32_bf16 v26, v17, v49
v_dot2c_f32_bf16 v27, v17, v57
v_dot2c_f32_bf16 v28, v17, v65
v_dot2c_f32_bf16 v29, v17, v73
buffer_load_dwordx4 v15, s[24:27], s64 offen offset:2048 sc1 lds
v_dot2c_f32_bf16 v30, v17, v81
v_dot2c_f32_bf16 v31, v17, v89
v_dot2c_f32_bf16 v24, v18, v34
v_dot2c_f32_bf16 v25, v18, v42
v_dot2c_f32_bf16 v26, v18, v50
v_dot2c_f32_bf16 v27, v18, v58
v_dot2c_f32_bf16 v28, v18, v66
v_dot2c_f32_bf16 v29, v18, v74
v_dot2c_f32_bf16 v30, v18, v82
v_dot2c_f32_bf16 v31, v18, v90
v_dot2c_f32_bf16 v24, v19, v35
v_dot2c_f32_bf16 v25, v19, v43
v_dot2c_f32_bf16 v26, v19, v51
v_dot2c_f32_bf16 v27, v19, v59
v_dot2c_f32_bf16 v28, v19, v67
v_dot2c_f32_bf16 v29, v19, v75
buffer_load_dwordx4 v15, s[24:27], s64 offen offset:3072 sc1 lds
v_dot2c_f32_bf16 v30, v19, v83
v_dot2c_f32_bf16 v31, v19, v91
v_dot2c_f32_bf16 v24, v20, v36
v_dot2c_f32_bf16 v25, v20, v44
v_dot2c_f32_bf16 v26, v20, v52
v_dot2c_f32_bf16 v27, v20, v60
v_dot2c_f32_bf16 v28, v20, v68
v_dot2c_f32_bf16 v29, v20, v76
v_dot2c_f32_bf16 v30, v20, v84
v_dot2c_f32_bf16 v31, v20, v92
v_dot2c_f32_bf16 v24, v21, v37
v_dot2c_f32_bf16 v25, v21, v45
v_dot2c_f32_bf16 v26, v21, v53
v_dot2c_f32_bf16 v27, v21, v61
v_dot2c_f32_bf16 v28, v21, v69
v_dot2c_f32_bf16 v29, v21, v77
s_mov_b32 m0, s70
s_mov_b32 s64, s68
s_add_u32 s68, s68, 16384
s_add_u32 s70, s70, 16384
s_cmp_ge_u32 s70, 163840
s_cselect_b32 s70, s80, s70
buffer_load_dwordx4 v15, s[24:27], s64 offen offset:0 sc1 lds
v_dot2c_f32_bf16 v30, v21, v85
v_dot2c_f32_bf16 v31, v21, v93
v_dot2c_f32_bf16 v24, v22, v38
v_dot2c_f32_bf16 v25, v22, v46
v_dot2c_f32_bf16 v26, v22, v54
v_dot2c_f32_bf16 v27, v22, v62
v_dot2c_f32_bf16 v28, v22, v70
v_dot2c_f32_bf16 v29, v22, v78
L_PAD10:
s_cbranch_execz L_MAIN
v_dot2c_f32_bf16 v30, v22, v86
v_dot2c_f32_bf16 v31, v22, v94
v_dot2c_f32_bf16 v24, v23, v39
v_dot2c_f32_bf16 v25, v23, v47
v_dot2c_f32_bf16 v26, v23, v55
v_dot2c_f32_bf16 v27, v23, v63
v_dot2c_f32_bf16 v28, v23, v71
v_dot2c_f32_bf16 v29, v23, v79
buffer_load_dwordx4 v15, s[24:27], s64 offen offset:1024 sc1 lds
v_dot2c_f32_bf16 v30, v23, v87
v_dot2c_f32_bf16 v31, v23, v95
v_mov_b32 v9, 0xf149f2ca
v_mul_f32 v11, 0xbfb8aa3b, v11
v_exp_f32 v11, v11
v_cmp_gt_u32 vcc, 2, v5
v_cmp_gt_u32 s[56:57], 4, v5
s_nop 0
v_cndmask_b32 v25, v25, v9, vcc
v_cndmask_b32 v26, v26, v9, s[56:57]
v_cmp_gt_u32 vcc, 6, v5
v_cmp_gt_u32 s[56:57], 8, v5
s_nop 0
v_cndmask_b32 v27, v27, v9, vcc
v_cndmask_b32 v28, v28, v9, s[56:57]
v_cmp_gt_u32 vcc, 10, v5
buffer_load_dwordx4 v15, s[24:27], s64 offen offset:2048 sc1 lds
v_cmp_gt_u32 s[56:57], 12, v5
s_nop 0
v_cndmask_b32 v29, v29, v9, vcc
v_cndmask_b32 v30, v30, v9, s[56:57]
v_cmp_gt_u32 vcc, 14, v5
s_nop 0
s_nop 0
v_cndmask_b32 v31, v31, v9, vcc
v_max3_f32 v10, v24, v25, v26
v_max3_f32 v10, v10, v27, v28
v_max3_f32 v10, v10, v29, v30
v_max_f32 v10, v10, v31
s_mov_b32 s52, 0x3eae1a93
v_sub_f32 v24, v24, v10
v_sub_f32 v25, v25, v10
v_sub_f32 v26, v26, v10
buffer_load_dwordx4 v15, s[24:27], s64 offen offset:3072 sc1 lds
v_sub_f32 v27, v27, v10
v_sub_f32 v28, v28, v10
v_sub_f32 v29, v29, v10
v_sub_f32 v30, v30, v10
v_sub_f32 v31, v31, v10
v_mul_f32 v24, s52, v24
v_mul_f32 v25, s52, v25
v_mul_f32 v26, s52, v26
v_mul_f32 v27, s52, v27
v_mul_f32 v28, s52, v28
v_mul_f32 v29, s52, v29
v_mul_f32 v30, s52, v30
v_mul_f32 v31, s52, v31
v_exp_f32 v24, v24
v_exp_f32 v25, v25
v_exp_f32 v26, v26
s_mov_b32 m0, s70
s_mov_b32 s64, s68
s_add_u32 s68, s68, 16384
s_add_u32 s70, s70, 16384
s_cmp_ge_u32 s70, 163840
s_cselect_b32 s70, s80, s70
buffer_load_dwordx4 v15, s[24:27], s64 offen offset:0 sc1 lds
v_exp_f32 v27, v27
v_exp_f32 v28, v28
v_exp_f32 v29, v29
v_exp_f32 v30, v30
v_exp_f32 v31, v31
v_cvt_pk_bf16_f32 v32, v24, 0
v_cvt_pk_bf16_f32 v40, v25, 0
v_cvt_pk_bf16_f32 v48, v26, 0
v_cvt_pk_bf16_f32 v56, v27, 0
v_cvt_pk_bf16_f32 v64, v28, 0
v_cvt_pk_bf16_f32 v72, v29, 0
v_cvt_pk_bf16_f32 v80, v30, 0
v_cvt_pk_bf16_f32 v88, v31, 0
v_lshlrev_b32 v33, 16, v32
v_lshlrev_b32 v41, 16, v40
v_lshlrev_b32 v49, 16, v48
buffer_load_dwordx4 v15, s[24:27], s64 offen offset:1024 sc1 lds
v_lshlrev_b32 v57, 16, v56
v_lshlrev_b32 v65, 16, v64
v_lshlrev_b32 v73, 16, v72
v_lshlrev_b32 v81, 16, v80
v_lshlrev_b32 v89, 16, v88
v_add_f32 v10, v33, v41
v_add_f32 v10, v10, v49
v_add_f32 v10, v10, v57
v_add_f32 v10, v10, v65
v_add_f32 v10, v10, v73
v_add_f32 v10, v10, v81
v_add_f32 v10, v10, v89
v_fmac_f32 v10, v10, v11
v_rcp_f32 v10, v10
v_dot2_f32_bf16 v192, v128, v32, 0
v_dot2_f32_bf16 v193, v128, v33, 0
buffer_load_dwordx4 v15, s[24:27], s64 offen offset:2048 sc1 lds
v_dot2_f32_bf16 v194, v129, v32, 0
v_dot2_f32_bf16 v195, v129, v33, 0
v_dot2_f32_bf16 v196, v130, v32, 0
v_dot2_f32_bf16 v197, v130, v33, 0
v_dot2_f32_bf16 v198, v131, v32, 0
v_dot2_f32_bf16 v199, v131, v33, 0
v_dot2_f32_bf16 v200, v132, v32, 0
v_dot2_f32_bf16 v201, v132, v33, 0
v_dot2_f32_bf16 v202, v133, v32, 0
v_dot2_f32_bf16 v203, v133, v33, 0
v_dot2_f32_bf16 v204, v134, v32, 0
v_dot2_f32_bf16 v205, v134, v33, 0
v_dot2_f32_bf16 v206, v135, v32, 0
v_dot2_f32_bf16 v207, v135, v33, 0
v_dot2_f32_bf16 v208, v96, v33, 0
v_dot2_f32_bf16 v209, v98, v33, 0
buffer_load_dwordx4 v15, s[24:27], s64 offen offset:3072 sc1 lds
v_dot2c_f32_bf16 v192, v136, v40
v_dot2c_f32_bf16 v193, v136, v41
v_dot2c_f32_bf16 v194, v137, v40
v_dot2c_f32_bf16 v195, v137, v41
v_dot2c_f32_bf16 v196, v138, v40
v_dot2c_f32_bf16 v197, v138, v41
v_dot2c_f32_bf16 v198, v139, v40
v_dot2c_f32_bf16 v199, v139, v41
v_dot2c_f32_bf16 v200, v140, v40
v_dot2c_f32_bf16 v201, v140, v41
v_dot2c_f32_bf16 v202, v141, v40
v_dot2c_f32_bf16 v203, v141, v41
v_dot2c_f32_bf16 v204, v142, v40
v_dot2c_f32_bf16 v205, v142, v41
v_dot2c_f32_bf16 v206, v143, v40
v_dot2c_f32_bf16 v207, v143, v41
s_mov_b32 m0, s70
s_mov_b32 s64, s68
s_add_u32 s68, s68, 16384
s_add_u32 s70, s70, 16384
s_cmp_ge_u32 s70, 163840
s_cselect_b32 s70, s80, s70
buffer_load_dwordx4 v15, s[24:27], s64 offen offset:0 sc1 lds
v_dot2c_f32_bf16 v208, v100, v41
v_dot2c_f32_bf16 v209, v102, v41
v_dot2c_f32_bf16 v192, v144, v48
v_dot2c_f32_bf16 v193, v144, v49
v_dot2c_f32_bf16 v194, v145, v48
v_dot2c_f32_bf16 v195, v145, v49
v_dot2c_f32_bf16 v196, v146, v48
v_dot2c_f32_bf16 v197, v146, v49
v_dot2c_f32_bf16 v198, v147, v48
v_dot2c_f32_bf16 v199, v147, v49
v_dot2c_f32_bf16 v200, v148, v48
v_dot2c_f32_bf16 v201, v148, v49
v_dot2c_f32_bf16 v202, v149, v48
v_dot2c_f32_bf16 v203, v149, v49
v_dot2c_f32_bf16 v204, v150, v48
v_dot2c_f32_bf16 v205, v150, v49
buffer_load_dwordx4 v15, s[24:27], s64 offen offset:1024 sc1 lds
v_dot2c_f32_bf16 v206, v151, v48
v_dot2c_f32_bf16 v207, v151, v49
v_dot2c_f32_bf16 v208, v104, v49
v_dot2c_f32_bf16 v209, v106, v49
v_dot2c_f32_bf16 v192, v152, v56
v_dot2c_f32_bf16 v193, v152, v57
v_dot2c_f32_bf16 v194, v153, v56
v_dot2c_f32_bf16 v195, v153, v57
v_dot2c_f32_bf16 v196, v154, v56
v_dot2c_f32_bf16 v197, v154, v57
v_dot2c_f32_bf16 v198, v155, v56
v_dot2c_f32_bf16 v199, v155, v57
v_dot2c_f32_bf16 v200, v156, v56
v_dot2c_f32_bf16 v201, v156, v57
v_dot2c_f32_bf16 v202, v157, v56
v_dot2c_f32_bf16 v203, v157, v57
buffer_load_dwordx4 v15, s[24:27], s64 offen offset:2048 sc1 lds
v_dot2c_f32_bf16 v204, v158, v56
v_dot2c_f32_bf16 v205, v158, v57
v_dot2c_f32_bf16 v206, v159, v56
v_dot2c_f32_bf16 v207, v159, v57
v_dot2c_f32_bf16 v208, v108, v57
v_dot2c_f32_bf16 v209, v110, v57
v_dot2c_f32_bf16 v192, v160, v64
v_dot2c_f32_bf16 v193, v160, v65
v_dot2c_f32_bf16 v194, v161, v64
v_dot2c_f32_bf16 v195, v161, v65
v_dot2c_f32_bf16 v196, v162, v64
v_dot2c_f32_bf16 v197, v162, v65
v_dot2c_f32_bf16 v198, v163, v64
v_dot2c_f32_bf16 v199, v163, v65
v_dot2c_f32_bf16 v200, v164, v64
v_dot2c_f32_bf16 v201, v164, v65
buffer_load_dword v12, v13, s[24:27], s75 offen sc1
v_dot2c_f32_bf16 v202, v165, v64
v_dot2c_f32_bf16 v203, v165, v65
v_dot2c_f32_bf16 v204, v166, v64
v_dot2c_f32_bf16 v205, v166, v65
v_dot2c_f32_bf16 v206, v167, v64
v_dot2c_f32_bf16 v207, v167, v65
v_dot2c_f32_bf16 v208, v112, v65
v_dot2c_f32_bf16 v209, v114, v65
v_dot2c_f32_bf16 v192, v168, v72
v_dot2c_f32_bf16 v193, v168, v73
v_dot2c_f32_bf16 v194, v169, v72
v_dot2c_f32_bf16 v195, v169, v73
v_dot2c_f32_bf16 v196, v170, v72
v_dot2c_f32_bf16 v197, v170, v73
v_dot2c_f32_bf16 v198, v171, v72
v_dot2c_f32_bf16 v199, v171, v73
buffer_load_dwordx4 v15, s[24:27], s64 offen offset:3072 sc1 lds
v_dot2c_f32_bf16 v200, v172, v72
v_dot2c_f32_bf16 v201, v172, v73
v_dot2c_f32_bf16 v202, v173, v72
v_dot2c_f32_bf16 v203, v173, v73
v_dot2c_f32_bf16 v204, v174, v72
v_dot2c_f32_bf16 v205, v174, v73
v_dot2c_f32_bf16 v206, v175, v72
v_dot2c_f32_bf16 v207, v175, v73
v_dot2c_f32_bf16 v208, v116, v73
v_dot2c_f32_bf16 v209, v118, v73
v_dot2c_f32_bf16 v192, v176, v80
v_dot2c_f32_bf16 v193, v176, v81
v_dot2c_f32_bf16 v194, v177, v80
v_dot2c_f32_bf16 v195, v177, v81
v_dot2c_f32_bf16 v196, v178, v80
v_dot2c_f32_bf16 v197, v178, v81
s_mov_b32 m0, s70
s_mov_b32 s64, s68
s_add_u32 s68, s68, 16384
s_add_u32 s70, s70, 16384
s_cmp_ge_u32 s70, 163840
s_cselect_b32 s70, s80, s70
buffer_load_dwordx4 v15, s[24:27], s64 offen offset:0 sc1 lds
v_dot2c_f32_bf16 v198, v179, v80
v_dot2c_f32_bf16 v199, v179, v81
v_dot2c_f32_bf16 v200, v180, v80
v_dot2c_f32_bf16 v201, v180, v81
v_dot2c_f32_bf16 v202, v181, v80
v_dot2c_f32_bf16 v203, v181, v81
v_dot2c_f32_bf16 v204, v182, v80
v_dot2c_f32_bf16 v205, v182, v81
v_dot2c_f32_bf16 v206, v183, v80
v_dot2c_f32_bf16 v207, v183, v81
v_dot2c_f32_bf16 v208, v120, v81
v_dot2c_f32_bf16 v209, v122, v81
v_dot2c_f32_bf16 v192, v184, v88
v_dot2c_f32_bf16 v193, v184, v89
v_dot2c_f32_bf16 v194, v185, v88
v_dot2c_f32_bf16 v195, v185, v89
buffer_load_dwordx4 v15, s[24:27], s64 offen offset:1024 sc1 lds
v_dot2c_f32_bf16 v196, v186, v88
v_dot2c_f32_bf16 v197, v186, v89
v_dot2c_f32_bf16 v198, v187, v88
v_dot2c_f32_bf16 v199, v187, v89
v_dot2c_f32_bf16 v200, v188, v88
v_dot2c_f32_bf16 v201, v188, v89
v_dot2c_f32_bf16 v202, v189, v88
v_dot2c_f32_bf16 v203, v189, v89
v_dot2c_f32_bf16 v204, v190, v88
v_dot2c_f32_bf16 v205, v190, v89
v_dot2c_f32_bf16 v206, v191, v88
v_dot2c_f32_bf16 v207, v191, v89
v_dot2c_f32_bf16 v208, v124, v89
v_dot2c_f32_bf16 v209, v126, v89
v_lshrrev_b32 v9, 5, v5
v_mul_u32_u24 v9, 303104, v9
buffer_load_dwordx4 v15, s[24:27], s64 offen offset:2048 sc1 lds
v_and_b32 v11, 1, v3
v_lshl_add_u32 v9, v11, 10, v9
v_lshl_add_u32 v9, v2, 4, v9
v_lshrrev_b32 v11, 3, v2
s_bitcmp0_b32 s4, 0
s_cselect_b32 s52, 100663168, 0
v_mul_lo_u32 v6, v11, s52
v_add_u32 v6, v6, v9
s_bitcmp1_b32 s4, 2
s_cselect_b32 s52, 100663168, 0
v_mul_lo_u32 v11, v11, s52
v_add_u32 v11, v11, v9
v_mul_f32 v192, v10, v192
v_mul_f32 v193, v10, v193
v_mul_f32 v194, v10, v194
v_mul_f32 v195, v10, v195
v_mul_f32 v196, v10, v196
v_mul_f32 v197, v10, v197
buffer_load_dwordx4 v15, s[24:27], s64 offen offset:3072 sc1 lds
v_mul_f32 v198, v10, v198
v_mul_f32 v199, v10, v199
v_mul_f32 v200, v10, v200
v_mul_f32 v201, v10, v201
v_mul_f32 v202, v10, v202
v_mul_f32 v203, v10, v203
v_mul_f32 v204, v10, v204
v_mul_f32 v205, v10, v205
v_mul_f32 v206, v10, v206
v_mul_f32 v207, v10, v207
v_mul_f32 v208, v10, v208
v_mul_f32 v209, v10, v209
v_cvt_pk_bf16_f32 v192, v192, v193
v_cvt_pk_bf16_f32 v193, v194, v195
v_cvt_pk_bf16_f32 v194, v196, v197
v_cvt_pk_bf16_f32 v195, v198, v199
v_cvt_pk_bf16_f32 v196, v200, v201
v_cvt_pk_bf16_f32 v197, v202, v203
v_cvt_pk_bf16_f32 v198, v204, v205
v_cvt_pk_bf16_f32 v199, v206, v207
v_cvt_pk_bf16_f32 v200, v208, v209
s_add_u32 s53, s53, 65536
s_bfe_u32 s54, s4, 131073
s_lshl_b32 s54, s54, 11
s_add_u32 s54, s54, s53
s_and_b32 s55, s4, 1
s_lshl_b32 s55, s55, 9
s_add_u32 s54, s54, s55
s_lshl2_add_u32 s52, s85, s86
s_lshl2_add_u32 s69, s52, s3
s_mul_i32 s69, s69, 28672
s_add_u32 s69, s69, 76546048
s_lshr_b32 s73, s52, 1
s_lshl_b32 s73, s73, 10
s_and_b32 s52, s52, 1
s_lshl_b32 s52, s52, 7
s_add_u32 s73, s73, s52
s_lshl2_add_u32 s73, s3, s73
s_add_u32 s73, s73, 75498112
ds_read_b128 v[144:147], v7 offset:0
ds_read_b128 v[148:151], v7 offset:1024
ds_read_b128 v[152:155], v7 offset:2048
ds_read_b128 v[156:159], v7 offset:3072
ds_read_b128 v[160:163], v7 offset:4096
ds_read_b128 v[164:167], v7 offset:5120
ds_read_b128 v[168:171], v7 offset:6144
ds_read_b128 v[172:175], v7 offset:7168
v_mov_b32 v10, 0
s_waitcnt vmcnt(5)
v_cmp_gt_u32 vcc, 8, v12
s_mov_b32 s92, 0
s_nop 3
s_cbranch_vccz L_ZBX
L_ZB:
s_sleep 2
buffer_load_dword v12, v13, s[24:27], s75 offen sc1
s_add_u32 s92, s92, 1
s_waitcnt vmcnt(0)
v_cmp_gt_u32 vcc, 8, v12
s_cmp_gt_u32 s92, 1048576
s_cbranch_scc1 L_ZBX
s_nop 2
s_cbranch_vccnz L_ZB
L_ZBX:
s_xor_b32 s65, s82, 0
s_add_u32 s65, s65, s77
buffer_load_dwordx4 a[0:3], v15, s[24:27], s65 offen offset:0 sc1
buffer_load_dwordx4 a[8:11], v15, s[24:27], s65 offen offset:2048 sc1
s_xor_b32 s93, s82, 0
s_add_u32 s93, s93, s81
buffer_load_dwordx4 a[4:7], v15, s[24:27], s93 offen offset:0 sc1
buffer_load_dwordx4 a[12:15], v15, s[24:27], s93 offen offset:2048 sc1
buffer_load_dwordx4 a[16:19], v14, s[24:27], s65 offen offset:0 sc1
buffer_load_dwordx4 a[24:27], v14, s[24:27], s65 offen offset:2048 sc1
buffer_load_dwordx4 a[20:23], v14, s[24:27], s93 offen offset:0 sc1
buffer_load_dwordx4 a[28:31], v14, s[24:27], s93 offen offset:2048 sc1
buffer_store_dwordx4 v[192:195], v9, s[24:27], s54 offen sc1
buffer_store_dwordx4 v[196:199], v6, s[24:27], s54 offen offset:256 sc1
s_bfe_u32 s55, s4, 65538
s_lshl_b32 s55, s55, 8
s_add_u32 s54, s53, s55
s_and_b32 s55, s4, 3
s_lshl2_add_u32 s54, s55, s54
s_add_u32 s54, s54, 8192
buffer_store_dword v200, v11, s[24:27], s54 offen sc1
s_waitcnt vmcnt(9) lgkmcnt(6)
v_mfma_f32_16x16x32_bf16 v[120:123], v[144:147], a[0:3], 0
s_waitcnt vmcnt(7)
s_add_u32 s91, s91, 16384
ds_read_b128 v[176:179], v7 offset:8192
v_mfma_f32_16x16x32_bf16 v[120:123], v[148:151], a[8:11], v[120:123]
s_xor_b32 s65, s82, 8192
s_add_u32 s65, s65, s77
ds_read_b128 v[180:183], v7 offset:9216
v_mfma_f32_16x16x32_bf16 v[124:127], v[148:151], a[12:15], 0
s_waitcnt lgkmcnt(6)
ds_read_b128 v[184:187], v7 offset:10240
v_mfma_f32_16x16x32_bf16 v[124:127], v[144:147], a[4:7], v[124:127]
buffer_load_dwordx4 a[32:35], v15, s[24:27], s65 offen offset:0 sc1
v_mfma_f32_16x16x32_bf16 v[72:75], v[152:155], a[0:3], 0
s_cmp_ge_u32 s91, 163840
s_cselect_b32 s91, 0, s91
ds_read_b128 v[188:191], v7 offset:11264
v_mfma_f32_16x16x32_bf16 v[72:75], v[156:159], a[8:11], v[72:75]
s_waitcnt lgkmcnt(6)
v_add_u32 v8, s91, v4
v_mfma_f32_16x16x32_bf16 v[76:79], v[156:159], a[12:15], 0
buffer_load_dwordx4 a[40:43], v15, s[24:27], s65 offen offset:2048 sc1
v_mfma_f32_16x16x32_bf16 v[76:79], v[152:155], a[4:7], v[76:79]
s_xor_b32 s93, s82, 8192
s_add_u32 s93, s93, s81
ds_read_b128 v[144:147], v7 offset:12288
v_mfma_f32_16x16x32_bf16 v[80:83], v[160:163], a[0:3], 0
ds_read_b128 v[148:151], v7 offset:13312
v_mfma_f32_16x16x32_bf16 v[80:83], v[164:167], a[8:11], v[80:83]
buffer_load_dwordx4 a[36:39], v15, s[24:27], s93 offen offset:0 sc1
v_mfma_f32_16x16x32_bf16 v[84:87], v[164:167], a[12:15], 0
ds_read_b128 v[152:155], v7 offset:14336
v_mfma_f32_16x16x32_bf16 v[84:87], v[160:163], a[4:7], v[84:87]
s_waitcnt lgkmcnt(7)
v_mfma_f32_16x16x32_bf16 v[88:91], v[168:171], a[0:3], 0
buffer_load_dwordx4 a[44:47], v15, s[24:27], s93 offen offset:2048 sc1
v_mfma_f32_16x16x32_bf16 v[88:91], v[172:175], a[8:11], v[88:91]
ds_read_b128 v[156:159], v7 offset:15360
v_mfma_f32_16x16x32_bf16 v[92:95], v[172:175], a[12:15], 0
s_waitcnt lgkmcnt(6)
s_add_u32 s91, s91, 16384
ds_read_b128 v[160:163], v8 offset:0
v_mfma_f32_16x16x32_bf16 v[92:95], v[168:171], a[4:7], v[92:95]
buffer_load_dwordx4 a[48:51], v14, s[24:27], s65 offen offset:0 sc1
v_mfma_f32_16x16x32_bf16 v[96:99], v[176:179], a[0:3], 0
s_cmp_ge_u32 s91, 163840
s_cselect_b32 s91, 0, s91
ds_read_b128 v[164:167], v8 offset:1024
v_mfma_f32_16x16x32_bf16 v[96:99], v[180:183], a[8:11], v[96:99]
v_add_u32 v7, s91, v4
v_mfma_f32_16x16x32_bf16 v[100:103], v[180:183], a[12:15], 0
buffer_load_dwordx4 a[56:59], v14, s[24:27], s65 offen offset:2048 sc1
v_mfma_f32_16x16x32_bf16 v[100:103], v[176:179], a[4:7], v[100:103]
s_waitcnt lgkmcnt(6)
ds_read_b128 v[168:171], v8 offset:2048
v_mfma_f32_16x16x32_bf16 v[104:107], v[184:187], a[0:3], 0
ds_read_b128 v[172:175], v8 offset:3072
v_mfma_f32_16x16x32_bf16 v[104:107], v[188:191], a[8:11], v[104:107]
v_mfma_f32_16x16x32_bf16 v[108:111], v[188:191], a[12:15], 0
buffer_load_dwordx4 a[52:55], v14, s[24:27], s93 offen offset:0 sc1
v_mfma_f32_16x16x32_bf16 v[108:111], v[184:187], a[4:7], v[108:111]
s_waitcnt lgkmcnt(6)
ds_read_b128 v[176:179], v8 offset:4096
v_mfma_f32_16x16x32_bf16 v[112:115], v[144:147], a[0:3], 0
ds_read_b128 v[180:183], v8 offset:5120
v_mfma_f32_16x16x32_bf16 v[112:115], v[148:151], a[8:11], v[112:115]
v_mfma_f32_16x16x32_bf16 v[116:119], v[148:151], a[12:15], 0
buffer_load_dwordx4 a[60:63], v14, s[24:27], s93 offen offset:2048 sc1
v_mfma_f32_16x16x32_bf16 v[116:119], v[144:147], a[4:7], v[116:119]
s_waitcnt lgkmcnt(6) vmcnt(13)
ds_read_b128 v[184:187], v8 offset:6144
v_mfma_f32_16x16x32_bf16 v[120:123], v[152:155], a[16:19], v[120:123]
ds_read_b128 v[188:191], v8 offset:7168
v_mfma_f32_16x16x32_bf16 v[120:123], v[156:159], a[24:27], v[120:123]
s_waitcnt vmcnt(11)
v_mfma_f32_16x16x32_bf16 v[124:127], v[156:159], a[28:31], v[124:127]
ds_read_b128 v[144:147], v8 offset:8192
v_mfma_f32_16x16x32_bf16 v[124:127], v[152:155], a[20:23], v[124:127]
s_waitcnt lgkmcnt(7)
v_mfma_f32_16x16x32_bf16 v[72:75], v[160:163], a[16:19], v[72:75]
ds_read_b128 v[148:151], v8 offset:9216
v_mfma_f32_16x16x32_bf16 v[72:75], v[164:167], a[24:27], v[72:75]
v_mfma_f32_16x16x32_bf16 v[76:79], v[164:167], a[28:31], v[76:79]
ds_read_b128 v[152:155], v8 offset:10240
v_mfma_f32_16x16x32_bf16 v[76:79], v[160:163], a[20:23], v[76:79]
s_waitcnt lgkmcnt(7)
v_mfma_f32_16x16x32_bf16 v[80:83], v[168:171], a[16:19], v[80:83]
ds_read_b128 v[156:159], v8 offset:11264
v_mfma_f32_16x16x32_bf16 v[80:83], v[172:175], a[24:27], v[80:83]
v_mfma_f32_16x16x32_bf16 v[84:87], v[172:175], a[28:31], v[84:87]
ds_read_b128 v[160:163], v8 offset:12288
v_mfma_f32_16x16x32_bf16 v[84:87], v[168:171], a[20:23], v[84:87]
s_waitcnt lgkmcnt(7)
v_mfma_f32_16x16x32_bf16 v[88:91], v[176:179], a[16:19], v[88:91]
s_xor_b32 s65, s82, 16384
s_add_u32 s65, s65, s77
ds_read_b128 v[164:167], v8 offset:13312
v_mfma_f32_16x16x32_bf16 v[88:91], v[180:183], a[24:27], v[88:91]
v_mfma_f32_16x16x32_bf16 v[92:95], v[180:183], a[28:31], v[92:95]
s_waitcnt lgkmcnt(6)
ds_read_b128 v[168:171], v8 offset:14336
v_add_u32 v11, s70, v4
v_mfma_f32_16x16x32_bf16 v[92:95], v[176:179], a[20:23], v[92:95]
s_add_u32 s70, s70, 16384
s_cmp_ge_u32 s70, 163840
s_cselect_b32 s70, s80, s70
v_mfma_f32_16x16x32_bf16 v[96:99], v[184:187], a[16:19], v[96:99]
buffer_load_dwordx4 a[64:67], v15, s[24:27], s65 offen offset:0 sc1
v_mfma_f32_16x16x32_bf16 v[96:99], v[188:191], a[24:27], v[96:99]
s_barrier
v_mfma_f32_16x16x32_bf16 v[100:103], v[188:191], a[28:31], v[100:103]
s_waitcnt lgkmcnt(5)
ds_read_b128 v[172:175], v8 offset:15360
v_mfma_f32_16x16x32_bf16 v[100:103], v[184:187], a[20:23], v[100:103]
buffer_load_dwordx4 a[72:75], v15, s[24:27], s65 offen offset:2048 sc1
v_mfma_f32_16x16x32_bf16 v[104:107], v[144:147], a[16:19], v[104:107]
ds_write_b64 v11, a[96:97] offset:0
v_mfma_f32_16x16x32_bf16 v[104:107], v[148:151], a[24:27], v[104:107]
s_xor_b32 s93, s82, 16384
s_add_u32 s93, s93, s81
ds_read_b128 v[176:179], v7 offset:0
v_mfma_f32_16x16x32_bf16 v[108:111], v[148:151], a[28:31], v[108:111]
buffer_load_dwordx4 a[68:71], v15, s[24:27], s93 offen offset:0 sc1
v_mfma_f32_16x16x32_bf16 v[108:111], v[144:147], a[20:23], v[108:111]
s_waitcnt lgkmcnt(6)
s_add_u32 s91, s91, 16384
ds_read_b128 v[180:183], v7 offset:1024
v_mfma_f32_16x16x32_bf16 v[112:115], v[152:155], a[16:19], v[112:115]
ds_write_b64 v11, a[98:99] offset:8
v_mfma_f32_16x16x32_bf16 v[112:115], v[156:159], a[24:27], v[112:115]
s_cmp_ge_u32 s91, 163840
s_cselect_b32 s91, 0, s91
ds_read_b128 v[184:187], v7 offset:2048
v_mfma_f32_16x16x32_bf16 v[116:119], v[156:159], a[28:31], v[116:119]
buffer_load_dwordx4 a[76:79], v15, s[24:27], s93 offen offset:2048 sc1
v_mfma_f32_16x16x32_bf16 v[116:119], v[152:155], a[20:23], v[116:119]
s_waitcnt lgkmcnt(7) vmcnt(10)
ds_read_b128 v[188:191], v7 offset:3072
v_add_u32 v8, s91, v4
v_mfma_f32_16x16x32_bf16 v[120:123], v[160:163], a[32:35], v[120:123]
s_waitcnt vmcnt(12)
s_waitcnt vmcnt(8)
ds_read_b128 v[144:147], v7 offset:4096
v_mfma_f32_16x16x32_bf16 v[120:123], v[164:167], a[40:43], v[120:123]
buffer_atomic_add v1, v0, s[24:27], s74 offen offset:4 sc1
v_mfma_f32_16x16x32_bf16 v[124:127], v[164:167], a[44:47], v[124:127]
ds_write_b64 v11, a[100:101] offset:1024
v_mfma_f32_16x16x32_bf16 v[124:127], v[160:163], a[36:39], v[124:127]
s_waitcnt lgkmcnt(8)
ds_read_b128 v[148:151], v7 offset:5120
v_mfma_f32_16x16x32_bf16 v[72:75], v[168:171], a[32:35], v[72:75]
ds_read_b128 v[152:155], v7 offset:6144
v_mfma_f32_16x16x32_bf16 v[72:75], v[172:175], a[40:43], v[72:75]
s_waitcnt lgkmcnt(7)
ds_read_b128 v[156:159], v7 offset:7168
v_mfma_f32_16x16x32_bf16 v[76:79], v[172:175], a[44:47], v[76:79]
ds_write_b64 v11, a[102:103] offset:1032
v_mfma_f32_16x16x32_bf16 v[76:79], v[168:171], a[36:39], v[76:79]
buffer_load_dwordx4 a[80:83], v14, s[24:27], s65 offen offset:0 sc1
v_mfma_f32_16x16x32_bf16 v[80:83], v[176:179], a[32:35], v[80:83]
ds_read_b128 v[160:163], v7 offset:8192
v_mfma_f32_16x16x32_bf16 v[80:83], v[180:183], a[40:43], v[80:83]
s_waitcnt lgkmcnt(7)
ds_read_b128 v[164:167], v7 offset:9216
v_mfma_f32_16x16x32_bf16 v[84:87], v[180:183], a[44:47], v[84:87]
ds_write_b64 v11, a[104:105] offset:2048
v_mfma_f32_16x16x32_bf16 v[84:87], v[176:179], a[36:39], v[84:87]
buffer_load_dwordx4 a[88:91], v14, s[24:27], s65 offen offset:2048 sc1
v_mfma_f32_16x16x32_bf16 v[88:91], v[184:187], a[32:35], v[88:91]
ds_read_b128 v[168:171], v7 offset:10240
v_mfma_f32_16x16x32_bf16 v[88:91], v[188:191], a[40:43], v[88:91]
s_waitcnt lgkmcnt(7)
ds_read_b128 v[172:175], v7 offset:11264
v_mfma_f32_16x16x32_bf16 v[92:95], v[188:191], a[44:47], v[92:95]
ds_write_b64 v11, a[106:107] offset:2056
v_mfma_f32_16x16x32_bf16 v[92:95], v[184:187], a[36:39], v[92:95]
buffer_load_dwordx4 a[84:87], v14, s[24:27], s93 offen offset:0 sc1
v_mfma_f32_16x16x32_bf16 v[96:99], v[144:147], a[32:35], v[96:99]
ds_read_b128 v[176:179], v7 offset:12288
v_mfma_f32_16x16x32_bf16 v[96:99], v[148:151], a[40:43], v[96:99]
s_waitcnt lgkmcnt(8)
ds_read_b128 v[180:183], v7 offset:13312
v_mfma_f32_16x16x32_bf16 v[100:103], v[148:151], a[44:47], v[100:103]
ds_write_b64 v11, a[108:109] offset:3072
v_mfma_f32_16x16x32_bf16 v[100:103], v[144:147], a[36:39], v[100:103]
buffer_load_dwordx4 a[92:95], v14, s[24:27], s93 offen offset:2048 sc1
v_mfma_f32_16x16x32_bf16 v[104:107], v[152:155], a[32:35], v[104:107]
ds_read_b128 v[184:187], v7 offset:14336
v_mfma_f32_16x16x32_bf16 v[104:107], v[156:159], a[40:43], v[104:107]
ds_read_b128 v[188:191], v7 offset:15360
v_mfma_f32_16x16x32_bf16 v[108:111], v[156:159], a[44:47], v[108:111]
ds_write_b64 v11, a[110:111] offset:3080
v_mfma_f32_16x16x32_bf16 v[108:111], v[152:155], a[36:39], v[108:111]
s_waitcnt lgkmcnt(10)
s_add_u32 s91, s91, 16384
ds_read_b128 v[144:147], v8 offset:0
v_mfma_f32_16x16x32_bf16 v[112:115], v[160:163], a[32:35], v[112:115]
s_xor_b32 s65, s82, 24576
s_add_u32 s65, s65, s77
ds_read_b128 v[148:151], v8 offset:1024
v_mfma_f32_16x16x32_bf16 v[112:115], v[164:167], a[40:43], v[112:115]
s_cmp_ge_u32 s91, 163840
s_cselect_b32 s91, 0, s91
v_add_u32 v7, s91, v4
v_mfma_f32_16x16x32_bf16 v[116:119], v[164:167], a[44:47], v[116:119]
buffer_load_dwordx4 a[192:195], v15, s[24:27], s65 offen offset:0 sc1
v_mfma_f32_16x16x32_bf16 v[116:119], v[160:163], a[36:39], v[116:119]
s_waitcnt lgkmcnt(9) vmcnt(12)
ds_read_b128 v[152:155], v8 offset:2048
v_mfma_f32_16x16x32_bf16 v[120:123], v[168:171], a[48:51], v[120:123]
ds_read_b128 v[156:159], v8 offset:3072
v_mfma_f32_16x16x32_bf16 v[120:123], v[172:175], a[56:59], v[120:123]
s_waitcnt vmcnt(10)
v_mfma_f32_16x16x32_bf16 v[124:127], v[172:175], a[60:63], v[124:127]
buffer_load_dwordx4 a[200:203], v15, s[24:27], s65 offen offset:2048 sc1
v_mfma_f32_16x16x32_bf16 v[124:127], v[168:171], a[52:55], v[124:127]
s_waitcnt lgkmcnt(8)
ds_read_b128 v[160:163], v8 offset:4096
v_mfma_f32_16x16x32_bf16 v[72:75], v[176:179], a[48:51], v[72:75]
s_xor_b32 s93, s82, 24576
s_add_u32 s93, s93, s81
ds_read_b128 v[164:167], v8 offset:5120
v_mfma_f32_16x16x32_bf16 v[72:75], v[180:183], a[56:59], v[72:75]
v_mfma_f32_16x16x32_bf16 v[76:79], v[180:183], a[60:63], v[76:79]
buffer_load_dwordx4 a[196:199], v15, s[24:27], s93 offen offset:0 sc1
v_mfma_f32_16x16x32_bf16 v[76:79], v[176:179], a[52:55], v[76:79]
s_waitcnt lgkmcnt(7)
ds_read_b128 v[168:171], v8 offset:6144
v_mfma_f32_16x16x32_bf16 v[80:83], v[184:187], a[48:51], v[80:83]
ds_read_b128 v[172:175], v8 offset:7168
v_mfma_f32_16x16x32_bf16 v[80:83], v[188:191], a[56:59], v[80:83]
v_mfma_f32_16x16x32_bf16 v[84:87], v[188:191], a[60:63], v[84:87]
buffer_load_dwordx4 a[204:207], v15, s[24:27], s93 offen offset:2048 sc1
v_mfma_f32_16x16x32_bf16 v[84:87], v[184:187], a[52:55], v[84:87]
s_waitcnt lgkmcnt(6)
ds_read_b128 v[176:179], v8 offset:8192
v_mfma_f32_16x16x32_bf16 v[88:91], v[144:147], a[48:51], v[88:91]
ds_read_b128 v[180:183], v8 offset:9216
v_mfma_f32_16x16x32_bf16 v[88:91], v[148:151], a[56:59], v[88:91]
v_mfma_f32_16x16x32_bf16 v[92:95], v[148:151], a[60:63], v[92:95]
ds_read_b128 v[184:187], v8 offset:10240
v_mfma_f32_16x16x32_bf16 v[92:95], v[144:147], a[52:55], v[92:95]
s_waitcnt lgkmcnt(7)
v_mfma_f32_16x16x32_bf16 v[96:99], v[152:155], a[48:51], v[96:99]
s_add_u32 s52, s84, 1
ds_read_b128 v[188:191], v8 offset:11264
v_mfma_f32_16x16x32_bf16 v[96:99], v[156:159], a[56:59], v[96:99]
v_mfma_f32_16x16x32_bf16 v[100:103], v[156:159], a[60:63], v[100:103]
buffer_load_dwordx4 a[208:211], v14, s[24:27], s65 offen offset:0 sc1
v_mfma_f32_16x16x32_bf16 v[100:103], v[152:155], a[52:55], v[100:103]
s_and_b32 s52, s52, 3
s_waitcnt lgkmcnt(6)
ds_read_b128 v[144:147], v8 offset:12288
v_mfma_f32_16x16x32_bf16 v[104:107], v[160:163], a[48:51], v[104:107]
ds_read_b128 v[148:151], v8 offset:13312
v_mfma_f32_16x16x32_bf16 v[104:107], v[164:167], a[56:59], v[104:107]
s_waitcnt lgkmcnt(6)
v_mfma_f32_16x16x32_bf16 v[108:111], v[164:167], a[60:63], v[108:111]
s_mul_i32 s52, s52, 6144
ds_read_b128 v[152:155], v8 offset:14336
v_add_u32 v11, s70, v4
v_mfma_f32_16x16x32_bf16 v[108:111], v[160:163], a[52:55], v[108:111]
s_add_u32 s70, s70, 16384
s_cmp_ge_u32 s70, 163840
s_cselect_b32 s70, s80, s70
v_mfma_f32_16x16x32_bf16 v[112:115], v[168:171], a[48:51], v[112:115]
s_waitcnt vmcnt(50)
ds_read_b128 v[156:159], v8 offset:15360
v_mfma_f32_16x16x32_bf16 v[112:115], v[172:175], a[56:59], v[112:115]
s_barrier
v_mfma_f32_16x16x32_bf16 v[116:119], v[172:175], a[60:63], v[116:119]
s_add_u32 s52, s52, s69
s_waitcnt lgkmcnt(6) vmcnt(12)
ds_read_b128 v[160:163], v7 offset:0
v_mfma_f32_16x16x32_bf16 v[116:119], v[168:171], a[52:55], v[116:119]
buffer_load_dwordx4 a[216:219], v14, s[24:27], s65 offen offset:2048 sc1
v_mfma_f32_16x16x32_bf16 v[120:123], v[176:179], a[64:67], v[120:123]
ds_write_b64 v11, a[112:113] offset:0
v_mfma_f32_16x16x32_bf16 v[120:123], v[180:183], a[72:75], v[120:123]
s_add_u32 s52, s52, 0
s_waitcnt vmcnt(11)
ds_read_b128 v[164:167], v7 offset:1024
v_mfma_f32_16x16x32_bf16 v[124:127], v[180:183], a[76:79], v[124:127]
buffer_load_dwordx4 a[212:215], v14, s[24:27], s93 offen offset:0 sc1
v_mfma_f32_16x16x32_bf16 v[124:127], v[176:179], a[68:71], v[124:127]
s_waitcnt lgkmcnt(7)
s_add_u32 s91, s91, 16384
ds_read_b128 v[168:171], v7 offset:2048
v_mfma_f32_16x16x32_bf16 v[72:75], v[184:187], a[64:67], v[72:75]
s_add_u32 s53, s84, 2
ds_read_b128 v[172:175], v7 offset:3072
v_mfma_f32_16x16x32_bf16 v[72:75], v[188:191], a[72:75], v[72:75]
ds_write_b64 v11, a[114:115] offset:8
v_mfma_f32_16x16x32_bf16 v[76:79], v[188:191], a[76:79], v[76:79]
buffer_load_dwordx4 a[220:223], v14, s[24:27], s93 offen offset:2048 sc1
v_mfma_f32_16x16x32_bf16 v[76:79], v[184:187], a[68:71], v[76:79]
s_and_b32 s53, s53, 3
s_waitcnt lgkmcnt(8)
ds_read_b128 v[176:179], v7 offset:4096
v_mfma_f32_16x16x32_bf16 v[80:83], v[144:147], a[64:67], v[80:83]
s_xor_b32 s65, s82, 32768
s_add_u32 s65, s65, s77
ds_read_b128 v[180:183], v7 offset:5120
v_mfma_f32_16x16x32_bf16 v[80:83], v[148:151], a[72:75], v[80:83]
L_PAD11:
s_cbranch_execz L_MAIN
ds_write_b64 v11, a[116:117] offset:1024
v_mfma_f32_16x16x32_bf16 v[84:87], v[148:151], a[76:79], v[84:87]
s_mul_i32 s53, s53, 6144
s_waitcnt lgkmcnt(9)
ds_read_b128 v[184:187], v7 offset:6144
v_mfma_f32_16x16x32_bf16 v[84:87], v[144:147], a[68:71], v[84:87]
buffer_load_dwordx4 a[224:227], v15, s[24:27], s65 offen offset:0 sc1
v_mfma_f32_16x16x32_bf16 v[88:91], v[152:155], a[64:67], v[88:91]
s_cmp_ge_u32 s91, 163840
s_cselect_b32 s91, 0, s91
ds_read_b128 v[188:191], v7 offset:7168
v_mfma_f32_16x16x32_bf16 v[88:91], v[156:159], a[72:75], v[88:91]
s_add_u32 s53, s53, s69
s_waitcnt lgkmcnt(8)
v_add_u32 v8, s91, v4
v_mfma_f32_16x16x32_bf16 v[92:95], v[156:159], a[76:79], v[92:95]
ds_write_b64 v11, a[118:119] offset:1032
v_mfma_f32_16x16x32_bf16 v[92:95], v[152:155], a[68:71], v[92:95]
buffer_load_dwordx4 a[232:235], v15, s[24:27], s65 offen offset:2048 sc1
v_mfma_f32_16x16x32_bf16 v[96:99], v[160:163], a[64:67], v[96:99]
s_add_u32 s53, s53, 2048
s_xor_b32 s93, s82, 32768
s_add_u32 s93, s93, s81
v_mfma_f32_16x16x32_bf16 v[96:99], v[164:167], a[72:75], v[96:99]
ds_read_b128 v[144:147], v7 offset:8192
v_mfma_f32_16x16x32_bf16 v[100:103], v[164:167], a[76:79], v[100:103]
ds_write_b64 v11, a[120:121] offset:2048
v_mfma_f32_16x16x32_bf16 v[100:103], v[160:163], a[68:71], v[100:103]
s_add_u32 s54, s84, 3
s_waitcnt lgkmcnt(9) vmcnt(12)
ds_read_b128 v[148:151], v7 offset:9216
v_mfma_f32_16x16x32_bf16 v[120:123], v[168:171], a[80:83], v[120:123]
buffer_load_dwordx4 a[228:231], v15, s[24:27], s93 offen offset:0 sc1
v_mfma_f32_16x16x32_bf16 v[120:123], v[172:175], a[88:91], v[120:123]
s_waitcnt vmcnt(11)
ds_read_b128 v[152:155], v7 offset:10240
v_mfma_f32_16x16x32_bf16 v[124:127], v[172:175], a[92:95], v[124:127]
s_and_b32 s54, s54, 3
s_waitcnt lgkmcnt(8)
ds_read_b128 v[156:159], v7 offset:11264
v_mfma_f32_16x16x32_bf16 v[124:127], v[168:171], a[84:87], v[124:127]
ds_write_b64 v11, a[122:123] offset:2056
v_mfma_f32_16x16x32_bf16 v[72:75], v[176:179], a[80:83], v[72:75]
buffer_load_dwordx4 a[236:239], v15, s[24:27], s93 offen offset:2048 sc1
v_mfma_f32_16x16x32_bf16 v[72:75], v[180:183], a[88:91], v[72:75]
s_mul_i32 s54, s54, 6144
ds_read_b128 v[160:163], v7 offset:12288
v_mfma_f32_16x16x32_bf16 v[76:79], v[180:183], a[92:95], v[76:79]
s_waitcnt lgkmcnt(8)
ds_read_b128 v[164:167], v7 offset:13312
v_mfma_f32_16x16x32_bf16 v[76:79], v[176:179], a[84:87], v[76:79]
ds_write_b64 v11, a[124:125] offset:3072
v_mfma_f32_16x16x32_bf16 v[80:83], v[184:187], a[80:83], v[80:83]
s_add_u32 s54, s54, s69
ds_read_b128 v[168:171], v7 offset:14336
v_mfma_f32_16x16x32_bf16 v[80:83], v[188:191], a[88:91], v[80:83]
ds_read_b128 v[172:175], v7 offset:15360
v_mfma_f32_16x16x32_bf16 v[84:87], v[188:191], a[92:95], v[84:87]
buffer_load_dwordx4 a[240:243], v14, s[24:27], s65 offen offset:0 sc1
v_mfma_f32_16x16x32_bf16 v[84:87], v[184:187], a[84:87], v[84:87]
s_add_u32 s54, s54, 4096
s_waitcnt lgkmcnt(8)
ds_read_b128 v[176:179], v8 offset:0
v_mfma_f32_16x16x32_bf16 v[88:91], v[144:147], a[80:83], v[88:91]
ds_write_b64 v11, a[126:127] offset:3080
v_mfma_f32_16x16x32_bf16 v[88:91], v[148:151], a[88:91], v[88:91]
s_add_u32 s91, s91, 16384
ds_read_b128 v[180:183], v8 offset:1024
v_add_u32 v11, s70, v4
v_mfma_f32_16x16x32_bf16 v[92:95], v[148:151], a[92:95], v[92:95]
s_sub_u32 s55, s3, s84
s_add_u32 s70, s70, 16384
ds_read_b128 v[184:187], v8 offset:2048
v_mfma_f32_16x16x32_bf16 v[92:95], v[144:147], a[84:87], v[92:95]
s_cmp_ge_u32 s70, 163840
s_cselect_b32 s70, s80, s70
s_waitcnt lgkmcnt(10)
v_mfma_f32_16x16x32_bf16 v[96:99], v[152:155], a[80:83], v[96:99]
buffer_load_dwordx4 a[248:251], v14, s[24:27], s65 offen offset:2048 sc1
v_mfma_f32_16x16x32_bf16 v[96:99], v[156:159], a[88:91], v[96:99]
s_and_b32 s55, s55, 3
s_waitcnt lgkmcnt(7) vmcnt(12)
ds_read_b128 v[188:191], v8 offset:3072
v_mfma_f32_16x16x32_bf16 v[100:103], v[156:159], a[92:95], v[100:103]
ds_write_b64 v11, a[160:161] offset:0
v_mfma_f32_16x16x32_bf16 v[100:103], v[152:155], a[84:87], v[100:103]
buffer_load_dwordx4 a[244:247], v14, s[24:27], s93 offen offset:0 sc1
v_mfma_f32_16x16x32_bf16 v[120:123], v[160:163], a[192:195], v[120:123]
s_lshl_b32 s55, s55, 10
ds_read_b128 v[144:147], v8 offset:4096
v_mfma_f32_16x16x32_bf16 v[120:123], v[164:167], a[200:203], v[120:123]
s_waitcnt vmcnt(11)
ds_read_b128 v[148:151], v8 offset:5120
v_mfma_f32_16x16x32_bf16 v[124:127], v[164:167], a[204:207], v[124:127]
ds_write_b64 v11, a[162:163] offset:8
v_mfma_f32_16x16x32_bf16 v[124:127], v[160:163], a[196:199], v[124:127]
s_add_u32 s55, s55, s69
s_waitcnt lgkmcnt(9)
ds_read_b128 v[152:155], v8 offset:6144
v_mfma_f32_16x16x32_bf16 v[72:75], v[168:171], a[192:195], v[72:75]
buffer_load_dwordx4 a[252:255], v14, s[24:27], s93 offen offset:2048 sc1
v_mfma_f32_16x16x32_bf16 v[72:75], v[172:175], a[200:203], v[72:75]
s_cmp_ge_u32 s91, 163840
s_cselect_b32 s91, 0, s91
ds_read_b128 v[156:159], v8 offset:7168
v_mfma_f32_16x16x32_bf16 v[76:79], v[172:175], a[204:207], v[76:79]
s_add_u32 s55, s55, 23552
s_waitcnt lgkmcnt(8)
ds_read_b128 v[160:163], v8 offset:8192
v_mfma_f32_16x16x32_bf16 v[76:79], v[168:171], a[196:199], v[76:79]
ds_write_b64 v11, a[164:165] offset:1024
v_mfma_f32_16x16x32_bf16 v[80:83], v[176:179], a[192:195], v[80:83]
s_xor_b32 s65, s82, 40960
s_add_u32 s65, s65, s77
ds_read_b128 v[164:167], v8 offset:9216
v_mfma_f32_16x16x32_bf16 v[80:83], v[180:183], a[200:203], v[80:83]
s_add_u32 s71, s69, 24576
s_waitcnt lgkmcnt(9)
v_add_u32 v7, s91, v4
v_mfma_f32_16x16x32_bf16 v[84:87], v[180:183], a[204:207], v[84:87]
buffer_load_dwordx4 a[96:99], v15, s[24:27], s65 offen offset:0 sc1
v_mfma_f32_16x16x32_bf16 v[84:87], v[176:179], a[196:199], v[84:87]
ds_write_b64 v11, a[166:167] offset:1032
v_mfma_f32_16x16x32_bf16 v[88:91], v[184:187], a[192:195], v[88:91]
s_cmp_eq_u32 s3, s84
s_cselect_b32 s55, 2147418112, s55
s_cselect_b32 s71, s71, 2147418112
v_mfma_f32_16x16x32_bf16 v[88:91], v[188:191], a[200:203], v[88:91]
ds_read_b128 v[168:171], v8 offset:10240
v_mfma_f32_16x16x32_bf16 v[92:95], v[188:191], a[204:207], v[92:95]
buffer_load_dwordx4 a[104:107], v15, s[24:27], s65 offen offset:2048 sc1
v_mfma_f32_16x16x32_bf16 v[92:95], v[184:187], a[196:199], v[92:95]
s_mul_i32 s83, s84, 6144
s_waitcnt lgkmcnt(8)
ds_read_b128 v[172:175], v8 offset:11264
v_mfma_f32_16x16x32_bf16 v[96:99], v[144:147], a[192:195], v[96:99]
ds_write_b64 v11, a[168:169] offset:2048
v_mfma_f32_16x16x32_bf16 v[96:99], v[148:151], a[200:203], v[96:99]
s_xor_b32 s93, s82, 40960
s_add_u32 s93, s93, s81
ds_read_b128 v[176:179], v8 offset:12288
v_mfma_f32_16x16x32_bf16 v[100:103], v[148:151], a[204:207], v[100:103]
s_add_u32 s69, s69, s83
s_waitcnt lgkmcnt(8) vmcnt(12)
ds_read_b128 v[180:183], v8 offset:13312
v_mfma_f32_16x16x32_bf16 v[100:103], v[144:147], a[196:199], v[100:103]
buffer_load_dwordx4 a[100:103], v15, s[24:27], s93 offen offset:0 sc1
v_mfma_f32_16x16x32_bf16 v[120:123], v[152:155], a[208:211], v[120:123]
s_waitcnt vmcnt(56)
s_waitcnt vmcnt(11)
ds_read_b128 v[184:187], v8 offset:14336
v_mfma_f32_16x16x32_bf16 v[120:123], v[156:159], a[216:219], v[120:123]
s_barrier
v_mfma_f32_16x16x32_bf16 v[124:127], v[156:159], a[220:223], v[124:127]
s_add_u32 s83, s69, 4096
s_waitcnt lgkmcnt(7)
ds_read_b128 v[188:191], v8 offset:15360
v_mfma_f32_16x16x32_bf16 v[124:127], v[152:155], a[212:215], v[124:127]
ds_write_b64 v11, a[170:171] offset:2056
v_mfma_f32_16x16x32_bf16 v[72:75], v[160:163], a[208:211], v[72:75]
buffer_load_dwordx4 a[108:111], v15, s[24:27], s93 offen offset:2048 sc1
v_mfma_f32_16x16x32_bf16 v[72:75], v[164:167], a[216:219], v[72:75]
s_add_u32 s91, s91, 16384
ds_read_b128 v[144:147], v7 offset:0
v_mfma_f32_16x16x32_bf16 v[76:79], v[164:167], a[220:223], v[76:79]
s_waitcnt lgkmcnt(7)
ds_read_b128 v[148:151], v7 offset:1024
v_mfma_f32_16x16x32_bf16 v[76:79], v[160:163], a[212:215], v[76:79]
ds_write_b64 v11, a[172:173] offset:3072
v_mfma_f32_16x16x32_bf16 v[80:83], v[168:171], a[208:211], v[80:83]
s_cmp_ge_u32 s91, 163840
s_cselect_b32 s91, 0, s91
ds_read_b128 v[152:155], v7 offset:2048
v_mfma_f32_16x16x32_bf16 v[80:83], v[172:175], a[216:219], v[80:83]
s_waitcnt lgkmcnt(7)
ds_read_b128 v[156:159], v7 offset:3072
v_add_u32 v8, s91, v4
v_mfma_f32_16x16x32_bf16 v[84:87], v[172:175], a[220:223], v[84:87]
buffer_load_dwordx4 a[112:115], v14, s[24:27], s65 offen offset:0 sc1
v_mfma_f32_16x16x32_bf16 v[84:87], v[168:171], a[212:215], v[84:87]
ds_write_b64 v11, a[174:175] offset:3080
v_mfma_f32_16x16x32_bf16 v[88:91], v[176:179], a[208:211], v[88:91]
s_add_u32 s68, s68, 49152
ds_read_b128 v[160:163], v7 offset:4096
v_mfma_f32_16x16x32_bf16 v[88:91], v[180:183], a[216:219], v[88:91]
ds_read_b128 v[164:167], v7 offset:5120
v_mfma_f32_16x16x32_bf16 v[92:95], v[180:183], a[220:223], v[92:95]
buffer_load_dwordx4 a[120:123], v14, s[24:27], s65 offen offset:2048 sc1
v_mfma_f32_16x16x32_bf16 v[92:95], v[176:179], a[212:215], v[92:95]
s_waitcnt lgkmcnt(9)
ds_read_b128 v[168:171], v7 offset:6144
v_mfma_f32_16x16x32_bf16 v[96:99], v[184:187], a[208:211], v[96:99]
ds_read_b128 v[172:175], v7 offset:7168
v_mfma_f32_16x16x32_bf16 v[96:99], v[188:191], a[216:219], v[96:99]
v_mfma_f32_16x16x32_bf16 v[100:103], v[188:191], a[220:223], v[100:103]
buffer_load_dwordx4 a[116:119], v14, s[24:27], s93 offen offset:0 sc1
v_mfma_f32_16x16x32_bf16 v[100:103], v[184:187], a[212:215], v[100:103]
s_waitcnt lgkmcnt(8) vmcnt(13)
ds_read_b128 v[176:179], v7 offset:8192
v_mfma_f32_16x16x32_bf16 v[120:123], v[144:147], a[224:227], v[120:123]
ds_read_b128 v[180:183], v7 offset:9216
v_mfma_f32_16x16x32_bf16 v[120:123], v[148:151], a[232:235], v[120:123]
s_waitcnt vmcnt(11)
v_mfma_f32_16x16x32_bf16 v[124:127], v[148:151], a[236:239], v[124:127]
buffer_load_dwordx4 a[124:127], v14, s[24:27], s93 offen offset:2048 sc1
v_mfma_f32_16x16x32_bf16 v[124:127], v[144:147], a[228:231], v[124:127]
s_waitcnt lgkmcnt(7)
ds_read_b128 v[184:187], v7 offset:10240
v_mfma_f32_16x16x32_bf16 v[72:75], v[152:155], a[224:227], v[72:75]
ds_read_b128 v[188:191], v7 offset:11264
v_mfma_f32_16x16x32_bf16 v[72:75], v[156:159], a[232:235], v[72:75]
v_mfma_f32_16x16x32_bf16 v[76:79], v[156:159], a[236:239], v[76:79]
ds_read_b128 v[144:147], v7 offset:12288
v_mfma_f32_16x16x32_bf16 v[76:79], v[152:155], a[228:231], v[76:79]
s_waitcnt lgkmcnt(7)
v_mfma_f32_16x16x32_bf16 v[80:83], v[160:163], a[224:227], v[80:83]
s_xor_b32 s65, s82, 49152
s_add_u32 s65, s65, s77
ds_read_b128 v[148:151], v7 offset:13312
v_mfma_f32_16x16x32_bf16 v[80:83], v[164:167], a[232:235], v[80:83]
v_mov_b32 v13, 0xffff0000
v_mul_u32_u24 v5, 1152, v2
v_mfma_f32_16x16x32_bf16 v[84:87], v[164:167], a[236:239], v[84:87]
buffer_load_dwordx4 a[128:131], v15, s[24:27], s65 offen offset:0 sc1
v_mfma_f32_16x16x32_bf16 v[84:87], v[160:163], a[228:231], v[84:87]
s_waitcnt lgkmcnt(6)
ds_read_b128 v[152:155], v7 offset:14336
v_lshl_add_u32 v6, v3, 3, v5
v_mfma_f32_16x16x32_bf16 v[88:91], v[168:171], a[224:227], v[88:91]
ds_read_b128 v[156:159], v7 offset:15360
v_and_b32 v9, 1, v3
v_mfma_f32_16x16x32_bf16 v[88:91], v[172:175], a[232:235], v[88:91]
s_add_u32 s91, s91, 16384
s_cmp_ge_u32 s91, 163840
s_cselect_b32 s91, 0, s91
v_mfma_f32_16x16x32_bf16 v[92:95], v[172:175], a[236:239], v[92:95]
buffer_load_dwordx4 a[136:139], v15, s[24:27], s65 offen offset:2048 sc1
v_mfma_f32_16x16x32_bf16 v[92:95], v[168:171], a[228:231], v[92:95]
s_waitcnt lgkmcnt(6)
ds_read_b128 v[160:163], v8 offset:0
v_add_u32 v7, s91, v4
v_mfma_f32_16x16x32_bf16 v[96:99], v[176:179], a[224:227], v[96:99]
s_xor_b32 s93, s82, 49152
s_add_u32 s93, s93, s81
ds_read_b128 v[164:167], v8 offset:1024
v_mfma_f32_16x16x32_bf16 v[96:99], v[180:183], a[232:235], v[96:99]
v_lshl_add_u32 v5, v9, 5, v5
v_lshrrev_b32 v9, 1, v3
v_mfma_f32_16x16x32_bf16 v[100:103], v[180:183], a[236:239], v[100:103]
buffer_load_dwordx4 a[132:135], v15, s[24:27], s93 offen offset:0 sc1
v_mfma_f32_16x16x32_bf16 v[100:103], v[176:179], a[228:231], v[100:103]
s_waitcnt lgkmcnt(6) vmcnt(13)
ds_read_b128 v[168:171], v8 offset:2048
v_lshl_add_u32 v5, v9, 4, v5
v_mfma_f32_16x16x32_bf16 v[120:123], v[184:187], a[240:243], v[120:123]
ds_read_b128 v[172:175], v8 offset:3072
v_mfma_f32_16x16x32_bf16 v[120:123], v[188:191], a[248:251], v[120:123]
s_waitcnt vmcnt(11)
v_mfma_f32_16x16x32_bf16 v[124:127], v[188:191], a[252:255], v[124:127]
buffer_load_dwordx4 a[140:143], v15, s[24:27], s93 offen offset:2048 sc1
v_mfma_f32_16x16x32_bf16 v[124:127], v[184:187], a[244:247], v[124:127]
s_waitcnt lgkmcnt(6)
ds_read_b128 v[176:179], v8 offset:4096
v_mfma_f32_16x16x32_bf16 v[72:75], v[144:147], a[240:243], v[72:75]
ds_read_b128 v[180:183], v8 offset:5120
v_mfma_f32_16x16x32_bf16 v[72:75], v[148:151], a[248:251], v[72:75]
v_mfma_f32_16x16x32_bf16 v[76:79], v[148:151], a[252:255], v[76:79]
ds_read_b128 v[184:187], v8 offset:6144
v_mfma_f32_16x16x32_bf16 v[76:79], v[144:147], a[244:247], v[76:79]
s_waitcnt lgkmcnt(7)
v_mfma_f32_16x16x32_bf16 v[80:83], v[152:155], a[240:243], v[80:83]
ds_read_b128 v[188:191], v8 offset:7168
v_mfma_f32_16x16x32_bf16 v[80:83], v[156:159], a[248:251], v[80:83]
s_waitcnt lgkmcnt(6)
v_mfma_f32_16x16x32_bf16 v[84:87], v[156:159], a[252:255], v[84:87]
buffer_load_dword v12, v10, s[24:27], s75 offen offset:4 sc1
v_mfma_f32_16x16x32_bf16 v[84:87], v[152:155], a[244:247], v[84:87]
buffer_load_dwordx4 a[144:147], v14, s[24:27], s65 offen offset:0 sc1
v_mfma_f32_16x16x32_bf16 v[88:91], v[160:163], a[240:243], v[88:91]
ds_read_b128 v[144:147], v8 offset:8192
v_mfma_f32_16x16x32_bf16 v[88:91], v[164:167], a[248:251], v[88:91]
ds_read_b128 v[148:151], v8 offset:9216
v_mfma_f32_16x16x32_bf16 v[92:95], v[164:167], a[252:255], v[92:95]
buffer_load_dwordx4 a[152:155], v14, s[24:27], s65 offen offset:2048 sc1
v_mfma_f32_16x16x32_bf16 v[92:95], v[160:163], a[244:247], v[92:95]
s_waitcnt lgkmcnt(6)
ds_read_b128 v[152:155], v8 offset:10240
v_mfma_f32_16x16x32_bf16 v[96:99], v[168:171], a[240:243], v[96:99]
ds_read_b128 v[156:159], v8 offset:11264
v_mfma_f32_16x16x32_bf16 v[96:99], v[172:175], a[248:251], v[96:99]
v_mfma_f32_16x16x32_bf16 v[100:103], v[172:175], a[252:255], v[100:103]
buffer_load_dwordx4 a[148:151], v14, s[24:27], s93 offen offset:0 sc1
v_mfma_f32_16x16x32_bf16 v[100:103], v[168:171], a[244:247], v[100:103]
s_waitcnt lgkmcnt(6) vmcnt(14)
ds_read_b128 v[160:163], v8 offset:12288
v_mfma_f32_16x16x32_bf16 v[120:123], v[176:179], a[96:99], v[120:123]
ds_read_b128 v[164:167], v8 offset:13312
v_mfma_f32_16x16x32_bf16 v[120:123], v[180:183], a[104:107], v[120:123]
s_waitcnt vmcnt(12)
v_mfma_f32_16x16x32_bf16 v[124:127], v[180:183], a[108:111], v[124:127]
buffer_load_dwordx4 a[156:159], v14, s[24:27], s93 offen offset:2048 sc1
v_mfma_f32_16x16x32_bf16 v[124:127], v[176:179], a[100:103], v[124:127]
s_waitcnt lgkmcnt(6)
ds_read_b128 v[168:171], v8 offset:14336
v_mfma_f32_16x16x32_bf16 v[72:75], v[184:187], a[96:99], v[72:75]
s_waitcnt vmcnt(61)
ds_read_b128 v[172:175], v8 offset:15360
v_mfma_f32_16x16x32_bf16 v[72:75], v[188:191], a[104:107], v[72:75]
s_barrier
v_mfma_f32_16x16x32_bf16 v[76:79], v[188:191], a[108:111], v[76:79]
s_add_u32 s91, s91, 16384
ds_read_b128 v[176:179], v7 offset:0
v_mfma_f32_16x16x32_bf16 v[76:79], v[184:187], a[100:103], v[76:79]
s_waitcnt lgkmcnt(7)
s_cmp_ge_u32 s91, 163840
s_cselect_b32 s91, 0, s91
v_mfma_f32_16x16x32_bf16 v[80:83], v[144:147], a[96:99], v[80:83]
s_xor_b32 s65, s82, 57344
s_add_u32 s65, s65, s77
ds_read_b128 v[180:183], v7 offset:1024
v_mfma_f32_16x16x32_bf16 v[80:83], v[148:151], a[104:107], v[80:83]
v_add_u32 v8, s91, v4
v_mfma_f32_16x16x32_bf16 v[84:87], v[148:151], a[108:111], v[84:87]
buffer_load_dwordx4 a[160:163], v15, s[24:27], s65 offen offset:0 sc1
v_mfma_f32_16x16x32_bf16 v[84:87], v[144:147], a[100:103], v[84:87]
s_waitcnt lgkmcnt(6)
ds_read_b128 v[184:187], v7 offset:2048
v_mfma_f32_16x16x32_bf16 v[88:91], v[152:155], a[96:99], v[88:91]
ds_read_b128 v[188:191], v7 offset:3072
v_mfma_f32_16x16x32_bf16 v[88:91], v[156:159], a[104:107], v[88:91]
v_mfma_f32_16x16x32_bf16 v[92:95], v[156:159], a[108:111], v[92:95]
buffer_load_dwordx4 a[168:171], v15, s[24:27], s65 offen offset:2048 sc1
v_mfma_f32_16x16x32_bf16 v[92:95], v[152:155], a[100:103], v[92:95]
s_waitcnt lgkmcnt(6)
ds_read_b128 v[144:147], v7 offset:4096
v_mfma_f32_16x16x32_bf16 v[96:99], v[160:163], a[96:99], v[96:99]
s_xor_b32 s93, s82, 57344
s_add_u32 s93, s93, s81
ds_read_b128 v[148:151], v7 offset:5120
v_mfma_f32_16x16x32_bf16 v[96:99], v[164:167], a[104:107], v[96:99]
v_mfma_f32_16x16x32_bf16 v[100:103], v[164:167], a[108:111], v[100:103]
buffer_load_dwordx4 a[164:167], v15, s[24:27], s93 offen offset:0 sc1
v_mfma_f32_16x16x32_bf16 v[100:103], v[160:163], a[100:103], v[100:103]
s_waitcnt lgkmcnt(6) vmcnt(14)
ds_read_b128 v[152:155], v7 offset:6144
v_mfma_f32_16x16x32_bf16 v[120:123], v[168:171], a[112:115], v[120:123]
ds_read_b128 v[156:159], v7 offset:7168
v_mfma_f32_16x16x32_bf16 v[120:123], v[172:175], a[120:123], v[120:123]
s_waitcnt vmcnt(12)
v_mfma_f32_16x16x32_bf16 v[124:127], v[172:175], a[124:127], v[124:127]
buffer_load_dwordx4 a[172:175], v15, s[24:27], s93 offen offset:2048 sc1
v_mfma_f32_16x16x32_bf16 v[124:127], v[168:171], a[116:119], v[124:127]
s_waitcnt lgkmcnt(6)
ds_read_b128 v[160:163], v7 offset:8192
v_mfma_f32_16x16x32_bf16 v[72:75], v[176:179], a[112:115], v[72:75]
ds_read_b128 v[164:167], v7 offset:9216
v_mfma_f32_16x16x32_bf16 v[72:75], v[180:183], a[120:123], v[72:75]
v_mfma_f32_16x16x32_bf16 v[76:79], v[180:183], a[124:127], v[76:79]
ds_read_b128 v[168:171], v7 offset:10240
v_mfma_f32_16x16x32_bf16 v[76:79], v[176:179], a[116:119], v[76:79]
s_waitcnt lgkmcnt(7)
v_mfma_f32_16x16x32_bf16 v[80:83], v[184:187], a[112:115], v[80:83]
ds_read_b128 v[172:175], v7 offset:11264
v_mfma_f32_16x16x32_bf16 v[80:83], v[188:191], a[120:123], v[80:83]
v_mfma_f32_16x16x32_bf16 v[84:87], v[188:191], a[124:127], v[84:87]
buffer_load_dwordx4 a[176:179], v14, s[24:27], s65 offen offset:0 sc1
v_mfma_f32_16x16x32_bf16 v[84:87], v[184:187], a[116:119], v[84:87]
s_waitcnt lgkmcnt(6)
ds_read_b128 v[176:179], v7 offset:12288
v_mfma_f32_16x16x32_bf16 v[88:91], v[144:147], a[112:115], v[88:91]
ds_read_b128 v[180:183], v7 offset:13312
v_mfma_f32_16x16x32_bf16 v[88:91], v[148:151], a[120:123], v[88:91]
v_mfma_f32_16x16x32_bf16 v[92:95], v[148:151], a[124:127], v[92:95]
buffer_load_dwordx4 a[184:187], v14, s[24:27], s65 offen offset:2048 sc1
v_mfma_f32_16x16x32_bf16 v[92:95], v[144:147], a[116:119], v[92:95]
s_waitcnt lgkmcnt(6)
ds_read_b128 v[184:187], v7 offset:14336
v_mfma_f32_16x16x32_bf16 v[96:99], v[152:155], a[112:115], v[96:99]
s_waitcnt vmcnt(10)
ds_read_b128 v[188:191], v7 offset:15360
v_mfma_f32_16x16x32_bf16 v[96:99], v[156:159], a[120:123], v[96:99]
s_add_u32 s91, s91, 16384
v_cmp_gt_u32 vcc, 8, v12
v_mfma_f32_16x16x32_bf16 v[100:103], v[156:159], a[124:127], v[100:103]
buffer_load_dwordx4 a[180:183], v14, s[24:27], s93 offen offset:0 sc1
v_mfma_f32_16x16x32_bf16 v[100:103], v[152:155], a[116:119], v[100:103]
s_waitcnt lgkmcnt(6) vmcnt(14)
ds_read_b128 v[144:147], v8 offset:0
v_mfma_f32_16x16x32_bf16 v[120:123], v[160:163], a[128:131], v[120:123]
s_cmp_ge_u32 s91, 163840
s_cselect_b32 s91, 0, s91
ds_read_b128 v[148:151], v8 offset:1024
v_mfma_f32_16x16x32_bf16 v[120:123], v[164:167], a[136:139], v[120:123]
s_waitcnt lgkmcnt(6) vmcnt(12)
v_add_u32 v7, s91, v4
v_mfma_f32_16x16x32_bf16 v[124:127], v[164:167], a[140:143], v[124:127]
s_cbranch_vccnz CK_ZAA
CK_ZAA_R:
v_mfma_f32_16x16x32_bf16 v[124:127], v[160:163], a[132:135], v[124:127]
buffer_load_dwordx4 a[188:191], v14, s[24:27], s93 offen offset:2048 sc1
v_mfma_f32_16x16x32_bf16 v[72:75], v[168:171], a[128:131], v[72:75]
ds_read_b128 v[152:155], v8 offset:2048
v_mfma_f32_16x16x32_bf16 v[72:75], v[172:175], a[136:139], v[72:75]
ds_read_b128 v[156:159], v8 offset:3072
v_mfma_f32_16x16x32_bf16 v[76:79], v[172:175], a[140:143], v[76:79]
ds_read_b128 v[160:163], v8 offset:4096
v_mfma_f32_16x16x32_bf16 v[76:79], v[168:171], a[132:135], v[76:79]
s_waitcnt lgkmcnt(7)
v_mfma_f32_16x16x32_bf16 v[80:83], v[176:179], a[128:131], v[80:83]
s_add_u32 s65, s77, 65536
ds_read_b128 v[164:167], v8 offset:5120
v_mfma_f32_16x16x32_bf16 v[80:83], v[180:183], a[136:139], v[80:83]
v_mfma_f32_16x16x32_bf16 v[84:87], v[180:183], a[140:143], v[84:87]
buffer_load_dwordx4 v[32:35], v15, s[24:27], s65 offen offset:0 sc1
v_mfma_f32_16x16x32_bf16 v[84:87], v[176:179], a[132:135], v[84:87]
s_waitcnt lgkmcnt(6)
ds_read_b128 v[168:171], v8 offset:6144
v_mfma_f32_16x16x32_bf16 v[88:91], v[184:187], a[128:131], v[88:91]
ds_read_b128 v[172:175], v8 offset:7168
v_mfma_f32_16x16x32_bf16 v[88:91], v[188:191], a[136:139], v[88:91]
v_mfma_f32_16x16x32_bf16 v[92:95], v[188:191], a[140:143], v[92:95]
buffer_load_dwordx4 v[40:43], v15, s[24:27], s65 offen offset:2048 sc1
v_mfma_f32_16x16x32_bf16 v[92:95], v[184:187], a[132:135], v[92:95]
s_waitcnt lgkmcnt(6)
ds_read_b128 v[176:179], v8 offset:8192
v_mfma_f32_16x16x32_bf16 v[96:99], v[144:147], a[128:131], v[96:99]
s_add_u32 s93, s81, 65536
ds_read_b128 v[180:183], v8 offset:9216
v_mfma_f32_16x16x32_bf16 v[96:99], v[148:151], a[136:139], v[96:99]
s_waitcnt lgkmcnt(6) vmcnt(12)
v_mfma_f32_16x16x32_bf16 v[100:103], v[148:151], a[140:143], v[100:103]
buffer_load_dwordx4 v[36:39], v15, s[24:27], s93 offen offset:0 sc1
v_mfma_f32_16x16x32_bf16 v[100:103], v[144:147], a[132:135], v[100:103]
s_mov_b32 m0, s70
s_mov_b32 s64, s68
s_add_u32 s68, s68, 16384
v_mfma_f32_16x16x32_bf16 v[120:123], v[152:155], a[144:147], v[120:123]
s_waitcnt vmcnt(11)
ds_read_b128 v[184:187], v8 offset:10240
v_mfma_f32_16x16x32_bf16 v[120:123], v[156:159], a[152:155], v[120:123]
s_add_u32 s70, s70, 16384
s_cmp_ge_u32 s70, 163840
s_cselect_b32 s70, s80, s70
v_mfma_f32_16x16x32_bf16 v[124:127], v[156:159], a[156:159], v[124:127]
buffer_load_dwordx4 v15, s[24:27], s64 offen offset:0 sc1 lds
v_mfma_f32_16x16x32_bf16 v[124:127], v[152:155], a[148:151], v[124:127]
s_waitcnt lgkmcnt(5)
ds_read_b128 v[188:191], v8 offset:11264
v_mfma_f32_16x16x32_bf16 v[72:75], v[160:163], a[144:147], v[72:75]
ds_read_b128 v[144:147], v8 offset:12288
v_mfma_f32_16x16x32_bf16 v[72:75], v[164:167], a[152:155], v[72:75]
buffer_load_dwordx4 v15, s[24:27], s64 offen offset:1024 sc1 lds
v_mfma_f32_16x16x32_bf16 v[76:79], v[164:167], a[156:159], v[76:79]
ds_read_b128 v[148:151], v8 offset:13312
v_mfma_f32_16x16x32_bf16 v[76:79], v[160:163], a[148:151], v[76:79]
s_waitcnt lgkmcnt(6)
ds_read_b128 v[152:155], v8 offset:14336
v_mfma_f32_16x16x32_bf16 v[80:83], v[168:171], a[144:147], v[80:83]
buffer_load_dwordx4 v[44:47], v15, s[24:27], s93 offen offset:2048 sc1
v_mfma_f32_16x16x32_bf16 v[80:83], v[172:175], a[152:155], v[80:83]
s_barrier
v_mfma_f32_16x16x32_bf16 v[84:87], v[172:175], a[156:159], v[84:87]
s_waitcnt lgkmcnt(5)
ds_read_b128 v[156:159], v8 offset:15360
v_mfma_f32_16x16x32_bf16 v[84:87], v[168:171], a[148:151], v[84:87]
buffer_load_dwordx4 v15, s[24:27], s64 offen offset:2048 sc1 lds
v_mfma_f32_16x16x32_bf16 v[88:91], v[176:179], a[144:147], v[88:91]
s_add_u32 s91, s91, 16384
ds_read_b128 v[160:163], v7 offset:0
v_mfma_f32_16x16x32_bf16 v[88:91], v[180:183], a[152:155], v[88:91]
s_cmp_ge_u32 s91, 163840
s_cselect_b32 s91, 0, s91
ds_read_b128 v[164:167], v7 offset:1024
v_mfma_f32_16x16x32_bf16 v[92:95], v[180:183], a[156:159], v[92:95]
buffer_load_dwordx4 v15, s[24:27], s64 offen offset:3072 sc1 lds
v_mfma_f32_16x16x32_bf16 v[92:95], v[176:179], a[148:151], v[92:95]
s_waitcnt lgkmcnt(6)
ds_read_b128 v[168:171], v7 offset:2048
v_add_u32 v8, s91, v4
v_mfma_f32_16x16x32_bf16 v[96:99], v[184:187], a[144:147], v[96:99]
ds_read_b128 v[172:175], v7 offset:3072
v_mfma_f32_16x16x32_bf16 v[96:99], v[188:191], a[152:155], v[96:99]
buffer_load_dwordx4 v[48:51], v14, s[24:27], s65 offen offset:0 sc1
v_mfma_f32_16x16x32_bf16 v[100:103], v[188:191], a[156:159], v[100:103]
ds_read_b128 v[176:179], v7 offset:4096
v_mfma_f32_16x16x32_bf16 v[100:103], v[184:187], a[148:151], v[100:103]
s_waitcnt lgkmcnt(7) vmcnt(15)
v_mfma_f32_16x16x32_bf16 v[120:123], v[144:147], a[160:163], v[120:123]
buffer_load_dwordx4 v[56:59], v14, s[24:27], s65 offen offset:2048 sc1
v_mfma_f32_16x16x32_bf16 v[120:123], v[148:151], a[168:171], v[120:123]
s_waitcnt vmcnt(14)
ds_read_b128 v[180:183], v7 offset:5120
v_mfma_f32_16x16x32_bf16 v[124:127], v[148:151], a[172:175], v[124:127]
s_waitcnt lgkmcnt(6)
ds_read_b128 v[184:187], v7 offset:6144
v_mfma_f32_16x16x32_bf16 v[124:127], v[144:147], a[164:167], v[124:127]
buffer_load_dwordx4 v[52:55], v14, s[24:27], s93 offen offset:0 sc1
v_mfma_f32_16x16x32_bf16 v[72:75], v[152:155], a[160:163], v[72:75]
ds_read_b128 v[188:191], v7 offset:7168
v_mfma_f32_16x16x32_bf16 v[72:75], v[156:159], a[168:171], v[72:75]
v_mfma_f32_16x16x32_bf16 v[76:79], v[156:159], a[172:175], v[76:79]
buffer_load_dwordx4 v[60:63], v14, s[24:27], s93 offen offset:2048 sc1
v_mfma_f32_16x16x32_bf16 v[76:79], v[152:155], a[164:167], v[76:79]
s_waitcnt lgkmcnt(6)
ds_read_b128 v[144:147], v7 offset:8192
v_mfma_f32_16x16x32_bf16 v[80:83], v[160:163], a[160:163], v[80:83]
ds_read_b128 v[148:151], v7 offset:9216
v_mfma_f32_16x16x32_bf16 v[80:83], v[164:167], a[168:171], v[80:83]
v_mfma_f32_16x16x32_bf16 v[84:87], v[164:167], a[172:175], v[84:87]
ds_read_b128 v[152:155], v7 offset:10240
v_mfma_f32_16x16x32_bf16 v[84:87], v[160:163], a[164:167], v[84:87]
s_waitcnt lgkmcnt(7)
v_mfma_f32_16x16x32_bf16 v[88:91], v[168:171], a[160:163], v[88:91]
s_add_u32 s65, s77, 73728
ds_read_b128 v[156:159], v7 offset:11264
v_mfma_f32_16x16x32_bf16 v[88:91], v[172:175], a[168:171], v[88:91]
v_mfma_f32_16x16x32_bf16 v[92:95], v[172:175], a[172:175], v[92:95]
buffer_load_dwordx4 v[64:67], v15, s[24:27], s65 offen offset:0 sc1
v_mfma_f32_16x16x32_bf16 v[92:95], v[168:171], a[164:167], v[92:95]
s_waitcnt lgkmcnt(6)
ds_read_b128 v[160:163], v7 offset:12288
v_mfma_f32_16x16x32_bf16 v[96:99], v[176:179], a[160:163], v[96:99]
ds_read_b128 v[164:167], v7 offset:13312
v_mfma_f32_16x16x32_bf16 v[96:99], v[180:183], a[168:171], v[96:99]
v_mfma_f32_16x16x32_bf16 v[100:103], v[180:183], a[172:175], v[100:103]
ds_read_b128 v[168:171], v7 offset:14336
v_mfma_f32_16x16x32_bf16 v[100:103], v[176:179], a[164:167], v[100:103]
s_add_u32 s93, s81, 73728
s_waitcnt lgkmcnt(7) vmcnt(15)
v_mfma_f32_16x16x32_bf16 v[120:123], v[184:187], a[176:179], v[120:123]
s_waitcnt vmcnt(13)
ds_read_b128 v[172:175], v7 offset:15360
v_mfma_f32_16x16x32_bf16 v[120:123], v[188:191], a[184:187], v[120:123]
buffer_load_dwordx4 v[68:71], v15, s[24:27], s93 offen offset:0 sc1
v_mfma_f32_16x16x32_bf16 v[124:127], v[188:191], a[188:191], v[124:127]
s_add_u32 s91, s91, 16384
ds_read_b128 v[176:179], v8 offset:0
v_mfma_f32_16x16x32_bf16 v[124:127], v[184:187], a[180:183], v[124:127]
s_waitcnt lgkmcnt(7)
s_cmp_ge_u32 s91, 163840
s_cselect_b32 s91, 0, s91
v_mfma_f32_16x16x32_bf16 v[72:75], v[144:147], a[176:179], v[72:75]
ds_read_b128 v[180:183], v8 offset:1024
v_add_u32 v7, s91, v4
v_mfma_f32_16x16x32_bf16 v[72:75], v[148:151], a[184:187], v[72:75]
v_mfma_f32_16x16x32_bf16 v[76:79], v[148:151], a[188:191], v[76:79]
s_mov_b32 m0, s70
s_mov_b32 s64, s68
s_add_u32 s68, s68, 16384
v_mfma_f32_16x16x32_bf16 v[76:79], v[144:147], a[180:183], v[76:79]
s_waitcnt lgkmcnt(6)
ds_read_b128 v[184:187], v8 offset:2048
v_mfma_f32_16x16x32_bf16 v[80:83], v[152:155], a[176:179], v[80:83]
s_add_u32 s70, s70, 16384
s_cmp_ge_u32 s70, 163840
s_cselect_b32 s70, s80, s70
v_mfma_f32_16x16x32_bf16 v[80:83], v[156:159], a[184:187], v[80:83]
buffer_load_dwordx4 v15, s[24:27], s64 offen offset:0 sc1 lds
v_mfma_f32_16x16x32_bf16 v[84:87], v[156:159], a[188:191], v[84:87]
ds_read_b128 v[188:191], v8 offset:3072
v_mfma_f32_16x16x32_bf16 v[84:87], v[152:155], a[180:183], v[84:87]
s_waitcnt lgkmcnt(6)
ds_read_b128 v[144:147], v8 offset:4096
v_mfma_f32_16x16x32_bf16 v[88:91], v[160:163], a[176:179], v[88:91]
buffer_load_dwordx4 v15, s[24:27], s64 offen offset:1024 sc1 lds
v_mfma_f32_16x16x32_bf16 v[88:91], v[164:167], a[184:187], v[88:91]
ds_read_b128 v[148:151], v8 offset:5120
v_mfma_f32_16x16x32_bf16 v[92:95], v[164:167], a[188:191], v[92:95]
s_waitcnt lgkmcnt(6)
ds_read_b128 v[152:155], v8 offset:6144
v_mfma_f32_16x16x32_bf16 v[92:95], v[160:163], a[180:183], v[92:95]
buffer_load_dwordx4 v15, s[24:27], s64 offen offset:2048 sc1 lds
v_mfma_f32_16x16x32_bf16 v[96:99], v[168:171], a[176:179], v[96:99]
L_PAD12:
s_cbranch_execz L_MAIN
ds_read_b128 v[156:159], v8 offset:7168
v_mfma_f32_16x16x32_bf16 v[96:99], v[172:175], a[184:187], v[96:99]
v_mfma_f32_16x16x32_bf16 v[100:103], v[172:175], a[188:191], v[100:103]
buffer_load_dwordx4 v15, s[24:27], s64 offen offset:3072 sc1 lds
v_mfma_f32_16x16x32_bf16 v[100:103], v[168:171], a[180:183], v[100:103]
s_waitcnt lgkmcnt(6) vmcnt(16)
ds_read_b128 v[160:163], v8 offset:8192
v_mfma_f32_16x16x32_bf16 v[120:123], v[176:179], v[32:35], v[120:123]
s_mov_b32 m0, s70
s_mov_b32 s64, s68
s_add_u32 s68, s68, 16384
v_mfma_f32_16x16x32_bf16 v[120:123], v[180:183], v[40:43], v[120:123]
s_waitcnt lgkmcnt(5) vmcnt(12)
ds_read_b128 v[164:167], v8 offset:9216
v_mfma_f32_16x16x32_bf16 v[124:127], v[180:183], v[44:47], v[124:127]
s_add_u32 s70, s70, 16384
s_cmp_ge_u32 s70, 163840
s_cselect_b32 s70, s80, s70
v_mfma_f32_16x16x32_bf16 v[124:127], v[176:179], v[36:39], v[124:127]
buffer_load_dwordx4 v15, s[24:27], s64 offen offset:0 sc1 lds
v_mfma_f32_16x16x32_bf16 v[72:75], v[184:187], v[32:35], v[72:75]
ds_read_b128 v[168:171], v8 offset:10240
v_mfma_f32_16x16x32_bf16 v[72:75], v[188:191], v[40:43], v[72:75]
ds_read_b128 v[172:175], v8 offset:11264
v_mfma_f32_16x16x32_bf16 v[76:79], v[188:191], v[44:47], v[76:79]
buffer_load_dwordx4 v15, s[24:27], s64 offen offset:1024 sc1 lds
v_mfma_f32_16x16x32_bf16 v[76:79], v[184:187], v[36:39], v[76:79]
s_waitcnt lgkmcnt(6)
ds_read_b128 v[176:179], v8 offset:12288
v_mfma_f32_16x16x32_bf16 v[80:83], v[144:147], v[32:35], v[80:83]
ds_read_b128 v[180:183], v8 offset:13312
v_mfma_f32_16x16x32_bf16 v[80:83], v[148:151], v[40:43], v[80:83]
buffer_load_dwordx4 v15, s[24:27], s64 offen offset:2048 sc1 lds
v_mfma_f32_16x16x32_bf16 v[84:87], v[148:151], v[44:47], v[84:87]
ds_read_b128 v[184:187], v8 offset:14336
v_mfma_f32_16x16x32_bf16 v[84:87], v[144:147], v[36:39], v[84:87]
s_waitcnt lgkmcnt(7)
v_mfma_f32_16x16x32_bf16 v[88:91], v[152:155], v[32:35], v[88:91]
s_waitcnt vmcnt(13)
ds_read_b128 v[188:191], v8 offset:15360
v_mfma_f32_16x16x32_bf16 v[88:91], v[156:159], v[40:43], v[88:91]
s_barrier
v_mfma_f32_16x16x32_bf16 v[92:95], v[156:159], v[44:47], v[92:95]
buffer_load_dwordx4 v15, s[24:27], s64 offen offset:3072 sc1 lds
v_mfma_f32_16x16x32_bf16 v[92:95], v[152:155], v[36:39], v[92:95]
s_waitcnt lgkmcnt(6)
s_add_u32 s91, s91, 16384
ds_read_b128 v[144:147], v7 offset:0
v_mfma_f32_16x16x32_bf16 v[96:99], v[160:163], v[32:35], v[96:99]
s_cmp_ge_u32 s91, 163840
s_cselect_b32 s91, 0, s91
ds_read_b128 v[148:151], v7 offset:1024
v_mfma_f32_16x16x32_bf16 v[96:99], v[164:167], v[40:43], v[96:99]
v_add_u32 v8, s91, v4
v_mfma_f32_16x16x32_bf16 v[100:103], v[164:167], v[44:47], v[100:103]
ds_read_b128 v[152:155], v7 offset:2048
v_mfma_f32_16x16x32_bf16 v[100:103], v[160:163], v[36:39], v[100:103]
s_waitcnt lgkmcnt(7) vmcnt(12)
v_mfma_f32_16x16x32_bf16 v[120:123], v[168:171], v[48:51], v[120:123]
ds_read_b128 v[156:159], v7 offset:3072
v_mfma_f32_16x16x32_bf16 v[120:123], v[172:175], v[56:59], v[120:123]
s_waitcnt vmcnt(10)
v_mfma_f32_16x16x32_bf16 v[124:127], v[172:175], v[60:63], v[124:127]
ds_read_b128 v[160:163], v7 offset:4096
v_mfma_f32_16x16x32_bf16 v[124:127], v[168:171], v[52:55], v[124:127]
s_waitcnt lgkmcnt(7)
v_mfma_f32_16x16x32_bf16 v[72:75], v[176:179], v[48:51], v[72:75]
ds_read_b128 v[164:167], v7 offset:5120
v_mfma_f32_16x16x32_bf16 v[72:75], v[180:183], v[56:59], v[72:75]
v_mfma_f32_16x16x32_bf16 v[76:79], v[180:183], v[60:63], v[76:79]
ds_read_b128 v[168:171], v7 offset:6144
v_mfma_f32_16x16x32_bf16 v[76:79], v[176:179], v[52:55], v[76:79]
s_waitcnt lgkmcnt(7)
v_mfma_f32_16x16x32_bf16 v[80:83], v[184:187], v[48:51], v[80:83]
ds_read_b128 v[172:175], v7 offset:7168
v_mfma_f32_16x16x32_bf16 v[80:83], v[188:191], v[56:59], v[80:83]
v_mfma_f32_16x16x32_bf16 v[84:87], v[188:191], v[60:63], v[84:87]
ds_read_b128 v[176:179], v7 offset:8192
v_mfma_f32_16x16x32_bf16 v[84:87], v[184:187], v[52:55], v[84:87]
s_waitcnt lgkmcnt(7)
v_mfma_f32_16x16x32_bf16 v[88:91], v[144:147], v[48:51], v[88:91]
ds_read_b128 v[180:183], v7 offset:9216
v_mfma_f32_16x16x32_bf16 v[88:91], v[148:151], v[56:59], v[88:91]
v_mfma_f32_16x16x32_bf16 v[92:95], v[148:151], v[60:63], v[92:95]
ds_read_b128 v[184:187], v7 offset:10240
v_mfma_f32_16x16x32_bf16 v[92:95], v[144:147], v[52:55], v[92:95]
s_waitcnt lgkmcnt(7)
v_mfma_f32_16x16x32_bf16 v[96:99], v[152:155], v[48:51], v[96:99]
ds_read_b128 v[188:191], v7 offset:11264
v_mfma_f32_16x16x32_bf16 v[96:99], v[156:159], v[56:59], v[96:99]
v_mfma_f32_16x16x32_bf16 v[100:103], v[156:159], v[60:63], v[100:103]
ds_read_b128 v[144:147], v7 offset:12288
v_mfma_f32_16x16x32_bf16 v[100:103], v[152:155], v[52:55], v[100:103]
s_waitcnt lgkmcnt(7) vmcnt(9)
v_mfma_f32_16x16x32_bf16 v[120:123], v[160:163], v[64:67], v[120:123]
s_waitcnt vmcnt(8)
ds_read_b128 v[148:151], v7 offset:13312
v_mfma_f32_16x16x32_bf16 v[124:127], v[160:163], v[68:71], v[124:127]
v_mfma_f32_16x16x32_bf16 v[72:75], v[164:167], v[64:67], v[72:75]
ds_read_b128 v[152:155], v7 offset:14336
v_mfma_f32_16x16x32_bf16 v[76:79], v[164:167], v[68:71], v[76:79]
s_waitcnt lgkmcnt(7)
v_mfma_f32_16x16x32_bf16 v[80:83], v[168:171], v[64:67], v[80:83]
ds_read_b128 v[156:159], v7 offset:15360
v_mfma_f32_16x16x32_bf16 v[84:87], v[168:171], v[68:71], v[84:87]
s_add_u32 s91, s91, 16384
s_cmp_ge_u32 s91, 163840
s_cselect_b32 s91, 0, s91
v_mfma_f32_16x16x32_bf16 v[88:91], v[172:175], v[64:67], v[88:91]
ds_read_b128 v[160:163], v8 offset:0
v_add_u32 v7, s91, v4
v_mfma_f32_16x16x32_bf16 v[92:95], v[172:175], v[68:71], v[92:95]
s_waitcnt lgkmcnt(7)
v_mfma_f32_16x16x32_bf16 v[96:99], v[176:179], v[64:67], v[96:99]
ds_read_b128 v[164:167], v8 offset:1024
v_cvt_pk_bf16_f32 v228, v120, v121
v_mfma_f32_16x16x32_bf16 v[100:103], v[176:179], v[68:71], v[100:103]
v_cvt_pk_bf16_f32 v229, v122, v123
v_mfma_f32_16x16x32_bf16 v[104:107], v[180:183], a[64:67], v[104:107]
s_waitcnt lgkmcnt(6)
ds_read_b128 v[168:171], v8 offset:2048
v_cvt_pk_bf16_f32 v230, v124, v125
v_mfma_f32_16x16x32_bf16 v[104:107], v[184:187], a[72:75], v[104:107]
v_cvt_pk_bf16_f32 v231, v126, v127
v_mfma_f32_16x16x32_bf16 v[108:111], v[184:187], a[76:79], v[108:111]
buffer_store_dwordx4 v[228:231], v15, s[24:27], s55 offen offset:0 sc1
v_mfma_f32_16x16x32_bf16 v[108:111], v[180:183], a[68:71], v[108:111]
ds_read_b128 v[172:175], v8 offset:3072
v_cvt_pk_bf16_f32 v72, v72, v73
v_mfma_f32_16x16x32_bf16 v[112:115], v[188:191], a[64:67], v[112:115]
s_waitcnt lgkmcnt(6)
ds_read_b128 v[176:179], v8 offset:4096
v_cvt_pk_bf16_f32 v73, v74, v75
v_mfma_f32_16x16x32_bf16 v[112:115], v[144:147], a[72:75], v[112:115]
v_cvt_pk_bf16_f32 v74, v80, v81
v_mfma_f32_16x16x32_bf16 v[116:119], v[144:147], a[76:79], v[116:119]
ds_read_b128 v[180:183], v8 offset:5120
v_cvt_pk_bf16_f32 v75, v82, v83
v_mfma_f32_16x16x32_bf16 v[116:119], v[188:191], a[68:71], v[116:119]
buffer_store_dwordx4 v[72:75], v15, s[24:27], s52 offen offset:0 sc1
v_mfma_f32_16x16x32_bf16 v[104:107], v[148:151], a[80:83], v[104:107]
s_waitcnt lgkmcnt(6)
ds_read_b128 v[184:187], v8 offset:6144
v_cvt_pk_bf16_f32 v76, v76, v77
v_mfma_f32_16x16x32_bf16 v[104:107], v[152:155], a[88:91], v[104:107]
v_cvt_pk_bf16_f32 v77, v78, v79
v_mfma_f32_16x16x32_bf16 v[108:111], v[152:155], a[92:95], v[108:111]
ds_read_b128 v[188:191], v8 offset:7168
v_cvt_pk_bf16_f32 v78, v84, v85
v_mfma_f32_16x16x32_bf16 v[108:111], v[148:151], a[84:87], v[108:111]
s_waitcnt lgkmcnt(6)
v_cvt_pk_bf16_f32 v79, v86, v87
v_mfma_f32_16x16x32_bf16 v[112:115], v[156:159], a[80:83], v[112:115]
buffer_store_dwordx4 v[76:79], v15, s[24:27], s52 offen offset:1024 sc1
v_mfma_f32_16x16x32_bf16 v[112:115], v[160:163], a[88:91], v[112:115]
ds_read_b128 v[144:147], v8 offset:8192
v_cvt_pk_bf16_f32 v88, v88, v89
v_mfma_f32_16x16x32_bf16 v[116:119], v[160:163], a[92:95], v[116:119]
ds_read_b128 v[148:151], v8 offset:9216
v_cvt_pk_bf16_f32 v89, v90, v91
v_mfma_f32_16x16x32_bf16 v[116:119], v[156:159], a[84:87], v[116:119]
v_cvt_pk_bf16_f32 v90, v96, v97
v_mfma_f32_16x16x32_bf16 v[104:107], v[164:167], a[192:195], v[104:107]
s_waitcnt lgkmcnt(6)
ds_read_b128 v[152:155], v8 offset:10240
v_cvt_pk_bf16_f32 v91, v98, v99
v_mfma_f32_16x16x32_bf16 v[104:107], v[168:171], a[200:203], v[104:107]
buffer_store_dwordx4 v[88:91], v15, s[24:27], s53 offen offset:0 sc1
v_mfma_f32_16x16x32_bf16 v[108:111], v[168:171], a[204:207], v[108:111]
ds_read_b128 v[156:159], v8 offset:11264
v_cvt_pk_bf16_f32 v92, v92, v93
v_mfma_f32_16x16x32_bf16 v[108:111], v[164:167], a[196:199], v[108:111]
v_cvt_pk_bf16_f32 v93, v94, v95
v_mfma_f32_16x16x32_bf16 v[112:115], v[172:175], a[192:195], v[112:115]
s_waitcnt lgkmcnt(6)
ds_read_b128 v[160:163], v8 offset:12288
v_cvt_pk_bf16_f32 v94, v100, v101
v_mfma_f32_16x16x32_bf16 v[112:115], v[176:179], a[200:203], v[112:115]
s_waitcnt lgkmcnt(5)
v_cvt_pk_bf16_f32 v95, v102, v103
v_mfma_f32_16x16x32_bf16 v[116:119], v[176:179], a[204:207], v[116:119]
buffer_store_dwordx4 v[92:95], v15, s[24:27], s53 offen offset:1024 sc1
v_mfma_f32_16x16x32_bf16 v[116:119], v[172:175], a[196:199], v[116:119]
s_mov_b32 m0, s70
s_mov_b32 s64, s68
s_add_u32 s68, s68, 16384
v_mfma_f32_16x16x32_bf16 v[104:107], v[180:183], a[208:211], v[104:107]
s_add_u32 s70, s70, 16384
s_cmp_ge_u32 s70, 163840
s_cselect_b32 s70, s80, s70
v_mfma_f32_16x16x32_bf16 v[104:107], v[184:187], a[216:219], v[104:107]
buffer_load_dwordx4 v15, s[24:27], s64 offen offset:0 sc1 lds
v_mfma_f32_16x16x32_bf16 v[108:111], v[184:187], a[220:223], v[108:111]
s_waitcnt vmcnt(6) lgkmcnt(3)
ds_read_b128 v[164:167], v8 offset:13312
v_mfma_f32_16x16x32_bf16 v[108:111], v[180:183], a[212:215], v[108:111]
s_barrier
v_mfma_f32_16x16x32_bf16 v[112:115], v[188:191], a[208:211], v[112:115]
buffer_load_dwordx4 v15, s[24:27], s64 offen offset:1024 sc1 lds
v_mfma_f32_16x16x32_bf16 v[112:115], v[144:147], a[216:219], v[112:115]
ds_read_b128 v[168:171], v8 offset:14336
v_mfma_f32_16x16x32_bf16 v[116:119], v[144:147], a[220:223], v[116:119]
ds_read_b128 v[172:175], v8 offset:15360
v_mfma_f32_16x16x32_bf16 v[116:119], v[188:191], a[212:215], v[116:119]
buffer_load_dwordx4 v15, s[24:27], s64 offen offset:2048 sc1 lds
v_mfma_f32_16x16x32_bf16 v[104:107], v[148:151], a[224:227], v[104:107]
s_waitcnt lgkmcnt(4)
s_add_u32 s91, s91, 16384
ds_read_b128 v[176:179], v7 offset:0
v_mfma_f32_16x16x32_bf16 v[104:107], v[152:155], a[232:235], v[104:107]
s_cmp_ge_u32 s91, 163840
s_cselect_b32 s91, 0, s91
ds_read_b128 v[180:183], v7 offset:1024
v_mfma_f32_16x16x32_bf16 v[108:111], v[152:155], a[236:239], v[108:111]
buffer_load_dwordx4 v15, s[24:27], s64 offen offset:3072 sc1 lds
v_mfma_f32_16x16x32_bf16 v[108:111], v[148:151], a[228:231], v[108:111]
s_mov_b32 m0, s70
s_mov_b32 s64, s68
s_add_u32 s68, s68, 16384
v_mfma_f32_16x16x32_bf16 v[112:115], v[156:159], a[224:227], v[112:115]
s_waitcnt lgkmcnt(4)
ds_read_b128 v[184:187], v7 offset:2048
v_add_u32 v8, s91, v4
v_mfma_f32_16x16x32_bf16 v[112:115], v[160:163], a[232:235], v[112:115]
s_add_u32 s70, s70, 16384
s_cmp_ge_u32 s70, 163840
s_cselect_b32 s70, s80, s70
v_mfma_f32_16x16x32_bf16 v[116:119], v[160:163], a[236:239], v[116:119]
buffer_load_dwordx4 v15, s[24:27], s64 offen offset:0 sc1 lds
v_mfma_f32_16x16x32_bf16 v[116:119], v[156:159], a[228:231], v[116:119]
ds_read_b128 v[188:191], v7 offset:3072
v_mfma_f32_16x16x32_bf16 v[104:107], v[164:167], a[240:243], v[104:107]
s_waitcnt lgkmcnt(4)
ds_read_b128 v[144:147], v7 offset:4096
v_mfma_f32_16x16x32_bf16 v[104:107], v[168:171], a[248:251], v[104:107]
buffer_load_dwordx4 v15, s[24:27], s64 offen offset:1024 sc1 lds
v_mfma_f32_16x16x32_bf16 v[108:111], v[168:171], a[252:255], v[108:111]
ds_read_b128 v[148:151], v7 offset:5120
v_mfma_f32_16x16x32_bf16 v[108:111], v[164:167], a[244:247], v[108:111]
s_waitcnt lgkmcnt(4)
ds_read_b128 v[152:155], v7 offset:6144
v_mfma_f32_16x16x32_bf16 v[112:115], v[172:175], a[240:243], v[112:115]
buffer_load_dwordx4 v15, s[24:27], s64 offen offset:2048 sc1 lds
v_mfma_f32_16x16x32_bf16 v[112:115], v[176:179], a[248:251], v[112:115]
ds_read_b128 v[156:159], v7 offset:7168
v_mfma_f32_16x16x32_bf16 v[116:119], v[176:179], a[252:255], v[116:119]
ds_read_b128 v[160:163], v7 offset:8192
v_mfma_f32_16x16x32_bf16 v[116:119], v[172:175], a[244:247], v[116:119]
buffer_load_dwordx4 v15, s[24:27], s64 offen offset:3072 sc1 lds
v_mfma_f32_16x16x32_bf16 v[104:107], v[180:183], a[96:99], v[104:107]
s_waitcnt lgkmcnt(5)
ds_read_b128 v[164:167], v7 offset:9216
v_mfma_f32_16x16x32_bf16 v[104:107], v[184:187], a[104:107], v[104:107]
ds_read_b128 v[168:171], v7 offset:10240
v_mfma_f32_16x16x32_bf16 v[108:111], v[184:187], a[108:111], v[108:111]
ds_read_b128 v[172:175], v7 offset:11264
v_mfma_f32_16x16x32_bf16 v[108:111], v[180:183], a[100:103], v[108:111]
v_mfma_f32_16x16x32_bf16 v[112:115], v[188:191], a[96:99], v[112:115]
s_waitcnt lgkmcnt(6)
ds_read_b128 v[176:179], v7 offset:12288
v_mfma_f32_16x16x32_bf16 v[112:115], v[144:147], a[104:107], v[112:115]
v_mfma_f32_16x16x32_bf16 v[116:119], v[144:147], a[108:111], v[116:119]
ds_read_b128 v[180:183], v7 offset:13312
v_mfma_f32_16x16x32_bf16 v[116:119], v[188:191], a[100:103], v[116:119]
v_mfma_f32_16x16x32_bf16 v[104:107], v[148:151], a[112:115], v[104:107]
s_waitcnt lgkmcnt(6)
ds_read_b128 v[184:187], v7 offset:14336
v_mfma_f32_16x16x32_bf16 v[104:107], v[152:155], a[120:123], v[104:107]
v_mfma_f32_16x16x32_bf16 v[108:111], v[152:155], a[124:127], v[108:111]
ds_read_b128 v[188:191], v7 offset:15360
v_mfma_f32_16x16x32_bf16 v[108:111], v[148:151], a[116:119], v[108:111]
s_add_u32 s91, s91, 16384
s_cmp_ge_u32 s91, 163840
s_cselect_b32 s91, 0, s91
v_mfma_f32_16x16x32_bf16 v[112:115], v[156:159], a[112:115], v[112:115]
s_waitcnt lgkmcnt(6)
ds_read_b128 v[144:147], v8 offset:0
v_add_u32 v7, s91, v4
v_mfma_f32_16x16x32_bf16 v[112:115], v[160:163], a[120:123], v[112:115]
v_mfma_f32_16x16x32_bf16 v[116:119], v[160:163], a[124:127], v[116:119]
ds_read_b128 v[148:151], v8 offset:1024
v_mfma_f32_16x16x32_bf16 v[116:119], v[156:159], a[116:119], v[116:119]
s_waitcnt lgkmcnt(6)
v_mfma_f32_16x16x32_bf16 v[104:107], v[164:167], a[128:131], v[104:107]
s_mov_b32 m0, s70
s_mov_b32 s64, s68
s_add_u32 s68, s68, 16384
v_mfma_f32_16x16x32_bf16 v[104:107], v[168:171], a[136:139], v[104:107]
ds_read_b128 v[152:155], v8 offset:2048
v_mfma_f32_16x16x32_bf16 v[108:111], v[168:171], a[140:143], v[108:111]
s_add_u32 s70, s70, 16384
s_cmp_ge_u32 s70, 163840
s_cselect_b32 s70, s80, s70
v_mfma_f32_16x16x32_bf16 v[108:111], v[164:167], a[132:135], v[108:111]
buffer_load_dwordx4 v15, s[24:27], s64 offen offset:0 sc1 lds
v_mfma_f32_16x16x32_bf16 v[112:115], v[172:175], a[128:131], v[112:115]
s_waitcnt lgkmcnt(5)
ds_read_b128 v[156:159], v8 offset:3072
v_mfma_f32_16x16x32_bf16 v[112:115], v[176:179], a[136:139], v[112:115]
ds_read_b128 v[160:163], v8 offset:4096
v_mfma_f32_16x16x32_bf16 v[116:119], v[176:179], a[140:143], v[116:119]
buffer_load_dwordx4 v15, s[24:27], s64 offen offset:1024 sc1 lds
v_mfma_f32_16x16x32_bf16 v[116:119], v[172:175], a[132:135], v[116:119]
ds_read_b128 v[164:167], v8 offset:5120
v_mfma_f32_16x16x32_bf16 v[104:107], v[180:183], a[144:147], v[104:107]
s_waitcnt vmcnt(10) lgkmcnt(6)
ds_read_b128 v[168:171], v8 offset:6144
v_mfma_f32_16x16x32_bf16 v[104:107], v[184:187], a[152:155], v[104:107]
buffer_atomic_add v1, v0, s[24:27], s73 offen offset:0 sc1
v_mfma_f32_16x16x32_bf16 v[108:111], v[184:187], a[156:159], v[108:111]
buffer_load_dwordx4 v15, s[24:27], s64 offen offset:2048 sc1 lds
v_mfma_f32_16x16x32_bf16 v[108:111], v[180:183], a[148:151], v[108:111]
ds_read_b128 v[172:175], v8 offset:7168
v_mfma_f32_16x16x32_bf16 v[112:115], v[188:191], a[144:147], v[112:115]
s_waitcnt lgkmcnt(6)
ds_read_b128 v[176:179], v8 offset:8192
v_mfma_f32_16x16x32_bf16 v[112:115], v[144:147], a[152:155], v[112:115]
buffer_load_dwordx4 v15, s[24:27], s64 offen offset:3072 sc1 lds
v_mfma_f32_16x16x32_bf16 v[116:119], v[144:147], a[156:159], v[116:119]
s_mov_b32 m0, s70
s_mov_b32 s64, s68
s_add_u32 s68, s68, 16384
v_mfma_f32_16x16x32_bf16 v[116:119], v[188:191], a[148:151], v[116:119]
s_waitcnt lgkmcnt(5)
ds_read_b128 v[180:183], v8 offset:9216
v_mfma_f32_16x16x32_bf16 v[104:107], v[148:151], a[160:163], v[104:107]
s_add_u32 s70, s70, 16384
s_cmp_ge_u32 s70, 163840
s_cselect_b32 s70, s80, s70
v_mfma_f32_16x16x32_bf16 v[104:107], v[152:155], a[168:171], v[104:107]
buffer_load_dwordx4 v15, s[24:27], s64 offen offset:0 sc1 lds
v_mfma_f32_16x16x32_bf16 v[108:111], v[152:155], a[172:175], v[108:111]
ds_read_b128 v[184:187], v8 offset:10240
v_mfma_f32_16x16x32_bf16 v[108:111], v[148:151], a[164:167], v[108:111]
s_waitcnt lgkmcnt(5)
ds_read_b128 v[188:191], v8 offset:11264
v_mfma_f32_16x16x32_bf16 v[112:115], v[156:159], a[160:163], v[112:115]
buffer_load_dwordx4 v15, s[24:27], s64 offen offset:1024 sc1 lds
v_mfma_f32_16x16x32_bf16 v[112:115], v[160:163], a[168:171], v[112:115]
ds_read_b128 v[144:147], v8 offset:12288
v_mfma_f32_16x16x32_bf16 v[116:119], v[160:163], a[172:175], v[116:119]
s_add_u32 s82, s84, 3
ds_read_b128 v[148:151], v8 offset:13312
v_mfma_f32_16x16x32_bf16 v[116:119], v[156:159], a[164:167], v[116:119]
buffer_load_dwordx4 v15, s[24:27], s64 offen offset:2048 sc1 lds
v_mfma_f32_16x16x32_bf16 v[104:107], v[164:167], a[176:179], v[104:107]
s_and_b32 s82, s82, 3
s_waitcnt lgkmcnt(6)
ds_read_b128 v[152:155], v8 offset:14336
v_mfma_f32_16x16x32_bf16 v[104:107], v[168:171], a[184:187], v[104:107]
v_mfma_f32_16x16x32_bf16 v[108:111], v[168:171], a[188:191], v[108:111]
s_waitcnt vmcnt(8)
s_lshl4_add_u32 s82, s82, s73
ds_read_b128 v[156:159], v8 offset:15360
v_mfma_f32_16x16x32_bf16 v[108:111], v[164:167], a[180:183], v[108:111]
s_barrier
v_mfma_f32_16x16x32_bf16 v[112:115], v[172:175], a[176:179], v[112:115]
s_lshl4_add_u32 s75, s84, s73
s_waitcnt lgkmcnt(6)
ds_read_b128 v[160:163], v7 offset:0
v_mfma_f32_16x16x32_bf16 v[112:115], v[176:179], a[184:187], v[112:115]
buffer_load_dwordx4 v15, s[24:27], s64 offen offset:3072 sc1 lds
v_mfma_f32_16x16x32_bf16 v[116:119], v[176:179], a[188:191], v[116:119]
s_add_u32 s91, s91, 16384
ds_read_b128 v[164:167], v7 offset:1024
v_mfma_f32_16x16x32_bf16 v[116:119], v[172:175], a[180:183], v[116:119]
s_cmp_ge_u32 s91, 163840
s_cselect_b32 s91, 0, s91
v_add_u32 v8, s91, v4
v_mfma_f32_16x16x32_bf16 v[104:107], v[180:183], v[32:35], v[104:107]
s_waitcnt lgkmcnt(6)
ds_read_b128 v[168:171], v7 offset:2048
v_mfma_f32_16x16x32_bf16 v[104:107], v[184:187], v[40:43], v[104:107]
v_mfma_f32_16x16x32_bf16 v[108:111], v[184:187], v[44:47], v[108:111]
ds_read_b128 v[172:175], v7 offset:3072
v_mfma_f32_16x16x32_bf16 v[108:111], v[180:183], v[36:39], v[108:111]
v_mfma_f32_16x16x32_bf16 v[112:115], v[188:191], v[32:35], v[112:115]
s_waitcnt lgkmcnt(6)
ds_read_b128 v[176:179], v7 offset:4096
v_mfma_f32_16x16x32_bf16 v[112:115], v[144:147], v[40:43], v[112:115]
v_mfma_f32_16x16x32_bf16 v[116:119], v[144:147], v[44:47], v[116:119]
ds_read_b128 v[180:183], v7 offset:5120
v_mfma_f32_16x16x32_bf16 v[116:119], v[188:191], v[36:39], v[116:119]
v_mfma_f32_16x16x32_bf16 v[104:107], v[148:151], v[48:51], v[104:107]
s_waitcnt lgkmcnt(6)
ds_read_b128 v[184:187], v7 offset:6144
v_mfma_f32_16x16x32_bf16 v[104:107], v[152:155], v[56:59], v[104:107]
v_mfma_f32_16x16x32_bf16 v[108:111], v[152:155], v[60:63], v[108:111]
ds_read_b128 v[188:191], v7 offset:7168
v_mfma_f32_16x16x32_bf16 v[108:111], v[148:151], v[52:55], v[108:111]
v_mfma_f32_16x16x32_bf16 v[112:115], v[156:159], v[48:51], v[112:115]
s_waitcnt lgkmcnt(6)
ds_read_b128 v[144:147], v7 offset:8192
v_mfma_f32_16x16x32_bf16 v[112:115], v[160:163], v[56:59], v[112:115]
v_mfma_f32_16x16x32_bf16 v[116:119], v[160:163], v[60:63], v[116:119]
ds_read_b128 v[148:151], v7 offset:9216
v_mfma_f32_16x16x32_bf16 v[116:119], v[156:159], v[52:55], v[116:119]
v_mfma_f32_16x16x32_bf16 v[104:107], v[164:167], v[64:67], v[104:107]
ds_read_b128 v[152:155], v7 offset:10240
v_mfma_f32_16x16x32_bf16 v[108:111], v[164:167], v[68:71], v[108:111]
s_waitcnt lgkmcnt(7)
v_mfma_f32_16x16x32_bf16 v[112:115], v[168:171], v[64:67], v[112:115]
ds_read_b128 v[156:159], v7 offset:11264
v_mfma_f32_16x16x32_bf16 v[116:119], v[168:171], v[68:71], v[116:119]
v_mfma_f32_16x16x32_bf16 v[128:131], v[172:175], a[0:3], 0
s_waitcnt lgkmcnt(6)
ds_read_b128 v[160:163], v7 offset:12288
v_mfma_f32_16x16x32_bf16 v[128:131], v[176:179], a[8:11], v[128:131]
v_mfma_f32_16x16x32_bf16 v[132:135], v[176:179], a[12:15], 0
ds_read_b128 v[164:167], v7 offset:13312
v_mfma_f32_16x16x32_bf16 v[132:135], v[172:175], a[4:7], v[132:135]
v_mfma_f32_16x16x32_bf16 v[136:139], v[180:183], a[0:3], 0
s_waitcnt lgkmcnt(6)
ds_read_b128 v[168:171], v7 offset:14336
v_mfma_f32_16x16x32_bf16 v[136:139], v[184:187], a[8:11], v[136:139]
v_cvt_pk_bf16_f32 v104, v104, v105
v_mfma_f32_16x16x32_bf16 v[140:143], v[184:187], a[12:15], 0
ds_read_b128 v[172:175], v7 offset:15360
v_cvt_pk_bf16_f32 v105, v106, v107
v_mfma_f32_16x16x32_bf16 v[140:143], v[180:183], a[4:7], v[140:143]
s_add_u32 s91, s91, 16384
v_cvt_pk_bf16_f32 v106, v112, v113
v_mfma_f32_16x16x32_bf16 v[128:131], v[188:191], a[16:19], v[128:131]
s_waitcnt lgkmcnt(6)
ds_read_b128 v[176:179], v8 offset:0
v_cvt_pk_bf16_f32 v107, v114, v115
v_mfma_f32_16x16x32_bf16 v[128:131], v[144:147], a[24:27], v[128:131]
buffer_store_dwordx4 v[104:107], v15, s[24:27], s54 offen offset:0 sc1
v_mfma_f32_16x16x32_bf16 v[132:135], v[144:147], a[28:31], v[132:135]
ds_read_b128 v[180:183], v8 offset:1024
v_cvt_pk_bf16_f32 v108, v108, v109
v_mfma_f32_16x16x32_bf16 v[132:135], v[188:191], a[20:23], v[132:135]
s_cmp_ge_u32 s91, 163840
s_cselect_b32 s91, 0, s91
v_cvt_pk_bf16_f32 v109, v110, v111
v_mfma_f32_16x16x32_bf16 v[136:139], v[148:151], a[16:19], v[136:139]
s_waitcnt lgkmcnt(6)
ds_read_b128 v[184:187], v8 offset:2048
v_cvt_pk_bf16_f32 v110, v116, v117
v_mfma_f32_16x16x32_bf16 v[136:139], v[152:155], a[24:27], v[136:139]
s_waitcnt lgkmcnt(5)
v_cvt_pk_bf16_f32 v111, v118, v119
v_add_u32 v7, s91, v4
v_mfma_f32_16x16x32_bf16 v[140:143], v[152:155], a[28:31], v[140:143]
buffer_store_dwordx4 v[108:111], v15, s[24:27], s54 offen offset:1024 sc1
v_mfma_f32_16x16x32_bf16 v[140:143], v[148:151], a[20:23], v[140:143]
s_mov_b32 m0, s70
s_mov_b32 s64, s68
s_add_u32 s68, s68, 16384
v_mfma_f32_16x16x32_bf16 v[128:131], v[156:159], a[32:35], v[128:131]
s_cmp_lt_u32 s3, 3
s_cselect_b32 s68, s64, 2147418112
ds_read_b128 v[188:191], v8 offset:3072
v_mfma_f32_16x16x32_bf16 v[128:131], v[160:163], a[40:43], v[128:131]
buffer_load_dwordx4 v15, s[24:27], s64 offen offset:0 sc1 lds
v_mfma_f32_16x16x32_bf16 v[132:135], v[160:163], a[44:47], v[132:135]
ds_read_b128 v[144:147], v8 offset:4096
v_mfma_f32_16x16x32_bf16 v[132:135], v[156:159], a[36:39], v[132:135]
s_waitcnt lgkmcnt(5)
ds_read_b128 v[148:151], v8 offset:5120
v_mfma_f32_16x16x32_bf16 v[136:139], v[164:167], a[32:35], v[136:139]
buffer_load_dwordx4 v15, s[24:27], s68 offen offset:1024 sc1 lds
v_mfma_f32_16x16x32_bf16 v[136:139], v[168:171], a[40:43], v[136:139]
ds_read_b128 v[152:155], v8 offset:6144
v_mfma_f32_16x16x32_bf16 v[140:143], v[168:171], a[44:47], v[140:143]
ds_read_b128 v[156:159], v8 offset:7168
v_mfma_f32_16x16x32_bf16 v[140:143], v[164:167], a[36:39], v[140:143]
buffer_load_dwordx4 v15, s[24:27], s68 offen offset:2048 sc1 lds
v_mfma_f32_16x16x32_bf16 v[128:131], v[172:175], a[48:51], v[128:131]
s_waitcnt lgkmcnt(6)
ds_read_b128 v[160:163], v8 offset:8192
v_mfma_f32_16x16x32_bf16 v[128:131], v[176:179], a[56:59], v[128:131]
v_mfma_f32_16x16x32_bf16 v[132:135], v[176:179], a[60:63], v[132:135]
buffer_load_dwordx4 v15, s[24:27], s68 offen offset:3072 sc1 lds
v_mfma_f32_16x16x32_bf16 v[132:135], v[172:175], a[52:55], v[132:135]
buffer_load_dword v12, v10, s[24:27], s73 offen sc1
v_mfma_f32_16x16x32_bf16 v[136:139], v[180:183], a[48:51], v[136:139]
s_waitcnt lgkmcnt(5)
ds_read_b128 v[164:167], v8 offset:9216
v_mfma_f32_16x16x32_bf16 v[136:139], v[184:187], a[56:59], v[136:139]
ds_read_b128 v[168:171], v8 offset:10240
v_mfma_f32_16x16x32_bf16 v[140:143], v[184:187], a[60:63], v[140:143]
ds_read_b128 v[172:175], v8 offset:11264
v_mfma_f32_16x16x32_bf16 v[140:143], v[180:183], a[52:55], v[140:143]
v_mfma_f32_16x16x32_bf16 v[128:131], v[188:191], a[64:67], v[128:131]
s_waitcnt lgkmcnt(6)
ds_read_b128 v[176:179], v8 offset:12288
v_mfma_f32_16x16x32_bf16 v[128:131], v[144:147], a[72:75], v[128:131]
v_mfma_f32_16x16x32_bf16 v[132:135], v[144:147], a[76:79], v[132:135]
ds_read_b128 v[180:183], v8 offset:13312
v_mfma_f32_16x16x32_bf16 v[132:135], v[188:191], a[68:71], v[132:135]
v_mfma_f32_16x16x32_bf16 v[136:139], v[148:151], a[64:67], v[136:139]
s_waitcnt lgkmcnt(6)
ds_read_b128 v[184:187], v8 offset:14336
v_mfma_f32_16x16x32_bf16 v[136:139], v[152:155], a[72:75], v[136:139]
v_mfma_f32_16x16x32_bf16 v[140:143], v[152:155], a[76:79], v[140:143]
s_waitcnt vmcnt(7)
ds_read_b128 v[188:191], v8 offset:15360
v_mfma_f32_16x16x32_bf16 v[140:143], v[148:151], a[68:71], v[140:143]
s_barrier
v_mfma_f32_16x16x32_bf16 v[128:131], v[156:159], a[80:83], v[128:131]
s_waitcnt lgkmcnt(6)
s_add_u32 s91, s91, 16384
ds_read_b128 v[144:147], v7 offset:0
v_mfma_f32_16x16x32_bf16 v[128:131], v[160:163], a[88:91], v[128:131]
s_cmp_ge_u32 s91, 163840
s_cselect_b32 s91, 0, s91
v_add_u32 v8, s91, v4
v_mfma_f32_16x16x32_bf16 v[132:135], v[160:163], a[92:95], v[132:135]
ds_read_b128 v[148:151], v7 offset:1024
v_mfma_f32_16x16x32_bf16 v[132:135], v[156:159], a[84:87], v[132:135]
v_mfma_f32_16x16x32_bf16 v[136:139], v[164:167], a[80:83], v[136:139]
s_waitcnt vmcnt(5) lgkmcnt(6)
ds_read_b128 v[152:155], v7 offset:2048
v_mfma_f32_16x16x32_bf16 v[136:139], v[168:171], a[88:91], v[136:139]
buffer_atomic_add v1, v0, s[24:27], s82 offen offset:16 sc1
v_mfma_f32_16x16x32_bf16 v[140:143], v[168:171], a[92:95], v[140:143]
s_and_b32 s54, s3, 1
ds_read_b128 v[156:159], v7 offset:3072
v_mfma_f32_16x16x32_bf16 v[140:143], v[164:167], a[84:87], v[140:143]
s_mul_i32 s54, s54, 18432
v_mfma_f32_16x16x32_bf16 v[128:131], v[172:175], a[192:195], v[128:131]
s_waitcnt lgkmcnt(6)
s_mul_i32 s55, s86, 288
ds_read_b128 v[160:163], v7 offset:4096
v_mfma_f32_16x16x32_bf16 v[128:131], v[176:179], a[200:203], v[128:131]
s_add_u32 s54, s54, s55
v_mfma_f32_16x16x32_bf16 v[132:135], v[176:179], a[204:207], v[132:135]
s_add_u32 s54, s54, 256
ds_read_b128 v[164:167], v7 offset:5120
v_mfma_f32_16x16x32_bf16 v[132:135], v[172:175], a[196:199], v[132:135]
s_sub_u32 s55, 63, s72
v_mfma_f32_16x16x32_bf16 v[136:139], v[180:183], a[192:195], v[136:139]
s_waitcnt lgkmcnt(6)
s_mul_i32 s55, s55, 36864
ds_read_b128 v[168:171], v7 offset:6144
v_mfma_f32_16x16x32_bf16 v[136:139], v[184:187], a[200:203], v[136:139]
s_waitcnt vmcnt(1)
s_add_u32 s55, s55, s54
v_cmp_gt_u32 vcc, 4, v12
v_mfma_f32_16x16x32_bf16 v[140:143], v[184:187], a[204:207], v[140:143]
s_mul_i32 s52, s72, 36864
ds_read_b128 v[172:175], v7 offset:7168
v_mfma_f32_16x16x32_bf16 v[140:143], v[180:183], a[196:199], v[140:143]
s_waitcnt lgkmcnt(6)
s_add_u32 s54, s54, s52
v_mfma_f32_16x16x32_bf16 v[128:131], v[188:191], a[208:211], v[128:131]
s_cmp_eq_u64 vcc, 0
s_cselect_b32 s81, s69, 2147418112
s_cselect_b32 s93, s71, 2147418112
v_mfma_f32_16x16x32_bf16 v[128:131], v[144:147], a[216:219], v[128:131]
s_lshl_b32 s53, s84, 6
ds_read_b128 v[176:179], v7 offset:8192
v_mfma_f32_16x16x32_bf16 v[132:135], v[144:147], a[220:223], v[132:135]
s_sub_u32 s53, s53, 256
ds_read_b128 v[180:183], v7 offset:9216
v_mfma_f32_16x16x32_bf16 v[132:135], v[188:191], a[212:215], v[132:135]
buffer_load_dwordx4 v[192:195], v15, s[24:27], s81 offen offset:0 sc1
v_mfma_f32_16x16x32_bf16 v[136:139], v[148:151], a[208:211], v[136:139]
s_waitcnt lgkmcnt(6)
s_add_u32 s52, s54, s53
ds_read_b128 v[184:187], v7 offset:10240
v_mfma_f32_16x16x32_bf16 v[136:139], v[152:155], a[216:219], v[136:139]
s_add_u32 s53, s55, s53
v_mfma_f32_16x16x32_bf16 v[140:143], v[152:155], a[220:223], v[140:143]
buffer_load_dwordx4 v[196:199], v15, s[24:27], s81 offen offset:1024 sc1
v_mfma_f32_16x16x32_bf16 v[140:143], v[148:151], a[212:215], v[140:143]
L_PAD13:
s_cbranch_execz L_MAIN
ds_read_b128 v[188:191], v7 offset:11264
v_mfma_f32_16x16x32_bf16 v[128:131], v[156:159], a[224:227], v[128:131]
s_waitcnt lgkmcnt(6)
ds_read_b128 v[144:147], v7 offset:12288
v_mfma_f32_16x16x32_bf16 v[128:131], v[160:163], a[232:235], v[128:131]
buffer_load_dwordx4 v[200:203], v15, s[24:27], s81 offen offset:2048 sc1
v_mfma_f32_16x16x32_bf16 v[132:135], v[160:163], a[236:239], v[132:135]
ds_read_b128 v[148:151], v7 offset:13312
v_mfma_f32_16x16x32_bf16 v[132:135], v[156:159], a[228:231], v[132:135]
s_waitcnt lgkmcnt(6)
v_mfma_f32_16x16x32_bf16 v[136:139], v[164:167], a[224:227], v[136:139]
buffer_load_dwordx4 v[204:207], v15, s[24:27], s81 offen offset:3072 sc1
v_mfma_f32_16x16x32_bf16 v[136:139], v[168:171], a[232:235], v[136:139]
ds_read_b128 v[152:155], v7 offset:14336
v_mfma_f32_16x16x32_bf16 v[140:143], v[168:171], a[236:239], v[140:143]
ds_read_b128 v[156:159], v7 offset:15360
v_mfma_f32_16x16x32_bf16 v[140:143], v[164:167], a[228:231], v[140:143]
buffer_load_dwordx4 v[208:211], v15, s[24:27], s93 offen offset:0 sc1
v_mfma_f32_16x16x32_bf16 v[128:131], v[172:175], a[240:243], v[128:131]
s_waitcnt lgkmcnt(6)
s_add_u32 s91, s91, 16384
ds_read_b128 v[160:163], v8 offset:0
v_mfma_f32_16x16x32_bf16 v[128:131], v[176:179], a[248:251], v[128:131]
s_cmp_ge_u32 s91, 163840
s_cselect_b32 s91, 0, s91
v_add_u32 v7, s91, v4
v_mfma_f32_16x16x32_bf16 v[132:135], v[176:179], a[252:255], v[132:135]
buffer_load_dwordx4 v[212:215], v15, s[24:27], s93 offen offset:1024 sc1
v_mfma_f32_16x16x32_bf16 v[132:135], v[172:175], a[244:247], v[132:135]
ds_read_b128 v[164:167], v8 offset:1024
v_mfma_f32_16x16x32_bf16 v[136:139], v[180:183], a[240:243], v[136:139]
s_waitcnt lgkmcnt(6)
ds_read_b128 v[168:171], v8 offset:2048
v_mfma_f32_16x16x32_bf16 v[136:139], v[184:187], a[248:251], v[136:139]
buffer_load_dwordx4 v[216:219], v15, s[24:27], s93 offen offset:2048 sc1
v_mfma_f32_16x16x32_bf16 v[140:143], v[184:187], a[252:255], v[140:143]
ds_read_b128 v[172:175], v8 offset:3072
v_mfma_f32_16x16x32_bf16 v[140:143], v[180:183], a[244:247], v[140:143]
v_mfma_f32_16x16x32_bf16 v[128:131], v[188:191], a[96:99], v[128:131]
s_waitcnt lgkmcnt(6)
ds_read_b128 v[176:179], v8 offset:4096
v_mfma_f32_16x16x32_bf16 v[128:131], v[144:147], a[104:107], v[128:131]
v_mfma_f32_16x16x32_bf16 v[132:135], v[144:147], a[108:111], v[132:135]
ds_read_b128 v[180:183], v8 offset:5120
v_mfma_f32_16x16x32_bf16 v[132:135], v[188:191], a[100:103], v[132:135]
v_mfma_f32_16x16x32_bf16 v[136:139], v[148:151], a[96:99], v[136:139]
s_waitcnt lgkmcnt(6)
ds_read_b128 v[184:187], v8 offset:6144
v_mfma_f32_16x16x32_bf16 v[136:139], v[152:155], a[104:107], v[136:139]
v_mfma_f32_16x16x32_bf16 v[140:143], v[152:155], a[108:111], v[140:143]
ds_read_b128 v[188:191], v8 offset:7168
v_mfma_f32_16x16x32_bf16 v[140:143], v[148:151], a[100:103], v[140:143]
v_mfma_f32_16x16x32_bf16 v[128:131], v[156:159], a[112:115], v[128:131]
s_waitcnt lgkmcnt(6)
ds_read_b128 v[144:147], v8 offset:8192
v_mfma_f32_16x16x32_bf16 v[128:131], v[160:163], a[120:123], v[128:131]
v_mfma_f32_16x16x32_bf16 v[132:135], v[160:163], a[124:127], v[132:135]
ds_read_b128 v[148:151], v8 offset:9216
v_mfma_f32_16x16x32_bf16 v[132:135], v[156:159], a[116:119], v[132:135]
s_waitcnt lgkmcnt(6)
v_mfma_f32_16x16x32_bf16 v[136:139], v[164:167], a[112:115], v[136:139]
buffer_load_dword v12, v10, s[24:27], s75 offen offset:16 sc1
v_mfma_f32_16x16x32_bf16 v[136:139], v[168:171], a[120:123], v[136:139]
ds_read_b128 v[152:155], v8 offset:10240
v_mfma_f32_16x16x32_bf16 v[140:143], v[168:171], a[124:127], v[140:143]
ds_read_b128 v[156:159], v8 offset:11264
v_mfma_f32_16x16x32_bf16 v[140:143], v[164:167], a[116:119], v[140:143]
v_mfma_f32_16x16x32_bf16 v[128:131], v[172:175], a[128:131], v[128:131]
s_waitcnt lgkmcnt(6)
ds_read_b128 v[160:163], v8 offset:12288
v_mfma_f32_16x16x32_bf16 v[128:131], v[176:179], a[136:139], v[128:131]
v_mfma_f32_16x16x32_bf16 v[132:135], v[176:179], a[140:143], v[132:135]
ds_read_b128 v[164:167], v8 offset:13312
v_mfma_f32_16x16x32_bf16 v[132:135], v[172:175], a[132:135], v[132:135]
v_mfma_f32_16x16x32_bf16 v[136:139], v[180:183], a[128:131], v[136:139]
s_waitcnt lgkmcnt(6)
ds_read_b128 v[168:171], v8 offset:14336
v_mfma_f32_16x16x32_bf16 v[136:139], v[184:187], a[136:139], v[136:139]
v_mfma_f32_16x16x32_bf16 v[140:143], v[184:187], a[140:143], v[140:143]
s_waitcnt vmcnt(10)
ds_read_b128 v[172:175], v8 offset:15360
v_mfma_f32_16x16x32_bf16 v[140:143], v[180:183], a[132:135], v[140:143]
s_barrier
v_mfma_f32_16x16x32_bf16 v[128:131], v[188:191], a[144:147], v[128:131]
s_waitcnt lgkmcnt(6)
ds_read_b128 v[176:179], v7 offset:0
v_mfma_f32_16x16x32_bf16 v[128:131], v[144:147], a[152:155], v[128:131]
v_mfma_f32_16x16x32_bf16 v[132:135], v[144:147], a[156:159], v[132:135]
ds_read_b128 v[180:183], v7 offset:1024
v_mfma_f32_16x16x32_bf16 v[132:135], v[188:191], a[148:151], v[132:135]
v_mfma_f32_16x16x32_bf16 v[136:139], v[148:151], a[144:147], v[136:139]
s_waitcnt lgkmcnt(6)
ds_read_b128 v[184:187], v7 offset:2048
v_mfma_f32_16x16x32_bf16 v[136:139], v[152:155], a[152:155], v[136:139]
v_mfma_f32_16x16x32_bf16 v[140:143], v[152:155], a[156:159], v[140:143]
ds_read_b128 v[188:191], v7 offset:3072
v_mfma_f32_16x16x32_bf16 v[140:143], v[148:151], a[148:151], v[140:143]
v_mfma_f32_16x16x32_bf16 v[128:131], v[156:159], a[160:163], v[128:131]
s_waitcnt lgkmcnt(6)
ds_read_b128 v[144:147], v7 offset:4096
v_mfma_f32_16x16x32_bf16 v[128:131], v[160:163], a[168:171], v[128:131]
v_mfma_f32_16x16x32_bf16 v[132:135], v[160:163], a[172:175], v[132:135]
ds_read_b128 v[148:151], v7 offset:5120
v_mfma_f32_16x16x32_bf16 v[132:135], v[156:159], a[164:167], v[132:135]
v_mfma_f32_16x16x32_bf16 v[136:139], v[164:167], a[160:163], v[136:139]
s_waitcnt lgkmcnt(6)
ds_read_b128 v[152:155], v7 offset:6144
v_mfma_f32_16x16x32_bf16 v[136:139], v[168:171], a[168:171], v[136:139]
v_mfma_f32_16x16x32_bf16 v[140:143], v[168:171], a[172:175], v[140:143]
s_waitcnt vmcnt(0)
ds_read_b128 v[156:159], v7 offset:7168
v_cmp_gt_u32 vcc, 1, v12
v_mfma_f32_16x16x32_bf16 v[140:143], v[164:167], a[164:167], v[140:143]
v_lshlrev_b32 v72, 16, v192
v_and_b32 v73, v13, v192
v_mfma_f32_16x16x32_bf16 v[128:131], v[172:175], a[176:179], v[128:131]
s_waitcnt lgkmcnt(6)
ds_read_b128 v[160:163], v7 offset:8192
v_lshlrev_b32 v74, 16, v193
v_mfma_f32_16x16x32_bf16 v[128:131], v[176:179], a[184:187], v[128:131]
s_cmp_eq_u64 vcc, 0
s_cselect_b32 s77, s83, 2147418112
v_and_b32 v75, v13, v193
v_mfma_f32_16x16x32_bf16 v[132:135], v[176:179], a[188:191], v[132:135]
buffer_load_dwordx4 v[220:223], v15, s[24:27], s77 offen offset:0 sc1
v_mfma_f32_16x16x32_bf16 v[132:135], v[172:175], a[180:183], v[132:135]
s_waitcnt lgkmcnt(5)
ds_read_b128 v[164:167], v7 offset:9216
v_lshlrev_b32 v80, 16, v194
v_mfma_f32_16x16x32_bf16 v[136:139], v[180:183], a[176:179], v[136:139]
buffer_load_dwordx4 v[224:227], v15, s[24:27], s77 offen offset:1024 sc1
v_mfma_f32_16x16x32_bf16 v[136:139], v[184:187], a[184:187], v[136:139]
ds_read_b128 v[168:171], v7 offset:10240
v_and_b32 v81, v13, v194
v_mfma_f32_16x16x32_bf16 v[140:143], v[184:187], a[188:191], v[140:143]
ds_read_b128 v[172:175], v7 offset:11264
v_lshlrev_b32 v82, 16, v195
v_mfma_f32_16x16x32_bf16 v[140:143], v[180:183], a[180:183], v[140:143]
s_waitcnt lgkmcnt(6)
v_and_b32 v83, v13, v195
v_lshlrev_b32 v76, 16, v196
v_mfma_f32_16x16x32_bf16 v[128:131], v[188:191], v[32:35], v[128:131]
buffer_load_dword v11, v10, s[24:27], s73 offen sc1
v_mfma_f32_16x16x32_bf16 v[128:131], v[144:147], v[40:43], v[128:131]
ds_read_b128 v[176:179], v7 offset:12288
v_and_b32 v77, v13, v196
v_mfma_f32_16x16x32_bf16 v[132:135], v[144:147], v[44:47], v[132:135]
buffer_load_dword v12, v10, s[24:27], s75 offen offset:16 sc1
v_mfma_f32_16x16x32_bf16 v[132:135], v[188:191], v[36:39], v[132:135]
v_lshlrev_b32 v78, 16, v197
v_and_b32 v79, v13, v197
v_mfma_f32_16x16x32_bf16 v[136:139], v[148:151], v[32:35], v[136:139]
s_waitcnt lgkmcnt(5)
v_lshlrev_b32 v84, 16, v198
v_and_b32 v85, v13, v198
v_mfma_f32_16x16x32_bf16 v[136:139], v[152:155], v[40:43], v[136:139]
v_lshlrev_b32 v86, 16, v199
v_and_b32 v87, v13, v199
v_mfma_f32_16x16x32_bf16 v[140:143], v[152:155], v[44:47], v[140:143]
v_lshlrev_b32 v88, 16, v200
v_and_b32 v89, v13, v200
v_mfma_f32_16x16x32_bf16 v[140:143], v[148:151], v[36:39], v[140:143]
v_lshlrev_b32 v90, 16, v201
v_and_b32 v91, v13, v201
v_mfma_f32_16x16x32_bf16 v[128:131], v[156:159], v[48:51], v[128:131]
s_waitcnt lgkmcnt(3)
v_lshlrev_b32 v96, 16, v202
v_and_b32 v97, v13, v202
v_mfma_f32_16x16x32_bf16 v[128:131], v[160:163], v[56:59], v[128:131]
v_lshlrev_b32 v98, 16, v203
v_and_b32 v99, v13, v203
v_mfma_f32_16x16x32_bf16 v[132:135], v[160:163], v[60:63], v[132:135]
v_lshlrev_b32 v92, 16, v204
v_and_b32 v93, v13, v204
v_mfma_f32_16x16x32_bf16 v[132:135], v[156:159], v[52:55], v[132:135]
v_lshlrev_b32 v94, 16, v205
v_and_b32 v95, v13, v205
v_mfma_f32_16x16x32_bf16 v[136:139], v[164:167], v[48:51], v[136:139]
s_waitcnt lgkmcnt(1)
v_lshlrev_b32 v100, 16, v206
v_and_b32 v101, v13, v206
v_mfma_f32_16x16x32_bf16 v[136:139], v[168:171], v[56:59], v[136:139]
v_lshlrev_b32 v102, 16, v207
v_and_b32 v103, v13, v207
v_mfma_f32_16x16x32_bf16 v[140:143], v[168:171], v[60:63], v[140:143]
v_mfma_f32_16x16x32_bf16 v[140:143], v[164:167], v[52:55], v[140:143]
v_mfma_f32_16x16x32_bf16 v[128:131], v[172:175], v[64:67], v[128:131]
v_mfma_f32_16x16x32_bf16 v[132:135], v[172:175], v[68:71], v[132:135]
s_waitcnt lgkmcnt(0)
v_mfma_f32_16x16x32_bf16 v[136:139], v[176:179], v[64:67], v[136:139]
v_mfma_f32_16x16x32_bf16 v[140:143], v[176:179], v[68:71], v[140:143]
s_max_u32 s92, s81, s77
s_cmp_lt_u32 s92, 2147418112
s_cbranch_scc1 L_P1
s_mov_b32 s92, 0
s_branch L_S1
L_S0:
buffer_load_dword v11, v10, s[24:27], s73 offen sc1
buffer_load_dword v12, v10, s[24:27], s75 offen offset:16 sc1
L_S1:
s_add_u32 s92, s92, 1
s_waitcnt vmcnt(0)
v_lshrrev_b32 v11, 2, v11
v_min_u32 v11, v11, v12
v_cmp_gt_u32 vcc, 1, v11
s_cmp_gt_u32 s92, 1048576
s_cbranch_scc1 L_S2
s_nop 2
s_cbranch_vccnz L_S0
L_S2:
buffer_load_dwordx4 v[220:223], v15, s[24:27], s83 offen offset:0 sc1
buffer_load_dwordx4 v[224:227], v15, s[24:27], s83 offen offset:1024 sc1
s_cmp_eq_u32 s81, s69
s_cbranch_scc1 L_P1
buffer_load_dwordx4 v[192:195], v15, s[24:27], s69 offen offset:0 sc1
buffer_load_dwordx4 v[196:199], v15, s[24:27], s69 offen offset:1024 sc1
buffer_load_dwordx4 v[200:203], v15, s[24:27], s69 offen offset:2048 sc1
buffer_load_dwordx4 v[204:207], v15, s[24:27], s69 offen offset:3072 sc1
buffer_load_dwordx4 v[208:211], v15, s[24:27], s71 offen offset:0 sc1
buffer_load_dwordx4 v[212:215], v15, s[24:27], s71 offen offset:1024 sc1
buffer_load_dwordx4 v[216:219], v15, s[24:27], s71 offen offset:2048 sc1
s_waitcnt vmcnt(3)
v_lshlrev_b32 v72, 16, v192
v_and_b32 v73, v13, v192
v_lshlrev_b32 v74, 16, v193
v_and_b32 v75, v13, v193
v_lshlrev_b32 v80, 16, v194
v_and_b32 v81, v13, v194
v_lshlrev_b32 v82, 16, v195
v_and_b32 v83, v13, v195
v_lshlrev_b32 v76, 16, v196
v_and_b32 v77, v13, v196
v_lshlrev_b32 v78, 16, v197
v_and_b32 v79, v13, v197
v_lshlrev_b32 v84, 16, v198
v_and_b32 v85, v13, v198
v_lshlrev_b32 v86, 16, v199
v_and_b32 v87, v13, v199
v_lshlrev_b32 v88, 16, v200
v_and_b32 v89, v13, v200
v_lshlrev_b32 v90, 16, v201
v_and_b32 v91, v13, v201
v_lshlrev_b32 v96, 16, v202
v_and_b32 v97, v13, v202
v_lshlrev_b32 v98, 16, v203
v_and_b32 v99, v13, v203
v_lshlrev_b32 v92, 16, v204
v_and_b32 v93, v13, v204
v_lshlrev_b32 v94, 16, v205
v_and_b32 v95, v13, v205
v_lshlrev_b32 v100, 16, v206
v_and_b32 v101, v13, v206
v_lshlrev_b32 v102, 16, v207
v_and_b32 v103, v13, v207
s_waitcnt vmcnt(0)
L_P1:
s_nop 1
v_pk_add_f32 v[72:73], v[72:73], v[88:89]
v_pk_add_f32 v[74:75], v[74:75], v[90:91]
v_pk_add_f32 v[76:77], v[76:77], v[92:93]
v_pk_add_f32 v[78:79], v[78:79], v[94:95]
v_pk_add_f32 v[80:81], v[80:81], v[96:97]
v_pk_add_f32 v[82:83], v[82:83], v[98:99]
v_pk_add_f32 v[84:85], v[84:85], v[100:101]
v_pk_add_f32 v[86:87], v[86:87], v[102:103]
v_pk_add_f32 v[128:129], v[128:129], v[72:73]
v_pk_add_f32 v[130:131], v[130:131], v[74:75]
v_pk_add_f32 v[132:133], v[132:133], v[76:77]
v_pk_add_f32 v[134:135], v[134:135], v[78:79]
v_pk_add_f32 v[136:137], v[136:137], v[80:81]
v_pk_add_f32 v[138:139], v[138:139], v[82:83]
v_pk_add_f32 v[140:141], v[140:141], v[84:85]
v_pk_add_f32 v[142:143], v[142:143], v[86:87]
s_cmp_lg_u32 s3, s84
s_cbranch_scc1 L_NO9
v_lshlrev_b32 v16, 16, v208
v_and_b32 v17, v13, v208
v_lshlrev_b32 v18, 16, v209
v_and_b32 v19, v13, v209
v_lshlrev_b32 v20, 16, v210
v_and_b32 v21, v13, v210
v_lshlrev_b32 v22, 16, v211
v_and_b32 v23, v13, v211
v_pk_add_f32 v[120:121], v[120:121], v[16:17]
v_pk_add_f32 v[122:123], v[122:123], v[18:19]
v_pk_add_f32 v[124:125], v[124:125], v[20:21]
v_pk_add_f32 v[126:127], v[126:127], v[22:23]
v_lshlrev_b32 v16, 16, v212
v_and_b32 v17, v13, v212
v_lshlrev_b32 v18, 16, v213
v_and_b32 v19, v13, v213
v_lshlrev_b32 v20, 16, v214
v_and_b32 v21, v13, v214
v_lshlrev_b32 v22, 16, v215
v_and_b32 v23, v13, v215
v_pk_add_f32 v[120:121], v[120:121], v[16:17]
v_pk_add_f32 v[122:123], v[122:123], v[18:19]
v_pk_add_f32 v[124:125], v[124:125], v[20:21]
v_pk_add_f32 v[126:127], v[126:127], v[22:23]
v_lshlrev_b32 v16, 16, v216
v_and_b32 v17, v13, v216
v_lshlrev_b32 v18, 16, v217
v_and_b32 v19, v13, v217
v_lshlrev_b32 v20, 16, v218
v_and_b32 v21, v13, v218
v_lshlrev_b32 v22, 16, v219
v_and_b32 v23, v13, v219
v_pk_add_f32 v[120:121], v[120:121], v[16:17]
v_pk_add_f32 v[122:123], v[122:123], v[18:19]
v_pk_add_f32 v[124:125], v[124:125], v[20:21]
v_pk_add_f32 v[126:127], v[126:127], v[22:23]
v_cvt_pk_bf16_f32 v228, v120, v121
v_cvt_pk_bf16_f32 v229, v122, v123
v_cvt_pk_bf16_f32 v230, v124, v125
v_cvt_pk_bf16_f32 v231, v126, v127
s_waitcnt vmcnt(0)
buffer_store_dwordx2 v[228:229], v6, s[44:47], s54 offen sc1
buffer_store_dwordx2 v[230:231], v6, s[44:47], s55 offen sc1
s_branch L_9D
L_NO9:
s_waitcnt vmcnt(0)
L_9D:
v_lshlrev_b32 v16, 16, v220
v_and_b32 v17, v13, v220
v_lshlrev_b32 v18, 16, v221
v_and_b32 v19, v13, v221
v_lshlrev_b32 v20, 16, v222
v_and_b32 v21, v13, v222
v_lshlrev_b32 v22, 16, v223
v_and_b32 v23, v13, v223
v_pk_add_f32 v[128:129], v[128:129], v[16:17]
v_pk_add_f32 v[130:131], v[130:131], v[18:19]
v_pk_add_f32 v[136:137], v[136:137], v[20:21]
v_pk_add_f32 v[138:139], v[138:139], v[22:23]
v_cvt_pk_bf16_f32 v128, v128, v129
v_cvt_pk_bf16_f32 v129, v130, v131
v_cvt_pk_bf16_f32 v130, v136, v137
v_cvt_pk_bf16_f32 v131, v138, v139
s_nop 1
v_permlane16_swap_b32 v128, v130
v_permlane16_swap_b32 v129, v131
buffer_store_dwordx4 v[128:131], v5, s[44:47], s52 offen sc1
v_lshlrev_b32 v16, 16, v224
v_and_b32 v17, v13, v224
v_lshlrev_b32 v18, 16, v225
v_and_b32 v19, v13, v225
v_lshlrev_b32 v20, 16, v226
v_and_b32 v21, v13, v226
v_lshlrev_b32 v22, 16, v227
v_and_b32 v23, v13, v227
v_pk_add_f32 v[132:133], v[132:133], v[16:17]
v_pk_add_f32 v[134:135], v[134:135], v[18:19]
v_pk_add_f32 v[140:141], v[140:141], v[20:21]
v_pk_add_f32 v[142:143], v[142:143], v[22:23]
v_cvt_pk_bf16_f32 v132, v132, v133
v_cvt_pk_bf16_f32 v133, v134, v135
v_cvt_pk_bf16_f32 v134, v140, v141
v_cvt_pk_bf16_f32 v135, v142, v143
s_nop 1
v_permlane16_swap_b32 v132, v134
v_permlane16_swap_b32 v133, v135
buffer_store_dwordx4 v[132:135], v5, s[44:47], s53 offen sc1
L_END:
s_endpgm
L_SE2:
v_accvgpr_read_b32 v180, a224
v_accvgpr_read_b32 v182, a228
v_cmp_nle_f32 vcc, v180, v7
v_cmp_nle_f32 s[96:97], v182, v7
s_nop 3
s_or_b64 vcc, vcc, s[96:97]
s_cbranch_vccnz SLOW0
SLOW0_R:
s_add_u32 s53, s77, 180224
buffer_load_dwordx4 a[112:115], v15, s[24:27], s53 offen offset:0 sc1
v_mul_f32 v8, 0x3fb8aa3b, v8
v_mul_f32 v9, 0x3fb8aa3b, v9
v_exp_f32 v8, v8
v_exp_f32 v9, v9
s_nop 0
v_fma_f32 v180, v180, v8, v180
v_fma_f32 v182, v182, v9, v182
v_rcp_f32 v180, v180
v_rcp_f32 v182, v182
s_add_u32 s52, s78, 4096
v_mov_b32 v181, v180
v_mov_b32 v183, v182
v_pk_mul_f32 v[36:37], v[36:37], v[180:181]
v_pk_mul_f32 v[38:39], v[38:39], v[180:181]
v_pk_mul_f32 v[32:33], v[32:33], v[180:181]
v_pk_mul_f32 v[34:35], v[34:35], v[180:181]
v_cvt_pk_bf16_f32 v36, v36, v37
v_cvt_pk_bf16_f32 v37, v38, v39
v_cvt_pk_bf16_f32 v38, v32, v33
v_cvt_pk_bf16_f32 v39, v34, v35
buffer_store_dwordx4 v[36:39], v15, s[24:27], s78 offen offset:0 sc1
buffer_load_dwordx4 a[116:119], v15, s[24:27], s53 offen offset:1024 sc1
v_pk_mul_f32 v[116:117], v[116:117], v[182:183]
v_pk_mul_f32 v[118:119], v[118:119], v[182:183]
v_pk_mul_f32 v[132:133], v[132:133], v[182:183]
v_pk_mul_f32 v[134:135], v[134:135], v[182:183]
v_cvt_pk_bf16_f32 v116, v116, v117
v_cvt_pk_bf16_f32 v117, v118, v119
v_cvt_pk_bf16_f32 v118, v132, v133
v_cvt_pk_bf16_f32 v119, v134, v135
buffer_store_dwordx4 v[116:119], v15, s[24:27], s78 offen offset:1024 sc1
v_pk_mul_f32 v[196:197], v[196:197], v[180:181]
v_pk_mul_f32 v[198:199], v[198:199], v[180:181]
v_pk_mul_f32 v[204:205], v[204:205], v[180:181]
v_pk_mul_f32 v[206:207], v[206:207], v[180:181]
v_cvt_pk_bf16_f32 v196, v196, v197
v_cvt_pk_bf16_f32 v197, v198, v199
v_cvt_pk_bf16_f32 v198, v204, v205
v_cvt_pk_bf16_f32 v199, v206, v207
buffer_store_dwordx4 v[196:199], v15, s[24:27], s78 offen offset:2048 sc1
v_pk_mul_f32 v[184:185], v[184:185], v[182:183]
v_pk_mul_f32 v[186:187], v[186:187], v[182:183]
v_pk_mul_f32 v[240:241], v[240:241], v[182:183]
buffer_load_dwordx4 a[120:123], v15, s[24:27], s53 offen offset:2048 sc1
v_pk_mul_f32 v[242:243], v[242:243], v[182:183]
v_cvt_pk_bf16_f32 v184, v184, v185
v_cvt_pk_bf16_f32 v185, v186, v187
v_cvt_pk_bf16_f32 v186, v240, v241
v_cvt_pk_bf16_f32 v187, v242, v243
buffer_store_dwordx4 v[184:187], v15, s[24:27], s78 offen offset:3072 sc1
v_pk_mul_f32 v[108:109], v[108:109], v[180:181]
v_pk_mul_f32 v[110:111], v[110:111], v[180:181]
v_pk_mul_f32 v[40:41], v[40:41], v[180:181]
v_pk_mul_f32 v[42:43], v[42:43], v[180:181]
v_cvt_pk_bf16_f32 v108, v108, v109
v_cvt_pk_bf16_f32 v109, v110, v111
v_cvt_pk_bf16_f32 v110, v40, v41
v_cvt_pk_bf16_f32 v111, v42, v43
buffer_store_dwordx4 v[108:111], v15, s[24:27], s52 offen offset:0 sc1
v_pk_mul_f32 v[188:189], v[188:189], v[182:183]
v_pk_mul_f32 v[190:191], v[190:191], v[182:183]
v_pk_mul_f32 v[56:57], v[56:57], v[182:183]
v_pk_mul_f32 v[58:59], v[58:59], v[182:183]
v_cvt_pk_bf16_f32 v188, v188, v189
v_cvt_pk_bf16_f32 v189, v190, v191
buffer_load_dwordx4 a[124:127], v15, s[24:27], s53 offen offset:3072 sc1
v_cvt_pk_bf16_f32 v190, v56, v57
v_cvt_pk_bf16_f32 v191, v58, v59
buffer_store_dwordx4 v[188:191], v15, s[24:27], s52 offen offset:1024 sc1
v_pk_mul_f32 v[80:81], v[80:81], v[180:181]
v_pk_mul_f32 v[82:83], v[82:83], v[180:181]
v_pk_mul_f32 v[168:169], v[168:169], v[180:181]
v_pk_mul_f32 v[170:171], v[170:171], v[180:181]
v_cvt_pk_bf16_f32 v80, v80, v81
v_cvt_pk_bf16_f32 v81, v82, v83
v_cvt_pk_bf16_f32 v82, v168, v169
v_cvt_pk_bf16_f32 v83, v170, v171
buffer_store_dwordx4 v[80:83], v15, s[24:27], s52 offen offset:2048 sc1
v_pk_mul_f32 v[88:89], v[88:89], v[182:183]
v_pk_mul_f32 v[90:91], v[90:91], v[182:183]
v_pk_mul_f32 v[192:193], v[192:193], v[182:183]
v_pk_mul_f32 v[194:195], v[194:195], v[182:183]
v_cvt_pk_bf16_f32 v88, v88, v89
v_cvt_pk_bf16_f32 v89, v90, v91
v_cvt_pk_bf16_f32 v90, v192, v193
v_cvt_pk_bf16_f32 v91, v194, v195
buffer_store_dwordx4 v[88:91], v15, s[24:27], s52 offen offset:3072 sc1
s_branch L_LA
CK_Z:
s_mov_b32 s92, 0
CK_Z_L:
s_sleep 1
buffer_load_dword v23, v22, s[40:43], 0 offen sc1
s_add_u32 s92, s92, 1
s_waitcnt vmcnt(0)
v_cmp_gt_u32 vcc, 1, v23
s_cmp_gt_u32 s92, 1048576
s_cbranch_scc1 CK_Z_R
s_nop 3
s_cbranch_vccnz CK_Z_L
s_branch CK_Z_R
CK_WA:
s_mov_b32 s92, 0
CK_WA_L:
s_sleep 1
buffer_load_dword v30, v29, s[24:27], s89 offen sc1
s_add_u32 s92, s92, 1
s_waitcnt vmcnt(0)
v_cmp_gt_u32 vcc, 18, v30
s_cmp_gt_u32 s92, 1048576
s_cbranch_scc1 CK_WA_R
s_nop 3
s_cbranch_vccnz CK_WA_L
s_branch CK_WA_R
CK_ZA:
s_mov_b32 s92, 0
CK_ZA_L:
s_sleep 1
buffer_load_dword v30, v28, s[40:43], 0 offen sc1
s_add_u32 s92, s92, 1
s_waitcnt vmcnt(0)
v_cmp_gt_u32 vcc, 1, v30
s_cmp_gt_u32 s92, 1048576
s_cbranch_scc1 CK_ZA_R
s_nop 3
s_cbranch_vccnz CK_ZA_L
s_branch CK_ZA_R
CK_KV:
s_mov_b32 s92, 0
CK_KV_L:
s_sleep 1
buffer_load_dword v30, v29, s[24:27], s89 offen offset:4 sc1
s_add_u32 s92, s92, 1
s_waitcnt vmcnt(0)
v_cmp_gt_u32 vcc, 8, v30
s_cmp_gt_u32 s92, 1048576
s_cbranch_scc1 CK_KV_R
s_nop 3
s_cbranch_vccnz CK_KV_L
s_branch CK_KV_R
D0:
v_cndmask_b32 v96, v96, v6, s[56:57]
v_cndmask_b32 v120, v120, v6, s[56:57]
v_mov_b32 v112, v6
v_cndmask_b32 v97, v97, v6, s[58:59]
v_cndmask_b32 v121, v121, v6, s[58:59]
v_mov_b32 v113, v6
v_cndmask_b32 v98, v98, v6, s[60:61]
v_cndmask_b32 v122, v122, v6, s[60:61]
v_mov_b32 v114, v6
v_cndmask_b32 v99, v99, v6, s[62:63]
v_cndmask_b32 v123, v123, v6, s[62:63]
v_mov_b32 v115, v6
s_branch D0_R
CK_Q:
s_mov_b32 s92, 0
CK_Q_L:
s_sleep 1
buffer_load_dword v172, v173, s[24:27], 0 offen sc1
s_add_u32 s92, s92, 1
s_waitcnt vmcnt(0)
v_cmp_gt_u32 vcc, 32, v172
s_cmp_gt_u32 s92, 1048576
s_cbranch_scc1 CK_Q_R
s_nop 3
s_cbranch_vccnz CK_Q_L
s_branch CK_Q_R
CK_ZAA:
s_mov_b32 s92, 0
CK_ZAA_L:
s_sleep 1
buffer_load_dword v12, v10, s[24:27], s75 offen offset:4 sc1
s_add_u32 s92, s92, 1
s_waitcnt vmcnt(0)
v_cmp_gt_u32 vcc, 8, v12
s_cmp_gt_u32 s92, 1048576
s_cbranch_scc1 CK_ZAA_R
s_nop 3
s_cbranch_vccnz CK_ZAA_L
s_branch CK_ZAA_R
SLOW0:
v_add_u32 v20, 4096, v15
s_mov_b32 s54, 0
v_mov_b32 v16, v6
v_mov_b32 v18, v6
SLOW0_P:
s_mov_b32 s53, 0
s_mov_b32 s52, s94
SLOW0_T:
s_add_u32 s55, s52, 24576
buffer_load_dwordx4 a[192:195], v15, s[24:27], s52 offen offset:0 sc1
buffer_load_dwordx4 a[196:199], v15, s[24:27], s52 offen offset:1024 sc1
buffer_load_dwordx4 a[200:203], v15, s[24:27], s52 offen offset:2048 sc1
buffer_load_dwordx4 a[204:207], v15, s[24:27], s52 offen offset:3072 sc1
buffer_load_dwordx4 a[208:211], v20, s[24:27], s52 offen offset:0 sc1
buffer_load_dwordx4 a[212:215], v20, s[24:27], s52 offen offset:1024 sc1
buffer_load_dwordx4 a[216:219], v20, s[24:27], s52 offen offset:2048 sc1
buffer_load_dwordx4 a[220:223], v20, s[24:27], s52 offen offset:3072 sc1
buffer_load_dwordx4 a[64:67], v15, s[24:27], s55 offen offset:0 sc1
buffer_load_dwordx4 a[68:71], v15, s[24:27], s55 offen offset:1024 sc1
buffer_load_dwordx4 a[72:75], v15, s[24:27], s55 offen offset:2048 sc1
buffer_load_dwordx4 a[76:79], v15, s[24:27], s55 offen offset:3072 sc1
buffer_load_dwordx4 a[80:83], v20, s[24:27], s55 offen offset:0 sc1
buffer_load_dwordx4 a[84:87], v20, s[24:27], s55 offen offset:1024 sc1
buffer_load_dwordx4 a[88:91], v20, s[24:27], s55 offen offset:2048 sc1
buffer_load_dwordx4 a[92:95], v20, s[24:27], s55 offen offset:3072 sc1
s_waitcnt vmcnt(0)
v_mfma_f32_16x16x32_bf16 v[44:47], a[192:195], a[32:35], 0
v_mfma_f32_16x16x32_bf16 v[44:47], a[196:199], a[36:39], v[44:47]
v_mfma_f32_16x16x32_bf16 v[44:47], a[200:203], a[28:31], v[44:47]
v_mfma_f32_16x16x32_bf16 v[44:47], a[204:207], a[20:23], v[44:47]
v_mfma_f32_16x16x32_bf16 v[52:55], a[192:195], a[44:47], 0
v_mfma_f32_16x16x32_bf16 v[52:55], a[196:199], a[40:43], v[52:55]
v_mfma_f32_16x16x32_bf16 v[52:55], a[200:203], a[12:15], v[52:55]
v_mfma_f32_16x16x32_bf16 v[52:55], a[204:207], a[4:7], v[52:55]
v_mfma_f32_16x16x32_bf16 v[64:67], a[208:211], a[32:35], 0
v_mfma_f32_16x16x32_bf16 v[64:67], a[212:215], a[36:39], v[64:67]
v_mfma_f32_16x16x32_bf16 v[64:67], a[216:219], a[28:31], v[64:67]
v_mfma_f32_16x16x32_bf16 v[64:67], a[220:223], a[20:23], v[64:67]
v_mfma_f32_16x16x32_bf16 v[212:215], a[208:211], a[44:47], 0
v_mfma_f32_16x16x32_bf16 v[212:215], a[212:215], a[40:43], v[212:215]
v_mfma_f32_16x16x32_bf16 v[212:215], a[216:219], a[12:15], v[212:215]
v_mfma_f32_16x16x32_bf16 v[212:215], a[220:223], a[4:7], v[212:215]
s_nop 7
s_cmp_lg_u32 s53, s66
s_cbranch_scc1 SLOW0_U
v_cndmask_b32 v44, v44, v6, s[56:57]
v_cndmask_b32 v212, v212, v6, s[56:57]
v_mov_b32 v64, v6
v_cndmask_b32 v45, v45, v6, s[58:59]
v_cndmask_b32 v213, v213, v6, s[58:59]
v_mov_b32 v65, v6
v_cndmask_b32 v46, v46, v6, s[60:61]
v_cndmask_b32 v214, v214, v6, s[60:61]
v_mov_b32 v66, v6
v_cndmask_b32 v47, v47, v6, s[62:63]
v_cndmask_b32 v215, v215, v6, s[62:63]
v_mov_b32 v67, v6
SLOW0_U:
s_cmp_lg_u32 s54, 0
s_cbranch_scc1 SLOW0_A
v_max3_f32 v16, v16, v44, v45
v_max3_f32 v16, v16, v46, v47
v_max3_f32 v18, v18, v52, v53
v_max3_f32 v18, v18, v54, v55
v_max3_f32 v16, v16, v64, v65
v_max3_f32 v16, v16, v66, v67
v_max3_f32 v18, v18, v212, v213
v_max3_f32 v18, v18, v214, v215
s_branch SLOW0_N
SLOW0_A:
v_sub_f32 v44, v44, v16
v_sub_f32 v45, v45, v16
v_sub_f32 v46, v46, v16
v_sub_f32 v47, v47, v16
v_sub_f32 v52, v52, v18
v_sub_f32 v53, v53, v18
v_sub_f32 v54, v54, v18
v_sub_f32 v55, v55, v18
v_sub_f32 v64, v64, v16
v_sub_f32 v65, v65, v16
v_sub_f32 v66, v66, v16
v_sub_f32 v67, v67, v16
v_sub_f32 v212, v212, v18
v_sub_f32 v213, v213, v18
v_sub_f32 v214, v214, v18
v_sub_f32 v215, v215, v18
v_exp_f32 v44, v44
v_exp_f32 v45, v45
v_exp_f32 v46, v46
v_exp_f32 v47, v47
v_exp_f32 v52, v52
v_exp_f32 v53, v53
v_exp_f32 v54, v54
v_exp_f32 v55, v55
v_exp_f32 v64, v64
v_exp_f32 v65, v65
v_exp_f32 v66, v66
v_exp_f32 v67, v67
v_exp_f32 v212, v212
v_exp_f32 v213, v213
v_exp_f32 v214, v214
v_exp_f32 v215, v215
s_nop 0
v_cvt_pk_bf16_f32 v124, v44, v45
v_cvt_pk_bf16_f32 v125, v46, v47
v_cvt_pk_bf16_f32 v140, v52, v53
v_cvt_pk_bf16_f32 v141, v54, v55
v_cvt_pk_bf16_f32 v126, v64, v65
v_cvt_pk_bf16_f32 v127, v66, v67
v_cvt_pk_bf16_f32 v142, v212, v213
v_cvt_pk_bf16_f32 v143, v214, v215
s_nop 1
v_mfma_f32_16x16x32_bf16 v[36:39], a[64:67], v[124:127], v[36:39]
v_mfma_f32_16x16x32_bf16 v[116:119], a[64:67], v[140:143], v[116:119]
v_mfma_f32_16x16x32_bf16 v[132:135], a[68:71], v[140:143], v[132:135]
v_mfma_f32_16x16x32_bf16 v[32:35], a[68:71], v[124:127], v[32:35]
v_mfma_f32_16x16x32_bf16 v[196:199], a[72:75], v[124:127], v[196:199]
v_mfma_f32_16x16x32_bf16 v[184:187], a[72:75], v[140:143], v[184:187]
v_mfma_f32_16x16x32_bf16 v[240:243], a[76:79], v[140:143], v[240:243]
v_mfma_f32_16x16x32_bf16 v[204:207], a[76:79], v[124:127], v[204:207]
v_mfma_f32_16x16x32_bf16 v[108:111], a[80:83], v[124:127], v[108:111]
v_mfma_f32_16x16x32_bf16 v[188:191], a[80:83], v[140:143], v[188:191]
v_mfma_f32_16x16x32_bf16 v[56:59], a[84:87], v[140:143], v[56:59]
v_mfma_f32_16x16x32_bf16 v[40:43], a[84:87], v[124:127], v[40:43]
v_mfma_f32_16x16x32_bf16 v[80:83], a[88:91], v[124:127], v[80:83]
v_mfma_f32_16x16x32_bf16 v[88:91], a[88:91], v[140:143], v[88:91]
v_mfma_f32_16x16x32_bf16 v[192:195], a[92:95], v[140:143], v[192:195]
v_mfma_f32_16x16x32_bf16 v[168:171], a[92:95], v[124:127], v[168:171]
v_mfma_f32_16x16x32_bf16 a[224:227], a[240:243], v[124:127], a[224:227]
v_mfma_f32_16x16x32_bf16 a[228:231], a[240:243], v[140:143], a[228:231]
SLOW0_N:
s_add_u32 s52, s52, 16384
s_add_u32 s53, s53, 1
s_cmp_le_u32 s53, s66
s_cbranch_scc1 SLOW0_T
s_cmp_lg_u32 s54, 0
s_cbranch_scc1 SLOW0_E
v_mov_b32 v17, v16
v_mov_b32 v19, v18
s_nop 1
v_permlane32_swap_b32 v17, v16
v_permlane32_swap_b32 v19, v18
s_nop 1
v_max_f32 v16, v16, v17
v_max_f32 v18, v18, v19
v_mov_b32 v17, v16
v_mov_b32 v19, v18
s_nop 1
v_permlane16_swap_b32 v17, v16
v_permlane16_swap_b32 v19, v18
s_nop 1
v_max_f32 v16, v16, v17
v_max_f32 v18, v18, v19
v_mov_b32 v36, 0
v_mov_b32 v37, 0
v_mov_b32 v38, 0
v_mov_b32 v39, 0
v_mov_b32 v32, 0
v_mov_b32 v33, 0
v_mov_b32 v34, 0
v_mov_b32 v35, 0
v_mov_b32 v196, 0
v_mov_b32 v197, 0
v_mov_b32 v198, 0
v_mov_b32 v199, 0
v_mov_b32 v204, 0
v_mov_b32 v205, 0
v_mov_b32 v206, 0
v_mov_b32 v207, 0
v_mov_b32 v108, 0
v_mov_b32 v109, 0
v_mov_b32 v110, 0
v_mov_b32 v111, 0
v_mov_b32 v40, 0
v_mov_b32 v41, 0
v_mov_b32 v42, 0
v_mov_b32 v43, 0
v_mov_b32 v80, 0
v_mov_b32 v81, 0
v_mov_b32 v82, 0
v_mov_b32 v83, 0
v_mov_b32 v168, 0
v_mov_b32 v169, 0
v_mov_b32 v170, 0
v_mov_b32 v171, 0
v_mov_b32 v116, 0
v_mov_b32 v117, 0
v_mov_b32 v118, 0
v_mov_b32 v119, 0
v_mov_b32 v132, 0
v_mov_b32 v133, 0
v_mov_b32 v134, 0
v_mov_b32 v135, 0
v_mov_b32 v184, 0
v_mov_b32 v185, 0
v_mov_b32 v186, 0
v_mov_b32 v187, 0
v_mov_b32 v240, 0
v_mov_b32 v241, 0
v_mov_b32 v242, 0
v_mov_b32 v243, 0
v_mov_b32 v188, 0
v_mov_b32 v189, 0
v_mov_b32 v190, 0
v_mov_b32 v191, 0
v_mov_b32 v56, 0
v_mov_b32 v57, 0
v_mov_b32 v58, 0
v_mov_b32 v59, 0
v_mov_b32 v88, 0
v_mov_b32 v89, 0
v_mov_b32 v90, 0
v_mov_b32 v91, 0
v_mov_b32 v192, 0
v_mov_b32 v193, 0
v_mov_b32 v194, 0
v_mov_b32 v195, 0
v_accvgpr_write_b32 a224, 0
v_accvgpr_write_b32 a225, 0
v_accvgpr_write_b32 a226, 0
v_accvgpr_write_b32 a227, 0
v_accvgpr_write_b32 a228, 0
v_accvgpr_write_b32 a229, 0
v_accvgpr_write_b32 a230, 0
v_accvgpr_write_b32 a231, 0
s_mov_b32 s54, 1
s_branch SLOW0_P
SLOW0_E:
s_nop 7
v_accvgpr_read_b32 v180, a224
v_accvgpr_read_b32 v182, a228
s_branch SLOW0_R
SLOW1:
v_add_u32 v20, 4096, v15
s_mov_b32 s54, 0
v_mov_b32 v16, v6
v_mov_b32 v18, v6
SLOW1_P:
s_mov_b32 s53, 0
s_mov_b32 s52, s94
SLOW1_T:
s_add_u32 s55, s52, 24576
buffer_load_dwordx4 a[192:195], v15, s[24:27], s52 offen offset:0 sc1
buffer_load_dwordx4 a[196:199], v15, s[24:27], s52 offen offset:1024 sc1
buffer_load_dwordx4 a[200:203], v15, s[24:27], s52 offen offset:2048 sc1
buffer_load_dwordx4 a[204:207], v15, s[24:27], s52 offen offset:3072 sc1
buffer_load_dwordx4 a[208:211], v20, s[24:27], s52 offen offset:0 sc1
buffer_load_dwordx4 a[212:215], v20, s[24:27], s52 offen offset:1024 sc1
buffer_load_dwordx4 a[216:219], v20, s[24:27], s52 offen offset:2048 sc1
buffer_load_dwordx4 a[220:223], v20, s[24:27], s52 offen offset:3072 sc1
buffer_load_dwordx4 a[64:67], v15, s[24:27], s55 offen offset:0 sc1
buffer_load_dwordx4 a[68:71], v15, s[24:27], s55 offen offset:1024 sc1
buffer_load_dwordx4 a[72:75], v15, s[24:27], s55 offen offset:2048 sc1
buffer_load_dwordx4 a[76:79], v15, s[24:27], s55 offen offset:3072 sc1
buffer_load_dwordx4 a[80:83], v20, s[24:27], s55 offen offset:0 sc1
buffer_load_dwordx4 a[84:87], v20, s[24:27], s55 offen offset:1024 sc1
buffer_load_dwordx4 a[88:91], v20, s[24:27], s55 offen offset:2048 sc1
buffer_load_dwordx4 a[92:95], v20, s[24:27], s55 offen offset:3072 sc1
s_waitcnt vmcnt(0)
v_mfma_f32_16x16x32_bf16 v[44:47], a[192:195], a[48:51], 0
v_mfma_f32_16x16x32_bf16 v[44:47], a[196:199], a[52:55], v[44:47]
v_mfma_f32_16x16x32_bf16 v[44:47], a[200:203], a[0:3], v[44:47]
v_mfma_f32_16x16x32_bf16 v[44:47], a[204:207], a[8:11], v[44:47]
v_mfma_f32_16x16x32_bf16 v[52:55], a[192:195], a[60:63], 0
v_mfma_f32_16x16x32_bf16 v[52:55], a[196:199], a[56:59], v[52:55]
v_mfma_f32_16x16x32_bf16 v[52:55], a[200:203], a[16:19], v[52:55]
v_mfma_f32_16x16x32_bf16 v[52:55], a[204:207], a[24:27], v[52:55]
v_mfma_f32_16x16x32_bf16 v[64:67], a[208:211], a[48:51], 0
v_mfma_f32_16x16x32_bf16 v[64:67], a[212:215], a[52:55], v[64:67]
v_mfma_f32_16x16x32_bf16 v[64:67], a[216:219], a[0:3], v[64:67]
v_mfma_f32_16x16x32_bf16 v[64:67], a[220:223], a[8:11], v[64:67]
v_mfma_f32_16x16x32_bf16 v[212:215], a[208:211], a[60:63], 0
v_mfma_f32_16x16x32_bf16 v[212:215], a[212:215], a[56:59], v[212:215]
v_mfma_f32_16x16x32_bf16 v[212:215], a[216:219], a[16:19], v[212:215]
v_mfma_f32_16x16x32_bf16 v[212:215], a[220:223], a[24:27], v[212:215]
s_nop 7
s_cmp_lg_u32 s53, s67
s_cbranch_scc1 SLOW1_U
v_cndmask_b32 v44, v44, v6, s[56:57]
v_cndmask_b32 v212, v212, v6, s[56:57]
v_mov_b32 v64, v6
v_cndmask_b32 v45, v45, v6, s[58:59]
v_cndmask_b32 v213, v213, v6, s[58:59]
v_mov_b32 v65, v6
v_cndmask_b32 v46, v46, v6, s[60:61]
v_cndmask_b32 v214, v214, v6, s[60:61]
v_mov_b32 v66, v6
v_cndmask_b32 v47, v47, v6, s[62:63]
v_cndmask_b32 v215, v215, v6, s[62:63]
v_mov_b32 v67, v6
SLOW1_U:
s_cmp_lg_u32 s54, 0
s_cbranch_scc1 SLOW1_A
v_max3_f32 v16, v16, v44, v45
v_max3_f32 v16, v16, v46, v47
v_max3_f32 v18, v18, v52, v53
v_max3_f32 v18, v18, v54, v55
v_max3_f32 v16, v16, v64, v65
v_max3_f32 v16, v16, v66, v67
v_max3_f32 v18, v18, v212, v213
v_max3_f32 v18, v18, v214, v215
s_branch SLOW1_N
SLOW1_A:
v_sub_f32 v44, v44, v16
v_sub_f32 v45, v45, v16
v_sub_f32 v46, v46, v16
v_sub_f32 v47, v47, v16
v_sub_f32 v52, v52, v18
v_sub_f32 v53, v53, v18
v_sub_f32 v54, v54, v18
v_sub_f32 v55, v55, v18
v_sub_f32 v64, v64, v16
v_sub_f32 v65, v65, v16
v_sub_f32 v66, v66, v16
v_sub_f32 v67, v67, v16
v_sub_f32 v212, v212, v18
v_sub_f32 v213, v213, v18
v_sub_f32 v214, v214, v18
v_sub_f32 v215, v215, v18
v_exp_f32 v44, v44
v_exp_f32 v45, v45
v_exp_f32 v46, v46
v_exp_f32 v47, v47
v_exp_f32 v52, v52
v_exp_f32 v53, v53
v_exp_f32 v54, v54
v_exp_f32 v55, v55
v_exp_f32 v64, v64
v_exp_f32 v65, v65
v_exp_f32 v66, v66
v_exp_f32 v67, v67
v_exp_f32 v212, v212
v_exp_f32 v213, v213
v_exp_f32 v214, v214
v_exp_f32 v215, v215
s_nop 0
v_cvt_pk_bf16_f32 v124, v44, v45
v_cvt_pk_bf16_f32 v125, v46, v47
v_cvt_pk_bf16_f32 v140, v52, v53
v_cvt_pk_bf16_f32 v141, v54, v55
v_cvt_pk_bf16_f32 v126, v64, v65
v_cvt_pk_bf16_f32 v127, v66, v67
v_cvt_pk_bf16_f32 v142, v212, v213
v_cvt_pk_bf16_f32 v143, v214, v215
s_nop 1
v_mfma_f32_16x16x32_bf16 v[60:63], a[64:67], v[124:127], v[60:63]
v_mfma_f32_16x16x32_bf16 v[148:151], a[64:67], v[140:143], v[148:151]
v_mfma_f32_16x16x32_bf16 v[48:51], a[68:71], v[140:143], v[48:51]
v_mfma_f32_16x16x32_bf16 v[68:71], a[68:71], v[124:127], v[68:71]
v_mfma_f32_16x16x32_bf16 v[72:75], a[72:75], v[124:127], v[72:75]
v_mfma_f32_16x16x32_bf16 v[236:239], a[72:75], v[140:143], v[236:239]
v_mfma_f32_16x16x32_bf16 v[224:227], a[76:79], v[140:143], v[224:227]
v_mfma_f32_16x16x32_bf16 v[220:223], a[76:79], v[124:127], v[220:223]
v_mfma_f32_16x16x32_bf16 v[84:87], a[80:83], v[124:127], v[84:87]
v_mfma_f32_16x16x32_bf16 v[164:167], a[80:83], v[140:143], v[164:167]
v_mfma_f32_16x16x32_bf16 v[156:159], a[84:87], v[140:143], v[156:159]
v_mfma_f32_16x16x32_bf16 v[76:79], a[84:87], v[124:127], v[76:79]
v_mfma_f32_16x16x32_bf16 v[160:163], a[88:91], v[124:127], v[160:163]
v_mfma_f32_16x16x32_bf16 v[216:219], a[88:91], v[140:143], v[216:219]
v_mfma_f32_16x16x32_bf16 v[208:211], a[92:95], v[140:143], v[208:211]
v_mfma_f32_16x16x32_bf16 v[252:255], a[92:95], v[124:127], v[252:255]
v_mfma_f32_16x16x32_bf16 a[232:235], a[240:243], v[124:127], a[232:235]
v_mfma_f32_16x16x32_bf16 a[236:239], a[240:243], v[140:143], a[236:239]
SLOW1_N:
s_add_u32 s52, s52, 16384
s_add_u32 s53, s53, 1
s_cmp_le_u32 s53, s67
s_cbranch_scc1 SLOW1_T
s_cmp_lg_u32 s54, 0
s_cbranch_scc1 SLOW1_E
v_mov_b32 v17, v16
v_mov_b32 v19, v18
s_nop 1
v_permlane32_swap_b32 v17, v16
v_permlane32_swap_b32 v19, v18
s_nop 1
v_max_f32 v16, v16, v17
v_max_f32 v18, v18, v19
v_mov_b32 v17, v16
v_mov_b32 v19, v18
s_nop 1
v_permlane16_swap_b32 v17, v16
v_permlane16_swap_b32 v19, v18
s_nop 1
v_max_f32 v16, v16, v17
v_max_f32 v18, v18, v19
v_mov_b32 v60, 0
v_mov_b32 v61, 0
v_mov_b32 v62, 0
v_mov_b32 v63, 0
v_mov_b32 v68, 0
v_mov_b32 v69, 0
v_mov_b32 v70, 0
v_mov_b32 v71, 0
v_mov_b32 v72, 0
v_mov_b32 v73, 0
v_mov_b32 v74, 0
v_mov_b32 v75, 0
v_mov_b32 v220, 0
v_mov_b32 v221, 0
v_mov_b32 v222, 0
v_mov_b32 v223, 0
v_mov_b32 v84, 0
v_mov_b32 v85, 0
v_mov_b32 v86, 0
v_mov_b32 v87, 0
v_mov_b32 v76, 0
v_mov_b32 v77, 0
v_mov_b32 v78, 0
v_mov_b32 v79, 0
v_mov_b32 v160, 0
v_mov_b32 v161, 0
v_mov_b32 v162, 0
v_mov_b32 v163, 0
v_mov_b32 v252, 0
v_mov_b32 v253, 0
v_mov_b32 v254, 0
v_mov_b32 v255, 0
v_mov_b32 v148, 0
v_mov_b32 v149, 0
v_mov_b32 v150, 0
v_mov_b32 v151, 0
v_mov_b32 v48, 0
v_mov_b32 v49, 0
v_mov_b32 v50, 0
v_mov_b32 v51, 0
v_mov_b32 v236, 0
v_mov_b32 v237, 0
v_mov_b32 v238, 0
v_mov_b32 v239, 0
v_mov_b32 v224, 0
v_mov_b32 v225, 0
v_mov_b32 v226, 0
v_mov_b32 v227, 0
v_mov_b32 v164, 0
v_mov_b32 v165, 0
v_mov_b32 v166, 0
v_mov_b32 v167, 0
v_mov_b32 v156, 0
v_mov_b32 v157, 0
v_mov_b32 v158, 0
v_mov_b32 v159, 0
v_mov_b32 v216, 0
v_mov_b32 v217, 0
v_mov_b32 v218, 0
v_mov_b32 v219, 0
v_mov_b32 v208, 0
v_mov_b32 v209, 0
v_mov_b32 v210, 0
v_mov_b32 v211, 0
v_accvgpr_write_b32 a232, 0
v_accvgpr_write_b32 a233, 0
v_accvgpr_write_b32 a234, 0
v_accvgpr_write_b32 a235, 0
v_accvgpr_write_b32 a236, 0
v_accvgpr_write_b32 a237, 0
v_accvgpr_write_b32 a238, 0
v_accvgpr_write_b32 a239, 0
s_mov_b32 s54, 1
s_branch SLOW1_P
SLOW1_E:
s_nop 7
v_accvgpr_read_b32 v180, a232
v_accvgpr_read_b32 v182, a236
s_add_u32 s52, s79, 4096
v_fma_f32 v180, v180, v10, v180
v_fma_f32 v182, v182, v11, v182
v_rcp_f32 v180, v180
v_rcp_f32 v182, v182
s_nop 0
v_pk_mul_f32 v[60:61], v[60:61], v[180:181] op_sel_hi:[1,0]
v_pk_mul_f32 v[62:63], v[62:63], v[180:181] op_sel_hi:[1,0]
v_pk_mul_f32 v[68:69], v[68:69], v[180:181] op_sel_hi:[1,0]
v_pk_mul_f32 v[70:71], v[70:71], v[180:181] op_sel_hi:[1,0]
v_cvt_pk_bf16_f32 v60, v60, v61
v_cvt_pk_bf16_f32 v61, v62, v63
v_cvt_pk_bf16_f32 v62, v68, v69
v_cvt_pk_bf16_f32 v63, v70, v71
s_branch L_EP
.section .rodata,"a"
.p2align 6
.amdhsa_kernel gated_mix__sliding_local_dilated__compressed_kv_cla__prompt_kernel
  .amdhsa_next_free_vgpr 512
  .amdhsa_next_free_sgpr 102
  .amdhsa_accum_offset 256
  .amdhsa_group_segment_fixed_size 0
  .amdhsa_kernarg_size 104
  .amdhsa_user_sgpr_count 2
  .amdhsa_user_sgpr_kernarg_segment_ptr 1
  .amdhsa_system_sgpr_workgroup_id_x 1
.end_amdhsa_kernel
```

```asm
; @launch grid=(256,1,1) block=(256,1,1) lds=163840
.amdgcn_target "amdgcn-amd-amdhsa--gfx950"
.text

.globl gated_mix__sliding_local_dilated__compressed_kv_cla__prompt_kernel
.p2align 8
.type gated_mix__sliding_local_dilated__compressed_kv_cla__prompt_kernel,@function
gated_mix__sliding_local_dilated__compressed_kv_cla__prompt_kernel:
s_cmp_ge_u32 s2, 256
s_cbranch_scc1 L_END
s_load_dwordx2 s[8:9], s[0:1], 32
s_load_dwordx2 s[56:57], s[0:1], 56
s_load_dwordx2 s[16:17], s[0:1], 48
s_load_dwordx2 s[24:25], s[0:1], 96
s_load_dwordx2 s[12:13], s[0:1], 0
s_load_dwordx2 s[20:21], s[0:1], 40
s_load_dwordx2 s[28:29], s[0:1], 8
s_load_dwordx2 s[48:49], s[0:1], 16
s_load_dwordx2 s[32:33], s[0:1], 64
s_load_dwordx2 s[36:37], s[0:1], 72
s_load_dwordx2 s[40:41], s[0:1], 88
s_load_dwordx2 s[44:45], s[0:1], 80
s_getpc_b64 s[96:97]
L_PC:
s_lshr_b32 s6, s2, 3
s_lshl_b32 s98, s6, 11
s_add_u32 s98, s98, L_MAIN-L_PC
s_add_u32 s96, s96, s98
s_addc_u32 s97, s97, 0
v_lshlrev_b32 v16, 3, v0
v_mov_b32 v17, s97
v_add_co_u32 v16, vcc, s96, v16
v_lshrrev_b32 v5, 6, v0
v_and_b32 v1, 63, v0
v_addc_co_u32 v17, vcc, 0, v17, vcc
v_readfirstlane_b32 s3, v5
global_load_dwordx2 a[252:253], v[16:17], off
v_and_b32 v2, 15, v0
v_lshrrev_b32 v3, 4, v1
v_lshlrev_b32 v4, 4, v1
s_and_b32 s7, s2, 7
s_and_b32 s65, s6, 3
s_lshl2_add_u32 s4, s7, s65
s_lshr_b32 s5, s6, 2
s_lshl2_add_u32 s66, s5, s3
s_sub_u32 s67, 63, s66
v_lshrrev_b32 v16, 3, v1
v_and_b32 v17, 7, v1
v_xor_b32 v18, v17, v3
v_lshlrev_b32 v19, 10, v16
v_lshl_add_u32 v5, v18, 4, v19
v_xor_b32 v18, 4, v18
v_lshl_add_u32 v6, v18, 4, v19
v_add_u32 v6, 7168, v6
v_and_b32 v18, 1, v3
v_lshlrev_b32 v18, 1, v18
v_xor_b32 v18, v17, v18
v_lshlrev_b32 v19, 13, v16
v_lshl_add_u32 v7, v18, 4, v19
v_xor_b32 v18, 4, v18
v_lshl_add_u32 v8, v18, 4, v19
v_add_u32 v8, 64512, v8
s_add_u32 s69, s65, s5
s_and_b32 s69, s69, 1
s_mul_i32 s64, s7, 2
s_and_b32 s64, s64, 7
s_or_b32 s69, s69, s64
s_add_u32 s93, s65, s5
s_and_b32 s93, s93, 0
s_mul_i32 s64, s7, 1
s_and_b32 s64, s64, 7
s_or_b32 s93, s93, s64
s_lshl_b32 s70, s69, 7
s_lshl_b32 s75, s69, 19
s_lshr_b32 s54, s3, 1
s_and_b32 s55, s3, 1
s_lshl3_add_u32 s87, s54, s5
s_lshl_b32 s64, s55, 5
s_add_u32 s68, s87, s64
s_lshl_b32 s68, s68, 15
s_lshl_b32 s73, s3, 13
s_add_u32 s73, s73, 65536
s_lshl1_add_u32 s74, s4, s55
s_lshl_b32 s74, s74, 7
s_lshl_b32 s64, s54, 18
s_add_u32 s74, s74, s64
s_lshl_b32 s77, s3, 12
s_add_u32 s71, s68, s70
s_add_u32 s76, s74, s75
s_mov_b32 s10, 2097152
s_mov_b32 s11, 0x20000
s_mov_b32 s58, 4194304
s_mov_b32 s59, 0x20000
s_waitcnt lgkmcnt(0)
s_add_u32 m0, s73, 0
s_add_u32 s64, s71, 0
buffer_load_dwordx4 v5, s[8:11], s64 offen lds
buffer_load_dwordx4 v6, s[8:11], s64 offen offset:1024 lds
s_add_u32 m0, s73, 2048
s_add_u32 s64, s71, 16384
buffer_load_dwordx4 v5, s[8:11], s64 offen lds
buffer_load_dwordx4 v6, s[8:11], s64 offen offset:1024 lds
s_add_u32 m0, s77, 0
s_add_u32 s64, s76, 0
buffer_load_dwordx4 v7, s[56:59], s64 offen lds
buffer_load_dwordx4 v8, s[56:59], s64 offen offset:1024 lds
s_add_u32 m0, s77, 2048
s_add_u32 s64, s76, 131072
buffer_load_dwordx4 v7, s[56:59], s64 offen lds
buffer_load_dwordx4 v8, s[56:59], s64 offen offset:1024 lds
s_add_u32 m0, s73, 4096
s_add_u32 s64, s71, 524288
buffer_load_dwordx4 v5, s[8:11], s64 offen lds
buffer_load_dwordx4 v6, s[8:11], s64 offen offset:1024 lds
s_add_u32 m0, s73, 6144
s_add_u32 s64, s71, 540672
buffer_load_dwordx4 v5, s[8:11], s64 offen lds
buffer_load_dwordx4 v6, s[8:11], s64 offen offset:1024 lds
s_mov_b32 s18, 4194304
s_mov_b32 s19, 0x20000
s_lshl_b32 s65, s54, 7
s_lshl_b32 s53, s55, 12
v_lshrrev_b32 v16, 1, v2
v_xor_b32 v16, v16, v3
v_add_u32 v17, s65, v2
v_lshlrev_b32 v17, 7, v17
v_add_u32 v17, 65536, v17
v_lshl_add_u32 v9, v16, 4, v17
v_xor_b32 v10, 64, v9
v_bfe_u32 v16, v1, 2, 2
v_lshl_add_u32 v17, v3, 3, v16
v_lshlrev_b32 v17, 7, v17
v_and_b32 v18, 3, v1
v_lshl_add_u32 v17, v18, 3, v17
v_add_u32 v17, s53, v17
v_lshrrev_b32 v16, 1, v16
v_and_b32 v18, 1, v3
v_lshl_add_u32 v16, v18, 1, v16
v_xor_b32 v18, 0, v16
v_lshl_add_u32 v11, v18, 5, v17
v_xor_b32 v18, 1, v16
v_lshl_add_u32 v12, v18, 5, v17
v_xor_b32 v18, 2, v16
v_lshl_add_u32 v13, v18, 5, v17
v_xor_b32 v18, 3, v16
v_lshl_add_u32 v14, v18, 5, v17
s_add_u32 m0, s77, 16384
s_add_u32 s64, s76, 0
buffer_load_dwordx4 v7, s[16:19], s64 offen lds
buffer_load_dwordx4 v8, s[16:19], s64 offen offset:1024 lds
s_add_u32 m0, s77, 18432
s_add_u32 s64, s76, 131072
buffer_load_dwordx4 v7, s[16:19], s64 offen lds
buffer_load_dwordx4 v8, s[16:19], s64 offen offset:1024 lds
s_mov_b64 exec, 0
s_cmp_eq_u32 s3, 0
s_cbranch_scc1 L_PAD0
s_cmp_eq_u32 s3, 1
s_cbranch_scc1 L_PAD1
s_cmp_eq_u32 s3, 2
s_cbranch_scc1 L_PAD2
s_branch L_PAD3
.p2align 12
.fill 591, 4, 0xbf800000
L_MAIN:
s_mov_b64 exec, -1
s_xor_b32 s71, s70, 128
s_add_u32 s71, s68, s71
s_add_u32 m0, s73, 32768
s_add_u32 s64, s71, 0
buffer_load_dwordx4 v5, s[8:11], s64 offen lds
buffer_load_dwordx4 v6, s[8:11], s64 offen offset:1024 lds
s_add_u32 m0, s73, 34816
s_add_u32 s64, s71, 16384
buffer_load_dwordx4 v5, s[8:11], s64 offen lds
buffer_load_dwordx4 v6, s[8:11], s64 offen offset:1024 lds
s_add_u32 m0, s73, 36864
s_add_u32 s64, s71, 524288
buffer_load_dwordx4 v5, s[8:11], s64 offen lds
buffer_load_dwordx4 v6, s[8:11], s64 offen offset:1024 lds
s_add_u32 m0, s73, 38912
s_add_u32 s64, s71, 540672
buffer_load_dwordx4 v5, s[8:11], s64 offen lds
buffer_load_dwordx4 v6, s[8:11], s64 offen offset:1024 lds
s_waitcnt vmcnt(12)
s_barrier
ds_read_b128 a[64:67], v9 offset:0
ds_read_b128 a[68:71], v10 offset:0
ds_read_b64_tr_b16 a[128:129], v11 offset:0
ds_read_b64_tr_b16 a[130:131], v11 offset:512
ds_read_b64_tr_b16 a[132:133], v11 offset:8192
ds_read_b64_tr_b16 a[134:135], v11 offset:8704
ds_read_b64_tr_b16 a[136:137], v12 offset:0
ds_read_b64_tr_b16 a[138:139], v12 offset:512
ds_read_b64_tr_b16 a[140:141], v12 offset:8192
ds_read_b64_tr_b16 a[142:143], v12 offset:8704
ds_read_b64_tr_b16 a[144:145], v13 offset:0
ds_read_b64_tr_b16 a[146:147], v13 offset:512
ds_read_b64_tr_b16 a[148:149], v13 offset:8192
ds_read_b64_tr_b16 a[150:151], v13 offset:8704
ds_read_b64_tr_b16 a[152:153], v14 offset:0
ds_read_b64_tr_b16 a[154:155], v14 offset:512
ds_read_b64_tr_b16 a[156:157], v14 offset:8192
ds_read_b64_tr_b16 a[158:159], v14 offset:8704
ds_read_b128 a[72:75], v9 offset:2048
ds_read_b128 a[76:79], v10 offset:2048
ds_read_b128 a[80:83], v9 offset:4096
ds_read_b128 a[84:87], v10 offset:4096
ds_read_b128 a[88:91], v9 offset:6144
ds_read_b128 a[92:95], v10 offset:6144
s_waitcnt lgkmcnt(0)
v_mfma_f32_16x16x32_bf16 v[32:35], a[64:67], a[128:131], 0
s_waitcnt vmcnt(8)
v_mfma_f32_16x16x32_bf16 v[32:35], a[68:71], a[132:135], v[32:35]
s_barrier
v_mfma_f32_16x16x32_bf16 v[40:43], a[68:71], a[140:143], 0
s_mov_b32 s26, 268435456
s_mov_b32 s27, 0x20000
ds_read_b128 a[96:99], v9 offset:8192
v_mfma_f32_16x16x32_bf16 v[40:43], a[64:67], a[136:139], v[40:43]
s_xor_b32 s76, s75, 524288
s_add_u32 s76, s74, s76
s_mov_b32 s14, 2359296
v_mfma_f32_16x16x32_bf16 v[48:51], a[64:67], a[144:147], 0
s_add_u32 m0, s77, 32768
s_add_u32 s64, s76, 0
s_mov_b32 s15, 0x20000
v_mfma_f32_16x16x32_bf16 v[48:51], a[68:71], a[148:151], v[48:51]
buffer_load_dwordx4 v7, s[56:59], s64 offen lds
v_mfma_f32_16x16x32_bf16 v[56:59], a[68:71], a[156:159], 0
s_mov_b32 s22, 4718592
s_mov_b32 s23, 0x20000
ds_read_b128 a[100:103], v10 offset:8192
v_mfma_f32_16x16x32_bf16 v[56:59], a[64:67], a[152:155], v[56:59]
buffer_load_dwordx4 v8, s[56:59], s64 offen offset:1024 lds
v_mfma_f32_16x16x32_bf16 v[60:63], a[72:75], a[152:155], 0
s_add_u32 m0, s77, 34816
s_add_u32 s64, s76, 131072
ds_read_b128 a[104:107], v9 offset:10240
v_mfma_f32_16x16x32_bf16 v[60:63], a[76:79], a[156:159], v[60:63]
s_mov_b32 s30, 1990656
s_mov_b32 s31, 0x20000
s_mov_b32 s34, 4718592
v_mfma_f32_16x16x32_bf16 v[52:55], a[76:79], a[148:151], 0
buffer_load_dwordx4 v7, s[56:59], s64 offen lds
v_mfma_f32_16x16x32_bf16 v[52:55], a[72:75], a[144:147], v[52:55]
s_mov_b32 s35, 0x20000
ds_read_b64_tr_b16 a[160:161], v11 offset:16384
ds_read_b64_tr_b16 a[162:163], v11 offset:16896
v_mfma_f32_16x16x32_bf16 v[44:47], a[72:75], a[136:139], 0
s_mov_b32 s38, 1152
s_mov_b32 s39, 0x20000
s_mov_b32 s42, 256
v_mfma_f32_16x16x32_bf16 v[44:47], a[76:79], a[140:143], v[44:47]
buffer_load_dwordx4 v8, s[56:59], s64 offen offset:1024 lds
v_mfma_f32_16x16x32_bf16 v[36:39], a[76:79], a[132:135], 0
s_mov_b32 s43, 0x20000
s_mov_b32 s46, 2359296
s_mov_b32 s47, 0x20000
v_mfma_f32_16x16x32_bf16 v[36:39], a[72:75], a[128:131], v[36:39]
s_add_u32 m0, s77, 49152
s_add_u32 s64, s76, 0
ds_read_b128 a[108:111], v10 offset:10240
v_mfma_f32_16x16x32_bf16 v[64:67], a[80:83], a[128:131], 0
s_mov_b32 s50, 663552
s_mov_b32 s51, 0x20000
s_lshl_b32 s89, s4, 10
v_mfma_f32_16x16x32_bf16 v[64:67], a[84:87], a[132:135], v[64:67]
buffer_load_dwordx4 v7, s[16:19], s64 offen lds
v_mfma_f32_16x16x32_bf16 v[72:75], a[84:87], a[140:143], 0
s_add_u32 s89, s89, 75497472
ds_read_b64_tr_b16 a[164:165], v11 offset:24576
ds_read_b64_tr_b16 a[166:167], v11 offset:25088
v_mfma_f32_16x16x32_bf16 v[72:75], a[80:83], a[136:139], v[72:75]
s_mul_i32 s94, s4, 1064960
s_cmp_eq_u32 s66, 0
s_cselect_b32 s52, s89, 2147418112
v_mfma_f32_16x16x32_bf16 v[80:83], a[80:83], a[144:147], 0
buffer_load_dwordx4 v8, s[16:19], s64 offen offset:1024 lds
v_mfma_f32_16x16x32_bf16 v[80:83], a[84:87], a[148:151], v[80:83]
s_add_u32 m0, s77, 51200
s_add_u32 s64, s76, 131072
ds_read_b128 a[112:115], v9 offset:12288
v_mfma_f32_16x16x32_bf16 v[88:91], a[84:87], a[156:159], 0
s_lshl_b32 s53, s5, 10
s_add_u32 s53, s53, s94
s_add_u32 s53, s53, 1048576
v_mfma_f32_16x16x32_bf16 v[88:91], a[80:83], a[152:155], v[88:91]
buffer_load_dwordx4 v7, s[16:19], s64 offen lds
v_mfma_f32_16x16x32_bf16 v[92:95], a[88:91], a[152:155], 0
ds_read_b64_tr_b16 a[168:169], v12 offset:16384
ds_read_b64_tr_b16 a[170:171], v12 offset:16896
v_mfma_f32_16x16x32_bf16 v[92:95], a[92:95], a[156:159], v[92:95]
s_cmp_eq_u32 s3, 1
s_cselect_b32 s52, s53, s52
s_mul_i32 s53, s2, 74
v_mfma_f32_16x16x32_bf16 v[84:87], a[92:95], a[148:151], 0
buffer_load_dwordx4 v8, s[16:19], s64 offen offset:1024 lds
v_mfma_f32_16x16x32_bf16 v[84:87], a[88:91], a[144:147], v[84:87]
s_add_u32 s53, s53, s55
s_lshl_b32 s53, s53, 10
s_add_u32 s53, s53, 54599680
v_mfma_f32_16x16x32_bf16 v[76:79], a[88:91], a[136:139], 0
s_cmp_ge_u32 s3, 2
s_cselect_b32 s52, s53, s52
ds_read_b128 a[116:119], v10 offset:12288
v_mfma_f32_16x16x32_bf16 v[76:79], a[92:95], a[140:143], v[76:79]
v_mov_b32 v16, 0
v_mov_b32 v17, 0
v_mfma_f32_16x16x32_bf16 v[68:71], a[92:95], a[132:135], 0
v_mov_b32 v18, 0
v_mov_b32 v19, 0
v_mfma_f32_16x16x32_bf16 v[68:71], a[88:91], a[128:131], v[68:71]
s_waitcnt lgkmcnt(6)
ds_read_b64_tr_b16 a[172:173], v12 offset:24576
ds_read_b64_tr_b16 a[174:175], v12 offset:25088
v_mfma_f32_16x16x32_bf16 v[96:99], a[96:99], a[128:131], 0
v_lshrrev_b32 v20, 3, v1
v_cmp_eq_u32 vcc, 3, v20
v_mfma_f32_16x16x32_bf16 v[96:99], a[100:103], a[132:135], v[96:99]
v_add_u32 v20, 100663168, v4
v_mov_b32 v21, s3
v_mfma_f32_16x16x32_bf16 v[104:107], a[100:103], a[140:143], 0
ds_read_b128 a[120:123], v9 offset:14336
v_cndmask_b32 v15, v4, v20, vcc
v_mfma_f32_16x16x32_bf16 v[104:107], a[96:99], a[136:139], v[104:107]
v_cmp_eq_u32 vcc, 0, v21
v_mov_b32 v21, 0
v_mfma_f32_16x16x32_bf16 v[112:115], a[96:99], a[144:147], 0
v_mov_b32 v21, 0
v_cndmask_b32 v20, v15, v4, vcc
v_mfma_f32_16x16x32_bf16 v[112:115], a[100:103], a[148:151], v[112:115]
ds_read_b64_tr_b16 a[176:177], v13 offset:16384
ds_read_b64_tr_b16 a[178:179], v13 offset:16896
v_mfma_f32_16x16x32_bf16 v[120:123], a[100:103], a[156:159], 0
v_mfma_f32_16x16x32_bf16 v[120:123], a[96:99], a[152:155], v[120:123]
v_mfma_f32_16x16x32_bf16 v[124:127], a[104:107], a[152:155], 0
v_mfma_f32_16x16x32_bf16 v[124:127], a[108:111], a[156:159], v[124:127]
ds_read_b128 a[124:127], v10 offset:14336
v_mfma_f32_16x16x32_bf16 v[116:119], a[108:111], a[148:151], 0
v_add_u32 v9, 32768, v9
v_add_u32 v10, 32768, v10
v_mfma_f32_16x16x32_bf16 v[116:119], a[104:107], a[144:147], v[116:119]
v_mfma_f32_16x16x32_bf16 v[108:111], a[104:107], a[136:139], 0
ds_read_b64_tr_b16 a[180:181], v13 offset:24576
ds_read_b64_tr_b16 a[182:183], v13 offset:25088
v_mfma_f32_16x16x32_bf16 v[108:111], a[108:111], a[140:143], v[108:111]
v_mfma_f32_16x16x32_bf16 v[100:103], a[108:111], a[132:135], 0
v_mfma_f32_16x16x32_bf16 v[100:103], a[104:107], a[128:131], v[100:103]
s_waitcnt lgkmcnt(2)
ds_read_b64_tr_b16 a[184:185], v14 offset:16384
ds_read_b64_tr_b16 a[186:187], v14 offset:16896
v_mfma_f32_16x16x32_bf16 v[128:131], a[112:115], a[128:131], 0
v_mfma_f32_16x16x32_bf16 v[128:131], a[116:119], a[132:135], v[128:131]
v_mfma_f32_16x16x32_bf16 v[136:139], a[116:119], a[140:143], 0
ds_read_b64_tr_b16 a[188:189], v14 offset:24576
ds_read_b64_tr_b16 a[190:191], v14 offset:25088
v_mfma_f32_16x16x32_bf16 v[136:139], a[112:115], a[136:139], v[136:139]
v_mfma_f32_16x16x32_bf16 v[144:147], a[112:115], a[144:147], 0
v_mfma_f32_16x16x32_bf16 v[144:147], a[116:119], a[148:151], v[144:147]
v_mfma_f32_16x16x32_bf16 v[152:155], a[116:119], a[156:159], 0
v_mfma_f32_16x16x32_bf16 v[152:155], a[112:115], a[152:155], v[152:155]
v_mfma_f32_16x16x32_bf16 v[156:159], a[120:123], a[152:155], 0
v_mfma_f32_16x16x32_bf16 v[156:159], a[124:127], a[156:159], v[156:159]
v_mfma_f32_16x16x32_bf16 v[148:151], a[124:127], a[148:151], 0
v_mfma_f32_16x16x32_bf16 v[148:151], a[120:123], a[144:147], v[148:151]
v_mfma_f32_16x16x32_bf16 v[140:143], a[120:123], a[136:139], 0
v_mfma_f32_16x16x32_bf16 v[140:143], a[124:127], a[140:143], v[140:143]
v_mfma_f32_16x16x32_bf16 v[132:135], a[124:127], a[132:135], 0
v_mfma_f32_16x16x32_bf16 v[132:135], a[120:123], a[128:131], v[132:135]
s_waitcnt lgkmcnt(0)
v_mfma_f32_16x16x32_bf16 v[160:163], a[160:163], a[64:67], 0
s_waitcnt vmcnt(4)
v_mfma_f32_16x16x32_bf16 v[160:163], a[164:167], a[68:71], v[160:163]
s_barrier
v_mfma_f32_16x16x32_bf16 v[164:167], a[172:175], a[68:71], 0
ds_read_b64_tr_b16 a[128:129], v11 offset:32768
ds_read_b64_tr_b16 a[130:131], v11 offset:33280
v_mfma_f32_16x16x32_bf16 v[164:167], a[168:171], a[64:67], v[164:167]
s_xor_b32 s71, s70, 256
s_add_u32 s71, s68, s71
v_mfma_f32_16x16x32_bf16 v[168:171], a[176:179], a[64:67], 0
s_add_u32 m0, s73, 65536
s_add_u32 s64, s71, 0
v_mfma_f32_16x16x32_bf16 v[168:171], a[180:183], a[68:71], v[168:171]
buffer_load_dwordx4 v5, s[8:11], s64 offen lds
v_mfma_f32_16x16x32_bf16 v[172:175], a[188:191], a[68:71], 0
v_mfma_f32_16x16x32_bf16 v[172:175], a[184:187], a[64:67], v[172:175]
ds_read_b128 a[64:67], v9 offset:0
v_mfma_f32_16x16x32_bf16 v[188:191], a[184:187], a[72:75], 0
buffer_load_dwordx4 v6, s[8:11], s64 offen offset:1024 lds
v_mfma_f32_16x16x32_bf16 v[188:191], a[188:191], a[76:79], v[188:191]
ds_read_b64_tr_b16 a[132:133], v11 offset:40960
ds_read_b64_tr_b16 a[134:135], v11 offset:41472
v_mfma_f32_16x16x32_bf16 v[184:187], a[180:183], a[76:79], 0
v_mfma_f32_16x16x32_bf16 v[184:187], a[176:179], a[72:75], v[184:187]
s_add_u32 m0, s73, 67584
s_add_u32 s64, s71, 16384
ds_read_b128 a[68:71], v10 offset:0
v_mfma_f32_16x16x32_bf16 v[180:183], a[168:171], a[72:75], 0
v_mfma_f32_16x16x32_bf16 v[180:183], a[172:175], a[76:79], v[180:183]
buffer_load_dwordx4 v5, s[8:11], s64 offen lds
v_mfma_f32_16x16x32_bf16 v[176:179], a[164:167], a[76:79], 0
L_PAD0:
s_cbranch_execz L_PAD4
v_mfma_f32_16x16x32_bf16 v[176:179], a[160:163], a[72:75], v[176:179]
ds_read_b64_tr_b16 a[136:137], v12 offset:32768
ds_read_b64_tr_b16 a[138:139], v12 offset:33280
v_mfma_f32_16x16x32_bf16 v[192:195], a[160:163], a[80:83], 0
v_mfma_f32_16x16x32_bf16 v[192:195], a[164:167], a[84:87], v[192:195]
v_mfma_f32_16x16x32_bf16 v[196:199], a[172:175], a[84:87], 0
buffer_load_dwordx4 v6, s[8:11], s64 offen offset:1024 lds
v_mfma_f32_16x16x32_bf16 v[196:199], a[168:171], a[80:83], v[196:199]
s_xor_b32 s76, s75, 1048576
s_add_u32 s76, s74, s76
ds_read_b128 a[72:75], v9 offset:2048
v_mfma_f32_16x16x32_bf16 v[200:203], a[176:179], a[80:83], 0
v_mfma_f32_16x16x32_bf16 v[200:203], a[180:183], a[84:87], v[200:203]
s_add_u32 m0, s77, 0
s_add_u32 s64, s76, 0
v_mfma_f32_16x16x32_bf16 v[204:207], a[188:191], a[84:87], 0
ds_read_b64_tr_b16 a[140:141], v12 offset:40960
ds_read_b64_tr_b16 a[142:143], v12 offset:41472
v_mfma_f32_16x16x32_bf16 v[204:207], a[184:187], a[80:83], v[204:207]
buffer_load_dwordx4 v7, s[56:59], s64 offen lds
v_mfma_f32_16x16x32_bf16 v[220:223], a[184:187], a[88:91], 0
ds_read_b128 a[76:79], v10 offset:2048
v_mfma_f32_16x16x32_bf16 v[220:223], a[188:191], a[92:95], v[220:223]
v_mfma_f32_16x16x32_bf16 v[216:219], a[180:183], a[92:95], 0
v_mfma_f32_16x16x32_bf16 v[216:219], a[176:179], a[88:91], v[216:219]
v_mfma_f32_16x16x32_bf16 v[212:215], a[168:171], a[88:91], 0
buffer_load_dwordx4 v8, s[56:59], s64 offen offset:1024 lds
v_mfma_f32_16x16x32_bf16 v[212:215], a[172:175], a[92:95], v[212:215]
ds_read_b64_tr_b16 a[144:145], v13 offset:32768
ds_read_b64_tr_b16 a[146:147], v13 offset:33280
v_mfma_f32_16x16x32_bf16 v[208:211], a[164:167], a[92:95], 0
v_mfma_f32_16x16x32_bf16 v[208:211], a[160:163], a[88:91], v[208:211]
s_add_u32 m0, s77, 2048
s_add_u32 s64, s76, 131072
ds_read_b128 a[80:83], v9 offset:4096
v_mfma_f32_16x16x32_bf16 v[224:227], a[160:163], a[96:99], 0
v_mfma_f32_16x16x32_bf16 v[224:227], a[164:167], a[100:103], v[224:227]
buffer_load_dwordx4 v7, s[56:59], s64 offen lds
v_mfma_f32_16x16x32_bf16 v[228:231], a[172:175], a[100:103], 0
ds_read_b64_tr_b16 a[148:149], v13 offset:40960
ds_read_b64_tr_b16 a[150:151], v13 offset:41472
v_mfma_f32_16x16x32_bf16 v[228:231], a[168:171], a[96:99], v[228:231]
v_mfma_f32_16x16x32_bf16 v[232:235], a[176:179], a[96:99], 0
buffer_store_dwordx4 v[16:19], v20, s[24:27], s52 offen sc1
v_mfma_f32_16x16x32_bf16 v[232:235], a[180:183], a[100:103], v[232:235]
buffer_load_dwordx4 v8, s[56:59], s64 offen offset:1024 lds
v_mfma_f32_16x16x32_bf16 v[236:239], a[188:191], a[100:103], 0
s_add_u32 s89, s89, 512
ds_read_b128 a[84:87], v10 offset:4096
v_mfma_f32_16x16x32_bf16 v[236:239], a[184:187], a[96:99], v[236:239]
s_cmp_eq_u32 s3, 0
s_cselect_b32 s90, s89, 2147418112
v_mov_b32 v24, 2147418112
v_mfma_f32_16x16x32_bf16 v[252:255], a[184:187], a[104:107], 0
s_add_u32 m0, s73, 69632
s_add_u32 s64, s71, 524288
v_cmp_eq_u32 vcc, 1, v1
v_mfma_f32_16x16x32_bf16 v[252:255], a[188:191], a[108:111], v[252:255]
s_lshl_b32 s53, s55, 12
ds_read_b64_tr_b16 a[152:153], v14 offset:32768
ds_read_b64_tr_b16 a[154:155], v14 offset:33280
v_mfma_f32_16x16x32_bf16 v[248:251], a[180:183], a[108:111], 0
buffer_load_dwordx4 v5, s[8:11], s64 offen lds
v_mfma_f32_16x16x32_bf16 v[248:251], a[176:179], a[104:107], v[248:251]
v_cndmask_b32 v0, v24, 0, vcc
v_mfma_f32_16x16x32_bf16 v[244:247], a[168:171], a[104:107], 0
s_mul_i32 s87, s87, 16384
s_add_u32 s87, s87, s94
ds_read_b128 a[88:91], v9 offset:6144
v_mfma_f32_16x16x32_bf16 v[244:247], a[172:175], a[108:111], v[244:247]
s_add_u32 s88, s87, s53
s_add_u32 s88, s88, 24576
s_lshr_b32 s53, s53, 1
v_mfma_f32_16x16x32_bf16 v[240:243], a[164:167], a[108:111], 0
s_add_u32 s87, s87, s53
s_lshl_b32 s80, s3, 10
s_mul_i32 s78, s4, 18
v_mfma_f32_16x16x32_bf16 v[240:243], a[160:163], a[104:107], v[240:243]
buffer_load_dwordx4 v6, s[8:11], s64 offen offset:1024 lds
v_mfma_f32_16x16x32_bf16 a[0:3], a[160:163], a[112:115], 0
s_add_u32 s78, s78, s54
ds_read_b64_tr_b16 a[156:157], v14 offset:40960
ds_read_b64_tr_b16 a[158:159], v14 offset:41472
v_mfma_f32_16x16x32_bf16 a[0:3], a[164:167], a[116:119], a[0:3]
s_lshl2_add_u32 s78, s78, s55
s_lshl_b32 s78, s78, 10
s_add_u32 s78, s78, 35651584
v_mfma_f32_16x16x32_bf16 a[4:7], a[172:175], a[116:119], 0
s_add_u32 m0, s73, 71680
s_add_u32 s64, s71, 540672
ds_read_b128 a[92:95], v10 offset:6144
v_mfma_f32_16x16x32_bf16 a[4:7], a[168:171], a[112:115], a[4:7]
s_add_u32 s80, s80, 8192
s_mov_b32 s91, 0x3e0293ee
s_mov_b32 s85, 0x05040100
v_mfma_f32_16x16x32_bf16 a[8:11], a[176:179], a[112:115], 0
buffer_load_dwordx4 v5, s[8:11], s64 offen lds
v_mfma_f32_16x16x32_bf16 a[8:11], a[180:183], a[116:119], a[8:11]
s_mov_b32 s86, 0x07060302
s_lshl2_add_u32 s52, s7, s3
s_and_b32 s65, s6, 3
v_mfma_f32_16x16x32_bf16 a[12:15], a[188:191], a[116:119], 0
s_max_u32 s95, s65, 1
s_mul_i32 s92, s5, 3
s_add_u32 s95, s95, s92
v_mfma_f32_16x16x32_bf16 a[12:15], a[184:187], a[112:115], a[12:15]
s_sub_u32 s95, 24, s95
s_cmp_eq_u32 s65, 1
s_cselect_b32 s95, 63, s95
v_mfma_f32_16x16x32_bf16 a[28:31], a[184:187], a[120:123], 0
s_mov_b32 s92, s95
s_mul_i32 s81, s92, 110592
s_mul_i32 s65, s52, 36
v_mfma_f32_16x16x32_bf16 a[28:31], a[188:191], a[124:127], a[28:31]
buffer_load_dwordx4 v6, s[8:11], s64 offen offset:1024 lds
v_mfma_f32_16x16x32_bf16 a[24:27], a[180:183], a[124:127], 0
s_add_u32 s81, s81, s65
s_mul_i32 s82, s52, 18
s_add_u32 s82, s82, s92
v_mfma_f32_16x16x32_bf16 a[24:27], a[176:179], a[120:123], a[24:27]
s_lshl_b32 s82, s82, 12
s_add_u32 s82, s82, 35651584
s_lshl_b32 s83, s92, 6
v_mfma_f32_16x16x32_bf16 a[20:23], a[168:171], a[120:123], 0
s_lshl_b32 s84, s52, 10
s_add_u32 s84, s84, 75497984
v_mfma_f32_16x16x32_bf16 a[20:23], a[172:175], a[124:127], a[20:23]
s_cmp_lt_u32 s92, 18
s_cselect_b32 s82, s82, 2147418112
s_cselect_b32 s84, s84, 2147418112
v_mfma_f32_16x16x32_bf16 a[16:19], a[164:167], a[124:127], 0
v_lshrrev_b32 v18, 2, v2
v_and_b32 v19, 3, v2
v_mfma_f32_16x16x32_bf16 a[16:19], a[160:163], a[120:123], a[16:19]
s_waitcnt lgkmcnt(0)
v_mul_u32_u24 v20, 1152, v18
v_cmp_eq_u32 vcc, 2, v19
v_mfma_f32_16x16x32_bf16 v[32:35], a[64:67], a[128:131], v[32:35]
s_waitcnt vmcnt(13)
v_lshl_add_u32 v20, v19, 3, v20
v_add_u32 v21, 1, v19
v_mfma_f32_16x16x32_bf16 v[32:35], a[68:71], a[132:135], v[32:35]
s_barrier
v_mfma_f32_16x16x32_bf16 v[40:43], a[68:71], a[140:143], v[40:43]
ds_read_b128 a[96:99], v9 offset:8192
v_cndmask_b32 v21, v21, 0, vcc
v_mfma_f32_16x16x32_bf16 v[40:43], a[64:67], a[136:139], v[40:43]
s_add_u32 m0, s77, 16384
s_add_u32 s64, s76, 0
v_cmp_eq_u32 vcc, 3, v18
v_mfma_f32_16x16x32_bf16 v[48:51], a[64:67], a[144:147], v[48:51]
buffer_load_dwordx4 v7, s[16:19], s64 offen lds
v_mfma_f32_16x16x32_bf16 v[48:51], a[68:71], a[148:151], v[48:51]
ds_read_b128 a[100:103], v10 offset:8192
v_mul_u32_u24 v21, 1152, v21
v_mfma_f32_16x16x32_bf16 v[56:59], a[68:71], a[156:159], v[56:59]
v_add_u32 v21, 32, v21
v_cndmask_b32 v20, v20, v21, vcc
v_mfma_f32_16x16x32_bf16 v[56:59], a[64:67], a[152:155], v[56:59]
v_cmp_eq_u32 vcc, 15, v2
v_mul_u32_u24 v21, 27648, v3
v_mfma_f32_16x16x32_bf16 v[60:63], a[72:75], a[152:155], v[60:63]
buffer_load_dwordx4 v8, s[16:19], s64 offen offset:1024 lds
v_mfma_f32_16x16x32_bf16 v[60:63], a[76:79], a[156:159], v[60:63]
ds_read_b128 a[104:107], v9 offset:10240
v_add_u32 v20, v20, v21
v_mfma_f32_16x16x32_bf16 v[52:55], a[76:79], a[148:151], v[52:55]
v_lshlrev_b32 v21, 4, v3
v_cndmask_b32 v26, v20, v24, vcc
v_mfma_f32_16x16x32_bf16 v[52:55], a[72:75], a[144:147], v[52:55]
s_add_u32 m0, s77, 18432
s_add_u32 s64, s76, 131072
v_cndmask_b32 v27, v24, v21, vcc
v_mfma_f32_16x16x32_bf16 v[44:47], a[72:75], a[136:139], v[44:47]
s_lshl_b32 s52, s4, 2
ds_read_b64_tr_b16 a[160:161], v11 offset:49152
ds_read_b64_tr_b16 a[162:163], v11 offset:49664
v_mfma_f32_16x16x32_bf16 v[44:47], a[76:79], a[140:143], v[44:47]
buffer_load_dwordx4 v7, s[16:19], s64 offen lds
v_mfma_f32_16x16x32_bf16 v[36:39], a[76:79], a[132:135], v[36:39]
s_cmp_eq_u32 s66, 0
s_cselect_b32 s52, s52, 2147418112
v_mfma_f32_16x16x32_bf16 v[36:39], a[72:75], a[128:131], v[36:39]
ds_read_b128 a[108:111], v10 offset:10240
v_mfma_f32_16x16x32_bf16 v[64:67], a[80:83], a[128:131], v[64:67]
v_mfma_f32_16x16x32_bf16 v[64:67], a[84:87], a[132:135], v[64:67]
v_mfma_f32_16x16x32_bf16 v[72:75], a[84:87], a[140:143], v[72:75]
buffer_load_dwordx4 v8, s[16:19], s64 offen offset:1024 lds
v_mfma_f32_16x16x32_bf16 v[72:75], a[80:83], a[136:139], v[72:75]
s_xor_b32 s71, s70, 384
s_add_u32 s71, s68, s71
v_mfma_f32_16x16x32_bf16 v[80:83], a[80:83], a[144:147], v[80:83]
ds_read_b64_tr_b16 a[164:165], v11 offset:57344
ds_read_b64_tr_b16 a[166:167], v11 offset:57856
v_mfma_f32_16x16x32_bf16 v[80:83], a[84:87], a[148:151], v[80:83]
s_add_u32 m0, s73, 0
s_add_u32 s64, s71, 0
ds_read_b128 a[112:115], v9 offset:12288
v_mfma_f32_16x16x32_bf16 v[88:91], a[84:87], a[156:159], v[88:91]
v_mfma_f32_16x16x32_bf16 v[88:91], a[80:83], a[152:155], v[88:91]
buffer_load_dwordx4 v5, s[8:11], s64 offen lds
v_mfma_f32_16x16x32_bf16 v[92:95], a[88:91], a[152:155], v[92:95]
ds_read_b64_tr_b16 a[168:169], v12 offset:49152
ds_read_b64_tr_b16 a[170:171], v12 offset:49664
v_mfma_f32_16x16x32_bf16 v[92:95], a[92:95], a[156:159], v[92:95]
v_mfma_f32_16x16x32_bf16 v[84:87], a[92:95], a[148:151], v[84:87]
v_mfma_f32_16x16x32_bf16 v[84:87], a[88:91], a[144:147], v[84:87]
v_mfma_f32_16x16x32_bf16 v[76:79], a[88:91], a[136:139], v[76:79]
buffer_load_dwordx4 v6, s[8:11], s64 offen offset:1024 lds
v_mfma_f32_16x16x32_bf16 v[76:79], a[92:95], a[140:143], v[76:79]
ds_read_b128 a[116:119], v10 offset:12288
v_mfma_f32_16x16x32_bf16 v[68:71], a[92:95], a[132:135], v[68:71]
v_mfma_f32_16x16x32_bf16 v[68:71], a[88:91], a[128:131], v[68:71]
s_add_u32 m0, s73, 2048
s_add_u32 s64, s71, 16384
s_waitcnt lgkmcnt(6)
v_mfma_f32_16x16x32_bf16 v[96:99], a[96:99], a[128:131], v[96:99]
ds_read_b64_tr_b16 a[172:173], v12 offset:57344
ds_read_b64_tr_b16 a[174:175], v12 offset:57856
v_mfma_f32_16x16x32_bf16 v[96:99], a[100:103], a[132:135], v[96:99]
buffer_load_dwordx4 v5, s[8:11], s64 offen lds
v_mfma_f32_16x16x32_bf16 v[104:107], a[100:103], a[140:143], v[104:107]
ds_read_b128 a[120:123], v9 offset:14336
v_mfma_f32_16x16x32_bf16 v[104:107], a[96:99], a[136:139], v[104:107]
v_mfma_f32_16x16x32_bf16 v[112:115], a[96:99], a[144:147], v[112:115]
v_mfma_f32_16x16x32_bf16 v[112:115], a[100:103], a[148:151], v[112:115]
buffer_load_dwordx4 v6, s[8:11], s64 offen offset:1024 lds
v_mfma_f32_16x16x32_bf16 v[120:123], a[100:103], a[156:159], v[120:123]
s_xor_b32 s76, s75, 1572864
s_add_u32 s76, s74, s76
v_mfma_f32_16x16x32_bf16 v[120:123], a[96:99], a[152:155], v[120:123]
ds_read_b64_tr_b16 a[176:177], v13 offset:49152
ds_read_b64_tr_b16 a[178:179], v13 offset:49664
v_mfma_f32_16x16x32_bf16 v[124:127], a[104:107], a[152:155], v[124:127]
s_add_u32 m0, s77, 32768
s_add_u32 s64, s76, 0
v_mfma_f32_16x16x32_bf16 v[124:127], a[108:111], a[156:159], v[124:127]
ds_read_b128 a[124:127], v10 offset:14336
v_mfma_f32_16x16x32_bf16 v[116:119], a[108:111], a[148:151], v[116:119]
buffer_load_dwordx4 v7, s[56:59], s64 offen lds
v_mfma_f32_16x16x32_bf16 v[116:119], a[104:107], a[144:147], v[116:119]
s_waitcnt vmcnt(14)
v_add_u32 v9, 32768, v9
v_add_u32 v10, 32768, v10
v_mfma_f32_16x16x32_bf16 v[108:111], a[104:107], a[136:139], v[108:111]
ds_read_b64_tr_b16 a[180:181], v13 offset:57344
ds_read_b64_tr_b16 a[182:183], v13 offset:57856
v_mfma_f32_16x16x32_bf16 v[108:111], a[108:111], a[140:143], v[108:111]
buffer_store_dword v1, v0, s[40:43], s52 offen sc1
v_mfma_f32_16x16x32_bf16 v[100:103], a[108:111], a[132:135], v[100:103]
s_waitcnt lgkmcnt(2)
s_lshl2_add_u32 s55, s95, s3
s_lshl3_add_u32 s54, s55, s7
v_mfma_f32_16x16x32_bf16 v[100:103], a[104:107], a[128:131], v[100:103]
buffer_load_dwordx4 v8, s[56:59], s64 offen offset:1024 lds
v_mfma_f32_16x16x32_bf16 v[128:131], a[112:115], a[128:131], v[128:131]
s_mul_i32 s53, s54, 3072
ds_read_b64_tr_b16 a[184:185], v14 offset:49152
ds_read_b64_tr_b16 a[186:187], v14 offset:49664
v_mfma_f32_16x16x32_bf16 v[128:131], a[116:119], a[132:135], v[128:131]
s_mul_i32 s55, s55, 48
s_add_u32 s55, s55, s7
s_lshl_b32 s55, s55, 10
v_mfma_f32_16x16x32_bf16 v[136:139], a[116:119], a[140:143], v[136:139]
s_add_u32 m0, s77, 34816
s_add_u32 s64, s76, 131072
v_min_u32 v20, 23, v1
v_mfma_f32_16x16x32_bf16 v[136:139], a[112:115], a[136:139], v[136:139]
ds_read_b64_tr_b16 a[188:189], v14 offset:57344
ds_read_b64_tr_b16 a[190:191], v14 offset:57856
v_mfma_f32_16x16x32_bf16 v[144:147], a[112:115], a[144:147], v[144:147]
buffer_load_dwordx4 v7, s[56:59], s64 offen lds
v_mfma_f32_16x16x32_bf16 v[144:147], a[116:119], a[148:151], v[144:147]
v_lshrrev_b32 v21, 3, v20
v_mul_u32_u24 v21, 7168, v21
v_mfma_f32_16x16x32_bf16 v[152:155], a[116:119], a[156:159], v[152:155]
v_lshlrev_b32 v20, 7, v20
v_add_u32 v21, v21, v20
v_mfma_f32_16x16x32_bf16 v[152:155], a[112:115], a[152:155], v[152:155]
v_mfma_f32_16x16x32_bf16 v[156:159], a[120:123], a[152:155], v[156:159]
v_mfma_f32_16x16x32_bf16 v[156:159], a[124:127], a[156:159], v[156:159]
buffer_load_dwordx4 v8, s[56:59], s64 offen offset:1024 lds
v_mfma_f32_16x16x32_bf16 v[148:151], a[124:127], a[148:151], v[148:151]
v_mfma_f32_16x16x32_bf16 v[148:151], a[120:123], a[144:147], v[148:151]
v_mfma_f32_16x16x32_bf16 v[140:143], a[120:123], a[136:139], v[140:143]
v_mfma_f32_16x16x32_bf16 v[140:143], a[124:127], a[140:143], v[140:143]
v_mfma_f32_16x16x32_bf16 v[132:135], a[124:127], a[132:135], v[132:135]
v_mfma_f32_16x16x32_bf16 v[132:135], a[120:123], a[128:131], v[132:135]
s_waitcnt lgkmcnt(0)
v_mfma_f32_16x16x32_bf16 v[160:163], a[160:163], a[64:67], v[160:163]
s_waitcnt vmcnt(13)
v_mfma_f32_16x16x32_bf16 v[160:163], a[164:167], a[68:71], v[160:163]
s_barrier
v_mfma_f32_16x16x32_bf16 v[164:167], a[172:175], a[68:71], v[164:167]
ds_read_b64_tr_b16 a[128:129], v11 offset:0
ds_read_b64_tr_b16 a[130:131], v11 offset:512
v_mfma_f32_16x16x32_bf16 v[164:167], a[168:171], a[64:67], v[164:167]
s_add_u32 m0, s73, 4096
s_add_u32 s64, s71, 524288
v_mfma_f32_16x16x32_bf16 v[168:171], a[176:179], a[64:67], v[168:171]
buffer_load_dwordx4 v5, s[8:11], s64 offen lds
v_mfma_f32_16x16x32_bf16 v[168:171], a[180:183], a[68:71], v[168:171]
v_mfma_f32_16x16x32_bf16 v[172:175], a[188:191], a[68:71], v[172:175]
v_mfma_f32_16x16x32_bf16 v[172:175], a[184:187], a[64:67], v[172:175]
ds_read_b128 a[64:67], v9 offset:0
v_mfma_f32_16x16x32_bf16 v[188:191], a[184:187], a[72:75], v[188:191]
buffer_load_dwordx4 v6, s[8:11], s64 offen offset:1024 lds
v_mfma_f32_16x16x32_bf16 v[188:191], a[188:191], a[76:79], v[188:191]
ds_read_b64_tr_b16 a[132:133], v11 offset:8192
ds_read_b64_tr_b16 a[134:135], v11 offset:8704
v_mfma_f32_16x16x32_bf16 v[184:187], a[180:183], a[76:79], v[184:187]
v_mfma_f32_16x16x32_bf16 v[184:187], a[176:179], a[72:75], v[184:187]
s_add_u32 m0, s73, 6144
s_add_u32 s64, s71, 540672
ds_read_b128 a[68:71], v10 offset:0
v_mfma_f32_16x16x32_bf16 v[180:183], a[168:171], a[72:75], v[180:183]
v_mfma_f32_16x16x32_bf16 v[180:183], a[172:175], a[76:79], v[180:183]
buffer_load_dwordx4 v5, s[8:11], s64 offen lds
v_mfma_f32_16x16x32_bf16 v[176:179], a[164:167], a[76:79], v[176:179]
v_mfma_f32_16x16x32_bf16 v[176:179], a[160:163], a[72:75], v[176:179]
ds_read_b64_tr_b16 a[136:137], v12 offset:0
ds_read_b64_tr_b16 a[138:139], v12 offset:512
v_mfma_f32_16x16x32_bf16 v[192:195], a[160:163], a[80:83], v[192:195]
v_mfma_f32_16x16x32_bf16 v[192:195], a[164:167], a[84:87], v[192:195]
v_mfma_f32_16x16x32_bf16 v[196:199], a[172:175], a[84:87], v[196:199]
buffer_load_dwordx4 v6, s[8:11], s64 offen offset:1024 lds
v_mfma_f32_16x16x32_bf16 v[196:199], a[168:171], a[80:83], v[196:199]
ds_read_b128 a[72:75], v9 offset:2048
v_mfma_f32_16x16x32_bf16 v[200:203], a[176:179], a[80:83], v[200:203]
v_mfma_f32_16x16x32_bf16 v[200:203], a[180:183], a[84:87], v[200:203]
s_add_u32 m0, s77, 49152
s_add_u32 s64, s76, 0
v_mfma_f32_16x16x32_bf16 v[204:207], a[188:191], a[84:87], v[204:207]
ds_read_b64_tr_b16 a[140:141], v12 offset:8192
ds_read_b64_tr_b16 a[142:143], v12 offset:8704
v_mfma_f32_16x16x32_bf16 v[204:207], a[184:187], a[80:83], v[204:207]
buffer_load_dwordx4 v7, s[16:19], s64 offen lds
v_mfma_f32_16x16x32_bf16 v[220:223], a[184:187], a[88:91], v[220:223]
ds_read_b128 a[76:79], v10 offset:2048
v_mfma_f32_16x16x32_bf16 v[220:223], a[188:191], a[92:95], v[220:223]
v_mfma_f32_16x16x32_bf16 v[216:219], a[180:183], a[92:95], v[216:219]
v_mfma_f32_16x16x32_bf16 v[216:219], a[176:179], a[88:91], v[216:219]
v_mfma_f32_16x16x32_bf16 v[212:215], a[168:171], a[88:91], v[212:215]
buffer_load_dwordx4 v8, s[16:19], s64 offen offset:1024 lds
v_mfma_f32_16x16x32_bf16 v[212:215], a[172:175], a[92:95], v[212:215]
ds_read_b64_tr_b16 a[144:145], v13 offset:0
ds_read_b64_tr_b16 a[146:147], v13 offset:512
v_mfma_f32_16x16x32_bf16 v[208:211], a[164:167], a[92:95], v[208:211]
v_mfma_f32_16x16x32_bf16 v[208:211], a[160:163], a[88:91], v[208:211]
s_add_u32 m0, s77, 51200
s_add_u32 s64, s76, 131072
ds_read_b128 a[80:83], v9 offset:4096
v_mfma_f32_16x16x32_bf16 v[224:227], a[160:163], a[96:99], v[224:227]
v_mfma_f32_16x16x32_bf16 v[224:227], a[164:167], a[100:103], v[224:227]
buffer_load_dwordx4 v7, s[16:19], s64 offen lds
v_mfma_f32_16x16x32_bf16 v[228:231], a[172:175], a[100:103], v[228:231]
ds_read_b64_tr_b16 a[148:149], v13 offset:8192
ds_read_b64_tr_b16 a[150:151], v13 offset:8704
v_mfma_f32_16x16x32_bf16 v[228:231], a[168:171], a[96:99], v[228:231]
v_mfma_f32_16x16x32_bf16 v[232:235], a[176:179], a[96:99], v[232:235]
v_mfma_f32_16x16x32_bf16 v[232:235], a[180:183], a[100:103], v[232:235]
buffer_load_dwordx4 v8, s[16:19], s64 offen offset:1024 lds
v_mfma_f32_16x16x32_bf16 v[236:239], a[188:191], a[100:103], v[236:239]
s_xor_b32 s71, s70, 512
s_add_u32 s71, s68, s71
ds_read_b128 a[84:87], v10 offset:4096
v_mfma_f32_16x16x32_bf16 v[236:239], a[184:187], a[96:99], v[236:239]
v_mfma_f32_16x16x32_bf16 v[252:255], a[184:187], a[104:107], v[252:255]
s_add_u32 m0, s73, 32768
s_add_u32 s64, s71, 0
v_mfma_f32_16x16x32_bf16 v[252:255], a[188:191], a[108:111], v[252:255]
ds_read_b64_tr_b16 a[152:153], v14 offset:0
ds_read_b64_tr_b16 a[154:155], v14 offset:512
v_mfma_f32_16x16x32_bf16 v[248:251], a[180:183], a[108:111], v[248:251]
buffer_load_dwordx4 v5, s[8:11], s64 offen lds
v_mfma_f32_16x16x32_bf16 v[248:251], a[176:179], a[104:107], v[248:251]
v_mfma_f32_16x16x32_bf16 v[244:247], a[168:171], a[104:107], v[244:247]
ds_read_b128 a[88:91], v9 offset:6144
v_mfma_f32_16x16x32_bf16 v[244:247], a[172:175], a[108:111], v[244:247]
v_mfma_f32_16x16x32_bf16 v[240:243], a[164:167], a[108:111], v[240:243]
v_mfma_f32_16x16x32_bf16 v[240:243], a[160:163], a[104:107], v[240:243]
buffer_load_dwordx4 v6, s[8:11], s64 offen offset:1024 lds
v_mfma_f32_16x16x32_bf16 a[0:3], a[160:163], a[112:115], a[0:3]
ds_read_b64_tr_b16 a[156:157], v14 offset:8192
ds_read_b64_tr_b16 a[158:159], v14 offset:8704
v_mfma_f32_16x16x32_bf16 a[0:3], a[164:167], a[116:119], a[0:3]
v_mfma_f32_16x16x32_bf16 a[4:7], a[172:175], a[116:119], a[4:7]
s_add_u32 m0, s73, 34816
s_add_u32 s64, s71, 16384
ds_read_b128 a[92:95], v10 offset:6144
v_mfma_f32_16x16x32_bf16 a[4:7], a[168:171], a[112:115], a[4:7]
v_mfma_f32_16x16x32_bf16 a[8:11], a[176:179], a[112:115], a[8:11]
buffer_load_dwordx4 v5, s[8:11], s64 offen lds
v_mfma_f32_16x16x32_bf16 a[8:11], a[180:183], a[116:119], a[8:11]
v_mfma_f32_16x16x32_bf16 a[12:15], a[188:191], a[116:119], a[12:15]
v_mfma_f32_16x16x32_bf16 a[12:15], a[184:187], a[112:115], a[12:15]
v_mfma_f32_16x16x32_bf16 a[28:31], a[184:187], a[120:123], a[28:31]
v_mfma_f32_16x16x32_bf16 a[28:31], a[188:191], a[124:127], a[28:31]
buffer_load_dwordx4 v6, s[8:11], s64 offen offset:1024 lds
v_mfma_f32_16x16x32_bf16 a[24:27], a[180:183], a[124:127], a[24:27]
v_mfma_f32_16x16x32_bf16 a[24:27], a[176:179], a[120:123], a[24:27]
v_mfma_f32_16x16x32_bf16 a[20:23], a[168:171], a[120:123], a[20:23]
v_mfma_f32_16x16x32_bf16 a[20:23], a[172:175], a[124:127], a[20:23]
v_mfma_f32_16x16x32_bf16 a[16:19], a[164:167], a[124:127], a[16:19]
v_mfma_f32_16x16x32_bf16 a[16:19], a[160:163], a[120:123], a[16:19]
s_waitcnt lgkmcnt(0)
v_mfma_f32_16x16x32_bf16 v[32:35], a[64:67], a[128:131], v[32:35]
s_waitcnt vmcnt(21)
v_mfma_f32_16x16x32_bf16 v[32:35], a[68:71], a[132:135], v[32:35]
s_barrier
v_mfma_f32_16x16x32_bf16 v[40:43], a[68:71], a[140:143], v[40:43]
s_add_u32 s52, s81, 0
ds_read_b128 a[96:99], v9 offset:8192
v_mfma_f32_16x16x32_bf16 v[40:43], a[64:67], a[136:139], v[40:43]
s_xor_b32 s76, s75, 2097152
s_add_u32 s76, s74, s76
v_mfma_f32_16x16x32_bf16 v[48:51], a[64:67], a[144:147], v[48:51]
s_add_u32 m0, s77, 0
s_add_u32 s64, s76, 0
v_mfma_f32_16x16x32_bf16 v[48:51], a[68:71], a[148:151], v[48:51]
buffer_load_dwordx4 v7, s[56:59], s64 offen lds
v_mfma_f32_16x16x32_bf16 v[56:59], a[68:71], a[156:159], v[56:59]
ds_read_b128 a[100:103], v10 offset:8192
v_mfma_f32_16x16x32_bf16 v[56:59], a[64:67], a[152:155], v[56:59]
buffer_load_dwordx2 a[192:193], v26, s[28:31], s52 offen
v_mfma_f32_16x16x32_bf16 v[60:63], a[72:75], a[152:155], v[60:63]
ds_read_b128 a[104:107], v9 offset:10240
v_mfma_f32_16x16x32_bf16 v[60:63], a[76:79], a[156:159], v[60:63]
v_mfma_f32_16x16x32_bf16 v[52:55], a[76:79], a[148:151], v[52:55]
s_add_u32 s52, s81, 3456
v_mfma_f32_16x16x32_bf16 v[52:55], a[72:75], a[144:147], v[52:55]
buffer_load_dwordx4 v8, s[56:59], s64 offen offset:1024 lds
v_mfma_f32_16x16x32_bf16 v[44:47], a[72:75], a[136:139], v[44:47]
ds_read_b64_tr_b16 a[160:161], v11 offset:16384
ds_read_b64_tr_b16 a[162:163], v11 offset:16896
v_mfma_f32_16x16x32_bf16 v[44:47], a[76:79], a[140:143], v[44:47]
buffer_load_dwordx2 a[194:195], v26, s[28:31], s52 offen
v_mfma_f32_16x16x32_bf16 v[36:39], a[76:79], a[132:135], v[36:39]
v_mfma_f32_16x16x32_bf16 v[36:39], a[72:75], a[128:131], v[36:39]
ds_read_b128 a[108:111], v10 offset:10240
v_mfma_f32_16x16x32_bf16 v[64:67], a[80:83], a[128:131], v[64:67]
s_add_u32 m0, s77, 2048
s_add_u32 s64, s76, 131072
s_add_u32 s52, s81, 6912
v_mfma_f32_16x16x32_bf16 v[64:67], a[84:87], a[132:135], v[64:67]
buffer_load_dwordx2 a[196:197], v26, s[28:31], s52 offen
v_mfma_f32_16x16x32_bf16 v[72:75], a[84:87], a[140:143], v[72:75]
buffer_load_dwordx4 v7, s[56:59], s64 offen lds
v_mfma_f32_16x16x32_bf16 v[72:75], a[80:83], a[136:139], v[72:75]
ds_read_b64_tr_b16 a[164:165], v11 offset:24576
ds_read_b64_tr_b16 a[166:167], v11 offset:25088
v_mfma_f32_16x16x32_bf16 v[80:83], a[80:83], a[144:147], v[80:83]
s_add_u32 s52, s81, 10368
v_mfma_f32_16x16x32_bf16 v[80:83], a[84:87], a[148:151], v[80:83]
ds_read_b128 a[112:115], v9 offset:12288
v_mfma_f32_16x16x32_bf16 v[88:91], a[84:87], a[156:159], v[88:91]
buffer_load_dwordx2 a[198:199], v26, s[28:31], s52 offen
v_mfma_f32_16x16x32_bf16 v[88:91], a[80:83], a[152:155], v[88:91]
v_mfma_f32_16x16x32_bf16 v[92:95], a[88:91], a[152:155], v[92:95]
ds_read_b64_tr_b16 a[168:169], v12 offset:16384
ds_read_b64_tr_b16 a[170:171], v12 offset:16896
v_mfma_f32_16x16x32_bf16 v[92:95], a[92:95], a[156:159], v[92:95]
buffer_load_dwordx4 v8, s[56:59], s64 offen offset:1024 lds
v_mfma_f32_16x16x32_bf16 v[84:87], a[92:95], a[148:151], v[84:87]
s_add_u32 s52, s81, 13824
v_mfma_f32_16x16x32_bf16 v[84:87], a[88:91], a[144:147], v[84:87]
buffer_load_dwordx2 a[200:201], v26, s[28:31], s52 offen
v_mfma_f32_16x16x32_bf16 v[76:79], a[88:91], a[136:139], v[76:79]
ds_read_b128 a[116:119], v10 offset:12288
v_mfma_f32_16x16x32_bf16 v[76:79], a[92:95], a[140:143], v[76:79]
v_mfma_f32_16x16x32_bf16 v[68:71], a[92:95], a[132:135], v[68:71]
s_add_u32 s52, s81, 17280
v_mfma_f32_16x16x32_bf16 v[68:71], a[88:91], a[128:131], v[68:71]
s_add_u32 m0, s73, 36864
s_add_u32 s64, s71, 524288
s_waitcnt lgkmcnt(6)
v_mfma_f32_16x16x32_bf16 v[96:99], a[96:99], a[128:131], v[96:99]
ds_read_b64_tr_b16 a[172:173], v12 offset:24576
ds_read_b64_tr_b16 a[174:175], v12 offset:25088
v_mfma_f32_16x16x32_bf16 v[96:99], a[100:103], a[132:135], v[96:99]
buffer_load_dwordx4 v5, s[8:11], s64 offen lds
v_mfma_f32_16x16x32_bf16 v[104:107], a[100:103], a[140:143], v[104:107]
ds_read_b128 a[120:123], v9 offset:14336
v_mfma_f32_16x16x32_bf16 v[104:107], a[96:99], a[136:139], v[104:107]
buffer_load_dwordx2 a[202:203], v26, s[28:31], s52 offen
v_mfma_f32_16x16x32_bf16 v[112:115], a[96:99], a[144:147], v[112:115]
v_mfma_f32_16x16x32_bf16 v[112:115], a[100:103], a[148:151], v[112:115]
ds_read_b64_tr_b16 a[176:177], v13 offset:16384
ds_read_b64_tr_b16 a[178:179], v13 offset:16896
v_mfma_f32_16x16x32_bf16 v[120:123], a[100:103], a[156:159], v[120:123]
s_add_u32 s52, s81, 20736
v_mfma_f32_16x16x32_bf16 v[120:123], a[96:99], a[152:155], v[120:123]
buffer_load_dwordx2 a[204:205], v26, s[28:31], s52 offen
v_mfma_f32_16x16x32_bf16 v[124:127], a[104:107], a[152:155], v[124:127]
buffer_load_dwordx4 v6, s[8:11], s64 offen offset:1024 lds
v_mfma_f32_16x16x32_bf16 v[124:127], a[108:111], a[156:159], v[124:127]
ds_read_b128 a[124:127], v10 offset:14336
v_mfma_f32_16x16x32_bf16 v[116:119], a[108:111], a[148:151], v[116:119]
s_add_u32 s52, s81, 24192
v_add_u32 v9, -65536, v9
v_add_u32 v10, -65536, v10
v_mfma_f32_16x16x32_bf16 v[116:119], a[104:107], a[144:147], v[116:119]
buffer_load_dwordx2 a[206:207], v26, s[28:31], s52 offen
v_mfma_f32_16x16x32_bf16 v[108:111], a[104:107], a[136:139], v[108:111]
ds_read_b64_tr_b16 a[180:181], v13 offset:24576
ds_read_b64_tr_b16 a[182:183], v13 offset:25088
v_mfma_f32_16x16x32_bf16 v[108:111], a[108:111], a[140:143], v[108:111]
s_add_u32 m0, s73, 38912
s_add_u32 s64, s71, 540672
v_mfma_f32_16x16x32_bf16 v[100:103], a[108:111], a[132:135], v[100:103]
s_waitcnt lgkmcnt(2)
v_mfma_f32_16x16x32_bf16 v[100:103], a[104:107], a[128:131], v[100:103]
buffer_load_dwordx4 v5, s[8:11], s64 offen lds
v_mfma_f32_16x16x32_bf16 v[128:131], a[112:115], a[128:131], v[128:131]
ds_read_b64_tr_b16 a[184:185], v14 offset:16384
ds_read_b64_tr_b16 a[186:187], v14 offset:16896
v_mfma_f32_16x16x32_bf16 v[128:131], a[116:119], a[132:135], v[128:131]
buffer_load_dwordx4 a[208:211], v27, s[36:39], s83 offen
v_mfma_f32_16x16x32_bf16 v[136:139], a[116:119], a[140:143], v[136:139]
ds_read_b64_tr_b16 a[188:189], v14 offset:24576
ds_read_b64_tr_b16 a[190:191], v14 offset:25088
v_mfma_f32_16x16x32_bf16 v[136:139], a[112:115], a[136:139], v[136:139]
v_mfma_f32_16x16x32_bf16 v[144:147], a[112:115], a[144:147], v[144:147]
v_mfma_f32_16x16x32_bf16 v[144:147], a[116:119], a[148:151], v[144:147]
v_mfma_f32_16x16x32_bf16 v[152:155], a[116:119], a[156:159], v[152:155]
buffer_load_dwordx4 v6, s[8:11], s64 offen offset:1024 lds
v_mfma_f32_16x16x32_bf16 v[152:155], a[112:115], a[152:155], v[152:155]
v_mfma_f32_16x16x32_bf16 v[156:159], a[120:123], a[152:155], v[156:159]
v_mfma_f32_16x16x32_bf16 v[156:159], a[124:127], a[156:159], v[156:159]
v_mfma_f32_16x16x32_bf16 v[148:151], a[124:127], a[148:151], v[148:151]
v_mfma_f32_16x16x32_bf16 v[148:151], a[120:123], a[144:147], v[148:151]
v_mfma_f32_16x16x32_bf16 v[140:143], a[120:123], a[136:139], v[140:143]
v_mfma_f32_16x16x32_bf16 v[140:143], a[124:127], a[140:143], v[140:143]
v_mfma_f32_16x16x32_bf16 v[132:135], a[124:127], a[132:135], v[132:135]
v_mfma_f32_16x16x32_bf16 v[132:135], a[120:123], a[128:131], v[132:135]
s_waitcnt lgkmcnt(0)
v_mfma_f32_16x16x32_bf16 v[160:163], a[160:163], a[64:67], v[160:163]
s_waitcnt vmcnt(25)
v_mfma_f32_16x16x32_bf16 v[160:163], a[164:167], a[68:71], v[160:163]
s_barrier
v_mfma_f32_16x16x32_bf16 v[164:167], a[172:175], a[68:71], v[164:167]
ds_read_b64_tr_b16 a[128:129], v11 offset:32768
ds_read_b64_tr_b16 a[130:131], v11 offset:33280
v_mfma_f32_16x16x32_bf16 v[164:167], a[168:171], a[64:67], v[164:167]
s_add_u32 m0, s77, 16384
s_add_u32 s64, s76, 0
v_mfma_f32_16x16x32_bf16 v[168:171], a[176:179], a[64:67], v[168:171]
buffer_load_dwordx4 v7, s[16:19], s64 offen lds
v_mfma_f32_16x16x32_bf16 v[168:171], a[180:183], a[68:71], v[168:171]
v_mfma_f32_16x16x32_bf16 v[172:175], a[188:191], a[68:71], v[172:175]
v_mfma_f32_16x16x32_bf16 v[172:175], a[184:187], a[64:67], v[172:175]
ds_read_b128 a[64:67], v9 offset:0
v_mfma_f32_16x16x32_bf16 v[188:191], a[184:187], a[72:75], v[188:191]
L_PAD1:
s_cbranch_execz L_PAD5
ds_read_b64_tr_b16 a[132:133], v11 offset:40960
ds_read_b64_tr_b16 a[134:135], v11 offset:41472
v_mfma_f32_16x16x32_bf16 v[188:191], a[188:191], a[76:79], v[188:191]
v_mfma_f32_16x16x32_bf16 v[184:187], a[180:183], a[76:79], v[184:187]
v_mfma_f32_16x16x32_bf16 v[184:187], a[176:179], a[72:75], v[184:187]
buffer_load_dwordx4 v8, s[16:19], s64 offen offset:1024 lds
v_mfma_f32_16x16x32_bf16 v[180:183], a[168:171], a[72:75], v[180:183]
ds_read_b128 a[68:71], v10 offset:0
v_mfma_f32_16x16x32_bf16 v[180:183], a[172:175], a[76:79], v[180:183]
v_mfma_f32_16x16x32_bf16 v[176:179], a[164:167], a[76:79], v[176:179]
v_mfma_f32_16x16x32_bf16 v[176:179], a[160:163], a[72:75], v[176:179]
ds_read_b64_tr_b16 a[136:137], v12 offset:32768
ds_read_b64_tr_b16 a[138:139], v12 offset:33280
v_mfma_f32_16x16x32_bf16 v[192:195], a[160:163], a[80:83], v[192:195]
s_add_u32 m0, s77, 18432
s_add_u32 s64, s76, 131072
v_mfma_f32_16x16x32_bf16 v[192:195], a[164:167], a[84:87], v[192:195]
v_mfma_f32_16x16x32_bf16 v[196:199], a[172:175], a[84:87], v[196:199]
buffer_load_dwordx4 v7, s[16:19], s64 offen lds
v_mfma_f32_16x16x32_bf16 v[196:199], a[168:171], a[80:83], v[196:199]
ds_read_b128 a[72:75], v9 offset:2048
v_mfma_f32_16x16x32_bf16 v[200:203], a[176:179], a[80:83], v[200:203]
v_mfma_f32_16x16x32_bf16 v[200:203], a[180:183], a[84:87], v[200:203]
ds_read_b64_tr_b16 a[140:141], v12 offset:40960
ds_read_b64_tr_b16 a[142:143], v12 offset:41472
v_mfma_f32_16x16x32_bf16 v[204:207], a[188:191], a[84:87], v[204:207]
v_mfma_f32_16x16x32_bf16 v[204:207], a[184:187], a[80:83], v[204:207]
v_mfma_f32_16x16x32_bf16 v[220:223], a[184:187], a[88:91], v[220:223]
ds_read_b128 a[76:79], v10 offset:2048
v_mfma_f32_16x16x32_bf16 v[220:223], a[188:191], a[92:95], v[220:223]
buffer_load_dwordx4 v8, s[16:19], s64 offen offset:1024 lds
v_mfma_f32_16x16x32_bf16 v[216:219], a[180:183], a[92:95], v[216:219]
s_xor_b32 s71, s70, 640
s_add_u32 s71, s68, s71
v_mfma_f32_16x16x32_bf16 v[216:219], a[176:179], a[88:91], v[216:219]
v_mfma_f32_16x16x32_bf16 v[212:215], a[168:171], a[88:91], v[212:215]
ds_read_b64_tr_b16 a[144:145], v13 offset:32768
ds_read_b64_tr_b16 a[146:147], v13 offset:33280
v_mfma_f32_16x16x32_bf16 v[212:215], a[172:175], a[92:95], v[212:215]
v_mfma_f32_16x16x32_bf16 v[208:211], a[164:167], a[92:95], v[208:211]
v_mfma_f32_16x16x32_bf16 v[208:211], a[160:163], a[88:91], v[208:211]
s_add_u32 m0, s73, 65536
s_add_u32 s64, s71, 0
ds_read_b128 a[80:83], v9 offset:4096
v_mfma_f32_16x16x32_bf16 v[224:227], a[160:163], a[96:99], v[224:227]
v_mfma_f32_16x16x32_bf16 v[224:227], a[164:167], a[100:103], v[224:227]
buffer_load_dwordx4 v5, s[8:11], s64 offen lds
v_mfma_f32_16x16x32_bf16 v[228:231], a[172:175], a[100:103], v[228:231]
ds_read_b64_tr_b16 a[148:149], v13 offset:40960
ds_read_b64_tr_b16 a[150:151], v13 offset:41472
v_mfma_f32_16x16x32_bf16 v[228:231], a[168:171], a[96:99], v[228:231]
v_mfma_f32_16x16x32_bf16 v[232:235], a[176:179], a[96:99], v[232:235]
v_mfma_f32_16x16x32_bf16 v[232:235], a[180:183], a[100:103], v[232:235]
ds_read_b128 a[84:87], v10 offset:4096
v_mfma_f32_16x16x32_bf16 v[236:239], a[188:191], a[100:103], v[236:239]
v_mfma_f32_16x16x32_bf16 v[236:239], a[184:187], a[96:99], v[236:239]
v_mfma_f32_16x16x32_bf16 v[252:255], a[184:187], a[104:107], v[252:255]
buffer_load_dwordx4 v6, s[8:11], s64 offen offset:1024 lds
v_mfma_f32_16x16x32_bf16 v[252:255], a[188:191], a[108:111], v[252:255]
ds_read_b64_tr_b16 a[152:153], v14 offset:32768
ds_read_b64_tr_b16 a[154:155], v14 offset:33280
v_mfma_f32_16x16x32_bf16 v[248:251], a[180:183], a[108:111], v[248:251]
v_mfma_f32_16x16x32_bf16 v[248:251], a[176:179], a[104:107], v[248:251]
v_mfma_f32_16x16x32_bf16 v[244:247], a[168:171], a[104:107], v[244:247]
ds_read_b128 a[88:91], v9 offset:6144
v_mfma_f32_16x16x32_bf16 v[244:247], a[172:175], a[108:111], v[244:247]
s_add_u32 m0, s73, 67584
s_add_u32 s64, s71, 16384
v_mfma_f32_16x16x32_bf16 v[240:243], a[164:167], a[108:111], v[240:243]
v_mfma_f32_16x16x32_bf16 v[240:243], a[160:163], a[104:107], v[240:243]
buffer_load_dwordx4 v5, s[8:11], s64 offen lds
v_mfma_f32_16x16x32_bf16 a[0:3], a[160:163], a[112:115], a[0:3]
ds_read_b64_tr_b16 a[156:157], v14 offset:40960
ds_read_b64_tr_b16 a[158:159], v14 offset:41472
v_mfma_f32_16x16x32_bf16 a[0:3], a[164:167], a[116:119], a[0:3]
v_mfma_f32_16x16x32_bf16 a[4:7], a[172:175], a[116:119], a[4:7]
ds_read_b128 a[92:95], v10 offset:6144
v_mfma_f32_16x16x32_bf16 a[4:7], a[168:171], a[112:115], a[4:7]
v_mfma_f32_16x16x32_bf16 a[8:11], a[176:179], a[112:115], a[8:11]
v_mfma_f32_16x16x32_bf16 a[8:11], a[180:183], a[116:119], a[8:11]
v_mfma_f32_16x16x32_bf16 a[12:15], a[188:191], a[116:119], a[12:15]
buffer_load_dwordx4 v6, s[8:11], s64 offen offset:1024 lds
v_mfma_f32_16x16x32_bf16 a[12:15], a[184:187], a[112:115], a[12:15]
v_mfma_f32_16x16x32_bf16 a[28:31], a[184:187], a[120:123], a[28:31]
v_mfma_f32_16x16x32_bf16 a[28:31], a[188:191], a[124:127], a[28:31]
v_mfma_f32_16x16x32_bf16 a[24:27], a[180:183], a[124:127], a[24:27]
v_mfma_f32_16x16x32_bf16 a[24:27], a[176:179], a[120:123], a[24:27]
v_mfma_f32_16x16x32_bf16 a[20:23], a[168:171], a[120:123], a[20:23]
v_mfma_f32_16x16x32_bf16 a[20:23], a[172:175], a[124:127], a[20:23]
v_mfma_f32_16x16x32_bf16 a[16:19], a[164:167], a[124:127], a[16:19]
v_mfma_f32_16x16x32_bf16 a[16:19], a[160:163], a[120:123], a[16:19]
s_waitcnt lgkmcnt(0)
v_mfma_f32_16x16x32_bf16 v[32:35], a[64:67], a[128:131], v[32:35]
s_waitcnt vmcnt(29)
v_mfma_f32_16x16x32_bf16 v[32:35], a[68:71], a[132:135], v[32:35]
s_barrier
v_mfma_f32_16x16x32_bf16 v[40:43], a[68:71], a[140:143], v[40:43]
ds_read_b128 a[96:99], v9 offset:8192
v_mfma_f32_16x16x32_bf16 v[40:43], a[64:67], a[136:139], v[40:43]
s_xor_b32 s76, s75, 2621440
s_add_u32 s76, s74, s76
v_mfma_f32_16x16x32_bf16 v[48:51], a[64:67], a[144:147], v[48:51]
s_add_u32 m0, s77, 32768
s_add_u32 s64, s76, 0
v_mfma_f32_16x16x32_bf16 v[48:51], a[68:71], a[148:151], v[48:51]
buffer_load_dwordx4 v7, s[56:59], s64 offen lds
v_mfma_f32_16x16x32_bf16 v[56:59], a[68:71], a[156:159], v[56:59]
ds_read_b128 a[100:103], v10 offset:8192
v_mfma_f32_16x16x32_bf16 v[56:59], a[64:67], a[152:155], v[56:59]
v_mfma_f32_16x16x32_bf16 v[60:63], a[72:75], a[152:155], v[60:63]
ds_read_b128 a[104:107], v9 offset:10240
v_mfma_f32_16x16x32_bf16 v[60:63], a[76:79], a[156:159], v[60:63]
v_mfma_f32_16x16x32_bf16 v[52:55], a[76:79], a[148:151], v[52:55]
v_mfma_f32_16x16x32_bf16 v[52:55], a[72:75], a[144:147], v[52:55]
buffer_load_dwordx4 v8, s[56:59], s64 offen offset:1024 lds
v_mfma_f32_16x16x32_bf16 v[44:47], a[72:75], a[136:139], v[44:47]
ds_read_b64_tr_b16 a[160:161], v11 offset:49152
ds_read_b64_tr_b16 a[162:163], v11 offset:49664
v_mfma_f32_16x16x32_bf16 v[44:47], a[76:79], a[140:143], v[44:47]
v_mfma_f32_16x16x32_bf16 v[36:39], a[76:79], a[132:135], v[36:39]
v_mfma_f32_16x16x32_bf16 v[36:39], a[72:75], a[128:131], v[36:39]
ds_read_b128 a[108:111], v10 offset:10240
v_mfma_f32_16x16x32_bf16 v[64:67], a[80:83], a[128:131], v[64:67]
s_add_u32 m0, s77, 34816
s_add_u32 s64, s76, 131072
v_mfma_f32_16x16x32_bf16 v[64:67], a[84:87], a[132:135], v[64:67]
v_mfma_f32_16x16x32_bf16 v[72:75], a[84:87], a[140:143], v[72:75]
buffer_load_dwordx4 v7, s[56:59], s64 offen lds
v_mfma_f32_16x16x32_bf16 v[72:75], a[80:83], a[136:139], v[72:75]
ds_read_b64_tr_b16 a[164:165], v11 offset:57344
ds_read_b64_tr_b16 a[166:167], v11 offset:57856
v_mfma_f32_16x16x32_bf16 v[80:83], a[80:83], a[144:147], v[80:83]
v_mfma_f32_16x16x32_bf16 v[80:83], a[84:87], a[148:151], v[80:83]
s_waitcnt vmcnt(12)
ds_read_b128 a[112:115], v9 offset:12288
v_mfma_f32_16x16x32_bf16 v[88:91], a[84:87], a[156:159], v[88:91]
v_mfma_f32_16x16x32_bf16 v[88:91], a[80:83], a[152:155], v[88:91]
v_accvgpr_read_b32 v16, a192
v_accvgpr_read_b32 v17, a194
v_mfma_f32_16x16x32_bf16 v[92:95], a[88:91], a[152:155], v[92:95]
ds_read_b64_tr_b16 a[168:169], v12 offset:49152
ds_read_b64_tr_b16 a[170:171], v12 offset:49664
v_mfma_f32_16x16x32_bf16 v[92:95], a[92:95], a[156:159], v[92:95]
buffer_load_dwordx4 v8, s[56:59], s64 offen offset:1024 lds
v_mfma_f32_16x16x32_bf16 v[84:87], a[92:95], a[148:151], v[84:87]
v_accvgpr_read_b32 v18, a196
v_accvgpr_read_b32 v19, a198
v_mfma_f32_16x16x32_bf16 v[84:87], a[88:91], a[144:147], v[84:87]
v_perm_b32 v24, v17, v16, s85
v_perm_b32 v25, v19, v18, s85
v_mfma_f32_16x16x32_bf16 v[76:79], a[88:91], a[136:139], v[76:79]
ds_read_b128 a[116:119], v10 offset:12288
v_perm_b32 v28, v17, v16, s86
v_mfma_f32_16x16x32_bf16 v[76:79], a[92:95], a[140:143], v[76:79]
v_perm_b32 v29, v19, v18, s86
v_accvgpr_read_b32 v16, a200
v_mfma_f32_16x16x32_bf16 v[68:71], a[92:95], a[132:135], v[68:71]
v_accvgpr_read_b32 v17, a202
v_accvgpr_read_b32 v18, a204
v_mfma_f32_16x16x32_bf16 v[68:71], a[88:91], a[128:131], v[68:71]
s_add_u32 m0, s73, 69632
s_add_u32 s64, s71, 524288
s_waitcnt lgkmcnt(6)
v_mfma_f32_16x16x32_bf16 v[96:99], a[96:99], a[128:131], v[96:99]
ds_read_b64_tr_b16 a[172:173], v12 offset:57344
ds_read_b64_tr_b16 a[174:175], v12 offset:57856
v_mfma_f32_16x16x32_bf16 v[96:99], a[100:103], a[132:135], v[96:99]
buffer_load_dwordx4 v5, s[8:11], s64 offen lds
v_mfma_f32_16x16x32_bf16 v[104:107], a[100:103], a[140:143], v[104:107]
ds_read_b128 a[120:123], v9 offset:14336
v_accvgpr_read_b32 v19, a206
v_mfma_f32_16x16x32_bf16 v[104:107], a[96:99], a[136:139], v[104:107]
v_perm_b32 v26, v17, v16, s85
v_perm_b32 v27, v19, v18, s85
v_mfma_f32_16x16x32_bf16 v[112:115], a[96:99], a[144:147], v[112:115]
v_perm_b32 v30, v17, v16, s86
v_perm_b32 v31, v19, v18, s86
v_mfma_f32_16x16x32_bf16 v[112:115], a[100:103], a[148:151], v[112:115]
ds_read_b64_tr_b16 a[176:177], v13 offset:49152
ds_read_b64_tr_b16 a[178:179], v13 offset:49664
v_mfma_f32_16x16x32_bf16 v[120:123], a[100:103], a[156:159], v[120:123]
v_accvgpr_read_b32 v16, a208
v_accvgpr_read_b32 v17, a209
v_mfma_f32_16x16x32_bf16 v[120:123], a[96:99], a[152:155], v[120:123]
v_accvgpr_read_b32 v18, a210
v_accvgpr_read_b32 v19, a211
v_mfma_f32_16x16x32_bf16 v[124:127], a[104:107], a[152:155], v[124:127]
buffer_load_dwordx4 v6, s[8:11], s64 offen offset:1024 lds
v_mfma_f32_16x16x32_bf16 v[124:127], a[108:111], a[156:159], v[124:127]
ds_read_b128 a[124:127], v10 offset:14336
v_or_b32 v24, v24, v16
v_mfma_f32_16x16x32_bf16 v[116:119], a[108:111], a[148:151], v[116:119]
v_add_u32 v9, 32768, v9
v_add_u32 v10, 32768, v10
v_mfma_f32_16x16x32_bf16 v[116:119], a[104:107], a[144:147], v[116:119]
v_or_b32 v25, v25, v17
v_or_b32 v26, v26, v18
v_mfma_f32_16x16x32_bf16 v[108:111], a[104:107], a[136:139], v[108:111]
ds_read_b64_tr_b16 a[180:181], v13 offset:57344
ds_read_b64_tr_b16 a[182:183], v13 offset:57856
v_mfma_f32_16x16x32_bf16 v[108:111], a[108:111], a[140:143], v[108:111]
s_add_u32 m0, s73, 71680
s_add_u32 s64, s71, 540672
v_or_b32 v27, v27, v19
v_mfma_f32_16x16x32_bf16 v[100:103], a[108:111], a[132:135], v[100:103]
s_waitcnt lgkmcnt(2)
v_mfma_f32_16x16x32_bf16 v[100:103], a[104:107], a[128:131], v[100:103]
buffer_load_dwordx4 v5, s[8:11], s64 offen lds
v_mfma_f32_16x16x32_bf16 v[128:131], a[112:115], a[128:131], v[128:131]
ds_read_b64_tr_b16 a[184:185], v14 offset:49152
ds_read_b64_tr_b16 a[186:187], v14 offset:49664
v_mfma_f32_16x16x32_bf16 v[128:131], a[116:119], a[132:135], v[128:131]
buffer_store_dwordx4 v[24:27], v15, s[24:27], s82 offen offset:0 sc1
v_mfma_f32_16x16x32_bf16 v[136:139], a[116:119], a[140:143], v[136:139]
ds_read_b64_tr_b16 a[188:189], v14 offset:57344
ds_read_b64_tr_b16 a[190:191], v14 offset:57856
v_mfma_f32_16x16x32_bf16 v[136:139], a[112:115], a[136:139], v[136:139]
v_mfma_f32_16x16x32_bf16 v[144:147], a[112:115], a[144:147], v[144:147]
v_mfma_f32_16x16x32_bf16 v[144:147], a[116:119], a[148:151], v[144:147]
buffer_store_dwordx4 v[28:31], v15, s[24:27], s82 offen offset:1024 sc1
v_mfma_f32_16x16x32_bf16 v[152:155], a[116:119], a[156:159], v[152:155]
buffer_load_dwordx4 v6, s[8:11], s64 offen offset:1024 lds
v_mfma_f32_16x16x32_bf16 v[152:155], a[112:115], a[152:155], v[152:155]
v_accvgpr_read_b32 v16, a193
v_accvgpr_read_b32 v17, a195
v_mfma_f32_16x16x32_bf16 v[156:159], a[120:123], a[152:155], v[156:159]
v_accvgpr_read_b32 v18, a197
v_accvgpr_read_b32 v19, a199
v_mfma_f32_16x16x32_bf16 v[156:159], a[124:127], a[156:159], v[156:159]
v_perm_b32 v24, v17, v16, s85
v_perm_b32 v25, v19, v18, s85
v_mfma_f32_16x16x32_bf16 v[148:151], a[124:127], a[148:151], v[148:151]
v_perm_b32 v28, v17, v16, s86
v_perm_b32 v29, v19, v18, s86
v_mfma_f32_16x16x32_bf16 v[148:151], a[120:123], a[144:147], v[148:151]
v_accvgpr_read_b32 v16, a201
v_accvgpr_read_b32 v17, a203
v_mfma_f32_16x16x32_bf16 v[140:143], a[120:123], a[136:139], v[140:143]
v_accvgpr_read_b32 v18, a205
v_accvgpr_read_b32 v19, a207
v_mfma_f32_16x16x32_bf16 v[140:143], a[124:127], a[140:143], v[140:143]
v_perm_b32 v26, v17, v16, s85
v_perm_b32 v27, v19, v18, s85
v_mfma_f32_16x16x32_bf16 v[132:135], a[124:127], a[132:135], v[132:135]
v_perm_b32 v30, v17, v16, s86
v_perm_b32 v31, v19, v18, s86
v_mfma_f32_16x16x32_bf16 v[132:135], a[120:123], a[128:131], v[132:135]
s_waitcnt lgkmcnt(0)
v_mfma_f32_16x16x32_bf16 v[160:163], a[160:163], a[64:67], v[160:163]
s_waitcnt vmcnt(18)
v_mfma_f32_16x16x32_bf16 v[160:163], a[164:167], a[68:71], v[160:163]
s_barrier
v_mfma_f32_16x16x32_bf16 v[164:167], a[172:175], a[68:71], v[164:167]
ds_read_b64_tr_b16 a[128:129], v11 offset:0
ds_read_b64_tr_b16 a[130:131], v11 offset:512
v_mfma_f32_16x16x32_bf16 v[164:167], a[168:171], a[64:67], v[164:167]
s_add_u32 m0, s77, 49152
s_add_u32 s64, s76, 0
v_mfma_f32_16x16x32_bf16 v[168:171], a[176:179], a[64:67], v[168:171]
buffer_load_dwordx4 v7, s[16:19], s64 offen lds
v_mfma_f32_16x16x32_bf16 v[168:171], a[180:183], a[68:71], v[168:171]
buffer_store_dwordx4 v[24:27], v15, s[24:27], s82 offen offset:2048 sc1
v_mfma_f32_16x16x32_bf16 v[172:175], a[188:191], a[68:71], v[172:175]
v_mfma_f32_16x16x32_bf16 v[172:175], a[184:187], a[64:67], v[172:175]
ds_read_b128 a[64:67], v9 offset:0
v_mfma_f32_16x16x32_bf16 v[188:191], a[184:187], a[72:75], v[188:191]
ds_read_b64_tr_b16 a[132:133], v11 offset:8192
ds_read_b64_tr_b16 a[134:135], v11 offset:8704
v_mfma_f32_16x16x32_bf16 v[188:191], a[188:191], a[76:79], v[188:191]
buffer_store_dwordx4 v[28:31], v15, s[24:27], s82 offen offset:3072 sc1
v_mfma_f32_16x16x32_bf16 v[184:187], a[180:183], a[76:79], v[184:187]
s_lshl_b32 s52, s7, 4
v_and_b32 v22, 3, v1
v_lshl_add_u32 v22, v22, 2, s52
v_mfma_f32_16x16x32_bf16 v[184:187], a[176:179], a[72:75], v[184:187]
buffer_load_dwordx4 v8, s[16:19], s64 offen offset:1024 lds
v_mfma_f32_16x16x32_bf16 v[180:183], a[168:171], a[72:75], v[180:183]
ds_read_b128 a[68:71], v10 offset:0
v_mfma_f32_16x16x32_bf16 v[180:183], a[172:175], a[76:79], v[180:183]
buffer_load_dword v23, v22, s[40:43], 0 offen sc1
v_mfma_f32_16x16x32_bf16 v[176:179], a[164:167], a[76:79], v[176:179]
v_mfma_f32_16x16x32_bf16 v[176:179], a[160:163], a[72:75], v[176:179]
ds_read_b64_tr_b16 a[136:137], v12 offset:0
ds_read_b64_tr_b16 a[138:139], v12 offset:512
v_mfma_f32_16x16x32_bf16 v[192:195], a[160:163], a[80:83], v[192:195]
s_add_u32 m0, s77, 51200
s_add_u32 s64, s76, 131072
v_mfma_f32_16x16x32_bf16 v[192:195], a[164:167], a[84:87], v[192:195]
v_mfma_f32_16x16x32_bf16 v[196:199], a[172:175], a[84:87], v[196:199]
buffer_load_dwordx4 v7, s[16:19], s64 offen lds
v_mfma_f32_16x16x32_bf16 v[196:199], a[168:171], a[80:83], v[196:199]
ds_read_b128 a[72:75], v9 offset:2048
v_mfma_f32_16x16x32_bf16 v[200:203], a[176:179], a[80:83], v[200:203]
v_mfma_f32_16x16x32_bf16 v[200:203], a[180:183], a[84:87], v[200:203]
ds_read_b64_tr_b16 a[140:141], v12 offset:8192
ds_read_b64_tr_b16 a[142:143], v12 offset:8704
v_mfma_f32_16x16x32_bf16 v[204:207], a[188:191], a[84:87], v[204:207]
v_mfma_f32_16x16x32_bf16 v[204:207], a[184:187], a[80:83], v[204:207]
v_mfma_f32_16x16x32_bf16 v[220:223], a[184:187], a[88:91], v[220:223]
ds_read_b128 a[76:79], v10 offset:2048
v_mfma_f32_16x16x32_bf16 v[220:223], a[188:191], a[92:95], v[220:223]
buffer_load_dwordx4 v8, s[16:19], s64 offen offset:1024 lds
v_mfma_f32_16x16x32_bf16 v[216:219], a[180:183], a[92:95], v[216:219]
s_xor_b32 s71, s70, 768
s_add_u32 s71, s68, s71
v_mfma_f32_16x16x32_bf16 v[216:219], a[176:179], a[88:91], v[216:219]
v_mfma_f32_16x16x32_bf16 v[212:215], a[168:171], a[88:91], v[212:215]
ds_read_b64_tr_b16 a[144:145], v13 offset:0
ds_read_b64_tr_b16 a[146:147], v13 offset:512
v_mfma_f32_16x16x32_bf16 v[212:215], a[172:175], a[92:95], v[212:215]
v_mfma_f32_16x16x32_bf16 v[208:211], a[164:167], a[92:95], v[208:211]
v_mfma_f32_16x16x32_bf16 v[208:211], a[160:163], a[88:91], v[208:211]
s_add_u32 m0, s73, 0
s_add_u32 s64, s71, 0
ds_read_b128 a[80:83], v9 offset:4096
v_mfma_f32_16x16x32_bf16 v[224:227], a[160:163], a[96:99], v[224:227]
v_mfma_f32_16x16x32_bf16 v[224:227], a[164:167], a[100:103], v[224:227]
buffer_load_dwordx4 v5, s[8:11], s64 offen lds
v_mfma_f32_16x16x32_bf16 v[228:231], a[172:175], a[100:103], v[228:231]
ds_read_b64_tr_b16 a[148:149], v13 offset:8192
ds_read_b64_tr_b16 a[150:151], v13 offset:8704
v_mfma_f32_16x16x32_bf16 v[228:231], a[168:171], a[96:99], v[228:231]
v_mfma_f32_16x16x32_bf16 v[232:235], a[176:179], a[96:99], v[232:235]
v_mfma_f32_16x16x32_bf16 v[232:235], a[180:183], a[100:103], v[232:235]
ds_read_b128 a[84:87], v10 offset:4096
v_mfma_f32_16x16x32_bf16 v[236:239], a[188:191], a[100:103], v[236:239]
v_mfma_f32_16x16x32_bf16 v[236:239], a[184:187], a[96:99], v[236:239]
v_mfma_f32_16x16x32_bf16 v[252:255], a[184:187], a[104:107], v[252:255]
buffer_load_dwordx4 v6, s[8:11], s64 offen offset:1024 lds
v_mfma_f32_16x16x32_bf16 v[252:255], a[188:191], a[108:111], v[252:255]
ds_read_b64_tr_b16 a[152:153], v14 offset:0
ds_read_b64_tr_b16 a[154:155], v14 offset:512
v_mfma_f32_16x16x32_bf16 v[248:251], a[180:183], a[108:111], v[248:251]
v_mfma_f32_16x16x32_bf16 v[248:251], a[176:179], a[104:107], v[248:251]
v_mfma_f32_16x16x32_bf16 v[244:247], a[168:171], a[104:107], v[244:247]
ds_read_b128 a[88:91], v9 offset:6144
v_mfma_f32_16x16x32_bf16 v[244:247], a[172:175], a[108:111], v[244:247]
s_add_u32 m0, s73, 2048
s_add_u32 s64, s71, 16384
v_mfma_f32_16x16x32_bf16 v[240:243], a[164:167], a[108:111], v[240:243]
v_mfma_f32_16x16x32_bf16 v[240:243], a[160:163], a[104:107], v[240:243]
buffer_load_dwordx4 v5, s[8:11], s64 offen lds
v_mfma_f32_16x16x32_bf16 a[0:3], a[160:163], a[112:115], a[0:3]
ds_read_b64_tr_b16 a[156:157], v14 offset:8192
ds_read_b64_tr_b16 a[158:159], v14 offset:8704
v_mfma_f32_16x16x32_bf16 a[0:3], a[164:167], a[116:119], a[0:3]
v_mfma_f32_16x16x32_bf16 a[4:7], a[172:175], a[116:119], a[4:7]
ds_read_b128 a[92:95], v10 offset:6144
v_mfma_f32_16x16x32_bf16 a[4:7], a[168:171], a[112:115], a[4:7]
v_mfma_f32_16x16x32_bf16 a[8:11], a[176:179], a[112:115], a[8:11]
v_mfma_f32_16x16x32_bf16 a[8:11], a[180:183], a[116:119], a[8:11]
v_mfma_f32_16x16x32_bf16 a[12:15], a[188:191], a[116:119], a[12:15]
buffer_load_dwordx4 v6, s[8:11], s64 offen offset:1024 lds
v_mfma_f32_16x16x32_bf16 a[12:15], a[184:187], a[112:115], a[12:15]
v_mfma_f32_16x16x32_bf16 a[28:31], a[184:187], a[120:123], a[28:31]
v_mfma_f32_16x16x32_bf16 a[28:31], a[188:191], a[124:127], a[28:31]
v_mfma_f32_16x16x32_bf16 a[24:27], a[180:183], a[124:127], a[24:27]
v_mfma_f32_16x16x32_bf16 a[24:27], a[176:179], a[120:123], a[24:27]
v_mfma_f32_16x16x32_bf16 a[20:23], a[168:171], a[120:123], a[20:23]
v_mfma_f32_16x16x32_bf16 a[20:23], a[172:175], a[124:127], a[20:23]
v_mfma_f32_16x16x32_bf16 a[16:19], a[164:167], a[124:127], a[16:19]
v_mfma_f32_16x16x32_bf16 a[16:19], a[160:163], a[120:123], a[16:19]
s_waitcnt lgkmcnt(0)
v_mfma_f32_16x16x32_bf16 v[32:35], a[64:67], a[128:131], v[32:35]
s_waitcnt vmcnt(25)
v_mfma_f32_16x16x32_bf16 v[32:35], a[68:71], a[132:135], v[32:35]
s_barrier
v_mfma_f32_16x16x32_bf16 v[40:43], a[68:71], a[140:143], v[40:43]
ds_read_b128 a[96:99], v9 offset:8192
v_mfma_f32_16x16x32_bf16 v[40:43], a[64:67], a[136:139], v[40:43]
s_xor_b32 s76, s75, 3145728
s_add_u32 s76, s74, s76
v_mfma_f32_16x16x32_bf16 v[48:51], a[64:67], a[144:147], v[48:51]
s_add_u32 m0, s77, 0
s_add_u32 s64, s76, 0
v_mfma_f32_16x16x32_bf16 v[48:51], a[68:71], a[148:151], v[48:51]
buffer_load_dwordx4 v7, s[56:59], s64 offen lds
v_mfma_f32_16x16x32_bf16 v[56:59], a[68:71], a[156:159], v[56:59]
ds_read_b128 a[100:103], v10 offset:8192
v_mfma_f32_16x16x32_bf16 v[56:59], a[64:67], a[152:155], v[56:59]
v_mfma_f32_16x16x32_bf16 v[60:63], a[72:75], a[152:155], v[60:63]
ds_read_b128 a[104:107], v9 offset:10240
v_mfma_f32_16x16x32_bf16 v[60:63], a[76:79], a[156:159], v[60:63]
v_mfma_f32_16x16x32_bf16 v[52:55], a[76:79], a[148:151], v[52:55]
v_mfma_f32_16x16x32_bf16 v[52:55], a[72:75], a[144:147], v[52:55]
buffer_load_dwordx4 v8, s[56:59], s64 offen offset:1024 lds
v_mfma_f32_16x16x32_bf16 v[44:47], a[72:75], a[136:139], v[44:47]
ds_read_b64_tr_b16 a[160:161], v11 offset:16384
ds_read_b64_tr_b16 a[162:163], v11 offset:16896
v_mfma_f32_16x16x32_bf16 v[44:47], a[76:79], a[140:143], v[44:47]
v_mfma_f32_16x16x32_bf16 v[36:39], a[76:79], a[132:135], v[36:39]
v_mfma_f32_16x16x32_bf16 v[36:39], a[72:75], a[128:131], v[36:39]
ds_read_b128 a[108:111], v10 offset:10240
v_mfma_f32_16x16x32_bf16 v[64:67], a[80:83], a[128:131], v[64:67]
s_add_u32 m0, s77, 2048
s_add_u32 s64, s76, 131072
s_waitcnt vmcnt(8)
v_mfma_f32_16x16x32_bf16 v[64:67], a[84:87], a[132:135], v[64:67]
v_cmp_gt_u32 vcc, 1, v23
v_mfma_f32_16x16x32_bf16 v[72:75], a[84:87], a[140:143], v[72:75]
buffer_load_dwordx4 v7, s[56:59], s64 offen lds
v_mfma_f32_16x16x32_bf16 v[72:75], a[80:83], a[136:139], v[72:75]
ds_read_b64_tr_b16 a[164:165], v11 offset:24576
ds_read_b64_tr_b16 a[166:167], v11 offset:25088
v_mfma_f32_16x16x32_bf16 v[80:83], a[80:83], a[144:147], v[80:83]
v_mfma_f32_16x16x32_bf16 v[80:83], a[84:87], a[148:151], v[80:83]
ds_read_b128 a[112:115], v9 offset:12288
v_mfma_f32_16x16x32_bf16 v[88:91], a[84:87], a[156:159], v[88:91]
s_cbranch_vccnz CK_Z
CK_Z_R:
v_mfma_f32_16x16x32_bf16 v[88:91], a[80:83], a[152:155], v[88:91]
buffer_atomic_add v1, v0, s[24:27], s84 offen offset:0 sc1
v_mfma_f32_16x16x32_bf16 v[92:95], a[88:91], a[152:155], v[92:95]
ds_read_b64_tr_b16 a[168:169], v12 offset:16384
ds_read_b64_tr_b16 a[170:171], v12 offset:16896
v_mfma_f32_16x16x32_bf16 v[92:95], a[92:95], a[156:159], v[92:95]
buffer_load_dwordx4 v8, s[56:59], s64 offen offset:1024 lds
v_mfma_f32_16x16x32_bf16 v[84:87], a[92:95], a[148:151], v[84:87]
v_mov_b32 v29, 0
v_mfma_f32_16x16x32_bf16 v[84:87], a[88:91], a[144:147], v[84:87]
v_mfma_f32_16x16x32_bf16 v[76:79], a[88:91], a[136:139], v[76:79]
ds_read_b128 a[116:119], v10 offset:12288
v_mfma_f32_16x16x32_bf16 v[76:79], a[92:95], a[140:143], v[76:79]
v_mfma_f32_16x16x32_bf16 v[68:71], a[92:95], a[132:135], v[68:71]
v_mfma_f32_16x16x32_bf16 v[68:71], a[88:91], a[128:131], v[68:71]
s_add_u32 m0, s73, 4096
s_add_u32 s64, s71, 524288
s_waitcnt lgkmcnt(6)
v_mfma_f32_16x16x32_bf16 v[96:99], a[96:99], a[128:131], v[96:99]
ds_read_b64_tr_b16 a[172:173], v12 offset:24576
ds_read_b64_tr_b16 a[174:175], v12 offset:25088
v_mfma_f32_16x16x32_bf16 v[96:99], a[100:103], a[132:135], v[96:99]
buffer_load_dwordx4 v5, s[8:11], s64 offen lds
v_mfma_f32_16x16x32_bf16 v[104:107], a[100:103], a[140:143], v[104:107]
ds_read_b128 a[120:123], v9 offset:14336
v_mfma_f32_16x16x32_bf16 v[104:107], a[96:99], a[136:139], v[104:107]
v_mfma_f32_16x16x32_bf16 v[112:115], a[96:99], a[144:147], v[112:115]
v_mfma_f32_16x16x32_bf16 v[112:115], a[100:103], a[148:151], v[112:115]
ds_read_b64_tr_b16 a[176:177], v13 offset:16384
ds_read_b64_tr_b16 a[178:179], v13 offset:16896
v_mfma_f32_16x16x32_bf16 v[120:123], a[100:103], a[156:159], v[120:123]
v_mfma_f32_16x16x32_bf16 v[120:123], a[96:99], a[152:155], v[120:123]
v_mfma_f32_16x16x32_bf16 v[124:127], a[104:107], a[152:155], v[124:127]
buffer_load_dwordx4 v6, s[8:11], s64 offen offset:1024 lds
v_mfma_f32_16x16x32_bf16 v[124:127], a[108:111], a[156:159], v[124:127]
ds_read_b128 a[124:127], v10 offset:14336
v_mfma_f32_16x16x32_bf16 v[116:119], a[108:111], a[148:151], v[116:119]
v_add_u32 v9, 32768, v9
v_add_u32 v10, 32768, v10
v_mfma_f32_16x16x32_bf16 v[116:119], a[104:107], a[144:147], v[116:119]
v_mfma_f32_16x16x32_bf16 v[108:111], a[104:107], a[136:139], v[108:111]
ds_read_b64_tr_b16 a[180:181], v13 offset:24576
ds_read_b64_tr_b16 a[182:183], v13 offset:25088
v_mfma_f32_16x16x32_bf16 v[108:111], a[108:111], a[140:143], v[108:111]
s_add_u32 m0, s73, 6144
s_add_u32 s64, s71, 540672
v_mfma_f32_16x16x32_bf16 v[100:103], a[108:111], a[132:135], v[100:103]
s_waitcnt lgkmcnt(2)
v_mfma_f32_16x16x32_bf16 v[100:103], a[104:107], a[128:131], v[100:103]
buffer_load_dwordx4 v5, s[8:11], s64 offen lds
v_mfma_f32_16x16x32_bf16 v[128:131], a[112:115], a[128:131], v[128:131]
ds_read_b64_tr_b16 a[184:185], v14 offset:16384
ds_read_b64_tr_b16 a[186:187], v14 offset:16896
v_mfma_f32_16x16x32_bf16 v[128:131], a[116:119], a[132:135], v[128:131]
v_mfma_f32_16x16x32_bf16 v[136:139], a[116:119], a[140:143], v[136:139]
ds_read_b64_tr_b16 a[188:189], v14 offset:24576
ds_read_b64_tr_b16 a[190:191], v14 offset:25088
v_mfma_f32_16x16x32_bf16 v[136:139], a[112:115], a[136:139], v[136:139]
v_mfma_f32_16x16x32_bf16 v[144:147], a[112:115], a[144:147], v[144:147]
v_mfma_f32_16x16x32_bf16 v[144:147], a[116:119], a[148:151], v[144:147]
v_mfma_f32_16x16x32_bf16 v[152:155], a[116:119], a[156:159], v[152:155]
buffer_load_dwordx4 v6, s[8:11], s64 offen offset:1024 lds
v_mfma_f32_16x16x32_bf16 v[152:155], a[112:115], a[152:155], v[152:155]
v_mfma_f32_16x16x32_bf16 v[156:159], a[120:123], a[152:155], v[156:159]
v_mfma_f32_16x16x32_bf16 v[156:159], a[124:127], a[156:159], v[156:159]
v_mfma_f32_16x16x32_bf16 v[148:151], a[124:127], a[148:151], v[148:151]
v_mfma_f32_16x16x32_bf16 v[148:151], a[120:123], a[144:147], v[148:151]
v_mfma_f32_16x16x32_bf16 v[140:143], a[120:123], a[136:139], v[140:143]
v_mfma_f32_16x16x32_bf16 v[140:143], a[124:127], a[140:143], v[140:143]
v_mfma_f32_16x16x32_bf16 v[132:135], a[124:127], a[132:135], v[132:135]
v_mfma_f32_16x16x32_bf16 v[132:135], a[120:123], a[128:131], v[132:135]
s_waitcnt lgkmcnt(0)
v_mfma_f32_16x16x32_bf16 v[160:163], a[160:163], a[64:67], v[160:163]
s_waitcnt vmcnt(20)
v_mfma_f32_16x16x32_bf16 v[160:163], a[164:167], a[68:71], v[160:163]
s_barrier
v_mfma_f32_16x16x32_bf16 v[164:167], a[172:175], a[68:71], v[164:167]
ds_read_b64_tr_b16 a[128:129], v11 offset:32768
ds_read_b64_tr_b16 a[130:131], v11 offset:33280
v_mfma_f32_16x16x32_bf16 v[164:167], a[168:171], a[64:67], v[164:167]
s_add_u32 m0, s77, 16384
s_add_u32 s64, s76, 0
v_mfma_f32_16x16x32_bf16 v[168:171], a[176:179], a[64:67], v[168:171]
buffer_load_dwordx4 v7, s[16:19], s64 offen lds
v_mfma_f32_16x16x32_bf16 v[168:171], a[180:183], a[68:71], v[168:171]
buffer_load_dword a253, v20, s[12:15], s53 offen
v_mfma_f32_16x16x32_bf16 v[172:175], a[188:191], a[68:71], v[172:175]
v_mfma_f32_16x16x32_bf16 v[172:175], a[184:187], a[64:67], v[172:175]
ds_read_b128 a[64:67], v9 offset:0
v_mfma_f32_16x16x32_bf16 v[188:191], a[184:187], a[72:75], v[188:191]
ds_read_b64_tr_b16 a[132:133], v11 offset:40960
ds_read_b64_tr_b16 a[134:135], v11 offset:41472
v_mfma_f32_16x16x32_bf16 v[188:191], a[188:191], a[76:79], v[188:191]
v_mfma_f32_16x16x32_bf16 v[184:187], a[180:183], a[76:79], v[184:187]
v_mfma_f32_16x16x32_bf16 v[184:187], a[176:179], a[72:75], v[184:187]
buffer_load_dwordx4 v8, s[16:19], s64 offen offset:1024 lds
v_mfma_f32_16x16x32_bf16 v[180:183], a[168:171], a[72:75], v[180:183]
ds_read_b128 a[68:71], v10 offset:0
v_mfma_f32_16x16x32_bf16 v[180:183], a[172:175], a[76:79], v[180:183]
v_mfma_f32_16x16x32_bf16 v[176:179], a[164:167], a[76:79], v[176:179]
v_mfma_f32_16x16x32_bf16 v[176:179], a[160:163], a[72:75], v[176:179]
ds_read_b64_tr_b16 a[136:137], v12 offset:32768
ds_read_b64_tr_b16 a[138:139], v12 offset:33280
v_mfma_f32_16x16x32_bf16 v[192:195], a[160:163], a[80:83], v[192:195]
s_add_u32 m0, s77, 18432
s_add_u32 s64, s76, 131072
v_mfma_f32_16x16x32_bf16 v[192:195], a[164:167], a[84:87], v[192:195]
v_mfma_f32_16x16x32_bf16 v[196:199], a[172:175], a[84:87], v[196:199]
buffer_load_dwordx4 v7, s[16:19], s64 offen lds
v_mfma_f32_16x16x32_bf16 v[196:199], a[168:171], a[80:83], v[196:199]
ds_read_b128 a[72:75], v9 offset:2048
v_mfma_f32_16x16x32_bf16 v[200:203], a[176:179], a[80:83], v[200:203]
v_mfma_f32_16x16x32_bf16 v[200:203], a[180:183], a[84:87], v[200:203]
ds_read_b64_tr_b16 a[140:141], v12 offset:40960
ds_read_b64_tr_b16 a[142:143], v12 offset:41472
v_mfma_f32_16x16x32_bf16 v[204:207], a[188:191], a[84:87], v[204:207]
v_mfma_f32_16x16x32_bf16 v[204:207], a[184:187], a[80:83], v[204:207]
v_mfma_f32_16x16x32_bf16 v[220:223], a[184:187], a[88:91], v[220:223]
ds_read_b128 a[76:79], v10 offset:2048
v_mfma_f32_16x16x32_bf16 v[220:223], a[188:191], a[92:95], v[220:223]
buffer_load_dwordx4 v8, s[16:19], s64 offen offset:1024 lds
v_mfma_f32_16x16x32_bf16 v[216:219], a[180:183], a[92:95], v[216:219]
s_xor_b32 s71, s70, 896
s_add_u32 s71, s68, s71
v_mfma_f32_16x16x32_bf16 v[216:219], a[176:179], a[88:91], v[216:219]
L_PAD2:
s_cbranch_execz L_PAD6
v_mfma_f32_16x16x32_bf16 v[212:215], a[168:171], a[88:91], v[212:215]
ds_read_b64_tr_b16 a[144:145], v13 offset:32768
ds_read_b64_tr_b16 a[146:147], v13 offset:33280
v_mfma_f32_16x16x32_bf16 v[212:215], a[172:175], a[92:95], v[212:215]
v_mfma_f32_16x16x32_bf16 v[208:211], a[164:167], a[92:95], v[208:211]
v_mfma_f32_16x16x32_bf16 v[208:211], a[160:163], a[88:91], v[208:211]
s_add_u32 m0, s73, 32768
s_add_u32 s64, s71, 0
ds_read_b128 a[80:83], v9 offset:4096
v_mfma_f32_16x16x32_bf16 v[224:227], a[160:163], a[96:99], v[224:227]
v_mfma_f32_16x16x32_bf16 v[224:227], a[164:167], a[100:103], v[224:227]
buffer_load_dwordx4 v5, s[8:11], s64 offen lds
v_mfma_f32_16x16x32_bf16 v[228:231], a[172:175], a[100:103], v[228:231]
ds_read_b64_tr_b16 a[148:149], v13 offset:40960
ds_read_b64_tr_b16 a[150:151], v13 offset:41472
v_mfma_f32_16x16x32_bf16 v[228:231], a[168:171], a[96:99], v[228:231]
v_mfma_f32_16x16x32_bf16 v[232:235], a[176:179], a[96:99], v[232:235]
v_mfma_f32_16x16x32_bf16 v[232:235], a[180:183], a[100:103], v[232:235]
ds_read_b128 a[84:87], v10 offset:4096
v_mfma_f32_16x16x32_bf16 v[236:239], a[188:191], a[100:103], v[236:239]
v_mfma_f32_16x16x32_bf16 v[236:239], a[184:187], a[96:99], v[236:239]
v_mfma_f32_16x16x32_bf16 v[252:255], a[184:187], a[104:107], v[252:255]
buffer_load_dwordx4 v6, s[8:11], s64 offen offset:1024 lds
v_mfma_f32_16x16x32_bf16 v[252:255], a[188:191], a[108:111], v[252:255]
ds_read_b64_tr_b16 a[152:153], v14 offset:32768
ds_read_b64_tr_b16 a[154:155], v14 offset:33280
v_mfma_f32_16x16x32_bf16 v[248:251], a[180:183], a[108:111], v[248:251]
v_mfma_f32_16x16x32_bf16 v[248:251], a[176:179], a[104:107], v[248:251]
v_mfma_f32_16x16x32_bf16 v[244:247], a[168:171], a[104:107], v[244:247]
ds_read_b128 a[88:91], v9 offset:6144
v_mfma_f32_16x16x32_bf16 v[244:247], a[172:175], a[108:111], v[244:247]
s_add_u32 m0, s73, 34816
s_add_u32 s64, s71, 16384
v_mfma_f32_16x16x32_bf16 v[240:243], a[164:167], a[108:111], v[240:243]
v_mfma_f32_16x16x32_bf16 v[240:243], a[160:163], a[104:107], v[240:243]
buffer_load_dwordx4 v5, s[8:11], s64 offen lds
v_mfma_f32_16x16x32_bf16 a[0:3], a[160:163], a[112:115], a[0:3]
ds_read_b64_tr_b16 a[156:157], v14 offset:40960
ds_read_b64_tr_b16 a[158:159], v14 offset:41472
v_mfma_f32_16x16x32_bf16 a[0:3], a[164:167], a[116:119], a[0:3]
v_mfma_f32_16x16x32_bf16 a[4:7], a[172:175], a[116:119], a[4:7]
ds_read_b128 a[92:95], v10 offset:6144
v_mfma_f32_16x16x32_bf16 a[4:7], a[168:171], a[112:115], a[4:7]
v_mfma_f32_16x16x32_bf16 a[8:11], a[176:179], a[112:115], a[8:11]
v_mfma_f32_16x16x32_bf16 a[8:11], a[180:183], a[116:119], a[8:11]
v_mfma_f32_16x16x32_bf16 a[12:15], a[188:191], a[116:119], a[12:15]
buffer_load_dwordx4 v6, s[8:11], s64 offen offset:1024 lds
v_mfma_f32_16x16x32_bf16 a[12:15], a[184:187], a[112:115], a[12:15]
v_mfma_f32_16x16x32_bf16 a[28:31], a[184:187], a[120:123], a[28:31]
v_mfma_f32_16x16x32_bf16 a[28:31], a[188:191], a[124:127], a[28:31]
v_mfma_f32_16x16x32_bf16 a[24:27], a[180:183], a[124:127], a[24:27]
v_mfma_f32_16x16x32_bf16 a[24:27], a[176:179], a[120:123], a[24:27]
v_mfma_f32_16x16x32_bf16 a[20:23], a[168:171], a[120:123], a[20:23]
v_mfma_f32_16x16x32_bf16 a[20:23], a[172:175], a[124:127], a[20:23]
v_mfma_f32_16x16x32_bf16 a[16:19], a[164:167], a[124:127], a[16:19]
v_mfma_f32_16x16x32_bf16 a[16:19], a[160:163], a[120:123], a[16:19]
s_waitcnt lgkmcnt(0)
v_mfma_f32_16x16x32_bf16 v[32:35], a[64:67], a[128:131], v[32:35]
s_waitcnt vmcnt(22)
v_mfma_f32_16x16x32_bf16 v[32:35], a[68:71], a[132:135], v[32:35]
s_barrier
v_mfma_f32_16x16x32_bf16 v[40:43], a[68:71], a[140:143], v[40:43]
ds_read_b128 a[96:99], v9 offset:8192
v_mfma_f32_16x16x32_bf16 v[40:43], a[64:67], a[136:139], v[40:43]
s_xor_b32 s76, s75, 3670016
s_add_u32 s76, s74, s76
v_mfma_f32_16x16x32_bf16 v[48:51], a[64:67], a[144:147], v[48:51]
s_add_u32 m0, s77, 32768
s_add_u32 s64, s76, 0
v_mfma_f32_16x16x32_bf16 v[48:51], a[68:71], a[148:151], v[48:51]
buffer_load_dwordx4 v7, s[56:59], s64 offen lds
v_mfma_f32_16x16x32_bf16 v[56:59], a[68:71], a[156:159], v[56:59]
ds_read_b128 a[100:103], v10 offset:8192
v_mfma_f32_16x16x32_bf16 v[56:59], a[64:67], a[152:155], v[56:59]
buffer_load_dword a252, v21, s[20:23], s55 offen
v_mfma_f32_16x16x32_bf16 v[60:63], a[72:75], a[152:155], v[60:63]
s_add_u32 s55, s55, 24576
s_mul_i32 s54, s54, 896
ds_read_b128 a[104:107], v9 offset:10240
v_mfma_f32_16x16x32_bf16 v[60:63], a[76:79], a[156:159], v[60:63]
v_mfma_f32_16x16x32_bf16 v[52:55], a[76:79], a[148:151], v[52:55]
v_mfma_f32_16x16x32_bf16 v[52:55], a[72:75], a[144:147], v[52:55]
buffer_load_dwordx4 v8, s[56:59], s64 offen offset:1024 lds
v_mfma_f32_16x16x32_bf16 v[44:47], a[72:75], a[136:139], v[44:47]
ds_read_b64_tr_b16 a[160:161], v11 offset:49152
ds_read_b64_tr_b16 a[162:163], v11 offset:49664
v_mfma_f32_16x16x32_bf16 v[44:47], a[76:79], a[140:143], v[44:47]
v_mfma_f32_16x16x32_bf16 v[36:39], a[76:79], a[132:135], v[36:39]
v_mfma_f32_16x16x32_bf16 v[36:39], a[72:75], a[128:131], v[36:39]
ds_read_b128 a[108:111], v10 offset:10240
v_mfma_f32_16x16x32_bf16 v[64:67], a[80:83], a[128:131], v[64:67]
s_add_u32 m0, s77, 34816
s_add_u32 s64, s76, 131072
v_mfma_f32_16x16x32_bf16 v[64:67], a[84:87], a[132:135], v[64:67]
v_mfma_f32_16x16x32_bf16 v[72:75], a[84:87], a[140:143], v[72:75]
buffer_load_dwordx4 v7, s[56:59], s64 offen lds
v_mfma_f32_16x16x32_bf16 v[72:75], a[80:83], a[136:139], v[72:75]
ds_read_b64_tr_b16 a[164:165], v11 offset:57344
ds_read_b64_tr_b16 a[166:167], v11 offset:57856
v_mfma_f32_16x16x32_bf16 v[80:83], a[80:83], a[144:147], v[80:83]
v_mfma_f32_16x16x32_bf16 v[80:83], a[84:87], a[148:151], v[80:83]
ds_read_b128 a[112:115], v9 offset:12288
v_mfma_f32_16x16x32_bf16 v[88:91], a[84:87], a[156:159], v[88:91]
v_mfma_f32_16x16x32_bf16 v[88:91], a[80:83], a[152:155], v[88:91]
v_mfma_f32_16x16x32_bf16 v[92:95], a[88:91], a[152:155], v[92:95]
ds_read_b64_tr_b16 a[168:169], v12 offset:49152
ds_read_b64_tr_b16 a[170:171], v12 offset:49664
v_mfma_f32_16x16x32_bf16 v[92:95], a[92:95], a[156:159], v[92:95]
buffer_load_dwordx4 v8, s[56:59], s64 offen offset:1024 lds
v_mfma_f32_16x16x32_bf16 v[84:87], a[92:95], a[148:151], v[84:87]
v_mfma_f32_16x16x32_bf16 v[84:87], a[88:91], a[144:147], v[84:87]
v_mfma_f32_16x16x32_bf16 v[76:79], a[88:91], a[136:139], v[76:79]
ds_read_b128 a[116:119], v10 offset:12288
v_mfma_f32_16x16x32_bf16 v[76:79], a[92:95], a[140:143], v[76:79]
v_mfma_f32_16x16x32_bf16 v[68:71], a[92:95], a[132:135], v[68:71]
v_mfma_f32_16x16x32_bf16 v[68:71], a[88:91], a[128:131], v[68:71]
s_add_u32 m0, s73, 36864
s_add_u32 s64, s71, 524288
s_waitcnt lgkmcnt(6)
v_mfma_f32_16x16x32_bf16 v[96:99], a[96:99], a[128:131], v[96:99]
ds_read_b64_tr_b16 a[172:173], v12 offset:57344
ds_read_b64_tr_b16 a[174:175], v12 offset:57856
v_mfma_f32_16x16x32_bf16 v[96:99], a[100:103], a[132:135], v[96:99]
buffer_load_dwordx4 v5, s[8:11], s64 offen lds
v_mfma_f32_16x16x32_bf16 v[104:107], a[100:103], a[140:143], v[104:107]
ds_read_b128 a[120:123], v9 offset:14336
v_mfma_f32_16x16x32_bf16 v[104:107], a[96:99], a[136:139], v[104:107]
v_mfma_f32_16x16x32_bf16 v[112:115], a[96:99], a[144:147], v[112:115]
v_mfma_f32_16x16x32_bf16 v[112:115], a[100:103], a[148:151], v[112:115]
ds_read_b64_tr_b16 a[176:177], v13 offset:49152
ds_read_b64_tr_b16 a[178:179], v13 offset:49664
v_mfma_f32_16x16x32_bf16 v[120:123], a[100:103], a[156:159], v[120:123]
v_mfma_f32_16x16x32_bf16 v[120:123], a[96:99], a[152:155], v[120:123]
v_mfma_f32_16x16x32_bf16 v[124:127], a[104:107], a[152:155], v[124:127]
buffer_load_dwordx4 v6, s[8:11], s64 offen offset:1024 lds
v_mfma_f32_16x16x32_bf16 v[124:127], a[108:111], a[156:159], v[124:127]
ds_read_b128 a[124:127], v10 offset:14336
v_mfma_f32_16x16x32_bf16 v[116:119], a[108:111], a[148:151], v[116:119]
v_add_u32 v9, -65536, v9
v_add_u32 v10, -65536, v10
v_mfma_f32_16x16x32_bf16 v[116:119], a[104:107], a[144:147], v[116:119]
buffer_load_dword v30, v29, s[24:27], s89 offen sc1
v_mfma_f32_16x16x32_bf16 v[108:111], a[104:107], a[136:139], v[108:111]
ds_read_b64_tr_b16 a[180:181], v13 offset:57344
ds_read_b64_tr_b16 a[182:183], v13 offset:57856
v_mfma_f32_16x16x32_bf16 v[108:111], a[108:111], a[140:143], v[108:111]
s_add_u32 m0, s73, 38912
s_add_u32 s64, s71, 540672
v_mfma_f32_16x16x32_bf16 v[100:103], a[108:111], a[132:135], v[100:103]
s_waitcnt lgkmcnt(2)
v_mfma_f32_16x16x32_bf16 v[100:103], a[104:107], a[128:131], v[100:103]
buffer_load_dwordx4 v5, s[8:11], s64 offen lds
v_mfma_f32_16x16x32_bf16 v[128:131], a[112:115], a[128:131], v[128:131]
ds_read_b64_tr_b16 a[184:185], v14 offset:49152
ds_read_b64_tr_b16 a[186:187], v14 offset:49664
v_mfma_f32_16x16x32_bf16 v[128:131], a[116:119], a[132:135], v[128:131]
v_mfma_f32_16x16x32_bf16 v[136:139], a[116:119], a[140:143], v[136:139]
ds_read_b64_tr_b16 a[188:189], v14 offset:57344
ds_read_b64_tr_b16 a[190:191], v14 offset:57856
v_mfma_f32_16x16x32_bf16 v[136:139], a[112:115], a[136:139], v[136:139]
v_mfma_f32_16x16x32_bf16 v[144:147], a[112:115], a[144:147], v[144:147]
v_mfma_f32_16x16x32_bf16 v[144:147], a[116:119], a[148:151], v[144:147]
v_mfma_f32_16x16x32_bf16 v[152:155], a[116:119], a[156:159], v[152:155]
buffer_load_dwordx4 v6, s[8:11], s64 offen offset:1024 lds
v_mfma_f32_16x16x32_bf16 v[152:155], a[112:115], a[152:155], v[152:155]
v_mfma_f32_16x16x32_bf16 v[156:159], a[120:123], a[152:155], v[156:159]
v_mfma_f32_16x16x32_bf16 v[156:159], a[124:127], a[156:159], v[156:159]
v_mfma_f32_16x16x32_bf16 v[148:151], a[124:127], a[148:151], v[148:151]
v_mfma_f32_16x16x32_bf16 v[148:151], a[120:123], a[144:147], v[148:151]
v_mfma_f32_16x16x32_bf16 v[140:143], a[120:123], a[136:139], v[140:143]
v_mfma_f32_16x16x32_bf16 v[140:143], a[124:127], a[140:143], v[140:143]
v_mfma_f32_16x16x32_bf16 v[132:135], a[124:127], a[132:135], v[132:135]
v_mfma_f32_16x16x32_bf16 v[132:135], a[120:123], a[128:131], v[132:135]
s_waitcnt lgkmcnt(0)
v_mfma_f32_16x16x32_bf16 v[160:163], a[160:163], a[64:67], v[160:163]
s_waitcnt vmcnt(19)
v_mfma_f32_16x16x32_bf16 v[160:163], a[164:167], a[68:71], v[160:163]
s_barrier
v_mfma_f32_16x16x32_bf16 v[164:167], a[172:175], a[68:71], v[164:167]
ds_read_b64_tr_b16 a[128:129], v11 offset:0
ds_read_b64_tr_b16 a[130:131], v11 offset:512
v_mfma_f32_16x16x32_bf16 v[164:167], a[168:171], a[64:67], v[164:167]
s_add_u32 m0, s77, 49152
s_add_u32 s64, s76, 0
v_mfma_f32_16x16x32_bf16 v[168:171], a[176:179], a[64:67], v[168:171]
buffer_load_dwordx4 v7, s[16:19], s64 offen lds
v_mfma_f32_16x16x32_bf16 v[168:171], a[180:183], a[68:71], v[168:171]
buffer_load_dword a252, v21, s[20:23], s55 offen
v_mfma_f32_16x16x32_bf16 v[172:175], a[188:191], a[68:71], v[172:175]
s_lshr_b32 s55, s2, 1
s_lshl2_add_u32 s55, s55, s3
s_mul_i32 s55, s55, 9216
v_mfma_f32_16x16x32_bf16 v[172:175], a[184:187], a[64:67], v[172:175]
s_and_b32 s53, s2, 1
s_lshl_b32 s53, s53, 9
ds_read_b128 a[64:67], v9 offset:0
v_mfma_f32_16x16x32_bf16 v[188:191], a[184:187], a[72:75], v[188:191]
s_add_u32 s55, s55, s53
ds_read_b64_tr_b16 a[132:133], v11 offset:8192
ds_read_b64_tr_b16 a[134:135], v11 offset:8704
v_mfma_f32_16x16x32_bf16 v[188:191], a[188:191], a[76:79], v[188:191]
v_min_u32 v20, 39, v1
v_and_b32 v21, 7, v20
v_mfma_f32_16x16x32_bf16 v[184:187], a[180:183], a[76:79], v[184:187]
v_mul_u32_u24 v21, 1152, v21
v_lshrrev_b32 v20, 3, v20
v_mfma_f32_16x16x32_bf16 v[184:187], a[176:179], a[72:75], v[184:187]
buffer_load_dwordx4 v8, s[16:19], s64 offen offset:1024 lds
v_mfma_f32_16x16x32_bf16 v[180:183], a[168:171], a[72:75], v[180:183]
ds_read_b128 a[68:71], v10 offset:0
v_lshl_add_u32 v21, v20, 7, v21
v_mfma_f32_16x16x32_bf16 v[180:183], a[172:175], a[76:79], v[180:183]
v_min_u32 v20, 6, v1
v_lshlrev_b32 v20, 7, v20
v_mfma_f32_16x16x32_bf16 v[176:179], a[164:167], a[76:79], v[176:179]
v_mfma_f32_16x16x32_bf16 v[176:179], a[160:163], a[72:75], v[176:179]
ds_read_b64_tr_b16 a[136:137], v12 offset:0
ds_read_b64_tr_b16 a[138:139], v12 offset:512
v_mfma_f32_16x16x32_bf16 v[192:195], a[160:163], a[80:83], v[192:195]
s_add_u32 m0, s77, 51200
s_add_u32 s64, s76, 131072
v_mfma_f32_16x16x32_bf16 v[192:195], a[164:167], a[84:87], v[192:195]
v_mfma_f32_16x16x32_bf16 v[196:199], a[172:175], a[84:87], v[196:199]
buffer_load_dwordx4 v7, s[16:19], s64 offen lds
v_mfma_f32_16x16x32_bf16 v[196:199], a[168:171], a[80:83], v[196:199]
ds_read_b128 a[72:75], v9 offset:2048
v_mfma_f32_16x16x32_bf16 v[200:203], a[176:179], a[80:83], v[200:203]
v_mfma_f32_16x16x32_bf16 v[200:203], a[180:183], a[84:87], v[200:203]
ds_read_b64_tr_b16 a[140:141], v12 offset:8192
ds_read_b64_tr_b16 a[142:143], v12 offset:8704
v_mfma_f32_16x16x32_bf16 v[204:207], a[188:191], a[84:87], v[204:207]
v_mfma_f32_16x16x32_bf16 v[204:207], a[184:187], a[80:83], v[204:207]
v_mfma_f32_16x16x32_bf16 v[220:223], a[184:187], a[88:91], v[220:223]
ds_read_b128 a[76:79], v10 offset:2048
v_mfma_f32_16x16x32_bf16 v[220:223], a[188:191], a[92:95], v[220:223]
buffer_load_dwordx4 v8, s[16:19], s64 offen offset:1024 lds
v_mfma_f32_16x16x32_bf16 v[216:219], a[180:183], a[92:95], v[216:219]
s_lshl_b32 s70, s93, 7
s_mul_i32 s68, s66, 36864
s_mul_i32 s69, s67, 36864
v_mfma_f32_16x16x32_bf16 v[216:219], a[176:179], a[88:91], v[216:219]
v_lshrrev_b32 v31, 3, v1
v_lshl_add_u32 v5, v31, 7, v5
v_mfma_f32_16x16x32_bf16 v[212:215], a[168:171], a[88:91], v[212:215]
v_lshl_add_u32 v6, v31, 7, v6
v_add_u32 v6, 1024, v6
v_mfma_f32_16x16x32_bf16 v[212:215], a[172:175], a[92:95], v[212:215]
s_mov_b32 s65, 1024
s_add_u32 s71, s68, s65
s_add_u32 s72, s69, s65
v_mfma_f32_16x16x32_bf16 v[208:211], a[164:167], a[92:95], v[208:211]
ds_read_b64_tr_b16 a[144:145], v13 offset:0
ds_read_b64_tr_b16 a[146:147], v13 offset:512
v_mfma_f32_16x16x32_bf16 v[208:211], a[160:163], a[88:91], v[208:211]
s_add_u32 m0, s73, 65536
s_add_u32 s64, s71, 0
ds_read_b128 a[80:83], v9 offset:4096
v_mfma_f32_16x16x32_bf16 v[224:227], a[160:163], a[96:99], v[224:227]
v_mfma_f32_16x16x32_bf16 v[224:227], a[164:167], a[100:103], v[224:227]
buffer_load_dwordx4 v5, s[12:15], s64 offen lds
v_mfma_f32_16x16x32_bf16 v[228:231], a[172:175], a[100:103], v[228:231]
ds_read_b64_tr_b16 a[148:149], v13 offset:8192
ds_read_b64_tr_b16 a[150:151], v13 offset:8704
v_mfma_f32_16x16x32_bf16 v[228:231], a[168:171], a[96:99], v[228:231]
v_mfma_f32_16x16x32_bf16 v[232:235], a[176:179], a[96:99], v[232:235]
v_mfma_f32_16x16x32_bf16 v[232:235], a[180:183], a[100:103], v[232:235]
ds_read_b128 a[84:87], v10 offset:4096
v_mfma_f32_16x16x32_bf16 v[236:239], a[188:191], a[100:103], v[236:239]
v_mfma_f32_16x16x32_bf16 v[236:239], a[184:187], a[96:99], v[236:239]
v_mfma_f32_16x16x32_bf16 v[252:255], a[184:187], a[104:107], v[252:255]
buffer_load_dwordx4 v6, s[12:15], s64 offen offset:1024 lds
v_mfma_f32_16x16x32_bf16 v[252:255], a[188:191], a[108:111], v[252:255]
ds_read_b64_tr_b16 a[152:153], v14 offset:0
ds_read_b64_tr_b16 a[154:155], v14 offset:512
v_mfma_f32_16x16x32_bf16 v[248:251], a[180:183], a[108:111], v[248:251]
v_mfma_f32_16x16x32_bf16 v[248:251], a[176:179], a[104:107], v[248:251]
v_mfma_f32_16x16x32_bf16 v[244:247], a[168:171], a[104:107], v[244:247]
ds_read_b128 a[88:91], v9 offset:6144
v_mfma_f32_16x16x32_bf16 v[244:247], a[172:175], a[108:111], v[244:247]
s_add_u32 m0, s73, 67584
s_add_u32 s64, s71, 18432
v_mfma_f32_16x16x32_bf16 v[240:243], a[164:167], a[108:111], v[240:243]
v_mfma_f32_16x16x32_bf16 v[240:243], a[160:163], a[104:107], v[240:243]
buffer_load_dwordx4 v5, s[12:15], s64 offen lds
v_mfma_f32_16x16x32_bf16 a[0:3], a[160:163], a[112:115], a[0:3]
ds_read_b64_tr_b16 a[156:157], v14 offset:8192
ds_read_b64_tr_b16 a[158:159], v14 offset:8704
v_mfma_f32_16x16x32_bf16 a[0:3], a[164:167], a[116:119], a[0:3]
v_mfma_f32_16x16x32_bf16 a[4:7], a[172:175], a[116:119], a[4:7]
s_waitcnt vmcnt(10)
ds_read_b128 a[92:95], v10 offset:6144
v_mfma_f32_16x16x32_bf16 a[4:7], a[168:171], a[112:115], a[4:7]
v_cmp_gt_u32 vcc, 18, v30
v_mfma_f32_16x16x32_bf16 a[8:11], a[176:179], a[112:115], a[8:11]
v_mfma_f32_16x16x32_bf16 a[8:11], a[180:183], a[116:119], a[8:11]
v_mfma_f32_16x16x32_bf16 a[12:15], a[188:191], a[116:119], a[12:15]
buffer_load_dwordx4 v6, s[12:15], s64 offen offset:1024 lds
v_mfma_f32_16x16x32_bf16 a[12:15], a[184:187], a[112:115], a[12:15]
v_mfma_f32_16x16x32_bf16 a[28:31], a[184:187], a[120:123], a[28:31]
s_cbranch_vccnz CK_WA
CK_WA_R:
v_mfma_f32_16x16x32_bf16 a[28:31], a[188:191], a[124:127], a[28:31]
v_mfma_f32_16x16x32_bf16 a[24:27], a[180:183], a[124:127], a[24:27]
v_mfma_f32_16x16x32_bf16 a[24:27], a[176:179], a[120:123], a[24:27]
v_mfma_f32_16x16x32_bf16 a[20:23], a[168:171], a[120:123], a[20:23]
v_mfma_f32_16x16x32_bf16 a[20:23], a[172:175], a[124:127], a[20:23]
v_mfma_f32_16x16x32_bf16 a[16:19], a[164:167], a[124:127], a[16:19]
v_mfma_f32_16x16x32_bf16 a[16:19], a[160:163], a[120:123], a[16:19]
s_waitcnt lgkmcnt(0)
v_mfma_f32_16x16x32_bf16 v[32:35], a[64:67], a[128:131], v[32:35]
s_waitcnt vmcnt(23)
v_mfma_f32_16x16x32_bf16 v[32:35], a[68:71], a[132:135], v[32:35]
s_barrier
v_mfma_f32_16x16x32_bf16 v[40:43], a[68:71], a[140:143], v[40:43]
ds_read_b128 a[96:99], v9 offset:8192
v_mfma_f32_16x16x32_bf16 v[40:43], a[64:67], a[136:139], v[40:43]
s_lshl_b32 s77, s3, 11
s_lshl_b32 s74, s3, 9
s_add_u32 s74, s74, s4
v_mfma_f32_16x16x32_bf16 v[48:51], a[64:67], a[144:147], v[48:51]
s_lshl_b32 s74, s74, 8
v_mfma_f32_16x16x32_bf16 v[48:51], a[68:71], a[148:151], v[48:51]
s_mov_b32 s75, 8
s_lshl_b32 s76, s75, 19
s_add_u32 s76, s76, s74
v_mfma_f32_16x16x32_bf16 v[56:59], a[68:71], a[156:159], v[56:59]
s_lshl_b32 s79, s75, 13
s_add_u32 s79, s79, s78
ds_read_b128 a[100:103], v10 offset:8192
v_mfma_f32_16x16x32_bf16 v[56:59], a[64:67], a[152:155], v[56:59]
s_add_u32 m0, s77, 0
s_add_u32 s64, s76, 0
v_mfma_f32_16x16x32_bf16 v[60:63], a[72:75], a[152:155], v[60:63]
buffer_load_dwordx4 v7, s[20:23], s64 offen lds
v_mfma_f32_16x16x32_bf16 v[60:63], a[76:79], a[156:159], v[60:63]
ds_read_b128 a[104:107], v9 offset:10240
v_mfma_f32_16x16x32_bf16 v[52:55], a[76:79], a[148:151], v[52:55]
buffer_load_dword a252, v21, s[32:35], s55 offen
v_mfma_f32_16x16x32_bf16 v[52:55], a[72:75], a[144:147], v[52:55]
ds_read_b64_tr_b16 a[160:161], v11 offset:16384
ds_read_b64_tr_b16 a[162:163], v11 offset:16896
v_mfma_f32_16x16x32_bf16 v[44:47], a[72:75], a[136:139], v[44:47]
buffer_load_dwordx4 v8, s[20:23], s64 offen offset:1024 lds
v_mfma_f32_16x16x32_bf16 v[44:47], a[76:79], a[140:143], v[44:47]
buffer_load_dword a253, v20, s[48:51], s54 offen
v_mfma_f32_16x16x32_bf16 v[36:39], a[76:79], a[132:135], v[36:39]
v_mfma_f32_16x16x32_bf16 v[36:39], a[72:75], a[128:131], v[36:39]
ds_read_b128 a[108:111], v10 offset:10240
v_mfma_f32_16x16x32_bf16 v[64:67], a[80:83], a[128:131], v[64:67]
v_mfma_f32_16x16x32_bf16 v[64:67], a[84:87], a[132:135], v[64:67]
v_mfma_f32_16x16x32_bf16 v[72:75], a[84:87], a[140:143], v[72:75]
s_add_u32 m0, s80, 0
s_add_u32 s64, s79, 0
v_mfma_f32_16x16x32_bf16 v[72:75], a[80:83], a[136:139], v[72:75]
ds_read_b64_tr_b16 a[164:165], v11 offset:24576
ds_read_b64_tr_b16 a[166:167], v11 offset:25088
v_mfma_f32_16x16x32_bf16 v[80:83], a[80:83], a[144:147], v[80:83]
buffer_load_dwordx4 v15, s[24:27], s64 offen sc1 lds
v_mfma_f32_16x16x32_bf16 v[80:83], a[84:87], a[148:151], v[80:83]
ds_read_b128 a[112:115], v9 offset:12288
v_mfma_f32_16x16x32_bf16 v[88:91], a[84:87], a[156:159], v[88:91]
v_mfma_f32_16x16x32_bf16 v[88:91], a[80:83], a[152:155], v[88:91]
v_mfma_f32_16x16x32_bf16 v[92:95], a[88:91], a[152:155], v[92:95]
ds_read_b64_tr_b16 a[168:169], v12 offset:16384
ds_read_b64_tr_b16 a[170:171], v12 offset:16896
v_mfma_f32_16x16x32_bf16 v[92:95], a[92:95], a[156:159], v[92:95]
v_mfma_f32_16x16x32_bf16 v[84:87], a[92:95], a[148:151], v[84:87]
s_add_u32 m0, s73, 69632
s_add_u32 s64, s72, 0
v_mfma_f32_16x16x32_bf16 v[84:87], a[88:91], a[144:147], v[84:87]
v_mfma_f32_16x16x32_bf16 v[76:79], a[88:91], a[136:139], v[76:79]
buffer_load_dwordx4 v5, s[12:15], s64 offen lds
v_mfma_f32_16x16x32_bf16 v[76:79], a[92:95], a[140:143], v[76:79]
ds_read_b128 a[116:119], v10 offset:12288
v_mfma_f32_16x16x32_bf16 v[68:71], a[92:95], a[132:135], v[68:71]
v_mfma_f32_16x16x32_bf16 v[68:71], a[88:91], a[128:131], v[68:71]
s_waitcnt lgkmcnt(6)
ds_read_b64_tr_b16 a[172:173], v12 offset:24576
ds_read_b64_tr_b16 a[174:175], v12 offset:25088
v_mfma_f32_16x16x32_bf16 v[96:99], a[96:99], a[128:131], v[96:99]
v_mfma_f32_16x16x32_bf16 v[96:99], a[100:103], a[132:135], v[96:99]
v_mfma_f32_16x16x32_bf16 v[104:107], a[100:103], a[140:143], v[104:107]
ds_read_b128 a[120:123], v9 offset:14336
v_mfma_f32_16x16x32_bf16 v[104:107], a[96:99], a[136:139], v[104:107]
v_mfma_f32_16x16x32_bf16 v[112:115], a[96:99], a[144:147], v[112:115]
v_mfma_f32_16x16x32_bf16 v[112:115], a[100:103], a[148:151], v[112:115]
buffer_load_dwordx4 v6, s[12:15], s64 offen offset:1024 lds
v_mfma_f32_16x16x32_bf16 v[120:123], a[100:103], a[156:159], v[120:123]
ds_read_b64_tr_b16 a[176:177], v13 offset:16384
ds_read_b64_tr_b16 a[178:179], v13 offset:16896
v_mfma_f32_16x16x32_bf16 v[120:123], a[96:99], a[152:155], v[120:123]
v_mfma_f32_16x16x32_bf16 v[124:127], a[104:107], a[152:155], v[124:127]
v_mfma_f32_16x16x32_bf16 v[124:127], a[108:111], a[156:159], v[124:127]
ds_read_b128 a[124:127], v10 offset:14336
v_mfma_f32_16x16x32_bf16 v[116:119], a[108:111], a[148:151], v[116:119]
v_add_u32 v9, 32768, v9
v_add_u32 v10, 32768, v10
v_mfma_f32_16x16x32_bf16 v[116:119], a[104:107], a[144:147], v[116:119]
s_add_u32 m0, s73, 71680
s_add_u32 s64, s72, 18432
v_mfma_f32_16x16x32_bf16 v[108:111], a[104:107], a[136:139], v[108:111]
ds_read_b64_tr_b16 a[180:181], v13 offset:24576
ds_read_b64_tr_b16 a[182:183], v13 offset:25088
v_mfma_f32_16x16x32_bf16 v[108:111], a[108:111], a[140:143], v[108:111]
buffer_load_dwordx4 v5, s[12:15], s64 offen lds
v_mfma_f32_16x16x32_bf16 v[100:103], a[108:111], a[132:135], v[100:103]
v_mfma_f32_16x16x32_bf16 v[100:103], a[104:107], a[128:131], v[100:103]
s_waitcnt lgkmcnt(2)
ds_read_b64_tr_b16 a[184:185], v14 offset:16384
ds_read_b64_tr_b16 a[186:187], v14 offset:16896
v_mfma_f32_16x16x32_bf16 v[128:131], a[112:115], a[128:131], v[128:131]
v_mfma_f32_16x16x32_bf16 v[128:131], a[116:119], a[132:135], v[128:131]
v_mfma_f32_16x16x32_bf16 v[136:139], a[116:119], a[140:143], v[136:139]
ds_read_b64_tr_b16 a[188:189], v14 offset:24576
ds_read_b64_tr_b16 a[190:191], v14 offset:25088
v_mfma_f32_16x16x32_bf16 v[136:139], a[112:115], a[136:139], v[136:139]
v_mfma_f32_16x16x32_bf16 v[144:147], a[112:115], a[144:147], v[144:147]
v_mfma_f32_16x16x32_bf16 v[144:147], a[116:119], a[148:151], v[144:147]
buffer_load_dwordx4 v6, s[12:15], s64 offen offset:1024 lds
v_mfma_f32_16x16x32_bf16 v[152:155], a[116:119], a[156:159], v[152:155]
v_mfma_f32_16x16x32_bf16 v[152:155], a[112:115], a[152:155], v[152:155]
v_mfma_f32_16x16x32_bf16 v[156:159], a[120:123], a[152:155], v[156:159]
v_mfma_f32_16x16x32_bf16 v[156:159], a[124:127], a[156:159], v[156:159]
v_mfma_f32_16x16x32_bf16 v[148:151], a[124:127], a[148:151], v[148:151]
v_mfma_f32_16x16x32_bf16 v[148:151], a[120:123], a[144:147], v[148:151]
v_mfma_f32_16x16x32_bf16 v[140:143], a[120:123], a[136:139], v[140:143]
v_mfma_f32_16x16x32_bf16 v[140:143], a[124:127], a[140:143], v[140:143]
v_mfma_f32_16x16x32_bf16 v[132:135], a[124:127], a[132:135], v[132:135]
v_mfma_f32_16x16x32_bf16 v[132:135], a[120:123], a[128:131], v[132:135]
s_waitcnt lgkmcnt(0)
v_mfma_f32_16x16x32_bf16 v[160:163], a[160:163], a[64:67], v[160:163]
s_waitcnt vmcnt(18)
v_mfma_f32_16x16x32_bf16 v[160:163], a[164:167], a[68:71], v[160:163]
s_barrier
v_mfma_f32_16x16x32_bf16 v[164:167], a[172:175], a[68:71], v[164:167]
ds_read_b64_tr_b16 a[128:129], v11 offset:32768
ds_read_b64_tr_b16 a[130:131], v11 offset:33280
v_mfma_f32_16x16x32_bf16 v[164:167], a[168:171], a[64:67], v[164:167]
s_add_u32 m0, s77, 16384
s_add_u32 s64, s76, 128
v_mfma_f32_16x16x32_bf16 v[168:171], a[176:179], a[64:67], v[168:171]
buffer_load_dwordx4 v7, s[20:23], s64 offen lds
v_mfma_f32_16x16x32_bf16 v[168:171], a[180:183], a[68:71], v[168:171]
v_mfma_f32_16x16x32_bf16 v[172:175], a[188:191], a[68:71], v[172:175]
v_mfma_f32_16x16x32_bf16 v[172:175], a[184:187], a[64:67], v[172:175]
ds_read_b128 a[64:67], v9 offset:0
v_mfma_f32_16x16x32_bf16 v[188:191], a[184:187], a[72:75], v[188:191]
ds_read_b64_tr_b16 a[132:133], v11 offset:40960
ds_read_b64_tr_b16 a[134:135], v11 offset:41472
v_mfma_f32_16x16x32_bf16 v[188:191], a[188:191], a[76:79], v[188:191]
v_mfma_f32_16x16x32_bf16 v[184:187], a[180:183], a[76:79], v[184:187]
v_mfma_f32_16x16x32_bf16 v[184:187], a[176:179], a[72:75], v[184:187]
ds_read_b128 a[68:71], v10 offset:0
v_mfma_f32_16x16x32_bf16 v[180:183], a[168:171], a[72:75], v[180:183]
buffer_load_dwordx4 v8, s[20:23], s64 offen offset:1024 lds
v_mfma_f32_16x16x32_bf16 v[180:183], a[172:175], a[76:79], v[180:183]
v_mfma_f32_16x16x32_bf16 v[176:179], a[164:167], a[76:79], v[176:179]
v_mfma_f32_16x16x32_bf16 v[176:179], a[160:163], a[72:75], v[176:179]
ds_read_b64_tr_b16 a[136:137], v12 offset:32768
ds_read_b64_tr_b16 a[138:139], v12 offset:33280
v_mfma_f32_16x16x32_bf16 v[192:195], a[160:163], a[80:83], v[192:195]
v_mfma_f32_16x16x32_bf16 v[192:195], a[164:167], a[84:87], v[192:195]
v_mfma_f32_16x16x32_bf16 v[196:199], a[172:175], a[84:87], v[196:199]
s_add_u32 m0, s80, 16384
s_add_u32 s64, s79, 2048
ds_read_b128 a[72:75], v9 offset:2048
v_mfma_f32_16x16x32_bf16 v[196:199], a[168:171], a[80:83], v[196:199]
v_mfma_f32_16x16x32_bf16 v[200:203], a[176:179], a[80:83], v[200:203]
buffer_load_dwordx4 v15, s[24:27], s64 offen sc1 lds
v_mfma_f32_16x16x32_bf16 v[200:203], a[180:183], a[84:87], v[200:203]
s_xor_b32 s65, s70, 0
s_add_u32 s71, s68, s65
s_add_u32 s72, s69, s65
v_mfma_f32_16x16x32_bf16 v[204:207], a[188:191], a[84:87], v[204:207]
ds_read_b64_tr_b16 a[140:141], v12 offset:40960
ds_read_b64_tr_b16 a[142:143], v12 offset:41472
v_mfma_f32_16x16x32_bf16 v[204:207], a[184:187], a[80:83], v[204:207]
v_mfma_f32_16x16x32_bf16 v[220:223], a[184:187], a[88:91], v[220:223]
ds_read_b128 a[76:79], v10 offset:2048
v_mfma_f32_16x16x32_bf16 v[220:223], a[188:191], a[92:95], v[220:223]
v_mfma_f32_16x16x32_bf16 v[216:219], a[180:183], a[92:95], v[216:219]
s_add_u32 m0, s73, 0
s_add_u32 s64, s71, 0
v_mfma_f32_16x16x32_bf16 v[216:219], a[176:179], a[88:91], v[216:219]
v_mfma_f32_16x16x32_bf16 v[212:215], a[168:171], a[88:91], v[212:215]
buffer_load_dwordx4 v5, s[12:15], s64 offen lds
v_mfma_f32_16x16x32_bf16 v[212:215], a[172:175], a[92:95], v[212:215]
ds_read_b64_tr_b16 a[144:145], v13 offset:32768
ds_read_b64_tr_b16 a[146:147], v13 offset:33280
v_mfma_f32_16x16x32_bf16 v[208:211], a[164:167], a[92:95], v[208:211]
v_mfma_f32_16x16x32_bf16 v[208:211], a[160:163], a[88:91], v[208:211]
ds_read_b128 a[80:83], v9 offset:4096
v_mfma_f32_16x16x32_bf16 v[224:227], a[160:163], a[96:99], v[224:227]
v_mfma_f32_16x16x32_bf16 v[224:227], a[164:167], a[100:103], v[224:227]
v_mfma_f32_16x16x32_bf16 v[228:231], a[172:175], a[100:103], v[228:231]
ds_read_b64_tr_b16 a[148:149], v13 offset:40960
ds_read_b64_tr_b16 a[150:151], v13 offset:41472
v_mfma_f32_16x16x32_bf16 v[228:231], a[168:171], a[96:99], v[228:231]
v_mfma_f32_16x16x32_bf16 v[232:235], a[176:179], a[96:99], v[232:235]
v_mfma_f32_16x16x32_bf16 v[232:235], a[180:183], a[100:103], v[232:235]
buffer_load_dwordx4 v6, s[12:15], s64 offen offset:1024 lds
v_mfma_f32_16x16x32_bf16 v[236:239], a[188:191], a[100:103], v[236:239]
ds_read_b128 a[84:87], v10 offset:4096
v_mfma_f32_16x16x32_bf16 v[236:239], a[184:187], a[96:99], v[236:239]
v_mfma_f32_16x16x32_bf16 v[252:255], a[184:187], a[104:107], v[252:255]
v_mfma_f32_16x16x32_bf16 v[252:255], a[188:191], a[108:111], v[252:255]
ds_read_b64_tr_b16 a[152:153], v14 offset:32768
ds_read_b64_tr_b16 a[154:155], v14 offset:33280
v_mfma_f32_16x16x32_bf16 v[248:251], a[180:183], a[108:111], v[248:251]
v_mfma_f32_16x16x32_bf16 v[248:251], a[176:179], a[104:107], v[248:251]
s_add_u32 m0, s73, 2048
s_add_u32 s64, s71, 18432
v_mfma_f32_16x16x32_bf16 v[244:247], a[168:171], a[104:107], v[244:247]
ds_read_b128 a[88:91], v9 offset:6144
v_mfma_f32_16x16x32_bf16 v[244:247], a[172:175], a[108:111], v[244:247]
buffer_load_dwordx4 v5, s[12:15], s64 offen lds
v_mfma_f32_16x16x32_bf16 v[240:243], a[164:167], a[108:111], v[240:243]
v_mfma_f32_16x16x32_bf16 v[240:243], a[160:163], a[104:107], v[240:243]
ds_read_b64_tr_b16 a[156:157], v14 offset:40960
ds_read_b64_tr_b16 a[158:159], v14 offset:41472
v_mfma_f32_16x16x32_bf16 a[0:3], a[160:163], a[112:115], a[0:3]
v_mfma_f32_16x16x32_bf16 a[0:3], a[164:167], a[116:119], a[0:3]
v_mfma_f32_16x16x32_bf16 a[4:7], a[172:175], a[116:119], a[4:7]
ds_read_b128 a[92:95], v10 offset:6144
v_mfma_f32_16x16x32_bf16 a[4:7], a[168:171], a[112:115], a[4:7]
v_mfma_f32_16x16x32_bf16 a[8:11], a[176:179], a[112:115], a[8:11]
v_mfma_f32_16x16x32_bf16 a[8:11], a[180:183], a[116:119], a[8:11]
buffer_load_dwordx4 v6, s[12:15], s64 offen offset:1024 lds
v_mfma_f32_16x16x32_bf16 a[12:15], a[188:191], a[116:119], a[12:15]
v_mfma_f32_16x16x32_bf16 a[12:15], a[184:187], a[112:115], a[12:15]
v_mfma_f32_16x16x32_bf16 a[28:31], a[184:187], a[120:123], a[28:31]
v_mfma_f32_16x16x32_bf16 a[28:31], a[188:191], a[124:127], a[28:31]
v_mfma_f32_16x16x32_bf16 a[24:27], a[180:183], a[124:127], a[24:27]
v_mfma_f32_16x16x32_bf16 a[24:27], a[176:179], a[120:123], a[24:27]
v_mfma_f32_16x16x32_bf16 a[20:23], a[168:171], a[120:123], a[20:23]
v_mfma_f32_16x16x32_bf16 a[20:23], a[172:175], a[124:127], a[20:23]
v_mfma_f32_16x16x32_bf16 a[16:19], a[164:167], a[124:127], a[16:19]
v_mfma_f32_16x16x32_bf16 a[16:19], a[160:163], a[120:123], a[16:19]
s_waitcnt lgkmcnt(0)
v_mfma_f32_16x16x32_bf16 v[32:35], a[64:67], a[128:131], v[32:35]
s_waitcnt vmcnt(20)
v_mfma_f32_16x16x32_bf16 v[32:35], a[68:71], a[132:135], v[32:35]
s_barrier
v_mfma_f32_16x16x32_bf16 v[40:43], a[68:71], a[140:143], v[40:43]
L_PAD3:
s_cbranch_execz L_PAD7
ds_read_b128 a[96:99], v9 offset:8192
v_mfma_f32_16x16x32_bf16 v[40:43], a[64:67], a[136:139], v[40:43]
s_xor_b32 s75, s93, 0
s_lshl_b32 s76, s75, 19
s_add_u32 s76, s76, s74
v_mfma_f32_16x16x32_bf16 v[48:51], a[64:67], a[144:147], v[48:51]
s_lshl_b32 s79, s75, 13
s_add_u32 s79, s79, s78
v_mfma_f32_16x16x32_bf16 v[48:51], a[68:71], a[148:151], v[48:51]
s_add_u32 m0, s77, 32768
s_add_u32 s64, s76, 0
ds_read_b128 a[100:103], v10 offset:8192
v_mfma_f32_16x16x32_bf16 v[56:59], a[68:71], a[156:159], v[56:59]
buffer_load_dwordx4 v7, s[20:23], s64 offen lds
v_mfma_f32_16x16x32_bf16 v[56:59], a[64:67], a[152:155], v[56:59]
v_mfma_f32_16x16x32_bf16 v[60:63], a[72:75], a[152:155], v[60:63]
ds_read_b128 a[104:107], v9 offset:10240
v_mfma_f32_16x16x32_bf16 v[60:63], a[76:79], a[156:159], v[60:63]
v_mfma_f32_16x16x32_bf16 v[52:55], a[76:79], a[148:151], v[52:55]
v_mfma_f32_16x16x32_bf16 v[52:55], a[72:75], a[144:147], v[52:55]
ds_read_b64_tr_b16 a[160:161], v11 offset:49152
ds_read_b64_tr_b16 a[162:163], v11 offset:49664
v_mfma_f32_16x16x32_bf16 v[44:47], a[72:75], a[136:139], v[44:47]
buffer_load_dwordx4 v8, s[20:23], s64 offen offset:1024 lds
v_mfma_f32_16x16x32_bf16 v[44:47], a[76:79], a[140:143], v[44:47]
v_mfma_f32_16x16x32_bf16 v[36:39], a[76:79], a[132:135], v[36:39]
v_mfma_f32_16x16x32_bf16 v[36:39], a[72:75], a[128:131], v[36:39]
ds_read_b128 a[108:111], v10 offset:10240
v_mfma_f32_16x16x32_bf16 v[64:67], a[80:83], a[128:131], v[64:67]
v_mfma_f32_16x16x32_bf16 v[64:67], a[84:87], a[132:135], v[64:67]
v_mfma_f32_16x16x32_bf16 v[72:75], a[84:87], a[140:143], v[72:75]
s_add_u32 m0, s80, 32768
s_add_u32 s64, s79, 0
v_mfma_f32_16x16x32_bf16 v[72:75], a[80:83], a[136:139], v[72:75]
ds_read_b64_tr_b16 a[164:165], v11 offset:57344
ds_read_b64_tr_b16 a[166:167], v11 offset:57856
v_mfma_f32_16x16x32_bf16 v[80:83], a[80:83], a[144:147], v[80:83]
buffer_load_dwordx4 v15, s[24:27], s64 offen sc1 lds
v_mfma_f32_16x16x32_bf16 v[80:83], a[84:87], a[148:151], v[80:83]
ds_read_b128 a[112:115], v9 offset:12288
v_mfma_f32_16x16x32_bf16 v[88:91], a[84:87], a[156:159], v[88:91]
v_cvt_pk_bf16_f32 v32, v32, v33
v_cvt_pk_bf16_f32 v33, v34, v35
v_mfma_f32_16x16x32_bf16 v[88:91], a[80:83], a[152:155], v[88:91]
v_cvt_pk_bf16_f32 v34, v36, v37
v_cvt_pk_bf16_f32 v35, v38, v39
v_mfma_f32_16x16x32_bf16 v[92:95], a[88:91], a[152:155], v[92:95]
ds_read_b64_tr_b16 a[168:169], v12 offset:49152
ds_read_b64_tr_b16 a[170:171], v12 offset:49664
v_mfma_f32_16x16x32_bf16 v[92:95], a[92:95], a[156:159], v[92:95]
v_cvt_pk_bf16_f32 v40, v40, v41
v_cvt_pk_bf16_f32 v41, v42, v43
v_mfma_f32_16x16x32_bf16 v[84:87], a[92:95], a[148:151], v[84:87]
s_add_u32 m0, s73, 4096
s_add_u32 s64, s72, 0
s_lshr_b32 s55, s3, 1
v_mfma_f32_16x16x32_bf16 v[84:87], a[88:91], a[144:147], v[84:87]
s_lshl_b32 s55, s55, 14
s_lshl_b32 s54, s3, 13
s_sub_u32 s55, s54, s55
v_mfma_f32_16x16x32_bf16 v[76:79], a[88:91], a[136:139], v[76:79]
buffer_load_dwordx4 v5, s[12:15], s64 offen lds
v_mfma_f32_16x16x32_bf16 v[76:79], a[92:95], a[140:143], v[76:79]
s_and_b32 s54, s3, 1
s_lshl_b32 s54, s54, 12
ds_read_b128 a[116:119], v10 offset:12288
v_mfma_f32_16x16x32_bf16 v[68:71], a[92:95], a[132:135], v[68:71]
s_add_u32 s53, s88, 0
v_cvt_pk_bf16_f32 v42, v44, v45
v_cvt_pk_bf16_f32 v43, v46, v47
v_mfma_f32_16x16x32_bf16 v[68:71], a[88:91], a[128:131], v[68:71]
s_waitcnt lgkmcnt(6)
ds_read_b64_tr_b16 a[172:173], v12 offset:57344
ds_read_b64_tr_b16 a[174:175], v12 offset:57856
v_mfma_f32_16x16x32_bf16 v[96:99], a[96:99], a[128:131], v[96:99]
buffer_store_dwordx4 v[32:35], v15, s[24:27], s53 offen offset:0 sc1
v_mfma_f32_16x16x32_bf16 v[96:99], a[100:103], a[132:135], v[96:99]
v_cvt_pk_bf16_f32 v48, v48, v49
v_cvt_pk_bf16_f32 v49, v50, v51
v_mfma_f32_16x16x32_bf16 v[104:107], a[100:103], a[140:143], v[104:107]
ds_read_b128 a[120:123], v9 offset:14336
v_cvt_pk_bf16_f32 v50, v52, v53
v_mfma_f32_16x16x32_bf16 v[104:107], a[96:99], a[136:139], v[104:107]
v_cvt_pk_bf16_f32 v51, v54, v55
v_cvt_pk_bf16_f32 v56, v56, v57
v_mfma_f32_16x16x32_bf16 v[112:115], a[96:99], a[144:147], v[112:115]
v_cvt_pk_bf16_f32 v57, v58, v59
v_cvt_pk_bf16_f32 v58, v60, v61
v_mfma_f32_16x16x32_bf16 v[112:115], a[100:103], a[148:151], v[112:115]
buffer_load_dwordx4 v6, s[12:15], s64 offen offset:1024 lds
v_mfma_f32_16x16x32_bf16 v[120:123], a[100:103], a[156:159], v[120:123]
ds_read_b64_tr_b16 a[176:177], v13 offset:49152
ds_read_b64_tr_b16 a[178:179], v13 offset:49664
v_mfma_f32_16x16x32_bf16 v[120:123], a[96:99], a[152:155], v[120:123]
v_cvt_pk_bf16_f32 v59, v62, v63
v_cvt_pk_bf16_f32 v64, v64, v65
v_mfma_f32_16x16x32_bf16 v[124:127], a[104:107], a[152:155], v[124:127]
v_cvt_pk_bf16_f32 v65, v66, v67
v_cvt_pk_bf16_f32 v66, v68, v69
v_mfma_f32_16x16x32_bf16 v[124:127], a[108:111], a[156:159], v[124:127]
ds_read_b128 a[124:127], v10 offset:14336
v_cvt_pk_bf16_f32 v67, v70, v71
v_mfma_f32_16x16x32_bf16 v[116:119], a[108:111], a[148:151], v[116:119]
v_add_u32 v9, 32768, v9
v_add_u32 v10, 32768, v10
v_mfma_f32_16x16x32_bf16 v[116:119], a[104:107], a[144:147], v[116:119]
s_add_u32 m0, s73, 6144
s_add_u32 s64, s72, 18432
v_cvt_pk_bf16_f32 v72, v72, v73
v_mfma_f32_16x16x32_bf16 v[108:111], a[104:107], a[136:139], v[108:111]
ds_read_b64_tr_b16 a[180:181], v13 offset:57344
ds_read_b64_tr_b16 a[182:183], v13 offset:57856
v_mfma_f32_16x16x32_bf16 v[108:111], a[108:111], a[140:143], v[108:111]
buffer_load_dwordx4 v5, s[12:15], s64 offen lds
v_mfma_f32_16x16x32_bf16 v[100:103], a[108:111], a[132:135], v[100:103]
v_cvt_pk_bf16_f32 v73, v74, v75
v_cvt_pk_bf16_f32 v74, v76, v77
v_mfma_f32_16x16x32_bf16 v[100:103], a[104:107], a[128:131], v[100:103]
s_waitcnt lgkmcnt(2)
ds_read_b64_tr_b16 a[184:185], v14 offset:49152
ds_read_b64_tr_b16 a[186:187], v14 offset:49664
v_mfma_f32_16x16x32_bf16 v[128:131], a[112:115], a[128:131], v[128:131]
v_cvt_pk_bf16_f32 v75, v78, v79
v_cvt_pk_bf16_f32 v80, v80, v81
v_mfma_f32_16x16x32_bf16 v[128:131], a[116:119], a[132:135], v[128:131]
v_cvt_pk_bf16_f32 v81, v82, v83
v_cvt_pk_bf16_f32 v82, v84, v85
v_mfma_f32_16x16x32_bf16 v[136:139], a[116:119], a[140:143], v[136:139]
ds_read_b64_tr_b16 a[188:189], v14 offset:57344
ds_read_b64_tr_b16 a[190:191], v14 offset:57856
v_mfma_f32_16x16x32_bf16 v[136:139], a[112:115], a[136:139], v[136:139]
v_add_u32 v9, s55, v9
v_add_u32 v10, s55, v10
v_mfma_f32_16x16x32_bf16 v[144:147], a[112:115], a[144:147], v[144:147]
v_subrev_u32 v11, s54, v11
v_subrev_u32 v12, s54, v12
v_mfma_f32_16x16x32_bf16 v[144:147], a[116:119], a[148:151], v[144:147]
buffer_load_dwordx4 v6, s[12:15], s64 offen offset:1024 lds
v_mfma_f32_16x16x32_bf16 v[152:155], a[116:119], a[156:159], v[152:155]
v_subrev_u32 v13, s54, v13
v_subrev_u32 v14, s54, v14
v_mfma_f32_16x16x32_bf16 v[152:155], a[112:115], a[152:155], v[152:155]
v_cvt_pk_bf16_f32 v83, v86, v87
v_cvt_pk_bf16_f32 v88, v88, v89
v_mfma_f32_16x16x32_bf16 v[156:159], a[120:123], a[152:155], v[156:159]
v_cvt_pk_bf16_f32 v89, v90, v91
v_cvt_pk_bf16_f32 v90, v92, v93
v_mfma_f32_16x16x32_bf16 v[156:159], a[124:127], a[156:159], v[156:159]
s_add_u32 s53, s88, 0
v_cvt_pk_bf16_f32 v91, v94, v95
v_cvt_pk_bf16_f32 v96, v96, v97
v_mfma_f32_16x16x32_bf16 v[148:151], a[124:127], a[148:151], v[148:151]
buffer_store_dwordx4 v[40:43], v15, s[24:27], s53 offen offset:1024 sc1
v_mfma_f32_16x16x32_bf16 v[148:151], a[120:123], a[144:147], v[148:151]
v_cvt_pk_bf16_f32 v97, v98, v99
v_cvt_pk_bf16_f32 v98, v100, v101
v_mfma_f32_16x16x32_bf16 v[140:143], a[120:123], a[136:139], v[140:143]
v_cvt_pk_bf16_f32 v99, v102, v103
v_cvt_pk_bf16_f32 v104, v104, v105
v_mfma_f32_16x16x32_bf16 v[140:143], a[124:127], a[140:143], v[140:143]
v_cvt_pk_bf16_f32 v105, v106, v107
v_cvt_pk_bf16_f32 v106, v108, v109
v_mfma_f32_16x16x32_bf16 v[132:135], a[124:127], a[132:135], v[132:135]
v_cvt_pk_bf16_f32 v107, v110, v111
v_cvt_pk_bf16_f32 v112, v112, v113
v_mfma_f32_16x16x32_bf16 v[132:135], a[120:123], a[128:131], v[132:135]
s_waitcnt lgkmcnt(0)
v_cvt_pk_bf16_f32 v113, v114, v115
v_cvt_pk_bf16_f32 v114, v116, v117
v_mfma_f32_16x16x32_bf16 v[160:163], a[160:163], a[64:67], v[160:163]
s_waitcnt vmcnt(16)
v_cvt_pk_bf16_f32 v115, v118, v119
v_cvt_pk_bf16_f32 v120, v120, v121
v_mfma_f32_16x16x32_bf16 v[160:163], a[164:167], a[68:71], v[160:163]
s_barrier
v_mfma_f32_16x16x32_bf16 v[164:167], a[172:175], a[68:71], v[164:167]
ds_read_b64_tr_b16 a[128:129], v11 offset:0
ds_read_b64_tr_b16 a[130:131], v11 offset:512
v_mfma_f32_16x16x32_bf16 v[164:167], a[168:171], a[64:67], v[164:167]
s_add_u32 m0, s77, 49152
s_add_u32 s64, s76, 128
v_cvt_pk_bf16_f32 v121, v122, v123
v_mfma_f32_16x16x32_bf16 v[168:171], a[176:179], a[64:67], v[168:171]
buffer_load_dwordx4 v7, s[20:23], s64 offen lds
v_mfma_f32_16x16x32_bf16 v[168:171], a[180:183], a[68:71], v[168:171]
ds_read_b64_tr_b16 a[132:133], v11 offset:4096
ds_read_b64_tr_b16 a[134:135], v11 offset:4608
v_mfma_f32_16x16x32_bf16 v[172:175], a[188:191], a[68:71], v[172:175]
v_cvt_pk_bf16_f32 v122, v124, v125
v_cvt_pk_bf16_f32 v123, v126, v127
v_mfma_f32_16x16x32_bf16 v[172:175], a[184:187], a[64:67], v[172:175]
v_cvt_pk_bf16_f32 v128, v128, v129
v_cvt_pk_bf16_f32 v129, v130, v131
v_mfma_f32_16x16x32_bf16 v[188:191], a[184:187], a[72:75], v[188:191]
ds_read_b64_tr_b16 a[136:137], v12 offset:0
ds_read_b64_tr_b16 a[138:139], v12 offset:512
v_mfma_f32_16x16x32_bf16 v[188:191], a[188:191], a[76:79], v[188:191]
v_cvt_pk_bf16_f32 v130, v132, v133
v_cvt_pk_bf16_f32 v131, v134, v135
v_mfma_f32_16x16x32_bf16 v[184:187], a[180:183], a[76:79], v[184:187]
v_cvt_pk_bf16_f32 v136, v136, v137
v_cvt_pk_bf16_f32 v137, v138, v139
v_mfma_f32_16x16x32_bf16 v[184:187], a[176:179], a[72:75], v[184:187]
ds_read_b64_tr_b16 a[140:141], v12 offset:4096
ds_read_b64_tr_b16 a[142:143], v12 offset:4608
v_mfma_f32_16x16x32_bf16 v[180:183], a[168:171], a[72:75], v[180:183]
buffer_load_dwordx4 v8, s[20:23], s64 offen offset:1024 lds
v_mfma_f32_16x16x32_bf16 v[180:183], a[172:175], a[76:79], v[180:183]
v_cvt_pk_bf16_f32 v138, v140, v141
v_cvt_pk_bf16_f32 v139, v142, v143
v_mfma_f32_16x16x32_bf16 v[176:179], a[164:167], a[76:79], v[176:179]
v_cvt_pk_bf16_f32 v144, v144, v145
v_cvt_pk_bf16_f32 v145, v146, v147
v_mfma_f32_16x16x32_bf16 v[176:179], a[160:163], a[72:75], v[176:179]
ds_read_b64_tr_b16 a[144:145], v13 offset:0
ds_read_b64_tr_b16 a[146:147], v13 offset:512
v_mfma_f32_16x16x32_bf16 v[192:195], a[160:163], a[80:83], v[192:195]
v_cvt_pk_bf16_f32 v146, v148, v149
v_cvt_pk_bf16_f32 v147, v150, v151
v_mfma_f32_16x16x32_bf16 v[192:195], a[164:167], a[84:87], v[192:195]
v_cvt_pk_bf16_f32 v152, v152, v153
v_cvt_pk_bf16_f32 v153, v154, v155
v_mfma_f32_16x16x32_bf16 v[196:199], a[172:175], a[84:87], v[196:199]
s_add_u32 m0, s80, 49152
s_add_u32 s64, s79, 2048
v_cvt_pk_bf16_f32 v154, v156, v157
v_mfma_f32_16x16x32_bf16 v[196:199], a[168:171], a[80:83], v[196:199]
ds_read_b64_tr_b16 a[148:149], v13 offset:4096
ds_read_b64_tr_b16 a[150:151], v13 offset:4608
v_mfma_f32_16x16x32_bf16 v[200:203], a[176:179], a[80:83], v[200:203]
buffer_load_dwordx4 v15, s[24:27], s64 offen sc1 lds
v_mfma_f32_16x16x32_bf16 v[200:203], a[180:183], a[84:87], v[200:203]
s_xor_b32 s65, s70, 128
s_add_u32 s71, s68, s65
s_add_u32 s72, s69, s65
v_mfma_f32_16x16x32_bf16 v[204:207], a[188:191], a[84:87], v[204:207]
s_add_u32 s53, s88, 0
ds_read_b64_tr_b16 a[152:153], v14 offset:0
ds_read_b64_tr_b16 a[154:155], v14 offset:512
v_mfma_f32_16x16x32_bf16 v[204:207], a[184:187], a[80:83], v[204:207]
buffer_store_dwordx4 v[48:51], v15, s[24:27], s53 offen offset:2048 sc1
v_mfma_f32_16x16x32_bf16 v[220:223], a[184:187], a[88:91], v[220:223]
ds_read_b64_tr_b16 a[156:157], v14 offset:4096
ds_read_b64_tr_b16 a[158:159], v14 offset:4608
v_mfma_f32_16x16x32_bf16 v[220:223], a[188:191], a[92:95], v[220:223]
v_cvt_pk_bf16_f32 v155, v158, v159
v_mul_f32 v160, s91, v160
v_mfma_f32_16x16x32_bf16 v[216:219], a[180:183], a[92:95], v[216:219]
s_add_u32 m0, s73, 32768
s_add_u32 s64, s71, 0
v_mul_f32 v161, s91, v161
v_mfma_f32_16x16x32_bf16 v[216:219], a[176:179], a[88:91], v[216:219]
v_mul_f32 v162, s91, v162
v_mul_f32 v163, s91, v163
v_mfma_f32_16x16x32_bf16 v[212:215], a[168:171], a[88:91], v[212:215]
buffer_load_dwordx4 v5, s[12:15], s64 offen lds
v_mfma_f32_16x16x32_bf16 v[212:215], a[172:175], a[92:95], v[212:215]
ds_read_b128 a[68:71], v4 offset:10240
v_mul_f32 v164, s91, v164
v_mfma_f32_16x16x32_bf16 v[208:211], a[164:167], a[92:95], v[208:211]
v_mul_f32 v165, s91, v165
v_mul_f32 v166, s91, v166
v_mfma_f32_16x16x32_bf16 v[208:211], a[160:163], a[88:91], v[208:211]
ds_read_b128 a[64:67], v4 offset:8192
v_mul_f32 v167, s91, v167
v_mfma_f32_16x16x32_bf16 v[224:227], a[160:163], a[96:99], v[224:227]
v_cvt_pk_bf16_f32 v160, v160, v161
v_cvt_pk_bf16_f32 v161, v162, v163
v_mfma_f32_16x16x32_bf16 v[224:227], a[164:167], a[100:103], v[224:227]
v_cvt_pk_bf16_f32 v162, v164, v165
v_cvt_pk_bf16_f32 v163, v166, v167
v_mfma_f32_16x16x32_bf16 v[228:231], a[172:175], a[100:103], v[228:231]
ds_read_b128 a[76:79], v4 offset:11264
v_mul_f32 v168, s91, v168
v_mfma_f32_16x16x32_bf16 v[228:231], a[168:171], a[96:99], v[228:231]
v_mul_f32 v169, s91, v169
v_mul_f32 v170, s91, v170
v_mfma_f32_16x16x32_bf16 v[232:235], a[176:179], a[96:99], v[232:235]
v_mul_f32 v171, s91, v171
v_mul_f32 v172, s91, v172
v_mfma_f32_16x16x32_bf16 v[232:235], a[180:183], a[100:103], v[232:235]
buffer_load_dwordx4 v6, s[12:15], s64 offen offset:1024 lds
v_mfma_f32_16x16x32_bf16 v[236:239], a[188:191], a[100:103], v[236:239]
ds_read_b128 a[72:75], v4 offset:9216
v_mul_f32 v173, s91, v173
v_mfma_f32_16x16x32_bf16 v[236:239], a[184:187], a[96:99], v[236:239]
v_mul_f32 v174, s91, v174
v_mul_f32 v175, s91, v175
v_mfma_f32_16x16x32_bf16 v[252:255], a[184:187], a[104:107], v[252:255]
v_cvt_pk_bf16_f32 v168, v168, v169
v_cvt_pk_bf16_f32 v169, v170, v171
v_mfma_f32_16x16x32_bf16 v[252:255], a[188:191], a[108:111], v[252:255]
ds_read_b128 a[84:87], v10 offset:0
v_cvt_pk_bf16_f32 v170, v172, v173
v_mfma_f32_16x16x32_bf16 v[248:251], a[180:183], a[108:111], v[248:251]
v_cvt_pk_bf16_f32 v171, v174, v175
v_mul_f32 v176, s91, v176
v_mfma_f32_16x16x32_bf16 v[248:251], a[176:179], a[104:107], v[248:251]
s_add_u32 m0, s73, 34816
s_add_u32 s64, s71, 18432
v_mul_f32 v177, s91, v177
v_mfma_f32_16x16x32_bf16 v[244:247], a[168:171], a[104:107], v[244:247]
ds_read_b128 a[80:83], v9 offset:0
v_mul_f32 v178, s91, v178
v_mfma_f32_16x16x32_bf16 v[244:247], a[172:175], a[108:111], v[244:247]
buffer_load_dwordx4 v5, s[12:15], s64 offen lds
v_mfma_f32_16x16x32_bf16 v[240:243], a[164:167], a[108:111], v[240:243]
v_mul_f32 v179, s91, v179
v_mul_f32 v180, s91, v180
v_mfma_f32_16x16x32_bf16 v[240:243], a[160:163], a[104:107], v[240:243]
s_add_u32 s53, s88, 0
ds_read_b128 a[92:95], v10 offset:2048
v_mul_f32 v181, s91, v181
v_mfma_f32_16x16x32_bf16 a[0:3], a[160:163], a[112:115], a[0:3]
buffer_store_dwordx4 v[56:59], v15, s[24:27], s53 offen offset:3072 sc1
v_mfma_f32_16x16x32_bf16 a[0:3], a[164:167], a[116:119], a[0:3]
v_mul_f32 v182, s91, v182
v_mul_f32 v183, s91, v183
v_mfma_f32_16x16x32_bf16 a[4:7], a[172:175], a[116:119], a[4:7]
ds_read_b128 a[88:91], v9 offset:2048
v_cvt_pk_bf16_f32 v176, v176, v177
v_mfma_f32_16x16x32_bf16 a[4:7], a[168:171], a[112:115], a[4:7]
v_cvt_pk_bf16_f32 v177, v178, v179
v_cvt_pk_bf16_f32 v178, v180, v181
v_mfma_f32_16x16x32_bf16 a[8:11], a[176:179], a[112:115], a[8:11]
v_cvt_pk_bf16_f32 v179, v182, v183
v_mul_f32 v184, s91, v184
v_mfma_f32_16x16x32_bf16 a[8:11], a[180:183], a[116:119], a[8:11]
buffer_load_dwordx4 v6, s[12:15], s64 offen offset:1024 lds
v_mfma_f32_16x16x32_bf16 a[12:15], a[188:191], a[116:119], a[12:15]
v_mul_f32 v185, s91, v185
v_mul_f32 v186, s91, v186
v_mfma_f32_16x16x32_bf16 a[12:15], a[184:187], a[112:115], a[12:15]
v_mul_f32 v187, s91, v187
v_mul_f32 v188, s91, v188
v_mfma_f32_16x16x32_bf16 a[28:31], a[184:187], a[120:123], a[28:31]
v_mul_f32 v189, s91, v189
v_mul_f32 v190, s91, v190
v_mfma_f32_16x16x32_bf16 a[28:31], a[188:191], a[124:127], a[28:31]
v_mul_f32 v191, s91, v191
v_cvt_pk_bf16_f32 v184, v184, v185
v_mfma_f32_16x16x32_bf16 a[24:27], a[180:183], a[124:127], a[24:27]
v_cvt_pk_bf16_f32 v185, v186, v187
v_cvt_pk_bf16_f32 v186, v188, v189
v_mfma_f32_16x16x32_bf16 a[24:27], a[176:179], a[120:123], a[24:27]
v_cvt_pk_bf16_f32 v187, v190, v191
v_mul_f32 v192, s91, v192
v_mfma_f32_16x16x32_bf16 a[20:23], a[168:171], a[120:123], a[20:23]
v_mul_f32 v193, s91, v193
v_mul_f32 v194, s91, v194
v_mfma_f32_16x16x32_bf16 a[20:23], a[172:175], a[124:127], a[20:23]
v_mul_f32 v195, s91, v195
v_mul_f32 v196, s91, v196
v_mfma_f32_16x16x32_bf16 a[16:19], a[164:167], a[124:127], a[16:19]
v_mul_f32 v197, s91, v197
v_mul_f32 v198, s91, v198
v_mfma_f32_16x16x32_bf16 a[16:19], a[160:163], a[120:123], a[16:19]
s_waitcnt lgkmcnt(0)
v_mul_f32 v199, s91, v199
v_cvt_pk_bf16_f32 v192, v192, v193
v_mfma_f32_16x16x32_bf16 v[36:39], a[128:131], a[80:83], 0
s_waitcnt vmcnt(22)
v_cvt_pk_bf16_f32 v193, v194, v195
v_cvt_pk_bf16_f32 v194, v196, v197
v_mfma_f32_16x16x32_bf16 v[36:39], a[132:135], a[84:87], v[36:39]
s_barrier
v_mfma_f32_16x16x32_bf16 v[44:47], a[140:143], a[84:87], 0
ds_read_b128 a[96:99], v9 offset:4096
v_cvt_pk_bf16_f32 v195, v198, v199
v_mfma_f32_16x16x32_bf16 v[44:47], a[136:139], a[80:83], v[44:47]
s_xor_b32 s75, s93, 1
s_lshl_b32 s76, s75, 19
s_add_u32 s76, s76, s74
v_mfma_f32_16x16x32_bf16 v[32:35], a[144:147], a[80:83], 0
s_lshl_b32 s79, s75, 13
s_add_u32 s79, s79, s78
ds_read_b128 a[100:103], v10 offset:4096
v_mfma_f32_16x16x32_bf16 v[32:35], a[148:151], a[84:87], v[32:35]
s_add_u32 m0, s77, 0
s_add_u32 s64, s76, 0
ds_read_b128 a[104:107], v9 offset:6144
v_mfma_f32_16x16x32_bf16 v[52:55], a[156:159], a[84:87], 0
buffer_load_dwordx4 v7, s[20:23], s64 offen lds
v_mfma_f32_16x16x32_bf16 v[52:55], a[152:155], a[80:83], v[52:55]
ds_read_b64_tr_b16 a[160:161], v11 offset:16384
ds_read_b64_tr_b16 a[162:163], v11 offset:16896
v_mfma_f32_16x16x32_bf16 v[60:63], a[64:67], a[80:83], 0
v_mul_f32 v200, s91, v200
v_mul_f32 v201, s91, v201
v_mfma_f32_16x16x32_bf16 v[60:63], a[68:71], a[84:87], v[60:63]
ds_read_b128 a[108:111], v10 offset:6144
v_mul_f32 v202, s91, v202
v_mfma_f32_16x16x32_bf16 v[68:71], a[76:79], a[84:87], 0
buffer_load_dwordx4 v8, s[20:23], s64 offen offset:1024 lds
v_mfma_f32_16x16x32_bf16 v[68:71], a[72:75], a[80:83], v[68:71]
s_add_u32 s53, s88, 262144
ds_read_b64_tr_b16 a[164:165], v11 offset:20480
ds_read_b64_tr_b16 a[166:167], v11 offset:20992
v_mfma_f32_16x16x32_bf16 v[76:79], a[72:75], a[88:91], 0
v_add_u32 v9, -65536, v9
v_add_u32 v10, -65536, v10
v_mfma_f32_16x16x32_bf16 v[76:79], a[76:79], a[92:95], v[76:79]
ds_read_b64_tr_b16 a[168:169], v12 offset:16384
ds_read_b64_tr_b16 a[170:171], v12 offset:16896
v_mfma_f32_16x16x32_bf16 v[84:87], a[68:71], a[92:95], 0
s_add_u32 m0, s80, 0
s_add_u32 s64, s79, 0
v_mul_f32 v203, s91, v203
v_mfma_f32_16x16x32_bf16 v[84:87], a[64:67], a[88:91], v[84:87]
ds_read_b64_tr_b16 a[172:173], v12 offset:20480
ds_read_b64_tr_b16 a[174:175], v12 offset:20992
v_mfma_f32_16x16x32_bf16 v[92:95], a[152:155], a[88:91], 0
buffer_load_dwordx4 v15, s[24:27], s64 offen sc1 lds
v_mfma_f32_16x16x32_bf16 v[92:95], a[156:159], a[92:95], v[92:95]
buffer_store_dwordx4 v[64:67], v15, s[24:27], s53 offen offset:0 sc1
v_mfma_f32_16x16x32_bf16 v[40:43], a[148:151], a[92:95], 0
ds_read_b64_tr_b16 a[176:177], v13 offset:16384
ds_read_b64_tr_b16 a[178:179], v13 offset:16896
v_mfma_f32_16x16x32_bf16 v[40:43], a[144:147], a[88:91], v[40:43]
v_mul_f32 v204, s91, v204
v_mul_f32 v205, s91, v205
v_mfma_f32_16x16x32_bf16 v[100:103], a[136:139], a[88:91], 0
s_add_u32 m0, s73, 36864
s_add_u32 s64, s72, 0
v_mul_f32 v206, s91, v206
v_mfma_f32_16x16x32_bf16 v[100:103], a[140:143], a[92:95], v[100:103]
ds_read_b64_tr_b16 a[180:181], v13 offset:20480
ds_read_b64_tr_b16 a[182:183], v13 offset:20992
v_mfma_f32_16x16x32_bf16 v[108:111], a[132:135], a[92:95], 0
buffer_load_dwordx4 v5, s[12:15], s64 offen lds
v_mfma_f32_16x16x32_bf16 v[108:111], a[128:131], a[88:91], v[108:111]
s_waitcnt lgkmcnt(14)
ds_read_b64_tr_b16 a[184:185], v14 offset:16384
ds_read_b64_tr_b16 a[186:187], v14 offset:16896
v_mfma_f32_16x16x32_bf16 v[116:119], a[128:131], a[96:99], 0
ds_read_b64_tr_b16 a[188:189], v14 offset:20480
ds_read_b64_tr_b16 a[190:191], v14 offset:20992
v_mfma_f32_16x16x32_bf16 v[116:119], a[132:135], a[100:103], v[116:119]
v_mul_f32 v207, s91, v207
v_cvt_pk_bf16_f32 v200, v200, v201
v_mfma_f32_16x16x32_bf16 v[124:127], a[140:143], a[100:103], 0
v_cvt_pk_bf16_f32 v201, v202, v203
v_cvt_pk_bf16_f32 v202, v204, v205
v_mfma_f32_16x16x32_bf16 v[124:127], a[136:139], a[96:99], v[124:127]
ds_read_b128 a[112:115], v4 offset:24576
v_cvt_pk_bf16_f32 v203, v206, v207
v_mfma_f32_16x16x32_bf16 v[132:135], a[144:147], a[96:99], 0
buffer_load_dwordx4 v6, s[12:15], s64 offen offset:1024 lds
v_mfma_f32_16x16x32_bf16 v[132:135], a[148:151], a[100:103], v[132:135]
ds_read_b128 a[116:119], v4 offset:26624
v_mul_f32 v208, s91, v208
v_mfma_f32_16x16x32_bf16 v[140:143], a[156:159], a[100:103], 0
v_mul_f32 v209, s91, v209
v_mul_f32 v210, s91, v210
v_mfma_f32_16x16x32_bf16 v[140:143], a[152:155], a[96:99], v[140:143]
ds_read_b128 a[120:123], v4 offset:25600
v_mul_f32 v211, s91, v211
v_mfma_f32_16x16x32_bf16 v[148:151], a[64:67], a[96:99], 0
s_add_u32 m0, s73, 38912
s_add_u32 s64, s72, 18432
v_mul_f32 v212, s91, v212
v_mfma_f32_16x16x32_bf16 v[148:151], a[68:71], a[100:103], v[148:151]
ds_read_b128 a[124:127], v4 offset:27648
v_mul_f32 v213, s91, v213
v_mfma_f32_16x16x32_bf16 v[48:51], a[76:79], a[100:103], 0
buffer_load_dwordx4 v5, s[12:15], s64 offen lds
v_mfma_f32_16x16x32_bf16 v[48:51], a[72:75], a[96:99], v[48:51]
s_waitcnt lgkmcnt(15)
v_mul_f32 v214, s91, v214
v_mul_f32 v215, s91, v215
v_mfma_f32_16x16x32_bf16 v[156:159], a[72:75], a[104:107], 0
v_cvt_pk_bf16_f32 v208, v208, v209
v_cvt_pk_bf16_f32 v209, v210, v211
v_mfma_f32_16x16x32_bf16 v[156:159], a[76:79], a[108:111], v[156:159]
s_add_u32 s53, s88, 262144
v_cvt_pk_bf16_f32 v210, v212, v213
v_cvt_pk_bf16_f32 v211, v214, v215
v_mfma_f32_16x16x32_bf16 v[164:167], a[68:71], a[108:111], 0
buffer_store_dwordx4 v[72:75], v15, s[24:27], s53 offen offset:1024 sc1
v_mfma_f32_16x16x32_bf16 v[164:167], a[64:67], a[104:107], v[164:167]
v_mul_f32 v216, s91, v216
v_mul_f32 v217, s91, v217
v_mfma_f32_16x16x32_bf16 v[172:175], a[152:155], a[104:107], 0
buffer_load_dwordx4 v6, s[12:15], s64 offen offset:1024 lds
v_mfma_f32_16x16x32_bf16 v[172:175], a[156:159], a[108:111], v[172:175]
v_mul_f32 v218, s91, v218
v_mul_f32 v219, s91, v219
v_mfma_f32_16x16x32_bf16 v[56:59], a[148:151], a[108:111], 0
v_mul_f32 v220, s91, v220
v_mul_f32 v221, s91, v221
v_mfma_f32_16x16x32_bf16 v[56:59], a[144:147], a[104:107], v[56:59]
v_mul_f32 v222, s91, v222
v_mul_f32 v223, s91, v223
v_mfma_f32_16x16x32_bf16 v[180:183], a[136:139], a[104:107], 0
v_cvt_pk_bf16_f32 v216, v216, v217
v_cvt_pk_bf16_f32 v217, v218, v219
v_mfma_f32_16x16x32_bf16 v[180:183], a[140:143], a[108:111], v[180:183]
v_cvt_pk_bf16_f32 v218, v220, v221
v_cvt_pk_bf16_f32 v219, v222, v223
v_mfma_f32_16x16x32_bf16 v[188:191], a[132:135], a[108:111], 0
v_mul_f32 v224, s91, v224
v_mul_f32 v225, s91, v225
v_mfma_f32_16x16x32_bf16 v[188:191], a[128:131], a[104:107], v[188:191]
s_waitcnt lgkmcnt(0)
v_mul_f32 v226, s91, v226
v_mul_f32 v227, s91, v227
v_mfma_f32_16x16x32_bf16 v[196:199], a[160:163], a[80:83], 0
s_waitcnt vmcnt(19)
v_mul_f32 v228, s91, v228
v_mul_f32 v229, s91, v229
v_mfma_f32_16x16x32_bf16 v[196:199], a[164:167], a[84:87], v[196:199]
s_barrier
v_mfma_f32_16x16x32_bf16 v[64:67], a[172:175], a[84:87], 0
ds_read_b64_tr_b16 a[128:129], v11 offset:32768
ds_read_b64_tr_b16 a[130:131], v11 offset:33280
v_mfma_f32_16x16x32_bf16 v[64:67], a[168:171], a[80:83], v[64:67]
s_add_u32 m0, s77, 16384
s_add_u32 s64, s76, 128
v_mul_f32 v230, s91, v230
v_mfma_f32_16x16x32_bf16 v[204:207], a[176:179], a[80:83], 0
buffer_load_dwordx4 v7, s[20:23], s64 offen lds
v_mfma_f32_16x16x32_bf16 v[204:207], a[180:183], a[84:87], v[204:207]
ds_read_b64_tr_b16 a[132:133], v11 offset:36864
ds_read_b64_tr_b16 a[134:135], v11 offset:37376
v_mfma_f32_16x16x32_bf16 v[212:215], a[188:191], a[84:87], 0
ds_read_b64_tr_b16 a[136:137], v12 offset:32768
ds_read_b64_tr_b16 a[138:139], v12 offset:33280
v_mfma_f32_16x16x32_bf16 v[212:215], a[184:187], a[80:83], v[212:215]
ds_read_b64_tr_b16 a[140:141], v12 offset:36864
ds_read_b64_tr_b16 a[142:143], v12 offset:37376
v_mfma_f32_16x16x32_bf16 v[72:75], a[112:115], a[80:83], 0
v_mul_f32 v231, s91, v231
v_cvt_pk_bf16_f32 v224, v224, v225
v_mfma_f32_16x16x32_bf16 v[72:75], a[116:119], a[84:87], v[72:75]
ds_read_b64_tr_b16 a[144:145], v13 offset:32768
ds_read_b64_tr_b16 a[146:147], v13 offset:33280
v_mfma_f32_16x16x32_bf16 v[220:223], a[124:127], a[84:87], 0
buffer_load_dwordx4 v8, s[20:23], s64 offen offset:1024 lds
v_mfma_f32_16x16x32_bf16 v[220:223], a[120:123], a[80:83], v[220:223]
ds_read_b64_tr_b16 a[148:149], v13 offset:36864
ds_read_b64_tr_b16 a[150:151], v13 offset:37376
v_mfma_f32_16x16x32_bf16 a[32:35], a[120:123], a[88:91], 0
v_cvt_pk_bf16_f32 v225, v226, v227
v_cvt_pk_bf16_f32 v226, v228, v229
v_mfma_f32_16x16x32_bf16 a[32:35], a[124:127], a[92:95], a[32:35]
ds_read_b64_tr_b16 a[152:153], v14 offset:32768
ds_read_b64_tr_b16 a[154:155], v14 offset:33280
v_mfma_f32_16x16x32_bf16 a[36:39], a[116:119], a[92:95], 0
s_add_u32 m0, s80, 16384
s_add_u32 s64, s79, 2048
v_cvt_pk_bf16_f32 v227, v230, v231
v_mfma_f32_16x16x32_bf16 a[36:39], a[112:115], a[88:91], a[36:39]
ds_read_b64_tr_b16 a[156:157], v14 offset:36864
ds_read_b64_tr_b16 a[158:159], v14 offset:37376
v_mfma_f32_16x16x32_bf16 v[228:231], a[184:187], a[88:91], 0
buffer_load_dwordx4 v15, s[24:27], s64 offen sc1 lds
v_mfma_f32_16x16x32_bf16 v[228:231], a[188:191], a[92:95], v[228:231]
s_xor_b32 s65, s70, 256
s_add_u32 s71, s68, s65
s_add_u32 s72, s69, s65
v_mfma_f32_16x16x32_bf16 a[40:43], a[180:183], a[92:95], 0
s_add_u32 s53, s88, 262144
ds_read_b128 a[64:67], v4 offset:40960
v_mul_f32 v232, s91, v232
v_mfma_f32_16x16x32_bf16 a[40:43], a[176:179], a[88:91], a[40:43]
buffer_store_dwordx4 v[80:83], v15, s[24:27], s53 offen offset:2048 sc1
v_mfma_f32_16x16x32_bf16 a[44:47], a[168:171], a[88:91], 0
s_add_u32 m0, s73, 65536
s_add_u32 s64, s71, 0
ds_read_b128 a[80:83], v9 offset:0
v_mfma_f32_16x16x32_bf16 a[44:47], a[172:175], a[92:95], a[44:47]
L_PAD4:
s_cbranch_execz L_PAD8
v_mul_f32 v233, s91, v233
v_mul_f32 v234, s91, v234
v_mfma_f32_16x16x32_bf16 v[80:83], a[164:167], a[92:95], 0
buffer_load_dwordx4 v5, s[12:15], s64 offen lds
v_mfma_f32_16x16x32_bf16 v[80:83], a[160:163], a[88:91], v[80:83]
ds_read_b128 a[68:71], v4 offset:43008
v_mul_f32 v235, s91, v235
v_mfma_f32_16x16x32_bf16 a[48:51], a[160:163], a[96:99], 0
ds_read_b128 a[84:87], v10 offset:0
v_mul_f32 v236, s91, v236
v_mfma_f32_16x16x32_bf16 a[48:51], a[164:167], a[100:103], a[48:51]
v_mul_f32 v237, s91, v237
v_mul_f32 v238, s91, v238
v_mfma_f32_16x16x32_bf16 a[52:55], a[172:175], a[100:103], 0
v_mul_f32 v239, s91, v239
v_cvt_pk_bf16_f32 v232, v232, v233
v_mfma_f32_16x16x32_bf16 a[52:55], a[168:171], a[96:99], a[52:55]
ds_read_b128 a[72:75], v4 offset:41984
v_cvt_pk_bf16_f32 v233, v234, v235
v_mfma_f32_16x16x32_bf16 a[56:59], a[176:179], a[96:99], 0
buffer_load_dwordx4 v6, s[12:15], s64 offen offset:1024 lds
v_mfma_f32_16x16x32_bf16 a[56:59], a[180:183], a[100:103], a[56:59]
ds_read_b128 a[88:91], v9 offset:2048
v_cvt_pk_bf16_f32 v234, v236, v237
v_mfma_f32_16x16x32_bf16 a[60:63], a[188:191], a[100:103], 0
v_cvt_pk_bf16_f32 v235, v238, v239
v_mul_f32 v240, s91, v240
v_mfma_f32_16x16x32_bf16 a[60:63], a[184:187], a[96:99], a[60:63]
ds_read_b128 a[76:79], v4 offset:44032
v_mul_f32 v241, s91, v241
v_mfma_f32_16x16x32_bf16 v[236:239], a[112:115], a[96:99], 0
s_add_u32 m0, s73, 67584
s_add_u32 s64, s71, 18432
v_mul_f32 v242, s91, v242
v_mfma_f32_16x16x32_bf16 v[236:239], a[116:119], a[100:103], v[236:239]
ds_read_b128 a[92:95], v10 offset:2048
v_mul_f32 v243, s91, v243
v_mfma_f32_16x16x32_bf16 a[192:195], a[124:127], a[100:103], 0
buffer_load_dwordx4 v5, s[12:15], s64 offen lds
v_mfma_f32_16x16x32_bf16 a[192:195], a[120:123], a[96:99], a[192:195]
v_mul_f32 v244, s91, v244
v_mul_f32 v245, s91, v245
v_mfma_f32_16x16x32_bf16 a[196:199], a[120:123], a[104:107], 0
v_mul_f32 v246, s91, v246
v_mul_f32 v247, s91, v247
v_mfma_f32_16x16x32_bf16 a[196:199], a[124:127], a[108:111], a[196:199]
v_cvt_pk_bf16_f32 v240, v240, v241
v_cvt_pk_bf16_f32 v241, v242, v243
v_mfma_f32_16x16x32_bf16 a[200:203], a[116:119], a[108:111], 0
v_cvt_pk_bf16_f32 v242, v244, v245
v_cvt_pk_bf16_f32 v243, v246, v247
v_mfma_f32_16x16x32_bf16 a[200:203], a[112:115], a[104:107], a[200:203]
v_mul_f32 v248, s91, v248
v_mul_f32 v249, s91, v249
v_mfma_f32_16x16x32_bf16 v[244:247], a[184:187], a[104:107], 0
buffer_load_dwordx4 v6, s[12:15], s64 offen offset:1024 lds
v_mfma_f32_16x16x32_bf16 v[244:247], a[188:191], a[108:111], v[244:247]
v_mul_f32 v250, s91, v250
v_mul_f32 v251, s91, v251
v_mfma_f32_16x16x32_bf16 a[204:207], a[180:183], a[108:111], 0
v_mul_f32 v252, s91, v252
v_mul_f32 v253, s91, v253
v_mfma_f32_16x16x32_bf16 a[204:207], a[176:179], a[104:107], a[204:207]
s_add_u32 s53, s88, 262144
v_mul_f32 v254, s91, v254
v_mul_f32 v255, s91, v255
v_mfma_f32_16x16x32_bf16 a[208:211], a[168:171], a[104:107], 0
buffer_store_dwordx4 v[88:91], v15, s[24:27], s53 offen offset:3072 sc1
v_mfma_f32_16x16x32_bf16 a[208:211], a[172:175], a[108:111], a[208:211]
v_cvt_pk_bf16_f32 v248, v248, v249
v_cvt_pk_bf16_f32 v249, v250, v251
v_mfma_f32_16x16x32_bf16 v[88:91], a[164:167], a[108:111], 0
v_cvt_pk_bf16_f32 v250, v252, v253
v_cvt_pk_bf16_f32 v251, v254, v255
v_mfma_f32_16x16x32_bf16 v[88:91], a[160:163], a[104:107], v[88:91]
s_waitcnt lgkmcnt(0)
v_accvgpr_read_b32 v16, a0
v_accvgpr_read_b32 v17, a1
v_mfma_f32_16x16x32_bf16 v[36:39], a[128:131], a[80:83], v[36:39]
s_waitcnt vmcnt(24)
v_accvgpr_read_b32 v18, a2
v_accvgpr_read_b32 v19, a3
v_mfma_f32_16x16x32_bf16 v[36:39], a[132:135], a[84:87], v[36:39]
s_barrier
v_mfma_f32_16x16x32_bf16 v[44:47], a[140:143], a[84:87], v[44:47]
ds_read_b128 a[96:99], v9 offset:4096
v_accvgpr_read_b32 v20, a4
v_mfma_f32_16x16x32_bf16 v[44:47], a[136:139], a[80:83], v[44:47]
s_xor_b32 s75, s93, 2
s_lshl_b32 s76, s75, 19
s_add_u32 s76, s76, s74
v_mfma_f32_16x16x32_bf16 v[32:35], a[144:147], a[80:83], v[32:35]
s_lshl_b32 s79, s75, 13
s_add_u32 s79, s79, s78
ds_read_b128 a[100:103], v10 offset:4096
v_mfma_f32_16x16x32_bf16 v[32:35], a[148:151], a[84:87], v[32:35]
s_add_u32 m0, s77, 32768
s_add_u32 s64, s76, 0
ds_read_b128 a[104:107], v9 offset:6144
v_mfma_f32_16x16x32_bf16 v[52:55], a[156:159], a[84:87], v[52:55]
buffer_load_dwordx4 v7, s[20:23], s64 offen lds
v_mfma_f32_16x16x32_bf16 v[52:55], a[152:155], a[80:83], v[52:55]
ds_read_b64_tr_b16 a[160:161], v11 offset:49152
ds_read_b64_tr_b16 a[162:163], v11 offset:49664
v_mfma_f32_16x16x32_bf16 v[60:63], a[64:67], a[80:83], v[60:63]
v_accvgpr_read_b32 v21, a5
v_accvgpr_read_b32 v22, a6
v_mfma_f32_16x16x32_bf16 v[60:63], a[68:71], a[84:87], v[60:63]
ds_read_b128 a[108:111], v10 offset:6144
v_accvgpr_read_b32 v23, a7
v_mfma_f32_16x16x32_bf16 v[68:71], a[76:79], a[84:87], v[68:71]
buffer_load_dwordx4 v8, s[20:23], s64 offen offset:1024 lds
v_mfma_f32_16x16x32_bf16 v[68:71], a[72:75], a[80:83], v[68:71]
ds_read_b64_tr_b16 a[164:165], v11 offset:53248
ds_read_b64_tr_b16 a[166:167], v11 offset:53760
v_mfma_f32_16x16x32_bf16 v[76:79], a[72:75], a[88:91], v[76:79]
v_add_u32 v9, 32768, v9
v_add_u32 v10, 32768, v10
v_mfma_f32_16x16x32_bf16 v[76:79], a[76:79], a[92:95], v[76:79]
ds_read_b64_tr_b16 a[168:169], v12 offset:49152
ds_read_b64_tr_b16 a[170:171], v12 offset:49664
v_mfma_f32_16x16x32_bf16 v[84:87], a[68:71], a[92:95], v[84:87]
s_add_u32 m0, s80, 32768
s_add_u32 s64, s79, 0
v_mul_f32 v16, s91, v16
v_mfma_f32_16x16x32_bf16 v[84:87], a[64:67], a[88:91], v[84:87]
ds_read_b64_tr_b16 a[172:173], v12 offset:53248
ds_read_b64_tr_b16 a[174:175], v12 offset:53760
v_mfma_f32_16x16x32_bf16 v[92:95], a[152:155], a[88:91], v[92:95]
buffer_load_dwordx4 v15, s[24:27], s64 offen sc1 lds
v_mfma_f32_16x16x32_bf16 v[92:95], a[156:159], a[92:95], v[92:95]
v_mul_f32 v17, s91, v17
v_mul_f32 v18, s91, v18
v_mfma_f32_16x16x32_bf16 v[40:43], a[148:151], a[92:95], v[40:43]
ds_read_b64_tr_b16 a[176:177], v13 offset:49152
ds_read_b64_tr_b16 a[178:179], v13 offset:49664
v_mfma_f32_16x16x32_bf16 v[40:43], a[144:147], a[88:91], v[40:43]
v_mul_f32 v19, s91, v19
v_mul_f32 v20, s91, v20
v_mfma_f32_16x16x32_bf16 v[100:103], a[136:139], a[88:91], v[100:103]
s_add_u32 m0, s73, 69632
s_add_u32 s64, s72, 0
v_mul_f32 v21, s91, v21
v_mfma_f32_16x16x32_bf16 v[100:103], a[140:143], a[92:95], v[100:103]
ds_read_b64_tr_b16 a[180:181], v13 offset:53248
ds_read_b64_tr_b16 a[182:183], v13 offset:53760
v_mfma_f32_16x16x32_bf16 v[108:111], a[132:135], a[92:95], v[108:111]
buffer_load_dwordx4 v5, s[12:15], s64 offen lds
v_mfma_f32_16x16x32_bf16 v[108:111], a[128:131], a[88:91], v[108:111]
s_waitcnt lgkmcnt(14)
ds_read_b64_tr_b16 a[184:185], v14 offset:49152
ds_read_b64_tr_b16 a[186:187], v14 offset:49664
v_mfma_f32_16x16x32_bf16 v[116:119], a[128:131], a[96:99], v[116:119]
s_add_u32 s53, s87, 0
ds_read_b64_tr_b16 a[188:189], v14 offset:53248
ds_read_b64_tr_b16 a[190:191], v14 offset:53760
v_mfma_f32_16x16x32_bf16 v[116:119], a[132:135], a[100:103], v[116:119]
buffer_store_dwordx4 v[160:163], v15, s[24:27], s53 offen offset:0 sc1
v_mfma_f32_16x16x32_bf16 v[124:127], a[140:143], a[100:103], v[124:127]
v_mul_f32 v22, s91, v22
v_mul_f32 v23, s91, v23
v_mfma_f32_16x16x32_bf16 v[124:127], a[136:139], a[96:99], v[124:127]
ds_read_b128 a[112:115], v4 offset:57344
v_cvt_pk_bf16_f32 v16, v16, v17
v_mfma_f32_16x16x32_bf16 v[132:135], a[144:147], a[96:99], v[132:135]
buffer_load_dwordx4 v6, s[12:15], s64 offen offset:1024 lds
v_mfma_f32_16x16x32_bf16 v[132:135], a[148:151], a[100:103], v[132:135]
ds_read_b128 a[116:119], v4 offset:59392
v_cvt_pk_bf16_f32 v17, v18, v19
v_mfma_f32_16x16x32_bf16 v[140:143], a[156:159], a[100:103], v[140:143]
v_cvt_pk_bf16_f32 v18, v20, v21
v_cvt_pk_bf16_f32 v19, v22, v23
v_mfma_f32_16x16x32_bf16 v[140:143], a[152:155], a[96:99], v[140:143]
ds_read_b128 a[120:123], v4 offset:58368
v_accvgpr_write_b32 a0, v16
v_mfma_f32_16x16x32_bf16 v[148:151], a[64:67], a[96:99], v[148:151]
s_add_u32 m0, s73, 71680
s_add_u32 s64, s72, 18432
v_accvgpr_write_b32 a1, v17
v_mfma_f32_16x16x32_bf16 v[148:151], a[68:71], a[100:103], v[148:151]
ds_read_b128 a[124:127], v4 offset:60416
v_accvgpr_write_b32 a2, v18
v_mfma_f32_16x16x32_bf16 v[48:51], a[76:79], a[100:103], v[48:51]
buffer_load_dwordx4 v5, s[12:15], s64 offen lds
v_mfma_f32_16x16x32_bf16 v[48:51], a[72:75], a[96:99], v[48:51]
s_waitcnt lgkmcnt(15)
v_accvgpr_write_b32 a3, v19
v_accvgpr_read_b32 v16, a8
v_mfma_f32_16x16x32_bf16 v[156:159], a[72:75], a[104:107], v[156:159]
v_accvgpr_read_b32 v17, a9
v_accvgpr_read_b32 v18, a10
v_mfma_f32_16x16x32_bf16 v[156:159], a[76:79], a[108:111], v[156:159]
v_accvgpr_read_b32 v19, a11
v_accvgpr_read_b32 v20, a12
v_mfma_f32_16x16x32_bf16 v[164:167], a[68:71], a[108:111], v[164:167]
v_accvgpr_read_b32 v21, a13
v_accvgpr_read_b32 v22, a14
v_mfma_f32_16x16x32_bf16 v[164:167], a[64:67], a[104:107], v[164:167]
v_accvgpr_read_b32 v23, a15
v_mul_f32 v16, s91, v16
v_mfma_f32_16x16x32_bf16 v[172:175], a[152:155], a[104:107], v[172:175]
buffer_load_dwordx4 v6, s[12:15], s64 offen offset:1024 lds
v_mfma_f32_16x16x32_bf16 v[172:175], a[156:159], a[108:111], v[172:175]
v_mul_f32 v17, s91, v17
v_mul_f32 v18, s91, v18
v_mfma_f32_16x16x32_bf16 v[56:59], a[148:151], a[108:111], v[56:59]
v_mul_f32 v19, s91, v19
v_mul_f32 v20, s91, v20
v_mfma_f32_16x16x32_bf16 v[56:59], a[144:147], a[104:107], v[56:59]
v_mul_f32 v21, s91, v21
v_mul_f32 v22, s91, v22
v_mfma_f32_16x16x32_bf16 v[180:183], a[136:139], a[104:107], v[180:183]
v_mul_f32 v23, s91, v23
v_cvt_pk_bf16_f32 v16, v16, v17
v_mfma_f32_16x16x32_bf16 v[180:183], a[140:143], a[108:111], v[180:183]
v_cvt_pk_bf16_f32 v17, v18, v19
v_cvt_pk_bf16_f32 v18, v20, v21
v_mfma_f32_16x16x32_bf16 v[188:191], a[132:135], a[108:111], v[188:191]
v_cvt_pk_bf16_f32 v19, v22, v23
v_accvgpr_write_b32 a8, v16
v_mfma_f32_16x16x32_bf16 v[188:191], a[128:131], a[104:107], v[188:191]
s_waitcnt lgkmcnt(0)
v_accvgpr_write_b32 a9, v17
v_accvgpr_write_b32 a10, v18
v_mfma_f32_16x16x32_bf16 v[196:199], a[160:163], a[80:83], v[196:199]
s_waitcnt vmcnt(17)
v_accvgpr_write_b32 a11, v19
v_accvgpr_read_b32 v16, a16
v_mfma_f32_16x16x32_bf16 v[196:199], a[164:167], a[84:87], v[196:199]
s_barrier
v_mfma_f32_16x16x32_bf16 v[64:67], a[172:175], a[84:87], v[64:67]
s_add_u32 s53, s87, 0
ds_read_b64_tr_b16 a[128:129], v11 offset:0
ds_read_b64_tr_b16 a[130:131], v11 offset:512
v_mfma_f32_16x16x32_bf16 v[64:67], a[168:171], a[80:83], v[64:67]
s_add_u32 m0, s77, 49152
s_add_u32 s64, s76, 128
v_accvgpr_read_b32 v17, a17
v_mfma_f32_16x16x32_bf16 v[204:207], a[176:179], a[80:83], v[204:207]
buffer_load_dwordx4 v7, s[20:23], s64 offen lds
v_mfma_f32_16x16x32_bf16 v[204:207], a[180:183], a[84:87], v[204:207]
ds_read_b64_tr_b16 a[132:133], v11 offset:4096
ds_read_b64_tr_b16 a[134:135], v11 offset:4608
v_mfma_f32_16x16x32_bf16 v[212:215], a[188:191], a[84:87], v[212:215]
ds_read_b64_tr_b16 a[136:137], v12 offset:0
ds_read_b64_tr_b16 a[138:139], v12 offset:512
v_mfma_f32_16x16x32_bf16 v[212:215], a[184:187], a[80:83], v[212:215]
ds_read_b64_tr_b16 a[140:141], v12 offset:4096
ds_read_b64_tr_b16 a[142:143], v12 offset:4608
v_mfma_f32_16x16x32_bf16 v[72:75], a[112:115], a[80:83], v[72:75]
buffer_store_dwordx4 v[168:171], v15, s[24:27], s53 offen offset:1024 sc1
v_mfma_f32_16x16x32_bf16 v[72:75], a[116:119], a[84:87], v[72:75]
ds_read_b64_tr_b16 a[144:145], v13 offset:0
ds_read_b64_tr_b16 a[146:147], v13 offset:512
v_mfma_f32_16x16x32_bf16 v[220:223], a[124:127], a[84:87], v[220:223]
buffer_load_dwordx4 v8, s[20:23], s64 offen offset:1024 lds
v_mfma_f32_16x16x32_bf16 v[220:223], a[120:123], a[80:83], v[220:223]
ds_read_b64_tr_b16 a[148:149], v13 offset:4096
ds_read_b64_tr_b16 a[150:151], v13 offset:4608
v_mfma_f32_16x16x32_bf16 a[32:35], a[120:123], a[88:91], a[32:35]
v_accvgpr_read_b32 v18, a18
v_accvgpr_read_b32 v19, a19
v_mfma_f32_16x16x32_bf16 a[32:35], a[124:127], a[92:95], a[32:35]
ds_read_b64_tr_b16 a[152:153], v14 offset:0
ds_read_b64_tr_b16 a[154:155], v14 offset:512
v_mfma_f32_16x16x32_bf16 a[36:39], a[116:119], a[92:95], a[36:39]
s_add_u32 m0, s80, 49152
s_add_u32 s64, s79, 2048
v_accvgpr_read_b32 v20, a20
v_mfma_f32_16x16x32_bf16 a[36:39], a[112:115], a[88:91], a[36:39]
ds_read_b64_tr_b16 a[156:157], v14 offset:4096
ds_read_b64_tr_b16 a[158:159], v14 offset:4608
v_mfma_f32_16x16x32_bf16 v[228:231], a[184:187], a[88:91], v[228:231]
buffer_load_dwordx4 v15, s[24:27], s64 offen sc1 lds
v_mfma_f32_16x16x32_bf16 v[228:231], a[188:191], a[92:95], v[228:231]
s_xor_b32 s65, s70, 384
s_add_u32 s71, s68, s65
s_add_u32 s72, s69, s65
v_mfma_f32_16x16x32_bf16 a[40:43], a[180:183], a[92:95], a[40:43]
ds_read_b128 a[64:67], v4 offset:8192
v_accvgpr_read_b32 v21, a21
v_mfma_f32_16x16x32_bf16 a[40:43], a[176:179], a[88:91], a[40:43]
v_accvgpr_read_b32 v22, a22
v_accvgpr_read_b32 v23, a23
v_mfma_f32_16x16x32_bf16 a[44:47], a[168:171], a[88:91], a[44:47]
s_add_u32 m0, s73, 0
s_add_u32 s64, s71, 0
ds_read_b128 a[80:83], v9 offset:0
v_mfma_f32_16x16x32_bf16 a[44:47], a[172:175], a[92:95], a[44:47]
v_mul_f32 v16, s91, v16
v_mul_f32 v17, s91, v17
v_mfma_f32_16x16x32_bf16 v[80:83], a[164:167], a[92:95], v[80:83]
buffer_load_dwordx4 v5, s[12:15], s64 offen lds
v_mfma_f32_16x16x32_bf16 v[80:83], a[160:163], a[88:91], v[80:83]
ds_read_b128 a[68:71], v4 offset:10240
v_mul_f32 v18, s91, v18
v_mfma_f32_16x16x32_bf16 a[48:51], a[160:163], a[96:99], a[48:51]
ds_read_b128 a[84:87], v10 offset:0
v_mul_f32 v19, s91, v19
v_mfma_f32_16x16x32_bf16 a[48:51], a[164:167], a[100:103], a[48:51]
v_mul_f32 v20, s91, v20
v_mul_f32 v21, s91, v21
v_mfma_f32_16x16x32_bf16 a[52:55], a[172:175], a[100:103], a[52:55]
v_mul_f32 v22, s91, v22
v_mul_f32 v23, s91, v23
v_mfma_f32_16x16x32_bf16 a[52:55], a[168:171], a[96:99], a[52:55]
ds_read_b128 a[72:75], v4 offset:9216
v_cvt_pk_bf16_f32 v16, v16, v17
v_mfma_f32_16x16x32_bf16 a[56:59], a[176:179], a[96:99], a[56:59]
buffer_load_dwordx4 v6, s[12:15], s64 offen offset:1024 lds
v_mfma_f32_16x16x32_bf16 a[56:59], a[180:183], a[100:103], a[56:59]
s_add_u32 s53, s87, 4096
ds_read_b128 a[88:91], v9 offset:2048
v_cvt_pk_bf16_f32 v17, v18, v19
v_mfma_f32_16x16x32_bf16 a[60:63], a[188:191], a[100:103], a[60:63]
buffer_store_dwordx4 v[176:179], v15, s[24:27], s53 offen offset:0 sc1
v_mfma_f32_16x16x32_bf16 a[60:63], a[184:187], a[96:99], a[60:63]
ds_read_b128 a[76:79], v4 offset:11264
v_cvt_pk_bf16_f32 v18, v20, v21
v_mfma_f32_16x16x32_bf16 v[236:239], a[112:115], a[96:99], v[236:239]
s_add_u32 m0, s73, 2048
s_add_u32 s64, s71, 18432
v_cvt_pk_bf16_f32 v19, v22, v23
v_mfma_f32_16x16x32_bf16 v[236:239], a[116:119], a[100:103], v[236:239]
ds_read_b128 a[92:95], v10 offset:2048
v_accvgpr_write_b32 a16, v16
v_mfma_f32_16x16x32_bf16 a[192:195], a[124:127], a[100:103], a[192:195]
buffer_load_dwordx4 v5, s[12:15], s64 offen lds
v_mfma_f32_16x16x32_bf16 a[192:195], a[120:123], a[96:99], a[192:195]
v_accvgpr_write_b32 a17, v17
v_accvgpr_write_b32 a18, v18
v_mfma_f32_16x16x32_bf16 a[196:199], a[120:123], a[104:107], a[196:199]
v_accvgpr_write_b32 a19, v19
v_accvgpr_read_b32 v16, a24
v_mfma_f32_16x16x32_bf16 a[196:199], a[124:127], a[108:111], a[196:199]
v_accvgpr_read_b32 v17, a25
v_accvgpr_read_b32 v18, a26
v_mfma_f32_16x16x32_bf16 a[200:203], a[116:119], a[108:111], a[200:203]
v_accvgpr_read_b32 v19, a27
v_accvgpr_read_b32 v20, a28
v_mfma_f32_16x16x32_bf16 a[200:203], a[112:115], a[104:107], a[200:203]
v_accvgpr_read_b32 v21, a29
v_accvgpr_read_b32 v22, a30
v_mfma_f32_16x16x32_bf16 v[244:247], a[184:187], a[104:107], v[244:247]
buffer_load_dwordx4 v6, s[12:15], s64 offen offset:1024 lds
v_mfma_f32_16x16x32_bf16 v[244:247], a[188:191], a[108:111], v[244:247]
v_accvgpr_read_b32 v23, a31
v_mul_f32 v16, s91, v16
v_mfma_f32_16x16x32_bf16 a[204:207], a[180:183], a[108:111], a[204:207]
v_mul_f32 v17, s91, v17
v_mul_f32 v18, s91, v18
v_mfma_f32_16x16x32_bf16 a[204:207], a[176:179], a[104:107], a[204:207]
v_mul_f32 v19, s91, v19
v_mul_f32 v20, s91, v20
v_mfma_f32_16x16x32_bf16 a[208:211], a[168:171], a[104:107], a[208:211]
v_mul_f32 v21, s91, v21
v_mul_f32 v22, s91, v22
v_mfma_f32_16x16x32_bf16 a[208:211], a[172:175], a[108:111], a[208:211]
v_mul_f32 v23, s91, v23
v_cvt_pk_bf16_f32 v16, v16, v17
v_mfma_f32_16x16x32_bf16 v[88:91], a[164:167], a[108:111], v[88:91]
v_cvt_pk_bf16_f32 v17, v18, v19
v_cvt_pk_bf16_f32 v18, v20, v21
v_mfma_f32_16x16x32_bf16 v[88:91], a[160:163], a[104:107], v[88:91]
s_waitcnt lgkmcnt(0)
v_cvt_pk_bf16_f32 v19, v22, v23
v_accvgpr_write_b32 a24, v16
v_mfma_f32_16x16x32_bf16 v[36:39], a[128:131], a[80:83], v[36:39]
s_waitcnt vmcnt(23)
v_accvgpr_write_b32 a25, v17
v_accvgpr_write_b32 a26, v18
v_mfma_f32_16x16x32_bf16 v[36:39], a[132:135], a[84:87], v[36:39]
s_barrier
v_mfma_f32_16x16x32_bf16 v[44:47], a[140:143], a[84:87], v[44:47]
ds_read_b128 a[96:99], v9 offset:4096
v_accvgpr_write_b32 a27, v19
v_mfma_f32_16x16x32_bf16 v[44:47], a[136:139], a[80:83], v[44:47]
s_xor_b32 s75, s93, 3
s_lshl_b32 s76, s75, 19
s_add_u32 s76, s76, s74
v_mfma_f32_16x16x32_bf16 v[32:35], a[144:147], a[80:83], v[32:35]
s_lshl_b32 s79, s75, 13
s_add_u32 s79, s79, s78
ds_read_b128 a[100:103], v10 offset:4096
v_mfma_f32_16x16x32_bf16 v[32:35], a[148:151], a[84:87], v[32:35]
s_add_u32 m0, s77, 0
s_add_u32 s64, s76, 0
ds_read_b128 a[104:107], v9 offset:6144
v_mfma_f32_16x16x32_bf16 v[52:55], a[156:159], a[84:87], v[52:55]
buffer_load_dwordx4 v7, s[20:23], s64 offen lds
v_mfma_f32_16x16x32_bf16 v[52:55], a[152:155], a[80:83], v[52:55]
s_add_u32 s53, s87, 4096
ds_read_b64_tr_b16 a[160:161], v11 offset:16384
ds_read_b64_tr_b16 a[162:163], v11 offset:16896
v_mfma_f32_16x16x32_bf16 v[60:63], a[64:67], a[80:83], v[60:63]
buffer_store_dwordx4 v[184:187], v15, s[24:27], s53 offen offset:1024 sc1
v_mfma_f32_16x16x32_bf16 v[60:63], a[68:71], a[84:87], v[60:63]
ds_read_b128 a[108:111], v10 offset:6144
v_accvgpr_write_b32 a4, v248
v_mfma_f32_16x16x32_bf16 v[68:71], a[76:79], a[84:87], v[68:71]
buffer_load_dwordx4 v8, s[20:23], s64 offen offset:1024 lds
v_mfma_f32_16x16x32_bf16 v[68:71], a[72:75], a[80:83], v[68:71]
ds_read_b64_tr_b16 a[164:165], v11 offset:20480
ds_read_b64_tr_b16 a[166:167], v11 offset:20992
v_mfma_f32_16x16x32_bf16 v[76:79], a[72:75], a[88:91], v[76:79]
v_add_u32 v9, 32768, v9
v_add_u32 v10, 32768, v10
v_mfma_f32_16x16x32_bf16 v[76:79], a[76:79], a[92:95], v[76:79]
ds_read_b64_tr_b16 a[168:169], v12 offset:16384
ds_read_b64_tr_b16 a[170:171], v12 offset:16896
v_mfma_f32_16x16x32_bf16 v[84:87], a[68:71], a[92:95], v[84:87]
s_add_u32 m0, s80, 0
s_add_u32 s64, s79, 0
v_accvgpr_write_b32 a5, v249
v_mfma_f32_16x16x32_bf16 v[84:87], a[64:67], a[88:91], v[84:87]
ds_read_b64_tr_b16 a[172:173], v12 offset:20480
ds_read_b64_tr_b16 a[174:175], v12 offset:20992
v_mfma_f32_16x16x32_bf16 v[92:95], a[152:155], a[88:91], v[92:95]
buffer_load_dwordx4 v15, s[24:27], s64 offen sc1 lds
v_mfma_f32_16x16x32_bf16 v[92:95], a[156:159], a[92:95], v[92:95]
v_accvgpr_write_b32 a6, v250
v_accvgpr_write_b32 a7, v251
v_mfma_f32_16x16x32_bf16 v[40:43], a[148:151], a[92:95], v[40:43]
ds_read_b64_tr_b16 a[176:177], v13 offset:16384
ds_read_b64_tr_b16 a[178:179], v13 offset:16896
v_mfma_f32_16x16x32_bf16 v[40:43], a[144:147], a[88:91], v[40:43]
v_accvgpr_write_b32 a12, v240
v_accvgpr_write_b32 a13, v241
v_mfma_f32_16x16x32_bf16 v[100:103], a[136:139], a[88:91], v[100:103]
s_add_u32 m0, s73, 4096
s_add_u32 s64, s72, 0
v_accvgpr_write_b32 a14, v242
v_mfma_f32_16x16x32_bf16 v[100:103], a[140:143], a[92:95], v[100:103]
ds_read_b64_tr_b16 a[180:181], v13 offset:20480
ds_read_b64_tr_b16 a[182:183], v13 offset:20992
v_mfma_f32_16x16x32_bf16 v[108:111], a[132:135], a[92:95], v[108:111]
buffer_load_dwordx4 v5, s[12:15], s64 offen lds
v_mfma_f32_16x16x32_bf16 v[108:111], a[128:131], a[88:91], v[108:111]
s_waitcnt lgkmcnt(14)
ds_read_b64_tr_b16 a[184:185], v14 offset:16384
ds_read_b64_tr_b16 a[186:187], v14 offset:16896
v_mfma_f32_16x16x32_bf16 v[116:119], a[128:131], a[96:99], v[116:119]
ds_read_b64_tr_b16 a[188:189], v14 offset:20480
ds_read_b64_tr_b16 a[190:191], v14 offset:20992
v_mfma_f32_16x16x32_bf16 v[116:119], a[132:135], a[100:103], v[116:119]
v_accvgpr_write_b32 a15, v243
v_accvgpr_write_b32 a20, v232
v_mfma_f32_16x16x32_bf16 v[124:127], a[140:143], a[100:103], v[124:127]
v_accvgpr_write_b32 a21, v233
v_accvgpr_write_b32 a22, v234
v_mfma_f32_16x16x32_bf16 v[124:127], a[136:139], a[96:99], v[124:127]
ds_read_b128 a[112:115], v4 offset:24576
v_accvgpr_write_b32 a23, v235
v_mfma_f32_16x16x32_bf16 v[132:135], a[144:147], a[96:99], v[132:135]
buffer_load_dwordx4 v6, s[12:15], s64 offen offset:1024 lds
v_mfma_f32_16x16x32_bf16 v[132:135], a[148:151], a[100:103], v[132:135]
ds_read_b128 a[116:119], v4 offset:26624
v_accvgpr_write_b32 a28, v224
v_mfma_f32_16x16x32_bf16 v[140:143], a[156:159], a[100:103], v[140:143]
v_accvgpr_write_b32 a29, v225
v_accvgpr_write_b32 a30, v226
v_mfma_f32_16x16x32_bf16 v[140:143], a[152:155], a[96:99], v[140:143]
ds_read_b128 a[120:123], v4 offset:25600
v_accvgpr_write_b32 a31, v227
v_mfma_f32_16x16x32_bf16 v[148:151], a[64:67], a[96:99], v[148:151]
s_add_u32 m0, s73, 6144
s_add_u32 s64, s72, 18432
v_accvgpr_read_b32 v252, a32
v_mfma_f32_16x16x32_bf16 v[148:151], a[68:71], a[100:103], v[148:151]
ds_read_b128 a[124:127], v4 offset:27648
v_accvgpr_read_b32 v253, a33
v_mfma_f32_16x16x32_bf16 v[48:51], a[76:79], a[100:103], v[48:51]
buffer_load_dwordx4 v5, s[12:15], s64 offen lds
v_mfma_f32_16x16x32_bf16 v[48:51], a[72:75], a[96:99], v[48:51]
s_waitcnt lgkmcnt(15)
s_add_u32 s53, s87, 262144
v_accvgpr_read_b32 v254, a34
v_mfma_f32_16x16x32_bf16 v[156:159], a[72:75], a[104:107], v[156:159]
buffer_store_dwordx4 v[192:195], v15, s[24:27], s53 offen offset:0 sc1
v_mfma_f32_16x16x32_bf16 v[156:159], a[76:79], a[108:111], v[156:159]
v_accvgpr_read_b32 v255, a35
v_accvgpr_read_b32 v160, a36
v_mfma_f32_16x16x32_bf16 v[164:167], a[68:71], a[108:111], v[164:167]
v_accvgpr_read_b32 v161, a37
v_accvgpr_read_b32 v162, a38
v_mfma_f32_16x16x32_bf16 v[164:167], a[64:67], a[104:107], v[164:167]
v_accvgpr_read_b32 v163, a39
v_accvgpr_read_b32 v168, a40
v_mfma_f32_16x16x32_bf16 v[172:175], a[152:155], a[104:107], v[172:175]
buffer_load_dwordx4 v6, s[12:15], s64 offen offset:1024 lds
v_mfma_f32_16x16x32_bf16 v[172:175], a[156:159], a[108:111], v[172:175]
v_accvgpr_read_b32 v169, a41
v_accvgpr_read_b32 v170, a42
v_mfma_f32_16x16x32_bf16 v[56:59], a[148:151], a[108:111], v[56:59]
v_accvgpr_read_b32 v171, a43
v_accvgpr_read_b32 v176, a44
v_mfma_f32_16x16x32_bf16 v[56:59], a[144:147], a[104:107], v[56:59]
v_accvgpr_read_b32 v177, a45
v_accvgpr_read_b32 v178, a46
v_mfma_f32_16x16x32_bf16 v[180:183], a[136:139], a[104:107], v[180:183]
v_accvgpr_read_b32 v179, a47
v_accvgpr_read_b32 v184, a48
v_mfma_f32_16x16x32_bf16 v[180:183], a[140:143], a[108:111], v[180:183]
v_accvgpr_read_b32 v185, a49
v_accvgpr_read_b32 v186, a50
v_mfma_f32_16x16x32_bf16 v[188:191], a[132:135], a[108:111], v[188:191]
v_accvgpr_read_b32 v187, a51
v_accvgpr_read_b32 v248, a52
v_mfma_f32_16x16x32_bf16 v[188:191], a[128:131], a[104:107], v[188:191]
s_waitcnt lgkmcnt(0)
v_accvgpr_read_b32 v249, a53
v_accvgpr_read_b32 v250, a54
v_mfma_f32_16x16x32_bf16 v[196:199], a[160:163], a[80:83], v[196:199]
s_waitcnt vmcnt(18)
v_accvgpr_read_b32 v251, a55
v_accvgpr_read_b32 v240, a56
v_mfma_f32_16x16x32_bf16 v[196:199], a[164:167], a[84:87], v[196:199]
s_barrier
v_mfma_f32_16x16x32_bf16 v[64:67], a[172:175], a[84:87], v[64:67]
ds_read_b64_tr_b16 a[128:129], v11 offset:32768
ds_read_b64_tr_b16 a[130:131], v11 offset:33280
v_mfma_f32_16x16x32_bf16 v[64:67], a[168:171], a[80:83], v[64:67]
s_add_u32 m0, s77, 16384
s_add_u32 s64, s76, 128
v_accvgpr_read_b32 v241, a57
v_mfma_f32_16x16x32_bf16 v[204:207], a[176:179], a[80:83], v[204:207]
buffer_load_dwordx4 v7, s[20:23], s64 offen lds
v_mfma_f32_16x16x32_bf16 v[204:207], a[180:183], a[84:87], v[204:207]
ds_read_b64_tr_b16 a[132:133], v11 offset:36864
ds_read_b64_tr_b16 a[134:135], v11 offset:37376
v_mfma_f32_16x16x32_bf16 v[212:215], a[188:191], a[84:87], v[212:215]
ds_read_b64_tr_b16 a[136:137], v12 offset:32768
ds_read_b64_tr_b16 a[138:139], v12 offset:33280
v_mfma_f32_16x16x32_bf16 v[212:215], a[184:187], a[80:83], v[212:215]
ds_read_b64_tr_b16 a[140:141], v12 offset:36864
ds_read_b64_tr_b16 a[142:143], v12 offset:37376
v_mfma_f32_16x16x32_bf16 v[72:75], a[112:115], a[80:83], v[72:75]
v_accvgpr_read_b32 v242, a58
v_accvgpr_read_b32 v243, a59
v_mfma_f32_16x16x32_bf16 v[72:75], a[116:119], a[84:87], v[72:75]
ds_read_b64_tr_b16 a[144:145], v13 offset:32768
ds_read_b64_tr_b16 a[146:147], v13 offset:33280
v_mfma_f32_16x16x32_bf16 v[220:223], a[124:127], a[84:87], v[220:223]
buffer_load_dwordx4 v8, s[20:23], s64 offen offset:1024 lds
v_mfma_f32_16x16x32_bf16 v[220:223], a[120:123], a[80:83], v[220:223]
ds_read_b64_tr_b16 a[148:149], v13 offset:36864
ds_read_b64_tr_b16 a[150:151], v13 offset:37376
v_mfma_f32_16x16x32_bf16 v[252:255], a[120:123], a[88:91], v[252:255]
v_accvgpr_read_b32 v232, a60
v_accvgpr_read_b32 v233, a61
v_mfma_f32_16x16x32_bf16 v[252:255], a[124:127], a[92:95], v[252:255]
s_add_u32 s53, s87, 262144
ds_read_b64_tr_b16 a[152:153], v14 offset:32768
ds_read_b64_tr_b16 a[154:155], v14 offset:33280
v_mfma_f32_16x16x32_bf16 v[160:163], a[116:119], a[92:95], v[160:163]
s_add_u32 m0, s80, 16384
s_add_u32 s64, s79, 2048
v_accvgpr_read_b32 v234, a62
v_mfma_f32_16x16x32_bf16 v[160:163], a[112:115], a[88:91], v[160:163]
L_PAD5:
s_cbranch_execz L_PAD9
ds_read_b64_tr_b16 a[156:157], v14 offset:36864
ds_read_b64_tr_b16 a[158:159], v14 offset:37376
v_mfma_f32_16x16x32_bf16 v[228:231], a[184:187], a[88:91], v[228:231]
buffer_load_dwordx4 v15, s[24:27], s64 offen sc1 lds
v_mfma_f32_16x16x32_bf16 v[228:231], a[188:191], a[92:95], v[228:231]
s_xor_b32 s65, s70, 512
s_add_u32 s71, s68, s65
s_add_u32 s72, s69, s65
v_mfma_f32_16x16x32_bf16 v[168:171], a[180:183], a[92:95], v[168:171]
ds_read_b128 a[64:67], v4 offset:40960
v_accvgpr_read_b32 v235, a63
v_mfma_f32_16x16x32_bf16 v[168:171], a[176:179], a[88:91], v[168:171]
buffer_store_dwordx4 v[200:203], v15, s[24:27], s53 offen offset:1024 sc1
v_mfma_f32_16x16x32_bf16 v[176:179], a[168:171], a[88:91], v[176:179]
s_add_u32 m0, s73, 32768
s_add_u32 s64, s71, 0
ds_read_b128 a[80:83], v9 offset:0
v_mfma_f32_16x16x32_bf16 v[176:179], a[172:175], a[92:95], v[176:179]
v_accvgpr_read_b32 v224, a192
v_accvgpr_read_b32 v225, a193
v_mfma_f32_16x16x32_bf16 v[80:83], a[164:167], a[92:95], v[80:83]
buffer_load_dwordx4 v5, s[12:15], s64 offen lds
v_mfma_f32_16x16x32_bf16 v[80:83], a[160:163], a[88:91], v[80:83]
ds_read_b128 a[68:71], v4 offset:43008
v_accvgpr_read_b32 v226, a194
v_mfma_f32_16x16x32_bf16 v[184:187], a[160:163], a[96:99], v[184:187]
ds_read_b128 a[84:87], v10 offset:0
v_accvgpr_read_b32 v227, a195
v_mfma_f32_16x16x32_bf16 v[184:187], a[164:167], a[100:103], v[184:187]
v_accvgpr_read_b32 v192, a204
v_accvgpr_read_b32 v193, a205
v_mfma_f32_16x16x32_bf16 v[248:251], a[172:175], a[100:103], v[248:251]
v_accvgpr_read_b32 v194, a206
v_accvgpr_read_b32 v195, a207
v_mfma_f32_16x16x32_bf16 v[248:251], a[168:171], a[96:99], v[248:251]
ds_read_b128 a[72:75], v4 offset:41984
v_accvgpr_read_b32 v200, a208
v_mfma_f32_16x16x32_bf16 v[240:243], a[176:179], a[96:99], v[240:243]
buffer_load_dwordx4 v6, s[12:15], s64 offen offset:1024 lds
v_mfma_f32_16x16x32_bf16 v[240:243], a[180:183], a[100:103], v[240:243]
ds_read_b128 a[88:91], v9 offset:2048
v_accvgpr_read_b32 v201, a209
v_mfma_f32_16x16x32_bf16 v[232:235], a[188:191], a[100:103], v[232:235]
v_accvgpr_read_b32 v202, a210
v_accvgpr_read_b32 v203, a211
v_mfma_f32_16x16x32_bf16 v[232:235], a[184:187], a[96:99], v[232:235]
ds_read_b128 a[76:79], v4 offset:44032
v_and_b32 v28, 31, v1
v_mfma_f32_16x16x32_bf16 v[236:239], a[112:115], a[96:99], v[236:239]
s_add_u32 m0, s73, 34816
s_add_u32 s64, s71, 18432
v_lshlrev_b32 v28, 2, v28
v_mfma_f32_16x16x32_bf16 v[236:239], a[116:119], a[100:103], v[236:239]
ds_read_b128 a[92:95], v10 offset:2048
v_mfma_f32_16x16x32_bf16 v[224:227], a[124:127], a[100:103], v[224:227]
buffer_load_dwordx4 v5, s[12:15], s64 offen lds
v_mfma_f32_16x16x32_bf16 v[224:227], a[120:123], a[96:99], v[224:227]
buffer_load_dword v30, v28, s[40:43], 0 offen sc1
v_mfma_f32_16x16x32_bf16 a[196:199], a[120:123], a[104:107], a[196:199]
v_mfma_f32_16x16x32_bf16 a[196:199], a[124:127], a[108:111], a[196:199]
v_mfma_f32_16x16x32_bf16 a[200:203], a[116:119], a[108:111], a[200:203]
v_mfma_f32_16x16x32_bf16 a[200:203], a[112:115], a[104:107], a[200:203]
v_mfma_f32_16x16x32_bf16 v[244:247], a[184:187], a[104:107], v[244:247]
buffer_load_dwordx4 v6, s[12:15], s64 offen offset:1024 lds
v_mfma_f32_16x16x32_bf16 v[244:247], a[188:191], a[108:111], v[244:247]
s_add_u32 s53, s87, 266240
v_mfma_f32_16x16x32_bf16 v[192:195], a[180:183], a[108:111], v[192:195]
buffer_store_dwordx4 v[208:211], v15, s[24:27], s53 offen offset:0 sc1
v_mfma_f32_16x16x32_bf16 v[192:195], a[176:179], a[104:107], v[192:195]
v_mfma_f32_16x16x32_bf16 v[200:203], a[168:171], a[104:107], v[200:203]
v_mfma_f32_16x16x32_bf16 v[200:203], a[172:175], a[108:111], v[200:203]
v_accvgpr_read_b32 v208, a196
v_accvgpr_read_b32 v209, a197
v_mfma_f32_16x16x32_bf16 v[88:91], a[164:167], a[108:111], v[88:91]
v_accvgpr_read_b32 v210, a198
v_accvgpr_read_b32 v211, a199
v_mfma_f32_16x16x32_bf16 v[88:91], a[160:163], a[104:107], v[88:91]
s_waitcnt lgkmcnt(0)
v_mfma_f32_16x16x32_bf16 v[36:39], a[128:131], a[80:83], v[36:39]
s_waitcnt vmcnt(24)
v_mfma_f32_16x16x32_bf16 v[36:39], a[132:135], a[84:87], v[36:39]
s_barrier
v_mfma_f32_16x16x32_bf16 v[44:47], a[140:143], a[84:87], v[44:47]
ds_read_b128 a[96:99], v9 offset:4096
v_mfma_f32_16x16x32_bf16 v[44:47], a[136:139], a[80:83], v[44:47]
s_xor_b32 s75, s93, 4
s_lshl_b32 s76, s75, 19
s_add_u32 s76, s76, s74
v_mfma_f32_16x16x32_bf16 v[32:35], a[144:147], a[80:83], v[32:35]
s_lshl_b32 s79, s75, 13
s_add_u32 s79, s79, s78
ds_read_b128 a[100:103], v10 offset:4096
v_mfma_f32_16x16x32_bf16 v[32:35], a[148:151], a[84:87], v[32:35]
s_add_u32 m0, s77, 32768
s_add_u32 s64, s76, 0
ds_read_b128 a[104:107], v9 offset:6144
v_mfma_f32_16x16x32_bf16 v[52:55], a[156:159], a[84:87], v[52:55]
buffer_load_dwordx4 v7, s[20:23], s64 offen lds
v_mfma_f32_16x16x32_bf16 v[52:55], a[152:155], a[80:83], v[52:55]
ds_read_b64_tr_b16 a[160:161], v11 offset:49152
ds_read_b64_tr_b16 a[162:163], v11 offset:49664
v_mfma_f32_16x16x32_bf16 v[60:63], a[64:67], a[80:83], v[60:63]
v_mfma_f32_16x16x32_bf16 v[60:63], a[68:71], a[84:87], v[60:63]
ds_read_b128 a[108:111], v10 offset:6144
v_mfma_f32_16x16x32_bf16 v[68:71], a[76:79], a[84:87], v[68:71]
buffer_load_dwordx4 v8, s[20:23], s64 offen offset:1024 lds
v_mfma_f32_16x16x32_bf16 v[68:71], a[72:75], a[80:83], v[68:71]
ds_read_b64_tr_b16 a[164:165], v11 offset:53248
ds_read_b64_tr_b16 a[166:167], v11 offset:53760
v_mfma_f32_16x16x32_bf16 v[76:79], a[72:75], a[88:91], v[76:79]
v_add_u32 v9, -65536, v9
v_add_u32 v10, -65536, v10
v_mfma_f32_16x16x32_bf16 v[76:79], a[76:79], a[92:95], v[76:79]
ds_read_b64_tr_b16 a[168:169], v12 offset:49152
ds_read_b64_tr_b16 a[170:171], v12 offset:49664
v_mfma_f32_16x16x32_bf16 v[84:87], a[68:71], a[92:95], v[84:87]
s_add_u32 m0, s80, 32768
s_add_u32 s64, s79, 0
v_mfma_f32_16x16x32_bf16 v[84:87], a[64:67], a[88:91], v[84:87]
ds_read_b64_tr_b16 a[172:173], v12 offset:53248
ds_read_b64_tr_b16 a[174:175], v12 offset:53760
v_mfma_f32_16x16x32_bf16 v[92:95], a[152:155], a[88:91], v[92:95]
buffer_load_dwordx4 v15, s[24:27], s64 offen sc1 lds
v_mfma_f32_16x16x32_bf16 v[92:95], a[156:159], a[92:95], v[92:95]
v_mfma_f32_16x16x32_bf16 v[40:43], a[148:151], a[92:95], v[40:43]
ds_read_b64_tr_b16 a[176:177], v13 offset:49152
ds_read_b64_tr_b16 a[178:179], v13 offset:49664
v_mfma_f32_16x16x32_bf16 v[40:43], a[144:147], a[88:91], v[40:43]
s_add_u32 s53, s87, 266240
v_mfma_f32_16x16x32_bf16 v[100:103], a[136:139], a[88:91], v[100:103]
s_add_u32 m0, s73, 36864
s_add_u32 s64, s72, 0
v_mfma_f32_16x16x32_bf16 v[100:103], a[140:143], a[92:95], v[100:103]
ds_read_b64_tr_b16 a[180:181], v13 offset:53248
ds_read_b64_tr_b16 a[182:183], v13 offset:53760
v_mfma_f32_16x16x32_bf16 v[108:111], a[132:135], a[92:95], v[108:111]
buffer_load_dwordx4 v5, s[12:15], s64 offen lds
v_mfma_f32_16x16x32_bf16 v[108:111], a[128:131], a[88:91], v[108:111]
s_waitcnt lgkmcnt(14)
ds_read_b64_tr_b16 a[184:185], v14 offset:49152
ds_read_b64_tr_b16 a[186:187], v14 offset:49664
v_mfma_f32_16x16x32_bf16 v[116:119], a[128:131], a[96:99], v[116:119]
ds_read_b64_tr_b16 a[188:189], v14 offset:53248
ds_read_b64_tr_b16 a[190:191], v14 offset:53760
v_mfma_f32_16x16x32_bf16 v[116:119], a[132:135], a[100:103], v[116:119]
buffer_store_dwordx4 v[216:219], v15, s[24:27], s53 offen offset:1024 sc1
v_mfma_f32_16x16x32_bf16 v[124:127], a[140:143], a[100:103], v[124:127]
v_mfma_f32_16x16x32_bf16 v[124:127], a[136:139], a[96:99], v[124:127]
ds_read_b128 a[112:115], v4 offset:57344
v_accvgpr_read_b32 v216, a200
v_mfma_f32_16x16x32_bf16 v[132:135], a[144:147], a[96:99], v[132:135]
buffer_load_dwordx4 v6, s[12:15], s64 offen offset:1024 lds
v_mfma_f32_16x16x32_bf16 v[132:135], a[148:151], a[100:103], v[132:135]
ds_read_b128 a[116:119], v4 offset:59392
v_accvgpr_read_b32 v217, a201
v_mfma_f32_16x16x32_bf16 v[140:143], a[156:159], a[100:103], v[140:143]
v_accvgpr_read_b32 v218, a202
v_accvgpr_read_b32 v219, a203
v_mfma_f32_16x16x32_bf16 v[140:143], a[152:155], a[96:99], v[140:143]
s_lshr_b32 s84, s7, 1
s_and_b32 s85, s7, 1
ds_read_b128 a[120:123], v4 offset:58368
v_mfma_f32_16x16x32_bf16 v[148:151], a[64:67], a[96:99], v[148:151]
s_add_u32 m0, s73, 38912
s_add_u32 s64, s72, 18432
s_xor_b32 s52, s5, 0
v_mfma_f32_16x16x32_bf16 v[148:151], a[68:71], a[100:103], v[148:151]
s_lshl1_add_u32 s85, s52, s85
s_and_b32 s86, s6, 3
ds_read_b128 a[124:127], v4 offset:60416
v_mfma_f32_16x16x32_bf16 v[48:51], a[76:79], a[100:103], v[48:51]
buffer_load_dwordx4 v5, s[12:15], s64 offen lds
v_mfma_f32_16x16x32_bf16 v[48:51], a[72:75], a[96:99], v[48:51]
s_waitcnt lgkmcnt(15)
s_lshl_b32 s83, s3, 13
s_add_u32 s83, s83, 131072
v_mfma_f32_16x16x32_bf16 v[156:159], a[72:75], a[104:107], v[156:159]
s_mul_i32 s52, s2, 5462
s_lshr_b32 s52, s52, 16
s_mul_i32 s54, s52, 12
v_mfma_f32_16x16x32_bf16 v[156:159], a[76:79], a[108:111], v[156:159]
s_sub_u32 s54, s2, s54
s_mul_i32 s54, s54, 3
s_add_u32 s54, s54, s3
v_mfma_f32_16x16x32_bf16 v[164:167], a[68:71], a[108:111], v[164:167]
s_mul_i32 s55, s52, 13108
s_lshr_b32 s55, s55, 16
s_mul_i32 s82, s55, 5
v_mfma_f32_16x16x32_bf16 v[164:167], a[64:67], a[104:107], v[164:167]
s_sub_u32 s52, s52, s82
v_mfma_f32_16x16x32_bf16 v[172:175], a[152:155], a[104:107], v[172:175]
buffer_load_dwordx4 v6, s[12:15], s64 offen offset:1024 lds
v_mfma_f32_16x16x32_bf16 v[172:175], a[156:159], a[108:111], v[172:175]
v_lshrrev_b32 v16, 1, v1
v_and_b32 v17, 1, v1
v_mfma_f32_16x16x32_bf16 v[56:59], a[148:151], a[108:111], v[56:59]
v_mul_u32_u24 v18, 1152, v16
v_lshl_add_u32 v18, v17, 4, v18
v_mfma_f32_16x16x32_bf16 v[56:59], a[144:147], a[104:107], v[56:59]
v_mov_b32 v24, v18
v_lshrrev_b32 v18, 4, v16
v_mfma_f32_16x16x32_bf16 v[180:183], a[136:139], a[104:107], v[180:183]
v_bfe_u32 v19, v16, 2, 2
v_and_b32 v16, 3, v16
v_mfma_f32_16x16x32_bf16 v[180:183], a[140:143], a[108:111], v[180:183]
v_lshrrev_b32 v20, 1, v19
v_mul_u32_u24 v20, 18, v20
v_mfma_f32_16x16x32_bf16 v[188:191], a[132:135], a[108:111], v[188:191]
s_add_u32 s53, s88, 524288
v_and_b32 v21, 1, v19
v_lshl_add_u32 v20, v21, 1, v20
v_mfma_f32_16x16x32_bf16 v[188:191], a[128:131], a[104:107], v[188:191]
s_waitcnt lgkmcnt(0)
v_lshl_add_u32 v20, v16, 2, v20
v_add_u32 v20, v20, v18
v_mfma_f32_16x16x32_bf16 v[196:199], a[160:163], a[80:83], v[196:199]
s_waitcnt vmcnt(18)
v_mad_u32_u24 v20, s52, 36, v20
v_lshlrev_b32 v21, 1, v18
v_mfma_f32_16x16x32_bf16 v[196:199], a[164:167], a[84:87], v[196:199]
s_barrier
v_mfma_f32_16x16x32_bf16 v[64:67], a[172:175], a[84:87], v[64:67]
ds_read_b64_tr_b16 a[128:129], v11 offset:0
ds_read_b64_tr_b16 a[130:131], v11 offset:512
v_mfma_f32_16x16x32_bf16 v[64:67], a[168:171], a[80:83], v[64:67]
s_add_u32 m0, s77, 49152
s_add_u32 s64, s76, 128
v_lshl_add_u32 v21, v19, 2, v21
v_mfma_f32_16x16x32_bf16 v[204:207], a[176:179], a[80:83], v[204:207]
buffer_load_dwordx4 v7, s[20:23], s64 offen lds
v_mfma_f32_16x16x32_bf16 v[204:207], a[180:183], a[84:87], v[204:207]
ds_read_b64_tr_b16 a[132:133], v11 offset:4096
ds_read_b64_tr_b16 a[134:135], v11 offset:4608
v_mfma_f32_16x16x32_bf16 v[212:215], a[188:191], a[84:87], v[212:215]
ds_read_b64_tr_b16 a[136:137], v12 offset:0
ds_read_b64_tr_b16 a[138:139], v12 offset:512
v_mfma_f32_16x16x32_bf16 v[212:215], a[184:187], a[80:83], v[212:215]
ds_read_b64_tr_b16 a[140:141], v12 offset:4096
ds_read_b64_tr_b16 a[142:143], v12 offset:4608
v_mfma_f32_16x16x32_bf16 v[72:75], a[112:115], a[80:83], v[72:75]
buffer_store_dwordx4 v[96:99], v15, s[24:27], s53 offen offset:0 sc1
v_mfma_f32_16x16x32_bf16 v[72:75], a[116:119], a[84:87], v[72:75]
ds_read_b64_tr_b16 a[144:145], v13 offset:0
ds_read_b64_tr_b16 a[146:147], v13 offset:512
v_mfma_f32_16x16x32_bf16 v[220:223], a[124:127], a[84:87], v[220:223]
buffer_load_dwordx4 v8, s[20:23], s64 offen offset:1024 lds
v_mfma_f32_16x16x32_bf16 v[220:223], a[120:123], a[80:83], v[220:223]
ds_read_b64_tr_b16 a[148:149], v13 offset:4096
ds_read_b64_tr_b16 a[150:151], v13 offset:4608
v_mfma_f32_16x16x32_bf16 v[252:255], a[120:123], a[88:91], v[252:255]
v_lshrrev_b32 v22, 1, v16
v_add_u32 v21, v21, v22
v_mfma_f32_16x16x32_bf16 v[252:255], a[124:127], a[92:95], v[252:255]
ds_read_b64_tr_b16 a[152:153], v14 offset:0
ds_read_b64_tr_b16 a[154:155], v14 offset:512
v_mfma_f32_16x16x32_bf16 v[160:163], a[116:119], a[92:95], v[160:163]
s_add_u32 m0, s80, 49152
s_add_u32 s64, s79, 2048
v_mul_u32_u24 v21, 18, v21
v_mfma_f32_16x16x32_bf16 v[160:163], a[112:115], a[88:91], v[160:163]
ds_read_b64_tr_b16 a[156:157], v14 offset:4096
ds_read_b64_tr_b16 a[158:159], v14 offset:4608
v_mfma_f32_16x16x32_bf16 v[228:231], a[184:187], a[88:91], v[228:231]
buffer_load_dwordx4 v15, s[24:27], s64 offen sc1 lds
v_mfma_f32_16x16x32_bf16 v[228:231], a[188:191], a[92:95], v[228:231]
s_xor_b32 s65, s70, 640
s_add_u32 s71, s68, s65
s_add_u32 s72, s69, s65
v_mfma_f32_16x16x32_bf16 v[168:171], a[180:183], a[92:95], v[168:171]
ds_read_b128 a[64:67], v4 offset:8192
v_and_b32 v22, 1, v16
v_mfma_f32_16x16x32_bf16 v[168:171], a[176:179], a[88:91], v[168:171]
v_add3_u32 v21, v21, v22, 16
v_cmp_lt_u32 s[96:97], 1, v19
v_mfma_f32_16x16x32_bf16 v[176:179], a[168:171], a[88:91], v[176:179]
s_add_u32 m0, s73, 65536
s_add_u32 s64, s71, 0
ds_read_b128 a[80:83], v9 offset:0
v_mfma_f32_16x16x32_bf16 v[176:179], a[172:175], a[92:95], v[176:179]
v_mov_b32 v22, 0x100000
v_mul_u32_u24 v23, 1, v23
v_mfma_f32_16x16x32_bf16 v[80:83], a[164:167], a[92:95], v[80:83]
buffer_load_dwordx4 v5, s[12:15], s64 offen lds
v_mfma_f32_16x16x32_bf16 v[80:83], a[160:163], a[88:91], v[80:83]
ds_read_b128 a[68:71], v4 offset:10240
v_cndmask_b32 v21, v21, v22, s[96:97]
v_mfma_f32_16x16x32_bf16 v[184:187], a[160:163], a[96:99], v[184:187]
ds_read_b128 a[84:87], v10 offset:0
v_mov_b32 v22, s52
v_mfma_f32_16x16x32_bf16 v[184:187], a[164:167], a[100:103], v[184:187]
s_add_u32 s53, s88, 524288
v_cmp_eq_u32 s[96:97], 4, v22
v_mfma_f32_16x16x32_bf16 v[248:251], a[172:175], a[100:103], v[248:251]
buffer_store_dwordx4 v[104:107], v15, s[24:27], s53 offen offset:1024 sc1
v_mfma_f32_16x16x32_bf16 v[248:251], a[168:171], a[96:99], v[248:251]
ds_read_b128 a[72:75], v4 offset:9216
v_cndmask_b32 v20, v20, v21, s[96:97]
v_mfma_f32_16x16x32_bf16 v[240:243], a[176:179], a[96:99], v[240:243]
buffer_load_dwordx4 v6, s[12:15], s64 offen offset:1024 lds
v_mfma_f32_16x16x32_bf16 v[240:243], a[180:183], a[100:103], v[240:243]
ds_read_b128 a[88:91], v9 offset:2048
v_mul_u32_u24 v20, 1152, v20
v_mfma_f32_16x16x32_bf16 v[232:235], a[188:191], a[100:103], v[232:235]
v_lshl_add_u32 v20, v17, 4, v20
v_mov_b32 v25, v20
v_mfma_f32_16x16x32_bf16 v[232:235], a[184:187], a[96:99], v[232:235]
ds_read_b128 a[76:79], v4 offset:11264
v_mov_b32 v16, s54
v_mfma_f32_16x16x32_bf16 v[236:239], a[112:115], a[96:99], v[236:239]
s_add_u32 m0, s73, 67584
s_add_u32 s64, s71, 18432
v_mov_b32 v17, s55
v_mfma_f32_16x16x32_bf16 v[236:239], a[116:119], a[100:103], v[236:239]
ds_read_b128 a[92:95], v10 offset:2048
v_add_u32 v18, 32, v22
v_mfma_f32_16x16x32_bf16 v[224:227], a[124:127], a[100:103], v[224:227]
buffer_load_dwordx4 v5, s[12:15], s64 offen lds
v_mfma_f32_16x16x32_bf16 v[224:227], a[120:123], a[96:99], v[224:227]
s_mul_i32 s82, s55, 165888
s_lshl_b32 s54, s54, 5
s_add_u32 s82, s82, s54
v_mfma_f32_16x16x32_bf16 v[208:211], a[120:123], a[104:107], v[208:211]
s_and_b32 s52, s2, 1
s_lshr_b32 s54, s3, 1
s_lshl1_add_u32 s52, s52, s54
v_mfma_f32_16x16x32_bf16 v[208:211], a[124:127], a[108:111], v[208:211]
s_mul_i32 s52, s52, 9
s_and_b32 s54, s3, 1
s_mul_i32 s55, s54, 5
v_mfma_f32_16x16x32_bf16 v[216:219], a[116:119], a[108:111], v[216:219]
s_add_u32 s52, s52, s55
s_lshr_b32 s55, s2, 1
s_mul_i32 s81, s55, 1152
v_mfma_f32_16x16x32_bf16 v[216:219], a[112:115], a[104:107], v[216:219]
s_add_u32 s81, s81, s52
s_lshl_b32 s81, s81, 5
v_mfma_f32_16x16x32_bf16 v[244:247], a[184:187], a[104:107], v[244:247]
buffer_load_dwordx4 v6, s[12:15], s64 offen offset:1024 lds
v_mfma_f32_16x16x32_bf16 v[244:247], a[188:191], a[108:111], v[244:247]
v_cmp_gt_u32 s[96:97], 5, v1
v_add_u32 v19, s52, v1
v_mfma_f32_16x16x32_bf16 v[192:195], a[180:183], a[108:111], v[192:195]
v_lshrrev_b32 v20, 5, s55
v_and_b32 v21, 31, s55
v_mfma_f32_16x16x32_bf16 v[192:195], a[176:179], a[104:107], v[192:195]
v_cndmask_b32 v16, v16, v19, s[96:97]
v_cndmask_b32 v17, v17, v20, s[96:97]
v_mfma_f32_16x16x32_bf16 v[200:203], a[168:171], a[104:107], v[200:203]
v_cndmask_b32 v18, v18, v21, s[96:97]
v_mul_u32_u24 v19, 7282, v16
v_mfma_f32_16x16x32_bf16 v[200:203], a[172:175], a[108:111], v[200:203]
v_lshrrev_b32 v19, 16, v19
v_mul_u32_u24 v20, 9, v19
v_mfma_f32_16x16x32_bf16 v[88:91], a[164:167], a[108:111], v[88:91]
v_sub_u32 v16, v16, v20
v_and_b32 v20, 1, v19
v_mfma_f32_16x16x32_bf16 v[88:91], a[160:163], a[104:107], v[88:91]
s_waitcnt lgkmcnt(0)
v_lshlrev_b32 v20, 2, v20
v_cndmask_b32 v20, 0, v20, s[96:97]
v_mfma_f32_16x16x32_bf16 v[36:39], a[128:131], a[80:83], v[36:39]
s_waitcnt vmcnt(24)
v_xor_b32 v18, v18, v20
v_lshl_add_u32 v19, v19, 2, v17
v_mfma_f32_16x16x32_bf16 v[36:39], a[132:135], a[84:87], v[36:39]
s_barrier
v_mfma_f32_16x16x32_bf16 v[44:47], a[140:143], a[84:87], v[44:47]
ds_read_b128 a[96:99], v9 offset:4096
v_mul_u32_u24 v19, 344064, v19
v_mfma_f32_16x16x32_bf16 v[44:47], a[136:139], a[80:83], v[44:47]
s_xor_b32 s75, s93, 5
s_lshl_b32 s76, s75, 19
s_add_u32 s76, s76, s74
v_mfma_f32_16x16x32_bf16 v[32:35], a[144:147], a[80:83], v[32:35]
s_lshl_b32 s79, s75, 13
s_add_u32 s79, s79, s78
ds_read_b128 a[100:103], v10 offset:4096
v_mfma_f32_16x16x32_bf16 v[32:35], a[148:151], a[84:87], v[32:35]
s_add_u32 m0, s77, 0
s_add_u32 s64, s76, 0
ds_read_b128 a[104:107], v9 offset:6144
v_mfma_f32_16x16x32_bf16 v[52:55], a[156:159], a[84:87], v[52:55]
buffer_load_dwordx4 v7, s[20:23], s64 offen lds
v_mfma_f32_16x16x32_bf16 v[52:55], a[152:155], a[80:83], v[52:55]
s_add_u32 s53, s88, 524288
ds_read_b64_tr_b16 a[160:161], v11 offset:16384
ds_read_b64_tr_b16 a[162:163], v11 offset:16896
v_mfma_f32_16x16x32_bf16 v[60:63], a[64:67], a[80:83], v[60:63]
buffer_store_dwordx4 v[112:115], v15, s[24:27], s53 offen offset:2048 sc1
v_mfma_f32_16x16x32_bf16 v[60:63], a[68:71], a[84:87], v[60:63]
ds_read_b128 a[108:111], v10 offset:6144
v_lshrrev_b32 v20, 1, v16
v_mfma_f32_16x16x32_bf16 v[68:71], a[76:79], a[84:87], v[68:71]
buffer_load_dwordx4 v8, s[20:23], s64 offen offset:1024 lds
v_mfma_f32_16x16x32_bf16 v[68:71], a[72:75], a[80:83], v[68:71]
ds_read_b64_tr_b16 a[164:165], v11 offset:20480
ds_read_b64_tr_b16 a[166:167], v11 offset:20992
v_mfma_f32_16x16x32_bf16 v[76:79], a[72:75], a[88:91], v[76:79]
v_add_u32 v9, 32768, v9
v_add_u32 v10, 32768, v10
v_mfma_f32_16x16x32_bf16 v[76:79], a[76:79], a[92:95], v[76:79]
ds_read_b64_tr_b16 a[168:169], v12 offset:16384
ds_read_b64_tr_b16 a[170:171], v12 offset:16896
v_mfma_f32_16x16x32_bf16 v[84:87], a[68:71], a[92:95], v[84:87]
s_add_u32 m0, s80, 0
s_add_u32 s64, s79, 0
v_sub_u32 v20, v20, v17
v_mfma_f32_16x16x32_bf16 v[84:87], a[64:67], a[88:91], v[84:87]
ds_read_b64_tr_b16 a[172:173], v12 offset:20480
ds_read_b64_tr_b16 a[174:175], v12 offset:20992
v_mfma_f32_16x16x32_bf16 v[92:95], a[152:155], a[88:91], v[92:95]
buffer_load_dwordx4 v15, s[24:27], s64 offen sc1 lds
v_mfma_f32_16x16x32_bf16 v[92:95], a[156:159], a[92:95], v[92:95]
v_add_u32 v20, 3, v20
v_and_b32 v20, 3, v20
v_mfma_f32_16x16x32_bf16 v[40:43], a[148:151], a[92:95], v[40:43]
s_waitcnt vmcnt(23)
ds_read_b64_tr_b16 a[176:177], v13 offset:16384
ds_read_b64_tr_b16 a[178:179], v13 offset:16896
v_mfma_f32_16x16x32_bf16 v[40:43], a[144:147], a[88:91], v[40:43]
v_cmp_gt_u32 vcc, 1, v30
v_cmp_eq_u32 s[96:97], 8, v16
v_mfma_f32_16x16x32_bf16 v[100:103], a[136:139], a[88:91], v[100:103]
s_add_u32 m0, s73, 69632
s_add_u32 s64, s72, 0
v_and_b32 v16, 1, v16
v_mfma_f32_16x16x32_bf16 v[100:103], a[140:143], a[92:95], v[100:103]
ds_read_b64_tr_b16 a[180:181], v13 offset:20480
ds_read_b64_tr_b16 a[182:183], v13 offset:20992
v_mfma_f32_16x16x32_bf16 v[108:111], a[132:135], a[92:95], v[108:111]
buffer_load_dwordx4 v5, s[12:15], s64 offen lds
v_mfma_f32_16x16x32_bf16 v[108:111], a[128:131], a[88:91], v[108:111]
s_waitcnt lgkmcnt(14)
ds_read_b64_tr_b16 a[184:185], v14 offset:16384
ds_read_b64_tr_b16 a[186:187], v14 offset:16896
v_mfma_f32_16x16x32_bf16 v[116:119], a[128:131], a[96:99], v[116:119]
ds_read_b64_tr_b16 a[188:189], v14 offset:20480
ds_read_b64_tr_b16 a[190:191], v14 offset:20992
v_mfma_f32_16x16x32_bf16 v[116:119], a[132:135], a[100:103], v[116:119]
s_cbranch_vccnz CK_ZA
CK_ZA_R:
v_mfma_f32_16x16x32_bf16 v[124:127], a[140:143], a[100:103], v[124:127]
v_lshl_add_u32 v21, v20, 1, v16
v_and_b32 v22, 1, v18
v_mfma_f32_16x16x32_bf16 v[124:127], a[136:139], a[96:99], v[124:127]
ds_read_b128 a[112:115], v4 offset:24576
v_lshl_add_u32 v19, v22, 10, v19
v_mfma_f32_16x16x32_bf16 v[132:135], a[144:147], a[96:99], v[132:135]
buffer_load_dwordx4 v6, s[12:15], s64 offen offset:1024 lds
v_mfma_f32_16x16x32_bf16 v[132:135], a[148:151], a[100:103], v[132:135]
ds_read_b128 a[116:119], v4 offset:26624
v_and_b32 v18, -2, v18
v_mfma_f32_16x16x32_bf16 v[140:143], a[156:159], a[100:103], v[140:143]
v_add_u32 v21, 1, v21
v_cndmask_b32 v21, v21, 0, s[96:97]
v_mfma_f32_16x16x32_bf16 v[140:143], a[152:155], a[96:99], v[140:143]
s_add_u32 s53, s88, 524288
ds_read_b128 a[120:123], v4 offset:25600
v_cndmask_b32 v20, v20, 0, s[96:97]
v_mfma_f32_16x16x32_bf16 v[148:151], a[64:67], a[96:99], v[148:151]
s_add_u32 m0, s73, 71680
s_add_u32 s64, s72, 18432
v_sub_u32 v17, 37, v18
v_mfma_f32_16x16x32_bf16 v[148:151], a[68:71], a[100:103], v[148:151]
ds_read_b128 a[124:127], v4 offset:27648
v_min_u32 v17, 2, v17
v_mfma_f32_16x16x32_bf16 v[48:51], a[76:79], a[100:103], v[48:51]
buffer_load_dwordx4 v5, s[12:15], s64 offen lds
v_mfma_f32_16x16x32_bf16 v[48:51], a[72:75], a[96:99], v[48:51]
s_waitcnt lgkmcnt(15)
v_mul_u32_u24 v21, v21, v17
v_mul_u32_u24 v22, v16, v17
v_mfma_f32_16x16x32_bf16 v[156:159], a[72:75], a[104:107], v[156:159]
buffer_store_dwordx4 v[120:123], v15, s[24:27], s53 offen offset:3072 sc1
v_mfma_f32_16x16x32_bf16 v[156:159], a[76:79], a[108:111], v[156:159]
v_min_u32 v23, 8, v18
v_mad_u32_u24 v21, v18, 5, v21
v_mfma_f32_16x16x32_bf16 v[164:167], a[68:71], a[108:111], v[164:167]
v_lshl_add_u32 v21, v23, 1, v21
v_lshl_add_u32 v22, v18, 1, v22
v_mfma_f32_16x16x32_bf16 v[164:167], a[64:67], a[104:107], v[164:167]
v_mad_u32_u24 v22, v20, 37, v22
v_mad_u32_u24 v22, v20, 37, v22
v_mfma_f32_16x16x32_bf16 v[172:175], a[152:155], a[104:107], v[172:175]
buffer_load_dwordx4 v6, s[12:15], s64 offen offset:1024 lds
v_mfma_f32_16x16x32_bf16 v[172:175], a[156:159], a[108:111], v[172:175]
v_lshl_add_u32 v20, v20, 6, v18
v_mov_b32 v23, 136
v_mfma_f32_16x16x32_bf16 v[56:59], a[148:151], a[108:111], v[56:59]
v_cmp_gt_u32 s[96:97], v23, v20
v_add_u32 v22, 37, v22
v_mfma_f32_16x16x32_bf16 v[56:59], a[144:147], a[104:107], v[56:59]
v_add_u32 v19, 38797312, v19
v_mfma_f32_16x16x32_bf16 v[180:183], a[136:139], a[104:107], v[180:183]
v_cndmask_b32 v21, v22, v21, s[96:97]
v_lshl_add_u32 v19, v21, 10, v19
v_mfma_f32_16x16x32_bf16 v[180:183], a[140:143], a[108:111], v[180:183]
s_cmp_eq_u32 s54, 1
s_cselect_b32 s96, 16, 0
v_mfma_f32_16x16x32_bf16 v[188:191], a[132:135], a[108:111], v[188:191]
s_cmp_eq_u32 s3, 3
s_cselect_b32 s52, 32, 0
s_or_b32 s96, s96, s52
v_mfma_f32_16x16x32_bf16 v[188:191], a[128:131], a[104:107], v[188:191]
s_waitcnt lgkmcnt(0)
s_cmp_ge_u32 s2, 240
s_cselect_b32 s52, 32, 0
v_mfma_f32_16x16x32_bf16 v[196:199], a[160:163], a[80:83], v[196:199]
s_waitcnt vmcnt(18)
s_or_b32 s96, s96, s52
s_mov_b32 s97, 0
v_mfma_f32_16x16x32_bf16 v[196:199], a[164:167], a[84:87], v[196:199]
s_barrier
v_mfma_f32_16x16x32_bf16 v[64:67], a[172:175], a[84:87], v[64:67]
ds_read_b64_tr_b16 a[128:129], v11 offset:32768
ds_read_b64_tr_b16 a[130:131], v11 offset:33280
v_mfma_f32_16x16x32_bf16 v[64:67], a[168:171], a[80:83], v[64:67]
s_add_u32 m0, s77, 16384
s_add_u32 s64, s76, 128
v_mov_b32 v20, 2147418112
v_mfma_f32_16x16x32_bf16 v[204:207], a[176:179], a[80:83], v[204:207]
buffer_load_dwordx4 v7, s[20:23], s64 offen lds
v_mfma_f32_16x16x32_bf16 v[204:207], a[180:183], a[84:87], v[204:207]
ds_read_b64_tr_b16 a[132:133], v11 offset:36864
ds_read_b64_tr_b16 a[134:135], v11 offset:37376
v_mfma_f32_16x16x32_bf16 v[212:215], a[188:191], a[84:87], v[212:215]
ds_read_b64_tr_b16 a[136:137], v12 offset:32768
ds_read_b64_tr_b16 a[138:139], v12 offset:33280
v_mfma_f32_16x16x32_bf16 v[212:215], a[184:187], a[80:83], v[212:215]
ds_read_b64_tr_b16 a[140:141], v12 offset:36864
ds_read_b64_tr_b16 a[142:143], v12 offset:37376
v_mfma_f32_16x16x32_bf16 v[72:75], a[112:115], a[80:83], v[72:75]
buffer_atomic_add v1, v0, s[24:27], s90 offen offset:4 sc1
v_mfma_f32_16x16x32_bf16 v[72:75], a[116:119], a[84:87], v[72:75]
ds_read_b64_tr_b16 a[144:145], v13 offset:32768
ds_read_b64_tr_b16 a[146:147], v13 offset:33280
v_mfma_f32_16x16x32_bf16 v[220:223], a[124:127], a[84:87], v[220:223]
buffer_load_dwordx4 v8, s[20:23], s64 offen offset:1024 lds
v_mfma_f32_16x16x32_bf16 v[220:223], a[120:123], a[80:83], v[220:223]
s_add_u32 s53, s88, 786432
ds_read_b64_tr_b16 a[148:149], v13 offset:36864
ds_read_b64_tr_b16 a[150:151], v13 offset:37376
v_mfma_f32_16x16x32_bf16 v[252:255], a[120:123], a[88:91], v[252:255]
buffer_store_dwordx4 v[128:131], v15, s[24:27], s53 offen offset:0 sc1
v_mfma_f32_16x16x32_bf16 v[252:255], a[124:127], a[92:95], v[252:255]
ds_read_b64_tr_b16 a[152:153], v14 offset:32768
ds_read_b64_tr_b16 a[154:155], v14 offset:33280
v_mfma_f32_16x16x32_bf16 v[160:163], a[116:119], a[92:95], v[160:163]
s_add_u32 m0, s80, 16384
s_add_u32 s64, s79, 2048
v_cndmask_b32 v26, v19, v20, s[96:97]
v_mfma_f32_16x16x32_bf16 v[160:163], a[112:115], a[88:91], v[160:163]
ds_read_b64_tr_b16 a[156:157], v14 offset:36864
ds_read_b64_tr_b16 a[158:159], v14 offset:37376
v_mfma_f32_16x16x32_bf16 v[228:231], a[184:187], a[88:91], v[228:231]
buffer_load_dwordx4 v15, s[24:27], s64 offen sc1 lds
v_mfma_f32_16x16x32_bf16 v[228:231], a[188:191], a[92:95], v[228:231]
s_xor_b32 s65, s70, 768
s_add_u32 s71, s68, s65
s_add_u32 s72, s69, s65
v_mfma_f32_16x16x32_bf16 v[168:171], a[180:183], a[92:95], v[168:171]
ds_read_b128 a[64:67], v4 offset:40960
v_lshlrev_b32 v27, 3, v1
v_mfma_f32_16x16x32_bf16 v[168:171], a[176:179], a[88:91], v[168:171]
v_add_u32 v27, s83, v27
v_lshrrev_b32 v22, 3, v1
v_mfma_f32_16x16x32_bf16 v[176:179], a[168:171], a[88:91], v[176:179]
s_add_u32 m0, s73, 0
s_add_u32 s64, s71, 0
ds_read_b128 a[80:83], v9 offset:0
v_mfma_f32_16x16x32_bf16 v[176:179], a[172:175], a[92:95], v[176:179]
v_mul_u32_u24 v22, 1152, v22
v_and_b32 v23, 7, v1
v_mfma_f32_16x16x32_bf16 v[80:83], a[164:167], a[92:95], v[80:83]
buffer_load_dwordx4 v5, s[12:15], s64 offen lds
v_mfma_f32_16x16x32_bf16 v[80:83], a[160:163], a[88:91], v[80:83]
L_PAD6:
s_cbranch_execz L_PAD10
ds_read_b128 a[68:71], v4 offset:43008
v_lshl_add_u32 v22, v23, 4, v22
v_mfma_f32_16x16x32_bf16 v[184:187], a[160:163], a[96:99], v[184:187]
ds_read_b128 a[84:87], v10 offset:0
v_lshrrev_b32 v23, 2, v1
v_mfma_f32_16x16x32_bf16 v[184:187], a[164:167], a[100:103], v[184:187]
v_mul_u32_u24 v23, 96, v23
v_add_u32 v23, v23, v27
v_mfma_f32_16x16x32_bf16 v[248:251], a[172:175], a[100:103], v[248:251]
v_and_b32 v16, 3, v1
v_cmp_eq_u32 s[96:97], 0, v16
v_mfma_f32_16x16x32_bf16 v[248:251], a[168:171], a[96:99], v[248:251]
ds_read_b128 a[72:75], v4 offset:41984
v_mov_b32 v16, 0x3f803f80
v_mfma_f32_16x16x32_bf16 v[240:243], a[176:179], a[96:99], v[240:243]
buffer_load_dwordx4 v6, s[12:15], s64 offen offset:1024 lds
v_mfma_f32_16x16x32_bf16 v[240:243], a[180:183], a[100:103], v[240:243]
ds_read_b128 a[88:91], v9 offset:2048
v_cndmask_b32 v16, 0, v16, s[96:97]
v_mfma_f32_16x16x32_bf16 v[232:235], a[188:191], a[100:103], v[232:235]
v_accvgpr_write_b32 a240, v16
v_accvgpr_write_b32 a241, v16
v_mfma_f32_16x16x32_bf16 v[232:235], a[184:187], a[96:99], v[232:235]
ds_read_b128 a[76:79], v4 offset:44032
v_accvgpr_write_b32 a242, v16
v_mfma_f32_16x16x32_bf16 v[236:239], a[112:115], a[96:99], v[236:239]
s_add_u32 m0, s73, 2048
s_add_u32 s64, s71, 18432
v_accvgpr_write_b32 a243, v16
v_mfma_f32_16x16x32_bf16 v[236:239], a[116:119], a[100:103], v[236:239]
ds_read_b128 a[92:95], v10 offset:2048
v_accvgpr_write_b32 a232, 0
v_mfma_f32_16x16x32_bf16 v[224:227], a[124:127], a[100:103], v[224:227]
buffer_load_dwordx4 v5, s[12:15], s64 offen lds
v_mfma_f32_16x16x32_bf16 v[224:227], a[120:123], a[96:99], v[224:227]
v_accvgpr_write_b32 a233, 0
v_accvgpr_write_b32 a234, 0
v_mfma_f32_16x16x32_bf16 v[208:211], a[120:123], a[104:107], v[208:211]
v_accvgpr_write_b32 a235, 0
v_accvgpr_write_b32 a236, 0
v_mfma_f32_16x16x32_bf16 v[208:211], a[124:127], a[108:111], v[208:211]
s_add_u32 s53, s88, 786432
v_accvgpr_write_b32 a237, 0
v_accvgpr_write_b32 a238, 0
v_mfma_f32_16x16x32_bf16 v[216:219], a[116:119], a[108:111], v[216:219]
buffer_store_dwordx4 v[136:139], v15, s[24:27], s53 offen offset:1024 sc1
v_mfma_f32_16x16x32_bf16 v[216:219], a[112:115], a[104:107], v[216:219]
v_accvgpr_write_b32 a239, 0
v_lshlrev_b32 v16, 2, v3
v_mfma_f32_16x16x32_bf16 v[244:247], a[184:187], a[104:107], v[244:247]
buffer_load_dwordx4 v6, s[12:15], s64 offen offset:1024 lds
v_mfma_f32_16x16x32_bf16 v[244:247], a[188:191], a[108:111], v[244:247]
v_sub_u32 v16, v2, v16
v_cmp_gt_i32 s[56:57], 0, v16
v_mfma_f32_16x16x32_bf16 v[192:195], a[180:183], a[108:111], v[192:195]
v_cmp_gt_i32 s[58:59], 1, v16
v_cmp_gt_i32 s[60:61], 2, v16
v_mfma_f32_16x16x32_bf16 v[192:195], a[176:179], a[104:107], v[192:195]
v_cmp_gt_i32 s[62:63], 3, v16
v_cmp_eq_u32 s[96:97], 3, v3
v_mfma_f32_16x16x32_bf16 v[200:203], a[168:171], a[104:107], v[200:203]
v_add_u32 v17, 48, v2
v_lshlrev_b32 v17, 2, v17
v_mfma_f32_16x16x32_bf16 v[200:203], a[172:175], a[108:111], v[200:203]
v_lshlrev_b32 v18, 16, v3
v_lshl_add_u32 v18, v2, 4, v18
v_mfma_f32_16x16x32_bf16 v[88:91], a[164:167], a[108:111], v[88:91]
v_add_u32 v19, 0x8000, v18
v_cndmask_b32 v19, v19, v20, s[96:97]
v_mfma_f32_16x16x32_bf16 v[88:91], a[160:163], a[104:107], v[88:91]
s_waitcnt lgkmcnt(0)
v_cmp_eq_u32 s[96:97], 0, v3
v_mfma_f32_16x16x32_bf16 v[36:39], a[128:131], a[80:83], v[36:39]
s_waitcnt vmcnt(24)
v_mfma_f32_16x16x32_bf16 v[36:39], a[132:135], a[84:87], v[36:39]
s_barrier
v_mfma_f32_16x16x32_bf16 v[44:47], a[140:143], a[84:87], v[44:47]
ds_read_b128 a[96:99], v9 offset:4096
v_cndmask_b32 v18, v18, v20, s[96:97]
v_mfma_f32_16x16x32_bf16 v[44:47], a[136:139], a[80:83], v[44:47]
s_xor_b32 s75, s93, 6
s_lshl_b32 s76, s75, 19
s_add_u32 s76, s76, s74
v_mfma_f32_16x16x32_bf16 v[32:35], a[144:147], a[80:83], v[32:35]
s_lshl_b32 s79, s75, 13
s_add_u32 s79, s79, s78
ds_read_b128 a[100:103], v10 offset:4096
v_mfma_f32_16x16x32_bf16 v[32:35], a[148:151], a[84:87], v[32:35]
s_add_u32 m0, s77, 32768
s_add_u32 s64, s76, 0
ds_read_b128 a[104:107], v9 offset:6144
v_mfma_f32_16x16x32_bf16 v[52:55], a[156:159], a[84:87], v[52:55]
buffer_load_dwordx4 v7, s[20:23], s64 offen lds
v_mfma_f32_16x16x32_bf16 v[52:55], a[152:155], a[80:83], v[52:55]
ds_read_b64_tr_b16 a[160:161], v11 offset:49152
ds_read_b64_tr_b16 a[162:163], v11 offset:49664
v_mfma_f32_16x16x32_bf16 v[60:63], a[64:67], a[80:83], v[60:63]
v_cndmask_b32 v19, v19, v20, s[96:97]
v_mfma_f32_16x16x32_bf16 v[60:63], a[68:71], a[84:87], v[60:63]
ds_read_b128 a[108:111], v10 offset:6144
v_mfma_f32_16x16x32_bf16 v[68:71], a[76:79], a[84:87], v[68:71]
buffer_load_dwordx4 v8, s[20:23], s64 offen offset:1024 lds
v_mfma_f32_16x16x32_bf16 v[68:71], a[72:75], a[80:83], v[68:71]
ds_read_b64_tr_b16 a[164:165], v11 offset:53248
ds_read_b64_tr_b16 a[166:167], v11 offset:53760
v_mfma_f32_16x16x32_bf16 v[76:79], a[72:75], a[88:91], v[76:79]
v_add_u32 v9, 32768, v9
v_add_u32 v10, 32768, v10
v_mfma_f32_16x16x32_bf16 v[76:79], a[76:79], a[92:95], v[76:79]
ds_read_b64_tr_b16 a[168:169], v12 offset:49152
ds_read_b64_tr_b16 a[170:171], v12 offset:49664
v_mfma_f32_16x16x32_bf16 v[84:87], a[68:71], a[92:95], v[84:87]
s_add_u32 m0, s80, 32768
s_add_u32 s64, s79, 0
v_mfma_f32_16x16x32_bf16 v[84:87], a[64:67], a[88:91], v[84:87]
ds_read_b64_tr_b16 a[172:173], v12 offset:53248
ds_read_b64_tr_b16 a[174:175], v12 offset:53760
v_mfma_f32_16x16x32_bf16 v[92:95], a[152:155], a[88:91], v[92:95]
buffer_load_dwordx4 v15, s[24:27], s64 offen sc1 lds
v_mfma_f32_16x16x32_bf16 v[92:95], a[156:159], a[92:95], v[92:95]
s_add_u32 s53, s88, 786432
v_mfma_f32_16x16x32_bf16 v[40:43], a[148:151], a[92:95], v[40:43]
ds_read_b64_tr_b16 a[176:177], v13 offset:49152
ds_read_b64_tr_b16 a[178:179], v13 offset:49664
v_mfma_f32_16x16x32_bf16 v[40:43], a[144:147], a[88:91], v[40:43]
buffer_store_dwordx4 v[144:147], v15, s[24:27], s53 offen offset:2048 sc1
v_mfma_f32_16x16x32_bf16 v[100:103], a[136:139], a[88:91], v[100:103]
s_add_u32 m0, s73, 4096
s_add_u32 s64, s72, 0
v_mfma_f32_16x16x32_bf16 v[100:103], a[140:143], a[92:95], v[100:103]
ds_read_b64_tr_b16 a[180:181], v13 offset:53248
ds_read_b64_tr_b16 a[182:183], v13 offset:53760
v_mfma_f32_16x16x32_bf16 v[108:111], a[132:135], a[92:95], v[108:111]
buffer_load_dwordx4 v5, s[12:15], s64 offen lds
v_mfma_f32_16x16x32_bf16 v[108:111], a[128:131], a[88:91], v[108:111]
s_waitcnt lgkmcnt(14)
ds_read_b64_tr_b16 a[184:185], v14 offset:49152
ds_read_b64_tr_b16 a[186:187], v14 offset:49664
v_mfma_f32_16x16x32_bf16 v[116:119], a[128:131], a[96:99], v[116:119]
ds_read_b64_tr_b16 a[188:189], v14 offset:53248
ds_read_b64_tr_b16 a[190:191], v14 offset:53760
v_mfma_f32_16x16x32_bf16 v[116:119], a[132:135], a[100:103], v[116:119]
v_mfma_f32_16x16x32_bf16 v[124:127], a[140:143], a[100:103], v[124:127]
v_mfma_f32_16x16x32_bf16 v[124:127], a[136:139], a[96:99], v[124:127]
ds_read_b128 a[112:115], v4 offset:57344
v_mfma_f32_16x16x32_bf16 v[132:135], a[144:147], a[96:99], v[132:135]
buffer_load_dwordx4 v6, s[12:15], s64 offen offset:1024 lds
v_mfma_f32_16x16x32_bf16 v[132:135], a[148:151], a[100:103], v[132:135]
ds_read_b128 a[116:119], v4 offset:59392
v_mfma_f32_16x16x32_bf16 v[140:143], a[156:159], a[100:103], v[140:143]
v_mfma_f32_16x16x32_bf16 v[140:143], a[152:155], a[96:99], v[140:143]
ds_read_b128 a[120:123], v4 offset:58368
v_mfma_f32_16x16x32_bf16 v[148:151], a[64:67], a[96:99], v[148:151]
s_add_u32 m0, s73, 6144
s_add_u32 s64, s72, 18432
v_mfma_f32_16x16x32_bf16 v[148:151], a[68:71], a[100:103], v[148:151]
ds_read_b128 a[124:127], v4 offset:60416
v_mfma_f32_16x16x32_bf16 v[48:51], a[76:79], a[100:103], v[48:51]
buffer_load_dwordx4 v5, s[12:15], s64 offen lds
v_mfma_f32_16x16x32_bf16 v[48:51], a[72:75], a[96:99], v[48:51]
s_waitcnt lgkmcnt(15)
v_mfma_f32_16x16x32_bf16 v[156:159], a[72:75], a[104:107], v[156:159]
v_mfma_f32_16x16x32_bf16 v[156:159], a[76:79], a[108:111], v[156:159]
v_mfma_f32_16x16x32_bf16 v[164:167], a[68:71], a[108:111], v[164:167]
v_mfma_f32_16x16x32_bf16 v[164:167], a[64:67], a[104:107], v[164:167]
v_mfma_f32_16x16x32_bf16 v[172:175], a[152:155], a[104:107], v[172:175]
buffer_load_dwordx4 v6, s[12:15], s64 offen offset:1024 lds
v_mfma_f32_16x16x32_bf16 v[172:175], a[156:159], a[108:111], v[172:175]
v_mfma_f32_16x16x32_bf16 v[56:59], a[148:151], a[108:111], v[56:59]
v_mfma_f32_16x16x32_bf16 v[56:59], a[144:147], a[104:107], v[56:59]
s_add_u32 s53, s88, 786432
v_mfma_f32_16x16x32_bf16 v[180:183], a[136:139], a[104:107], v[180:183]
buffer_store_dwordx4 v[152:155], v15, s[24:27], s53 offen offset:3072 sc1
v_mfma_f32_16x16x32_bf16 v[180:183], a[140:143], a[108:111], v[180:183]
v_mfma_f32_16x16x32_bf16 v[188:191], a[132:135], a[108:111], v[188:191]
v_mfma_f32_16x16x32_bf16 v[188:191], a[128:131], a[104:107], v[188:191]
s_waitcnt lgkmcnt(0)
v_mov_b32 v96, 0
v_mov_b32 v97, 0
v_mfma_f32_16x16x32_bf16 v[196:199], a[160:163], a[80:83], v[196:199]
s_waitcnt vmcnt(19)
v_mov_b32 v98, 0
v_mov_b32 v99, 0
v_mfma_f32_16x16x32_bf16 v[196:199], a[164:167], a[84:87], v[196:199]
s_barrier
v_mfma_f32_16x16x32_bf16 v[64:67], a[172:175], a[84:87], v[64:67]
ds_read_b64_tr_b16 a[128:129], v11 offset:0
ds_read_b64_tr_b16 a[130:131], v11 offset:512
v_mfma_f32_16x16x32_bf16 v[64:67], a[168:171], a[80:83], v[64:67]
s_add_u32 m0, s77, 49152
s_add_u32 s64, s76, 128
v_mov_b32 v104, 0
v_mfma_f32_16x16x32_bf16 v[204:207], a[176:179], a[80:83], v[204:207]
buffer_load_dwordx4 v7, s[20:23], s64 offen lds
v_mfma_f32_16x16x32_bf16 v[204:207], a[180:183], a[84:87], v[204:207]
ds_read_b64_tr_b16 a[132:133], v11 offset:4096
ds_read_b64_tr_b16 a[134:135], v11 offset:4608
v_mfma_f32_16x16x32_bf16 v[212:215], a[188:191], a[84:87], v[212:215]
ds_read_b64_tr_b16 a[136:137], v12 offset:0
ds_read_b64_tr_b16 a[138:139], v12 offset:512
v_mfma_f32_16x16x32_bf16 v[212:215], a[184:187], a[80:83], v[212:215]
ds_read_b64_tr_b16 a[140:141], v12 offset:4096
ds_read_b64_tr_b16 a[142:143], v12 offset:4608
v_mfma_f32_16x16x32_bf16 v[72:75], a[112:115], a[80:83], v[72:75]
buffer_load_dword v30, v29, s[24:27], s89 offen offset:4 sc1
v_mfma_f32_16x16x32_bf16 v[72:75], a[116:119], a[84:87], v[72:75]
ds_read_b64_tr_b16 a[144:145], v13 offset:0
ds_read_b64_tr_b16 a[146:147], v13 offset:512
v_mfma_f32_16x16x32_bf16 v[220:223], a[124:127], a[84:87], v[220:223]
buffer_load_dwordx4 v8, s[20:23], s64 offen offset:1024 lds
v_mfma_f32_16x16x32_bf16 v[220:223], a[120:123], a[80:83], v[220:223]
ds_read_b64_tr_b16 a[148:149], v13 offset:4096
ds_read_b64_tr_b16 a[150:151], v13 offset:4608
v_mfma_f32_16x16x32_bf16 v[252:255], a[120:123], a[88:91], v[252:255]
v_mov_b32 v105, 0
v_mov_b32 v106, 0
v_mfma_f32_16x16x32_bf16 v[252:255], a[124:127], a[92:95], v[252:255]
ds_read_b64_tr_b16 a[152:153], v14 offset:0
ds_read_b64_tr_b16 a[154:155], v14 offset:512
v_mfma_f32_16x16x32_bf16 v[160:163], a[116:119], a[92:95], v[160:163]
s_add_u32 m0, s80, 49152
s_add_u32 s64, s79, 2048
v_mov_b32 v107, 0
v_mfma_f32_16x16x32_bf16 v[160:163], a[112:115], a[88:91], v[160:163]
ds_read_b64_tr_b16 a[156:157], v14 offset:4096
ds_read_b64_tr_b16 a[158:159], v14 offset:4608
v_mfma_f32_16x16x32_bf16 v[228:231], a[184:187], a[88:91], v[228:231]
buffer_load_dwordx4 v15, s[24:27], s64 offen sc1 lds
v_mfma_f32_16x16x32_bf16 v[228:231], a[188:191], a[92:95], v[228:231]
s_xor_b32 s65, s70, 896
s_add_u32 s71, s68, s65
s_add_u32 s72, s69, s65
v_mfma_f32_16x16x32_bf16 v[168:171], a[180:183], a[92:95], v[168:171]
ds_read_b128 a[64:67], v4 offset:8192
v_mov_b32 v112, 0
v_mfma_f32_16x16x32_bf16 v[168:171], a[176:179], a[88:91], v[168:171]
v_mov_b32 v113, 0
v_mov_b32 v114, 0
v_mfma_f32_16x16x32_bf16 v[176:179], a[168:171], a[88:91], v[176:179]
s_add_u32 m0, s73, 32768
s_add_u32 s64, s71, 0
ds_read_b128 a[80:83], v9 offset:0
v_mfma_f32_16x16x32_bf16 v[176:179], a[172:175], a[92:95], v[176:179]
v_mov_b32 v115, 0
v_mov_b32 v120, 0
v_mfma_f32_16x16x32_bf16 v[80:83], a[164:167], a[92:95], v[80:83]
buffer_load_dwordx4 v5, s[12:15], s64 offen lds
v_mfma_f32_16x16x32_bf16 v[80:83], a[160:163], a[88:91], v[80:83]
s_add_u32 s53, s87, 524288
ds_read_b128 a[68:71], v4 offset:10240
v_mov_b32 v121, 0
v_mfma_f32_16x16x32_bf16 v[184:187], a[160:163], a[96:99], v[184:187]
ds_read_b128 a[84:87], v10 offset:0
v_mov_b32 v122, 0
v_mfma_f32_16x16x32_bf16 v[184:187], a[164:167], a[100:103], v[184:187]
buffer_store_dwordx4 a[28:31], v15, s[24:27], s53 offen offset:0 sc1
v_mfma_f32_16x16x32_bf16 v[248:251], a[172:175], a[100:103], v[248:251]
v_mov_b32 v123, 0
v_mov_b32 v128, 0
v_mfma_f32_16x16x32_bf16 v[248:251], a[168:171], a[96:99], v[248:251]
ds_read_b128 a[72:75], v4 offset:9216
v_mov_b32 v129, 0
v_mfma_f32_16x16x32_bf16 v[240:243], a[176:179], a[96:99], v[240:243]
buffer_load_dwordx4 v6, s[12:15], s64 offen offset:1024 lds
v_mfma_f32_16x16x32_bf16 v[240:243], a[180:183], a[100:103], v[240:243]
ds_read_b128 a[88:91], v9 offset:2048
v_mov_b32 v130, 0
v_mfma_f32_16x16x32_bf16 v[232:235], a[188:191], a[100:103], v[232:235]
v_mov_b32 v131, 0
v_mov_b32 v136, 0
v_mfma_f32_16x16x32_bf16 v[232:235], a[184:187], a[96:99], v[232:235]
ds_read_b128 a[76:79], v4 offset:11264
v_mov_b32 v137, 0
v_mfma_f32_16x16x32_bf16 v[236:239], a[112:115], a[96:99], v[236:239]
s_add_u32 m0, s73, 34816
s_add_u32 s64, s71, 18432
v_mov_b32 v138, 0
v_mfma_f32_16x16x32_bf16 v[236:239], a[116:119], a[100:103], v[236:239]
ds_read_b128 a[92:95], v10 offset:2048
v_mov_b32 v139, 0
v_mfma_f32_16x16x32_bf16 v[224:227], a[124:127], a[100:103], v[224:227]
buffer_load_dwordx4 v5, s[12:15], s64 offen lds
v_mfma_f32_16x16x32_bf16 v[224:227], a[120:123], a[96:99], v[224:227]
v_mov_b32 v144, 0
v_mov_b32 v145, 0
v_mfma_f32_16x16x32_bf16 v[208:211], a[120:123], a[104:107], v[208:211]
v_mov_b32 v146, 0
v_mov_b32 v147, 0
v_mfma_f32_16x16x32_bf16 v[208:211], a[124:127], a[108:111], v[208:211]
v_mov_b32 v152, 0
v_mov_b32 v153, 0
v_mfma_f32_16x16x32_bf16 v[216:219], a[116:119], a[108:111], v[216:219]
v_mov_b32 v154, 0
v_mov_b32 v155, 0
v_mfma_f32_16x16x32_bf16 v[216:219], a[112:115], a[104:107], v[216:219]
v_mfma_f32_16x16x32_bf16 v[244:247], a[184:187], a[104:107], v[244:247]
buffer_load_dwordx4 v6, s[12:15], s64 offen offset:1024 lds
v_mfma_f32_16x16x32_bf16 v[244:247], a[188:191], a[108:111], v[244:247]
v_mfma_f32_16x16x32_bf16 v[192:195], a[180:183], a[108:111], v[192:195]
v_mfma_f32_16x16x32_bf16 v[192:195], a[176:179], a[104:107], v[192:195]
v_mfma_f32_16x16x32_bf16 v[200:203], a[168:171], a[104:107], v[200:203]
v_mfma_f32_16x16x32_bf16 v[200:203], a[172:175], a[108:111], v[200:203]
v_mfma_f32_16x16x32_bf16 v[88:91], a[164:167], a[108:111], v[88:91]
v_mfma_f32_16x16x32_bf16 v[88:91], a[160:163], a[104:107], v[88:91]
s_waitcnt lgkmcnt(0)
v_mfma_f32_16x16x32_bf16 v[36:39], a[128:131], a[80:83], v[36:39]
s_waitcnt vmcnt(23)
v_mfma_f32_16x16x32_bf16 v[36:39], a[132:135], a[84:87], v[36:39]
s_barrier
v_mfma_f32_16x16x32_bf16 v[44:47], a[140:143], a[84:87], v[44:47]
s_add_u32 s53, s87, 524288
ds_read_b128 a[96:99], v9 offset:4096
v_mfma_f32_16x16x32_bf16 v[44:47], a[136:139], a[80:83], v[44:47]
s_xor_b32 s75, s93, 7
s_lshl_b32 s76, s75, 19
s_add_u32 s76, s76, s74
v_mfma_f32_16x16x32_bf16 v[32:35], a[144:147], a[80:83], v[32:35]
s_lshl_b32 s79, s75, 13
s_add_u32 s79, s79, s78
ds_read_b128 a[100:103], v10 offset:4096
v_mfma_f32_16x16x32_bf16 v[32:35], a[148:151], a[84:87], v[32:35]
s_add_u32 m0, s77, 0
s_add_u32 s64, s76, 0
ds_read_b128 a[104:107], v9 offset:6144
v_mfma_f32_16x16x32_bf16 v[52:55], a[156:159], a[84:87], v[52:55]
buffer_load_dwordx4 v7, s[20:23], s64 offen lds
v_mfma_f32_16x16x32_bf16 v[52:55], a[152:155], a[80:83], v[52:55]
ds_read_b64_tr_b16 a[160:161], v11 offset:16384
ds_read_b64_tr_b16 a[162:163], v11 offset:16896
v_mfma_f32_16x16x32_bf16 v[60:63], a[64:67], a[80:83], v[60:63]
buffer_store_dwordx4 a[20:23], v15, s[24:27], s53 offen offset:1024 sc1
v_mfma_f32_16x16x32_bf16 v[60:63], a[68:71], a[84:87], v[60:63]
ds_read_b128 a[108:111], v10 offset:6144
v_mfma_f32_16x16x32_bf16 v[68:71], a[76:79], a[84:87], v[68:71]
buffer_load_dwordx4 v8, s[20:23], s64 offen offset:1024 lds
v_mfma_f32_16x16x32_bf16 v[68:71], a[72:75], a[80:83], v[68:71]
ds_read_b64_tr_b16 a[164:165], v11 offset:20480
ds_read_b64_tr_b16 a[166:167], v11 offset:20992
v_mfma_f32_16x16x32_bf16 v[76:79], a[72:75], a[88:91], v[76:79]
v_add_u32 v9, -65536, v9
v_add_u32 v10, -65536, v10
v_mfma_f32_16x16x32_bf16 v[76:79], a[76:79], a[92:95], v[76:79]
ds_read_b64_tr_b16 a[168:169], v12 offset:16384
ds_read_b64_tr_b16 a[170:171], v12 offset:16896
v_mfma_f32_16x16x32_bf16 v[84:87], a[68:71], a[92:95], v[84:87]
s_add_u32 m0, s80, 0
s_add_u32 s64, s79, 0
v_mfma_f32_16x16x32_bf16 v[84:87], a[64:67], a[88:91], v[84:87]
ds_read_b64_tr_b16 a[172:173], v12 offset:20480
ds_read_b64_tr_b16 a[174:175], v12 offset:20992
v_mfma_f32_16x16x32_bf16 v[92:95], a[152:155], a[88:91], v[92:95]
buffer_load_dwordx4 v15, s[24:27], s64 offen sc1 lds
v_mfma_f32_16x16x32_bf16 v[92:95], a[156:159], a[92:95], v[92:95]
v_mfma_f32_16x16x32_bf16 v[40:43], a[148:151], a[92:95], v[40:43]
ds_read_b64_tr_b16 a[176:177], v13 offset:16384
ds_read_b64_tr_b16 a[178:179], v13 offset:16896
v_mfma_f32_16x16x32_bf16 v[40:43], a[144:147], a[88:91], v[40:43]
v_mfma_f32_16x16x32_bf16 v[100:103], a[136:139], a[88:91], v[100:103]
s_add_u32 m0, s73, 36864
s_add_u32 s64, s72, 0
v_mfma_f32_16x16x32_bf16 v[100:103], a[140:143], a[92:95], v[100:103]
ds_read_b64_tr_b16 a[180:181], v13 offset:20480
ds_read_b64_tr_b16 a[182:183], v13 offset:20992
v_mfma_f32_16x16x32_bf16 v[108:111], a[132:135], a[92:95], v[108:111]
buffer_load_dwordx4 v5, s[12:15], s64 offen lds
v_mfma_f32_16x16x32_bf16 v[108:111], a[128:131], a[88:91], v[108:111]
s_waitcnt lgkmcnt(14)
ds_read_b64_tr_b16 a[184:185], v14 offset:16384
ds_read_b64_tr_b16 a[186:187], v14 offset:16896
v_mfma_f32_16x16x32_bf16 v[116:119], a[128:131], a[96:99], v[116:119]
ds_read_b64_tr_b16 a[188:189], v14 offset:20480
ds_read_b64_tr_b16 a[190:191], v14 offset:20992
v_mfma_f32_16x16x32_bf16 v[116:119], a[132:135], a[100:103], v[116:119]
v_mfma_f32_16x16x32_bf16 v[124:127], a[140:143], a[100:103], v[124:127]
v_mfma_f32_16x16x32_bf16 v[124:127], a[136:139], a[96:99], v[124:127]
ds_read_b128 a[112:115], v4 offset:24576
v_mfma_f32_16x16x32_bf16 v[132:135], a[144:147], a[96:99], v[132:135]
buffer_load_dwordx4 v6, s[12:15], s64 offen offset:1024 lds
v_mfma_f32_16x16x32_bf16 v[132:135], a[148:151], a[100:103], v[132:135]
s_add_u32 s53, s87, 528384
ds_read_b128 a[116:119], v4 offset:26624
v_mfma_f32_16x16x32_bf16 v[140:143], a[156:159], a[100:103], v[140:143]
buffer_store_dwordx4 a[12:15], v15, s[24:27], s53 offen offset:0 sc1
v_mfma_f32_16x16x32_bf16 v[140:143], a[152:155], a[96:99], v[140:143]
ds_read_b128 a[120:123], v4 offset:25600
v_mfma_f32_16x16x32_bf16 v[148:151], a[64:67], a[96:99], v[148:151]
s_add_u32 m0, s73, 38912
s_add_u32 s64, s72, 18432
v_mfma_f32_16x16x32_bf16 v[148:151], a[68:71], a[100:103], v[148:151]
ds_read_b128 a[124:127], v4 offset:27648
v_mfma_f32_16x16x32_bf16 v[48:51], a[76:79], a[100:103], v[48:51]
buffer_load_dwordx4 v5, s[12:15], s64 offen lds
v_mfma_f32_16x16x32_bf16 v[48:51], a[72:75], a[96:99], v[48:51]
s_waitcnt lgkmcnt(15)
v_mfma_f32_16x16x32_bf16 v[156:159], a[72:75], a[104:107], v[156:159]
v_mfma_f32_16x16x32_bf16 v[156:159], a[76:79], a[108:111], v[156:159]
v_mfma_f32_16x16x32_bf16 v[164:167], a[68:71], a[108:111], v[164:167]
v_mfma_f32_16x16x32_bf16 v[164:167], a[64:67], a[104:107], v[164:167]
v_mfma_f32_16x16x32_bf16 v[172:175], a[152:155], a[104:107], v[172:175]
buffer_load_dwordx4 v6, s[12:15], s64 offen offset:1024 lds
v_mfma_f32_16x16x32_bf16 v[172:175], a[156:159], a[108:111], v[172:175]
v_mfma_f32_16x16x32_bf16 v[56:59], a[148:151], a[108:111], v[56:59]
v_mfma_f32_16x16x32_bf16 v[56:59], a[144:147], a[104:107], v[56:59]
v_mfma_f32_16x16x32_bf16 v[180:183], a[136:139], a[104:107], v[180:183]
v_mfma_f32_16x16x32_bf16 v[180:183], a[140:143], a[108:111], v[180:183]
v_mfma_f32_16x16x32_bf16 v[188:191], a[132:135], a[108:111], v[188:191]
v_mfma_f32_16x16x32_bf16 v[188:191], a[128:131], a[104:107], v[188:191]
s_waitcnt lgkmcnt(0)
v_mfma_f32_16x16x32_bf16 v[196:199], a[160:163], a[80:83], v[196:199]
s_waitcnt vmcnt(19)
v_mfma_f32_16x16x32_bf16 v[196:199], a[164:167], a[84:87], v[196:199]
s_barrier
v_mfma_f32_16x16x32_bf16 v[64:67], a[172:175], a[84:87], v[64:67]
ds_read_b64_tr_b16 a[128:129], v11 offset:32768
ds_read_b64_tr_b16 a[130:131], v11 offset:33280
v_mfma_f32_16x16x32_bf16 v[64:67], a[168:171], a[80:83], v[64:67]
s_add_u32 m0, s77, 16384
s_add_u32 s64, s76, 128
v_mfma_f32_16x16x32_bf16 v[204:207], a[176:179], a[80:83], v[204:207]
buffer_load_dwordx4 v7, s[20:23], s64 offen lds
v_mfma_f32_16x16x32_bf16 v[204:207], a[180:183], a[84:87], v[204:207]
ds_read_b64_tr_b16 a[132:133], v11 offset:36864
ds_read_b64_tr_b16 a[134:135], v11 offset:37376
v_mfma_f32_16x16x32_bf16 v[212:215], a[188:191], a[84:87], v[212:215]
ds_read_b64_tr_b16 a[136:137], v12 offset:32768
ds_read_b64_tr_b16 a[138:139], v12 offset:33280
v_mfma_f32_16x16x32_bf16 v[212:215], a[184:187], a[80:83], v[212:215]
s_add_u32 s53, s87, 528384
ds_read_b64_tr_b16 a[140:141], v12 offset:36864
ds_read_b64_tr_b16 a[142:143], v12 offset:37376
v_mfma_f32_16x16x32_bf16 v[72:75], a[112:115], a[80:83], v[72:75]
buffer_load_dwordx4 v8, s[20:23], s64 offen offset:1024 lds
v_mfma_f32_16x16x32_bf16 v[72:75], a[116:119], a[84:87], v[72:75]
ds_read_b64_tr_b16 a[144:145], v13 offset:32768
ds_read_b64_tr_b16 a[146:147], v13 offset:33280
v_mfma_f32_16x16x32_bf16 v[220:223], a[124:127], a[84:87], v[220:223]
buffer_store_dwordx4 a[4:7], v15, s[24:27], s53 offen offset:1024 sc1
v_mfma_f32_16x16x32_bf16 v[220:223], a[120:123], a[80:83], v[220:223]
s_add_u32 m0, s80, 16384
s_add_u32 s64, s79, 2048
v_mfma_f32_16x16x32_bf16 v[252:255], a[120:123], a[88:91], v[252:255]
ds_read_b64_tr_b16 a[148:149], v13 offset:36864
ds_read_b64_tr_b16 a[150:151], v13 offset:37376
v_mfma_f32_16x16x32_bf16 v[252:255], a[124:127], a[92:95], v[252:255]
buffer_load_dwordx4 v15, s[24:27], s64 offen sc1 lds
v_mfma_f32_16x16x32_bf16 v[160:163], a[116:119], a[92:95], v[160:163]
ds_read_b64_tr_b16 a[152:153], v14 offset:32768
ds_read_b64_tr_b16 a[154:155], v14 offset:33280
v_mfma_f32_16x16x32_bf16 v[160:163], a[112:115], a[88:91], v[160:163]
ds_read_b64_tr_b16 a[156:157], v14 offset:36864
ds_read_b64_tr_b16 a[158:159], v14 offset:37376
v_mfma_f32_16x16x32_bf16 v[228:231], a[184:187], a[88:91], v[228:231]
s_add_u32 m0, s83, 0
s_add_u32 s64, s81, 0
v_mfma_f32_16x16x32_bf16 v[228:231], a[188:191], a[92:95], v[228:231]
v_mfma_f32_16x16x32_bf16 v[168:171], a[180:183], a[92:95], v[168:171]
buffer_load_dwordx4 v22, s[32:35], s64 offen lds
v_mfma_f32_16x16x32_bf16 v[168:171], a[176:179], a[88:91], v[168:171]
ds_read_b128 a[64:67], v4 offset:40960
v_mfma_f32_16x16x32_bf16 v[176:179], a[168:171], a[88:91], v[176:179]
s_add_u32 m0, s83, 1024
s_add_u32 s64, s81, 9216
ds_read_b128 a[80:83], v9 offset:0
v_mfma_f32_16x16x32_bf16 v[176:179], a[172:175], a[92:95], v[176:179]
v_mfma_f32_16x16x32_bf16 v[80:83], a[164:167], a[92:95], v[80:83]
buffer_load_dwordx4 v22, s[32:35], s64 offen lds
v_mfma_f32_16x16x32_bf16 v[80:83], a[160:163], a[88:91], v[80:83]
ds_read_b128 a[68:71], v4 offset:43008
v_mfma_f32_16x16x32_bf16 v[184:187], a[160:163], a[96:99], v[184:187]
ds_read_b128 a[84:87], v10 offset:0
v_mfma_f32_16x16x32_bf16 v[184:187], a[164:167], a[100:103], v[184:187]
s_add_u32 m0, s83, 2048
s_add_u32 s64, s81, 18432
v_mfma_f32_16x16x32_bf16 v[248:251], a[172:175], a[100:103], v[248:251]
v_mfma_f32_16x16x32_bf16 v[248:251], a[168:171], a[96:99], v[248:251]
buffer_load_dwordx4 v22, s[32:35], s64 offen lds
v_mfma_f32_16x16x32_bf16 v[240:243], a[176:179], a[96:99], v[240:243]
ds_read_b128 a[72:75], v4 offset:41984
v_mfma_f32_16x16x32_bf16 v[240:243], a[180:183], a[100:103], v[240:243]
ds_read_b128 a[88:91], v9 offset:2048
v_mfma_f32_16x16x32_bf16 v[232:235], a[188:191], a[100:103], v[232:235]
s_add_u32 m0, s83, 3072
s_add_u32 s64, s81, 27648
v_mfma_f32_16x16x32_bf16 v[232:235], a[184:187], a[96:99], v[232:235]
ds_read_b128 a[76:79], v4 offset:44032
v_mfma_f32_16x16x32_bf16 v[236:239], a[112:115], a[96:99], v[236:239]
buffer_load_dwordx4 v22, s[32:35], s64 offen lds
v_mfma_f32_16x16x32_bf16 v[236:239], a[116:119], a[100:103], v[236:239]
ds_read_b128 a[92:95], v10 offset:2048
v_mfma_f32_16x16x32_bf16 v[224:227], a[124:127], a[100:103], v[224:227]
s_add_u32 m0, s83, 4096
s_add_u32 s64, s81, 128
s_add_u32 s53, s87, 786432
v_mfma_f32_16x16x32_bf16 v[224:227], a[120:123], a[96:99], v[224:227]
buffer_store_dwordx4 a[0:3], v15, s[24:27], s53 offen offset:0 sc1
v_mfma_f32_16x16x32_bf16 v[208:211], a[120:123], a[104:107], v[208:211]
buffer_load_dwordx4 v24, s[32:35], s64 offen lds
v_mfma_f32_16x16x32_bf16 v[208:211], a[124:127], a[108:111], v[208:211]
s_waitcnt vmcnt(26)
v_mfma_f32_16x16x32_bf16 v[216:219], a[116:119], a[108:111], v[216:219]
v_cmp_gt_u32 vcc, 8, v30
v_mfma_f32_16x16x32_bf16 v[216:219], a[112:115], a[104:107], v[216:219]
s_add_u32 m0, s83, 5120
s_add_u32 s64, s82, 0
v_mfma_f32_16x16x32_bf16 v[244:247], a[184:187], a[104:107], v[244:247]
v_mfma_f32_16x16x32_bf16 v[244:247], a[188:191], a[108:111], v[244:247]
buffer_load_dwordx4 v25, s[48:51], s64 offen lds
v_mfma_f32_16x16x32_bf16 v[192:195], a[180:183], a[108:111], v[192:195]
v_mfma_f32_16x16x32_bf16 v[192:195], a[176:179], a[104:107], v[192:195]
s_cbranch_vccnz CK_KV
CK_KV_R:
v_mfma_f32_16x16x32_bf16 v[200:203], a[168:171], a[104:107], v[200:203]
v_mfma_f32_16x16x32_bf16 v[200:203], a[172:175], a[108:111], v[200:203]
v_mfma_f32_16x16x32_bf16 v[88:91], a[164:167], a[108:111], v[88:91]
v_mfma_f32_16x16x32_bf16 v[88:91], a[160:163], a[104:107], v[88:91]
s_waitcnt lgkmcnt(0)
v_mfma_f32_16x16x32_bf16 v[36:39], a[128:131], a[80:83], v[36:39]
s_waitcnt vmcnt(25)
v_mov_b32 v6, 0xf149f2ca
v_mfma_f32_16x16x32_bf16 v[36:39], a[132:135], a[84:87], v[36:39]
s_barrier
v_mfma_f32_16x16x32_bf16 v[44:47], a[140:143], a[84:87], v[44:47]
ds_read_b128 a[96:99], v9 offset:4096
v_mfma_f32_16x16x32_bf16 v[44:47], a[136:139], a[80:83], v[44:47]
s_lshl_b32 s70, s3, 12
s_add_u32 s68, s70, s94
ds_read_b128 a[100:103], v10 offset:4096
v_mfma_f32_16x16x32_bf16 v[32:35], a[144:147], a[80:83], v[32:35]
s_add_u32 m0, s70, 32768
s_cmp_lt_u32 s3, 2
s_cselect_b32 s64, s68, 2147418112
v_mfma_f32_16x16x32_bf16 v[32:35], a[148:151], a[84:87], v[32:35]
buffer_load_dwordx4 v15, s[24:27], s64 offen offset:0 sc1 lds
v_mfma_f32_16x16x32_bf16 v[52:55], a[156:159], a[84:87], v[52:55]
ds_read_b128 a[104:107], v9 offset:6144
v_mfma_f32_16x16x32_bf16 v[52:55], a[152:155], a[80:83], v[52:55]
ds_read_b64_tr_b16 a[160:161], v11 offset:49152
ds_read_b64_tr_b16 a[162:163], v11 offset:49664
v_mfma_f32_16x16x32_bf16 v[60:63], a[64:67], a[80:83], v[60:63]
s_cmp_eq_u32 s66, 0
s_cbranch_scc1 D0
D0_R:
v_mfma_f32_16x16x32_bf16 v[60:63], a[68:71], a[84:87], v[60:63]
s_lshl_b32 s52, s4, 18
s_add_u32 s52, s52, 45088768
ds_read_b128 a[108:111], v10 offset:6144
v_mfma_f32_16x16x32_bf16 v[68:71], a[76:79], a[84:87], v[68:71]
s_lshl_b32 s54, s66, 9
v_add_u32 v9, 32768, v9
v_add_u32 v10, 32768, v10
v_mfma_f32_16x16x32_bf16 v[68:71], a[72:75], a[80:83], v[68:71]
s_add_u32 s54, s54, s52
ds_read_b64_tr_b16 a[164:165], v11 offset:53248
ds_read_b64_tr_b16 a[166:167], v11 offset:53760
v_mfma_f32_16x16x32_bf16 v[76:79], a[72:75], a[88:91], v[76:79]
s_lshl_b32 s55, s67, 9
s_add_u32 s55, s55, s52
v_mfma_f32_16x16x32_bf16 v[76:79], a[76:79], a[92:95], v[76:79]
s_add_u32 s53, s87, 786432
ds_read_b64_tr_b16 a[168:169], v12 offset:49152
ds_read_b64_tr_b16 a[170:171], v12 offset:49664
v_mfma_f32_16x16x32_bf16 v[84:87], a[68:71], a[92:95], v[84:87]
buffer_load_dwordx4 v15, s[24:27], s64 offen offset:1024 sc1 lds
v_mfma_f32_16x16x32_bf16 v[84:87], a[64:67], a[88:91], v[84:87]
s_max_u32 s65, s66, 1
ds_read_b64_tr_b16 a[172:173], v12 offset:53248
ds_read_b64_tr_b16 a[174:175], v12 offset:53760
L_PAD7:
s_cbranch_execz L_PAD11
v_mfma_f32_16x16x32_bf16 v[92:95], a[152:155], a[88:91], v[92:95]
buffer_store_dwordx4 a[8:11], v15, s[24:27], s53 offen offset:1024 sc1
v_mfma_f32_16x16x32_bf16 v[92:95], a[156:159], a[92:95], v[92:95]
s_lshl_b32 s65, s65, 9
s_add_u32 s52, s52, s65
s_sub_u32 s65, s55, s52
v_mfma_f32_16x16x32_bf16 v[40:43], a[148:151], a[92:95], v[40:43]
s_sub_u32 s65, s65, 163840
ds_read_b64_tr_b16 a[176:177], v13 offset:49152
ds_read_b64_tr_b16 a[178:179], v13 offset:49664
v_mfma_f32_16x16x32_bf16 v[40:43], a[144:147], a[88:91], v[40:43]
s_add_u32 s52, s52, 65280
v_mfma_f32_16x16x32_bf16 v[100:103], a[136:139], a[88:91], v[100:103]
ds_read_b64_tr_b16 a[180:181], v13 offset:53248
ds_read_b64_tr_b16 a[182:183], v13 offset:53760
v_mfma_f32_16x16x32_bf16 v[100:103], a[140:143], a[92:95], v[100:103]
v_cmp_lt_u32 s[96:97], 0, v3
v_lshlrev_b32 v16, 15, v3
v_mfma_f32_16x16x32_bf16 v[108:111], a[132:135], a[92:95], v[108:111]
ds_read_b64_tr_b16 a[184:185], v14 offset:49152
ds_read_b64_tr_b16 a[186:187], v14 offset:49664
v_mfma_f32_16x16x32_bf16 v[108:111], a[128:131], a[88:91], v[108:111]
s_waitcnt lgkmcnt(15)
v_lshl_add_u32 v16, v2, 4, v16
v_add_u32 v16, s52, v16
v_mfma_f32_16x16x32_bf16 v[116:119], a[128:131], a[96:99], v[116:119]
ds_read_b64_tr_b16 a[188:189], v14 offset:53248
ds_read_b64_tr_b16 a[190:191], v14 offset:53760
v_mfma_f32_16x16x32_bf16 v[116:119], a[132:135], a[100:103], v[116:119]
buffer_load_dwordx4 v15, s[24:27], s64 offen offset:2048 sc1 lds
v_mfma_f32_16x16x32_bf16 v[124:127], a[140:143], a[100:103], v[124:127]
v_accvgpr_write_b32 a244, v16
v_add_u32 v16, 131072, v16
v_mfma_f32_16x16x32_bf16 v[124:127], a[136:139], a[96:99], v[124:127]
ds_read_b128 a[112:115], v4 offset:57344
v_add_u32 v21, s65, v16
v_mfma_f32_16x16x32_bf16 v[132:135], a[144:147], a[96:99], v[132:135]
v_cndmask_b32 v16, v16, v21, s[96:97]
v_accvgpr_write_b32 a248, v16
v_mfma_f32_16x16x32_bf16 v[132:135], a[148:151], a[100:103], v[132:135]
ds_read_b128 a[116:119], v4 offset:59392
v_cmp_lt_u32 s[96:97], 1, v3
v_mfma_f32_16x16x32_bf16 v[140:143], a[156:159], a[100:103], v[140:143]
v_add_u32 v21, 131072, v21
v_mfma_f32_16x16x32_bf16 v[140:143], a[152:155], a[96:99], v[140:143]
ds_read_b128 a[120:123], v4 offset:58368
v_cndmask_b32 v21, v21, v20, s[96:97]
v_mfma_f32_16x16x32_bf16 v[148:151], a[64:67], a[96:99], v[148:151]
v_accvgpr_write_b32 a252, v21
v_mfma_f32_16x16x32_bf16 v[148:151], a[68:71], a[100:103], v[148:151]
ds_read_b128 a[124:127], v4 offset:60416
v_mfma_f32_16x16x32_bf16 v[48:51], a[76:79], a[100:103], v[48:51]
s_waitcnt lgkmcnt(15)
v_mfma_f32_16x16x32_bf16 v[48:51], a[72:75], a[96:99], v[48:51]
buffer_load_dwordx4 v15, s[24:27], s64 offen offset:3072 sc1 lds
v_mfma_f32_16x16x32_bf16 v[156:159], a[72:75], a[104:107], v[156:159]
v_mfma_f32_16x16x32_bf16 v[156:159], a[76:79], a[108:111], v[156:159]
v_mfma_f32_16x16x32_bf16 v[164:167], a[68:71], a[108:111], v[164:167]
v_mfma_f32_16x16x32_bf16 v[164:167], a[64:67], a[104:107], v[164:167]
v_mfma_f32_16x16x32_bf16 v[172:175], a[152:155], a[104:107], v[172:175]
s_add_u32 s53, s87, 790528
v_mfma_f32_16x16x32_bf16 v[172:175], a[156:159], a[108:111], v[172:175]
buffer_store_dwordx4 a[16:19], v15, s[24:27], s53 offen offset:0 sc1
v_mfma_f32_16x16x32_bf16 v[56:59], a[148:151], a[108:111], v[56:59]
v_mfma_f32_16x16x32_bf16 v[56:59], a[144:147], a[104:107], v[56:59]
v_mfma_f32_16x16x32_bf16 v[180:183], a[136:139], a[104:107], v[180:183]
v_mfma_f32_16x16x32_bf16 v[180:183], a[140:143], a[108:111], v[180:183]
v_mfma_f32_16x16x32_bf16 v[188:191], a[132:135], a[108:111], v[188:191]
v_mfma_f32_16x16x32_bf16 v[188:191], a[128:131], a[104:107], v[188:191]
s_waitcnt lgkmcnt(0)
v_mfma_f32_16x16x32_bf16 v[196:199], a[160:163], a[80:83], v[196:199]
s_waitcnt vmcnt(17)
v_mfma_f32_16x16x32_bf16 v[196:199], a[164:167], a[84:87], v[196:199]
s_barrier
v_mfma_f32_16x16x32_bf16 v[64:67], a[172:175], a[84:87], v[64:67]
ds_read_b64_tr_b16 a[128:129], v11 offset:0
ds_read_b64_tr_b16 a[130:131], v11 offset:512
v_mfma_f32_16x16x32_bf16 v[64:67], a[168:171], a[80:83], v[64:67]
s_add_u32 m0, s70, 49152
s_add_u32 s64, s68, 16384
s_waitcnt vmcnt(6)
v_mfma_f32_16x16x32_bf16 v[204:207], a[176:179], a[80:83], v[204:207]
buffer_load_dwordx4 v15, s[24:27], s64 offen offset:0 sc1 lds
v_mfma_f32_16x16x32_bf16 v[204:207], a[180:183], a[84:87], v[204:207]
ds_read_b64_tr_b16 a[132:133], v11 offset:4096
ds_read_b64_tr_b16 a[134:135], v11 offset:4608
v_mfma_f32_16x16x32_bf16 v[212:215], a[188:191], a[84:87], v[212:215]
ds_read_b64_tr_b16 a[136:137], v12 offset:0
ds_read_b64_tr_b16 a[138:139], v12 offset:512
v_mfma_f32_16x16x32_bf16 v[212:215], a[184:187], a[80:83], v[212:215]
ds_read_b64_tr_b16 a[140:141], v12 offset:4096
ds_read_b64_tr_b16 a[142:143], v12 offset:4608
v_mfma_f32_16x16x32_bf16 v[72:75], a[112:115], a[80:83], v[72:75]
ds_read_b64_tr_b16 a[192:193], v23 offset:0
ds_read_b64_tr_b16 a[194:195], v23 offset:2048
v_mfma_f32_16x16x32_bf16 v[72:75], a[116:119], a[84:87], v[72:75]
ds_read_b64_tr_b16 a[144:145], v13 offset:0
ds_read_b64_tr_b16 a[146:147], v13 offset:512
v_mfma_f32_16x16x32_bf16 v[220:223], a[124:127], a[84:87], v[220:223]
ds_read_b64_tr_b16 a[196:197], v23 offset:32
ds_read_b64_tr_b16 a[198:199], v23 offset:2080
v_mfma_f32_16x16x32_bf16 v[220:223], a[120:123], a[80:83], v[220:223]
ds_read_b64_tr_b16 a[148:149], v13 offset:4096
ds_read_b64_tr_b16 a[150:151], v13 offset:4608
v_mfma_f32_16x16x32_bf16 v[252:255], a[120:123], a[88:91], v[252:255]
ds_read_b64_tr_b16 a[200:201], v23 offset:64
ds_read_b64_tr_b16 a[202:203], v23 offset:2112
v_mfma_f32_16x16x32_bf16 v[252:255], a[124:127], a[92:95], v[252:255]
ds_read_b64_tr_b16 a[152:153], v14 offset:0
ds_read_b64_tr_b16 a[154:155], v14 offset:512
v_mfma_f32_16x16x32_bf16 v[160:163], a[116:119], a[92:95], v[160:163]
buffer_load_dwordx4 v15, s[24:27], s64 offen offset:1024 sc1 lds
v_mfma_f32_16x16x32_bf16 v[160:163], a[112:115], a[88:91], v[160:163]
ds_read_b64_tr_b16 a[156:157], v14 offset:4096
ds_read_b64_tr_b16 a[158:159], v14 offset:4608
v_mfma_f32_16x16x32_bf16 v[228:231], a[184:187], a[88:91], v[228:231]
ds_read_b64_tr_b16 a[204:205], v23 offset:96
ds_read_b64_tr_b16 a[206:207], v23 offset:2144
v_mfma_f32_16x16x32_bf16 v[228:231], a[188:191], a[92:95], v[228:231]
ds_read_b64_tr_b16 a[208:209], v27 offset:4096
ds_read_b64_tr_b16 a[210:211], v27 offset:4608
v_mfma_f32_16x16x32_bf16 v[168:171], a[180:183], a[92:95], v[168:171]
ds_read_b128 a[64:67], v4 offset:8192
v_mfma_f32_16x16x32_bf16 v[168:171], a[176:179], a[88:91], v[168:171]
s_add_u32 s53, s87, 790528
ds_read_b64_tr_b16 a[212:213], v27 offset:5120
ds_read_b64_tr_b16 a[214:215], v27 offset:5632
v_mfma_f32_16x16x32_bf16 v[176:179], a[168:171], a[88:91], v[176:179]
ds_read_b128 a[80:83], v9 offset:0
v_readlane_b32 s81, v26, 0
v_mfma_f32_16x16x32_bf16 v[176:179], a[172:175], a[92:95], v[176:179]
buffer_store_dwordx4 a[24:27], v15, s[24:27], s53 offen offset:1024 sc1
v_mfma_f32_16x16x32_bf16 v[80:83], a[164:167], a[92:95], v[80:83]
ds_read_b128 a[68:71], v4 offset:10240
v_readlane_b32 s82, v26, 1
v_mfma_f32_16x16x32_bf16 v[80:83], a[160:163], a[88:91], v[80:83]
v_readlane_b32 s71, v26, 2
v_readlane_b32 s72, v26, 3
v_mfma_f32_16x16x32_bf16 v[184:187], a[160:163], a[96:99], v[184:187]
ds_read_b128 a[84:87], v10 offset:0
v_readlane_b32 s74, v26, 4
v_mfma_f32_16x16x32_bf16 v[184:187], a[164:167], a[100:103], v[184:187]
buffer_load_dwordx4 v15, s[24:27], s64 offen offset:2048 sc1 lds
v_mfma_f32_16x16x32_bf16 v[248:251], a[172:175], a[100:103], v[248:251]
v_readlane_b32 s75, v26, 5
v_mfma_f32_16x16x32_bf16 v[248:251], a[168:171], a[96:99], v[248:251]
ds_read_b128 a[72:75], v4 offset:9216
v_mfma_f32_16x16x32_bf16 v[240:243], a[176:179], a[96:99], v[240:243]
v_mfma_f32_16x16x32_bf16 v[240:243], a[180:183], a[100:103], v[240:243]
ds_read_b128 a[88:91], v9 offset:2048
v_mfma_f32_16x16x32_bf16 v[232:235], a[188:191], a[100:103], v[232:235]
v_mfma_f32_16x16x32_bf16 v[232:235], a[184:187], a[96:99], v[232:235]
ds_read_b128 a[76:79], v4 offset:11264
v_mfma_f32_16x16x32_bf16 v[236:239], a[112:115], a[96:99], v[236:239]
v_mfma_f32_16x16x32_bf16 v[236:239], a[116:119], a[100:103], v[236:239]
ds_read_b128 a[92:95], v10 offset:2048
v_mfma_f32_16x16x32_bf16 v[224:227], a[124:127], a[100:103], v[224:227]
v_mfma_f32_16x16x32_bf16 v[224:227], a[120:123], a[96:99], v[224:227]
buffer_load_dwordx4 v15, s[24:27], s64 offen offset:3072 sc1 lds
v_mfma_f32_16x16x32_bf16 v[208:211], a[120:123], a[104:107], v[208:211]
v_mfma_f32_16x16x32_bf16 v[208:211], a[124:127], a[108:111], v[208:211]
v_mfma_f32_16x16x32_bf16 v[216:219], a[116:119], a[108:111], v[216:219]
v_mfma_f32_16x16x32_bf16 v[216:219], a[112:115], a[104:107], v[216:219]
v_mfma_f32_16x16x32_bf16 v[244:247], a[184:187], a[104:107], v[244:247]
v_mfma_f32_16x16x32_bf16 v[244:247], a[188:191], a[108:111], v[244:247]
v_mfma_f32_16x16x32_bf16 v[192:195], a[180:183], a[108:111], v[192:195]
v_mfma_f32_16x16x32_bf16 v[192:195], a[176:179], a[104:107], v[192:195]
v_mfma_f32_16x16x32_bf16 v[200:203], a[168:171], a[104:107], v[200:203]
v_mfma_f32_16x16x32_bf16 v[200:203], a[172:175], a[108:111], v[200:203]
v_mfma_f32_16x16x32_bf16 v[88:91], a[164:167], a[108:111], v[88:91]
v_mfma_f32_16x16x32_bf16 v[88:91], a[160:163], a[104:107], v[88:91]
s_waitcnt lgkmcnt(0)
v_mfma_f32_16x16x32_bf16 v[36:39], a[128:131], a[80:83], v[36:39]
s_waitcnt vmcnt(18)
v_mfma_f32_16x16x32_bf16 v[36:39], a[132:135], a[84:87], v[36:39]
s_barrier
v_mfma_f32_16x16x32_bf16 v[44:47], a[140:143], a[84:87], v[44:47]
ds_read_b128 a[96:99], v9 offset:4096
v_mfma_f32_16x16x32_bf16 v[44:47], a[136:139], a[80:83], v[44:47]
s_add_u32 m0, s70, 65536
s_add_u32 s64, s68, 32768
ds_read_b128 a[100:103], v10 offset:4096
v_mfma_f32_16x16x32_bf16 v[32:35], a[144:147], a[80:83], v[32:35]
buffer_load_dwordx4 v15, s[24:27], s64 offen offset:0 sc1 lds
v_mfma_f32_16x16x32_bf16 v[32:35], a[148:151], a[84:87], v[32:35]
ds_read_b128 a[104:107], v9 offset:6144
v_mfma_f32_16x16x32_bf16 v[52:55], a[156:159], a[84:87], v[52:55]
ds_read_b64_tr_b16 a[160:161], v11 offset:16384
ds_read_b64_tr_b16 a[162:163], v11 offset:16896
v_mfma_f32_16x16x32_bf16 v[52:55], a[152:155], a[80:83], v[52:55]
buffer_store_dwordx4 a[192:195], v15, s[24:27], s81 offen sc1
v_mfma_f32_16x16x32_bf16 v[60:63], a[64:67], a[80:83], v[60:63]
v_mfma_f32_16x16x32_bf16 v[60:63], a[68:71], a[84:87], v[60:63]
ds_read_b128 a[108:111], v10 offset:6144
v_mfma_f32_16x16x32_bf16 v[68:71], a[76:79], a[84:87], v[68:71]
v_cvt_pk_bf16_f32 v36, v36, v37
v_cvt_pk_bf16_f32 v37, v38, v39
v_mfma_f32_16x16x32_bf16 v[68:71], a[72:75], a[80:83], v[68:71]
ds_read_b64_tr_b16 a[164:165], v11 offset:20480
ds_read_b64_tr_b16 a[166:167], v11 offset:20992
v_mfma_f32_16x16x32_bf16 v[76:79], a[72:75], a[88:91], v[76:79]
buffer_store_dwordx4 a[196:199], v15, s[24:27], s82 offen sc1
v_mfma_f32_16x16x32_bf16 v[76:79], a[76:79], a[92:95], v[76:79]
ds_read_b64_tr_b16 a[168:169], v12 offset:16384
ds_read_b64_tr_b16 a[170:171], v12 offset:16896
v_mfma_f32_16x16x32_bf16 v[84:87], a[68:71], a[92:95], v[84:87]
buffer_load_dwordx4 v15, s[24:27], s64 offen offset:1024 sc1 lds
v_mfma_f32_16x16x32_bf16 v[84:87], a[64:67], a[88:91], v[84:87]
ds_read_b64_tr_b16 a[172:173], v12 offset:20480
ds_read_b64_tr_b16 a[174:175], v12 offset:20992
v_mfma_f32_16x16x32_bf16 v[92:95], a[152:155], a[88:91], v[92:95]
v_cvt_pk_bf16_f32 v38, v44, v45
v_cvt_pk_bf16_f32 v39, v46, v47
v_mfma_f32_16x16x32_bf16 v[92:95], a[156:159], a[92:95], v[92:95]
buffer_store_dwordx4 a[200:203], v15, s[24:27], s71 offen sc1
v_mfma_f32_16x16x32_bf16 v[40:43], a[148:151], a[92:95], v[40:43]
ds_read_b64_tr_b16 a[176:177], v13 offset:16384
ds_read_b64_tr_b16 a[178:179], v13 offset:16896
v_mfma_f32_16x16x32_bf16 v[40:43], a[144:147], a[88:91], v[40:43]
v_accvgpr_write_b32 a32, v36
v_accvgpr_write_b32 a33, v37
v_mfma_f32_16x16x32_bf16 v[100:103], a[136:139], a[88:91], v[100:103]
ds_read_b64_tr_b16 a[180:181], v13 offset:20480
ds_read_b64_tr_b16 a[182:183], v13 offset:20992
v_mfma_f32_16x16x32_bf16 v[100:103], a[140:143], a[92:95], v[100:103]
v_accvgpr_write_b32 a34, v38
v_accvgpr_write_b32 a35, v39
v_mfma_f32_16x16x32_bf16 v[108:111], a[132:135], a[92:95], v[108:111]
ds_read_b64_tr_b16 a[184:185], v14 offset:16384
ds_read_b64_tr_b16 a[186:187], v14 offset:16896
v_mfma_f32_16x16x32_bf16 v[108:111], a[128:131], a[88:91], v[108:111]
s_waitcnt lgkmcnt(15)
v_cvt_pk_bf16_f32 v32, v32, v33
v_cvt_pk_bf16_f32 v33, v34, v35
v_mfma_f32_16x16x32_bf16 v[116:119], a[128:131], a[96:99], v[116:119]
ds_read_b64_tr_b16 a[188:189], v14 offset:20480
ds_read_b64_tr_b16 a[190:191], v14 offset:20992
v_mfma_f32_16x16x32_bf16 v[116:119], a[132:135], a[100:103], v[116:119]
buffer_load_dwordx4 v15, s[24:27], s64 offen offset:2048 sc1 lds
v_mfma_f32_16x16x32_bf16 v[124:127], a[140:143], a[100:103], v[124:127]
buffer_store_dwordx4 a[204:207], v15, s[24:27], s72 offen sc1
v_mfma_f32_16x16x32_bf16 v[124:127], a[136:139], a[96:99], v[124:127]
ds_read_b128 a[112:115], v4 offset:24576
v_cvt_pk_bf16_f32 v34, v52, v53
v_mfma_f32_16x16x32_bf16 v[132:135], a[144:147], a[96:99], v[132:135]
v_cvt_pk_bf16_f32 v35, v54, v55
v_accvgpr_write_b32 a36, v32
v_mfma_f32_16x16x32_bf16 v[132:135], a[148:151], a[100:103], v[132:135]
ds_read_b128 a[116:119], v4 offset:26624
v_accvgpr_write_b32 a37, v33
v_mfma_f32_16x16x32_bf16 v[140:143], a[156:159], a[100:103], v[140:143]
v_accvgpr_write_b32 a38, v34
v_accvgpr_write_b32 a39, v35
v_mfma_f32_16x16x32_bf16 v[140:143], a[152:155], a[96:99], v[140:143]
ds_read_b128 a[120:123], v4 offset:25600
v_cvt_pk_bf16_f32 v40, v40, v41
v_mfma_f32_16x16x32_bf16 v[148:151], a[64:67], a[96:99], v[148:151]
buffer_store_dwordx4 a[208:211], v15, s[24:27], s74 offen sc1
v_mfma_f32_16x16x32_bf16 v[148:151], a[68:71], a[100:103], v[148:151]
ds_read_b128 a[124:127], v4 offset:27648
v_cvt_pk_bf16_f32 v41, v42, v43
v_mfma_f32_16x16x32_bf16 v[48:51], a[76:79], a[100:103], v[48:51]
s_waitcnt lgkmcnt(15)
v_cvt_pk_bf16_f32 v42, v92, v93
v_cvt_pk_bf16_f32 v43, v94, v95
v_mfma_f32_16x16x32_bf16 v[48:51], a[72:75], a[96:99], v[48:51]
buffer_load_dwordx4 v15, s[24:27], s64 offen offset:3072 sc1 lds
v_mfma_f32_16x16x32_bf16 v[156:159], a[72:75], a[104:107], v[156:159]
v_accvgpr_write_b32 a40, v40
v_accvgpr_write_b32 a41, v41
v_mfma_f32_16x16x32_bf16 v[156:159], a[76:79], a[108:111], v[156:159]
buffer_store_dwordx4 a[212:215], v15, s[24:27], s75 offen sc1
v_mfma_f32_16x16x32_bf16 v[164:167], a[68:71], a[108:111], v[164:167]
v_accvgpr_write_b32 a42, v42
v_accvgpr_write_b32 a43, v43
v_mfma_f32_16x16x32_bf16 v[164:167], a[64:67], a[104:107], v[164:167]
v_cvt_pk_bf16_f32 v108, v108, v109
v_cvt_pk_bf16_f32 v109, v110, v111
v_mfma_f32_16x16x32_bf16 v[172:175], a[152:155], a[104:107], v[172:175]
v_cvt_pk_bf16_f32 v110, v100, v101
v_cvt_pk_bf16_f32 v111, v102, v103
v_mfma_f32_16x16x32_bf16 v[172:175], a[156:159], a[108:111], v[172:175]
v_accvgpr_write_b32 a44, v108
v_accvgpr_write_b32 a45, v109
v_mfma_f32_16x16x32_bf16 v[56:59], a[148:151], a[108:111], v[56:59]
v_accvgpr_write_b32 a46, v110
v_accvgpr_write_b32 a47, v111
v_mfma_f32_16x16x32_bf16 v[56:59], a[144:147], a[104:107], v[56:59]
v_cvt_pk_bf16_f32 v116, v116, v117
v_cvt_pk_bf16_f32 v117, v118, v119
v_mfma_f32_16x16x32_bf16 v[180:183], a[136:139], a[104:107], v[180:183]
v_cvt_pk_bf16_f32 v118, v124, v125
v_cvt_pk_bf16_f32 v119, v126, v127
v_mfma_f32_16x16x32_bf16 v[180:183], a[140:143], a[108:111], v[180:183]
v_accvgpr_write_b32 a48, v116
v_accvgpr_write_b32 a49, v117
v_mfma_f32_16x16x32_bf16 v[188:191], a[132:135], a[108:111], v[188:191]
v_accvgpr_write_b32 a50, v118
v_accvgpr_write_b32 a51, v119
v_mfma_f32_16x16x32_bf16 v[188:191], a[128:131], a[104:107], v[188:191]
s_waitcnt lgkmcnt(0)
v_cvt_pk_bf16_f32 v132, v132, v133
v_cvt_pk_bf16_f32 v133, v134, v135
v_mfma_f32_16x16x32_bf16 v[196:199], a[160:163], a[80:83], v[196:199]
s_waitcnt vmcnt(16)
v_cvt_pk_bf16_f32 v134, v140, v141
v_cvt_pk_bf16_f32 v135, v142, v143
v_mfma_f32_16x16x32_bf16 v[196:199], a[164:167], a[84:87], v[196:199]
s_barrier
v_mfma_f32_16x16x32_bf16 v[64:67], a[172:175], a[84:87], v[64:67]
ds_read_b128 a[192:195], v4 offset:32768
v_accvgpr_write_b32 a52, v132
v_mfma_f32_16x16x32_bf16 v[64:67], a[168:171], a[80:83], v[64:67]
s_add_u32 m0, s70, 81920
s_add_u32 s64, s68, 49152
v_accvgpr_write_b32 a53, v133
v_mfma_f32_16x16x32_bf16 v[204:207], a[176:179], a[80:83], v[204:207]
buffer_load_dwordx4 v15, s[24:27], s64 offen offset:0 sc1 lds
v_mfma_f32_16x16x32_bf16 v[204:207], a[180:183], a[84:87], v[204:207]
ds_read_b128 a[196:199], v4 offset:33792
v_accvgpr_write_b32 a54, v134
v_mfma_f32_16x16x32_bf16 v[212:215], a[188:191], a[84:87], v[212:215]
v_accvgpr_write_b32 a55, v135
v_cvt_pk_bf16_f32 v56, v56, v57
v_mfma_f32_16x16x32_bf16 v[212:215], a[184:187], a[80:83], v[212:215]
ds_read_b128 a[200:203], v4 offset:34816
v_cvt_pk_bf16_f32 v57, v58, v59
v_mfma_f32_16x16x32_bf16 v[80:83], a[160:163], a[88:91], v[80:83]
v_cvt_pk_bf16_f32 v58, v172, v173
v_cvt_pk_bf16_f32 v59, v174, v175
v_mfma_f32_16x16x32_bf16 v[80:83], a[164:167], a[92:95], v[80:83]
ds_read_b128 a[204:207], v4 offset:35840
v_accvgpr_write_b32 a56, v56
v_mfma_f32_16x16x32_bf16 v[176:179], a[172:175], a[92:95], v[176:179]
v_accvgpr_write_b32 a57, v57
v_accvgpr_write_b32 a58, v58
v_mfma_f32_16x16x32_bf16 v[176:179], a[168:171], a[88:91], v[176:179]
ds_read_b128 a[208:211], v4 offset:36864
v_accvgpr_write_b32 a59, v59
v_mfma_f32_16x16x32_bf16 v[168:171], a[176:179], a[88:91], v[168:171]
v_cvt_pk_bf16_f32 v188, v188, v189
v_cvt_pk_bf16_f32 v189, v190, v191
v_mfma_f32_16x16x32_bf16 v[168:171], a[180:183], a[92:95], v[168:171]
ds_read_b128 a[212:215], v4 offset:37888
v_cvt_pk_bf16_f32 v190, v180, v181
v_mfma_f32_16x16x32_bf16 v[228:231], a[188:191], a[92:95], v[228:231]
buffer_load_dwordx4 v15, s[24:27], s64 offen offset:1024 sc1 lds
v_mfma_f32_16x16x32_bf16 v[228:231], a[184:187], a[88:91], v[228:231]
ds_read_b128 a[216:219], v4 offset:38912
v_cvt_pk_bf16_f32 v191, v182, v183
v_mfma_f32_16x16x32_bf16 v[184:187], a[160:163], a[96:99], v[184:187]
v_accvgpr_write_b32 a60, v188
v_accvgpr_write_b32 a61, v189
v_mfma_f32_16x16x32_bf16 v[184:187], a[164:167], a[100:103], v[184:187]
ds_read_b128 a[220:223], v4 offset:39936
v_accvgpr_write_b32 a62, v190
v_mfma_f32_16x16x32_bf16 v[248:251], a[172:175], a[100:103], v[248:251]
v_accvgpr_write_b32 a63, v191
v_cvt_pk_bf16_f32 v196, v196, v197
v_mfma_f32_16x16x32_bf16 v[248:251], a[168:171], a[96:99], v[248:251]
v_cvt_pk_bf16_f32 v197, v198, v199
v_cvt_pk_bf16_f32 v198, v64, v65
v_mfma_f32_16x16x32_bf16 v[240:243], a[176:179], a[96:99], v[240:243]
v_cvt_pk_bf16_f32 v199, v66, v67
v_accvgpr_write_b32 a28, v196
v_mfma_f32_16x16x32_bf16 v[240:243], a[180:183], a[100:103], v[240:243]
v_accvgpr_write_b32 a29, v197
v_accvgpr_write_b32 a30, v198
v_mfma_f32_16x16x32_bf16 v[232:235], a[188:191], a[100:103], v[232:235]
v_accvgpr_write_b32 a31, v199
v_cvt_pk_bf16_f32 v204, v204, v205
v_mfma_f32_16x16x32_bf16 v[232:235], a[184:187], a[96:99], v[232:235]
v_cvt_pk_bf16_f32 v205, v206, v207
v_cvt_pk_bf16_f32 v206, v212, v213
v_mfma_f32_16x16x32_bf16 v[88:91], a[160:163], a[104:107], v[88:91]
v_cvt_pk_bf16_f32 v207, v214, v215
v_accvgpr_write_b32 a20, v204
v_mfma_f32_16x16x32_bf16 v[88:91], a[164:167], a[108:111], v[88:91]
buffer_load_dwordx4 v15, s[24:27], s64 offen offset:2048 sc1 lds
v_mfma_f32_16x16x32_bf16 v[200:203], a[172:175], a[108:111], v[200:203]
v_accvgpr_write_b32 a21, v205
v_accvgpr_write_b32 a22, v206
v_mfma_f32_16x16x32_bf16 v[200:203], a[168:171], a[104:107], v[200:203]
v_accvgpr_write_b32 a23, v207
v_cvt_pk_bf16_f32 v80, v80, v81
v_mfma_f32_16x16x32_bf16 v[192:195], a[176:179], a[104:107], v[192:195]
v_cvt_pk_bf16_f32 v81, v82, v83
v_cvt_pk_bf16_f32 v82, v176, v177
v_mfma_f32_16x16x32_bf16 v[192:195], a[180:183], a[108:111], v[192:195]
v_cvt_pk_bf16_f32 v83, v178, v179
v_accvgpr_write_b32 a12, v80
v_mfma_f32_16x16x32_bf16 v[244:247], a[188:191], a[108:111], v[244:247]
v_accvgpr_write_b32 a13, v81
v_accvgpr_write_b32 a14, v82
v_mfma_f32_16x16x32_bf16 v[244:247], a[184:187], a[104:107], v[244:247]
v_accvgpr_write_b32 a15, v83
v_cvt_pk_bf16_f32 v168, v168, v169
v_mfma_f32_16x16x32_bf16 v[72:75], a[112:115], a[80:83], v[72:75]
v_cvt_pk_bf16_f32 v169, v170, v171
v_cvt_pk_bf16_f32 v170, v228, v229
v_mfma_f32_16x16x32_bf16 v[72:75], a[116:119], a[84:87], v[72:75]
v_cvt_pk_bf16_f32 v171, v230, v231
v_accvgpr_write_b32 a4, v168
v_mfma_f32_16x16x32_bf16 v[220:223], a[124:127], a[84:87], v[220:223]
v_accvgpr_write_b32 a5, v169
v_accvgpr_write_b32 a6, v170
v_mfma_f32_16x16x32_bf16 v[220:223], a[120:123], a[80:83], v[220:223]
buffer_load_dwordx4 v15, s[24:27], s64 offen offset:3072 sc1 lds
v_mfma_f32_16x16x32_bf16 v[160:163], a[112:115], a[88:91], v[160:163]
v_accvgpr_write_b32 a7, v171
v_cvt_pk_bf16_f32 v184, v184, v185
v_mfma_f32_16x16x32_bf16 v[160:163], a[116:119], a[92:95], v[160:163]
v_cvt_pk_bf16_f32 v185, v186, v187
v_cvt_pk_bf16_f32 v186, v248, v249
v_mfma_f32_16x16x32_bf16 v[252:255], a[124:127], a[92:95], v[252:255]
v_cvt_pk_bf16_f32 v187, v250, v251
v_accvgpr_write_b32 a0, v184
v_mfma_f32_16x16x32_bf16 v[252:255], a[120:123], a[88:91], v[252:255]
v_accvgpr_write_b32 a1, v185
v_accvgpr_write_b32 a2, v186
v_mfma_f32_16x16x32_bf16 v[236:239], a[112:115], a[96:99], v[236:239]
v_accvgpr_write_b32 a3, v187
v_cvt_pk_bf16_f32 v240, v240, v241
v_mfma_f32_16x16x32_bf16 v[236:239], a[116:119], a[100:103], v[236:239]
v_cvt_pk_bf16_f32 v241, v242, v243
v_cvt_pk_bf16_f32 v242, v232, v233
v_mfma_f32_16x16x32_bf16 v[224:227], a[124:127], a[100:103], v[224:227]
v_cvt_pk_bf16_f32 v243, v234, v235
v_accvgpr_write_b32 a8, v240
v_mfma_f32_16x16x32_bf16 v[224:227], a[120:123], a[96:99], v[224:227]
v_accvgpr_write_b32 a9, v241
v_accvgpr_write_b32 a10, v242
v_mfma_f32_16x16x32_bf16 v[216:219], a[112:115], a[104:107], v[216:219]
v_accvgpr_write_b32 a11, v243
v_cvt_pk_bf16_f32 v88, v88, v89
v_mfma_f32_16x16x32_bf16 v[216:219], a[116:119], a[108:111], v[216:219]
v_cvt_pk_bf16_f32 v89, v90, v91
v_cvt_pk_bf16_f32 v90, v200, v201
v_mfma_f32_16x16x32_bf16 v[208:211], a[124:127], a[108:111], v[208:211]
v_cvt_pk_bf16_f32 v91, v202, v203
v_accvgpr_write_b32 a16, v88
v_mfma_f32_16x16x32_bf16 v[208:211], a[120:123], a[104:107], v[208:211]
s_waitcnt lgkmcnt(0)
v_accvgpr_write_b32 a17, v89
v_accvgpr_write_b32 a18, v90
v_mfma_f32_16x16x32_bf16 v[44:47], a[192:195], a[32:35], v[96:99]
v_accvgpr_write_b32 a19, v91
v_cvt_pk_bf16_f32 v192, v192, v193
v_mfma_f32_16x16x32_bf16 v[44:47], a[196:199], a[36:39], v[44:47]
v_cvt_pk_bf16_f32 v193, v194, v195
v_cvt_pk_bf16_f32 v194, v244, v245
v_mfma_f32_16x16x32_bf16 v[44:47], a[200:203], a[28:31], v[44:47]
v_cvt_pk_bf16_f32 v195, v246, v247
v_accvgpr_write_b32 a24, v192
v_mfma_f32_16x16x32_bf16 v[44:47], a[204:207], a[20:23], v[44:47]
v_accvgpr_write_b32 a25, v193
v_accvgpr_write_b32 a26, v194
v_mfma_f32_16x16x32_bf16 v[52:55], a[192:195], a[44:47], v[104:107]
ds_bpermute_b32 v8, v17, v63
v_accvgpr_write_b32 a27, v195
v_mfma_f32_16x16x32_bf16 v[52:55], a[196:199], a[40:43], v[52:55]
v_cvt_pk_bf16_f32 v60, v60, v61
v_cvt_pk_bf16_f32 v61, v62, v63
v_mfma_f32_16x16x32_bf16 v[52:55], a[200:203], a[12:15], v[52:55]
v_cvt_pk_bf16_f32 v62, v68, v69
v_cvt_pk_bf16_f32 v63, v70, v71
v_mfma_f32_16x16x32_bf16 v[52:55], a[204:207], a[4:7], v[52:55]
v_accvgpr_write_b32 a128, v60
v_accvgpr_write_b32 a129, v61
v_mfma_f32_16x16x32_bf16 v[64:67], a[208:211], a[32:35], v[112:115]
v_accvgpr_write_b32 a130, v62
v_accvgpr_write_b32 a131, v63
v_mfma_f32_16x16x32_bf16 v[64:67], a[212:215], a[36:39], v[64:67]
ds_bpermute_b32 v9, v17, v87
v_cvt_pk_bf16_f32 v84, v84, v85
v_mfma_f32_16x16x32_bf16 v[64:67], a[216:219], a[28:31], v[64:67]
v_cvt_pk_bf16_f32 v85, v86, v87
v_cvt_pk_bf16_f32 v86, v76, v77
v_mfma_f32_16x16x32_bf16 v[64:67], a[220:223], a[20:23], v[64:67]
v_cvt_pk_bf16_f32 v87, v78, v79
v_mfma_f32_16x16x32_bf16 v[212:215], a[208:211], a[44:47], v[120:123]
buffer_store_dwordx4 v[84:87], v18, s[24:27], s54 offen offset:256 sc1
v_mfma_f32_16x16x32_bf16 v[212:215], a[212:215], a[40:43], v[212:215]
v_accvgpr_write_b32 a136, v84
v_accvgpr_write_b32 a137, v85
v_mfma_f32_16x16x32_bf16 v[212:215], a[216:219], a[12:15], v[212:215]
v_accvgpr_write_b32 a138, v86
v_accvgpr_write_b32 a139, v87
v_mfma_f32_16x16x32_bf16 v[212:215], a[220:223], a[4:7], v[212:215]
s_waitcnt vmcnt(15)
ds_bpermute_b32 v10, v17, v151
v_cvt_pk_bf16_f32 v148, v148, v149
v_mfma_f32_16x16x32_bf16 v[100:103], a[192:195], a[48:51], v[128:131]
s_barrier
v_cvt_pk_bf16_f32 v149, v150, v151
v_cvt_pk_bf16_f32 v150, v48, v49
v_mfma_f32_16x16x32_bf16 v[100:103], a[196:199], a[52:55], v[100:103]
v_cvt_pk_bf16_f32 v151, v50, v51
v_accvgpr_write_b32 a144, v148
v_mfma_f32_16x16x32_bf16 v[100:103], a[200:203], a[0:3], v[100:103]
ds_bpermute_b32 v11, v17, v167
v_accvgpr_write_b32 a145, v149
v_mfma_f32_16x16x32_bf16 v[100:103], a[204:207], a[8:11], v[100:103]
v_cvt_pk_bf16_f32 v164, v164, v165
v_cvt_pk_bf16_f32 v165, v166, v167
v_mfma_f32_16x16x32_bf16 v[92:95], a[192:195], a[60:63], v[136:139]
v_cvt_pk_bf16_f32 v166, v156, v157
v_cvt_pk_bf16_f32 v167, v158, v159
v_mfma_f32_16x16x32_bf16 v[92:95], a[196:199], a[56:59], v[92:95]
buffer_store_dwordx4 v[164:167], v18, s[24:27], s55 offen offset:256 sc1
v_mfma_f32_16x16x32_bf16 v[92:95], a[200:203], a[16:19], v[92:95]
v_cvt_pk_bf16_f32 v72, v72, v73
v_cvt_pk_bf16_f32 v73, v74, v75
v_mfma_f32_16x16x32_bf16 v[92:95], a[204:207], a[24:27], v[92:95]
v_cvt_pk_bf16_f32 v74, v220, v221
v_cvt_pk_bf16_f32 v75, v222, v223
v_mfma_f32_16x16x32_bf16 v[176:179], a[208:211], a[48:51], v[144:147]
v_cvt_pk_bf16_f32 v160, v160, v161
v_cvt_pk_bf16_f32 v161, v162, v163
v_mfma_f32_16x16x32_bf16 v[176:179], a[212:215], a[52:55], v[176:179]
L_PAD8:
s_cbranch_execz L_PAD12
v_cvt_pk_bf16_f32 v162, v252, v253
v_cvt_pk_bf16_f32 v163, v254, v255
v_mfma_f32_16x16x32_bf16 v[176:179], a[216:219], a[0:3], v[176:179]
buffer_store_dwordx4 v[160:163], v19, s[24:27], s54 offen offset:256 sc1
v_mfma_f32_16x16x32_bf16 v[176:179], a[220:223], a[8:11], v[176:179]
v_cvt_pk_bf16_f32 v236, v236, v237
v_cvt_pk_bf16_f32 v237, v238, v239
v_mfma_f32_16x16x32_bf16 v[228:231], a[208:211], a[60:63], v[152:155]
v_cvt_pk_bf16_f32 v238, v224, v225
v_cvt_pk_bf16_f32 v239, v226, v227
v_mfma_f32_16x16x32_bf16 v[228:231], a[212:215], a[56:59], v[228:231]
v_cvt_pk_bf16_f32 v216, v216, v217
v_cvt_pk_bf16_f32 v217, v218, v219
v_mfma_f32_16x16x32_bf16 v[228:231], a[216:219], a[16:19], v[228:231]
v_cvt_pk_bf16_f32 v218, v208, v209
v_cvt_pk_bf16_f32 v219, v210, v211
v_mfma_f32_16x16x32_bf16 v[228:231], a[220:223], a[24:27], v[228:231]
buffer_store_dwordx4 v[216:219], v19, s[24:27], s55 offen offset:256 sc1
ds_read_b128 a[64:67], v4 offset:57344
ds_read_b128 a[68:71], v4 offset:58368
ds_read_b128 a[72:75], v4 offset:59392
ds_read_b128 a[76:79], v4 offset:60416
ds_read_b128 a[80:83], v4 offset:61440
ds_read_b128 a[84:87], v4 offset:62464
ds_read_b128 a[88:91], v4 offset:63488
ds_read_b128 a[92:95], v4 offset:64512
s_add_u32 m0, s70, 98304
s_add_u32 s64, s68, 65536
buffer_load_dwordx4 v15, s[24:27], s64 offen offset:0 sc1 lds
v_max3_f32 v24, v44, v45, v46
v_max3_f32 v25, v47, v64, v65
v_max3_f32 v26, v52, v53, v54
v_max3_f32 v27, v55, v212, v213
v_max3_f32 v24, v24, v66, v67
v_max_f32 v24, v24, v25
v_max3_f32 v26, v26, v214, v215
v_max_f32 v26, v26, v27
v_mov_b32 v25, v24
buffer_load_dwordx4 v15, s[24:27], s64 offen offset:1024 sc1 lds
v_mov_b32 v27, v26
s_nop 1
v_permlane32_swap_b32 v25, v24
v_permlane32_swap_b32 v27, v26
s_nop 0
v_max_f32 v24, v24, v25
v_max_f32 v26, v26, v27
v_mov_b32 v25, v24
v_mov_b32 v27, v26
buffer_load_dwordx4 v15, s[24:27], s64 offen offset:2048 sc1 lds
s_nop 1
v_permlane16_swap_b32 v25, v24
v_permlane16_swap_b32 v27, v26
s_nop 0
v_max_f32 v24, v24, v25
v_max_f32 v26, v26, v27
v_pk_add_f32 v[44:45], v[44:45], v[24:25] op_sel_hi:[1,0] neg_lo:[0,1] neg_hi:[0,1]
v_pk_add_f32 v[46:47], v[46:47], v[24:25] op_sel_hi:[1,0] neg_lo:[0,1] neg_hi:[0,1]
v_pk_add_f32 v[52:53], v[52:53], v[26:27] op_sel_hi:[1,0] neg_lo:[0,1] neg_hi:[0,1]
buffer_load_dwordx4 v15, s[24:27], s64 offen offset:3072 sc1 lds
v_pk_add_f32 v[54:55], v[54:55], v[26:27] op_sel_hi:[1,0] neg_lo:[0,1] neg_hi:[0,1]
v_pk_add_f32 v[64:65], v[64:65], v[24:25] op_sel_hi:[1,0] neg_lo:[0,1] neg_hi:[0,1]
v_pk_add_f32 v[66:67], v[66:67], v[24:25] op_sel_hi:[1,0] neg_lo:[0,1] neg_hi:[0,1]
v_pk_add_f32 v[212:213], v[212:213], v[26:27] op_sel_hi:[1,0] neg_lo:[0,1] neg_hi:[0,1]
v_pk_add_f32 v[214:215], v[214:215], v[26:27] op_sel_hi:[1,0] neg_lo:[0,1] neg_hi:[0,1]
v_pk_add_f32 v[96:97], v[96:97], v[24:25] op_sel_hi:[1,0] neg_lo:[0,1] neg_hi:[0,1]
v_pk_add_f32 v[98:99], v[98:99], v[24:25] op_sel_hi:[1,0] neg_lo:[0,1] neg_hi:[0,1]
v_pk_add_f32 v[104:105], v[104:105], v[26:27] op_sel_hi:[1,0] neg_lo:[0,1] neg_hi:[0,1]
v_pk_add_f32 v[106:107], v[106:107], v[26:27] op_sel_hi:[1,0] neg_lo:[0,1] neg_hi:[0,1]
s_add_u32 m0, s70, 114688
s_add_u32 s64, s68, 81920
buffer_load_dwordx4 v15, s[24:27], s64 offen offset:0 sc1 lds
v_pk_add_f32 v[112:113], v[112:113], v[24:25] op_sel_hi:[1,0] neg_lo:[0,1] neg_hi:[0,1]
v_pk_add_f32 v[114:115], v[114:115], v[24:25] op_sel_hi:[1,0] neg_lo:[0,1] neg_hi:[0,1]
v_pk_add_f32 v[120:121], v[120:121], v[26:27] op_sel_hi:[1,0] neg_lo:[0,1] neg_hi:[0,1]
v_pk_add_f32 v[122:123], v[122:123], v[26:27] op_sel_hi:[1,0] neg_lo:[0,1] neg_hi:[0,1]
v_exp_f32 v44, v44
v_exp_f32 v45, v45
v_exp_f32 v46, v46
v_exp_f32 v47, v47
v_cvt_pk_bf16_f32 v124, v44, v45
buffer_load_dwordx4 v15, s[24:27], s64 offen offset:1024 sc1 lds
v_exp_f32 v52, v52
v_exp_f32 v53, v53
v_cvt_pk_bf16_f32 v125, v46, v47
v_exp_f32 v54, v54
v_exp_f32 v55, v55
v_cvt_pk_bf16_f32 v140, v52, v53
v_exp_f32 v64, v64
v_exp_f32 v65, v65
v_cvt_pk_bf16_f32 v141, v54, v55
buffer_load_dwordx4 v15, s[24:27], s64 offen offset:2048 sc1 lds
v_exp_f32 v66, v66
v_exp_f32 v67, v67
v_cvt_pk_bf16_f32 v126, v64, v65
v_exp_f32 v212, v212
v_exp_f32 v213, v213
v_cvt_pk_bf16_f32 v127, v66, v67
v_exp_f32 v214, v214
v_exp_f32 v215, v215
v_cvt_pk_bf16_f32 v142, v212, v213
buffer_load_dwordx4 v15, s[24:27], s64 offen offset:3072 sc1 lds
v_max3_f32 v24, v100, v101, v102
v_cvt_pk_bf16_f32 v143, v214, v215
v_max3_f32 v25, v103, v176, v177
v_max3_f32 v26, v92, v93, v94
v_max3_f32 v27, v95, v228, v229
v_max3_f32 v24, v24, v178, v179
v_max_f32 v24, v24, v25
v_max3_f32 v26, v26, v230, v231
v_max_f32 v26, v26, v27
v_mov_b32 v25, v24
v_mov_b32 v27, v26
s_nop 1
v_permlane32_swap_b32 v25, v24
v_permlane32_swap_b32 v27, v26
s_nop 0
v_max_f32 v24, v24, v25
s_cmp_lt_u32 s3, 1
s_cbranch_scc1 L_SK5
s_add_u32 m0, s70, 131072
s_add_u32 s64, s68, 98304
buffer_load_dwordx4 v15, s[24:27], s64 offen offset:0 sc1 lds
buffer_load_dwordx4 v15, s[24:27], s64 offen offset:1024 sc1 lds
buffer_load_dwordx4 v15, s[24:27], s64 offen offset:2048 sc1 lds
buffer_load_dwordx4 v15, s[24:27], s64 offen offset:3072 sc1 lds
L_SK5:
v_max_f32 v26, v26, v27
v_mov_b32 v25, v24
v_mov_b32 v27, v26
s_nop 1
v_permlane16_swap_b32 v25, v24
v_permlane16_swap_b32 v27, v26
s_nop 0
v_max_f32 v24, v24, v25
v_max_f32 v26, v26, v27
v_pk_add_f32 v[100:101], v[100:101], v[24:25] op_sel_hi:[1,0] neg_lo:[0,1] neg_hi:[0,1]
v_pk_add_f32 v[102:103], v[102:103], v[24:25] op_sel_hi:[1,0] neg_lo:[0,1] neg_hi:[0,1]
v_pk_add_f32 v[92:93], v[92:93], v[26:27] op_sel_hi:[1,0] neg_lo:[0,1] neg_hi:[0,1]
v_pk_add_f32 v[94:95], v[94:95], v[26:27] op_sel_hi:[1,0] neg_lo:[0,1] neg_hi:[0,1]
v_pk_add_f32 v[176:177], v[176:177], v[24:25] op_sel_hi:[1,0] neg_lo:[0,1] neg_hi:[0,1]
v_pk_add_f32 v[178:179], v[178:179], v[24:25] op_sel_hi:[1,0] neg_lo:[0,1] neg_hi:[0,1]
v_pk_add_f32 v[228:229], v[228:229], v[26:27] op_sel_hi:[1,0] neg_lo:[0,1] neg_hi:[0,1]
v_pk_add_f32 v[230:231], v[230:231], v[26:27] op_sel_hi:[1,0] neg_lo:[0,1] neg_hi:[0,1]
v_pk_add_f32 v[128:129], v[128:129], v[24:25] op_sel_hi:[1,0] neg_lo:[0,1] neg_hi:[0,1]
v_pk_add_f32 v[130:131], v[130:131], v[24:25] op_sel_hi:[1,0] neg_lo:[0,1] neg_hi:[0,1]
v_pk_add_f32 v[136:137], v[136:137], v[26:27] op_sel_hi:[1,0] neg_lo:[0,1] neg_hi:[0,1]
v_pk_add_f32 v[138:139], v[138:139], v[26:27] op_sel_hi:[1,0] neg_lo:[0,1] neg_hi:[0,1]
v_pk_add_f32 v[144:145], v[144:145], v[24:25] op_sel_hi:[1,0] neg_lo:[0,1] neg_hi:[0,1]
v_pk_add_f32 v[146:147], v[146:147], v[24:25] op_sel_hi:[1,0] neg_lo:[0,1] neg_hi:[0,1]
v_pk_add_f32 v[152:153], v[152:153], v[26:27] op_sel_hi:[1,0] neg_lo:[0,1] neg_hi:[0,1]
v_pk_add_f32 v[154:155], v[154:155], v[26:27] op_sel_hi:[1,0] neg_lo:[0,1] neg_hi:[0,1]
v_accvgpr_write_b32 a146, v150
s_cmp_lt_u32 s3, 2
s_cbranch_scc1 L_SK6
s_add_u32 m0, s70, 147456
s_add_u32 s64, s68, 114688
buffer_load_dwordx4 v15, s[24:27], s64 offen offset:0 sc1 lds
buffer_load_dwordx4 v15, s[24:27], s64 offen offset:1024 sc1 lds
buffer_load_dwordx4 v15, s[24:27], s64 offen offset:2048 sc1 lds
buffer_load_dwordx4 v15, s[24:27], s64 offen offset:3072 sc1 lds
L_SK6:
v_accvgpr_write_b32 a147, v151
v_accvgpr_write_b32 a152, v164
v_accvgpr_write_b32 a153, v165
v_accvgpr_write_b32 a154, v166
v_accvgpr_write_b32 a155, v167
v_accvgpr_write_b32 a132, v72
v_accvgpr_write_b32 a133, v73
v_accvgpr_write_b32 a134, v74
v_accvgpr_write_b32 a135, v75
v_accvgpr_write_b32 a140, v160
v_accvgpr_write_b32 a141, v161
v_accvgpr_write_b32 a142, v162
v_accvgpr_write_b32 a143, v163
v_accvgpr_write_b32 a148, v236
v_accvgpr_write_b32 a149, v237
v_accvgpr_write_b32 a150, v238
v_accvgpr_write_b32 a151, v239
v_accvgpr_write_b32 a156, v216
v_accvgpr_write_b32 a157, v217
v_accvgpr_write_b32 a158, v218
v_accvgpr_write_b32 a159, v219
v_mov_b64 v[60:61], 0
v_mov_b64 v[62:63], 0
v_mov_b64 v[68:69], 0
v_mov_b64 v[70:71], 0
v_mov_b64 v[72:73], 0
s_cmp_lt_u32 s3, 3
s_cbranch_scc1 L_SK7
s_add_u32 m0, s70, 0
s_add_u32 s64, s68, 131072
buffer_load_dwordx4 v15, s[24:27], s64 offen offset:0 sc1 lds
buffer_load_dwordx4 v15, s[24:27], s64 offen offset:1024 sc1 lds
buffer_load_dwordx4 v15, s[24:27], s64 offen offset:2048 sc1 lds
buffer_load_dwordx4 v15, s[24:27], s64 offen offset:3072 sc1 lds
L_SK7:
v_mov_b64 v[74:75], 0
v_mov_b64 v[220:221], 0
v_mov_b64 v[222:223], 0
v_mov_b64 v[84:85], 0
v_mov_b64 v[86:87], 0
v_mov_b64 v[76:77], 0
v_mov_b64 v[78:79], 0
v_mov_b64 v[160:161], 0
v_mov_b64 v[162:163], 0
v_mov_b64 v[252:253], 0
v_mov_b64 v[254:255], 0
v_mov_b64 v[148:149], 0
v_mov_b64 v[150:151], 0
v_mov_b64 v[48:49], 0
v_mov_b64 v[50:51], 0
v_mov_b64 v[236:237], 0
v_mov_b64 v[238:239], 0
v_mov_b64 v[224:225], 0
v_mov_b64 v[226:227], 0
v_mov_b64 v[164:165], 0
v_mov_b64 v[166:167], 0
v_mov_b64 v[156:157], 0
v_mov_b64 v[158:159], 0
v_mov_b64 v[216:217], 0
v_mov_b64 v[218:219], 0
v_mov_b64 v[208:209], 0
v_mov_b64 v[210:211], 0
ds_read_b128 a[192:195], v4 offset:49152
ds_read_b128 a[196:199], v4 offset:50176
ds_read_b128 a[200:203], v4 offset:51200
ds_read_b128 a[204:207], v4 offset:52224
ds_read_b128 a[208:211], v4 offset:53248
ds_read_b128 a[212:215], v4 offset:54272
ds_read_b128 a[216:219], v4 offset:55296
ds_read_b128 a[220:223], v4 offset:56320
s_waitcnt lgkmcnt(8)
s_lshl2_add_u32 s77, s86, s84
s_mul_i32 s77, s77, 344064
s_mov_b32 s80, s70
s_cmp_lt_u32 s3, 2
s_cselect_b32 s53, 8, -2
s_add_u32 s53, s53, s3
v_mfma_f32_16x16x32_bf16 v[36:39], a[64:67], v[124:127], 0
s_mul_i32 s52, s5, 65536
v_exp_f32 v100, v100
v_mfma_f32_16x16x32_bf16 v[116:119], a[64:67], v[140:143], 0
s_sub_u32 s52, 1064960, s52
v_exp_f32 v101, v101
v_mfma_f32_16x16x32_bf16 v[132:135], a[68:71], v[140:143], 0
s_add_u32 s71, s68, s52
v_exp_f32 v102, v102
v_mfma_f32_16x16x32_bf16 v[32:35], a[68:71], v[124:127], 0
s_add_u32 s77, s77, s80
v_exp_f32 v103, v103
v_mfma_f32_16x16x32_bf16 v[196:199], a[72:75], v[124:127], 0
s_add_u32 s77, s77, 38797312
v_cvt_pk_bf16_f32 v248, v100, v101
v_cvt_pk_bf16_f32 v249, v102, v103
v_mfma_f32_16x16x32_bf16 v[184:187], a[72:75], v[140:143], 0
s_add_u32 s52, s3, 6
v_exp_f32 v92, v92
v_mfma_f32_16x16x32_bf16 v[240:243], a[76:79], v[140:143], 0
s_mul_i32 s52, s52, 16384
v_exp_f32 v93, v93
v_mfma_f32_16x16x32_bf16 v[204:207], a[76:79], v[124:127], 0
s_add_u32 s68, s68, s52
v_exp_f32 v94, v94
v_mfma_f32_16x16x32_bf16 v[108:111], a[80:83], v[124:127], 0
s_lshl_b32 s53, s53, 14
v_exp_f32 v95, v95
v_mfma_f32_16x16x32_bf16 v[188:191], a[80:83], v[140:143], 0
s_add_u32 s70, s70, s53
v_cvt_pk_bf16_f32 v232, v92, v93
v_cvt_pk_bf16_f32 v233, v94, v95
v_mfma_f32_16x16x32_bf16 v[56:59], a[84:87], v[140:143], 0
s_mov_b32 s75, 65536
v_exp_f32 v176, v176
v_mfma_f32_16x16x32_bf16 v[40:43], a[84:87], v[124:127], 0
s_mov_b32 s72, 1
v_exp_f32 v177, v177
v_mfma_f32_16x16x32_bf16 v[80:83], a[88:91], v[124:127], 0
s_mov_b32 s73, 9
v_exp_f32 v178, v178
v_mfma_f32_16x16x32_bf16 v[88:91], a[88:91], v[140:143], 0
s_lshl2_add_u32 s69, s5, 4
v_exp_f32 v179, v179
v_mfma_f32_16x16x32_bf16 v[192:195], a[92:95], v[140:143], 0
s_max_u32 s69, s69, 12
v_cvt_pk_bf16_f32 v250, v176, v177
v_cvt_pk_bf16_f32 v251, v178, v179
v_mfma_f32_16x16x32_bf16 v[168:171], a[92:95], v[124:127], 0
s_min_u32 s74, s73, s66
v_exp_f32 v228, v228
v_mfma_f32_16x16x32_bf16 a[224:227], a[240:243], v[124:127], 0
s_mov_b32 s93, 9
s_waitcnt vmcnt(8) lgkmcnt(0)
v_mfma_f32_16x16x32_bf16 a[228:231], a[240:243], v[140:143], 0
s_cmp_lt_u32 s66, 2
buffer_atomic_add v1, v0, s[24:27], s89 offen offset:8 sc1
s_cbranch_scc1 L_NE
L_DUAL:
v_mfma_f32_16x16x32_bf16 v[44:47], a[192:195], a[32:35], v[96:99]
s_barrier
v_mfma_f32_16x16x32_bf16 v[44:47], a[196:199], a[36:39], v[44:47]
s_cmp_eq_u32 s68, s71
v_exp_f32 v229, v229
v_mfma_f32_16x16x32_bf16 v[44:47], a[200:203], a[28:31], v[44:47]
s_cselect_b32 s64, s77, s68
v_add_u32 v5, s75, v4
v_cvt_pk_bf16_f32 v234, v228, v229
v_mfma_f32_16x16x32_bf16 v[44:47], a[204:207], a[20:23], v[44:47]
s_mov_b32 m0, s70
v_exp_f32 v230, v230
v_mfma_f32_16x16x32_bf16 v[52:55], a[192:195], a[44:47], v[104:107]
buffer_load_dwordx4 v15, s[24:27], s64 offen offset:0 sc1 lds
v_mfma_f32_16x16x32_bf16 v[52:55], a[196:199], a[40:43], v[52:55]
s_add_u32 s75, s75, 16384
v_exp_f32 v231, v231
v_mfma_f32_16x16x32_bf16 v[52:55], a[200:203], a[12:15], v[52:55]
v_cvt_pk_bf16_f32 v235, v230, v231
v_mfma_f32_16x16x32_bf16 v[52:55], a[204:207], a[4:7], v[52:55]
s_cmp_ge_u32 s75, 163840
v_exp_f32 v44, v44
v_mfma_f32_16x16x32_bf16 v[64:67], a[208:211], a[32:35], v[112:115]
v_mfma_f32_16x16x32_bf16 v[64:67], a[212:215], a[36:39], v[64:67]
s_cselect_b32 s75, 0, s75
v_exp_f32 v45, v45
v_mfma_f32_16x16x32_bf16 v[64:67], a[216:219], a[28:31], v[64:67]
v_cvt_pk_bf16_f32 v124, v44, v45
v_mfma_f32_16x16x32_bf16 v[64:67], a[220:223], a[20:23], v[64:67]
s_add_u32 s68, s64, 16384
v_exp_f32 v46, v46
v_mfma_f32_16x16x32_bf16 v[212:215], a[208:211], a[44:47], v[120:123]
buffer_load_dwordx4 v15, s[24:27], s64 offen offset:1024 sc1 lds
v_mfma_f32_16x16x32_bf16 v[212:215], a[212:215], a[40:43], v[212:215]
s_add_u32 s70, s70, 16384
v_exp_f32 v47, v47
v_mfma_f32_16x16x32_bf16 v[212:215], a[216:219], a[12:15], v[212:215]
v_cvt_pk_bf16_f32 v125, v46, v47
v_mfma_f32_16x16x32_bf16 v[212:215], a[220:223], a[4:7], v[212:215]
v_exp_f32 v52, v52
v_mfma_f32_16x16x32_bf16 v[60:63], a[64:67], v[248:251], v[60:63]
v_mfma_f32_16x16x32_bf16 v[148:151], a[64:67], v[232:235], v[148:151]
s_cmp_ge_u32 s70, 163840
v_exp_f32 v53, v53
v_mfma_f32_16x16x32_bf16 v[48:51], a[68:71], v[232:235], v[48:51]
ds_read_b128 a[64:67], v5 offset:8192
v_cvt_pk_bf16_f32 v140, v52, v53
v_mfma_f32_16x16x32_bf16 v[68:71], a[68:71], v[248:251], v[68:71]
s_cselect_b32 s70, s80, s70
v_exp_f32 v54, v54
v_mfma_f32_16x16x32_bf16 v[72:75], a[72:75], v[248:251], v[72:75]
buffer_load_dwordx4 v15, s[24:27], s64 offen offset:2048 sc1 lds
v_mfma_f32_16x16x32_bf16 v[236:239], a[72:75], v[232:235], v[236:239]
v_exp_f32 v55, v55
v_mfma_f32_16x16x32_bf16 v[224:227], a[76:79], v[232:235], v[224:227]
ds_read_b128 a[68:71], v5 offset:9216
v_cvt_pk_bf16_f32 v141, v54, v55
v_mfma_f32_16x16x32_bf16 v[220:223], a[76:79], v[248:251], v[220:223]
v_exp_f32 v64, v64
v_mfma_f32_16x16x32_bf16 v[84:87], a[80:83], v[248:251], v[84:87]
ds_read_b128 a[72:75], v5 offset:10240
v_mfma_f32_16x16x32_bf16 v[164:167], a[80:83], v[232:235], v[164:167]
v_exp_f32 v65, v65
v_mfma_f32_16x16x32_bf16 v[156:159], a[84:87], v[232:235], v[156:159]
ds_read_b128 a[76:79], v5 offset:11264
v_cvt_pk_bf16_f32 v126, v64, v65
v_mfma_f32_16x16x32_bf16 v[76:79], a[84:87], v[248:251], v[76:79]
v_exp_f32 v66, v66
v_mfma_f32_16x16x32_bf16 v[160:163], a[88:91], v[248:251], v[160:163]
buffer_load_dwordx4 v15, s[24:27], s64 offen offset:3072 sc1 lds
v_mfma_f32_16x16x32_bf16 v[216:219], a[88:91], v[232:235], v[216:219]
v_exp_f32 v67, v67
v_mfma_f32_16x16x32_bf16 v[208:211], a[92:95], v[232:235], v[208:211]
ds_read_b128 a[80:83], v5 offset:12288
v_cvt_pk_bf16_f32 v127, v66, v67
v_mfma_f32_16x16x32_bf16 v[252:255], a[92:95], v[248:251], v[252:255]
v_exp_f32 v212, v212
v_mfma_f32_16x16x32_bf16 a[232:235], a[240:243], v[248:251], a[232:235]
ds_read_b128 a[84:87], v5 offset:13312
v_mfma_f32_16x16x32_bf16 a[236:239], a[240:243], v[232:235], a[236:239]
ds_read_b128 a[88:91], v5 offset:14336
v_mfma_f32_16x16x32_bf16 v[100:103], a[192:195], a[48:51], v[128:131]
ds_read_b128 a[92:95], v5 offset:15360
v_mfma_f32_16x16x32_bf16 v[100:103], a[196:199], a[52:55], v[100:103]
v_exp_f32 v213, v213
v_mfma_f32_16x16x32_bf16 v[100:103], a[200:203], a[0:3], v[100:103]
v_cvt_pk_bf16_f32 v142, v212, v213
v_mfma_f32_16x16x32_bf16 v[100:103], a[204:207], a[8:11], v[100:103]
v_exp_f32 v214, v214
v_mfma_f32_16x16x32_bf16 v[92:95], a[192:195], a[60:63], v[136:139]
s_nop 0
v_mfma_f32_16x16x32_bf16 v[92:95], a[196:199], a[56:59], v[92:95]
v_exp_f32 v215, v215
v_mfma_f32_16x16x32_bf16 v[92:95], a[200:203], a[16:19], v[92:95]
ds_read_b128 a[192:195], v5 offset:0
v_cvt_pk_bf16_f32 v143, v214, v215
v_mfma_f32_16x16x32_bf16 v[92:95], a[204:207], a[24:27], v[92:95]
v_exp_f32 v100, v100
v_mfma_f32_16x16x32_bf16 v[176:179], a[208:211], a[48:51], v[144:147]
ds_read_b128 a[196:199], v5 offset:1024
v_mfma_f32_16x16x32_bf16 v[176:179], a[212:215], a[52:55], v[176:179]
v_exp_f32 v101, v101
v_mfma_f32_16x16x32_bf16 v[176:179], a[216:219], a[0:3], v[176:179]
ds_read_b128 a[200:203], v5 offset:2048
v_cvt_pk_bf16_f32 v248, v100, v101
v_mfma_f32_16x16x32_bf16 v[176:179], a[220:223], a[8:11], v[176:179]
v_exp_f32 v102, v102
v_mfma_f32_16x16x32_bf16 v[228:231], a[208:211], a[60:63], v[152:155]
ds_read_b128 a[204:207], v5 offset:3072
v_mfma_f32_16x16x32_bf16 v[228:231], a[212:215], a[56:59], v[228:231]
v_exp_f32 v103, v103
v_mfma_f32_16x16x32_bf16 v[228:231], a[216:219], a[16:19], v[228:231]
ds_read_b128 a[208:211], v5 offset:4096
v_cvt_pk_bf16_f32 v249, v102, v103
v_mfma_f32_16x16x32_bf16 v[228:231], a[220:223], a[24:27], v[228:231]
s_waitcnt lgkmcnt(5)
v_exp_f32 v92, v92
v_mfma_f32_16x16x32_bf16 v[36:39], a[64:67], v[124:127], v[36:39]
ds_read_b128 a[212:215], v5 offset:5120
v_mfma_f32_16x16x32_bf16 v[116:119], a[64:67], v[140:143], v[116:119]
v_exp_f32 v93, v93
v_mfma_f32_16x16x32_bf16 v[132:135], a[68:71], v[140:143], v[132:135]
ds_read_b128 a[216:219], v5 offset:6144
v_cvt_pk_bf16_f32 v232, v92, v93
v_mfma_f32_16x16x32_bf16 v[32:35], a[68:71], v[124:127], v[32:35]
v_exp_f32 v94, v94
v_mfma_f32_16x16x32_bf16 v[196:199], a[72:75], v[124:127], v[196:199]
ds_read_b128 a[220:223], v5 offset:7168
v_mfma_f32_16x16x32_bf16 v[184:187], a[72:75], v[140:143], v[184:187]
s_add_u32 s72, s72, 1
v_exp_f32 v95, v95
v_mfma_f32_16x16x32_bf16 v[240:243], a[76:79], v[140:143], v[240:243]
v_cvt_pk_bf16_f32 v233, v94, v95
v_mfma_f32_16x16x32_bf16 v[204:207], a[76:79], v[124:127], v[204:207]
v_exp_f32 v176, v176
v_mfma_f32_16x16x32_bf16 v[108:111], a[80:83], v[124:127], v[108:111]
v_mfma_f32_16x16x32_bf16 v[188:191], a[80:83], v[140:143], v[188:191]
v_exp_f32 v177, v177
v_mfma_f32_16x16x32_bf16 v[56:59], a[84:87], v[140:143], v[56:59]
v_cvt_pk_bf16_f32 v250, v176, v177
v_mfma_f32_16x16x32_bf16 v[40:43], a[84:87], v[124:127], v[40:43]
v_exp_f32 v178, v178
v_mfma_f32_16x16x32_bf16 v[80:83], a[88:91], v[124:127], v[80:83]
v_mfma_f32_16x16x32_bf16 v[88:91], a[88:91], v[140:143], v[88:91]
s_cmp_lt_u32 s72, s74
v_exp_f32 v179, v179
v_mfma_f32_16x16x32_bf16 v[192:195], a[92:95], v[140:143], v[192:195]
v_cvt_pk_bf16_f32 v251, v178, v179
v_mfma_f32_16x16x32_bf16 v[168:171], a[92:95], v[124:127], v[168:171]
s_waitcnt vmcnt(8) lgkmcnt(0)
v_exp_f32 v228, v228
v_mfma_f32_16x16x32_bf16 a[224:227], a[240:243], v[124:127], a[224:227]
v_mfma_f32_16x16x32_bf16 a[228:231], a[240:243], v[140:143], a[228:231]
s_cbranch_scc1 L_DUAL
L_DISP:
s_cmp_eq_u32 s72, s93
s_cbranch_scc1 L_STOP
L_NE:
s_mov_b32 s74, s93
s_cmp_gt_u32 s72, s66
s_cbranch_scc1 L_SINGLE
v_cndmask_b32 v96, v96, v6, s[56:57]
v_cndmask_b32 v120, v120, v6, s[56:57]
v_mov_b32 v112, v6
v_cndmask_b32 v97, v97, v6, s[58:59]
v_cndmask_b32 v121, v121, v6, s[58:59]
v_mov_b32 v113, v6
v_cndmask_b32 v98, v98, v6, s[60:61]
v_cndmask_b32 v122, v122, v6, s[60:61]
v_mov_b32 v114, v6
v_cndmask_b32 v99, v99, v6, s[62:63]
v_cndmask_b32 v123, v123, v6, s[62:63]
v_mov_b32 v115, v6
s_mov_b32 s74, 0
s_branch L_DUAL
L_STOP:
s_cmp_eq_u32 s72, 3
s_cbranch_scc1 L_E0
s_cmp_eq_u32 s72, 9
s_cbranch_scc1 L_E1
s_cmp_lg_u32 s72, 11
s_cbranch_scc1 L_SE
v_cmp_gt_u32 vcc, 32, v172
s_mov_b32 s73, 32
s_min_u32 s93, s73, s69
s_min_u32 s74, s93, s66
v_accvgpr_read_b32 v16, a244
v_accvgpr_read_b32 v17, a248
v_accvgpr_read_b32 v18, a252
s_cbranch_vccnz CK_Q
CK_Q_R:
buffer_load_dwordx4 a[244:247], v16, s[24:27], 0 offen sc1
buffer_load_dwordx4 a[248:251], v17, s[24:27], 0 offen sc1
buffer_load_dwordx4 a[252:255], v18, s[24:27], 0 offen sc1
s_add_u32 s53, s77, 163840
buffer_load_dwordx4 a[96:99], v15, s[24:27], s53 offen offset:0 sc1
buffer_load_dwordx4 a[100:103], v15, s[24:27], s53 offen offset:1024 sc1
buffer_load_dwordx4 a[104:107], v15, s[24:27], s53 offen offset:2048 sc1
buffer_load_dwordx4 a[108:111], v15, s[24:27], s53 offen offset:3072 sc1
s_cmp_lt_u32 s72, s66
s_cbranch_scc1 L_DUAL
s_mov_b32 s74, s93
s_cmp_gt_u32 s72, s66
s_cbranch_scc1 L_SINGLE
s_branch L_NE
L_E0:
buffer_atomic_add v1, v0, s[24:27], s89 offen offset:8 sc1
s_mov_b32 s73, 9
s_min_u32 s93, s73, s69
s_min_u32 s74, s93, s66
s_cmp_lt_u32 s72, s66
s_cbranch_scc1 L_DUAL
s_mov_b32 s74, s93
s_cmp_gt_u32 s72, s66
s_cbranch_scc1 L_SINGLE
s_branch L_NE
L_E1:
v_and_b32 v173, 31, v1
v_lshlrev_b32 v173, 10, v173
v_add_u32 v173, 75497992, v173
buffer_load_dword v172, v173, s[24:27], 0 offen sc1
s_mov_b32 s73, 11
s_cmp_lt_u32 s4, 16
s_cselect_b32 s52, s66, s67
s_and_b32 s53, s4, 15
s_lshl4_add_u32 s52, s52, s53
s_mul_i32 s52, s52, 2304
v_lshlrev_b32 v16, 2, v1
buffer_store_dwordx4 v[0:3], v4, s[44:47], s52 offen sc1
buffer_store_dwordx4 v[0:3], v4, s[44:47], s52 offen offset:1024 sc1
buffer_store_dword v0, v16, s[44:47], s52 offen offset:2048 sc1
s_min_u32 s93, s73, s69
s_min_u32 s74, s93, s66
s_cmp_lt_u32 s72, s66
s_cbranch_scc1 L_DUAL
s_mov_b32 s74, s93
s_cmp_gt_u32 s72, s66
s_cbranch_scc1 L_SINGLE
s_branch L_NE
L_SE:
s_lshr_b32 s52, s4, 3
s_mul_i32 s52, s52, 75776
s_add_u32 s52, s52, 54525952
s_and_b32 s53, s4, 7
s_mul_i32 s53, s53, 8192
s_add_u32 s52, s52, s53
s_mul_i32 s78, s66, 303104
s_add_u32 s78, s78, s52
s_mul_i32 s79, s67, 303104
s_add_u32 s79, s79, s52
s_mov_b32 s76, 0
v_mov_b32 v7, 0x5d800000
s_mov_b32 s69, 64
v_accvgpr_read_b32 v180, a224
v_accvgpr_read_b32 v182, a228
v_cmp_nle_f32 vcc, v180, v7
v_cmp_nle_f32 s[96:97], v182, v7
s_nop 3
s_or_b64 vcc, vcc, s[96:97]
s_cbranch_vccnz L_NS
s_add_u32 s53, s77, 180224
buffer_load_dwordx4 a[112:115], v15, s[24:27], s53 offen offset:0 sc1
v_mul_f32 v8, 0x3fb8aa3b, v8
v_mul_f32 v9, 0x3fb8aa3b, v9
v_exp_f32 v8, v8
v_exp_f32 v9, v9
s_nop 0
v_fma_f32 v180, v180, v8, v180
v_fma_f32 v182, v182, v9, v182
v_rcp_f32 v180, v180
v_rcp_f32 v182, v182
s_add_u32 s52, s78, 4096
v_mov_b32 v181, v180
v_mov_b32 v183, v182
v_pk_mul_f32 v[36:37], v[36:37], v[180:181]
v_pk_mul_f32 v[38:39], v[38:39], v[180:181]
v_pk_mul_f32 v[32:33], v[32:33], v[180:181]
v_pk_mul_f32 v[34:35], v[34:35], v[180:181]
v_cvt_pk_bf16_f32 v36, v36, v37
v_cvt_pk_bf16_f32 v37, v38, v39
v_cvt_pk_bf16_f32 v38, v32, v33
v_cvt_pk_bf16_f32 v39, v34, v35
buffer_store_dwordx4 v[36:39], v15, s[24:27], s78 offen offset:0 sc1
buffer_load_dwordx4 a[116:119], v15, s[24:27], s53 offen offset:1024 sc1
v_pk_mul_f32 v[116:117], v[116:117], v[182:183]
v_pk_mul_f32 v[118:119], v[118:119], v[182:183]
v_pk_mul_f32 v[132:133], v[132:133], v[182:183]
v_pk_mul_f32 v[134:135], v[134:135], v[182:183]
v_cvt_pk_bf16_f32 v116, v116, v117
v_cvt_pk_bf16_f32 v117, v118, v119
v_cvt_pk_bf16_f32 v118, v132, v133
v_cvt_pk_bf16_f32 v119, v134, v135
buffer_store_dwordx4 v[116:119], v15, s[24:27], s78 offen offset:1024 sc1
v_pk_mul_f32 v[196:197], v[196:197], v[180:181]
v_pk_mul_f32 v[198:199], v[198:199], v[180:181]
v_pk_mul_f32 v[204:205], v[204:205], v[180:181]
v_pk_mul_f32 v[206:207], v[206:207], v[180:181]
v_cvt_pk_bf16_f32 v196, v196, v197
v_cvt_pk_bf16_f32 v197, v198, v199
v_cvt_pk_bf16_f32 v198, v204, v205
v_cvt_pk_bf16_f32 v199, v206, v207
buffer_store_dwordx4 v[196:199], v15, s[24:27], s78 offen offset:2048 sc1
v_pk_mul_f32 v[184:185], v[184:185], v[182:183]
v_pk_mul_f32 v[186:187], v[186:187], v[182:183]
v_pk_mul_f32 v[240:241], v[240:241], v[182:183]
buffer_load_dwordx4 a[120:123], v15, s[24:27], s53 offen offset:2048 sc1
v_pk_mul_f32 v[242:243], v[242:243], v[182:183]
v_cvt_pk_bf16_f32 v184, v184, v185
v_cvt_pk_bf16_f32 v185, v186, v187
v_cvt_pk_bf16_f32 v186, v240, v241
v_cvt_pk_bf16_f32 v187, v242, v243
buffer_store_dwordx4 v[184:187], v15, s[24:27], s78 offen offset:3072 sc1
v_pk_mul_f32 v[108:109], v[108:109], v[180:181]
v_pk_mul_f32 v[110:111], v[110:111], v[180:181]
v_pk_mul_f32 v[40:41], v[40:41], v[180:181]
v_pk_mul_f32 v[42:43], v[42:43], v[180:181]
v_cvt_pk_bf16_f32 v108, v108, v109
v_cvt_pk_bf16_f32 v109, v110, v111
v_cvt_pk_bf16_f32 v110, v40, v41
v_cvt_pk_bf16_f32 v111, v42, v43
buffer_store_dwordx4 v[108:111], v15, s[24:27], s52 offen offset:0 sc1
v_pk_mul_f32 v[188:189], v[188:189], v[182:183]
v_pk_mul_f32 v[190:191], v[190:191], v[182:183]
v_pk_mul_f32 v[56:57], v[56:57], v[182:183]
v_pk_mul_f32 v[58:59], v[58:59], v[182:183]
v_cvt_pk_bf16_f32 v188, v188, v189
v_cvt_pk_bf16_f32 v189, v190, v191
buffer_load_dwordx4 a[124:127], v15, s[24:27], s53 offen offset:3072 sc1
v_cvt_pk_bf16_f32 v190, v56, v57
v_cvt_pk_bf16_f32 v191, v58, v59
buffer_store_dwordx4 v[188:191], v15, s[24:27], s52 offen offset:1024 sc1
v_pk_mul_f32 v[80:81], v[80:81], v[180:181]
v_pk_mul_f32 v[82:83], v[82:83], v[180:181]
v_pk_mul_f32 v[168:169], v[168:169], v[180:181]
v_pk_mul_f32 v[170:171], v[170:171], v[180:181]
v_cvt_pk_bf16_f32 v80, v80, v81
v_cvt_pk_bf16_f32 v81, v82, v83
v_cvt_pk_bf16_f32 v82, v168, v169
v_cvt_pk_bf16_f32 v83, v170, v171
buffer_store_dwordx4 v[80:83], v15, s[24:27], s52 offen offset:2048 sc1
v_pk_mul_f32 v[88:89], v[88:89], v[182:183]
v_pk_mul_f32 v[90:91], v[90:91], v[182:183]
v_pk_mul_f32 v[192:193], v[192:193], v[182:183]
v_pk_mul_f32 v[194:195], v[194:195], v[182:183]
v_cvt_pk_bf16_f32 v88, v88, v89
v_cvt_pk_bf16_f32 v89, v90, v91
v_cvt_pk_bf16_f32 v90, v192, v193
v_cvt_pk_bf16_f32 v91, v194, v195
buffer_store_dwordx4 v[88:91], v15, s[24:27], s52 offen offset:3072 sc1
L_PAD9:
s_cbranch_execz L_PAD13
s_mov_b32 s76, 1
L_NS:
s_mov_b32 s74, s73
s_mov_b32 s93, s73
s_cmp_eq_u32 s72, 32
s_cbranch_scc1 L_FIN
L_SINGLE:
v_mfma_f32_16x16x32_bf16 v[44:47], a[192:195], a[48:51], v[128:131]
s_barrier
v_mfma_f32_16x16x32_bf16 v[44:47], a[196:199], a[52:55], v[44:47]
s_cmp_eq_u32 s68, s71
v_exp_f32 v229, v229
v_mfma_f32_16x16x32_bf16 v[44:47], a[200:203], a[0:3], v[44:47]
s_cselect_b32 s64, s77, s68
v_add_u32 v5, s75, v4
v_cvt_pk_bf16_f32 v234, v228, v229
v_mfma_f32_16x16x32_bf16 v[44:47], a[204:207], a[8:11], v[44:47]
s_mov_b32 m0, s70
v_exp_f32 v230, v230
v_mfma_f32_16x16x32_bf16 v[52:55], a[192:195], a[60:63], v[136:139]
buffer_load_dwordx4 v15, s[24:27], s64 offen offset:0 sc1 lds
v_mfma_f32_16x16x32_bf16 v[52:55], a[196:199], a[56:59], v[52:55]
s_add_u32 s75, s75, 16384
v_exp_f32 v231, v231
v_mfma_f32_16x16x32_bf16 v[52:55], a[200:203], a[16:19], v[52:55]
ds_read_b128 a[192:195], v5 offset:0
v_cvt_pk_bf16_f32 v235, v230, v231
v_mfma_f32_16x16x32_bf16 v[52:55], a[204:207], a[24:27], v[52:55]
s_cmp_ge_u32 s75, 163840
v_exp_f32 v44, v44
v_mfma_f32_16x16x32_bf16 v[64:67], a[208:211], a[48:51], v[144:147]
ds_read_b128 a[196:199], v5 offset:1024
ds_read_b128 a[200:203], v5 offset:2048
v_mfma_f32_16x16x32_bf16 v[64:67], a[212:215], a[52:55], v[64:67]
s_cselect_b32 s75, 0, s75
v_exp_f32 v45, v45
v_mfma_f32_16x16x32_bf16 v[64:67], a[216:219], a[0:3], v[64:67]
ds_read_b128 a[204:207], v5 offset:3072
v_cvt_pk_bf16_f32 v124, v44, v45
v_mfma_f32_16x16x32_bf16 v[64:67], a[220:223], a[8:11], v[64:67]
s_add_u32 s68, s64, 16384
v_exp_f32 v46, v46
v_mfma_f32_16x16x32_bf16 v[212:215], a[208:211], a[60:63], v[152:155]
buffer_load_dwordx4 v15, s[24:27], s64 offen offset:1024 sc1 lds
v_mfma_f32_16x16x32_bf16 v[212:215], a[212:215], a[56:59], v[212:215]
s_add_u32 s70, s70, 16384
v_exp_f32 v47, v47
v_mfma_f32_16x16x32_bf16 v[212:215], a[216:219], a[16:19], v[212:215]
ds_read_b128 a[208:211], v5 offset:4096
v_cvt_pk_bf16_f32 v125, v46, v47
v_mfma_f32_16x16x32_bf16 v[212:215], a[220:223], a[24:27], v[212:215]
s_waitcnt lgkmcnt(5)
v_exp_f32 v52, v52
v_mfma_f32_16x16x32_bf16 v[60:63], a[64:67], v[248:251], v[60:63]
ds_read_b128 a[212:215], v5 offset:5120
ds_read_b128 a[216:219], v5 offset:6144
v_mfma_f32_16x16x32_bf16 v[148:151], a[64:67], v[232:235], v[148:151]
s_cmp_ge_u32 s70, 163840
v_exp_f32 v53, v53
v_mfma_f32_16x16x32_bf16 v[48:51], a[68:71], v[232:235], v[48:51]
ds_read_b128 a[220:223], v5 offset:7168
v_cvt_pk_bf16_f32 v140, v52, v53
v_mfma_f32_16x16x32_bf16 v[68:71], a[68:71], v[248:251], v[68:71]
s_cselect_b32 s70, s80, s70
v_exp_f32 v54, v54
v_mfma_f32_16x16x32_bf16 v[72:75], a[72:75], v[248:251], v[72:75]
buffer_load_dwordx4 v15, s[24:27], s64 offen offset:2048 sc1 lds
v_mfma_f32_16x16x32_bf16 v[236:239], a[72:75], v[232:235], v[236:239]
v_exp_f32 v55, v55
v_mfma_f32_16x16x32_bf16 v[224:227], a[76:79], v[232:235], v[224:227]
ds_read_b128 a[64:67], v5 offset:8192
v_cvt_pk_bf16_f32 v141, v54, v55
v_mfma_f32_16x16x32_bf16 v[220:223], a[76:79], v[248:251], v[220:223]
v_exp_f32 v64, v64
v_mfma_f32_16x16x32_bf16 v[84:87], a[80:83], v[248:251], v[84:87]
ds_read_b128 a[68:71], v5 offset:9216
ds_read_b128 a[72:75], v5 offset:10240
v_mfma_f32_16x16x32_bf16 v[164:167], a[80:83], v[232:235], v[164:167]
v_exp_f32 v65, v65
v_mfma_f32_16x16x32_bf16 v[156:159], a[84:87], v[232:235], v[156:159]
ds_read_b128 a[76:79], v5 offset:11264
v_cvt_pk_bf16_f32 v126, v64, v65
v_mfma_f32_16x16x32_bf16 v[76:79], a[84:87], v[248:251], v[76:79]
s_cmp_eq_u32 s68, s71
v_exp_f32 v66, v66
v_mfma_f32_16x16x32_bf16 v[160:163], a[88:91], v[248:251], v[160:163]
buffer_load_dwordx4 v15, s[24:27], s64 offen offset:3072 sc1 lds
v_mfma_f32_16x16x32_bf16 v[216:219], a[88:91], v[232:235], v[216:219]
s_cselect_b32 s64, s77, s68
v_exp_f32 v67, v67
v_mfma_f32_16x16x32_bf16 v[208:211], a[92:95], v[232:235], v[208:211]
ds_read_b128 a[80:83], v5 offset:12288
v_cvt_pk_bf16_f32 v127, v66, v67
v_mfma_f32_16x16x32_bf16 v[252:255], a[92:95], v[248:251], v[252:255]
s_waitcnt lgkmcnt(5)
v_exp_f32 v212, v212
v_mfma_f32_16x16x32_bf16 a[232:235], a[240:243], v[248:251], a[232:235]
ds_read_b128 a[84:87], v5 offset:13312
ds_read_b128 a[88:91], v5 offset:14336
v_mfma_f32_16x16x32_bf16 a[236:239], a[240:243], v[232:235], a[236:239]
s_mov_b32 m0, s70
ds_read_b128 a[92:95], v5 offset:15360
v_mfma_f32_16x16x32_bf16 v[100:103], a[192:195], a[48:51], v[128:131]
buffer_load_dwordx4 v15, s[24:27], s64 offen offset:0 sc1 lds
v_mfma_f32_16x16x32_bf16 v[100:103], a[196:199], a[52:55], v[100:103]
v_exp_f32 v213, v213
v_mfma_f32_16x16x32_bf16 v[100:103], a[200:203], a[0:3], v[100:103]
v_add_u32 v5, s75, v4
v_cvt_pk_bf16_f32 v142, v212, v213
v_mfma_f32_16x16x32_bf16 v[100:103], a[204:207], a[8:11], v[100:103]
v_exp_f32 v214, v214
v_mfma_f32_16x16x32_bf16 v[92:95], a[192:195], a[60:63], v[136:139]
buffer_load_dwordx4 v15, s[24:27], s64 offen offset:1024 sc1 lds
v_mfma_f32_16x16x32_bf16 v[92:95], a[196:199], a[56:59], v[92:95]
s_add_u32 s75, s75, 16384
v_exp_f32 v215, v215
v_mfma_f32_16x16x32_bf16 v[92:95], a[200:203], a[16:19], v[92:95]
ds_read_b128 a[192:195], v5 offset:0
v_cvt_pk_bf16_f32 v143, v214, v215
v_mfma_f32_16x16x32_bf16 v[92:95], a[204:207], a[24:27], v[92:95]
s_cmp_ge_u32 s75, 163840
v_exp_f32 v100, v100
v_mfma_f32_16x16x32_bf16 v[176:179], a[208:211], a[48:51], v[144:147]
ds_read_b128 a[196:199], v5 offset:1024
ds_read_b128 a[200:203], v5 offset:2048
v_mfma_f32_16x16x32_bf16 v[176:179], a[212:215], a[52:55], v[176:179]
s_cselect_b32 s75, 0, s75
v_exp_f32 v101, v101
v_mfma_f32_16x16x32_bf16 v[176:179], a[216:219], a[0:3], v[176:179]
ds_read_b128 a[204:207], v5 offset:3072
v_cvt_pk_bf16_f32 v248, v100, v101
v_mfma_f32_16x16x32_bf16 v[176:179], a[220:223], a[8:11], v[176:179]
s_add_u32 s68, s64, 16384
v_exp_f32 v102, v102
v_mfma_f32_16x16x32_bf16 v[228:231], a[208:211], a[60:63], v[152:155]
buffer_load_dwordx4 v15, s[24:27], s64 offen offset:2048 sc1 lds
v_mfma_f32_16x16x32_bf16 v[228:231], a[212:215], a[56:59], v[228:231]
s_add_u32 s70, s70, 16384
v_exp_f32 v103, v103
v_mfma_f32_16x16x32_bf16 v[228:231], a[216:219], a[16:19], v[228:231]
ds_read_b128 a[208:211], v5 offset:4096
v_cvt_pk_bf16_f32 v249, v102, v103
v_mfma_f32_16x16x32_bf16 v[228:231], a[220:223], a[24:27], v[228:231]
s_waitcnt lgkmcnt(5)
v_exp_f32 v92, v92
v_mfma_f32_16x16x32_bf16 v[60:63], a[64:67], v[124:127], v[60:63]
ds_read_b128 a[212:215], v5 offset:5120
ds_read_b128 a[216:219], v5 offset:6144
v_mfma_f32_16x16x32_bf16 v[148:151], a[64:67], v[140:143], v[148:151]
s_cmp_ge_u32 s70, 163840
v_exp_f32 v93, v93
v_mfma_f32_16x16x32_bf16 v[48:51], a[68:71], v[140:143], v[48:51]
ds_read_b128 a[220:223], v5 offset:7168
v_cvt_pk_bf16_f32 v232, v92, v93
v_mfma_f32_16x16x32_bf16 v[68:71], a[68:71], v[124:127], v[68:71]
s_cselect_b32 s70, s80, s70
v_exp_f32 v94, v94
v_mfma_f32_16x16x32_bf16 v[72:75], a[72:75], v[124:127], v[72:75]
buffer_load_dwordx4 v15, s[24:27], s64 offen offset:3072 sc1 lds
v_mfma_f32_16x16x32_bf16 v[236:239], a[72:75], v[140:143], v[236:239]
s_add_u32 s72, s72, 1
v_exp_f32 v95, v95
v_mfma_f32_16x16x32_bf16 v[224:227], a[76:79], v[140:143], v[224:227]
ds_read_b128 a[64:67], v5 offset:8192
v_cvt_pk_bf16_f32 v233, v94, v95
v_mfma_f32_16x16x32_bf16 v[220:223], a[76:79], v[124:127], v[220:223]
v_exp_f32 v176, v176
v_mfma_f32_16x16x32_bf16 v[84:87], a[80:83], v[124:127], v[84:87]
ds_read_b128 a[68:71], v5 offset:9216
ds_read_b128 a[72:75], v5 offset:10240
v_mfma_f32_16x16x32_bf16 v[164:167], a[80:83], v[140:143], v[164:167]
v_exp_f32 v177, v177
v_mfma_f32_16x16x32_bf16 v[156:159], a[84:87], v[140:143], v[156:159]
ds_read_b128 a[76:79], v5 offset:11264
v_cvt_pk_bf16_f32 v250, v176, v177
v_mfma_f32_16x16x32_bf16 v[76:79], a[84:87], v[124:127], v[76:79]
v_exp_f32 v178, v178
v_mfma_f32_16x16x32_bf16 v[160:163], a[88:91], v[124:127], v[160:163]
ds_read_b128 a[80:83], v5 offset:12288
ds_read_b128 a[84:87], v5 offset:13312
v_mfma_f32_16x16x32_bf16 v[216:219], a[88:91], v[140:143], v[216:219]
s_cmp_lt_u32 s72, s74
v_exp_f32 v179, v179
v_mfma_f32_16x16x32_bf16 v[208:211], a[92:95], v[140:143], v[208:211]
ds_read_b128 a[88:91], v5 offset:14336
v_cvt_pk_bf16_f32 v251, v178, v179
v_mfma_f32_16x16x32_bf16 v[252:255], a[92:95], v[124:127], v[252:255]
s_waitcnt vmcnt(8) lgkmcnt(7)
v_exp_f32 v228, v228
v_mfma_f32_16x16x32_bf16 a[232:235], a[240:243], v[124:127], a[232:235]
ds_read_b128 a[92:95], v5 offset:15360
v_mfma_f32_16x16x32_bf16 a[236:239], a[240:243], v[140:143], a[236:239]
s_cbranch_scc1 L_SINGLE
s_cmp_eq_u32 s72, s69
s_cbranch_scc1 L_SE
s_cmp_lt_u32 s72, 32
s_cbranch_scc1 L_STOP
L_FIN:
s_add_u32 s53, s77, 196608
buffer_load_dwordx4 a[160:163], v15, s[24:27], s53 offen offset:0 sc1
v_cndmask_b32 v128, v128, v6, s[56:57]
v_cndmask_b32 v152, v152, v6, s[56:57]
v_mov_b32 v144, v6
buffer_load_dwordx4 a[164:167], v15, s[24:27], s53 offen offset:1024 sc1
v_cndmask_b32 v129, v129, v6, s[58:59]
v_cndmask_b32 v153, v153, v6, s[58:59]
v_mov_b32 v145, v6
buffer_load_dwordx4 a[168:171], v15, s[24:27], s53 offen offset:2048 sc1
v_cndmask_b32 v130, v130, v6, s[60:61]
v_cndmask_b32 v154, v154, v6, s[60:61]
v_mov_b32 v146, v6
buffer_load_dwordx4 a[172:175], v15, s[24:27], s53 offen offset:3072 sc1
v_cndmask_b32 v131, v131, v6, s[62:63]
v_cndmask_b32 v155, v155, v6, s[62:63]
v_mov_b32 v147, v6
s_mov_b32 s83, s75
s_sub_u32 s91, s70, s80
v_mfma_f32_16x16x32_bf16 v[44:47], a[192:195], a[48:51], v[128:131]
s_barrier
v_mfma_f32_16x16x32_bf16 v[44:47], a[196:199], a[52:55], v[44:47]
s_mov_b32 m0, s70
v_exp_f32 v229, v229
v_mfma_f32_16x16x32_bf16 v[44:47], a[200:203], a[0:3], v[44:47]
s_mov_b32 s64, s68
v_add_u32 v5, s75, v4
v_cvt_pk_bf16_f32 v234, v228, v229
v_mfma_f32_16x16x32_bf16 v[44:47], a[204:207], a[8:11], v[44:47]
s_add_u32 s68, s68, 16384
v_exp_f32 v230, v230
v_mfma_f32_16x16x32_bf16 v[52:55], a[192:195], a[60:63], v[136:139]
buffer_load_dwordx4 v15, s[24:27], s64 offen offset:0 sc1 lds
v_mfma_f32_16x16x32_bf16 v[52:55], a[196:199], a[56:59], v[52:55]
s_add_u32 s70, s70, 16384
v_exp_f32 v231, v231
v_mfma_f32_16x16x32_bf16 v[52:55], a[200:203], a[16:19], v[52:55]
v_cvt_pk_bf16_f32 v235, v230, v231
v_mul_f32 v10, 0x3fb8aa3b, v10
v_mfma_f32_16x16x32_bf16 v[52:55], a[204:207], a[24:27], v[52:55]
s_cmp_ge_u32 s70, 163840
v_exp_f32 v44, v44
v_mfma_f32_16x16x32_bf16 v[64:67], a[208:211], a[48:51], v[144:147]
buffer_load_dwordx4 v15, s[24:27], s64 offen offset:1024 sc1 lds
v_mfma_f32_16x16x32_bf16 v[64:67], a[212:215], a[52:55], v[64:67]
s_cselect_b32 s70, s80, s70
v_exp_f32 v45, v45
v_mfma_f32_16x16x32_bf16 v[64:67], a[216:219], a[0:3], v[64:67]
v_cvt_pk_bf16_f32 v124, v44, v45
v_mul_f32 v11, 0x3fb8aa3b, v11
v_mfma_f32_16x16x32_bf16 v[64:67], a[220:223], a[8:11], v[64:67]
v_exp_f32 v46, v46
v_mfma_f32_16x16x32_bf16 v[212:215], a[208:211], a[60:63], v[152:155]
buffer_load_dwordx4 v15, s[24:27], s64 offen offset:2048 sc1 lds
v_mfma_f32_16x16x32_bf16 v[212:215], a[212:215], a[56:59], v[212:215]
v_exp_f32 v47, v47
v_mfma_f32_16x16x32_bf16 v[212:215], a[216:219], a[16:19], v[212:215]
v_cvt_pk_bf16_f32 v125, v46, v47
v_mfma_f32_16x16x32_bf16 v[212:215], a[220:223], a[24:27], v[212:215]
s_waitcnt lgkmcnt(0)
v_exp_f32 v52, v52
v_mfma_f32_16x16x32_bf16 v[60:63], a[64:67], v[248:251], v[60:63]
buffer_load_dwordx4 v15, s[24:27], s64 offen offset:3072 sc1 lds
v_mfma_f32_16x16x32_bf16 v[148:151], a[64:67], v[232:235], v[148:151]
s_mov_b32 m0, s70
v_exp_f32 v53, v53
v_mfma_f32_16x16x32_bf16 v[48:51], a[68:71], v[232:235], v[48:51]
s_mov_b32 s64, s68
ds_read_b128 a[64:67], v5 offset:8192
v_cvt_pk_bf16_f32 v140, v52, v53
v_mfma_f32_16x16x32_bf16 v[68:71], a[68:71], v[248:251], v[68:71]
s_add_u32 s68, s68, 16384
v_exp_f32 v54, v54
v_mfma_f32_16x16x32_bf16 v[72:75], a[72:75], v[248:251], v[72:75]
buffer_load_dwordx4 v15, s[24:27], s64 offen offset:0 sc1 lds
v_mfma_f32_16x16x32_bf16 v[236:239], a[72:75], v[232:235], v[236:239]
s_add_u32 s70, s70, 16384
v_exp_f32 v55, v55
v_mfma_f32_16x16x32_bf16 v[224:227], a[76:79], v[232:235], v[224:227]
ds_read_b128 a[68:71], v5 offset:9216
v_cvt_pk_bf16_f32 v141, v54, v55
v_mfma_f32_16x16x32_bf16 v[220:223], a[76:79], v[248:251], v[220:223]
s_cmp_ge_u32 s70, 163840
v_exp_f32 v64, v64
v_mfma_f32_16x16x32_bf16 v[84:87], a[80:83], v[248:251], v[84:87]
ds_read_b128 a[72:75], v5 offset:10240
v_mfma_f32_16x16x32_bf16 v[164:167], a[80:83], v[232:235], v[164:167]
s_cselect_b32 s70, s80, s70
v_exp_f32 v65, v65
v_mfma_f32_16x16x32_bf16 v[156:159], a[84:87], v[232:235], v[156:159]
ds_read_b128 a[76:79], v5 offset:11264
v_cvt_pk_bf16_f32 v126, v64, v65
v_mfma_f32_16x16x32_bf16 v[76:79], a[84:87], v[248:251], v[76:79]
v_exp_f32 v66, v66
v_mfma_f32_16x16x32_bf16 v[160:163], a[88:91], v[248:251], v[160:163]
buffer_load_dwordx4 v15, s[24:27], s64 offen offset:1024 sc1 lds
v_mfma_f32_16x16x32_bf16 v[216:219], a[88:91], v[232:235], v[216:219]
s_add_u32 s52, s79, 4096
v_exp_f32 v67, v67
v_mfma_f32_16x16x32_bf16 v[208:211], a[92:95], v[232:235], v[208:211]
ds_read_b128 a[80:83], v5 offset:12288
v_cvt_pk_bf16_f32 v127, v66, v67
v_mfma_f32_16x16x32_bf16 v[252:255], a[92:95], v[248:251], v[252:255]
v_exp_f32 v212, v212
v_mfma_f32_16x16x32_bf16 a[232:235], a[240:243], v[248:251], a[232:235]
ds_read_b128 a[84:87], v5 offset:13312
ds_read_b128 a[88:91], v5 offset:14336
v_mfma_f32_16x16x32_bf16 a[236:239], a[240:243], v[232:235], a[236:239]
ds_read_b128 a[92:95], v5 offset:15360
v_exp_f32 v213, v213
v_exp_f32 v214, v214
v_exp_f32 v215, v215
v_exp_f32 v10, v10
v_cvt_pk_bf16_f32 v142, v212, v213
v_cvt_pk_bf16_f32 v143, v214, v215
v_exp_f32 v11, v11
s_waitcnt lgkmcnt(0)
v_mfma_f32_16x16x32_bf16 a[232:235], a[240:243], v[124:127], a[232:235]
buffer_load_dwordx4 v15, s[24:27], s64 offen offset:2048 sc1 lds
v_mfma_f32_16x16x32_bf16 a[236:239], a[240:243], v[140:143], a[236:239]
s_barrier
v_mfma_f32_16x16x32_bf16 v[60:63], a[64:67], v[124:127], v[60:63]
v_cmp_eq_u32 vcc, 0, v3
v_mul_u32_u24 v244, 1536, v3
v_mfma_f32_16x16x32_bf16 v[148:151], a[64:67], v[140:143], v[148:151]
v_mov_b32 v246, 9728
v_cndmask_b32 v244, v244, v246, vcc
v_mfma_f32_16x16x32_bf16 v[48:51], a[68:71], v[140:143], v[48:51]
buffer_load_dwordx4 v15, s[24:27], s64 offen offset:3072 sc1 lds
v_mfma_f32_16x16x32_bf16 v[68:71], a[68:71], v[124:127], v[68:71]
v_lshl_add_u32 v247, v2, 4, s83
v_mov_b32 v246, 10496
v_mfma_f32_16x16x32_bf16 v[72:75], a[72:75], v[124:127], v[72:75]
v_accvgpr_read_b32 v180, a232
v_accvgpr_read_b32 v182, a236
v_mfma_f32_16x16x32_bf16 v[236:239], a[72:75], v[140:143], v[236:239]
v_cmp_nle_f32 vcc, v180, v7
v_cmp_nle_f32 s[96:97], v182, v7
v_mfma_f32_16x16x32_bf16 v[224:227], a[76:79], v[140:143], v[224:227]
v_fma_f32 v180, v180, v10, v180
v_fma_f32 v182, v182, v11, v182
v_mfma_f32_16x16x32_bf16 v[220:223], a[76:79], v[124:127], v[220:223]
v_rcp_f32 v180, v180
v_mfma_f32_16x16x32_bf16 v[84:87], a[80:83], v[124:127], v[84:87]
s_or_b64 vcc, vcc, s[96:97]
v_rcp_f32 v182, v182
v_mfma_f32_16x16x32_bf16 v[164:167], a[80:83], v[140:143], v[164:167]
v_mul_f32 v60, v180, v60
v_mul_f32 v61, v180, v61
v_mfma_f32_16x16x32_bf16 v[156:159], a[84:87], v[140:143], v[156:159]
v_mul_f32 v62, v180, v62
v_mul_f32 v63, v180, v63
v_mfma_f32_16x16x32_bf16 v[76:79], a[84:87], v[124:127], v[76:79]
v_mul_f32 v68, v180, v68
v_mul_f32 v69, v180, v69
v_mfma_f32_16x16x32_bf16 v[160:163], a[88:91], v[124:127], v[160:163]
v_mul_f32 v70, v180, v70
v_mul_f32 v71, v180, v71
v_mfma_f32_16x16x32_bf16 v[216:219], a[88:91], v[140:143], v[216:219]
v_cvt_pk_bf16_f32 v60, v60, v61
v_cvt_pk_bf16_f32 v61, v62, v63
v_mfma_f32_16x16x32_bf16 v[208:211], a[92:95], v[140:143], v[208:211]
v_cvt_pk_bf16_f32 v62, v68, v69
v_cvt_pk_bf16_f32 v63, v70, v71
v_mfma_f32_16x16x32_bf16 v[252:255], a[92:95], v[124:127], v[252:255]
s_cbranch_vccnz SLOW1
L_EP:
buffer_store_dwordx4 v[60:63], v15, s[24:27], s79 offen offset:0 sc1
v_pk_mul_f32 v[148:149], v[148:149], v[182:183] op_sel_hi:[1,0]
v_pk_mul_f32 v[150:151], v[150:151], v[182:183] op_sel_hi:[1,0]
v_pk_mul_f32 v[48:49], v[48:49], v[182:183] op_sel_hi:[1,0]
v_pk_mul_f32 v[50:51], v[50:51], v[182:183] op_sel_hi:[1,0]
v_cvt_pk_bf16_f32 v148, v148, v149
v_cvt_pk_bf16_f32 v149, v150, v151
v_cvt_pk_bf16_f32 v150, v48, v49
v_cvt_pk_bf16_f32 v151, v50, v51
buffer_store_dwordx4 v[148:151], v15, s[24:27], s79 offen offset:1024 sc1
v_pk_mul_f32 v[72:73], v[72:73], v[180:181] op_sel_hi:[1,0]
v_pk_mul_f32 v[74:75], v[74:75], v[180:181] op_sel_hi:[1,0]
v_pk_mul_f32 v[220:221], v[220:221], v[180:181] op_sel_hi:[1,0]
v_pk_mul_f32 v[222:223], v[222:223], v[180:181] op_sel_hi:[1,0]
v_cvt_pk_bf16_f32 v72, v72, v73
v_cvt_pk_bf16_f32 v73, v74, v75
v_cvt_pk_bf16_f32 v74, v220, v221
v_cvt_pk_bf16_f32 v75, v222, v223
buffer_store_dwordx4 v[72:75], v15, s[24:27], s79 offen offset:2048 sc1
v_pk_mul_f32 v[236:237], v[236:237], v[182:183] op_sel_hi:[1,0]
v_pk_mul_f32 v[238:239], v[238:239], v[182:183] op_sel_hi:[1,0]
v_pk_mul_f32 v[224:225], v[224:225], v[182:183] op_sel_hi:[1,0]
v_pk_mul_f32 v[226:227], v[226:227], v[182:183] op_sel_hi:[1,0]
v_cvt_pk_bf16_f32 v236, v236, v237
v_cvt_pk_bf16_f32 v237, v238, v239
v_cvt_pk_bf16_f32 v238, v224, v225
v_cvt_pk_bf16_f32 v239, v226, v227
buffer_store_dwordx4 v[236:239], v15, s[24:27], s79 offen offset:3072 sc1
v_pk_mul_f32 v[84:85], v[84:85], v[180:181] op_sel_hi:[1,0]
v_pk_mul_f32 v[86:87], v[86:87], v[180:181] op_sel_hi:[1,0]
v_pk_mul_f32 v[76:77], v[76:77], v[180:181] op_sel_hi:[1,0]
v_pk_mul_f32 v[78:79], v[78:79], v[180:181] op_sel_hi:[1,0]
v_cvt_pk_bf16_f32 v84, v84, v85
v_cvt_pk_bf16_f32 v85, v86, v87
v_cvt_pk_bf16_f32 v86, v76, v77
v_cvt_pk_bf16_f32 v87, v78, v79
buffer_store_dwordx4 v[84:87], v15, s[24:27], s52 offen offset:0 sc1
v_pk_mul_f32 v[164:165], v[164:165], v[182:183] op_sel_hi:[1,0]
v_pk_mul_f32 v[166:167], v[166:167], v[182:183] op_sel_hi:[1,0]
v_pk_mul_f32 v[156:157], v[156:157], v[182:183] op_sel_hi:[1,0]
v_pk_mul_f32 v[158:159], v[158:159], v[182:183] op_sel_hi:[1,0]
v_cvt_pk_bf16_f32 v164, v164, v165
v_cvt_pk_bf16_f32 v165, v166, v167
v_cvt_pk_bf16_f32 v166, v156, v157
v_cvt_pk_bf16_f32 v167, v158, v159
buffer_store_dwordx4 v[164:167], v15, s[24:27], s52 offen offset:1024 sc1
v_pk_mul_f32 v[160:161], v[160:161], v[180:181] op_sel_hi:[1,0]
v_pk_mul_f32 v[162:163], v[162:163], v[180:181] op_sel_hi:[1,0]
v_pk_mul_f32 v[252:253], v[252:253], v[180:181] op_sel_hi:[1,0]
v_pk_mul_f32 v[254:255], v[254:255], v[180:181] op_sel_hi:[1,0]
v_cvt_pk_bf16_f32 v160, v160, v161
v_cvt_pk_bf16_f32 v161, v162, v163
v_cvt_pk_bf16_f32 v162, v252, v253
v_cvt_pk_bf16_f32 v163, v254, v255
buffer_store_dwordx4 v[160:163], v15, s[24:27], s52 offen offset:2048 sc1
v_pk_mul_f32 v[216:217], v[216:217], v[182:183] op_sel_hi:[1,0]
v_pk_mul_f32 v[218:219], v[218:219], v[182:183] op_sel_hi:[1,0]
v_pk_mul_f32 v[208:209], v[208:209], v[182:183] op_sel_hi:[1,0]
v_pk_mul_f32 v[210:211], v[210:211], v[182:183] op_sel_hi:[1,0]
v_cvt_pk_bf16_f32 v216, v216, v217
v_cvt_pk_bf16_f32 v217, v218, v219
v_cvt_pk_bf16_f32 v218, v208, v209
v_cvt_pk_bf16_f32 v219, v210, v211
buffer_store_dwordx4 v[216:219], v15, s[24:27], s52 offen offset:3072 sc1
v_cmp_eq_u32 vcc, 3, v3
v_mul_u32_u24 v200, 768, v3
v_add_u32 v200, v200, v247
ds_write_b128 v200, a[244:247] offset:0
v_cndmask_b32 v245, v244, v246, vcc
ds_write_b128 v200, a[248:251] offset:3072
v_add_u32 v247, -1280, v247
ds_write_b128 v200, a[252:255] offset:6144
v_add_u32 v244, v244, v247
v_add_u32 v245, v245, v247
ds_write_b128 v244, a[128:131] offset:0
v_cmp_lt_u32 vcc, 31, v1
ds_write_b128 v245, a[132:135] offset:768
v_and_b32 v202, 31, v1
ds_write_b128 v244, a[136:139] offset:256
v_mov_b32 v200, s66
ds_write_b128 v245, a[140:143] offset:1024
v_mov_b32 v203, s67
ds_write_b128 v244, a[144:147] offset:3840
v_cndmask_b32 v200, v200, v203, vcc
ds_write_b128 v245, a[148:151] offset:4608
v_lshl_add_u32 v200, v200, 5, v202
ds_write_b128 v244, a[152:155] offset:4096
v_lshrrev_b32 v201, 5, v1
ds_write_b128 v245, a[156:159] offset:4864
v_mul_u32_u24 v201, 3840, v201
v_lshl_add_u32 v201, v202, 4, v201
v_add_u32 v201, s83, v201
s_cmp_eq_u32 s76, 0
s_cbranch_scc1 L_SE2
L_LA:
v_mov_b32 v5, v200
v_mov_b32 v6, v201
v_mov_b32 v13, 0
s_lshl_b32 s74, s66, 10
s_lshr_b32 s52, s4, 3
s_lshl_b32 s52, s52, 7
s_add_u32 s74, s74, s52
s_add_u32 s74, s74, 75497472
ds_read_b128 v[16:19], v6 offset:8448
ds_read_b128 v[20:23], v6 offset:9216
ds_read_b128 v[96:99], v6 offset:3328
ds_read_b128 v[32:35], v6 offset:256
ds_read_b128 v[36:39], v6 offset:1024
ds_read_b128 v[100:103], v6 offset:3296
ds_read_b128 v[40:43], v6 offset:224
ds_read_b128 v[44:47], v6 offset:992
ds_read_b128 v[104:107], v6 offset:3264
ds_read_b128 v[48:51], v6 offset:192
ds_read_b128 v[52:55], v6 offset:960
ds_read_b128 v[108:111], v6 offset:3232
ds_read_b128 v[56:59], v6 offset:160
ds_read_b128 v[60:63], v6 offset:928
ds_read_b128 v[112:115], v6 offset:3200
ds_read_b128 v[64:67], v6 offset:128
ds_read_b128 v[68:71], v6 offset:896
ds_read_b128 v[116:119], v6 offset:3168
ds_read_b128 v[72:75], v6 offset:96
ds_read_b128 v[76:79], v6 offset:864
ds_read_b128 v[120:123], v6 offset:3136
ds_read_b128 v[80:83], v6 offset:64
ds_read_b128 v[84:87], v6 offset:832
ds_read_b128 v[124:127], v6 offset:3104
ds_read_b128 v[88:91], v6 offset:32
ds_read_b128 v[92:95], v6 offset:800
ds_read_b128 v[128:131], v6 offset:1792
ds_read_b128 v[132:135], v6 offset:2560
s_waitcnt vmcnt(0)
buffer_atomic_add v1, v0, s[24:27], s74 offen offset:0 sc1
ds_read_b128 v[136:139], v6 offset:1760
ds_read_b128 v[140:143], v6 offset:2528
ds_read_b128 v[144:147], v6 offset:1728
ds_read_b128 v[148:151], v6 offset:2496
ds_read_b128 v[152:155], v6 offset:1696
ds_read_b128 v[156:159], v6 offset:2464
ds_read_b128 v[160:163], v6 offset:1664
ds_read_b128 v[164:167], v6 offset:2432
ds_read_b128 v[168:171], v6 offset:1632
ds_read_b128 v[172:175], v6 offset:2400
ds_read_b128 v[176:179], v6 offset:1600
ds_read_b128 v[180:183], v6 offset:2368
ds_read_b128 v[184:187], v6 offset:1568
ds_read_b128 v[188:191], v6 offset:2336
s_lshr_b32 s52, s3, 1
s_lshl1_add_u32 s72, s85, s52
s_lshl3_add_u32 s75, s72, s84
s_lshl_b32 s75, s75, 7
s_add_u32 s75, s75, 75497472
s_and_b32 s82, s86, 1
s_lshl_b32 s82, s82, 13
s_lshr_b32 s53, s4, 3
s_mul_i32 s53, s53, 75776
s_add_u32 s53, s53, 54525952
s_and_b32 s52, s3, 1
s_lshl_b32 s52, s52, 10
s_add_u32 s52, s52, s53
s_sub_u32 s54, 63, s72
s_mul_i32 s77, s72, 303104
s_add_u32 s77, s77, s52
s_mul_i32 s81, s54, 303104
s_add_u32 s81, s81, s52
s_add_u32 s91, s91, 114688
s_sub_u32 s52, s91, 163840
s_cmp_ge_u32 s91, 163840
s_cselect_b32 s91, s52, s91
v_add_u32 v14, 4096, v15
v_add_u32 v7, s91, v4
s_waitcnt lgkmcnt(0)
s_barrier
s_mov_b32 m0, s70
s_mov_b32 s64, s68
s_add_u32 s68, s68, 16384
s_add_u32 s70, s70, 16384
s_cmp_ge_u32 s70, 163840
s_cselect_b32 s70, s80, s70
buffer_load_dwordx4 v15, s[24:27], s64 offen offset:0 sc1 lds
v_and_b32 v9, 0xffff, v97
v_and_b32 v11, 0xffff0000, v97
v_dot2_f32_bf16 v24, v98, v99, 0
v_dot2_f32_bf16 v25, v102, v99, 0
v_dot2_f32_bf16 v26, v106, v99, 0
v_dot2_f32_bf16 v27, v110, v99, 0
v_dot2_f32_bf16 v28, v114, v99, 0
v_dot2_f32_bf16 v29, v118, v99, 0
v_dot2_f32_bf16 v30, v122, v99, 0
v_dot2_f32_bf16 v31, v126, v99, 0
v_dot2c_f32_bf16 v24, v96, v9
v_dot2c_f32_bf16 v25, v100, v9
v_dot2c_f32_bf16 v26, v104, v9
v_dot2c_f32_bf16 v27, v108, v9
v_dot2c_f32_bf16 v28, v112, v9
v_dot2c_f32_bf16 v29, v116, v9
buffer_load_dwordx4 v15, s[24:27], s64 offen offset:1024 sc1 lds
v_dot2c_f32_bf16 v30, v120, v9
v_dot2c_f32_bf16 v31, v124, v9
v_dot2c_f32_bf16 v24, v16, v32
v_dot2c_f32_bf16 v25, v16, v40
v_dot2c_f32_bf16 v26, v16, v48
v_dot2c_f32_bf16 v27, v16, v56
v_dot2c_f32_bf16 v28, v16, v64
v_dot2c_f32_bf16 v29, v16, v72
v_dot2c_f32_bf16 v30, v16, v80
v_dot2c_f32_bf16 v31, v16, v88
v_dot2c_f32_bf16 v24, v17, v33
v_dot2c_f32_bf16 v25, v17, v41
v_dot2c_f32_bf16 v26, v17, v49
v_dot2c_f32_bf16 v27, v17, v57
v_dot2c_f32_bf16 v28, v17, v65
v_dot2c_f32_bf16 v29, v17, v73
buffer_load_dwordx4 v15, s[24:27], s64 offen offset:2048 sc1 lds
v_dot2c_f32_bf16 v30, v17, v81
v_dot2c_f32_bf16 v31, v17, v89
v_dot2c_f32_bf16 v24, v18, v34
v_dot2c_f32_bf16 v25, v18, v42
v_dot2c_f32_bf16 v26, v18, v50
v_dot2c_f32_bf16 v27, v18, v58
v_dot2c_f32_bf16 v28, v18, v66
v_dot2c_f32_bf16 v29, v18, v74
v_dot2c_f32_bf16 v30, v18, v82
v_dot2c_f32_bf16 v31, v18, v90
v_dot2c_f32_bf16 v24, v19, v35
v_dot2c_f32_bf16 v25, v19, v43
v_dot2c_f32_bf16 v26, v19, v51
v_dot2c_f32_bf16 v27, v19, v59
v_dot2c_f32_bf16 v28, v19, v67
v_dot2c_f32_bf16 v29, v19, v75
buffer_load_dwordx4 v15, s[24:27], s64 offen offset:3072 sc1 lds
v_dot2c_f32_bf16 v30, v19, v83
v_dot2c_f32_bf16 v31, v19, v91
v_dot2c_f32_bf16 v24, v20, v36
v_dot2c_f32_bf16 v25, v20, v44
v_dot2c_f32_bf16 v26, v20, v52
v_dot2c_f32_bf16 v27, v20, v60
v_dot2c_f32_bf16 v28, v20, v68
v_dot2c_f32_bf16 v29, v20, v76
v_dot2c_f32_bf16 v30, v20, v84
v_dot2c_f32_bf16 v31, v20, v92
v_dot2c_f32_bf16 v24, v21, v37
v_dot2c_f32_bf16 v25, v21, v45
v_dot2c_f32_bf16 v26, v21, v53
v_dot2c_f32_bf16 v27, v21, v61
v_dot2c_f32_bf16 v28, v21, v69
v_dot2c_f32_bf16 v29, v21, v77
s_mov_b32 m0, s70
s_mov_b32 s64, s68
s_add_u32 s68, s68, 16384
s_add_u32 s70, s70, 16384
s_cmp_ge_u32 s70, 163840
s_cselect_b32 s70, s80, s70
buffer_load_dwordx4 v15, s[24:27], s64 offen offset:0 sc1 lds
v_dot2c_f32_bf16 v30, v21, v85
v_dot2c_f32_bf16 v31, v21, v93
v_dot2c_f32_bf16 v24, v22, v38
v_dot2c_f32_bf16 v25, v22, v46
v_dot2c_f32_bf16 v26, v22, v54
v_dot2c_f32_bf16 v27, v22, v62
v_dot2c_f32_bf16 v28, v22, v70
v_dot2c_f32_bf16 v29, v22, v78
L_PAD10:
s_cbranch_execz L_MAIN
v_dot2c_f32_bf16 v30, v22, v86
v_dot2c_f32_bf16 v31, v22, v94
v_dot2c_f32_bf16 v24, v23, v39
v_dot2c_f32_bf16 v25, v23, v47
v_dot2c_f32_bf16 v26, v23, v55
v_dot2c_f32_bf16 v27, v23, v63
v_dot2c_f32_bf16 v28, v23, v71
v_dot2c_f32_bf16 v29, v23, v79
buffer_load_dwordx4 v15, s[24:27], s64 offen offset:1024 sc1 lds
v_dot2c_f32_bf16 v30, v23, v87
v_dot2c_f32_bf16 v31, v23, v95
v_mov_b32 v9, 0xf149f2ca
v_mul_f32 v11, 0xbfb8aa3b, v11
v_exp_f32 v11, v11
v_cmp_gt_u32 vcc, 2, v5
v_cmp_gt_u32 s[56:57], 4, v5
s_nop 0
v_cndmask_b32 v25, v25, v9, vcc
v_cndmask_b32 v26, v26, v9, s[56:57]
v_cmp_gt_u32 vcc, 6, v5
v_cmp_gt_u32 s[56:57], 8, v5
s_nop 0
v_cndmask_b32 v27, v27, v9, vcc
v_cndmask_b32 v28, v28, v9, s[56:57]
v_cmp_gt_u32 vcc, 10, v5
buffer_load_dwordx4 v15, s[24:27], s64 offen offset:2048 sc1 lds
v_cmp_gt_u32 s[56:57], 12, v5
s_nop 0
v_cndmask_b32 v29, v29, v9, vcc
v_cndmask_b32 v30, v30, v9, s[56:57]
v_cmp_gt_u32 vcc, 14, v5
s_nop 0
s_nop 0
v_cndmask_b32 v31, v31, v9, vcc
v_max3_f32 v10, v24, v25, v26
v_max3_f32 v10, v10, v27, v28
v_max3_f32 v10, v10, v29, v30
v_max_f32 v10, v10, v31
s_mov_b32 s52, 0x3eae1a93
v_sub_f32 v24, v24, v10
v_sub_f32 v25, v25, v10
v_sub_f32 v26, v26, v10
buffer_load_dwordx4 v15, s[24:27], s64 offen offset:3072 sc1 lds
v_sub_f32 v27, v27, v10
v_sub_f32 v28, v28, v10
v_sub_f32 v29, v29, v10
v_sub_f32 v30, v30, v10
v_sub_f32 v31, v31, v10
v_mul_f32 v24, s52, v24
v_mul_f32 v25, s52, v25
v_mul_f32 v26, s52, v26
v_mul_f32 v27, s52, v27
v_mul_f32 v28, s52, v28
v_mul_f32 v29, s52, v29
v_mul_f32 v30, s52, v30
v_mul_f32 v31, s52, v31
v_exp_f32 v24, v24
v_exp_f32 v25, v25
v_exp_f32 v26, v26
s_mov_b32 m0, s70
s_mov_b32 s64, s68
s_add_u32 s68, s68, 16384
s_add_u32 s70, s70, 16384
s_cmp_ge_u32 s70, 163840
s_cselect_b32 s70, s80, s70
buffer_load_dwordx4 v15, s[24:27], s64 offen offset:0 sc1 lds
v_exp_f32 v27, v27
v_exp_f32 v28, v28
v_exp_f32 v29, v29
v_exp_f32 v30, v30
v_exp_f32 v31, v31
v_cvt_pk_bf16_f32 v32, v24, 0
v_cvt_pk_bf16_f32 v40, v25, 0
v_cvt_pk_bf16_f32 v48, v26, 0
v_cvt_pk_bf16_f32 v56, v27, 0
v_cvt_pk_bf16_f32 v64, v28, 0
v_cvt_pk_bf16_f32 v72, v29, 0
v_cvt_pk_bf16_f32 v80, v30, 0
v_cvt_pk_bf16_f32 v88, v31, 0
v_lshlrev_b32 v33, 16, v32
v_lshlrev_b32 v41, 16, v40
v_lshlrev_b32 v49, 16, v48
buffer_load_dwordx4 v15, s[24:27], s64 offen offset:1024 sc1 lds
v_lshlrev_b32 v57, 16, v56
v_lshlrev_b32 v65, 16, v64
v_lshlrev_b32 v73, 16, v72
v_lshlrev_b32 v81, 16, v80
v_lshlrev_b32 v89, 16, v88
v_add_f32 v10, v33, v41
v_add_f32 v10, v10, v49
v_add_f32 v10, v10, v57
v_add_f32 v10, v10, v65
v_add_f32 v10, v10, v73
v_add_f32 v10, v10, v81
v_add_f32 v10, v10, v89
v_fmac_f32 v10, v10, v11
v_rcp_f32 v10, v10
v_dot2_f32_bf16 v192, v128, v32, 0
v_dot2_f32_bf16 v193, v128, v33, 0
buffer_load_dwordx4 v15, s[24:27], s64 offen offset:2048 sc1 lds
v_dot2_f32_bf16 v194, v129, v32, 0
v_dot2_f32_bf16 v195, v129, v33, 0
v_dot2_f32_bf16 v196, v130, v32, 0
v_dot2_f32_bf16 v197, v130, v33, 0
v_dot2_f32_bf16 v198, v131, v32, 0
v_dot2_f32_bf16 v199, v131, v33, 0
v_dot2_f32_bf16 v200, v132, v32, 0
v_dot2_f32_bf16 v201, v132, v33, 0
v_dot2_f32_bf16 v202, v133, v32, 0
v_dot2_f32_bf16 v203, v133, v33, 0
v_dot2_f32_bf16 v204, v134, v32, 0
v_dot2_f32_bf16 v205, v134, v33, 0
v_dot2_f32_bf16 v206, v135, v32, 0
v_dot2_f32_bf16 v207, v135, v33, 0
v_dot2_f32_bf16 v208, v96, v33, 0
v_dot2_f32_bf16 v209, v98, v33, 0
buffer_load_dwordx4 v15, s[24:27], s64 offen offset:3072 sc1 lds
v_dot2c_f32_bf16 v192, v136, v40
v_dot2c_f32_bf16 v193, v136, v41
v_dot2c_f32_bf16 v194, v137, v40
v_dot2c_f32_bf16 v195, v137, v41
v_dot2c_f32_bf16 v196, v138, v40
v_dot2c_f32_bf16 v197, v138, v41
v_dot2c_f32_bf16 v198, v139, v40
v_dot2c_f32_bf16 v199, v139, v41
v_dot2c_f32_bf16 v200, v140, v40
v_dot2c_f32_bf16 v201, v140, v41
v_dot2c_f32_bf16 v202, v141, v40
v_dot2c_f32_bf16 v203, v141, v41
v_dot2c_f32_bf16 v204, v142, v40
v_dot2c_f32_bf16 v205, v142, v41
v_dot2c_f32_bf16 v206, v143, v40
v_dot2c_f32_bf16 v207, v143, v41
s_mov_b32 m0, s70
s_mov_b32 s64, s68
s_add_u32 s68, s68, 16384
s_add_u32 s70, s70, 16384
s_cmp_ge_u32 s70, 163840
s_cselect_b32 s70, s80, s70
buffer_load_dwordx4 v15, s[24:27], s64 offen offset:0 sc1 lds
v_dot2c_f32_bf16 v208, v100, v41
v_dot2c_f32_bf16 v209, v102, v41
v_dot2c_f32_bf16 v192, v144, v48
v_dot2c_f32_bf16 v193, v144, v49
v_dot2c_f32_bf16 v194, v145, v48
v_dot2c_f32_bf16 v195, v145, v49
v_dot2c_f32_bf16 v196, v146, v48
v_dot2c_f32_bf16 v197, v146, v49
v_dot2c_f32_bf16 v198, v147, v48
v_dot2c_f32_bf16 v199, v147, v49
v_dot2c_f32_bf16 v200, v148, v48
v_dot2c_f32_bf16 v201, v148, v49
v_dot2c_f32_bf16 v202, v149, v48
v_dot2c_f32_bf16 v203, v149, v49
v_dot2c_f32_bf16 v204, v150, v48
v_dot2c_f32_bf16 v205, v150, v49
buffer_load_dwordx4 v15, s[24:27], s64 offen offset:1024 sc1 lds
v_dot2c_f32_bf16 v206, v151, v48
v_dot2c_f32_bf16 v207, v151, v49
v_dot2c_f32_bf16 v208, v104, v49
v_dot2c_f32_bf16 v209, v106, v49
v_dot2c_f32_bf16 v192, v152, v56
v_dot2c_f32_bf16 v193, v152, v57
v_dot2c_f32_bf16 v194, v153, v56
v_dot2c_f32_bf16 v195, v153, v57
v_dot2c_f32_bf16 v196, v154, v56
v_dot2c_f32_bf16 v197, v154, v57
v_dot2c_f32_bf16 v198, v155, v56
v_dot2c_f32_bf16 v199, v155, v57
v_dot2c_f32_bf16 v200, v156, v56
v_dot2c_f32_bf16 v201, v156, v57
v_dot2c_f32_bf16 v202, v157, v56
v_dot2c_f32_bf16 v203, v157, v57
buffer_load_dwordx4 v15, s[24:27], s64 offen offset:2048 sc1 lds
v_dot2c_f32_bf16 v204, v158, v56
v_dot2c_f32_bf16 v205, v158, v57
v_dot2c_f32_bf16 v206, v159, v56
v_dot2c_f32_bf16 v207, v159, v57
v_dot2c_f32_bf16 v208, v108, v57
v_dot2c_f32_bf16 v209, v110, v57
v_dot2c_f32_bf16 v192, v160, v64
v_dot2c_f32_bf16 v193, v160, v65
v_dot2c_f32_bf16 v194, v161, v64
v_dot2c_f32_bf16 v195, v161, v65
v_dot2c_f32_bf16 v196, v162, v64
v_dot2c_f32_bf16 v197, v162, v65
v_dot2c_f32_bf16 v198, v163, v64
v_dot2c_f32_bf16 v199, v163, v65
v_dot2c_f32_bf16 v200, v164, v64
v_dot2c_f32_bf16 v201, v164, v65
buffer_load_dword v12, v13, s[24:27], s75 offen sc1
v_dot2c_f32_bf16 v202, v165, v64
v_dot2c_f32_bf16 v203, v165, v65
v_dot2c_f32_bf16 v204, v166, v64
v_dot2c_f32_bf16 v205, v166, v65
v_dot2c_f32_bf16 v206, v167, v64
v_dot2c_f32_bf16 v207, v167, v65
v_dot2c_f32_bf16 v208, v112, v65
v_dot2c_f32_bf16 v209, v114, v65
v_dot2c_f32_bf16 v192, v168, v72
v_dot2c_f32_bf16 v193, v168, v73
v_dot2c_f32_bf16 v194, v169, v72
v_dot2c_f32_bf16 v195, v169, v73
v_dot2c_f32_bf16 v196, v170, v72
v_dot2c_f32_bf16 v197, v170, v73
v_dot2c_f32_bf16 v198, v171, v72
v_dot2c_f32_bf16 v199, v171, v73
buffer_load_dwordx4 v15, s[24:27], s64 offen offset:3072 sc1 lds
v_dot2c_f32_bf16 v200, v172, v72
v_dot2c_f32_bf16 v201, v172, v73
v_dot2c_f32_bf16 v202, v173, v72
v_dot2c_f32_bf16 v203, v173, v73
v_dot2c_f32_bf16 v204, v174, v72
v_dot2c_f32_bf16 v205, v174, v73
v_dot2c_f32_bf16 v206, v175, v72
v_dot2c_f32_bf16 v207, v175, v73
v_dot2c_f32_bf16 v208, v116, v73
v_dot2c_f32_bf16 v209, v118, v73
v_dot2c_f32_bf16 v192, v176, v80
v_dot2c_f32_bf16 v193, v176, v81
v_dot2c_f32_bf16 v194, v177, v80
v_dot2c_f32_bf16 v195, v177, v81
v_dot2c_f32_bf16 v196, v178, v80
v_dot2c_f32_bf16 v197, v178, v81
s_mov_b32 m0, s70
s_mov_b32 s64, s68
s_add_u32 s68, s68, 16384
s_add_u32 s70, s70, 16384
s_cmp_ge_u32 s70, 163840
s_cselect_b32 s70, s80, s70
buffer_load_dwordx4 v15, s[24:27], s64 offen offset:0 sc1 lds
v_dot2c_f32_bf16 v198, v179, v80
v_dot2c_f32_bf16 v199, v179, v81
v_dot2c_f32_bf16 v200, v180, v80
v_dot2c_f32_bf16 v201, v180, v81
v_dot2c_f32_bf16 v202, v181, v80
v_dot2c_f32_bf16 v203, v181, v81
v_dot2c_f32_bf16 v204, v182, v80
v_dot2c_f32_bf16 v205, v182, v81
v_dot2c_f32_bf16 v206, v183, v80
v_dot2c_f32_bf16 v207, v183, v81
v_dot2c_f32_bf16 v208, v120, v81
v_dot2c_f32_bf16 v209, v122, v81
v_dot2c_f32_bf16 v192, v184, v88
v_dot2c_f32_bf16 v193, v184, v89
v_dot2c_f32_bf16 v194, v185, v88
v_dot2c_f32_bf16 v195, v185, v89
buffer_load_dwordx4 v15, s[24:27], s64 offen offset:1024 sc1 lds
v_dot2c_f32_bf16 v196, v186, v88
v_dot2c_f32_bf16 v197, v186, v89
v_dot2c_f32_bf16 v198, v187, v88
v_dot2c_f32_bf16 v199, v187, v89
v_dot2c_f32_bf16 v200, v188, v88
v_dot2c_f32_bf16 v201, v188, v89
v_dot2c_f32_bf16 v202, v189, v88
v_dot2c_f32_bf16 v203, v189, v89
v_dot2c_f32_bf16 v204, v190, v88
v_dot2c_f32_bf16 v205, v190, v89
v_dot2c_f32_bf16 v206, v191, v88
v_dot2c_f32_bf16 v207, v191, v89
v_dot2c_f32_bf16 v208, v124, v89
v_dot2c_f32_bf16 v209, v126, v89
v_lshrrev_b32 v9, 5, v5
v_mul_u32_u24 v9, 303104, v9
buffer_load_dwordx4 v15, s[24:27], s64 offen offset:2048 sc1 lds
v_and_b32 v11, 1, v3
v_lshl_add_u32 v9, v11, 10, v9
v_lshl_add_u32 v9, v2, 4, v9
v_lshrrev_b32 v11, 3, v2
s_bitcmp0_b32 s4, 0
s_cselect_b32 s52, 100663168, 0
v_mul_lo_u32 v6, v11, s52
v_add_u32 v6, v6, v9
s_bitcmp1_b32 s4, 2
s_cselect_b32 s52, 100663168, 0
v_mul_lo_u32 v11, v11, s52
v_add_u32 v11, v11, v9
v_mul_f32 v192, v10, v192
v_mul_f32 v193, v10, v193
v_mul_f32 v194, v10, v194
v_mul_f32 v195, v10, v195
v_mul_f32 v196, v10, v196
v_mul_f32 v197, v10, v197
buffer_load_dwordx4 v15, s[24:27], s64 offen offset:3072 sc1 lds
v_mul_f32 v198, v10, v198
v_mul_f32 v199, v10, v199
v_mul_f32 v200, v10, v200
v_mul_f32 v201, v10, v201
v_mul_f32 v202, v10, v202
v_mul_f32 v203, v10, v203
v_mul_f32 v204, v10, v204
v_mul_f32 v205, v10, v205
v_mul_f32 v206, v10, v206
v_mul_f32 v207, v10, v207
v_mul_f32 v208, v10, v208
v_mul_f32 v209, v10, v209
v_cvt_pk_bf16_f32 v192, v192, v193
v_cvt_pk_bf16_f32 v193, v194, v195
v_cvt_pk_bf16_f32 v194, v196, v197
v_cvt_pk_bf16_f32 v195, v198, v199
v_cvt_pk_bf16_f32 v196, v200, v201
v_cvt_pk_bf16_f32 v197, v202, v203
v_cvt_pk_bf16_f32 v198, v204, v205
v_cvt_pk_bf16_f32 v199, v206, v207
v_cvt_pk_bf16_f32 v200, v208, v209
s_add_u32 s53, s53, 65536
s_bfe_u32 s54, s4, 131073
s_lshl_b32 s54, s54, 11
s_add_u32 s54, s54, s53
s_and_b32 s55, s4, 1
s_lshl_b32 s55, s55, 9
s_add_u32 s54, s54, s55
s_lshl2_add_u32 s52, s85, s86
s_lshl2_add_u32 s69, s52, s3
s_mul_i32 s69, s69, 28672
s_add_u32 s69, s69, 76546048
s_lshr_b32 s73, s52, 1
s_lshl_b32 s73, s73, 10
s_and_b32 s52, s52, 1
s_lshl_b32 s52, s52, 7
s_add_u32 s73, s73, s52
s_lshl2_add_u32 s73, s3, s73
s_add_u32 s73, s73, 75498112
ds_read_b128 v[144:147], v7 offset:0
ds_read_b128 v[148:151], v7 offset:1024
ds_read_b128 v[152:155], v7 offset:2048
ds_read_b128 v[156:159], v7 offset:3072
ds_read_b128 v[160:163], v7 offset:4096
ds_read_b128 v[164:167], v7 offset:5120
ds_read_b128 v[168:171], v7 offset:6144
ds_read_b128 v[172:175], v7 offset:7168
v_mov_b32 v10, 0
s_waitcnt vmcnt(5)
v_cmp_gt_u32 vcc, 8, v12
s_mov_b32 s92, 0
s_nop 3
s_cbranch_vccz L_ZBX
L_ZB:
s_sleep 2
buffer_load_dword v12, v13, s[24:27], s75 offen sc1
s_add_u32 s92, s92, 1
s_waitcnt vmcnt(0)
v_cmp_gt_u32 vcc, 8, v12
s_cmp_gt_u32 s92, 1048576
s_cbranch_scc1 L_ZBX
s_nop 2
s_cbranch_vccnz L_ZB
L_ZBX:
s_xor_b32 s65, s82, 0
s_add_u32 s65, s65, s77
buffer_load_dwordx4 a[0:3], v15, s[24:27], s65 offen offset:0 sc1
buffer_load_dwordx4 a[8:11], v15, s[24:27], s65 offen offset:2048 sc1
s_xor_b32 s93, s82, 0
s_add_u32 s93, s93, s81
buffer_load_dwordx4 a[4:7], v15, s[24:27], s93 offen offset:0 sc1
buffer_load_dwordx4 a[12:15], v15, s[24:27], s93 offen offset:2048 sc1
buffer_load_dwordx4 a[16:19], v14, s[24:27], s65 offen offset:0 sc1
buffer_load_dwordx4 a[24:27], v14, s[24:27], s65 offen offset:2048 sc1
buffer_load_dwordx4 a[20:23], v14, s[24:27], s93 offen offset:0 sc1
buffer_load_dwordx4 a[28:31], v14, s[24:27], s93 offen offset:2048 sc1
buffer_store_dwordx4 v[192:195], v9, s[24:27], s54 offen sc1
buffer_store_dwordx4 v[196:199], v6, s[24:27], s54 offen offset:256 sc1
s_bfe_u32 s55, s4, 65538
s_lshl_b32 s55, s55, 8
s_add_u32 s54, s53, s55
s_and_b32 s55, s4, 3
s_lshl2_add_u32 s54, s55, s54
s_add_u32 s54, s54, 8192
buffer_store_dword v200, v11, s[24:27], s54 offen sc1
s_waitcnt vmcnt(9) lgkmcnt(6)
v_mfma_f32_16x16x32_bf16 v[120:123], v[144:147], a[0:3], 0
s_waitcnt vmcnt(7)
s_add_u32 s91, s91, 16384
ds_read_b128 v[176:179], v7 offset:8192
v_mfma_f32_16x16x32_bf16 v[120:123], v[148:151], a[8:11], v[120:123]
s_xor_b32 s65, s82, 8192
s_add_u32 s65, s65, s77
ds_read_b128 v[180:183], v7 offset:9216
v_mfma_f32_16x16x32_bf16 v[124:127], v[148:151], a[12:15], 0
s_waitcnt lgkmcnt(6)
ds_read_b128 v[184:187], v7 offset:10240
v_mfma_f32_16x16x32_bf16 v[124:127], v[144:147], a[4:7], v[124:127]
buffer_load_dwordx4 a[32:35], v15, s[24:27], s65 offen offset:0 sc1
v_mfma_f32_16x16x32_bf16 v[72:75], v[152:155], a[0:3], 0
s_cmp_ge_u32 s91, 163840
s_cselect_b32 s91, 0, s91
ds_read_b128 v[188:191], v7 offset:11264
v_mfma_f32_16x16x32_bf16 v[72:75], v[156:159], a[8:11], v[72:75]
s_waitcnt lgkmcnt(6)
v_add_u32 v8, s91, v4
v_mfma_f32_16x16x32_bf16 v[76:79], v[156:159], a[12:15], 0
buffer_load_dwordx4 a[40:43], v15, s[24:27], s65 offen offset:2048 sc1
v_mfma_f32_16x16x32_bf16 v[76:79], v[152:155], a[4:7], v[76:79]
s_xor_b32 s93, s82, 8192
s_add_u32 s93, s93, s81
ds_read_b128 v[144:147], v7 offset:12288
v_mfma_f32_16x16x32_bf16 v[80:83], v[160:163], a[0:3], 0
ds_read_b128 v[148:151], v7 offset:13312
v_mfma_f32_16x16x32_bf16 v[80:83], v[164:167], a[8:11], v[80:83]
buffer_load_dwordx4 a[36:39], v15, s[24:27], s93 offen offset:0 sc1
v_mfma_f32_16x16x32_bf16 v[84:87], v[164:167], a[12:15], 0
ds_read_b128 v[152:155], v7 offset:14336
v_mfma_f32_16x16x32_bf16 v[84:87], v[160:163], a[4:7], v[84:87]
s_waitcnt lgkmcnt(7)
v_mfma_f32_16x16x32_bf16 v[88:91], v[168:171], a[0:3], 0
buffer_load_dwordx4 a[44:47], v15, s[24:27], s93 offen offset:2048 sc1
v_mfma_f32_16x16x32_bf16 v[88:91], v[172:175], a[8:11], v[88:91]
ds_read_b128 v[156:159], v7 offset:15360
v_mfma_f32_16x16x32_bf16 v[92:95], v[172:175], a[12:15], 0
s_waitcnt lgkmcnt(6)
s_add_u32 s91, s91, 16384
ds_read_b128 v[160:163], v8 offset:0
v_mfma_f32_16x16x32_bf16 v[92:95], v[168:171], a[4:7], v[92:95]
buffer_load_dwordx4 a[48:51], v14, s[24:27], s65 offen offset:0 sc1
v_mfma_f32_16x16x32_bf16 v[96:99], v[176:179], a[0:3], 0
s_cmp_ge_u32 s91, 163840
s_cselect_b32 s91, 0, s91
ds_read_b128 v[164:167], v8 offset:1024
v_mfma_f32_16x16x32_bf16 v[96:99], v[180:183], a[8:11], v[96:99]
v_add_u32 v7, s91, v4
v_mfma_f32_16x16x32_bf16 v[100:103], v[180:183], a[12:15], 0
buffer_load_dwordx4 a[56:59], v14, s[24:27], s65 offen offset:2048 sc1
v_mfma_f32_16x16x32_bf16 v[100:103], v[176:179], a[4:7], v[100:103]
s_waitcnt lgkmcnt(6)
ds_read_b128 v[168:171], v8 offset:2048
v_mfma_f32_16x16x32_bf16 v[104:107], v[184:187], a[0:3], 0
ds_read_b128 v[172:175], v8 offset:3072
v_mfma_f32_16x16x32_bf16 v[104:107], v[188:191], a[8:11], v[104:107]
v_mfma_f32_16x16x32_bf16 v[108:111], v[188:191], a[12:15], 0
buffer_load_dwordx4 a[52:55], v14, s[24:27], s93 offen offset:0 sc1
v_mfma_f32_16x16x32_bf16 v[108:111], v[184:187], a[4:7], v[108:111]
s_waitcnt lgkmcnt(6)
ds_read_b128 v[176:179], v8 offset:4096
v_mfma_f32_16x16x32_bf16 v[112:115], v[144:147], a[0:3], 0
ds_read_b128 v[180:183], v8 offset:5120
v_mfma_f32_16x16x32_bf16 v[112:115], v[148:151], a[8:11], v[112:115]
v_mfma_f32_16x16x32_bf16 v[116:119], v[148:151], a[12:15], 0
buffer_load_dwordx4 a[60:63], v14, s[24:27], s93 offen offset:2048 sc1
v_mfma_f32_16x16x32_bf16 v[116:119], v[144:147], a[4:7], v[116:119]
s_waitcnt lgkmcnt(6) vmcnt(13)
ds_read_b128 v[184:187], v8 offset:6144
v_mfma_f32_16x16x32_bf16 v[120:123], v[152:155], a[16:19], v[120:123]
ds_read_b128 v[188:191], v8 offset:7168
v_mfma_f32_16x16x32_bf16 v[120:123], v[156:159], a[24:27], v[120:123]
s_waitcnt vmcnt(11)
v_mfma_f32_16x16x32_bf16 v[124:127], v[156:159], a[28:31], v[124:127]
ds_read_b128 v[144:147], v8 offset:8192
v_mfma_f32_16x16x32_bf16 v[124:127], v[152:155], a[20:23], v[124:127]
s_waitcnt lgkmcnt(7)
v_mfma_f32_16x16x32_bf16 v[72:75], v[160:163], a[16:19], v[72:75]
ds_read_b128 v[148:151], v8 offset:9216
v_mfma_f32_16x16x32_bf16 v[72:75], v[164:167], a[24:27], v[72:75]
v_mfma_f32_16x16x32_bf16 v[76:79], v[164:167], a[28:31], v[76:79]
ds_read_b128 v[152:155], v8 offset:10240
v_mfma_f32_16x16x32_bf16 v[76:79], v[160:163], a[20:23], v[76:79]
s_waitcnt lgkmcnt(7)
v_mfma_f32_16x16x32_bf16 v[80:83], v[168:171], a[16:19], v[80:83]
ds_read_b128 v[156:159], v8 offset:11264
v_mfma_f32_16x16x32_bf16 v[80:83], v[172:175], a[24:27], v[80:83]
v_mfma_f32_16x16x32_bf16 v[84:87], v[172:175], a[28:31], v[84:87]
ds_read_b128 v[160:163], v8 offset:12288
v_mfma_f32_16x16x32_bf16 v[84:87], v[168:171], a[20:23], v[84:87]
s_waitcnt lgkmcnt(7)
v_mfma_f32_16x16x32_bf16 v[88:91], v[176:179], a[16:19], v[88:91]
s_xor_b32 s65, s82, 16384
s_add_u32 s65, s65, s77
ds_read_b128 v[164:167], v8 offset:13312
v_mfma_f32_16x16x32_bf16 v[88:91], v[180:183], a[24:27], v[88:91]
v_mfma_f32_16x16x32_bf16 v[92:95], v[180:183], a[28:31], v[92:95]
s_waitcnt lgkmcnt(6)
ds_read_b128 v[168:171], v8 offset:14336
v_add_u32 v11, s70, v4
v_mfma_f32_16x16x32_bf16 v[92:95], v[176:179], a[20:23], v[92:95]
s_add_u32 s70, s70, 16384
s_cmp_ge_u32 s70, 163840
s_cselect_b32 s70, s80, s70
v_mfma_f32_16x16x32_bf16 v[96:99], v[184:187], a[16:19], v[96:99]
buffer_load_dwordx4 a[64:67], v15, s[24:27], s65 offen offset:0 sc1
v_mfma_f32_16x16x32_bf16 v[96:99], v[188:191], a[24:27], v[96:99]
s_barrier
v_mfma_f32_16x16x32_bf16 v[100:103], v[188:191], a[28:31], v[100:103]
s_waitcnt lgkmcnt(5)
ds_read_b128 v[172:175], v8 offset:15360
v_mfma_f32_16x16x32_bf16 v[100:103], v[184:187], a[20:23], v[100:103]
buffer_load_dwordx4 a[72:75], v15, s[24:27], s65 offen offset:2048 sc1
v_mfma_f32_16x16x32_bf16 v[104:107], v[144:147], a[16:19], v[104:107]
ds_write_b64 v11, a[96:97] offset:0
v_mfma_f32_16x16x32_bf16 v[104:107], v[148:151], a[24:27], v[104:107]
s_xor_b32 s93, s82, 16384
s_add_u32 s93, s93, s81
ds_read_b128 v[176:179], v7 offset:0
v_mfma_f32_16x16x32_bf16 v[108:111], v[148:151], a[28:31], v[108:111]
buffer_load_dwordx4 a[68:71], v15, s[24:27], s93 offen offset:0 sc1
v_mfma_f32_16x16x32_bf16 v[108:111], v[144:147], a[20:23], v[108:111]
s_waitcnt lgkmcnt(6)
s_add_u32 s91, s91, 16384
ds_read_b128 v[180:183], v7 offset:1024
v_mfma_f32_16x16x32_bf16 v[112:115], v[152:155], a[16:19], v[112:115]
ds_write_b64 v11, a[98:99] offset:8
v_mfma_f32_16x16x32_bf16 v[112:115], v[156:159], a[24:27], v[112:115]
s_cmp_ge_u32 s91, 163840
s_cselect_b32 s91, 0, s91
ds_read_b128 v[184:187], v7 offset:2048
v_mfma_f32_16x16x32_bf16 v[116:119], v[156:159], a[28:31], v[116:119]
buffer_load_dwordx4 a[76:79], v15, s[24:27], s93 offen offset:2048 sc1
v_mfma_f32_16x16x32_bf16 v[116:119], v[152:155], a[20:23], v[116:119]
s_waitcnt lgkmcnt(7) vmcnt(10)
ds_read_b128 v[188:191], v7 offset:3072
v_add_u32 v8, s91, v4
v_mfma_f32_16x16x32_bf16 v[120:123], v[160:163], a[32:35], v[120:123]
s_waitcnt vmcnt(12)
s_waitcnt vmcnt(8)
ds_read_b128 v[144:147], v7 offset:4096
v_mfma_f32_16x16x32_bf16 v[120:123], v[164:167], a[40:43], v[120:123]
buffer_atomic_add v1, v0, s[24:27], s74 offen offset:4 sc1
v_mfma_f32_16x16x32_bf16 v[124:127], v[164:167], a[44:47], v[124:127]
ds_write_b64 v11, a[100:101] offset:1024
v_mfma_f32_16x16x32_bf16 v[124:127], v[160:163], a[36:39], v[124:127]
s_waitcnt lgkmcnt(8)
ds_read_b128 v[148:151], v7 offset:5120
v_mfma_f32_16x16x32_bf16 v[72:75], v[168:171], a[32:35], v[72:75]
ds_read_b128 v[152:155], v7 offset:6144
v_mfma_f32_16x16x32_bf16 v[72:75], v[172:175], a[40:43], v[72:75]
s_waitcnt lgkmcnt(7)
ds_read_b128 v[156:159], v7 offset:7168
v_mfma_f32_16x16x32_bf16 v[76:79], v[172:175], a[44:47], v[76:79]
ds_write_b64 v11, a[102:103] offset:1032
v_mfma_f32_16x16x32_bf16 v[76:79], v[168:171], a[36:39], v[76:79]
buffer_load_dwordx4 a[80:83], v14, s[24:27], s65 offen offset:0 sc1
v_mfma_f32_16x16x32_bf16 v[80:83], v[176:179], a[32:35], v[80:83]
ds_read_b128 v[160:163], v7 offset:8192
v_mfma_f32_16x16x32_bf16 v[80:83], v[180:183], a[40:43], v[80:83]
s_waitcnt lgkmcnt(7)
ds_read_b128 v[164:167], v7 offset:9216
v_mfma_f32_16x16x32_bf16 v[84:87], v[180:183], a[44:47], v[84:87]
ds_write_b64 v11, a[104:105] offset:2048
v_mfma_f32_16x16x32_bf16 v[84:87], v[176:179], a[36:39], v[84:87]
buffer_load_dwordx4 a[88:91], v14, s[24:27], s65 offen offset:2048 sc1
v_mfma_f32_16x16x32_bf16 v[88:91], v[184:187], a[32:35], v[88:91]
ds_read_b128 v[168:171], v7 offset:10240
v_mfma_f32_16x16x32_bf16 v[88:91], v[188:191], a[40:43], v[88:91]
s_waitcnt lgkmcnt(7)
ds_read_b128 v[172:175], v7 offset:11264
v_mfma_f32_16x16x32_bf16 v[92:95], v[188:191], a[44:47], v[92:95]
ds_write_b64 v11, a[106:107] offset:2056
v_mfma_f32_16x16x32_bf16 v[92:95], v[184:187], a[36:39], v[92:95]
buffer_load_dwordx4 a[84:87], v14, s[24:27], s93 offen offset:0 sc1
v_mfma_f32_16x16x32_bf16 v[96:99], v[144:147], a[32:35], v[96:99]
ds_read_b128 v[176:179], v7 offset:12288
v_mfma_f32_16x16x32_bf16 v[96:99], v[148:151], a[40:43], v[96:99]
s_waitcnt lgkmcnt(8)
ds_read_b128 v[180:183], v7 offset:13312
v_mfma_f32_16x16x32_bf16 v[100:103], v[148:151], a[44:47], v[100:103]
ds_write_b64 v11, a[108:109] offset:3072
v_mfma_f32_16x16x32_bf16 v[100:103], v[144:147], a[36:39], v[100:103]
buffer_load_dwordx4 a[92:95], v14, s[24:27], s93 offen offset:2048 sc1
v_mfma_f32_16x16x32_bf16 v[104:107], v[152:155], a[32:35], v[104:107]
ds_read_b128 v[184:187], v7 offset:14336
v_mfma_f32_16x16x32_bf16 v[104:107], v[156:159], a[40:43], v[104:107]
ds_read_b128 v[188:191], v7 offset:15360
v_mfma_f32_16x16x32_bf16 v[108:111], v[156:159], a[44:47], v[108:111]
ds_write_b64 v11, a[110:111] offset:3080
v_mfma_f32_16x16x32_bf16 v[108:111], v[152:155], a[36:39], v[108:111]
s_waitcnt lgkmcnt(10)
s_add_u32 s91, s91, 16384
ds_read_b128 v[144:147], v8 offset:0
v_mfma_f32_16x16x32_bf16 v[112:115], v[160:163], a[32:35], v[112:115]
s_xor_b32 s65, s82, 24576
s_add_u32 s65, s65, s77
ds_read_b128 v[148:151], v8 offset:1024
v_mfma_f32_16x16x32_bf16 v[112:115], v[164:167], a[40:43], v[112:115]
s_cmp_ge_u32 s91, 163840
s_cselect_b32 s91, 0, s91
v_add_u32 v7, s91, v4
v_mfma_f32_16x16x32_bf16 v[116:119], v[164:167], a[44:47], v[116:119]
buffer_load_dwordx4 a[192:195], v15, s[24:27], s65 offen offset:0 sc1
v_mfma_f32_16x16x32_bf16 v[116:119], v[160:163], a[36:39], v[116:119]
s_waitcnt lgkmcnt(9) vmcnt(12)
ds_read_b128 v[152:155], v8 offset:2048
v_mfma_f32_16x16x32_bf16 v[120:123], v[168:171], a[48:51], v[120:123]
ds_read_b128 v[156:159], v8 offset:3072
v_mfma_f32_16x16x32_bf16 v[120:123], v[172:175], a[56:59], v[120:123]
s_waitcnt vmcnt(10)
v_mfma_f32_16x16x32_bf16 v[124:127], v[172:175], a[60:63], v[124:127]
buffer_load_dwordx4 a[200:203], v15, s[24:27], s65 offen offset:2048 sc1
v_mfma_f32_16x16x32_bf16 v[124:127], v[168:171], a[52:55], v[124:127]
s_waitcnt lgkmcnt(8)
ds_read_b128 v[160:163], v8 offset:4096
v_mfma_f32_16x16x32_bf16 v[72:75], v[176:179], a[48:51], v[72:75]
s_xor_b32 s93, s82, 24576
s_add_u32 s93, s93, s81
ds_read_b128 v[164:167], v8 offset:5120
v_mfma_f32_16x16x32_bf16 v[72:75], v[180:183], a[56:59], v[72:75]
v_mfma_f32_16x16x32_bf16 v[76:79], v[180:183], a[60:63], v[76:79]
buffer_load_dwordx4 a[196:199], v15, s[24:27], s93 offen offset:0 sc1
v_mfma_f32_16x16x32_bf16 v[76:79], v[176:179], a[52:55], v[76:79]
s_waitcnt lgkmcnt(7)
ds_read_b128 v[168:171], v8 offset:6144
v_mfma_f32_16x16x32_bf16 v[80:83], v[184:187], a[48:51], v[80:83]
ds_read_b128 v[172:175], v8 offset:7168
v_mfma_f32_16x16x32_bf16 v[80:83], v[188:191], a[56:59], v[80:83]
v_mfma_f32_16x16x32_bf16 v[84:87], v[188:191], a[60:63], v[84:87]
buffer_load_dwordx4 a[204:207], v15, s[24:27], s93 offen offset:2048 sc1
v_mfma_f32_16x16x32_bf16 v[84:87], v[184:187], a[52:55], v[84:87]
s_waitcnt lgkmcnt(6)
ds_read_b128 v[176:179], v8 offset:8192
v_mfma_f32_16x16x32_bf16 v[88:91], v[144:147], a[48:51], v[88:91]
ds_read_b128 v[180:183], v8 offset:9216
v_mfma_f32_16x16x32_bf16 v[88:91], v[148:151], a[56:59], v[88:91]
v_mfma_f32_16x16x32_bf16 v[92:95], v[148:151], a[60:63], v[92:95]
ds_read_b128 v[184:187], v8 offset:10240
v_mfma_f32_16x16x32_bf16 v[92:95], v[144:147], a[52:55], v[92:95]
s_waitcnt lgkmcnt(7)
v_mfma_f32_16x16x32_bf16 v[96:99], v[152:155], a[48:51], v[96:99]
s_add_u32 s52, s84, 1
ds_read_b128 v[188:191], v8 offset:11264
v_mfma_f32_16x16x32_bf16 v[96:99], v[156:159], a[56:59], v[96:99]
v_mfma_f32_16x16x32_bf16 v[100:103], v[156:159], a[60:63], v[100:103]
buffer_load_dwordx4 a[208:211], v14, s[24:27], s65 offen offset:0 sc1
v_mfma_f32_16x16x32_bf16 v[100:103], v[152:155], a[52:55], v[100:103]
s_and_b32 s52, s52, 3
s_waitcnt lgkmcnt(6)
ds_read_b128 v[144:147], v8 offset:12288
v_mfma_f32_16x16x32_bf16 v[104:107], v[160:163], a[48:51], v[104:107]
ds_read_b128 v[148:151], v8 offset:13312
v_mfma_f32_16x16x32_bf16 v[104:107], v[164:167], a[56:59], v[104:107]
s_waitcnt lgkmcnt(6)
v_mfma_f32_16x16x32_bf16 v[108:111], v[164:167], a[60:63], v[108:111]
s_mul_i32 s52, s52, 6144
ds_read_b128 v[152:155], v8 offset:14336
v_add_u32 v11, s70, v4
v_mfma_f32_16x16x32_bf16 v[108:111], v[160:163], a[52:55], v[108:111]
s_add_u32 s70, s70, 16384
s_cmp_ge_u32 s70, 163840
s_cselect_b32 s70, s80, s70
v_mfma_f32_16x16x32_bf16 v[112:115], v[168:171], a[48:51], v[112:115]
s_waitcnt vmcnt(50)
ds_read_b128 v[156:159], v8 offset:15360
v_mfma_f32_16x16x32_bf16 v[112:115], v[172:175], a[56:59], v[112:115]
s_barrier
v_mfma_f32_16x16x32_bf16 v[116:119], v[172:175], a[60:63], v[116:119]
s_add_u32 s52, s52, s69
s_waitcnt lgkmcnt(6) vmcnt(12)
ds_read_b128 v[160:163], v7 offset:0
v_mfma_f32_16x16x32_bf16 v[116:119], v[168:171], a[52:55], v[116:119]
buffer_load_dwordx4 a[216:219], v14, s[24:27], s65 offen offset:2048 sc1
v_mfma_f32_16x16x32_bf16 v[120:123], v[176:179], a[64:67], v[120:123]
ds_write_b64 v11, a[112:113] offset:0
v_mfma_f32_16x16x32_bf16 v[120:123], v[180:183], a[72:75], v[120:123]
s_add_u32 s52, s52, 0
s_waitcnt vmcnt(11)
ds_read_b128 v[164:167], v7 offset:1024
v_mfma_f32_16x16x32_bf16 v[124:127], v[180:183], a[76:79], v[124:127]
buffer_load_dwordx4 a[212:215], v14, s[24:27], s93 offen offset:0 sc1
v_mfma_f32_16x16x32_bf16 v[124:127], v[176:179], a[68:71], v[124:127]
s_waitcnt lgkmcnt(7)
s_add_u32 s91, s91, 16384
ds_read_b128 v[168:171], v7 offset:2048
v_mfma_f32_16x16x32_bf16 v[72:75], v[184:187], a[64:67], v[72:75]
s_add_u32 s53, s84, 2
ds_read_b128 v[172:175], v7 offset:3072
v_mfma_f32_16x16x32_bf16 v[72:75], v[188:191], a[72:75], v[72:75]
ds_write_b64 v11, a[114:115] offset:8
v_mfma_f32_16x16x32_bf16 v[76:79], v[188:191], a[76:79], v[76:79]
buffer_load_dwordx4 a[220:223], v14, s[24:27], s93 offen offset:2048 sc1
v_mfma_f32_16x16x32_bf16 v[76:79], v[184:187], a[68:71], v[76:79]
s_and_b32 s53, s53, 3
s_waitcnt lgkmcnt(8)
ds_read_b128 v[176:179], v7 offset:4096
v_mfma_f32_16x16x32_bf16 v[80:83], v[144:147], a[64:67], v[80:83]
s_xor_b32 s65, s82, 32768
s_add_u32 s65, s65, s77
ds_read_b128 v[180:183], v7 offset:5120
v_mfma_f32_16x16x32_bf16 v[80:83], v[148:151], a[72:75], v[80:83]
L_PAD11:
s_cbranch_execz L_MAIN
ds_write_b64 v11, a[116:117] offset:1024
v_mfma_f32_16x16x32_bf16 v[84:87], v[148:151], a[76:79], v[84:87]
s_mul_i32 s53, s53, 6144
s_waitcnt lgkmcnt(9)
ds_read_b128 v[184:187], v7 offset:6144
v_mfma_f32_16x16x32_bf16 v[84:87], v[144:147], a[68:71], v[84:87]
buffer_load_dwordx4 a[224:227], v15, s[24:27], s65 offen offset:0 sc1
v_mfma_f32_16x16x32_bf16 v[88:91], v[152:155], a[64:67], v[88:91]
s_cmp_ge_u32 s91, 163840
s_cselect_b32 s91, 0, s91
ds_read_b128 v[188:191], v7 offset:7168
v_mfma_f32_16x16x32_bf16 v[88:91], v[156:159], a[72:75], v[88:91]
s_add_u32 s53, s53, s69
s_waitcnt lgkmcnt(8)
v_add_u32 v8, s91, v4
v_mfma_f32_16x16x32_bf16 v[92:95], v[156:159], a[76:79], v[92:95]
ds_write_b64 v11, a[118:119] offset:1032
v_mfma_f32_16x16x32_bf16 v[92:95], v[152:155], a[68:71], v[92:95]
buffer_load_dwordx4 a[232:235], v15, s[24:27], s65 offen offset:2048 sc1
v_mfma_f32_16x16x32_bf16 v[96:99], v[160:163], a[64:67], v[96:99]
s_add_u32 s53, s53, 2048
s_xor_b32 s93, s82, 32768
s_add_u32 s93, s93, s81
v_mfma_f32_16x16x32_bf16 v[96:99], v[164:167], a[72:75], v[96:99]
ds_read_b128 v[144:147], v7 offset:8192
v_mfma_f32_16x16x32_bf16 v[100:103], v[164:167], a[76:79], v[100:103]
ds_write_b64 v11, a[120:121] offset:2048
v_mfma_f32_16x16x32_bf16 v[100:103], v[160:163], a[68:71], v[100:103]
s_add_u32 s54, s84, 3
s_waitcnt lgkmcnt(9) vmcnt(12)
ds_read_b128 v[148:151], v7 offset:9216
v_mfma_f32_16x16x32_bf16 v[120:123], v[168:171], a[80:83], v[120:123]
buffer_load_dwordx4 a[228:231], v15, s[24:27], s93 offen offset:0 sc1
v_mfma_f32_16x16x32_bf16 v[120:123], v[172:175], a[88:91], v[120:123]
s_waitcnt vmcnt(11)
ds_read_b128 v[152:155], v7 offset:10240
v_mfma_f32_16x16x32_bf16 v[124:127], v[172:175], a[92:95], v[124:127]
s_and_b32 s54, s54, 3
s_waitcnt lgkmcnt(8)
ds_read_b128 v[156:159], v7 offset:11264
v_mfma_f32_16x16x32_bf16 v[124:127], v[168:171], a[84:87], v[124:127]
ds_write_b64 v11, a[122:123] offset:2056
v_mfma_f32_16x16x32_bf16 v[72:75], v[176:179], a[80:83], v[72:75]
buffer_load_dwordx4 a[236:239], v15, s[24:27], s93 offen offset:2048 sc1
v_mfma_f32_16x16x32_bf16 v[72:75], v[180:183], a[88:91], v[72:75]
s_mul_i32 s54, s54, 6144
ds_read_b128 v[160:163], v7 offset:12288
v_mfma_f32_16x16x32_bf16 v[76:79], v[180:183], a[92:95], v[76:79]
s_waitcnt lgkmcnt(8)
ds_read_b128 v[164:167], v7 offset:13312
v_mfma_f32_16x16x32_bf16 v[76:79], v[176:179], a[84:87], v[76:79]
ds_write_b64 v11, a[124:125] offset:3072
v_mfma_f32_16x16x32_bf16 v[80:83], v[184:187], a[80:83], v[80:83]
s_add_u32 s54, s54, s69
ds_read_b128 v[168:171], v7 offset:14336
v_mfma_f32_16x16x32_bf16 v[80:83], v[188:191], a[88:91], v[80:83]
ds_read_b128 v[172:175], v7 offset:15360
v_mfma_f32_16x16x32_bf16 v[84:87], v[188:191], a[92:95], v[84:87]
buffer_load_dwordx4 a[240:243], v14, s[24:27], s65 offen offset:0 sc1
v_mfma_f32_16x16x32_bf16 v[84:87], v[184:187], a[84:87], v[84:87]
s_add_u32 s54, s54, 4096
s_waitcnt lgkmcnt(8)
ds_read_b128 v[176:179], v8 offset:0
v_mfma_f32_16x16x32_bf16 v[88:91], v[144:147], a[80:83], v[88:91]
ds_write_b64 v11, a[126:127] offset:3080
v_mfma_f32_16x16x32_bf16 v[88:91], v[148:151], a[88:91], v[88:91]
s_add_u32 s91, s91, 16384
ds_read_b128 v[180:183], v8 offset:1024
v_add_u32 v11, s70, v4
v_mfma_f32_16x16x32_bf16 v[92:95], v[148:151], a[92:95], v[92:95]
s_sub_u32 s55, s3, s84
s_add_u32 s70, s70, 16384
ds_read_b128 v[184:187], v8 offset:2048
v_mfma_f32_16x16x32_bf16 v[92:95], v[144:147], a[84:87], v[92:95]
s_cmp_ge_u32 s70, 163840
s_cselect_b32 s70, s80, s70
s_waitcnt lgkmcnt(10)
v_mfma_f32_16x16x32_bf16 v[96:99], v[152:155], a[80:83], v[96:99]
buffer_load_dwordx4 a[248:251], v14, s[24:27], s65 offen offset:2048 sc1
v_mfma_f32_16x16x32_bf16 v[96:99], v[156:159], a[88:91], v[96:99]
s_and_b32 s55, s55, 3
s_waitcnt lgkmcnt(7) vmcnt(12)
ds_read_b128 v[188:191], v8 offset:3072
v_mfma_f32_16x16x32_bf16 v[100:103], v[156:159], a[92:95], v[100:103]
ds_write_b64 v11, a[160:161] offset:0
v_mfma_f32_16x16x32_bf16 v[100:103], v[152:155], a[84:87], v[100:103]
buffer_load_dwordx4 a[244:247], v14, s[24:27], s93 offen offset:0 sc1
v_mfma_f32_16x16x32_bf16 v[120:123], v[160:163], a[192:195], v[120:123]
s_lshl_b32 s55, s55, 10
ds_read_b128 v[144:147], v8 offset:4096
v_mfma_f32_16x16x32_bf16 v[120:123], v[164:167], a[200:203], v[120:123]
s_waitcnt vmcnt(11)
ds_read_b128 v[148:151], v8 offset:5120
v_mfma_f32_16x16x32_bf16 v[124:127], v[164:167], a[204:207], v[124:127]
ds_write_b64 v11, a[162:163] offset:8
v_mfma_f32_16x16x32_bf16 v[124:127], v[160:163], a[196:199], v[124:127]
s_add_u32 s55, s55, s69
s_waitcnt lgkmcnt(9)
ds_read_b128 v[152:155], v8 offset:6144
v_mfma_f32_16x16x32_bf16 v[72:75], v[168:171], a[192:195], v[72:75]
buffer_load_dwordx4 a[252:255], v14, s[24:27], s93 offen offset:2048 sc1
v_mfma_f32_16x16x32_bf16 v[72:75], v[172:175], a[200:203], v[72:75]
s_cmp_ge_u32 s91, 163840
s_cselect_b32 s91, 0, s91
ds_read_b128 v[156:159], v8 offset:7168
v_mfma_f32_16x16x32_bf16 v[76:79], v[172:175], a[204:207], v[76:79]
s_add_u32 s55, s55, 23552
s_waitcnt lgkmcnt(8)
ds_read_b128 v[160:163], v8 offset:8192
v_mfma_f32_16x16x32_bf16 v[76:79], v[168:171], a[196:199], v[76:79]
ds_write_b64 v11, a[164:165] offset:1024
v_mfma_f32_16x16x32_bf16 v[80:83], v[176:179], a[192:195], v[80:83]
s_xor_b32 s65, s82, 40960
s_add_u32 s65, s65, s77
ds_read_b128 v[164:167], v8 offset:9216
v_mfma_f32_16x16x32_bf16 v[80:83], v[180:183], a[200:203], v[80:83]
s_add_u32 s71, s69, 24576
s_waitcnt lgkmcnt(9)
v_add_u32 v7, s91, v4
v_mfma_f32_16x16x32_bf16 v[84:87], v[180:183], a[204:207], v[84:87]
buffer_load_dwordx4 a[96:99], v15, s[24:27], s65 offen offset:0 sc1
v_mfma_f32_16x16x32_bf16 v[84:87], v[176:179], a[196:199], v[84:87]
ds_write_b64 v11, a[166:167] offset:1032
v_mfma_f32_16x16x32_bf16 v[88:91], v[184:187], a[192:195], v[88:91]
s_cmp_eq_u32 s3, s84
s_cselect_b32 s55, 2147418112, s55
s_cselect_b32 s71, s71, 2147418112
v_mfma_f32_16x16x32_bf16 v[88:91], v[188:191], a[200:203], v[88:91]
ds_read_b128 v[168:171], v8 offset:10240
v_mfma_f32_16x16x32_bf16 v[92:95], v[188:191], a[204:207], v[92:95]
buffer_load_dwordx4 a[104:107], v15, s[24:27], s65 offen offset:2048 sc1
v_mfma_f32_16x16x32_bf16 v[92:95], v[184:187], a[196:199], v[92:95]
s_mul_i32 s83, s84, 6144
s_waitcnt lgkmcnt(8)
ds_read_b128 v[172:175], v8 offset:11264
v_mfma_f32_16x16x32_bf16 v[96:99], v[144:147], a[192:195], v[96:99]
ds_write_b64 v11, a[168:169] offset:2048
v_mfma_f32_16x16x32_bf16 v[96:99], v[148:151], a[200:203], v[96:99]
s_xor_b32 s93, s82, 40960
s_add_u32 s93, s93, s81
ds_read_b128 v[176:179], v8 offset:12288
v_mfma_f32_16x16x32_bf16 v[100:103], v[148:151], a[204:207], v[100:103]
s_add_u32 s69, s69, s83
s_waitcnt lgkmcnt(8) vmcnt(12)
ds_read_b128 v[180:183], v8 offset:13312
v_mfma_f32_16x16x32_bf16 v[100:103], v[144:147], a[196:199], v[100:103]
buffer_load_dwordx4 a[100:103], v15, s[24:27], s93 offen offset:0 sc1
v_mfma_f32_16x16x32_bf16 v[120:123], v[152:155], a[208:211], v[120:123]
s_waitcnt vmcnt(56)
s_waitcnt vmcnt(11)
ds_read_b128 v[184:187], v8 offset:14336
v_mfma_f32_16x16x32_bf16 v[120:123], v[156:159], a[216:219], v[120:123]
s_barrier
v_mfma_f32_16x16x32_bf16 v[124:127], v[156:159], a[220:223], v[124:127]
s_add_u32 s83, s69, 4096
s_waitcnt lgkmcnt(7)
ds_read_b128 v[188:191], v8 offset:15360
v_mfma_f32_16x16x32_bf16 v[124:127], v[152:155], a[212:215], v[124:127]
ds_write_b64 v11, a[170:171] offset:2056
v_mfma_f32_16x16x32_bf16 v[72:75], v[160:163], a[208:211], v[72:75]
buffer_load_dwordx4 a[108:111], v15, s[24:27], s93 offen offset:2048 sc1
v_mfma_f32_16x16x32_bf16 v[72:75], v[164:167], a[216:219], v[72:75]
s_add_u32 s91, s91, 16384
ds_read_b128 v[144:147], v7 offset:0
v_mfma_f32_16x16x32_bf16 v[76:79], v[164:167], a[220:223], v[76:79]
s_waitcnt lgkmcnt(7)
ds_read_b128 v[148:151], v7 offset:1024
v_mfma_f32_16x16x32_bf16 v[76:79], v[160:163], a[212:215], v[76:79]
ds_write_b64 v11, a[172:173] offset:3072
v_mfma_f32_16x16x32_bf16 v[80:83], v[168:171], a[208:211], v[80:83]
s_cmp_ge_u32 s91, 163840
s_cselect_b32 s91, 0, s91
ds_read_b128 v[152:155], v7 offset:2048
v_mfma_f32_16x16x32_bf16 v[80:83], v[172:175], a[216:219], v[80:83]
s_waitcnt lgkmcnt(7)
ds_read_b128 v[156:159], v7 offset:3072
v_add_u32 v8, s91, v4
v_mfma_f32_16x16x32_bf16 v[84:87], v[172:175], a[220:223], v[84:87]
buffer_load_dwordx4 a[112:115], v14, s[24:27], s65 offen offset:0 sc1
v_mfma_f32_16x16x32_bf16 v[84:87], v[168:171], a[212:215], v[84:87]
ds_write_b64 v11, a[174:175] offset:3080
v_mfma_f32_16x16x32_bf16 v[88:91], v[176:179], a[208:211], v[88:91]
s_add_u32 s68, s68, 49152
ds_read_b128 v[160:163], v7 offset:4096
v_mfma_f32_16x16x32_bf16 v[88:91], v[180:183], a[216:219], v[88:91]
ds_read_b128 v[164:167], v7 offset:5120
v_mfma_f32_16x16x32_bf16 v[92:95], v[180:183], a[220:223], v[92:95]
buffer_load_dwordx4 a[120:123], v14, s[24:27], s65 offen offset:2048 sc1
v_mfma_f32_16x16x32_bf16 v[92:95], v[176:179], a[212:215], v[92:95]
s_waitcnt lgkmcnt(9)
ds_read_b128 v[168:171], v7 offset:6144
v_mfma_f32_16x16x32_bf16 v[96:99], v[184:187], a[208:211], v[96:99]
ds_read_b128 v[172:175], v7 offset:7168
v_mfma_f32_16x16x32_bf16 v[96:99], v[188:191], a[216:219], v[96:99]
v_mfma_f32_16x16x32_bf16 v[100:103], v[188:191], a[220:223], v[100:103]
buffer_load_dwordx4 a[116:119], v14, s[24:27], s93 offen offset:0 sc1
v_mfma_f32_16x16x32_bf16 v[100:103], v[184:187], a[212:215], v[100:103]
s_waitcnt lgkmcnt(8) vmcnt(13)
ds_read_b128 v[176:179], v7 offset:8192
v_mfma_f32_16x16x32_bf16 v[120:123], v[144:147], a[224:227], v[120:123]
ds_read_b128 v[180:183], v7 offset:9216
v_mfma_f32_16x16x32_bf16 v[120:123], v[148:151], a[232:235], v[120:123]
s_waitcnt vmcnt(11)
v_mfma_f32_16x16x32_bf16 v[124:127], v[148:151], a[236:239], v[124:127]
buffer_load_dwordx4 a[124:127], v14, s[24:27], s93 offen offset:2048 sc1
v_mfma_f32_16x16x32_bf16 v[124:127], v[144:147], a[228:231], v[124:127]
s_waitcnt lgkmcnt(7)
ds_read_b128 v[184:187], v7 offset:10240
v_mfma_f32_16x16x32_bf16 v[72:75], v[152:155], a[224:227], v[72:75]
ds_read_b128 v[188:191], v7 offset:11264
v_mfma_f32_16x16x32_bf16 v[72:75], v[156:159], a[232:235], v[72:75]
v_mfma_f32_16x16x32_bf16 v[76:79], v[156:159], a[236:239], v[76:79]
ds_read_b128 v[144:147], v7 offset:12288
v_mfma_f32_16x16x32_bf16 v[76:79], v[152:155], a[228:231], v[76:79]
s_waitcnt lgkmcnt(7)
v_mfma_f32_16x16x32_bf16 v[80:83], v[160:163], a[224:227], v[80:83]
s_xor_b32 s65, s82, 49152
s_add_u32 s65, s65, s77
ds_read_b128 v[148:151], v7 offset:13312
v_mfma_f32_16x16x32_bf16 v[80:83], v[164:167], a[232:235], v[80:83]
v_mov_b32 v13, 0xffff0000
v_mul_u32_u24 v5, 1152, v2
v_mfma_f32_16x16x32_bf16 v[84:87], v[164:167], a[236:239], v[84:87]
buffer_load_dwordx4 a[128:131], v15, s[24:27], s65 offen offset:0 sc1
v_mfma_f32_16x16x32_bf16 v[84:87], v[160:163], a[228:231], v[84:87]
s_waitcnt lgkmcnt(6)
ds_read_b128 v[152:155], v7 offset:14336
v_lshl_add_u32 v6, v3, 3, v5
v_mfma_f32_16x16x32_bf16 v[88:91], v[168:171], a[224:227], v[88:91]
ds_read_b128 v[156:159], v7 offset:15360
v_and_b32 v9, 1, v3
v_mfma_f32_16x16x32_bf16 v[88:91], v[172:175], a[232:235], v[88:91]
s_add_u32 s91, s91, 16384
s_cmp_ge_u32 s91, 163840
s_cselect_b32 s91, 0, s91
v_mfma_f32_16x16x32_bf16 v[92:95], v[172:175], a[236:239], v[92:95]
buffer_load_dwordx4 a[136:139], v15, s[24:27], s65 offen offset:2048 sc1
v_mfma_f32_16x16x32_bf16 v[92:95], v[168:171], a[228:231], v[92:95]
s_waitcnt lgkmcnt(6)
ds_read_b128 v[160:163], v8 offset:0
v_add_u32 v7, s91, v4
v_mfma_f32_16x16x32_bf16 v[96:99], v[176:179], a[224:227], v[96:99]
s_xor_b32 s93, s82, 49152
s_add_u32 s93, s93, s81
ds_read_b128 v[164:167], v8 offset:1024
v_mfma_f32_16x16x32_bf16 v[96:99], v[180:183], a[232:235], v[96:99]
v_lshl_add_u32 v5, v9, 5, v5
v_lshrrev_b32 v9, 1, v3
v_mfma_f32_16x16x32_bf16 v[100:103], v[180:183], a[236:239], v[100:103]
buffer_load_dwordx4 a[132:135], v15, s[24:27], s93 offen offset:0 sc1
v_mfma_f32_16x16x32_bf16 v[100:103], v[176:179], a[228:231], v[100:103]
s_waitcnt lgkmcnt(6) vmcnt(13)
ds_read_b128 v[168:171], v8 offset:2048
v_lshl_add_u32 v5, v9, 4, v5
v_mfma_f32_16x16x32_bf16 v[120:123], v[184:187], a[240:243], v[120:123]
ds_read_b128 v[172:175], v8 offset:3072
v_mfma_f32_16x16x32_bf16 v[120:123], v[188:191], a[248:251], v[120:123]
s_waitcnt vmcnt(11)
v_mfma_f32_16x16x32_bf16 v[124:127], v[188:191], a[252:255], v[124:127]
buffer_load_dwordx4 a[140:143], v15, s[24:27], s93 offen offset:2048 sc1
v_mfma_f32_16x16x32_bf16 v[124:127], v[184:187], a[244:247], v[124:127]
s_waitcnt lgkmcnt(6)
ds_read_b128 v[176:179], v8 offset:4096
v_mfma_f32_16x16x32_bf16 v[72:75], v[144:147], a[240:243], v[72:75]
ds_read_b128 v[180:183], v8 offset:5120
v_mfma_f32_16x16x32_bf16 v[72:75], v[148:151], a[248:251], v[72:75]
v_mfma_f32_16x16x32_bf16 v[76:79], v[148:151], a[252:255], v[76:79]
ds_read_b128 v[184:187], v8 offset:6144
v_mfma_f32_16x16x32_bf16 v[76:79], v[144:147], a[244:247], v[76:79]
s_waitcnt lgkmcnt(7)
v_mfma_f32_16x16x32_bf16 v[80:83], v[152:155], a[240:243], v[80:83]
ds_read_b128 v[188:191], v8 offset:7168
v_mfma_f32_16x16x32_bf16 v[80:83], v[156:159], a[248:251], v[80:83]
s_waitcnt lgkmcnt(6)
v_mfma_f32_16x16x32_bf16 v[84:87], v[156:159], a[252:255], v[84:87]
buffer_load_dword v12, v10, s[24:27], s75 offen offset:4 sc1
v_mfma_f32_16x16x32_bf16 v[84:87], v[152:155], a[244:247], v[84:87]
buffer_load_dwordx4 a[144:147], v14, s[24:27], s65 offen offset:0 sc1
v_mfma_f32_16x16x32_bf16 v[88:91], v[160:163], a[240:243], v[88:91]
ds_read_b128 v[144:147], v8 offset:8192
v_mfma_f32_16x16x32_bf16 v[88:91], v[164:167], a[248:251], v[88:91]
ds_read_b128 v[148:151], v8 offset:9216
v_mfma_f32_16x16x32_bf16 v[92:95], v[164:167], a[252:255], v[92:95]
buffer_load_dwordx4 a[152:155], v14, s[24:27], s65 offen offset:2048 sc1
v_mfma_f32_16x16x32_bf16 v[92:95], v[160:163], a[244:247], v[92:95]
s_waitcnt lgkmcnt(6)
ds_read_b128 v[152:155], v8 offset:10240
v_mfma_f32_16x16x32_bf16 v[96:99], v[168:171], a[240:243], v[96:99]
ds_read_b128 v[156:159], v8 offset:11264
v_mfma_f32_16x16x32_bf16 v[96:99], v[172:175], a[248:251], v[96:99]
v_mfma_f32_16x16x32_bf16 v[100:103], v[172:175], a[252:255], v[100:103]
buffer_load_dwordx4 a[148:151], v14, s[24:27], s93 offen offset:0 sc1
v_mfma_f32_16x16x32_bf16 v[100:103], v[168:171], a[244:247], v[100:103]
s_waitcnt lgkmcnt(6) vmcnt(14)
ds_read_b128 v[160:163], v8 offset:12288
v_mfma_f32_16x16x32_bf16 v[120:123], v[176:179], a[96:99], v[120:123]
ds_read_b128 v[164:167], v8 offset:13312
v_mfma_f32_16x16x32_bf16 v[120:123], v[180:183], a[104:107], v[120:123]
s_waitcnt vmcnt(12)
v_mfma_f32_16x16x32_bf16 v[124:127], v[180:183], a[108:111], v[124:127]
buffer_load_dwordx4 a[156:159], v14, s[24:27], s93 offen offset:2048 sc1
v_mfma_f32_16x16x32_bf16 v[124:127], v[176:179], a[100:103], v[124:127]
s_waitcnt lgkmcnt(6)
ds_read_b128 v[168:171], v8 offset:14336
v_mfma_f32_16x16x32_bf16 v[72:75], v[184:187], a[96:99], v[72:75]
s_waitcnt vmcnt(61)
ds_read_b128 v[172:175], v8 offset:15360
v_mfma_f32_16x16x32_bf16 v[72:75], v[188:191], a[104:107], v[72:75]
s_barrier
v_mfma_f32_16x16x32_bf16 v[76:79], v[188:191], a[108:111], v[76:79]
s_add_u32 s91, s91, 16384
ds_read_b128 v[176:179], v7 offset:0
v_mfma_f32_16x16x32_bf16 v[76:79], v[184:187], a[100:103], v[76:79]
s_waitcnt lgkmcnt(7)
s_cmp_ge_u32 s91, 163840
s_cselect_b32 s91, 0, s91
v_mfma_f32_16x16x32_bf16 v[80:83], v[144:147], a[96:99], v[80:83]
s_xor_b32 s65, s82, 57344
s_add_u32 s65, s65, s77
ds_read_b128 v[180:183], v7 offset:1024
v_mfma_f32_16x16x32_bf16 v[80:83], v[148:151], a[104:107], v[80:83]
v_add_u32 v8, s91, v4
v_mfma_f32_16x16x32_bf16 v[84:87], v[148:151], a[108:111], v[84:87]
buffer_load_dwordx4 a[160:163], v15, s[24:27], s65 offen offset:0 sc1
v_mfma_f32_16x16x32_bf16 v[84:87], v[144:147], a[100:103], v[84:87]
s_waitcnt lgkmcnt(6)
ds_read_b128 v[184:187], v7 offset:2048
v_mfma_f32_16x16x32_bf16 v[88:91], v[152:155], a[96:99], v[88:91]
ds_read_b128 v[188:191], v7 offset:3072
v_mfma_f32_16x16x32_bf16 v[88:91], v[156:159], a[104:107], v[88:91]
v_mfma_f32_16x16x32_bf16 v[92:95], v[156:159], a[108:111], v[92:95]
buffer_load_dwordx4 a[168:171], v15, s[24:27], s65 offen offset:2048 sc1
v_mfma_f32_16x16x32_bf16 v[92:95], v[152:155], a[100:103], v[92:95]
s_waitcnt lgkmcnt(6)
ds_read_b128 v[144:147], v7 offset:4096
v_mfma_f32_16x16x32_bf16 v[96:99], v[160:163], a[96:99], v[96:99]
s_xor_b32 s93, s82, 57344
s_add_u32 s93, s93, s81
ds_read_b128 v[148:151], v7 offset:5120
v_mfma_f32_16x16x32_bf16 v[96:99], v[164:167], a[104:107], v[96:99]
v_mfma_f32_16x16x32_bf16 v[100:103], v[164:167], a[108:111], v[100:103]
buffer_load_dwordx4 a[164:167], v15, s[24:27], s93 offen offset:0 sc1
v_mfma_f32_16x16x32_bf16 v[100:103], v[160:163], a[100:103], v[100:103]
s_waitcnt lgkmcnt(6) vmcnt(14)
ds_read_b128 v[152:155], v7 offset:6144
v_mfma_f32_16x16x32_bf16 v[120:123], v[168:171], a[112:115], v[120:123]
ds_read_b128 v[156:159], v7 offset:7168
v_mfma_f32_16x16x32_bf16 v[120:123], v[172:175], a[120:123], v[120:123]
s_waitcnt vmcnt(12)
v_mfma_f32_16x16x32_bf16 v[124:127], v[172:175], a[124:127], v[124:127]
buffer_load_dwordx4 a[172:175], v15, s[24:27], s93 offen offset:2048 sc1
v_mfma_f32_16x16x32_bf16 v[124:127], v[168:171], a[116:119], v[124:127]
s_waitcnt lgkmcnt(6)
ds_read_b128 v[160:163], v7 offset:8192
v_mfma_f32_16x16x32_bf16 v[72:75], v[176:179], a[112:115], v[72:75]
ds_read_b128 v[164:167], v7 offset:9216
v_mfma_f32_16x16x32_bf16 v[72:75], v[180:183], a[120:123], v[72:75]
v_mfma_f32_16x16x32_bf16 v[76:79], v[180:183], a[124:127], v[76:79]
ds_read_b128 v[168:171], v7 offset:10240
v_mfma_f32_16x16x32_bf16 v[76:79], v[176:179], a[116:119], v[76:79]
s_waitcnt lgkmcnt(7)
v_mfma_f32_16x16x32_bf16 v[80:83], v[184:187], a[112:115], v[80:83]
ds_read_b128 v[172:175], v7 offset:11264
v_mfma_f32_16x16x32_bf16 v[80:83], v[188:191], a[120:123], v[80:83]
v_mfma_f32_16x16x32_bf16 v[84:87], v[188:191], a[124:127], v[84:87]
buffer_load_dwordx4 a[176:179], v14, s[24:27], s65 offen offset:0 sc1
v_mfma_f32_16x16x32_bf16 v[84:87], v[184:187], a[116:119], v[84:87]
s_waitcnt lgkmcnt(6)
ds_read_b128 v[176:179], v7 offset:12288
v_mfma_f32_16x16x32_bf16 v[88:91], v[144:147], a[112:115], v[88:91]
ds_read_b128 v[180:183], v7 offset:13312
v_mfma_f32_16x16x32_bf16 v[88:91], v[148:151], a[120:123], v[88:91]
v_mfma_f32_16x16x32_bf16 v[92:95], v[148:151], a[124:127], v[92:95]
buffer_load_dwordx4 a[184:187], v14, s[24:27], s65 offen offset:2048 sc1
v_mfma_f32_16x16x32_bf16 v[92:95], v[144:147], a[116:119], v[92:95]
s_waitcnt lgkmcnt(6)
ds_read_b128 v[184:187], v7 offset:14336
v_mfma_f32_16x16x32_bf16 v[96:99], v[152:155], a[112:115], v[96:99]
s_waitcnt vmcnt(10)
ds_read_b128 v[188:191], v7 offset:15360
v_mfma_f32_16x16x32_bf16 v[96:99], v[156:159], a[120:123], v[96:99]
s_add_u32 s91, s91, 16384
v_cmp_gt_u32 vcc, 8, v12
v_mfma_f32_16x16x32_bf16 v[100:103], v[156:159], a[124:127], v[100:103]
buffer_load_dwordx4 a[180:183], v14, s[24:27], s93 offen offset:0 sc1
v_mfma_f32_16x16x32_bf16 v[100:103], v[152:155], a[116:119], v[100:103]
s_waitcnt lgkmcnt(6) vmcnt(14)
ds_read_b128 v[144:147], v8 offset:0
v_mfma_f32_16x16x32_bf16 v[120:123], v[160:163], a[128:131], v[120:123]
s_cmp_ge_u32 s91, 163840
s_cselect_b32 s91, 0, s91
ds_read_b128 v[148:151], v8 offset:1024
v_mfma_f32_16x16x32_bf16 v[120:123], v[164:167], a[136:139], v[120:123]
s_waitcnt lgkmcnt(6) vmcnt(12)
v_add_u32 v7, s91, v4
v_mfma_f32_16x16x32_bf16 v[124:127], v[164:167], a[140:143], v[124:127]
s_cbranch_vccnz CK_ZAA
CK_ZAA_R:
v_mfma_f32_16x16x32_bf16 v[124:127], v[160:163], a[132:135], v[124:127]
buffer_load_dwordx4 a[188:191], v14, s[24:27], s93 offen offset:2048 sc1
v_mfma_f32_16x16x32_bf16 v[72:75], v[168:171], a[128:131], v[72:75]
ds_read_b128 v[152:155], v8 offset:2048
v_mfma_f32_16x16x32_bf16 v[72:75], v[172:175], a[136:139], v[72:75]
ds_read_b128 v[156:159], v8 offset:3072
v_mfma_f32_16x16x32_bf16 v[76:79], v[172:175], a[140:143], v[76:79]
ds_read_b128 v[160:163], v8 offset:4096
v_mfma_f32_16x16x32_bf16 v[76:79], v[168:171], a[132:135], v[76:79]
s_waitcnt lgkmcnt(7)
v_mfma_f32_16x16x32_bf16 v[80:83], v[176:179], a[128:131], v[80:83]
s_add_u32 s65, s77, 65536
ds_read_b128 v[164:167], v8 offset:5120
v_mfma_f32_16x16x32_bf16 v[80:83], v[180:183], a[136:139], v[80:83]
v_mfma_f32_16x16x32_bf16 v[84:87], v[180:183], a[140:143], v[84:87]
buffer_load_dwordx4 v[32:35], v15, s[24:27], s65 offen offset:0 sc1
v_mfma_f32_16x16x32_bf16 v[84:87], v[176:179], a[132:135], v[84:87]
s_waitcnt lgkmcnt(6)
ds_read_b128 v[168:171], v8 offset:6144
v_mfma_f32_16x16x32_bf16 v[88:91], v[184:187], a[128:131], v[88:91]
ds_read_b128 v[172:175], v8 offset:7168
v_mfma_f32_16x16x32_bf16 v[88:91], v[188:191], a[136:139], v[88:91]
v_mfma_f32_16x16x32_bf16 v[92:95], v[188:191], a[140:143], v[92:95]
buffer_load_dwordx4 v[40:43], v15, s[24:27], s65 offen offset:2048 sc1
v_mfma_f32_16x16x32_bf16 v[92:95], v[184:187], a[132:135], v[92:95]
s_waitcnt lgkmcnt(6)
ds_read_b128 v[176:179], v8 offset:8192
v_mfma_f32_16x16x32_bf16 v[96:99], v[144:147], a[128:131], v[96:99]
s_add_u32 s93, s81, 65536
ds_read_b128 v[180:183], v8 offset:9216
v_mfma_f32_16x16x32_bf16 v[96:99], v[148:151], a[136:139], v[96:99]
s_waitcnt lgkmcnt(6) vmcnt(12)
v_mfma_f32_16x16x32_bf16 v[100:103], v[148:151], a[140:143], v[100:103]
buffer_load_dwordx4 v[36:39], v15, s[24:27], s93 offen offset:0 sc1
v_mfma_f32_16x16x32_bf16 v[100:103], v[144:147], a[132:135], v[100:103]
s_mov_b32 m0, s70
s_mov_b32 s64, s68
s_add_u32 s68, s68, 16384
v_mfma_f32_16x16x32_bf16 v[120:123], v[152:155], a[144:147], v[120:123]
s_waitcnt vmcnt(11)
ds_read_b128 v[184:187], v8 offset:10240
v_mfma_f32_16x16x32_bf16 v[120:123], v[156:159], a[152:155], v[120:123]
s_add_u32 s70, s70, 16384
s_cmp_ge_u32 s70, 163840
s_cselect_b32 s70, s80, s70
v_mfma_f32_16x16x32_bf16 v[124:127], v[156:159], a[156:159], v[124:127]
buffer_load_dwordx4 v15, s[24:27], s64 offen offset:0 sc1 lds
v_mfma_f32_16x16x32_bf16 v[124:127], v[152:155], a[148:151], v[124:127]
s_waitcnt lgkmcnt(5)
ds_read_b128 v[188:191], v8 offset:11264
v_mfma_f32_16x16x32_bf16 v[72:75], v[160:163], a[144:147], v[72:75]
ds_read_b128 v[144:147], v8 offset:12288
v_mfma_f32_16x16x32_bf16 v[72:75], v[164:167], a[152:155], v[72:75]
buffer_load_dwordx4 v15, s[24:27], s64 offen offset:1024 sc1 lds
v_mfma_f32_16x16x32_bf16 v[76:79], v[164:167], a[156:159], v[76:79]
ds_read_b128 v[148:151], v8 offset:13312
v_mfma_f32_16x16x32_bf16 v[76:79], v[160:163], a[148:151], v[76:79]
s_waitcnt lgkmcnt(6)
ds_read_b128 v[152:155], v8 offset:14336
v_mfma_f32_16x16x32_bf16 v[80:83], v[168:171], a[144:147], v[80:83]
buffer_load_dwordx4 v[44:47], v15, s[24:27], s93 offen offset:2048 sc1
v_mfma_f32_16x16x32_bf16 v[80:83], v[172:175], a[152:155], v[80:83]
s_barrier
v_mfma_f32_16x16x32_bf16 v[84:87], v[172:175], a[156:159], v[84:87]
s_waitcnt lgkmcnt(5)
ds_read_b128 v[156:159], v8 offset:15360
v_mfma_f32_16x16x32_bf16 v[84:87], v[168:171], a[148:151], v[84:87]
buffer_load_dwordx4 v15, s[24:27], s64 offen offset:2048 sc1 lds
v_mfma_f32_16x16x32_bf16 v[88:91], v[176:179], a[144:147], v[88:91]
s_add_u32 s91, s91, 16384
ds_read_b128 v[160:163], v7 offset:0
v_mfma_f32_16x16x32_bf16 v[88:91], v[180:183], a[152:155], v[88:91]
s_cmp_ge_u32 s91, 163840
s_cselect_b32 s91, 0, s91
ds_read_b128 v[164:167], v7 offset:1024
v_mfma_f32_16x16x32_bf16 v[92:95], v[180:183], a[156:159], v[92:95]
buffer_load_dwordx4 v15, s[24:27], s64 offen offset:3072 sc1 lds
v_mfma_f32_16x16x32_bf16 v[92:95], v[176:179], a[148:151], v[92:95]
s_waitcnt lgkmcnt(6)
ds_read_b128 v[168:171], v7 offset:2048
v_add_u32 v8, s91, v4
v_mfma_f32_16x16x32_bf16 v[96:99], v[184:187], a[144:147], v[96:99]
ds_read_b128 v[172:175], v7 offset:3072
v_mfma_f32_16x16x32_bf16 v[96:99], v[188:191], a[152:155], v[96:99]
buffer_load_dwordx4 v[48:51], v14, s[24:27], s65 offen offset:0 sc1
v_mfma_f32_16x16x32_bf16 v[100:103], v[188:191], a[156:159], v[100:103]
ds_read_b128 v[176:179], v7 offset:4096
v_mfma_f32_16x16x32_bf16 v[100:103], v[184:187], a[148:151], v[100:103]
s_waitcnt lgkmcnt(7) vmcnt(15)
v_mfma_f32_16x16x32_bf16 v[120:123], v[144:147], a[160:163], v[120:123]
buffer_load_dwordx4 v[56:59], v14, s[24:27], s65 offen offset:2048 sc1
v_mfma_f32_16x16x32_bf16 v[120:123], v[148:151], a[168:171], v[120:123]
s_waitcnt vmcnt(14)
ds_read_b128 v[180:183], v7 offset:5120
v_mfma_f32_16x16x32_bf16 v[124:127], v[148:151], a[172:175], v[124:127]
s_waitcnt lgkmcnt(6)
ds_read_b128 v[184:187], v7 offset:6144
v_mfma_f32_16x16x32_bf16 v[124:127], v[144:147], a[164:167], v[124:127]
buffer_load_dwordx4 v[52:55], v14, s[24:27], s93 offen offset:0 sc1
v_mfma_f32_16x16x32_bf16 v[72:75], v[152:155], a[160:163], v[72:75]
ds_read_b128 v[188:191], v7 offset:7168
v_mfma_f32_16x16x32_bf16 v[72:75], v[156:159], a[168:171], v[72:75]
v_mfma_f32_16x16x32_bf16 v[76:79], v[156:159], a[172:175], v[76:79]
buffer_load_dwordx4 v[60:63], v14, s[24:27], s93 offen offset:2048 sc1
v_mfma_f32_16x16x32_bf16 v[76:79], v[152:155], a[164:167], v[76:79]
s_waitcnt lgkmcnt(6)
ds_read_b128 v[144:147], v7 offset:8192
v_mfma_f32_16x16x32_bf16 v[80:83], v[160:163], a[160:163], v[80:83]
ds_read_b128 v[148:151], v7 offset:9216
v_mfma_f32_16x16x32_bf16 v[80:83], v[164:167], a[168:171], v[80:83]
v_mfma_f32_16x16x32_bf16 v[84:87], v[164:167], a[172:175], v[84:87]
ds_read_b128 v[152:155], v7 offset:10240
v_mfma_f32_16x16x32_bf16 v[84:87], v[160:163], a[164:167], v[84:87]
s_waitcnt lgkmcnt(7)
v_mfma_f32_16x16x32_bf16 v[88:91], v[168:171], a[160:163], v[88:91]
s_add_u32 s65, s77, 73728
ds_read_b128 v[156:159], v7 offset:11264
v_mfma_f32_16x16x32_bf16 v[88:91], v[172:175], a[168:171], v[88:91]
v_mfma_f32_16x16x32_bf16 v[92:95], v[172:175], a[172:175], v[92:95]
buffer_load_dwordx4 v[64:67], v15, s[24:27], s65 offen offset:0 sc1
v_mfma_f32_16x16x32_bf16 v[92:95], v[168:171], a[164:167], v[92:95]
s_waitcnt lgkmcnt(6)
ds_read_b128 v[160:163], v7 offset:12288
v_mfma_f32_16x16x32_bf16 v[96:99], v[176:179], a[160:163], v[96:99]
ds_read_b128 v[164:167], v7 offset:13312
v_mfma_f32_16x16x32_bf16 v[96:99], v[180:183], a[168:171], v[96:99]
v_mfma_f32_16x16x32_bf16 v[100:103], v[180:183], a[172:175], v[100:103]
ds_read_b128 v[168:171], v7 offset:14336
v_mfma_f32_16x16x32_bf16 v[100:103], v[176:179], a[164:167], v[100:103]
s_add_u32 s93, s81, 73728
s_waitcnt lgkmcnt(7) vmcnt(15)
v_mfma_f32_16x16x32_bf16 v[120:123], v[184:187], a[176:179], v[120:123]
s_waitcnt vmcnt(13)
ds_read_b128 v[172:175], v7 offset:15360
v_mfma_f32_16x16x32_bf16 v[120:123], v[188:191], a[184:187], v[120:123]
buffer_load_dwordx4 v[68:71], v15, s[24:27], s93 offen offset:0 sc1
v_mfma_f32_16x16x32_bf16 v[124:127], v[188:191], a[188:191], v[124:127]
s_add_u32 s91, s91, 16384
ds_read_b128 v[176:179], v8 offset:0
v_mfma_f32_16x16x32_bf16 v[124:127], v[184:187], a[180:183], v[124:127]
s_waitcnt lgkmcnt(7)
s_cmp_ge_u32 s91, 163840
s_cselect_b32 s91, 0, s91
v_mfma_f32_16x16x32_bf16 v[72:75], v[144:147], a[176:179], v[72:75]
ds_read_b128 v[180:183], v8 offset:1024
v_add_u32 v7, s91, v4
v_mfma_f32_16x16x32_bf16 v[72:75], v[148:151], a[184:187], v[72:75]
v_mfma_f32_16x16x32_bf16 v[76:79], v[148:151], a[188:191], v[76:79]
s_mov_b32 m0, s70
s_mov_b32 s64, s68
s_add_u32 s68, s68, 16384
v_mfma_f32_16x16x32_bf16 v[76:79], v[144:147], a[180:183], v[76:79]
s_waitcnt lgkmcnt(6)
ds_read_b128 v[184:187], v8 offset:2048
v_mfma_f32_16x16x32_bf16 v[80:83], v[152:155], a[176:179], v[80:83]
s_add_u32 s70, s70, 16384
s_cmp_ge_u32 s70, 163840
s_cselect_b32 s70, s80, s70
v_mfma_f32_16x16x32_bf16 v[80:83], v[156:159], a[184:187], v[80:83]
buffer_load_dwordx4 v15, s[24:27], s64 offen offset:0 sc1 lds
v_mfma_f32_16x16x32_bf16 v[84:87], v[156:159], a[188:191], v[84:87]
ds_read_b128 v[188:191], v8 offset:3072
v_mfma_f32_16x16x32_bf16 v[84:87], v[152:155], a[180:183], v[84:87]
s_waitcnt lgkmcnt(6)
ds_read_b128 v[144:147], v8 offset:4096
v_mfma_f32_16x16x32_bf16 v[88:91], v[160:163], a[176:179], v[88:91]
buffer_load_dwordx4 v15, s[24:27], s64 offen offset:1024 sc1 lds
v_mfma_f32_16x16x32_bf16 v[88:91], v[164:167], a[184:187], v[88:91]
ds_read_b128 v[148:151], v8 offset:5120
v_mfma_f32_16x16x32_bf16 v[92:95], v[164:167], a[188:191], v[92:95]
s_waitcnt lgkmcnt(6)
ds_read_b128 v[152:155], v8 offset:6144
v_mfma_f32_16x16x32_bf16 v[92:95], v[160:163], a[180:183], v[92:95]
buffer_load_dwordx4 v15, s[24:27], s64 offen offset:2048 sc1 lds
v_mfma_f32_16x16x32_bf16 v[96:99], v[168:171], a[176:179], v[96:99]
L_PAD12:
s_cbranch_execz L_MAIN
ds_read_b128 v[156:159], v8 offset:7168
v_mfma_f32_16x16x32_bf16 v[96:99], v[172:175], a[184:187], v[96:99]
v_mfma_f32_16x16x32_bf16 v[100:103], v[172:175], a[188:191], v[100:103]
buffer_load_dwordx4 v15, s[24:27], s64 offen offset:3072 sc1 lds
v_mfma_f32_16x16x32_bf16 v[100:103], v[168:171], a[180:183], v[100:103]
s_waitcnt lgkmcnt(6) vmcnt(16)
ds_read_b128 v[160:163], v8 offset:8192
v_mfma_f32_16x16x32_bf16 v[120:123], v[176:179], v[32:35], v[120:123]
s_mov_b32 m0, s70
s_mov_b32 s64, s68
s_add_u32 s68, s68, 16384
v_mfma_f32_16x16x32_bf16 v[120:123], v[180:183], v[40:43], v[120:123]
s_waitcnt lgkmcnt(5) vmcnt(12)
ds_read_b128 v[164:167], v8 offset:9216
v_mfma_f32_16x16x32_bf16 v[124:127], v[180:183], v[44:47], v[124:127]
s_add_u32 s70, s70, 16384
s_cmp_ge_u32 s70, 163840
s_cselect_b32 s70, s80, s70
v_mfma_f32_16x16x32_bf16 v[124:127], v[176:179], v[36:39], v[124:127]
buffer_load_dwordx4 v15, s[24:27], s64 offen offset:0 sc1 lds
v_mfma_f32_16x16x32_bf16 v[72:75], v[184:187], v[32:35], v[72:75]
ds_read_b128 v[168:171], v8 offset:10240
v_mfma_f32_16x16x32_bf16 v[72:75], v[188:191], v[40:43], v[72:75]
ds_read_b128 v[172:175], v8 offset:11264
v_mfma_f32_16x16x32_bf16 v[76:79], v[188:191], v[44:47], v[76:79]
buffer_load_dwordx4 v15, s[24:27], s64 offen offset:1024 sc1 lds
v_mfma_f32_16x16x32_bf16 v[76:79], v[184:187], v[36:39], v[76:79]
s_waitcnt lgkmcnt(6)
ds_read_b128 v[176:179], v8 offset:12288
v_mfma_f32_16x16x32_bf16 v[80:83], v[144:147], v[32:35], v[80:83]
ds_read_b128 v[180:183], v8 offset:13312
v_mfma_f32_16x16x32_bf16 v[80:83], v[148:151], v[40:43], v[80:83]
buffer_load_dwordx4 v15, s[24:27], s64 offen offset:2048 sc1 lds
v_mfma_f32_16x16x32_bf16 v[84:87], v[148:151], v[44:47], v[84:87]
ds_read_b128 v[184:187], v8 offset:14336
v_mfma_f32_16x16x32_bf16 v[84:87], v[144:147], v[36:39], v[84:87]
s_waitcnt lgkmcnt(7)
v_mfma_f32_16x16x32_bf16 v[88:91], v[152:155], v[32:35], v[88:91]
s_waitcnt vmcnt(13)
ds_read_b128 v[188:191], v8 offset:15360
v_mfma_f32_16x16x32_bf16 v[88:91], v[156:159], v[40:43], v[88:91]
s_barrier
v_mfma_f32_16x16x32_bf16 v[92:95], v[156:159], v[44:47], v[92:95]
buffer_load_dwordx4 v15, s[24:27], s64 offen offset:3072 sc1 lds
v_mfma_f32_16x16x32_bf16 v[92:95], v[152:155], v[36:39], v[92:95]
s_waitcnt lgkmcnt(6)
s_add_u32 s91, s91, 16384
ds_read_b128 v[144:147], v7 offset:0
v_mfma_f32_16x16x32_bf16 v[96:99], v[160:163], v[32:35], v[96:99]
s_cmp_ge_u32 s91, 163840
s_cselect_b32 s91, 0, s91
ds_read_b128 v[148:151], v7 offset:1024
v_mfma_f32_16x16x32_bf16 v[96:99], v[164:167], v[40:43], v[96:99]
v_add_u32 v8, s91, v4
v_mfma_f32_16x16x32_bf16 v[100:103], v[164:167], v[44:47], v[100:103]
ds_read_b128 v[152:155], v7 offset:2048
v_mfma_f32_16x16x32_bf16 v[100:103], v[160:163], v[36:39], v[100:103]
s_waitcnt lgkmcnt(7) vmcnt(12)
v_mfma_f32_16x16x32_bf16 v[120:123], v[168:171], v[48:51], v[120:123]
ds_read_b128 v[156:159], v7 offset:3072
v_mfma_f32_16x16x32_bf16 v[120:123], v[172:175], v[56:59], v[120:123]
s_waitcnt vmcnt(10)
v_mfma_f32_16x16x32_bf16 v[124:127], v[172:175], v[60:63], v[124:127]
ds_read_b128 v[160:163], v7 offset:4096
v_mfma_f32_16x16x32_bf16 v[124:127], v[168:171], v[52:55], v[124:127]
s_waitcnt lgkmcnt(7)
v_mfma_f32_16x16x32_bf16 v[72:75], v[176:179], v[48:51], v[72:75]
ds_read_b128 v[164:167], v7 offset:5120
v_mfma_f32_16x16x32_bf16 v[72:75], v[180:183], v[56:59], v[72:75]
v_mfma_f32_16x16x32_bf16 v[76:79], v[180:183], v[60:63], v[76:79]
ds_read_b128 v[168:171], v7 offset:6144
v_mfma_f32_16x16x32_bf16 v[76:79], v[176:179], v[52:55], v[76:79]
s_waitcnt lgkmcnt(7)
v_mfma_f32_16x16x32_bf16 v[80:83], v[184:187], v[48:51], v[80:83]
ds_read_b128 v[172:175], v7 offset:7168
v_mfma_f32_16x16x32_bf16 v[80:83], v[188:191], v[56:59], v[80:83]
v_mfma_f32_16x16x32_bf16 v[84:87], v[188:191], v[60:63], v[84:87]
ds_read_b128 v[176:179], v7 offset:8192
v_mfma_f32_16x16x32_bf16 v[84:87], v[184:187], v[52:55], v[84:87]
s_waitcnt lgkmcnt(7)
v_mfma_f32_16x16x32_bf16 v[88:91], v[144:147], v[48:51], v[88:91]
ds_read_b128 v[180:183], v7 offset:9216
v_mfma_f32_16x16x32_bf16 v[88:91], v[148:151], v[56:59], v[88:91]
v_mfma_f32_16x16x32_bf16 v[92:95], v[148:151], v[60:63], v[92:95]
ds_read_b128 v[184:187], v7 offset:10240
v_mfma_f32_16x16x32_bf16 v[92:95], v[144:147], v[52:55], v[92:95]
s_waitcnt lgkmcnt(7)
v_mfma_f32_16x16x32_bf16 v[96:99], v[152:155], v[48:51], v[96:99]
ds_read_b128 v[188:191], v7 offset:11264
v_mfma_f32_16x16x32_bf16 v[96:99], v[156:159], v[56:59], v[96:99]
v_mfma_f32_16x16x32_bf16 v[100:103], v[156:159], v[60:63], v[100:103]
ds_read_b128 v[144:147], v7 offset:12288
v_mfma_f32_16x16x32_bf16 v[100:103], v[152:155], v[52:55], v[100:103]
s_waitcnt lgkmcnt(7) vmcnt(9)
v_mfma_f32_16x16x32_bf16 v[120:123], v[160:163], v[64:67], v[120:123]
s_waitcnt vmcnt(8)
ds_read_b128 v[148:151], v7 offset:13312
v_mfma_f32_16x16x32_bf16 v[124:127], v[160:163], v[68:71], v[124:127]
v_mfma_f32_16x16x32_bf16 v[72:75], v[164:167], v[64:67], v[72:75]
ds_read_b128 v[152:155], v7 offset:14336
v_mfma_f32_16x16x32_bf16 v[76:79], v[164:167], v[68:71], v[76:79]
s_waitcnt lgkmcnt(7)
v_mfma_f32_16x16x32_bf16 v[80:83], v[168:171], v[64:67], v[80:83]
ds_read_b128 v[156:159], v7 offset:15360
v_mfma_f32_16x16x32_bf16 v[84:87], v[168:171], v[68:71], v[84:87]
s_add_u32 s91, s91, 16384
s_cmp_ge_u32 s91, 163840
s_cselect_b32 s91, 0, s91
v_mfma_f32_16x16x32_bf16 v[88:91], v[172:175], v[64:67], v[88:91]
ds_read_b128 v[160:163], v8 offset:0
v_add_u32 v7, s91, v4
v_mfma_f32_16x16x32_bf16 v[92:95], v[172:175], v[68:71], v[92:95]
s_waitcnt lgkmcnt(7)
v_mfma_f32_16x16x32_bf16 v[96:99], v[176:179], v[64:67], v[96:99]
ds_read_b128 v[164:167], v8 offset:1024
v_cvt_pk_bf16_f32 v228, v120, v121
v_mfma_f32_16x16x32_bf16 v[100:103], v[176:179], v[68:71], v[100:103]
v_cvt_pk_bf16_f32 v229, v122, v123
v_mfma_f32_16x16x32_bf16 v[104:107], v[180:183], a[64:67], v[104:107]
s_waitcnt lgkmcnt(6)
ds_read_b128 v[168:171], v8 offset:2048
v_cvt_pk_bf16_f32 v230, v124, v125
v_mfma_f32_16x16x32_bf16 v[104:107], v[184:187], a[72:75], v[104:107]
v_cvt_pk_bf16_f32 v231, v126, v127
v_mfma_f32_16x16x32_bf16 v[108:111], v[184:187], a[76:79], v[108:111]
buffer_store_dwordx4 v[228:231], v15, s[24:27], s55 offen offset:0 sc1
v_mfma_f32_16x16x32_bf16 v[108:111], v[180:183], a[68:71], v[108:111]
ds_read_b128 v[172:175], v8 offset:3072
v_cvt_pk_bf16_f32 v72, v72, v73
v_mfma_f32_16x16x32_bf16 v[112:115], v[188:191], a[64:67], v[112:115]
s_waitcnt lgkmcnt(6)
ds_read_b128 v[176:179], v8 offset:4096
v_cvt_pk_bf16_f32 v73, v74, v75
v_mfma_f32_16x16x32_bf16 v[112:115], v[144:147], a[72:75], v[112:115]
v_cvt_pk_bf16_f32 v74, v80, v81
v_mfma_f32_16x16x32_bf16 v[116:119], v[144:147], a[76:79], v[116:119]
ds_read_b128 v[180:183], v8 offset:5120
v_cvt_pk_bf16_f32 v75, v82, v83
v_mfma_f32_16x16x32_bf16 v[116:119], v[188:191], a[68:71], v[116:119]
buffer_store_dwordx4 v[72:75], v15, s[24:27], s52 offen offset:0 sc1
v_mfma_f32_16x16x32_bf16 v[104:107], v[148:151], a[80:83], v[104:107]
s_waitcnt lgkmcnt(6)
ds_read_b128 v[184:187], v8 offset:6144
v_cvt_pk_bf16_f32 v76, v76, v77
v_mfma_f32_16x16x32_bf16 v[104:107], v[152:155], a[88:91], v[104:107]
v_cvt_pk_bf16_f32 v77, v78, v79
v_mfma_f32_16x16x32_bf16 v[108:111], v[152:155], a[92:95], v[108:111]
ds_read_b128 v[188:191], v8 offset:7168
v_cvt_pk_bf16_f32 v78, v84, v85
v_mfma_f32_16x16x32_bf16 v[108:111], v[148:151], a[84:87], v[108:111]
s_waitcnt lgkmcnt(6)
v_cvt_pk_bf16_f32 v79, v86, v87
v_mfma_f32_16x16x32_bf16 v[112:115], v[156:159], a[80:83], v[112:115]
buffer_store_dwordx4 v[76:79], v15, s[24:27], s52 offen offset:1024 sc1
v_mfma_f32_16x16x32_bf16 v[112:115], v[160:163], a[88:91], v[112:115]
ds_read_b128 v[144:147], v8 offset:8192
v_cvt_pk_bf16_f32 v88, v88, v89
v_mfma_f32_16x16x32_bf16 v[116:119], v[160:163], a[92:95], v[116:119]
ds_read_b128 v[148:151], v8 offset:9216
v_cvt_pk_bf16_f32 v89, v90, v91
v_mfma_f32_16x16x32_bf16 v[116:119], v[156:159], a[84:87], v[116:119]
v_cvt_pk_bf16_f32 v90, v96, v97
v_mfma_f32_16x16x32_bf16 v[104:107], v[164:167], a[192:195], v[104:107]
s_waitcnt lgkmcnt(6)
ds_read_b128 v[152:155], v8 offset:10240
v_cvt_pk_bf16_f32 v91, v98, v99
v_mfma_f32_16x16x32_bf16 v[104:107], v[168:171], a[200:203], v[104:107]
buffer_store_dwordx4 v[88:91], v15, s[24:27], s53 offen offset:0 sc1
v_mfma_f32_16x16x32_bf16 v[108:111], v[168:171], a[204:207], v[108:111]
ds_read_b128 v[156:159], v8 offset:11264
v_cvt_pk_bf16_f32 v92, v92, v93
v_mfma_f32_16x16x32_bf16 v[108:111], v[164:167], a[196:199], v[108:111]
v_cvt_pk_bf16_f32 v93, v94, v95
v_mfma_f32_16x16x32_bf16 v[112:115], v[172:175], a[192:195], v[112:115]
s_waitcnt lgkmcnt(6)
ds_read_b128 v[160:163], v8 offset:12288
v_cvt_pk_bf16_f32 v94, v100, v101
v_mfma_f32_16x16x32_bf16 v[112:115], v[176:179], a[200:203], v[112:115]
s_waitcnt lgkmcnt(5)
v_cvt_pk_bf16_f32 v95, v102, v103
v_mfma_f32_16x16x32_bf16 v[116:119], v[176:179], a[204:207], v[116:119]
buffer_store_dwordx4 v[92:95], v15, s[24:27], s53 offen offset:1024 sc1
v_mfma_f32_16x16x32_bf16 v[116:119], v[172:175], a[196:199], v[116:119]
s_mov_b32 m0, s70
s_mov_b32 s64, s68
s_add_u32 s68, s68, 16384
v_mfma_f32_16x16x32_bf16 v[104:107], v[180:183], a[208:211], v[104:107]
s_add_u32 s70, s70, 16384
s_cmp_ge_u32 s70, 163840
s_cselect_b32 s70, s80, s70
v_mfma_f32_16x16x32_bf16 v[104:107], v[184:187], a[216:219], v[104:107]
buffer_load_dwordx4 v15, s[24:27], s64 offen offset:0 sc1 lds
v_mfma_f32_16x16x32_bf16 v[108:111], v[184:187], a[220:223], v[108:111]
s_waitcnt vmcnt(6) lgkmcnt(3)
ds_read_b128 v[164:167], v8 offset:13312
v_mfma_f32_16x16x32_bf16 v[108:111], v[180:183], a[212:215], v[108:111]
s_barrier
v_mfma_f32_16x16x32_bf16 v[112:115], v[188:191], a[208:211], v[112:115]
buffer_load_dwordx4 v15, s[24:27], s64 offen offset:1024 sc1 lds
v_mfma_f32_16x16x32_bf16 v[112:115], v[144:147], a[216:219], v[112:115]
ds_read_b128 v[168:171], v8 offset:14336
v_mfma_f32_16x16x32_bf16 v[116:119], v[144:147], a[220:223], v[116:119]
ds_read_b128 v[172:175], v8 offset:15360
v_mfma_f32_16x16x32_bf16 v[116:119], v[188:191], a[212:215], v[116:119]
buffer_load_dwordx4 v15, s[24:27], s64 offen offset:2048 sc1 lds
v_mfma_f32_16x16x32_bf16 v[104:107], v[148:151], a[224:227], v[104:107]
s_waitcnt lgkmcnt(4)
s_add_u32 s91, s91, 16384
ds_read_b128 v[176:179], v7 offset:0
v_mfma_f32_16x16x32_bf16 v[104:107], v[152:155], a[232:235], v[104:107]
s_cmp_ge_u32 s91, 163840
s_cselect_b32 s91, 0, s91
ds_read_b128 v[180:183], v7 offset:1024
v_mfma_f32_16x16x32_bf16 v[108:111], v[152:155], a[236:239], v[108:111]
buffer_load_dwordx4 v15, s[24:27], s64 offen offset:3072 sc1 lds
v_mfma_f32_16x16x32_bf16 v[108:111], v[148:151], a[228:231], v[108:111]
s_mov_b32 m0, s70
s_mov_b32 s64, s68
s_add_u32 s68, s68, 16384
v_mfma_f32_16x16x32_bf16 v[112:115], v[156:159], a[224:227], v[112:115]
s_waitcnt lgkmcnt(4)
ds_read_b128 v[184:187], v7 offset:2048
v_add_u32 v8, s91, v4
v_mfma_f32_16x16x32_bf16 v[112:115], v[160:163], a[232:235], v[112:115]
s_add_u32 s70, s70, 16384
s_cmp_ge_u32 s70, 163840
s_cselect_b32 s70, s80, s70
v_mfma_f32_16x16x32_bf16 v[116:119], v[160:163], a[236:239], v[116:119]
buffer_load_dwordx4 v15, s[24:27], s64 offen offset:0 sc1 lds
v_mfma_f32_16x16x32_bf16 v[116:119], v[156:159], a[228:231], v[116:119]
ds_read_b128 v[188:191], v7 offset:3072
v_mfma_f32_16x16x32_bf16 v[104:107], v[164:167], a[240:243], v[104:107]
s_waitcnt lgkmcnt(4)
ds_read_b128 v[144:147], v7 offset:4096
v_mfma_f32_16x16x32_bf16 v[104:107], v[168:171], a[248:251], v[104:107]
buffer_load_dwordx4 v15, s[24:27], s64 offen offset:1024 sc1 lds
v_mfma_f32_16x16x32_bf16 v[108:111], v[168:171], a[252:255], v[108:111]
ds_read_b128 v[148:151], v7 offset:5120
v_mfma_f32_16x16x32_bf16 v[108:111], v[164:167], a[244:247], v[108:111]
s_waitcnt lgkmcnt(4)
ds_read_b128 v[152:155], v7 offset:6144
v_mfma_f32_16x16x32_bf16 v[112:115], v[172:175], a[240:243], v[112:115]
buffer_load_dwordx4 v15, s[24:27], s64 offen offset:2048 sc1 lds
v_mfma_f32_16x16x32_bf16 v[112:115], v[176:179], a[248:251], v[112:115]
ds_read_b128 v[156:159], v7 offset:7168
v_mfma_f32_16x16x32_bf16 v[116:119], v[176:179], a[252:255], v[116:119]
ds_read_b128 v[160:163], v7 offset:8192
v_mfma_f32_16x16x32_bf16 v[116:119], v[172:175], a[244:247], v[116:119]
buffer_load_dwordx4 v15, s[24:27], s64 offen offset:3072 sc1 lds
v_mfma_f32_16x16x32_bf16 v[104:107], v[180:183], a[96:99], v[104:107]
s_waitcnt lgkmcnt(5)
ds_read_b128 v[164:167], v7 offset:9216
v_mfma_f32_16x16x32_bf16 v[104:107], v[184:187], a[104:107], v[104:107]
ds_read_b128 v[168:171], v7 offset:10240
v_mfma_f32_16x16x32_bf16 v[108:111], v[184:187], a[108:111], v[108:111]
ds_read_b128 v[172:175], v7 offset:11264
v_mfma_f32_16x16x32_bf16 v[108:111], v[180:183], a[100:103], v[108:111]
v_mfma_f32_16x16x32_bf16 v[112:115], v[188:191], a[96:99], v[112:115]
s_waitcnt lgkmcnt(6)
ds_read_b128 v[176:179], v7 offset:12288
v_mfma_f32_16x16x32_bf16 v[112:115], v[144:147], a[104:107], v[112:115]
v_mfma_f32_16x16x32_bf16 v[116:119], v[144:147], a[108:111], v[116:119]
ds_read_b128 v[180:183], v7 offset:13312
v_mfma_f32_16x16x32_bf16 v[116:119], v[188:191], a[100:103], v[116:119]
v_mfma_f32_16x16x32_bf16 v[104:107], v[148:151], a[112:115], v[104:107]
s_waitcnt lgkmcnt(6)
ds_read_b128 v[184:187], v7 offset:14336
v_mfma_f32_16x16x32_bf16 v[104:107], v[152:155], a[120:123], v[104:107]
v_mfma_f32_16x16x32_bf16 v[108:111], v[152:155], a[124:127], v[108:111]
ds_read_b128 v[188:191], v7 offset:15360
v_mfma_f32_16x16x32_bf16 v[108:111], v[148:151], a[116:119], v[108:111]
s_add_u32 s91, s91, 16384
s_cmp_ge_u32 s91, 163840
s_cselect_b32 s91, 0, s91
v_mfma_f32_16x16x32_bf16 v[112:115], v[156:159], a[112:115], v[112:115]
s_waitcnt lgkmcnt(6)
ds_read_b128 v[144:147], v8 offset:0
v_add_u32 v7, s91, v4
v_mfma_f32_16x16x32_bf16 v[112:115], v[160:163], a[120:123], v[112:115]
v_mfma_f32_16x16x32_bf16 v[116:119], v[160:163], a[124:127], v[116:119]
ds_read_b128 v[148:151], v8 offset:1024
v_mfma_f32_16x16x32_bf16 v[116:119], v[156:159], a[116:119], v[116:119]
s_waitcnt lgkmcnt(6)
v_mfma_f32_16x16x32_bf16 v[104:107], v[164:167], a[128:131], v[104:107]
s_mov_b32 m0, s70
s_mov_b32 s64, s68
s_add_u32 s68, s68, 16384
v_mfma_f32_16x16x32_bf16 v[104:107], v[168:171], a[136:139], v[104:107]
ds_read_b128 v[152:155], v8 offset:2048
v_mfma_f32_16x16x32_bf16 v[108:111], v[168:171], a[140:143], v[108:111]
s_add_u32 s70, s70, 16384
s_cmp_ge_u32 s70, 163840
s_cselect_b32 s70, s80, s70
v_mfma_f32_16x16x32_bf16 v[108:111], v[164:167], a[132:135], v[108:111]
buffer_load_dwordx4 v15, s[24:27], s64 offen offset:0 sc1 lds
v_mfma_f32_16x16x32_bf16 v[112:115], v[172:175], a[128:131], v[112:115]
s_waitcnt lgkmcnt(5)
ds_read_b128 v[156:159], v8 offset:3072
v_mfma_f32_16x16x32_bf16 v[112:115], v[176:179], a[136:139], v[112:115]
ds_read_b128 v[160:163], v8 offset:4096
v_mfma_f32_16x16x32_bf16 v[116:119], v[176:179], a[140:143], v[116:119]
buffer_load_dwordx4 v15, s[24:27], s64 offen offset:1024 sc1 lds
v_mfma_f32_16x16x32_bf16 v[116:119], v[172:175], a[132:135], v[116:119]
ds_read_b128 v[164:167], v8 offset:5120
v_mfma_f32_16x16x32_bf16 v[104:107], v[180:183], a[144:147], v[104:107]
s_waitcnt vmcnt(10) lgkmcnt(6)
ds_read_b128 v[168:171], v8 offset:6144
v_mfma_f32_16x16x32_bf16 v[104:107], v[184:187], a[152:155], v[104:107]
buffer_atomic_add v1, v0, s[24:27], s73 offen offset:0 sc1
v_mfma_f32_16x16x32_bf16 v[108:111], v[184:187], a[156:159], v[108:111]
buffer_load_dwordx4 v15, s[24:27], s64 offen offset:2048 sc1 lds
v_mfma_f32_16x16x32_bf16 v[108:111], v[180:183], a[148:151], v[108:111]
ds_read_b128 v[172:175], v8 offset:7168
v_mfma_f32_16x16x32_bf16 v[112:115], v[188:191], a[144:147], v[112:115]
s_waitcnt lgkmcnt(6)
ds_read_b128 v[176:179], v8 offset:8192
v_mfma_f32_16x16x32_bf16 v[112:115], v[144:147], a[152:155], v[112:115]
buffer_load_dwordx4 v15, s[24:27], s64 offen offset:3072 sc1 lds
v_mfma_f32_16x16x32_bf16 v[116:119], v[144:147], a[156:159], v[116:119]
s_mov_b32 m0, s70
s_mov_b32 s64, s68
s_add_u32 s68, s68, 16384
v_mfma_f32_16x16x32_bf16 v[116:119], v[188:191], a[148:151], v[116:119]
s_waitcnt lgkmcnt(5)
ds_read_b128 v[180:183], v8 offset:9216
v_mfma_f32_16x16x32_bf16 v[104:107], v[148:151], a[160:163], v[104:107]
s_add_u32 s70, s70, 16384
s_cmp_ge_u32 s70, 163840
s_cselect_b32 s70, s80, s70
v_mfma_f32_16x16x32_bf16 v[104:107], v[152:155], a[168:171], v[104:107]
buffer_load_dwordx4 v15, s[24:27], s64 offen offset:0 sc1 lds
v_mfma_f32_16x16x32_bf16 v[108:111], v[152:155], a[172:175], v[108:111]
ds_read_b128 v[184:187], v8 offset:10240
v_mfma_f32_16x16x32_bf16 v[108:111], v[148:151], a[164:167], v[108:111]
s_waitcnt lgkmcnt(5)
ds_read_b128 v[188:191], v8 offset:11264
v_mfma_f32_16x16x32_bf16 v[112:115], v[156:159], a[160:163], v[112:115]
buffer_load_dwordx4 v15, s[24:27], s64 offen offset:1024 sc1 lds
v_mfma_f32_16x16x32_bf16 v[112:115], v[160:163], a[168:171], v[112:115]
ds_read_b128 v[144:147], v8 offset:12288
v_mfma_f32_16x16x32_bf16 v[116:119], v[160:163], a[172:175], v[116:119]
s_add_u32 s82, s84, 3
ds_read_b128 v[148:151], v8 offset:13312
v_mfma_f32_16x16x32_bf16 v[116:119], v[156:159], a[164:167], v[116:119]
buffer_load_dwordx4 v15, s[24:27], s64 offen offset:2048 sc1 lds
v_mfma_f32_16x16x32_bf16 v[104:107], v[164:167], a[176:179], v[104:107]
s_and_b32 s82, s82, 3
s_waitcnt lgkmcnt(6)
ds_read_b128 v[152:155], v8 offset:14336
v_mfma_f32_16x16x32_bf16 v[104:107], v[168:171], a[184:187], v[104:107]
v_mfma_f32_16x16x32_bf16 v[108:111], v[168:171], a[188:191], v[108:111]
s_waitcnt vmcnt(8)
s_lshl4_add_u32 s82, s82, s73
ds_read_b128 v[156:159], v8 offset:15360
v_mfma_f32_16x16x32_bf16 v[108:111], v[164:167], a[180:183], v[108:111]
s_barrier
v_mfma_f32_16x16x32_bf16 v[112:115], v[172:175], a[176:179], v[112:115]
s_lshl4_add_u32 s75, s84, s73
s_waitcnt lgkmcnt(6)
ds_read_b128 v[160:163], v7 offset:0
v_mfma_f32_16x16x32_bf16 v[112:115], v[176:179], a[184:187], v[112:115]
buffer_load_dwordx4 v15, s[24:27], s64 offen offset:3072 sc1 lds
v_mfma_f32_16x16x32_bf16 v[116:119], v[176:179], a[188:191], v[116:119]
s_add_u32 s91, s91, 16384
ds_read_b128 v[164:167], v7 offset:1024
v_mfma_f32_16x16x32_bf16 v[116:119], v[172:175], a[180:183], v[116:119]
s_cmp_ge_u32 s91, 163840
s_cselect_b32 s91, 0, s91
v_add_u32 v8, s91, v4
v_mfma_f32_16x16x32_bf16 v[104:107], v[180:183], v[32:35], v[104:107]
s_waitcnt lgkmcnt(6)
ds_read_b128 v[168:171], v7 offset:2048
v_mfma_f32_16x16x32_bf16 v[104:107], v[184:187], v[40:43], v[104:107]
v_mfma_f32_16x16x32_bf16 v[108:111], v[184:187], v[44:47], v[108:111]
ds_read_b128 v[172:175], v7 offset:3072
v_mfma_f32_16x16x32_bf16 v[108:111], v[180:183], v[36:39], v[108:111]
v_mfma_f32_16x16x32_bf16 v[112:115], v[188:191], v[32:35], v[112:115]
s_waitcnt lgkmcnt(6)
ds_read_b128 v[176:179], v7 offset:4096
v_mfma_f32_16x16x32_bf16 v[112:115], v[144:147], v[40:43], v[112:115]
v_mfma_f32_16x16x32_bf16 v[116:119], v[144:147], v[44:47], v[116:119]
ds_read_b128 v[180:183], v7 offset:5120
v_mfma_f32_16x16x32_bf16 v[116:119], v[188:191], v[36:39], v[116:119]
v_mfma_f32_16x16x32_bf16 v[104:107], v[148:151], v[48:51], v[104:107]
s_waitcnt lgkmcnt(6)
ds_read_b128 v[184:187], v7 offset:6144
v_mfma_f32_16x16x32_bf16 v[104:107], v[152:155], v[56:59], v[104:107]
v_mfma_f32_16x16x32_bf16 v[108:111], v[152:155], v[60:63], v[108:111]
ds_read_b128 v[188:191], v7 offset:7168
v_mfma_f32_16x16x32_bf16 v[108:111], v[148:151], v[52:55], v[108:111]
v_mfma_f32_16x16x32_bf16 v[112:115], v[156:159], v[48:51], v[112:115]
s_waitcnt lgkmcnt(6)
ds_read_b128 v[144:147], v7 offset:8192
v_mfma_f32_16x16x32_bf16 v[112:115], v[160:163], v[56:59], v[112:115]
v_mfma_f32_16x16x32_bf16 v[116:119], v[160:163], v[60:63], v[116:119]
ds_read_b128 v[148:151], v7 offset:9216
v_mfma_f32_16x16x32_bf16 v[116:119], v[156:159], v[52:55], v[116:119]
v_mfma_f32_16x16x32_bf16 v[104:107], v[164:167], v[64:67], v[104:107]
ds_read_b128 v[152:155], v7 offset:10240
v_mfma_f32_16x16x32_bf16 v[108:111], v[164:167], v[68:71], v[108:111]
s_waitcnt lgkmcnt(7)
v_mfma_f32_16x16x32_bf16 v[112:115], v[168:171], v[64:67], v[112:115]
ds_read_b128 v[156:159], v7 offset:11264
v_mfma_f32_16x16x32_bf16 v[116:119], v[168:171], v[68:71], v[116:119]
v_mfma_f32_16x16x32_bf16 v[128:131], v[172:175], a[0:3], 0
s_waitcnt lgkmcnt(6)
ds_read_b128 v[160:163], v7 offset:12288
v_mfma_f32_16x16x32_bf16 v[128:131], v[176:179], a[8:11], v[128:131]
v_mfma_f32_16x16x32_bf16 v[132:135], v[176:179], a[12:15], 0
ds_read_b128 v[164:167], v7 offset:13312
v_mfma_f32_16x16x32_bf16 v[132:135], v[172:175], a[4:7], v[132:135]
v_mfma_f32_16x16x32_bf16 v[136:139], v[180:183], a[0:3], 0
s_waitcnt lgkmcnt(6)
ds_read_b128 v[168:171], v7 offset:14336
v_mfma_f32_16x16x32_bf16 v[136:139], v[184:187], a[8:11], v[136:139]
v_cvt_pk_bf16_f32 v104, v104, v105
v_mfma_f32_16x16x32_bf16 v[140:143], v[184:187], a[12:15], 0
ds_read_b128 v[172:175], v7 offset:15360
v_cvt_pk_bf16_f32 v105, v106, v107
v_mfma_f32_16x16x32_bf16 v[140:143], v[180:183], a[4:7], v[140:143]
s_add_u32 s91, s91, 16384
v_cvt_pk_bf16_f32 v106, v112, v113
v_mfma_f32_16x16x32_bf16 v[128:131], v[188:191], a[16:19], v[128:131]
s_waitcnt lgkmcnt(6)
ds_read_b128 v[176:179], v8 offset:0
v_cvt_pk_bf16_f32 v107, v114, v115
v_mfma_f32_16x16x32_bf16 v[128:131], v[144:147], a[24:27], v[128:131]
buffer_store_dwordx4 v[104:107], v15, s[24:27], s54 offen offset:0 sc1
v_mfma_f32_16x16x32_bf16 v[132:135], v[144:147], a[28:31], v[132:135]
ds_read_b128 v[180:183], v8 offset:1024
v_cvt_pk_bf16_f32 v108, v108, v109
v_mfma_f32_16x16x32_bf16 v[132:135], v[188:191], a[20:23], v[132:135]
s_cmp_ge_u32 s91, 163840
s_cselect_b32 s91, 0, s91
v_cvt_pk_bf16_f32 v109, v110, v111
v_mfma_f32_16x16x32_bf16 v[136:139], v[148:151], a[16:19], v[136:139]
s_waitcnt lgkmcnt(6)
ds_read_b128 v[184:187], v8 offset:2048
v_cvt_pk_bf16_f32 v110, v116, v117
v_mfma_f32_16x16x32_bf16 v[136:139], v[152:155], a[24:27], v[136:139]
s_waitcnt lgkmcnt(5)
v_cvt_pk_bf16_f32 v111, v118, v119
v_add_u32 v7, s91, v4
v_mfma_f32_16x16x32_bf16 v[140:143], v[152:155], a[28:31], v[140:143]
buffer_store_dwordx4 v[108:111], v15, s[24:27], s54 offen offset:1024 sc1
v_mfma_f32_16x16x32_bf16 v[140:143], v[148:151], a[20:23], v[140:143]
s_mov_b32 m0, s70
s_mov_b32 s64, s68
s_add_u32 s68, s68, 16384
v_mfma_f32_16x16x32_bf16 v[128:131], v[156:159], a[32:35], v[128:131]
s_cmp_lt_u32 s3, 3
s_cselect_b32 s68, s64, 2147418112
ds_read_b128 v[188:191], v8 offset:3072
v_mfma_f32_16x16x32_bf16 v[128:131], v[160:163], a[40:43], v[128:131]
buffer_load_dwordx4 v15, s[24:27], s64 offen offset:0 sc1 lds
v_mfma_f32_16x16x32_bf16 v[132:135], v[160:163], a[44:47], v[132:135]
ds_read_b128 v[144:147], v8 offset:4096
v_mfma_f32_16x16x32_bf16 v[132:135], v[156:159], a[36:39], v[132:135]
s_waitcnt lgkmcnt(5)
ds_read_b128 v[148:151], v8 offset:5120
v_mfma_f32_16x16x32_bf16 v[136:139], v[164:167], a[32:35], v[136:139]
buffer_load_dwordx4 v15, s[24:27], s68 offen offset:1024 sc1 lds
v_mfma_f32_16x16x32_bf16 v[136:139], v[168:171], a[40:43], v[136:139]
ds_read_b128 v[152:155], v8 offset:6144
v_mfma_f32_16x16x32_bf16 v[140:143], v[168:171], a[44:47], v[140:143]
ds_read_b128 v[156:159], v8 offset:7168
v_mfma_f32_16x16x32_bf16 v[140:143], v[164:167], a[36:39], v[140:143]
buffer_load_dwordx4 v15, s[24:27], s68 offen offset:2048 sc1 lds
v_mfma_f32_16x16x32_bf16 v[128:131], v[172:175], a[48:51], v[128:131]
s_waitcnt lgkmcnt(6)
ds_read_b128 v[160:163], v8 offset:8192
v_mfma_f32_16x16x32_bf16 v[128:131], v[176:179], a[56:59], v[128:131]
v_mfma_f32_16x16x32_bf16 v[132:135], v[176:179], a[60:63], v[132:135]
buffer_load_dwordx4 v15, s[24:27], s68 offen offset:3072 sc1 lds
v_mfma_f32_16x16x32_bf16 v[132:135], v[172:175], a[52:55], v[132:135]
buffer_load_dword v12, v10, s[24:27], s73 offen sc1
v_mfma_f32_16x16x32_bf16 v[136:139], v[180:183], a[48:51], v[136:139]
s_waitcnt lgkmcnt(5)
ds_read_b128 v[164:167], v8 offset:9216
v_mfma_f32_16x16x32_bf16 v[136:139], v[184:187], a[56:59], v[136:139]
ds_read_b128 v[168:171], v8 offset:10240
v_mfma_f32_16x16x32_bf16 v[140:143], v[184:187], a[60:63], v[140:143]
ds_read_b128 v[172:175], v8 offset:11264
v_mfma_f32_16x16x32_bf16 v[140:143], v[180:183], a[52:55], v[140:143]
v_mfma_f32_16x16x32_bf16 v[128:131], v[188:191], a[64:67], v[128:131]
s_waitcnt lgkmcnt(6)
ds_read_b128 v[176:179], v8 offset:12288
v_mfma_f32_16x16x32_bf16 v[128:131], v[144:147], a[72:75], v[128:131]
v_mfma_f32_16x16x32_bf16 v[132:135], v[144:147], a[76:79], v[132:135]
ds_read_b128 v[180:183], v8 offset:13312
v_mfma_f32_16x16x32_bf16 v[132:135], v[188:191], a[68:71], v[132:135]
v_mfma_f32_16x16x32_bf16 v[136:139], v[148:151], a[64:67], v[136:139]
s_waitcnt lgkmcnt(6)
ds_read_b128 v[184:187], v8 offset:14336
v_mfma_f32_16x16x32_bf16 v[136:139], v[152:155], a[72:75], v[136:139]
v_mfma_f32_16x16x32_bf16 v[140:143], v[152:155], a[76:79], v[140:143]
s_waitcnt vmcnt(7)
ds_read_b128 v[188:191], v8 offset:15360
v_mfma_f32_16x16x32_bf16 v[140:143], v[148:151], a[68:71], v[140:143]
s_barrier
v_mfma_f32_16x16x32_bf16 v[128:131], v[156:159], a[80:83], v[128:131]
s_waitcnt lgkmcnt(6)
s_add_u32 s91, s91, 16384
ds_read_b128 v[144:147], v7 offset:0
v_mfma_f32_16x16x32_bf16 v[128:131], v[160:163], a[88:91], v[128:131]
s_cmp_ge_u32 s91, 163840
s_cselect_b32 s91, 0, s91
v_add_u32 v8, s91, v4
v_mfma_f32_16x16x32_bf16 v[132:135], v[160:163], a[92:95], v[132:135]
ds_read_b128 v[148:151], v7 offset:1024
v_mfma_f32_16x16x32_bf16 v[132:135], v[156:159], a[84:87], v[132:135]
v_mfma_f32_16x16x32_bf16 v[136:139], v[164:167], a[80:83], v[136:139]
s_waitcnt vmcnt(5) lgkmcnt(6)
ds_read_b128 v[152:155], v7 offset:2048
v_mfma_f32_16x16x32_bf16 v[136:139], v[168:171], a[88:91], v[136:139]
buffer_atomic_add v1, v0, s[24:27], s82 offen offset:16 sc1
v_mfma_f32_16x16x32_bf16 v[140:143], v[168:171], a[92:95], v[140:143]
s_and_b32 s54, s3, 1
ds_read_b128 v[156:159], v7 offset:3072
v_mfma_f32_16x16x32_bf16 v[140:143], v[164:167], a[84:87], v[140:143]
s_mul_i32 s54, s54, 18432
v_mfma_f32_16x16x32_bf16 v[128:131], v[172:175], a[192:195], v[128:131]
s_waitcnt lgkmcnt(6)
s_mul_i32 s55, s86, 288
ds_read_b128 v[160:163], v7 offset:4096
v_mfma_f32_16x16x32_bf16 v[128:131], v[176:179], a[200:203], v[128:131]
s_add_u32 s54, s54, s55
v_mfma_f32_16x16x32_bf16 v[132:135], v[176:179], a[204:207], v[132:135]
s_add_u32 s54, s54, 256
ds_read_b128 v[164:167], v7 offset:5120
v_mfma_f32_16x16x32_bf16 v[132:135], v[172:175], a[196:199], v[132:135]
s_sub_u32 s55, 63, s72
v_mfma_f32_16x16x32_bf16 v[136:139], v[180:183], a[192:195], v[136:139]
s_waitcnt lgkmcnt(6)
s_mul_i32 s55, s55, 36864
ds_read_b128 v[168:171], v7 offset:6144
v_mfma_f32_16x16x32_bf16 v[136:139], v[184:187], a[200:203], v[136:139]
s_waitcnt vmcnt(1)
s_add_u32 s55, s55, s54
v_cmp_gt_u32 vcc, 4, v12
v_mfma_f32_16x16x32_bf16 v[140:143], v[184:187], a[204:207], v[140:143]
s_mul_i32 s52, s72, 36864
ds_read_b128 v[172:175], v7 offset:7168
v_mfma_f32_16x16x32_bf16 v[140:143], v[180:183], a[196:199], v[140:143]
s_waitcnt lgkmcnt(6)
s_add_u32 s54, s54, s52
v_mfma_f32_16x16x32_bf16 v[128:131], v[188:191], a[208:211], v[128:131]
s_cmp_eq_u64 vcc, 0
s_cselect_b32 s81, s69, 2147418112
s_cselect_b32 s93, s71, 2147418112
v_mfma_f32_16x16x32_bf16 v[128:131], v[144:147], a[216:219], v[128:131]
s_lshl_b32 s53, s84, 6
ds_read_b128 v[176:179], v7 offset:8192
v_mfma_f32_16x16x32_bf16 v[132:135], v[144:147], a[220:223], v[132:135]
s_sub_u32 s53, s53, 256
ds_read_b128 v[180:183], v7 offset:9216
v_mfma_f32_16x16x32_bf16 v[132:135], v[188:191], a[212:215], v[132:135]
buffer_load_dwordx4 v[192:195], v15, s[24:27], s81 offen offset:0 sc1
v_mfma_f32_16x16x32_bf16 v[136:139], v[148:151], a[208:211], v[136:139]
s_waitcnt lgkmcnt(6)
s_add_u32 s52, s54, s53
ds_read_b128 v[184:187], v7 offset:10240
v_mfma_f32_16x16x32_bf16 v[136:139], v[152:155], a[216:219], v[136:139]
s_add_u32 s53, s55, s53
v_mfma_f32_16x16x32_bf16 v[140:143], v[152:155], a[220:223], v[140:143]
buffer_load_dwordx4 v[196:199], v15, s[24:27], s81 offen offset:1024 sc1
v_mfma_f32_16x16x32_bf16 v[140:143], v[148:151], a[212:215], v[140:143]
L_PAD13:
s_cbranch_execz L_MAIN
ds_read_b128 v[188:191], v7 offset:11264
v_mfma_f32_16x16x32_bf16 v[128:131], v[156:159], a[224:227], v[128:131]
s_waitcnt lgkmcnt(6)
ds_read_b128 v[144:147], v7 offset:12288
v_mfma_f32_16x16x32_bf16 v[128:131], v[160:163], a[232:235], v[128:131]
buffer_load_dwordx4 v[200:203], v15, s[24:27], s81 offen offset:2048 sc1
v_mfma_f32_16x16x32_bf16 v[132:135], v[160:163], a[236:239], v[132:135]
ds_read_b128 v[148:151], v7 offset:13312
v_mfma_f32_16x16x32_bf16 v[132:135], v[156:159], a[228:231], v[132:135]
s_waitcnt lgkmcnt(6)
v_mfma_f32_16x16x32_bf16 v[136:139], v[164:167], a[224:227], v[136:139]
buffer_load_dwordx4 v[204:207], v15, s[24:27], s81 offen offset:3072 sc1
v_mfma_f32_16x16x32_bf16 v[136:139], v[168:171], a[232:235], v[136:139]
ds_read_b128 v[152:155], v7 offset:14336
v_mfma_f32_16x16x32_bf16 v[140:143], v[168:171], a[236:239], v[140:143]
ds_read_b128 v[156:159], v7 offset:15360
v_mfma_f32_16x16x32_bf16 v[140:143], v[164:167], a[228:231], v[140:143]
buffer_load_dwordx4 v[208:211], v15, s[24:27], s93 offen offset:0 sc1
v_mfma_f32_16x16x32_bf16 v[128:131], v[172:175], a[240:243], v[128:131]
s_waitcnt lgkmcnt(6)
s_add_u32 s91, s91, 16384
ds_read_b128 v[160:163], v8 offset:0
v_mfma_f32_16x16x32_bf16 v[128:131], v[176:179], a[248:251], v[128:131]
s_cmp_ge_u32 s91, 163840
s_cselect_b32 s91, 0, s91
v_add_u32 v7, s91, v4
v_mfma_f32_16x16x32_bf16 v[132:135], v[176:179], a[252:255], v[132:135]
buffer_load_dwordx4 v[212:215], v15, s[24:27], s93 offen offset:1024 sc1
v_mfma_f32_16x16x32_bf16 v[132:135], v[172:175], a[244:247], v[132:135]
ds_read_b128 v[164:167], v8 offset:1024
v_mfma_f32_16x16x32_bf16 v[136:139], v[180:183], a[240:243], v[136:139]
s_waitcnt lgkmcnt(6)
ds_read_b128 v[168:171], v8 offset:2048
v_mfma_f32_16x16x32_bf16 v[136:139], v[184:187], a[248:251], v[136:139]
buffer_load_dwordx4 v[216:219], v15, s[24:27], s93 offen offset:2048 sc1
v_mfma_f32_16x16x32_bf16 v[140:143], v[184:187], a[252:255], v[140:143]
ds_read_b128 v[172:175], v8 offset:3072
v_mfma_f32_16x16x32_bf16 v[140:143], v[180:183], a[244:247], v[140:143]
v_mfma_f32_16x16x32_bf16 v[128:131], v[188:191], a[96:99], v[128:131]
s_waitcnt lgkmcnt(6)
ds_read_b128 v[176:179], v8 offset:4096
v_mfma_f32_16x16x32_bf16 v[128:131], v[144:147], a[104:107], v[128:131]
v_mfma_f32_16x16x32_bf16 v[132:135], v[144:147], a[108:111], v[132:135]
ds_read_b128 v[180:183], v8 offset:5120
v_mfma_f32_16x16x32_bf16 v[132:135], v[188:191], a[100:103], v[132:135]
v_mfma_f32_16x16x32_bf16 v[136:139], v[148:151], a[96:99], v[136:139]
s_waitcnt lgkmcnt(6)
ds_read_b128 v[184:187], v8 offset:6144
v_mfma_f32_16x16x32_bf16 v[136:139], v[152:155], a[104:107], v[136:139]
v_mfma_f32_16x16x32_bf16 v[140:143], v[152:155], a[108:111], v[140:143]
ds_read_b128 v[188:191], v8 offset:7168
v_mfma_f32_16x16x32_bf16 v[140:143], v[148:151], a[100:103], v[140:143]
v_mfma_f32_16x16x32_bf16 v[128:131], v[156:159], a[112:115], v[128:131]
s_waitcnt lgkmcnt(6)
ds_read_b128 v[144:147], v8 offset:8192
v_mfma_f32_16x16x32_bf16 v[128:131], v[160:163], a[120:123], v[128:131]
v_mfma_f32_16x16x32_bf16 v[132:135], v[160:163], a[124:127], v[132:135]
ds_read_b128 v[148:151], v8 offset:9216
v_mfma_f32_16x16x32_bf16 v[132:135], v[156:159], a[116:119], v[132:135]
s_waitcnt lgkmcnt(6)
v_mfma_f32_16x16x32_bf16 v[136:139], v[164:167], a[112:115], v[136:139]
buffer_load_dword v12, v10, s[24:27], s75 offen offset:16 sc1
v_mfma_f32_16x16x32_bf16 v[136:139], v[168:171], a[120:123], v[136:139]
ds_read_b128 v[152:155], v8 offset:10240
v_mfma_f32_16x16x32_bf16 v[140:143], v[168:171], a[124:127], v[140:143]
ds_read_b128 v[156:159], v8 offset:11264
v_mfma_f32_16x16x32_bf16 v[140:143], v[164:167], a[116:119], v[140:143]
v_mfma_f32_16x16x32_bf16 v[128:131], v[172:175], a[128:131], v[128:131]
s_waitcnt lgkmcnt(6)
ds_read_b128 v[160:163], v8 offset:12288
v_mfma_f32_16x16x32_bf16 v[128:131], v[176:179], a[136:139], v[128:131]
v_mfma_f32_16x16x32_bf16 v[132:135], v[176:179], a[140:143], v[132:135]
ds_read_b128 v[164:167], v8 offset:13312
v_mfma_f32_16x16x32_bf16 v[132:135], v[172:175], a[132:135], v[132:135]
v_mfma_f32_16x16x32_bf16 v[136:139], v[180:183], a[128:131], v[136:139]
s_waitcnt lgkmcnt(6)
ds_read_b128 v[168:171], v8 offset:14336
v_mfma_f32_16x16x32_bf16 v[136:139], v[184:187], a[136:139], v[136:139]
v_mfma_f32_16x16x32_bf16 v[140:143], v[184:187], a[140:143], v[140:143]
s_waitcnt vmcnt(10)
ds_read_b128 v[172:175], v8 offset:15360
v_mfma_f32_16x16x32_bf16 v[140:143], v[180:183], a[132:135], v[140:143]
s_barrier
v_mfma_f32_16x16x32_bf16 v[128:131], v[188:191], a[144:147], v[128:131]
s_waitcnt lgkmcnt(6)
ds_read_b128 v[176:179], v7 offset:0
v_mfma_f32_16x16x32_bf16 v[128:131], v[144:147], a[152:155], v[128:131]
v_mfma_f32_16x16x32_bf16 v[132:135], v[144:147], a[156:159], v[132:135]
ds_read_b128 v[180:183], v7 offset:1024
v_mfma_f32_16x16x32_bf16 v[132:135], v[188:191], a[148:151], v[132:135]
v_mfma_f32_16x16x32_bf16 v[136:139], v[148:151], a[144:147], v[136:139]
s_waitcnt lgkmcnt(6)
ds_read_b128 v[184:187], v7 offset:2048
v_mfma_f32_16x16x32_bf16 v[136:139], v[152:155], a[152:155], v[136:139]
v_mfma_f32_16x16x32_bf16 v[140:143], v[152:155], a[156:159], v[140:143]
ds_read_b128 v[188:191], v7 offset:3072
v_mfma_f32_16x16x32_bf16 v[140:143], v[148:151], a[148:151], v[140:143]
v_mfma_f32_16x16x32_bf16 v[128:131], v[156:159], a[160:163], v[128:131]
s_waitcnt lgkmcnt(6)
ds_read_b128 v[144:147], v7 offset:4096
v_mfma_f32_16x16x32_bf16 v[128:131], v[160:163], a[168:171], v[128:131]
v_mfma_f32_16x16x32_bf16 v[132:135], v[160:163], a[172:175], v[132:135]
ds_read_b128 v[148:151], v7 offset:5120
v_mfma_f32_16x16x32_bf16 v[132:135], v[156:159], a[164:167], v[132:135]
v_mfma_f32_16x16x32_bf16 v[136:139], v[164:167], a[160:163], v[136:139]
s_waitcnt lgkmcnt(6)
ds_read_b128 v[152:155], v7 offset:6144
v_mfma_f32_16x16x32_bf16 v[136:139], v[168:171], a[168:171], v[136:139]
v_mfma_f32_16x16x32_bf16 v[140:143], v[168:171], a[172:175], v[140:143]
s_waitcnt vmcnt(0)
ds_read_b128 v[156:159], v7 offset:7168
v_cmp_gt_u32 vcc, 1, v12
v_mfma_f32_16x16x32_bf16 v[140:143], v[164:167], a[164:167], v[140:143]
v_lshlrev_b32 v72, 16, v192
v_and_b32 v73, v13, v192
v_mfma_f32_16x16x32_bf16 v[128:131], v[172:175], a[176:179], v[128:131]
s_waitcnt lgkmcnt(6)
ds_read_b128 v[160:163], v7 offset:8192
v_lshlrev_b32 v74, 16, v193
v_mfma_f32_16x16x32_bf16 v[128:131], v[176:179], a[184:187], v[128:131]
s_cmp_eq_u64 vcc, 0
s_cselect_b32 s77, s83, 2147418112
v_and_b32 v75, v13, v193
v_mfma_f32_16x16x32_bf16 v[132:135], v[176:179], a[188:191], v[132:135]
buffer_load_dwordx4 v[220:223], v15, s[24:27], s77 offen offset:0 sc1
v_mfma_f32_16x16x32_bf16 v[132:135], v[172:175], a[180:183], v[132:135]
s_waitcnt lgkmcnt(5)
ds_read_b128 v[164:167], v7 offset:9216
v_lshlrev_b32 v80, 16, v194
v_mfma_f32_16x16x32_bf16 v[136:139], v[180:183], a[176:179], v[136:139]
buffer_load_dwordx4 v[224:227], v15, s[24:27], s77 offen offset:1024 sc1
v_mfma_f32_16x16x32_bf16 v[136:139], v[184:187], a[184:187], v[136:139]
ds_read_b128 v[168:171], v7 offset:10240
v_and_b32 v81, v13, v194
v_mfma_f32_16x16x32_bf16 v[140:143], v[184:187], a[188:191], v[140:143]
ds_read_b128 v[172:175], v7 offset:11264
v_lshlrev_b32 v82, 16, v195
v_mfma_f32_16x16x32_bf16 v[140:143], v[180:183], a[180:183], v[140:143]
s_waitcnt lgkmcnt(6)
v_and_b32 v83, v13, v195
v_lshlrev_b32 v76, 16, v196
v_mfma_f32_16x16x32_bf16 v[128:131], v[188:191], v[32:35], v[128:131]
buffer_load_dword v11, v10, s[24:27], s73 offen sc1
v_mfma_f32_16x16x32_bf16 v[128:131], v[144:147], v[40:43], v[128:131]
ds_read_b128 v[176:179], v7 offset:12288
v_and_b32 v77, v13, v196
v_mfma_f32_16x16x32_bf16 v[132:135], v[144:147], v[44:47], v[132:135]
buffer_load_dword v12, v10, s[24:27], s75 offen offset:16 sc1
v_mfma_f32_16x16x32_bf16 v[132:135], v[188:191], v[36:39], v[132:135]
v_lshlrev_b32 v78, 16, v197
v_and_b32 v79, v13, v197
v_mfma_f32_16x16x32_bf16 v[136:139], v[148:151], v[32:35], v[136:139]
s_waitcnt lgkmcnt(5)
v_lshlrev_b32 v84, 16, v198
v_and_b32 v85, v13, v198
v_mfma_f32_16x16x32_bf16 v[136:139], v[152:155], v[40:43], v[136:139]
v_lshlrev_b32 v86, 16, v199
v_and_b32 v87, v13, v199
v_mfma_f32_16x16x32_bf16 v[140:143], v[152:155], v[44:47], v[140:143]
v_lshlrev_b32 v88, 16, v200
v_and_b32 v89, v13, v200
v_mfma_f32_16x16x32_bf16 v[140:143], v[148:151], v[36:39], v[140:143]
v_lshlrev_b32 v90, 16, v201
v_and_b32 v91, v13, v201
v_mfma_f32_16x16x32_bf16 v[128:131], v[156:159], v[48:51], v[128:131]
s_waitcnt lgkmcnt(3)
v_lshlrev_b32 v96, 16, v202
v_and_b32 v97, v13, v202
v_mfma_f32_16x16x32_bf16 v[128:131], v[160:163], v[56:59], v[128:131]
v_lshlrev_b32 v98, 16, v203
v_and_b32 v99, v13, v203
v_mfma_f32_16x16x32_bf16 v[132:135], v[160:163], v[60:63], v[132:135]
v_lshlrev_b32 v92, 16, v204
v_and_b32 v93, v13, v204
v_mfma_f32_16x16x32_bf16 v[132:135], v[156:159], v[52:55], v[132:135]
v_lshlrev_b32 v94, 16, v205
v_and_b32 v95, v13, v205
v_mfma_f32_16x16x32_bf16 v[136:139], v[164:167], v[48:51], v[136:139]
s_waitcnt lgkmcnt(1)
v_lshlrev_b32 v100, 16, v206
v_and_b32 v101, v13, v206
v_mfma_f32_16x16x32_bf16 v[136:139], v[168:171], v[56:59], v[136:139]
v_lshlrev_b32 v102, 16, v207
v_and_b32 v103, v13, v207
v_mfma_f32_16x16x32_bf16 v[140:143], v[168:171], v[60:63], v[140:143]
v_mfma_f32_16x16x32_bf16 v[140:143], v[164:167], v[52:55], v[140:143]
v_mfma_f32_16x16x32_bf16 v[128:131], v[172:175], v[64:67], v[128:131]
v_mfma_f32_16x16x32_bf16 v[132:135], v[172:175], v[68:71], v[132:135]
s_waitcnt lgkmcnt(0)
v_mfma_f32_16x16x32_bf16 v[136:139], v[176:179], v[64:67], v[136:139]
v_mfma_f32_16x16x32_bf16 v[140:143], v[176:179], v[68:71], v[140:143]
s_max_u32 s92, s81, s77
s_cmp_lt_u32 s92, 2147418112
s_cbranch_scc1 L_P1
s_mov_b32 s92, 0
s_branch L_S1
L_S0:
buffer_load_dword v11, v10, s[24:27], s73 offen sc1
buffer_load_dword v12, v10, s[24:27], s75 offen offset:16 sc1
L_S1:
s_add_u32 s92, s92, 1
s_waitcnt vmcnt(0)
v_lshrrev_b32 v11, 2, v11
v_min_u32 v11, v11, v12
v_cmp_gt_u32 vcc, 1, v11
s_cmp_gt_u32 s92, 1048576
s_cbranch_scc1 L_S2
s_nop 2
s_cbranch_vccnz L_S0
L_S2:
buffer_load_dwordx4 v[220:223], v15, s[24:27], s83 offen offset:0 sc1
buffer_load_dwordx4 v[224:227], v15, s[24:27], s83 offen offset:1024 sc1
s_cmp_eq_u32 s81, s69
s_cbranch_scc1 L_P1
buffer_load_dwordx4 v[192:195], v15, s[24:27], s69 offen offset:0 sc1
buffer_load_dwordx4 v[196:199], v15, s[24:27], s69 offen offset:1024 sc1
buffer_load_dwordx4 v[200:203], v15, s[24:27], s69 offen offset:2048 sc1
buffer_load_dwordx4 v[204:207], v15, s[24:27], s69 offen offset:3072 sc1
buffer_load_dwordx4 v[208:211], v15, s[24:27], s71 offen offset:0 sc1
buffer_load_dwordx4 v[212:215], v15, s[24:27], s71 offen offset:1024 sc1
buffer_load_dwordx4 v[216:219], v15, s[24:27], s71 offen offset:2048 sc1
s_waitcnt vmcnt(3)
v_lshlrev_b32 v72, 16, v192
v_and_b32 v73, v13, v192
v_lshlrev_b32 v74, 16, v193
v_and_b32 v75, v13, v193
v_lshlrev_b32 v80, 16, v194
v_and_b32 v81, v13, v194
v_lshlrev_b32 v82, 16, v195
v_and_b32 v83, v13, v195
v_lshlrev_b32 v76, 16, v196
v_and_b32 v77, v13, v196
v_lshlrev_b32 v78, 16, v197
v_and_b32 v79, v13, v197
v_lshlrev_b32 v84, 16, v198
v_and_b32 v85, v13, v198
v_lshlrev_b32 v86, 16, v199
v_and_b32 v87, v13, v199
v_lshlrev_b32 v88, 16, v200
v_and_b32 v89, v13, v200
v_lshlrev_b32 v90, 16, v201
v_and_b32 v91, v13, v201
v_lshlrev_b32 v96, 16, v202
v_and_b32 v97, v13, v202
v_lshlrev_b32 v98, 16, v203
v_and_b32 v99, v13, v203
v_lshlrev_b32 v92, 16, v204
v_and_b32 v93, v13, v204
v_lshlrev_b32 v94, 16, v205
v_and_b32 v95, v13, v205
v_lshlrev_b32 v100, 16, v206
v_and_b32 v101, v13, v206
v_lshlrev_b32 v102, 16, v207
v_and_b32 v103, v13, v207
s_waitcnt vmcnt(0)
L_P1:
s_nop 1
v_pk_add_f32 v[72:73], v[72:73], v[88:89]
v_pk_add_f32 v[74:75], v[74:75], v[90:91]
v_pk_add_f32 v[76:77], v[76:77], v[92:93]
v_pk_add_f32 v[78:79], v[78:79], v[94:95]
v_pk_add_f32 v[80:81], v[80:81], v[96:97]
v_pk_add_f32 v[82:83], v[82:83], v[98:99]
v_pk_add_f32 v[84:85], v[84:85], v[100:101]
v_pk_add_f32 v[86:87], v[86:87], v[102:103]
v_pk_add_f32 v[128:129], v[128:129], v[72:73]
v_pk_add_f32 v[130:131], v[130:131], v[74:75]
v_pk_add_f32 v[132:133], v[132:133], v[76:77]
v_pk_add_f32 v[134:135], v[134:135], v[78:79]
v_pk_add_f32 v[136:137], v[136:137], v[80:81]
v_pk_add_f32 v[138:139], v[138:139], v[82:83]
v_pk_add_f32 v[140:141], v[140:141], v[84:85]
v_pk_add_f32 v[142:143], v[142:143], v[86:87]
s_cmp_lg_u32 s3, s84
s_cbranch_scc1 L_NO9
v_lshlrev_b32 v16, 16, v208
v_and_b32 v17, v13, v208
v_lshlrev_b32 v18, 16, v209
v_and_b32 v19, v13, v209
v_lshlrev_b32 v20, 16, v210
v_and_b32 v21, v13, v210
v_lshlrev_b32 v22, 16, v211
v_and_b32 v23, v13, v211
v_pk_add_f32 v[120:121], v[120:121], v[16:17]
v_pk_add_f32 v[122:123], v[122:123], v[18:19]
v_pk_add_f32 v[124:125], v[124:125], v[20:21]
v_pk_add_f32 v[126:127], v[126:127], v[22:23]
v_lshlrev_b32 v16, 16, v212
v_and_b32 v17, v13, v212
v_lshlrev_b32 v18, 16, v213
v_and_b32 v19, v13, v213
v_lshlrev_b32 v20, 16, v214
v_and_b32 v21, v13, v214
v_lshlrev_b32 v22, 16, v215
v_and_b32 v23, v13, v215
v_pk_add_f32 v[120:121], v[120:121], v[16:17]
v_pk_add_f32 v[122:123], v[122:123], v[18:19]
v_pk_add_f32 v[124:125], v[124:125], v[20:21]
v_pk_add_f32 v[126:127], v[126:127], v[22:23]
v_lshlrev_b32 v16, 16, v216
v_and_b32 v17, v13, v216
v_lshlrev_b32 v18, 16, v217
v_and_b32 v19, v13, v217
v_lshlrev_b32 v20, 16, v218
v_and_b32 v21, v13, v218
v_lshlrev_b32 v22, 16, v219
v_and_b32 v23, v13, v219
v_pk_add_f32 v[120:121], v[120:121], v[16:17]
v_pk_add_f32 v[122:123], v[122:123], v[18:19]
v_pk_add_f32 v[124:125], v[124:125], v[20:21]
v_pk_add_f32 v[126:127], v[126:127], v[22:23]
v_cvt_pk_bf16_f32 v228, v120, v121
v_cvt_pk_bf16_f32 v229, v122, v123
v_cvt_pk_bf16_f32 v230, v124, v125
v_cvt_pk_bf16_f32 v231, v126, v127
s_waitcnt vmcnt(0)
buffer_store_dwordx2 v[228:229], v6, s[44:47], s54 offen sc1
buffer_store_dwordx2 v[230:231], v6, s[44:47], s55 offen sc1
s_branch L_9D
L_NO9:
s_waitcnt vmcnt(0)
L_9D:
v_lshlrev_b32 v16, 16, v220
v_and_b32 v17, v13, v220
v_lshlrev_b32 v18, 16, v221
v_and_b32 v19, v13, v221
v_lshlrev_b32 v20, 16, v222
v_and_b32 v21, v13, v222
v_lshlrev_b32 v22, 16, v223
v_and_b32 v23, v13, v223
v_pk_add_f32 v[128:129], v[128:129], v[16:17]
v_pk_add_f32 v[130:131], v[130:131], v[18:19]
v_pk_add_f32 v[136:137], v[136:137], v[20:21]
v_pk_add_f32 v[138:139], v[138:139], v[22:23]
v_cvt_pk_bf16_f32 v128, v128, v129
v_cvt_pk_bf16_f32 v129, v130, v131
v_cvt_pk_bf16_f32 v130, v136, v137
v_cvt_pk_bf16_f32 v131, v138, v139
s_nop 1
v_permlane16_swap_b32 v128, v130
v_permlane16_swap_b32 v129, v131
buffer_store_dwordx4 v[128:131], v5, s[44:47], s52 offen sc1
v_lshlrev_b32 v16, 16, v224
v_and_b32 v17, v13, v224
v_lshlrev_b32 v18, 16, v225
v_and_b32 v19, v13, v225
v_lshlrev_b32 v20, 16, v226
v_and_b32 v21, v13, v226
v_lshlrev_b32 v22, 16, v227
v_and_b32 v23, v13, v227
v_pk_add_f32 v[132:133], v[132:133], v[16:17]
v_pk_add_f32 v[134:135], v[134:135], v[18:19]
v_pk_add_f32 v[140:141], v[140:141], v[20:21]
v_pk_add_f32 v[142:143], v[142:143], v[22:23]
v_cvt_pk_bf16_f32 v132, v132, v133
v_cvt_pk_bf16_f32 v133, v134, v135
v_cvt_pk_bf16_f32 v134, v140, v141
v_cvt_pk_bf16_f32 v135, v142, v143
s_nop 1
v_permlane16_swap_b32 v132, v134
v_permlane16_swap_b32 v133, v135
buffer_store_dwordx4 v[132:135], v5, s[44:47], s53 offen sc1
L_END:
s_endpgm
L_SE2:
v_accvgpr_read_b32 v180, a224
v_accvgpr_read_b32 v182, a228
v_cmp_nle_f32 vcc, v180, v7
v_cmp_nle_f32 s[96:97], v182, v7
s_nop 3
s_or_b64 vcc, vcc, s[96:97]
s_cbranch_vccnz SLOW0
SLOW0_R:
s_add_u32 s53, s77, 180224
buffer_load_dwordx4 a[112:115], v15, s[24:27], s53 offen offset:0 sc1
v_mul_f32 v8, 0x3fb8aa3b, v8
v_mul_f32 v9, 0x3fb8aa3b, v9
v_exp_f32 v8, v8
v_exp_f32 v9, v9
s_nop 0
v_fma_f32 v180, v180, v8, v180
v_fma_f32 v182, v182, v9, v182
v_rcp_f32 v180, v180
v_rcp_f32 v182, v182
s_add_u32 s52, s78, 4096
v_mov_b32 v181, v180
v_mov_b32 v183, v182
v_pk_mul_f32 v[36:37], v[36:37], v[180:181]
v_pk_mul_f32 v[38:39], v[38:39], v[180:181]
v_pk_mul_f32 v[32:33], v[32:33], v[180:181]
v_pk_mul_f32 v[34:35], v[34:35], v[180:181]
v_cvt_pk_bf16_f32 v36, v36, v37
v_cvt_pk_bf16_f32 v37, v38, v39
v_cvt_pk_bf16_f32 v38, v32, v33
v_cvt_pk_bf16_f32 v39, v34, v35
buffer_store_dwordx4 v[36:39], v15, s[24:27], s78 offen offset:0 sc1
buffer_load_dwordx4 a[116:119], v15, s[24:27], s53 offen offset:1024 sc1
v_pk_mul_f32 v[116:117], v[116:117], v[182:183]
v_pk_mul_f32 v[118:119], v[118:119], v[182:183]
v_pk_mul_f32 v[132:133], v[132:133], v[182:183]
v_pk_mul_f32 v[134:135], v[134:135], v[182:183]
v_cvt_pk_bf16_f32 v116, v116, v117
v_cvt_pk_bf16_f32 v117, v118, v119
v_cvt_pk_bf16_f32 v118, v132, v133
v_cvt_pk_bf16_f32 v119, v134, v135
buffer_store_dwordx4 v[116:119], v15, s[24:27], s78 offen offset:1024 sc1
v_pk_mul_f32 v[196:197], v[196:197], v[180:181]
v_pk_mul_f32 v[198:199], v[198:199], v[180:181]
v_pk_mul_f32 v[204:205], v[204:205], v[180:181]
v_pk_mul_f32 v[206:207], v[206:207], v[180:181]
v_cvt_pk_bf16_f32 v196, v196, v197
v_cvt_pk_bf16_f32 v197, v198, v199
v_cvt_pk_bf16_f32 v198, v204, v205
v_cvt_pk_bf16_f32 v199, v206, v207
buffer_store_dwordx4 v[196:199], v15, s[24:27], s78 offen offset:2048 sc1
v_pk_mul_f32 v[184:185], v[184:185], v[182:183]
v_pk_mul_f32 v[186:187], v[186:187], v[182:183]
v_pk_mul_f32 v[240:241], v[240:241], v[182:183]
buffer_load_dwordx4 a[120:123], v15, s[24:27], s53 offen offset:2048 sc1
v_pk_mul_f32 v[242:243], v[242:243], v[182:183]
v_cvt_pk_bf16_f32 v184, v184, v185
v_cvt_pk_bf16_f32 v185, v186, v187
v_cvt_pk_bf16_f32 v186, v240, v241
v_cvt_pk_bf16_f32 v187, v242, v243
buffer_store_dwordx4 v[184:187], v15, s[24:27], s78 offen offset:3072 sc1
v_pk_mul_f32 v[108:109], v[108:109], v[180:181]
v_pk_mul_f32 v[110:111], v[110:111], v[180:181]
v_pk_mul_f32 v[40:41], v[40:41], v[180:181]
v_pk_mul_f32 v[42:43], v[42:43], v[180:181]
v_cvt_pk_bf16_f32 v108, v108, v109
v_cvt_pk_bf16_f32 v109, v110, v111
v_cvt_pk_bf16_f32 v110, v40, v41
v_cvt_pk_bf16_f32 v111, v42, v43
buffer_store_dwordx4 v[108:111], v15, s[24:27], s52 offen offset:0 sc1
v_pk_mul_f32 v[188:189], v[188:189], v[182:183]
v_pk_mul_f32 v[190:191], v[190:191], v[182:183]
v_pk_mul_f32 v[56:57], v[56:57], v[182:183]
v_pk_mul_f32 v[58:59], v[58:59], v[182:183]
v_cvt_pk_bf16_f32 v188, v188, v189
v_cvt_pk_bf16_f32 v189, v190, v191
buffer_load_dwordx4 a[124:127], v15, s[24:27], s53 offen offset:3072 sc1
v_cvt_pk_bf16_f32 v190, v56, v57
v_cvt_pk_bf16_f32 v191, v58, v59
buffer_store_dwordx4 v[188:191], v15, s[24:27], s52 offen offset:1024 sc1
v_pk_mul_f32 v[80:81], v[80:81], v[180:181]
v_pk_mul_f32 v[82:83], v[82:83], v[180:181]
v_pk_mul_f32 v[168:169], v[168:169], v[180:181]
v_pk_mul_f32 v[170:171], v[170:171], v[180:181]
v_cvt_pk_bf16_f32 v80, v80, v81
v_cvt_pk_bf16_f32 v81, v82, v83
v_cvt_pk_bf16_f32 v82, v168, v169
v_cvt_pk_bf16_f32 v83, v170, v171
buffer_store_dwordx4 v[80:83], v15, s[24:27], s52 offen offset:2048 sc1
v_pk_mul_f32 v[88:89], v[88:89], v[182:183]
v_pk_mul_f32 v[90:91], v[90:91], v[182:183]
v_pk_mul_f32 v[192:193], v[192:193], v[182:183]
v_pk_mul_f32 v[194:195], v[194:195], v[182:183]
v_cvt_pk_bf16_f32 v88, v88, v89
v_cvt_pk_bf16_f32 v89, v90, v91
v_cvt_pk_bf16_f32 v90, v192, v193
v_cvt_pk_bf16_f32 v91, v194, v195
buffer_store_dwordx4 v[88:91], v15, s[24:27], s52 offen offset:3072 sc1
s_branch L_LA
CK_Z:
s_mov_b32 s92, 0
CK_Z_L:
s_sleep 1
buffer_load_dword v23, v22, s[40:43], 0 offen sc1
s_add_u32 s92, s92, 1
s_waitcnt vmcnt(0)
v_cmp_gt_u32 vcc, 1, v23
s_cmp_gt_u32 s92, 1048576
s_cbranch_scc1 CK_Z_R
s_nop 3
s_cbranch_vccnz CK_Z_L
s_branch CK_Z_R
CK_WA:
s_mov_b32 s92, 0
CK_WA_L:
s_sleep 1
buffer_load_dword v30, v29, s[24:27], s89 offen sc1
s_add_u32 s92, s92, 1
s_waitcnt vmcnt(0)
v_cmp_gt_u32 vcc, 18, v30
s_cmp_gt_u32 s92, 1048576
s_cbranch_scc1 CK_WA_R
s_nop 3
s_cbranch_vccnz CK_WA_L
s_branch CK_WA_R
CK_ZA:
s_mov_b32 s92, 0
CK_ZA_L:
s_sleep 1
buffer_load_dword v30, v28, s[40:43], 0 offen sc1
s_add_u32 s92, s92, 1
s_waitcnt vmcnt(0)
v_cmp_gt_u32 vcc, 1, v30
s_cmp_gt_u32 s92, 1048576
s_cbranch_scc1 CK_ZA_R
s_nop 3
s_cbranch_vccnz CK_ZA_L
s_branch CK_ZA_R
CK_KV:
s_mov_b32 s92, 0
CK_KV_L:
s_sleep 1
buffer_load_dword v30, v29, s[24:27], s89 offen offset:4 sc1
s_add_u32 s92, s92, 1
s_waitcnt vmcnt(0)
v_cmp_gt_u32 vcc, 8, v30
s_cmp_gt_u32 s92, 1048576
s_cbranch_scc1 CK_KV_R
s_nop 3
s_cbranch_vccnz CK_KV_L
s_branch CK_KV_R
D0:
v_cndmask_b32 v96, v96, v6, s[56:57]
v_cndmask_b32 v120, v120, v6, s[56:57]
v_mov_b32 v112, v6
v_cndmask_b32 v97, v97, v6, s[58:59]
v_cndmask_b32 v121, v121, v6, s[58:59]
v_mov_b32 v113, v6
v_cndmask_b32 v98, v98, v6, s[60:61]
v_cndmask_b32 v122, v122, v6, s[60:61]
v_mov_b32 v114, v6
v_cndmask_b32 v99, v99, v6, s[62:63]
v_cndmask_b32 v123, v123, v6, s[62:63]
v_mov_b32 v115, v6
s_branch D0_R
CK_Q:
s_mov_b32 s92, 0
CK_Q_L:
s_sleep 1
buffer_load_dword v172, v173, s[24:27], 0 offen sc1
s_add_u32 s92, s92, 1
s_waitcnt vmcnt(0)
v_cmp_gt_u32 vcc, 32, v172
s_cmp_gt_u32 s92, 1048576
s_cbranch_scc1 CK_Q_R
s_nop 3
s_cbranch_vccnz CK_Q_L
s_branch CK_Q_R
CK_ZAA:
s_mov_b32 s92, 0
CK_ZAA_L:
s_sleep 1
buffer_load_dword v12, v10, s[24:27], s75 offen offset:4 sc1
s_add_u32 s92, s92, 1
s_waitcnt vmcnt(0)
v_cmp_gt_u32 vcc, 8, v12
s_cmp_gt_u32 s92, 1048576
s_cbranch_scc1 CK_ZAA_R
s_nop 3
s_cbranch_vccnz CK_ZAA_L
s_branch CK_ZAA_R
SLOW0:
v_add_u32 v20, 4096, v15
s_mov_b32 s54, 0
v_mov_b32 v16, v6
v_mov_b32 v18, v6
SLOW0_P:
s_mov_b32 s53, 0
s_mov_b32 s52, s94
SLOW0_T:
s_add_u32 s55, s52, 24576
buffer_load_dwordx4 a[192:195], v15, s[24:27], s52 offen offset:0 sc1
buffer_load_dwordx4 a[196:199], v15, s[24:27], s52 offen offset:1024 sc1
buffer_load_dwordx4 a[200:203], v15, s[24:27], s52 offen offset:2048 sc1
buffer_load_dwordx4 a[204:207], v15, s[24:27], s52 offen offset:3072 sc1
buffer_load_dwordx4 a[208:211], v20, s[24:27], s52 offen offset:0 sc1
buffer_load_dwordx4 a[212:215], v20, s[24:27], s52 offen offset:1024 sc1
buffer_load_dwordx4 a[216:219], v20, s[24:27], s52 offen offset:2048 sc1
buffer_load_dwordx4 a[220:223], v20, s[24:27], s52 offen offset:3072 sc1
buffer_load_dwordx4 a[64:67], v15, s[24:27], s55 offen offset:0 sc1
buffer_load_dwordx4 a[68:71], v15, s[24:27], s55 offen offset:1024 sc1
buffer_load_dwordx4 a[72:75], v15, s[24:27], s55 offen offset:2048 sc1
buffer_load_dwordx4 a[76:79], v15, s[24:27], s55 offen offset:3072 sc1
buffer_load_dwordx4 a[80:83], v20, s[24:27], s55 offen offset:0 sc1
buffer_load_dwordx4 a[84:87], v20, s[24:27], s55 offen offset:1024 sc1
buffer_load_dwordx4 a[88:91], v20, s[24:27], s55 offen offset:2048 sc1
buffer_load_dwordx4 a[92:95], v20, s[24:27], s55 offen offset:3072 sc1
s_waitcnt vmcnt(0)
v_mfma_f32_16x16x32_bf16 v[44:47], a[192:195], a[32:35], 0
v_mfma_f32_16x16x32_bf16 v[44:47], a[196:199], a[36:39], v[44:47]
v_mfma_f32_16x16x32_bf16 v[44:47], a[200:203], a[28:31], v[44:47]
v_mfma_f32_16x16x32_bf16 v[44:47], a[204:207], a[20:23], v[44:47]
v_mfma_f32_16x16x32_bf16 v[52:55], a[192:195], a[44:47], 0
v_mfma_f32_16x16x32_bf16 v[52:55], a[196:199], a[40:43], v[52:55]
v_mfma_f32_16x16x32_bf16 v[52:55], a[200:203], a[12:15], v[52:55]
v_mfma_f32_16x16x32_bf16 v[52:55], a[204:207], a[4:7], v[52:55]
v_mfma_f32_16x16x32_bf16 v[64:67], a[208:211], a[32:35], 0
v_mfma_f32_16x16x32_bf16 v[64:67], a[212:215], a[36:39], v[64:67]
v_mfma_f32_16x16x32_bf16 v[64:67], a[216:219], a[28:31], v[64:67]
v_mfma_f32_16x16x32_bf16 v[64:67], a[220:223], a[20:23], v[64:67]
v_mfma_f32_16x16x32_bf16 v[212:215], a[208:211], a[44:47], 0
v_mfma_f32_16x16x32_bf16 v[212:215], a[212:215], a[40:43], v[212:215]
v_mfma_f32_16x16x32_bf16 v[212:215], a[216:219], a[12:15], v[212:215]
v_mfma_f32_16x16x32_bf16 v[212:215], a[220:223], a[4:7], v[212:215]
s_nop 7
s_cmp_lg_u32 s53, s66
s_cbranch_scc1 SLOW0_U
v_cndmask_b32 v44, v44, v6, s[56:57]
v_cndmask_b32 v212, v212, v6, s[56:57]
v_mov_b32 v64, v6
v_cndmask_b32 v45, v45, v6, s[58:59]
v_cndmask_b32 v213, v213, v6, s[58:59]
v_mov_b32 v65, v6
v_cndmask_b32 v46, v46, v6, s[60:61]
v_cndmask_b32 v214, v214, v6, s[60:61]
v_mov_b32 v66, v6
v_cndmask_b32 v47, v47, v6, s[62:63]
v_cndmask_b32 v215, v215, v6, s[62:63]
v_mov_b32 v67, v6
SLOW0_U:
s_cmp_lg_u32 s54, 0
s_cbranch_scc1 SLOW0_A
v_max3_f32 v16, v16, v44, v45
v_max3_f32 v16, v16, v46, v47
v_max3_f32 v18, v18, v52, v53
v_max3_f32 v18, v18, v54, v55
v_max3_f32 v16, v16, v64, v65
v_max3_f32 v16, v16, v66, v67
v_max3_f32 v18, v18, v212, v213
v_max3_f32 v18, v18, v214, v215
s_branch SLOW0_N
SLOW0_A:
v_sub_f32 v44, v44, v16
v_sub_f32 v45, v45, v16
v_sub_f32 v46, v46, v16
v_sub_f32 v47, v47, v16
v_sub_f32 v52, v52, v18
v_sub_f32 v53, v53, v18
v_sub_f32 v54, v54, v18
v_sub_f32 v55, v55, v18
v_sub_f32 v64, v64, v16
v_sub_f32 v65, v65, v16
v_sub_f32 v66, v66, v16
v_sub_f32 v67, v67, v16
v_sub_f32 v212, v212, v18
v_sub_f32 v213, v213, v18
v_sub_f32 v214, v214, v18
v_sub_f32 v215, v215, v18
v_exp_f32 v44, v44
v_exp_f32 v45, v45
v_exp_f32 v46, v46
v_exp_f32 v47, v47
v_exp_f32 v52, v52
v_exp_f32 v53, v53
v_exp_f32 v54, v54
v_exp_f32 v55, v55
v_exp_f32 v64, v64
v_exp_f32 v65, v65
v_exp_f32 v66, v66
v_exp_f32 v67, v67
v_exp_f32 v212, v212
v_exp_f32 v213, v213
v_exp_f32 v214, v214
v_exp_f32 v215, v215
s_nop 0
v_cvt_pk_bf16_f32 v124, v44, v45
v_cvt_pk_bf16_f32 v125, v46, v47
v_cvt_pk_bf16_f32 v140, v52, v53
v_cvt_pk_bf16_f32 v141, v54, v55
v_cvt_pk_bf16_f32 v126, v64, v65
v_cvt_pk_bf16_f32 v127, v66, v67
v_cvt_pk_bf16_f32 v142, v212, v213
v_cvt_pk_bf16_f32 v143, v214, v215
s_nop 1
v_mfma_f32_16x16x32_bf16 v[36:39], a[64:67], v[124:127], v[36:39]
v_mfma_f32_16x16x32_bf16 v[116:119], a[64:67], v[140:143], v[116:119]
v_mfma_f32_16x16x32_bf16 v[132:135], a[68:71], v[140:143], v[132:135]
v_mfma_f32_16x16x32_bf16 v[32:35], a[68:71], v[124:127], v[32:35]
v_mfma_f32_16x16x32_bf16 v[196:199], a[72:75], v[124:127], v[196:199]
v_mfma_f32_16x16x32_bf16 v[184:187], a[72:75], v[140:143], v[184:187]
v_mfma_f32_16x16x32_bf16 v[240:243], a[76:79], v[140:143], v[240:243]
v_mfma_f32_16x16x32_bf16 v[204:207], a[76:79], v[124:127], v[204:207]
v_mfma_f32_16x16x32_bf16 v[108:111], a[80:83], v[124:127], v[108:111]
v_mfma_f32_16x16x32_bf16 v[188:191], a[80:83], v[140:143], v[188:191]
v_mfma_f32_16x16x32_bf16 v[56:59], a[84:87], v[140:143], v[56:59]
v_mfma_f32_16x16x32_bf16 v[40:43], a[84:87], v[124:127], v[40:43]
v_mfma_f32_16x16x32_bf16 v[80:83], a[88:91], v[124:127], v[80:83]
v_mfma_f32_16x16x32_bf16 v[88:91], a[88:91], v[140:143], v[88:91]
v_mfma_f32_16x16x32_bf16 v[192:195], a[92:95], v[140:143], v[192:195]
v_mfma_f32_16x16x32_bf16 v[168:171], a[92:95], v[124:127], v[168:171]
v_mfma_f32_16x16x32_bf16 a[224:227], a[240:243], v[124:127], a[224:227]
v_mfma_f32_16x16x32_bf16 a[228:231], a[240:243], v[140:143], a[228:231]
SLOW0_N:
s_add_u32 s52, s52, 16384
s_add_u32 s53, s53, 1
s_cmp_le_u32 s53, s66
s_cbranch_scc1 SLOW0_T
s_cmp_lg_u32 s54, 0
s_cbranch_scc1 SLOW0_E
v_mov_b32 v17, v16
v_mov_b32 v19, v18
s_nop 1
v_permlane32_swap_b32 v17, v16
v_permlane32_swap_b32 v19, v18
s_nop 1
v_max_f32 v16, v16, v17
v_max_f32 v18, v18, v19
v_mov_b32 v17, v16
v_mov_b32 v19, v18
s_nop 1
v_permlane16_swap_b32 v17, v16
v_permlane16_swap_b32 v19, v18
s_nop 1
v_max_f32 v16, v16, v17
v_max_f32 v18, v18, v19
v_mov_b32 v36, 0
v_mov_b32 v37, 0
v_mov_b32 v38, 0
v_mov_b32 v39, 0
v_mov_b32 v32, 0
v_mov_b32 v33, 0
v_mov_b32 v34, 0
v_mov_b32 v35, 0
v_mov_b32 v196, 0
v_mov_b32 v197, 0
v_mov_b32 v198, 0
v_mov_b32 v199, 0
v_mov_b32 v204, 0
v_mov_b32 v205, 0
v_mov_b32 v206, 0
v_mov_b32 v207, 0
v_mov_b32 v108, 0
v_mov_b32 v109, 0
v_mov_b32 v110, 0
v_mov_b32 v111, 0
v_mov_b32 v40, 0
v_mov_b32 v41, 0
v_mov_b32 v42, 0
v_mov_b32 v43, 0
v_mov_b32 v80, 0
v_mov_b32 v81, 0
v_mov_b32 v82, 0
v_mov_b32 v83, 0
v_mov_b32 v168, 0
v_mov_b32 v169, 0
v_mov_b32 v170, 0
v_mov_b32 v171, 0
v_mov_b32 v116, 0
v_mov_b32 v117, 0
v_mov_b32 v118, 0
v_mov_b32 v119, 0
v_mov_b32 v132, 0
v_mov_b32 v133, 0
v_mov_b32 v134, 0
v_mov_b32 v135, 0
v_mov_b32 v184, 0
v_mov_b32 v185, 0
v_mov_b32 v186, 0
v_mov_b32 v187, 0
v_mov_b32 v240, 0
v_mov_b32 v241, 0
v_mov_b32 v242, 0
v_mov_b32 v243, 0
v_mov_b32 v188, 0
v_mov_b32 v189, 0
v_mov_b32 v190, 0
v_mov_b32 v191, 0
v_mov_b32 v56, 0
v_mov_b32 v57, 0
v_mov_b32 v58, 0
v_mov_b32 v59, 0
v_mov_b32 v88, 0
v_mov_b32 v89, 0
v_mov_b32 v90, 0
v_mov_b32 v91, 0
v_mov_b32 v192, 0
v_mov_b32 v193, 0
v_mov_b32 v194, 0
v_mov_b32 v195, 0
v_accvgpr_write_b32 a224, 0
v_accvgpr_write_b32 a225, 0
v_accvgpr_write_b32 a226, 0
v_accvgpr_write_b32 a227, 0
v_accvgpr_write_b32 a228, 0
v_accvgpr_write_b32 a229, 0
v_accvgpr_write_b32 a230, 0
v_accvgpr_write_b32 a231, 0
s_mov_b32 s54, 1
s_branch SLOW0_P
SLOW0_E:
s_nop 7
v_accvgpr_read_b32 v180, a224
v_accvgpr_read_b32 v182, a228
s_branch SLOW0_R
SLOW1:
v_add_u32 v20, 4096, v15
s_mov_b32 s54, 0
v_mov_b32 v16, v6
v_mov_b32 v18, v6
SLOW1_P:
s_mov_b32 s53, 0
s_mov_b32 s52, s94
SLOW1_T:
s_add_u32 s55, s52, 24576
buffer_load_dwordx4 a[192:195], v15, s[24:27], s52 offen offset:0 sc1
buffer_load_dwordx4 a[196:199], v15, s[24:27], s52 offen offset:1024 sc1
buffer_load_dwordx4 a[200:203], v15, s[24:27], s52 offen offset:2048 sc1
buffer_load_dwordx4 a[204:207], v15, s[24:27], s52 offen offset:3072 sc1
buffer_load_dwordx4 a[208:211], v20, s[24:27], s52 offen offset:0 sc1
buffer_load_dwordx4 a[212:215], v20, s[24:27], s52 offen offset:1024 sc1
buffer_load_dwordx4 a[216:219], v20, s[24:27], s52 offen offset:2048 sc1
buffer_load_dwordx4 a[220:223], v20, s[24:27], s52 offen offset:3072 sc1
buffer_load_dwordx4 a[64:67], v15, s[24:27], s55 offen offset:0 sc1
buffer_load_dwordx4 a[68:71], v15, s[24:27], s55 offen offset:1024 sc1
buffer_load_dwordx4 a[72:75], v15, s[24:27], s55 offen offset:2048 sc1
buffer_load_dwordx4 a[76:79], v15, s[24:27], s55 offen offset:3072 sc1
buffer_load_dwordx4 a[80:83], v20, s[24:27], s55 offen offset:0 sc1
buffer_load_dwordx4 a[84:87], v20, s[24:27], s55 offen offset:1024 sc1
buffer_load_dwordx4 a[88:91], v20, s[24:27], s55 offen offset:2048 sc1
buffer_load_dwordx4 a[92:95], v20, s[24:27], s55 offen offset:3072 sc1
s_waitcnt vmcnt(0)
v_mfma_f32_16x16x32_bf16 v[44:47], a[192:195], a[48:51], 0
v_mfma_f32_16x16x32_bf16 v[44:47], a[196:199], a[52:55], v[44:47]
v_mfma_f32_16x16x32_bf16 v[44:47], a[200:203], a[0:3], v[44:47]
v_mfma_f32_16x16x32_bf16 v[44:47], a[204:207], a[8:11], v[44:47]
v_mfma_f32_16x16x32_bf16 v[52:55], a[192:195], a[60:63], 0
v_mfma_f32_16x16x32_bf16 v[52:55], a[196:199], a[56:59], v[52:55]
v_mfma_f32_16x16x32_bf16 v[52:55], a[200:203], a[16:19], v[52:55]
v_mfma_f32_16x16x32_bf16 v[52:55], a[204:207], a[24:27], v[52:55]
v_mfma_f32_16x16x32_bf16 v[64:67], a[208:211], a[48:51], 0
v_mfma_f32_16x16x32_bf16 v[64:67], a[212:215], a[52:55], v[64:67]
v_mfma_f32_16x16x32_bf16 v[64:67], a[216:219], a[0:3], v[64:67]
v_mfma_f32_16x16x32_bf16 v[64:67], a[220:223], a[8:11], v[64:67]
v_mfma_f32_16x16x32_bf16 v[212:215], a[208:211], a[60:63], 0
v_mfma_f32_16x16x32_bf16 v[212:215], a[212:215], a[56:59], v[212:215]
v_mfma_f32_16x16x32_bf16 v[212:215], a[216:219], a[16:19], v[212:215]
v_mfma_f32_16x16x32_bf16 v[212:215], a[220:223], a[24:27], v[212:215]
s_nop 7
s_cmp_lg_u32 s53, s67
s_cbranch_scc1 SLOW1_U
v_cndmask_b32 v44, v44, v6, s[56:57]
v_cndmask_b32 v212, v212, v6, s[56:57]
v_mov_b32 v64, v6
v_cndmask_b32 v45, v45, v6, s[58:59]
v_cndmask_b32 v213, v213, v6, s[58:59]
v_mov_b32 v65, v6
v_cndmask_b32 v46, v46, v6, s[60:61]
v_cndmask_b32 v214, v214, v6, s[60:61]
v_mov_b32 v66, v6
v_cndmask_b32 v47, v47, v6, s[62:63]
v_cndmask_b32 v215, v215, v6, s[62:63]
v_mov_b32 v67, v6
SLOW1_U:
s_cmp_lg_u32 s54, 0
s_cbranch_scc1 SLOW1_A
v_max3_f32 v16, v16, v44, v45
v_max3_f32 v16, v16, v46, v47
v_max3_f32 v18, v18, v52, v53
v_max3_f32 v18, v18, v54, v55
v_max3_f32 v16, v16, v64, v65
v_max3_f32 v16, v16, v66, v67
v_max3_f32 v18, v18, v212, v213
v_max3_f32 v18, v18, v214, v215
s_branch SLOW1_N
SLOW1_A:
v_sub_f32 v44, v44, v16
v_sub_f32 v45, v45, v16
v_sub_f32 v46, v46, v16
v_sub_f32 v47, v47, v16
v_sub_f32 v52, v52, v18
v_sub_f32 v53, v53, v18
v_sub_f32 v54, v54, v18
v_sub_f32 v55, v55, v18
v_sub_f32 v64, v64, v16
v_sub_f32 v65, v65, v16
v_sub_f32 v66, v66, v16
v_sub_f32 v67, v67, v16
v_sub_f32 v212, v212, v18
v_sub_f32 v213, v213, v18
v_sub_f32 v214, v214, v18
v_sub_f32 v215, v215, v18
v_exp_f32 v44, v44
v_exp_f32 v45, v45
v_exp_f32 v46, v46
v_exp_f32 v47, v47
v_exp_f32 v52, v52
v_exp_f32 v53, v53
v_exp_f32 v54, v54
v_exp_f32 v55, v55
v_exp_f32 v64, v64
v_exp_f32 v65, v65
v_exp_f32 v66, v66
v_exp_f32 v67, v67
v_exp_f32 v212, v212
v_exp_f32 v213, v213
v_exp_f32 v214, v214
v_exp_f32 v215, v215
s_nop 0
v_cvt_pk_bf16_f32 v124, v44, v45
v_cvt_pk_bf16_f32 v125, v46, v47
v_cvt_pk_bf16_f32 v140, v52, v53
v_cvt_pk_bf16_f32 v141, v54, v55
v_cvt_pk_bf16_f32 v126, v64, v65
v_cvt_pk_bf16_f32 v127, v66, v67
v_cvt_pk_bf16_f32 v142, v212, v213
v_cvt_pk_bf16_f32 v143, v214, v215
s_nop 1
v_mfma_f32_16x16x32_bf16 v[60:63], a[64:67], v[124:127], v[60:63]
v_mfma_f32_16x16x32_bf16 v[148:151], a[64:67], v[140:143], v[148:151]
v_mfma_f32_16x16x32_bf16 v[48:51], a[68:71], v[140:143], v[48:51]
v_mfma_f32_16x16x32_bf16 v[68:71], a[68:71], v[124:127], v[68:71]
v_mfma_f32_16x16x32_bf16 v[72:75], a[72:75], v[124:127], v[72:75]
v_mfma_f32_16x16x32_bf16 v[236:239], a[72:75], v[140:143], v[236:239]
v_mfma_f32_16x16x32_bf16 v[224:227], a[76:79], v[140:143], v[224:227]
v_mfma_f32_16x16x32_bf16 v[220:223], a[76:79], v[124:127], v[220:223]
v_mfma_f32_16x16x32_bf16 v[84:87], a[80:83], v[124:127], v[84:87]
v_mfma_f32_16x16x32_bf16 v[164:167], a[80:83], v[140:143], v[164:167]
v_mfma_f32_16x16x32_bf16 v[156:159], a[84:87], v[140:143], v[156:159]
v_mfma_f32_16x16x32_bf16 v[76:79], a[84:87], v[124:127], v[76:79]
v_mfma_f32_16x16x32_bf16 v[160:163], a[88:91], v[124:127], v[160:163]
v_mfma_f32_16x16x32_bf16 v[216:219], a[88:91], v[140:143], v[216:219]
v_mfma_f32_16x16x32_bf16 v[208:211], a[92:95], v[140:143], v[208:211]
v_mfma_f32_16x16x32_bf16 v[252:255], a[92:95], v[124:127], v[252:255]
v_mfma_f32_16x16x32_bf16 a[232:235], a[240:243], v[124:127], a[232:235]
v_mfma_f32_16x16x32_bf16 a[236:239], a[240:243], v[140:143], a[236:239]
SLOW1_N:
s_add_u32 s52, s52, 16384
s_add_u32 s53, s53, 1
s_cmp_le_u32 s53, s67
s_cbranch_scc1 SLOW1_T
s_cmp_lg_u32 s54, 0
s_cbranch_scc1 SLOW1_E
v_mov_b32 v17, v16
v_mov_b32 v19, v18
s_nop 1
v_permlane32_swap_b32 v17, v16
v_permlane32_swap_b32 v19, v18
s_nop 1
v_max_f32 v16, v16, v17
v_max_f32 v18, v18, v19
v_mov_b32 v17, v16
v_mov_b32 v19, v18
s_nop 1
v_permlane16_swap_b32 v17, v16
v_permlane16_swap_b32 v19, v18
s_nop 1
v_max_f32 v16, v16, v17
v_max_f32 v18, v18, v19
v_mov_b32 v60, 0
v_mov_b32 v61, 0
v_mov_b32 v62, 0
v_mov_b32 v63, 0
v_mov_b32 v68, 0
v_mov_b32 v69, 0
v_mov_b32 v70, 0
v_mov_b32 v71, 0
v_mov_b32 v72, 0
v_mov_b32 v73, 0
v_mov_b32 v74, 0
v_mov_b32 v75, 0
v_mov_b32 v220, 0
v_mov_b32 v221, 0
v_mov_b32 v222, 0
v_mov_b32 v223, 0
v_mov_b32 v84, 0
v_mov_b32 v85, 0
v_mov_b32 v86, 0
v_mov_b32 v87, 0
v_mov_b32 v76, 0
v_mov_b32 v77, 0
v_mov_b32 v78, 0
v_mov_b32 v79, 0
v_mov_b32 v160, 0
v_mov_b32 v161, 0
v_mov_b32 v162, 0
v_mov_b32 v163, 0
v_mov_b32 v252, 0
v_mov_b32 v253, 0
v_mov_b32 v254, 0
v_mov_b32 v255, 0
v_mov_b32 v148, 0
v_mov_b32 v149, 0
v_mov_b32 v150, 0
v_mov_b32 v151, 0
v_mov_b32 v48, 0
v_mov_b32 v49, 0
v_mov_b32 v50, 0
v_mov_b32 v51, 0
v_mov_b32 v236, 0
v_mov_b32 v237, 0
v_mov_b32 v238, 0
v_mov_b32 v239, 0
v_mov_b32 v224, 0
v_mov_b32 v225, 0
v_mov_b32 v226, 0
v_mov_b32 v227, 0
v_mov_b32 v164, 0
v_mov_b32 v165, 0
v_mov_b32 v166, 0
v_mov_b32 v167, 0
v_mov_b32 v156, 0
v_mov_b32 v157, 0
v_mov_b32 v158, 0
v_mov_b32 v159, 0
v_mov_b32 v216, 0
v_mov_b32 v217, 0
v_mov_b32 v218, 0
v_mov_b32 v219, 0
v_mov_b32 v208, 0
v_mov_b32 v209, 0
v_mov_b32 v210, 0
v_mov_b32 v211, 0
v_accvgpr_write_b32 a232, 0
v_accvgpr_write_b32 a233, 0
v_accvgpr_write_b32 a234, 0
v_accvgpr_write_b32 a235, 0
v_accvgpr_write_b32 a236, 0
v_accvgpr_write_b32 a237, 0
v_accvgpr_write_b32 a238, 0
v_accvgpr_write_b32 a239, 0
s_mov_b32 s54, 1
s_branch SLOW1_P
SLOW1_E:
s_nop 7
v_accvgpr_read_b32 v180, a232
v_accvgpr_read_b32 v182, a236
s_add_u32 s52, s79, 4096
v_fma_f32 v180, v180, v10, v180
v_fma_f32 v182, v182, v11, v182
v_rcp_f32 v180, v180
v_rcp_f32 v182, v182
s_nop 0
v_pk_mul_f32 v[60:61], v[60:61], v[180:181] op_sel_hi:[1,0]
v_pk_mul_f32 v[62:63], v[62:63], v[180:181] op_sel_hi:[1,0]
v_pk_mul_f32 v[68:69], v[68:69], v[180:181] op_sel_hi:[1,0]
v_pk_mul_f32 v[70:71], v[70:71], v[180:181] op_sel_hi:[1,0]
v_cvt_pk_bf16_f32 v60, v60, v61
v_cvt_pk_bf16_f32 v61, v62, v63
v_cvt_pk_bf16_f32 v62, v68, v69
v_cvt_pk_bf16_f32 v63, v70, v71
s_branch L_EP
.section .rodata,"a"
.p2align 6
.amdhsa_kernel gated_mix__sliding_local_dilated__compressed_kv_cla__prompt_kernel
  .amdhsa_next_free_vgpr 512
  .amdhsa_next_free_sgpr 102
  .amdhsa_accum_offset 256
  .amdhsa_group_segment_fixed_size 0
  .amdhsa_kernarg_size 104
  .amdhsa_user_sgpr_count 2
  .amdhsa_user_sgpr_kernarg_segment_ptr 1
  .amdhsa_system_sgpr_workgroup_id_x 1
.end_amdhsa_kernel
```

```asm
; @launch grid=(256,1,1) block=(256,1,1) lds=163840
.amdgcn_target "amdgcn-amd-amdhsa--gfx950"
.text

.globl gated_mix__sliding_local_dilated__compressed_kv_cla__prompt_kernel
.p2align 8
.type gated_mix__sliding_local_dilated__compressed_kv_cla__prompt_kernel,@function
gated_mix__sliding_local_dilated__compressed_kv_cla__prompt_kernel:
s_cmp_ge_u32 s2, 256
s_cbranch_scc1 L_END
s_load_dwordx2 s[8:9], s[0:1], 32
s_load_dwordx2 s[56:57], s[0:1], 56
s_load_dwordx2 s[16:17], s[0:1], 48
s_load_dwordx2 s[24:25], s[0:1], 96
s_load_dwordx2 s[12:13], s[0:1], 0
s_load_dwordx2 s[20:21], s[0:1], 40
s_load_dwordx2 s[28:29], s[0:1], 8
s_load_dwordx2 s[48:49], s[0:1], 16
s_load_dwordx2 s[32:33], s[0:1], 64
s_load_dwordx2 s[36:37], s[0:1], 72
s_load_dwordx2 s[40:41], s[0:1], 88
s_load_dwordx2 s[44:45], s[0:1], 80
s_getpc_b64 s[96:97]
L_PC:
s_lshr_b32 s6, s2, 3
s_lshl_b32 s98, s6, 11
s_add_u32 s98, s98, L_MAIN-L_PC
s_add_u32 s96, s96, s98
s_addc_u32 s97, s97, 0
v_lshlrev_b32 v16, 3, v0
v_mov_b32 v17, s97
v_add_co_u32 v16, vcc, s96, v16
v_lshrrev_b32 v5, 6, v0
v_and_b32 v1, 63, v0
v_addc_co_u32 v17, vcc, 0, v17, vcc
v_readfirstlane_b32 s3, v5
global_load_dwordx2 a[252:253], v[16:17], off
v_and_b32 v2, 15, v0
v_lshrrev_b32 v3, 4, v1
v_lshlrev_b32 v4, 4, v1
s_and_b32 s7, s2, 7
s_and_b32 s65, s6, 3
s_lshl2_add_u32 s4, s7, s65
s_lshr_b32 s5, s6, 2
s_lshl2_add_u32 s66, s5, s3
s_sub_u32 s67, 63, s66
v_lshrrev_b32 v16, 3, v1
v_and_b32 v17, 7, v1
v_xor_b32 v18, v17, v3
v_lshlrev_b32 v19, 10, v16
v_lshl_add_u32 v5, v18, 4, v19
v_xor_b32 v18, 4, v18
v_lshl_add_u32 v6, v18, 4, v19
v_add_u32 v6, 7168, v6
v_and_b32 v18, 1, v3
v_lshlrev_b32 v18, 1, v18
v_xor_b32 v18, v17, v18
v_lshlrev_b32 v19, 13, v16
v_lshl_add_u32 v7, v18, 4, v19
v_xor_b32 v18, 4, v18
v_lshl_add_u32 v8, v18, 4, v19
v_add_u32 v8, 64512, v8
s_add_u32 s69, s65, s5
s_and_b32 s69, s69, 1
s_mul_i32 s64, s7, 2
s_and_b32 s64, s64, 7
s_or_b32 s69, s69, s64
s_add_u32 s93, s65, s5
s_and_b32 s93, s93, 0
s_mul_i32 s64, s7, 1
s_and_b32 s64, s64, 7
s_or_b32 s93, s93, s64
s_lshl_b32 s70, s69, 7
s_lshl_b32 s75, s69, 19
s_lshr_b32 s54, s3, 1
s_and_b32 s55, s3, 1
s_lshl3_add_u32 s87, s54, s5
s_lshl_b32 s64, s55, 5
s_add_u32 s68, s87, s64
s_lshl_b32 s68, s68, 15
s_lshl_b32 s73, s3, 13
s_add_u32 s73, s73, 65536
s_lshl1_add_u32 s74, s4, s55
s_lshl_b32 s74, s74, 7
s_lshl_b32 s64, s54, 18
s_add_u32 s74, s74, s64
s_lshl_b32 s77, s3, 12
s_add_u32 s71, s68, s70
s_add_u32 s76, s74, s75
s_mov_b32 s10, 2097152
s_mov_b32 s11, 0x20000
s_mov_b32 s58, 4194304
s_mov_b32 s59, 0x20000
s_waitcnt lgkmcnt(0)
s_add_u32 m0, s73, 0
s_add_u32 s64, s71, 0
buffer_load_dwordx4 v5, s[8:11], s64 offen lds
buffer_load_dwordx4 v6, s[8:11], s64 offen offset:1024 lds
s_add_u32 m0, s73, 2048
s_add_u32 s64, s71, 16384
buffer_load_dwordx4 v5, s[8:11], s64 offen lds
buffer_load_dwordx4 v6, s[8:11], s64 offen offset:1024 lds
s_add_u32 m0, s77, 0
s_add_u32 s64, s76, 0
buffer_load_dwordx4 v7, s[56:59], s64 offen lds
buffer_load_dwordx4 v8, s[56:59], s64 offen offset:1024 lds
s_add_u32 m0, s77, 2048
s_add_u32 s64, s76, 131072
buffer_load_dwordx4 v7, s[56:59], s64 offen lds
buffer_load_dwordx4 v8, s[56:59], s64 offen offset:1024 lds
s_add_u32 m0, s73, 4096
s_add_u32 s64, s71, 524288
buffer_load_dwordx4 v5, s[8:11], s64 offen lds
buffer_load_dwordx4 v6, s[8:11], s64 offen offset:1024 lds
s_add_u32 m0, s73, 6144
s_add_u32 s64, s71, 540672
buffer_load_dwordx4 v5, s[8:11], s64 offen lds
buffer_load_dwordx4 v6, s[8:11], s64 offen offset:1024 lds
s_mov_b32 s18, 4194304
s_mov_b32 s19, 0x20000
s_lshl_b32 s65, s54, 7
s_lshl_b32 s53, s55, 12
v_lshrrev_b32 v16, 1, v2
v_xor_b32 v16, v16, v3
v_add_u32 v17, s65, v2
v_lshlrev_b32 v17, 7, v17
v_add_u32 v17, 65536, v17
v_lshl_add_u32 v9, v16, 4, v17
v_xor_b32 v10, 64, v9
v_bfe_u32 v16, v1, 2, 2
v_lshl_add_u32 v17, v3, 3, v16
v_lshlrev_b32 v17, 7, v17
v_and_b32 v18, 3, v1
v_lshl_add_u32 v17, v18, 3, v17
v_add_u32 v17, s53, v17
v_lshrrev_b32 v16, 1, v16
v_and_b32 v18, 1, v3
v_lshl_add_u32 v16, v18, 1, v16
v_xor_b32 v18, 0, v16
v_lshl_add_u32 v11, v18, 5, v17
v_xor_b32 v18, 1, v16
v_lshl_add_u32 v12, v18, 5, v17
v_xor_b32 v18, 2, v16
v_lshl_add_u32 v13, v18, 5, v17
v_xor_b32 v18, 3, v16
v_lshl_add_u32 v14, v18, 5, v17
s_add_u32 m0, s77, 16384
s_add_u32 s64, s76, 0
buffer_load_dwordx4 v7, s[16:19], s64 offen lds
buffer_load_dwordx4 v8, s[16:19], s64 offen offset:1024 lds
s_add_u32 m0, s77, 18432
s_add_u32 s64, s76, 131072
buffer_load_dwordx4 v7, s[16:19], s64 offen lds
buffer_load_dwordx4 v8, s[16:19], s64 offen offset:1024 lds
s_mov_b64 exec, 0
s_cmp_eq_u32 s3, 0
s_cbranch_scc1 L_PAD0
s_cmp_eq_u32 s3, 1
s_cbranch_scc1 L_PAD1
s_cmp_eq_u32 s3, 2
s_cbranch_scc1 L_PAD2
s_branch L_PAD3
.p2align 12
.fill 592, 4, 0xbf800000
L_MAIN:
s_mov_b64 exec, -1
s_xor_b32 s71, s70, 128
s_add_u32 s71, s68, s71
s_add_u32 m0, s73, 32768
s_add_u32 s64, s71, 0
buffer_load_dwordx4 v5, s[8:11], s64 offen lds
buffer_load_dwordx4 v6, s[8:11], s64 offen offset:1024 lds
s_add_u32 m0, s73, 34816
s_add_u32 s64, s71, 16384
buffer_load_dwordx4 v5, s[8:11], s64 offen lds
buffer_load_dwordx4 v6, s[8:11], s64 offen offset:1024 lds
s_add_u32 m0, s73, 36864
s_add_u32 s64, s71, 524288
buffer_load_dwordx4 v5, s[8:11], s64 offen lds
buffer_load_dwordx4 v6, s[8:11], s64 offen offset:1024 lds
s_add_u32 m0, s73, 38912
s_add_u32 s64, s71, 540672
buffer_load_dwordx4 v5, s[8:11], s64 offen lds
buffer_load_dwordx4 v6, s[8:11], s64 offen offset:1024 lds
s_waitcnt vmcnt(12)
s_barrier
ds_read_b128 a[64:67], v9 offset:0
ds_read_b128 a[68:71], v10 offset:0
ds_read_b64_tr_b16 a[128:129], v11 offset:0
ds_read_b64_tr_b16 a[130:131], v11 offset:512
ds_read_b64_tr_b16 a[132:133], v11 offset:8192
ds_read_b64_tr_b16 a[134:135], v11 offset:8704
ds_read_b64_tr_b16 a[136:137], v12 offset:0
ds_read_b64_tr_b16 a[138:139], v12 offset:512
ds_read_b64_tr_b16 a[140:141], v12 offset:8192
ds_read_b64_tr_b16 a[142:143], v12 offset:8704
ds_read_b64_tr_b16 a[144:145], v13 offset:0
ds_read_b64_tr_b16 a[146:147], v13 offset:512
ds_read_b64_tr_b16 a[148:149], v13 offset:8192
ds_read_b64_tr_b16 a[150:151], v13 offset:8704
ds_read_b64_tr_b16 a[152:153], v14 offset:0
ds_read_b64_tr_b16 a[154:155], v14 offset:512
ds_read_b64_tr_b16 a[156:157], v14 offset:8192
ds_read_b64_tr_b16 a[158:159], v14 offset:8704
ds_read_b128 a[72:75], v9 offset:2048
ds_read_b128 a[76:79], v10 offset:2048
ds_read_b128 a[80:83], v9 offset:4096
ds_read_b128 a[84:87], v10 offset:4096
ds_read_b128 a[88:91], v9 offset:6144
ds_read_b128 a[92:95], v10 offset:6144
s_waitcnt lgkmcnt(0)
v_mfma_f32_16x16x32_bf16 v[32:35], a[64:67], a[128:131], 0
s_waitcnt vmcnt(8)
v_mfma_f32_16x16x32_bf16 v[32:35], a[68:71], a[132:135], v[32:35]
s_barrier
v_mfma_f32_16x16x32_bf16 v[40:43], a[68:71], a[140:143], 0
s_mov_b32 s26, 268435456
s_mov_b32 s27, 0x20000
ds_read_b128 a[96:99], v9 offset:8192
v_mfma_f32_16x16x32_bf16 v[40:43], a[64:67], a[136:139], v[40:43]
s_xor_b32 s76, s75, 524288
s_add_u32 s76, s74, s76
s_mov_b32 s14, 2359296
v_mfma_f32_16x16x32_bf16 v[48:51], a[64:67], a[144:147], 0
s_add_u32 m0, s77, 32768
s_add_u32 s64, s76, 0
s_mov_b32 s15, 0x20000
v_mfma_f32_16x16x32_bf16 v[48:51], a[68:71], a[148:151], v[48:51]
buffer_load_dwordx4 v7, s[56:59], s64 offen lds
v_mfma_f32_16x16x32_bf16 v[56:59], a[68:71], a[156:159], 0
s_mov_b32 s22, 4718592
s_mov_b32 s23, 0x20000
ds_read_b128 a[100:103], v10 offset:8192
v_mfma_f32_16x16x32_bf16 v[56:59], a[64:67], a[152:155], v[56:59]
buffer_load_dwordx4 v8, s[56:59], s64 offen offset:1024 lds
v_mfma_f32_16x16x32_bf16 v[60:63], a[72:75], a[152:155], 0
s_add_u32 m0, s77, 34816
s_add_u32 s64, s76, 131072
ds_read_b128 a[104:107], v9 offset:10240
v_mfma_f32_16x16x32_bf16 v[60:63], a[76:79], a[156:159], v[60:63]
s_mov_b32 s30, 1990656
s_mov_b32 s31, 0x20000
s_mov_b32 s34, 4718592
v_mfma_f32_16x16x32_bf16 v[52:55], a[76:79], a[148:151], 0
buffer_load_dwordx4 v7, s[56:59], s64 offen lds
v_mfma_f32_16x16x32_bf16 v[52:55], a[72:75], a[144:147], v[52:55]
s_mov_b32 s35, 0x20000
ds_read_b64_tr_b16 a[160:161], v11 offset:16384
ds_read_b64_tr_b16 a[162:163], v11 offset:16896
v_mfma_f32_16x16x32_bf16 v[44:47], a[72:75], a[136:139], 0
s_mov_b32 s38, 1152
s_mov_b32 s39, 0x20000
s_mov_b32 s42, 256
v_mfma_f32_16x16x32_bf16 v[44:47], a[76:79], a[140:143], v[44:47]
buffer_load_dwordx4 v8, s[56:59], s64 offen offset:1024 lds
v_mfma_f32_16x16x32_bf16 v[36:39], a[76:79], a[132:135], 0
s_mov_b32 s43, 0x20000
s_mov_b32 s46, 2359296
s_mov_b32 s47, 0x20000
v_mfma_f32_16x16x32_bf16 v[36:39], a[72:75], a[128:131], v[36:39]
s_add_u32 m0, s77, 49152
s_add_u32 s64, s76, 0
ds_read_b128 a[108:111], v10 offset:10240
v_mfma_f32_16x16x32_bf16 v[64:67], a[80:83], a[128:131], 0
s_mov_b32 s50, 663552
s_mov_b32 s51, 0x20000
s_lshl_b32 s89, s4, 10
v_mfma_f32_16x16x32_bf16 v[64:67], a[84:87], a[132:135], v[64:67]
buffer_load_dwordx4 v7, s[16:19], s64 offen lds
v_mfma_f32_16x16x32_bf16 v[72:75], a[84:87], a[140:143], 0
s_add_u32 s89, s89, 75497472
ds_read_b64_tr_b16 a[164:165], v11 offset:24576
ds_read_b64_tr_b16 a[166:167], v11 offset:25088
v_mfma_f32_16x16x32_bf16 v[72:75], a[80:83], a[136:139], v[72:75]
s_mul_i32 s94, s4, 1064960
s_lshl_b32 s52, s5, 15
s_add_u32 s52, s52, s89
v_mfma_f32_16x16x32_bf16 v[80:83], a[80:83], a[144:147], 0
buffer_load_dwordx4 v8, s[16:19], s64 offen offset:1024 lds
v_mfma_f32_16x16x32_bf16 v[80:83], a[84:87], a[148:151], v[80:83]
s_add_u32 m0, s77, 51200
s_add_u32 s64, s76, 131072
ds_read_b128 a[112:115], v9 offset:12288
v_mfma_f32_16x16x32_bf16 v[88:91], a[84:87], a[156:159], 0
s_lshl_b32 s53, s5, 10
s_add_u32 s53, s53, s94
s_add_u32 s53, s53, 1048576
v_mfma_f32_16x16x32_bf16 v[88:91], a[80:83], a[152:155], v[88:91]
buffer_load_dwordx4 v7, s[16:19], s64 offen lds
v_mfma_f32_16x16x32_bf16 v[92:95], a[88:91], a[152:155], 0
ds_read_b64_tr_b16 a[168:169], v12 offset:16384
ds_read_b64_tr_b16 a[170:171], v12 offset:16896
v_mfma_f32_16x16x32_bf16 v[92:95], a[92:95], a[156:159], v[92:95]
s_cmp_eq_u32 s3, 1
s_cselect_b32 s52, s53, s52
s_mul_i32 s53, s2, 74
v_mfma_f32_16x16x32_bf16 v[84:87], a[92:95], a[148:151], 0
buffer_load_dwordx4 v8, s[16:19], s64 offen offset:1024 lds
v_mfma_f32_16x16x32_bf16 v[84:87], a[88:91], a[144:147], v[84:87]
s_add_u32 s53, s53, s55
s_lshl_b32 s53, s53, 10
s_add_u32 s53, s53, 54599680
v_mfma_f32_16x16x32_bf16 v[76:79], a[88:91], a[136:139], 0
s_cmp_ge_u32 s3, 2
s_cselect_b32 s52, s53, s52
ds_read_b128 a[116:119], v10 offset:12288
v_mfma_f32_16x16x32_bf16 v[76:79], a[92:95], a[140:143], v[76:79]
v_mov_b32 v16, 0
v_mov_b32 v17, 0
v_mfma_f32_16x16x32_bf16 v[68:71], a[92:95], a[132:135], 0
v_mov_b32 v18, 0
v_mov_b32 v19, 0
v_mfma_f32_16x16x32_bf16 v[68:71], a[88:91], a[128:131], v[68:71]
s_waitcnt lgkmcnt(6)
ds_read_b64_tr_b16 a[172:173], v12 offset:24576
ds_read_b64_tr_b16 a[174:175], v12 offset:25088
v_mfma_f32_16x16x32_bf16 v[96:99], a[96:99], a[128:131], 0
v_lshrrev_b32 v20, 3, v1
v_cmp_eq_u32 vcc, 3, v20
v_mfma_f32_16x16x32_bf16 v[96:99], a[100:103], a[132:135], v[96:99]
v_add_u32 v20, 100663168, v4
v_mov_b32 v21, s3
v_mfma_f32_16x16x32_bf16 v[104:107], a[100:103], a[140:143], 0
ds_read_b128 a[120:123], v9 offset:14336
v_cndmask_b32 v15, v4, v20, vcc
v_mfma_f32_16x16x32_bf16 v[104:107], a[96:99], a[136:139], v[104:107]
v_cmp_eq_u32 vcc, 0, v21
v_mov_b32 v21, 0
v_mfma_f32_16x16x32_bf16 v[112:115], a[96:99], a[144:147], 0
v_mov_b32 v21, 0
v_cndmask_b32 v20, v15, v4, vcc
v_mfma_f32_16x16x32_bf16 v[112:115], a[100:103], a[148:151], v[112:115]
ds_read_b64_tr_b16 a[176:177], v13 offset:16384
ds_read_b64_tr_b16 a[178:179], v13 offset:16896
v_mfma_f32_16x16x32_bf16 v[120:123], a[100:103], a[156:159], 0
v_mfma_f32_16x16x32_bf16 v[120:123], a[96:99], a[152:155], v[120:123]
v_mfma_f32_16x16x32_bf16 v[124:127], a[104:107], a[152:155], 0
v_mfma_f32_16x16x32_bf16 v[124:127], a[108:111], a[156:159], v[124:127]
ds_read_b128 a[124:127], v10 offset:14336
v_mfma_f32_16x16x32_bf16 v[116:119], a[108:111], a[148:151], 0
v_add_u32 v9, 32768, v9
v_add_u32 v10, 32768, v10
v_mfma_f32_16x16x32_bf16 v[116:119], a[104:107], a[144:147], v[116:119]
v_mfma_f32_16x16x32_bf16 v[108:111], a[104:107], a[136:139], 0
ds_read_b64_tr_b16 a[180:181], v13 offset:24576
ds_read_b64_tr_b16 a[182:183], v13 offset:25088
v_mfma_f32_16x16x32_bf16 v[108:111], a[108:111], a[140:143], v[108:111]
v_mfma_f32_16x16x32_bf16 v[100:103], a[108:111], a[132:135], 0
v_mfma_f32_16x16x32_bf16 v[100:103], a[104:107], a[128:131], v[100:103]
s_waitcnt lgkmcnt(2)
ds_read_b64_tr_b16 a[184:185], v14 offset:16384
ds_read_b64_tr_b16 a[186:187], v14 offset:16896
v_mfma_f32_16x16x32_bf16 v[128:131], a[112:115], a[128:131], 0
v_mfma_f32_16x16x32_bf16 v[128:131], a[116:119], a[132:135], v[128:131]
v_mfma_f32_16x16x32_bf16 v[136:139], a[116:119], a[140:143], 0
ds_read_b64_tr_b16 a[188:189], v14 offset:24576
ds_read_b64_tr_b16 a[190:191], v14 offset:25088
v_mfma_f32_16x16x32_bf16 v[136:139], a[112:115], a[136:139], v[136:139]
v_mfma_f32_16x16x32_bf16 v[144:147], a[112:115], a[144:147], 0
v_mfma_f32_16x16x32_bf16 v[144:147], a[116:119], a[148:151], v[144:147]
v_mfma_f32_16x16x32_bf16 v[152:155], a[116:119], a[156:159], 0
v_mfma_f32_16x16x32_bf16 v[152:155], a[112:115], a[152:155], v[152:155]
v_mfma_f32_16x16x32_bf16 v[156:159], a[120:123], a[152:155], 0
v_mfma_f32_16x16x32_bf16 v[156:159], a[124:127], a[156:159], v[156:159]
v_mfma_f32_16x16x32_bf16 v[148:151], a[124:127], a[148:151], 0
v_mfma_f32_16x16x32_bf16 v[148:151], a[120:123], a[144:147], v[148:151]
v_mfma_f32_16x16x32_bf16 v[140:143], a[120:123], a[136:139], 0
v_mfma_f32_16x16x32_bf16 v[140:143], a[124:127], a[140:143], v[140:143]
v_mfma_f32_16x16x32_bf16 v[132:135], a[124:127], a[132:135], 0
v_mfma_f32_16x16x32_bf16 v[132:135], a[120:123], a[128:131], v[132:135]
s_waitcnt lgkmcnt(0)
v_mfma_f32_16x16x32_bf16 v[160:163], a[160:163], a[64:67], 0
s_waitcnt vmcnt(4)
v_mfma_f32_16x16x32_bf16 v[160:163], a[164:167], a[68:71], v[160:163]
s_barrier
v_mfma_f32_16x16x32_bf16 v[164:167], a[172:175], a[68:71], 0
ds_read_b64_tr_b16 a[128:129], v11 offset:32768
ds_read_b64_tr_b16 a[130:131], v11 offset:33280
v_mfma_f32_16x16x32_bf16 v[164:167], a[168:171], a[64:67], v[164:167]
s_xor_b32 s71, s70, 256
s_add_u32 s71, s68, s71
v_mfma_f32_16x16x32_bf16 v[168:171], a[176:179], a[64:67], 0
s_add_u32 m0, s73, 65536
s_add_u32 s64, s71, 0
v_mfma_f32_16x16x32_bf16 v[168:171], a[180:183], a[68:71], v[168:171]
buffer_load_dwordx4 v5, s[8:11], s64 offen lds
v_mfma_f32_16x16x32_bf16 v[172:175], a[188:191], a[68:71], 0
v_mfma_f32_16x16x32_bf16 v[172:175], a[184:187], a[64:67], v[172:175]
ds_read_b128 a[64:67], v9 offset:0
v_mfma_f32_16x16x32_bf16 v[188:191], a[184:187], a[72:75], 0
buffer_load_dwordx4 v6, s[8:11], s64 offen offset:1024 lds
v_mfma_f32_16x16x32_bf16 v[188:191], a[188:191], a[76:79], v[188:191]
ds_read_b64_tr_b16 a[132:133], v11 offset:40960
ds_read_b64_tr_b16 a[134:135], v11 offset:41472
v_mfma_f32_16x16x32_bf16 v[184:187], a[180:183], a[76:79], 0
v_mfma_f32_16x16x32_bf16 v[184:187], a[176:179], a[72:75], v[184:187]
s_add_u32 m0, s73, 67584
s_add_u32 s64, s71, 16384
ds_read_b128 a[68:71], v10 offset:0
v_mfma_f32_16x16x32_bf16 v[180:183], a[168:171], a[72:75], 0
v_mfma_f32_16x16x32_bf16 v[180:183], a[172:175], a[76:79], v[180:183]
buffer_load_dwordx4 v5, s[8:11], s64 offen lds
v_mfma_f32_16x16x32_bf16 v[176:179], a[164:167], a[76:79], 0
L_PAD0:
s_cbranch_execz L_PAD4
v_mfma_f32_16x16x32_bf16 v[176:179], a[160:163], a[72:75], v[176:179]
ds_read_b64_tr_b16 a[136:137], v12 offset:32768
ds_read_b64_tr_b16 a[138:139], v12 offset:33280
v_mfma_f32_16x16x32_bf16 v[192:195], a[160:163], a[80:83], 0
v_mfma_f32_16x16x32_bf16 v[192:195], a[164:167], a[84:87], v[192:195]
v_mfma_f32_16x16x32_bf16 v[196:199], a[172:175], a[84:87], 0
buffer_load_dwordx4 v6, s[8:11], s64 offen offset:1024 lds
v_mfma_f32_16x16x32_bf16 v[196:199], a[168:171], a[80:83], v[196:199]
s_xor_b32 s76, s75, 1048576
s_add_u32 s76, s74, s76
ds_read_b128 a[72:75], v9 offset:2048
v_mfma_f32_16x16x32_bf16 v[200:203], a[176:179], a[80:83], 0
v_mfma_f32_16x16x32_bf16 v[200:203], a[180:183], a[84:87], v[200:203]
s_add_u32 m0, s77, 0
s_add_u32 s64, s76, 0
v_mfma_f32_16x16x32_bf16 v[204:207], a[188:191], a[84:87], 0
ds_read_b64_tr_b16 a[140:141], v12 offset:40960
ds_read_b64_tr_b16 a[142:143], v12 offset:41472
v_mfma_f32_16x16x32_bf16 v[204:207], a[184:187], a[80:83], v[204:207]
buffer_load_dwordx4 v7, s[56:59], s64 offen lds
v_mfma_f32_16x16x32_bf16 v[220:223], a[184:187], a[88:91], 0
ds_read_b128 a[76:79], v10 offset:2048
v_mfma_f32_16x16x32_bf16 v[220:223], a[188:191], a[92:95], v[220:223]
v_mfma_f32_16x16x32_bf16 v[216:219], a[180:183], a[92:95], 0
v_mfma_f32_16x16x32_bf16 v[216:219], a[176:179], a[88:91], v[216:219]
v_mfma_f32_16x16x32_bf16 v[212:215], a[168:171], a[88:91], 0
buffer_load_dwordx4 v8, s[56:59], s64 offen offset:1024 lds
v_mfma_f32_16x16x32_bf16 v[212:215], a[172:175], a[92:95], v[212:215]
ds_read_b64_tr_b16 a[144:145], v13 offset:32768
ds_read_b64_tr_b16 a[146:147], v13 offset:33280
v_mfma_f32_16x16x32_bf16 v[208:211], a[164:167], a[92:95], 0
v_mfma_f32_16x16x32_bf16 v[208:211], a[160:163], a[88:91], v[208:211]
s_add_u32 m0, s77, 2048
s_add_u32 s64, s76, 131072
ds_read_b128 a[80:83], v9 offset:4096
v_mfma_f32_16x16x32_bf16 v[224:227], a[160:163], a[96:99], 0
v_mfma_f32_16x16x32_bf16 v[224:227], a[164:167], a[100:103], v[224:227]
buffer_load_dwordx4 v7, s[56:59], s64 offen lds
v_mfma_f32_16x16x32_bf16 v[228:231], a[172:175], a[100:103], 0
ds_read_b64_tr_b16 a[148:149], v13 offset:40960
ds_read_b64_tr_b16 a[150:151], v13 offset:41472
v_mfma_f32_16x16x32_bf16 v[228:231], a[168:171], a[96:99], v[228:231]
v_mfma_f32_16x16x32_bf16 v[232:235], a[176:179], a[96:99], 0
buffer_store_dwordx4 v[16:19], v20, s[24:27], s52 offen sc1
v_mfma_f32_16x16x32_bf16 v[232:235], a[180:183], a[100:103], v[232:235]
buffer_load_dwordx4 v8, s[56:59], s64 offen offset:1024 lds
v_mfma_f32_16x16x32_bf16 v[236:239], a[188:191], a[100:103], 0
s_add_u32 s89, s89, 512
ds_read_b128 a[84:87], v10 offset:4096
v_mfma_f32_16x16x32_bf16 v[236:239], a[184:187], a[96:99], v[236:239]
s_cmp_eq_u32 s3, 0
s_cselect_b32 s90, s89, 2147418112
v_mov_b32 v24, 2147418112
v_mfma_f32_16x16x32_bf16 v[252:255], a[184:187], a[104:107], 0
s_add_u32 m0, s73, 69632
s_add_u32 s64, s71, 524288
v_cmp_eq_u32 vcc, 1, v1
v_mfma_f32_16x16x32_bf16 v[252:255], a[188:191], a[108:111], v[252:255]
s_lshl_b32 s53, s55, 12
ds_read_b64_tr_b16 a[152:153], v14 offset:32768
ds_read_b64_tr_b16 a[154:155], v14 offset:33280
v_mfma_f32_16x16x32_bf16 v[248:251], a[180:183], a[108:111], 0
buffer_load_dwordx4 v5, s[8:11], s64 offen lds
v_mfma_f32_16x16x32_bf16 v[248:251], a[176:179], a[104:107], v[248:251]
v_cndmask_b32 v0, v24, 0, vcc
v_mfma_f32_16x16x32_bf16 v[244:247], a[168:171], a[104:107], 0
s_mul_i32 s87, s87, 16384
s_add_u32 s87, s87, s94
ds_read_b128 a[88:91], v9 offset:6144
v_mfma_f32_16x16x32_bf16 v[244:247], a[172:175], a[108:111], v[244:247]
s_add_u32 s88, s87, s53
s_add_u32 s88, s88, 24576
s_lshr_b32 s53, s53, 1
v_mfma_f32_16x16x32_bf16 v[240:243], a[164:167], a[108:111], 0
s_add_u32 s87, s87, s53
s_lshl_b32 s80, s3, 10
s_mul_i32 s78, s4, 18
v_mfma_f32_16x16x32_bf16 v[240:243], a[160:163], a[104:107], v[240:243]
buffer_load_dwordx4 v6, s[8:11], s64 offen offset:1024 lds
v_mfma_f32_16x16x32_bf16 a[0:3], a[160:163], a[112:115], 0
s_add_u32 s78, s78, s54
ds_read_b64_tr_b16 a[156:157], v14 offset:40960
ds_read_b64_tr_b16 a[158:159], v14 offset:41472
v_mfma_f32_16x16x32_bf16 a[0:3], a[164:167], a[116:119], a[0:3]
s_lshl2_add_u32 s78, s78, s55
s_lshl_b32 s78, s78, 10
s_add_u32 s78, s78, 35651584
v_mfma_f32_16x16x32_bf16 a[4:7], a[172:175], a[116:119], 0
s_add_u32 m0, s73, 71680
s_add_u32 s64, s71, 540672
ds_read_b128 a[92:95], v10 offset:6144
v_mfma_f32_16x16x32_bf16 a[4:7], a[168:171], a[112:115], a[4:7]
s_add_u32 s80, s80, 8192
s_mov_b32 s91, 0x3e0293ee
s_mov_b32 s85, 0x05040100
v_mfma_f32_16x16x32_bf16 a[8:11], a[176:179], a[112:115], 0
buffer_load_dwordx4 v5, s[8:11], s64 offen lds
v_mfma_f32_16x16x32_bf16 a[8:11], a[180:183], a[116:119], a[8:11]
s_mov_b32 s86, 0x07060302
s_lshl2_add_u32 s52, s7, s3
s_and_b32 s65, s6, 3
v_mfma_f32_16x16x32_bf16 a[12:15], a[188:191], a[116:119], 0
s_max_u32 s95, s65, 1
s_mul_i32 s92, s5, 3
s_add_u32 s95, s95, s92
v_mfma_f32_16x16x32_bf16 a[12:15], a[184:187], a[112:115], a[12:15]
s_sub_u32 s95, 24, s95
s_cmp_eq_u32 s65, 1
s_cselect_b32 s95, 63, s95
v_mfma_f32_16x16x32_bf16 a[28:31], a[184:187], a[120:123], 0
s_mov_b32 s92, s95
s_mul_i32 s81, s92, 110592
s_mul_i32 s65, s52, 36
v_mfma_f32_16x16x32_bf16 a[28:31], a[188:191], a[124:127], a[28:31]
buffer_load_dwordx4 v6, s[8:11], s64 offen offset:1024 lds
v_mfma_f32_16x16x32_bf16 a[24:27], a[180:183], a[124:127], 0
s_add_u32 s81, s81, s65
s_mul_i32 s82, s52, 18
s_add_u32 s82, s82, s92
v_mfma_f32_16x16x32_bf16 a[24:27], a[176:179], a[120:123], a[24:27]
s_lshl_b32 s82, s82, 12
s_add_u32 s82, s82, 35651584
s_lshl_b32 s83, s92, 6
v_mfma_f32_16x16x32_bf16 a[20:23], a[168:171], a[120:123], 0
s_lshl_b32 s84, s52, 10
s_add_u32 s84, s84, 75497984
v_mfma_f32_16x16x32_bf16 a[20:23], a[172:175], a[124:127], a[20:23]
s_cmp_lt_u32 s92, 18
s_cselect_b32 s82, s82, 2147418112
s_cselect_b32 s84, s84, 2147418112
v_mfma_f32_16x16x32_bf16 a[16:19], a[164:167], a[124:127], 0
v_lshrrev_b32 v18, 2, v2
v_and_b32 v19, 3, v2
v_mfma_f32_16x16x32_bf16 a[16:19], a[160:163], a[120:123], a[16:19]
s_waitcnt lgkmcnt(0)
v_mul_u32_u24 v20, 1152, v18
v_cmp_eq_u32 vcc, 2, v19
v_mfma_f32_16x16x32_bf16 v[32:35], a[64:67], a[128:131], v[32:35]
s_waitcnt vmcnt(13)
v_lshl_add_u32 v20, v19, 3, v20
v_add_u32 v21, 1, v19
v_mfma_f32_16x16x32_bf16 v[32:35], a[68:71], a[132:135], v[32:35]
s_barrier
v_mfma_f32_16x16x32_bf16 v[40:43], a[68:71], a[140:143], v[40:43]
ds_read_b128 a[96:99], v9 offset:8192
v_cndmask_b32 v21, v21, 0, vcc
v_mfma_f32_16x16x32_bf16 v[40:43], a[64:67], a[136:139], v[40:43]
s_add_u32 m0, s77, 16384
s_add_u32 s64, s76, 0
v_cmp_eq_u32 vcc, 3, v18
v_mfma_f32_16x16x32_bf16 v[48:51], a[64:67], a[144:147], v[48:51]
buffer_load_dwordx4 v7, s[16:19], s64 offen lds
v_mfma_f32_16x16x32_bf16 v[48:51], a[68:71], a[148:151], v[48:51]
ds_read_b128 a[100:103], v10 offset:8192
v_mul_u32_u24 v21, 1152, v21
v_mfma_f32_16x16x32_bf16 v[56:59], a[68:71], a[156:159], v[56:59]
v_add_u32 v21, 32, v21
v_cndmask_b32 v20, v20, v21, vcc
v_mfma_f32_16x16x32_bf16 v[56:59], a[64:67], a[152:155], v[56:59]
v_cmp_eq_u32 vcc, 15, v2
v_mul_u32_u24 v21, 27648, v3
v_mfma_f32_16x16x32_bf16 v[60:63], a[72:75], a[152:155], v[60:63]
buffer_load_dwordx4 v8, s[16:19], s64 offen offset:1024 lds
v_mfma_f32_16x16x32_bf16 v[60:63], a[76:79], a[156:159], v[60:63]
ds_read_b128 a[104:107], v9 offset:10240
v_add_u32 v20, v20, v21
v_mfma_f32_16x16x32_bf16 v[52:55], a[76:79], a[148:151], v[52:55]
v_lshlrev_b32 v21, 4, v3
v_cndmask_b32 v26, v20, v24, vcc
v_mfma_f32_16x16x32_bf16 v[52:55], a[72:75], a[144:147], v[52:55]
s_add_u32 m0, s77, 18432
s_add_u32 s64, s76, 131072
v_cndmask_b32 v27, v24, v21, vcc
v_mfma_f32_16x16x32_bf16 v[44:47], a[72:75], a[136:139], v[44:47]
s_lshl_b32 s52, s4, 2
ds_read_b64_tr_b16 a[160:161], v11 offset:49152
ds_read_b64_tr_b16 a[162:163], v11 offset:49664
v_mfma_f32_16x16x32_bf16 v[44:47], a[76:79], a[140:143], v[44:47]
buffer_load_dwordx4 v7, s[16:19], s64 offen lds
v_mfma_f32_16x16x32_bf16 v[36:39], a[76:79], a[132:135], v[36:39]
s_cmp_eq_u32 s66, 0
s_cselect_b32 s52, s52, 2147418112
v_mfma_f32_16x16x32_bf16 v[36:39], a[72:75], a[128:131], v[36:39]
ds_read_b128 a[108:111], v10 offset:10240
v_mfma_f32_16x16x32_bf16 v[64:67], a[80:83], a[128:131], v[64:67]
v_mfma_f32_16x16x32_bf16 v[64:67], a[84:87], a[132:135], v[64:67]
v_mfma_f32_16x16x32_bf16 v[72:75], a[84:87], a[140:143], v[72:75]
buffer_load_dwordx4 v8, s[16:19], s64 offen offset:1024 lds
v_mfma_f32_16x16x32_bf16 v[72:75], a[80:83], a[136:139], v[72:75]
s_xor_b32 s71, s70, 384
s_add_u32 s71, s68, s71
v_mfma_f32_16x16x32_bf16 v[80:83], a[80:83], a[144:147], v[80:83]
ds_read_b64_tr_b16 a[164:165], v11 offset:57344
ds_read_b64_tr_b16 a[166:167], v11 offset:57856
v_mfma_f32_16x16x32_bf16 v[80:83], a[84:87], a[148:151], v[80:83]
s_add_u32 m0, s73, 0
s_add_u32 s64, s71, 0
ds_read_b128 a[112:115], v9 offset:12288
v_mfma_f32_16x16x32_bf16 v[88:91], a[84:87], a[156:159], v[88:91]
v_mfma_f32_16x16x32_bf16 v[88:91], a[80:83], a[152:155], v[88:91]
buffer_load_dwordx4 v5, s[8:11], s64 offen lds
v_mfma_f32_16x16x32_bf16 v[92:95], a[88:91], a[152:155], v[92:95]
ds_read_b64_tr_b16 a[168:169], v12 offset:49152
ds_read_b64_tr_b16 a[170:171], v12 offset:49664
v_mfma_f32_16x16x32_bf16 v[92:95], a[92:95], a[156:159], v[92:95]
v_mfma_f32_16x16x32_bf16 v[84:87], a[92:95], a[148:151], v[84:87]
v_mfma_f32_16x16x32_bf16 v[84:87], a[88:91], a[144:147], v[84:87]
v_mfma_f32_16x16x32_bf16 v[76:79], a[88:91], a[136:139], v[76:79]
buffer_load_dwordx4 v6, s[8:11], s64 offen offset:1024 lds
v_mfma_f32_16x16x32_bf16 v[76:79], a[92:95], a[140:143], v[76:79]
ds_read_b128 a[116:119], v10 offset:12288
v_mfma_f32_16x16x32_bf16 v[68:71], a[92:95], a[132:135], v[68:71]
v_mfma_f32_16x16x32_bf16 v[68:71], a[88:91], a[128:131], v[68:71]
s_add_u32 m0, s73, 2048
s_add_u32 s64, s71, 16384
s_waitcnt lgkmcnt(6)
v_mfma_f32_16x16x32_bf16 v[96:99], a[96:99], a[128:131], v[96:99]
ds_read_b64_tr_b16 a[172:173], v12 offset:57344
ds_read_b64_tr_b16 a[174:175], v12 offset:57856
v_mfma_f32_16x16x32_bf16 v[96:99], a[100:103], a[132:135], v[96:99]
buffer_load_dwordx4 v5, s[8:11], s64 offen lds
v_mfma_f32_16x16x32_bf16 v[104:107], a[100:103], a[140:143], v[104:107]
ds_read_b128 a[120:123], v9 offset:14336
v_mfma_f32_16x16x32_bf16 v[104:107], a[96:99], a[136:139], v[104:107]
v_mfma_f32_16x16x32_bf16 v[112:115], a[96:99], a[144:147], v[112:115]
v_mfma_f32_16x16x32_bf16 v[112:115], a[100:103], a[148:151], v[112:115]
buffer_load_dwordx4 v6, s[8:11], s64 offen offset:1024 lds
v_mfma_f32_16x16x32_bf16 v[120:123], a[100:103], a[156:159], v[120:123]
s_xor_b32 s76, s75, 1572864
s_add_u32 s76, s74, s76
v_mfma_f32_16x16x32_bf16 v[120:123], a[96:99], a[152:155], v[120:123]
ds_read_b64_tr_b16 a[176:177], v13 offset:49152
ds_read_b64_tr_b16 a[178:179], v13 offset:49664
v_mfma_f32_16x16x32_bf16 v[124:127], a[104:107], a[152:155], v[124:127]
s_add_u32 m0, s77, 32768
s_add_u32 s64, s76, 0
v_mfma_f32_16x16x32_bf16 v[124:127], a[108:111], a[156:159], v[124:127]
ds_read_b128 a[124:127], v10 offset:14336
v_mfma_f32_16x16x32_bf16 v[116:119], a[108:111], a[148:151], v[116:119]
buffer_load_dwordx4 v7, s[56:59], s64 offen lds
v_mfma_f32_16x16x32_bf16 v[116:119], a[104:107], a[144:147], v[116:119]
s_waitcnt vmcnt(14)
v_add_u32 v9, 32768, v9
v_add_u32 v10, 32768, v10
v_mfma_f32_16x16x32_bf16 v[108:111], a[104:107], a[136:139], v[108:111]
ds_read_b64_tr_b16 a[180:181], v13 offset:57344
ds_read_b64_tr_b16 a[182:183], v13 offset:57856
v_mfma_f32_16x16x32_bf16 v[108:111], a[108:111], a[140:143], v[108:111]
buffer_store_dword v1, v0, s[40:43], s52 offen sc1
v_mfma_f32_16x16x32_bf16 v[100:103], a[108:111], a[132:135], v[100:103]
s_waitcnt lgkmcnt(2)
s_lshl2_add_u32 s55, s95, s3
s_lshl3_add_u32 s54, s55, s7
v_mfma_f32_16x16x32_bf16 v[100:103], a[104:107], a[128:131], v[100:103]
buffer_load_dwordx4 v8, s[56:59], s64 offen offset:1024 lds
v_mfma_f32_16x16x32_bf16 v[128:131], a[112:115], a[128:131], v[128:131]
s_mul_i32 s53, s54, 3072
ds_read_b64_tr_b16 a[184:185], v14 offset:49152
ds_read_b64_tr_b16 a[186:187], v14 offset:49664
v_mfma_f32_16x16x32_bf16 v[128:131], a[116:119], a[132:135], v[128:131]
s_mul_i32 s55, s55, 48
s_add_u32 s55, s55, s7
s_lshl_b32 s55, s55, 10
v_mfma_f32_16x16x32_bf16 v[136:139], a[116:119], a[140:143], v[136:139]
s_add_u32 m0, s77, 34816
s_add_u32 s64, s76, 131072
v_min_u32 v20, 23, v1
v_mfma_f32_16x16x32_bf16 v[136:139], a[112:115], a[136:139], v[136:139]
ds_read_b64_tr_b16 a[188:189], v14 offset:57344
ds_read_b64_tr_b16 a[190:191], v14 offset:57856
v_mfma_f32_16x16x32_bf16 v[144:147], a[112:115], a[144:147], v[144:147]
buffer_load_dwordx4 v7, s[56:59], s64 offen lds
v_mfma_f32_16x16x32_bf16 v[144:147], a[116:119], a[148:151], v[144:147]
v_lshrrev_b32 v21, 3, v20
v_mul_u32_u24 v21, 7168, v21
v_mfma_f32_16x16x32_bf16 v[152:155], a[116:119], a[156:159], v[152:155]
v_lshlrev_b32 v20, 7, v20
v_add_u32 v21, v21, v20
v_mfma_f32_16x16x32_bf16 v[152:155], a[112:115], a[152:155], v[152:155]
v_mfma_f32_16x16x32_bf16 v[156:159], a[120:123], a[152:155], v[156:159]
v_mfma_f32_16x16x32_bf16 v[156:159], a[124:127], a[156:159], v[156:159]
buffer_load_dwordx4 v8, s[56:59], s64 offen offset:1024 lds
v_mfma_f32_16x16x32_bf16 v[148:151], a[124:127], a[148:151], v[148:151]
v_mfma_f32_16x16x32_bf16 v[148:151], a[120:123], a[144:147], v[148:151]
v_mfma_f32_16x16x32_bf16 v[140:143], a[120:123], a[136:139], v[140:143]
v_mfma_f32_16x16x32_bf16 v[140:143], a[124:127], a[140:143], v[140:143]
v_mfma_f32_16x16x32_bf16 v[132:135], a[124:127], a[132:135], v[132:135]
v_mfma_f32_16x16x32_bf16 v[132:135], a[120:123], a[128:131], v[132:135]
s_waitcnt lgkmcnt(0)
v_mfma_f32_16x16x32_bf16 v[160:163], a[160:163], a[64:67], v[160:163]
s_waitcnt vmcnt(13)
v_mfma_f32_16x16x32_bf16 v[160:163], a[164:167], a[68:71], v[160:163]
s_barrier
v_mfma_f32_16x16x32_bf16 v[164:167], a[172:175], a[68:71], v[164:167]
ds_read_b64_tr_b16 a[128:129], v11 offset:0
ds_read_b64_tr_b16 a[130:131], v11 offset:512
v_mfma_f32_16x16x32_bf16 v[164:167], a[168:171], a[64:67], v[164:167]
s_add_u32 m0, s73, 4096
s_add_u32 s64, s71, 524288
v_mfma_f32_16x16x32_bf16 v[168:171], a[176:179], a[64:67], v[168:171]
buffer_load_dwordx4 v5, s[8:11], s64 offen lds
v_mfma_f32_16x16x32_bf16 v[168:171], a[180:183], a[68:71], v[168:171]
v_mfma_f32_16x16x32_bf16 v[172:175], a[188:191], a[68:71], v[172:175]
v_mfma_f32_16x16x32_bf16 v[172:175], a[184:187], a[64:67], v[172:175]
ds_read_b128 a[64:67], v9 offset:0
v_mfma_f32_16x16x32_bf16 v[188:191], a[184:187], a[72:75], v[188:191]
buffer_load_dwordx4 v6, s[8:11], s64 offen offset:1024 lds
v_mfma_f32_16x16x32_bf16 v[188:191], a[188:191], a[76:79], v[188:191]
ds_read_b64_tr_b16 a[132:133], v11 offset:8192
ds_read_b64_tr_b16 a[134:135], v11 offset:8704
v_mfma_f32_16x16x32_bf16 v[184:187], a[180:183], a[76:79], v[184:187]
v_mfma_f32_16x16x32_bf16 v[184:187], a[176:179], a[72:75], v[184:187]
s_add_u32 m0, s73, 6144
s_add_u32 s64, s71, 540672
ds_read_b128 a[68:71], v10 offset:0
v_mfma_f32_16x16x32_bf16 v[180:183], a[168:171], a[72:75], v[180:183]
v_mfma_f32_16x16x32_bf16 v[180:183], a[172:175], a[76:79], v[180:183]
buffer_load_dwordx4 v5, s[8:11], s64 offen lds
v_mfma_f32_16x16x32_bf16 v[176:179], a[164:167], a[76:79], v[176:179]
v_mfma_f32_16x16x32_bf16 v[176:179], a[160:163], a[72:75], v[176:179]
ds_read_b64_tr_b16 a[136:137], v12 offset:0
ds_read_b64_tr_b16 a[138:139], v12 offset:512
v_mfma_f32_16x16x32_bf16 v[192:195], a[160:163], a[80:83], v[192:195]
v_mfma_f32_16x16x32_bf16 v[192:195], a[164:167], a[84:87], v[192:195]
v_mfma_f32_16x16x32_bf16 v[196:199], a[172:175], a[84:87], v[196:199]
buffer_load_dwordx4 v6, s[8:11], s64 offen offset:1024 lds
v_mfma_f32_16x16x32_bf16 v[196:199], a[168:171], a[80:83], v[196:199]
ds_read_b128 a[72:75], v9 offset:2048
v_mfma_f32_16x16x32_bf16 v[200:203], a[176:179], a[80:83], v[200:203]
v_mfma_f32_16x16x32_bf16 v[200:203], a[180:183], a[84:87], v[200:203]
s_add_u32 m0, s77, 49152
s_add_u32 s64, s76, 0
v_mfma_f32_16x16x32_bf16 v[204:207], a[188:191], a[84:87], v[204:207]
ds_read_b64_tr_b16 a[140:141], v12 offset:8192
ds_read_b64_tr_b16 a[142:143], v12 offset:8704
v_mfma_f32_16x16x32_bf16 v[204:207], a[184:187], a[80:83], v[204:207]
buffer_load_dwordx4 v7, s[16:19], s64 offen lds
v_mfma_f32_16x16x32_bf16 v[220:223], a[184:187], a[88:91], v[220:223]
ds_read_b128 a[76:79], v10 offset:2048
v_mfma_f32_16x16x32_bf16 v[220:223], a[188:191], a[92:95], v[220:223]
v_mfma_f32_16x16x32_bf16 v[216:219], a[180:183], a[92:95], v[216:219]
v_mfma_f32_16x16x32_bf16 v[216:219], a[176:179], a[88:91], v[216:219]
v_mfma_f32_16x16x32_bf16 v[212:215], a[168:171], a[88:91], v[212:215]
buffer_load_dwordx4 v8, s[16:19], s64 offen offset:1024 lds
v_mfma_f32_16x16x32_bf16 v[212:215], a[172:175], a[92:95], v[212:215]
ds_read_b64_tr_b16 a[144:145], v13 offset:0
ds_read_b64_tr_b16 a[146:147], v13 offset:512
v_mfma_f32_16x16x32_bf16 v[208:211], a[164:167], a[92:95], v[208:211]
v_mfma_f32_16x16x32_bf16 v[208:211], a[160:163], a[88:91], v[208:211]
s_add_u32 m0, s77, 51200
s_add_u32 s64, s76, 131072
ds_read_b128 a[80:83], v9 offset:4096
v_mfma_f32_16x16x32_bf16 v[224:227], a[160:163], a[96:99], v[224:227]
v_mfma_f32_16x16x32_bf16 v[224:227], a[164:167], a[100:103], v[224:227]
buffer_load_dwordx4 v7, s[16:19], s64 offen lds
v_mfma_f32_16x16x32_bf16 v[228:231], a[172:175], a[100:103], v[228:231]
ds_read_b64_tr_b16 a[148:149], v13 offset:8192
ds_read_b64_tr_b16 a[150:151], v13 offset:8704
v_mfma_f32_16x16x32_bf16 v[228:231], a[168:171], a[96:99], v[228:231]
v_mfma_f32_16x16x32_bf16 v[232:235], a[176:179], a[96:99], v[232:235]
v_mfma_f32_16x16x32_bf16 v[232:235], a[180:183], a[100:103], v[232:235]
buffer_load_dwordx4 v8, s[16:19], s64 offen offset:1024 lds
v_mfma_f32_16x16x32_bf16 v[236:239], a[188:191], a[100:103], v[236:239]
s_xor_b32 s71, s70, 512
s_add_u32 s71, s68, s71
ds_read_b128 a[84:87], v10 offset:4096
v_mfma_f32_16x16x32_bf16 v[236:239], a[184:187], a[96:99], v[236:239]
v_mfma_f32_16x16x32_bf16 v[252:255], a[184:187], a[104:107], v[252:255]
s_add_u32 m0, s73, 32768
s_add_u32 s64, s71, 0
v_mfma_f32_16x16x32_bf16 v[252:255], a[188:191], a[108:111], v[252:255]
ds_read_b64_tr_b16 a[152:153], v14 offset:0
ds_read_b64_tr_b16 a[154:155], v14 offset:512
v_mfma_f32_16x16x32_bf16 v[248:251], a[180:183], a[108:111], v[248:251]
buffer_load_dwordx4 v5, s[8:11], s64 offen lds
v_mfma_f32_16x16x32_bf16 v[248:251], a[176:179], a[104:107], v[248:251]
v_mfma_f32_16x16x32_bf16 v[244:247], a[168:171], a[104:107], v[244:247]
ds_read_b128 a[88:91], v9 offset:6144
v_mfma_f32_16x16x32_bf16 v[244:247], a[172:175], a[108:111], v[244:247]
v_mfma_f32_16x16x32_bf16 v[240:243], a[164:167], a[108:111], v[240:243]
v_mfma_f32_16x16x32_bf16 v[240:243], a[160:163], a[104:107], v[240:243]
buffer_load_dwordx4 v6, s[8:11], s64 offen offset:1024 lds
v_mfma_f32_16x16x32_bf16 a[0:3], a[160:163], a[112:115], a[0:3]
ds_read_b64_tr_b16 a[156:157], v14 offset:8192
ds_read_b64_tr_b16 a[158:159], v14 offset:8704
v_mfma_f32_16x16x32_bf16 a[0:3], a[164:167], a[116:119], a[0:3]
v_mfma_f32_16x16x32_bf16 a[4:7], a[172:175], a[116:119], a[4:7]
s_add_u32 m0, s73, 34816
s_add_u32 s64, s71, 16384
ds_read_b128 a[92:95], v10 offset:6144
v_mfma_f32_16x16x32_bf16 a[4:7], a[168:171], a[112:115], a[4:7]
v_mfma_f32_16x16x32_bf16 a[8:11], a[176:179], a[112:115], a[8:11]
buffer_load_dwordx4 v5, s[8:11], s64 offen lds
v_mfma_f32_16x16x32_bf16 a[8:11], a[180:183], a[116:119], a[8:11]
v_mfma_f32_16x16x32_bf16 a[12:15], a[188:191], a[116:119], a[12:15]
v_mfma_f32_16x16x32_bf16 a[12:15], a[184:187], a[112:115], a[12:15]
v_mfma_f32_16x16x32_bf16 a[28:31], a[184:187], a[120:123], a[28:31]
v_mfma_f32_16x16x32_bf16 a[28:31], a[188:191], a[124:127], a[28:31]
buffer_load_dwordx4 v6, s[8:11], s64 offen offset:1024 lds
v_mfma_f32_16x16x32_bf16 a[24:27], a[180:183], a[124:127], a[24:27]
v_mfma_f32_16x16x32_bf16 a[24:27], a[176:179], a[120:123], a[24:27]
v_mfma_f32_16x16x32_bf16 a[20:23], a[168:171], a[120:123], a[20:23]
v_mfma_f32_16x16x32_bf16 a[20:23], a[172:175], a[124:127], a[20:23]
v_mfma_f32_16x16x32_bf16 a[16:19], a[164:167], a[124:127], a[16:19]
v_mfma_f32_16x16x32_bf16 a[16:19], a[160:163], a[120:123], a[16:19]
s_waitcnt lgkmcnt(0)
v_mfma_f32_16x16x32_bf16 v[32:35], a[64:67], a[128:131], v[32:35]
s_waitcnt vmcnt(21)
v_mfma_f32_16x16x32_bf16 v[32:35], a[68:71], a[132:135], v[32:35]
s_barrier
v_mfma_f32_16x16x32_bf16 v[40:43], a[68:71], a[140:143], v[40:43]
s_add_u32 s52, s81, 0
ds_read_b128 a[96:99], v9 offset:8192
v_mfma_f32_16x16x32_bf16 v[40:43], a[64:67], a[136:139], v[40:43]
s_xor_b32 s76, s75, 2097152
s_add_u32 s76, s74, s76
v_mfma_f32_16x16x32_bf16 v[48:51], a[64:67], a[144:147], v[48:51]
s_add_u32 m0, s77, 0
s_add_u32 s64, s76, 0
v_mfma_f32_16x16x32_bf16 v[48:51], a[68:71], a[148:151], v[48:51]
buffer_load_dwordx4 v7, s[56:59], s64 offen lds
v_mfma_f32_16x16x32_bf16 v[56:59], a[68:71], a[156:159], v[56:59]
ds_read_b128 a[100:103], v10 offset:8192
v_mfma_f32_16x16x32_bf16 v[56:59], a[64:67], a[152:155], v[56:59]
buffer_load_dwordx2 a[192:193], v26, s[28:31], s52 offen
v_mfma_f32_16x16x32_bf16 v[60:63], a[72:75], a[152:155], v[60:63]
ds_read_b128 a[104:107], v9 offset:10240
v_mfma_f32_16x16x32_bf16 v[60:63], a[76:79], a[156:159], v[60:63]
v_mfma_f32_16x16x32_bf16 v[52:55], a[76:79], a[148:151], v[52:55]
s_add_u32 s52, s81, 3456
v_mfma_f32_16x16x32_bf16 v[52:55], a[72:75], a[144:147], v[52:55]
buffer_load_dwordx4 v8, s[56:59], s64 offen offset:1024 lds
v_mfma_f32_16x16x32_bf16 v[44:47], a[72:75], a[136:139], v[44:47]
ds_read_b64_tr_b16 a[160:161], v11 offset:16384
ds_read_b64_tr_b16 a[162:163], v11 offset:16896
v_mfma_f32_16x16x32_bf16 v[44:47], a[76:79], a[140:143], v[44:47]
buffer_load_dwordx2 a[194:195], v26, s[28:31], s52 offen
v_mfma_f32_16x16x32_bf16 v[36:39], a[76:79], a[132:135], v[36:39]
v_mfma_f32_16x16x32_bf16 v[36:39], a[72:75], a[128:131], v[36:39]
ds_read_b128 a[108:111], v10 offset:10240
v_mfma_f32_16x16x32_bf16 v[64:67], a[80:83], a[128:131], v[64:67]
s_add_u32 m0, s77, 2048
s_add_u32 s64, s76, 131072
s_add_u32 s52, s81, 6912
v_mfma_f32_16x16x32_bf16 v[64:67], a[84:87], a[132:135], v[64:67]
buffer_load_dwordx2 a[196:197], v26, s[28:31], s52 offen
v_mfma_f32_16x16x32_bf16 v[72:75], a[84:87], a[140:143], v[72:75]
buffer_load_dwordx4 v7, s[56:59], s64 offen lds
v_mfma_f32_16x16x32_bf16 v[72:75], a[80:83], a[136:139], v[72:75]
ds_read_b64_tr_b16 a[164:165], v11 offset:24576
ds_read_b64_tr_b16 a[166:167], v11 offset:25088
v_mfma_f32_16x16x32_bf16 v[80:83], a[80:83], a[144:147], v[80:83]
s_add_u32 s52, s81, 10368
v_mfma_f32_16x16x32_bf16 v[80:83], a[84:87], a[148:151], v[80:83]
ds_read_b128 a[112:115], v9 offset:12288
v_mfma_f32_16x16x32_bf16 v[88:91], a[84:87], a[156:159], v[88:91]
buffer_load_dwordx2 a[198:199], v26, s[28:31], s52 offen
v_mfma_f32_16x16x32_bf16 v[88:91], a[80:83], a[152:155], v[88:91]
v_mfma_f32_16x16x32_bf16 v[92:95], a[88:91], a[152:155], v[92:95]
ds_read_b64_tr_b16 a[168:169], v12 offset:16384
ds_read_b64_tr_b16 a[170:171], v12 offset:16896
v_mfma_f32_16x16x32_bf16 v[92:95], a[92:95], a[156:159], v[92:95]
buffer_load_dwordx4 v8, s[56:59], s64 offen offset:1024 lds
v_mfma_f32_16x16x32_bf16 v[84:87], a[92:95], a[148:151], v[84:87]
s_add_u32 s52, s81, 13824
v_mfma_f32_16x16x32_bf16 v[84:87], a[88:91], a[144:147], v[84:87]
buffer_load_dwordx2 a[200:201], v26, s[28:31], s52 offen
v_mfma_f32_16x16x32_bf16 v[76:79], a[88:91], a[136:139], v[76:79]
ds_read_b128 a[116:119], v10 offset:12288
v_mfma_f32_16x16x32_bf16 v[76:79], a[92:95], a[140:143], v[76:79]
v_mfma_f32_16x16x32_bf16 v[68:71], a[92:95], a[132:135], v[68:71]
s_add_u32 s52, s81, 17280
v_mfma_f32_16x16x32_bf16 v[68:71], a[88:91], a[128:131], v[68:71]
s_add_u32 m0, s73, 36864
s_add_u32 s64, s71, 524288
s_waitcnt lgkmcnt(6)
v_mfma_f32_16x16x32_bf16 v[96:99], a[96:99], a[128:131], v[96:99]
ds_read_b64_tr_b16 a[172:173], v12 offset:24576
ds_read_b64_tr_b16 a[174:175], v12 offset:25088
v_mfma_f32_16x16x32_bf16 v[96:99], a[100:103], a[132:135], v[96:99]
buffer_load_dwordx4 v5, s[8:11], s64 offen lds
v_mfma_f32_16x16x32_bf16 v[104:107], a[100:103], a[140:143], v[104:107]
ds_read_b128 a[120:123], v9 offset:14336
v_mfma_f32_16x16x32_bf16 v[104:107], a[96:99], a[136:139], v[104:107]
buffer_load_dwordx2 a[202:203], v26, s[28:31], s52 offen
v_mfma_f32_16x16x32_bf16 v[112:115], a[96:99], a[144:147], v[112:115]
v_mfma_f32_16x16x32_bf16 v[112:115], a[100:103], a[148:151], v[112:115]
ds_read_b64_tr_b16 a[176:177], v13 offset:16384
ds_read_b64_tr_b16 a[178:179], v13 offset:16896
v_mfma_f32_16x16x32_bf16 v[120:123], a[100:103], a[156:159], v[120:123]
s_add_u32 s52, s81, 20736
v_mfma_f32_16x16x32_bf16 v[120:123], a[96:99], a[152:155], v[120:123]
buffer_load_dwordx2 a[204:205], v26, s[28:31], s52 offen
v_mfma_f32_16x16x32_bf16 v[124:127], a[104:107], a[152:155], v[124:127]
buffer_load_dwordx4 v6, s[8:11], s64 offen offset:1024 lds
v_mfma_f32_16x16x32_bf16 v[124:127], a[108:111], a[156:159], v[124:127]
ds_read_b128 a[124:127], v10 offset:14336
v_mfma_f32_16x16x32_bf16 v[116:119], a[108:111], a[148:151], v[116:119]
s_add_u32 s52, s81, 24192
v_add_u32 v9, -65536, v9
v_add_u32 v10, -65536, v10
v_mfma_f32_16x16x32_bf16 v[116:119], a[104:107], a[144:147], v[116:119]
buffer_load_dwordx2 a[206:207], v26, s[28:31], s52 offen
v_mfma_f32_16x16x32_bf16 v[108:111], a[104:107], a[136:139], v[108:111]
ds_read_b64_tr_b16 a[180:181], v13 offset:24576
ds_read_b64_tr_b16 a[182:183], v13 offset:25088
v_mfma_f32_16x16x32_bf16 v[108:111], a[108:111], a[140:143], v[108:111]
s_add_u32 m0, s73, 38912
s_add_u32 s64, s71, 540672
v_mfma_f32_16x16x32_bf16 v[100:103], a[108:111], a[132:135], v[100:103]
s_waitcnt lgkmcnt(2)
v_mfma_f32_16x16x32_bf16 v[100:103], a[104:107], a[128:131], v[100:103]
buffer_load_dwordx4 v5, s[8:11], s64 offen lds
v_mfma_f32_16x16x32_bf16 v[128:131], a[112:115], a[128:131], v[128:131]
ds_read_b64_tr_b16 a[184:185], v14 offset:16384
ds_read_b64_tr_b16 a[186:187], v14 offset:16896
v_mfma_f32_16x16x32_bf16 v[128:131], a[116:119], a[132:135], v[128:131]
buffer_load_dwordx4 a[208:211], v27, s[36:39], s83 offen
v_mfma_f32_16x16x32_bf16 v[136:139], a[116:119], a[140:143], v[136:139]
ds_read_b64_tr_b16 a[188:189], v14 offset:24576
ds_read_b64_tr_b16 a[190:191], v14 offset:25088
v_mfma_f32_16x16x32_bf16 v[136:139], a[112:115], a[136:139], v[136:139]
v_mfma_f32_16x16x32_bf16 v[144:147], a[112:115], a[144:147], v[144:147]
v_mfma_f32_16x16x32_bf16 v[144:147], a[116:119], a[148:151], v[144:147]
v_mfma_f32_16x16x32_bf16 v[152:155], a[116:119], a[156:159], v[152:155]
buffer_load_dwordx4 v6, s[8:11], s64 offen offset:1024 lds
v_mfma_f32_16x16x32_bf16 v[152:155], a[112:115], a[152:155], v[152:155]
v_mfma_f32_16x16x32_bf16 v[156:159], a[120:123], a[152:155], v[156:159]
v_mfma_f32_16x16x32_bf16 v[156:159], a[124:127], a[156:159], v[156:159]
v_mfma_f32_16x16x32_bf16 v[148:151], a[124:127], a[148:151], v[148:151]
v_mfma_f32_16x16x32_bf16 v[148:151], a[120:123], a[144:147], v[148:151]
v_mfma_f32_16x16x32_bf16 v[140:143], a[120:123], a[136:139], v[140:143]
v_mfma_f32_16x16x32_bf16 v[140:143], a[124:127], a[140:143], v[140:143]
v_mfma_f32_16x16x32_bf16 v[132:135], a[124:127], a[132:135], v[132:135]
v_mfma_f32_16x16x32_bf16 v[132:135], a[120:123], a[128:131], v[132:135]
s_waitcnt lgkmcnt(0)
v_mfma_f32_16x16x32_bf16 v[160:163], a[160:163], a[64:67], v[160:163]
s_waitcnt vmcnt(25)
v_mfma_f32_16x16x32_bf16 v[160:163], a[164:167], a[68:71], v[160:163]
s_barrier
v_mfma_f32_16x16x32_bf16 v[164:167], a[172:175], a[68:71], v[164:167]
ds_read_b64_tr_b16 a[128:129], v11 offset:32768
ds_read_b64_tr_b16 a[130:131], v11 offset:33280
v_mfma_f32_16x16x32_bf16 v[164:167], a[168:171], a[64:67], v[164:167]
s_add_u32 m0, s77, 16384
s_add_u32 s64, s76, 0
v_mfma_f32_16x16x32_bf16 v[168:171], a[176:179], a[64:67], v[168:171]
buffer_load_dwordx4 v7, s[16:19], s64 offen lds
v_mfma_f32_16x16x32_bf16 v[168:171], a[180:183], a[68:71], v[168:171]
v_mfma_f32_16x16x32_bf16 v[172:175], a[188:191], a[68:71], v[172:175]
v_mfma_f32_16x16x32_bf16 v[172:175], a[184:187], a[64:67], v[172:175]
ds_read_b128 a[64:67], v9 offset:0
v_mfma_f32_16x16x32_bf16 v[188:191], a[184:187], a[72:75], v[188:191]
L_PAD1:
s_cbranch_execz L_PAD5
ds_read_b64_tr_b16 a[132:133], v11 offset:40960
ds_read_b64_tr_b16 a[134:135], v11 offset:41472
v_mfma_f32_16x16x32_bf16 v[188:191], a[188:191], a[76:79], v[188:191]
v_mfma_f32_16x16x32_bf16 v[184:187], a[180:183], a[76:79], v[184:187]
v_mfma_f32_16x16x32_bf16 v[184:187], a[176:179], a[72:75], v[184:187]
buffer_load_dwordx4 v8, s[16:19], s64 offen offset:1024 lds
v_mfma_f32_16x16x32_bf16 v[180:183], a[168:171], a[72:75], v[180:183]
ds_read_b128 a[68:71], v10 offset:0
v_mfma_f32_16x16x32_bf16 v[180:183], a[172:175], a[76:79], v[180:183]
v_mfma_f32_16x16x32_bf16 v[176:179], a[164:167], a[76:79], v[176:179]
v_mfma_f32_16x16x32_bf16 v[176:179], a[160:163], a[72:75], v[176:179]
ds_read_b64_tr_b16 a[136:137], v12 offset:32768
ds_read_b64_tr_b16 a[138:139], v12 offset:33280
v_mfma_f32_16x16x32_bf16 v[192:195], a[160:163], a[80:83], v[192:195]
s_add_u32 m0, s77, 18432
s_add_u32 s64, s76, 131072
v_mfma_f32_16x16x32_bf16 v[192:195], a[164:167], a[84:87], v[192:195]
v_mfma_f32_16x16x32_bf16 v[196:199], a[172:175], a[84:87], v[196:199]
buffer_load_dwordx4 v7, s[16:19], s64 offen lds
v_mfma_f32_16x16x32_bf16 v[196:199], a[168:171], a[80:83], v[196:199]
ds_read_b128 a[72:75], v9 offset:2048
v_mfma_f32_16x16x32_bf16 v[200:203], a[176:179], a[80:83], v[200:203]
v_mfma_f32_16x16x32_bf16 v[200:203], a[180:183], a[84:87], v[200:203]
ds_read_b64_tr_b16 a[140:141], v12 offset:40960
ds_read_b64_tr_b16 a[142:143], v12 offset:41472
v_mfma_f32_16x16x32_bf16 v[204:207], a[188:191], a[84:87], v[204:207]
v_mfma_f32_16x16x32_bf16 v[204:207], a[184:187], a[80:83], v[204:207]
v_mfma_f32_16x16x32_bf16 v[220:223], a[184:187], a[88:91], v[220:223]
ds_read_b128 a[76:79], v10 offset:2048
v_mfma_f32_16x16x32_bf16 v[220:223], a[188:191], a[92:95], v[220:223]
buffer_load_dwordx4 v8, s[16:19], s64 offen offset:1024 lds
v_mfma_f32_16x16x32_bf16 v[216:219], a[180:183], a[92:95], v[216:219]
s_xor_b32 s71, s70, 640
s_add_u32 s71, s68, s71
v_mfma_f32_16x16x32_bf16 v[216:219], a[176:179], a[88:91], v[216:219]
v_mfma_f32_16x16x32_bf16 v[212:215], a[168:171], a[88:91], v[212:215]
ds_read_b64_tr_b16 a[144:145], v13 offset:32768
ds_read_b64_tr_b16 a[146:147], v13 offset:33280
v_mfma_f32_16x16x32_bf16 v[212:215], a[172:175], a[92:95], v[212:215]
v_mfma_f32_16x16x32_bf16 v[208:211], a[164:167], a[92:95], v[208:211]
v_mfma_f32_16x16x32_bf16 v[208:211], a[160:163], a[88:91], v[208:211]
s_add_u32 m0, s73, 65536
s_add_u32 s64, s71, 0
ds_read_b128 a[80:83], v9 offset:4096
v_mfma_f32_16x16x32_bf16 v[224:227], a[160:163], a[96:99], v[224:227]
v_mfma_f32_16x16x32_bf16 v[224:227], a[164:167], a[100:103], v[224:227]
buffer_load_dwordx4 v5, s[8:11], s64 offen lds
v_mfma_f32_16x16x32_bf16 v[228:231], a[172:175], a[100:103], v[228:231]
ds_read_b64_tr_b16 a[148:149], v13 offset:40960
ds_read_b64_tr_b16 a[150:151], v13 offset:41472
v_mfma_f32_16x16x32_bf16 v[228:231], a[168:171], a[96:99], v[228:231]
v_mfma_f32_16x16x32_bf16 v[232:235], a[176:179], a[96:99], v[232:235]
v_mfma_f32_16x16x32_bf16 v[232:235], a[180:183], a[100:103], v[232:235]
ds_read_b128 a[84:87], v10 offset:4096
v_mfma_f32_16x16x32_bf16 v[236:239], a[188:191], a[100:103], v[236:239]
v_mfma_f32_16x16x32_bf16 v[236:239], a[184:187], a[96:99], v[236:239]
v_mfma_f32_16x16x32_bf16 v[252:255], a[184:187], a[104:107], v[252:255]
buffer_load_dwordx4 v6, s[8:11], s64 offen offset:1024 lds
v_mfma_f32_16x16x32_bf16 v[252:255], a[188:191], a[108:111], v[252:255]
ds_read_b64_tr_b16 a[152:153], v14 offset:32768
ds_read_b64_tr_b16 a[154:155], v14 offset:33280
v_mfma_f32_16x16x32_bf16 v[248:251], a[180:183], a[108:111], v[248:251]
v_mfma_f32_16x16x32_bf16 v[248:251], a[176:179], a[104:107], v[248:251]
v_mfma_f32_16x16x32_bf16 v[244:247], a[168:171], a[104:107], v[244:247]
ds_read_b128 a[88:91], v9 offset:6144
v_mfma_f32_16x16x32_bf16 v[244:247], a[172:175], a[108:111], v[244:247]
s_add_u32 m0, s73, 67584
s_add_u32 s64, s71, 16384
v_mfma_f32_16x16x32_bf16 v[240:243], a[164:167], a[108:111], v[240:243]
v_mfma_f32_16x16x32_bf16 v[240:243], a[160:163], a[104:107], v[240:243]
buffer_load_dwordx4 v5, s[8:11], s64 offen lds
v_mfma_f32_16x16x32_bf16 a[0:3], a[160:163], a[112:115], a[0:3]
ds_read_b64_tr_b16 a[156:157], v14 offset:40960
ds_read_b64_tr_b16 a[158:159], v14 offset:41472
v_mfma_f32_16x16x32_bf16 a[0:3], a[164:167], a[116:119], a[0:3]
v_mfma_f32_16x16x32_bf16 a[4:7], a[172:175], a[116:119], a[4:7]
ds_read_b128 a[92:95], v10 offset:6144
v_mfma_f32_16x16x32_bf16 a[4:7], a[168:171], a[112:115], a[4:7]
v_mfma_f32_16x16x32_bf16 a[8:11], a[176:179], a[112:115], a[8:11]
v_mfma_f32_16x16x32_bf16 a[8:11], a[180:183], a[116:119], a[8:11]
v_mfma_f32_16x16x32_bf16 a[12:15], a[188:191], a[116:119], a[12:15]
buffer_load_dwordx4 v6, s[8:11], s64 offen offset:1024 lds
v_mfma_f32_16x16x32_bf16 a[12:15], a[184:187], a[112:115], a[12:15]
v_mfma_f32_16x16x32_bf16 a[28:31], a[184:187], a[120:123], a[28:31]
v_mfma_f32_16x16x32_bf16 a[28:31], a[188:191], a[124:127], a[28:31]
v_mfma_f32_16x16x32_bf16 a[24:27], a[180:183], a[124:127], a[24:27]
v_mfma_f32_16x16x32_bf16 a[24:27], a[176:179], a[120:123], a[24:27]
v_mfma_f32_16x16x32_bf16 a[20:23], a[168:171], a[120:123], a[20:23]
v_mfma_f32_16x16x32_bf16 a[20:23], a[172:175], a[124:127], a[20:23]
v_mfma_f32_16x16x32_bf16 a[16:19], a[164:167], a[124:127], a[16:19]
v_mfma_f32_16x16x32_bf16 a[16:19], a[160:163], a[120:123], a[16:19]
s_waitcnt lgkmcnt(0)
v_mfma_f32_16x16x32_bf16 v[32:35], a[64:67], a[128:131], v[32:35]
s_waitcnt vmcnt(29)
v_mfma_f32_16x16x32_bf16 v[32:35], a[68:71], a[132:135], v[32:35]
s_barrier
v_mfma_f32_16x16x32_bf16 v[40:43], a[68:71], a[140:143], v[40:43]
ds_read_b128 a[96:99], v9 offset:8192
v_mfma_f32_16x16x32_bf16 v[40:43], a[64:67], a[136:139], v[40:43]
s_xor_b32 s76, s75, 2621440
s_add_u32 s76, s74, s76
v_mfma_f32_16x16x32_bf16 v[48:51], a[64:67], a[144:147], v[48:51]
s_add_u32 m0, s77, 32768
s_add_u32 s64, s76, 0
v_mfma_f32_16x16x32_bf16 v[48:51], a[68:71], a[148:151], v[48:51]
buffer_load_dwordx4 v7, s[56:59], s64 offen lds
v_mfma_f32_16x16x32_bf16 v[56:59], a[68:71], a[156:159], v[56:59]
ds_read_b128 a[100:103], v10 offset:8192
v_mfma_f32_16x16x32_bf16 v[56:59], a[64:67], a[152:155], v[56:59]
v_mfma_f32_16x16x32_bf16 v[60:63], a[72:75], a[152:155], v[60:63]
ds_read_b128 a[104:107], v9 offset:10240
v_mfma_f32_16x16x32_bf16 v[60:63], a[76:79], a[156:159], v[60:63]
v_mfma_f32_16x16x32_bf16 v[52:55], a[76:79], a[148:151], v[52:55]
v_mfma_f32_16x16x32_bf16 v[52:55], a[72:75], a[144:147], v[52:55]
buffer_load_dwordx4 v8, s[56:59], s64 offen offset:1024 lds
v_mfma_f32_16x16x32_bf16 v[44:47], a[72:75], a[136:139], v[44:47]
ds_read_b64_tr_b16 a[160:161], v11 offset:49152
ds_read_b64_tr_b16 a[162:163], v11 offset:49664
v_mfma_f32_16x16x32_bf16 v[44:47], a[76:79], a[140:143], v[44:47]
v_mfma_f32_16x16x32_bf16 v[36:39], a[76:79], a[132:135], v[36:39]
v_mfma_f32_16x16x32_bf16 v[36:39], a[72:75], a[128:131], v[36:39]
ds_read_b128 a[108:111], v10 offset:10240
v_mfma_f32_16x16x32_bf16 v[64:67], a[80:83], a[128:131], v[64:67]
s_add_u32 m0, s77, 34816
s_add_u32 s64, s76, 131072
v_mfma_f32_16x16x32_bf16 v[64:67], a[84:87], a[132:135], v[64:67]
v_mfma_f32_16x16x32_bf16 v[72:75], a[84:87], a[140:143], v[72:75]
buffer_load_dwordx4 v7, s[56:59], s64 offen lds
v_mfma_f32_16x16x32_bf16 v[72:75], a[80:83], a[136:139], v[72:75]
ds_read_b64_tr_b16 a[164:165], v11 offset:57344
ds_read_b64_tr_b16 a[166:167], v11 offset:57856
v_mfma_f32_16x16x32_bf16 v[80:83], a[80:83], a[144:147], v[80:83]
v_mfma_f32_16x16x32_bf16 v[80:83], a[84:87], a[148:151], v[80:83]
s_waitcnt vmcnt(12)
ds_read_b128 a[112:115], v9 offset:12288
v_mfma_f32_16x16x32_bf16 v[88:91], a[84:87], a[156:159], v[88:91]
v_mfma_f32_16x16x32_bf16 v[88:91], a[80:83], a[152:155], v[88:91]
v_accvgpr_read_b32 v16, a192
v_accvgpr_read_b32 v17, a194
v_mfma_f32_16x16x32_bf16 v[92:95], a[88:91], a[152:155], v[92:95]
ds_read_b64_tr_b16 a[168:169], v12 offset:49152
ds_read_b64_tr_b16 a[170:171], v12 offset:49664
v_mfma_f32_16x16x32_bf16 v[92:95], a[92:95], a[156:159], v[92:95]
buffer_load_dwordx4 v8, s[56:59], s64 offen offset:1024 lds
v_mfma_f32_16x16x32_bf16 v[84:87], a[92:95], a[148:151], v[84:87]
v_accvgpr_read_b32 v18, a196
v_accvgpr_read_b32 v19, a198
v_mfma_f32_16x16x32_bf16 v[84:87], a[88:91], a[144:147], v[84:87]
v_perm_b32 v24, v17, v16, s85
v_perm_b32 v25, v19, v18, s85
v_mfma_f32_16x16x32_bf16 v[76:79], a[88:91], a[136:139], v[76:79]
ds_read_b128 a[116:119], v10 offset:12288
v_perm_b32 v28, v17, v16, s86
v_mfma_f32_16x16x32_bf16 v[76:79], a[92:95], a[140:143], v[76:79]
v_perm_b32 v29, v19, v18, s86
v_accvgpr_read_b32 v16, a200
v_mfma_f32_16x16x32_bf16 v[68:71], a[92:95], a[132:135], v[68:71]
v_accvgpr_read_b32 v17, a202
v_accvgpr_read_b32 v18, a204
v_mfma_f32_16x16x32_bf16 v[68:71], a[88:91], a[128:131], v[68:71]
s_add_u32 m0, s73, 69632
s_add_u32 s64, s71, 524288
s_waitcnt lgkmcnt(6)
v_mfma_f32_16x16x32_bf16 v[96:99], a[96:99], a[128:131], v[96:99]
ds_read_b64_tr_b16 a[172:173], v12 offset:57344
ds_read_b64_tr_b16 a[174:175], v12 offset:57856
v_mfma_f32_16x16x32_bf16 v[96:99], a[100:103], a[132:135], v[96:99]
buffer_load_dwordx4 v5, s[8:11], s64 offen lds
v_mfma_f32_16x16x32_bf16 v[104:107], a[100:103], a[140:143], v[104:107]
ds_read_b128 a[120:123], v9 offset:14336
v_accvgpr_read_b32 v19, a206
v_mfma_f32_16x16x32_bf16 v[104:107], a[96:99], a[136:139], v[104:107]
v_perm_b32 v26, v17, v16, s85
v_perm_b32 v27, v19, v18, s85
v_mfma_f32_16x16x32_bf16 v[112:115], a[96:99], a[144:147], v[112:115]
v_perm_b32 v30, v17, v16, s86
v_perm_b32 v31, v19, v18, s86
v_mfma_f32_16x16x32_bf16 v[112:115], a[100:103], a[148:151], v[112:115]
ds_read_b64_tr_b16 a[176:177], v13 offset:49152
ds_read_b64_tr_b16 a[178:179], v13 offset:49664
v_mfma_f32_16x16x32_bf16 v[120:123], a[100:103], a[156:159], v[120:123]
v_accvgpr_read_b32 v16, a208
v_accvgpr_read_b32 v17, a209
v_mfma_f32_16x16x32_bf16 v[120:123], a[96:99], a[152:155], v[120:123]
v_accvgpr_read_b32 v18, a210
v_accvgpr_read_b32 v19, a211
v_mfma_f32_16x16x32_bf16 v[124:127], a[104:107], a[152:155], v[124:127]
buffer_load_dwordx4 v6, s[8:11], s64 offen offset:1024 lds
v_mfma_f32_16x16x32_bf16 v[124:127], a[108:111], a[156:159], v[124:127]
ds_read_b128 a[124:127], v10 offset:14336
v_or_b32 v24, v24, v16
v_mfma_f32_16x16x32_bf16 v[116:119], a[108:111], a[148:151], v[116:119]
v_add_u32 v9, 32768, v9
v_add_u32 v10, 32768, v10
v_mfma_f32_16x16x32_bf16 v[116:119], a[104:107], a[144:147], v[116:119]
v_or_b32 v25, v25, v17
v_or_b32 v26, v26, v18
v_mfma_f32_16x16x32_bf16 v[108:111], a[104:107], a[136:139], v[108:111]
ds_read_b64_tr_b16 a[180:181], v13 offset:57344
ds_read_b64_tr_b16 a[182:183], v13 offset:57856
v_mfma_f32_16x16x32_bf16 v[108:111], a[108:111], a[140:143], v[108:111]
s_add_u32 m0, s73, 71680
s_add_u32 s64, s71, 540672
v_or_b32 v27, v27, v19
v_mfma_f32_16x16x32_bf16 v[100:103], a[108:111], a[132:135], v[100:103]
s_waitcnt lgkmcnt(2)
v_mfma_f32_16x16x32_bf16 v[100:103], a[104:107], a[128:131], v[100:103]
buffer_load_dwordx4 v5, s[8:11], s64 offen lds
v_mfma_f32_16x16x32_bf16 v[128:131], a[112:115], a[128:131], v[128:131]
ds_read_b64_tr_b16 a[184:185], v14 offset:49152
ds_read_b64_tr_b16 a[186:187], v14 offset:49664
v_mfma_f32_16x16x32_bf16 v[128:131], a[116:119], a[132:135], v[128:131]
buffer_store_dwordx4 v[24:27], v15, s[24:27], s82 offen offset:0 sc1
v_mfma_f32_16x16x32_bf16 v[136:139], a[116:119], a[140:143], v[136:139]
ds_read_b64_tr_b16 a[188:189], v14 offset:57344
ds_read_b64_tr_b16 a[190:191], v14 offset:57856
v_mfma_f32_16x16x32_bf16 v[136:139], a[112:115], a[136:139], v[136:139]
v_mfma_f32_16x16x32_bf16 v[144:147], a[112:115], a[144:147], v[144:147]
v_mfma_f32_16x16x32_bf16 v[144:147], a[116:119], a[148:151], v[144:147]
buffer_store_dwordx4 v[28:31], v15, s[24:27], s82 offen offset:1024 sc1
v_mfma_f32_16x16x32_bf16 v[152:155], a[116:119], a[156:159], v[152:155]
buffer_load_dwordx4 v6, s[8:11], s64 offen offset:1024 lds
v_mfma_f32_16x16x32_bf16 v[152:155], a[112:115], a[152:155], v[152:155]
v_accvgpr_read_b32 v16, a193
v_accvgpr_read_b32 v17, a195
v_mfma_f32_16x16x32_bf16 v[156:159], a[120:123], a[152:155], v[156:159]
v_accvgpr_read_b32 v18, a197
v_accvgpr_read_b32 v19, a199
v_mfma_f32_16x16x32_bf16 v[156:159], a[124:127], a[156:159], v[156:159]
v_perm_b32 v24, v17, v16, s85
v_perm_b32 v25, v19, v18, s85
v_mfma_f32_16x16x32_bf16 v[148:151], a[124:127], a[148:151], v[148:151]
v_perm_b32 v28, v17, v16, s86
v_perm_b32 v29, v19, v18, s86
v_mfma_f32_16x16x32_bf16 v[148:151], a[120:123], a[144:147], v[148:151]
v_accvgpr_read_b32 v16, a201
v_accvgpr_read_b32 v17, a203
v_mfma_f32_16x16x32_bf16 v[140:143], a[120:123], a[136:139], v[140:143]
v_accvgpr_read_b32 v18, a205
v_accvgpr_read_b32 v19, a207
v_mfma_f32_16x16x32_bf16 v[140:143], a[124:127], a[140:143], v[140:143]
v_perm_b32 v26, v17, v16, s85
v_perm_b32 v27, v19, v18, s85
v_mfma_f32_16x16x32_bf16 v[132:135], a[124:127], a[132:135], v[132:135]
v_perm_b32 v30, v17, v16, s86
v_perm_b32 v31, v19, v18, s86
v_mfma_f32_16x16x32_bf16 v[132:135], a[120:123], a[128:131], v[132:135]
s_waitcnt lgkmcnt(0)
v_mfma_f32_16x16x32_bf16 v[160:163], a[160:163], a[64:67], v[160:163]
s_waitcnt vmcnt(18)
v_mfma_f32_16x16x32_bf16 v[160:163], a[164:167], a[68:71], v[160:163]
s_barrier
v_mfma_f32_16x16x32_bf16 v[164:167], a[172:175], a[68:71], v[164:167]
ds_read_b64_tr_b16 a[128:129], v11 offset:0
ds_read_b64_tr_b16 a[130:131], v11 offset:512
v_mfma_f32_16x16x32_bf16 v[164:167], a[168:171], a[64:67], v[164:167]
s_add_u32 m0, s77, 49152
s_add_u32 s64, s76, 0
v_mfma_f32_16x16x32_bf16 v[168:171], a[176:179], a[64:67], v[168:171]
buffer_load_dwordx4 v7, s[16:19], s64 offen lds
v_mfma_f32_16x16x32_bf16 v[168:171], a[180:183], a[68:71], v[168:171]
buffer_store_dwordx4 v[24:27], v15, s[24:27], s82 offen offset:2048 sc1
v_mfma_f32_16x16x32_bf16 v[172:175], a[188:191], a[68:71], v[172:175]
v_mfma_f32_16x16x32_bf16 v[172:175], a[184:187], a[64:67], v[172:175]
ds_read_b128 a[64:67], v9 offset:0
v_mfma_f32_16x16x32_bf16 v[188:191], a[184:187], a[72:75], v[188:191]
ds_read_b64_tr_b16 a[132:133], v11 offset:8192
ds_read_b64_tr_b16 a[134:135], v11 offset:8704
v_mfma_f32_16x16x32_bf16 v[188:191], a[188:191], a[76:79], v[188:191]
buffer_store_dwordx4 v[28:31], v15, s[24:27], s82 offen offset:3072 sc1
v_mfma_f32_16x16x32_bf16 v[184:187], a[180:183], a[76:79], v[184:187]
s_lshl_b32 s52, s7, 4
v_and_b32 v22, 3, v1
v_lshl_add_u32 v22, v22, 2, s52
v_mfma_f32_16x16x32_bf16 v[184:187], a[176:179], a[72:75], v[184:187]
buffer_load_dwordx4 v8, s[16:19], s64 offen offset:1024 lds
v_mfma_f32_16x16x32_bf16 v[180:183], a[168:171], a[72:75], v[180:183]
ds_read_b128 a[68:71], v10 offset:0
v_mfma_f32_16x16x32_bf16 v[180:183], a[172:175], a[76:79], v[180:183]
buffer_load_dword v23, v22, s[40:43], 0 offen sc1
v_mfma_f32_16x16x32_bf16 v[176:179], a[164:167], a[76:79], v[176:179]
v_mfma_f32_16x16x32_bf16 v[176:179], a[160:163], a[72:75], v[176:179]
ds_read_b64_tr_b16 a[136:137], v12 offset:0
ds_read_b64_tr_b16 a[138:139], v12 offset:512
v_mfma_f32_16x16x32_bf16 v[192:195], a[160:163], a[80:83], v[192:195]
s_add_u32 m0, s77, 51200
s_add_u32 s64, s76, 131072
v_mfma_f32_16x16x32_bf16 v[192:195], a[164:167], a[84:87], v[192:195]
v_mfma_f32_16x16x32_bf16 v[196:199], a[172:175], a[84:87], v[196:199]
buffer_load_dwordx4 v7, s[16:19], s64 offen lds
v_mfma_f32_16x16x32_bf16 v[196:199], a[168:171], a[80:83], v[196:199]
ds_read_b128 a[72:75], v9 offset:2048
v_mfma_f32_16x16x32_bf16 v[200:203], a[176:179], a[80:83], v[200:203]
v_mfma_f32_16x16x32_bf16 v[200:203], a[180:183], a[84:87], v[200:203]
ds_read_b64_tr_b16 a[140:141], v12 offset:8192
ds_read_b64_tr_b16 a[142:143], v12 offset:8704
v_mfma_f32_16x16x32_bf16 v[204:207], a[188:191], a[84:87], v[204:207]
v_mfma_f32_16x16x32_bf16 v[204:207], a[184:187], a[80:83], v[204:207]
v_mfma_f32_16x16x32_bf16 v[220:223], a[184:187], a[88:91], v[220:223]
ds_read_b128 a[76:79], v10 offset:2048
v_mfma_f32_16x16x32_bf16 v[220:223], a[188:191], a[92:95], v[220:223]
buffer_load_dwordx4 v8, s[16:19], s64 offen offset:1024 lds
v_mfma_f32_16x16x32_bf16 v[216:219], a[180:183], a[92:95], v[216:219]
s_xor_b32 s71, s70, 768
s_add_u32 s71, s68, s71
v_mfma_f32_16x16x32_bf16 v[216:219], a[176:179], a[88:91], v[216:219]
v_mfma_f32_16x16x32_bf16 v[212:215], a[168:171], a[88:91], v[212:215]
ds_read_b64_tr_b16 a[144:145], v13 offset:0
ds_read_b64_tr_b16 a[146:147], v13 offset:512
v_mfma_f32_16x16x32_bf16 v[212:215], a[172:175], a[92:95], v[212:215]
v_mfma_f32_16x16x32_bf16 v[208:211], a[164:167], a[92:95], v[208:211]
v_mfma_f32_16x16x32_bf16 v[208:211], a[160:163], a[88:91], v[208:211]
s_add_u32 m0, s73, 0
s_add_u32 s64, s71, 0
ds_read_b128 a[80:83], v9 offset:4096
v_mfma_f32_16x16x32_bf16 v[224:227], a[160:163], a[96:99], v[224:227]
v_mfma_f32_16x16x32_bf16 v[224:227], a[164:167], a[100:103], v[224:227]
buffer_load_dwordx4 v5, s[8:11], s64 offen lds
v_mfma_f32_16x16x32_bf16 v[228:231], a[172:175], a[100:103], v[228:231]
ds_read_b64_tr_b16 a[148:149], v13 offset:8192
ds_read_b64_tr_b16 a[150:151], v13 offset:8704
v_mfma_f32_16x16x32_bf16 v[228:231], a[168:171], a[96:99], v[228:231]
v_mfma_f32_16x16x32_bf16 v[232:235], a[176:179], a[96:99], v[232:235]
v_mfma_f32_16x16x32_bf16 v[232:235], a[180:183], a[100:103], v[232:235]
ds_read_b128 a[84:87], v10 offset:4096
v_mfma_f32_16x16x32_bf16 v[236:239], a[188:191], a[100:103], v[236:239]
v_mfma_f32_16x16x32_bf16 v[236:239], a[184:187], a[96:99], v[236:239]
v_mfma_f32_16x16x32_bf16 v[252:255], a[184:187], a[104:107], v[252:255]
buffer_load_dwordx4 v6, s[8:11], s64 offen offset:1024 lds
v_mfma_f32_16x16x32_bf16 v[252:255], a[188:191], a[108:111], v[252:255]
ds_read_b64_tr_b16 a[152:153], v14 offset:0
ds_read_b64_tr_b16 a[154:155], v14 offset:512
v_mfma_f32_16x16x32_bf16 v[248:251], a[180:183], a[108:111], v[248:251]
v_mfma_f32_16x16x32_bf16 v[248:251], a[176:179], a[104:107], v[248:251]
v_mfma_f32_16x16x32_bf16 v[244:247], a[168:171], a[104:107], v[244:247]
ds_read_b128 a[88:91], v9 offset:6144
v_mfma_f32_16x16x32_bf16 v[244:247], a[172:175], a[108:111], v[244:247]
s_add_u32 m0, s73, 2048
s_add_u32 s64, s71, 16384
v_mfma_f32_16x16x32_bf16 v[240:243], a[164:167], a[108:111], v[240:243]
v_mfma_f32_16x16x32_bf16 v[240:243], a[160:163], a[104:107], v[240:243]
buffer_load_dwordx4 v5, s[8:11], s64 offen lds
v_mfma_f32_16x16x32_bf16 a[0:3], a[160:163], a[112:115], a[0:3]
ds_read_b64_tr_b16 a[156:157], v14 offset:8192
ds_read_b64_tr_b16 a[158:159], v14 offset:8704
v_mfma_f32_16x16x32_bf16 a[0:3], a[164:167], a[116:119], a[0:3]
v_mfma_f32_16x16x32_bf16 a[4:7], a[172:175], a[116:119], a[4:7]
ds_read_b128 a[92:95], v10 offset:6144
v_mfma_f32_16x16x32_bf16 a[4:7], a[168:171], a[112:115], a[4:7]
v_mfma_f32_16x16x32_bf16 a[8:11], a[176:179], a[112:115], a[8:11]
v_mfma_f32_16x16x32_bf16 a[8:11], a[180:183], a[116:119], a[8:11]
v_mfma_f32_16x16x32_bf16 a[12:15], a[188:191], a[116:119], a[12:15]
buffer_load_dwordx4 v6, s[8:11], s64 offen offset:1024 lds
v_mfma_f32_16x16x32_bf16 a[12:15], a[184:187], a[112:115], a[12:15]
v_mfma_f32_16x16x32_bf16 a[28:31], a[184:187], a[120:123], a[28:31]
v_mfma_f32_16x16x32_bf16 a[28:31], a[188:191], a[124:127], a[28:31]
v_mfma_f32_16x16x32_bf16 a[24:27], a[180:183], a[124:127], a[24:27]
v_mfma_f32_16x16x32_bf16 a[24:27], a[176:179], a[120:123], a[24:27]
v_mfma_f32_16x16x32_bf16 a[20:23], a[168:171], a[120:123], a[20:23]
v_mfma_f32_16x16x32_bf16 a[20:23], a[172:175], a[124:127], a[20:23]
v_mfma_f32_16x16x32_bf16 a[16:19], a[164:167], a[124:127], a[16:19]
v_mfma_f32_16x16x32_bf16 a[16:19], a[160:163], a[120:123], a[16:19]
s_waitcnt lgkmcnt(0)
v_mfma_f32_16x16x32_bf16 v[32:35], a[64:67], a[128:131], v[32:35]
s_waitcnt vmcnt(25)
v_mfma_f32_16x16x32_bf16 v[32:35], a[68:71], a[132:135], v[32:35]
s_barrier
v_mfma_f32_16x16x32_bf16 v[40:43], a[68:71], a[140:143], v[40:43]
ds_read_b128 a[96:99], v9 offset:8192
v_mfma_f32_16x16x32_bf16 v[40:43], a[64:67], a[136:139], v[40:43]
s_xor_b32 s76, s75, 3145728
s_add_u32 s76, s74, s76
v_mfma_f32_16x16x32_bf16 v[48:51], a[64:67], a[144:147], v[48:51]
s_add_u32 m0, s77, 0
s_add_u32 s64, s76, 0
v_mfma_f32_16x16x32_bf16 v[48:51], a[68:71], a[148:151], v[48:51]
buffer_load_dwordx4 v7, s[56:59], s64 offen lds
v_mfma_f32_16x16x32_bf16 v[56:59], a[68:71], a[156:159], v[56:59]
ds_read_b128 a[100:103], v10 offset:8192
v_mfma_f32_16x16x32_bf16 v[56:59], a[64:67], a[152:155], v[56:59]
v_mfma_f32_16x16x32_bf16 v[60:63], a[72:75], a[152:155], v[60:63]
ds_read_b128 a[104:107], v9 offset:10240
v_mfma_f32_16x16x32_bf16 v[60:63], a[76:79], a[156:159], v[60:63]
v_mfma_f32_16x16x32_bf16 v[52:55], a[76:79], a[148:151], v[52:55]
v_mfma_f32_16x16x32_bf16 v[52:55], a[72:75], a[144:147], v[52:55]
buffer_load_dwordx4 v8, s[56:59], s64 offen offset:1024 lds
v_mfma_f32_16x16x32_bf16 v[44:47], a[72:75], a[136:139], v[44:47]
ds_read_b64_tr_b16 a[160:161], v11 offset:16384
ds_read_b64_tr_b16 a[162:163], v11 offset:16896
v_mfma_f32_16x16x32_bf16 v[44:47], a[76:79], a[140:143], v[44:47]
v_mfma_f32_16x16x32_bf16 v[36:39], a[76:79], a[132:135], v[36:39]
v_mfma_f32_16x16x32_bf16 v[36:39], a[72:75], a[128:131], v[36:39]
ds_read_b128 a[108:111], v10 offset:10240
v_mfma_f32_16x16x32_bf16 v[64:67], a[80:83], a[128:131], v[64:67]
s_add_u32 m0, s77, 2048
s_add_u32 s64, s76, 131072
s_waitcnt vmcnt(8)
v_mfma_f32_16x16x32_bf16 v[64:67], a[84:87], a[132:135], v[64:67]
v_cmp_gt_u32 vcc, 1, v23
v_mfma_f32_16x16x32_bf16 v[72:75], a[84:87], a[140:143], v[72:75]
buffer_load_dwordx4 v7, s[56:59], s64 offen lds
v_mfma_f32_16x16x32_bf16 v[72:75], a[80:83], a[136:139], v[72:75]
ds_read_b64_tr_b16 a[164:165], v11 offset:24576
ds_read_b64_tr_b16 a[166:167], v11 offset:25088
v_mfma_f32_16x16x32_bf16 v[80:83], a[80:83], a[144:147], v[80:83]
v_mfma_f32_16x16x32_bf16 v[80:83], a[84:87], a[148:151], v[80:83]
ds_read_b128 a[112:115], v9 offset:12288
v_mfma_f32_16x16x32_bf16 v[88:91], a[84:87], a[156:159], v[88:91]
s_cbranch_vccnz CK_Z
CK_Z_R:
v_mfma_f32_16x16x32_bf16 v[88:91], a[80:83], a[152:155], v[88:91]
buffer_atomic_add v1, v0, s[24:27], s84 offen offset:0 sc1
v_mfma_f32_16x16x32_bf16 v[92:95], a[88:91], a[152:155], v[92:95]
ds_read_b64_tr_b16 a[168:169], v12 offset:16384
ds_read_b64_tr_b16 a[170:171], v12 offset:16896
v_mfma_f32_16x16x32_bf16 v[92:95], a[92:95], a[156:159], v[92:95]
buffer_load_dwordx4 v8, s[56:59], s64 offen offset:1024 lds
v_mfma_f32_16x16x32_bf16 v[84:87], a[92:95], a[148:151], v[84:87]
v_mov_b32 v29, 0
v_mfma_f32_16x16x32_bf16 v[84:87], a[88:91], a[144:147], v[84:87]
v_mfma_f32_16x16x32_bf16 v[76:79], a[88:91], a[136:139], v[76:79]
ds_read_b128 a[116:119], v10 offset:12288
v_mfma_f32_16x16x32_bf16 v[76:79], a[92:95], a[140:143], v[76:79]
v_mfma_f32_16x16x32_bf16 v[68:71], a[92:95], a[132:135], v[68:71]
v_mfma_f32_16x16x32_bf16 v[68:71], a[88:91], a[128:131], v[68:71]
s_add_u32 m0, s73, 4096
s_add_u32 s64, s71, 524288
s_waitcnt lgkmcnt(6)
v_mfma_f32_16x16x32_bf16 v[96:99], a[96:99], a[128:131], v[96:99]
ds_read_b64_tr_b16 a[172:173], v12 offset:24576
ds_read_b64_tr_b16 a[174:175], v12 offset:25088
v_mfma_f32_16x16x32_bf16 v[96:99], a[100:103], a[132:135], v[96:99]
buffer_load_dwordx4 v5, s[8:11], s64 offen lds
v_mfma_f32_16x16x32_bf16 v[104:107], a[100:103], a[140:143], v[104:107]
ds_read_b128 a[120:123], v9 offset:14336
v_mfma_f32_16x16x32_bf16 v[104:107], a[96:99], a[136:139], v[104:107]
v_mfma_f32_16x16x32_bf16 v[112:115], a[96:99], a[144:147], v[112:115]
v_mfma_f32_16x16x32_bf16 v[112:115], a[100:103], a[148:151], v[112:115]
ds_read_b64_tr_b16 a[176:177], v13 offset:16384
ds_read_b64_tr_b16 a[178:179], v13 offset:16896
v_mfma_f32_16x16x32_bf16 v[120:123], a[100:103], a[156:159], v[120:123]
v_mfma_f32_16x16x32_bf16 v[120:123], a[96:99], a[152:155], v[120:123]
v_mfma_f32_16x16x32_bf16 v[124:127], a[104:107], a[152:155], v[124:127]
buffer_load_dwordx4 v6, s[8:11], s64 offen offset:1024 lds
v_mfma_f32_16x16x32_bf16 v[124:127], a[108:111], a[156:159], v[124:127]
ds_read_b128 a[124:127], v10 offset:14336
v_mfma_f32_16x16x32_bf16 v[116:119], a[108:111], a[148:151], v[116:119]
v_add_u32 v9, 32768, v9
v_add_u32 v10, 32768, v10
v_mfma_f32_16x16x32_bf16 v[116:119], a[104:107], a[144:147], v[116:119]
v_mfma_f32_16x16x32_bf16 v[108:111], a[104:107], a[136:139], v[108:111]
ds_read_b64_tr_b16 a[180:181], v13 offset:24576
ds_read_b64_tr_b16 a[182:183], v13 offset:25088
v_mfma_f32_16x16x32_bf16 v[108:111], a[108:111], a[140:143], v[108:111]
s_add_u32 m0, s73, 6144
s_add_u32 s64, s71, 540672
v_mfma_f32_16x16x32_bf16 v[100:103], a[108:111], a[132:135], v[100:103]
s_waitcnt lgkmcnt(2)
v_mfma_f32_16x16x32_bf16 v[100:103], a[104:107], a[128:131], v[100:103]
buffer_load_dwordx4 v5, s[8:11], s64 offen lds
v_mfma_f32_16x16x32_bf16 v[128:131], a[112:115], a[128:131], v[128:131]
ds_read_b64_tr_b16 a[184:185], v14 offset:16384
ds_read_b64_tr_b16 a[186:187], v14 offset:16896
v_mfma_f32_16x16x32_bf16 v[128:131], a[116:119], a[132:135], v[128:131]
v_mfma_f32_16x16x32_bf16 v[136:139], a[116:119], a[140:143], v[136:139]
ds_read_b64_tr_b16 a[188:189], v14 offset:24576
ds_read_b64_tr_b16 a[190:191], v14 offset:25088
v_mfma_f32_16x16x32_bf16 v[136:139], a[112:115], a[136:139], v[136:139]
v_mfma_f32_16x16x32_bf16 v[144:147], a[112:115], a[144:147], v[144:147]
v_mfma_f32_16x16x32_bf16 v[144:147], a[116:119], a[148:151], v[144:147]
v_mfma_f32_16x16x32_bf16 v[152:155], a[116:119], a[156:159], v[152:155]
buffer_load_dwordx4 v6, s[8:11], s64 offen offset:1024 lds
v_mfma_f32_16x16x32_bf16 v[152:155], a[112:115], a[152:155], v[152:155]
v_mfma_f32_16x16x32_bf16 v[156:159], a[120:123], a[152:155], v[156:159]
v_mfma_f32_16x16x32_bf16 v[156:159], a[124:127], a[156:159], v[156:159]
v_mfma_f32_16x16x32_bf16 v[148:151], a[124:127], a[148:151], v[148:151]
v_mfma_f32_16x16x32_bf16 v[148:151], a[120:123], a[144:147], v[148:151]
v_mfma_f32_16x16x32_bf16 v[140:143], a[120:123], a[136:139], v[140:143]
v_mfma_f32_16x16x32_bf16 v[140:143], a[124:127], a[140:143], v[140:143]
v_mfma_f32_16x16x32_bf16 v[132:135], a[124:127], a[132:135], v[132:135]
v_mfma_f32_16x16x32_bf16 v[132:135], a[120:123], a[128:131], v[132:135]
s_waitcnt lgkmcnt(0)
v_mfma_f32_16x16x32_bf16 v[160:163], a[160:163], a[64:67], v[160:163]
s_waitcnt vmcnt(20)
v_mfma_f32_16x16x32_bf16 v[160:163], a[164:167], a[68:71], v[160:163]
s_barrier
v_mfma_f32_16x16x32_bf16 v[164:167], a[172:175], a[68:71], v[164:167]
ds_read_b64_tr_b16 a[128:129], v11 offset:32768
ds_read_b64_tr_b16 a[130:131], v11 offset:33280
v_mfma_f32_16x16x32_bf16 v[164:167], a[168:171], a[64:67], v[164:167]
s_add_u32 m0, s77, 16384
s_add_u32 s64, s76, 0
v_mfma_f32_16x16x32_bf16 v[168:171], a[176:179], a[64:67], v[168:171]
buffer_load_dwordx4 v7, s[16:19], s64 offen lds
v_mfma_f32_16x16x32_bf16 v[168:171], a[180:183], a[68:71], v[168:171]
buffer_load_dword a253, v20, s[12:15], s53 offen
v_mfma_f32_16x16x32_bf16 v[172:175], a[188:191], a[68:71], v[172:175]
v_mfma_f32_16x16x32_bf16 v[172:175], a[184:187], a[64:67], v[172:175]
ds_read_b128 a[64:67], v9 offset:0
v_mfma_f32_16x16x32_bf16 v[188:191], a[184:187], a[72:75], v[188:191]
ds_read_b64_tr_b16 a[132:133], v11 offset:40960
ds_read_b64_tr_b16 a[134:135], v11 offset:41472
v_mfma_f32_16x16x32_bf16 v[188:191], a[188:191], a[76:79], v[188:191]
v_mfma_f32_16x16x32_bf16 v[184:187], a[180:183], a[76:79], v[184:187]
v_mfma_f32_16x16x32_bf16 v[184:187], a[176:179], a[72:75], v[184:187]
buffer_load_dwordx4 v8, s[16:19], s64 offen offset:1024 lds
v_mfma_f32_16x16x32_bf16 v[180:183], a[168:171], a[72:75], v[180:183]
ds_read_b128 a[68:71], v10 offset:0
v_mfma_f32_16x16x32_bf16 v[180:183], a[172:175], a[76:79], v[180:183]
v_mfma_f32_16x16x32_bf16 v[176:179], a[164:167], a[76:79], v[176:179]
v_mfma_f32_16x16x32_bf16 v[176:179], a[160:163], a[72:75], v[176:179]
ds_read_b64_tr_b16 a[136:137], v12 offset:32768
ds_read_b64_tr_b16 a[138:139], v12 offset:33280
v_mfma_f32_16x16x32_bf16 v[192:195], a[160:163], a[80:83], v[192:195]
s_add_u32 m0, s77, 18432
s_add_u32 s64, s76, 131072
v_mfma_f32_16x16x32_bf16 v[192:195], a[164:167], a[84:87], v[192:195]
v_mfma_f32_16x16x32_bf16 v[196:199], a[172:175], a[84:87], v[196:199]
buffer_load_dwordx4 v7, s[16:19], s64 offen lds
v_mfma_f32_16x16x32_bf16 v[196:199], a[168:171], a[80:83], v[196:199]
ds_read_b128 a[72:75], v9 offset:2048
v_mfma_f32_16x16x32_bf16 v[200:203], a[176:179], a[80:83], v[200:203]
v_mfma_f32_16x16x32_bf16 v[200:203], a[180:183], a[84:87], v[200:203]
ds_read_b64_tr_b16 a[140:141], v12 offset:40960
ds_read_b64_tr_b16 a[142:143], v12 offset:41472
v_mfma_f32_16x16x32_bf16 v[204:207], a[188:191], a[84:87], v[204:207]
v_mfma_f32_16x16x32_bf16 v[204:207], a[184:187], a[80:83], v[204:207]
v_mfma_f32_16x16x32_bf16 v[220:223], a[184:187], a[88:91], v[220:223]
ds_read_b128 a[76:79], v10 offset:2048
v_mfma_f32_16x16x32_bf16 v[220:223], a[188:191], a[92:95], v[220:223]
buffer_load_dwordx4 v8, s[16:19], s64 offen offset:1024 lds
v_mfma_f32_16x16x32_bf16 v[216:219], a[180:183], a[92:95], v[216:219]
s_xor_b32 s71, s70, 896
s_add_u32 s71, s68, s71
v_mfma_f32_16x16x32_bf16 v[216:219], a[176:179], a[88:91], v[216:219]
L_PAD2:
s_cbranch_execz L_PAD6
v_mfma_f32_16x16x32_bf16 v[212:215], a[168:171], a[88:91], v[212:215]
ds_read_b64_tr_b16 a[144:145], v13 offset:32768
ds_read_b64_tr_b16 a[146:147], v13 offset:33280
v_mfma_f32_16x16x32_bf16 v[212:215], a[172:175], a[92:95], v[212:215]
v_mfma_f32_16x16x32_bf16 v[208:211], a[164:167], a[92:95], v[208:211]
v_mfma_f32_16x16x32_bf16 v[208:211], a[160:163], a[88:91], v[208:211]
s_add_u32 m0, s73, 32768
s_add_u32 s64, s71, 0
ds_read_b128 a[80:83], v9 offset:4096
v_mfma_f32_16x16x32_bf16 v[224:227], a[160:163], a[96:99], v[224:227]
v_mfma_f32_16x16x32_bf16 v[224:227], a[164:167], a[100:103], v[224:227]
buffer_load_dwordx4 v5, s[8:11], s64 offen lds
v_mfma_f32_16x16x32_bf16 v[228:231], a[172:175], a[100:103], v[228:231]
ds_read_b64_tr_b16 a[148:149], v13 offset:40960
ds_read_b64_tr_b16 a[150:151], v13 offset:41472
v_mfma_f32_16x16x32_bf16 v[228:231], a[168:171], a[96:99], v[228:231]
v_mfma_f32_16x16x32_bf16 v[232:235], a[176:179], a[96:99], v[232:235]
v_mfma_f32_16x16x32_bf16 v[232:235], a[180:183], a[100:103], v[232:235]
ds_read_b128 a[84:87], v10 offset:4096
v_mfma_f32_16x16x32_bf16 v[236:239], a[188:191], a[100:103], v[236:239]
v_mfma_f32_16x16x32_bf16 v[236:239], a[184:187], a[96:99], v[236:239]
v_mfma_f32_16x16x32_bf16 v[252:255], a[184:187], a[104:107], v[252:255]
buffer_load_dwordx4 v6, s[8:11], s64 offen offset:1024 lds
v_mfma_f32_16x16x32_bf16 v[252:255], a[188:191], a[108:111], v[252:255]
ds_read_b64_tr_b16 a[152:153], v14 offset:32768
ds_read_b64_tr_b16 a[154:155], v14 offset:33280
v_mfma_f32_16x16x32_bf16 v[248:251], a[180:183], a[108:111], v[248:251]
v_mfma_f32_16x16x32_bf16 v[248:251], a[176:179], a[104:107], v[248:251]
v_mfma_f32_16x16x32_bf16 v[244:247], a[168:171], a[104:107], v[244:247]
ds_read_b128 a[88:91], v9 offset:6144
v_mfma_f32_16x16x32_bf16 v[244:247], a[172:175], a[108:111], v[244:247]
s_add_u32 m0, s73, 34816
s_add_u32 s64, s71, 16384
v_mfma_f32_16x16x32_bf16 v[240:243], a[164:167], a[108:111], v[240:243]
v_mfma_f32_16x16x32_bf16 v[240:243], a[160:163], a[104:107], v[240:243]
buffer_load_dwordx4 v5, s[8:11], s64 offen lds
v_mfma_f32_16x16x32_bf16 a[0:3], a[160:163], a[112:115], a[0:3]
ds_read_b64_tr_b16 a[156:157], v14 offset:40960
ds_read_b64_tr_b16 a[158:159], v14 offset:41472
v_mfma_f32_16x16x32_bf16 a[0:3], a[164:167], a[116:119], a[0:3]
v_mfma_f32_16x16x32_bf16 a[4:7], a[172:175], a[116:119], a[4:7]
ds_read_b128 a[92:95], v10 offset:6144
v_mfma_f32_16x16x32_bf16 a[4:7], a[168:171], a[112:115], a[4:7]
v_mfma_f32_16x16x32_bf16 a[8:11], a[176:179], a[112:115], a[8:11]
v_mfma_f32_16x16x32_bf16 a[8:11], a[180:183], a[116:119], a[8:11]
v_mfma_f32_16x16x32_bf16 a[12:15], a[188:191], a[116:119], a[12:15]
buffer_load_dwordx4 v6, s[8:11], s64 offen offset:1024 lds
v_mfma_f32_16x16x32_bf16 a[12:15], a[184:187], a[112:115], a[12:15]
v_mfma_f32_16x16x32_bf16 a[28:31], a[184:187], a[120:123], a[28:31]
v_mfma_f32_16x16x32_bf16 a[28:31], a[188:191], a[124:127], a[28:31]
v_mfma_f32_16x16x32_bf16 a[24:27], a[180:183], a[124:127], a[24:27]
v_mfma_f32_16x16x32_bf16 a[24:27], a[176:179], a[120:123], a[24:27]
v_mfma_f32_16x16x32_bf16 a[20:23], a[168:171], a[120:123], a[20:23]
v_mfma_f32_16x16x32_bf16 a[20:23], a[172:175], a[124:127], a[20:23]
v_mfma_f32_16x16x32_bf16 a[16:19], a[164:167], a[124:127], a[16:19]
v_mfma_f32_16x16x32_bf16 a[16:19], a[160:163], a[120:123], a[16:19]
s_waitcnt lgkmcnt(0)
v_mfma_f32_16x16x32_bf16 v[32:35], a[64:67], a[128:131], v[32:35]
s_waitcnt vmcnt(22)
v_mfma_f32_16x16x32_bf16 v[32:35], a[68:71], a[132:135], v[32:35]
s_barrier
v_mfma_f32_16x16x32_bf16 v[40:43], a[68:71], a[140:143], v[40:43]
ds_read_b128 a[96:99], v9 offset:8192
v_mfma_f32_16x16x32_bf16 v[40:43], a[64:67], a[136:139], v[40:43]
s_xor_b32 s76, s75, 3670016
s_add_u32 s76, s74, s76
v_mfma_f32_16x16x32_bf16 v[48:51], a[64:67], a[144:147], v[48:51]
s_add_u32 m0, s77, 32768
s_add_u32 s64, s76, 0
v_mfma_f32_16x16x32_bf16 v[48:51], a[68:71], a[148:151], v[48:51]
buffer_load_dwordx4 v7, s[56:59], s64 offen lds
v_mfma_f32_16x16x32_bf16 v[56:59], a[68:71], a[156:159], v[56:59]
ds_read_b128 a[100:103], v10 offset:8192
v_mfma_f32_16x16x32_bf16 v[56:59], a[64:67], a[152:155], v[56:59]
buffer_load_dword a252, v21, s[20:23], s55 offen
v_mfma_f32_16x16x32_bf16 v[60:63], a[72:75], a[152:155], v[60:63]
s_add_u32 s55, s55, 24576
s_mul_i32 s54, s54, 896
ds_read_b128 a[104:107], v9 offset:10240
v_mfma_f32_16x16x32_bf16 v[60:63], a[76:79], a[156:159], v[60:63]
v_mfma_f32_16x16x32_bf16 v[52:55], a[76:79], a[148:151], v[52:55]
v_mfma_f32_16x16x32_bf16 v[52:55], a[72:75], a[144:147], v[52:55]
buffer_load_dwordx4 v8, s[56:59], s64 offen offset:1024 lds
v_mfma_f32_16x16x32_bf16 v[44:47], a[72:75], a[136:139], v[44:47]
ds_read_b64_tr_b16 a[160:161], v11 offset:49152
ds_read_b64_tr_b16 a[162:163], v11 offset:49664
v_mfma_f32_16x16x32_bf16 v[44:47], a[76:79], a[140:143], v[44:47]
v_mfma_f32_16x16x32_bf16 v[36:39], a[76:79], a[132:135], v[36:39]
v_mfma_f32_16x16x32_bf16 v[36:39], a[72:75], a[128:131], v[36:39]
ds_read_b128 a[108:111], v10 offset:10240
v_mfma_f32_16x16x32_bf16 v[64:67], a[80:83], a[128:131], v[64:67]
s_add_u32 m0, s77, 34816
s_add_u32 s64, s76, 131072
v_mfma_f32_16x16x32_bf16 v[64:67], a[84:87], a[132:135], v[64:67]
v_mfma_f32_16x16x32_bf16 v[72:75], a[84:87], a[140:143], v[72:75]
buffer_load_dwordx4 v7, s[56:59], s64 offen lds
v_mfma_f32_16x16x32_bf16 v[72:75], a[80:83], a[136:139], v[72:75]
ds_read_b64_tr_b16 a[164:165], v11 offset:57344
ds_read_b64_tr_b16 a[166:167], v11 offset:57856
v_mfma_f32_16x16x32_bf16 v[80:83], a[80:83], a[144:147], v[80:83]
v_mfma_f32_16x16x32_bf16 v[80:83], a[84:87], a[148:151], v[80:83]
ds_read_b128 a[112:115], v9 offset:12288
v_mfma_f32_16x16x32_bf16 v[88:91], a[84:87], a[156:159], v[88:91]
v_mfma_f32_16x16x32_bf16 v[88:91], a[80:83], a[152:155], v[88:91]
v_mfma_f32_16x16x32_bf16 v[92:95], a[88:91], a[152:155], v[92:95]
ds_read_b64_tr_b16 a[168:169], v12 offset:49152
ds_read_b64_tr_b16 a[170:171], v12 offset:49664
v_mfma_f32_16x16x32_bf16 v[92:95], a[92:95], a[156:159], v[92:95]
buffer_load_dwordx4 v8, s[56:59], s64 offen offset:1024 lds
v_mfma_f32_16x16x32_bf16 v[84:87], a[92:95], a[148:151], v[84:87]
v_mfma_f32_16x16x32_bf16 v[84:87], a[88:91], a[144:147], v[84:87]
v_mfma_f32_16x16x32_bf16 v[76:79], a[88:91], a[136:139], v[76:79]
ds_read_b128 a[116:119], v10 offset:12288
v_mfma_f32_16x16x32_bf16 v[76:79], a[92:95], a[140:143], v[76:79]
v_mfma_f32_16x16x32_bf16 v[68:71], a[92:95], a[132:135], v[68:71]
v_mfma_f32_16x16x32_bf16 v[68:71], a[88:91], a[128:131], v[68:71]
s_add_u32 m0, s73, 36864
s_add_u32 s64, s71, 524288
s_waitcnt lgkmcnt(6)
v_mfma_f32_16x16x32_bf16 v[96:99], a[96:99], a[128:131], v[96:99]
ds_read_b64_tr_b16 a[172:173], v12 offset:57344
ds_read_b64_tr_b16 a[174:175], v12 offset:57856
v_mfma_f32_16x16x32_bf16 v[96:99], a[100:103], a[132:135], v[96:99]
buffer_load_dwordx4 v5, s[8:11], s64 offen lds
v_mfma_f32_16x16x32_bf16 v[104:107], a[100:103], a[140:143], v[104:107]
ds_read_b128 a[120:123], v9 offset:14336
v_mfma_f32_16x16x32_bf16 v[104:107], a[96:99], a[136:139], v[104:107]
v_mfma_f32_16x16x32_bf16 v[112:115], a[96:99], a[144:147], v[112:115]
v_mfma_f32_16x16x32_bf16 v[112:115], a[100:103], a[148:151], v[112:115]
ds_read_b64_tr_b16 a[176:177], v13 offset:49152
ds_read_b64_tr_b16 a[178:179], v13 offset:49664
v_mfma_f32_16x16x32_bf16 v[120:123], a[100:103], a[156:159], v[120:123]
v_mfma_f32_16x16x32_bf16 v[120:123], a[96:99], a[152:155], v[120:123]
v_mfma_f32_16x16x32_bf16 v[124:127], a[104:107], a[152:155], v[124:127]
buffer_load_dwordx4 v6, s[8:11], s64 offen offset:1024 lds
v_mfma_f32_16x16x32_bf16 v[124:127], a[108:111], a[156:159], v[124:127]
ds_read_b128 a[124:127], v10 offset:14336
v_mfma_f32_16x16x32_bf16 v[116:119], a[108:111], a[148:151], v[116:119]
v_add_u32 v9, -65536, v9
v_add_u32 v10, -65536, v10
v_mfma_f32_16x16x32_bf16 v[116:119], a[104:107], a[144:147], v[116:119]
buffer_load_dword v30, v29, s[24:27], s89 offen sc1
v_mfma_f32_16x16x32_bf16 v[108:111], a[104:107], a[136:139], v[108:111]
ds_read_b64_tr_b16 a[180:181], v13 offset:57344
ds_read_b64_tr_b16 a[182:183], v13 offset:57856
v_mfma_f32_16x16x32_bf16 v[108:111], a[108:111], a[140:143], v[108:111]
s_add_u32 m0, s73, 38912
s_add_u32 s64, s71, 540672
v_mfma_f32_16x16x32_bf16 v[100:103], a[108:111], a[132:135], v[100:103]
s_waitcnt lgkmcnt(2)
v_mfma_f32_16x16x32_bf16 v[100:103], a[104:107], a[128:131], v[100:103]
buffer_load_dwordx4 v5, s[8:11], s64 offen lds
v_mfma_f32_16x16x32_bf16 v[128:131], a[112:115], a[128:131], v[128:131]
ds_read_b64_tr_b16 a[184:185], v14 offset:49152
ds_read_b64_tr_b16 a[186:187], v14 offset:49664
v_mfma_f32_16x16x32_bf16 v[128:131], a[116:119], a[132:135], v[128:131]
v_mfma_f32_16x16x32_bf16 v[136:139], a[116:119], a[140:143], v[136:139]
ds_read_b64_tr_b16 a[188:189], v14 offset:57344
ds_read_b64_tr_b16 a[190:191], v14 offset:57856
v_mfma_f32_16x16x32_bf16 v[136:139], a[112:115], a[136:139], v[136:139]
v_mfma_f32_16x16x32_bf16 v[144:147], a[112:115], a[144:147], v[144:147]
v_mfma_f32_16x16x32_bf16 v[144:147], a[116:119], a[148:151], v[144:147]
v_mfma_f32_16x16x32_bf16 v[152:155], a[116:119], a[156:159], v[152:155]
buffer_load_dwordx4 v6, s[8:11], s64 offen offset:1024 lds
v_mfma_f32_16x16x32_bf16 v[152:155], a[112:115], a[152:155], v[152:155]
v_mfma_f32_16x16x32_bf16 v[156:159], a[120:123], a[152:155], v[156:159]
v_mfma_f32_16x16x32_bf16 v[156:159], a[124:127], a[156:159], v[156:159]
v_mfma_f32_16x16x32_bf16 v[148:151], a[124:127], a[148:151], v[148:151]
v_mfma_f32_16x16x32_bf16 v[148:151], a[120:123], a[144:147], v[148:151]
v_mfma_f32_16x16x32_bf16 v[140:143], a[120:123], a[136:139], v[140:143]
v_mfma_f32_16x16x32_bf16 v[140:143], a[124:127], a[140:143], v[140:143]
v_mfma_f32_16x16x32_bf16 v[132:135], a[124:127], a[132:135], v[132:135]
v_mfma_f32_16x16x32_bf16 v[132:135], a[120:123], a[128:131], v[132:135]
s_waitcnt lgkmcnt(0)
v_mfma_f32_16x16x32_bf16 v[160:163], a[160:163], a[64:67], v[160:163]
s_waitcnt vmcnt(19)
v_mfma_f32_16x16x32_bf16 v[160:163], a[164:167], a[68:71], v[160:163]
s_barrier
v_mfma_f32_16x16x32_bf16 v[164:167], a[172:175], a[68:71], v[164:167]
ds_read_b64_tr_b16 a[128:129], v11 offset:0
ds_read_b64_tr_b16 a[130:131], v11 offset:512
v_mfma_f32_16x16x32_bf16 v[164:167], a[168:171], a[64:67], v[164:167]
s_add_u32 m0, s77, 49152
s_add_u32 s64, s76, 0
v_mfma_f32_16x16x32_bf16 v[168:171], a[176:179], a[64:67], v[168:171]
buffer_load_dwordx4 v7, s[16:19], s64 offen lds
v_mfma_f32_16x16x32_bf16 v[168:171], a[180:183], a[68:71], v[168:171]
buffer_load_dword a252, v21, s[20:23], s55 offen
v_mfma_f32_16x16x32_bf16 v[172:175], a[188:191], a[68:71], v[172:175]
s_lshr_b32 s55, s2, 1
s_lshl2_add_u32 s55, s55, s3
s_mul_i32 s55, s55, 9216
v_mfma_f32_16x16x32_bf16 v[172:175], a[184:187], a[64:67], v[172:175]
s_and_b32 s53, s2, 1
s_lshl_b32 s53, s53, 9
ds_read_b128 a[64:67], v9 offset:0
v_mfma_f32_16x16x32_bf16 v[188:191], a[184:187], a[72:75], v[188:191]
s_add_u32 s55, s55, s53
ds_read_b64_tr_b16 a[132:133], v11 offset:8192
ds_read_b64_tr_b16 a[134:135], v11 offset:8704
v_mfma_f32_16x16x32_bf16 v[188:191], a[188:191], a[76:79], v[188:191]
v_min_u32 v20, 39, v1
v_and_b32 v21, 7, v20
v_mfma_f32_16x16x32_bf16 v[184:187], a[180:183], a[76:79], v[184:187]
v_mul_u32_u24 v21, 1152, v21
v_lshrrev_b32 v20, 3, v20
v_mfma_f32_16x16x32_bf16 v[184:187], a[176:179], a[72:75], v[184:187]
buffer_load_dwordx4 v8, s[16:19], s64 offen offset:1024 lds
v_mfma_f32_16x16x32_bf16 v[180:183], a[168:171], a[72:75], v[180:183]
ds_read_b128 a[68:71], v10 offset:0
v_lshl_add_u32 v21, v20, 7, v21
v_mfma_f32_16x16x32_bf16 v[180:183], a[172:175], a[76:79], v[180:183]
v_min_u32 v20, 6, v1
v_lshlrev_b32 v20, 7, v20
v_mfma_f32_16x16x32_bf16 v[176:179], a[164:167], a[76:79], v[176:179]
v_mfma_f32_16x16x32_bf16 v[176:179], a[160:163], a[72:75], v[176:179]
ds_read_b64_tr_b16 a[136:137], v12 offset:0
ds_read_b64_tr_b16 a[138:139], v12 offset:512
v_mfma_f32_16x16x32_bf16 v[192:195], a[160:163], a[80:83], v[192:195]
s_add_u32 m0, s77, 51200
s_add_u32 s64, s76, 131072
v_mfma_f32_16x16x32_bf16 v[192:195], a[164:167], a[84:87], v[192:195]
v_mfma_f32_16x16x32_bf16 v[196:199], a[172:175], a[84:87], v[196:199]
buffer_load_dwordx4 v7, s[16:19], s64 offen lds
v_mfma_f32_16x16x32_bf16 v[196:199], a[168:171], a[80:83], v[196:199]
ds_read_b128 a[72:75], v9 offset:2048
v_mfma_f32_16x16x32_bf16 v[200:203], a[176:179], a[80:83], v[200:203]
v_mfma_f32_16x16x32_bf16 v[200:203], a[180:183], a[84:87], v[200:203]
ds_read_b64_tr_b16 a[140:141], v12 offset:8192
ds_read_b64_tr_b16 a[142:143], v12 offset:8704
v_mfma_f32_16x16x32_bf16 v[204:207], a[188:191], a[84:87], v[204:207]
v_mfma_f32_16x16x32_bf16 v[204:207], a[184:187], a[80:83], v[204:207]
v_mfma_f32_16x16x32_bf16 v[220:223], a[184:187], a[88:91], v[220:223]
ds_read_b128 a[76:79], v10 offset:2048
v_mfma_f32_16x16x32_bf16 v[220:223], a[188:191], a[92:95], v[220:223]
buffer_load_dwordx4 v8, s[16:19], s64 offen offset:1024 lds
v_mfma_f32_16x16x32_bf16 v[216:219], a[180:183], a[92:95], v[216:219]
s_lshl_b32 s70, s93, 7
s_mul_i32 s68, s66, 36864
s_mul_i32 s69, s67, 36864
v_mfma_f32_16x16x32_bf16 v[216:219], a[176:179], a[88:91], v[216:219]
v_lshrrev_b32 v31, 3, v1
v_lshl_add_u32 v5, v31, 7, v5
v_mfma_f32_16x16x32_bf16 v[212:215], a[168:171], a[88:91], v[212:215]
v_lshl_add_u32 v6, v31, 7, v6
v_add_u32 v6, 1024, v6
v_mfma_f32_16x16x32_bf16 v[212:215], a[172:175], a[92:95], v[212:215]
s_mov_b32 s65, 1024
s_add_u32 s71, s68, s65
s_add_u32 s72, s69, s65
v_mfma_f32_16x16x32_bf16 v[208:211], a[164:167], a[92:95], v[208:211]
ds_read_b64_tr_b16 a[144:145], v13 offset:0
ds_read_b64_tr_b16 a[146:147], v13 offset:512
v_mfma_f32_16x16x32_bf16 v[208:211], a[160:163], a[88:91], v[208:211]
s_add_u32 m0, s73, 65536
s_add_u32 s64, s71, 0
ds_read_b128 a[80:83], v9 offset:4096
v_mfma_f32_16x16x32_bf16 v[224:227], a[160:163], a[96:99], v[224:227]
v_mfma_f32_16x16x32_bf16 v[224:227], a[164:167], a[100:103], v[224:227]
buffer_load_dwordx4 v5, s[12:15], s64 offen lds
v_mfma_f32_16x16x32_bf16 v[228:231], a[172:175], a[100:103], v[228:231]
ds_read_b64_tr_b16 a[148:149], v13 offset:8192
ds_read_b64_tr_b16 a[150:151], v13 offset:8704
v_mfma_f32_16x16x32_bf16 v[228:231], a[168:171], a[96:99], v[228:231]
v_mfma_f32_16x16x32_bf16 v[232:235], a[176:179], a[96:99], v[232:235]
v_mfma_f32_16x16x32_bf16 v[232:235], a[180:183], a[100:103], v[232:235]
ds_read_b128 a[84:87], v10 offset:4096
v_mfma_f32_16x16x32_bf16 v[236:239], a[188:191], a[100:103], v[236:239]
v_mfma_f32_16x16x32_bf16 v[236:239], a[184:187], a[96:99], v[236:239]
v_mfma_f32_16x16x32_bf16 v[252:255], a[184:187], a[104:107], v[252:255]
buffer_load_dwordx4 v6, s[12:15], s64 offen offset:1024 lds
v_mfma_f32_16x16x32_bf16 v[252:255], a[188:191], a[108:111], v[252:255]
ds_read_b64_tr_b16 a[152:153], v14 offset:0
ds_read_b64_tr_b16 a[154:155], v14 offset:512
v_mfma_f32_16x16x32_bf16 v[248:251], a[180:183], a[108:111], v[248:251]
v_mfma_f32_16x16x32_bf16 v[248:251], a[176:179], a[104:107], v[248:251]
v_mfma_f32_16x16x32_bf16 v[244:247], a[168:171], a[104:107], v[244:247]
ds_read_b128 a[88:91], v9 offset:6144
v_mfma_f32_16x16x32_bf16 v[244:247], a[172:175], a[108:111], v[244:247]
s_add_u32 m0, s73, 67584
s_add_u32 s64, s71, 18432
v_mfma_f32_16x16x32_bf16 v[240:243], a[164:167], a[108:111], v[240:243]
v_mfma_f32_16x16x32_bf16 v[240:243], a[160:163], a[104:107], v[240:243]
buffer_load_dwordx4 v5, s[12:15], s64 offen lds
v_mfma_f32_16x16x32_bf16 a[0:3], a[160:163], a[112:115], a[0:3]
ds_read_b64_tr_b16 a[156:157], v14 offset:8192
ds_read_b64_tr_b16 a[158:159], v14 offset:8704
v_mfma_f32_16x16x32_bf16 a[0:3], a[164:167], a[116:119], a[0:3]
v_mfma_f32_16x16x32_bf16 a[4:7], a[172:175], a[116:119], a[4:7]
s_waitcnt vmcnt(10)
ds_read_b128 a[92:95], v10 offset:6144
v_mfma_f32_16x16x32_bf16 a[4:7], a[168:171], a[112:115], a[4:7]
v_cmp_gt_u32 vcc, 18, v30
v_mfma_f32_16x16x32_bf16 a[8:11], a[176:179], a[112:115], a[8:11]
v_mfma_f32_16x16x32_bf16 a[8:11], a[180:183], a[116:119], a[8:11]
v_mfma_f32_16x16x32_bf16 a[12:15], a[188:191], a[116:119], a[12:15]
buffer_load_dwordx4 v6, s[12:15], s64 offen offset:1024 lds
v_mfma_f32_16x16x32_bf16 a[12:15], a[184:187], a[112:115], a[12:15]
v_mfma_f32_16x16x32_bf16 a[28:31], a[184:187], a[120:123], a[28:31]
s_cbranch_vccnz CK_WA
CK_WA_R:
v_mfma_f32_16x16x32_bf16 a[28:31], a[188:191], a[124:127], a[28:31]
v_mfma_f32_16x16x32_bf16 a[24:27], a[180:183], a[124:127], a[24:27]
v_mfma_f32_16x16x32_bf16 a[24:27], a[176:179], a[120:123], a[24:27]
v_mfma_f32_16x16x32_bf16 a[20:23], a[168:171], a[120:123], a[20:23]
v_mfma_f32_16x16x32_bf16 a[20:23], a[172:175], a[124:127], a[20:23]
v_mfma_f32_16x16x32_bf16 a[16:19], a[164:167], a[124:127], a[16:19]
v_mfma_f32_16x16x32_bf16 a[16:19], a[160:163], a[120:123], a[16:19]
s_waitcnt lgkmcnt(0)
v_mfma_f32_16x16x32_bf16 v[32:35], a[64:67], a[128:131], v[32:35]
s_waitcnt vmcnt(23)
v_mfma_f32_16x16x32_bf16 v[32:35], a[68:71], a[132:135], v[32:35]
s_barrier
v_mfma_f32_16x16x32_bf16 v[40:43], a[68:71], a[140:143], v[40:43]
ds_read_b128 a[96:99], v9 offset:8192
v_mfma_f32_16x16x32_bf16 v[40:43], a[64:67], a[136:139], v[40:43]
s_lshl_b32 s77, s3, 11
s_lshl_b32 s74, s3, 9
s_add_u32 s74, s74, s4
v_mfma_f32_16x16x32_bf16 v[48:51], a[64:67], a[144:147], v[48:51]
s_lshl_b32 s74, s74, 8
v_mfma_f32_16x16x32_bf16 v[48:51], a[68:71], a[148:151], v[48:51]
s_mov_b32 s75, 8
s_lshl_b32 s76, s75, 19
s_add_u32 s76, s76, s74
v_mfma_f32_16x16x32_bf16 v[56:59], a[68:71], a[156:159], v[56:59]
s_lshl_b32 s79, s75, 13
s_add_u32 s79, s79, s78
ds_read_b128 a[100:103], v10 offset:8192
v_mfma_f32_16x16x32_bf16 v[56:59], a[64:67], a[152:155], v[56:59]
s_add_u32 m0, s77, 0
s_add_u32 s64, s76, 0
v_mfma_f32_16x16x32_bf16 v[60:63], a[72:75], a[152:155], v[60:63]
buffer_load_dwordx4 v7, s[20:23], s64 offen lds
v_mfma_f32_16x16x32_bf16 v[60:63], a[76:79], a[156:159], v[60:63]
ds_read_b128 a[104:107], v9 offset:10240
v_mfma_f32_16x16x32_bf16 v[52:55], a[76:79], a[148:151], v[52:55]
buffer_load_dword a252, v21, s[32:35], s55 offen
v_mfma_f32_16x16x32_bf16 v[52:55], a[72:75], a[144:147], v[52:55]
ds_read_b64_tr_b16 a[160:161], v11 offset:16384
ds_read_b64_tr_b16 a[162:163], v11 offset:16896
v_mfma_f32_16x16x32_bf16 v[44:47], a[72:75], a[136:139], v[44:47]
buffer_load_dwordx4 v8, s[20:23], s64 offen offset:1024 lds
v_mfma_f32_16x16x32_bf16 v[44:47], a[76:79], a[140:143], v[44:47]
buffer_load_dword a253, v20, s[48:51], s54 offen
v_mfma_f32_16x16x32_bf16 v[36:39], a[76:79], a[132:135], v[36:39]
v_mfma_f32_16x16x32_bf16 v[36:39], a[72:75], a[128:131], v[36:39]
ds_read_b128 a[108:111], v10 offset:10240
v_mfma_f32_16x16x32_bf16 v[64:67], a[80:83], a[128:131], v[64:67]
v_mfma_f32_16x16x32_bf16 v[64:67], a[84:87], a[132:135], v[64:67]
v_mfma_f32_16x16x32_bf16 v[72:75], a[84:87], a[140:143], v[72:75]
s_add_u32 m0, s80, 0
s_add_u32 s64, s79, 0
v_mfma_f32_16x16x32_bf16 v[72:75], a[80:83], a[136:139], v[72:75]
ds_read_b64_tr_b16 a[164:165], v11 offset:24576
ds_read_b64_tr_b16 a[166:167], v11 offset:25088
v_mfma_f32_16x16x32_bf16 v[80:83], a[80:83], a[144:147], v[80:83]
buffer_load_dwordx4 v15, s[24:27], s64 offen sc1 lds
v_mfma_f32_16x16x32_bf16 v[80:83], a[84:87], a[148:151], v[80:83]
ds_read_b128 a[112:115], v9 offset:12288
v_mfma_f32_16x16x32_bf16 v[88:91], a[84:87], a[156:159], v[88:91]
v_mfma_f32_16x16x32_bf16 v[88:91], a[80:83], a[152:155], v[88:91]
v_mfma_f32_16x16x32_bf16 v[92:95], a[88:91], a[152:155], v[92:95]
ds_read_b64_tr_b16 a[168:169], v12 offset:16384
ds_read_b64_tr_b16 a[170:171], v12 offset:16896
v_mfma_f32_16x16x32_bf16 v[92:95], a[92:95], a[156:159], v[92:95]
v_mfma_f32_16x16x32_bf16 v[84:87], a[92:95], a[148:151], v[84:87]
s_add_u32 m0, s73, 69632
s_add_u32 s64, s72, 0
v_mfma_f32_16x16x32_bf16 v[84:87], a[88:91], a[144:147], v[84:87]
v_mfma_f32_16x16x32_bf16 v[76:79], a[88:91], a[136:139], v[76:79]
buffer_load_dwordx4 v5, s[12:15], s64 offen lds
v_mfma_f32_16x16x32_bf16 v[76:79], a[92:95], a[140:143], v[76:79]
ds_read_b128 a[116:119], v10 offset:12288
v_mfma_f32_16x16x32_bf16 v[68:71], a[92:95], a[132:135], v[68:71]
v_mfma_f32_16x16x32_bf16 v[68:71], a[88:91], a[128:131], v[68:71]
s_waitcnt lgkmcnt(6)
ds_read_b64_tr_b16 a[172:173], v12 offset:24576
ds_read_b64_tr_b16 a[174:175], v12 offset:25088
v_mfma_f32_16x16x32_bf16 v[96:99], a[96:99], a[128:131], v[96:99]
v_mfma_f32_16x16x32_bf16 v[96:99], a[100:103], a[132:135], v[96:99]
v_mfma_f32_16x16x32_bf16 v[104:107], a[100:103], a[140:143], v[104:107]
ds_read_b128 a[120:123], v9 offset:14336
v_mfma_f32_16x16x32_bf16 v[104:107], a[96:99], a[136:139], v[104:107]
v_mfma_f32_16x16x32_bf16 v[112:115], a[96:99], a[144:147], v[112:115]
v_mfma_f32_16x16x32_bf16 v[112:115], a[100:103], a[148:151], v[112:115]
buffer_load_dwordx4 v6, s[12:15], s64 offen offset:1024 lds
v_mfma_f32_16x16x32_bf16 v[120:123], a[100:103], a[156:159], v[120:123]
ds_read_b64_tr_b16 a[176:177], v13 offset:16384
ds_read_b64_tr_b16 a[178:179], v13 offset:16896
v_mfma_f32_16x16x32_bf16 v[120:123], a[96:99], a[152:155], v[120:123]
v_mfma_f32_16x16x32_bf16 v[124:127], a[104:107], a[152:155], v[124:127]
v_mfma_f32_16x16x32_bf16 v[124:127], a[108:111], a[156:159], v[124:127]
ds_read_b128 a[124:127], v10 offset:14336
v_mfma_f32_16x16x32_bf16 v[116:119], a[108:111], a[148:151], v[116:119]
v_add_u32 v9, 32768, v9
v_add_u32 v10, 32768, v10
v_mfma_f32_16x16x32_bf16 v[116:119], a[104:107], a[144:147], v[116:119]
s_add_u32 m0, s73, 71680
s_add_u32 s64, s72, 18432
v_mfma_f32_16x16x32_bf16 v[108:111], a[104:107], a[136:139], v[108:111]
ds_read_b64_tr_b16 a[180:181], v13 offset:24576
ds_read_b64_tr_b16 a[182:183], v13 offset:25088
v_mfma_f32_16x16x32_bf16 v[108:111], a[108:111], a[140:143], v[108:111]
buffer_load_dwordx4 v5, s[12:15], s64 offen lds
v_mfma_f32_16x16x32_bf16 v[100:103], a[108:111], a[132:135], v[100:103]
v_mfma_f32_16x16x32_bf16 v[100:103], a[104:107], a[128:131], v[100:103]
s_waitcnt lgkmcnt(2)
ds_read_b64_tr_b16 a[184:185], v14 offset:16384
ds_read_b64_tr_b16 a[186:187], v14 offset:16896
v_mfma_f32_16x16x32_bf16 v[128:131], a[112:115], a[128:131], v[128:131]
v_mfma_f32_16x16x32_bf16 v[128:131], a[116:119], a[132:135], v[128:131]
v_mfma_f32_16x16x32_bf16 v[136:139], a[116:119], a[140:143], v[136:139]
ds_read_b64_tr_b16 a[188:189], v14 offset:24576
ds_read_b64_tr_b16 a[190:191], v14 offset:25088
v_mfma_f32_16x16x32_bf16 v[136:139], a[112:115], a[136:139], v[136:139]
v_mfma_f32_16x16x32_bf16 v[144:147], a[112:115], a[144:147], v[144:147]
v_mfma_f32_16x16x32_bf16 v[144:147], a[116:119], a[148:151], v[144:147]
buffer_load_dwordx4 v6, s[12:15], s64 offen offset:1024 lds
v_mfma_f32_16x16x32_bf16 v[152:155], a[116:119], a[156:159], v[152:155]
v_mfma_f32_16x16x32_bf16 v[152:155], a[112:115], a[152:155], v[152:155]
v_mfma_f32_16x16x32_bf16 v[156:159], a[120:123], a[152:155], v[156:159]
v_mfma_f32_16x16x32_bf16 v[156:159], a[124:127], a[156:159], v[156:159]
v_mfma_f32_16x16x32_bf16 v[148:151], a[124:127], a[148:151], v[148:151]
v_mfma_f32_16x16x32_bf16 v[148:151], a[120:123], a[144:147], v[148:151]
v_mfma_f32_16x16x32_bf16 v[140:143], a[120:123], a[136:139], v[140:143]
v_mfma_f32_16x16x32_bf16 v[140:143], a[124:127], a[140:143], v[140:143]
v_mfma_f32_16x16x32_bf16 v[132:135], a[124:127], a[132:135], v[132:135]
v_mfma_f32_16x16x32_bf16 v[132:135], a[120:123], a[128:131], v[132:135]
s_waitcnt lgkmcnt(0)
v_mfma_f32_16x16x32_bf16 v[160:163], a[160:163], a[64:67], v[160:163]
s_waitcnt vmcnt(18)
v_mfma_f32_16x16x32_bf16 v[160:163], a[164:167], a[68:71], v[160:163]
s_barrier
v_mfma_f32_16x16x32_bf16 v[164:167], a[172:175], a[68:71], v[164:167]
ds_read_b64_tr_b16 a[128:129], v11 offset:32768
ds_read_b64_tr_b16 a[130:131], v11 offset:33280
v_mfma_f32_16x16x32_bf16 v[164:167], a[168:171], a[64:67], v[164:167]
s_add_u32 m0, s77, 16384
s_add_u32 s64, s76, 128
v_mfma_f32_16x16x32_bf16 v[168:171], a[176:179], a[64:67], v[168:171]
buffer_load_dwordx4 v7, s[20:23], s64 offen lds
v_mfma_f32_16x16x32_bf16 v[168:171], a[180:183], a[68:71], v[168:171]
v_mfma_f32_16x16x32_bf16 v[172:175], a[188:191], a[68:71], v[172:175]
v_mfma_f32_16x16x32_bf16 v[172:175], a[184:187], a[64:67], v[172:175]
ds_read_b128 a[64:67], v9 offset:0
v_mfma_f32_16x16x32_bf16 v[188:191], a[184:187], a[72:75], v[188:191]
ds_read_b64_tr_b16 a[132:133], v11 offset:40960
ds_read_b64_tr_b16 a[134:135], v11 offset:41472
v_mfma_f32_16x16x32_bf16 v[188:191], a[188:191], a[76:79], v[188:191]
v_mfma_f32_16x16x32_bf16 v[184:187], a[180:183], a[76:79], v[184:187]
v_mfma_f32_16x16x32_bf16 v[184:187], a[176:179], a[72:75], v[184:187]
ds_read_b128 a[68:71], v10 offset:0
v_mfma_f32_16x16x32_bf16 v[180:183], a[168:171], a[72:75], v[180:183]
buffer_load_dwordx4 v8, s[20:23], s64 offen offset:1024 lds
v_mfma_f32_16x16x32_bf16 v[180:183], a[172:175], a[76:79], v[180:183]
v_mfma_f32_16x16x32_bf16 v[176:179], a[164:167], a[76:79], v[176:179]
v_mfma_f32_16x16x32_bf16 v[176:179], a[160:163], a[72:75], v[176:179]
ds_read_b64_tr_b16 a[136:137], v12 offset:32768
ds_read_b64_tr_b16 a[138:139], v12 offset:33280
v_mfma_f32_16x16x32_bf16 v[192:195], a[160:163], a[80:83], v[192:195]
v_mfma_f32_16x16x32_bf16 v[192:195], a[164:167], a[84:87], v[192:195]
v_mfma_f32_16x16x32_bf16 v[196:199], a[172:175], a[84:87], v[196:199]
s_add_u32 m0, s80, 16384
s_add_u32 s64, s79, 2048
ds_read_b128 a[72:75], v9 offset:2048
v_mfma_f32_16x16x32_bf16 v[196:199], a[168:171], a[80:83], v[196:199]
v_mfma_f32_16x16x32_bf16 v[200:203], a[176:179], a[80:83], v[200:203]
buffer_load_dwordx4 v15, s[24:27], s64 offen sc1 lds
v_mfma_f32_16x16x32_bf16 v[200:203], a[180:183], a[84:87], v[200:203]
s_xor_b32 s65, s70, 0
s_add_u32 s71, s68, s65
s_add_u32 s72, s69, s65
v_mfma_f32_16x16x32_bf16 v[204:207], a[188:191], a[84:87], v[204:207]
ds_read_b64_tr_b16 a[140:141], v12 offset:40960
ds_read_b64_tr_b16 a[142:143], v12 offset:41472
v_mfma_f32_16x16x32_bf16 v[204:207], a[184:187], a[80:83], v[204:207]
v_mfma_f32_16x16x32_bf16 v[220:223], a[184:187], a[88:91], v[220:223]
ds_read_b128 a[76:79], v10 offset:2048
v_mfma_f32_16x16x32_bf16 v[220:223], a[188:191], a[92:95], v[220:223]
v_mfma_f32_16x16x32_bf16 v[216:219], a[180:183], a[92:95], v[216:219]
s_add_u32 m0, s73, 0
s_add_u32 s64, s71, 0
v_mfma_f32_16x16x32_bf16 v[216:219], a[176:179], a[88:91], v[216:219]
v_mfma_f32_16x16x32_bf16 v[212:215], a[168:171], a[88:91], v[212:215]
buffer_load_dwordx4 v5, s[12:15], s64 offen lds
v_mfma_f32_16x16x32_bf16 v[212:215], a[172:175], a[92:95], v[212:215]
ds_read_b64_tr_b16 a[144:145], v13 offset:32768
ds_read_b64_tr_b16 a[146:147], v13 offset:33280
v_mfma_f32_16x16x32_bf16 v[208:211], a[164:167], a[92:95], v[208:211]
v_mfma_f32_16x16x32_bf16 v[208:211], a[160:163], a[88:91], v[208:211]
ds_read_b128 a[80:83], v9 offset:4096
v_mfma_f32_16x16x32_bf16 v[224:227], a[160:163], a[96:99], v[224:227]
v_mfma_f32_16x16x32_bf16 v[224:227], a[164:167], a[100:103], v[224:227]
v_mfma_f32_16x16x32_bf16 v[228:231], a[172:175], a[100:103], v[228:231]
ds_read_b64_tr_b16 a[148:149], v13 offset:40960
ds_read_b64_tr_b16 a[150:151], v13 offset:41472
v_mfma_f32_16x16x32_bf16 v[228:231], a[168:171], a[96:99], v[228:231]
v_mfma_f32_16x16x32_bf16 v[232:235], a[176:179], a[96:99], v[232:235]
v_mfma_f32_16x16x32_bf16 v[232:235], a[180:183], a[100:103], v[232:235]
buffer_load_dwordx4 v6, s[12:15], s64 offen offset:1024 lds
v_mfma_f32_16x16x32_bf16 v[236:239], a[188:191], a[100:103], v[236:239]
ds_read_b128 a[84:87], v10 offset:4096
v_mfma_f32_16x16x32_bf16 v[236:239], a[184:187], a[96:99], v[236:239]
v_mfma_f32_16x16x32_bf16 v[252:255], a[184:187], a[104:107], v[252:255]
v_mfma_f32_16x16x32_bf16 v[252:255], a[188:191], a[108:111], v[252:255]
ds_read_b64_tr_b16 a[152:153], v14 offset:32768
ds_read_b64_tr_b16 a[154:155], v14 offset:33280
v_mfma_f32_16x16x32_bf16 v[248:251], a[180:183], a[108:111], v[248:251]
v_mfma_f32_16x16x32_bf16 v[248:251], a[176:179], a[104:107], v[248:251]
s_add_u32 m0, s73, 2048
s_add_u32 s64, s71, 18432
v_mfma_f32_16x16x32_bf16 v[244:247], a[168:171], a[104:107], v[244:247]
ds_read_b128 a[88:91], v9 offset:6144
v_mfma_f32_16x16x32_bf16 v[244:247], a[172:175], a[108:111], v[244:247]
buffer_load_dwordx4 v5, s[12:15], s64 offen lds
v_mfma_f32_16x16x32_bf16 v[240:243], a[164:167], a[108:111], v[240:243]
v_mfma_f32_16x16x32_bf16 v[240:243], a[160:163], a[104:107], v[240:243]
ds_read_b64_tr_b16 a[156:157], v14 offset:40960
ds_read_b64_tr_b16 a[158:159], v14 offset:41472
v_mfma_f32_16x16x32_bf16 a[0:3], a[160:163], a[112:115], a[0:3]
v_mfma_f32_16x16x32_bf16 a[0:3], a[164:167], a[116:119], a[0:3]
v_mfma_f32_16x16x32_bf16 a[4:7], a[172:175], a[116:119], a[4:7]
ds_read_b128 a[92:95], v10 offset:6144
v_mfma_f32_16x16x32_bf16 a[4:7], a[168:171], a[112:115], a[4:7]
v_mfma_f32_16x16x32_bf16 a[8:11], a[176:179], a[112:115], a[8:11]
v_mfma_f32_16x16x32_bf16 a[8:11], a[180:183], a[116:119], a[8:11]
buffer_load_dwordx4 v6, s[12:15], s64 offen offset:1024 lds
v_mfma_f32_16x16x32_bf16 a[12:15], a[188:191], a[116:119], a[12:15]
v_mfma_f32_16x16x32_bf16 a[12:15], a[184:187], a[112:115], a[12:15]
v_mfma_f32_16x16x32_bf16 a[28:31], a[184:187], a[120:123], a[28:31]
v_mfma_f32_16x16x32_bf16 a[28:31], a[188:191], a[124:127], a[28:31]
v_mfma_f32_16x16x32_bf16 a[24:27], a[180:183], a[124:127], a[24:27]
v_mfma_f32_16x16x32_bf16 a[24:27], a[176:179], a[120:123], a[24:27]
v_mfma_f32_16x16x32_bf16 a[20:23], a[168:171], a[120:123], a[20:23]
v_mfma_f32_16x16x32_bf16 a[20:23], a[172:175], a[124:127], a[20:23]
v_mfma_f32_16x16x32_bf16 a[16:19], a[164:167], a[124:127], a[16:19]
v_mfma_f32_16x16x32_bf16 a[16:19], a[160:163], a[120:123], a[16:19]
s_waitcnt lgkmcnt(0)
v_mfma_f32_16x16x32_bf16 v[32:35], a[64:67], a[128:131], v[32:35]
s_waitcnt vmcnt(20)
v_mfma_f32_16x16x32_bf16 v[32:35], a[68:71], a[132:135], v[32:35]
s_barrier
v_mfma_f32_16x16x32_bf16 v[40:43], a[68:71], a[140:143], v[40:43]
L_PAD3:
s_cbranch_execz L_PAD7
ds_read_b128 a[96:99], v9 offset:8192
v_mfma_f32_16x16x32_bf16 v[40:43], a[64:67], a[136:139], v[40:43]
s_xor_b32 s75, s93, 0
s_lshl_b32 s76, s75, 19
s_add_u32 s76, s76, s74
v_mfma_f32_16x16x32_bf16 v[48:51], a[64:67], a[144:147], v[48:51]
s_lshl_b32 s79, s75, 13
s_add_u32 s79, s79, s78
v_mfma_f32_16x16x32_bf16 v[48:51], a[68:71], a[148:151], v[48:51]
s_add_u32 m0, s77, 32768
s_add_u32 s64, s76, 0
ds_read_b128 a[100:103], v10 offset:8192
v_mfma_f32_16x16x32_bf16 v[56:59], a[68:71], a[156:159], v[56:59]
buffer_load_dwordx4 v7, s[20:23], s64 offen lds
v_mfma_f32_16x16x32_bf16 v[56:59], a[64:67], a[152:155], v[56:59]
v_mfma_f32_16x16x32_bf16 v[60:63], a[72:75], a[152:155], v[60:63]
ds_read_b128 a[104:107], v9 offset:10240
v_mfma_f32_16x16x32_bf16 v[60:63], a[76:79], a[156:159], v[60:63]
v_mfma_f32_16x16x32_bf16 v[52:55], a[76:79], a[148:151], v[52:55]
v_mfma_f32_16x16x32_bf16 v[52:55], a[72:75], a[144:147], v[52:55]
ds_read_b64_tr_b16 a[160:161], v11 offset:49152
ds_read_b64_tr_b16 a[162:163], v11 offset:49664
v_mfma_f32_16x16x32_bf16 v[44:47], a[72:75], a[136:139], v[44:47]
buffer_load_dwordx4 v8, s[20:23], s64 offen offset:1024 lds
v_mfma_f32_16x16x32_bf16 v[44:47], a[76:79], a[140:143], v[44:47]
v_mfma_f32_16x16x32_bf16 v[36:39], a[76:79], a[132:135], v[36:39]
v_mfma_f32_16x16x32_bf16 v[36:39], a[72:75], a[128:131], v[36:39]
ds_read_b128 a[108:111], v10 offset:10240
v_mfma_f32_16x16x32_bf16 v[64:67], a[80:83], a[128:131], v[64:67]
v_mfma_f32_16x16x32_bf16 v[64:67], a[84:87], a[132:135], v[64:67]
v_mfma_f32_16x16x32_bf16 v[72:75], a[84:87], a[140:143], v[72:75]
s_add_u32 m0, s80, 32768
s_add_u32 s64, s79, 0
v_mfma_f32_16x16x32_bf16 v[72:75], a[80:83], a[136:139], v[72:75]
ds_read_b64_tr_b16 a[164:165], v11 offset:57344
ds_read_b64_tr_b16 a[166:167], v11 offset:57856
v_mfma_f32_16x16x32_bf16 v[80:83], a[80:83], a[144:147], v[80:83]
buffer_load_dwordx4 v15, s[24:27], s64 offen sc1 lds
v_mfma_f32_16x16x32_bf16 v[80:83], a[84:87], a[148:151], v[80:83]
ds_read_b128 a[112:115], v9 offset:12288
v_mfma_f32_16x16x32_bf16 v[88:91], a[84:87], a[156:159], v[88:91]
v_cvt_pk_bf16_f32 v32, v32, v33
v_cvt_pk_bf16_f32 v33, v34, v35
v_mfma_f32_16x16x32_bf16 v[88:91], a[80:83], a[152:155], v[88:91]
v_cvt_pk_bf16_f32 v34, v36, v37
v_cvt_pk_bf16_f32 v35, v38, v39
v_mfma_f32_16x16x32_bf16 v[92:95], a[88:91], a[152:155], v[92:95]
ds_read_b64_tr_b16 a[168:169], v12 offset:49152
ds_read_b64_tr_b16 a[170:171], v12 offset:49664
v_mfma_f32_16x16x32_bf16 v[92:95], a[92:95], a[156:159], v[92:95]
v_cvt_pk_bf16_f32 v40, v40, v41
v_cvt_pk_bf16_f32 v41, v42, v43
v_mfma_f32_16x16x32_bf16 v[84:87], a[92:95], a[148:151], v[84:87]
s_add_u32 m0, s73, 4096
s_add_u32 s64, s72, 0
s_lshr_b32 s55, s3, 1
v_mfma_f32_16x16x32_bf16 v[84:87], a[88:91], a[144:147], v[84:87]
s_lshl_b32 s55, s55, 14
s_lshl_b32 s54, s3, 13
s_sub_u32 s55, s54, s55
v_mfma_f32_16x16x32_bf16 v[76:79], a[88:91], a[136:139], v[76:79]
buffer_load_dwordx4 v5, s[12:15], s64 offen lds
v_mfma_f32_16x16x32_bf16 v[76:79], a[92:95], a[140:143], v[76:79]
s_and_b32 s54, s3, 1
s_lshl_b32 s54, s54, 12
ds_read_b128 a[116:119], v10 offset:12288
v_mfma_f32_16x16x32_bf16 v[68:71], a[92:95], a[132:135], v[68:71]
s_add_u32 s53, s88, 0
v_cvt_pk_bf16_f32 v42, v44, v45
v_cvt_pk_bf16_f32 v43, v46, v47
v_mfma_f32_16x16x32_bf16 v[68:71], a[88:91], a[128:131], v[68:71]
s_waitcnt lgkmcnt(6)
ds_read_b64_tr_b16 a[172:173], v12 offset:57344
ds_read_b64_tr_b16 a[174:175], v12 offset:57856
v_mfma_f32_16x16x32_bf16 v[96:99], a[96:99], a[128:131], v[96:99]
buffer_store_dwordx4 v[32:35], v15, s[24:27], s53 offen offset:0 sc1
v_mfma_f32_16x16x32_bf16 v[96:99], a[100:103], a[132:135], v[96:99]
v_cvt_pk_bf16_f32 v48, v48, v49
v_cvt_pk_bf16_f32 v49, v50, v51
v_mfma_f32_16x16x32_bf16 v[104:107], a[100:103], a[140:143], v[104:107]
ds_read_b128 a[120:123], v9 offset:14336
v_cvt_pk_bf16_f32 v50, v52, v53
v_mfma_f32_16x16x32_bf16 v[104:107], a[96:99], a[136:139], v[104:107]
v_cvt_pk_bf16_f32 v51, v54, v55
v_cvt_pk_bf16_f32 v56, v56, v57
v_mfma_f32_16x16x32_bf16 v[112:115], a[96:99], a[144:147], v[112:115]
v_cvt_pk_bf16_f32 v57, v58, v59
v_cvt_pk_bf16_f32 v58, v60, v61
v_mfma_f32_16x16x32_bf16 v[112:115], a[100:103], a[148:151], v[112:115]
buffer_load_dwordx4 v6, s[12:15], s64 offen offset:1024 lds
v_mfma_f32_16x16x32_bf16 v[120:123], a[100:103], a[156:159], v[120:123]
ds_read_b64_tr_b16 a[176:177], v13 offset:49152
ds_read_b64_tr_b16 a[178:179], v13 offset:49664
v_mfma_f32_16x16x32_bf16 v[120:123], a[96:99], a[152:155], v[120:123]
v_cvt_pk_bf16_f32 v59, v62, v63
v_cvt_pk_bf16_f32 v64, v64, v65
v_mfma_f32_16x16x32_bf16 v[124:127], a[104:107], a[152:155], v[124:127]
v_cvt_pk_bf16_f32 v65, v66, v67
v_cvt_pk_bf16_f32 v66, v68, v69
v_mfma_f32_16x16x32_bf16 v[124:127], a[108:111], a[156:159], v[124:127]
ds_read_b128 a[124:127], v10 offset:14336
v_cvt_pk_bf16_f32 v67, v70, v71
v_mfma_f32_16x16x32_bf16 v[116:119], a[108:111], a[148:151], v[116:119]
v_add_u32 v9, 32768, v9
v_add_u32 v10, 32768, v10
v_mfma_f32_16x16x32_bf16 v[116:119], a[104:107], a[144:147], v[116:119]
s_add_u32 m0, s73, 6144
s_add_u32 s64, s72, 18432
v_cvt_pk_bf16_f32 v72, v72, v73
v_mfma_f32_16x16x32_bf16 v[108:111], a[104:107], a[136:139], v[108:111]
ds_read_b64_tr_b16 a[180:181], v13 offset:57344
ds_read_b64_tr_b16 a[182:183], v13 offset:57856
v_mfma_f32_16x16x32_bf16 v[108:111], a[108:111], a[140:143], v[108:111]
buffer_load_dwordx4 v5, s[12:15], s64 offen lds
v_mfma_f32_16x16x32_bf16 v[100:103], a[108:111], a[132:135], v[100:103]
v_cvt_pk_bf16_f32 v73, v74, v75
v_cvt_pk_bf16_f32 v74, v76, v77
v_mfma_f32_16x16x32_bf16 v[100:103], a[104:107], a[128:131], v[100:103]
s_waitcnt lgkmcnt(2)
ds_read_b64_tr_b16 a[184:185], v14 offset:49152
ds_read_b64_tr_b16 a[186:187], v14 offset:49664
v_mfma_f32_16x16x32_bf16 v[128:131], a[112:115], a[128:131], v[128:131]
v_cvt_pk_bf16_f32 v75, v78, v79
v_cvt_pk_bf16_f32 v80, v80, v81
v_mfma_f32_16x16x32_bf16 v[128:131], a[116:119], a[132:135], v[128:131]
v_cvt_pk_bf16_f32 v81, v82, v83
v_cvt_pk_bf16_f32 v82, v84, v85
v_mfma_f32_16x16x32_bf16 v[136:139], a[116:119], a[140:143], v[136:139]
ds_read_b64_tr_b16 a[188:189], v14 offset:57344
ds_read_b64_tr_b16 a[190:191], v14 offset:57856
v_mfma_f32_16x16x32_bf16 v[136:139], a[112:115], a[136:139], v[136:139]
v_add_u32 v9, s55, v9
v_add_u32 v10, s55, v10
v_mfma_f32_16x16x32_bf16 v[144:147], a[112:115], a[144:147], v[144:147]
v_subrev_u32 v11, s54, v11
v_subrev_u32 v12, s54, v12
v_mfma_f32_16x16x32_bf16 v[144:147], a[116:119], a[148:151], v[144:147]
buffer_load_dwordx4 v6, s[12:15], s64 offen offset:1024 lds
v_mfma_f32_16x16x32_bf16 v[152:155], a[116:119], a[156:159], v[152:155]
v_subrev_u32 v13, s54, v13
v_subrev_u32 v14, s54, v14
v_mfma_f32_16x16x32_bf16 v[152:155], a[112:115], a[152:155], v[152:155]
v_cvt_pk_bf16_f32 v83, v86, v87
v_cvt_pk_bf16_f32 v88, v88, v89
v_mfma_f32_16x16x32_bf16 v[156:159], a[120:123], a[152:155], v[156:159]
v_cvt_pk_bf16_f32 v89, v90, v91
v_cvt_pk_bf16_f32 v90, v92, v93
v_mfma_f32_16x16x32_bf16 v[156:159], a[124:127], a[156:159], v[156:159]
s_add_u32 s53, s88, 0
v_cvt_pk_bf16_f32 v91, v94, v95
v_cvt_pk_bf16_f32 v96, v96, v97
v_mfma_f32_16x16x32_bf16 v[148:151], a[124:127], a[148:151], v[148:151]
buffer_store_dwordx4 v[40:43], v15, s[24:27], s53 offen offset:1024 sc1
v_mfma_f32_16x16x32_bf16 v[148:151], a[120:123], a[144:147], v[148:151]
v_cvt_pk_bf16_f32 v97, v98, v99
v_cvt_pk_bf16_f32 v98, v100, v101
v_mfma_f32_16x16x32_bf16 v[140:143], a[120:123], a[136:139], v[140:143]
v_cvt_pk_bf16_f32 v99, v102, v103
v_cvt_pk_bf16_f32 v104, v104, v105
v_mfma_f32_16x16x32_bf16 v[140:143], a[124:127], a[140:143], v[140:143]
v_cvt_pk_bf16_f32 v105, v106, v107
v_cvt_pk_bf16_f32 v106, v108, v109
v_mfma_f32_16x16x32_bf16 v[132:135], a[124:127], a[132:135], v[132:135]
v_cvt_pk_bf16_f32 v107, v110, v111
v_cvt_pk_bf16_f32 v112, v112, v113
v_mfma_f32_16x16x32_bf16 v[132:135], a[120:123], a[128:131], v[132:135]
s_waitcnt lgkmcnt(0)
v_cvt_pk_bf16_f32 v113, v114, v115
v_cvt_pk_bf16_f32 v114, v116, v117
v_mfma_f32_16x16x32_bf16 v[160:163], a[160:163], a[64:67], v[160:163]
s_waitcnt vmcnt(16)
v_cvt_pk_bf16_f32 v115, v118, v119
v_cvt_pk_bf16_f32 v120, v120, v121
v_mfma_f32_16x16x32_bf16 v[160:163], a[164:167], a[68:71], v[160:163]
s_barrier
v_mfma_f32_16x16x32_bf16 v[164:167], a[172:175], a[68:71], v[164:167]
ds_read_b64_tr_b16 a[128:129], v11 offset:0
ds_read_b64_tr_b16 a[130:131], v11 offset:512
v_mfma_f32_16x16x32_bf16 v[164:167], a[168:171], a[64:67], v[164:167]
s_add_u32 m0, s77, 49152
s_add_u32 s64, s76, 128
v_cvt_pk_bf16_f32 v121, v122, v123
v_mfma_f32_16x16x32_bf16 v[168:171], a[176:179], a[64:67], v[168:171]
buffer_load_dwordx4 v7, s[20:23], s64 offen lds
v_mfma_f32_16x16x32_bf16 v[168:171], a[180:183], a[68:71], v[168:171]
ds_read_b64_tr_b16 a[132:133], v11 offset:4096
ds_read_b64_tr_b16 a[134:135], v11 offset:4608
v_mfma_f32_16x16x32_bf16 v[172:175], a[188:191], a[68:71], v[172:175]
v_cvt_pk_bf16_f32 v122, v124, v125
v_cvt_pk_bf16_f32 v123, v126, v127
v_mfma_f32_16x16x32_bf16 v[172:175], a[184:187], a[64:67], v[172:175]
v_cvt_pk_bf16_f32 v128, v128, v129
v_cvt_pk_bf16_f32 v129, v130, v131
v_mfma_f32_16x16x32_bf16 v[188:191], a[184:187], a[72:75], v[188:191]
ds_read_b64_tr_b16 a[136:137], v12 offset:0
ds_read_b64_tr_b16 a[138:139], v12 offset:512
v_mfma_f32_16x16x32_bf16 v[188:191], a[188:191], a[76:79], v[188:191]
v_cvt_pk_bf16_f32 v130, v132, v133
v_cvt_pk_bf16_f32 v131, v134, v135
v_mfma_f32_16x16x32_bf16 v[184:187], a[180:183], a[76:79], v[184:187]
v_cvt_pk_bf16_f32 v136, v136, v137
v_cvt_pk_bf16_f32 v137, v138, v139
v_mfma_f32_16x16x32_bf16 v[184:187], a[176:179], a[72:75], v[184:187]
ds_read_b64_tr_b16 a[140:141], v12 offset:4096
ds_read_b64_tr_b16 a[142:143], v12 offset:4608
v_mfma_f32_16x16x32_bf16 v[180:183], a[168:171], a[72:75], v[180:183]
buffer_load_dwordx4 v8, s[20:23], s64 offen offset:1024 lds
v_mfma_f32_16x16x32_bf16 v[180:183], a[172:175], a[76:79], v[180:183]
v_cvt_pk_bf16_f32 v138, v140, v141
v_cvt_pk_bf16_f32 v139, v142, v143
v_mfma_f32_16x16x32_bf16 v[176:179], a[164:167], a[76:79], v[176:179]
v_cvt_pk_bf16_f32 v144, v144, v145
v_cvt_pk_bf16_f32 v145, v146, v147
v_mfma_f32_16x16x32_bf16 v[176:179], a[160:163], a[72:75], v[176:179]
ds_read_b64_tr_b16 a[144:145], v13 offset:0
ds_read_b64_tr_b16 a[146:147], v13 offset:512
v_mfma_f32_16x16x32_bf16 v[192:195], a[160:163], a[80:83], v[192:195]
v_cvt_pk_bf16_f32 v146, v148, v149
v_cvt_pk_bf16_f32 v147, v150, v151
v_mfma_f32_16x16x32_bf16 v[192:195], a[164:167], a[84:87], v[192:195]
v_cvt_pk_bf16_f32 v152, v152, v153
v_cvt_pk_bf16_f32 v153, v154, v155
v_mfma_f32_16x16x32_bf16 v[196:199], a[172:175], a[84:87], v[196:199]
s_add_u32 m0, s80, 49152
s_add_u32 s64, s79, 2048
v_cvt_pk_bf16_f32 v154, v156, v157
v_mfma_f32_16x16x32_bf16 v[196:199], a[168:171], a[80:83], v[196:199]
ds_read_b64_tr_b16 a[148:149], v13 offset:4096
ds_read_b64_tr_b16 a[150:151], v13 offset:4608
v_mfma_f32_16x16x32_bf16 v[200:203], a[176:179], a[80:83], v[200:203]
buffer_load_dwordx4 v15, s[24:27], s64 offen sc1 lds
v_mfma_f32_16x16x32_bf16 v[200:203], a[180:183], a[84:87], v[200:203]
s_xor_b32 s65, s70, 128
s_add_u32 s71, s68, s65
s_add_u32 s72, s69, s65
v_mfma_f32_16x16x32_bf16 v[204:207], a[188:191], a[84:87], v[204:207]
s_add_u32 s53, s88, 0
ds_read_b64_tr_b16 a[152:153], v14 offset:0
ds_read_b64_tr_b16 a[154:155], v14 offset:512
v_mfma_f32_16x16x32_bf16 v[204:207], a[184:187], a[80:83], v[204:207]
buffer_store_dwordx4 v[48:51], v15, s[24:27], s53 offen offset:2048 sc1
v_mfma_f32_16x16x32_bf16 v[220:223], a[184:187], a[88:91], v[220:223]
ds_read_b64_tr_b16 a[156:157], v14 offset:4096
ds_read_b64_tr_b16 a[158:159], v14 offset:4608
v_mfma_f32_16x16x32_bf16 v[220:223], a[188:191], a[92:95], v[220:223]
v_cvt_pk_bf16_f32 v155, v158, v159
v_mul_f32 v160, s91, v160
v_mfma_f32_16x16x32_bf16 v[216:219], a[180:183], a[92:95], v[216:219]
s_add_u32 m0, s73, 32768
s_add_u32 s64, s71, 0
v_mul_f32 v161, s91, v161
v_mfma_f32_16x16x32_bf16 v[216:219], a[176:179], a[88:91], v[216:219]
v_mul_f32 v162, s91, v162
v_mul_f32 v163, s91, v163
v_mfma_f32_16x16x32_bf16 v[212:215], a[168:171], a[88:91], v[212:215]
buffer_load_dwordx4 v5, s[12:15], s64 offen lds
v_mfma_f32_16x16x32_bf16 v[212:215], a[172:175], a[92:95], v[212:215]
ds_read_b128 a[68:71], v4 offset:10240
v_mul_f32 v164, s91, v164
v_mfma_f32_16x16x32_bf16 v[208:211], a[164:167], a[92:95], v[208:211]
v_mul_f32 v165, s91, v165
v_mul_f32 v166, s91, v166
v_mfma_f32_16x16x32_bf16 v[208:211], a[160:163], a[88:91], v[208:211]
ds_read_b128 a[64:67], v4 offset:8192
v_mul_f32 v167, s91, v167
v_mfma_f32_16x16x32_bf16 v[224:227], a[160:163], a[96:99], v[224:227]
v_cvt_pk_bf16_f32 v160, v160, v161
v_cvt_pk_bf16_f32 v161, v162, v163
v_mfma_f32_16x16x32_bf16 v[224:227], a[164:167], a[100:103], v[224:227]
v_cvt_pk_bf16_f32 v162, v164, v165
v_cvt_pk_bf16_f32 v163, v166, v167
v_mfma_f32_16x16x32_bf16 v[228:231], a[172:175], a[100:103], v[228:231]
ds_read_b128 a[76:79], v4 offset:11264
v_mul_f32 v168, s91, v168
v_mfma_f32_16x16x32_bf16 v[228:231], a[168:171], a[96:99], v[228:231]
v_mul_f32 v169, s91, v169
v_mul_f32 v170, s91, v170
v_mfma_f32_16x16x32_bf16 v[232:235], a[176:179], a[96:99], v[232:235]
v_mul_f32 v171, s91, v171
v_mul_f32 v172, s91, v172
v_mfma_f32_16x16x32_bf16 v[232:235], a[180:183], a[100:103], v[232:235]
buffer_load_dwordx4 v6, s[12:15], s64 offen offset:1024 lds
v_mfma_f32_16x16x32_bf16 v[236:239], a[188:191], a[100:103], v[236:239]
ds_read_b128 a[72:75], v4 offset:9216
v_mul_f32 v173, s91, v173
v_mfma_f32_16x16x32_bf16 v[236:239], a[184:187], a[96:99], v[236:239]
v_mul_f32 v174, s91, v174
v_mul_f32 v175, s91, v175
v_mfma_f32_16x16x32_bf16 v[252:255], a[184:187], a[104:107], v[252:255]
v_cvt_pk_bf16_f32 v168, v168, v169
v_cvt_pk_bf16_f32 v169, v170, v171
v_mfma_f32_16x16x32_bf16 v[252:255], a[188:191], a[108:111], v[252:255]
ds_read_b128 a[84:87], v10 offset:0
v_cvt_pk_bf16_f32 v170, v172, v173
v_mfma_f32_16x16x32_bf16 v[248:251], a[180:183], a[108:111], v[248:251]
v_cvt_pk_bf16_f32 v171, v174, v175
v_mul_f32 v176, s91, v176
v_mfma_f32_16x16x32_bf16 v[248:251], a[176:179], a[104:107], v[248:251]
s_add_u32 m0, s73, 34816
s_add_u32 s64, s71, 18432
v_mul_f32 v177, s91, v177
v_mfma_f32_16x16x32_bf16 v[244:247], a[168:171], a[104:107], v[244:247]
ds_read_b128 a[80:83], v9 offset:0
v_mul_f32 v178, s91, v178
v_mfma_f32_16x16x32_bf16 v[244:247], a[172:175], a[108:111], v[244:247]
buffer_load_dwordx4 v5, s[12:15], s64 offen lds
v_mfma_f32_16x16x32_bf16 v[240:243], a[164:167], a[108:111], v[240:243]
v_mul_f32 v179, s91, v179
v_mul_f32 v180, s91, v180
v_mfma_f32_16x16x32_bf16 v[240:243], a[160:163], a[104:107], v[240:243]
s_add_u32 s53, s88, 0
ds_read_b128 a[92:95], v10 offset:2048
v_mul_f32 v181, s91, v181
v_mfma_f32_16x16x32_bf16 a[0:3], a[160:163], a[112:115], a[0:3]
buffer_store_dwordx4 v[56:59], v15, s[24:27], s53 offen offset:3072 sc1
v_mfma_f32_16x16x32_bf16 a[0:3], a[164:167], a[116:119], a[0:3]
v_mul_f32 v182, s91, v182
v_mul_f32 v183, s91, v183
v_mfma_f32_16x16x32_bf16 a[4:7], a[172:175], a[116:119], a[4:7]
ds_read_b128 a[88:91], v9 offset:2048
v_cvt_pk_bf16_f32 v176, v176, v177
v_mfma_f32_16x16x32_bf16 a[4:7], a[168:171], a[112:115], a[4:7]
v_cvt_pk_bf16_f32 v177, v178, v179
v_cvt_pk_bf16_f32 v178, v180, v181
v_mfma_f32_16x16x32_bf16 a[8:11], a[176:179], a[112:115], a[8:11]
v_cvt_pk_bf16_f32 v179, v182, v183
v_mul_f32 v184, s91, v184
v_mfma_f32_16x16x32_bf16 a[8:11], a[180:183], a[116:119], a[8:11]
buffer_load_dwordx4 v6, s[12:15], s64 offen offset:1024 lds
v_mfma_f32_16x16x32_bf16 a[12:15], a[188:191], a[116:119], a[12:15]
v_mul_f32 v185, s91, v185
v_mul_f32 v186, s91, v186
v_mfma_f32_16x16x32_bf16 a[12:15], a[184:187], a[112:115], a[12:15]
v_mul_f32 v187, s91, v187
v_mul_f32 v188, s91, v188
v_mfma_f32_16x16x32_bf16 a[28:31], a[184:187], a[120:123], a[28:31]
v_mul_f32 v189, s91, v189
v_mul_f32 v190, s91, v190
v_mfma_f32_16x16x32_bf16 a[28:31], a[188:191], a[124:127], a[28:31]
v_mul_f32 v191, s91, v191
v_cvt_pk_bf16_f32 v184, v184, v185
v_mfma_f32_16x16x32_bf16 a[24:27], a[180:183], a[124:127], a[24:27]
v_cvt_pk_bf16_f32 v185, v186, v187
v_cvt_pk_bf16_f32 v186, v188, v189
v_mfma_f32_16x16x32_bf16 a[24:27], a[176:179], a[120:123], a[24:27]
v_cvt_pk_bf16_f32 v187, v190, v191
v_mul_f32 v192, s91, v192
v_mfma_f32_16x16x32_bf16 a[20:23], a[168:171], a[120:123], a[20:23]
v_mul_f32 v193, s91, v193
v_mul_f32 v194, s91, v194
v_mfma_f32_16x16x32_bf16 a[20:23], a[172:175], a[124:127], a[20:23]
v_mul_f32 v195, s91, v195
v_mul_f32 v196, s91, v196
v_mfma_f32_16x16x32_bf16 a[16:19], a[164:167], a[124:127], a[16:19]
v_mul_f32 v197, s91, v197
v_mul_f32 v198, s91, v198
v_mfma_f32_16x16x32_bf16 a[16:19], a[160:163], a[120:123], a[16:19]
s_waitcnt lgkmcnt(0)
v_mul_f32 v199, s91, v199
v_cvt_pk_bf16_f32 v192, v192, v193
v_mfma_f32_16x16x32_bf16 v[36:39], a[128:131], a[80:83], 0
s_waitcnt vmcnt(22)
v_cvt_pk_bf16_f32 v193, v194, v195
v_cvt_pk_bf16_f32 v194, v196, v197
v_mfma_f32_16x16x32_bf16 v[36:39], a[132:135], a[84:87], v[36:39]
s_barrier
v_mfma_f32_16x16x32_bf16 v[44:47], a[140:143], a[84:87], 0
ds_read_b128 a[96:99], v9 offset:4096
v_cvt_pk_bf16_f32 v195, v198, v199
v_mfma_f32_16x16x32_bf16 v[44:47], a[136:139], a[80:83], v[44:47]
s_xor_b32 s75, s93, 1
s_lshl_b32 s76, s75, 19
s_add_u32 s76, s76, s74
v_mfma_f32_16x16x32_bf16 v[32:35], a[144:147], a[80:83], 0
s_lshl_b32 s79, s75, 13
s_add_u32 s79, s79, s78
ds_read_b128 a[100:103], v10 offset:4096
v_mfma_f32_16x16x32_bf16 v[32:35], a[148:151], a[84:87], v[32:35]
s_add_u32 m0, s77, 0
s_add_u32 s64, s76, 0
ds_read_b128 a[104:107], v9 offset:6144
v_mfma_f32_16x16x32_bf16 v[52:55], a[156:159], a[84:87], 0
buffer_load_dwordx4 v7, s[20:23], s64 offen lds
v_mfma_f32_16x16x32_bf16 v[52:55], a[152:155], a[80:83], v[52:55]
ds_read_b64_tr_b16 a[160:161], v11 offset:16384
ds_read_b64_tr_b16 a[162:163], v11 offset:16896
v_mfma_f32_16x16x32_bf16 v[60:63], a[64:67], a[80:83], 0
v_mul_f32 v200, s91, v200
v_mul_f32 v201, s91, v201
v_mfma_f32_16x16x32_bf16 v[60:63], a[68:71], a[84:87], v[60:63]
ds_read_b128 a[108:111], v10 offset:6144
v_mul_f32 v202, s91, v202
v_mfma_f32_16x16x32_bf16 v[68:71], a[76:79], a[84:87], 0
buffer_load_dwordx4 v8, s[20:23], s64 offen offset:1024 lds
v_mfma_f32_16x16x32_bf16 v[68:71], a[72:75], a[80:83], v[68:71]
s_add_u32 s53, s88, 262144
ds_read_b64_tr_b16 a[164:165], v11 offset:20480
ds_read_b64_tr_b16 a[166:167], v11 offset:20992
v_mfma_f32_16x16x32_bf16 v[76:79], a[72:75], a[88:91], 0
v_add_u32 v9, -65536, v9
v_add_u32 v10, -65536, v10
v_mfma_f32_16x16x32_bf16 v[76:79], a[76:79], a[92:95], v[76:79]
ds_read_b64_tr_b16 a[168:169], v12 offset:16384
ds_read_b64_tr_b16 a[170:171], v12 offset:16896
v_mfma_f32_16x16x32_bf16 v[84:87], a[68:71], a[92:95], 0
s_add_u32 m0, s80, 0
s_add_u32 s64, s79, 0
v_mul_f32 v203, s91, v203
v_mfma_f32_16x16x32_bf16 v[84:87], a[64:67], a[88:91], v[84:87]
ds_read_b64_tr_b16 a[172:173], v12 offset:20480
ds_read_b64_tr_b16 a[174:175], v12 offset:20992
v_mfma_f32_16x16x32_bf16 v[92:95], a[152:155], a[88:91], 0
buffer_load_dwordx4 v15, s[24:27], s64 offen sc1 lds
v_mfma_f32_16x16x32_bf16 v[92:95], a[156:159], a[92:95], v[92:95]
buffer_store_dwordx4 v[64:67], v15, s[24:27], s53 offen offset:0 sc1
v_mfma_f32_16x16x32_bf16 v[40:43], a[148:151], a[92:95], 0
ds_read_b64_tr_b16 a[176:177], v13 offset:16384
ds_read_b64_tr_b16 a[178:179], v13 offset:16896
v_mfma_f32_16x16x32_bf16 v[40:43], a[144:147], a[88:91], v[40:43]
v_mul_f32 v204, s91, v204
v_mul_f32 v205, s91, v205
v_mfma_f32_16x16x32_bf16 v[100:103], a[136:139], a[88:91], 0
s_add_u32 m0, s73, 36864
s_add_u32 s64, s72, 0
v_mul_f32 v206, s91, v206
v_mfma_f32_16x16x32_bf16 v[100:103], a[140:143], a[92:95], v[100:103]
ds_read_b64_tr_b16 a[180:181], v13 offset:20480
ds_read_b64_tr_b16 a[182:183], v13 offset:20992
v_mfma_f32_16x16x32_bf16 v[108:111], a[132:135], a[92:95], 0
buffer_load_dwordx4 v5, s[12:15], s64 offen lds
v_mfma_f32_16x16x32_bf16 v[108:111], a[128:131], a[88:91], v[108:111]
s_waitcnt lgkmcnt(14)
ds_read_b64_tr_b16 a[184:185], v14 offset:16384
ds_read_b64_tr_b16 a[186:187], v14 offset:16896
v_mfma_f32_16x16x32_bf16 v[116:119], a[128:131], a[96:99], 0
ds_read_b64_tr_b16 a[188:189], v14 offset:20480
ds_read_b64_tr_b16 a[190:191], v14 offset:20992
v_mfma_f32_16x16x32_bf16 v[116:119], a[132:135], a[100:103], v[116:119]
v_mul_f32 v207, s91, v207
v_cvt_pk_bf16_f32 v200, v200, v201
v_mfma_f32_16x16x32_bf16 v[124:127], a[140:143], a[100:103], 0
v_cvt_pk_bf16_f32 v201, v202, v203
v_cvt_pk_bf16_f32 v202, v204, v205
v_mfma_f32_16x16x32_bf16 v[124:127], a[136:139], a[96:99], v[124:127]
ds_read_b128 a[112:115], v4 offset:24576
v_cvt_pk_bf16_f32 v203, v206, v207
v_mfma_f32_16x16x32_bf16 v[132:135], a[144:147], a[96:99], 0
buffer_load_dwordx4 v6, s[12:15], s64 offen offset:1024 lds
v_mfma_f32_16x16x32_bf16 v[132:135], a[148:151], a[100:103], v[132:135]
ds_read_b128 a[116:119], v4 offset:26624
v_mul_f32 v208, s91, v208
v_mfma_f32_16x16x32_bf16 v[140:143], a[156:159], a[100:103], 0
v_mul_f32 v209, s91, v209
v_mul_f32 v210, s91, v210
v_mfma_f32_16x16x32_bf16 v[140:143], a[152:155], a[96:99], v[140:143]
ds_read_b128 a[120:123], v4 offset:25600
v_mul_f32 v211, s91, v211
v_mfma_f32_16x16x32_bf16 v[148:151], a[64:67], a[96:99], 0
s_add_u32 m0, s73, 38912
s_add_u32 s64, s72, 18432
v_mul_f32 v212, s91, v212
v_mfma_f32_16x16x32_bf16 v[148:151], a[68:71], a[100:103], v[148:151]
ds_read_b128 a[124:127], v4 offset:27648
v_mul_f32 v213, s91, v213
v_mfma_f32_16x16x32_bf16 v[48:51], a[76:79], a[100:103], 0
buffer_load_dwordx4 v5, s[12:15], s64 offen lds
v_mfma_f32_16x16x32_bf16 v[48:51], a[72:75], a[96:99], v[48:51]
s_waitcnt lgkmcnt(15)
v_mul_f32 v214, s91, v214
v_mul_f32 v215, s91, v215
v_mfma_f32_16x16x32_bf16 v[156:159], a[72:75], a[104:107], 0
v_cvt_pk_bf16_f32 v208, v208, v209
v_cvt_pk_bf16_f32 v209, v210, v211
v_mfma_f32_16x16x32_bf16 v[156:159], a[76:79], a[108:111], v[156:159]
s_add_u32 s53, s88, 262144
v_cvt_pk_bf16_f32 v210, v212, v213
v_cvt_pk_bf16_f32 v211, v214, v215
v_mfma_f32_16x16x32_bf16 v[164:167], a[68:71], a[108:111], 0
buffer_store_dwordx4 v[72:75], v15, s[24:27], s53 offen offset:1024 sc1
v_mfma_f32_16x16x32_bf16 v[164:167], a[64:67], a[104:107], v[164:167]
v_mul_f32 v216, s91, v216
v_mul_f32 v217, s91, v217
v_mfma_f32_16x16x32_bf16 v[172:175], a[152:155], a[104:107], 0
buffer_load_dwordx4 v6, s[12:15], s64 offen offset:1024 lds
v_mfma_f32_16x16x32_bf16 v[172:175], a[156:159], a[108:111], v[172:175]
v_mul_f32 v218, s91, v218
v_mul_f32 v219, s91, v219
v_mfma_f32_16x16x32_bf16 v[56:59], a[148:151], a[108:111], 0
v_mul_f32 v220, s91, v220
v_mul_f32 v221, s91, v221
v_mfma_f32_16x16x32_bf16 v[56:59], a[144:147], a[104:107], v[56:59]
v_mul_f32 v222, s91, v222
v_mul_f32 v223, s91, v223
v_mfma_f32_16x16x32_bf16 v[180:183], a[136:139], a[104:107], 0
v_cvt_pk_bf16_f32 v216, v216, v217
v_cvt_pk_bf16_f32 v217, v218, v219
v_mfma_f32_16x16x32_bf16 v[180:183], a[140:143], a[108:111], v[180:183]
v_cvt_pk_bf16_f32 v218, v220, v221
v_cvt_pk_bf16_f32 v219, v222, v223
v_mfma_f32_16x16x32_bf16 v[188:191], a[132:135], a[108:111], 0
v_mul_f32 v224, s91, v224
v_mul_f32 v225, s91, v225
v_mfma_f32_16x16x32_bf16 v[188:191], a[128:131], a[104:107], v[188:191]
s_waitcnt lgkmcnt(0)
v_mul_f32 v226, s91, v226
v_mul_f32 v227, s91, v227
v_mfma_f32_16x16x32_bf16 v[196:199], a[160:163], a[80:83], 0
s_waitcnt vmcnt(19)
v_mul_f32 v228, s91, v228
v_mul_f32 v229, s91, v229
v_mfma_f32_16x16x32_bf16 v[196:199], a[164:167], a[84:87], v[196:199]
s_barrier
v_mfma_f32_16x16x32_bf16 v[64:67], a[172:175], a[84:87], 0
ds_read_b64_tr_b16 a[128:129], v11 offset:32768
ds_read_b64_tr_b16 a[130:131], v11 offset:33280
v_mfma_f32_16x16x32_bf16 v[64:67], a[168:171], a[80:83], v[64:67]
s_add_u32 m0, s77, 16384
s_add_u32 s64, s76, 128
v_mul_f32 v230, s91, v230
v_mfma_f32_16x16x32_bf16 v[204:207], a[176:179], a[80:83], 0
buffer_load_dwordx4 v7, s[20:23], s64 offen lds
v_mfma_f32_16x16x32_bf16 v[204:207], a[180:183], a[84:87], v[204:207]
ds_read_b64_tr_b16 a[132:133], v11 offset:36864
ds_read_b64_tr_b16 a[134:135], v11 offset:37376
v_mfma_f32_16x16x32_bf16 v[212:215], a[188:191], a[84:87], 0
ds_read_b64_tr_b16 a[136:137], v12 offset:32768
ds_read_b64_tr_b16 a[138:139], v12 offset:33280
v_mfma_f32_16x16x32_bf16 v[212:215], a[184:187], a[80:83], v[212:215]
ds_read_b64_tr_b16 a[140:141], v12 offset:36864
ds_read_b64_tr_b16 a[142:143], v12 offset:37376
v_mfma_f32_16x16x32_bf16 v[72:75], a[112:115], a[80:83], 0
v_mul_f32 v231, s91, v231
v_cvt_pk_bf16_f32 v224, v224, v225
v_mfma_f32_16x16x32_bf16 v[72:75], a[116:119], a[84:87], v[72:75]
ds_read_b64_tr_b16 a[144:145], v13 offset:32768
ds_read_b64_tr_b16 a[146:147], v13 offset:33280
v_mfma_f32_16x16x32_bf16 v[220:223], a[124:127], a[84:87], 0
buffer_load_dwordx4 v8, s[20:23], s64 offen offset:1024 lds
v_mfma_f32_16x16x32_bf16 v[220:223], a[120:123], a[80:83], v[220:223]
ds_read_b64_tr_b16 a[148:149], v13 offset:36864
ds_read_b64_tr_b16 a[150:151], v13 offset:37376
v_mfma_f32_16x16x32_bf16 a[32:35], a[120:123], a[88:91], 0
v_cvt_pk_bf16_f32 v225, v226, v227
v_cvt_pk_bf16_f32 v226, v228, v229
v_mfma_f32_16x16x32_bf16 a[32:35], a[124:127], a[92:95], a[32:35]
ds_read_b64_tr_b16 a[152:153], v14 offset:32768
ds_read_b64_tr_b16 a[154:155], v14 offset:33280
v_mfma_f32_16x16x32_bf16 a[36:39], a[116:119], a[92:95], 0
s_add_u32 m0, s80, 16384
s_add_u32 s64, s79, 2048
v_cvt_pk_bf16_f32 v227, v230, v231
v_mfma_f32_16x16x32_bf16 a[36:39], a[112:115], a[88:91], a[36:39]
ds_read_b64_tr_b16 a[156:157], v14 offset:36864
ds_read_b64_tr_b16 a[158:159], v14 offset:37376
v_mfma_f32_16x16x32_bf16 v[228:231], a[184:187], a[88:91], 0
buffer_load_dwordx4 v15, s[24:27], s64 offen sc1 lds
v_mfma_f32_16x16x32_bf16 v[228:231], a[188:191], a[92:95], v[228:231]
s_xor_b32 s65, s70, 256
s_add_u32 s71, s68, s65
s_add_u32 s72, s69, s65
v_mfma_f32_16x16x32_bf16 a[40:43], a[180:183], a[92:95], 0
s_add_u32 s53, s88, 262144
ds_read_b128 a[64:67], v4 offset:40960
v_mul_f32 v232, s91, v232
v_mfma_f32_16x16x32_bf16 a[40:43], a[176:179], a[88:91], a[40:43]
buffer_store_dwordx4 v[80:83], v15, s[24:27], s53 offen offset:2048 sc1
v_mfma_f32_16x16x32_bf16 a[44:47], a[168:171], a[88:91], 0
s_add_u32 m0, s73, 65536
s_add_u32 s64, s71, 0
ds_read_b128 a[80:83], v9 offset:0
v_mfma_f32_16x16x32_bf16 a[44:47], a[172:175], a[92:95], a[44:47]
L_PAD4:
s_cbranch_execz L_PAD8
v_mul_f32 v233, s91, v233
v_mul_f32 v234, s91, v234
v_mfma_f32_16x16x32_bf16 v[80:83], a[164:167], a[92:95], 0
buffer_load_dwordx4 v5, s[12:15], s64 offen lds
v_mfma_f32_16x16x32_bf16 v[80:83], a[160:163], a[88:91], v[80:83]
ds_read_b128 a[68:71], v4 offset:43008
v_mul_f32 v235, s91, v235
v_mfma_f32_16x16x32_bf16 a[48:51], a[160:163], a[96:99], 0
ds_read_b128 a[84:87], v10 offset:0
v_mul_f32 v236, s91, v236
v_mfma_f32_16x16x32_bf16 a[48:51], a[164:167], a[100:103], a[48:51]
v_mul_f32 v237, s91, v237
v_mul_f32 v238, s91, v238
v_mfma_f32_16x16x32_bf16 a[52:55], a[172:175], a[100:103], 0
v_mul_f32 v239, s91, v239
v_cvt_pk_bf16_f32 v232, v232, v233
v_mfma_f32_16x16x32_bf16 a[52:55], a[168:171], a[96:99], a[52:55]
ds_read_b128 a[72:75], v4 offset:41984
v_cvt_pk_bf16_f32 v233, v234, v235
v_mfma_f32_16x16x32_bf16 a[56:59], a[176:179], a[96:99], 0
buffer_load_dwordx4 v6, s[12:15], s64 offen offset:1024 lds
v_mfma_f32_16x16x32_bf16 a[56:59], a[180:183], a[100:103], a[56:59]
ds_read_b128 a[88:91], v9 offset:2048
v_cvt_pk_bf16_f32 v234, v236, v237
v_mfma_f32_16x16x32_bf16 a[60:63], a[188:191], a[100:103], 0
v_cvt_pk_bf16_f32 v235, v238, v239
v_mul_f32 v240, s91, v240
v_mfma_f32_16x16x32_bf16 a[60:63], a[184:187], a[96:99], a[60:63]
ds_read_b128 a[76:79], v4 offset:44032
v_mul_f32 v241, s91, v241
v_mfma_f32_16x16x32_bf16 v[236:239], a[112:115], a[96:99], 0
s_add_u32 m0, s73, 67584
s_add_u32 s64, s71, 18432
v_mul_f32 v242, s91, v242
v_mfma_f32_16x16x32_bf16 v[236:239], a[116:119], a[100:103], v[236:239]
ds_read_b128 a[92:95], v10 offset:2048
v_mul_f32 v243, s91, v243
v_mfma_f32_16x16x32_bf16 a[192:195], a[124:127], a[100:103], 0
buffer_load_dwordx4 v5, s[12:15], s64 offen lds
v_mfma_f32_16x16x32_bf16 a[192:195], a[120:123], a[96:99], a[192:195]
v_mul_f32 v244, s91, v244
v_mul_f32 v245, s91, v245
v_mfma_f32_16x16x32_bf16 a[196:199], a[120:123], a[104:107], 0
v_mul_f32 v246, s91, v246
v_mul_f32 v247, s91, v247
v_mfma_f32_16x16x32_bf16 a[196:199], a[124:127], a[108:111], a[196:199]
v_cvt_pk_bf16_f32 v240, v240, v241
v_cvt_pk_bf16_f32 v241, v242, v243
v_mfma_f32_16x16x32_bf16 a[200:203], a[116:119], a[108:111], 0
v_cvt_pk_bf16_f32 v242, v244, v245
v_cvt_pk_bf16_f32 v243, v246, v247
v_mfma_f32_16x16x32_bf16 a[200:203], a[112:115], a[104:107], a[200:203]
v_mul_f32 v248, s91, v248
v_mul_f32 v249, s91, v249
v_mfma_f32_16x16x32_bf16 v[244:247], a[184:187], a[104:107], 0
buffer_load_dwordx4 v6, s[12:15], s64 offen offset:1024 lds
v_mfma_f32_16x16x32_bf16 v[244:247], a[188:191], a[108:111], v[244:247]
v_mul_f32 v250, s91, v250
v_mul_f32 v251, s91, v251
v_mfma_f32_16x16x32_bf16 a[204:207], a[180:183], a[108:111], 0
v_mul_f32 v252, s91, v252
v_mul_f32 v253, s91, v253
v_mfma_f32_16x16x32_bf16 a[204:207], a[176:179], a[104:107], a[204:207]
s_add_u32 s53, s88, 262144
v_mul_f32 v254, s91, v254
v_mul_f32 v255, s91, v255
v_mfma_f32_16x16x32_bf16 a[208:211], a[168:171], a[104:107], 0
buffer_store_dwordx4 v[88:91], v15, s[24:27], s53 offen offset:3072 sc1
v_mfma_f32_16x16x32_bf16 a[208:211], a[172:175], a[108:111], a[208:211]
v_cvt_pk_bf16_f32 v248, v248, v249
v_cvt_pk_bf16_f32 v249, v250, v251
v_mfma_f32_16x16x32_bf16 v[88:91], a[164:167], a[108:111], 0
v_cvt_pk_bf16_f32 v250, v252, v253
v_cvt_pk_bf16_f32 v251, v254, v255
v_mfma_f32_16x16x32_bf16 v[88:91], a[160:163], a[104:107], v[88:91]
s_waitcnt lgkmcnt(0)
v_accvgpr_read_b32 v16, a0
v_accvgpr_read_b32 v17, a1
v_mfma_f32_16x16x32_bf16 v[36:39], a[128:131], a[80:83], v[36:39]
s_waitcnt vmcnt(24)
v_accvgpr_read_b32 v18, a2
v_accvgpr_read_b32 v19, a3
v_mfma_f32_16x16x32_bf16 v[36:39], a[132:135], a[84:87], v[36:39]
s_barrier
v_mfma_f32_16x16x32_bf16 v[44:47], a[140:143], a[84:87], v[44:47]
ds_read_b128 a[96:99], v9 offset:4096
v_accvgpr_read_b32 v20, a4
v_mfma_f32_16x16x32_bf16 v[44:47], a[136:139], a[80:83], v[44:47]
s_xor_b32 s75, s93, 2
s_lshl_b32 s76, s75, 19
s_add_u32 s76, s76, s74
v_mfma_f32_16x16x32_bf16 v[32:35], a[144:147], a[80:83], v[32:35]
s_lshl_b32 s79, s75, 13
s_add_u32 s79, s79, s78
ds_read_b128 a[100:103], v10 offset:4096
v_mfma_f32_16x16x32_bf16 v[32:35], a[148:151], a[84:87], v[32:35]
s_add_u32 m0, s77, 32768
s_add_u32 s64, s76, 0
ds_read_b128 a[104:107], v9 offset:6144
v_mfma_f32_16x16x32_bf16 v[52:55], a[156:159], a[84:87], v[52:55]
buffer_load_dwordx4 v7, s[20:23], s64 offen lds
v_mfma_f32_16x16x32_bf16 v[52:55], a[152:155], a[80:83], v[52:55]
ds_read_b64_tr_b16 a[160:161], v11 offset:49152
ds_read_b64_tr_b16 a[162:163], v11 offset:49664
v_mfma_f32_16x16x32_bf16 v[60:63], a[64:67], a[80:83], v[60:63]
v_accvgpr_read_b32 v21, a5
v_accvgpr_read_b32 v22, a6
v_mfma_f32_16x16x32_bf16 v[60:63], a[68:71], a[84:87], v[60:63]
ds_read_b128 a[108:111], v10 offset:6144
v_accvgpr_read_b32 v23, a7
v_mfma_f32_16x16x32_bf16 v[68:71], a[76:79], a[84:87], v[68:71]
buffer_load_dwordx4 v8, s[20:23], s64 offen offset:1024 lds
v_mfma_f32_16x16x32_bf16 v[68:71], a[72:75], a[80:83], v[68:71]
ds_read_b64_tr_b16 a[164:165], v11 offset:53248
ds_read_b64_tr_b16 a[166:167], v11 offset:53760
v_mfma_f32_16x16x32_bf16 v[76:79], a[72:75], a[88:91], v[76:79]
v_add_u32 v9, 32768, v9
v_add_u32 v10, 32768, v10
v_mfma_f32_16x16x32_bf16 v[76:79], a[76:79], a[92:95], v[76:79]
ds_read_b64_tr_b16 a[168:169], v12 offset:49152
ds_read_b64_tr_b16 a[170:171], v12 offset:49664
v_mfma_f32_16x16x32_bf16 v[84:87], a[68:71], a[92:95], v[84:87]
s_add_u32 m0, s80, 32768
s_add_u32 s64, s79, 0
v_mul_f32 v16, s91, v16
v_mfma_f32_16x16x32_bf16 v[84:87], a[64:67], a[88:91], v[84:87]
ds_read_b64_tr_b16 a[172:173], v12 offset:53248
ds_read_b64_tr_b16 a[174:175], v12 offset:53760
v_mfma_f32_16x16x32_bf16 v[92:95], a[152:155], a[88:91], v[92:95]
buffer_load_dwordx4 v15, s[24:27], s64 offen sc1 lds
v_mfma_f32_16x16x32_bf16 v[92:95], a[156:159], a[92:95], v[92:95]
v_mul_f32 v17, s91, v17
v_mul_f32 v18, s91, v18
v_mfma_f32_16x16x32_bf16 v[40:43], a[148:151], a[92:95], v[40:43]
ds_read_b64_tr_b16 a[176:177], v13 offset:49152
ds_read_b64_tr_b16 a[178:179], v13 offset:49664
v_mfma_f32_16x16x32_bf16 v[40:43], a[144:147], a[88:91], v[40:43]
v_mul_f32 v19, s91, v19
v_mul_f32 v20, s91, v20
v_mfma_f32_16x16x32_bf16 v[100:103], a[136:139], a[88:91], v[100:103]
s_add_u32 m0, s73, 69632
s_add_u32 s64, s72, 0
v_mul_f32 v21, s91, v21
v_mfma_f32_16x16x32_bf16 v[100:103], a[140:143], a[92:95], v[100:103]
ds_read_b64_tr_b16 a[180:181], v13 offset:53248
ds_read_b64_tr_b16 a[182:183], v13 offset:53760
v_mfma_f32_16x16x32_bf16 v[108:111], a[132:135], a[92:95], v[108:111]
buffer_load_dwordx4 v5, s[12:15], s64 offen lds
v_mfma_f32_16x16x32_bf16 v[108:111], a[128:131], a[88:91], v[108:111]
s_waitcnt lgkmcnt(14)
ds_read_b64_tr_b16 a[184:185], v14 offset:49152
ds_read_b64_tr_b16 a[186:187], v14 offset:49664
v_mfma_f32_16x16x32_bf16 v[116:119], a[128:131], a[96:99], v[116:119]
s_add_u32 s53, s87, 0
ds_read_b64_tr_b16 a[188:189], v14 offset:53248
ds_read_b64_tr_b16 a[190:191], v14 offset:53760
v_mfma_f32_16x16x32_bf16 v[116:119], a[132:135], a[100:103], v[116:119]
buffer_store_dwordx4 v[160:163], v15, s[24:27], s53 offen offset:0 sc1
v_mfma_f32_16x16x32_bf16 v[124:127], a[140:143], a[100:103], v[124:127]
v_mul_f32 v22, s91, v22
v_mul_f32 v23, s91, v23
v_mfma_f32_16x16x32_bf16 v[124:127], a[136:139], a[96:99], v[124:127]
ds_read_b128 a[112:115], v4 offset:57344
v_cvt_pk_bf16_f32 v16, v16, v17
v_mfma_f32_16x16x32_bf16 v[132:135], a[144:147], a[96:99], v[132:135]
buffer_load_dwordx4 v6, s[12:15], s64 offen offset:1024 lds
v_mfma_f32_16x16x32_bf16 v[132:135], a[148:151], a[100:103], v[132:135]
ds_read_b128 a[116:119], v4 offset:59392
v_cvt_pk_bf16_f32 v17, v18, v19
v_mfma_f32_16x16x32_bf16 v[140:143], a[156:159], a[100:103], v[140:143]
v_cvt_pk_bf16_f32 v18, v20, v21
v_cvt_pk_bf16_f32 v19, v22, v23
v_mfma_f32_16x16x32_bf16 v[140:143], a[152:155], a[96:99], v[140:143]
ds_read_b128 a[120:123], v4 offset:58368
v_accvgpr_write_b32 a0, v16
v_mfma_f32_16x16x32_bf16 v[148:151], a[64:67], a[96:99], v[148:151]
s_add_u32 m0, s73, 71680
s_add_u32 s64, s72, 18432
v_accvgpr_write_b32 a1, v17
v_mfma_f32_16x16x32_bf16 v[148:151], a[68:71], a[100:103], v[148:151]
ds_read_b128 a[124:127], v4 offset:60416
v_accvgpr_write_b32 a2, v18
v_mfma_f32_16x16x32_bf16 v[48:51], a[76:79], a[100:103], v[48:51]
buffer_load_dwordx4 v5, s[12:15], s64 offen lds
v_mfma_f32_16x16x32_bf16 v[48:51], a[72:75], a[96:99], v[48:51]
s_waitcnt lgkmcnt(15)
v_accvgpr_write_b32 a3, v19
v_accvgpr_read_b32 v16, a8
v_mfma_f32_16x16x32_bf16 v[156:159], a[72:75], a[104:107], v[156:159]
v_accvgpr_read_b32 v17, a9
v_accvgpr_read_b32 v18, a10
v_mfma_f32_16x16x32_bf16 v[156:159], a[76:79], a[108:111], v[156:159]
v_accvgpr_read_b32 v19, a11
v_accvgpr_read_b32 v20, a12
v_mfma_f32_16x16x32_bf16 v[164:167], a[68:71], a[108:111], v[164:167]
v_accvgpr_read_b32 v21, a13
v_accvgpr_read_b32 v22, a14
v_mfma_f32_16x16x32_bf16 v[164:167], a[64:67], a[104:107], v[164:167]
v_accvgpr_read_b32 v23, a15
v_mul_f32 v16, s91, v16
v_mfma_f32_16x16x32_bf16 v[172:175], a[152:155], a[104:107], v[172:175]
buffer_load_dwordx4 v6, s[12:15], s64 offen offset:1024 lds
v_mfma_f32_16x16x32_bf16 v[172:175], a[156:159], a[108:111], v[172:175]
v_mul_f32 v17, s91, v17
v_mul_f32 v18, s91, v18
v_mfma_f32_16x16x32_bf16 v[56:59], a[148:151], a[108:111], v[56:59]
v_mul_f32 v19, s91, v19
v_mul_f32 v20, s91, v20
v_mfma_f32_16x16x32_bf16 v[56:59], a[144:147], a[104:107], v[56:59]
v_mul_f32 v21, s91, v21
v_mul_f32 v22, s91, v22
v_mfma_f32_16x16x32_bf16 v[180:183], a[136:139], a[104:107], v[180:183]
v_mul_f32 v23, s91, v23
v_cvt_pk_bf16_f32 v16, v16, v17
v_mfma_f32_16x16x32_bf16 v[180:183], a[140:143], a[108:111], v[180:183]
v_cvt_pk_bf16_f32 v17, v18, v19
v_cvt_pk_bf16_f32 v18, v20, v21
v_mfma_f32_16x16x32_bf16 v[188:191], a[132:135], a[108:111], v[188:191]
v_cvt_pk_bf16_f32 v19, v22, v23
v_accvgpr_write_b32 a8, v16
v_mfma_f32_16x16x32_bf16 v[188:191], a[128:131], a[104:107], v[188:191]
s_waitcnt lgkmcnt(0)
v_accvgpr_write_b32 a9, v17
v_accvgpr_write_b32 a10, v18
v_mfma_f32_16x16x32_bf16 v[196:199], a[160:163], a[80:83], v[196:199]
s_waitcnt vmcnt(17)
v_accvgpr_write_b32 a11, v19
v_accvgpr_read_b32 v16, a16
v_mfma_f32_16x16x32_bf16 v[196:199], a[164:167], a[84:87], v[196:199]
s_barrier
v_mfma_f32_16x16x32_bf16 v[64:67], a[172:175], a[84:87], v[64:67]
s_add_u32 s53, s87, 0
ds_read_b64_tr_b16 a[128:129], v11 offset:0
ds_read_b64_tr_b16 a[130:131], v11 offset:512
v_mfma_f32_16x16x32_bf16 v[64:67], a[168:171], a[80:83], v[64:67]
s_add_u32 m0, s77, 49152
s_add_u32 s64, s76, 128
v_accvgpr_read_b32 v17, a17
v_mfma_f32_16x16x32_bf16 v[204:207], a[176:179], a[80:83], v[204:207]
buffer_load_dwordx4 v7, s[20:23], s64 offen lds
v_mfma_f32_16x16x32_bf16 v[204:207], a[180:183], a[84:87], v[204:207]
ds_read_b64_tr_b16 a[132:133], v11 offset:4096
ds_read_b64_tr_b16 a[134:135], v11 offset:4608
v_mfma_f32_16x16x32_bf16 v[212:215], a[188:191], a[84:87], v[212:215]
ds_read_b64_tr_b16 a[136:137], v12 offset:0
ds_read_b64_tr_b16 a[138:139], v12 offset:512
v_mfma_f32_16x16x32_bf16 v[212:215], a[184:187], a[80:83], v[212:215]
ds_read_b64_tr_b16 a[140:141], v12 offset:4096
ds_read_b64_tr_b16 a[142:143], v12 offset:4608
v_mfma_f32_16x16x32_bf16 v[72:75], a[112:115], a[80:83], v[72:75]
buffer_store_dwordx4 v[168:171], v15, s[24:27], s53 offen offset:1024 sc1
v_mfma_f32_16x16x32_bf16 v[72:75], a[116:119], a[84:87], v[72:75]
ds_read_b64_tr_b16 a[144:145], v13 offset:0
ds_read_b64_tr_b16 a[146:147], v13 offset:512
v_mfma_f32_16x16x32_bf16 v[220:223], a[124:127], a[84:87], v[220:223]
buffer_load_dwordx4 v8, s[20:23], s64 offen offset:1024 lds
v_mfma_f32_16x16x32_bf16 v[220:223], a[120:123], a[80:83], v[220:223]
ds_read_b64_tr_b16 a[148:149], v13 offset:4096
ds_read_b64_tr_b16 a[150:151], v13 offset:4608
v_mfma_f32_16x16x32_bf16 a[32:35], a[120:123], a[88:91], a[32:35]
v_accvgpr_read_b32 v18, a18
v_accvgpr_read_b32 v19, a19
v_mfma_f32_16x16x32_bf16 a[32:35], a[124:127], a[92:95], a[32:35]
ds_read_b64_tr_b16 a[152:153], v14 offset:0
ds_read_b64_tr_b16 a[154:155], v14 offset:512
v_mfma_f32_16x16x32_bf16 a[36:39], a[116:119], a[92:95], a[36:39]
s_add_u32 m0, s80, 49152
s_add_u32 s64, s79, 2048
v_accvgpr_read_b32 v20, a20
v_mfma_f32_16x16x32_bf16 a[36:39], a[112:115], a[88:91], a[36:39]
ds_read_b64_tr_b16 a[156:157], v14 offset:4096
ds_read_b64_tr_b16 a[158:159], v14 offset:4608
v_mfma_f32_16x16x32_bf16 v[228:231], a[184:187], a[88:91], v[228:231]
buffer_load_dwordx4 v15, s[24:27], s64 offen sc1 lds
v_mfma_f32_16x16x32_bf16 v[228:231], a[188:191], a[92:95], v[228:231]
s_xor_b32 s65, s70, 384
s_add_u32 s71, s68, s65
s_add_u32 s72, s69, s65
v_mfma_f32_16x16x32_bf16 a[40:43], a[180:183], a[92:95], a[40:43]
ds_read_b128 a[64:67], v4 offset:8192
v_accvgpr_read_b32 v21, a21
v_mfma_f32_16x16x32_bf16 a[40:43], a[176:179], a[88:91], a[40:43]
v_accvgpr_read_b32 v22, a22
v_accvgpr_read_b32 v23, a23
v_mfma_f32_16x16x32_bf16 a[44:47], a[168:171], a[88:91], a[44:47]
s_add_u32 m0, s73, 0
s_add_u32 s64, s71, 0
ds_read_b128 a[80:83], v9 offset:0
v_mfma_f32_16x16x32_bf16 a[44:47], a[172:175], a[92:95], a[44:47]
v_mul_f32 v16, s91, v16
v_mul_f32 v17, s91, v17
v_mfma_f32_16x16x32_bf16 v[80:83], a[164:167], a[92:95], v[80:83]
buffer_load_dwordx4 v5, s[12:15], s64 offen lds
v_mfma_f32_16x16x32_bf16 v[80:83], a[160:163], a[88:91], v[80:83]
ds_read_b128 a[68:71], v4 offset:10240
v_mul_f32 v18, s91, v18
v_mfma_f32_16x16x32_bf16 a[48:51], a[160:163], a[96:99], a[48:51]
ds_read_b128 a[84:87], v10 offset:0
v_mul_f32 v19, s91, v19
v_mfma_f32_16x16x32_bf16 a[48:51], a[164:167], a[100:103], a[48:51]
v_mul_f32 v20, s91, v20
v_mul_f32 v21, s91, v21
v_mfma_f32_16x16x32_bf16 a[52:55], a[172:175], a[100:103], a[52:55]
v_mul_f32 v22, s91, v22
v_mul_f32 v23, s91, v23
v_mfma_f32_16x16x32_bf16 a[52:55], a[168:171], a[96:99], a[52:55]
ds_read_b128 a[72:75], v4 offset:9216
v_cvt_pk_bf16_f32 v16, v16, v17
v_mfma_f32_16x16x32_bf16 a[56:59], a[176:179], a[96:99], a[56:59]
buffer_load_dwordx4 v6, s[12:15], s64 offen offset:1024 lds
v_mfma_f32_16x16x32_bf16 a[56:59], a[180:183], a[100:103], a[56:59]
s_add_u32 s53, s87, 4096
ds_read_b128 a[88:91], v9 offset:2048
v_cvt_pk_bf16_f32 v17, v18, v19
v_mfma_f32_16x16x32_bf16 a[60:63], a[188:191], a[100:103], a[60:63]
buffer_store_dwordx4 v[176:179], v15, s[24:27], s53 offen offset:0 sc1
v_mfma_f32_16x16x32_bf16 a[60:63], a[184:187], a[96:99], a[60:63]
ds_read_b128 a[76:79], v4 offset:11264
v_cvt_pk_bf16_f32 v18, v20, v21
v_mfma_f32_16x16x32_bf16 v[236:239], a[112:115], a[96:99], v[236:239]
s_add_u32 m0, s73, 2048
s_add_u32 s64, s71, 18432
v_cvt_pk_bf16_f32 v19, v22, v23
v_mfma_f32_16x16x32_bf16 v[236:239], a[116:119], a[100:103], v[236:239]
ds_read_b128 a[92:95], v10 offset:2048
v_accvgpr_write_b32 a16, v16
v_mfma_f32_16x16x32_bf16 a[192:195], a[124:127], a[100:103], a[192:195]
buffer_load_dwordx4 v5, s[12:15], s64 offen lds
v_mfma_f32_16x16x32_bf16 a[192:195], a[120:123], a[96:99], a[192:195]
v_accvgpr_write_b32 a17, v17
v_accvgpr_write_b32 a18, v18
v_mfma_f32_16x16x32_bf16 a[196:199], a[120:123], a[104:107], a[196:199]
v_accvgpr_write_b32 a19, v19
v_accvgpr_read_b32 v16, a24
v_mfma_f32_16x16x32_bf16 a[196:199], a[124:127], a[108:111], a[196:199]
v_accvgpr_read_b32 v17, a25
v_accvgpr_read_b32 v18, a26
v_mfma_f32_16x16x32_bf16 a[200:203], a[116:119], a[108:111], a[200:203]
v_accvgpr_read_b32 v19, a27
v_accvgpr_read_b32 v20, a28
v_mfma_f32_16x16x32_bf16 a[200:203], a[112:115], a[104:107], a[200:203]
v_accvgpr_read_b32 v21, a29
v_accvgpr_read_b32 v22, a30
v_mfma_f32_16x16x32_bf16 v[244:247], a[184:187], a[104:107], v[244:247]
buffer_load_dwordx4 v6, s[12:15], s64 offen offset:1024 lds
v_mfma_f32_16x16x32_bf16 v[244:247], a[188:191], a[108:111], v[244:247]
v_accvgpr_read_b32 v23, a31
v_mul_f32 v16, s91, v16
v_mfma_f32_16x16x32_bf16 a[204:207], a[180:183], a[108:111], a[204:207]
v_mul_f32 v17, s91, v17
v_mul_f32 v18, s91, v18
v_mfma_f32_16x16x32_bf16 a[204:207], a[176:179], a[104:107], a[204:207]
v_mul_f32 v19, s91, v19
v_mul_f32 v20, s91, v20
v_mfma_f32_16x16x32_bf16 a[208:211], a[168:171], a[104:107], a[208:211]
v_mul_f32 v21, s91, v21
v_mul_f32 v22, s91, v22
v_mfma_f32_16x16x32_bf16 a[208:211], a[172:175], a[108:111], a[208:211]
v_mul_f32 v23, s91, v23
v_cvt_pk_bf16_f32 v16, v16, v17
v_mfma_f32_16x16x32_bf16 v[88:91], a[164:167], a[108:111], v[88:91]
v_cvt_pk_bf16_f32 v17, v18, v19
v_cvt_pk_bf16_f32 v18, v20, v21
v_mfma_f32_16x16x32_bf16 v[88:91], a[160:163], a[104:107], v[88:91]
s_waitcnt lgkmcnt(0)
v_cvt_pk_bf16_f32 v19, v22, v23
v_accvgpr_write_b32 a24, v16
v_mfma_f32_16x16x32_bf16 v[36:39], a[128:131], a[80:83], v[36:39]
s_waitcnt vmcnt(23)
v_accvgpr_write_b32 a25, v17
v_accvgpr_write_b32 a26, v18
v_mfma_f32_16x16x32_bf16 v[36:39], a[132:135], a[84:87], v[36:39]
s_barrier
v_mfma_f32_16x16x32_bf16 v[44:47], a[140:143], a[84:87], v[44:47]
ds_read_b128 a[96:99], v9 offset:4096
v_accvgpr_write_b32 a27, v19
v_mfma_f32_16x16x32_bf16 v[44:47], a[136:139], a[80:83], v[44:47]
s_xor_b32 s75, s93, 3
s_lshl_b32 s76, s75, 19
s_add_u32 s76, s76, s74
v_mfma_f32_16x16x32_bf16 v[32:35], a[144:147], a[80:83], v[32:35]
s_lshl_b32 s79, s75, 13
s_add_u32 s79, s79, s78
ds_read_b128 a[100:103], v10 offset:4096
v_mfma_f32_16x16x32_bf16 v[32:35], a[148:151], a[84:87], v[32:35]
s_add_u32 m0, s77, 0
s_add_u32 s64, s76, 0
ds_read_b128 a[104:107], v9 offset:6144
v_mfma_f32_16x16x32_bf16 v[52:55], a[156:159], a[84:87], v[52:55]
buffer_load_dwordx4 v7, s[20:23], s64 offen lds
v_mfma_f32_16x16x32_bf16 v[52:55], a[152:155], a[80:83], v[52:55]
s_add_u32 s53, s87, 4096
ds_read_b64_tr_b16 a[160:161], v11 offset:16384
ds_read_b64_tr_b16 a[162:163], v11 offset:16896
v_mfma_f32_16x16x32_bf16 v[60:63], a[64:67], a[80:83], v[60:63]
buffer_store_dwordx4 v[184:187], v15, s[24:27], s53 offen offset:1024 sc1
v_mfma_f32_16x16x32_bf16 v[60:63], a[68:71], a[84:87], v[60:63]
ds_read_b128 a[108:111], v10 offset:6144
v_accvgpr_write_b32 a4, v248
v_mfma_f32_16x16x32_bf16 v[68:71], a[76:79], a[84:87], v[68:71]
buffer_load_dwordx4 v8, s[20:23], s64 offen offset:1024 lds
v_mfma_f32_16x16x32_bf16 v[68:71], a[72:75], a[80:83], v[68:71]
ds_read_b64_tr_b16 a[164:165], v11 offset:20480
ds_read_b64_tr_b16 a[166:167], v11 offset:20992
v_mfma_f32_16x16x32_bf16 v[76:79], a[72:75], a[88:91], v[76:79]
v_add_u32 v9, 32768, v9
v_add_u32 v10, 32768, v10
v_mfma_f32_16x16x32_bf16 v[76:79], a[76:79], a[92:95], v[76:79]
ds_read_b64_tr_b16 a[168:169], v12 offset:16384
ds_read_b64_tr_b16 a[170:171], v12 offset:16896
v_mfma_f32_16x16x32_bf16 v[84:87], a[68:71], a[92:95], v[84:87]
s_add_u32 m0, s80, 0
s_add_u32 s64, s79, 0
v_accvgpr_write_b32 a5, v249
v_mfma_f32_16x16x32_bf16 v[84:87], a[64:67], a[88:91], v[84:87]
ds_read_b64_tr_b16 a[172:173], v12 offset:20480
ds_read_b64_tr_b16 a[174:175], v12 offset:20992
v_mfma_f32_16x16x32_bf16 v[92:95], a[152:155], a[88:91], v[92:95]
buffer_load_dwordx4 v15, s[24:27], s64 offen sc1 lds
v_mfma_f32_16x16x32_bf16 v[92:95], a[156:159], a[92:95], v[92:95]
v_accvgpr_write_b32 a6, v250
v_accvgpr_write_b32 a7, v251
v_mfma_f32_16x16x32_bf16 v[40:43], a[148:151], a[92:95], v[40:43]
ds_read_b64_tr_b16 a[176:177], v13 offset:16384
ds_read_b64_tr_b16 a[178:179], v13 offset:16896
v_mfma_f32_16x16x32_bf16 v[40:43], a[144:147], a[88:91], v[40:43]
v_accvgpr_write_b32 a12, v240
v_accvgpr_write_b32 a13, v241
v_mfma_f32_16x16x32_bf16 v[100:103], a[136:139], a[88:91], v[100:103]
s_add_u32 m0, s73, 4096
s_add_u32 s64, s72, 0
v_accvgpr_write_b32 a14, v242
v_mfma_f32_16x16x32_bf16 v[100:103], a[140:143], a[92:95], v[100:103]
ds_read_b64_tr_b16 a[180:181], v13 offset:20480
ds_read_b64_tr_b16 a[182:183], v13 offset:20992
v_mfma_f32_16x16x32_bf16 v[108:111], a[132:135], a[92:95], v[108:111]
buffer_load_dwordx4 v5, s[12:15], s64 offen lds
v_mfma_f32_16x16x32_bf16 v[108:111], a[128:131], a[88:91], v[108:111]
s_waitcnt lgkmcnt(14)
ds_read_b64_tr_b16 a[184:185], v14 offset:16384
ds_read_b64_tr_b16 a[186:187], v14 offset:16896
v_mfma_f32_16x16x32_bf16 v[116:119], a[128:131], a[96:99], v[116:119]
ds_read_b64_tr_b16 a[188:189], v14 offset:20480
ds_read_b64_tr_b16 a[190:191], v14 offset:20992
v_mfma_f32_16x16x32_bf16 v[116:119], a[132:135], a[100:103], v[116:119]
v_accvgpr_write_b32 a15, v243
v_accvgpr_write_b32 a20, v232
v_mfma_f32_16x16x32_bf16 v[124:127], a[140:143], a[100:103], v[124:127]
v_accvgpr_write_b32 a21, v233
v_accvgpr_write_b32 a22, v234
v_mfma_f32_16x16x32_bf16 v[124:127], a[136:139], a[96:99], v[124:127]
ds_read_b128 a[112:115], v4 offset:24576
v_accvgpr_write_b32 a23, v235
v_mfma_f32_16x16x32_bf16 v[132:135], a[144:147], a[96:99], v[132:135]
buffer_load_dwordx4 v6, s[12:15], s64 offen offset:1024 lds
v_mfma_f32_16x16x32_bf16 v[132:135], a[148:151], a[100:103], v[132:135]
ds_read_b128 a[116:119], v4 offset:26624
v_accvgpr_write_b32 a28, v224
v_mfma_f32_16x16x32_bf16 v[140:143], a[156:159], a[100:103], v[140:143]
v_accvgpr_write_b32 a29, v225
v_accvgpr_write_b32 a30, v226
v_mfma_f32_16x16x32_bf16 v[140:143], a[152:155], a[96:99], v[140:143]
ds_read_b128 a[120:123], v4 offset:25600
v_accvgpr_write_b32 a31, v227
v_mfma_f32_16x16x32_bf16 v[148:151], a[64:67], a[96:99], v[148:151]
s_add_u32 m0, s73, 6144
s_add_u32 s64, s72, 18432
v_accvgpr_read_b32 v252, a32
v_mfma_f32_16x16x32_bf16 v[148:151], a[68:71], a[100:103], v[148:151]
ds_read_b128 a[124:127], v4 offset:27648
v_accvgpr_read_b32 v253, a33
v_mfma_f32_16x16x32_bf16 v[48:51], a[76:79], a[100:103], v[48:51]
buffer_load_dwordx4 v5, s[12:15], s64 offen lds
v_mfma_f32_16x16x32_bf16 v[48:51], a[72:75], a[96:99], v[48:51]
s_waitcnt lgkmcnt(15)
s_add_u32 s53, s87, 262144
v_accvgpr_read_b32 v254, a34
v_mfma_f32_16x16x32_bf16 v[156:159], a[72:75], a[104:107], v[156:159]
buffer_store_dwordx4 v[192:195], v15, s[24:27], s53 offen offset:0 sc1
v_mfma_f32_16x16x32_bf16 v[156:159], a[76:79], a[108:111], v[156:159]
v_accvgpr_read_b32 v255, a35
v_accvgpr_read_b32 v160, a36
v_mfma_f32_16x16x32_bf16 v[164:167], a[68:71], a[108:111], v[164:167]
v_accvgpr_read_b32 v161, a37
v_accvgpr_read_b32 v162, a38
v_mfma_f32_16x16x32_bf16 v[164:167], a[64:67], a[104:107], v[164:167]
v_accvgpr_read_b32 v163, a39
v_accvgpr_read_b32 v168, a40
v_mfma_f32_16x16x32_bf16 v[172:175], a[152:155], a[104:107], v[172:175]
buffer_load_dwordx4 v6, s[12:15], s64 offen offset:1024 lds
v_mfma_f32_16x16x32_bf16 v[172:175], a[156:159], a[108:111], v[172:175]
v_accvgpr_read_b32 v169, a41
v_accvgpr_read_b32 v170, a42
v_mfma_f32_16x16x32_bf16 v[56:59], a[148:151], a[108:111], v[56:59]
v_accvgpr_read_b32 v171, a43
v_accvgpr_read_b32 v176, a44
v_mfma_f32_16x16x32_bf16 v[56:59], a[144:147], a[104:107], v[56:59]
v_accvgpr_read_b32 v177, a45
v_accvgpr_read_b32 v178, a46
v_mfma_f32_16x16x32_bf16 v[180:183], a[136:139], a[104:107], v[180:183]
v_accvgpr_read_b32 v179, a47
v_accvgpr_read_b32 v184, a48
v_mfma_f32_16x16x32_bf16 v[180:183], a[140:143], a[108:111], v[180:183]
v_accvgpr_read_b32 v185, a49
v_accvgpr_read_b32 v186, a50
v_mfma_f32_16x16x32_bf16 v[188:191], a[132:135], a[108:111], v[188:191]
v_accvgpr_read_b32 v187, a51
v_accvgpr_read_b32 v248, a52
v_mfma_f32_16x16x32_bf16 v[188:191], a[128:131], a[104:107], v[188:191]
s_waitcnt lgkmcnt(0)
v_accvgpr_read_b32 v249, a53
v_accvgpr_read_b32 v250, a54
v_mfma_f32_16x16x32_bf16 v[196:199], a[160:163], a[80:83], v[196:199]
s_waitcnt vmcnt(18)
v_accvgpr_read_b32 v251, a55
v_accvgpr_read_b32 v240, a56
v_mfma_f32_16x16x32_bf16 v[196:199], a[164:167], a[84:87], v[196:199]
s_barrier
v_mfma_f32_16x16x32_bf16 v[64:67], a[172:175], a[84:87], v[64:67]
ds_read_b64_tr_b16 a[128:129], v11 offset:32768
ds_read_b64_tr_b16 a[130:131], v11 offset:33280
v_mfma_f32_16x16x32_bf16 v[64:67], a[168:171], a[80:83], v[64:67]
s_add_u32 m0, s77, 16384
s_add_u32 s64, s76, 128
v_accvgpr_read_b32 v241, a57
v_mfma_f32_16x16x32_bf16 v[204:207], a[176:179], a[80:83], v[204:207]
buffer_load_dwordx4 v7, s[20:23], s64 offen lds
v_mfma_f32_16x16x32_bf16 v[204:207], a[180:183], a[84:87], v[204:207]
ds_read_b64_tr_b16 a[132:133], v11 offset:36864
ds_read_b64_tr_b16 a[134:135], v11 offset:37376
v_mfma_f32_16x16x32_bf16 v[212:215], a[188:191], a[84:87], v[212:215]
ds_read_b64_tr_b16 a[136:137], v12 offset:32768
ds_read_b64_tr_b16 a[138:139], v12 offset:33280
v_mfma_f32_16x16x32_bf16 v[212:215], a[184:187], a[80:83], v[212:215]
ds_read_b64_tr_b16 a[140:141], v12 offset:36864
ds_read_b64_tr_b16 a[142:143], v12 offset:37376
v_mfma_f32_16x16x32_bf16 v[72:75], a[112:115], a[80:83], v[72:75]
v_accvgpr_read_b32 v242, a58
v_accvgpr_read_b32 v243, a59
v_mfma_f32_16x16x32_bf16 v[72:75], a[116:119], a[84:87], v[72:75]
ds_read_b64_tr_b16 a[144:145], v13 offset:32768
ds_read_b64_tr_b16 a[146:147], v13 offset:33280
v_mfma_f32_16x16x32_bf16 v[220:223], a[124:127], a[84:87], v[220:223]
buffer_load_dwordx4 v8, s[20:23], s64 offen offset:1024 lds
v_mfma_f32_16x16x32_bf16 v[220:223], a[120:123], a[80:83], v[220:223]
ds_read_b64_tr_b16 a[148:149], v13 offset:36864
ds_read_b64_tr_b16 a[150:151], v13 offset:37376
v_mfma_f32_16x16x32_bf16 v[252:255], a[120:123], a[88:91], v[252:255]
v_accvgpr_read_b32 v232, a60
v_accvgpr_read_b32 v233, a61
v_mfma_f32_16x16x32_bf16 v[252:255], a[124:127], a[92:95], v[252:255]
s_add_u32 s53, s87, 262144
ds_read_b64_tr_b16 a[152:153], v14 offset:32768
ds_read_b64_tr_b16 a[154:155], v14 offset:33280
v_mfma_f32_16x16x32_bf16 v[160:163], a[116:119], a[92:95], v[160:163]
s_add_u32 m0, s80, 16384
s_add_u32 s64, s79, 2048
v_accvgpr_read_b32 v234, a62
v_mfma_f32_16x16x32_bf16 v[160:163], a[112:115], a[88:91], v[160:163]
L_PAD5:
s_cbranch_execz L_PAD9
ds_read_b64_tr_b16 a[156:157], v14 offset:36864
ds_read_b64_tr_b16 a[158:159], v14 offset:37376
v_mfma_f32_16x16x32_bf16 v[228:231], a[184:187], a[88:91], v[228:231]
buffer_load_dwordx4 v15, s[24:27], s64 offen sc1 lds
v_mfma_f32_16x16x32_bf16 v[228:231], a[188:191], a[92:95], v[228:231]
s_xor_b32 s65, s70, 512
s_add_u32 s71, s68, s65
s_add_u32 s72, s69, s65
v_mfma_f32_16x16x32_bf16 v[168:171], a[180:183], a[92:95], v[168:171]
ds_read_b128 a[64:67], v4 offset:40960
v_accvgpr_read_b32 v235, a63
v_mfma_f32_16x16x32_bf16 v[168:171], a[176:179], a[88:91], v[168:171]
buffer_store_dwordx4 v[200:203], v15, s[24:27], s53 offen offset:1024 sc1
v_mfma_f32_16x16x32_bf16 v[176:179], a[168:171], a[88:91], v[176:179]
s_add_u32 m0, s73, 32768
s_add_u32 s64, s71, 0
ds_read_b128 a[80:83], v9 offset:0
v_mfma_f32_16x16x32_bf16 v[176:179], a[172:175], a[92:95], v[176:179]
v_accvgpr_read_b32 v224, a192
v_accvgpr_read_b32 v225, a193
v_mfma_f32_16x16x32_bf16 v[80:83], a[164:167], a[92:95], v[80:83]
buffer_load_dwordx4 v5, s[12:15], s64 offen lds
v_mfma_f32_16x16x32_bf16 v[80:83], a[160:163], a[88:91], v[80:83]
ds_read_b128 a[68:71], v4 offset:43008
v_accvgpr_read_b32 v226, a194
v_mfma_f32_16x16x32_bf16 v[184:187], a[160:163], a[96:99], v[184:187]
ds_read_b128 a[84:87], v10 offset:0
v_accvgpr_read_b32 v227, a195
v_mfma_f32_16x16x32_bf16 v[184:187], a[164:167], a[100:103], v[184:187]
v_accvgpr_read_b32 v192, a204
v_accvgpr_read_b32 v193, a205
v_mfma_f32_16x16x32_bf16 v[248:251], a[172:175], a[100:103], v[248:251]
v_accvgpr_read_b32 v194, a206
v_accvgpr_read_b32 v195, a207
v_mfma_f32_16x16x32_bf16 v[248:251], a[168:171], a[96:99], v[248:251]
ds_read_b128 a[72:75], v4 offset:41984
v_accvgpr_read_b32 v200, a208
v_mfma_f32_16x16x32_bf16 v[240:243], a[176:179], a[96:99], v[240:243]
buffer_load_dwordx4 v6, s[12:15], s64 offen offset:1024 lds
v_mfma_f32_16x16x32_bf16 v[240:243], a[180:183], a[100:103], v[240:243]
ds_read_b128 a[88:91], v9 offset:2048
v_accvgpr_read_b32 v201, a209
v_mfma_f32_16x16x32_bf16 v[232:235], a[188:191], a[100:103], v[232:235]
v_accvgpr_read_b32 v202, a210
v_accvgpr_read_b32 v203, a211
v_mfma_f32_16x16x32_bf16 v[232:235], a[184:187], a[96:99], v[232:235]
ds_read_b128 a[76:79], v4 offset:44032
v_and_b32 v28, 31, v1
v_mfma_f32_16x16x32_bf16 v[236:239], a[112:115], a[96:99], v[236:239]
s_add_u32 m0, s73, 34816
s_add_u32 s64, s71, 18432
v_lshlrev_b32 v28, 2, v28
v_mfma_f32_16x16x32_bf16 v[236:239], a[116:119], a[100:103], v[236:239]
ds_read_b128 a[92:95], v10 offset:2048
v_mfma_f32_16x16x32_bf16 v[224:227], a[124:127], a[100:103], v[224:227]
buffer_load_dwordx4 v5, s[12:15], s64 offen lds
v_mfma_f32_16x16x32_bf16 v[224:227], a[120:123], a[96:99], v[224:227]
buffer_load_dword v30, v28, s[40:43], 0 offen sc1
v_mfma_f32_16x16x32_bf16 a[196:199], a[120:123], a[104:107], a[196:199]
v_mfma_f32_16x16x32_bf16 a[196:199], a[124:127], a[108:111], a[196:199]
v_mfma_f32_16x16x32_bf16 a[200:203], a[116:119], a[108:111], a[200:203]
v_mfma_f32_16x16x32_bf16 a[200:203], a[112:115], a[104:107], a[200:203]
v_mfma_f32_16x16x32_bf16 v[244:247], a[184:187], a[104:107], v[244:247]
buffer_load_dwordx4 v6, s[12:15], s64 offen offset:1024 lds
v_mfma_f32_16x16x32_bf16 v[244:247], a[188:191], a[108:111], v[244:247]
s_add_u32 s53, s87, 266240
v_mfma_f32_16x16x32_bf16 v[192:195], a[180:183], a[108:111], v[192:195]
buffer_store_dwordx4 v[208:211], v15, s[24:27], s53 offen offset:0 sc1
v_mfma_f32_16x16x32_bf16 v[192:195], a[176:179], a[104:107], v[192:195]
v_mfma_f32_16x16x32_bf16 v[200:203], a[168:171], a[104:107], v[200:203]
v_mfma_f32_16x16x32_bf16 v[200:203], a[172:175], a[108:111], v[200:203]
v_accvgpr_read_b32 v208, a196
v_accvgpr_read_b32 v209, a197
v_mfma_f32_16x16x32_bf16 v[88:91], a[164:167], a[108:111], v[88:91]
v_accvgpr_read_b32 v210, a198
v_accvgpr_read_b32 v211, a199
v_mfma_f32_16x16x32_bf16 v[88:91], a[160:163], a[104:107], v[88:91]
s_waitcnt lgkmcnt(0)
v_mfma_f32_16x16x32_bf16 v[36:39], a[128:131], a[80:83], v[36:39]
s_waitcnt vmcnt(24)
v_mfma_f32_16x16x32_bf16 v[36:39], a[132:135], a[84:87], v[36:39]
s_barrier
v_mfma_f32_16x16x32_bf16 v[44:47], a[140:143], a[84:87], v[44:47]
ds_read_b128 a[96:99], v9 offset:4096
v_mfma_f32_16x16x32_bf16 v[44:47], a[136:139], a[80:83], v[44:47]
s_xor_b32 s75, s93, 4
s_lshl_b32 s76, s75, 19
s_add_u32 s76, s76, s74
v_mfma_f32_16x16x32_bf16 v[32:35], a[144:147], a[80:83], v[32:35]
s_lshl_b32 s79, s75, 13
s_add_u32 s79, s79, s78
ds_read_b128 a[100:103], v10 offset:4096
v_mfma_f32_16x16x32_bf16 v[32:35], a[148:151], a[84:87], v[32:35]
s_add_u32 m0, s77, 32768
s_add_u32 s64, s76, 0
ds_read_b128 a[104:107], v9 offset:6144
v_mfma_f32_16x16x32_bf16 v[52:55], a[156:159], a[84:87], v[52:55]
buffer_load_dwordx4 v7, s[20:23], s64 offen lds
v_mfma_f32_16x16x32_bf16 v[52:55], a[152:155], a[80:83], v[52:55]
ds_read_b64_tr_b16 a[160:161], v11 offset:49152
ds_read_b64_tr_b16 a[162:163], v11 offset:49664
v_mfma_f32_16x16x32_bf16 v[60:63], a[64:67], a[80:83], v[60:63]
v_mfma_f32_16x16x32_bf16 v[60:63], a[68:71], a[84:87], v[60:63]
ds_read_b128 a[108:111], v10 offset:6144
v_mfma_f32_16x16x32_bf16 v[68:71], a[76:79], a[84:87], v[68:71]
buffer_load_dwordx4 v8, s[20:23], s64 offen offset:1024 lds
v_mfma_f32_16x16x32_bf16 v[68:71], a[72:75], a[80:83], v[68:71]
ds_read_b64_tr_b16 a[164:165], v11 offset:53248
ds_read_b64_tr_b16 a[166:167], v11 offset:53760
v_mfma_f32_16x16x32_bf16 v[76:79], a[72:75], a[88:91], v[76:79]
v_add_u32 v9, -65536, v9
v_add_u32 v10, -65536, v10
v_mfma_f32_16x16x32_bf16 v[76:79], a[76:79], a[92:95], v[76:79]
ds_read_b64_tr_b16 a[168:169], v12 offset:49152
ds_read_b64_tr_b16 a[170:171], v12 offset:49664
v_mfma_f32_16x16x32_bf16 v[84:87], a[68:71], a[92:95], v[84:87]
s_add_u32 m0, s80, 32768
s_add_u32 s64, s79, 0
v_mfma_f32_16x16x32_bf16 v[84:87], a[64:67], a[88:91], v[84:87]
ds_read_b64_tr_b16 a[172:173], v12 offset:53248
ds_read_b64_tr_b16 a[174:175], v12 offset:53760
v_mfma_f32_16x16x32_bf16 v[92:95], a[152:155], a[88:91], v[92:95]
buffer_load_dwordx4 v15, s[24:27], s64 offen sc1 lds
v_mfma_f32_16x16x32_bf16 v[92:95], a[156:159], a[92:95], v[92:95]
v_mfma_f32_16x16x32_bf16 v[40:43], a[148:151], a[92:95], v[40:43]
ds_read_b64_tr_b16 a[176:177], v13 offset:49152
ds_read_b64_tr_b16 a[178:179], v13 offset:49664
v_mfma_f32_16x16x32_bf16 v[40:43], a[144:147], a[88:91], v[40:43]
s_add_u32 s53, s87, 266240
v_mfma_f32_16x16x32_bf16 v[100:103], a[136:139], a[88:91], v[100:103]
s_add_u32 m0, s73, 36864
s_add_u32 s64, s72, 0
v_mfma_f32_16x16x32_bf16 v[100:103], a[140:143], a[92:95], v[100:103]
ds_read_b64_tr_b16 a[180:181], v13 offset:53248
ds_read_b64_tr_b16 a[182:183], v13 offset:53760
v_mfma_f32_16x16x32_bf16 v[108:111], a[132:135], a[92:95], v[108:111]
buffer_load_dwordx4 v5, s[12:15], s64 offen lds
v_mfma_f32_16x16x32_bf16 v[108:111], a[128:131], a[88:91], v[108:111]
s_waitcnt lgkmcnt(14)
ds_read_b64_tr_b16 a[184:185], v14 offset:49152
ds_read_b64_tr_b16 a[186:187], v14 offset:49664
v_mfma_f32_16x16x32_bf16 v[116:119], a[128:131], a[96:99], v[116:119]
ds_read_b64_tr_b16 a[188:189], v14 offset:53248
ds_read_b64_tr_b16 a[190:191], v14 offset:53760
v_mfma_f32_16x16x32_bf16 v[116:119], a[132:135], a[100:103], v[116:119]
buffer_store_dwordx4 v[216:219], v15, s[24:27], s53 offen offset:1024 sc1
v_mfma_f32_16x16x32_bf16 v[124:127], a[140:143], a[100:103], v[124:127]
v_mfma_f32_16x16x32_bf16 v[124:127], a[136:139], a[96:99], v[124:127]
ds_read_b128 a[112:115], v4 offset:57344
v_accvgpr_read_b32 v216, a200
v_mfma_f32_16x16x32_bf16 v[132:135], a[144:147], a[96:99], v[132:135]
buffer_load_dwordx4 v6, s[12:15], s64 offen offset:1024 lds
v_mfma_f32_16x16x32_bf16 v[132:135], a[148:151], a[100:103], v[132:135]
ds_read_b128 a[116:119], v4 offset:59392
v_accvgpr_read_b32 v217, a201
v_mfma_f32_16x16x32_bf16 v[140:143], a[156:159], a[100:103], v[140:143]
v_accvgpr_read_b32 v218, a202
v_accvgpr_read_b32 v219, a203
v_mfma_f32_16x16x32_bf16 v[140:143], a[152:155], a[96:99], v[140:143]
s_lshr_b32 s84, s7, 1
s_and_b32 s85, s7, 1
ds_read_b128 a[120:123], v4 offset:58368
v_mfma_f32_16x16x32_bf16 v[148:151], a[64:67], a[96:99], v[148:151]
s_add_u32 m0, s73, 38912
s_add_u32 s64, s72, 18432
s_xor_b32 s52, s5, 0
v_mfma_f32_16x16x32_bf16 v[148:151], a[68:71], a[100:103], v[148:151]
s_lshl1_add_u32 s85, s52, s85
s_and_b32 s86, s6, 3
ds_read_b128 a[124:127], v4 offset:60416
v_mfma_f32_16x16x32_bf16 v[48:51], a[76:79], a[100:103], v[48:51]
buffer_load_dwordx4 v5, s[12:15], s64 offen lds
v_mfma_f32_16x16x32_bf16 v[48:51], a[72:75], a[96:99], v[48:51]
s_waitcnt lgkmcnt(15)
s_lshl_b32 s83, s3, 13
s_add_u32 s83, s83, 131072
v_mfma_f32_16x16x32_bf16 v[156:159], a[72:75], a[104:107], v[156:159]
s_mul_i32 s52, s2, 5462
s_lshr_b32 s52, s52, 16
s_mul_i32 s54, s52, 12
v_mfma_f32_16x16x32_bf16 v[156:159], a[76:79], a[108:111], v[156:159]
s_sub_u32 s54, s2, s54
s_mul_i32 s54, s54, 3
s_add_u32 s54, s54, s3
v_mfma_f32_16x16x32_bf16 v[164:167], a[68:71], a[108:111], v[164:167]
s_mul_i32 s55, s52, 13108
s_lshr_b32 s55, s55, 16
s_mul_i32 s82, s55, 5
v_mfma_f32_16x16x32_bf16 v[164:167], a[64:67], a[104:107], v[164:167]
s_sub_u32 s52, s52, s82
v_mfma_f32_16x16x32_bf16 v[172:175], a[152:155], a[104:107], v[172:175]
buffer_load_dwordx4 v6, s[12:15], s64 offen offset:1024 lds
v_mfma_f32_16x16x32_bf16 v[172:175], a[156:159], a[108:111], v[172:175]
v_lshrrev_b32 v16, 1, v1
v_and_b32 v17, 1, v1
v_mfma_f32_16x16x32_bf16 v[56:59], a[148:151], a[108:111], v[56:59]
v_mul_u32_u24 v18, 1152, v16
v_lshl_add_u32 v18, v17, 4, v18
v_mfma_f32_16x16x32_bf16 v[56:59], a[144:147], a[104:107], v[56:59]
v_mov_b32 v24, v18
v_lshrrev_b32 v18, 4, v16
v_mfma_f32_16x16x32_bf16 v[180:183], a[136:139], a[104:107], v[180:183]
v_bfe_u32 v19, v16, 2, 2
v_and_b32 v16, 3, v16
v_mfma_f32_16x16x32_bf16 v[180:183], a[140:143], a[108:111], v[180:183]
v_lshrrev_b32 v20, 1, v19
v_mul_u32_u24 v20, 18, v20
v_mfma_f32_16x16x32_bf16 v[188:191], a[132:135], a[108:111], v[188:191]
s_add_u32 s53, s88, 524288
v_and_b32 v21, 1, v19
v_lshl_add_u32 v20, v21, 1, v20
v_mfma_f32_16x16x32_bf16 v[188:191], a[128:131], a[104:107], v[188:191]
s_waitcnt lgkmcnt(0)
v_lshl_add_u32 v20, v16, 2, v20
v_add_u32 v20, v20, v18
v_mfma_f32_16x16x32_bf16 v[196:199], a[160:163], a[80:83], v[196:199]
s_waitcnt vmcnt(18)
v_mad_u32_u24 v20, s52, 36, v20
v_lshlrev_b32 v21, 1, v18
v_mfma_f32_16x16x32_bf16 v[196:199], a[164:167], a[84:87], v[196:199]
s_barrier
v_mfma_f32_16x16x32_bf16 v[64:67], a[172:175], a[84:87], v[64:67]
ds_read_b64_tr_b16 a[128:129], v11 offset:0
ds_read_b64_tr_b16 a[130:131], v11 offset:512
v_mfma_f32_16x16x32_bf16 v[64:67], a[168:171], a[80:83], v[64:67]
s_add_u32 m0, s77, 49152
s_add_u32 s64, s76, 128
v_lshl_add_u32 v21, v19, 2, v21
v_mfma_f32_16x16x32_bf16 v[204:207], a[176:179], a[80:83], v[204:207]
buffer_load_dwordx4 v7, s[20:23], s64 offen lds
v_mfma_f32_16x16x32_bf16 v[204:207], a[180:183], a[84:87], v[204:207]
ds_read_b64_tr_b16 a[132:133], v11 offset:4096
ds_read_b64_tr_b16 a[134:135], v11 offset:4608
v_mfma_f32_16x16x32_bf16 v[212:215], a[188:191], a[84:87], v[212:215]
ds_read_b64_tr_b16 a[136:137], v12 offset:0
ds_read_b64_tr_b16 a[138:139], v12 offset:512
v_mfma_f32_16x16x32_bf16 v[212:215], a[184:187], a[80:83], v[212:215]
ds_read_b64_tr_b16 a[140:141], v12 offset:4096
ds_read_b64_tr_b16 a[142:143], v12 offset:4608
v_mfma_f32_16x16x32_bf16 v[72:75], a[112:115], a[80:83], v[72:75]
buffer_store_dwordx4 v[96:99], v15, s[24:27], s53 offen offset:0 sc1
v_mfma_f32_16x16x32_bf16 v[72:75], a[116:119], a[84:87], v[72:75]
ds_read_b64_tr_b16 a[144:145], v13 offset:0
ds_read_b64_tr_b16 a[146:147], v13 offset:512
v_mfma_f32_16x16x32_bf16 v[220:223], a[124:127], a[84:87], v[220:223]
buffer_load_dwordx4 v8, s[20:23], s64 offen offset:1024 lds
v_mfma_f32_16x16x32_bf16 v[220:223], a[120:123], a[80:83], v[220:223]
ds_read_b64_tr_b16 a[148:149], v13 offset:4096
ds_read_b64_tr_b16 a[150:151], v13 offset:4608
v_mfma_f32_16x16x32_bf16 v[252:255], a[120:123], a[88:91], v[252:255]
v_lshrrev_b32 v22, 1, v16
v_add_u32 v21, v21, v22
v_mfma_f32_16x16x32_bf16 v[252:255], a[124:127], a[92:95], v[252:255]
ds_read_b64_tr_b16 a[152:153], v14 offset:0
ds_read_b64_tr_b16 a[154:155], v14 offset:512
v_mfma_f32_16x16x32_bf16 v[160:163], a[116:119], a[92:95], v[160:163]
s_add_u32 m0, s80, 49152
s_add_u32 s64, s79, 2048
v_mul_u32_u24 v21, 18, v21
v_mfma_f32_16x16x32_bf16 v[160:163], a[112:115], a[88:91], v[160:163]
ds_read_b64_tr_b16 a[156:157], v14 offset:4096
ds_read_b64_tr_b16 a[158:159], v14 offset:4608
v_mfma_f32_16x16x32_bf16 v[228:231], a[184:187], a[88:91], v[228:231]
buffer_load_dwordx4 v15, s[24:27], s64 offen sc1 lds
v_mfma_f32_16x16x32_bf16 v[228:231], a[188:191], a[92:95], v[228:231]
s_xor_b32 s65, s70, 640
s_add_u32 s71, s68, s65
s_add_u32 s72, s69, s65
v_mfma_f32_16x16x32_bf16 v[168:171], a[180:183], a[92:95], v[168:171]
ds_read_b128 a[64:67], v4 offset:8192
v_and_b32 v22, 1, v16
v_mfma_f32_16x16x32_bf16 v[168:171], a[176:179], a[88:91], v[168:171]
v_add3_u32 v21, v21, v22, 16
v_cmp_lt_u32 s[96:97], 1, v19
v_mfma_f32_16x16x32_bf16 v[176:179], a[168:171], a[88:91], v[176:179]
s_add_u32 m0, s73, 65536
s_add_u32 s64, s71, 0
ds_read_b128 a[80:83], v9 offset:0
v_mfma_f32_16x16x32_bf16 v[176:179], a[172:175], a[92:95], v[176:179]
v_mov_b32 v22, 0x100000
v_mul_u32_u24 v23, 1, v23
v_mfma_f32_16x16x32_bf16 v[80:83], a[164:167], a[92:95], v[80:83]
buffer_load_dwordx4 v5, s[12:15], s64 offen lds
v_mfma_f32_16x16x32_bf16 v[80:83], a[160:163], a[88:91], v[80:83]
ds_read_b128 a[68:71], v4 offset:10240
v_cndmask_b32 v21, v21, v22, s[96:97]
v_mfma_f32_16x16x32_bf16 v[184:187], a[160:163], a[96:99], v[184:187]
ds_read_b128 a[84:87], v10 offset:0
v_mov_b32 v22, s52
v_mfma_f32_16x16x32_bf16 v[184:187], a[164:167], a[100:103], v[184:187]
s_add_u32 s53, s88, 524288
v_cmp_eq_u32 s[96:97], 4, v22
v_mfma_f32_16x16x32_bf16 v[248:251], a[172:175], a[100:103], v[248:251]
buffer_store_dwordx4 v[104:107], v15, s[24:27], s53 offen offset:1024 sc1
v_mfma_f32_16x16x32_bf16 v[248:251], a[168:171], a[96:99], v[248:251]
ds_read_b128 a[72:75], v4 offset:9216
v_cndmask_b32 v20, v20, v21, s[96:97]
v_mfma_f32_16x16x32_bf16 v[240:243], a[176:179], a[96:99], v[240:243]
buffer_load_dwordx4 v6, s[12:15], s64 offen offset:1024 lds
v_mfma_f32_16x16x32_bf16 v[240:243], a[180:183], a[100:103], v[240:243]
ds_read_b128 a[88:91], v9 offset:2048
v_mul_u32_u24 v20, 1152, v20
v_mfma_f32_16x16x32_bf16 v[232:235], a[188:191], a[100:103], v[232:235]
v_lshl_add_u32 v20, v17, 4, v20
v_mov_b32 v25, v20
v_mfma_f32_16x16x32_bf16 v[232:235], a[184:187], a[96:99], v[232:235]
ds_read_b128 a[76:79], v4 offset:11264
v_mov_b32 v16, s54
v_mfma_f32_16x16x32_bf16 v[236:239], a[112:115], a[96:99], v[236:239]
s_add_u32 m0, s73, 67584
s_add_u32 s64, s71, 18432
v_mov_b32 v17, s55
v_mfma_f32_16x16x32_bf16 v[236:239], a[116:119], a[100:103], v[236:239]
ds_read_b128 a[92:95], v10 offset:2048
v_add_u32 v18, 32, v22
v_mfma_f32_16x16x32_bf16 v[224:227], a[124:127], a[100:103], v[224:227]
buffer_load_dwordx4 v5, s[12:15], s64 offen lds
v_mfma_f32_16x16x32_bf16 v[224:227], a[120:123], a[96:99], v[224:227]
s_mul_i32 s82, s55, 165888
s_lshl_b32 s54, s54, 5
s_add_u32 s82, s82, s54
v_mfma_f32_16x16x32_bf16 v[208:211], a[120:123], a[104:107], v[208:211]
s_and_b32 s52, s2, 1
s_lshr_b32 s54, s3, 1
s_lshl1_add_u32 s52, s52, s54
v_mfma_f32_16x16x32_bf16 v[208:211], a[124:127], a[108:111], v[208:211]
s_mul_i32 s52, s52, 9
s_and_b32 s54, s3, 1
s_mul_i32 s55, s54, 5
v_mfma_f32_16x16x32_bf16 v[216:219], a[116:119], a[108:111], v[216:219]
s_add_u32 s52, s52, s55
s_lshr_b32 s55, s2, 1
s_mul_i32 s81, s55, 1152
v_mfma_f32_16x16x32_bf16 v[216:219], a[112:115], a[104:107], v[216:219]
s_add_u32 s81, s81, s52
s_lshl_b32 s81, s81, 5
v_mfma_f32_16x16x32_bf16 v[244:247], a[184:187], a[104:107], v[244:247]
buffer_load_dwordx4 v6, s[12:15], s64 offen offset:1024 lds
v_mfma_f32_16x16x32_bf16 v[244:247], a[188:191], a[108:111], v[244:247]
v_cmp_gt_u32 s[96:97], 5, v1
v_add_u32 v19, s52, v1
v_mfma_f32_16x16x32_bf16 v[192:195], a[180:183], a[108:111], v[192:195]
v_lshrrev_b32 v20, 5, s55
v_and_b32 v21, 31, s55
v_mfma_f32_16x16x32_bf16 v[192:195], a[176:179], a[104:107], v[192:195]
v_cndmask_b32 v16, v16, v19, s[96:97]
v_cndmask_b32 v17, v17, v20, s[96:97]
v_mfma_f32_16x16x32_bf16 v[200:203], a[168:171], a[104:107], v[200:203]
v_cndmask_b32 v18, v18, v21, s[96:97]
v_mul_u32_u24 v19, 7282, v16
v_mfma_f32_16x16x32_bf16 v[200:203], a[172:175], a[108:111], v[200:203]
v_lshrrev_b32 v19, 16, v19
v_mul_u32_u24 v20, 9, v19
v_mfma_f32_16x16x32_bf16 v[88:91], a[164:167], a[108:111], v[88:91]
v_sub_u32 v16, v16, v20
v_and_b32 v20, 1, v19
v_mfma_f32_16x16x32_bf16 v[88:91], a[160:163], a[104:107], v[88:91]
s_waitcnt lgkmcnt(0)
v_lshlrev_b32 v20, 2, v20
v_cndmask_b32 v20, 0, v20, s[96:97]
v_mfma_f32_16x16x32_bf16 v[36:39], a[128:131], a[80:83], v[36:39]
s_waitcnt vmcnt(24)
v_xor_b32 v18, v18, v20
v_lshl_add_u32 v19, v19, 2, v17
v_mfma_f32_16x16x32_bf16 v[36:39], a[132:135], a[84:87], v[36:39]
s_barrier
v_mfma_f32_16x16x32_bf16 v[44:47], a[140:143], a[84:87], v[44:47]
ds_read_b128 a[96:99], v9 offset:4096
v_mul_u32_u24 v19, 344064, v19
v_mfma_f32_16x16x32_bf16 v[44:47], a[136:139], a[80:83], v[44:47]
s_xor_b32 s75, s93, 5
s_lshl_b32 s76, s75, 19
s_add_u32 s76, s76, s74
v_mfma_f32_16x16x32_bf16 v[32:35], a[144:147], a[80:83], v[32:35]
s_lshl_b32 s79, s75, 13
s_add_u32 s79, s79, s78
ds_read_b128 a[100:103], v10 offset:4096
v_mfma_f32_16x16x32_bf16 v[32:35], a[148:151], a[84:87], v[32:35]
s_add_u32 m0, s77, 0
s_add_u32 s64, s76, 0
ds_read_b128 a[104:107], v9 offset:6144
v_mfma_f32_16x16x32_bf16 v[52:55], a[156:159], a[84:87], v[52:55]
buffer_load_dwordx4 v7, s[20:23], s64 offen lds
v_mfma_f32_16x16x32_bf16 v[52:55], a[152:155], a[80:83], v[52:55]
s_add_u32 s53, s88, 524288
ds_read_b64_tr_b16 a[160:161], v11 offset:16384
ds_read_b64_tr_b16 a[162:163], v11 offset:16896
v_mfma_f32_16x16x32_bf16 v[60:63], a[64:67], a[80:83], v[60:63]
buffer_store_dwordx4 v[112:115], v15, s[24:27], s53 offen offset:2048 sc1
v_mfma_f32_16x16x32_bf16 v[60:63], a[68:71], a[84:87], v[60:63]
ds_read_b128 a[108:111], v10 offset:6144
v_lshrrev_b32 v20, 1, v16
v_mfma_f32_16x16x32_bf16 v[68:71], a[76:79], a[84:87], v[68:71]
buffer_load_dwordx4 v8, s[20:23], s64 offen offset:1024 lds
v_mfma_f32_16x16x32_bf16 v[68:71], a[72:75], a[80:83], v[68:71]
ds_read_b64_tr_b16 a[164:165], v11 offset:20480
ds_read_b64_tr_b16 a[166:167], v11 offset:20992
v_mfma_f32_16x16x32_bf16 v[76:79], a[72:75], a[88:91], v[76:79]
v_add_u32 v9, 32768, v9
v_add_u32 v10, 32768, v10
v_mfma_f32_16x16x32_bf16 v[76:79], a[76:79], a[92:95], v[76:79]
ds_read_b64_tr_b16 a[168:169], v12 offset:16384
ds_read_b64_tr_b16 a[170:171], v12 offset:16896
v_mfma_f32_16x16x32_bf16 v[84:87], a[68:71], a[92:95], v[84:87]
s_add_u32 m0, s80, 0
s_add_u32 s64, s79, 0
v_sub_u32 v20, v20, v17
v_mfma_f32_16x16x32_bf16 v[84:87], a[64:67], a[88:91], v[84:87]
ds_read_b64_tr_b16 a[172:173], v12 offset:20480
ds_read_b64_tr_b16 a[174:175], v12 offset:20992
v_mfma_f32_16x16x32_bf16 v[92:95], a[152:155], a[88:91], v[92:95]
buffer_load_dwordx4 v15, s[24:27], s64 offen sc1 lds
v_mfma_f32_16x16x32_bf16 v[92:95], a[156:159], a[92:95], v[92:95]
v_add_u32 v20, 3, v20
v_and_b32 v20, 3, v20
v_mfma_f32_16x16x32_bf16 v[40:43], a[148:151], a[92:95], v[40:43]
s_waitcnt vmcnt(23)
ds_read_b64_tr_b16 a[176:177], v13 offset:16384
ds_read_b64_tr_b16 a[178:179], v13 offset:16896
v_mfma_f32_16x16x32_bf16 v[40:43], a[144:147], a[88:91], v[40:43]
v_cmp_gt_u32 vcc, 1, v30
v_cmp_eq_u32 s[96:97], 8, v16
v_mfma_f32_16x16x32_bf16 v[100:103], a[136:139], a[88:91], v[100:103]
s_add_u32 m0, s73, 69632
s_add_u32 s64, s72, 0
v_and_b32 v16, 1, v16
v_mfma_f32_16x16x32_bf16 v[100:103], a[140:143], a[92:95], v[100:103]
ds_read_b64_tr_b16 a[180:181], v13 offset:20480
ds_read_b64_tr_b16 a[182:183], v13 offset:20992
v_mfma_f32_16x16x32_bf16 v[108:111], a[132:135], a[92:95], v[108:111]
buffer_load_dwordx4 v5, s[12:15], s64 offen lds
v_mfma_f32_16x16x32_bf16 v[108:111], a[128:131], a[88:91], v[108:111]
s_waitcnt lgkmcnt(14)
ds_read_b64_tr_b16 a[184:185], v14 offset:16384
ds_read_b64_tr_b16 a[186:187], v14 offset:16896
v_mfma_f32_16x16x32_bf16 v[116:119], a[128:131], a[96:99], v[116:119]
ds_read_b64_tr_b16 a[188:189], v14 offset:20480
ds_read_b64_tr_b16 a[190:191], v14 offset:20992
v_mfma_f32_16x16x32_bf16 v[116:119], a[132:135], a[100:103], v[116:119]
s_cbranch_vccnz CK_ZA
CK_ZA_R:
v_mfma_f32_16x16x32_bf16 v[124:127], a[140:143], a[100:103], v[124:127]
v_lshl_add_u32 v21, v20, 1, v16
v_and_b32 v22, 1, v18
v_mfma_f32_16x16x32_bf16 v[124:127], a[136:139], a[96:99], v[124:127]
ds_read_b128 a[112:115], v4 offset:24576
v_lshl_add_u32 v19, v22, 10, v19
v_mfma_f32_16x16x32_bf16 v[132:135], a[144:147], a[96:99], v[132:135]
buffer_load_dwordx4 v6, s[12:15], s64 offen offset:1024 lds
v_mfma_f32_16x16x32_bf16 v[132:135], a[148:151], a[100:103], v[132:135]
ds_read_b128 a[116:119], v4 offset:26624
v_and_b32 v18, -2, v18
v_mfma_f32_16x16x32_bf16 v[140:143], a[156:159], a[100:103], v[140:143]
v_add_u32 v21, 1, v21
v_cndmask_b32 v21, v21, 0, s[96:97]
v_mfma_f32_16x16x32_bf16 v[140:143], a[152:155], a[96:99], v[140:143]
s_add_u32 s53, s88, 524288
ds_read_b128 a[120:123], v4 offset:25600
v_cndmask_b32 v20, v20, 0, s[96:97]
v_mfma_f32_16x16x32_bf16 v[148:151], a[64:67], a[96:99], v[148:151]
s_add_u32 m0, s73, 71680
s_add_u32 s64, s72, 18432
v_sub_u32 v17, 37, v18
v_mfma_f32_16x16x32_bf16 v[148:151], a[68:71], a[100:103], v[148:151]
ds_read_b128 a[124:127], v4 offset:27648
v_min_u32 v17, 2, v17
v_mfma_f32_16x16x32_bf16 v[48:51], a[76:79], a[100:103], v[48:51]
buffer_load_dwordx4 v5, s[12:15], s64 offen lds
v_mfma_f32_16x16x32_bf16 v[48:51], a[72:75], a[96:99], v[48:51]
s_waitcnt lgkmcnt(15)
v_mul_u32_u24 v21, v21, v17
v_mul_u32_u24 v22, v16, v17
v_mfma_f32_16x16x32_bf16 v[156:159], a[72:75], a[104:107], v[156:159]
buffer_store_dwordx4 v[120:123], v15, s[24:27], s53 offen offset:3072 sc1
v_mfma_f32_16x16x32_bf16 v[156:159], a[76:79], a[108:111], v[156:159]
v_min_u32 v23, 8, v18
v_mad_u32_u24 v21, v18, 5, v21
v_mfma_f32_16x16x32_bf16 v[164:167], a[68:71], a[108:111], v[164:167]
v_lshl_add_u32 v21, v23, 1, v21
v_lshl_add_u32 v22, v18, 1, v22
v_mfma_f32_16x16x32_bf16 v[164:167], a[64:67], a[104:107], v[164:167]
v_mad_u32_u24 v22, v20, 37, v22
v_mad_u32_u24 v22, v20, 37, v22
v_mfma_f32_16x16x32_bf16 v[172:175], a[152:155], a[104:107], v[172:175]
buffer_load_dwordx4 v6, s[12:15], s64 offen offset:1024 lds
v_mfma_f32_16x16x32_bf16 v[172:175], a[156:159], a[108:111], v[172:175]
v_lshl_add_u32 v20, v20, 6, v18
v_mov_b32 v23, 136
v_mfma_f32_16x16x32_bf16 v[56:59], a[148:151], a[108:111], v[56:59]
v_cmp_gt_u32 s[96:97], v23, v20
v_add_u32 v22, 37, v22
v_mfma_f32_16x16x32_bf16 v[56:59], a[144:147], a[104:107], v[56:59]
v_add_u32 v19, 38797312, v19
v_mfma_f32_16x16x32_bf16 v[180:183], a[136:139], a[104:107], v[180:183]
v_cndmask_b32 v21, v22, v21, s[96:97]
v_lshl_add_u32 v19, v21, 10, v19
v_mfma_f32_16x16x32_bf16 v[180:183], a[140:143], a[108:111], v[180:183]
s_cmp_eq_u32 s54, 1
s_cselect_b32 s96, 16, 0
v_mfma_f32_16x16x32_bf16 v[188:191], a[132:135], a[108:111], v[188:191]
s_cmp_eq_u32 s3, 3
s_cselect_b32 s52, 32, 0
s_or_b32 s96, s96, s52
v_mfma_f32_16x16x32_bf16 v[188:191], a[128:131], a[104:107], v[188:191]
s_waitcnt lgkmcnt(0)
s_cmp_ge_u32 s2, 240
s_cselect_b32 s52, 32, 0
v_mfma_f32_16x16x32_bf16 v[196:199], a[160:163], a[80:83], v[196:199]
s_waitcnt vmcnt(18)
s_or_b32 s96, s96, s52
s_mov_b32 s97, 0
v_mfma_f32_16x16x32_bf16 v[196:199], a[164:167], a[84:87], v[196:199]
s_barrier
v_mfma_f32_16x16x32_bf16 v[64:67], a[172:175], a[84:87], v[64:67]
ds_read_b64_tr_b16 a[128:129], v11 offset:32768
ds_read_b64_tr_b16 a[130:131], v11 offset:33280
v_mfma_f32_16x16x32_bf16 v[64:67], a[168:171], a[80:83], v[64:67]
s_add_u32 m0, s77, 16384
s_add_u32 s64, s76, 128
v_mov_b32 v20, 2147418112
v_mfma_f32_16x16x32_bf16 v[204:207], a[176:179], a[80:83], v[204:207]
buffer_load_dwordx4 v7, s[20:23], s64 offen lds
v_mfma_f32_16x16x32_bf16 v[204:207], a[180:183], a[84:87], v[204:207]
ds_read_b64_tr_b16 a[132:133], v11 offset:36864
ds_read_b64_tr_b16 a[134:135], v11 offset:37376
v_mfma_f32_16x16x32_bf16 v[212:215], a[188:191], a[84:87], v[212:215]
ds_read_b64_tr_b16 a[136:137], v12 offset:32768
ds_read_b64_tr_b16 a[138:139], v12 offset:33280
v_mfma_f32_16x16x32_bf16 v[212:215], a[184:187], a[80:83], v[212:215]
ds_read_b64_tr_b16 a[140:141], v12 offset:36864
ds_read_b64_tr_b16 a[142:143], v12 offset:37376
v_mfma_f32_16x16x32_bf16 v[72:75], a[112:115], a[80:83], v[72:75]
buffer_atomic_add v1, v0, s[24:27], s90 offen offset:4 sc1
v_mfma_f32_16x16x32_bf16 v[72:75], a[116:119], a[84:87], v[72:75]
ds_read_b64_tr_b16 a[144:145], v13 offset:32768
ds_read_b64_tr_b16 a[146:147], v13 offset:33280
v_mfma_f32_16x16x32_bf16 v[220:223], a[124:127], a[84:87], v[220:223]
buffer_load_dwordx4 v8, s[20:23], s64 offen offset:1024 lds
v_mfma_f32_16x16x32_bf16 v[220:223], a[120:123], a[80:83], v[220:223]
s_add_u32 s53, s88, 786432
ds_read_b64_tr_b16 a[148:149], v13 offset:36864
ds_read_b64_tr_b16 a[150:151], v13 offset:37376
v_mfma_f32_16x16x32_bf16 v[252:255], a[120:123], a[88:91], v[252:255]
buffer_store_dwordx4 v[128:131], v15, s[24:27], s53 offen offset:0 sc1
v_mfma_f32_16x16x32_bf16 v[252:255], a[124:127], a[92:95], v[252:255]
ds_read_b64_tr_b16 a[152:153], v14 offset:32768
ds_read_b64_tr_b16 a[154:155], v14 offset:33280
v_mfma_f32_16x16x32_bf16 v[160:163], a[116:119], a[92:95], v[160:163]
s_add_u32 m0, s80, 16384
s_add_u32 s64, s79, 2048
v_cndmask_b32 v26, v19, v20, s[96:97]
v_mfma_f32_16x16x32_bf16 v[160:163], a[112:115], a[88:91], v[160:163]
ds_read_b64_tr_b16 a[156:157], v14 offset:36864
ds_read_b64_tr_b16 a[158:159], v14 offset:37376
v_mfma_f32_16x16x32_bf16 v[228:231], a[184:187], a[88:91], v[228:231]
buffer_load_dwordx4 v15, s[24:27], s64 offen sc1 lds
v_mfma_f32_16x16x32_bf16 v[228:231], a[188:191], a[92:95], v[228:231]
s_xor_b32 s65, s70, 768
s_add_u32 s71, s68, s65
s_add_u32 s72, s69, s65
v_mfma_f32_16x16x32_bf16 v[168:171], a[180:183], a[92:95], v[168:171]
ds_read_b128 a[64:67], v4 offset:40960
v_lshlrev_b32 v27, 3, v1
v_mfma_f32_16x16x32_bf16 v[168:171], a[176:179], a[88:91], v[168:171]
v_add_u32 v27, s83, v27
v_lshrrev_b32 v22, 3, v1
v_mfma_f32_16x16x32_bf16 v[176:179], a[168:171], a[88:91], v[176:179]
s_add_u32 m0, s73, 0
s_add_u32 s64, s71, 0
ds_read_b128 a[80:83], v9 offset:0
v_mfma_f32_16x16x32_bf16 v[176:179], a[172:175], a[92:95], v[176:179]
v_mul_u32_u24 v22, 1152, v22
v_and_b32 v23, 7, v1
v_mfma_f32_16x16x32_bf16 v[80:83], a[164:167], a[92:95], v[80:83]
buffer_load_dwordx4 v5, s[12:15], s64 offen lds
v_mfma_f32_16x16x32_bf16 v[80:83], a[160:163], a[88:91], v[80:83]
L_PAD6:
s_cbranch_execz L_PAD10
ds_read_b128 a[68:71], v4 offset:43008
v_lshl_add_u32 v22, v23, 4, v22
v_mfma_f32_16x16x32_bf16 v[184:187], a[160:163], a[96:99], v[184:187]
ds_read_b128 a[84:87], v10 offset:0
v_lshrrev_b32 v23, 2, v1
v_mfma_f32_16x16x32_bf16 v[184:187], a[164:167], a[100:103], v[184:187]
v_mul_u32_u24 v23, 96, v23
v_add_u32 v23, v23, v27
v_mfma_f32_16x16x32_bf16 v[248:251], a[172:175], a[100:103], v[248:251]
v_and_b32 v16, 3, v1
v_cmp_eq_u32 s[96:97], 0, v16
v_mfma_f32_16x16x32_bf16 v[248:251], a[168:171], a[96:99], v[248:251]
ds_read_b128 a[72:75], v4 offset:41984
v_mov_b32 v16, 0x3f803f80
v_mfma_f32_16x16x32_bf16 v[240:243], a[176:179], a[96:99], v[240:243]
buffer_load_dwordx4 v6, s[12:15], s64 offen offset:1024 lds
v_mfma_f32_16x16x32_bf16 v[240:243], a[180:183], a[100:103], v[240:243]
ds_read_b128 a[88:91], v9 offset:2048
v_cndmask_b32 v16, 0, v16, s[96:97]
v_mfma_f32_16x16x32_bf16 v[232:235], a[188:191], a[100:103], v[232:235]
v_accvgpr_write_b32 a240, v16
v_accvgpr_write_b32 a241, v16
v_mfma_f32_16x16x32_bf16 v[232:235], a[184:187], a[96:99], v[232:235]
ds_read_b128 a[76:79], v4 offset:44032
v_accvgpr_write_b32 a242, v16
v_mfma_f32_16x16x32_bf16 v[236:239], a[112:115], a[96:99], v[236:239]
s_add_u32 m0, s73, 2048
s_add_u32 s64, s71, 18432
v_accvgpr_write_b32 a243, v16
v_mfma_f32_16x16x32_bf16 v[236:239], a[116:119], a[100:103], v[236:239]
ds_read_b128 a[92:95], v10 offset:2048
v_accvgpr_write_b32 a232, 0
v_mfma_f32_16x16x32_bf16 v[224:227], a[124:127], a[100:103], v[224:227]
buffer_load_dwordx4 v5, s[12:15], s64 offen lds
v_mfma_f32_16x16x32_bf16 v[224:227], a[120:123], a[96:99], v[224:227]
v_accvgpr_write_b32 a233, 0
v_accvgpr_write_b32 a234, 0
v_mfma_f32_16x16x32_bf16 v[208:211], a[120:123], a[104:107], v[208:211]
v_accvgpr_write_b32 a235, 0
v_accvgpr_write_b32 a236, 0
v_mfma_f32_16x16x32_bf16 v[208:211], a[124:127], a[108:111], v[208:211]
s_add_u32 s53, s88, 786432
v_accvgpr_write_b32 a237, 0
v_accvgpr_write_b32 a238, 0
v_mfma_f32_16x16x32_bf16 v[216:219], a[116:119], a[108:111], v[216:219]
buffer_store_dwordx4 v[136:139], v15, s[24:27], s53 offen offset:1024 sc1
v_mfma_f32_16x16x32_bf16 v[216:219], a[112:115], a[104:107], v[216:219]
v_accvgpr_write_b32 a239, 0
v_lshlrev_b32 v16, 2, v3
v_mfma_f32_16x16x32_bf16 v[244:247], a[184:187], a[104:107], v[244:247]
buffer_load_dwordx4 v6, s[12:15], s64 offen offset:1024 lds
v_mfma_f32_16x16x32_bf16 v[244:247], a[188:191], a[108:111], v[244:247]
v_sub_u32 v16, v2, v16
v_cmp_gt_i32 s[56:57], 0, v16
v_mfma_f32_16x16x32_bf16 v[192:195], a[180:183], a[108:111], v[192:195]
v_cmp_gt_i32 s[58:59], 1, v16
v_cmp_gt_i32 s[60:61], 2, v16
v_mfma_f32_16x16x32_bf16 v[192:195], a[176:179], a[104:107], v[192:195]
v_cmp_gt_i32 s[62:63], 3, v16
v_cmp_eq_u32 s[96:97], 3, v3
v_mfma_f32_16x16x32_bf16 v[200:203], a[168:171], a[104:107], v[200:203]
v_add_u32 v17, 48, v2
v_lshlrev_b32 v17, 2, v17
v_mfma_f32_16x16x32_bf16 v[200:203], a[172:175], a[108:111], v[200:203]
v_lshlrev_b32 v18, 16, v3
v_lshl_add_u32 v18, v2, 4, v18
v_mfma_f32_16x16x32_bf16 v[88:91], a[164:167], a[108:111], v[88:91]
v_add_u32 v19, 0x8000, v18
v_cndmask_b32 v19, v19, v20, s[96:97]
v_mfma_f32_16x16x32_bf16 v[88:91], a[160:163], a[104:107], v[88:91]
s_waitcnt lgkmcnt(0)
v_cmp_eq_u32 s[96:97], 0, v3
v_mfma_f32_16x16x32_bf16 v[36:39], a[128:131], a[80:83], v[36:39]
s_waitcnt vmcnt(24)
v_mfma_f32_16x16x32_bf16 v[36:39], a[132:135], a[84:87], v[36:39]
s_barrier
v_mfma_f32_16x16x32_bf16 v[44:47], a[140:143], a[84:87], v[44:47]
ds_read_b128 a[96:99], v9 offset:4096
v_cndmask_b32 v18, v18, v20, s[96:97]
v_mfma_f32_16x16x32_bf16 v[44:47], a[136:139], a[80:83], v[44:47]
s_xor_b32 s75, s93, 6
s_lshl_b32 s76, s75, 19
s_add_u32 s76, s76, s74
v_mfma_f32_16x16x32_bf16 v[32:35], a[144:147], a[80:83], v[32:35]
s_lshl_b32 s79, s75, 13
s_add_u32 s79, s79, s78
ds_read_b128 a[100:103], v10 offset:4096
v_mfma_f32_16x16x32_bf16 v[32:35], a[148:151], a[84:87], v[32:35]
s_add_u32 m0, s77, 32768
s_add_u32 s64, s76, 0
ds_read_b128 a[104:107], v9 offset:6144
v_mfma_f32_16x16x32_bf16 v[52:55], a[156:159], a[84:87], v[52:55]
buffer_load_dwordx4 v7, s[20:23], s64 offen lds
v_mfma_f32_16x16x32_bf16 v[52:55], a[152:155], a[80:83], v[52:55]
ds_read_b64_tr_b16 a[160:161], v11 offset:49152
ds_read_b64_tr_b16 a[162:163], v11 offset:49664
v_mfma_f32_16x16x32_bf16 v[60:63], a[64:67], a[80:83], v[60:63]
v_cndmask_b32 v19, v19, v20, s[96:97]
v_mfma_f32_16x16x32_bf16 v[60:63], a[68:71], a[84:87], v[60:63]
ds_read_b128 a[108:111], v10 offset:6144
v_mfma_f32_16x16x32_bf16 v[68:71], a[76:79], a[84:87], v[68:71]
buffer_load_dwordx4 v8, s[20:23], s64 offen offset:1024 lds
v_mfma_f32_16x16x32_bf16 v[68:71], a[72:75], a[80:83], v[68:71]
ds_read_b64_tr_b16 a[164:165], v11 offset:53248
ds_read_b64_tr_b16 a[166:167], v11 offset:53760
v_mfma_f32_16x16x32_bf16 v[76:79], a[72:75], a[88:91], v[76:79]
v_add_u32 v9, 32768, v9
v_add_u32 v10, 32768, v10
v_mfma_f32_16x16x32_bf16 v[76:79], a[76:79], a[92:95], v[76:79]
ds_read_b64_tr_b16 a[168:169], v12 offset:49152
ds_read_b64_tr_b16 a[170:171], v12 offset:49664
v_mfma_f32_16x16x32_bf16 v[84:87], a[68:71], a[92:95], v[84:87]
s_add_u32 m0, s80, 32768
s_add_u32 s64, s79, 0
v_mfma_f32_16x16x32_bf16 v[84:87], a[64:67], a[88:91], v[84:87]
ds_read_b64_tr_b16 a[172:173], v12 offset:53248
ds_read_b64_tr_b16 a[174:175], v12 offset:53760
v_mfma_f32_16x16x32_bf16 v[92:95], a[152:155], a[88:91], v[92:95]
buffer_load_dwordx4 v15, s[24:27], s64 offen sc1 lds
v_mfma_f32_16x16x32_bf16 v[92:95], a[156:159], a[92:95], v[92:95]
s_add_u32 s53, s88, 786432
v_mfma_f32_16x16x32_bf16 v[40:43], a[148:151], a[92:95], v[40:43]
ds_read_b64_tr_b16 a[176:177], v13 offset:49152
ds_read_b64_tr_b16 a[178:179], v13 offset:49664
v_mfma_f32_16x16x32_bf16 v[40:43], a[144:147], a[88:91], v[40:43]
buffer_store_dwordx4 v[144:147], v15, s[24:27], s53 offen offset:2048 sc1
v_mfma_f32_16x16x32_bf16 v[100:103], a[136:139], a[88:91], v[100:103]
s_add_u32 m0, s73, 4096
s_add_u32 s64, s72, 0
v_mfma_f32_16x16x32_bf16 v[100:103], a[140:143], a[92:95], v[100:103]
ds_read_b64_tr_b16 a[180:181], v13 offset:53248
ds_read_b64_tr_b16 a[182:183], v13 offset:53760
v_mfma_f32_16x16x32_bf16 v[108:111], a[132:135], a[92:95], v[108:111]
buffer_load_dwordx4 v5, s[12:15], s64 offen lds
v_mfma_f32_16x16x32_bf16 v[108:111], a[128:131], a[88:91], v[108:111]
s_waitcnt lgkmcnt(14)
ds_read_b64_tr_b16 a[184:185], v14 offset:49152
ds_read_b64_tr_b16 a[186:187], v14 offset:49664
v_mfma_f32_16x16x32_bf16 v[116:119], a[128:131], a[96:99], v[116:119]
ds_read_b64_tr_b16 a[188:189], v14 offset:53248
ds_read_b64_tr_b16 a[190:191], v14 offset:53760
v_mfma_f32_16x16x32_bf16 v[116:119], a[132:135], a[100:103], v[116:119]
v_mfma_f32_16x16x32_bf16 v[124:127], a[140:143], a[100:103], v[124:127]
v_mfma_f32_16x16x32_bf16 v[124:127], a[136:139], a[96:99], v[124:127]
ds_read_b128 a[112:115], v4 offset:57344
v_mfma_f32_16x16x32_bf16 v[132:135], a[144:147], a[96:99], v[132:135]
buffer_load_dwordx4 v6, s[12:15], s64 offen offset:1024 lds
v_mfma_f32_16x16x32_bf16 v[132:135], a[148:151], a[100:103], v[132:135]
ds_read_b128 a[116:119], v4 offset:59392
v_mfma_f32_16x16x32_bf16 v[140:143], a[156:159], a[100:103], v[140:143]
v_mfma_f32_16x16x32_bf16 v[140:143], a[152:155], a[96:99], v[140:143]
ds_read_b128 a[120:123], v4 offset:58368
v_mfma_f32_16x16x32_bf16 v[148:151], a[64:67], a[96:99], v[148:151]
s_add_u32 m0, s73, 6144
s_add_u32 s64, s72, 18432
v_mfma_f32_16x16x32_bf16 v[148:151], a[68:71], a[100:103], v[148:151]
ds_read_b128 a[124:127], v4 offset:60416
v_mfma_f32_16x16x32_bf16 v[48:51], a[76:79], a[100:103], v[48:51]
buffer_load_dwordx4 v5, s[12:15], s64 offen lds
v_mfma_f32_16x16x32_bf16 v[48:51], a[72:75], a[96:99], v[48:51]
s_waitcnt lgkmcnt(15)
v_mfma_f32_16x16x32_bf16 v[156:159], a[72:75], a[104:107], v[156:159]
v_mfma_f32_16x16x32_bf16 v[156:159], a[76:79], a[108:111], v[156:159]
v_mfma_f32_16x16x32_bf16 v[164:167], a[68:71], a[108:111], v[164:167]
v_mfma_f32_16x16x32_bf16 v[164:167], a[64:67], a[104:107], v[164:167]
v_mfma_f32_16x16x32_bf16 v[172:175], a[152:155], a[104:107], v[172:175]
buffer_load_dwordx4 v6, s[12:15], s64 offen offset:1024 lds
v_mfma_f32_16x16x32_bf16 v[172:175], a[156:159], a[108:111], v[172:175]
v_mfma_f32_16x16x32_bf16 v[56:59], a[148:151], a[108:111], v[56:59]
v_mfma_f32_16x16x32_bf16 v[56:59], a[144:147], a[104:107], v[56:59]
s_add_u32 s53, s88, 786432
v_mfma_f32_16x16x32_bf16 v[180:183], a[136:139], a[104:107], v[180:183]
buffer_store_dwordx4 v[152:155], v15, s[24:27], s53 offen offset:3072 sc1
v_mfma_f32_16x16x32_bf16 v[180:183], a[140:143], a[108:111], v[180:183]
v_mfma_f32_16x16x32_bf16 v[188:191], a[132:135], a[108:111], v[188:191]
v_mfma_f32_16x16x32_bf16 v[188:191], a[128:131], a[104:107], v[188:191]
s_waitcnt lgkmcnt(0)
v_mov_b32 v96, 0
v_mov_b32 v97, 0
v_mfma_f32_16x16x32_bf16 v[196:199], a[160:163], a[80:83], v[196:199]
s_waitcnt vmcnt(19)
v_mov_b32 v98, 0
v_mov_b32 v99, 0
v_mfma_f32_16x16x32_bf16 v[196:199], a[164:167], a[84:87], v[196:199]
s_barrier
v_mfma_f32_16x16x32_bf16 v[64:67], a[172:175], a[84:87], v[64:67]
ds_read_b64_tr_b16 a[128:129], v11 offset:0
ds_read_b64_tr_b16 a[130:131], v11 offset:512
v_mfma_f32_16x16x32_bf16 v[64:67], a[168:171], a[80:83], v[64:67]
s_add_u32 m0, s77, 49152
s_add_u32 s64, s76, 128
v_mov_b32 v104, 0
v_mfma_f32_16x16x32_bf16 v[204:207], a[176:179], a[80:83], v[204:207]
buffer_load_dwordx4 v7, s[20:23], s64 offen lds
v_mfma_f32_16x16x32_bf16 v[204:207], a[180:183], a[84:87], v[204:207]
ds_read_b64_tr_b16 a[132:133], v11 offset:4096
ds_read_b64_tr_b16 a[134:135], v11 offset:4608
v_mfma_f32_16x16x32_bf16 v[212:215], a[188:191], a[84:87], v[212:215]
ds_read_b64_tr_b16 a[136:137], v12 offset:0
ds_read_b64_tr_b16 a[138:139], v12 offset:512
v_mfma_f32_16x16x32_bf16 v[212:215], a[184:187], a[80:83], v[212:215]
ds_read_b64_tr_b16 a[140:141], v12 offset:4096
ds_read_b64_tr_b16 a[142:143], v12 offset:4608
v_mfma_f32_16x16x32_bf16 v[72:75], a[112:115], a[80:83], v[72:75]
buffer_load_dword v30, v29, s[24:27], s89 offen offset:4 sc1
v_mfma_f32_16x16x32_bf16 v[72:75], a[116:119], a[84:87], v[72:75]
ds_read_b64_tr_b16 a[144:145], v13 offset:0
ds_read_b64_tr_b16 a[146:147], v13 offset:512
v_mfma_f32_16x16x32_bf16 v[220:223], a[124:127], a[84:87], v[220:223]
buffer_load_dwordx4 v8, s[20:23], s64 offen offset:1024 lds
v_mfma_f32_16x16x32_bf16 v[220:223], a[120:123], a[80:83], v[220:223]
ds_read_b64_tr_b16 a[148:149], v13 offset:4096
ds_read_b64_tr_b16 a[150:151], v13 offset:4608
v_mfma_f32_16x16x32_bf16 v[252:255], a[120:123], a[88:91], v[252:255]
v_mov_b32 v105, 0
v_mov_b32 v106, 0
v_mfma_f32_16x16x32_bf16 v[252:255], a[124:127], a[92:95], v[252:255]
ds_read_b64_tr_b16 a[152:153], v14 offset:0
ds_read_b64_tr_b16 a[154:155], v14 offset:512
v_mfma_f32_16x16x32_bf16 v[160:163], a[116:119], a[92:95], v[160:163]
s_add_u32 m0, s80, 49152
s_add_u32 s64, s79, 2048
v_mov_b32 v107, 0
v_mfma_f32_16x16x32_bf16 v[160:163], a[112:115], a[88:91], v[160:163]
ds_read_b64_tr_b16 a[156:157], v14 offset:4096
ds_read_b64_tr_b16 a[158:159], v14 offset:4608
v_mfma_f32_16x16x32_bf16 v[228:231], a[184:187], a[88:91], v[228:231]
buffer_load_dwordx4 v15, s[24:27], s64 offen sc1 lds
v_mfma_f32_16x16x32_bf16 v[228:231], a[188:191], a[92:95], v[228:231]
s_xor_b32 s65, s70, 896
s_add_u32 s71, s68, s65
s_add_u32 s72, s69, s65
v_mfma_f32_16x16x32_bf16 v[168:171], a[180:183], a[92:95], v[168:171]
ds_read_b128 a[64:67], v4 offset:8192
v_mov_b32 v112, 0
v_mfma_f32_16x16x32_bf16 v[168:171], a[176:179], a[88:91], v[168:171]
v_mov_b32 v113, 0
v_mov_b32 v114, 0
v_mfma_f32_16x16x32_bf16 v[176:179], a[168:171], a[88:91], v[176:179]
s_add_u32 m0, s73, 32768
s_add_u32 s64, s71, 0
ds_read_b128 a[80:83], v9 offset:0
v_mfma_f32_16x16x32_bf16 v[176:179], a[172:175], a[92:95], v[176:179]
v_mov_b32 v115, 0
v_mov_b32 v120, 0
v_mfma_f32_16x16x32_bf16 v[80:83], a[164:167], a[92:95], v[80:83]
buffer_load_dwordx4 v5, s[12:15], s64 offen lds
v_mfma_f32_16x16x32_bf16 v[80:83], a[160:163], a[88:91], v[80:83]
s_add_u32 s53, s87, 524288
ds_read_b128 a[68:71], v4 offset:10240
v_mov_b32 v121, 0
v_mfma_f32_16x16x32_bf16 v[184:187], a[160:163], a[96:99], v[184:187]
ds_read_b128 a[84:87], v10 offset:0
v_mov_b32 v122, 0
v_mfma_f32_16x16x32_bf16 v[184:187], a[164:167], a[100:103], v[184:187]
buffer_store_dwordx4 a[28:31], v15, s[24:27], s53 offen offset:0 sc1
v_mfma_f32_16x16x32_bf16 v[248:251], a[172:175], a[100:103], v[248:251]
v_mov_b32 v123, 0
v_mov_b32 v128, 0
v_mfma_f32_16x16x32_bf16 v[248:251], a[168:171], a[96:99], v[248:251]
ds_read_b128 a[72:75], v4 offset:9216
v_mov_b32 v129, 0
v_mfma_f32_16x16x32_bf16 v[240:243], a[176:179], a[96:99], v[240:243]
buffer_load_dwordx4 v6, s[12:15], s64 offen offset:1024 lds
v_mfma_f32_16x16x32_bf16 v[240:243], a[180:183], a[100:103], v[240:243]
ds_read_b128 a[88:91], v9 offset:2048
v_mov_b32 v130, 0
v_mfma_f32_16x16x32_bf16 v[232:235], a[188:191], a[100:103], v[232:235]
v_mov_b32 v131, 0
v_mov_b32 v136, 0
v_mfma_f32_16x16x32_bf16 v[232:235], a[184:187], a[96:99], v[232:235]
ds_read_b128 a[76:79], v4 offset:11264
v_mov_b32 v137, 0
v_mfma_f32_16x16x32_bf16 v[236:239], a[112:115], a[96:99], v[236:239]
s_add_u32 m0, s73, 34816
s_add_u32 s64, s71, 18432
v_mov_b32 v138, 0
v_mfma_f32_16x16x32_bf16 v[236:239], a[116:119], a[100:103], v[236:239]
ds_read_b128 a[92:95], v10 offset:2048
v_mov_b32 v139, 0
v_mfma_f32_16x16x32_bf16 v[224:227], a[124:127], a[100:103], v[224:227]
buffer_load_dwordx4 v5, s[12:15], s64 offen lds
v_mfma_f32_16x16x32_bf16 v[224:227], a[120:123], a[96:99], v[224:227]
v_mov_b32 v144, 0
v_mov_b32 v145, 0
v_mfma_f32_16x16x32_bf16 v[208:211], a[120:123], a[104:107], v[208:211]
v_mov_b32 v146, 0
v_mov_b32 v147, 0
v_mfma_f32_16x16x32_bf16 v[208:211], a[124:127], a[108:111], v[208:211]
v_mov_b32 v152, 0
v_mov_b32 v153, 0
v_mfma_f32_16x16x32_bf16 v[216:219], a[116:119], a[108:111], v[216:219]
v_mov_b32 v154, 0
v_mov_b32 v155, 0
v_mfma_f32_16x16x32_bf16 v[216:219], a[112:115], a[104:107], v[216:219]
v_mfma_f32_16x16x32_bf16 v[244:247], a[184:187], a[104:107], v[244:247]
buffer_load_dwordx4 v6, s[12:15], s64 offen offset:1024 lds
v_mfma_f32_16x16x32_bf16 v[244:247], a[188:191], a[108:111], v[244:247]
v_mfma_f32_16x16x32_bf16 v[192:195], a[180:183], a[108:111], v[192:195]
v_mfma_f32_16x16x32_bf16 v[192:195], a[176:179], a[104:107], v[192:195]
v_mfma_f32_16x16x32_bf16 v[200:203], a[168:171], a[104:107], v[200:203]
v_mfma_f32_16x16x32_bf16 v[200:203], a[172:175], a[108:111], v[200:203]
v_mfma_f32_16x16x32_bf16 v[88:91], a[164:167], a[108:111], v[88:91]
v_mfma_f32_16x16x32_bf16 v[88:91], a[160:163], a[104:107], v[88:91]
s_waitcnt lgkmcnt(0)
v_mfma_f32_16x16x32_bf16 v[36:39], a[128:131], a[80:83], v[36:39]
s_waitcnt vmcnt(23)
v_mfma_f32_16x16x32_bf16 v[36:39], a[132:135], a[84:87], v[36:39]
s_barrier
v_mfma_f32_16x16x32_bf16 v[44:47], a[140:143], a[84:87], v[44:47]
s_add_u32 s53, s87, 524288
ds_read_b128 a[96:99], v9 offset:4096
v_mfma_f32_16x16x32_bf16 v[44:47], a[136:139], a[80:83], v[44:47]
s_xor_b32 s75, s93, 7
s_lshl_b32 s76, s75, 19
s_add_u32 s76, s76, s74
v_mfma_f32_16x16x32_bf16 v[32:35], a[144:147], a[80:83], v[32:35]
s_lshl_b32 s79, s75, 13
s_add_u32 s79, s79, s78
ds_read_b128 a[100:103], v10 offset:4096
v_mfma_f32_16x16x32_bf16 v[32:35], a[148:151], a[84:87], v[32:35]
s_add_u32 m0, s77, 0
s_add_u32 s64, s76, 0
ds_read_b128 a[104:107], v9 offset:6144
v_mfma_f32_16x16x32_bf16 v[52:55], a[156:159], a[84:87], v[52:55]
buffer_load_dwordx4 v7, s[20:23], s64 offen lds
v_mfma_f32_16x16x32_bf16 v[52:55], a[152:155], a[80:83], v[52:55]
ds_read_b64_tr_b16 a[160:161], v11 offset:16384
ds_read_b64_tr_b16 a[162:163], v11 offset:16896
v_mfma_f32_16x16x32_bf16 v[60:63], a[64:67], a[80:83], v[60:63]
buffer_store_dwordx4 a[20:23], v15, s[24:27], s53 offen offset:1024 sc1
v_mfma_f32_16x16x32_bf16 v[60:63], a[68:71], a[84:87], v[60:63]
ds_read_b128 a[108:111], v10 offset:6144
v_mfma_f32_16x16x32_bf16 v[68:71], a[76:79], a[84:87], v[68:71]
buffer_load_dwordx4 v8, s[20:23], s64 offen offset:1024 lds
v_mfma_f32_16x16x32_bf16 v[68:71], a[72:75], a[80:83], v[68:71]
ds_read_b64_tr_b16 a[164:165], v11 offset:20480
ds_read_b64_tr_b16 a[166:167], v11 offset:20992
v_mfma_f32_16x16x32_bf16 v[76:79], a[72:75], a[88:91], v[76:79]
v_add_u32 v9, -65536, v9
v_add_u32 v10, -65536, v10
v_mfma_f32_16x16x32_bf16 v[76:79], a[76:79], a[92:95], v[76:79]
ds_read_b64_tr_b16 a[168:169], v12 offset:16384
ds_read_b64_tr_b16 a[170:171], v12 offset:16896
v_mfma_f32_16x16x32_bf16 v[84:87], a[68:71], a[92:95], v[84:87]
s_add_u32 m0, s80, 0
s_add_u32 s64, s79, 0
v_mfma_f32_16x16x32_bf16 v[84:87], a[64:67], a[88:91], v[84:87]
ds_read_b64_tr_b16 a[172:173], v12 offset:20480
ds_read_b64_tr_b16 a[174:175], v12 offset:20992
v_mfma_f32_16x16x32_bf16 v[92:95], a[152:155], a[88:91], v[92:95]
buffer_load_dwordx4 v15, s[24:27], s64 offen sc1 lds
v_mfma_f32_16x16x32_bf16 v[92:95], a[156:159], a[92:95], v[92:95]
v_mfma_f32_16x16x32_bf16 v[40:43], a[148:151], a[92:95], v[40:43]
ds_read_b64_tr_b16 a[176:177], v13 offset:16384
ds_read_b64_tr_b16 a[178:179], v13 offset:16896
v_mfma_f32_16x16x32_bf16 v[40:43], a[144:147], a[88:91], v[40:43]
v_mfma_f32_16x16x32_bf16 v[100:103], a[136:139], a[88:91], v[100:103]
s_add_u32 m0, s73, 36864
s_add_u32 s64, s72, 0
v_mfma_f32_16x16x32_bf16 v[100:103], a[140:143], a[92:95], v[100:103]
ds_read_b64_tr_b16 a[180:181], v13 offset:20480
ds_read_b64_tr_b16 a[182:183], v13 offset:20992
v_mfma_f32_16x16x32_bf16 v[108:111], a[132:135], a[92:95], v[108:111]
buffer_load_dwordx4 v5, s[12:15], s64 offen lds
v_mfma_f32_16x16x32_bf16 v[108:111], a[128:131], a[88:91], v[108:111]
s_waitcnt lgkmcnt(14)
ds_read_b64_tr_b16 a[184:185], v14 offset:16384
ds_read_b64_tr_b16 a[186:187], v14 offset:16896
v_mfma_f32_16x16x32_bf16 v[116:119], a[128:131], a[96:99], v[116:119]
ds_read_b64_tr_b16 a[188:189], v14 offset:20480
ds_read_b64_tr_b16 a[190:191], v14 offset:20992
v_mfma_f32_16x16x32_bf16 v[116:119], a[132:135], a[100:103], v[116:119]
v_mfma_f32_16x16x32_bf16 v[124:127], a[140:143], a[100:103], v[124:127]
v_mfma_f32_16x16x32_bf16 v[124:127], a[136:139], a[96:99], v[124:127]
ds_read_b128 a[112:115], v4 offset:24576
v_mfma_f32_16x16x32_bf16 v[132:135], a[144:147], a[96:99], v[132:135]
buffer_load_dwordx4 v6, s[12:15], s64 offen offset:1024 lds
v_mfma_f32_16x16x32_bf16 v[132:135], a[148:151], a[100:103], v[132:135]
s_add_u32 s53, s87, 528384
ds_read_b128 a[116:119], v4 offset:26624
v_mfma_f32_16x16x32_bf16 v[140:143], a[156:159], a[100:103], v[140:143]
buffer_store_dwordx4 a[12:15], v15, s[24:27], s53 offen offset:0 sc1
v_mfma_f32_16x16x32_bf16 v[140:143], a[152:155], a[96:99], v[140:143]
ds_read_b128 a[120:123], v4 offset:25600
v_mfma_f32_16x16x32_bf16 v[148:151], a[64:67], a[96:99], v[148:151]
s_add_u32 m0, s73, 38912
s_add_u32 s64, s72, 18432
v_mfma_f32_16x16x32_bf16 v[148:151], a[68:71], a[100:103], v[148:151]
ds_read_b128 a[124:127], v4 offset:27648
v_mfma_f32_16x16x32_bf16 v[48:51], a[76:79], a[100:103], v[48:51]
buffer_load_dwordx4 v5, s[12:15], s64 offen lds
v_mfma_f32_16x16x32_bf16 v[48:51], a[72:75], a[96:99], v[48:51]
s_waitcnt lgkmcnt(15)
v_mfma_f32_16x16x32_bf16 v[156:159], a[72:75], a[104:107], v[156:159]
v_mfma_f32_16x16x32_bf16 v[156:159], a[76:79], a[108:111], v[156:159]
v_mfma_f32_16x16x32_bf16 v[164:167], a[68:71], a[108:111], v[164:167]
v_mfma_f32_16x16x32_bf16 v[164:167], a[64:67], a[104:107], v[164:167]
v_mfma_f32_16x16x32_bf16 v[172:175], a[152:155], a[104:107], v[172:175]
buffer_load_dwordx4 v6, s[12:15], s64 offen offset:1024 lds
v_mfma_f32_16x16x32_bf16 v[172:175], a[156:159], a[108:111], v[172:175]
v_mfma_f32_16x16x32_bf16 v[56:59], a[148:151], a[108:111], v[56:59]
v_mfma_f32_16x16x32_bf16 v[56:59], a[144:147], a[104:107], v[56:59]
v_mfma_f32_16x16x32_bf16 v[180:183], a[136:139], a[104:107], v[180:183]
v_mfma_f32_16x16x32_bf16 v[180:183], a[140:143], a[108:111], v[180:183]
v_mfma_f32_16x16x32_bf16 v[188:191], a[132:135], a[108:111], v[188:191]
v_mfma_f32_16x16x32_bf16 v[188:191], a[128:131], a[104:107], v[188:191]
s_waitcnt lgkmcnt(0)
v_mfma_f32_16x16x32_bf16 v[196:199], a[160:163], a[80:83], v[196:199]
s_waitcnt vmcnt(19)
v_mfma_f32_16x16x32_bf16 v[196:199], a[164:167], a[84:87], v[196:199]
s_barrier
v_mfma_f32_16x16x32_bf16 v[64:67], a[172:175], a[84:87], v[64:67]
ds_read_b64_tr_b16 a[128:129], v11 offset:32768
ds_read_b64_tr_b16 a[130:131], v11 offset:33280
v_mfma_f32_16x16x32_bf16 v[64:67], a[168:171], a[80:83], v[64:67]
s_add_u32 m0, s77, 16384
s_add_u32 s64, s76, 128
v_mfma_f32_16x16x32_bf16 v[204:207], a[176:179], a[80:83], v[204:207]
buffer_load_dwordx4 v7, s[20:23], s64 offen lds
v_mfma_f32_16x16x32_bf16 v[204:207], a[180:183], a[84:87], v[204:207]
ds_read_b64_tr_b16 a[132:133], v11 offset:36864
ds_read_b64_tr_b16 a[134:135], v11 offset:37376
v_mfma_f32_16x16x32_bf16 v[212:215], a[188:191], a[84:87], v[212:215]
ds_read_b64_tr_b16 a[136:137], v12 offset:32768
ds_read_b64_tr_b16 a[138:139], v12 offset:33280
v_mfma_f32_16x16x32_bf16 v[212:215], a[184:187], a[80:83], v[212:215]
s_add_u32 s53, s87, 528384
ds_read_b64_tr_b16 a[140:141], v12 offset:36864
ds_read_b64_tr_b16 a[142:143], v12 offset:37376
v_mfma_f32_16x16x32_bf16 v[72:75], a[112:115], a[80:83], v[72:75]
buffer_load_dwordx4 v8, s[20:23], s64 offen offset:1024 lds
v_mfma_f32_16x16x32_bf16 v[72:75], a[116:119], a[84:87], v[72:75]
ds_read_b64_tr_b16 a[144:145], v13 offset:32768
ds_read_b64_tr_b16 a[146:147], v13 offset:33280
v_mfma_f32_16x16x32_bf16 v[220:223], a[124:127], a[84:87], v[220:223]
buffer_store_dwordx4 a[4:7], v15, s[24:27], s53 offen offset:1024 sc1
v_mfma_f32_16x16x32_bf16 v[220:223], a[120:123], a[80:83], v[220:223]
s_add_u32 m0, s80, 16384
s_add_u32 s64, s79, 2048
v_mfma_f32_16x16x32_bf16 v[252:255], a[120:123], a[88:91], v[252:255]
ds_read_b64_tr_b16 a[148:149], v13 offset:36864
ds_read_b64_tr_b16 a[150:151], v13 offset:37376
v_mfma_f32_16x16x32_bf16 v[252:255], a[124:127], a[92:95], v[252:255]
buffer_load_dwordx4 v15, s[24:27], s64 offen sc1 lds
v_mfma_f32_16x16x32_bf16 v[160:163], a[116:119], a[92:95], v[160:163]
ds_read_b64_tr_b16 a[152:153], v14 offset:32768
ds_read_b64_tr_b16 a[154:155], v14 offset:33280
v_mfma_f32_16x16x32_bf16 v[160:163], a[112:115], a[88:91], v[160:163]
ds_read_b64_tr_b16 a[156:157], v14 offset:36864
ds_read_b64_tr_b16 a[158:159], v14 offset:37376
v_mfma_f32_16x16x32_bf16 v[228:231], a[184:187], a[88:91], v[228:231]
s_add_u32 m0, s83, 0
s_add_u32 s64, s81, 0
v_mfma_f32_16x16x32_bf16 v[228:231], a[188:191], a[92:95], v[228:231]
v_mfma_f32_16x16x32_bf16 v[168:171], a[180:183], a[92:95], v[168:171]
buffer_load_dwordx4 v22, s[32:35], s64 offen lds
v_mfma_f32_16x16x32_bf16 v[168:171], a[176:179], a[88:91], v[168:171]
ds_read_b128 a[64:67], v4 offset:40960
v_mfma_f32_16x16x32_bf16 v[176:179], a[168:171], a[88:91], v[176:179]
s_add_u32 m0, s83, 1024
s_add_u32 s64, s81, 9216
ds_read_b128 a[80:83], v9 offset:0
v_mfma_f32_16x16x32_bf16 v[176:179], a[172:175], a[92:95], v[176:179]
v_mfma_f32_16x16x32_bf16 v[80:83], a[164:167], a[92:95], v[80:83]
buffer_load_dwordx4 v22, s[32:35], s64 offen lds
v_mfma_f32_16x16x32_bf16 v[80:83], a[160:163], a[88:91], v[80:83]
ds_read_b128 a[68:71], v4 offset:43008
v_mfma_f32_16x16x32_bf16 v[184:187], a[160:163], a[96:99], v[184:187]
ds_read_b128 a[84:87], v10 offset:0
v_mfma_f32_16x16x32_bf16 v[184:187], a[164:167], a[100:103], v[184:187]
s_add_u32 m0, s83, 2048
s_add_u32 s64, s81, 18432
v_mfma_f32_16x16x32_bf16 v[248:251], a[172:175], a[100:103], v[248:251]
v_mfma_f32_16x16x32_bf16 v[248:251], a[168:171], a[96:99], v[248:251]
buffer_load_dwordx4 v22, s[32:35], s64 offen lds
v_mfma_f32_16x16x32_bf16 v[240:243], a[176:179], a[96:99], v[240:243]
ds_read_b128 a[72:75], v4 offset:41984
v_mfma_f32_16x16x32_bf16 v[240:243], a[180:183], a[100:103], v[240:243]
ds_read_b128 a[88:91], v9 offset:2048
v_mfma_f32_16x16x32_bf16 v[232:235], a[188:191], a[100:103], v[232:235]
s_add_u32 m0, s83, 3072
s_add_u32 s64, s81, 27648
v_mfma_f32_16x16x32_bf16 v[232:235], a[184:187], a[96:99], v[232:235]
ds_read_b128 a[76:79], v4 offset:44032
v_mfma_f32_16x16x32_bf16 v[236:239], a[112:115], a[96:99], v[236:239]
buffer_load_dwordx4 v22, s[32:35], s64 offen lds
v_mfma_f32_16x16x32_bf16 v[236:239], a[116:119], a[100:103], v[236:239]
ds_read_b128 a[92:95], v10 offset:2048
v_mfma_f32_16x16x32_bf16 v[224:227], a[124:127], a[100:103], v[224:227]
s_add_u32 m0, s83, 4096
s_add_u32 s64, s81, 128
s_add_u32 s53, s87, 786432
v_mfma_f32_16x16x32_bf16 v[224:227], a[120:123], a[96:99], v[224:227]
buffer_store_dwordx4 a[0:3], v15, s[24:27], s53 offen offset:0 sc1
v_mfma_f32_16x16x32_bf16 v[208:211], a[120:123], a[104:107], v[208:211]
buffer_load_dwordx4 v24, s[32:35], s64 offen lds
v_mfma_f32_16x16x32_bf16 v[208:211], a[124:127], a[108:111], v[208:211]
s_waitcnt vmcnt(26)
v_mfma_f32_16x16x32_bf16 v[216:219], a[116:119], a[108:111], v[216:219]
v_cmp_gt_u32 vcc, 8, v30
v_mfma_f32_16x16x32_bf16 v[216:219], a[112:115], a[104:107], v[216:219]
s_add_u32 m0, s83, 5120
s_add_u32 s64, s82, 0
v_mfma_f32_16x16x32_bf16 v[244:247], a[184:187], a[104:107], v[244:247]
v_mfma_f32_16x16x32_bf16 v[244:247], a[188:191], a[108:111], v[244:247]
buffer_load_dwordx4 v25, s[48:51], s64 offen lds
v_mfma_f32_16x16x32_bf16 v[192:195], a[180:183], a[108:111], v[192:195]
v_mfma_f32_16x16x32_bf16 v[192:195], a[176:179], a[104:107], v[192:195]
s_cbranch_vccnz CK_KV
CK_KV_R:
v_mfma_f32_16x16x32_bf16 v[200:203], a[168:171], a[104:107], v[200:203]
v_mfma_f32_16x16x32_bf16 v[200:203], a[172:175], a[108:111], v[200:203]
v_mfma_f32_16x16x32_bf16 v[88:91], a[164:167], a[108:111], v[88:91]
v_mfma_f32_16x16x32_bf16 v[88:91], a[160:163], a[104:107], v[88:91]
s_waitcnt lgkmcnt(0)
v_mfma_f32_16x16x32_bf16 v[36:39], a[128:131], a[80:83], v[36:39]
s_waitcnt vmcnt(25)
v_mov_b32 v6, 0xf149f2ca
v_mfma_f32_16x16x32_bf16 v[36:39], a[132:135], a[84:87], v[36:39]
s_barrier
v_mfma_f32_16x16x32_bf16 v[44:47], a[140:143], a[84:87], v[44:47]
ds_read_b128 a[96:99], v9 offset:4096
v_mfma_f32_16x16x32_bf16 v[44:47], a[136:139], a[80:83], v[44:47]
s_lshl_b32 s70, s3, 12
s_add_u32 s68, s70, s94
ds_read_b128 a[100:103], v10 offset:4096
v_mfma_f32_16x16x32_bf16 v[32:35], a[144:147], a[80:83], v[32:35]
s_add_u32 m0, s70, 32768
s_cmp_lt_u32 s3, 2
s_cselect_b32 s64, s68, 2147418112
v_mfma_f32_16x16x32_bf16 v[32:35], a[148:151], a[84:87], v[32:35]
buffer_load_dwordx4 v15, s[24:27], s64 offen offset:0 sc1 lds
v_mfma_f32_16x16x32_bf16 v[52:55], a[156:159], a[84:87], v[52:55]
ds_read_b128 a[104:107], v9 offset:6144
v_mfma_f32_16x16x32_bf16 v[52:55], a[152:155], a[80:83], v[52:55]
ds_read_b64_tr_b16 a[160:161], v11 offset:49152
ds_read_b64_tr_b16 a[162:163], v11 offset:49664
v_mfma_f32_16x16x32_bf16 v[60:63], a[64:67], a[80:83], v[60:63]
s_cmp_eq_u32 s66, 0
s_cbranch_scc1 D0
D0_R:
v_mfma_f32_16x16x32_bf16 v[60:63], a[68:71], a[84:87], v[60:63]
s_lshl_b32 s52, s4, 18
s_add_u32 s52, s52, 45088768
ds_read_b128 a[108:111], v10 offset:6144
v_mfma_f32_16x16x32_bf16 v[68:71], a[76:79], a[84:87], v[68:71]
s_lshl_b32 s54, s66, 9
v_add_u32 v9, 32768, v9
v_add_u32 v10, 32768, v10
v_mfma_f32_16x16x32_bf16 v[68:71], a[72:75], a[80:83], v[68:71]
s_add_u32 s54, s54, s52
ds_read_b64_tr_b16 a[164:165], v11 offset:53248
ds_read_b64_tr_b16 a[166:167], v11 offset:53760
v_mfma_f32_16x16x32_bf16 v[76:79], a[72:75], a[88:91], v[76:79]
s_lshl_b32 s55, s67, 9
s_add_u32 s55, s55, s52
v_mfma_f32_16x16x32_bf16 v[76:79], a[76:79], a[92:95], v[76:79]
s_add_u32 s53, s87, 786432
ds_read_b64_tr_b16 a[168:169], v12 offset:49152
ds_read_b64_tr_b16 a[170:171], v12 offset:49664
v_mfma_f32_16x16x32_bf16 v[84:87], a[68:71], a[92:95], v[84:87]
buffer_load_dwordx4 v15, s[24:27], s64 offen offset:1024 sc1 lds
v_mfma_f32_16x16x32_bf16 v[84:87], a[64:67], a[88:91], v[84:87]
s_max_u32 s65, s66, 1
ds_read_b64_tr_b16 a[172:173], v12 offset:53248
ds_read_b64_tr_b16 a[174:175], v12 offset:53760
L_PAD7:
s_cbranch_execz L_PAD11
v_mfma_f32_16x16x32_bf16 v[92:95], a[152:155], a[88:91], v[92:95]
buffer_store_dwordx4 a[8:11], v15, s[24:27], s53 offen offset:1024 sc1
v_mfma_f32_16x16x32_bf16 v[92:95], a[156:159], a[92:95], v[92:95]
s_lshl_b32 s65, s65, 9
s_add_u32 s52, s52, s65
s_sub_u32 s65, s55, s52
v_mfma_f32_16x16x32_bf16 v[40:43], a[148:151], a[92:95], v[40:43]
s_sub_u32 s65, s65, 163840
ds_read_b64_tr_b16 a[176:177], v13 offset:49152
ds_read_b64_tr_b16 a[178:179], v13 offset:49664
v_mfma_f32_16x16x32_bf16 v[40:43], a[144:147], a[88:91], v[40:43]
s_add_u32 s52, s52, 65280
v_mfma_f32_16x16x32_bf16 v[100:103], a[136:139], a[88:91], v[100:103]
ds_read_b64_tr_b16 a[180:181], v13 offset:53248
ds_read_b64_tr_b16 a[182:183], v13 offset:53760
v_mfma_f32_16x16x32_bf16 v[100:103], a[140:143], a[92:95], v[100:103]
v_cmp_lt_u32 s[96:97], 0, v3
v_lshlrev_b32 v16, 15, v3
v_mfma_f32_16x16x32_bf16 v[108:111], a[132:135], a[92:95], v[108:111]
ds_read_b64_tr_b16 a[184:185], v14 offset:49152
ds_read_b64_tr_b16 a[186:187], v14 offset:49664
v_mfma_f32_16x16x32_bf16 v[108:111], a[128:131], a[88:91], v[108:111]
s_waitcnt lgkmcnt(15)
v_lshl_add_u32 v16, v2, 4, v16
v_add_u32 v16, s52, v16
v_mfma_f32_16x16x32_bf16 v[116:119], a[128:131], a[96:99], v[116:119]
ds_read_b64_tr_b16 a[188:189], v14 offset:53248
ds_read_b64_tr_b16 a[190:191], v14 offset:53760
v_mfma_f32_16x16x32_bf16 v[116:119], a[132:135], a[100:103], v[116:119]
buffer_load_dwordx4 v15, s[24:27], s64 offen offset:2048 sc1 lds
v_mfma_f32_16x16x32_bf16 v[124:127], a[140:143], a[100:103], v[124:127]
v_accvgpr_write_b32 a244, v16
v_add_u32 v16, 131072, v16
v_mfma_f32_16x16x32_bf16 v[124:127], a[136:139], a[96:99], v[124:127]
ds_read_b128 a[112:115], v4 offset:57344
v_add_u32 v21, s65, v16
v_mfma_f32_16x16x32_bf16 v[132:135], a[144:147], a[96:99], v[132:135]
v_cndmask_b32 v16, v16, v21, s[96:97]
v_accvgpr_write_b32 a248, v16
v_mfma_f32_16x16x32_bf16 v[132:135], a[148:151], a[100:103], v[132:135]
ds_read_b128 a[116:119], v4 offset:59392
v_cmp_lt_u32 s[96:97], 1, v3
v_mfma_f32_16x16x32_bf16 v[140:143], a[156:159], a[100:103], v[140:143]
v_add_u32 v21, 131072, v21
v_mfma_f32_16x16x32_bf16 v[140:143], a[152:155], a[96:99], v[140:143]
ds_read_b128 a[120:123], v4 offset:58368
v_cndmask_b32 v21, v21, v20, s[96:97]
v_mfma_f32_16x16x32_bf16 v[148:151], a[64:67], a[96:99], v[148:151]
v_accvgpr_write_b32 a252, v21
v_mfma_f32_16x16x32_bf16 v[148:151], a[68:71], a[100:103], v[148:151]
ds_read_b128 a[124:127], v4 offset:60416
v_mfma_f32_16x16x32_bf16 v[48:51], a[76:79], a[100:103], v[48:51]
s_waitcnt lgkmcnt(15)
v_mfma_f32_16x16x32_bf16 v[48:51], a[72:75], a[96:99], v[48:51]
buffer_load_dwordx4 v15, s[24:27], s64 offen offset:3072 sc1 lds
v_mfma_f32_16x16x32_bf16 v[156:159], a[72:75], a[104:107], v[156:159]
v_mfma_f32_16x16x32_bf16 v[156:159], a[76:79], a[108:111], v[156:159]
v_mfma_f32_16x16x32_bf16 v[164:167], a[68:71], a[108:111], v[164:167]
v_mfma_f32_16x16x32_bf16 v[164:167], a[64:67], a[104:107], v[164:167]
v_mfma_f32_16x16x32_bf16 v[172:175], a[152:155], a[104:107], v[172:175]
s_add_u32 s53, s87, 790528
v_mfma_f32_16x16x32_bf16 v[172:175], a[156:159], a[108:111], v[172:175]
buffer_store_dwordx4 a[16:19], v15, s[24:27], s53 offen offset:0 sc1
v_mfma_f32_16x16x32_bf16 v[56:59], a[148:151], a[108:111], v[56:59]
v_mfma_f32_16x16x32_bf16 v[56:59], a[144:147], a[104:107], v[56:59]
v_mfma_f32_16x16x32_bf16 v[180:183], a[136:139], a[104:107], v[180:183]
v_mfma_f32_16x16x32_bf16 v[180:183], a[140:143], a[108:111], v[180:183]
v_mfma_f32_16x16x32_bf16 v[188:191], a[132:135], a[108:111], v[188:191]
v_mfma_f32_16x16x32_bf16 v[188:191], a[128:131], a[104:107], v[188:191]
s_waitcnt lgkmcnt(0)
v_mfma_f32_16x16x32_bf16 v[196:199], a[160:163], a[80:83], v[196:199]
s_waitcnt vmcnt(17)
v_mfma_f32_16x16x32_bf16 v[196:199], a[164:167], a[84:87], v[196:199]
s_barrier
v_mfma_f32_16x16x32_bf16 v[64:67], a[172:175], a[84:87], v[64:67]
ds_read_b64_tr_b16 a[128:129], v11 offset:0
ds_read_b64_tr_b16 a[130:131], v11 offset:512
v_mfma_f32_16x16x32_bf16 v[64:67], a[168:171], a[80:83], v[64:67]
s_add_u32 m0, s70, 49152
s_add_u32 s64, s68, 16384
s_waitcnt vmcnt(6)
v_mfma_f32_16x16x32_bf16 v[204:207], a[176:179], a[80:83], v[204:207]
buffer_load_dwordx4 v15, s[24:27], s64 offen offset:0 sc1 lds
v_mfma_f32_16x16x32_bf16 v[204:207], a[180:183], a[84:87], v[204:207]
ds_read_b64_tr_b16 a[132:133], v11 offset:4096
ds_read_b64_tr_b16 a[134:135], v11 offset:4608
v_mfma_f32_16x16x32_bf16 v[212:215], a[188:191], a[84:87], v[212:215]
ds_read_b64_tr_b16 a[136:137], v12 offset:0
ds_read_b64_tr_b16 a[138:139], v12 offset:512
v_mfma_f32_16x16x32_bf16 v[212:215], a[184:187], a[80:83], v[212:215]
ds_read_b64_tr_b16 a[140:141], v12 offset:4096
ds_read_b64_tr_b16 a[142:143], v12 offset:4608
v_mfma_f32_16x16x32_bf16 v[72:75], a[112:115], a[80:83], v[72:75]
ds_read_b64_tr_b16 a[192:193], v23 offset:0
ds_read_b64_tr_b16 a[194:195], v23 offset:2048
v_mfma_f32_16x16x32_bf16 v[72:75], a[116:119], a[84:87], v[72:75]
ds_read_b64_tr_b16 a[144:145], v13 offset:0
ds_read_b64_tr_b16 a[146:147], v13 offset:512
v_mfma_f32_16x16x32_bf16 v[220:223], a[124:127], a[84:87], v[220:223]
ds_read_b64_tr_b16 a[196:197], v23 offset:32
ds_read_b64_tr_b16 a[198:199], v23 offset:2080
v_mfma_f32_16x16x32_bf16 v[220:223], a[120:123], a[80:83], v[220:223]
ds_read_b64_tr_b16 a[148:149], v13 offset:4096
ds_read_b64_tr_b16 a[150:151], v13 offset:4608
v_mfma_f32_16x16x32_bf16 v[252:255], a[120:123], a[88:91], v[252:255]
ds_read_b64_tr_b16 a[200:201], v23 offset:64
ds_read_b64_tr_b16 a[202:203], v23 offset:2112
v_mfma_f32_16x16x32_bf16 v[252:255], a[124:127], a[92:95], v[252:255]
ds_read_b64_tr_b16 a[152:153], v14 offset:0
ds_read_b64_tr_b16 a[154:155], v14 offset:512
v_mfma_f32_16x16x32_bf16 v[160:163], a[116:119], a[92:95], v[160:163]
buffer_load_dwordx4 v15, s[24:27], s64 offen offset:1024 sc1 lds
v_mfma_f32_16x16x32_bf16 v[160:163], a[112:115], a[88:91], v[160:163]
ds_read_b64_tr_b16 a[156:157], v14 offset:4096
ds_read_b64_tr_b16 a[158:159], v14 offset:4608
v_mfma_f32_16x16x32_bf16 v[228:231], a[184:187], a[88:91], v[228:231]
ds_read_b64_tr_b16 a[204:205], v23 offset:96
ds_read_b64_tr_b16 a[206:207], v23 offset:2144
v_mfma_f32_16x16x32_bf16 v[228:231], a[188:191], a[92:95], v[228:231]
ds_read_b64_tr_b16 a[208:209], v27 offset:4096
ds_read_b64_tr_b16 a[210:211], v27 offset:4608
v_mfma_f32_16x16x32_bf16 v[168:171], a[180:183], a[92:95], v[168:171]
ds_read_b128 a[64:67], v4 offset:8192
v_mfma_f32_16x16x32_bf16 v[168:171], a[176:179], a[88:91], v[168:171]
s_add_u32 s53, s87, 790528
ds_read_b64_tr_b16 a[212:213], v27 offset:5120
ds_read_b64_tr_b16 a[214:215], v27 offset:5632
v_mfma_f32_16x16x32_bf16 v[176:179], a[168:171], a[88:91], v[176:179]
ds_read_b128 a[80:83], v9 offset:0
v_readlane_b32 s81, v26, 0
v_mfma_f32_16x16x32_bf16 v[176:179], a[172:175], a[92:95], v[176:179]
buffer_store_dwordx4 a[24:27], v15, s[24:27], s53 offen offset:1024 sc1
v_mfma_f32_16x16x32_bf16 v[80:83], a[164:167], a[92:95], v[80:83]
ds_read_b128 a[68:71], v4 offset:10240
v_readlane_b32 s82, v26, 1
v_mfma_f32_16x16x32_bf16 v[80:83], a[160:163], a[88:91], v[80:83]
v_readlane_b32 s71, v26, 2
v_readlane_b32 s72, v26, 3
v_mfma_f32_16x16x32_bf16 v[184:187], a[160:163], a[96:99], v[184:187]
ds_read_b128 a[84:87], v10 offset:0
v_readlane_b32 s74, v26, 4
v_mfma_f32_16x16x32_bf16 v[184:187], a[164:167], a[100:103], v[184:187]
buffer_load_dwordx4 v15, s[24:27], s64 offen offset:2048 sc1 lds
v_mfma_f32_16x16x32_bf16 v[248:251], a[172:175], a[100:103], v[248:251]
v_readlane_b32 s75, v26, 5
v_mfma_f32_16x16x32_bf16 v[248:251], a[168:171], a[96:99], v[248:251]
ds_read_b128 a[72:75], v4 offset:9216
v_mfma_f32_16x16x32_bf16 v[240:243], a[176:179], a[96:99], v[240:243]
v_mfma_f32_16x16x32_bf16 v[240:243], a[180:183], a[100:103], v[240:243]
ds_read_b128 a[88:91], v9 offset:2048
v_mfma_f32_16x16x32_bf16 v[232:235], a[188:191], a[100:103], v[232:235]
v_mfma_f32_16x16x32_bf16 v[232:235], a[184:187], a[96:99], v[232:235]
ds_read_b128 a[76:79], v4 offset:11264
v_mfma_f32_16x16x32_bf16 v[236:239], a[112:115], a[96:99], v[236:239]
v_mfma_f32_16x16x32_bf16 v[236:239], a[116:119], a[100:103], v[236:239]
ds_read_b128 a[92:95], v10 offset:2048
v_mfma_f32_16x16x32_bf16 v[224:227], a[124:127], a[100:103], v[224:227]
v_mfma_f32_16x16x32_bf16 v[224:227], a[120:123], a[96:99], v[224:227]
buffer_load_dwordx4 v15, s[24:27], s64 offen offset:3072 sc1 lds
v_mfma_f32_16x16x32_bf16 v[208:211], a[120:123], a[104:107], v[208:211]
v_mfma_f32_16x16x32_bf16 v[208:211], a[124:127], a[108:111], v[208:211]
v_mfma_f32_16x16x32_bf16 v[216:219], a[116:119], a[108:111], v[216:219]
v_mfma_f32_16x16x32_bf16 v[216:219], a[112:115], a[104:107], v[216:219]
v_mfma_f32_16x16x32_bf16 v[244:247], a[184:187], a[104:107], v[244:247]
v_mfma_f32_16x16x32_bf16 v[244:247], a[188:191], a[108:111], v[244:247]
v_mfma_f32_16x16x32_bf16 v[192:195], a[180:183], a[108:111], v[192:195]
v_mfma_f32_16x16x32_bf16 v[192:195], a[176:179], a[104:107], v[192:195]
v_mfma_f32_16x16x32_bf16 v[200:203], a[168:171], a[104:107], v[200:203]
v_mfma_f32_16x16x32_bf16 v[200:203], a[172:175], a[108:111], v[200:203]
v_mfma_f32_16x16x32_bf16 v[88:91], a[164:167], a[108:111], v[88:91]
v_mfma_f32_16x16x32_bf16 v[88:91], a[160:163], a[104:107], v[88:91]
s_waitcnt lgkmcnt(0)
v_mfma_f32_16x16x32_bf16 v[36:39], a[128:131], a[80:83], v[36:39]
s_waitcnt vmcnt(18)
v_mfma_f32_16x16x32_bf16 v[36:39], a[132:135], a[84:87], v[36:39]
s_barrier
v_mfma_f32_16x16x32_bf16 v[44:47], a[140:143], a[84:87], v[44:47]
ds_read_b128 a[96:99], v9 offset:4096
v_mfma_f32_16x16x32_bf16 v[44:47], a[136:139], a[80:83], v[44:47]
s_add_u32 m0, s70, 65536
s_add_u32 s64, s68, 32768
ds_read_b128 a[100:103], v10 offset:4096
v_mfma_f32_16x16x32_bf16 v[32:35], a[144:147], a[80:83], v[32:35]
buffer_load_dwordx4 v15, s[24:27], s64 offen offset:0 sc1 lds
v_mfma_f32_16x16x32_bf16 v[32:35], a[148:151], a[84:87], v[32:35]
ds_read_b128 a[104:107], v9 offset:6144
v_mfma_f32_16x16x32_bf16 v[52:55], a[156:159], a[84:87], v[52:55]
ds_read_b64_tr_b16 a[160:161], v11 offset:16384
ds_read_b64_tr_b16 a[162:163], v11 offset:16896
v_mfma_f32_16x16x32_bf16 v[52:55], a[152:155], a[80:83], v[52:55]
buffer_store_dwordx4 a[192:195], v15, s[24:27], s81 offen sc1
v_mfma_f32_16x16x32_bf16 v[60:63], a[64:67], a[80:83], v[60:63]
v_mfma_f32_16x16x32_bf16 v[60:63], a[68:71], a[84:87], v[60:63]
ds_read_b128 a[108:111], v10 offset:6144
v_mfma_f32_16x16x32_bf16 v[68:71], a[76:79], a[84:87], v[68:71]
v_cvt_pk_bf16_f32 v36, v36, v37
v_cvt_pk_bf16_f32 v37, v38, v39
v_mfma_f32_16x16x32_bf16 v[68:71], a[72:75], a[80:83], v[68:71]
ds_read_b64_tr_b16 a[164:165], v11 offset:20480
ds_read_b64_tr_b16 a[166:167], v11 offset:20992
v_mfma_f32_16x16x32_bf16 v[76:79], a[72:75], a[88:91], v[76:79]
buffer_store_dwordx4 a[196:199], v15, s[24:27], s82 offen sc1
v_mfma_f32_16x16x32_bf16 v[76:79], a[76:79], a[92:95], v[76:79]
ds_read_b64_tr_b16 a[168:169], v12 offset:16384
ds_read_b64_tr_b16 a[170:171], v12 offset:16896
v_mfma_f32_16x16x32_bf16 v[84:87], a[68:71], a[92:95], v[84:87]
buffer_load_dwordx4 v15, s[24:27], s64 offen offset:1024 sc1 lds
v_mfma_f32_16x16x32_bf16 v[84:87], a[64:67], a[88:91], v[84:87]
ds_read_b64_tr_b16 a[172:173], v12 offset:20480
ds_read_b64_tr_b16 a[174:175], v12 offset:20992
v_mfma_f32_16x16x32_bf16 v[92:95], a[152:155], a[88:91], v[92:95]
v_cvt_pk_bf16_f32 v38, v44, v45
v_cvt_pk_bf16_f32 v39, v46, v47
v_mfma_f32_16x16x32_bf16 v[92:95], a[156:159], a[92:95], v[92:95]
buffer_store_dwordx4 a[200:203], v15, s[24:27], s71 offen sc1
v_mfma_f32_16x16x32_bf16 v[40:43], a[148:151], a[92:95], v[40:43]
ds_read_b64_tr_b16 a[176:177], v13 offset:16384
ds_read_b64_tr_b16 a[178:179], v13 offset:16896
v_mfma_f32_16x16x32_bf16 v[40:43], a[144:147], a[88:91], v[40:43]
v_accvgpr_write_b32 a32, v36
v_accvgpr_write_b32 a33, v37
v_mfma_f32_16x16x32_bf16 v[100:103], a[136:139], a[88:91], v[100:103]
ds_read_b64_tr_b16 a[180:181], v13 offset:20480
ds_read_b64_tr_b16 a[182:183], v13 offset:20992
v_mfma_f32_16x16x32_bf16 v[100:103], a[140:143], a[92:95], v[100:103]
v_accvgpr_write_b32 a34, v38
v_accvgpr_write_b32 a35, v39
v_mfma_f32_16x16x32_bf16 v[108:111], a[132:135], a[92:95], v[108:111]
ds_read_b64_tr_b16 a[184:185], v14 offset:16384
ds_read_b64_tr_b16 a[186:187], v14 offset:16896
v_mfma_f32_16x16x32_bf16 v[108:111], a[128:131], a[88:91], v[108:111]
s_waitcnt lgkmcnt(15)
v_cvt_pk_bf16_f32 v32, v32, v33
v_cvt_pk_bf16_f32 v33, v34, v35
v_mfma_f32_16x16x32_bf16 v[116:119], a[128:131], a[96:99], v[116:119]
ds_read_b64_tr_b16 a[188:189], v14 offset:20480
ds_read_b64_tr_b16 a[190:191], v14 offset:20992
v_mfma_f32_16x16x32_bf16 v[116:119], a[132:135], a[100:103], v[116:119]
buffer_load_dwordx4 v15, s[24:27], s64 offen offset:2048 sc1 lds
v_mfma_f32_16x16x32_bf16 v[124:127], a[140:143], a[100:103], v[124:127]
buffer_store_dwordx4 a[204:207], v15, s[24:27], s72 offen sc1
v_mfma_f32_16x16x32_bf16 v[124:127], a[136:139], a[96:99], v[124:127]
ds_read_b128 a[112:115], v4 offset:24576
v_cvt_pk_bf16_f32 v34, v52, v53
v_mfma_f32_16x16x32_bf16 v[132:135], a[144:147], a[96:99], v[132:135]
v_cvt_pk_bf16_f32 v35, v54, v55
v_accvgpr_write_b32 a36, v32
v_mfma_f32_16x16x32_bf16 v[132:135], a[148:151], a[100:103], v[132:135]
ds_read_b128 a[116:119], v4 offset:26624
v_accvgpr_write_b32 a37, v33
v_mfma_f32_16x16x32_bf16 v[140:143], a[156:159], a[100:103], v[140:143]
v_accvgpr_write_b32 a38, v34
v_accvgpr_write_b32 a39, v35
v_mfma_f32_16x16x32_bf16 v[140:143], a[152:155], a[96:99], v[140:143]
ds_read_b128 a[120:123], v4 offset:25600
v_cvt_pk_bf16_f32 v40, v40, v41
v_mfma_f32_16x16x32_bf16 v[148:151], a[64:67], a[96:99], v[148:151]
buffer_store_dwordx4 a[208:211], v15, s[24:27], s74 offen sc1
v_mfma_f32_16x16x32_bf16 v[148:151], a[68:71], a[100:103], v[148:151]
ds_read_b128 a[124:127], v4 offset:27648
v_cvt_pk_bf16_f32 v41, v42, v43
v_mfma_f32_16x16x32_bf16 v[48:51], a[76:79], a[100:103], v[48:51]
s_waitcnt lgkmcnt(15)
v_cvt_pk_bf16_f32 v42, v92, v93
v_cvt_pk_bf16_f32 v43, v94, v95
v_mfma_f32_16x16x32_bf16 v[48:51], a[72:75], a[96:99], v[48:51]
buffer_load_dwordx4 v15, s[24:27], s64 offen offset:3072 sc1 lds
v_mfma_f32_16x16x32_bf16 v[156:159], a[72:75], a[104:107], v[156:159]
v_accvgpr_write_b32 a40, v40
v_accvgpr_write_b32 a41, v41
v_mfma_f32_16x16x32_bf16 v[156:159], a[76:79], a[108:111], v[156:159]
buffer_store_dwordx4 a[212:215], v15, s[24:27], s75 offen sc1
v_mfma_f32_16x16x32_bf16 v[164:167], a[68:71], a[108:111], v[164:167]
v_accvgpr_write_b32 a42, v42
v_accvgpr_write_b32 a43, v43
v_mfma_f32_16x16x32_bf16 v[164:167], a[64:67], a[104:107], v[164:167]
v_cvt_pk_bf16_f32 v108, v108, v109
v_cvt_pk_bf16_f32 v109, v110, v111
v_mfma_f32_16x16x32_bf16 v[172:175], a[152:155], a[104:107], v[172:175]
v_cvt_pk_bf16_f32 v110, v100, v101
v_cvt_pk_bf16_f32 v111, v102, v103
v_mfma_f32_16x16x32_bf16 v[172:175], a[156:159], a[108:111], v[172:175]
v_accvgpr_write_b32 a44, v108
v_accvgpr_write_b32 a45, v109
v_mfma_f32_16x16x32_bf16 v[56:59], a[148:151], a[108:111], v[56:59]
v_accvgpr_write_b32 a46, v110
v_accvgpr_write_b32 a47, v111
v_mfma_f32_16x16x32_bf16 v[56:59], a[144:147], a[104:107], v[56:59]
v_cvt_pk_bf16_f32 v116, v116, v117
v_cvt_pk_bf16_f32 v117, v118, v119
v_mfma_f32_16x16x32_bf16 v[180:183], a[136:139], a[104:107], v[180:183]
v_cvt_pk_bf16_f32 v118, v124, v125
v_cvt_pk_bf16_f32 v119, v126, v127
v_mfma_f32_16x16x32_bf16 v[180:183], a[140:143], a[108:111], v[180:183]
v_accvgpr_write_b32 a48, v116
v_accvgpr_write_b32 a49, v117
v_mfma_f32_16x16x32_bf16 v[188:191], a[132:135], a[108:111], v[188:191]
v_accvgpr_write_b32 a50, v118
v_accvgpr_write_b32 a51, v119
v_mfma_f32_16x16x32_bf16 v[188:191], a[128:131], a[104:107], v[188:191]
s_waitcnt lgkmcnt(0)
v_cvt_pk_bf16_f32 v132, v132, v133
v_cvt_pk_bf16_f32 v133, v134, v135
v_mfma_f32_16x16x32_bf16 v[196:199], a[160:163], a[80:83], v[196:199]
s_waitcnt vmcnt(16)
v_cvt_pk_bf16_f32 v134, v140, v141
v_cvt_pk_bf16_f32 v135, v142, v143
v_mfma_f32_16x16x32_bf16 v[196:199], a[164:167], a[84:87], v[196:199]
s_barrier
v_mfma_f32_16x16x32_bf16 v[64:67], a[172:175], a[84:87], v[64:67]
ds_read_b128 a[192:195], v4 offset:32768
v_accvgpr_write_b32 a52, v132
v_mfma_f32_16x16x32_bf16 v[64:67], a[168:171], a[80:83], v[64:67]
s_add_u32 m0, s70, 81920
s_add_u32 s64, s68, 49152
v_accvgpr_write_b32 a53, v133
v_mfma_f32_16x16x32_bf16 v[204:207], a[176:179], a[80:83], v[204:207]
buffer_load_dwordx4 v15, s[24:27], s64 offen offset:0 sc1 lds
v_mfma_f32_16x16x32_bf16 v[204:207], a[180:183], a[84:87], v[204:207]
ds_read_b128 a[196:199], v4 offset:33792
v_accvgpr_write_b32 a54, v134
v_mfma_f32_16x16x32_bf16 v[212:215], a[188:191], a[84:87], v[212:215]
v_accvgpr_write_b32 a55, v135
v_cvt_pk_bf16_f32 v56, v56, v57
v_mfma_f32_16x16x32_bf16 v[212:215], a[184:187], a[80:83], v[212:215]
ds_read_b128 a[200:203], v4 offset:34816
v_cvt_pk_bf16_f32 v57, v58, v59
v_mfma_f32_16x16x32_bf16 v[80:83], a[160:163], a[88:91], v[80:83]
v_cvt_pk_bf16_f32 v58, v172, v173
v_cvt_pk_bf16_f32 v59, v174, v175
v_mfma_f32_16x16x32_bf16 v[80:83], a[164:167], a[92:95], v[80:83]
ds_read_b128 a[204:207], v4 offset:35840
v_accvgpr_write_b32 a56, v56
v_mfma_f32_16x16x32_bf16 v[176:179], a[172:175], a[92:95], v[176:179]
v_accvgpr_write_b32 a57, v57
v_accvgpr_write_b32 a58, v58
v_mfma_f32_16x16x32_bf16 v[176:179], a[168:171], a[88:91], v[176:179]
ds_read_b128 a[208:211], v4 offset:36864
v_accvgpr_write_b32 a59, v59
v_mfma_f32_16x16x32_bf16 v[168:171], a[176:179], a[88:91], v[168:171]
v_cvt_pk_bf16_f32 v188, v188, v189
v_cvt_pk_bf16_f32 v189, v190, v191
v_mfma_f32_16x16x32_bf16 v[168:171], a[180:183], a[92:95], v[168:171]
ds_read_b128 a[212:215], v4 offset:37888
v_cvt_pk_bf16_f32 v190, v180, v181
v_mfma_f32_16x16x32_bf16 v[228:231], a[188:191], a[92:95], v[228:231]
buffer_load_dwordx4 v15, s[24:27], s64 offen offset:1024 sc1 lds
v_mfma_f32_16x16x32_bf16 v[228:231], a[184:187], a[88:91], v[228:231]
ds_read_b128 a[216:219], v4 offset:38912
v_cvt_pk_bf16_f32 v191, v182, v183
v_mfma_f32_16x16x32_bf16 v[184:187], a[160:163], a[96:99], v[184:187]
v_accvgpr_write_b32 a60, v188
v_accvgpr_write_b32 a61, v189
v_mfma_f32_16x16x32_bf16 v[184:187], a[164:167], a[100:103], v[184:187]
ds_read_b128 a[220:223], v4 offset:39936
v_accvgpr_write_b32 a62, v190
v_mfma_f32_16x16x32_bf16 v[248:251], a[172:175], a[100:103], v[248:251]
v_accvgpr_write_b32 a63, v191
v_cvt_pk_bf16_f32 v196, v196, v197
v_mfma_f32_16x16x32_bf16 v[248:251], a[168:171], a[96:99], v[248:251]
v_cvt_pk_bf16_f32 v197, v198, v199
v_cvt_pk_bf16_f32 v198, v64, v65
v_mfma_f32_16x16x32_bf16 v[240:243], a[176:179], a[96:99], v[240:243]
v_cvt_pk_bf16_f32 v199, v66, v67
v_accvgpr_write_b32 a28, v196
v_mfma_f32_16x16x32_bf16 v[240:243], a[180:183], a[100:103], v[240:243]
v_accvgpr_write_b32 a29, v197
v_accvgpr_write_b32 a30, v198
v_mfma_f32_16x16x32_bf16 v[232:235], a[188:191], a[100:103], v[232:235]
v_accvgpr_write_b32 a31, v199
v_cvt_pk_bf16_f32 v204, v204, v205
v_mfma_f32_16x16x32_bf16 v[232:235], a[184:187], a[96:99], v[232:235]
v_cvt_pk_bf16_f32 v205, v206, v207
v_cvt_pk_bf16_f32 v206, v212, v213
v_mfma_f32_16x16x32_bf16 v[88:91], a[160:163], a[104:107], v[88:91]
v_cvt_pk_bf16_f32 v207, v214, v215
v_accvgpr_write_b32 a20, v204
v_mfma_f32_16x16x32_bf16 v[88:91], a[164:167], a[108:111], v[88:91]
buffer_load_dwordx4 v15, s[24:27], s64 offen offset:2048 sc1 lds
v_mfma_f32_16x16x32_bf16 v[200:203], a[172:175], a[108:111], v[200:203]
v_accvgpr_write_b32 a21, v205
v_accvgpr_write_b32 a22, v206
v_mfma_f32_16x16x32_bf16 v[200:203], a[168:171], a[104:107], v[200:203]
v_accvgpr_write_b32 a23, v207
v_cvt_pk_bf16_f32 v80, v80, v81
v_mfma_f32_16x16x32_bf16 v[192:195], a[176:179], a[104:107], v[192:195]
v_cvt_pk_bf16_f32 v81, v82, v83
v_cvt_pk_bf16_f32 v82, v176, v177
v_mfma_f32_16x16x32_bf16 v[192:195], a[180:183], a[108:111], v[192:195]
v_cvt_pk_bf16_f32 v83, v178, v179
v_accvgpr_write_b32 a12, v80
v_mfma_f32_16x16x32_bf16 v[244:247], a[188:191], a[108:111], v[244:247]
v_accvgpr_write_b32 a13, v81
v_accvgpr_write_b32 a14, v82
v_mfma_f32_16x16x32_bf16 v[244:247], a[184:187], a[104:107], v[244:247]
v_accvgpr_write_b32 a15, v83
v_cvt_pk_bf16_f32 v168, v168, v169
v_mfma_f32_16x16x32_bf16 v[72:75], a[112:115], a[80:83], v[72:75]
v_cvt_pk_bf16_f32 v169, v170, v171
v_cvt_pk_bf16_f32 v170, v228, v229
v_mfma_f32_16x16x32_bf16 v[72:75], a[116:119], a[84:87], v[72:75]
v_cvt_pk_bf16_f32 v171, v230, v231
v_accvgpr_write_b32 a4, v168
v_mfma_f32_16x16x32_bf16 v[220:223], a[124:127], a[84:87], v[220:223]
v_accvgpr_write_b32 a5, v169
v_accvgpr_write_b32 a6, v170
v_mfma_f32_16x16x32_bf16 v[220:223], a[120:123], a[80:83], v[220:223]
buffer_load_dwordx4 v15, s[24:27], s64 offen offset:3072 sc1 lds
v_mfma_f32_16x16x32_bf16 v[160:163], a[112:115], a[88:91], v[160:163]
v_accvgpr_write_b32 a7, v171
v_cvt_pk_bf16_f32 v184, v184, v185
v_mfma_f32_16x16x32_bf16 v[160:163], a[116:119], a[92:95], v[160:163]
v_cvt_pk_bf16_f32 v185, v186, v187
v_cvt_pk_bf16_f32 v186, v248, v249
v_mfma_f32_16x16x32_bf16 v[252:255], a[124:127], a[92:95], v[252:255]
v_cvt_pk_bf16_f32 v187, v250, v251
v_accvgpr_write_b32 a0, v184
v_mfma_f32_16x16x32_bf16 v[252:255], a[120:123], a[88:91], v[252:255]
v_accvgpr_write_b32 a1, v185
v_accvgpr_write_b32 a2, v186
v_mfma_f32_16x16x32_bf16 v[236:239], a[112:115], a[96:99], v[236:239]
v_accvgpr_write_b32 a3, v187
v_cvt_pk_bf16_f32 v240, v240, v241
v_mfma_f32_16x16x32_bf16 v[236:239], a[116:119], a[100:103], v[236:239]
v_cvt_pk_bf16_f32 v241, v242, v243
v_cvt_pk_bf16_f32 v242, v232, v233
v_mfma_f32_16x16x32_bf16 v[224:227], a[124:127], a[100:103], v[224:227]
v_cvt_pk_bf16_f32 v243, v234, v235
v_accvgpr_write_b32 a8, v240
v_mfma_f32_16x16x32_bf16 v[224:227], a[120:123], a[96:99], v[224:227]
v_accvgpr_write_b32 a9, v241
v_accvgpr_write_b32 a10, v242
v_mfma_f32_16x16x32_bf16 v[216:219], a[112:115], a[104:107], v[216:219]
v_accvgpr_write_b32 a11, v243
v_cvt_pk_bf16_f32 v88, v88, v89
v_mfma_f32_16x16x32_bf16 v[216:219], a[116:119], a[108:111], v[216:219]
v_cvt_pk_bf16_f32 v89, v90, v91
v_cvt_pk_bf16_f32 v90, v200, v201
v_mfma_f32_16x16x32_bf16 v[208:211], a[124:127], a[108:111], v[208:211]
v_cvt_pk_bf16_f32 v91, v202, v203
v_accvgpr_write_b32 a16, v88
v_mfma_f32_16x16x32_bf16 v[208:211], a[120:123], a[104:107], v[208:211]
s_waitcnt lgkmcnt(0)
v_accvgpr_write_b32 a17, v89
v_accvgpr_write_b32 a18, v90
v_mfma_f32_16x16x32_bf16 v[44:47], a[192:195], a[32:35], v[96:99]
v_accvgpr_write_b32 a19, v91
v_cvt_pk_bf16_f32 v192, v192, v193
v_mfma_f32_16x16x32_bf16 v[44:47], a[196:199], a[36:39], v[44:47]
v_cvt_pk_bf16_f32 v193, v194, v195
v_cvt_pk_bf16_f32 v194, v244, v245
v_mfma_f32_16x16x32_bf16 v[44:47], a[200:203], a[28:31], v[44:47]
v_cvt_pk_bf16_f32 v195, v246, v247
v_accvgpr_write_b32 a24, v192
v_mfma_f32_16x16x32_bf16 v[44:47], a[204:207], a[20:23], v[44:47]
v_accvgpr_write_b32 a25, v193
v_accvgpr_write_b32 a26, v194
v_mfma_f32_16x16x32_bf16 v[52:55], a[192:195], a[44:47], v[104:107]
ds_bpermute_b32 v8, v17, v63
v_accvgpr_write_b32 a27, v195
v_mfma_f32_16x16x32_bf16 v[52:55], a[196:199], a[40:43], v[52:55]
v_cvt_pk_bf16_f32 v60, v60, v61
v_cvt_pk_bf16_f32 v61, v62, v63
v_mfma_f32_16x16x32_bf16 v[52:55], a[200:203], a[12:15], v[52:55]
v_cvt_pk_bf16_f32 v62, v68, v69
v_cvt_pk_bf16_f32 v63, v70, v71
v_mfma_f32_16x16x32_bf16 v[52:55], a[204:207], a[4:7], v[52:55]
v_accvgpr_write_b32 a128, v60
v_accvgpr_write_b32 a129, v61
v_mfma_f32_16x16x32_bf16 v[64:67], a[208:211], a[32:35], v[112:115]
v_accvgpr_write_b32 a130, v62
v_accvgpr_write_b32 a131, v63
v_mfma_f32_16x16x32_bf16 v[64:67], a[212:215], a[36:39], v[64:67]
ds_bpermute_b32 v9, v17, v87
v_cvt_pk_bf16_f32 v84, v84, v85
v_mfma_f32_16x16x32_bf16 v[64:67], a[216:219], a[28:31], v[64:67]
v_cvt_pk_bf16_f32 v85, v86, v87
v_cvt_pk_bf16_f32 v86, v76, v77
v_mfma_f32_16x16x32_bf16 v[64:67], a[220:223], a[20:23], v[64:67]
v_cvt_pk_bf16_f32 v87, v78, v79
v_mfma_f32_16x16x32_bf16 v[212:215], a[208:211], a[44:47], v[120:123]
buffer_store_dwordx4 v[84:87], v18, s[24:27], s54 offen offset:256 sc1
v_mfma_f32_16x16x32_bf16 v[212:215], a[212:215], a[40:43], v[212:215]
v_accvgpr_write_b32 a136, v84
v_accvgpr_write_b32 a137, v85
v_mfma_f32_16x16x32_bf16 v[212:215], a[216:219], a[12:15], v[212:215]
v_accvgpr_write_b32 a138, v86
v_accvgpr_write_b32 a139, v87
v_mfma_f32_16x16x32_bf16 v[212:215], a[220:223], a[4:7], v[212:215]
s_waitcnt vmcnt(15)
ds_bpermute_b32 v10, v17, v151
v_cvt_pk_bf16_f32 v148, v148, v149
v_mfma_f32_16x16x32_bf16 v[100:103], a[192:195], a[48:51], v[128:131]
s_barrier
v_cvt_pk_bf16_f32 v149, v150, v151
v_cvt_pk_bf16_f32 v150, v48, v49
v_mfma_f32_16x16x32_bf16 v[100:103], a[196:199], a[52:55], v[100:103]
v_cvt_pk_bf16_f32 v151, v50, v51
v_accvgpr_write_b32 a144, v148
v_mfma_f32_16x16x32_bf16 v[100:103], a[200:203], a[0:3], v[100:103]
ds_bpermute_b32 v11, v17, v167
v_accvgpr_write_b32 a145, v149
v_mfma_f32_16x16x32_bf16 v[100:103], a[204:207], a[8:11], v[100:103]
v_cvt_pk_bf16_f32 v164, v164, v165
v_cvt_pk_bf16_f32 v165, v166, v167
v_mfma_f32_16x16x32_bf16 v[92:95], a[192:195], a[60:63], v[136:139]
v_cvt_pk_bf16_f32 v166, v156, v157
v_cvt_pk_bf16_f32 v167, v158, v159
v_mfma_f32_16x16x32_bf16 v[92:95], a[196:199], a[56:59], v[92:95]
buffer_store_dwordx4 v[164:167], v18, s[24:27], s55 offen offset:256 sc1
v_mfma_f32_16x16x32_bf16 v[92:95], a[200:203], a[16:19], v[92:95]
v_cvt_pk_bf16_f32 v72, v72, v73
v_cvt_pk_bf16_f32 v73, v74, v75
v_mfma_f32_16x16x32_bf16 v[92:95], a[204:207], a[24:27], v[92:95]
v_cvt_pk_bf16_f32 v74, v220, v221
v_cvt_pk_bf16_f32 v75, v222, v223
v_mfma_f32_16x16x32_bf16 v[176:179], a[208:211], a[48:51], v[144:147]
v_cvt_pk_bf16_f32 v160, v160, v161
v_cvt_pk_bf16_f32 v161, v162, v163
v_mfma_f32_16x16x32_bf16 v[176:179], a[212:215], a[52:55], v[176:179]
L_PAD8:
s_cbranch_execz L_PAD12
v_cvt_pk_bf16_f32 v162, v252, v253
v_cvt_pk_bf16_f32 v163, v254, v255
v_mfma_f32_16x16x32_bf16 v[176:179], a[216:219], a[0:3], v[176:179]
buffer_store_dwordx4 v[160:163], v19, s[24:27], s54 offen offset:256 sc1
v_mfma_f32_16x16x32_bf16 v[176:179], a[220:223], a[8:11], v[176:179]
v_cvt_pk_bf16_f32 v236, v236, v237
v_cvt_pk_bf16_f32 v237, v238, v239
v_mfma_f32_16x16x32_bf16 v[228:231], a[208:211], a[60:63], v[152:155]
v_cvt_pk_bf16_f32 v238, v224, v225
v_cvt_pk_bf16_f32 v239, v226, v227
v_mfma_f32_16x16x32_bf16 v[228:231], a[212:215], a[56:59], v[228:231]
v_cvt_pk_bf16_f32 v216, v216, v217
v_cvt_pk_bf16_f32 v217, v218, v219
v_mfma_f32_16x16x32_bf16 v[228:231], a[216:219], a[16:19], v[228:231]
v_cvt_pk_bf16_f32 v218, v208, v209
v_cvt_pk_bf16_f32 v219, v210, v211
v_mfma_f32_16x16x32_bf16 v[228:231], a[220:223], a[24:27], v[228:231]
buffer_store_dwordx4 v[216:219], v19, s[24:27], s55 offen offset:256 sc1
ds_read_b128 a[64:67], v4 offset:57344
ds_read_b128 a[68:71], v4 offset:58368
ds_read_b128 a[72:75], v4 offset:59392
ds_read_b128 a[76:79], v4 offset:60416
ds_read_b128 a[80:83], v4 offset:61440
ds_read_b128 a[84:87], v4 offset:62464
ds_read_b128 a[88:91], v4 offset:63488
ds_read_b128 a[92:95], v4 offset:64512
s_add_u32 m0, s70, 98304
s_add_u32 s64, s68, 65536
buffer_load_dwordx4 v15, s[24:27], s64 offen offset:0 sc1 lds
v_max3_f32 v24, v44, v45, v46
v_max3_f32 v25, v47, v64, v65
v_max3_f32 v26, v52, v53, v54
v_max3_f32 v27, v55, v212, v213
v_max3_f32 v24, v24, v66, v67
v_max_f32 v24, v24, v25
v_max3_f32 v26, v26, v214, v215
v_max_f32 v26, v26, v27
v_mov_b32 v25, v24
buffer_load_dwordx4 v15, s[24:27], s64 offen offset:1024 sc1 lds
v_mov_b32 v27, v26
s_nop 1
v_permlane32_swap_b32 v25, v24
v_permlane32_swap_b32 v27, v26
s_nop 0
v_max_f32 v24, v24, v25
v_max_f32 v26, v26, v27
v_mov_b32 v25, v24
v_mov_b32 v27, v26
buffer_load_dwordx4 v15, s[24:27], s64 offen offset:2048 sc1 lds
s_nop 1
v_permlane16_swap_b32 v25, v24
v_permlane16_swap_b32 v27, v26
s_nop 0
v_max_f32 v24, v24, v25
v_max_f32 v26, v26, v27
v_pk_add_f32 v[44:45], v[44:45], v[24:25] op_sel_hi:[1,0] neg_lo:[0,1] neg_hi:[0,1]
v_pk_add_f32 v[46:47], v[46:47], v[24:25] op_sel_hi:[1,0] neg_lo:[0,1] neg_hi:[0,1]
v_pk_add_f32 v[52:53], v[52:53], v[26:27] op_sel_hi:[1,0] neg_lo:[0,1] neg_hi:[0,1]
buffer_load_dwordx4 v15, s[24:27], s64 offen offset:3072 sc1 lds
v_pk_add_f32 v[54:55], v[54:55], v[26:27] op_sel_hi:[1,0] neg_lo:[0,1] neg_hi:[0,1]
v_pk_add_f32 v[64:65], v[64:65], v[24:25] op_sel_hi:[1,0] neg_lo:[0,1] neg_hi:[0,1]
v_pk_add_f32 v[66:67], v[66:67], v[24:25] op_sel_hi:[1,0] neg_lo:[0,1] neg_hi:[0,1]
v_pk_add_f32 v[212:213], v[212:213], v[26:27] op_sel_hi:[1,0] neg_lo:[0,1] neg_hi:[0,1]
v_pk_add_f32 v[214:215], v[214:215], v[26:27] op_sel_hi:[1,0] neg_lo:[0,1] neg_hi:[0,1]
v_pk_add_f32 v[96:97], v[96:97], v[24:25] op_sel_hi:[1,0] neg_lo:[0,1] neg_hi:[0,1]
v_pk_add_f32 v[98:99], v[98:99], v[24:25] op_sel_hi:[1,0] neg_lo:[0,1] neg_hi:[0,1]
v_pk_add_f32 v[104:105], v[104:105], v[26:27] op_sel_hi:[1,0] neg_lo:[0,1] neg_hi:[0,1]
v_pk_add_f32 v[106:107], v[106:107], v[26:27] op_sel_hi:[1,0] neg_lo:[0,1] neg_hi:[0,1]
s_add_u32 m0, s70, 114688
s_add_u32 s64, s68, 81920
buffer_load_dwordx4 v15, s[24:27], s64 offen offset:0 sc1 lds
v_pk_add_f32 v[112:113], v[112:113], v[24:25] op_sel_hi:[1,0] neg_lo:[0,1] neg_hi:[0,1]
v_pk_add_f32 v[114:115], v[114:115], v[24:25] op_sel_hi:[1,0] neg_lo:[0,1] neg_hi:[0,1]
v_pk_add_f32 v[120:121], v[120:121], v[26:27] op_sel_hi:[1,0] neg_lo:[0,1] neg_hi:[0,1]
v_pk_add_f32 v[122:123], v[122:123], v[26:27] op_sel_hi:[1,0] neg_lo:[0,1] neg_hi:[0,1]
v_exp_f32 v44, v44
v_exp_f32 v45, v45
v_exp_f32 v46, v46
v_exp_f32 v47, v47
v_cvt_pk_bf16_f32 v124, v44, v45
buffer_load_dwordx4 v15, s[24:27], s64 offen offset:1024 sc1 lds
v_exp_f32 v52, v52
v_exp_f32 v53, v53
v_cvt_pk_bf16_f32 v125, v46, v47
v_exp_f32 v54, v54
v_exp_f32 v55, v55
v_cvt_pk_bf16_f32 v140, v52, v53
v_exp_f32 v64, v64
v_exp_f32 v65, v65
v_cvt_pk_bf16_f32 v141, v54, v55
buffer_load_dwordx4 v15, s[24:27], s64 offen offset:2048 sc1 lds
v_exp_f32 v66, v66
v_exp_f32 v67, v67
v_cvt_pk_bf16_f32 v126, v64, v65
v_exp_f32 v212, v212
v_exp_f32 v213, v213
v_cvt_pk_bf16_f32 v127, v66, v67
v_exp_f32 v214, v214
v_exp_f32 v215, v215
v_cvt_pk_bf16_f32 v142, v212, v213
buffer_load_dwordx4 v15, s[24:27], s64 offen offset:3072 sc1 lds
v_max3_f32 v24, v100, v101, v102
v_cvt_pk_bf16_f32 v143, v214, v215
v_max3_f32 v25, v103, v176, v177
v_max3_f32 v26, v92, v93, v94
v_max3_f32 v27, v95, v228, v229
v_max3_f32 v24, v24, v178, v179
v_max_f32 v24, v24, v25
v_max3_f32 v26, v26, v230, v231
v_max_f32 v26, v26, v27
v_mov_b32 v25, v24
v_mov_b32 v27, v26
s_nop 1
v_permlane32_swap_b32 v25, v24
v_permlane32_swap_b32 v27, v26
s_nop 0
v_max_f32 v24, v24, v25
s_cmp_lt_u32 s3, 1
s_cbranch_scc1 L_SK5
s_add_u32 m0, s70, 131072
s_add_u32 s64, s68, 98304
buffer_load_dwordx4 v15, s[24:27], s64 offen offset:0 sc1 lds
buffer_load_dwordx4 v15, s[24:27], s64 offen offset:1024 sc1 lds
buffer_load_dwordx4 v15, s[24:27], s64 offen offset:2048 sc1 lds
buffer_load_dwordx4 v15, s[24:27], s64 offen offset:3072 sc1 lds
L_SK5:
v_max_f32 v26, v26, v27
v_mov_b32 v25, v24
v_mov_b32 v27, v26
s_nop 1
v_permlane16_swap_b32 v25, v24
v_permlane16_swap_b32 v27, v26
s_nop 0
v_max_f32 v24, v24, v25
v_max_f32 v26, v26, v27
v_pk_add_f32 v[100:101], v[100:101], v[24:25] op_sel_hi:[1,0] neg_lo:[0,1] neg_hi:[0,1]
v_pk_add_f32 v[102:103], v[102:103], v[24:25] op_sel_hi:[1,0] neg_lo:[0,1] neg_hi:[0,1]
v_pk_add_f32 v[92:93], v[92:93], v[26:27] op_sel_hi:[1,0] neg_lo:[0,1] neg_hi:[0,1]
v_pk_add_f32 v[94:95], v[94:95], v[26:27] op_sel_hi:[1,0] neg_lo:[0,1] neg_hi:[0,1]
v_pk_add_f32 v[176:177], v[176:177], v[24:25] op_sel_hi:[1,0] neg_lo:[0,1] neg_hi:[0,1]
v_pk_add_f32 v[178:179], v[178:179], v[24:25] op_sel_hi:[1,0] neg_lo:[0,1] neg_hi:[0,1]
v_pk_add_f32 v[228:229], v[228:229], v[26:27] op_sel_hi:[1,0] neg_lo:[0,1] neg_hi:[0,1]
v_pk_add_f32 v[230:231], v[230:231], v[26:27] op_sel_hi:[1,0] neg_lo:[0,1] neg_hi:[0,1]
v_pk_add_f32 v[128:129], v[128:129], v[24:25] op_sel_hi:[1,0] neg_lo:[0,1] neg_hi:[0,1]
v_pk_add_f32 v[130:131], v[130:131], v[24:25] op_sel_hi:[1,0] neg_lo:[0,1] neg_hi:[0,1]
v_pk_add_f32 v[136:137], v[136:137], v[26:27] op_sel_hi:[1,0] neg_lo:[0,1] neg_hi:[0,1]
v_pk_add_f32 v[138:139], v[138:139], v[26:27] op_sel_hi:[1,0] neg_lo:[0,1] neg_hi:[0,1]
v_pk_add_f32 v[144:145], v[144:145], v[24:25] op_sel_hi:[1,0] neg_lo:[0,1] neg_hi:[0,1]
v_pk_add_f32 v[146:147], v[146:147], v[24:25] op_sel_hi:[1,0] neg_lo:[0,1] neg_hi:[0,1]
v_pk_add_f32 v[152:153], v[152:153], v[26:27] op_sel_hi:[1,0] neg_lo:[0,1] neg_hi:[0,1]
v_pk_add_f32 v[154:155], v[154:155], v[26:27] op_sel_hi:[1,0] neg_lo:[0,1] neg_hi:[0,1]
v_accvgpr_write_b32 a146, v150
s_cmp_lt_u32 s3, 2
s_cbranch_scc1 L_SK6
s_add_u32 m0, s70, 147456
s_add_u32 s64, s68, 114688
buffer_load_dwordx4 v15, s[24:27], s64 offen offset:0 sc1 lds
buffer_load_dwordx4 v15, s[24:27], s64 offen offset:1024 sc1 lds
buffer_load_dwordx4 v15, s[24:27], s64 offen offset:2048 sc1 lds
buffer_load_dwordx4 v15, s[24:27], s64 offen offset:3072 sc1 lds
L_SK6:
v_accvgpr_write_b32 a147, v151
v_accvgpr_write_b32 a152, v164
v_accvgpr_write_b32 a153, v165
v_accvgpr_write_b32 a154, v166
v_accvgpr_write_b32 a155, v167
v_accvgpr_write_b32 a132, v72
v_accvgpr_write_b32 a133, v73
v_accvgpr_write_b32 a134, v74
v_accvgpr_write_b32 a135, v75
v_accvgpr_write_b32 a140, v160
v_accvgpr_write_b32 a141, v161
v_accvgpr_write_b32 a142, v162
v_accvgpr_write_b32 a143, v163
v_accvgpr_write_b32 a148, v236
v_accvgpr_write_b32 a149, v237
v_accvgpr_write_b32 a150, v238
v_accvgpr_write_b32 a151, v239
v_accvgpr_write_b32 a156, v216
v_accvgpr_write_b32 a157, v217
v_accvgpr_write_b32 a158, v218
v_accvgpr_write_b32 a159, v219
v_mov_b64 v[60:61], 0
v_mov_b64 v[62:63], 0
v_mov_b64 v[68:69], 0
v_mov_b64 v[70:71], 0
v_mov_b64 v[72:73], 0
s_cmp_lt_u32 s3, 3
s_cbranch_scc1 L_SK7
s_add_u32 m0, s70, 0
s_add_u32 s64, s68, 131072
buffer_load_dwordx4 v15, s[24:27], s64 offen offset:0 sc1 lds
buffer_load_dwordx4 v15, s[24:27], s64 offen offset:1024 sc1 lds
buffer_load_dwordx4 v15, s[24:27], s64 offen offset:2048 sc1 lds
buffer_load_dwordx4 v15, s[24:27], s64 offen offset:3072 sc1 lds
L_SK7:
v_mov_b64 v[74:75], 0
v_mov_b64 v[220:221], 0
v_mov_b64 v[222:223], 0
v_mov_b64 v[84:85], 0
v_mov_b64 v[86:87], 0
v_mov_b64 v[76:77], 0
v_mov_b64 v[78:79], 0
v_mov_b64 v[160:161], 0
v_mov_b64 v[162:163], 0
v_mov_b64 v[252:253], 0
v_mov_b64 v[254:255], 0
v_mov_b64 v[148:149], 0
v_mov_b64 v[150:151], 0
v_mov_b64 v[48:49], 0
v_mov_b64 v[50:51], 0
v_mov_b64 v[236:237], 0
v_mov_b64 v[238:239], 0
v_mov_b64 v[224:225], 0
v_mov_b64 v[226:227], 0
v_mov_b64 v[164:165], 0
v_mov_b64 v[166:167], 0
v_mov_b64 v[156:157], 0
v_mov_b64 v[158:159], 0
v_mov_b64 v[216:217], 0
v_mov_b64 v[218:219], 0
v_mov_b64 v[208:209], 0
v_mov_b64 v[210:211], 0
ds_read_b128 a[192:195], v4 offset:49152
ds_read_b128 a[196:199], v4 offset:50176
ds_read_b128 a[200:203], v4 offset:51200
ds_read_b128 a[204:207], v4 offset:52224
ds_read_b128 a[208:211], v4 offset:53248
ds_read_b128 a[212:215], v4 offset:54272
ds_read_b128 a[216:219], v4 offset:55296
ds_read_b128 a[220:223], v4 offset:56320
s_waitcnt lgkmcnt(8)
s_lshl2_add_u32 s77, s86, s84
s_mul_i32 s77, s77, 344064
s_mov_b32 s80, s70
s_cmp_lt_u32 s3, 2
s_cselect_b32 s53, 8, -2
s_add_u32 s53, s53, s3
v_mfma_f32_16x16x32_bf16 v[36:39], a[64:67], v[124:127], 0
s_mul_i32 s52, s5, 65536
v_exp_f32 v100, v100
v_mfma_f32_16x16x32_bf16 v[116:119], a[64:67], v[140:143], 0
s_sub_u32 s52, 1064960, s52
v_exp_f32 v101, v101
v_mfma_f32_16x16x32_bf16 v[132:135], a[68:71], v[140:143], 0
s_add_u32 s71, s68, s52
v_exp_f32 v102, v102
v_mfma_f32_16x16x32_bf16 v[32:35], a[68:71], v[124:127], 0
s_add_u32 s77, s77, s80
v_exp_f32 v103, v103
v_mfma_f32_16x16x32_bf16 v[196:199], a[72:75], v[124:127], 0
s_add_u32 s77, s77, 38797312
v_cvt_pk_bf16_f32 v248, v100, v101
v_cvt_pk_bf16_f32 v249, v102, v103
v_mfma_f32_16x16x32_bf16 v[184:187], a[72:75], v[140:143], 0
s_add_u32 s52, s3, 6
v_exp_f32 v92, v92
v_mfma_f32_16x16x32_bf16 v[240:243], a[76:79], v[140:143], 0
s_mul_i32 s52, s52, 16384
v_exp_f32 v93, v93
v_mfma_f32_16x16x32_bf16 v[204:207], a[76:79], v[124:127], 0
s_add_u32 s68, s68, s52
v_exp_f32 v94, v94
v_mfma_f32_16x16x32_bf16 v[108:111], a[80:83], v[124:127], 0
s_lshl_b32 s53, s53, 14
v_exp_f32 v95, v95
v_mfma_f32_16x16x32_bf16 v[188:191], a[80:83], v[140:143], 0
s_add_u32 s70, s70, s53
v_cvt_pk_bf16_f32 v232, v92, v93
v_cvt_pk_bf16_f32 v233, v94, v95
v_mfma_f32_16x16x32_bf16 v[56:59], a[84:87], v[140:143], 0
s_mov_b32 s75, 65536
v_exp_f32 v176, v176
v_mfma_f32_16x16x32_bf16 v[40:43], a[84:87], v[124:127], 0
s_mov_b32 s72, 1
v_exp_f32 v177, v177
v_mfma_f32_16x16x32_bf16 v[80:83], a[88:91], v[124:127], 0
s_mov_b32 s73, 9
v_exp_f32 v178, v178
v_mfma_f32_16x16x32_bf16 v[88:91], a[88:91], v[140:143], 0
s_lshl2_add_u32 s69, s5, 4
v_exp_f32 v179, v179
v_mfma_f32_16x16x32_bf16 v[192:195], a[92:95], v[140:143], 0
s_max_u32 s69, s69, 12
v_cvt_pk_bf16_f32 v250, v176, v177
v_cvt_pk_bf16_f32 v251, v178, v179
v_mfma_f32_16x16x32_bf16 v[168:171], a[92:95], v[124:127], 0
s_min_u32 s74, s73, s66
v_exp_f32 v228, v228
v_mfma_f32_16x16x32_bf16 a[224:227], a[240:243], v[124:127], 0
s_mov_b32 s93, 9
s_waitcnt vmcnt(8) lgkmcnt(0)
v_mfma_f32_16x16x32_bf16 a[228:231], a[240:243], v[140:143], 0
s_cmp_lt_u32 s66, 2
buffer_atomic_add v1, v0, s[24:27], s89 offen offset:8 sc1
s_cbranch_scc1 L_NE
L_DUAL:
v_mfma_f32_16x16x32_bf16 v[44:47], a[192:195], a[32:35], v[96:99]
s_barrier
v_mfma_f32_16x16x32_bf16 v[44:47], a[196:199], a[36:39], v[44:47]
s_cmp_eq_u32 s68, s71
v_exp_f32 v229, v229
v_mfma_f32_16x16x32_bf16 v[44:47], a[200:203], a[28:31], v[44:47]
s_cselect_b32 s64, s77, s68
v_add_u32 v5, s75, v4
v_cvt_pk_bf16_f32 v234, v228, v229
v_mfma_f32_16x16x32_bf16 v[44:47], a[204:207], a[20:23], v[44:47]
s_mov_b32 m0, s70
v_exp_f32 v230, v230
v_mfma_f32_16x16x32_bf16 v[52:55], a[192:195], a[44:47], v[104:107]
buffer_load_dwordx4 v15, s[24:27], s64 offen offset:0 sc1 lds
v_mfma_f32_16x16x32_bf16 v[52:55], a[196:199], a[40:43], v[52:55]
s_add_u32 s75, s75, 16384
v_exp_f32 v231, v231
v_mfma_f32_16x16x32_bf16 v[52:55], a[200:203], a[12:15], v[52:55]
v_cvt_pk_bf16_f32 v235, v230, v231
v_mfma_f32_16x16x32_bf16 v[52:55], a[204:207], a[4:7], v[52:55]
s_cmp_ge_u32 s75, 163840
v_exp_f32 v44, v44
v_mfma_f32_16x16x32_bf16 v[64:67], a[208:211], a[32:35], v[112:115]
v_mfma_f32_16x16x32_bf16 v[64:67], a[212:215], a[36:39], v[64:67]
s_cselect_b32 s75, 0, s75
v_exp_f32 v45, v45
v_mfma_f32_16x16x32_bf16 v[64:67], a[216:219], a[28:31], v[64:67]
v_cvt_pk_bf16_f32 v124, v44, v45
v_mfma_f32_16x16x32_bf16 v[64:67], a[220:223], a[20:23], v[64:67]
s_add_u32 s68, s64, 16384
v_exp_f32 v46, v46
v_mfma_f32_16x16x32_bf16 v[212:215], a[208:211], a[44:47], v[120:123]
buffer_load_dwordx4 v15, s[24:27], s64 offen offset:1024 sc1 lds
v_mfma_f32_16x16x32_bf16 v[212:215], a[212:215], a[40:43], v[212:215]
s_add_u32 s70, s70, 16384
v_exp_f32 v47, v47
v_mfma_f32_16x16x32_bf16 v[212:215], a[216:219], a[12:15], v[212:215]
v_cvt_pk_bf16_f32 v125, v46, v47
v_mfma_f32_16x16x32_bf16 v[212:215], a[220:223], a[4:7], v[212:215]
v_exp_f32 v52, v52
v_mfma_f32_16x16x32_bf16 v[60:63], a[64:67], v[248:251], v[60:63]
v_mfma_f32_16x16x32_bf16 v[148:151], a[64:67], v[232:235], v[148:151]
s_cmp_ge_u32 s70, 163840
v_exp_f32 v53, v53
v_mfma_f32_16x16x32_bf16 v[48:51], a[68:71], v[232:235], v[48:51]
ds_read_b128 a[64:67], v5 offset:8192
v_cvt_pk_bf16_f32 v140, v52, v53
v_mfma_f32_16x16x32_bf16 v[68:71], a[68:71], v[248:251], v[68:71]
s_cselect_b32 s70, s80, s70
v_exp_f32 v54, v54
v_mfma_f32_16x16x32_bf16 v[72:75], a[72:75], v[248:251], v[72:75]
buffer_load_dwordx4 v15, s[24:27], s64 offen offset:2048 sc1 lds
v_mfma_f32_16x16x32_bf16 v[236:239], a[72:75], v[232:235], v[236:239]
v_exp_f32 v55, v55
v_mfma_f32_16x16x32_bf16 v[224:227], a[76:79], v[232:235], v[224:227]
ds_read_b128 a[68:71], v5 offset:9216
v_cvt_pk_bf16_f32 v141, v54, v55
v_mfma_f32_16x16x32_bf16 v[220:223], a[76:79], v[248:251], v[220:223]
v_exp_f32 v64, v64
v_mfma_f32_16x16x32_bf16 v[84:87], a[80:83], v[248:251], v[84:87]
ds_read_b128 a[72:75], v5 offset:10240
v_mfma_f32_16x16x32_bf16 v[164:167], a[80:83], v[232:235], v[164:167]
v_exp_f32 v65, v65
v_mfma_f32_16x16x32_bf16 v[156:159], a[84:87], v[232:235], v[156:159]
ds_read_b128 a[76:79], v5 offset:11264
v_cvt_pk_bf16_f32 v126, v64, v65
v_mfma_f32_16x16x32_bf16 v[76:79], a[84:87], v[248:251], v[76:79]
v_exp_f32 v66, v66
v_mfma_f32_16x16x32_bf16 v[160:163], a[88:91], v[248:251], v[160:163]
buffer_load_dwordx4 v15, s[24:27], s64 offen offset:3072 sc1 lds
v_mfma_f32_16x16x32_bf16 v[216:219], a[88:91], v[232:235], v[216:219]
v_exp_f32 v67, v67
v_mfma_f32_16x16x32_bf16 v[208:211], a[92:95], v[232:235], v[208:211]
ds_read_b128 a[80:83], v5 offset:12288
v_cvt_pk_bf16_f32 v127, v66, v67
v_mfma_f32_16x16x32_bf16 v[252:255], a[92:95], v[248:251], v[252:255]
v_exp_f32 v212, v212
v_mfma_f32_16x16x32_bf16 a[232:235], a[240:243], v[248:251], a[232:235]
ds_read_b128 a[84:87], v5 offset:13312
v_mfma_f32_16x16x32_bf16 a[236:239], a[240:243], v[232:235], a[236:239]
ds_read_b128 a[88:91], v5 offset:14336
v_mfma_f32_16x16x32_bf16 v[100:103], a[192:195], a[48:51], v[128:131]
ds_read_b128 a[92:95], v5 offset:15360
v_mfma_f32_16x16x32_bf16 v[100:103], a[196:199], a[52:55], v[100:103]
v_exp_f32 v213, v213
v_mfma_f32_16x16x32_bf16 v[100:103], a[200:203], a[0:3], v[100:103]
v_cvt_pk_bf16_f32 v142, v212, v213
v_mfma_f32_16x16x32_bf16 v[100:103], a[204:207], a[8:11], v[100:103]
v_exp_f32 v214, v214
v_mfma_f32_16x16x32_bf16 v[92:95], a[192:195], a[60:63], v[136:139]
s_nop 0
v_mfma_f32_16x16x32_bf16 v[92:95], a[196:199], a[56:59], v[92:95]
v_exp_f32 v215, v215
v_mfma_f32_16x16x32_bf16 v[92:95], a[200:203], a[16:19], v[92:95]
ds_read_b128 a[192:195], v5 offset:0
v_cvt_pk_bf16_f32 v143, v214, v215
v_mfma_f32_16x16x32_bf16 v[92:95], a[204:207], a[24:27], v[92:95]
v_exp_f32 v100, v100
v_mfma_f32_16x16x32_bf16 v[176:179], a[208:211], a[48:51], v[144:147]
ds_read_b128 a[196:199], v5 offset:1024
v_mfma_f32_16x16x32_bf16 v[176:179], a[212:215], a[52:55], v[176:179]
v_exp_f32 v101, v101
v_mfma_f32_16x16x32_bf16 v[176:179], a[216:219], a[0:3], v[176:179]
ds_read_b128 a[200:203], v5 offset:2048
v_cvt_pk_bf16_f32 v248, v100, v101
v_mfma_f32_16x16x32_bf16 v[176:179], a[220:223], a[8:11], v[176:179]
v_exp_f32 v102, v102
v_mfma_f32_16x16x32_bf16 v[228:231], a[208:211], a[60:63], v[152:155]
ds_read_b128 a[204:207], v5 offset:3072
v_mfma_f32_16x16x32_bf16 v[228:231], a[212:215], a[56:59], v[228:231]
v_exp_f32 v103, v103
v_mfma_f32_16x16x32_bf16 v[228:231], a[216:219], a[16:19], v[228:231]
ds_read_b128 a[208:211], v5 offset:4096
v_cvt_pk_bf16_f32 v249, v102, v103
v_mfma_f32_16x16x32_bf16 v[228:231], a[220:223], a[24:27], v[228:231]
s_waitcnt lgkmcnt(5)
v_exp_f32 v92, v92
v_mfma_f32_16x16x32_bf16 v[36:39], a[64:67], v[124:127], v[36:39]
ds_read_b128 a[212:215], v5 offset:5120
v_mfma_f32_16x16x32_bf16 v[116:119], a[64:67], v[140:143], v[116:119]
v_exp_f32 v93, v93
v_mfma_f32_16x16x32_bf16 v[132:135], a[68:71], v[140:143], v[132:135]
ds_read_b128 a[216:219], v5 offset:6144
v_cvt_pk_bf16_f32 v232, v92, v93
v_mfma_f32_16x16x32_bf16 v[32:35], a[68:71], v[124:127], v[32:35]
v_exp_f32 v94, v94
v_mfma_f32_16x16x32_bf16 v[196:199], a[72:75], v[124:127], v[196:199]
ds_read_b128 a[220:223], v5 offset:7168
v_mfma_f32_16x16x32_bf16 v[184:187], a[72:75], v[140:143], v[184:187]
s_add_u32 s72, s72, 1
v_exp_f32 v95, v95
v_mfma_f32_16x16x32_bf16 v[240:243], a[76:79], v[140:143], v[240:243]
v_cvt_pk_bf16_f32 v233, v94, v95
v_mfma_f32_16x16x32_bf16 v[204:207], a[76:79], v[124:127], v[204:207]
v_exp_f32 v176, v176
v_mfma_f32_16x16x32_bf16 v[108:111], a[80:83], v[124:127], v[108:111]
v_mfma_f32_16x16x32_bf16 v[188:191], a[80:83], v[140:143], v[188:191]
v_exp_f32 v177, v177
v_mfma_f32_16x16x32_bf16 v[56:59], a[84:87], v[140:143], v[56:59]
v_cvt_pk_bf16_f32 v250, v176, v177
v_mfma_f32_16x16x32_bf16 v[40:43], a[84:87], v[124:127], v[40:43]
v_exp_f32 v178, v178
v_mfma_f32_16x16x32_bf16 v[80:83], a[88:91], v[124:127], v[80:83]
v_mfma_f32_16x16x32_bf16 v[88:91], a[88:91], v[140:143], v[88:91]
s_cmp_lt_u32 s72, s74
v_exp_f32 v179, v179
v_mfma_f32_16x16x32_bf16 v[192:195], a[92:95], v[140:143], v[192:195]
v_cvt_pk_bf16_f32 v251, v178, v179
v_mfma_f32_16x16x32_bf16 v[168:171], a[92:95], v[124:127], v[168:171]
s_waitcnt vmcnt(8) lgkmcnt(0)
v_exp_f32 v228, v228
v_mfma_f32_16x16x32_bf16 a[224:227], a[240:243], v[124:127], a[224:227]
v_mfma_f32_16x16x32_bf16 a[228:231], a[240:243], v[140:143], a[228:231]
s_cbranch_scc1 L_DUAL
L_DISP:
s_cmp_eq_u32 s72, s93
s_cbranch_scc1 L_STOP
L_NE:
s_mov_b32 s74, s93
s_cmp_gt_u32 s72, s66
s_cbranch_scc1 L_SINGLE
v_cndmask_b32 v96, v96, v6, s[56:57]
v_cndmask_b32 v120, v120, v6, s[56:57]
v_mov_b32 v112, v6
v_cndmask_b32 v97, v97, v6, s[58:59]
v_cndmask_b32 v121, v121, v6, s[58:59]
v_mov_b32 v113, v6
v_cndmask_b32 v98, v98, v6, s[60:61]
v_cndmask_b32 v122, v122, v6, s[60:61]
v_mov_b32 v114, v6
v_cndmask_b32 v99, v99, v6, s[62:63]
v_cndmask_b32 v123, v123, v6, s[62:63]
v_mov_b32 v115, v6
s_mov_b32 s74, 0
s_branch L_DUAL
L_STOP:
s_cmp_eq_u32 s72, 3
s_cbranch_scc1 L_E0
s_cmp_eq_u32 s72, 9
s_cbranch_scc1 L_E1
s_cmp_lg_u32 s72, 11
s_cbranch_scc1 L_SE
v_cmp_gt_u32 vcc, 32, v172
s_mov_b32 s73, 32
s_min_u32 s93, s73, s69
s_min_u32 s74, s93, s66
v_accvgpr_read_b32 v16, a244
v_accvgpr_read_b32 v17, a248
v_accvgpr_read_b32 v18, a252
s_cbranch_vccnz CK_Q
CK_Q_R:
buffer_load_dwordx4 a[244:247], v16, s[24:27], 0 offen sc1
buffer_load_dwordx4 a[248:251], v17, s[24:27], 0 offen sc1
buffer_load_dwordx4 a[252:255], v18, s[24:27], 0 offen sc1
s_add_u32 s53, s77, 163840
buffer_load_dwordx4 a[96:99], v15, s[24:27], s53 offen offset:0 sc1
buffer_load_dwordx4 a[100:103], v15, s[24:27], s53 offen offset:1024 sc1
buffer_load_dwordx4 a[104:107], v15, s[24:27], s53 offen offset:2048 sc1
buffer_load_dwordx4 a[108:111], v15, s[24:27], s53 offen offset:3072 sc1
s_cmp_lt_u32 s72, s66
s_cbranch_scc1 L_DUAL
s_mov_b32 s74, s93
s_cmp_gt_u32 s72, s66
s_cbranch_scc1 L_SINGLE
s_branch L_NE
L_E0:
buffer_atomic_add v1, v0, s[24:27], s89 offen offset:8 sc1
s_mov_b32 s73, 9
s_min_u32 s93, s73, s69
s_min_u32 s74, s93, s66
s_cmp_lt_u32 s72, s66
s_cbranch_scc1 L_DUAL
s_mov_b32 s74, s93
s_cmp_gt_u32 s72, s66
s_cbranch_scc1 L_SINGLE
s_branch L_NE
L_E1:
v_and_b32 v173, 31, v1
v_lshlrev_b32 v173, 10, v173
v_add_u32 v173, 75497992, v173
buffer_load_dword v172, v173, s[24:27], 0 offen sc1
s_mov_b32 s73, 11
s_cmp_lt_u32 s4, 16
s_cselect_b32 s52, s66, s67
s_and_b32 s53, s4, 15
s_lshl4_add_u32 s52, s52, s53
s_mul_i32 s52, s52, 2304
v_lshlrev_b32 v16, 2, v1
buffer_store_dwordx4 v[0:3], v4, s[44:47], s52 offen sc1
buffer_store_dwordx4 v[0:3], v4, s[44:47], s52 offen offset:1024 sc1
buffer_store_dword v0, v16, s[44:47], s52 offen offset:2048 sc1
s_min_u32 s93, s73, s69
s_min_u32 s74, s93, s66
s_cmp_lt_u32 s72, s66
s_cbranch_scc1 L_DUAL
s_mov_b32 s74, s93
s_cmp_gt_u32 s72, s66
s_cbranch_scc1 L_SINGLE
s_branch L_NE
L_SE:
s_lshr_b32 s52, s4, 3
s_mul_i32 s52, s52, 75776
s_add_u32 s52, s52, 54525952
s_and_b32 s53, s4, 7
s_mul_i32 s53, s53, 8192
s_add_u32 s52, s52, s53
s_mul_i32 s78, s66, 303104
s_add_u32 s78, s78, s52
s_mul_i32 s79, s67, 303104
s_add_u32 s79, s79, s52
s_mov_b32 s76, 0
v_mov_b32 v7, 0x5d800000
s_mov_b32 s69, 64
v_accvgpr_read_b32 v180, a224
v_accvgpr_read_b32 v182, a228
v_cmp_nle_f32 vcc, v180, v7
v_cmp_nle_f32 s[96:97], v182, v7
s_nop 3
s_or_b64 vcc, vcc, s[96:97]
s_cbranch_vccnz L_NS
s_add_u32 s53, s77, 180224
buffer_load_dwordx4 a[112:115], v15, s[24:27], s53 offen offset:0 sc1
v_mul_f32 v8, 0x3fb8aa3b, v8
v_mul_f32 v9, 0x3fb8aa3b, v9
v_exp_f32 v8, v8
v_exp_f32 v9, v9
s_nop 0
v_fma_f32 v180, v180, v8, v180
v_fma_f32 v182, v182, v9, v182
v_rcp_f32 v180, v180
v_rcp_f32 v182, v182
s_add_u32 s52, s78, 4096
v_mov_b32 v181, v180
v_mov_b32 v183, v182
v_pk_mul_f32 v[36:37], v[36:37], v[180:181]
v_pk_mul_f32 v[38:39], v[38:39], v[180:181]
v_pk_mul_f32 v[32:33], v[32:33], v[180:181]
v_pk_mul_f32 v[34:35], v[34:35], v[180:181]
v_cvt_pk_bf16_f32 v36, v36, v37
v_cvt_pk_bf16_f32 v37, v38, v39
v_cvt_pk_bf16_f32 v38, v32, v33
v_cvt_pk_bf16_f32 v39, v34, v35
buffer_store_dwordx4 v[36:39], v15, s[24:27], s78 offen offset:0 sc1
buffer_load_dwordx4 a[116:119], v15, s[24:27], s53 offen offset:1024 sc1
v_pk_mul_f32 v[116:117], v[116:117], v[182:183]
v_pk_mul_f32 v[118:119], v[118:119], v[182:183]
v_pk_mul_f32 v[132:133], v[132:133], v[182:183]
v_pk_mul_f32 v[134:135], v[134:135], v[182:183]
v_cvt_pk_bf16_f32 v116, v116, v117
v_cvt_pk_bf16_f32 v117, v118, v119
v_cvt_pk_bf16_f32 v118, v132, v133
v_cvt_pk_bf16_f32 v119, v134, v135
buffer_store_dwordx4 v[116:119], v15, s[24:27], s78 offen offset:1024 sc1
v_pk_mul_f32 v[196:197], v[196:197], v[180:181]
v_pk_mul_f32 v[198:199], v[198:199], v[180:181]
v_pk_mul_f32 v[204:205], v[204:205], v[180:181]
v_pk_mul_f32 v[206:207], v[206:207], v[180:181]
v_cvt_pk_bf16_f32 v196, v196, v197
v_cvt_pk_bf16_f32 v197, v198, v199
v_cvt_pk_bf16_f32 v198, v204, v205
v_cvt_pk_bf16_f32 v199, v206, v207
buffer_store_dwordx4 v[196:199], v15, s[24:27], s78 offen offset:2048 sc1
v_pk_mul_f32 v[184:185], v[184:185], v[182:183]
v_pk_mul_f32 v[186:187], v[186:187], v[182:183]
v_pk_mul_f32 v[240:241], v[240:241], v[182:183]
buffer_load_dwordx4 a[120:123], v15, s[24:27], s53 offen offset:2048 sc1
v_pk_mul_f32 v[242:243], v[242:243], v[182:183]
v_cvt_pk_bf16_f32 v184, v184, v185
v_cvt_pk_bf16_f32 v185, v186, v187
v_cvt_pk_bf16_f32 v186, v240, v241
v_cvt_pk_bf16_f32 v187, v242, v243
buffer_store_dwordx4 v[184:187], v15, s[24:27], s78 offen offset:3072 sc1
v_pk_mul_f32 v[108:109], v[108:109], v[180:181]
v_pk_mul_f32 v[110:111], v[110:111], v[180:181]
v_pk_mul_f32 v[40:41], v[40:41], v[180:181]
v_pk_mul_f32 v[42:43], v[42:43], v[180:181]
v_cvt_pk_bf16_f32 v108, v108, v109
v_cvt_pk_bf16_f32 v109, v110, v111
v_cvt_pk_bf16_f32 v110, v40, v41
v_cvt_pk_bf16_f32 v111, v42, v43
buffer_store_dwordx4 v[108:111], v15, s[24:27], s52 offen offset:0 sc1
v_pk_mul_f32 v[188:189], v[188:189], v[182:183]
v_pk_mul_f32 v[190:191], v[190:191], v[182:183]
v_pk_mul_f32 v[56:57], v[56:57], v[182:183]
v_pk_mul_f32 v[58:59], v[58:59], v[182:183]
v_cvt_pk_bf16_f32 v188, v188, v189
v_cvt_pk_bf16_f32 v189, v190, v191
buffer_load_dwordx4 a[124:127], v15, s[24:27], s53 offen offset:3072 sc1
v_cvt_pk_bf16_f32 v190, v56, v57
v_cvt_pk_bf16_f32 v191, v58, v59
buffer_store_dwordx4 v[188:191], v15, s[24:27], s52 offen offset:1024 sc1
v_pk_mul_f32 v[80:81], v[80:81], v[180:181]
v_pk_mul_f32 v[82:83], v[82:83], v[180:181]
v_pk_mul_f32 v[168:169], v[168:169], v[180:181]
v_pk_mul_f32 v[170:171], v[170:171], v[180:181]
v_cvt_pk_bf16_f32 v80, v80, v81
v_cvt_pk_bf16_f32 v81, v82, v83
v_cvt_pk_bf16_f32 v82, v168, v169
v_cvt_pk_bf16_f32 v83, v170, v171
buffer_store_dwordx4 v[80:83], v15, s[24:27], s52 offen offset:2048 sc1
v_pk_mul_f32 v[88:89], v[88:89], v[182:183]
v_pk_mul_f32 v[90:91], v[90:91], v[182:183]
v_pk_mul_f32 v[192:193], v[192:193], v[182:183]
v_pk_mul_f32 v[194:195], v[194:195], v[182:183]
v_cvt_pk_bf16_f32 v88, v88, v89
v_cvt_pk_bf16_f32 v89, v90, v91
v_cvt_pk_bf16_f32 v90, v192, v193
v_cvt_pk_bf16_f32 v91, v194, v195
buffer_store_dwordx4 v[88:91], v15, s[24:27], s52 offen offset:3072 sc1
L_PAD9:
s_cbranch_execz L_PAD13
s_mov_b32 s76, 1
L_NS:
s_mov_b32 s74, s73
s_mov_b32 s93, s73
s_cmp_eq_u32 s72, 32
s_cbranch_scc1 L_FIN
L_SINGLE:
v_mfma_f32_16x16x32_bf16 v[44:47], a[192:195], a[48:51], v[128:131]
s_barrier
v_mfma_f32_16x16x32_bf16 v[44:47], a[196:199], a[52:55], v[44:47]
s_cmp_eq_u32 s68, s71
v_exp_f32 v229, v229
v_mfma_f32_16x16x32_bf16 v[44:47], a[200:203], a[0:3], v[44:47]
s_cselect_b32 s64, s77, s68
v_add_u32 v5, s75, v4
v_cvt_pk_bf16_f32 v234, v228, v229
v_mfma_f32_16x16x32_bf16 v[44:47], a[204:207], a[8:11], v[44:47]
s_mov_b32 m0, s70
v_exp_f32 v230, v230
v_mfma_f32_16x16x32_bf16 v[52:55], a[192:195], a[60:63], v[136:139]
buffer_load_dwordx4 v15, s[24:27], s64 offen offset:0 sc1 lds
v_mfma_f32_16x16x32_bf16 v[52:55], a[196:199], a[56:59], v[52:55]
s_add_u32 s75, s75, 16384
v_exp_f32 v231, v231
v_mfma_f32_16x16x32_bf16 v[52:55], a[200:203], a[16:19], v[52:55]
ds_read_b128 a[192:195], v5 offset:0
v_cvt_pk_bf16_f32 v235, v230, v231
v_mfma_f32_16x16x32_bf16 v[52:55], a[204:207], a[24:27], v[52:55]
s_cmp_ge_u32 s75, 163840
v_exp_f32 v44, v44
v_mfma_f32_16x16x32_bf16 v[64:67], a[208:211], a[48:51], v[144:147]
ds_read_b128 a[196:199], v5 offset:1024
ds_read_b128 a[200:203], v5 offset:2048
v_mfma_f32_16x16x32_bf16 v[64:67], a[212:215], a[52:55], v[64:67]
s_cselect_b32 s75, 0, s75
v_exp_f32 v45, v45
v_mfma_f32_16x16x32_bf16 v[64:67], a[216:219], a[0:3], v[64:67]
ds_read_b128 a[204:207], v5 offset:3072
v_cvt_pk_bf16_f32 v124, v44, v45
v_mfma_f32_16x16x32_bf16 v[64:67], a[220:223], a[8:11], v[64:67]
s_add_u32 s68, s64, 16384
v_exp_f32 v46, v46
v_mfma_f32_16x16x32_bf16 v[212:215], a[208:211], a[60:63], v[152:155]
buffer_load_dwordx4 v15, s[24:27], s64 offen offset:1024 sc1 lds
v_mfma_f32_16x16x32_bf16 v[212:215], a[212:215], a[56:59], v[212:215]
s_add_u32 s70, s70, 16384
v_exp_f32 v47, v47
v_mfma_f32_16x16x32_bf16 v[212:215], a[216:219], a[16:19], v[212:215]
ds_read_b128 a[208:211], v5 offset:4096
v_cvt_pk_bf16_f32 v125, v46, v47
v_mfma_f32_16x16x32_bf16 v[212:215], a[220:223], a[24:27], v[212:215]
s_waitcnt lgkmcnt(5)
v_exp_f32 v52, v52
v_mfma_f32_16x16x32_bf16 v[60:63], a[64:67], v[248:251], v[60:63]
ds_read_b128 a[212:215], v5 offset:5120
ds_read_b128 a[216:219], v5 offset:6144
v_mfma_f32_16x16x32_bf16 v[148:151], a[64:67], v[232:235], v[148:151]
s_cmp_ge_u32 s70, 163840
v_exp_f32 v53, v53
v_mfma_f32_16x16x32_bf16 v[48:51], a[68:71], v[232:235], v[48:51]
ds_read_b128 a[220:223], v5 offset:7168
v_cvt_pk_bf16_f32 v140, v52, v53
v_mfma_f32_16x16x32_bf16 v[68:71], a[68:71], v[248:251], v[68:71]
s_cselect_b32 s70, s80, s70
v_exp_f32 v54, v54
v_mfma_f32_16x16x32_bf16 v[72:75], a[72:75], v[248:251], v[72:75]
buffer_load_dwordx4 v15, s[24:27], s64 offen offset:2048 sc1 lds
v_mfma_f32_16x16x32_bf16 v[236:239], a[72:75], v[232:235], v[236:239]
v_exp_f32 v55, v55
v_mfma_f32_16x16x32_bf16 v[224:227], a[76:79], v[232:235], v[224:227]
ds_read_b128 a[64:67], v5 offset:8192
v_cvt_pk_bf16_f32 v141, v54, v55
v_mfma_f32_16x16x32_bf16 v[220:223], a[76:79], v[248:251], v[220:223]
v_exp_f32 v64, v64
v_mfma_f32_16x16x32_bf16 v[84:87], a[80:83], v[248:251], v[84:87]
ds_read_b128 a[68:71], v5 offset:9216
ds_read_b128 a[72:75], v5 offset:10240
v_mfma_f32_16x16x32_bf16 v[164:167], a[80:83], v[232:235], v[164:167]
v_exp_f32 v65, v65
v_mfma_f32_16x16x32_bf16 v[156:159], a[84:87], v[232:235], v[156:159]
ds_read_b128 a[76:79], v5 offset:11264
v_cvt_pk_bf16_f32 v126, v64, v65
v_mfma_f32_16x16x32_bf16 v[76:79], a[84:87], v[248:251], v[76:79]
s_cmp_eq_u32 s68, s71
v_exp_f32 v66, v66
v_mfma_f32_16x16x32_bf16 v[160:163], a[88:91], v[248:251], v[160:163]
buffer_load_dwordx4 v15, s[24:27], s64 offen offset:3072 sc1 lds
v_mfma_f32_16x16x32_bf16 v[216:219], a[88:91], v[232:235], v[216:219]
s_cselect_b32 s64, s77, s68
v_exp_f32 v67, v67
v_mfma_f32_16x16x32_bf16 v[208:211], a[92:95], v[232:235], v[208:211]
ds_read_b128 a[80:83], v5 offset:12288
v_cvt_pk_bf16_f32 v127, v66, v67
v_mfma_f32_16x16x32_bf16 v[252:255], a[92:95], v[248:251], v[252:255]
s_waitcnt lgkmcnt(5)
v_exp_f32 v212, v212
v_mfma_f32_16x16x32_bf16 a[232:235], a[240:243], v[248:251], a[232:235]
ds_read_b128 a[84:87], v5 offset:13312
ds_read_b128 a[88:91], v5 offset:14336
v_mfma_f32_16x16x32_bf16 a[236:239], a[240:243], v[232:235], a[236:239]
s_mov_b32 m0, s70
ds_read_b128 a[92:95], v5 offset:15360
v_mfma_f32_16x16x32_bf16 v[100:103], a[192:195], a[48:51], v[128:131]
buffer_load_dwordx4 v15, s[24:27], s64 offen offset:0 sc1 lds
v_mfma_f32_16x16x32_bf16 v[100:103], a[196:199], a[52:55], v[100:103]
v_exp_f32 v213, v213
v_mfma_f32_16x16x32_bf16 v[100:103], a[200:203], a[0:3], v[100:103]
v_add_u32 v5, s75, v4
v_cvt_pk_bf16_f32 v142, v212, v213
v_mfma_f32_16x16x32_bf16 v[100:103], a[204:207], a[8:11], v[100:103]
v_exp_f32 v214, v214
v_mfma_f32_16x16x32_bf16 v[92:95], a[192:195], a[60:63], v[136:139]
buffer_load_dwordx4 v15, s[24:27], s64 offen offset:1024 sc1 lds
v_mfma_f32_16x16x32_bf16 v[92:95], a[196:199], a[56:59], v[92:95]
s_add_u32 s75, s75, 16384
v_exp_f32 v215, v215
v_mfma_f32_16x16x32_bf16 v[92:95], a[200:203], a[16:19], v[92:95]
ds_read_b128 a[192:195], v5 offset:0
v_cvt_pk_bf16_f32 v143, v214, v215
v_mfma_f32_16x16x32_bf16 v[92:95], a[204:207], a[24:27], v[92:95]
s_cmp_ge_u32 s75, 163840
v_exp_f32 v100, v100
v_mfma_f32_16x16x32_bf16 v[176:179], a[208:211], a[48:51], v[144:147]
ds_read_b128 a[196:199], v5 offset:1024
ds_read_b128 a[200:203], v5 offset:2048
v_mfma_f32_16x16x32_bf16 v[176:179], a[212:215], a[52:55], v[176:179]
s_cselect_b32 s75, 0, s75
v_exp_f32 v101, v101
v_mfma_f32_16x16x32_bf16 v[176:179], a[216:219], a[0:3], v[176:179]
ds_read_b128 a[204:207], v5 offset:3072
v_cvt_pk_bf16_f32 v248, v100, v101
v_mfma_f32_16x16x32_bf16 v[176:179], a[220:223], a[8:11], v[176:179]
s_add_u32 s68, s64, 16384
v_exp_f32 v102, v102
v_mfma_f32_16x16x32_bf16 v[228:231], a[208:211], a[60:63], v[152:155]
buffer_load_dwordx4 v15, s[24:27], s64 offen offset:2048 sc1 lds
v_mfma_f32_16x16x32_bf16 v[228:231], a[212:215], a[56:59], v[228:231]
s_add_u32 s70, s70, 16384
v_exp_f32 v103, v103
v_mfma_f32_16x16x32_bf16 v[228:231], a[216:219], a[16:19], v[228:231]
ds_read_b128 a[208:211], v5 offset:4096
v_cvt_pk_bf16_f32 v249, v102, v103
v_mfma_f32_16x16x32_bf16 v[228:231], a[220:223], a[24:27], v[228:231]
s_waitcnt lgkmcnt(5)
v_exp_f32 v92, v92
v_mfma_f32_16x16x32_bf16 v[60:63], a[64:67], v[124:127], v[60:63]
ds_read_b128 a[212:215], v5 offset:5120
ds_read_b128 a[216:219], v5 offset:6144
v_mfma_f32_16x16x32_bf16 v[148:151], a[64:67], v[140:143], v[148:151]
s_cmp_ge_u32 s70, 163840
v_exp_f32 v93, v93
v_mfma_f32_16x16x32_bf16 v[48:51], a[68:71], v[140:143], v[48:51]
ds_read_b128 a[220:223], v5 offset:7168
v_cvt_pk_bf16_f32 v232, v92, v93
v_mfma_f32_16x16x32_bf16 v[68:71], a[68:71], v[124:127], v[68:71]
s_cselect_b32 s70, s80, s70
v_exp_f32 v94, v94
v_mfma_f32_16x16x32_bf16 v[72:75], a[72:75], v[124:127], v[72:75]
buffer_load_dwordx4 v15, s[24:27], s64 offen offset:3072 sc1 lds
v_mfma_f32_16x16x32_bf16 v[236:239], a[72:75], v[140:143], v[236:239]
s_add_u32 s72, s72, 1
v_exp_f32 v95, v95
v_mfma_f32_16x16x32_bf16 v[224:227], a[76:79], v[140:143], v[224:227]
ds_read_b128 a[64:67], v5 offset:8192
v_cvt_pk_bf16_f32 v233, v94, v95
v_mfma_f32_16x16x32_bf16 v[220:223], a[76:79], v[124:127], v[220:223]
v_exp_f32 v176, v176
v_mfma_f32_16x16x32_bf16 v[84:87], a[80:83], v[124:127], v[84:87]
ds_read_b128 a[68:71], v5 offset:9216
ds_read_b128 a[72:75], v5 offset:10240
v_mfma_f32_16x16x32_bf16 v[164:167], a[80:83], v[140:143], v[164:167]
v_exp_f32 v177, v177
v_mfma_f32_16x16x32_bf16 v[156:159], a[84:87], v[140:143], v[156:159]
ds_read_b128 a[76:79], v5 offset:11264
v_cvt_pk_bf16_f32 v250, v176, v177
v_mfma_f32_16x16x32_bf16 v[76:79], a[84:87], v[124:127], v[76:79]
v_exp_f32 v178, v178
v_mfma_f32_16x16x32_bf16 v[160:163], a[88:91], v[124:127], v[160:163]
ds_read_b128 a[80:83], v5 offset:12288
ds_read_b128 a[84:87], v5 offset:13312
v_mfma_f32_16x16x32_bf16 v[216:219], a[88:91], v[140:143], v[216:219]
s_cmp_lt_u32 s72, s74
v_exp_f32 v179, v179
v_mfma_f32_16x16x32_bf16 v[208:211], a[92:95], v[140:143], v[208:211]
ds_read_b128 a[88:91], v5 offset:14336
v_cvt_pk_bf16_f32 v251, v178, v179
v_mfma_f32_16x16x32_bf16 v[252:255], a[92:95], v[124:127], v[252:255]
s_waitcnt vmcnt(8) lgkmcnt(7)
v_exp_f32 v228, v228
v_mfma_f32_16x16x32_bf16 a[232:235], a[240:243], v[124:127], a[232:235]
ds_read_b128 a[92:95], v5 offset:15360
v_mfma_f32_16x16x32_bf16 a[236:239], a[240:243], v[140:143], a[236:239]
s_cbranch_scc1 L_SINGLE
s_cmp_eq_u32 s72, s69
s_cbranch_scc1 L_SE
s_cmp_lt_u32 s72, 32
s_cbranch_scc1 L_STOP
L_FIN:
s_add_u32 s53, s77, 196608
buffer_load_dwordx4 a[160:163], v15, s[24:27], s53 offen offset:0 sc1
v_cndmask_b32 v128, v128, v6, s[56:57]
v_cndmask_b32 v152, v152, v6, s[56:57]
v_mov_b32 v144, v6
buffer_load_dwordx4 a[164:167], v15, s[24:27], s53 offen offset:1024 sc1
v_cndmask_b32 v129, v129, v6, s[58:59]
v_cndmask_b32 v153, v153, v6, s[58:59]
v_mov_b32 v145, v6
buffer_load_dwordx4 a[168:171], v15, s[24:27], s53 offen offset:2048 sc1
v_cndmask_b32 v130, v130, v6, s[60:61]
v_cndmask_b32 v154, v154, v6, s[60:61]
v_mov_b32 v146, v6
buffer_load_dwordx4 a[172:175], v15, s[24:27], s53 offen offset:3072 sc1
v_cndmask_b32 v131, v131, v6, s[62:63]
v_cndmask_b32 v155, v155, v6, s[62:63]
v_mov_b32 v147, v6
s_mov_b32 s83, s75
s_sub_u32 s91, s70, s80
v_mfma_f32_16x16x32_bf16 v[44:47], a[192:195], a[48:51], v[128:131]
s_barrier
v_mfma_f32_16x16x32_bf16 v[44:47], a[196:199], a[52:55], v[44:47]
s_mov_b32 m0, s70
v_exp_f32 v229, v229
v_mfma_f32_16x16x32_bf16 v[44:47], a[200:203], a[0:3], v[44:47]
s_mov_b32 s64, s68
v_add_u32 v5, s75, v4
v_cvt_pk_bf16_f32 v234, v228, v229
v_mfma_f32_16x16x32_bf16 v[44:47], a[204:207], a[8:11], v[44:47]
s_add_u32 s68, s68, 16384
v_exp_f32 v230, v230
v_mfma_f32_16x16x32_bf16 v[52:55], a[192:195], a[60:63], v[136:139]
buffer_load_dwordx4 v15, s[24:27], s64 offen offset:0 sc1 lds
v_mfma_f32_16x16x32_bf16 v[52:55], a[196:199], a[56:59], v[52:55]
s_add_u32 s70, s70, 16384
v_exp_f32 v231, v231
v_mfma_f32_16x16x32_bf16 v[52:55], a[200:203], a[16:19], v[52:55]
v_cvt_pk_bf16_f32 v235, v230, v231
v_mul_f32 v10, 0x3fb8aa3b, v10
v_mfma_f32_16x16x32_bf16 v[52:55], a[204:207], a[24:27], v[52:55]
s_cmp_ge_u32 s70, 163840
v_exp_f32 v44, v44
v_mfma_f32_16x16x32_bf16 v[64:67], a[208:211], a[48:51], v[144:147]
buffer_load_dwordx4 v15, s[24:27], s64 offen offset:1024 sc1 lds
v_mfma_f32_16x16x32_bf16 v[64:67], a[212:215], a[52:55], v[64:67]
s_cselect_b32 s70, s80, s70
v_exp_f32 v45, v45
v_mfma_f32_16x16x32_bf16 v[64:67], a[216:219], a[0:3], v[64:67]
v_cvt_pk_bf16_f32 v124, v44, v45
v_mul_f32 v11, 0x3fb8aa3b, v11
v_mfma_f32_16x16x32_bf16 v[64:67], a[220:223], a[8:11], v[64:67]
v_exp_f32 v46, v46
v_mfma_f32_16x16x32_bf16 v[212:215], a[208:211], a[60:63], v[152:155]
buffer_load_dwordx4 v15, s[24:27], s64 offen offset:2048 sc1 lds
v_mfma_f32_16x16x32_bf16 v[212:215], a[212:215], a[56:59], v[212:215]
v_exp_f32 v47, v47
v_mfma_f32_16x16x32_bf16 v[212:215], a[216:219], a[16:19], v[212:215]
v_cvt_pk_bf16_f32 v125, v46, v47
v_mfma_f32_16x16x32_bf16 v[212:215], a[220:223], a[24:27], v[212:215]
s_waitcnt lgkmcnt(0)
v_exp_f32 v52, v52
v_mfma_f32_16x16x32_bf16 v[60:63], a[64:67], v[248:251], v[60:63]
buffer_load_dwordx4 v15, s[24:27], s64 offen offset:3072 sc1 lds
v_mfma_f32_16x16x32_bf16 v[148:151], a[64:67], v[232:235], v[148:151]
s_mov_b32 m0, s70
v_exp_f32 v53, v53
v_mfma_f32_16x16x32_bf16 v[48:51], a[68:71], v[232:235], v[48:51]
s_mov_b32 s64, s68
ds_read_b128 a[64:67], v5 offset:8192
v_cvt_pk_bf16_f32 v140, v52, v53
v_mfma_f32_16x16x32_bf16 v[68:71], a[68:71], v[248:251], v[68:71]
s_add_u32 s68, s68, 16384
v_exp_f32 v54, v54
v_mfma_f32_16x16x32_bf16 v[72:75], a[72:75], v[248:251], v[72:75]
buffer_load_dwordx4 v15, s[24:27], s64 offen offset:0 sc1 lds
v_mfma_f32_16x16x32_bf16 v[236:239], a[72:75], v[232:235], v[236:239]
s_add_u32 s70, s70, 16384
v_exp_f32 v55, v55
v_mfma_f32_16x16x32_bf16 v[224:227], a[76:79], v[232:235], v[224:227]
ds_read_b128 a[68:71], v5 offset:9216
v_cvt_pk_bf16_f32 v141, v54, v55
v_mfma_f32_16x16x32_bf16 v[220:223], a[76:79], v[248:251], v[220:223]
s_cmp_ge_u32 s70, 163840
v_exp_f32 v64, v64
v_mfma_f32_16x16x32_bf16 v[84:87], a[80:83], v[248:251], v[84:87]
ds_read_b128 a[72:75], v5 offset:10240
v_mfma_f32_16x16x32_bf16 v[164:167], a[80:83], v[232:235], v[164:167]
s_cselect_b32 s70, s80, s70
v_exp_f32 v65, v65
v_mfma_f32_16x16x32_bf16 v[156:159], a[84:87], v[232:235], v[156:159]
ds_read_b128 a[76:79], v5 offset:11264
v_cvt_pk_bf16_f32 v126, v64, v65
v_mfma_f32_16x16x32_bf16 v[76:79], a[84:87], v[248:251], v[76:79]
v_exp_f32 v66, v66
v_mfma_f32_16x16x32_bf16 v[160:163], a[88:91], v[248:251], v[160:163]
buffer_load_dwordx4 v15, s[24:27], s64 offen offset:1024 sc1 lds
v_mfma_f32_16x16x32_bf16 v[216:219], a[88:91], v[232:235], v[216:219]
s_add_u32 s52, s79, 4096
v_exp_f32 v67, v67
v_mfma_f32_16x16x32_bf16 v[208:211], a[92:95], v[232:235], v[208:211]
ds_read_b128 a[80:83], v5 offset:12288
v_cvt_pk_bf16_f32 v127, v66, v67
v_mfma_f32_16x16x32_bf16 v[252:255], a[92:95], v[248:251], v[252:255]
v_exp_f32 v212, v212
v_mfma_f32_16x16x32_bf16 a[232:235], a[240:243], v[248:251], a[232:235]
ds_read_b128 a[84:87], v5 offset:13312
ds_read_b128 a[88:91], v5 offset:14336
v_mfma_f32_16x16x32_bf16 a[236:239], a[240:243], v[232:235], a[236:239]
ds_read_b128 a[92:95], v5 offset:15360
v_exp_f32 v213, v213
v_exp_f32 v214, v214
v_exp_f32 v215, v215
v_exp_f32 v10, v10
v_cvt_pk_bf16_f32 v142, v212, v213
v_cvt_pk_bf16_f32 v143, v214, v215
v_exp_f32 v11, v11
s_waitcnt lgkmcnt(0)
v_mfma_f32_16x16x32_bf16 a[232:235], a[240:243], v[124:127], a[232:235]
buffer_load_dwordx4 v15, s[24:27], s64 offen offset:2048 sc1 lds
v_mfma_f32_16x16x32_bf16 a[236:239], a[240:243], v[140:143], a[236:239]
s_barrier
v_mfma_f32_16x16x32_bf16 v[60:63], a[64:67], v[124:127], v[60:63]
v_cmp_eq_u32 vcc, 0, v3
v_mul_u32_u24 v244, 1536, v3
v_mfma_f32_16x16x32_bf16 v[148:151], a[64:67], v[140:143], v[148:151]
v_mov_b32 v246, 9728
v_cndmask_b32 v244, v244, v246, vcc
v_mfma_f32_16x16x32_bf16 v[48:51], a[68:71], v[140:143], v[48:51]
buffer_load_dwordx4 v15, s[24:27], s64 offen offset:3072 sc1 lds
v_mfma_f32_16x16x32_bf16 v[68:71], a[68:71], v[124:127], v[68:71]
v_lshl_add_u32 v247, v2, 4, s83
v_mov_b32 v246, 10496
v_mfma_f32_16x16x32_bf16 v[72:75], a[72:75], v[124:127], v[72:75]
v_accvgpr_read_b32 v180, a232
v_accvgpr_read_b32 v182, a236
v_mfma_f32_16x16x32_bf16 v[236:239], a[72:75], v[140:143], v[236:239]
v_cmp_nle_f32 vcc, v180, v7
v_cmp_nle_f32 s[96:97], v182, v7
v_mfma_f32_16x16x32_bf16 v[224:227], a[76:79], v[140:143], v[224:227]
v_fma_f32 v180, v180, v10, v180
v_fma_f32 v182, v182, v11, v182
v_mfma_f32_16x16x32_bf16 v[220:223], a[76:79], v[124:127], v[220:223]
v_rcp_f32 v180, v180
v_mfma_f32_16x16x32_bf16 v[84:87], a[80:83], v[124:127], v[84:87]
s_or_b64 vcc, vcc, s[96:97]
v_rcp_f32 v182, v182
v_mfma_f32_16x16x32_bf16 v[164:167], a[80:83], v[140:143], v[164:167]
v_mul_f32 v60, v180, v60
v_mul_f32 v61, v180, v61
v_mfma_f32_16x16x32_bf16 v[156:159], a[84:87], v[140:143], v[156:159]
v_mul_f32 v62, v180, v62
v_mul_f32 v63, v180, v63
v_mfma_f32_16x16x32_bf16 v[76:79], a[84:87], v[124:127], v[76:79]
v_mul_f32 v68, v180, v68
v_mul_f32 v69, v180, v69
v_mfma_f32_16x16x32_bf16 v[160:163], a[88:91], v[124:127], v[160:163]
v_mul_f32 v70, v180, v70
v_mul_f32 v71, v180, v71
v_mfma_f32_16x16x32_bf16 v[216:219], a[88:91], v[140:143], v[216:219]
v_cvt_pk_bf16_f32 v60, v60, v61
v_cvt_pk_bf16_f32 v61, v62, v63
v_mfma_f32_16x16x32_bf16 v[208:211], a[92:95], v[140:143], v[208:211]
v_cvt_pk_bf16_f32 v62, v68, v69
v_cvt_pk_bf16_f32 v63, v70, v71
v_mfma_f32_16x16x32_bf16 v[252:255], a[92:95], v[124:127], v[252:255]
s_cbranch_vccnz SLOW1
L_EP:
buffer_store_dwordx4 v[60:63], v15, s[24:27], s79 offen offset:0 sc1
v_pk_mul_f32 v[148:149], v[148:149], v[182:183] op_sel_hi:[1,0]
v_pk_mul_f32 v[150:151], v[150:151], v[182:183] op_sel_hi:[1,0]
v_pk_mul_f32 v[48:49], v[48:49], v[182:183] op_sel_hi:[1,0]
v_pk_mul_f32 v[50:51], v[50:51], v[182:183] op_sel_hi:[1,0]
v_cvt_pk_bf16_f32 v148, v148, v149
v_cvt_pk_bf16_f32 v149, v150, v151
v_cvt_pk_bf16_f32 v150, v48, v49
v_cvt_pk_bf16_f32 v151, v50, v51
buffer_store_dwordx4 v[148:151], v15, s[24:27], s79 offen offset:1024 sc1
v_pk_mul_f32 v[72:73], v[72:73], v[180:181] op_sel_hi:[1,0]
v_pk_mul_f32 v[74:75], v[74:75], v[180:181] op_sel_hi:[1,0]
v_pk_mul_f32 v[220:221], v[220:221], v[180:181] op_sel_hi:[1,0]
v_pk_mul_f32 v[222:223], v[222:223], v[180:181] op_sel_hi:[1,0]
v_cvt_pk_bf16_f32 v72, v72, v73
v_cvt_pk_bf16_f32 v73, v74, v75
v_cvt_pk_bf16_f32 v74, v220, v221
v_cvt_pk_bf16_f32 v75, v222, v223
buffer_store_dwordx4 v[72:75], v15, s[24:27], s79 offen offset:2048 sc1
v_pk_mul_f32 v[236:237], v[236:237], v[182:183] op_sel_hi:[1,0]
v_pk_mul_f32 v[238:239], v[238:239], v[182:183] op_sel_hi:[1,0]
v_pk_mul_f32 v[224:225], v[224:225], v[182:183] op_sel_hi:[1,0]
v_pk_mul_f32 v[226:227], v[226:227], v[182:183] op_sel_hi:[1,0]
v_cvt_pk_bf16_f32 v236, v236, v237
v_cvt_pk_bf16_f32 v237, v238, v239
v_cvt_pk_bf16_f32 v238, v224, v225
v_cvt_pk_bf16_f32 v239, v226, v227
buffer_store_dwordx4 v[236:239], v15, s[24:27], s79 offen offset:3072 sc1
v_pk_mul_f32 v[84:85], v[84:85], v[180:181] op_sel_hi:[1,0]
v_pk_mul_f32 v[86:87], v[86:87], v[180:181] op_sel_hi:[1,0]
v_pk_mul_f32 v[76:77], v[76:77], v[180:181] op_sel_hi:[1,0]
v_pk_mul_f32 v[78:79], v[78:79], v[180:181] op_sel_hi:[1,0]
v_cvt_pk_bf16_f32 v84, v84, v85
v_cvt_pk_bf16_f32 v85, v86, v87
v_cvt_pk_bf16_f32 v86, v76, v77
v_cvt_pk_bf16_f32 v87, v78, v79
buffer_store_dwordx4 v[84:87], v15, s[24:27], s52 offen offset:0 sc1
v_pk_mul_f32 v[164:165], v[164:165], v[182:183] op_sel_hi:[1,0]
v_pk_mul_f32 v[166:167], v[166:167], v[182:183] op_sel_hi:[1,0]
v_pk_mul_f32 v[156:157], v[156:157], v[182:183] op_sel_hi:[1,0]
v_pk_mul_f32 v[158:159], v[158:159], v[182:183] op_sel_hi:[1,0]
v_cvt_pk_bf16_f32 v164, v164, v165
v_cvt_pk_bf16_f32 v165, v166, v167
v_cvt_pk_bf16_f32 v166, v156, v157
v_cvt_pk_bf16_f32 v167, v158, v159
buffer_store_dwordx4 v[164:167], v15, s[24:27], s52 offen offset:1024 sc1
v_pk_mul_f32 v[160:161], v[160:161], v[180:181] op_sel_hi:[1,0]
v_pk_mul_f32 v[162:163], v[162:163], v[180:181] op_sel_hi:[1,0]
v_pk_mul_f32 v[252:253], v[252:253], v[180:181] op_sel_hi:[1,0]
v_pk_mul_f32 v[254:255], v[254:255], v[180:181] op_sel_hi:[1,0]
v_cvt_pk_bf16_f32 v160, v160, v161
v_cvt_pk_bf16_f32 v161, v162, v163
v_cvt_pk_bf16_f32 v162, v252, v253
v_cvt_pk_bf16_f32 v163, v254, v255
buffer_store_dwordx4 v[160:163], v15, s[24:27], s52 offen offset:2048 sc1
v_pk_mul_f32 v[216:217], v[216:217], v[182:183] op_sel_hi:[1,0]
v_pk_mul_f32 v[218:219], v[218:219], v[182:183] op_sel_hi:[1,0]
v_pk_mul_f32 v[208:209], v[208:209], v[182:183] op_sel_hi:[1,0]
v_pk_mul_f32 v[210:211], v[210:211], v[182:183] op_sel_hi:[1,0]
v_cvt_pk_bf16_f32 v216, v216, v217
v_cvt_pk_bf16_f32 v217, v218, v219
v_cvt_pk_bf16_f32 v218, v208, v209
v_cvt_pk_bf16_f32 v219, v210, v211
buffer_store_dwordx4 v[216:219], v15, s[24:27], s52 offen offset:3072 sc1
v_cmp_eq_u32 vcc, 3, v3
v_mul_u32_u24 v200, 768, v3
v_add_u32 v200, v200, v247
ds_write_b128 v200, a[244:247] offset:0
v_cndmask_b32 v245, v244, v246, vcc
ds_write_b128 v200, a[248:251] offset:3072
v_add_u32 v247, -1280, v247
ds_write_b128 v200, a[252:255] offset:6144
v_add_u32 v244, v244, v247
v_add_u32 v245, v245, v247
ds_write_b128 v244, a[128:131] offset:0
v_cmp_lt_u32 vcc, 31, v1
ds_write_b128 v245, a[132:135] offset:768
v_and_b32 v202, 31, v1
ds_write_b128 v244, a[136:139] offset:256
v_mov_b32 v200, s66
ds_write_b128 v245, a[140:143] offset:1024
v_mov_b32 v203, s67
ds_write_b128 v244, a[144:147] offset:3840
v_cndmask_b32 v200, v200, v203, vcc
ds_write_b128 v245, a[148:151] offset:4608
v_lshl_add_u32 v200, v200, 5, v202
ds_write_b128 v244, a[152:155] offset:4096
v_lshrrev_b32 v201, 5, v1
ds_write_b128 v245, a[156:159] offset:4864
v_mul_u32_u24 v201, 3840, v201
v_lshl_add_u32 v201, v202, 4, v201
v_add_u32 v201, s83, v201
s_cmp_eq_u32 s76, 0
s_cbranch_scc1 L_SE2
L_LA:
v_mov_b32 v5, v200
v_mov_b32 v6, v201
v_mov_b32 v13, 0
s_lshl_b32 s74, s66, 10
s_lshr_b32 s52, s4, 3
s_lshl_b32 s52, s52, 8
s_add_u32 s74, s74, s52
s_add_u32 s74, s74, 75530240
ds_read_b128 v[16:19], v6 offset:8448
ds_read_b128 v[20:23], v6 offset:9216
ds_read_b128 v[96:99], v6 offset:3328
ds_read_b128 v[32:35], v6 offset:256
ds_read_b128 v[36:39], v6 offset:1024
ds_read_b128 v[100:103], v6 offset:3296
ds_read_b128 v[40:43], v6 offset:224
ds_read_b128 v[44:47], v6 offset:992
ds_read_b128 v[104:107], v6 offset:3264
ds_read_b128 v[48:51], v6 offset:192
ds_read_b128 v[52:55], v6 offset:960
ds_read_b128 v[108:111], v6 offset:3232
ds_read_b128 v[56:59], v6 offset:160
ds_read_b128 v[60:63], v6 offset:928
ds_read_b128 v[112:115], v6 offset:3200
ds_read_b128 v[64:67], v6 offset:128
ds_read_b128 v[68:71], v6 offset:896
ds_read_b128 v[116:119], v6 offset:3168
ds_read_b128 v[72:75], v6 offset:96
ds_read_b128 v[76:79], v6 offset:864
ds_read_b128 v[120:123], v6 offset:3136
ds_read_b128 v[80:83], v6 offset:64
ds_read_b128 v[84:87], v6 offset:832
ds_read_b128 v[124:127], v6 offset:3104
ds_read_b128 v[88:91], v6 offset:32
ds_read_b128 v[92:95], v6 offset:800
ds_read_b128 v[128:131], v6 offset:1792
ds_read_b128 v[132:135], v6 offset:2560
s_waitcnt vmcnt(0)
buffer_atomic_add v1, v0, s[24:27], s74 offen offset:0 sc1
ds_read_b128 v[136:139], v6 offset:1760
ds_read_b128 v[140:143], v6 offset:2528
ds_read_b128 v[144:147], v6 offset:1728
ds_read_b128 v[148:151], v6 offset:2496
ds_read_b128 v[152:155], v6 offset:1696
ds_read_b128 v[156:159], v6 offset:2464
ds_read_b128 v[160:163], v6 offset:1664
ds_read_b128 v[164:167], v6 offset:2432
ds_read_b128 v[168:171], v6 offset:1632
ds_read_b128 v[172:175], v6 offset:2400
ds_read_b128 v[176:179], v6 offset:1600
ds_read_b128 v[180:183], v6 offset:2368
ds_read_b128 v[184:187], v6 offset:1568
ds_read_b128 v[188:191], v6 offset:2336
s_lshr_b32 s52, s3, 1
s_lshl1_add_u32 s72, s85, s52
s_lshl2_add_u32 s75, s72, s84
s_lshl_b32 s75, s75, 8
s_add_u32 s75, s75, 75530240
s_and_b32 s82, s86, 1
s_lshl_b32 s82, s82, 13
s_lshr_b32 s53, s4, 3
s_mul_i32 s53, s53, 75776
s_add_u32 s53, s53, 54525952
s_and_b32 s52, s3, 1
s_lshl_b32 s52, s52, 10
s_add_u32 s52, s52, s53
s_sub_u32 s54, 63, s72
s_mul_i32 s77, s72, 303104
s_add_u32 s77, s77, s52
s_mul_i32 s81, s54, 303104
s_add_u32 s81, s81, s52
s_add_u32 s91, s91, 114688
s_sub_u32 s52, s91, 163840
s_cmp_ge_u32 s91, 163840
s_cselect_b32 s91, s52, s91
v_add_u32 v14, 4096, v15
v_add_u32 v7, s91, v4
s_waitcnt lgkmcnt(0)
s_barrier
s_mov_b32 m0, s70
s_mov_b32 s64, s68
s_add_u32 s68, s68, 16384
s_add_u32 s70, s70, 16384
s_cmp_ge_u32 s70, 163840
s_cselect_b32 s70, s80, s70
buffer_load_dwordx4 v15, s[24:27], s64 offen offset:0 sc1 lds
v_and_b32 v9, 0xffff, v97
v_and_b32 v11, 0xffff0000, v97
v_dot2_f32_bf16 v24, v98, v99, 0
v_dot2_f32_bf16 v25, v102, v99, 0
v_dot2_f32_bf16 v26, v106, v99, 0
v_dot2_f32_bf16 v27, v110, v99, 0
v_dot2_f32_bf16 v28, v114, v99, 0
v_dot2_f32_bf16 v29, v118, v99, 0
v_dot2_f32_bf16 v30, v122, v99, 0
v_dot2_f32_bf16 v31, v126, v99, 0
v_dot2c_f32_bf16 v24, v96, v9
buffer_load_dwordx4 v15, s[24:27], s64 offen offset:1024 sc1 lds
v_dot2c_f32_bf16 v25, v100, v9
v_dot2c_f32_bf16 v26, v104, v9
v_dot2c_f32_bf16 v27, v108, v9
v_dot2c_f32_bf16 v28, v112, v9
v_dot2c_f32_bf16 v29, v116, v9
v_dot2c_f32_bf16 v30, v120, v9
v_dot2c_f32_bf16 v31, v124, v9
v_dot2c_f32_bf16 v24, v16, v32
v_dot2c_f32_bf16 v25, v16, v40
v_dot2c_f32_bf16 v26, v16, v48
v_dot2c_f32_bf16 v27, v16, v56
buffer_load_dwordx4 v15, s[24:27], s64 offen offset:2048 sc1 lds
v_dot2c_f32_bf16 v28, v16, v64
v_dot2c_f32_bf16 v29, v16, v72
v_dot2c_f32_bf16 v30, v16, v80
v_dot2c_f32_bf16 v31, v16, v88
v_dot2c_f32_bf16 v24, v17, v33
v_dot2c_f32_bf16 v25, v17, v41
v_dot2c_f32_bf16 v26, v17, v49
v_dot2c_f32_bf16 v27, v17, v57
v_dot2c_f32_bf16 v28, v17, v65
v_dot2c_f32_bf16 v29, v17, v73
v_dot2c_f32_bf16 v30, v17, v81
buffer_load_dwordx4 v15, s[24:27], s64 offen offset:3072 sc1 lds
v_dot2c_f32_bf16 v31, v17, v89
v_dot2c_f32_bf16 v24, v18, v34
v_dot2c_f32_bf16 v25, v18, v42
v_dot2c_f32_bf16 v26, v18, v50
v_dot2c_f32_bf16 v27, v18, v58
v_dot2c_f32_bf16 v28, v18, v66
v_dot2c_f32_bf16 v29, v18, v74
v_dot2c_f32_bf16 v30, v18, v82
v_dot2c_f32_bf16 v31, v18, v90
v_dot2c_f32_bf16 v24, v19, v35
v_dot2c_f32_bf16 v25, v19, v43
s_mov_b32 m0, s70
s_mov_b32 s64, s68
s_add_u32 s68, s68, 16384
s_add_u32 s70, s70, 16384
s_cmp_ge_u32 s70, 163840
s_cselect_b32 s70, s80, s70
buffer_load_dwordx4 v15, s[24:27], s64 offen offset:0 sc1 lds
v_dot2c_f32_bf16 v26, v19, v51
v_dot2c_f32_bf16 v27, v19, v59
v_dot2c_f32_bf16 v28, v19, v67
v_dot2c_f32_bf16 v29, v19, v75
v_dot2c_f32_bf16 v30, v19, v83
v_dot2c_f32_bf16 v31, v19, v91
v_dot2c_f32_bf16 v24, v20, v36
v_dot2c_f32_bf16 v25, v20, v44
v_dot2c_f32_bf16 v26, v20, v52
v_dot2c_f32_bf16 v27, v20, v60
v_dot2c_f32_bf16 v28, v20, v68
buffer_load_dwordx4 v15, s[24:27], s64 offen offset:1024 sc1 lds
v_dot2c_f32_bf16 v29, v20, v76
v_dot2c_f32_bf16 v30, v20, v84
v_dot2c_f32_bf16 v31, v20, v92
v_dot2c_f32_bf16 v24, v21, v37
v_dot2c_f32_bf16 v25, v21, v45
v_dot2c_f32_bf16 v26, v21, v53
v_dot2c_f32_bf16 v27, v21, v61
v_dot2c_f32_bf16 v28, v21, v69
v_dot2c_f32_bf16 v29, v21, v77
v_dot2c_f32_bf16 v30, v21, v85
v_dot2c_f32_bf16 v31, v21, v93
buffer_load_dwordx4 v15, s[24:27], s64 offen offset:2048 sc1 lds
v_dot2c_f32_bf16 v24, v22, v38
v_dot2c_f32_bf16 v25, v22, v46
L_PAD10:
s_cbranch_execz L_MAIN
v_dot2c_f32_bf16 v26, v22, v54
v_dot2c_f32_bf16 v27, v22, v62
v_dot2c_f32_bf16 v28, v22, v70
v_dot2c_f32_bf16 v29, v22, v78
v_dot2c_f32_bf16 v30, v22, v86
v_dot2c_f32_bf16 v31, v22, v94
v_dot2c_f32_bf16 v24, v23, v39
v_dot2c_f32_bf16 v25, v23, v47
v_dot2c_f32_bf16 v26, v23, v55
buffer_load_dwordx4 v15, s[24:27], s64 offen offset:3072 sc1 lds
v_dot2c_f32_bf16 v27, v23, v63
v_dot2c_f32_bf16 v28, v23, v71
v_dot2c_f32_bf16 v29, v23, v79
v_dot2c_f32_bf16 v30, v23, v87
v_dot2c_f32_bf16 v31, v23, v95
v_mov_b32 v9, 0xf149f2ca
v_mul_f32 v11, 0xbfb8aa3b, v11
v_exp_f32 v11, v11
v_cmp_gt_u32 vcc, 2, v5
v_cmp_gt_u32 s[56:57], 4, v5
s_nop 0
s_mov_b32 m0, s70
s_mov_b32 s64, s68
s_add_u32 s68, s68, 16384
s_add_u32 s70, s70, 16384
s_cmp_ge_u32 s70, 163840
s_cselect_b32 s70, s80, s70
buffer_load_dwordx4 v15, s[24:27], s64 offen offset:0 sc1 lds
v_cndmask_b32 v25, v25, v9, vcc
v_cndmask_b32 v26, v26, v9, s[56:57]
v_cmp_gt_u32 vcc, 6, v5
v_cmp_gt_u32 s[56:57], 8, v5
s_nop 0
v_cndmask_b32 v27, v27, v9, vcc
v_cndmask_b32 v28, v28, v9, s[56:57]
v_cmp_gt_u32 vcc, 10, v5
v_cmp_gt_u32 s[56:57], 12, v5
s_nop 0
v_cndmask_b32 v29, v29, v9, vcc
buffer_load_dwordx4 v15, s[24:27], s64 offen offset:1024 sc1 lds
v_cndmask_b32 v30, v30, v9, s[56:57]
v_cmp_gt_u32 vcc, 14, v5
s_nop 0
s_nop 0
v_cndmask_b32 v31, v31, v9, vcc
v_max3_f32 v10, v24, v25, v26
v_max3_f32 v10, v10, v27, v28
v_max3_f32 v10, v10, v29, v30
v_max_f32 v10, v10, v31
s_mov_b32 s52, 0x3eae1a93
v_sub_f32 v24, v24, v10
buffer_load_dwordx4 v15, s[24:27], s64 offen offset:2048 sc1 lds
v_sub_f32 v25, v25, v10
v_sub_f32 v26, v26, v10
v_sub_f32 v27, v27, v10
v_sub_f32 v28, v28, v10
v_sub_f32 v29, v29, v10
v_sub_f32 v30, v30, v10
v_sub_f32 v31, v31, v10
v_mul_f32 v24, s52, v24
v_mul_f32 v25, s52, v25
v_mul_f32 v26, s52, v26
v_mul_f32 v27, s52, v27
buffer_load_dwordx4 v15, s[24:27], s64 offen offset:3072 sc1 lds
v_mul_f32 v28, s52, v28
v_mul_f32 v29, s52, v29
v_mul_f32 v30, s52, v30
v_mul_f32 v31, s52, v31
v_exp_f32 v24, v24
v_exp_f32 v25, v25
v_exp_f32 v26, v26
v_exp_f32 v27, v27
v_exp_f32 v28, v28
v_exp_f32 v29, v29
v_exp_f32 v30, v30
s_mov_b32 m0, s70
s_mov_b32 s64, s68
s_add_u32 s68, s68, 16384
s_add_u32 s70, s70, 16384
s_cmp_ge_u32 s70, 163840
s_cselect_b32 s70, s80, s70
buffer_load_dwordx4 v15, s[24:27], s64 offen offset:0 sc1 lds
v_exp_f32 v31, v31
v_cvt_pk_bf16_f32 v32, v24, 0
v_cvt_pk_bf16_f32 v40, v25, 0
v_cvt_pk_bf16_f32 v48, v26, 0
v_cvt_pk_bf16_f32 v56, v27, 0
v_cvt_pk_bf16_f32 v64, v28, 0
v_cvt_pk_bf16_f32 v72, v29, 0
v_cvt_pk_bf16_f32 v80, v30, 0
v_cvt_pk_bf16_f32 v88, v31, 0
v_lshlrev_b32 v33, 16, v32
v_lshlrev_b32 v41, 16, v40
buffer_load_dwordx4 v15, s[24:27], s64 offen offset:1024 sc1 lds
v_lshlrev_b32 v49, 16, v48
v_lshlrev_b32 v57, 16, v56
v_lshlrev_b32 v65, 16, v64
v_lshlrev_b32 v73, 16, v72
v_lshlrev_b32 v81, 16, v80
v_lshlrev_b32 v89, 16, v88
v_add_f32 v10, v33, v41
v_add_f32 v10, v10, v49
v_add_f32 v10, v10, v57
v_add_f32 v10, v10, v65
v_add_f32 v10, v10, v73
buffer_load_dwordx4 v15, s[24:27], s64 offen offset:2048 sc1 lds
v_add_f32 v10, v10, v81
v_add_f32 v10, v10, v89
v_fmac_f32 v10, v10, v11
v_rcp_f32 v10, v10
v_dot2_f32_bf16 v192, v128, v32, 0
v_dot2_f32_bf16 v193, v128, v33, 0
v_dot2_f32_bf16 v194, v129, v32, 0
v_dot2_f32_bf16 v195, v129, v33, 0
v_dot2_f32_bf16 v196, v130, v32, 0
v_dot2_f32_bf16 v197, v130, v33, 0
v_dot2_f32_bf16 v198, v131, v32, 0
buffer_load_dwordx4 v15, s[24:27], s64 offen offset:3072 sc1 lds
v_dot2_f32_bf16 v199, v131, v33, 0
v_dot2_f32_bf16 v200, v132, v32, 0
v_dot2_f32_bf16 v201, v132, v33, 0
v_dot2_f32_bf16 v202, v133, v32, 0
v_dot2_f32_bf16 v203, v133, v33, 0
v_dot2_f32_bf16 v204, v134, v32, 0
v_dot2_f32_bf16 v205, v134, v33, 0
v_dot2_f32_bf16 v206, v135, v32, 0
v_dot2_f32_bf16 v207, v135, v33, 0
v_dot2_f32_bf16 v208, v96, v33, 0
v_dot2_f32_bf16 v209, v98, v33, 0
buffer_load_dword v12, v13, s[24:27], s75 offen sc1
v_dot2c_f32_bf16 v192, v136, v40
v_dot2c_f32_bf16 v193, v136, v41
v_dot2c_f32_bf16 v194, v137, v40
v_dot2c_f32_bf16 v195, v137, v41
v_dot2c_f32_bf16 v196, v138, v40
v_dot2c_f32_bf16 v197, v138, v41
v_dot2c_f32_bf16 v198, v139, v40
v_dot2c_f32_bf16 v199, v139, v41
v_dot2c_f32_bf16 v200, v140, v40
v_dot2c_f32_bf16 v201, v140, v41
v_dot2c_f32_bf16 v202, v141, v40
s_mov_b32 m0, s70
s_mov_b32 s64, s68
s_add_u32 s68, s68, 16384
s_add_u32 s70, s70, 16384
s_cmp_ge_u32 s70, 163840
s_cselect_b32 s70, s80, s70
buffer_load_dwordx4 v15, s[24:27], s64 offen offset:0 sc1 lds
v_dot2c_f32_bf16 v203, v141, v41
v_dot2c_f32_bf16 v204, v142, v40
v_dot2c_f32_bf16 v205, v142, v41
v_dot2c_f32_bf16 v206, v143, v40
v_dot2c_f32_bf16 v207, v143, v41
v_dot2c_f32_bf16 v208, v100, v41
v_dot2c_f32_bf16 v209, v102, v41
v_dot2c_f32_bf16 v192, v144, v48
v_dot2c_f32_bf16 v193, v144, v49
v_dot2c_f32_bf16 v194, v145, v48
v_dot2c_f32_bf16 v195, v145, v49
buffer_load_dwordx4 v15, s[24:27], s64 offen offset:1024 sc1 lds
v_dot2c_f32_bf16 v196, v146, v48
v_dot2c_f32_bf16 v197, v146, v49
v_dot2c_f32_bf16 v198, v147, v48
v_dot2c_f32_bf16 v199, v147, v49
v_dot2c_f32_bf16 v200, v148, v48
v_dot2c_f32_bf16 v201, v148, v49
v_dot2c_f32_bf16 v202, v149, v48
v_dot2c_f32_bf16 v203, v149, v49
v_dot2c_f32_bf16 v204, v150, v48
v_dot2c_f32_bf16 v205, v150, v49
v_dot2c_f32_bf16 v206, v151, v48
buffer_load_dwordx4 v15, s[24:27], s64 offen offset:2048 sc1 lds
v_dot2c_f32_bf16 v207, v151, v49
v_dot2c_f32_bf16 v208, v104, v49
v_dot2c_f32_bf16 v209, v106, v49
v_dot2c_f32_bf16 v192, v152, v56
v_dot2c_f32_bf16 v193, v152, v57
v_dot2c_f32_bf16 v194, v153, v56
v_dot2c_f32_bf16 v195, v153, v57
v_dot2c_f32_bf16 v196, v154, v56
v_dot2c_f32_bf16 v197, v154, v57
v_dot2c_f32_bf16 v198, v155, v56
v_dot2c_f32_bf16 v199, v155, v57
buffer_load_dwordx4 v15, s[24:27], s64 offen offset:3072 sc1 lds
v_dot2c_f32_bf16 v200, v156, v56
v_dot2c_f32_bf16 v201, v156, v57
v_dot2c_f32_bf16 v202, v157, v56
v_dot2c_f32_bf16 v203, v157, v57
v_dot2c_f32_bf16 v204, v158, v56
v_dot2c_f32_bf16 v205, v158, v57
v_dot2c_f32_bf16 v206, v159, v56
v_dot2c_f32_bf16 v207, v159, v57
v_dot2c_f32_bf16 v208, v108, v57
v_dot2c_f32_bf16 v209, v110, v57
v_dot2c_f32_bf16 v192, v160, v64
s_waitcnt vmcnt(4)
v_cmp_gt_u32 s[96:97], 8, v12
s_nop 3
s_cmp_eq_u64 s[96:97], 0
s_cselect_b32 s78, s77, 2147418112
s_cselect_b32 s79, s81, 2147418112
s_xor_b32 s65, s82, 0
s_add_u32 s65, s65, s78
buffer_load_dwordx4 a[0:3], v15, s[24:27], s65 offen offset:0 sc1
v_dot2c_f32_bf16 v193, v160, v65
v_dot2c_f32_bf16 v194, v161, v64
v_dot2c_f32_bf16 v195, v161, v65
v_dot2c_f32_bf16 v196, v162, v64
v_dot2c_f32_bf16 v197, v162, v65
v_dot2c_f32_bf16 v198, v163, v64
v_dot2c_f32_bf16 v199, v163, v65
v_dot2c_f32_bf16 v200, v164, v64
v_dot2c_f32_bf16 v201, v164, v65
v_dot2c_f32_bf16 v202, v165, v64
v_dot2c_f32_bf16 v203, v165, v65
buffer_load_dwordx4 a[8:11], v15, s[24:27], s65 offen offset:2048 sc1
v_dot2c_f32_bf16 v204, v166, v64
v_dot2c_f32_bf16 v205, v166, v65
v_dot2c_f32_bf16 v206, v167, v64
v_dot2c_f32_bf16 v207, v167, v65
v_dot2c_f32_bf16 v208, v112, v65
v_dot2c_f32_bf16 v209, v114, v65
v_dot2c_f32_bf16 v192, v168, v72
v_dot2c_f32_bf16 v193, v168, v73
v_dot2c_f32_bf16 v194, v169, v72
v_dot2c_f32_bf16 v195, v169, v73
v_dot2c_f32_bf16 v196, v170, v72
s_xor_b32 s93, s82, 0
s_add_u32 s93, s93, s79
buffer_load_dwordx4 a[4:7], v15, s[24:27], s93 offen offset:0 sc1
v_dot2c_f32_bf16 v197, v170, v73
v_dot2c_f32_bf16 v198, v171, v72
v_dot2c_f32_bf16 v199, v171, v73
v_dot2c_f32_bf16 v200, v172, v72
v_dot2c_f32_bf16 v201, v172, v73
v_dot2c_f32_bf16 v202, v173, v72
v_dot2c_f32_bf16 v203, v173, v73
v_dot2c_f32_bf16 v204, v174, v72
v_dot2c_f32_bf16 v205, v174, v73
v_dot2c_f32_bf16 v206, v175, v72
v_dot2c_f32_bf16 v207, v175, v73
buffer_load_dwordx4 a[12:15], v15, s[24:27], s93 offen offset:2048 sc1
v_dot2c_f32_bf16 v208, v116, v73
v_dot2c_f32_bf16 v209, v118, v73
v_dot2c_f32_bf16 v192, v176, v80
v_dot2c_f32_bf16 v193, v176, v81
v_dot2c_f32_bf16 v194, v177, v80
v_dot2c_f32_bf16 v195, v177, v81
v_dot2c_f32_bf16 v196, v178, v80
v_dot2c_f32_bf16 v197, v178, v81
v_dot2c_f32_bf16 v198, v179, v80
v_dot2c_f32_bf16 v199, v179, v81
v_dot2c_f32_bf16 v200, v180, v80
buffer_load_dwordx4 a[16:19], v14, s[24:27], s65 offen offset:0 sc1
v_dot2c_f32_bf16 v201, v180, v81
v_dot2c_f32_bf16 v202, v181, v80
v_dot2c_f32_bf16 v203, v181, v81
v_dot2c_f32_bf16 v204, v182, v80
v_dot2c_f32_bf16 v205, v182, v81
v_dot2c_f32_bf16 v206, v183, v80
v_dot2c_f32_bf16 v207, v183, v81
v_dot2c_f32_bf16 v208, v120, v81
v_dot2c_f32_bf16 v209, v122, v81
v_dot2c_f32_bf16 v192, v184, v88
v_dot2c_f32_bf16 v193, v184, v89
buffer_load_dwordx4 a[24:27], v14, s[24:27], s65 offen offset:2048 sc1
v_dot2c_f32_bf16 v194, v185, v88
v_dot2c_f32_bf16 v195, v185, v89
v_dot2c_f32_bf16 v196, v186, v88
v_dot2c_f32_bf16 v197, v186, v89
v_dot2c_f32_bf16 v198, v187, v88
v_dot2c_f32_bf16 v199, v187, v89
v_dot2c_f32_bf16 v200, v188, v88
v_dot2c_f32_bf16 v201, v188, v89
v_dot2c_f32_bf16 v202, v189, v88
v_dot2c_f32_bf16 v203, v189, v89
v_dot2c_f32_bf16 v204, v190, v88
buffer_load_dwordx4 a[20:23], v14, s[24:27], s93 offen offset:0 sc1
v_dot2c_f32_bf16 v205, v190, v89
v_dot2c_f32_bf16 v206, v191, v88
v_dot2c_f32_bf16 v207, v191, v89
v_dot2c_f32_bf16 v208, v124, v89
v_dot2c_f32_bf16 v209, v126, v89
v_lshrrev_b32 v9, 5, v5
v_mul_u32_u24 v9, 303104, v9
v_and_b32 v11, 1, v3
v_lshl_add_u32 v9, v11, 10, v9
v_lshl_add_u32 v9, v2, 4, v9
v_lshrrev_b32 v11, 3, v2
buffer_load_dwordx4 a[28:31], v14, s[24:27], s93 offen offset:2048 sc1
s_bitcmp0_b32 s4, 0
s_cselect_b32 s52, 100663168, 0
v_mul_lo_u32 v6, v11, s52
v_add_u32 v6, v6, v9
s_bitcmp1_b32 s4, 2
s_cselect_b32 s52, 100663168, 0
v_mul_lo_u32 v11, v11, s52
v_add_u32 v11, v11, v9
v_mul_f32 v192, v10, v192
v_mul_f32 v193, v10, v193
v_mul_f32 v194, v10, v194
v_mul_f32 v195, v10, v195
v_mul_f32 v196, v10, v196
buffer_load_dword v12, v13, s[24:27], s75 offen sc1
v_mul_f32 v197, v10, v197
v_mul_f32 v198, v10, v198
v_mul_f32 v199, v10, v199
v_mul_f32 v200, v10, v200
v_mul_f32 v201, v10, v201
v_mul_f32 v202, v10, v202
v_mul_f32 v203, v10, v203
v_mul_f32 v204, v10, v204
v_mul_f32 v205, v10, v205
v_mul_f32 v206, v10, v206
v_mul_f32 v207, v10, v207
v_mul_f32 v208, v10, v208
v_mul_f32 v209, v10, v209
v_cvt_pk_bf16_f32 v192, v192, v193
v_cvt_pk_bf16_f32 v193, v194, v195
v_cvt_pk_bf16_f32 v194, v196, v197
v_cvt_pk_bf16_f32 v195, v198, v199
v_cvt_pk_bf16_f32 v196, v200, v201
v_cvt_pk_bf16_f32 v197, v202, v203
v_cvt_pk_bf16_f32 v198, v204, v205
v_cvt_pk_bf16_f32 v199, v206, v207
v_cvt_pk_bf16_f32 v200, v208, v209
s_add_u32 s53, s53, 65536
s_bfe_u32 s54, s4, 131073
s_lshl_b32 s54, s54, 11
s_add_u32 s54, s54, s53
s_and_b32 s55, s4, 1
s_lshl_b32 s55, s55, 9
s_add_u32 s54, s54, s55
s_lshl2_add_u32 s52, s85, s86
s_lshl2_add_u32 s52, s52, s3
s_mul_i32 s69, s52, 28672
s_add_u32 s69, s69, 76546048
s_mul_i32 s73, s52, 640
s_add_u32 s73, s73, 75563008
ds_read_b128 v[144:147], v7 offset:0
ds_read_b128 v[148:151], v7 offset:1024
ds_read_b128 v[152:155], v7 offset:2048
ds_read_b128 v[156:159], v7 offset:3072
ds_read_b128 v[160:163], v7 offset:4096
ds_read_b128 v[164:167], v7 offset:5120
ds_read_b128 v[168:171], v7 offset:6144
ds_read_b128 v[172:175], v7 offset:7168
v_mov_b32 v10, 0
s_mov_b32 s92, 0
s_cmp_eq_u32 s78, s77
s_cbranch_scc1 L_ZBX
s_branch L_ZB1
L_ZB:
s_sleep 2
buffer_load_dword v12, v13, s[24:27], s75 offen sc1
L_ZB1:
s_add_u32 s92, s92, 1
s_waitcnt vmcnt(0)
v_cmp_gt_u32 vcc, 8, v12
s_cmp_gt_u32 s92, 1048576
s_cbranch_scc1 L_ZBY
s_nop 2
s_cbranch_vccnz L_ZB
L_ZBY:
s_xor_b32 s65, s82, 0
s_add_u32 s65, s65, s77
buffer_load_dwordx4 a[0:3], v15, s[24:27], s65 offen offset:0 sc1
buffer_load_dwordx4 a[8:11], v15, s[24:27], s65 offen offset:2048 sc1
s_xor_b32 s93, s82, 0
s_add_u32 s93, s93, s81
buffer_load_dwordx4 a[4:7], v15, s[24:27], s93 offen offset:0 sc1
buffer_load_dwordx4 a[12:15], v15, s[24:27], s93 offen offset:2048 sc1
buffer_load_dwordx4 a[16:19], v14, s[24:27], s65 offen offset:0 sc1
buffer_load_dwordx4 a[24:27], v14, s[24:27], s65 offen offset:2048 sc1
buffer_load_dwordx4 a[20:23], v14, s[24:27], s93 offen offset:0 sc1
buffer_load_dwordx4 a[28:31], v14, s[24:27], s93 offen offset:2048 sc1
L_ZBX:
buffer_store_dwordx4 v[192:195], v9, s[24:27], s54 offen sc1
buffer_store_dwordx4 v[196:199], v6, s[24:27], s54 offen offset:256 sc1
s_bfe_u32 s55, s4, 65538
s_lshl_b32 s55, s55, 8
s_add_u32 s54, s53, s55
s_and_b32 s55, s4, 3
s_lshl2_add_u32 s54, s55, s54
s_add_u32 s54, s54, 8192
buffer_store_dword v200, v11, s[24:27], s54 offen sc1
s_waitcnt vmcnt(9) lgkmcnt(6)
v_mfma_f32_16x16x32_bf16 v[120:123], v[144:147], a[0:3], 0
s_waitcnt vmcnt(7)
s_add_u32 s91, s91, 16384
ds_read_b128 v[176:179], v7 offset:8192
v_mfma_f32_16x16x32_bf16 v[120:123], v[148:151], a[8:11], v[120:123]
s_xor_b32 s65, s82, 8192
s_add_u32 s65, s65, s77
ds_read_b128 v[180:183], v7 offset:9216
v_mfma_f32_16x16x32_bf16 v[124:127], v[148:151], a[12:15], 0
s_waitcnt lgkmcnt(6)
ds_read_b128 v[184:187], v7 offset:10240
v_mfma_f32_16x16x32_bf16 v[124:127], v[144:147], a[4:7], v[124:127]
buffer_load_dwordx4 a[32:35], v15, s[24:27], s65 offen offset:0 sc1
v_mfma_f32_16x16x32_bf16 v[72:75], v[152:155], a[0:3], 0
s_cmp_ge_u32 s91, 163840
s_cselect_b32 s91, 0, s91
ds_read_b128 v[188:191], v7 offset:11264
v_mfma_f32_16x16x32_bf16 v[72:75], v[156:159], a[8:11], v[72:75]
s_waitcnt lgkmcnt(6)
v_add_u32 v8, s91, v4
v_mfma_f32_16x16x32_bf16 v[76:79], v[156:159], a[12:15], 0
buffer_load_dwordx4 a[40:43], v15, s[24:27], s65 offen offset:2048 sc1
v_mfma_f32_16x16x32_bf16 v[76:79], v[152:155], a[4:7], v[76:79]
s_xor_b32 s93, s82, 8192
s_add_u32 s93, s93, s81
ds_read_b128 v[144:147], v7 offset:12288
v_mfma_f32_16x16x32_bf16 v[80:83], v[160:163], a[0:3], 0
ds_read_b128 v[148:151], v7 offset:13312
v_mfma_f32_16x16x32_bf16 v[80:83], v[164:167], a[8:11], v[80:83]
buffer_load_dwordx4 a[36:39], v15, s[24:27], s93 offen offset:0 sc1
v_mfma_f32_16x16x32_bf16 v[84:87], v[164:167], a[12:15], 0
ds_read_b128 v[152:155], v7 offset:14336
v_mfma_f32_16x16x32_bf16 v[84:87], v[160:163], a[4:7], v[84:87]
s_waitcnt lgkmcnt(7)
v_mfma_f32_16x16x32_bf16 v[88:91], v[168:171], a[0:3], 0
buffer_load_dwordx4 a[44:47], v15, s[24:27], s93 offen offset:2048 sc1
v_mfma_f32_16x16x32_bf16 v[88:91], v[172:175], a[8:11], v[88:91]
ds_read_b128 v[156:159], v7 offset:15360
v_mfma_f32_16x16x32_bf16 v[92:95], v[172:175], a[12:15], 0
s_waitcnt lgkmcnt(6)
s_add_u32 s91, s91, 16384
ds_read_b128 v[160:163], v8 offset:0
v_mfma_f32_16x16x32_bf16 v[92:95], v[168:171], a[4:7], v[92:95]
buffer_load_dwordx4 a[48:51], v14, s[24:27], s65 offen offset:0 sc1
v_mfma_f32_16x16x32_bf16 v[96:99], v[176:179], a[0:3], 0
s_cmp_ge_u32 s91, 163840
s_cselect_b32 s91, 0, s91
ds_read_b128 v[164:167], v8 offset:1024
v_mfma_f32_16x16x32_bf16 v[96:99], v[180:183], a[8:11], v[96:99]
v_add_u32 v7, s91, v4
v_mfma_f32_16x16x32_bf16 v[100:103], v[180:183], a[12:15], 0
buffer_load_dwordx4 a[56:59], v14, s[24:27], s65 offen offset:2048 sc1
v_mfma_f32_16x16x32_bf16 v[100:103], v[176:179], a[4:7], v[100:103]
s_waitcnt lgkmcnt(6)
ds_read_b128 v[168:171], v8 offset:2048
v_mfma_f32_16x16x32_bf16 v[104:107], v[184:187], a[0:3], 0
ds_read_b128 v[172:175], v8 offset:3072
v_mfma_f32_16x16x32_bf16 v[104:107], v[188:191], a[8:11], v[104:107]
v_mfma_f32_16x16x32_bf16 v[108:111], v[188:191], a[12:15], 0
buffer_load_dwordx4 a[52:55], v14, s[24:27], s93 offen offset:0 sc1
v_mfma_f32_16x16x32_bf16 v[108:111], v[184:187], a[4:7], v[108:111]
s_waitcnt lgkmcnt(6)
ds_read_b128 v[176:179], v8 offset:4096
v_mfma_f32_16x16x32_bf16 v[112:115], v[144:147], a[0:3], 0
ds_read_b128 v[180:183], v8 offset:5120
v_mfma_f32_16x16x32_bf16 v[112:115], v[148:151], a[8:11], v[112:115]
v_mfma_f32_16x16x32_bf16 v[116:119], v[148:151], a[12:15], 0
buffer_load_dwordx4 a[60:63], v14, s[24:27], s93 offen offset:2048 sc1
v_mfma_f32_16x16x32_bf16 v[116:119], v[144:147], a[4:7], v[116:119]
s_waitcnt lgkmcnt(6) vmcnt(13)
ds_read_b128 v[184:187], v8 offset:6144
v_mfma_f32_16x16x32_bf16 v[120:123], v[152:155], a[16:19], v[120:123]
ds_read_b128 v[188:191], v8 offset:7168
v_mfma_f32_16x16x32_bf16 v[120:123], v[156:159], a[24:27], v[120:123]
s_waitcnt vmcnt(11)
v_mfma_f32_16x16x32_bf16 v[124:127], v[156:159], a[28:31], v[124:127]
ds_read_b128 v[144:147], v8 offset:8192
v_mfma_f32_16x16x32_bf16 v[124:127], v[152:155], a[20:23], v[124:127]
s_waitcnt lgkmcnt(7)
v_mfma_f32_16x16x32_bf16 v[72:75], v[160:163], a[16:19], v[72:75]
ds_read_b128 v[148:151], v8 offset:9216
v_mfma_f32_16x16x32_bf16 v[72:75], v[164:167], a[24:27], v[72:75]
v_mfma_f32_16x16x32_bf16 v[76:79], v[164:167], a[28:31], v[76:79]
ds_read_b128 v[152:155], v8 offset:10240
v_mfma_f32_16x16x32_bf16 v[76:79], v[160:163], a[20:23], v[76:79]
s_waitcnt lgkmcnt(7)
v_mfma_f32_16x16x32_bf16 v[80:83], v[168:171], a[16:19], v[80:83]
ds_read_b128 v[156:159], v8 offset:11264
v_mfma_f32_16x16x32_bf16 v[80:83], v[172:175], a[24:27], v[80:83]
v_mfma_f32_16x16x32_bf16 v[84:87], v[172:175], a[28:31], v[84:87]
ds_read_b128 v[160:163], v8 offset:12288
v_mfma_f32_16x16x32_bf16 v[84:87], v[168:171], a[20:23], v[84:87]
s_waitcnt lgkmcnt(7)
v_mfma_f32_16x16x32_bf16 v[88:91], v[176:179], a[16:19], v[88:91]
s_xor_b32 s65, s82, 16384
s_add_u32 s65, s65, s77
ds_read_b128 v[164:167], v8 offset:13312
v_mfma_f32_16x16x32_bf16 v[88:91], v[180:183], a[24:27], v[88:91]
v_mfma_f32_16x16x32_bf16 v[92:95], v[180:183], a[28:31], v[92:95]
s_waitcnt lgkmcnt(6)
ds_read_b128 v[168:171], v8 offset:14336
v_add_u32 v11, s70, v4
v_mfma_f32_16x16x32_bf16 v[92:95], v[176:179], a[20:23], v[92:95]
s_add_u32 s70, s70, 16384
s_cmp_ge_u32 s70, 163840
s_cselect_b32 s70, s80, s70
v_mfma_f32_16x16x32_bf16 v[96:99], v[184:187], a[16:19], v[96:99]
buffer_load_dwordx4 a[64:67], v15, s[24:27], s65 offen offset:0 sc1
v_mfma_f32_16x16x32_bf16 v[96:99], v[188:191], a[24:27], v[96:99]
s_barrier
v_mfma_f32_16x16x32_bf16 v[100:103], v[188:191], a[28:31], v[100:103]
s_waitcnt lgkmcnt(5)
ds_read_b128 v[172:175], v8 offset:15360
v_mfma_f32_16x16x32_bf16 v[100:103], v[184:187], a[20:23], v[100:103]
buffer_load_dwordx4 a[72:75], v15, s[24:27], s65 offen offset:2048 sc1
v_mfma_f32_16x16x32_bf16 v[104:107], v[144:147], a[16:19], v[104:107]
ds_write_b64 v11, a[96:97] offset:0
v_mfma_f32_16x16x32_bf16 v[104:107], v[148:151], a[24:27], v[104:107]
s_xor_b32 s93, s82, 16384
s_add_u32 s93, s93, s81
ds_read_b128 v[176:179], v7 offset:0
v_mfma_f32_16x16x32_bf16 v[108:111], v[148:151], a[28:31], v[108:111]
buffer_load_dwordx4 a[68:71], v15, s[24:27], s93 offen offset:0 sc1
v_mfma_f32_16x16x32_bf16 v[108:111], v[144:147], a[20:23], v[108:111]
s_waitcnt lgkmcnt(6)
s_add_u32 s91, s91, 16384
ds_read_b128 v[180:183], v7 offset:1024
v_mfma_f32_16x16x32_bf16 v[112:115], v[152:155], a[16:19], v[112:115]
ds_write_b64 v11, a[98:99] offset:8
v_mfma_f32_16x16x32_bf16 v[112:115], v[156:159], a[24:27], v[112:115]
s_cmp_ge_u32 s91, 163840
s_cselect_b32 s91, 0, s91
ds_read_b128 v[184:187], v7 offset:2048
v_mfma_f32_16x16x32_bf16 v[116:119], v[156:159], a[28:31], v[116:119]
buffer_load_dwordx4 a[76:79], v15, s[24:27], s93 offen offset:2048 sc1
v_mfma_f32_16x16x32_bf16 v[116:119], v[152:155], a[20:23], v[116:119]
s_waitcnt lgkmcnt(7) vmcnt(10)
ds_read_b128 v[188:191], v7 offset:3072
v_add_u32 v8, s91, v4
v_mfma_f32_16x16x32_bf16 v[120:123], v[160:163], a[32:35], v[120:123]
s_waitcnt vmcnt(12)
s_waitcnt vmcnt(8)
ds_read_b128 v[144:147], v7 offset:4096
v_mfma_f32_16x16x32_bf16 v[120:123], v[164:167], a[40:43], v[120:123]
buffer_atomic_add v1, v0, s[24:27], s74 offen offset:128 sc1
v_mfma_f32_16x16x32_bf16 v[124:127], v[164:167], a[44:47], v[124:127]
ds_write_b64 v11, a[100:101] offset:1024
v_mfma_f32_16x16x32_bf16 v[124:127], v[160:163], a[36:39], v[124:127]
s_waitcnt lgkmcnt(8)
ds_read_b128 v[148:151], v7 offset:5120
v_mfma_f32_16x16x32_bf16 v[72:75], v[168:171], a[32:35], v[72:75]
ds_read_b128 v[152:155], v7 offset:6144
v_mfma_f32_16x16x32_bf16 v[72:75], v[172:175], a[40:43], v[72:75]
s_waitcnt lgkmcnt(7)
ds_read_b128 v[156:159], v7 offset:7168
v_mfma_f32_16x16x32_bf16 v[76:79], v[172:175], a[44:47], v[76:79]
ds_write_b64 v11, a[102:103] offset:1032
v_mfma_f32_16x16x32_bf16 v[76:79], v[168:171], a[36:39], v[76:79]
buffer_load_dwordx4 a[80:83], v14, s[24:27], s65 offen offset:0 sc1
v_mfma_f32_16x16x32_bf16 v[80:83], v[176:179], a[32:35], v[80:83]
ds_read_b128 v[160:163], v7 offset:8192
v_mfma_f32_16x16x32_bf16 v[80:83], v[180:183], a[40:43], v[80:83]
s_waitcnt lgkmcnt(7)
ds_read_b128 v[164:167], v7 offset:9216
v_mfma_f32_16x16x32_bf16 v[84:87], v[180:183], a[44:47], v[84:87]
ds_write_b64 v11, a[104:105] offset:2048
v_mfma_f32_16x16x32_bf16 v[84:87], v[176:179], a[36:39], v[84:87]
buffer_load_dwordx4 a[88:91], v14, s[24:27], s65 offen offset:2048 sc1
v_mfma_f32_16x16x32_bf16 v[88:91], v[184:187], a[32:35], v[88:91]
ds_read_b128 v[168:171], v7 offset:10240
v_mfma_f32_16x16x32_bf16 v[88:91], v[188:191], a[40:43], v[88:91]
s_waitcnt lgkmcnt(7)
ds_read_b128 v[172:175], v7 offset:11264
v_mfma_f32_16x16x32_bf16 v[92:95], v[188:191], a[44:47], v[92:95]
ds_write_b64 v11, a[106:107] offset:2056
v_mfma_f32_16x16x32_bf16 v[92:95], v[184:187], a[36:39], v[92:95]
buffer_load_dwordx4 a[84:87], v14, s[24:27], s93 offen offset:0 sc1
v_mfma_f32_16x16x32_bf16 v[96:99], v[144:147], a[32:35], v[96:99]
ds_read_b128 v[176:179], v7 offset:12288
v_mfma_f32_16x16x32_bf16 v[96:99], v[148:151], a[40:43], v[96:99]
s_waitcnt lgkmcnt(8)
ds_read_b128 v[180:183], v7 offset:13312
v_mfma_f32_16x16x32_bf16 v[100:103], v[148:151], a[44:47], v[100:103]
ds_write_b64 v11, a[108:109] offset:3072
v_mfma_f32_16x16x32_bf16 v[100:103], v[144:147], a[36:39], v[100:103]
buffer_load_dwordx4 a[92:95], v14, s[24:27], s93 offen offset:2048 sc1
v_mfma_f32_16x16x32_bf16 v[104:107], v[152:155], a[32:35], v[104:107]
ds_read_b128 v[184:187], v7 offset:14336
v_mfma_f32_16x16x32_bf16 v[104:107], v[156:159], a[40:43], v[104:107]
ds_read_b128 v[188:191], v7 offset:15360
v_mfma_f32_16x16x32_bf16 v[108:111], v[156:159], a[44:47], v[108:111]
ds_write_b64 v11, a[110:111] offset:3080
v_mfma_f32_16x16x32_bf16 v[108:111], v[152:155], a[36:39], v[108:111]
s_waitcnt lgkmcnt(10)
s_add_u32 s91, s91, 16384
ds_read_b128 v[144:147], v8 offset:0
v_mfma_f32_16x16x32_bf16 v[112:115], v[160:163], a[32:35], v[112:115]
s_xor_b32 s65, s82, 24576
s_add_u32 s65, s65, s77
ds_read_b128 v[148:151], v8 offset:1024
v_mfma_f32_16x16x32_bf16 v[112:115], v[164:167], a[40:43], v[112:115]
s_cmp_ge_u32 s91, 163840
s_cselect_b32 s91, 0, s91
v_add_u32 v7, s91, v4
v_mfma_f32_16x16x32_bf16 v[116:119], v[164:167], a[44:47], v[116:119]
buffer_load_dwordx4 a[192:195], v15, s[24:27], s65 offen offset:0 sc1
v_mfma_f32_16x16x32_bf16 v[116:119], v[160:163], a[36:39], v[116:119]
s_waitcnt lgkmcnt(9) vmcnt(12)
ds_read_b128 v[152:155], v8 offset:2048
v_mfma_f32_16x16x32_bf16 v[120:123], v[168:171], a[48:51], v[120:123]
ds_read_b128 v[156:159], v8 offset:3072
v_mfma_f32_16x16x32_bf16 v[120:123], v[172:175], a[56:59], v[120:123]
s_waitcnt vmcnt(10)
v_mfma_f32_16x16x32_bf16 v[124:127], v[172:175], a[60:63], v[124:127]
buffer_load_dwordx4 a[200:203], v15, s[24:27], s65 offen offset:2048 sc1
v_mfma_f32_16x16x32_bf16 v[124:127], v[168:171], a[52:55], v[124:127]
s_waitcnt lgkmcnt(8)
ds_read_b128 v[160:163], v8 offset:4096
v_mfma_f32_16x16x32_bf16 v[72:75], v[176:179], a[48:51], v[72:75]
s_xor_b32 s93, s82, 24576
s_add_u32 s93, s93, s81
ds_read_b128 v[164:167], v8 offset:5120
v_mfma_f32_16x16x32_bf16 v[72:75], v[180:183], a[56:59], v[72:75]
v_mfma_f32_16x16x32_bf16 v[76:79], v[180:183], a[60:63], v[76:79]
buffer_load_dwordx4 a[196:199], v15, s[24:27], s93 offen offset:0 sc1
v_mfma_f32_16x16x32_bf16 v[76:79], v[176:179], a[52:55], v[76:79]
s_waitcnt lgkmcnt(7)
ds_read_b128 v[168:171], v8 offset:6144
v_mfma_f32_16x16x32_bf16 v[80:83], v[184:187], a[48:51], v[80:83]
ds_read_b128 v[172:175], v8 offset:7168
v_mfma_f32_16x16x32_bf16 v[80:83], v[188:191], a[56:59], v[80:83]
v_mfma_f32_16x16x32_bf16 v[84:87], v[188:191], a[60:63], v[84:87]
buffer_load_dwordx4 a[204:207], v15, s[24:27], s93 offen offset:2048 sc1
v_mfma_f32_16x16x32_bf16 v[84:87], v[184:187], a[52:55], v[84:87]
s_waitcnt lgkmcnt(6)
ds_read_b128 v[176:179], v8 offset:8192
v_mfma_f32_16x16x32_bf16 v[88:91], v[144:147], a[48:51], v[88:91]
ds_read_b128 v[180:183], v8 offset:9216
v_mfma_f32_16x16x32_bf16 v[88:91], v[148:151], a[56:59], v[88:91]
v_mfma_f32_16x16x32_bf16 v[92:95], v[148:151], a[60:63], v[92:95]
ds_read_b128 v[184:187], v8 offset:10240
v_mfma_f32_16x16x32_bf16 v[92:95], v[144:147], a[52:55], v[92:95]
s_waitcnt lgkmcnt(7)
v_mfma_f32_16x16x32_bf16 v[96:99], v[152:155], a[48:51], v[96:99]
s_add_u32 s52, s84, 1
ds_read_b128 v[188:191], v8 offset:11264
v_mfma_f32_16x16x32_bf16 v[96:99], v[156:159], a[56:59], v[96:99]
v_mfma_f32_16x16x32_bf16 v[100:103], v[156:159], a[60:63], v[100:103]
buffer_load_dwordx4 a[208:211], v14, s[24:27], s65 offen offset:0 sc1
v_mfma_f32_16x16x32_bf16 v[100:103], v[152:155], a[52:55], v[100:103]
s_and_b32 s52, s52, 3
s_waitcnt lgkmcnt(6)
ds_read_b128 v[144:147], v8 offset:12288
v_mfma_f32_16x16x32_bf16 v[104:107], v[160:163], a[48:51], v[104:107]
ds_read_b128 v[148:151], v8 offset:13312
v_mfma_f32_16x16x32_bf16 v[104:107], v[164:167], a[56:59], v[104:107]
s_waitcnt lgkmcnt(6)
v_mfma_f32_16x16x32_bf16 v[108:111], v[164:167], a[60:63], v[108:111]
s_mul_i32 s52, s52, 6144
ds_read_b128 v[152:155], v8 offset:14336
v_add_u32 v11, s70, v4
v_mfma_f32_16x16x32_bf16 v[108:111], v[160:163], a[52:55], v[108:111]
s_add_u32 s70, s70, 16384
s_cmp_ge_u32 s70, 163840
s_cselect_b32 s70, s80, s70
v_mfma_f32_16x16x32_bf16 v[112:115], v[168:171], a[48:51], v[112:115]
s_waitcnt vmcnt(51)
ds_read_b128 v[156:159], v8 offset:15360
v_mfma_f32_16x16x32_bf16 v[112:115], v[172:175], a[56:59], v[112:115]
s_barrier
v_mfma_f32_16x16x32_bf16 v[116:119], v[172:175], a[60:63], v[116:119]
s_add_u32 s52, s52, s69
s_waitcnt lgkmcnt(6) vmcnt(12)
ds_read_b128 v[160:163], v7 offset:0
v_mfma_f32_16x16x32_bf16 v[116:119], v[168:171], a[52:55], v[116:119]
buffer_load_dwordx4 a[216:219], v14, s[24:27], s65 offen offset:2048 sc1
v_mfma_f32_16x16x32_bf16 v[120:123], v[176:179], a[64:67], v[120:123]
ds_write_b64 v11, a[112:113] offset:0
v_mfma_f32_16x16x32_bf16 v[120:123], v[180:183], a[72:75], v[120:123]
s_add_u32 s52, s52, 0
s_waitcnt vmcnt(11)
ds_read_b128 v[164:167], v7 offset:1024
v_mfma_f32_16x16x32_bf16 v[124:127], v[180:183], a[76:79], v[124:127]
buffer_load_dwordx4 a[212:215], v14, s[24:27], s93 offen offset:0 sc1
v_mfma_f32_16x16x32_bf16 v[124:127], v[176:179], a[68:71], v[124:127]
s_waitcnt lgkmcnt(7)
s_add_u32 s91, s91, 16384
ds_read_b128 v[168:171], v7 offset:2048
v_mfma_f32_16x16x32_bf16 v[72:75], v[184:187], a[64:67], v[72:75]
s_add_u32 s53, s84, 2
ds_read_b128 v[172:175], v7 offset:3072
v_mfma_f32_16x16x32_bf16 v[72:75], v[188:191], a[72:75], v[72:75]
L_PAD11:
s_cbranch_execz L_MAIN
ds_write_b64 v11, a[114:115] offset:8
v_mfma_f32_16x16x32_bf16 v[76:79], v[188:191], a[76:79], v[76:79]
buffer_load_dwordx4 a[220:223], v14, s[24:27], s93 offen offset:2048 sc1
v_mfma_f32_16x16x32_bf16 v[76:79], v[184:187], a[68:71], v[76:79]
s_and_b32 s53, s53, 3
s_waitcnt lgkmcnt(8)
ds_read_b128 v[176:179], v7 offset:4096
v_mfma_f32_16x16x32_bf16 v[80:83], v[144:147], a[64:67], v[80:83]
s_xor_b32 s65, s82, 32768
s_add_u32 s65, s65, s77
ds_read_b128 v[180:183], v7 offset:5120
v_mfma_f32_16x16x32_bf16 v[80:83], v[148:151], a[72:75], v[80:83]
ds_write_b64 v11, a[116:117] offset:1024
v_mfma_f32_16x16x32_bf16 v[84:87], v[148:151], a[76:79], v[84:87]
s_mul_i32 s53, s53, 6144
s_waitcnt lgkmcnt(9)
ds_read_b128 v[184:187], v7 offset:6144
v_mfma_f32_16x16x32_bf16 v[84:87], v[144:147], a[68:71], v[84:87]
buffer_load_dwordx4 a[224:227], v15, s[24:27], s65 offen offset:0 sc1
v_mfma_f32_16x16x32_bf16 v[88:91], v[152:155], a[64:67], v[88:91]
s_cmp_ge_u32 s91, 163840
s_cselect_b32 s91, 0, s91
ds_read_b128 v[188:191], v7 offset:7168
v_mfma_f32_16x16x32_bf16 v[88:91], v[156:159], a[72:75], v[88:91]
s_add_u32 s53, s53, s69
s_waitcnt lgkmcnt(8)
v_add_u32 v8, s91, v4
v_mfma_f32_16x16x32_bf16 v[92:95], v[156:159], a[76:79], v[92:95]
ds_write_b64 v11, a[118:119] offset:1032
v_mfma_f32_16x16x32_bf16 v[92:95], v[152:155], a[68:71], v[92:95]
buffer_load_dwordx4 a[232:235], v15, s[24:27], s65 offen offset:2048 sc1
v_mfma_f32_16x16x32_bf16 v[96:99], v[160:163], a[64:67], v[96:99]
s_add_u32 s53, s53, 2048
s_xor_b32 s93, s82, 32768
s_add_u32 s93, s93, s81
v_mfma_f32_16x16x32_bf16 v[96:99], v[164:167], a[72:75], v[96:99]
ds_read_b128 v[144:147], v7 offset:8192
v_mfma_f32_16x16x32_bf16 v[100:103], v[164:167], a[76:79], v[100:103]
ds_write_b64 v11, a[120:121] offset:2048
v_mfma_f32_16x16x32_bf16 v[100:103], v[160:163], a[68:71], v[100:103]
s_add_u32 s54, s84, 3
s_waitcnt lgkmcnt(9) vmcnt(12)
ds_read_b128 v[148:151], v7 offset:9216
v_mfma_f32_16x16x32_bf16 v[120:123], v[168:171], a[80:83], v[120:123]
buffer_load_dwordx4 a[228:231], v15, s[24:27], s93 offen offset:0 sc1
v_mfma_f32_16x16x32_bf16 v[120:123], v[172:175], a[88:91], v[120:123]
s_waitcnt vmcnt(11)
ds_read_b128 v[152:155], v7 offset:10240
v_mfma_f32_16x16x32_bf16 v[124:127], v[172:175], a[92:95], v[124:127]
s_and_b32 s54, s54, 3
s_waitcnt lgkmcnt(8)
ds_read_b128 v[156:159], v7 offset:11264
v_mfma_f32_16x16x32_bf16 v[124:127], v[168:171], a[84:87], v[124:127]
ds_write_b64 v11, a[122:123] offset:2056
v_mfma_f32_16x16x32_bf16 v[72:75], v[176:179], a[80:83], v[72:75]
buffer_load_dwordx4 a[236:239], v15, s[24:27], s93 offen offset:2048 sc1
v_mfma_f32_16x16x32_bf16 v[72:75], v[180:183], a[88:91], v[72:75]
s_mul_i32 s54, s54, 6144
ds_read_b128 v[160:163], v7 offset:12288
v_mfma_f32_16x16x32_bf16 v[76:79], v[180:183], a[92:95], v[76:79]
s_waitcnt lgkmcnt(8)
ds_read_b128 v[164:167], v7 offset:13312
v_mfma_f32_16x16x32_bf16 v[76:79], v[176:179], a[84:87], v[76:79]
ds_write_b64 v11, a[124:125] offset:3072
v_mfma_f32_16x16x32_bf16 v[80:83], v[184:187], a[80:83], v[80:83]
s_add_u32 s54, s54, s69
ds_read_b128 v[168:171], v7 offset:14336
v_mfma_f32_16x16x32_bf16 v[80:83], v[188:191], a[88:91], v[80:83]
ds_read_b128 v[172:175], v7 offset:15360
v_mfma_f32_16x16x32_bf16 v[84:87], v[188:191], a[92:95], v[84:87]
buffer_load_dwordx4 a[240:243], v14, s[24:27], s65 offen offset:0 sc1
v_mfma_f32_16x16x32_bf16 v[84:87], v[184:187], a[84:87], v[84:87]
s_add_u32 s54, s54, 4096
s_waitcnt lgkmcnt(8)
ds_read_b128 v[176:179], v8 offset:0
v_mfma_f32_16x16x32_bf16 v[88:91], v[144:147], a[80:83], v[88:91]
ds_write_b64 v11, a[126:127] offset:3080
v_mfma_f32_16x16x32_bf16 v[88:91], v[148:151], a[88:91], v[88:91]
s_add_u32 s91, s91, 16384
ds_read_b128 v[180:183], v8 offset:1024
v_add_u32 v11, s70, v4
v_mfma_f32_16x16x32_bf16 v[92:95], v[148:151], a[92:95], v[92:95]
s_sub_u32 s55, s3, s84
s_add_u32 s70, s70, 16384
ds_read_b128 v[184:187], v8 offset:2048
v_mfma_f32_16x16x32_bf16 v[92:95], v[144:147], a[84:87], v[92:95]
s_cmp_ge_u32 s70, 163840
s_cselect_b32 s70, s80, s70
s_waitcnt lgkmcnt(10)
v_mfma_f32_16x16x32_bf16 v[96:99], v[152:155], a[80:83], v[96:99]
buffer_load_dwordx4 a[248:251], v14, s[24:27], s65 offen offset:2048 sc1
v_mfma_f32_16x16x32_bf16 v[96:99], v[156:159], a[88:91], v[96:99]
s_and_b32 s55, s55, 3
s_waitcnt lgkmcnt(7) vmcnt(12)
ds_read_b128 v[188:191], v8 offset:3072
v_mfma_f32_16x16x32_bf16 v[100:103], v[156:159], a[92:95], v[100:103]
ds_write_b64 v11, a[160:161] offset:0
v_mfma_f32_16x16x32_bf16 v[100:103], v[152:155], a[84:87], v[100:103]
buffer_load_dwordx4 a[244:247], v14, s[24:27], s93 offen offset:0 sc1
v_mfma_f32_16x16x32_bf16 v[120:123], v[160:163], a[192:195], v[120:123]
s_lshl_b32 s55, s55, 10
ds_read_b128 v[144:147], v8 offset:4096
v_mfma_f32_16x16x32_bf16 v[120:123], v[164:167], a[200:203], v[120:123]
s_waitcnt vmcnt(11)
ds_read_b128 v[148:151], v8 offset:5120
v_mfma_f32_16x16x32_bf16 v[124:127], v[164:167], a[204:207], v[124:127]
ds_write_b64 v11, a[162:163] offset:8
v_mfma_f32_16x16x32_bf16 v[124:127], v[160:163], a[196:199], v[124:127]
s_add_u32 s55, s55, s69
s_waitcnt lgkmcnt(9)
ds_read_b128 v[152:155], v8 offset:6144
v_mfma_f32_16x16x32_bf16 v[72:75], v[168:171], a[192:195], v[72:75]
buffer_load_dwordx4 a[252:255], v14, s[24:27], s93 offen offset:2048 sc1
v_mfma_f32_16x16x32_bf16 v[72:75], v[172:175], a[200:203], v[72:75]
s_cmp_ge_u32 s91, 163840
s_cselect_b32 s91, 0, s91
ds_read_b128 v[156:159], v8 offset:7168
v_mfma_f32_16x16x32_bf16 v[76:79], v[172:175], a[204:207], v[76:79]
s_add_u32 s55, s55, 23552
s_waitcnt lgkmcnt(8)
ds_read_b128 v[160:163], v8 offset:8192
v_mfma_f32_16x16x32_bf16 v[76:79], v[168:171], a[196:199], v[76:79]
ds_write_b64 v11, a[164:165] offset:1024
v_mfma_f32_16x16x32_bf16 v[80:83], v[176:179], a[192:195], v[80:83]
s_xor_b32 s65, s82, 40960
s_add_u32 s65, s65, s77
ds_read_b128 v[164:167], v8 offset:9216
v_mfma_f32_16x16x32_bf16 v[80:83], v[180:183], a[200:203], v[80:83]
s_add_u32 s71, s69, 24576
s_waitcnt lgkmcnt(9)
v_add_u32 v7, s91, v4
v_mfma_f32_16x16x32_bf16 v[84:87], v[180:183], a[204:207], v[84:87]
buffer_load_dwordx4 a[96:99], v15, s[24:27], s65 offen offset:0 sc1
v_mfma_f32_16x16x32_bf16 v[84:87], v[176:179], a[196:199], v[84:87]
ds_write_b64 v11, a[166:167] offset:1032
v_mfma_f32_16x16x32_bf16 v[88:91], v[184:187], a[192:195], v[88:91]
s_cmp_eq_u32 s3, s84
s_cselect_b32 s55, 2147418112, s55
s_cselect_b32 s71, s71, 2147418112
v_mfma_f32_16x16x32_bf16 v[88:91], v[188:191], a[200:203], v[88:91]
ds_read_b128 v[168:171], v8 offset:10240
v_mfma_f32_16x16x32_bf16 v[92:95], v[188:191], a[204:207], v[92:95]
buffer_load_dwordx4 a[104:107], v15, s[24:27], s65 offen offset:2048 sc1
v_mfma_f32_16x16x32_bf16 v[92:95], v[184:187], a[196:199], v[92:95]
s_mul_i32 s83, s84, 6144
s_waitcnt lgkmcnt(8)
ds_read_b128 v[172:175], v8 offset:11264
v_mfma_f32_16x16x32_bf16 v[96:99], v[144:147], a[192:195], v[96:99]
ds_write_b64 v11, a[168:169] offset:2048
v_mfma_f32_16x16x32_bf16 v[96:99], v[148:151], a[200:203], v[96:99]
s_xor_b32 s93, s82, 40960
s_add_u32 s93, s93, s81
ds_read_b128 v[176:179], v8 offset:12288
v_mfma_f32_16x16x32_bf16 v[100:103], v[148:151], a[204:207], v[100:103]
s_add_u32 s69, s69, s83
s_waitcnt lgkmcnt(8) vmcnt(12)
ds_read_b128 v[180:183], v8 offset:13312
v_mfma_f32_16x16x32_bf16 v[100:103], v[144:147], a[196:199], v[100:103]
buffer_load_dwordx4 a[100:103], v15, s[24:27], s93 offen offset:0 sc1
v_mfma_f32_16x16x32_bf16 v[120:123], v[152:155], a[208:211], v[120:123]
s_waitcnt vmcnt(57)
s_waitcnt vmcnt(11)
ds_read_b128 v[184:187], v8 offset:14336
v_mfma_f32_16x16x32_bf16 v[120:123], v[156:159], a[216:219], v[120:123]
s_barrier
v_mfma_f32_16x16x32_bf16 v[124:127], v[156:159], a[220:223], v[124:127]
s_add_u32 s83, s69, 4096
s_waitcnt lgkmcnt(7)
ds_read_b128 v[188:191], v8 offset:15360
v_mfma_f32_16x16x32_bf16 v[124:127], v[152:155], a[212:215], v[124:127]
ds_write_b64 v11, a[170:171] offset:2056
v_mfma_f32_16x16x32_bf16 v[72:75], v[160:163], a[208:211], v[72:75]
buffer_load_dwordx4 a[108:111], v15, s[24:27], s93 offen offset:2048 sc1
v_mfma_f32_16x16x32_bf16 v[72:75], v[164:167], a[216:219], v[72:75]
s_add_u32 s91, s91, 16384
ds_read_b128 v[144:147], v7 offset:0
v_mfma_f32_16x16x32_bf16 v[76:79], v[164:167], a[220:223], v[76:79]
s_waitcnt lgkmcnt(7)
ds_read_b128 v[148:151], v7 offset:1024
v_mfma_f32_16x16x32_bf16 v[76:79], v[160:163], a[212:215], v[76:79]
ds_write_b64 v11, a[172:173] offset:3072
v_mfma_f32_16x16x32_bf16 v[80:83], v[168:171], a[208:211], v[80:83]
s_cmp_ge_u32 s91, 163840
s_cselect_b32 s91, 0, s91
ds_read_b128 v[152:155], v7 offset:2048
v_mfma_f32_16x16x32_bf16 v[80:83], v[172:175], a[216:219], v[80:83]
s_waitcnt lgkmcnt(7)
ds_read_b128 v[156:159], v7 offset:3072
v_add_u32 v8, s91, v4
v_mfma_f32_16x16x32_bf16 v[84:87], v[172:175], a[220:223], v[84:87]
buffer_load_dwordx4 a[112:115], v14, s[24:27], s65 offen offset:0 sc1
v_mfma_f32_16x16x32_bf16 v[84:87], v[168:171], a[212:215], v[84:87]
ds_write_b64 v11, a[174:175] offset:3080
v_mfma_f32_16x16x32_bf16 v[88:91], v[176:179], a[208:211], v[88:91]
s_add_u32 s68, s68, 49152
ds_read_b128 v[160:163], v7 offset:4096
v_mfma_f32_16x16x32_bf16 v[88:91], v[180:183], a[216:219], v[88:91]
ds_read_b128 v[164:167], v7 offset:5120
v_mfma_f32_16x16x32_bf16 v[92:95], v[180:183], a[220:223], v[92:95]
buffer_load_dwordx4 a[120:123], v14, s[24:27], s65 offen offset:2048 sc1
v_mfma_f32_16x16x32_bf16 v[92:95], v[176:179], a[212:215], v[92:95]
s_waitcnt lgkmcnt(9)
ds_read_b128 v[168:171], v7 offset:6144
v_mfma_f32_16x16x32_bf16 v[96:99], v[184:187], a[208:211], v[96:99]
ds_read_b128 v[172:175], v7 offset:7168
v_mfma_f32_16x16x32_bf16 v[96:99], v[188:191], a[216:219], v[96:99]
v_mfma_f32_16x16x32_bf16 v[100:103], v[188:191], a[220:223], v[100:103]
buffer_load_dwordx4 a[116:119], v14, s[24:27], s93 offen offset:0 sc1
v_mfma_f32_16x16x32_bf16 v[100:103], v[184:187], a[212:215], v[100:103]
s_waitcnt lgkmcnt(8) vmcnt(13)
ds_read_b128 v[176:179], v7 offset:8192
v_mfma_f32_16x16x32_bf16 v[120:123], v[144:147], a[224:227], v[120:123]
ds_read_b128 v[180:183], v7 offset:9216
v_mfma_f32_16x16x32_bf16 v[120:123], v[148:151], a[232:235], v[120:123]
s_waitcnt vmcnt(11)
v_mfma_f32_16x16x32_bf16 v[124:127], v[148:151], a[236:239], v[124:127]
buffer_load_dwordx4 a[124:127], v14, s[24:27], s93 offen offset:2048 sc1
v_mfma_f32_16x16x32_bf16 v[124:127], v[144:147], a[228:231], v[124:127]
s_waitcnt lgkmcnt(7)
ds_read_b128 v[184:187], v7 offset:10240
v_mfma_f32_16x16x32_bf16 v[72:75], v[152:155], a[224:227], v[72:75]
ds_read_b128 v[188:191], v7 offset:11264
v_mfma_f32_16x16x32_bf16 v[72:75], v[156:159], a[232:235], v[72:75]
v_mfma_f32_16x16x32_bf16 v[76:79], v[156:159], a[236:239], v[76:79]
ds_read_b128 v[144:147], v7 offset:12288
v_mfma_f32_16x16x32_bf16 v[76:79], v[152:155], a[228:231], v[76:79]
s_waitcnt lgkmcnt(7)
v_mfma_f32_16x16x32_bf16 v[80:83], v[160:163], a[224:227], v[80:83]
s_xor_b32 s65, s82, 49152
s_add_u32 s65, s65, s77
ds_read_b128 v[148:151], v7 offset:13312
v_mfma_f32_16x16x32_bf16 v[80:83], v[164:167], a[232:235], v[80:83]
v_mov_b32 v13, 0xffff0000
v_mul_u32_u24 v5, 1152, v2
v_mfma_f32_16x16x32_bf16 v[84:87], v[164:167], a[236:239], v[84:87]
buffer_load_dwordx4 a[128:131], v15, s[24:27], s65 offen offset:0 sc1
v_mfma_f32_16x16x32_bf16 v[84:87], v[160:163], a[228:231], v[84:87]
s_waitcnt lgkmcnt(6)
ds_read_b128 v[152:155], v7 offset:14336
v_lshl_add_u32 v6, v3, 3, v5
v_mfma_f32_16x16x32_bf16 v[88:91], v[168:171], a[224:227], v[88:91]
ds_read_b128 v[156:159], v7 offset:15360
v_and_b32 v9, 1, v3
v_mfma_f32_16x16x32_bf16 v[88:91], v[172:175], a[232:235], v[88:91]
s_add_u32 s91, s91, 16384
s_cmp_ge_u32 s91, 163840
s_cselect_b32 s91, 0, s91
v_mfma_f32_16x16x32_bf16 v[92:95], v[172:175], a[236:239], v[92:95]
buffer_load_dwordx4 a[136:139], v15, s[24:27], s65 offen offset:2048 sc1
v_mfma_f32_16x16x32_bf16 v[92:95], v[168:171], a[228:231], v[92:95]
s_waitcnt lgkmcnt(6)
ds_read_b128 v[160:163], v8 offset:0
v_add_u32 v7, s91, v4
v_mfma_f32_16x16x32_bf16 v[96:99], v[176:179], a[224:227], v[96:99]
s_xor_b32 s93, s82, 49152
s_add_u32 s93, s93, s81
ds_read_b128 v[164:167], v8 offset:1024
v_mfma_f32_16x16x32_bf16 v[96:99], v[180:183], a[232:235], v[96:99]
v_lshl_add_u32 v5, v9, 5, v5
v_lshrrev_b32 v9, 1, v3
v_mfma_f32_16x16x32_bf16 v[100:103], v[180:183], a[236:239], v[100:103]
buffer_load_dwordx4 a[132:135], v15, s[24:27], s93 offen offset:0 sc1
v_mfma_f32_16x16x32_bf16 v[100:103], v[176:179], a[228:231], v[100:103]
s_waitcnt lgkmcnt(6) vmcnt(13)
ds_read_b128 v[168:171], v8 offset:2048
v_lshl_add_u32 v5, v9, 4, v5
v_mfma_f32_16x16x32_bf16 v[120:123], v[184:187], a[240:243], v[120:123]
ds_read_b128 v[172:175], v8 offset:3072
v_mfma_f32_16x16x32_bf16 v[120:123], v[188:191], a[248:251], v[120:123]
s_waitcnt vmcnt(11)
v_mfma_f32_16x16x32_bf16 v[124:127], v[188:191], a[252:255], v[124:127]
buffer_load_dwordx4 a[140:143], v15, s[24:27], s93 offen offset:2048 sc1
v_mfma_f32_16x16x32_bf16 v[124:127], v[184:187], a[244:247], v[124:127]
s_waitcnt lgkmcnt(6)
ds_read_b128 v[176:179], v8 offset:4096
v_mfma_f32_16x16x32_bf16 v[72:75], v[144:147], a[240:243], v[72:75]
ds_read_b128 v[180:183], v8 offset:5120
v_mfma_f32_16x16x32_bf16 v[72:75], v[148:151], a[248:251], v[72:75]
v_mfma_f32_16x16x32_bf16 v[76:79], v[148:151], a[252:255], v[76:79]
ds_read_b128 v[184:187], v8 offset:6144
v_mfma_f32_16x16x32_bf16 v[76:79], v[144:147], a[244:247], v[76:79]
s_waitcnt lgkmcnt(7)
v_mfma_f32_16x16x32_bf16 v[80:83], v[152:155], a[240:243], v[80:83]
ds_read_b128 v[188:191], v8 offset:7168
v_mfma_f32_16x16x32_bf16 v[80:83], v[156:159], a[248:251], v[80:83]
s_waitcnt lgkmcnt(6)
v_mfma_f32_16x16x32_bf16 v[84:87], v[156:159], a[252:255], v[84:87]
buffer_load_dword v12, v10, s[24:27], s75 offen offset:128 sc1
v_mfma_f32_16x16x32_bf16 v[84:87], v[152:155], a[244:247], v[84:87]
buffer_load_dwordx4 a[144:147], v14, s[24:27], s65 offen offset:0 sc1
v_mfma_f32_16x16x32_bf16 v[88:91], v[160:163], a[240:243], v[88:91]
ds_read_b128 v[144:147], v8 offset:8192
v_mfma_f32_16x16x32_bf16 v[88:91], v[164:167], a[248:251], v[88:91]
ds_read_b128 v[148:151], v8 offset:9216
v_mfma_f32_16x16x32_bf16 v[92:95], v[164:167], a[252:255], v[92:95]
buffer_load_dwordx4 a[152:155], v14, s[24:27], s65 offen offset:2048 sc1
v_mfma_f32_16x16x32_bf16 v[92:95], v[160:163], a[244:247], v[92:95]
s_waitcnt lgkmcnt(6)
ds_read_b128 v[152:155], v8 offset:10240
v_mfma_f32_16x16x32_bf16 v[96:99], v[168:171], a[240:243], v[96:99]
ds_read_b128 v[156:159], v8 offset:11264
v_mfma_f32_16x16x32_bf16 v[96:99], v[172:175], a[248:251], v[96:99]
v_mfma_f32_16x16x32_bf16 v[100:103], v[172:175], a[252:255], v[100:103]
buffer_load_dwordx4 a[148:151], v14, s[24:27], s93 offen offset:0 sc1
v_mfma_f32_16x16x32_bf16 v[100:103], v[168:171], a[244:247], v[100:103]
s_waitcnt lgkmcnt(6) vmcnt(14)
ds_read_b128 v[160:163], v8 offset:12288
v_mfma_f32_16x16x32_bf16 v[120:123], v[176:179], a[96:99], v[120:123]
ds_read_b128 v[164:167], v8 offset:13312
v_mfma_f32_16x16x32_bf16 v[120:123], v[180:183], a[104:107], v[120:123]
s_waitcnt vmcnt(12)
v_mfma_f32_16x16x32_bf16 v[124:127], v[180:183], a[108:111], v[124:127]
buffer_load_dwordx4 a[156:159], v14, s[24:27], s93 offen offset:2048 sc1
v_mfma_f32_16x16x32_bf16 v[124:127], v[176:179], a[100:103], v[124:127]
s_waitcnt lgkmcnt(6)
ds_read_b128 v[168:171], v8 offset:14336
v_mfma_f32_16x16x32_bf16 v[72:75], v[184:187], a[96:99], v[72:75]
s_waitcnt vmcnt(62)
ds_read_b128 v[172:175], v8 offset:15360
v_mfma_f32_16x16x32_bf16 v[72:75], v[188:191], a[104:107], v[72:75]
s_barrier
v_mfma_f32_16x16x32_bf16 v[76:79], v[188:191], a[108:111], v[76:79]
s_add_u32 s91, s91, 16384
ds_read_b128 v[176:179], v7 offset:0
v_mfma_f32_16x16x32_bf16 v[76:79], v[184:187], a[100:103], v[76:79]
s_waitcnt lgkmcnt(7)
s_cmp_ge_u32 s91, 163840
s_cselect_b32 s91, 0, s91
v_mfma_f32_16x16x32_bf16 v[80:83], v[144:147], a[96:99], v[80:83]
s_xor_b32 s65, s82, 57344
s_add_u32 s65, s65, s77
ds_read_b128 v[180:183], v7 offset:1024
v_mfma_f32_16x16x32_bf16 v[80:83], v[148:151], a[104:107], v[80:83]
v_add_u32 v8, s91, v4
v_mfma_f32_16x16x32_bf16 v[84:87], v[148:151], a[108:111], v[84:87]
buffer_load_dwordx4 a[160:163], v15, s[24:27], s65 offen offset:0 sc1
v_mfma_f32_16x16x32_bf16 v[84:87], v[144:147], a[100:103], v[84:87]
s_waitcnt lgkmcnt(6)
ds_read_b128 v[184:187], v7 offset:2048
v_mfma_f32_16x16x32_bf16 v[88:91], v[152:155], a[96:99], v[88:91]
ds_read_b128 v[188:191], v7 offset:3072
v_mfma_f32_16x16x32_bf16 v[88:91], v[156:159], a[104:107], v[88:91]
v_mfma_f32_16x16x32_bf16 v[92:95], v[156:159], a[108:111], v[92:95]
buffer_load_dwordx4 a[168:171], v15, s[24:27], s65 offen offset:2048 sc1
v_mfma_f32_16x16x32_bf16 v[92:95], v[152:155], a[100:103], v[92:95]
s_waitcnt lgkmcnt(6)
ds_read_b128 v[144:147], v7 offset:4096
v_mfma_f32_16x16x32_bf16 v[96:99], v[160:163], a[96:99], v[96:99]
s_xor_b32 s93, s82, 57344
s_add_u32 s93, s93, s81
ds_read_b128 v[148:151], v7 offset:5120
v_mfma_f32_16x16x32_bf16 v[96:99], v[164:167], a[104:107], v[96:99]
v_mfma_f32_16x16x32_bf16 v[100:103], v[164:167], a[108:111], v[100:103]
buffer_load_dwordx4 a[164:167], v15, s[24:27], s93 offen offset:0 sc1
v_mfma_f32_16x16x32_bf16 v[100:103], v[160:163], a[100:103], v[100:103]
s_waitcnt lgkmcnt(6) vmcnt(14)
ds_read_b128 v[152:155], v7 offset:6144
v_mfma_f32_16x16x32_bf16 v[120:123], v[168:171], a[112:115], v[120:123]
ds_read_b128 v[156:159], v7 offset:7168
v_mfma_f32_16x16x32_bf16 v[120:123], v[172:175], a[120:123], v[120:123]
s_waitcnt vmcnt(12)
v_mfma_f32_16x16x32_bf16 v[124:127], v[172:175], a[124:127], v[124:127]
buffer_load_dwordx4 a[172:175], v15, s[24:27], s93 offen offset:2048 sc1
v_mfma_f32_16x16x32_bf16 v[124:127], v[168:171], a[116:119], v[124:127]
s_waitcnt lgkmcnt(6)
ds_read_b128 v[160:163], v7 offset:8192
v_mfma_f32_16x16x32_bf16 v[72:75], v[176:179], a[112:115], v[72:75]
ds_read_b128 v[164:167], v7 offset:9216
v_mfma_f32_16x16x32_bf16 v[72:75], v[180:183], a[120:123], v[72:75]
v_mfma_f32_16x16x32_bf16 v[76:79], v[180:183], a[124:127], v[76:79]
ds_read_b128 v[168:171], v7 offset:10240
v_mfma_f32_16x16x32_bf16 v[76:79], v[176:179], a[116:119], v[76:79]
s_waitcnt lgkmcnt(7)
v_mfma_f32_16x16x32_bf16 v[80:83], v[184:187], a[112:115], v[80:83]
ds_read_b128 v[172:175], v7 offset:11264
v_mfma_f32_16x16x32_bf16 v[80:83], v[188:191], a[120:123], v[80:83]
v_mfma_f32_16x16x32_bf16 v[84:87], v[188:191], a[124:127], v[84:87]
buffer_load_dwordx4 a[176:179], v14, s[24:27], s65 offen offset:0 sc1
v_mfma_f32_16x16x32_bf16 v[84:87], v[184:187], a[116:119], v[84:87]
s_waitcnt lgkmcnt(6)
ds_read_b128 v[176:179], v7 offset:12288
v_mfma_f32_16x16x32_bf16 v[88:91], v[144:147], a[112:115], v[88:91]
ds_read_b128 v[180:183], v7 offset:13312
v_mfma_f32_16x16x32_bf16 v[88:91], v[148:151], a[120:123], v[88:91]
v_mfma_f32_16x16x32_bf16 v[92:95], v[148:151], a[124:127], v[92:95]
buffer_load_dwordx4 a[184:187], v14, s[24:27], s65 offen offset:2048 sc1
v_mfma_f32_16x16x32_bf16 v[92:95], v[144:147], a[116:119], v[92:95]
s_waitcnt lgkmcnt(6)
ds_read_b128 v[184:187], v7 offset:14336
v_mfma_f32_16x16x32_bf16 v[96:99], v[152:155], a[112:115], v[96:99]
s_waitcnt vmcnt(10)
ds_read_b128 v[188:191], v7 offset:15360
v_mfma_f32_16x16x32_bf16 v[96:99], v[156:159], a[120:123], v[96:99]
s_add_u32 s91, s91, 16384
v_cmp_gt_u32 vcc, 8, v12
v_mfma_f32_16x16x32_bf16 v[100:103], v[156:159], a[124:127], v[100:103]
buffer_load_dwordx4 a[180:183], v14, s[24:27], s93 offen offset:0 sc1
v_mfma_f32_16x16x32_bf16 v[100:103], v[152:155], a[116:119], v[100:103]
s_waitcnt lgkmcnt(6) vmcnt(14)
ds_read_b128 v[144:147], v8 offset:0
v_mfma_f32_16x16x32_bf16 v[120:123], v[160:163], a[128:131], v[120:123]
s_cmp_ge_u32 s91, 163840
s_cselect_b32 s91, 0, s91
ds_read_b128 v[148:151], v8 offset:1024
v_mfma_f32_16x16x32_bf16 v[120:123], v[164:167], a[136:139], v[120:123]
s_waitcnt lgkmcnt(6) vmcnt(12)
v_add_u32 v7, s91, v4
v_mfma_f32_16x16x32_bf16 v[124:127], v[164:167], a[140:143], v[124:127]
s_cbranch_vccnz CK_ZAA
CK_ZAA_R:
v_mfma_f32_16x16x32_bf16 v[124:127], v[160:163], a[132:135], v[124:127]
buffer_load_dwordx4 a[188:191], v14, s[24:27], s93 offen offset:2048 sc1
v_mfma_f32_16x16x32_bf16 v[72:75], v[168:171], a[128:131], v[72:75]
ds_read_b128 v[152:155], v8 offset:2048
v_mfma_f32_16x16x32_bf16 v[72:75], v[172:175], a[136:139], v[72:75]
ds_read_b128 v[156:159], v8 offset:3072
v_mfma_f32_16x16x32_bf16 v[76:79], v[172:175], a[140:143], v[76:79]
ds_read_b128 v[160:163], v8 offset:4096
v_mfma_f32_16x16x32_bf16 v[76:79], v[168:171], a[132:135], v[76:79]
s_waitcnt lgkmcnt(7)
v_mfma_f32_16x16x32_bf16 v[80:83], v[176:179], a[128:131], v[80:83]
s_add_u32 s65, s77, 65536
ds_read_b128 v[164:167], v8 offset:5120
v_mfma_f32_16x16x32_bf16 v[80:83], v[180:183], a[136:139], v[80:83]
v_mfma_f32_16x16x32_bf16 v[84:87], v[180:183], a[140:143], v[84:87]
buffer_load_dwordx4 v[32:35], v15, s[24:27], s65 offen offset:0 sc1
v_mfma_f32_16x16x32_bf16 v[84:87], v[176:179], a[132:135], v[84:87]
s_waitcnt lgkmcnt(6)
ds_read_b128 v[168:171], v8 offset:6144
v_mfma_f32_16x16x32_bf16 v[88:91], v[184:187], a[128:131], v[88:91]
ds_read_b128 v[172:175], v8 offset:7168
v_mfma_f32_16x16x32_bf16 v[88:91], v[188:191], a[136:139], v[88:91]
v_mfma_f32_16x16x32_bf16 v[92:95], v[188:191], a[140:143], v[92:95]
buffer_load_dwordx4 v[40:43], v15, s[24:27], s65 offen offset:2048 sc1
v_mfma_f32_16x16x32_bf16 v[92:95], v[184:187], a[132:135], v[92:95]
s_waitcnt lgkmcnt(6)
ds_read_b128 v[176:179], v8 offset:8192
v_mfma_f32_16x16x32_bf16 v[96:99], v[144:147], a[128:131], v[96:99]
s_add_u32 s93, s81, 65536
ds_read_b128 v[180:183], v8 offset:9216
v_mfma_f32_16x16x32_bf16 v[96:99], v[148:151], a[136:139], v[96:99]
s_waitcnt lgkmcnt(6) vmcnt(12)
v_mfma_f32_16x16x32_bf16 v[100:103], v[148:151], a[140:143], v[100:103]
buffer_load_dwordx4 v[36:39], v15, s[24:27], s93 offen offset:0 sc1
v_mfma_f32_16x16x32_bf16 v[100:103], v[144:147], a[132:135], v[100:103]
s_mov_b32 m0, s70
s_mov_b32 s64, s68
s_add_u32 s68, s68, 16384
v_mfma_f32_16x16x32_bf16 v[120:123], v[152:155], a[144:147], v[120:123]
s_waitcnt vmcnt(11)
ds_read_b128 v[184:187], v8 offset:10240
v_mfma_f32_16x16x32_bf16 v[120:123], v[156:159], a[152:155], v[120:123]
s_add_u32 s70, s70, 16384
s_cmp_ge_u32 s70, 163840
s_cselect_b32 s70, s80, s70
v_mfma_f32_16x16x32_bf16 v[124:127], v[156:159], a[156:159], v[124:127]
buffer_load_dwordx4 v15, s[24:27], s64 offen offset:0 sc1 lds
v_mfma_f32_16x16x32_bf16 v[124:127], v[152:155], a[148:151], v[124:127]
s_waitcnt lgkmcnt(5)
ds_read_b128 v[188:191], v8 offset:11264
v_mfma_f32_16x16x32_bf16 v[72:75], v[160:163], a[144:147], v[72:75]
ds_read_b128 v[144:147], v8 offset:12288
v_mfma_f32_16x16x32_bf16 v[72:75], v[164:167], a[152:155], v[72:75]
buffer_load_dwordx4 v15, s[24:27], s64 offen offset:1024 sc1 lds
v_mfma_f32_16x16x32_bf16 v[76:79], v[164:167], a[156:159], v[76:79]
ds_read_b128 v[148:151], v8 offset:13312
v_mfma_f32_16x16x32_bf16 v[76:79], v[160:163], a[148:151], v[76:79]
s_waitcnt lgkmcnt(6)
ds_read_b128 v[152:155], v8 offset:14336
v_mfma_f32_16x16x32_bf16 v[80:83], v[168:171], a[144:147], v[80:83]
buffer_load_dwordx4 v[44:47], v15, s[24:27], s93 offen offset:2048 sc1
v_mfma_f32_16x16x32_bf16 v[80:83], v[172:175], a[152:155], v[80:83]
s_barrier
v_mfma_f32_16x16x32_bf16 v[84:87], v[172:175], a[156:159], v[84:87]
s_waitcnt lgkmcnt(5)
ds_read_b128 v[156:159], v8 offset:15360
v_mfma_f32_16x16x32_bf16 v[84:87], v[168:171], a[148:151], v[84:87]
buffer_load_dwordx4 v15, s[24:27], s64 offen offset:2048 sc1 lds
v_mfma_f32_16x16x32_bf16 v[88:91], v[176:179], a[144:147], v[88:91]
s_add_u32 s91, s91, 16384
ds_read_b128 v[160:163], v7 offset:0
v_mfma_f32_16x16x32_bf16 v[88:91], v[180:183], a[152:155], v[88:91]
s_cmp_ge_u32 s91, 163840
s_cselect_b32 s91, 0, s91
ds_read_b128 v[164:167], v7 offset:1024
v_mfma_f32_16x16x32_bf16 v[92:95], v[180:183], a[156:159], v[92:95]
buffer_load_dwordx4 v15, s[24:27], s64 offen offset:3072 sc1 lds
v_mfma_f32_16x16x32_bf16 v[92:95], v[176:179], a[148:151], v[92:95]
s_waitcnt lgkmcnt(6)
ds_read_b128 v[168:171], v7 offset:2048
v_add_u32 v8, s91, v4
v_mfma_f32_16x16x32_bf16 v[96:99], v[184:187], a[144:147], v[96:99]
ds_read_b128 v[172:175], v7 offset:3072
v_mfma_f32_16x16x32_bf16 v[96:99], v[188:191], a[152:155], v[96:99]
buffer_load_dwordx4 v[48:51], v14, s[24:27], s65 offen offset:0 sc1
v_mfma_f32_16x16x32_bf16 v[100:103], v[188:191], a[156:159], v[100:103]
ds_read_b128 v[176:179], v7 offset:4096
v_mfma_f32_16x16x32_bf16 v[100:103], v[184:187], a[148:151], v[100:103]
s_waitcnt lgkmcnt(7) vmcnt(15)
v_mfma_f32_16x16x32_bf16 v[120:123], v[144:147], a[160:163], v[120:123]
buffer_load_dwordx4 v[56:59], v14, s[24:27], s65 offen offset:2048 sc1
v_mfma_f32_16x16x32_bf16 v[120:123], v[148:151], a[168:171], v[120:123]
s_waitcnt vmcnt(14)
ds_read_b128 v[180:183], v7 offset:5120
v_mfma_f32_16x16x32_bf16 v[124:127], v[148:151], a[172:175], v[124:127]
s_waitcnt lgkmcnt(6)
ds_read_b128 v[184:187], v7 offset:6144
v_mfma_f32_16x16x32_bf16 v[124:127], v[144:147], a[164:167], v[124:127]
buffer_load_dwordx4 v[52:55], v14, s[24:27], s93 offen offset:0 sc1
v_mfma_f32_16x16x32_bf16 v[72:75], v[152:155], a[160:163], v[72:75]
ds_read_b128 v[188:191], v7 offset:7168
v_mfma_f32_16x16x32_bf16 v[72:75], v[156:159], a[168:171], v[72:75]
v_mfma_f32_16x16x32_bf16 v[76:79], v[156:159], a[172:175], v[76:79]
buffer_load_dwordx4 v[60:63], v14, s[24:27], s93 offen offset:2048 sc1
v_mfma_f32_16x16x32_bf16 v[76:79], v[152:155], a[164:167], v[76:79]
s_waitcnt lgkmcnt(6)
ds_read_b128 v[144:147], v7 offset:8192
v_mfma_f32_16x16x32_bf16 v[80:83], v[160:163], a[160:163], v[80:83]
ds_read_b128 v[148:151], v7 offset:9216
v_mfma_f32_16x16x32_bf16 v[80:83], v[164:167], a[168:171], v[80:83]
v_mfma_f32_16x16x32_bf16 v[84:87], v[164:167], a[172:175], v[84:87]
ds_read_b128 v[152:155], v7 offset:10240
v_mfma_f32_16x16x32_bf16 v[84:87], v[160:163], a[164:167], v[84:87]
s_waitcnt lgkmcnt(7)
v_mfma_f32_16x16x32_bf16 v[88:91], v[168:171], a[160:163], v[88:91]
s_add_u32 s65, s77, 73728
ds_read_b128 v[156:159], v7 offset:11264
v_mfma_f32_16x16x32_bf16 v[88:91], v[172:175], a[168:171], v[88:91]
v_mfma_f32_16x16x32_bf16 v[92:95], v[172:175], a[172:175], v[92:95]
buffer_load_dwordx4 v[64:67], v15, s[24:27], s65 offen offset:0 sc1
v_mfma_f32_16x16x32_bf16 v[92:95], v[168:171], a[164:167], v[92:95]
s_waitcnt lgkmcnt(6)
ds_read_b128 v[160:163], v7 offset:12288
v_mfma_f32_16x16x32_bf16 v[96:99], v[176:179], a[160:163], v[96:99]
ds_read_b128 v[164:167], v7 offset:13312
v_mfma_f32_16x16x32_bf16 v[96:99], v[180:183], a[168:171], v[96:99]
v_mfma_f32_16x16x32_bf16 v[100:103], v[180:183], a[172:175], v[100:103]
ds_read_b128 v[168:171], v7 offset:14336
v_mfma_f32_16x16x32_bf16 v[100:103], v[176:179], a[164:167], v[100:103]
s_add_u32 s93, s81, 73728
s_waitcnt lgkmcnt(7) vmcnt(15)
v_mfma_f32_16x16x32_bf16 v[120:123], v[184:187], a[176:179], v[120:123]
s_waitcnt vmcnt(13)
ds_read_b128 v[172:175], v7 offset:15360
v_mfma_f32_16x16x32_bf16 v[120:123], v[188:191], a[184:187], v[120:123]
buffer_load_dwordx4 v[68:71], v15, s[24:27], s93 offen offset:0 sc1
v_mfma_f32_16x16x32_bf16 v[124:127], v[188:191], a[188:191], v[124:127]
s_add_u32 s91, s91, 16384
ds_read_b128 v[176:179], v8 offset:0
v_mfma_f32_16x16x32_bf16 v[124:127], v[184:187], a[180:183], v[124:127]
s_waitcnt lgkmcnt(7)
s_cmp_ge_u32 s91, 163840
s_cselect_b32 s91, 0, s91
v_mfma_f32_16x16x32_bf16 v[72:75], v[144:147], a[176:179], v[72:75]
ds_read_b128 v[180:183], v8 offset:1024
v_add_u32 v7, s91, v4
v_mfma_f32_16x16x32_bf16 v[72:75], v[148:151], a[184:187], v[72:75]
v_mfma_f32_16x16x32_bf16 v[76:79], v[148:151], a[188:191], v[76:79]
s_mov_b32 m0, s70
s_mov_b32 s64, s68
s_add_u32 s68, s68, 16384
v_mfma_f32_16x16x32_bf16 v[76:79], v[144:147], a[180:183], v[76:79]
s_waitcnt lgkmcnt(6)
ds_read_b128 v[184:187], v8 offset:2048
v_mfma_f32_16x16x32_bf16 v[80:83], v[152:155], a[176:179], v[80:83]
s_add_u32 s70, s70, 16384
s_cmp_ge_u32 s70, 163840
s_cselect_b32 s70, s80, s70
v_mfma_f32_16x16x32_bf16 v[80:83], v[156:159], a[184:187], v[80:83]
buffer_load_dwordx4 v15, s[24:27], s64 offen offset:0 sc1 lds
v_mfma_f32_16x16x32_bf16 v[84:87], v[156:159], a[188:191], v[84:87]
L_PAD12:
s_cbranch_execz L_MAIN
ds_read_b128 v[188:191], v8 offset:3072
v_mfma_f32_16x16x32_bf16 v[84:87], v[152:155], a[180:183], v[84:87]
s_waitcnt lgkmcnt(6)
ds_read_b128 v[144:147], v8 offset:4096
v_mfma_f32_16x16x32_bf16 v[88:91], v[160:163], a[176:179], v[88:91]
buffer_load_dwordx4 v15, s[24:27], s64 offen offset:1024 sc1 lds
v_mfma_f32_16x16x32_bf16 v[88:91], v[164:167], a[184:187], v[88:91]
ds_read_b128 v[148:151], v8 offset:5120
v_mfma_f32_16x16x32_bf16 v[92:95], v[164:167], a[188:191], v[92:95]
s_waitcnt lgkmcnt(6)
ds_read_b128 v[152:155], v8 offset:6144
v_mfma_f32_16x16x32_bf16 v[92:95], v[160:163], a[180:183], v[92:95]
buffer_load_dwordx4 v15, s[24:27], s64 offen offset:2048 sc1 lds
v_mfma_f32_16x16x32_bf16 v[96:99], v[168:171], a[176:179], v[96:99]
ds_read_b128 v[156:159], v8 offset:7168
v_mfma_f32_16x16x32_bf16 v[96:99], v[172:175], a[184:187], v[96:99]
v_mfma_f32_16x16x32_bf16 v[100:103], v[172:175], a[188:191], v[100:103]
buffer_load_dwordx4 v15, s[24:27], s64 offen offset:3072 sc1 lds
v_mfma_f32_16x16x32_bf16 v[100:103], v[168:171], a[180:183], v[100:103]
s_waitcnt lgkmcnt(6) vmcnt(16)
ds_read_b128 v[160:163], v8 offset:8192
v_mfma_f32_16x16x32_bf16 v[120:123], v[176:179], v[32:35], v[120:123]
s_mov_b32 m0, s70
s_mov_b32 s64, s68
s_add_u32 s68, s68, 16384
v_mfma_f32_16x16x32_bf16 v[120:123], v[180:183], v[40:43], v[120:123]
s_waitcnt lgkmcnt(5) vmcnt(12)
ds_read_b128 v[164:167], v8 offset:9216
v_mfma_f32_16x16x32_bf16 v[124:127], v[180:183], v[44:47], v[124:127]
s_add_u32 s70, s70, 16384
s_cmp_ge_u32 s70, 163840
s_cselect_b32 s70, s80, s70
v_mfma_f32_16x16x32_bf16 v[124:127], v[176:179], v[36:39], v[124:127]
buffer_load_dwordx4 v15, s[24:27], s64 offen offset:0 sc1 lds
v_mfma_f32_16x16x32_bf16 v[72:75], v[184:187], v[32:35], v[72:75]
ds_read_b128 v[168:171], v8 offset:10240
v_mfma_f32_16x16x32_bf16 v[72:75], v[188:191], v[40:43], v[72:75]
ds_read_b128 v[172:175], v8 offset:11264
v_mfma_f32_16x16x32_bf16 v[76:79], v[188:191], v[44:47], v[76:79]
buffer_load_dwordx4 v15, s[24:27], s64 offen offset:1024 sc1 lds
v_mfma_f32_16x16x32_bf16 v[76:79], v[184:187], v[36:39], v[76:79]
s_waitcnt lgkmcnt(6)
ds_read_b128 v[176:179], v8 offset:12288
v_mfma_f32_16x16x32_bf16 v[80:83], v[144:147], v[32:35], v[80:83]
ds_read_b128 v[180:183], v8 offset:13312
v_mfma_f32_16x16x32_bf16 v[80:83], v[148:151], v[40:43], v[80:83]
buffer_load_dwordx4 v15, s[24:27], s64 offen offset:2048 sc1 lds
v_mfma_f32_16x16x32_bf16 v[84:87], v[148:151], v[44:47], v[84:87]
ds_read_b128 v[184:187], v8 offset:14336
v_mfma_f32_16x16x32_bf16 v[84:87], v[144:147], v[36:39], v[84:87]
s_waitcnt lgkmcnt(7)
v_mfma_f32_16x16x32_bf16 v[88:91], v[152:155], v[32:35], v[88:91]
s_waitcnt vmcnt(13)
ds_read_b128 v[188:191], v8 offset:15360
v_mfma_f32_16x16x32_bf16 v[88:91], v[156:159], v[40:43], v[88:91]
s_barrier
v_mfma_f32_16x16x32_bf16 v[92:95], v[156:159], v[44:47], v[92:95]
buffer_load_dwordx4 v15, s[24:27], s64 offen offset:3072 sc1 lds
v_mfma_f32_16x16x32_bf16 v[92:95], v[152:155], v[36:39], v[92:95]
s_waitcnt lgkmcnt(6)
s_add_u32 s91, s91, 16384
ds_read_b128 v[144:147], v7 offset:0
v_mfma_f32_16x16x32_bf16 v[96:99], v[160:163], v[32:35], v[96:99]
s_cmp_ge_u32 s91, 163840
s_cselect_b32 s91, 0, s91
ds_read_b128 v[148:151], v7 offset:1024
v_mfma_f32_16x16x32_bf16 v[96:99], v[164:167], v[40:43], v[96:99]
v_add_u32 v8, s91, v4
v_mfma_f32_16x16x32_bf16 v[100:103], v[164:167], v[44:47], v[100:103]
ds_read_b128 v[152:155], v7 offset:2048
v_mfma_f32_16x16x32_bf16 v[100:103], v[160:163], v[36:39], v[100:103]
s_waitcnt lgkmcnt(7) vmcnt(12)
v_mfma_f32_16x16x32_bf16 v[120:123], v[168:171], v[48:51], v[120:123]
ds_read_b128 v[156:159], v7 offset:3072
v_mfma_f32_16x16x32_bf16 v[120:123], v[172:175], v[56:59], v[120:123]
s_waitcnt vmcnt(10)
v_mfma_f32_16x16x32_bf16 v[124:127], v[172:175], v[60:63], v[124:127]
ds_read_b128 v[160:163], v7 offset:4096
v_mfma_f32_16x16x32_bf16 v[124:127], v[168:171], v[52:55], v[124:127]
s_waitcnt lgkmcnt(7)
v_mfma_f32_16x16x32_bf16 v[72:75], v[176:179], v[48:51], v[72:75]
ds_read_b128 v[164:167], v7 offset:5120
v_mfma_f32_16x16x32_bf16 v[72:75], v[180:183], v[56:59], v[72:75]
v_mfma_f32_16x16x32_bf16 v[76:79], v[180:183], v[60:63], v[76:79]
ds_read_b128 v[168:171], v7 offset:6144
v_mfma_f32_16x16x32_bf16 v[76:79], v[176:179], v[52:55], v[76:79]
s_waitcnt lgkmcnt(7)
v_mfma_f32_16x16x32_bf16 v[80:83], v[184:187], v[48:51], v[80:83]
ds_read_b128 v[172:175], v7 offset:7168
v_mfma_f32_16x16x32_bf16 v[80:83], v[188:191], v[56:59], v[80:83]
v_mfma_f32_16x16x32_bf16 v[84:87], v[188:191], v[60:63], v[84:87]
ds_read_b128 v[176:179], v7 offset:8192
v_mfma_f32_16x16x32_bf16 v[84:87], v[184:187], v[52:55], v[84:87]
s_waitcnt lgkmcnt(7)
v_mfma_f32_16x16x32_bf16 v[88:91], v[144:147], v[48:51], v[88:91]
ds_read_b128 v[180:183], v7 offset:9216
v_mfma_f32_16x16x32_bf16 v[88:91], v[148:151], v[56:59], v[88:91]
v_mfma_f32_16x16x32_bf16 v[92:95], v[148:151], v[60:63], v[92:95]
ds_read_b128 v[184:187], v7 offset:10240
v_mfma_f32_16x16x32_bf16 v[92:95], v[144:147], v[52:55], v[92:95]
s_waitcnt lgkmcnt(7)
v_mfma_f32_16x16x32_bf16 v[96:99], v[152:155], v[48:51], v[96:99]
ds_read_b128 v[188:191], v7 offset:11264
v_mfma_f32_16x16x32_bf16 v[96:99], v[156:159], v[56:59], v[96:99]
v_mfma_f32_16x16x32_bf16 v[100:103], v[156:159], v[60:63], v[100:103]
ds_read_b128 v[144:147], v7 offset:12288
v_mfma_f32_16x16x32_bf16 v[100:103], v[152:155], v[52:55], v[100:103]
s_waitcnt lgkmcnt(7) vmcnt(9)
v_mfma_f32_16x16x32_bf16 v[120:123], v[160:163], v[64:67], v[120:123]
s_waitcnt vmcnt(8)
ds_read_b128 v[148:151], v7 offset:13312
v_mfma_f32_16x16x32_bf16 v[124:127], v[160:163], v[68:71], v[124:127]
v_mfma_f32_16x16x32_bf16 v[72:75], v[164:167], v[64:67], v[72:75]
ds_read_b128 v[152:155], v7 offset:14336
v_mfma_f32_16x16x32_bf16 v[76:79], v[164:167], v[68:71], v[76:79]
s_waitcnt lgkmcnt(7)
v_mfma_f32_16x16x32_bf16 v[80:83], v[168:171], v[64:67], v[80:83]
ds_read_b128 v[156:159], v7 offset:15360
v_mfma_f32_16x16x32_bf16 v[84:87], v[168:171], v[68:71], v[84:87]
s_add_u32 s91, s91, 16384
s_cmp_ge_u32 s91, 163840
s_cselect_b32 s91, 0, s91
v_mfma_f32_16x16x32_bf16 v[88:91], v[172:175], v[64:67], v[88:91]
ds_read_b128 v[160:163], v8 offset:0
v_add_u32 v7, s91, v4
v_mfma_f32_16x16x32_bf16 v[92:95], v[172:175], v[68:71], v[92:95]
s_waitcnt lgkmcnt(7)
v_mfma_f32_16x16x32_bf16 v[96:99], v[176:179], v[64:67], v[96:99]
ds_read_b128 v[164:167], v8 offset:1024
v_cvt_pk_bf16_f32 v228, v120, v121
v_mfma_f32_16x16x32_bf16 v[100:103], v[176:179], v[68:71], v[100:103]
v_cvt_pk_bf16_f32 v229, v122, v123
v_mfma_f32_16x16x32_bf16 v[104:107], v[180:183], a[64:67], v[104:107]
s_waitcnt lgkmcnt(6)
ds_read_b128 v[168:171], v8 offset:2048
v_cvt_pk_bf16_f32 v230, v124, v125
v_mfma_f32_16x16x32_bf16 v[104:107], v[184:187], a[72:75], v[104:107]
v_cvt_pk_bf16_f32 v231, v126, v127
v_mfma_f32_16x16x32_bf16 v[108:111], v[184:187], a[76:79], v[108:111]
buffer_store_dwordx4 v[228:231], v15, s[24:27], s55 offen offset:0 sc1
v_mfma_f32_16x16x32_bf16 v[108:111], v[180:183], a[68:71], v[108:111]
ds_read_b128 v[172:175], v8 offset:3072
v_cvt_pk_bf16_f32 v72, v72, v73
v_mfma_f32_16x16x32_bf16 v[112:115], v[188:191], a[64:67], v[112:115]
s_waitcnt lgkmcnt(6)
ds_read_b128 v[176:179], v8 offset:4096
v_cvt_pk_bf16_f32 v73, v74, v75
v_mfma_f32_16x16x32_bf16 v[112:115], v[144:147], a[72:75], v[112:115]
v_cvt_pk_bf16_f32 v74, v80, v81
v_mfma_f32_16x16x32_bf16 v[116:119], v[144:147], a[76:79], v[116:119]
ds_read_b128 v[180:183], v8 offset:5120
v_cvt_pk_bf16_f32 v75, v82, v83
v_mfma_f32_16x16x32_bf16 v[116:119], v[188:191], a[68:71], v[116:119]
buffer_store_dwordx4 v[72:75], v15, s[24:27], s52 offen offset:0 sc1
v_mfma_f32_16x16x32_bf16 v[104:107], v[148:151], a[80:83], v[104:107]
s_waitcnt lgkmcnt(6)
ds_read_b128 v[184:187], v8 offset:6144
v_cvt_pk_bf16_f32 v76, v76, v77
v_mfma_f32_16x16x32_bf16 v[104:107], v[152:155], a[88:91], v[104:107]
v_cvt_pk_bf16_f32 v77, v78, v79
v_mfma_f32_16x16x32_bf16 v[108:111], v[152:155], a[92:95], v[108:111]
ds_read_b128 v[188:191], v8 offset:7168
v_cvt_pk_bf16_f32 v78, v84, v85
v_mfma_f32_16x16x32_bf16 v[108:111], v[148:151], a[84:87], v[108:111]
s_waitcnt lgkmcnt(6)
v_cvt_pk_bf16_f32 v79, v86, v87
v_mfma_f32_16x16x32_bf16 v[112:115], v[156:159], a[80:83], v[112:115]
buffer_store_dwordx4 v[76:79], v15, s[24:27], s52 offen offset:1024 sc1
v_mfma_f32_16x16x32_bf16 v[112:115], v[160:163], a[88:91], v[112:115]
ds_read_b128 v[144:147], v8 offset:8192
v_cvt_pk_bf16_f32 v88, v88, v89
v_mfma_f32_16x16x32_bf16 v[116:119], v[160:163], a[92:95], v[116:119]
ds_read_b128 v[148:151], v8 offset:9216
v_cvt_pk_bf16_f32 v89, v90, v91
v_mfma_f32_16x16x32_bf16 v[116:119], v[156:159], a[84:87], v[116:119]
v_cvt_pk_bf16_f32 v90, v96, v97
v_mfma_f32_16x16x32_bf16 v[104:107], v[164:167], a[192:195], v[104:107]
s_waitcnt lgkmcnt(6)
ds_read_b128 v[152:155], v8 offset:10240
v_cvt_pk_bf16_f32 v91, v98, v99
v_mfma_f32_16x16x32_bf16 v[104:107], v[168:171], a[200:203], v[104:107]
buffer_store_dwordx4 v[88:91], v15, s[24:27], s53 offen offset:0 sc1
v_mfma_f32_16x16x32_bf16 v[108:111], v[168:171], a[204:207], v[108:111]
ds_read_b128 v[156:159], v8 offset:11264
v_cvt_pk_bf16_f32 v92, v92, v93
v_mfma_f32_16x16x32_bf16 v[108:111], v[164:167], a[196:199], v[108:111]
v_cvt_pk_bf16_f32 v93, v94, v95
v_mfma_f32_16x16x32_bf16 v[112:115], v[172:175], a[192:195], v[112:115]
s_waitcnt lgkmcnt(6)
ds_read_b128 v[160:163], v8 offset:12288
v_cvt_pk_bf16_f32 v94, v100, v101
v_mfma_f32_16x16x32_bf16 v[112:115], v[176:179], a[200:203], v[112:115]
s_waitcnt lgkmcnt(5)
v_cvt_pk_bf16_f32 v95, v102, v103
v_mfma_f32_16x16x32_bf16 v[116:119], v[176:179], a[204:207], v[116:119]
buffer_store_dwordx4 v[92:95], v15, s[24:27], s53 offen offset:1024 sc1
v_mfma_f32_16x16x32_bf16 v[116:119], v[172:175], a[196:199], v[116:119]
s_mov_b32 m0, s70
s_mov_b32 s64, s68
s_add_u32 s68, s68, 16384
v_mfma_f32_16x16x32_bf16 v[104:107], v[180:183], a[208:211], v[104:107]
s_add_u32 s70, s70, 16384
s_cmp_ge_u32 s70, 163840
s_cselect_b32 s70, s80, s70
v_mfma_f32_16x16x32_bf16 v[104:107], v[184:187], a[216:219], v[104:107]
buffer_load_dwordx4 v15, s[24:27], s64 offen offset:0 sc1 lds
v_mfma_f32_16x16x32_bf16 v[108:111], v[184:187], a[220:223], v[108:111]
s_waitcnt vmcnt(6) lgkmcnt(3)
ds_read_b128 v[164:167], v8 offset:13312
v_mfma_f32_16x16x32_bf16 v[108:111], v[180:183], a[212:215], v[108:111]
s_barrier
v_mfma_f32_16x16x32_bf16 v[112:115], v[188:191], a[208:211], v[112:115]
buffer_load_dwordx4 v15, s[24:27], s64 offen offset:1024 sc1 lds
v_mfma_f32_16x16x32_bf16 v[112:115], v[144:147], a[216:219], v[112:115]
ds_read_b128 v[168:171], v8 offset:14336
v_mfma_f32_16x16x32_bf16 v[116:119], v[144:147], a[220:223], v[116:119]
ds_read_b128 v[172:175], v8 offset:15360
v_mfma_f32_16x16x32_bf16 v[116:119], v[188:191], a[212:215], v[116:119]
buffer_load_dwordx4 v15, s[24:27], s64 offen offset:2048 sc1 lds
v_mfma_f32_16x16x32_bf16 v[104:107], v[148:151], a[224:227], v[104:107]
s_waitcnt lgkmcnt(4)
s_add_u32 s91, s91, 16384
ds_read_b128 v[176:179], v7 offset:0
v_mfma_f32_16x16x32_bf16 v[104:107], v[152:155], a[232:235], v[104:107]
s_cmp_ge_u32 s91, 163840
s_cselect_b32 s91, 0, s91
ds_read_b128 v[180:183], v7 offset:1024
v_mfma_f32_16x16x32_bf16 v[108:111], v[152:155], a[236:239], v[108:111]
buffer_load_dwordx4 v15, s[24:27], s64 offen offset:3072 sc1 lds
v_mfma_f32_16x16x32_bf16 v[108:111], v[148:151], a[228:231], v[108:111]
s_mov_b32 m0, s70
s_mov_b32 s64, s68
s_add_u32 s68, s68, 16384
v_mfma_f32_16x16x32_bf16 v[112:115], v[156:159], a[224:227], v[112:115]
s_waitcnt lgkmcnt(4)
ds_read_b128 v[184:187], v7 offset:2048
v_add_u32 v8, s91, v4
v_mfma_f32_16x16x32_bf16 v[112:115], v[160:163], a[232:235], v[112:115]
s_add_u32 s70, s70, 16384
s_cmp_ge_u32 s70, 163840
s_cselect_b32 s70, s80, s70
v_mfma_f32_16x16x32_bf16 v[116:119], v[160:163], a[236:239], v[116:119]
buffer_load_dwordx4 v15, s[24:27], s64 offen offset:0 sc1 lds
v_mfma_f32_16x16x32_bf16 v[116:119], v[156:159], a[228:231], v[116:119]
ds_read_b128 v[188:191], v7 offset:3072
v_mfma_f32_16x16x32_bf16 v[104:107], v[164:167], a[240:243], v[104:107]
s_waitcnt lgkmcnt(4)
ds_read_b128 v[144:147], v7 offset:4096
v_mfma_f32_16x16x32_bf16 v[104:107], v[168:171], a[248:251], v[104:107]
buffer_load_dwordx4 v15, s[24:27], s64 offen offset:1024 sc1 lds
v_mfma_f32_16x16x32_bf16 v[108:111], v[168:171], a[252:255], v[108:111]
ds_read_b128 v[148:151], v7 offset:5120
v_mfma_f32_16x16x32_bf16 v[108:111], v[164:167], a[244:247], v[108:111]
s_waitcnt lgkmcnt(4)
ds_read_b128 v[152:155], v7 offset:6144
v_mfma_f32_16x16x32_bf16 v[112:115], v[172:175], a[240:243], v[112:115]
buffer_load_dwordx4 v15, s[24:27], s64 offen offset:2048 sc1 lds
v_mfma_f32_16x16x32_bf16 v[112:115], v[176:179], a[248:251], v[112:115]
ds_read_b128 v[156:159], v7 offset:7168
v_mfma_f32_16x16x32_bf16 v[116:119], v[176:179], a[252:255], v[116:119]
ds_read_b128 v[160:163], v7 offset:8192
v_mfma_f32_16x16x32_bf16 v[116:119], v[172:175], a[244:247], v[116:119]
buffer_load_dwordx4 v15, s[24:27], s64 offen offset:3072 sc1 lds
v_mfma_f32_16x16x32_bf16 v[104:107], v[180:183], a[96:99], v[104:107]
s_waitcnt lgkmcnt(5)
ds_read_b128 v[164:167], v7 offset:9216
v_mfma_f32_16x16x32_bf16 v[104:107], v[184:187], a[104:107], v[104:107]
ds_read_b128 v[168:171], v7 offset:10240
v_mfma_f32_16x16x32_bf16 v[108:111], v[184:187], a[108:111], v[108:111]
ds_read_b128 v[172:175], v7 offset:11264
v_mfma_f32_16x16x32_bf16 v[108:111], v[180:183], a[100:103], v[108:111]
v_mfma_f32_16x16x32_bf16 v[112:115], v[188:191], a[96:99], v[112:115]
s_waitcnt lgkmcnt(6)
ds_read_b128 v[176:179], v7 offset:12288
v_mfma_f32_16x16x32_bf16 v[112:115], v[144:147], a[104:107], v[112:115]
v_mfma_f32_16x16x32_bf16 v[116:119], v[144:147], a[108:111], v[116:119]
ds_read_b128 v[180:183], v7 offset:13312
v_mfma_f32_16x16x32_bf16 v[116:119], v[188:191], a[100:103], v[116:119]
v_mfma_f32_16x16x32_bf16 v[104:107], v[148:151], a[112:115], v[104:107]
s_waitcnt lgkmcnt(6)
ds_read_b128 v[184:187], v7 offset:14336
v_mfma_f32_16x16x32_bf16 v[104:107], v[152:155], a[120:123], v[104:107]
v_mfma_f32_16x16x32_bf16 v[108:111], v[152:155], a[124:127], v[108:111]
ds_read_b128 v[188:191], v7 offset:15360
v_mfma_f32_16x16x32_bf16 v[108:111], v[148:151], a[116:119], v[108:111]
s_add_u32 s91, s91, 16384
s_cmp_ge_u32 s91, 163840
s_cselect_b32 s91, 0, s91
v_mfma_f32_16x16x32_bf16 v[112:115], v[156:159], a[112:115], v[112:115]
s_waitcnt lgkmcnt(6)
ds_read_b128 v[144:147], v8 offset:0
v_add_u32 v7, s91, v4
v_mfma_f32_16x16x32_bf16 v[112:115], v[160:163], a[120:123], v[112:115]
v_mfma_f32_16x16x32_bf16 v[116:119], v[160:163], a[124:127], v[116:119]
ds_read_b128 v[148:151], v8 offset:1024
v_mfma_f32_16x16x32_bf16 v[116:119], v[156:159], a[116:119], v[116:119]
s_waitcnt lgkmcnt(6)
v_mfma_f32_16x16x32_bf16 v[104:107], v[164:167], a[128:131], v[104:107]
s_mov_b32 m0, s70
s_mov_b32 s64, s68
s_add_u32 s68, s68, 16384
v_mfma_f32_16x16x32_bf16 v[104:107], v[168:171], a[136:139], v[104:107]
ds_read_b128 v[152:155], v8 offset:2048
v_mfma_f32_16x16x32_bf16 v[108:111], v[168:171], a[140:143], v[108:111]
s_add_u32 s70, s70, 16384
s_cmp_ge_u32 s70, 163840
s_cselect_b32 s70, s80, s70
v_mfma_f32_16x16x32_bf16 v[108:111], v[164:167], a[132:135], v[108:111]
buffer_load_dwordx4 v15, s[24:27], s64 offen offset:0 sc1 lds
v_mfma_f32_16x16x32_bf16 v[112:115], v[172:175], a[128:131], v[112:115]
s_waitcnt lgkmcnt(5)
ds_read_b128 v[156:159], v8 offset:3072
v_mfma_f32_16x16x32_bf16 v[112:115], v[176:179], a[136:139], v[112:115]
ds_read_b128 v[160:163], v8 offset:4096
v_mfma_f32_16x16x32_bf16 v[116:119], v[176:179], a[140:143], v[116:119]
buffer_load_dwordx4 v15, s[24:27], s64 offen offset:1024 sc1 lds
v_mfma_f32_16x16x32_bf16 v[116:119], v[172:175], a[132:135], v[116:119]
ds_read_b128 v[164:167], v8 offset:5120
v_mfma_f32_16x16x32_bf16 v[104:107], v[180:183], a[144:147], v[104:107]
s_waitcnt vmcnt(10) lgkmcnt(6)
ds_read_b128 v[168:171], v8 offset:6144
v_mfma_f32_16x16x32_bf16 v[104:107], v[184:187], a[152:155], v[104:107]
buffer_atomic_add v1, v0, s[24:27], s73 offen offset:0 sc1
v_mfma_f32_16x16x32_bf16 v[108:111], v[184:187], a[156:159], v[108:111]
buffer_load_dwordx4 v15, s[24:27], s64 offen offset:2048 sc1 lds
v_mfma_f32_16x16x32_bf16 v[108:111], v[180:183], a[148:151], v[108:111]
ds_read_b128 v[172:175], v8 offset:7168
v_mfma_f32_16x16x32_bf16 v[112:115], v[188:191], a[144:147], v[112:115]
s_waitcnt lgkmcnt(6)
ds_read_b128 v[176:179], v8 offset:8192
v_mfma_f32_16x16x32_bf16 v[112:115], v[144:147], a[152:155], v[112:115]
buffer_load_dwordx4 v15, s[24:27], s64 offen offset:3072 sc1 lds
v_mfma_f32_16x16x32_bf16 v[116:119], v[144:147], a[156:159], v[116:119]
s_mov_b32 m0, s70
s_mov_b32 s64, s68
s_add_u32 s68, s68, 16384
v_mfma_f32_16x16x32_bf16 v[116:119], v[188:191], a[148:151], v[116:119]
s_waitcnt lgkmcnt(5)
ds_read_b128 v[180:183], v8 offset:9216
v_mfma_f32_16x16x32_bf16 v[104:107], v[148:151], a[160:163], v[104:107]
s_add_u32 s70, s70, 16384
s_cmp_ge_u32 s70, 163840
s_cselect_b32 s70, s80, s70
v_mfma_f32_16x16x32_bf16 v[104:107], v[152:155], a[168:171], v[104:107]
buffer_load_dwordx4 v15, s[24:27], s64 offen offset:0 sc1 lds
v_mfma_f32_16x16x32_bf16 v[108:111], v[152:155], a[172:175], v[108:111]
ds_read_b128 v[184:187], v8 offset:10240
v_mfma_f32_16x16x32_bf16 v[108:111], v[148:151], a[164:167], v[108:111]
s_waitcnt lgkmcnt(5)
ds_read_b128 v[188:191], v8 offset:11264
v_mfma_f32_16x16x32_bf16 v[112:115], v[156:159], a[160:163], v[112:115]
buffer_load_dwordx4 v15, s[24:27], s64 offen offset:1024 sc1 lds
v_mfma_f32_16x16x32_bf16 v[112:115], v[160:163], a[168:171], v[112:115]
ds_read_b128 v[144:147], v8 offset:12288
v_mfma_f32_16x16x32_bf16 v[116:119], v[160:163], a[172:175], v[116:119]
s_add_u32 s82, s84, 3
ds_read_b128 v[148:151], v8 offset:13312
v_mfma_f32_16x16x32_bf16 v[116:119], v[156:159], a[164:167], v[116:119]
buffer_load_dwordx4 v15, s[24:27], s64 offen offset:2048 sc1 lds
v_mfma_f32_16x16x32_bf16 v[104:107], v[164:167], a[176:179], v[104:107]
s_and_b32 s82, s82, 3
s_waitcnt lgkmcnt(6)
ds_read_b128 v[152:155], v8 offset:14336
v_mfma_f32_16x16x32_bf16 v[104:107], v[168:171], a[184:187], v[104:107]
v_mfma_f32_16x16x32_bf16 v[108:111], v[168:171], a[188:191], v[108:111]
s_waitcnt vmcnt(8)
s_lshl_b32 s82, s82, 7
ds_read_b128 v[156:159], v8 offset:15360
v_mfma_f32_16x16x32_bf16 v[108:111], v[164:167], a[180:183], v[108:111]
s_barrier
v_mfma_f32_16x16x32_bf16 v[112:115], v[172:175], a[176:179], v[112:115]
s_add_u32 s82, s82, s73
s_waitcnt lgkmcnt(6)
ds_read_b128 v[160:163], v7 offset:0
v_mfma_f32_16x16x32_bf16 v[112:115], v[176:179], a[184:187], v[112:115]
buffer_load_dwordx4 v15, s[24:27], s64 offen offset:3072 sc1 lds
v_mfma_f32_16x16x32_bf16 v[116:119], v[176:179], a[188:191], v[116:119]
s_lshl_b32 s75, s84, 7
s_add_u32 s91, s91, 16384
ds_read_b128 v[164:167], v7 offset:1024
v_mfma_f32_16x16x32_bf16 v[116:119], v[172:175], a[180:183], v[116:119]
s_cmp_ge_u32 s91, 163840
s_cselect_b32 s91, 0, s91
v_add_u32 v8, s91, v4
v_mfma_f32_16x16x32_bf16 v[104:107], v[180:183], v[32:35], v[104:107]
s_add_u32 s75, s75, s73
s_waitcnt lgkmcnt(6)
ds_read_b128 v[168:171], v7 offset:2048
v_mfma_f32_16x16x32_bf16 v[104:107], v[184:187], v[40:43], v[104:107]
v_mfma_f32_16x16x32_bf16 v[108:111], v[184:187], v[44:47], v[108:111]
ds_read_b128 v[172:175], v7 offset:3072
v_mfma_f32_16x16x32_bf16 v[108:111], v[180:183], v[36:39], v[108:111]
v_mfma_f32_16x16x32_bf16 v[112:115], v[188:191], v[32:35], v[112:115]
s_waitcnt lgkmcnt(6)
ds_read_b128 v[176:179], v7 offset:4096
v_mfma_f32_16x16x32_bf16 v[112:115], v[144:147], v[40:43], v[112:115]
v_mfma_f32_16x16x32_bf16 v[116:119], v[144:147], v[44:47], v[116:119]
ds_read_b128 v[180:183], v7 offset:5120
v_mfma_f32_16x16x32_bf16 v[116:119], v[188:191], v[36:39], v[116:119]
v_mfma_f32_16x16x32_bf16 v[104:107], v[148:151], v[48:51], v[104:107]
s_waitcnt lgkmcnt(6)
ds_read_b128 v[184:187], v7 offset:6144
v_mfma_f32_16x16x32_bf16 v[104:107], v[152:155], v[56:59], v[104:107]
v_mfma_f32_16x16x32_bf16 v[108:111], v[152:155], v[60:63], v[108:111]
ds_read_b128 v[188:191], v7 offset:7168
v_mfma_f32_16x16x32_bf16 v[108:111], v[148:151], v[52:55], v[108:111]
v_mfma_f32_16x16x32_bf16 v[112:115], v[156:159], v[48:51], v[112:115]
s_waitcnt lgkmcnt(6)
ds_read_b128 v[144:147], v7 offset:8192
v_mfma_f32_16x16x32_bf16 v[112:115], v[160:163], v[56:59], v[112:115]
v_mfma_f32_16x16x32_bf16 v[116:119], v[160:163], v[60:63], v[116:119]
ds_read_b128 v[148:151], v7 offset:9216
v_mfma_f32_16x16x32_bf16 v[116:119], v[156:159], v[52:55], v[116:119]
v_mfma_f32_16x16x32_bf16 v[104:107], v[164:167], v[64:67], v[104:107]
ds_read_b128 v[152:155], v7 offset:10240
v_mfma_f32_16x16x32_bf16 v[108:111], v[164:167], v[68:71], v[108:111]
s_waitcnt lgkmcnt(7)
v_mfma_f32_16x16x32_bf16 v[112:115], v[168:171], v[64:67], v[112:115]
ds_read_b128 v[156:159], v7 offset:11264
v_mfma_f32_16x16x32_bf16 v[116:119], v[168:171], v[68:71], v[116:119]
v_mfma_f32_16x16x32_bf16 v[128:131], v[172:175], a[0:3], 0
s_waitcnt lgkmcnt(6)
ds_read_b128 v[160:163], v7 offset:12288
v_mfma_f32_16x16x32_bf16 v[128:131], v[176:179], a[8:11], v[128:131]
v_mfma_f32_16x16x32_bf16 v[132:135], v[176:179], a[12:15], 0
ds_read_b128 v[164:167], v7 offset:13312
v_mfma_f32_16x16x32_bf16 v[132:135], v[172:175], a[4:7], v[132:135]
v_mfma_f32_16x16x32_bf16 v[136:139], v[180:183], a[0:3], 0
s_waitcnt lgkmcnt(6)
ds_read_b128 v[168:171], v7 offset:14336
v_mfma_f32_16x16x32_bf16 v[136:139], v[184:187], a[8:11], v[136:139]
v_cvt_pk_bf16_f32 v104, v104, v105
v_mfma_f32_16x16x32_bf16 v[140:143], v[184:187], a[12:15], 0
ds_read_b128 v[172:175], v7 offset:15360
v_cvt_pk_bf16_f32 v105, v106, v107
v_mfma_f32_16x16x32_bf16 v[140:143], v[180:183], a[4:7], v[140:143]
s_add_u32 s91, s91, 16384
v_cvt_pk_bf16_f32 v106, v112, v113
v_mfma_f32_16x16x32_bf16 v[128:131], v[188:191], a[16:19], v[128:131]
s_waitcnt lgkmcnt(6)
ds_read_b128 v[176:179], v8 offset:0
v_cvt_pk_bf16_f32 v107, v114, v115
v_mfma_f32_16x16x32_bf16 v[128:131], v[144:147], a[24:27], v[128:131]
buffer_store_dwordx4 v[104:107], v15, s[24:27], s54 offen offset:0 sc1
v_mfma_f32_16x16x32_bf16 v[132:135], v[144:147], a[28:31], v[132:135]
ds_read_b128 v[180:183], v8 offset:1024
v_cvt_pk_bf16_f32 v108, v108, v109
v_mfma_f32_16x16x32_bf16 v[132:135], v[188:191], a[20:23], v[132:135]
s_cmp_ge_u32 s91, 163840
s_cselect_b32 s91, 0, s91
v_cvt_pk_bf16_f32 v109, v110, v111
v_mfma_f32_16x16x32_bf16 v[136:139], v[148:151], a[16:19], v[136:139]
s_waitcnt lgkmcnt(6)
ds_read_b128 v[184:187], v8 offset:2048
v_cvt_pk_bf16_f32 v110, v116, v117
v_mfma_f32_16x16x32_bf16 v[136:139], v[152:155], a[24:27], v[136:139]
s_waitcnt lgkmcnt(5)
v_cvt_pk_bf16_f32 v111, v118, v119
v_add_u32 v7, s91, v4
v_mfma_f32_16x16x32_bf16 v[140:143], v[152:155], a[28:31], v[140:143]
buffer_store_dwordx4 v[108:111], v15, s[24:27], s54 offen offset:1024 sc1
v_mfma_f32_16x16x32_bf16 v[140:143], v[148:151], a[20:23], v[140:143]
s_mov_b32 m0, s70
s_mov_b32 s64, s68
s_add_u32 s68, s68, 16384
v_mfma_f32_16x16x32_bf16 v[128:131], v[156:159], a[32:35], v[128:131]
s_cmp_lt_u32 s3, 3
s_cselect_b32 s68, s64, 2147418112
ds_read_b128 v[188:191], v8 offset:3072
v_mfma_f32_16x16x32_bf16 v[128:131], v[160:163], a[40:43], v[128:131]
buffer_load_dwordx4 v15, s[24:27], s64 offen offset:0 sc1 lds
v_mfma_f32_16x16x32_bf16 v[132:135], v[160:163], a[44:47], v[132:135]
ds_read_b128 v[144:147], v8 offset:4096
v_mfma_f32_16x16x32_bf16 v[132:135], v[156:159], a[36:39], v[132:135]
s_waitcnt lgkmcnt(5)
ds_read_b128 v[148:151], v8 offset:5120
v_mfma_f32_16x16x32_bf16 v[136:139], v[164:167], a[32:35], v[136:139]
buffer_load_dwordx4 v15, s[24:27], s68 offen offset:1024 sc1 lds
v_mfma_f32_16x16x32_bf16 v[136:139], v[168:171], a[40:43], v[136:139]
ds_read_b128 v[152:155], v8 offset:6144
v_mfma_f32_16x16x32_bf16 v[140:143], v[168:171], a[44:47], v[140:143]
ds_read_b128 v[156:159], v8 offset:7168
v_mfma_f32_16x16x32_bf16 v[140:143], v[164:167], a[36:39], v[140:143]
buffer_load_dwordx4 v15, s[24:27], s68 offen offset:2048 sc1 lds
v_mfma_f32_16x16x32_bf16 v[128:131], v[172:175], a[48:51], v[128:131]
s_waitcnt lgkmcnt(6)
ds_read_b128 v[160:163], v8 offset:8192
v_mfma_f32_16x16x32_bf16 v[128:131], v[176:179], a[56:59], v[128:131]
v_mfma_f32_16x16x32_bf16 v[132:135], v[176:179], a[60:63], v[132:135]
buffer_load_dwordx4 v15, s[24:27], s68 offen offset:3072 sc1 lds
v_mfma_f32_16x16x32_bf16 v[132:135], v[172:175], a[52:55], v[132:135]
buffer_load_dword v12, v10, s[24:27], s73 offen sc1
v_mfma_f32_16x16x32_bf16 v[136:139], v[180:183], a[48:51], v[136:139]
s_waitcnt lgkmcnt(5)
ds_read_b128 v[164:167], v8 offset:9216
v_mfma_f32_16x16x32_bf16 v[136:139], v[184:187], a[56:59], v[136:139]
ds_read_b128 v[168:171], v8 offset:10240
v_mfma_f32_16x16x32_bf16 v[140:143], v[184:187], a[60:63], v[140:143]
ds_read_b128 v[172:175], v8 offset:11264
v_mfma_f32_16x16x32_bf16 v[140:143], v[180:183], a[52:55], v[140:143]
v_mfma_f32_16x16x32_bf16 v[128:131], v[188:191], a[64:67], v[128:131]
s_waitcnt lgkmcnt(6)
ds_read_b128 v[176:179], v8 offset:12288
v_mfma_f32_16x16x32_bf16 v[128:131], v[144:147], a[72:75], v[128:131]
v_mfma_f32_16x16x32_bf16 v[132:135], v[144:147], a[76:79], v[132:135]
ds_read_b128 v[180:183], v8 offset:13312
v_mfma_f32_16x16x32_bf16 v[132:135], v[188:191], a[68:71], v[132:135]
v_mfma_f32_16x16x32_bf16 v[136:139], v[148:151], a[64:67], v[136:139]
s_waitcnt lgkmcnt(6)
ds_read_b128 v[184:187], v8 offset:14336
v_mfma_f32_16x16x32_bf16 v[136:139], v[152:155], a[72:75], v[136:139]
v_mfma_f32_16x16x32_bf16 v[140:143], v[152:155], a[76:79], v[140:143]
s_waitcnt vmcnt(7)
ds_read_b128 v[188:191], v8 offset:15360
v_mfma_f32_16x16x32_bf16 v[140:143], v[148:151], a[68:71], v[140:143]
s_barrier
v_mfma_f32_16x16x32_bf16 v[128:131], v[156:159], a[80:83], v[128:131]
s_waitcnt lgkmcnt(6)
s_add_u32 s91, s91, 16384
ds_read_b128 v[144:147], v7 offset:0
v_mfma_f32_16x16x32_bf16 v[128:131], v[160:163], a[88:91], v[128:131]
s_cmp_ge_u32 s91, 163840
s_cselect_b32 s91, 0, s91
v_add_u32 v8, s91, v4
v_mfma_f32_16x16x32_bf16 v[132:135], v[160:163], a[92:95], v[132:135]
ds_read_b128 v[148:151], v7 offset:1024
v_mfma_f32_16x16x32_bf16 v[132:135], v[156:159], a[84:87], v[132:135]
v_mfma_f32_16x16x32_bf16 v[136:139], v[164:167], a[80:83], v[136:139]
s_waitcnt vmcnt(5) lgkmcnt(6)
ds_read_b128 v[152:155], v7 offset:2048
v_mfma_f32_16x16x32_bf16 v[136:139], v[168:171], a[88:91], v[136:139]
buffer_atomic_add v1, v0, s[24:27], s82 offen offset:128 sc1
v_mfma_f32_16x16x32_bf16 v[140:143], v[168:171], a[92:95], v[140:143]
s_and_b32 s54, s3, 1
ds_read_b128 v[156:159], v7 offset:3072
v_mfma_f32_16x16x32_bf16 v[140:143], v[164:167], a[84:87], v[140:143]
s_mul_i32 s54, s54, 18432
v_mfma_f32_16x16x32_bf16 v[128:131], v[172:175], a[192:195], v[128:131]
s_waitcnt lgkmcnt(6)
s_mul_i32 s55, s86, 288
ds_read_b128 v[160:163], v7 offset:4096
v_mfma_f32_16x16x32_bf16 v[128:131], v[176:179], a[200:203], v[128:131]
s_add_u32 s54, s54, s55
v_mfma_f32_16x16x32_bf16 v[132:135], v[176:179], a[204:207], v[132:135]
s_add_u32 s54, s54, 256
ds_read_b128 v[164:167], v7 offset:5120
v_mfma_f32_16x16x32_bf16 v[132:135], v[172:175], a[196:199], v[132:135]
s_sub_u32 s55, 63, s72
v_mfma_f32_16x16x32_bf16 v[136:139], v[180:183], a[192:195], v[136:139]
s_waitcnt lgkmcnt(6)
s_mul_i32 s55, s55, 36864
ds_read_b128 v[168:171], v7 offset:6144
v_mfma_f32_16x16x32_bf16 v[136:139], v[184:187], a[200:203], v[136:139]
s_waitcnt vmcnt(1)
s_add_u32 s55, s55, s54
v_cmp_gt_u32 vcc, 4, v12
v_mfma_f32_16x16x32_bf16 v[140:143], v[184:187], a[204:207], v[140:143]
s_mul_i32 s52, s72, 36864
ds_read_b128 v[172:175], v7 offset:7168
v_mfma_f32_16x16x32_bf16 v[140:143], v[180:183], a[196:199], v[140:143]
s_waitcnt lgkmcnt(6)
s_add_u32 s54, s54, s52
v_mfma_f32_16x16x32_bf16 v[128:131], v[188:191], a[208:211], v[128:131]
s_cmp_eq_u64 vcc, 0
s_cselect_b32 s81, s69, 2147418112
s_cselect_b32 s93, s71, 2147418112
v_mfma_f32_16x16x32_bf16 v[128:131], v[144:147], a[216:219], v[128:131]
s_lshl_b32 s53, s84, 6
ds_read_b128 v[176:179], v7 offset:8192
v_mfma_f32_16x16x32_bf16 v[132:135], v[144:147], a[220:223], v[132:135]
L_PAD13:
s_cbranch_execz L_MAIN
s_sub_u32 s53, s53, 256
ds_read_b128 v[180:183], v7 offset:9216
v_mfma_f32_16x16x32_bf16 v[132:135], v[188:191], a[212:215], v[132:135]
buffer_load_dwordx4 v[192:195], v15, s[24:27], s81 offen offset:0 sc1
v_mfma_f32_16x16x32_bf16 v[136:139], v[148:151], a[208:211], v[136:139]
s_waitcnt lgkmcnt(6)
s_add_u32 s52, s54, s53
ds_read_b128 v[184:187], v7 offset:10240
v_mfma_f32_16x16x32_bf16 v[136:139], v[152:155], a[216:219], v[136:139]
s_add_u32 s53, s55, s53
v_mfma_f32_16x16x32_bf16 v[140:143], v[152:155], a[220:223], v[140:143]
buffer_load_dwordx4 v[196:199], v15, s[24:27], s81 offen offset:1024 sc1
v_mfma_f32_16x16x32_bf16 v[140:143], v[148:151], a[212:215], v[140:143]
ds_read_b128 v[188:191], v7 offset:11264
v_mfma_f32_16x16x32_bf16 v[128:131], v[156:159], a[224:227], v[128:131]
s_waitcnt lgkmcnt(6)
ds_read_b128 v[144:147], v7 offset:12288
v_mfma_f32_16x16x32_bf16 v[128:131], v[160:163], a[232:235], v[128:131]
buffer_load_dwordx4 v[200:203], v15, s[24:27], s81 offen offset:2048 sc1
v_mfma_f32_16x16x32_bf16 v[132:135], v[160:163], a[236:239], v[132:135]
ds_read_b128 v[148:151], v7 offset:13312
v_mfma_f32_16x16x32_bf16 v[132:135], v[156:159], a[228:231], v[132:135]
s_waitcnt lgkmcnt(6)
v_mfma_f32_16x16x32_bf16 v[136:139], v[164:167], a[224:227], v[136:139]
buffer_load_dwordx4 v[204:207], v15, s[24:27], s81 offen offset:3072 sc1
v_mfma_f32_16x16x32_bf16 v[136:139], v[168:171], a[232:235], v[136:139]
ds_read_b128 v[152:155], v7 offset:14336
v_mfma_f32_16x16x32_bf16 v[140:143], v[168:171], a[236:239], v[140:143]
ds_read_b128 v[156:159], v7 offset:15360
v_mfma_f32_16x16x32_bf16 v[140:143], v[164:167], a[228:231], v[140:143]
buffer_load_dwordx4 v[208:211], v15, s[24:27], s93 offen offset:0 sc1
v_mfma_f32_16x16x32_bf16 v[128:131], v[172:175], a[240:243], v[128:131]
s_waitcnt lgkmcnt(6)
s_add_u32 s91, s91, 16384
ds_read_b128 v[160:163], v8 offset:0
v_mfma_f32_16x16x32_bf16 v[128:131], v[176:179], a[248:251], v[128:131]
s_cmp_ge_u32 s91, 163840
s_cselect_b32 s91, 0, s91
v_add_u32 v7, s91, v4
v_mfma_f32_16x16x32_bf16 v[132:135], v[176:179], a[252:255], v[132:135]
buffer_load_dwordx4 v[212:215], v15, s[24:27], s93 offen offset:1024 sc1
v_mfma_f32_16x16x32_bf16 v[132:135], v[172:175], a[244:247], v[132:135]
ds_read_b128 v[164:167], v8 offset:1024
v_mfma_f32_16x16x32_bf16 v[136:139], v[180:183], a[240:243], v[136:139]
s_waitcnt lgkmcnt(6)
ds_read_b128 v[168:171], v8 offset:2048
v_mfma_f32_16x16x32_bf16 v[136:139], v[184:187], a[248:251], v[136:139]
buffer_load_dwordx4 v[216:219], v15, s[24:27], s93 offen offset:2048 sc1
v_mfma_f32_16x16x32_bf16 v[140:143], v[184:187], a[252:255], v[140:143]
ds_read_b128 v[172:175], v8 offset:3072
v_mfma_f32_16x16x32_bf16 v[140:143], v[180:183], a[244:247], v[140:143]
v_mfma_f32_16x16x32_bf16 v[128:131], v[188:191], a[96:99], v[128:131]
s_waitcnt lgkmcnt(6)
ds_read_b128 v[176:179], v8 offset:4096
v_mfma_f32_16x16x32_bf16 v[128:131], v[144:147], a[104:107], v[128:131]
v_mfma_f32_16x16x32_bf16 v[132:135], v[144:147], a[108:111], v[132:135]
ds_read_b128 v[180:183], v8 offset:5120
v_mfma_f32_16x16x32_bf16 v[132:135], v[188:191], a[100:103], v[132:135]
v_mfma_f32_16x16x32_bf16 v[136:139], v[148:151], a[96:99], v[136:139]
s_waitcnt lgkmcnt(6)
ds_read_b128 v[184:187], v8 offset:6144
v_mfma_f32_16x16x32_bf16 v[136:139], v[152:155], a[104:107], v[136:139]
v_mfma_f32_16x16x32_bf16 v[140:143], v[152:155], a[108:111], v[140:143]
ds_read_b128 v[188:191], v8 offset:7168
v_mfma_f32_16x16x32_bf16 v[140:143], v[148:151], a[100:103], v[140:143]
v_mfma_f32_16x16x32_bf16 v[128:131], v[156:159], a[112:115], v[128:131]
s_waitcnt lgkmcnt(6)
ds_read_b128 v[144:147], v8 offset:8192
v_mfma_f32_16x16x32_bf16 v[128:131], v[160:163], a[120:123], v[128:131]
v_mfma_f32_16x16x32_bf16 v[132:135], v[160:163], a[124:127], v[132:135]
ds_read_b128 v[148:151], v8 offset:9216
v_mfma_f32_16x16x32_bf16 v[132:135], v[156:159], a[116:119], v[132:135]
s_waitcnt lgkmcnt(6)
v_mfma_f32_16x16x32_bf16 v[136:139], v[164:167], a[112:115], v[136:139]
buffer_load_dword v12, v10, s[24:27], s75 offen offset:128 sc1
v_mfma_f32_16x16x32_bf16 v[136:139], v[168:171], a[120:123], v[136:139]
ds_read_b128 v[152:155], v8 offset:10240
v_mfma_f32_16x16x32_bf16 v[140:143], v[168:171], a[124:127], v[140:143]
ds_read_b128 v[156:159], v8 offset:11264
v_mfma_f32_16x16x32_bf16 v[140:143], v[164:167], a[116:119], v[140:143]
v_mfma_f32_16x16x32_bf16 v[128:131], v[172:175], a[128:131], v[128:131]
s_waitcnt lgkmcnt(6)
ds_read_b128 v[160:163], v8 offset:12288
v_mfma_f32_16x16x32_bf16 v[128:131], v[176:179], a[136:139], v[128:131]
v_mfma_f32_16x16x32_bf16 v[132:135], v[176:179], a[140:143], v[132:135]
ds_read_b128 v[164:167], v8 offset:13312
v_mfma_f32_16x16x32_bf16 v[132:135], v[172:175], a[132:135], v[132:135]
v_mfma_f32_16x16x32_bf16 v[136:139], v[180:183], a[128:131], v[136:139]
s_waitcnt lgkmcnt(6)
ds_read_b128 v[168:171], v8 offset:14336
v_mfma_f32_16x16x32_bf16 v[136:139], v[184:187], a[136:139], v[136:139]
v_mfma_f32_16x16x32_bf16 v[140:143], v[184:187], a[140:143], v[140:143]
s_waitcnt vmcnt(10)
ds_read_b128 v[172:175], v8 offset:15360
v_mfma_f32_16x16x32_bf16 v[140:143], v[180:183], a[132:135], v[140:143]
s_barrier
v_mfma_f32_16x16x32_bf16 v[128:131], v[188:191], a[144:147], v[128:131]
s_waitcnt lgkmcnt(6)
ds_read_b128 v[176:179], v7 offset:0
v_mfma_f32_16x16x32_bf16 v[128:131], v[144:147], a[152:155], v[128:131]
v_mfma_f32_16x16x32_bf16 v[132:135], v[144:147], a[156:159], v[132:135]
ds_read_b128 v[180:183], v7 offset:1024
v_mfma_f32_16x16x32_bf16 v[132:135], v[188:191], a[148:151], v[132:135]
v_mfma_f32_16x16x32_bf16 v[136:139], v[148:151], a[144:147], v[136:139]
s_waitcnt lgkmcnt(6)
ds_read_b128 v[184:187], v7 offset:2048
v_mfma_f32_16x16x32_bf16 v[136:139], v[152:155], a[152:155], v[136:139]
v_mfma_f32_16x16x32_bf16 v[140:143], v[152:155], a[156:159], v[140:143]
ds_read_b128 v[188:191], v7 offset:3072
v_mfma_f32_16x16x32_bf16 v[140:143], v[148:151], a[148:151], v[140:143]
v_mfma_f32_16x16x32_bf16 v[128:131], v[156:159], a[160:163], v[128:131]
s_waitcnt lgkmcnt(6)
ds_read_b128 v[144:147], v7 offset:4096
v_mfma_f32_16x16x32_bf16 v[128:131], v[160:163], a[168:171], v[128:131]
v_mfma_f32_16x16x32_bf16 v[132:135], v[160:163], a[172:175], v[132:135]
ds_read_b128 v[148:151], v7 offset:5120
v_mfma_f32_16x16x32_bf16 v[132:135], v[156:159], a[164:167], v[132:135]
v_mfma_f32_16x16x32_bf16 v[136:139], v[164:167], a[160:163], v[136:139]
s_waitcnt lgkmcnt(6)
ds_read_b128 v[152:155], v7 offset:6144
v_mfma_f32_16x16x32_bf16 v[136:139], v[168:171], a[168:171], v[136:139]
v_mfma_f32_16x16x32_bf16 v[140:143], v[168:171], a[172:175], v[140:143]
s_waitcnt vmcnt(0)
ds_read_b128 v[156:159], v7 offset:7168
v_cmp_gt_u32 vcc, 1, v12
v_mfma_f32_16x16x32_bf16 v[140:143], v[164:167], a[164:167], v[140:143]
v_lshlrev_b32 v72, 16, v192
v_and_b32 v73, v13, v192
v_mfma_f32_16x16x32_bf16 v[128:131], v[172:175], a[176:179], v[128:131]
s_waitcnt lgkmcnt(6)
ds_read_b128 v[160:163], v7 offset:8192
v_lshlrev_b32 v74, 16, v193
v_mfma_f32_16x16x32_bf16 v[128:131], v[176:179], a[184:187], v[128:131]
s_cmp_eq_u64 vcc, 0
s_cselect_b32 s77, s83, 2147418112
v_and_b32 v75, v13, v193
v_mfma_f32_16x16x32_bf16 v[132:135], v[176:179], a[188:191], v[132:135]
buffer_load_dwordx4 v[220:223], v15, s[24:27], s77 offen offset:0 sc1
v_mfma_f32_16x16x32_bf16 v[132:135], v[172:175], a[180:183], v[132:135]
s_waitcnt lgkmcnt(5)
ds_read_b128 v[164:167], v7 offset:9216
v_lshlrev_b32 v80, 16, v194
v_mfma_f32_16x16x32_bf16 v[136:139], v[180:183], a[176:179], v[136:139]
buffer_load_dwordx4 v[224:227], v15, s[24:27], s77 offen offset:1024 sc1
v_mfma_f32_16x16x32_bf16 v[136:139], v[184:187], a[184:187], v[136:139]
ds_read_b128 v[168:171], v7 offset:10240
v_and_b32 v81, v13, v194
v_mfma_f32_16x16x32_bf16 v[140:143], v[184:187], a[188:191], v[140:143]
ds_read_b128 v[172:175], v7 offset:11264
v_lshlrev_b32 v82, 16, v195
v_mfma_f32_16x16x32_bf16 v[140:143], v[180:183], a[180:183], v[140:143]
s_waitcnt lgkmcnt(6)
v_and_b32 v83, v13, v195
v_lshlrev_b32 v76, 16, v196
v_mfma_f32_16x16x32_bf16 v[128:131], v[188:191], v[32:35], v[128:131]
buffer_load_dword v11, v10, s[24:27], s73 offen sc1
v_mfma_f32_16x16x32_bf16 v[128:131], v[144:147], v[40:43], v[128:131]
ds_read_b128 v[176:179], v7 offset:12288
v_and_b32 v77, v13, v196
v_mfma_f32_16x16x32_bf16 v[132:135], v[144:147], v[44:47], v[132:135]
buffer_load_dword v12, v10, s[24:27], s75 offen offset:128 sc1
v_mfma_f32_16x16x32_bf16 v[132:135], v[188:191], v[36:39], v[132:135]
v_lshlrev_b32 v78, 16, v197
v_and_b32 v79, v13, v197
v_mfma_f32_16x16x32_bf16 v[136:139], v[148:151], v[32:35], v[136:139]
s_waitcnt lgkmcnt(5)
v_lshlrev_b32 v84, 16, v198
v_and_b32 v85, v13, v198
v_mfma_f32_16x16x32_bf16 v[136:139], v[152:155], v[40:43], v[136:139]
v_lshlrev_b32 v86, 16, v199
v_and_b32 v87, v13, v199
v_mfma_f32_16x16x32_bf16 v[140:143], v[152:155], v[44:47], v[140:143]
v_lshlrev_b32 v88, 16, v200
v_and_b32 v89, v13, v200
v_mfma_f32_16x16x32_bf16 v[140:143], v[148:151], v[36:39], v[140:143]
v_lshlrev_b32 v90, 16, v201
v_and_b32 v91, v13, v201
v_mfma_f32_16x16x32_bf16 v[128:131], v[156:159], v[48:51], v[128:131]
s_waitcnt lgkmcnt(3)
v_lshlrev_b32 v96, 16, v202
v_and_b32 v97, v13, v202
v_mfma_f32_16x16x32_bf16 v[128:131], v[160:163], v[56:59], v[128:131]
v_lshlrev_b32 v98, 16, v203
v_and_b32 v99, v13, v203
v_mfma_f32_16x16x32_bf16 v[132:135], v[160:163], v[60:63], v[132:135]
v_lshlrev_b32 v92, 16, v204
v_and_b32 v93, v13, v204
v_mfma_f32_16x16x32_bf16 v[132:135], v[156:159], v[52:55], v[132:135]
v_lshlrev_b32 v94, 16, v205
v_and_b32 v95, v13, v205
v_mfma_f32_16x16x32_bf16 v[136:139], v[164:167], v[48:51], v[136:139]
s_waitcnt lgkmcnt(1)
v_lshlrev_b32 v100, 16, v206
v_and_b32 v101, v13, v206
v_mfma_f32_16x16x32_bf16 v[136:139], v[168:171], v[56:59], v[136:139]
v_lshlrev_b32 v102, 16, v207
v_and_b32 v103, v13, v207
v_mfma_f32_16x16x32_bf16 v[140:143], v[168:171], v[60:63], v[140:143]
v_mfma_f32_16x16x32_bf16 v[140:143], v[164:167], v[52:55], v[140:143]
v_mfma_f32_16x16x32_bf16 v[128:131], v[172:175], v[64:67], v[128:131]
v_mfma_f32_16x16x32_bf16 v[132:135], v[172:175], v[68:71], v[132:135]
s_waitcnt lgkmcnt(0)
v_mfma_f32_16x16x32_bf16 v[136:139], v[176:179], v[64:67], v[136:139]
v_mfma_f32_16x16x32_bf16 v[140:143], v[176:179], v[68:71], v[140:143]
s_max_u32 s92, s81, s77
s_cmp_lt_u32 s92, 2147418112
s_cbranch_scc1 L_P1
s_mov_b32 s92, 0
s_branch L_S1
L_S0:
s_sleep 8
buffer_load_dword v11, v10, s[24:27], s73 offen sc1
buffer_load_dword v12, v10, s[24:27], s75 offen offset:128 sc1
L_S1:
s_waitcnt vmcnt(0)
v_cmp_gt_u32 vcc, 4, v11
s_add_u32 s92, s92, 1
s_cmp_gt_u32 s92, 1048576
s_cbranch_scc1 L_S2
s_nop 1
s_cbranch_vccnz L_S0
L_S2:
s_cmp_eq_u32 s81, s69
s_cbranch_scc1 L_S4
buffer_load_dwordx4 v[192:195], v15, s[24:27], s69 offen offset:0 sc1
buffer_load_dwordx4 v[196:199], v15, s[24:27], s69 offen offset:1024 sc1
buffer_load_dwordx4 v[200:203], v15, s[24:27], s69 offen offset:2048 sc1
buffer_load_dwordx4 v[204:207], v15, s[24:27], s69 offen offset:3072 sc1
buffer_load_dwordx4 v[208:211], v15, s[24:27], s71 offen offset:0 sc1
buffer_load_dwordx4 v[212:215], v15, s[24:27], s71 offen offset:1024 sc1
buffer_load_dwordx4 v[216:219], v15, s[24:27], s71 offen offset:2048 sc1
s_branch L_S4
L_S3:
s_sleep 2
buffer_load_dword v12, v10, s[24:27], s75 offen offset:128 sc1
s_waitcnt vmcnt(0)
L_S4:
v_cmp_gt_u32 vcc, 1, v12
s_add_u32 s92, s92, 1
s_cmp_gt_u32 s92, 1048576
s_cbranch_scc1 L_S5
s_nop 1
s_cbranch_vccnz L_S3
L_S5:
buffer_load_dwordx4 v[220:223], v15, s[24:27], s83 offen offset:0 sc1
buffer_load_dwordx4 v[224:227], v15, s[24:27], s83 offen offset:1024 sc1
s_cmp_eq_u32 s81, s69
s_cbranch_scc1 L_P1
s_waitcnt vmcnt(2)
v_lshlrev_b32 v72, 16, v192
v_and_b32 v73, v13, v192
v_lshlrev_b32 v74, 16, v193
v_and_b32 v75, v13, v193
v_lshlrev_b32 v80, 16, v194
v_and_b32 v81, v13, v194
v_lshlrev_b32 v82, 16, v195
v_and_b32 v83, v13, v195
v_lshlrev_b32 v76, 16, v196
v_and_b32 v77, v13, v196
v_lshlrev_b32 v78, 16, v197
v_and_b32 v79, v13, v197
v_lshlrev_b32 v84, 16, v198
v_and_b32 v85, v13, v198
v_lshlrev_b32 v86, 16, v199
v_and_b32 v87, v13, v199
v_lshlrev_b32 v88, 16, v200
v_and_b32 v89, v13, v200
v_lshlrev_b32 v90, 16, v201
v_and_b32 v91, v13, v201
v_lshlrev_b32 v96, 16, v202
v_and_b32 v97, v13, v202
v_lshlrev_b32 v98, 16, v203
v_and_b32 v99, v13, v203
v_lshlrev_b32 v92, 16, v204
v_and_b32 v93, v13, v204
v_lshlrev_b32 v94, 16, v205
v_and_b32 v95, v13, v205
v_lshlrev_b32 v100, 16, v206
v_and_b32 v101, v13, v206
v_lshlrev_b32 v102, 16, v207
v_and_b32 v103, v13, v207
L_P1:
s_nop 1
v_pk_add_f32 v[72:73], v[72:73], v[88:89]
v_pk_add_f32 v[74:75], v[74:75], v[90:91]
v_pk_add_f32 v[76:77], v[76:77], v[92:93]
v_pk_add_f32 v[78:79], v[78:79], v[94:95]
v_pk_add_f32 v[80:81], v[80:81], v[96:97]
v_pk_add_f32 v[82:83], v[82:83], v[98:99]
v_pk_add_f32 v[84:85], v[84:85], v[100:101]
v_pk_add_f32 v[86:87], v[86:87], v[102:103]
v_pk_add_f32 v[128:129], v[128:129], v[72:73]
v_pk_add_f32 v[130:131], v[130:131], v[74:75]
v_pk_add_f32 v[132:133], v[132:133], v[76:77]
v_pk_add_f32 v[134:135], v[134:135], v[78:79]
v_pk_add_f32 v[136:137], v[136:137], v[80:81]
v_pk_add_f32 v[138:139], v[138:139], v[82:83]
v_pk_add_f32 v[140:141], v[140:141], v[84:85]
v_pk_add_f32 v[142:143], v[142:143], v[86:87]
s_cmp_lg_u32 s3, s84
s_cbranch_scc1 L_NO9
v_lshlrev_b32 v16, 16, v208
v_and_b32 v17, v13, v208
v_lshlrev_b32 v18, 16, v209
v_and_b32 v19, v13, v209
v_lshlrev_b32 v20, 16, v210
v_and_b32 v21, v13, v210
v_lshlrev_b32 v22, 16, v211
v_and_b32 v23, v13, v211
v_pk_add_f32 v[120:121], v[120:121], v[16:17]
v_pk_add_f32 v[122:123], v[122:123], v[18:19]
v_pk_add_f32 v[124:125], v[124:125], v[20:21]
v_pk_add_f32 v[126:127], v[126:127], v[22:23]
v_lshlrev_b32 v16, 16, v212
v_and_b32 v17, v13, v212
v_lshlrev_b32 v18, 16, v213
v_and_b32 v19, v13, v213
v_lshlrev_b32 v20, 16, v214
v_and_b32 v21, v13, v214
v_lshlrev_b32 v22, 16, v215
v_and_b32 v23, v13, v215
v_pk_add_f32 v[120:121], v[120:121], v[16:17]
v_pk_add_f32 v[122:123], v[122:123], v[18:19]
v_pk_add_f32 v[124:125], v[124:125], v[20:21]
v_pk_add_f32 v[126:127], v[126:127], v[22:23]
v_lshlrev_b32 v16, 16, v216
v_and_b32 v17, v13, v216
v_lshlrev_b32 v18, 16, v217
v_and_b32 v19, v13, v217
v_lshlrev_b32 v20, 16, v218
v_and_b32 v21, v13, v218
v_lshlrev_b32 v22, 16, v219
v_and_b32 v23, v13, v219
v_pk_add_f32 v[120:121], v[120:121], v[16:17]
v_pk_add_f32 v[122:123], v[122:123], v[18:19]
v_pk_add_f32 v[124:125], v[124:125], v[20:21]
v_pk_add_f32 v[126:127], v[126:127], v[22:23]
v_cvt_pk_bf16_f32 v228, v120, v121
v_cvt_pk_bf16_f32 v229, v122, v123
v_cvt_pk_bf16_f32 v230, v124, v125
v_cvt_pk_bf16_f32 v231, v126, v127
s_waitcnt vmcnt(0)
buffer_store_dwordx2 v[228:229], v6, s[44:47], s54 offen sc1
buffer_store_dwordx2 v[230:231], v6, s[44:47], s55 offen sc1
s_branch L_9D
L_NO9:
s_waitcnt vmcnt(0)
L_9D:
v_lshlrev_b32 v16, 16, v220
v_and_b32 v17, v13, v220
v_lshlrev_b32 v18, 16, v221
v_and_b32 v19, v13, v221
v_lshlrev_b32 v20, 16, v222
v_and_b32 v21, v13, v222
v_lshlrev_b32 v22, 16, v223
v_and_b32 v23, v13, v223
v_pk_add_f32 v[128:129], v[128:129], v[16:17]
v_pk_add_f32 v[130:131], v[130:131], v[18:19]
v_pk_add_f32 v[136:137], v[136:137], v[20:21]
v_pk_add_f32 v[138:139], v[138:139], v[22:23]
v_cvt_pk_bf16_f32 v128, v128, v129
v_cvt_pk_bf16_f32 v129, v130, v131
v_cvt_pk_bf16_f32 v130, v136, v137
v_cvt_pk_bf16_f32 v131, v138, v139
s_nop 1
v_permlane16_swap_b32 v128, v130
v_permlane16_swap_b32 v129, v131
buffer_store_dwordx4 v[128:131], v5, s[44:47], s52 offen sc1
v_lshlrev_b32 v16, 16, v224
v_and_b32 v17, v13, v224
v_lshlrev_b32 v18, 16, v225
v_and_b32 v19, v13, v225
v_lshlrev_b32 v20, 16, v226
v_and_b32 v21, v13, v226
v_lshlrev_b32 v22, 16, v227
v_and_b32 v23, v13, v227
v_pk_add_f32 v[132:133], v[132:133], v[16:17]
v_pk_add_f32 v[134:135], v[134:135], v[18:19]
v_pk_add_f32 v[140:141], v[140:141], v[20:21]
v_pk_add_f32 v[142:143], v[142:143], v[22:23]
v_cvt_pk_bf16_f32 v132, v132, v133
v_cvt_pk_bf16_f32 v133, v134, v135
v_cvt_pk_bf16_f32 v134, v140, v141
v_cvt_pk_bf16_f32 v135, v142, v143
s_nop 1
v_permlane16_swap_b32 v132, v134
v_permlane16_swap_b32 v133, v135
buffer_store_dwordx4 v[132:135], v5, s[44:47], s53 offen sc1
L_END:
s_endpgm
L_SE2:
v_accvgpr_read_b32 v180, a224
v_accvgpr_read_b32 v182, a228
v_cmp_nle_f32 vcc, v180, v7
v_cmp_nle_f32 s[96:97], v182, v7
s_nop 3
s_or_b64 vcc, vcc, s[96:97]
s_cbranch_vccnz SLOW0
SLOW0_R:
s_add_u32 s53, s77, 180224
buffer_load_dwordx4 a[112:115], v15, s[24:27], s53 offen offset:0 sc1
v_mul_f32 v8, 0x3fb8aa3b, v8
v_mul_f32 v9, 0x3fb8aa3b, v9
v_exp_f32 v8, v8
v_exp_f32 v9, v9
s_nop 0
v_fma_f32 v180, v180, v8, v180
v_fma_f32 v182, v182, v9, v182
v_rcp_f32 v180, v180
v_rcp_f32 v182, v182
s_add_u32 s52, s78, 4096
v_mov_b32 v181, v180
v_mov_b32 v183, v182
v_pk_mul_f32 v[36:37], v[36:37], v[180:181]
v_pk_mul_f32 v[38:39], v[38:39], v[180:181]
v_pk_mul_f32 v[32:33], v[32:33], v[180:181]
v_pk_mul_f32 v[34:35], v[34:35], v[180:181]
v_cvt_pk_bf16_f32 v36, v36, v37
v_cvt_pk_bf16_f32 v37, v38, v39
v_cvt_pk_bf16_f32 v38, v32, v33
v_cvt_pk_bf16_f32 v39, v34, v35
buffer_store_dwordx4 v[36:39], v15, s[24:27], s78 offen offset:0 sc1
buffer_load_dwordx4 a[116:119], v15, s[24:27], s53 offen offset:1024 sc1
v_pk_mul_f32 v[116:117], v[116:117], v[182:183]
v_pk_mul_f32 v[118:119], v[118:119], v[182:183]
v_pk_mul_f32 v[132:133], v[132:133], v[182:183]
v_pk_mul_f32 v[134:135], v[134:135], v[182:183]
v_cvt_pk_bf16_f32 v116, v116, v117
v_cvt_pk_bf16_f32 v117, v118, v119
v_cvt_pk_bf16_f32 v118, v132, v133
v_cvt_pk_bf16_f32 v119, v134, v135
buffer_store_dwordx4 v[116:119], v15, s[24:27], s78 offen offset:1024 sc1
v_pk_mul_f32 v[196:197], v[196:197], v[180:181]
v_pk_mul_f32 v[198:199], v[198:199], v[180:181]
v_pk_mul_f32 v[204:205], v[204:205], v[180:181]
v_pk_mul_f32 v[206:207], v[206:207], v[180:181]
v_cvt_pk_bf16_f32 v196, v196, v197
v_cvt_pk_bf16_f32 v197, v198, v199
v_cvt_pk_bf16_f32 v198, v204, v205
v_cvt_pk_bf16_f32 v199, v206, v207
buffer_store_dwordx4 v[196:199], v15, s[24:27], s78 offen offset:2048 sc1
v_pk_mul_f32 v[184:185], v[184:185], v[182:183]
v_pk_mul_f32 v[186:187], v[186:187], v[182:183]
v_pk_mul_f32 v[240:241], v[240:241], v[182:183]
buffer_load_dwordx4 a[120:123], v15, s[24:27], s53 offen offset:2048 sc1
v_pk_mul_f32 v[242:243], v[242:243], v[182:183]
v_cvt_pk_bf16_f32 v184, v184, v185
v_cvt_pk_bf16_f32 v185, v186, v187
v_cvt_pk_bf16_f32 v186, v240, v241
v_cvt_pk_bf16_f32 v187, v242, v243
buffer_store_dwordx4 v[184:187], v15, s[24:27], s78 offen offset:3072 sc1
v_pk_mul_f32 v[108:109], v[108:109], v[180:181]
v_pk_mul_f32 v[110:111], v[110:111], v[180:181]
v_pk_mul_f32 v[40:41], v[40:41], v[180:181]
v_pk_mul_f32 v[42:43], v[42:43], v[180:181]
v_cvt_pk_bf16_f32 v108, v108, v109
v_cvt_pk_bf16_f32 v109, v110, v111
v_cvt_pk_bf16_f32 v110, v40, v41
v_cvt_pk_bf16_f32 v111, v42, v43
buffer_store_dwordx4 v[108:111], v15, s[24:27], s52 offen offset:0 sc1
v_pk_mul_f32 v[188:189], v[188:189], v[182:183]
v_pk_mul_f32 v[190:191], v[190:191], v[182:183]
v_pk_mul_f32 v[56:57], v[56:57], v[182:183]
v_pk_mul_f32 v[58:59], v[58:59], v[182:183]
v_cvt_pk_bf16_f32 v188, v188, v189
v_cvt_pk_bf16_f32 v189, v190, v191
buffer_load_dwordx4 a[124:127], v15, s[24:27], s53 offen offset:3072 sc1
v_cvt_pk_bf16_f32 v190, v56, v57
v_cvt_pk_bf16_f32 v191, v58, v59
buffer_store_dwordx4 v[188:191], v15, s[24:27], s52 offen offset:1024 sc1
v_pk_mul_f32 v[80:81], v[80:81], v[180:181]
v_pk_mul_f32 v[82:83], v[82:83], v[180:181]
v_pk_mul_f32 v[168:169], v[168:169], v[180:181]
v_pk_mul_f32 v[170:171], v[170:171], v[180:181]
v_cvt_pk_bf16_f32 v80, v80, v81
v_cvt_pk_bf16_f32 v81, v82, v83
v_cvt_pk_bf16_f32 v82, v168, v169
v_cvt_pk_bf16_f32 v83, v170, v171
buffer_store_dwordx4 v[80:83], v15, s[24:27], s52 offen offset:2048 sc1
v_pk_mul_f32 v[88:89], v[88:89], v[182:183]
v_pk_mul_f32 v[90:91], v[90:91], v[182:183]
v_pk_mul_f32 v[192:193], v[192:193], v[182:183]
v_pk_mul_f32 v[194:195], v[194:195], v[182:183]
v_cvt_pk_bf16_f32 v88, v88, v89
v_cvt_pk_bf16_f32 v89, v90, v91
v_cvt_pk_bf16_f32 v90, v192, v193
v_cvt_pk_bf16_f32 v91, v194, v195
buffer_store_dwordx4 v[88:91], v15, s[24:27], s52 offen offset:3072 sc1
s_branch L_LA
CK_Z:
s_mov_b32 s92, 0
CK_Z_L:
s_sleep 1
buffer_load_dword v23, v22, s[40:43], 0 offen sc1
s_add_u32 s92, s92, 1
s_waitcnt vmcnt(0)
v_cmp_gt_u32 vcc, 1, v23
s_cmp_gt_u32 s92, 1048576
s_cbranch_scc1 CK_Z_R
s_nop 3
s_cbranch_vccnz CK_Z_L
s_branch CK_Z_R
CK_WA:
s_mov_b32 s92, 0
CK_WA_L:
s_sleep 1
buffer_load_dword v30, v29, s[24:27], s89 offen sc1
s_add_u32 s92, s92, 1
s_waitcnt vmcnt(0)
v_cmp_gt_u32 vcc, 18, v30
s_cmp_gt_u32 s92, 1048576
s_cbranch_scc1 CK_WA_R
s_nop 3
s_cbranch_vccnz CK_WA_L
s_branch CK_WA_R
CK_ZA:
s_mov_b32 s92, 0
CK_ZA_L:
s_sleep 1
buffer_load_dword v30, v28, s[40:43], 0 offen sc1
s_add_u32 s92, s92, 1
s_waitcnt vmcnt(0)
v_cmp_gt_u32 vcc, 1, v30
s_cmp_gt_u32 s92, 1048576
s_cbranch_scc1 CK_ZA_R
s_nop 3
s_cbranch_vccnz CK_ZA_L
s_branch CK_ZA_R
CK_KV:
s_mov_b32 s92, 0
CK_KV_L:
s_sleep 1
buffer_load_dword v30, v29, s[24:27], s89 offen offset:4 sc1
s_add_u32 s92, s92, 1
s_waitcnt vmcnt(0)
v_cmp_gt_u32 vcc, 8, v30
s_cmp_gt_u32 s92, 1048576
s_cbranch_scc1 CK_KV_R
s_nop 3
s_cbranch_vccnz CK_KV_L
s_branch CK_KV_R
D0:
v_cndmask_b32 v96, v96, v6, s[56:57]
v_cndmask_b32 v120, v120, v6, s[56:57]
v_mov_b32 v112, v6
v_cndmask_b32 v97, v97, v6, s[58:59]
v_cndmask_b32 v121, v121, v6, s[58:59]
v_mov_b32 v113, v6
v_cndmask_b32 v98, v98, v6, s[60:61]
v_cndmask_b32 v122, v122, v6, s[60:61]
v_mov_b32 v114, v6
v_cndmask_b32 v99, v99, v6, s[62:63]
v_cndmask_b32 v123, v123, v6, s[62:63]
v_mov_b32 v115, v6
s_branch D0_R
CK_Q:
s_mov_b32 s92, 0
CK_Q_L:
s_sleep 1
buffer_load_dword v172, v173, s[24:27], 0 offen sc1
s_add_u32 s92, s92, 1
s_waitcnt vmcnt(0)
v_cmp_gt_u32 vcc, 32, v172
s_cmp_gt_u32 s92, 1048576
s_cbranch_scc1 CK_Q_R
s_nop 3
s_cbranch_vccnz CK_Q_L
s_branch CK_Q_R
CK_ZAA:
s_mov_b32 s92, 0
CK_ZAA_L:
s_sleep 1
buffer_load_dword v12, v10, s[24:27], s75 offen offset:128 sc1
s_add_u32 s92, s92, 1
s_waitcnt vmcnt(0)
v_cmp_gt_u32 vcc, 8, v12
s_cmp_gt_u32 s92, 1048576
s_cbranch_scc1 CK_ZAA_R
s_nop 3
s_cbranch_vccnz CK_ZAA_L
s_branch CK_ZAA_R
SLOW0:
v_add_u32 v20, 4096, v15
s_mov_b32 s54, 0
v_mov_b32 v16, v6
v_mov_b32 v18, v6
SLOW0_P:
s_mov_b32 s53, 0
s_mov_b32 s52, s94
SLOW0_T:
s_add_u32 s55, s52, 24576
buffer_load_dwordx4 a[192:195], v15, s[24:27], s52 offen offset:0 sc1
buffer_load_dwordx4 a[196:199], v15, s[24:27], s52 offen offset:1024 sc1
buffer_load_dwordx4 a[200:203], v15, s[24:27], s52 offen offset:2048 sc1
buffer_load_dwordx4 a[204:207], v15, s[24:27], s52 offen offset:3072 sc1
buffer_load_dwordx4 a[208:211], v20, s[24:27], s52 offen offset:0 sc1
buffer_load_dwordx4 a[212:215], v20, s[24:27], s52 offen offset:1024 sc1
buffer_load_dwordx4 a[216:219], v20, s[24:27], s52 offen offset:2048 sc1
buffer_load_dwordx4 a[220:223], v20, s[24:27], s52 offen offset:3072 sc1
buffer_load_dwordx4 a[64:67], v15, s[24:27], s55 offen offset:0 sc1
buffer_load_dwordx4 a[68:71], v15, s[24:27], s55 offen offset:1024 sc1
buffer_load_dwordx4 a[72:75], v15, s[24:27], s55 offen offset:2048 sc1
buffer_load_dwordx4 a[76:79], v15, s[24:27], s55 offen offset:3072 sc1
buffer_load_dwordx4 a[80:83], v20, s[24:27], s55 offen offset:0 sc1
buffer_load_dwordx4 a[84:87], v20, s[24:27], s55 offen offset:1024 sc1
buffer_load_dwordx4 a[88:91], v20, s[24:27], s55 offen offset:2048 sc1
buffer_load_dwordx4 a[92:95], v20, s[24:27], s55 offen offset:3072 sc1
s_waitcnt vmcnt(0)
v_mfma_f32_16x16x32_bf16 v[44:47], a[192:195], a[32:35], 0
v_mfma_f32_16x16x32_bf16 v[44:47], a[196:199], a[36:39], v[44:47]
v_mfma_f32_16x16x32_bf16 v[44:47], a[200:203], a[28:31], v[44:47]
v_mfma_f32_16x16x32_bf16 v[44:47], a[204:207], a[20:23], v[44:47]
v_mfma_f32_16x16x32_bf16 v[52:55], a[192:195], a[44:47], 0
v_mfma_f32_16x16x32_bf16 v[52:55], a[196:199], a[40:43], v[52:55]
v_mfma_f32_16x16x32_bf16 v[52:55], a[200:203], a[12:15], v[52:55]
v_mfma_f32_16x16x32_bf16 v[52:55], a[204:207], a[4:7], v[52:55]
v_mfma_f32_16x16x32_bf16 v[64:67], a[208:211], a[32:35], 0
v_mfma_f32_16x16x32_bf16 v[64:67], a[212:215], a[36:39], v[64:67]
v_mfma_f32_16x16x32_bf16 v[64:67], a[216:219], a[28:31], v[64:67]
v_mfma_f32_16x16x32_bf16 v[64:67], a[220:223], a[20:23], v[64:67]
v_mfma_f32_16x16x32_bf16 v[212:215], a[208:211], a[44:47], 0
v_mfma_f32_16x16x32_bf16 v[212:215], a[212:215], a[40:43], v[212:215]
v_mfma_f32_16x16x32_bf16 v[212:215], a[216:219], a[12:15], v[212:215]
v_mfma_f32_16x16x32_bf16 v[212:215], a[220:223], a[4:7], v[212:215]
s_nop 7
s_cmp_lg_u32 s53, s66
s_cbranch_scc1 SLOW0_U
v_cndmask_b32 v44, v44, v6, s[56:57]
v_cndmask_b32 v212, v212, v6, s[56:57]
v_mov_b32 v64, v6
v_cndmask_b32 v45, v45, v6, s[58:59]
v_cndmask_b32 v213, v213, v6, s[58:59]
v_mov_b32 v65, v6
v_cndmask_b32 v46, v46, v6, s[60:61]
v_cndmask_b32 v214, v214, v6, s[60:61]
v_mov_b32 v66, v6
v_cndmask_b32 v47, v47, v6, s[62:63]
v_cndmask_b32 v215, v215, v6, s[62:63]
v_mov_b32 v67, v6
SLOW0_U:
s_cmp_lg_u32 s54, 0
s_cbranch_scc1 SLOW0_A
v_max3_f32 v16, v16, v44, v45
v_max3_f32 v16, v16, v46, v47
v_max3_f32 v18, v18, v52, v53
v_max3_f32 v18, v18, v54, v55
v_max3_f32 v16, v16, v64, v65
v_max3_f32 v16, v16, v66, v67
v_max3_f32 v18, v18, v212, v213
v_max3_f32 v18, v18, v214, v215
s_branch SLOW0_N
SLOW0_A:
v_sub_f32 v44, v44, v16
v_sub_f32 v45, v45, v16
v_sub_f32 v46, v46, v16
v_sub_f32 v47, v47, v16
v_sub_f32 v52, v52, v18
v_sub_f32 v53, v53, v18
v_sub_f32 v54, v54, v18
v_sub_f32 v55, v55, v18
v_sub_f32 v64, v64, v16
v_sub_f32 v65, v65, v16
v_sub_f32 v66, v66, v16
v_sub_f32 v67, v67, v16
v_sub_f32 v212, v212, v18
v_sub_f32 v213, v213, v18
v_sub_f32 v214, v214, v18
v_sub_f32 v215, v215, v18
v_exp_f32 v44, v44
v_exp_f32 v45, v45
v_exp_f32 v46, v46
v_exp_f32 v47, v47
v_exp_f32 v52, v52
v_exp_f32 v53, v53
v_exp_f32 v54, v54
v_exp_f32 v55, v55
v_exp_f32 v64, v64
v_exp_f32 v65, v65
v_exp_f32 v66, v66
v_exp_f32 v67, v67
v_exp_f32 v212, v212
v_exp_f32 v213, v213
v_exp_f32 v214, v214
v_exp_f32 v215, v215
s_nop 0
v_cvt_pk_bf16_f32 v124, v44, v45
v_cvt_pk_bf16_f32 v125, v46, v47
v_cvt_pk_bf16_f32 v140, v52, v53
v_cvt_pk_bf16_f32 v141, v54, v55
v_cvt_pk_bf16_f32 v126, v64, v65
v_cvt_pk_bf16_f32 v127, v66, v67
v_cvt_pk_bf16_f32 v142, v212, v213
v_cvt_pk_bf16_f32 v143, v214, v215
s_nop 1
v_mfma_f32_16x16x32_bf16 v[36:39], a[64:67], v[124:127], v[36:39]
v_mfma_f32_16x16x32_bf16 v[116:119], a[64:67], v[140:143], v[116:119]
v_mfma_f32_16x16x32_bf16 v[132:135], a[68:71], v[140:143], v[132:135]
v_mfma_f32_16x16x32_bf16 v[32:35], a[68:71], v[124:127], v[32:35]
v_mfma_f32_16x16x32_bf16 v[196:199], a[72:75], v[124:127], v[196:199]
v_mfma_f32_16x16x32_bf16 v[184:187], a[72:75], v[140:143], v[184:187]
v_mfma_f32_16x16x32_bf16 v[240:243], a[76:79], v[140:143], v[240:243]
v_mfma_f32_16x16x32_bf16 v[204:207], a[76:79], v[124:127], v[204:207]
v_mfma_f32_16x16x32_bf16 v[108:111], a[80:83], v[124:127], v[108:111]
v_mfma_f32_16x16x32_bf16 v[188:191], a[80:83], v[140:143], v[188:191]
v_mfma_f32_16x16x32_bf16 v[56:59], a[84:87], v[140:143], v[56:59]
v_mfma_f32_16x16x32_bf16 v[40:43], a[84:87], v[124:127], v[40:43]
v_mfma_f32_16x16x32_bf16 v[80:83], a[88:91], v[124:127], v[80:83]
v_mfma_f32_16x16x32_bf16 v[88:91], a[88:91], v[140:143], v[88:91]
v_mfma_f32_16x16x32_bf16 v[192:195], a[92:95], v[140:143], v[192:195]
v_mfma_f32_16x16x32_bf16 v[168:171], a[92:95], v[124:127], v[168:171]
v_mfma_f32_16x16x32_bf16 a[224:227], a[240:243], v[124:127], a[224:227]
v_mfma_f32_16x16x32_bf16 a[228:231], a[240:243], v[140:143], a[228:231]
SLOW0_N:
s_add_u32 s52, s52, 16384
s_add_u32 s53, s53, 1
s_cmp_le_u32 s53, s66
s_cbranch_scc1 SLOW0_T
s_cmp_lg_u32 s54, 0
s_cbranch_scc1 SLOW0_E
v_mov_b32 v17, v16
v_mov_b32 v19, v18
s_nop 1
v_permlane32_swap_b32 v17, v16
v_permlane32_swap_b32 v19, v18
s_nop 1
v_max_f32 v16, v16, v17
v_max_f32 v18, v18, v19
v_mov_b32 v17, v16
v_mov_b32 v19, v18
s_nop 1
v_permlane16_swap_b32 v17, v16
v_permlane16_swap_b32 v19, v18
s_nop 1
v_max_f32 v16, v16, v17
v_max_f32 v18, v18, v19
v_mov_b32 v36, 0
v_mov_b32 v37, 0
v_mov_b32 v38, 0
v_mov_b32 v39, 0
v_mov_b32 v32, 0
v_mov_b32 v33, 0
v_mov_b32 v34, 0
v_mov_b32 v35, 0
v_mov_b32 v196, 0
v_mov_b32 v197, 0
v_mov_b32 v198, 0
v_mov_b32 v199, 0
v_mov_b32 v204, 0
v_mov_b32 v205, 0
v_mov_b32 v206, 0
v_mov_b32 v207, 0
v_mov_b32 v108, 0
v_mov_b32 v109, 0
v_mov_b32 v110, 0
v_mov_b32 v111, 0
v_mov_b32 v40, 0
v_mov_b32 v41, 0
v_mov_b32 v42, 0
v_mov_b32 v43, 0
v_mov_b32 v80, 0
v_mov_b32 v81, 0
v_mov_b32 v82, 0
v_mov_b32 v83, 0
v_mov_b32 v168, 0
v_mov_b32 v169, 0
v_mov_b32 v170, 0
v_mov_b32 v171, 0
v_mov_b32 v116, 0
v_mov_b32 v117, 0
v_mov_b32 v118, 0
v_mov_b32 v119, 0
v_mov_b32 v132, 0
v_mov_b32 v133, 0
v_mov_b32 v134, 0
v_mov_b32 v135, 0
v_mov_b32 v184, 0
v_mov_b32 v185, 0
v_mov_b32 v186, 0
v_mov_b32 v187, 0
v_mov_b32 v240, 0
v_mov_b32 v241, 0
v_mov_b32 v242, 0
v_mov_b32 v243, 0
v_mov_b32 v188, 0
v_mov_b32 v189, 0
v_mov_b32 v190, 0
v_mov_b32 v191, 0
v_mov_b32 v56, 0
v_mov_b32 v57, 0
v_mov_b32 v58, 0
v_mov_b32 v59, 0
v_mov_b32 v88, 0
v_mov_b32 v89, 0
v_mov_b32 v90, 0
v_mov_b32 v91, 0
v_mov_b32 v192, 0
v_mov_b32 v193, 0
v_mov_b32 v194, 0
v_mov_b32 v195, 0
v_accvgpr_write_b32 a224, 0
v_accvgpr_write_b32 a225, 0
v_accvgpr_write_b32 a226, 0
v_accvgpr_write_b32 a227, 0
v_accvgpr_write_b32 a228, 0
v_accvgpr_write_b32 a229, 0
v_accvgpr_write_b32 a230, 0
v_accvgpr_write_b32 a231, 0
s_mov_b32 s54, 1
s_branch SLOW0_P
SLOW0_E:
s_nop 7
v_accvgpr_read_b32 v180, a224
v_accvgpr_read_b32 v182, a228
s_branch SLOW0_R
SLOW1:
v_add_u32 v20, 4096, v15
s_mov_b32 s54, 0
v_mov_b32 v16, v6
v_mov_b32 v18, v6
SLOW1_P:
s_mov_b32 s53, 0
s_mov_b32 s52, s94
SLOW1_T:
s_add_u32 s55, s52, 24576
buffer_load_dwordx4 a[192:195], v15, s[24:27], s52 offen offset:0 sc1
buffer_load_dwordx4 a[196:199], v15, s[24:27], s52 offen offset:1024 sc1
buffer_load_dwordx4 a[200:203], v15, s[24:27], s52 offen offset:2048 sc1
buffer_load_dwordx4 a[204:207], v15, s[24:27], s52 offen offset:3072 sc1
buffer_load_dwordx4 a[208:211], v20, s[24:27], s52 offen offset:0 sc1
buffer_load_dwordx4 a[212:215], v20, s[24:27], s52 offen offset:1024 sc1
buffer_load_dwordx4 a[216:219], v20, s[24:27], s52 offen offset:2048 sc1
buffer_load_dwordx4 a[220:223], v20, s[24:27], s52 offen offset:3072 sc1
buffer_load_dwordx4 a[64:67], v15, s[24:27], s55 offen offset:0 sc1
buffer_load_dwordx4 a[68:71], v15, s[24:27], s55 offen offset:1024 sc1
buffer_load_dwordx4 a[72:75], v15, s[24:27], s55 offen offset:2048 sc1
buffer_load_dwordx4 a[76:79], v15, s[24:27], s55 offen offset:3072 sc1
buffer_load_dwordx4 a[80:83], v20, s[24:27], s55 offen offset:0 sc1
buffer_load_dwordx4 a[84:87], v20, s[24:27], s55 offen offset:1024 sc1
buffer_load_dwordx4 a[88:91], v20, s[24:27], s55 offen offset:2048 sc1
buffer_load_dwordx4 a[92:95], v20, s[24:27], s55 offen offset:3072 sc1
s_waitcnt vmcnt(0)
v_mfma_f32_16x16x32_bf16 v[44:47], a[192:195], a[48:51], 0
v_mfma_f32_16x16x32_bf16 v[44:47], a[196:199], a[52:55], v[44:47]
v_mfma_f32_16x16x32_bf16 v[44:47], a[200:203], a[0:3], v[44:47]
v_mfma_f32_16x16x32_bf16 v[44:47], a[204:207], a[8:11], v[44:47]
v_mfma_f32_16x16x32_bf16 v[52:55], a[192:195], a[60:63], 0
v_mfma_f32_16x16x32_bf16 v[52:55], a[196:199], a[56:59], v[52:55]
v_mfma_f32_16x16x32_bf16 v[52:55], a[200:203], a[16:19], v[52:55]
v_mfma_f32_16x16x32_bf16 v[52:55], a[204:207], a[24:27], v[52:55]
v_mfma_f32_16x16x32_bf16 v[64:67], a[208:211], a[48:51], 0
v_mfma_f32_16x16x32_bf16 v[64:67], a[212:215], a[52:55], v[64:67]
v_mfma_f32_16x16x32_bf16 v[64:67], a[216:219], a[0:3], v[64:67]
v_mfma_f32_16x16x32_bf16 v[64:67], a[220:223], a[8:11], v[64:67]
v_mfma_f32_16x16x32_bf16 v[212:215], a[208:211], a[60:63], 0
v_mfma_f32_16x16x32_bf16 v[212:215], a[212:215], a[56:59], v[212:215]
v_mfma_f32_16x16x32_bf16 v[212:215], a[216:219], a[16:19], v[212:215]
v_mfma_f32_16x16x32_bf16 v[212:215], a[220:223], a[24:27], v[212:215]
s_nop 7
s_cmp_lg_u32 s53, s67
s_cbranch_scc1 SLOW1_U
v_cndmask_b32 v44, v44, v6, s[56:57]
v_cndmask_b32 v212, v212, v6, s[56:57]
v_mov_b32 v64, v6
v_cndmask_b32 v45, v45, v6, s[58:59]
v_cndmask_b32 v213, v213, v6, s[58:59]
v_mov_b32 v65, v6
v_cndmask_b32 v46, v46, v6, s[60:61]
v_cndmask_b32 v214, v214, v6, s[60:61]
v_mov_b32 v66, v6
v_cndmask_b32 v47, v47, v6, s[62:63]
v_cndmask_b32 v215, v215, v6, s[62:63]
v_mov_b32 v67, v6
SLOW1_U:
s_cmp_lg_u32 s54, 0
s_cbranch_scc1 SLOW1_A
v_max3_f32 v16, v16, v44, v45
v_max3_f32 v16, v16, v46, v47
v_max3_f32 v18, v18, v52, v53
v_max3_f32 v18, v18, v54, v55
v_max3_f32 v16, v16, v64, v65
v_max3_f32 v16, v16, v66, v67
v_max3_f32 v18, v18, v212, v213
v_max3_f32 v18, v18, v214, v215
s_branch SLOW1_N
SLOW1_A:
v_sub_f32 v44, v44, v16
v_sub_f32 v45, v45, v16
v_sub_f32 v46, v46, v16
v_sub_f32 v47, v47, v16
v_sub_f32 v52, v52, v18
v_sub_f32 v53, v53, v18
v_sub_f32 v54, v54, v18
v_sub_f32 v55, v55, v18
v_sub_f32 v64, v64, v16
v_sub_f32 v65, v65, v16
v_sub_f32 v66, v66, v16
v_sub_f32 v67, v67, v16
v_sub_f32 v212, v212, v18
v_sub_f32 v213, v213, v18
v_sub_f32 v214, v214, v18
v_sub_f32 v215, v215, v18
v_exp_f32 v44, v44
v_exp_f32 v45, v45
v_exp_f32 v46, v46
v_exp_f32 v47, v47
v_exp_f32 v52, v52
v_exp_f32 v53, v53
v_exp_f32 v54, v54
v_exp_f32 v55, v55
v_exp_f32 v64, v64
v_exp_f32 v65, v65
v_exp_f32 v66, v66
v_exp_f32 v67, v67
v_exp_f32 v212, v212
v_exp_f32 v213, v213
v_exp_f32 v214, v214
v_exp_f32 v215, v215
s_nop 0
v_cvt_pk_bf16_f32 v124, v44, v45
v_cvt_pk_bf16_f32 v125, v46, v47
v_cvt_pk_bf16_f32 v140, v52, v53
v_cvt_pk_bf16_f32 v141, v54, v55
v_cvt_pk_bf16_f32 v126, v64, v65
v_cvt_pk_bf16_f32 v127, v66, v67
v_cvt_pk_bf16_f32 v142, v212, v213
v_cvt_pk_bf16_f32 v143, v214, v215
s_nop 1
v_mfma_f32_16x16x32_bf16 v[60:63], a[64:67], v[124:127], v[60:63]
v_mfma_f32_16x16x32_bf16 v[148:151], a[64:67], v[140:143], v[148:151]
v_mfma_f32_16x16x32_bf16 v[48:51], a[68:71], v[140:143], v[48:51]
v_mfma_f32_16x16x32_bf16 v[68:71], a[68:71], v[124:127], v[68:71]
v_mfma_f32_16x16x32_bf16 v[72:75], a[72:75], v[124:127], v[72:75]
v_mfma_f32_16x16x32_bf16 v[236:239], a[72:75], v[140:143], v[236:239]
v_mfma_f32_16x16x32_bf16 v[224:227], a[76:79], v[140:143], v[224:227]
v_mfma_f32_16x16x32_bf16 v[220:223], a[76:79], v[124:127], v[220:223]
v_mfma_f32_16x16x32_bf16 v[84:87], a[80:83], v[124:127], v[84:87]
v_mfma_f32_16x16x32_bf16 v[164:167], a[80:83], v[140:143], v[164:167]
v_mfma_f32_16x16x32_bf16 v[156:159], a[84:87], v[140:143], v[156:159]
v_mfma_f32_16x16x32_bf16 v[76:79], a[84:87], v[124:127], v[76:79]
v_mfma_f32_16x16x32_bf16 v[160:163], a[88:91], v[124:127], v[160:163]
v_mfma_f32_16x16x32_bf16 v[216:219], a[88:91], v[140:143], v[216:219]
v_mfma_f32_16x16x32_bf16 v[208:211], a[92:95], v[140:143], v[208:211]
v_mfma_f32_16x16x32_bf16 v[252:255], a[92:95], v[124:127], v[252:255]
v_mfma_f32_16x16x32_bf16 a[232:235], a[240:243], v[124:127], a[232:235]
v_mfma_f32_16x16x32_bf16 a[236:239], a[240:243], v[140:143], a[236:239]
SLOW1_N:
s_add_u32 s52, s52, 16384
s_add_u32 s53, s53, 1
s_cmp_le_u32 s53, s67
s_cbranch_scc1 SLOW1_T
s_cmp_lg_u32 s54, 0
s_cbranch_scc1 SLOW1_E
v_mov_b32 v17, v16
v_mov_b32 v19, v18
s_nop 1
v_permlane32_swap_b32 v17, v16
v_permlane32_swap_b32 v19, v18
s_nop 1
v_max_f32 v16, v16, v17
v_max_f32 v18, v18, v19
v_mov_b32 v17, v16
v_mov_b32 v19, v18
s_nop 1
v_permlane16_swap_b32 v17, v16
v_permlane16_swap_b32 v19, v18
s_nop 1
v_max_f32 v16, v16, v17
v_max_f32 v18, v18, v19
v_mov_b32 v60, 0
v_mov_b32 v61, 0
v_mov_b32 v62, 0
v_mov_b32 v63, 0
v_mov_b32 v68, 0
v_mov_b32 v69, 0
v_mov_b32 v70, 0
v_mov_b32 v71, 0
v_mov_b32 v72, 0
v_mov_b32 v73, 0
v_mov_b32 v74, 0
v_mov_b32 v75, 0
v_mov_b32 v220, 0
v_mov_b32 v221, 0
v_mov_b32 v222, 0
v_mov_b32 v223, 0
v_mov_b32 v84, 0
v_mov_b32 v85, 0
v_mov_b32 v86, 0
v_mov_b32 v87, 0
v_mov_b32 v76, 0
v_mov_b32 v77, 0
v_mov_b32 v78, 0
v_mov_b32 v79, 0
v_mov_b32 v160, 0
v_mov_b32 v161, 0
v_mov_b32 v162, 0
v_mov_b32 v163, 0
v_mov_b32 v252, 0
v_mov_b32 v253, 0
v_mov_b32 v254, 0
v_mov_b32 v255, 0
v_mov_b32 v148, 0
v_mov_b32 v149, 0
v_mov_b32 v150, 0
v_mov_b32 v151, 0
v_mov_b32 v48, 0
v_mov_b32 v49, 0
v_mov_b32 v50, 0
v_mov_b32 v51, 0
v_mov_b32 v236, 0
v_mov_b32 v237, 0
v_mov_b32 v238, 0
v_mov_b32 v239, 0
v_mov_b32 v224, 0
v_mov_b32 v225, 0
v_mov_b32 v226, 0
v_mov_b32 v227, 0
v_mov_b32 v164, 0
v_mov_b32 v165, 0
v_mov_b32 v166, 0
v_mov_b32 v167, 0
v_mov_b32 v156, 0
v_mov_b32 v157, 0
v_mov_b32 v158, 0
v_mov_b32 v159, 0
v_mov_b32 v216, 0
v_mov_b32 v217, 0
v_mov_b32 v218, 0
v_mov_b32 v219, 0
v_mov_b32 v208, 0
v_mov_b32 v209, 0
v_mov_b32 v210, 0
v_mov_b32 v211, 0
v_accvgpr_write_b32 a232, 0
v_accvgpr_write_b32 a233, 0
v_accvgpr_write_b32 a234, 0
v_accvgpr_write_b32 a235, 0
v_accvgpr_write_b32 a236, 0
v_accvgpr_write_b32 a237, 0
v_accvgpr_write_b32 a238, 0
v_accvgpr_write_b32 a239, 0
s_mov_b32 s54, 1
s_branch SLOW1_P
SLOW1_E:
s_nop 7
v_accvgpr_read_b32 v180, a232
v_accvgpr_read_b32 v182, a236
s_add_u32 s52, s79, 4096
v_fma_f32 v180, v180, v10, v180
v_fma_f32 v182, v182, v11, v182
v_rcp_f32 v180, v180
v_rcp_f32 v182, v182
s_nop 0
v_pk_mul_f32 v[60:61], v[60:61], v[180:181] op_sel_hi:[1,0]
v_pk_mul_f32 v[62:63], v[62:63], v[180:181] op_sel_hi:[1,0]
v_pk_mul_f32 v[68:69], v[68:69], v[180:181] op_sel_hi:[1,0]
v_pk_mul_f32 v[70:71], v[70:71], v[180:181] op_sel_hi:[1,0]
v_cvt_pk_bf16_f32 v60, v60, v61
v_cvt_pk_bf16_f32 v61, v62, v63
v_cvt_pk_bf16_f32 v62, v68, v69
v_cvt_pk_bf16_f32 v63, v70, v71
s_branch L_EP
.section .rodata,"a"
.p2align 6
.amdhsa_kernel gated_mix__sliding_local_dilated__compressed_kv_cla__prompt_kernel
  .amdhsa_next_free_vgpr 512
  .amdhsa_next_free_sgpr 102
  .amdhsa_accum_offset 256
  .amdhsa_group_segment_fixed_size 0
  .amdhsa_kernarg_size 104
  .amdhsa_user_sgpr_count 2
  .amdhsa_user_sgpr_kernarg_segment_ptr 1
  .amdhsa_system_sgpr_workgroup_id_x 1
.end_amdhsa_kernel
```

```asm
; @launch grid=(256,1,1) block=(256,1,1) lds=163840
.amdgcn_target "amdgcn-amd-amdhsa--gfx950"
.text

.globl gated_mix__sliding_local_dilated__compressed_kv_cla__prompt_kernel
.p2align 8
.type gated_mix__sliding_local_dilated__compressed_kv_cla__prompt_kernel,@function
gated_mix__sliding_local_dilated__compressed_kv_cla__prompt_kernel:
s_cmp_ge_u32 s2, 256
s_cbranch_scc1 L_END
s_load_dwordx2 s[8:9], s[0:1], 32
s_load_dwordx2 s[56:57], s[0:1], 56
s_load_dwordx2 s[16:17], s[0:1], 48
s_load_dwordx2 s[24:25], s[0:1], 96
s_load_dwordx2 s[12:13], s[0:1], 0
s_load_dwordx2 s[20:21], s[0:1], 40
s_load_dwordx2 s[28:29], s[0:1], 8
s_load_dwordx2 s[48:49], s[0:1], 16
s_load_dwordx2 s[32:33], s[0:1], 64
s_load_dwordx2 s[36:37], s[0:1], 72
s_load_dwordx2 s[40:41], s[0:1], 88
s_load_dwordx2 s[44:45], s[0:1], 80
s_getpc_b64 s[96:97]
L_PC:
s_lshr_b32 s6, s2, 3
s_lshl_b32 s98, s6, 11
s_add_u32 s98, s98, L_MAIN-L_PC
s_add_u32 s96, s96, s98
s_addc_u32 s97, s97, 0
v_lshlrev_b32 v16, 3, v0
v_mov_b32 v17, s97
v_add_co_u32 v16, vcc, s96, v16
v_lshrrev_b32 v5, 6, v0
v_and_b32 v1, 63, v0
v_addc_co_u32 v17, vcc, 0, v17, vcc
v_readfirstlane_b32 s3, v5
global_load_dwordx2 a[252:253], v[16:17], off
v_and_b32 v2, 15, v0
v_lshrrev_b32 v3, 4, v1
v_lshlrev_b32 v4, 4, v1
s_and_b32 s7, s2, 7
s_and_b32 s65, s6, 3
s_lshl2_add_u32 s4, s7, s65
s_lshr_b32 s5, s6, 2
s_lshl2_add_u32 s66, s5, s3
s_sub_u32 s67, 63, s66
v_lshrrev_b32 v16, 3, v1
v_and_b32 v17, 7, v1
v_xor_b32 v18, v17, v3
v_lshlrev_b32 v19, 10, v16
v_lshl_add_u32 v5, v18, 4, v19
v_xor_b32 v18, 4, v18
v_lshl_add_u32 v6, v18, 4, v19
v_add_u32 v6, 7168, v6
v_and_b32 v18, 1, v3
v_lshlrev_b32 v18, 1, v18
v_xor_b32 v18, v17, v18
v_lshlrev_b32 v19, 13, v16
v_lshl_add_u32 v7, v18, 4, v19
v_xor_b32 v18, 4, v18
v_lshl_add_u32 v8, v18, 4, v19
v_add_u32 v8, 64512, v8
s_add_u32 s69, s65, s5
s_and_b32 s69, s69, 1
s_mul_i32 s64, s7, 2
s_and_b32 s64, s64, 7
s_or_b32 s69, s69, s64
s_add_u32 s93, s65, s5
s_and_b32 s93, s93, 0
s_mul_i32 s64, s7, 1
s_and_b32 s64, s64, 7
s_or_b32 s93, s93, s64
s_lshl_b32 s70, s69, 7
s_lshl_b32 s75, s69, 19
s_lshr_b32 s54, s3, 1
s_and_b32 s55, s3, 1
s_lshl3_add_u32 s87, s54, s5
s_lshl_b32 s64, s55, 5
s_add_u32 s68, s87, s64
s_lshl_b32 s68, s68, 15
s_lshl_b32 s73, s3, 13
s_add_u32 s73, s73, 65536
s_lshl1_add_u32 s74, s4, s55
s_lshl_b32 s74, s74, 7
s_lshl_b32 s64, s54, 18
s_add_u32 s74, s74, s64
s_lshl_b32 s77, s3, 12
s_add_u32 s71, s68, s70
s_add_u32 s76, s74, s75
s_mov_b32 s10, 2097152
s_mov_b32 s11, 0x20000
s_mov_b32 s58, 4194304
s_mov_b32 s59, 0x20000
s_waitcnt lgkmcnt(0)
s_add_u32 m0, s73, 0
s_add_u32 s64, s71, 0
buffer_load_dwordx4 v5, s[8:11], s64 offen lds
buffer_load_dwordx4 v6, s[8:11], s64 offen offset:1024 lds
s_add_u32 m0, s73, 2048
s_add_u32 s64, s71, 16384
buffer_load_dwordx4 v5, s[8:11], s64 offen lds
buffer_load_dwordx4 v6, s[8:11], s64 offen offset:1024 lds
s_add_u32 m0, s77, 0
s_add_u32 s64, s76, 0
buffer_load_dwordx4 v7, s[56:59], s64 offen lds
buffer_load_dwordx4 v8, s[56:59], s64 offen offset:1024 lds
s_add_u32 m0, s77, 2048
s_add_u32 s64, s76, 131072
buffer_load_dwordx4 v7, s[56:59], s64 offen lds
buffer_load_dwordx4 v8, s[56:59], s64 offen offset:1024 lds
s_add_u32 m0, s73, 4096
s_add_u32 s64, s71, 524288
buffer_load_dwordx4 v5, s[8:11], s64 offen lds
buffer_load_dwordx4 v6, s[8:11], s64 offen offset:1024 lds
s_add_u32 m0, s73, 6144
s_add_u32 s64, s71, 540672
buffer_load_dwordx4 v5, s[8:11], s64 offen lds
buffer_load_dwordx4 v6, s[8:11], s64 offen offset:1024 lds
s_mov_b32 s18, 4194304
s_mov_b32 s19, 0x20000
s_lshl_b32 s65, s54, 7
s_lshl_b32 s53, s55, 12
v_lshrrev_b32 v16, 1, v2
v_xor_b32 v16, v16, v3
v_add_u32 v17, s65, v2
v_lshlrev_b32 v17, 7, v17
v_add_u32 v17, 65536, v17
v_lshl_add_u32 v9, v16, 4, v17
v_xor_b32 v10, 64, v9
v_bfe_u32 v16, v1, 2, 2
v_lshl_add_u32 v17, v3, 3, v16
v_lshlrev_b32 v17, 7, v17
v_and_b32 v18, 3, v1
v_lshl_add_u32 v17, v18, 3, v17
v_add_u32 v17, s53, v17
v_lshrrev_b32 v16, 1, v16
v_and_b32 v18, 1, v3
v_lshl_add_u32 v16, v18, 1, v16
v_xor_b32 v18, 0, v16
v_lshl_add_u32 v11, v18, 5, v17
v_xor_b32 v18, 1, v16
v_lshl_add_u32 v12, v18, 5, v17
v_xor_b32 v18, 2, v16
v_lshl_add_u32 v13, v18, 5, v17
v_xor_b32 v18, 3, v16
v_lshl_add_u32 v14, v18, 5, v17
s_add_u32 m0, s77, 16384
s_add_u32 s64, s76, 0
buffer_load_dwordx4 v7, s[16:19], s64 offen lds
buffer_load_dwordx4 v8, s[16:19], s64 offen offset:1024 lds
s_add_u32 m0, s77, 18432
s_add_u32 s64, s76, 131072
buffer_load_dwordx4 v7, s[16:19], s64 offen lds
buffer_load_dwordx4 v8, s[16:19], s64 offen offset:1024 lds
s_mov_b64 exec, 0
s_cmp_eq_u32 s3, 0
s_cbranch_scc1 L_PAD0
s_cmp_eq_u32 s3, 1
s_cbranch_scc1 L_PAD1
s_cmp_eq_u32 s3, 2
s_cbranch_scc1 L_PAD2
s_branch L_PAD3
.p2align 12
.fill 604, 4, 0xbf800000
L_MAIN:
s_mov_b64 exec, -1
s_xor_b32 s71, s70, 128
s_add_u32 s71, s68, s71
s_add_u32 m0, s73, 32768
s_add_u32 s64, s71, 0
buffer_load_dwordx4 v5, s[8:11], s64 offen lds
buffer_load_dwordx4 v6, s[8:11], s64 offen offset:1024 lds
s_add_u32 m0, s73, 34816
s_add_u32 s64, s71, 16384
buffer_load_dwordx4 v5, s[8:11], s64 offen lds
buffer_load_dwordx4 v6, s[8:11], s64 offen offset:1024 lds
s_add_u32 m0, s73, 36864
s_add_u32 s64, s71, 524288
buffer_load_dwordx4 v5, s[8:11], s64 offen lds
buffer_load_dwordx4 v6, s[8:11], s64 offen offset:1024 lds
s_add_u32 m0, s73, 38912
s_add_u32 s64, s71, 540672
buffer_load_dwordx4 v5, s[8:11], s64 offen lds
buffer_load_dwordx4 v6, s[8:11], s64 offen offset:1024 lds
s_waitcnt vmcnt(12)
s_barrier
ds_read_b128 a[64:67], v9 offset:0
ds_read_b128 a[68:71], v10 offset:0
ds_read_b64_tr_b16 a[128:129], v11 offset:0
ds_read_b64_tr_b16 a[130:131], v11 offset:512
ds_read_b64_tr_b16 a[132:133], v11 offset:8192
ds_read_b64_tr_b16 a[134:135], v11 offset:8704
ds_read_b64_tr_b16 a[136:137], v12 offset:0
ds_read_b64_tr_b16 a[138:139], v12 offset:512
ds_read_b64_tr_b16 a[140:141], v12 offset:8192
ds_read_b64_tr_b16 a[142:143], v12 offset:8704
ds_read_b64_tr_b16 a[144:145], v13 offset:0
ds_read_b64_tr_b16 a[146:147], v13 offset:512
ds_read_b64_tr_b16 a[148:149], v13 offset:8192
ds_read_b64_tr_b16 a[150:151], v13 offset:8704
ds_read_b64_tr_b16 a[152:153], v14 offset:0
ds_read_b64_tr_b16 a[154:155], v14 offset:512
ds_read_b64_tr_b16 a[156:157], v14 offset:8192
ds_read_b64_tr_b16 a[158:159], v14 offset:8704
ds_read_b128 a[72:75], v9 offset:2048
ds_read_b128 a[76:79], v10 offset:2048
ds_read_b128 a[80:83], v9 offset:4096
ds_read_b128 a[84:87], v10 offset:4096
ds_read_b128 a[88:91], v9 offset:6144
ds_read_b128 a[92:95], v10 offset:6144
s_waitcnt lgkmcnt(0)
v_mfma_f32_16x16x32_bf16 v[32:35], a[64:67], a[128:131], 0
s_waitcnt vmcnt(8)
v_mfma_f32_16x16x32_bf16 v[32:35], a[68:71], a[132:135], v[32:35]
s_barrier
v_mfma_f32_16x16x32_bf16 v[40:43], a[68:71], a[140:143], 0
s_mov_b32 s26, 268435456
s_mov_b32 s27, 0x20000
ds_read_b128 a[96:99], v9 offset:8192
v_mfma_f32_16x16x32_bf16 v[40:43], a[64:67], a[136:139], v[40:43]
s_xor_b32 s76, s75, 524288
s_add_u32 s76, s74, s76
s_mov_b32 s14, 2359296
v_mfma_f32_16x16x32_bf16 v[48:51], a[64:67], a[144:147], 0
s_add_u32 m0, s77, 32768
s_add_u32 s64, s76, 0
s_mov_b32 s15, 0x20000
v_mfma_f32_16x16x32_bf16 v[48:51], a[68:71], a[148:151], v[48:51]
buffer_load_dwordx4 v7, s[56:59], s64 offen lds
v_mfma_f32_16x16x32_bf16 v[56:59], a[68:71], a[156:159], 0
s_mov_b32 s22, 4718592
s_mov_b32 s23, 0x20000
ds_read_b128 a[100:103], v10 offset:8192
v_mfma_f32_16x16x32_bf16 v[56:59], a[64:67], a[152:155], v[56:59]
buffer_load_dwordx4 v8, s[56:59], s64 offen offset:1024 lds
v_mfma_f32_16x16x32_bf16 v[60:63], a[72:75], a[152:155], 0
s_add_u32 m0, s77, 34816
s_add_u32 s64, s76, 131072
ds_read_b128 a[104:107], v9 offset:10240
v_mfma_f32_16x16x32_bf16 v[60:63], a[76:79], a[156:159], v[60:63]
s_mov_b32 s30, 1990656
s_mov_b32 s31, 0x20000
s_mov_b32 s34, 4718592
v_mfma_f32_16x16x32_bf16 v[52:55], a[76:79], a[148:151], 0
buffer_load_dwordx4 v7, s[56:59], s64 offen lds
v_mfma_f32_16x16x32_bf16 v[52:55], a[72:75], a[144:147], v[52:55]
s_mov_b32 s35, 0x20000
ds_read_b64_tr_b16 a[160:161], v11 offset:16384
ds_read_b64_tr_b16 a[162:163], v11 offset:16896
v_mfma_f32_16x16x32_bf16 v[44:47], a[72:75], a[136:139], 0
s_mov_b32 s38, 1152
s_mov_b32 s39, 0x20000
s_mov_b32 s42, 256
v_mfma_f32_16x16x32_bf16 v[44:47], a[76:79], a[140:143], v[44:47]
buffer_load_dwordx4 v8, s[56:59], s64 offen offset:1024 lds
v_mfma_f32_16x16x32_bf16 v[36:39], a[76:79], a[132:135], 0
s_mov_b32 s43, 0x20000
s_mov_b32 s46, 2359296
s_mov_b32 s47, 0x20000
v_mfma_f32_16x16x32_bf16 v[36:39], a[72:75], a[128:131], v[36:39]
s_add_u32 m0, s77, 49152
s_add_u32 s64, s76, 0
ds_read_b128 a[108:111], v10 offset:10240
v_mfma_f32_16x16x32_bf16 v[64:67], a[80:83], a[128:131], 0
s_mov_b32 s50, 663552
s_mov_b32 s51, 0x20000
s_lshl_b32 s89, s4, 10
v_mfma_f32_16x16x32_bf16 v[64:67], a[84:87], a[132:135], v[64:67]
buffer_load_dwordx4 v7, s[16:19], s64 offen lds
v_mfma_f32_16x16x32_bf16 v[72:75], a[84:87], a[140:143], 0
s_add_u32 s89, s89, 75497472
ds_read_b64_tr_b16 a[164:165], v11 offset:24576
ds_read_b64_tr_b16 a[166:167], v11 offset:25088
v_mfma_f32_16x16x32_bf16 v[72:75], a[80:83], a[136:139], v[72:75]
s_mul_i32 s94, s4, 1064960
s_lshl_b32 s52, s5, 15
s_add_u32 s52, s52, s89
v_mfma_f32_16x16x32_bf16 v[80:83], a[80:83], a[144:147], 0
buffer_load_dwordx4 v8, s[16:19], s64 offen offset:1024 lds
v_mfma_f32_16x16x32_bf16 v[80:83], a[84:87], a[148:151], v[80:83]
s_add_u32 m0, s77, 51200
s_add_u32 s64, s76, 131072
ds_read_b128 a[112:115], v9 offset:12288
v_mfma_f32_16x16x32_bf16 v[88:91], a[84:87], a[156:159], 0
s_lshl_b32 s53, s5, 10
s_add_u32 s53, s53, s94
s_add_u32 s53, s53, 1048576
v_mfma_f32_16x16x32_bf16 v[88:91], a[80:83], a[152:155], v[88:91]
buffer_load_dwordx4 v7, s[16:19], s64 offen lds
v_mfma_f32_16x16x32_bf16 v[92:95], a[88:91], a[152:155], 0
ds_read_b64_tr_b16 a[168:169], v12 offset:16384
ds_read_b64_tr_b16 a[170:171], v12 offset:16896
v_mfma_f32_16x16x32_bf16 v[92:95], a[92:95], a[156:159], v[92:95]
s_cmp_eq_u32 s3, 1
s_cselect_b32 s52, s53, s52
s_mul_i32 s53, s2, 74
v_mfma_f32_16x16x32_bf16 v[84:87], a[92:95], a[148:151], 0
buffer_load_dwordx4 v8, s[16:19], s64 offen offset:1024 lds
v_mfma_f32_16x16x32_bf16 v[84:87], a[88:91], a[144:147], v[84:87]
s_add_u32 s53, s53, s55
s_lshl_b32 s53, s53, 10
s_add_u32 s53, s53, 54599680
v_mfma_f32_16x16x32_bf16 v[76:79], a[88:91], a[136:139], 0
s_cmp_ge_u32 s3, 2
s_cselect_b32 s52, s53, s52
ds_read_b128 a[116:119], v10 offset:12288
v_mfma_f32_16x16x32_bf16 v[76:79], a[92:95], a[140:143], v[76:79]
v_mov_b32 v16, 0
v_mov_b32 v17, 0
v_mfma_f32_16x16x32_bf16 v[68:71], a[92:95], a[132:135], 0
v_mov_b32 v18, 0
v_mov_b32 v19, 0
v_mfma_f32_16x16x32_bf16 v[68:71], a[88:91], a[128:131], v[68:71]
s_waitcnt lgkmcnt(6)
ds_read_b64_tr_b16 a[172:173], v12 offset:24576
ds_read_b64_tr_b16 a[174:175], v12 offset:25088
v_mfma_f32_16x16x32_bf16 v[96:99], a[96:99], a[128:131], 0
v_lshrrev_b32 v20, 3, v1
v_cmp_eq_u32 vcc, 3, v20
v_mfma_f32_16x16x32_bf16 v[96:99], a[100:103], a[132:135], v[96:99]
v_add_u32 v20, 100663168, v4
v_mov_b32 v21, s3
v_mfma_f32_16x16x32_bf16 v[104:107], a[100:103], a[140:143], 0
ds_read_b128 a[120:123], v9 offset:14336
v_cndmask_b32 v15, v4, v20, vcc
v_mfma_f32_16x16x32_bf16 v[104:107], a[96:99], a[136:139], v[104:107]
v_cmp_eq_u32 vcc, 0, v21
v_mov_b32 v21, 0
v_mfma_f32_16x16x32_bf16 v[112:115], a[96:99], a[144:147], 0
v_mov_b32 v21, 0
v_cndmask_b32 v20, v15, v4, vcc
v_mfma_f32_16x16x32_bf16 v[112:115], a[100:103], a[148:151], v[112:115]
ds_read_b64_tr_b16 a[176:177], v13 offset:16384
ds_read_b64_tr_b16 a[178:179], v13 offset:16896
v_mfma_f32_16x16x32_bf16 v[120:123], a[100:103], a[156:159], 0
v_mfma_f32_16x16x32_bf16 v[120:123], a[96:99], a[152:155], v[120:123]
v_mfma_f32_16x16x32_bf16 v[124:127], a[104:107], a[152:155], 0
v_mfma_f32_16x16x32_bf16 v[124:127], a[108:111], a[156:159], v[124:127]
ds_read_b128 a[124:127], v10 offset:14336
v_mfma_f32_16x16x32_bf16 v[116:119], a[108:111], a[148:151], 0
v_add_u32 v9, 32768, v9
v_add_u32 v10, 32768, v10
v_mfma_f32_16x16x32_bf16 v[116:119], a[104:107], a[144:147], v[116:119]
v_mfma_f32_16x16x32_bf16 v[108:111], a[104:107], a[136:139], 0
ds_read_b64_tr_b16 a[180:181], v13 offset:24576
ds_read_b64_tr_b16 a[182:183], v13 offset:25088
v_mfma_f32_16x16x32_bf16 v[108:111], a[108:111], a[140:143], v[108:111]
v_mfma_f32_16x16x32_bf16 v[100:103], a[108:111], a[132:135], 0
v_mfma_f32_16x16x32_bf16 v[100:103], a[104:107], a[128:131], v[100:103]
s_waitcnt lgkmcnt(2)
ds_read_b64_tr_b16 a[184:185], v14 offset:16384
ds_read_b64_tr_b16 a[186:187], v14 offset:16896
v_mfma_f32_16x16x32_bf16 v[128:131], a[112:115], a[128:131], 0
v_mfma_f32_16x16x32_bf16 v[128:131], a[116:119], a[132:135], v[128:131]
v_mfma_f32_16x16x32_bf16 v[136:139], a[116:119], a[140:143], 0
ds_read_b64_tr_b16 a[188:189], v14 offset:24576
ds_read_b64_tr_b16 a[190:191], v14 offset:25088
v_mfma_f32_16x16x32_bf16 v[136:139], a[112:115], a[136:139], v[136:139]
v_mfma_f32_16x16x32_bf16 v[144:147], a[112:115], a[144:147], 0
v_mfma_f32_16x16x32_bf16 v[144:147], a[116:119], a[148:151], v[144:147]
v_mfma_f32_16x16x32_bf16 v[152:155], a[116:119], a[156:159], 0
v_mfma_f32_16x16x32_bf16 v[152:155], a[112:115], a[152:155], v[152:155]
v_mfma_f32_16x16x32_bf16 v[156:159], a[120:123], a[152:155], 0
v_mfma_f32_16x16x32_bf16 v[156:159], a[124:127], a[156:159], v[156:159]
v_mfma_f32_16x16x32_bf16 v[148:151], a[124:127], a[148:151], 0
v_mfma_f32_16x16x32_bf16 v[148:151], a[120:123], a[144:147], v[148:151]
v_mfma_f32_16x16x32_bf16 v[140:143], a[120:123], a[136:139], 0
v_mfma_f32_16x16x32_bf16 v[140:143], a[124:127], a[140:143], v[140:143]
v_mfma_f32_16x16x32_bf16 v[132:135], a[124:127], a[132:135], 0
v_mfma_f32_16x16x32_bf16 v[132:135], a[120:123], a[128:131], v[132:135]
s_waitcnt lgkmcnt(0)
v_mfma_f32_16x16x32_bf16 v[160:163], a[160:163], a[64:67], 0
s_waitcnt vmcnt(4)
v_mfma_f32_16x16x32_bf16 v[160:163], a[164:167], a[68:71], v[160:163]
s_barrier
v_mfma_f32_16x16x32_bf16 v[164:167], a[172:175], a[68:71], 0
ds_read_b64_tr_b16 a[128:129], v11 offset:32768
ds_read_b64_tr_b16 a[130:131], v11 offset:33280
v_mfma_f32_16x16x32_bf16 v[164:167], a[168:171], a[64:67], v[164:167]
s_xor_b32 s71, s70, 256
s_add_u32 s71, s68, s71
v_mfma_f32_16x16x32_bf16 v[168:171], a[176:179], a[64:67], 0
s_add_u32 m0, s73, 65536
s_add_u32 s64, s71, 0
v_mfma_f32_16x16x32_bf16 v[168:171], a[180:183], a[68:71], v[168:171]
buffer_load_dwordx4 v5, s[8:11], s64 offen lds
v_mfma_f32_16x16x32_bf16 v[172:175], a[188:191], a[68:71], 0
v_mfma_f32_16x16x32_bf16 v[172:175], a[184:187], a[64:67], v[172:175]
ds_read_b128 a[64:67], v9 offset:0
v_mfma_f32_16x16x32_bf16 v[188:191], a[184:187], a[72:75], 0
buffer_load_dwordx4 v6, s[8:11], s64 offen offset:1024 lds
v_mfma_f32_16x16x32_bf16 v[188:191], a[188:191], a[76:79], v[188:191]
ds_read_b64_tr_b16 a[132:133], v11 offset:40960
ds_read_b64_tr_b16 a[134:135], v11 offset:41472
v_mfma_f32_16x16x32_bf16 v[184:187], a[180:183], a[76:79], 0
v_mfma_f32_16x16x32_bf16 v[184:187], a[176:179], a[72:75], v[184:187]
s_add_u32 m0, s73, 67584
s_add_u32 s64, s71, 16384
ds_read_b128 a[68:71], v10 offset:0
v_mfma_f32_16x16x32_bf16 v[180:183], a[168:171], a[72:75], 0
L_PAD0:
s_cbranch_execz L_PAD4
v_mfma_f32_16x16x32_bf16 v[180:183], a[172:175], a[76:79], v[180:183]
buffer_load_dwordx4 v5, s[8:11], s64 offen lds
v_mfma_f32_16x16x32_bf16 v[176:179], a[164:167], a[76:79], 0
v_mfma_f32_16x16x32_bf16 v[176:179], a[160:163], a[72:75], v[176:179]
ds_read_b64_tr_b16 a[136:137], v12 offset:32768
ds_read_b64_tr_b16 a[138:139], v12 offset:33280
v_mfma_f32_16x16x32_bf16 v[192:195], a[160:163], a[80:83], 0
v_mfma_f32_16x16x32_bf16 v[192:195], a[164:167], a[84:87], v[192:195]
v_mfma_f32_16x16x32_bf16 v[196:199], a[172:175], a[84:87], 0
buffer_load_dwordx4 v6, s[8:11], s64 offen offset:1024 lds
v_mfma_f32_16x16x32_bf16 v[196:199], a[168:171], a[80:83], v[196:199]
s_xor_b32 s76, s75, 1048576
s_add_u32 s76, s74, s76
ds_read_b128 a[72:75], v9 offset:2048
v_mfma_f32_16x16x32_bf16 v[200:203], a[176:179], a[80:83], 0
v_mfma_f32_16x16x32_bf16 v[200:203], a[180:183], a[84:87], v[200:203]
s_add_u32 m0, s77, 0
s_add_u32 s64, s76, 0
v_mfma_f32_16x16x32_bf16 v[204:207], a[188:191], a[84:87], 0
ds_read_b64_tr_b16 a[140:141], v12 offset:40960
ds_read_b64_tr_b16 a[142:143], v12 offset:41472
v_mfma_f32_16x16x32_bf16 v[204:207], a[184:187], a[80:83], v[204:207]
buffer_load_dwordx4 v7, s[56:59], s64 offen lds
v_mfma_f32_16x16x32_bf16 v[220:223], a[184:187], a[88:91], 0
ds_read_b128 a[76:79], v10 offset:2048
v_mfma_f32_16x16x32_bf16 v[220:223], a[188:191], a[92:95], v[220:223]
v_mfma_f32_16x16x32_bf16 v[216:219], a[180:183], a[92:95], 0
v_mfma_f32_16x16x32_bf16 v[216:219], a[176:179], a[88:91], v[216:219]
v_mfma_f32_16x16x32_bf16 v[212:215], a[168:171], a[88:91], 0
buffer_load_dwordx4 v8, s[56:59], s64 offen offset:1024 lds
v_mfma_f32_16x16x32_bf16 v[212:215], a[172:175], a[92:95], v[212:215]
ds_read_b64_tr_b16 a[144:145], v13 offset:32768
ds_read_b64_tr_b16 a[146:147], v13 offset:33280
v_mfma_f32_16x16x32_bf16 v[208:211], a[164:167], a[92:95], 0
v_mfma_f32_16x16x32_bf16 v[208:211], a[160:163], a[88:91], v[208:211]
s_add_u32 m0, s77, 2048
s_add_u32 s64, s76, 131072
ds_read_b128 a[80:83], v9 offset:4096
v_mfma_f32_16x16x32_bf16 v[224:227], a[160:163], a[96:99], 0
v_mfma_f32_16x16x32_bf16 v[224:227], a[164:167], a[100:103], v[224:227]
buffer_load_dwordx4 v7, s[56:59], s64 offen lds
v_mfma_f32_16x16x32_bf16 v[228:231], a[172:175], a[100:103], 0
ds_read_b64_tr_b16 a[148:149], v13 offset:40960
ds_read_b64_tr_b16 a[150:151], v13 offset:41472
v_mfma_f32_16x16x32_bf16 v[228:231], a[168:171], a[96:99], v[228:231]
v_mfma_f32_16x16x32_bf16 v[232:235], a[176:179], a[96:99], 0
buffer_store_dwordx4 v[16:19], v20, s[24:27], s52 offen sc1
v_mfma_f32_16x16x32_bf16 v[232:235], a[180:183], a[100:103], v[232:235]
buffer_load_dwordx4 v8, s[56:59], s64 offen offset:1024 lds
v_mfma_f32_16x16x32_bf16 v[236:239], a[188:191], a[100:103], 0
s_add_u32 s89, s89, 512
ds_read_b128 a[84:87], v10 offset:4096
v_mfma_f32_16x16x32_bf16 v[236:239], a[184:187], a[96:99], v[236:239]
s_cmp_eq_u32 s3, 0
s_cselect_b32 s90, s89, 2147418112
v_mov_b32 v24, 2147418112
v_mfma_f32_16x16x32_bf16 v[252:255], a[184:187], a[104:107], 0
s_add_u32 m0, s73, 69632
s_add_u32 s64, s71, 524288
v_cmp_eq_u32 vcc, 1, v1
v_mfma_f32_16x16x32_bf16 v[252:255], a[188:191], a[108:111], v[252:255]
s_lshl_b32 s53, s55, 12
ds_read_b64_tr_b16 a[152:153], v14 offset:32768
ds_read_b64_tr_b16 a[154:155], v14 offset:33280
v_mfma_f32_16x16x32_bf16 v[248:251], a[180:183], a[108:111], 0
buffer_load_dwordx4 v5, s[8:11], s64 offen lds
v_mfma_f32_16x16x32_bf16 v[248:251], a[176:179], a[104:107], v[248:251]
v_cndmask_b32 v0, v24, 0, vcc
v_mfma_f32_16x16x32_bf16 v[244:247], a[168:171], a[104:107], 0
s_mul_i32 s87, s87, 16384
s_add_u32 s87, s87, s94
ds_read_b128 a[88:91], v9 offset:6144
v_mfma_f32_16x16x32_bf16 v[244:247], a[172:175], a[108:111], v[244:247]
s_add_u32 s88, s87, s53
s_add_u32 s88, s88, 24576
s_lshr_b32 s53, s53, 1
v_mfma_f32_16x16x32_bf16 v[240:243], a[164:167], a[108:111], 0
s_add_u32 s87, s87, s53
s_lshl_b32 s80, s3, 10
s_mul_i32 s78, s4, 18
v_mfma_f32_16x16x32_bf16 v[240:243], a[160:163], a[104:107], v[240:243]
buffer_load_dwordx4 v6, s[8:11], s64 offen offset:1024 lds
v_mfma_f32_16x16x32_bf16 a[0:3], a[160:163], a[112:115], 0
s_add_u32 s78, s78, s54
ds_read_b64_tr_b16 a[156:157], v14 offset:40960
ds_read_b64_tr_b16 a[158:159], v14 offset:41472
v_mfma_f32_16x16x32_bf16 a[0:3], a[164:167], a[116:119], a[0:3]
s_lshl2_add_u32 s78, s78, s55
s_lshl_b32 s78, s78, 10
s_add_u32 s78, s78, 35651584
v_mfma_f32_16x16x32_bf16 a[4:7], a[172:175], a[116:119], 0
s_add_u32 m0, s73, 71680
s_add_u32 s64, s71, 540672
ds_read_b128 a[92:95], v10 offset:6144
v_mfma_f32_16x16x32_bf16 a[4:7], a[168:171], a[112:115], a[4:7]
s_add_u32 s80, s80, 8192
s_mov_b32 s91, 0x3e0293ee
s_mov_b32 s85, 0x05040100
v_mfma_f32_16x16x32_bf16 a[8:11], a[176:179], a[112:115], 0
buffer_load_dwordx4 v5, s[8:11], s64 offen lds
v_mfma_f32_16x16x32_bf16 a[8:11], a[180:183], a[116:119], a[8:11]
s_mov_b32 s86, 0x07060302
s_lshl2_add_u32 s52, s7, s3
s_and_b32 s65, s6, 3
v_mfma_f32_16x16x32_bf16 a[12:15], a[188:191], a[116:119], 0
s_max_u32 s95, s65, 1
s_mul_i32 s92, s5, 3
s_add_u32 s95, s95, s92
v_mfma_f32_16x16x32_bf16 a[12:15], a[184:187], a[112:115], a[12:15]
s_sub_u32 s95, 24, s95
s_cmp_eq_u32 s65, 1
s_cselect_b32 s95, 63, s95
v_mfma_f32_16x16x32_bf16 a[28:31], a[184:187], a[120:123], 0
s_mov_b32 s92, s95
s_mul_i32 s81, s92, 110592
s_mul_i32 s65, s52, 36
v_mfma_f32_16x16x32_bf16 a[28:31], a[188:191], a[124:127], a[28:31]
buffer_load_dwordx4 v6, s[8:11], s64 offen offset:1024 lds
v_mfma_f32_16x16x32_bf16 a[24:27], a[180:183], a[124:127], 0
s_add_u32 s81, s81, s65
s_mul_i32 s82, s52, 18
s_add_u32 s82, s82, s92
v_mfma_f32_16x16x32_bf16 a[24:27], a[176:179], a[120:123], a[24:27]
s_lshl_b32 s82, s82, 12
s_add_u32 s82, s82, 35651584
s_lshl_b32 s83, s92, 6
v_mfma_f32_16x16x32_bf16 a[20:23], a[168:171], a[120:123], 0
s_lshl_b32 s84, s52, 10
s_add_u32 s84, s84, 75497984
v_mfma_f32_16x16x32_bf16 a[20:23], a[172:175], a[124:127], a[20:23]
s_cmp_lt_u32 s92, 18
s_cselect_b32 s82, s82, 2147418112
s_cselect_b32 s84, s84, 2147418112
v_mfma_f32_16x16x32_bf16 a[16:19], a[164:167], a[124:127], 0
v_lshrrev_b32 v18, 2, v2
v_and_b32 v19, 3, v2
v_mfma_f32_16x16x32_bf16 a[16:19], a[160:163], a[120:123], a[16:19]
s_waitcnt lgkmcnt(0)
v_mul_u32_u24 v20, 1152, v18
v_cmp_eq_u32 vcc, 2, v19
v_mfma_f32_16x16x32_bf16 v[32:35], a[64:67], a[128:131], v[32:35]
s_waitcnt vmcnt(13)
v_lshl_add_u32 v20, v19, 3, v20
v_add_u32 v21, 1, v19
v_mfma_f32_16x16x32_bf16 v[32:35], a[68:71], a[132:135], v[32:35]
s_barrier
v_mfma_f32_16x16x32_bf16 v[40:43], a[68:71], a[140:143], v[40:43]
ds_read_b128 a[96:99], v9 offset:8192
v_cndmask_b32 v21, v21, 0, vcc
v_mfma_f32_16x16x32_bf16 v[40:43], a[64:67], a[136:139], v[40:43]
s_add_u32 m0, s77, 16384
s_add_u32 s64, s76, 0
v_cmp_eq_u32 vcc, 3, v18
v_mfma_f32_16x16x32_bf16 v[48:51], a[64:67], a[144:147], v[48:51]
buffer_load_dwordx4 v7, s[16:19], s64 offen lds
v_mfma_f32_16x16x32_bf16 v[48:51], a[68:71], a[148:151], v[48:51]
ds_read_b128 a[100:103], v10 offset:8192
v_mul_u32_u24 v21, 1152, v21
v_mfma_f32_16x16x32_bf16 v[56:59], a[68:71], a[156:159], v[56:59]
v_add_u32 v21, 32, v21
v_cndmask_b32 v20, v20, v21, vcc
v_mfma_f32_16x16x32_bf16 v[56:59], a[64:67], a[152:155], v[56:59]
v_cmp_eq_u32 vcc, 15, v2
v_mul_u32_u24 v21, 27648, v3
v_mfma_f32_16x16x32_bf16 v[60:63], a[72:75], a[152:155], v[60:63]
buffer_load_dwordx4 v8, s[16:19], s64 offen offset:1024 lds
v_mfma_f32_16x16x32_bf16 v[60:63], a[76:79], a[156:159], v[60:63]
ds_read_b128 a[104:107], v9 offset:10240
v_add_u32 v20, v20, v21
v_mfma_f32_16x16x32_bf16 v[52:55], a[76:79], a[148:151], v[52:55]
v_lshlrev_b32 v21, 4, v3
v_cndmask_b32 v26, v20, v24, vcc
v_mfma_f32_16x16x32_bf16 v[52:55], a[72:75], a[144:147], v[52:55]
s_add_u32 m0, s77, 18432
s_add_u32 s64, s76, 131072
v_cndmask_b32 v27, v24, v21, vcc
v_mfma_f32_16x16x32_bf16 v[44:47], a[72:75], a[136:139], v[44:47]
s_lshl_b32 s52, s4, 2
ds_read_b64_tr_b16 a[160:161], v11 offset:49152
ds_read_b64_tr_b16 a[162:163], v11 offset:49664
v_mfma_f32_16x16x32_bf16 v[44:47], a[76:79], a[140:143], v[44:47]
buffer_load_dwordx4 v7, s[16:19], s64 offen lds
v_mfma_f32_16x16x32_bf16 v[36:39], a[76:79], a[132:135], v[36:39]
s_cmp_eq_u32 s66, 0
s_cselect_b32 s52, s52, 2147418112
v_mfma_f32_16x16x32_bf16 v[36:39], a[72:75], a[128:131], v[36:39]
ds_read_b128 a[108:111], v10 offset:10240
v_mfma_f32_16x16x32_bf16 v[64:67], a[80:83], a[128:131], v[64:67]
v_mfma_f32_16x16x32_bf16 v[64:67], a[84:87], a[132:135], v[64:67]
v_mfma_f32_16x16x32_bf16 v[72:75], a[84:87], a[140:143], v[72:75]
buffer_load_dwordx4 v8, s[16:19], s64 offen offset:1024 lds
v_mfma_f32_16x16x32_bf16 v[72:75], a[80:83], a[136:139], v[72:75]
s_xor_b32 s71, s70, 384
s_add_u32 s71, s68, s71
v_mfma_f32_16x16x32_bf16 v[80:83], a[80:83], a[144:147], v[80:83]
ds_read_b64_tr_b16 a[164:165], v11 offset:57344
ds_read_b64_tr_b16 a[166:167], v11 offset:57856
v_mfma_f32_16x16x32_bf16 v[80:83], a[84:87], a[148:151], v[80:83]
s_add_u32 m0, s73, 0
s_add_u32 s64, s71, 0
ds_read_b128 a[112:115], v9 offset:12288
v_mfma_f32_16x16x32_bf16 v[88:91], a[84:87], a[156:159], v[88:91]
v_mfma_f32_16x16x32_bf16 v[88:91], a[80:83], a[152:155], v[88:91]
buffer_load_dwordx4 v5, s[8:11], s64 offen lds
v_mfma_f32_16x16x32_bf16 v[92:95], a[88:91], a[152:155], v[92:95]
ds_read_b64_tr_b16 a[168:169], v12 offset:49152
ds_read_b64_tr_b16 a[170:171], v12 offset:49664
v_mfma_f32_16x16x32_bf16 v[92:95], a[92:95], a[156:159], v[92:95]
v_mfma_f32_16x16x32_bf16 v[84:87], a[92:95], a[148:151], v[84:87]
v_mfma_f32_16x16x32_bf16 v[84:87], a[88:91], a[144:147], v[84:87]
v_mfma_f32_16x16x32_bf16 v[76:79], a[88:91], a[136:139], v[76:79]
buffer_load_dwordx4 v6, s[8:11], s64 offen offset:1024 lds
v_mfma_f32_16x16x32_bf16 v[76:79], a[92:95], a[140:143], v[76:79]
ds_read_b128 a[116:119], v10 offset:12288
v_mfma_f32_16x16x32_bf16 v[68:71], a[92:95], a[132:135], v[68:71]
v_mfma_f32_16x16x32_bf16 v[68:71], a[88:91], a[128:131], v[68:71]
s_add_u32 m0, s73, 2048
s_add_u32 s64, s71, 16384
s_waitcnt lgkmcnt(6)
v_mfma_f32_16x16x32_bf16 v[96:99], a[96:99], a[128:131], v[96:99]
ds_read_b64_tr_b16 a[172:173], v12 offset:57344
ds_read_b64_tr_b16 a[174:175], v12 offset:57856
v_mfma_f32_16x16x32_bf16 v[96:99], a[100:103], a[132:135], v[96:99]
buffer_load_dwordx4 v5, s[8:11], s64 offen lds
v_mfma_f32_16x16x32_bf16 v[104:107], a[100:103], a[140:143], v[104:107]
ds_read_b128 a[120:123], v9 offset:14336
v_mfma_f32_16x16x32_bf16 v[104:107], a[96:99], a[136:139], v[104:107]
v_mfma_f32_16x16x32_bf16 v[112:115], a[96:99], a[144:147], v[112:115]
v_mfma_f32_16x16x32_bf16 v[112:115], a[100:103], a[148:151], v[112:115]
buffer_load_dwordx4 v6, s[8:11], s64 offen offset:1024 lds
v_mfma_f32_16x16x32_bf16 v[120:123], a[100:103], a[156:159], v[120:123]
s_xor_b32 s76, s75, 1572864
s_add_u32 s76, s74, s76
v_mfma_f32_16x16x32_bf16 v[120:123], a[96:99], a[152:155], v[120:123]
ds_read_b64_tr_b16 a[176:177], v13 offset:49152
ds_read_b64_tr_b16 a[178:179], v13 offset:49664
v_mfma_f32_16x16x32_bf16 v[124:127], a[104:107], a[152:155], v[124:127]
s_add_u32 m0, s77, 32768
s_add_u32 s64, s76, 0
v_mfma_f32_16x16x32_bf16 v[124:127], a[108:111], a[156:159], v[124:127]
ds_read_b128 a[124:127], v10 offset:14336
v_mfma_f32_16x16x32_bf16 v[116:119], a[108:111], a[148:151], v[116:119]
buffer_load_dwordx4 v7, s[56:59], s64 offen lds
v_mfma_f32_16x16x32_bf16 v[116:119], a[104:107], a[144:147], v[116:119]
s_waitcnt vmcnt(14)
v_add_u32 v9, 32768, v9
v_add_u32 v10, 32768, v10
v_mfma_f32_16x16x32_bf16 v[108:111], a[104:107], a[136:139], v[108:111]
ds_read_b64_tr_b16 a[180:181], v13 offset:57344
ds_read_b64_tr_b16 a[182:183], v13 offset:57856
v_mfma_f32_16x16x32_bf16 v[108:111], a[108:111], a[140:143], v[108:111]
buffer_store_dword v1, v0, s[40:43], s52 offen sc1
v_mfma_f32_16x16x32_bf16 v[100:103], a[108:111], a[132:135], v[100:103]
s_waitcnt lgkmcnt(2)
s_lshl2_add_u32 s55, s95, s3
s_lshl3_add_u32 s54, s55, s7
v_mfma_f32_16x16x32_bf16 v[100:103], a[104:107], a[128:131], v[100:103]
buffer_load_dwordx4 v8, s[56:59], s64 offen offset:1024 lds
v_mfma_f32_16x16x32_bf16 v[128:131], a[112:115], a[128:131], v[128:131]
s_mul_i32 s53, s54, 3072
ds_read_b64_tr_b16 a[184:185], v14 offset:49152
ds_read_b64_tr_b16 a[186:187], v14 offset:49664
v_mfma_f32_16x16x32_bf16 v[128:131], a[116:119], a[132:135], v[128:131]
s_mul_i32 s55, s55, 48
s_add_u32 s55, s55, s7
s_lshl_b32 s55, s55, 10
v_mfma_f32_16x16x32_bf16 v[136:139], a[116:119], a[140:143], v[136:139]
s_add_u32 m0, s77, 34816
s_add_u32 s64, s76, 131072
v_min_u32 v20, 23, v1
v_mfma_f32_16x16x32_bf16 v[136:139], a[112:115], a[136:139], v[136:139]
ds_read_b64_tr_b16 a[188:189], v14 offset:57344
ds_read_b64_tr_b16 a[190:191], v14 offset:57856
v_mfma_f32_16x16x32_bf16 v[144:147], a[112:115], a[144:147], v[144:147]
buffer_load_dwordx4 v7, s[56:59], s64 offen lds
v_mfma_f32_16x16x32_bf16 v[144:147], a[116:119], a[148:151], v[144:147]
v_lshrrev_b32 v21, 3, v20
v_mul_u32_u24 v21, 7168, v21
v_mfma_f32_16x16x32_bf16 v[152:155], a[116:119], a[156:159], v[152:155]
v_lshlrev_b32 v20, 7, v20
v_add_u32 v21, v21, v20
v_mfma_f32_16x16x32_bf16 v[152:155], a[112:115], a[152:155], v[152:155]
v_mfma_f32_16x16x32_bf16 v[156:159], a[120:123], a[152:155], v[156:159]
v_mfma_f32_16x16x32_bf16 v[156:159], a[124:127], a[156:159], v[156:159]
buffer_load_dwordx4 v8, s[56:59], s64 offen offset:1024 lds
v_mfma_f32_16x16x32_bf16 v[148:151], a[124:127], a[148:151], v[148:151]
v_mfma_f32_16x16x32_bf16 v[148:151], a[120:123], a[144:147], v[148:151]
v_mfma_f32_16x16x32_bf16 v[140:143], a[120:123], a[136:139], v[140:143]
v_mfma_f32_16x16x32_bf16 v[140:143], a[124:127], a[140:143], v[140:143]
v_mfma_f32_16x16x32_bf16 v[132:135], a[124:127], a[132:135], v[132:135]
v_mfma_f32_16x16x32_bf16 v[132:135], a[120:123], a[128:131], v[132:135]
s_waitcnt lgkmcnt(0)
v_mfma_f32_16x16x32_bf16 v[160:163], a[160:163], a[64:67], v[160:163]
s_waitcnt vmcnt(13)
v_mfma_f32_16x16x32_bf16 v[160:163], a[164:167], a[68:71], v[160:163]
s_barrier
v_mfma_f32_16x16x32_bf16 v[164:167], a[172:175], a[68:71], v[164:167]
ds_read_b64_tr_b16 a[128:129], v11 offset:0
ds_read_b64_tr_b16 a[130:131], v11 offset:512
v_mfma_f32_16x16x32_bf16 v[164:167], a[168:171], a[64:67], v[164:167]
s_add_u32 m0, s73, 4096
s_add_u32 s64, s71, 524288
v_mfma_f32_16x16x32_bf16 v[168:171], a[176:179], a[64:67], v[168:171]
buffer_load_dwordx4 v5, s[8:11], s64 offen lds
v_mfma_f32_16x16x32_bf16 v[168:171], a[180:183], a[68:71], v[168:171]
v_mfma_f32_16x16x32_bf16 v[172:175], a[188:191], a[68:71], v[172:175]
v_mfma_f32_16x16x32_bf16 v[172:175], a[184:187], a[64:67], v[172:175]
ds_read_b128 a[64:67], v9 offset:0
v_mfma_f32_16x16x32_bf16 v[188:191], a[184:187], a[72:75], v[188:191]
buffer_load_dwordx4 v6, s[8:11], s64 offen offset:1024 lds
v_mfma_f32_16x16x32_bf16 v[188:191], a[188:191], a[76:79], v[188:191]
ds_read_b64_tr_b16 a[132:133], v11 offset:8192
ds_read_b64_tr_b16 a[134:135], v11 offset:8704
v_mfma_f32_16x16x32_bf16 v[184:187], a[180:183], a[76:79], v[184:187]
v_mfma_f32_16x16x32_bf16 v[184:187], a[176:179], a[72:75], v[184:187]
s_add_u32 m0, s73, 6144
s_add_u32 s64, s71, 540672
ds_read_b128 a[68:71], v10 offset:0
v_mfma_f32_16x16x32_bf16 v[180:183], a[168:171], a[72:75], v[180:183]
v_mfma_f32_16x16x32_bf16 v[180:183], a[172:175], a[76:79], v[180:183]
buffer_load_dwordx4 v5, s[8:11], s64 offen lds
v_mfma_f32_16x16x32_bf16 v[176:179], a[164:167], a[76:79], v[176:179]
v_mfma_f32_16x16x32_bf16 v[176:179], a[160:163], a[72:75], v[176:179]
ds_read_b64_tr_b16 a[136:137], v12 offset:0
ds_read_b64_tr_b16 a[138:139], v12 offset:512
v_mfma_f32_16x16x32_bf16 v[192:195], a[160:163], a[80:83], v[192:195]
v_mfma_f32_16x16x32_bf16 v[192:195], a[164:167], a[84:87], v[192:195]
v_mfma_f32_16x16x32_bf16 v[196:199], a[172:175], a[84:87], v[196:199]
buffer_load_dwordx4 v6, s[8:11], s64 offen offset:1024 lds
v_mfma_f32_16x16x32_bf16 v[196:199], a[168:171], a[80:83], v[196:199]
ds_read_b128 a[72:75], v9 offset:2048
v_mfma_f32_16x16x32_bf16 v[200:203], a[176:179], a[80:83], v[200:203]
v_mfma_f32_16x16x32_bf16 v[200:203], a[180:183], a[84:87], v[200:203]
s_add_u32 m0, s77, 49152
s_add_u32 s64, s76, 0
v_mfma_f32_16x16x32_bf16 v[204:207], a[188:191], a[84:87], v[204:207]
ds_read_b64_tr_b16 a[140:141], v12 offset:8192
ds_read_b64_tr_b16 a[142:143], v12 offset:8704
v_mfma_f32_16x16x32_bf16 v[204:207], a[184:187], a[80:83], v[204:207]
buffer_load_dwordx4 v7, s[16:19], s64 offen lds
v_mfma_f32_16x16x32_bf16 v[220:223], a[184:187], a[88:91], v[220:223]
ds_read_b128 a[76:79], v10 offset:2048
v_mfma_f32_16x16x32_bf16 v[220:223], a[188:191], a[92:95], v[220:223]
v_mfma_f32_16x16x32_bf16 v[216:219], a[180:183], a[92:95], v[216:219]
v_mfma_f32_16x16x32_bf16 v[216:219], a[176:179], a[88:91], v[216:219]
v_mfma_f32_16x16x32_bf16 v[212:215], a[168:171], a[88:91], v[212:215]
buffer_load_dwordx4 v8, s[16:19], s64 offen offset:1024 lds
v_mfma_f32_16x16x32_bf16 v[212:215], a[172:175], a[92:95], v[212:215]
ds_read_b64_tr_b16 a[144:145], v13 offset:0
ds_read_b64_tr_b16 a[146:147], v13 offset:512
v_mfma_f32_16x16x32_bf16 v[208:211], a[164:167], a[92:95], v[208:211]
v_mfma_f32_16x16x32_bf16 v[208:211], a[160:163], a[88:91], v[208:211]
s_add_u32 m0, s77, 51200
s_add_u32 s64, s76, 131072
ds_read_b128 a[80:83], v9 offset:4096
v_mfma_f32_16x16x32_bf16 v[224:227], a[160:163], a[96:99], v[224:227]
v_mfma_f32_16x16x32_bf16 v[224:227], a[164:167], a[100:103], v[224:227]
buffer_load_dwordx4 v7, s[16:19], s64 offen lds
v_mfma_f32_16x16x32_bf16 v[228:231], a[172:175], a[100:103], v[228:231]
ds_read_b64_tr_b16 a[148:149], v13 offset:8192
ds_read_b64_tr_b16 a[150:151], v13 offset:8704
v_mfma_f32_16x16x32_bf16 v[228:231], a[168:171], a[96:99], v[228:231]
v_mfma_f32_16x16x32_bf16 v[232:235], a[176:179], a[96:99], v[232:235]
v_mfma_f32_16x16x32_bf16 v[232:235], a[180:183], a[100:103], v[232:235]
buffer_load_dwordx4 v8, s[16:19], s64 offen offset:1024 lds
v_mfma_f32_16x16x32_bf16 v[236:239], a[188:191], a[100:103], v[236:239]
s_xor_b32 s71, s70, 512
s_add_u32 s71, s68, s71
ds_read_b128 a[84:87], v10 offset:4096
v_mfma_f32_16x16x32_bf16 v[236:239], a[184:187], a[96:99], v[236:239]
v_mfma_f32_16x16x32_bf16 v[252:255], a[184:187], a[104:107], v[252:255]
s_add_u32 m0, s73, 32768
s_add_u32 s64, s71, 0
v_mfma_f32_16x16x32_bf16 v[252:255], a[188:191], a[108:111], v[252:255]
ds_read_b64_tr_b16 a[152:153], v14 offset:0
ds_read_b64_tr_b16 a[154:155], v14 offset:512
v_mfma_f32_16x16x32_bf16 v[248:251], a[180:183], a[108:111], v[248:251]
buffer_load_dwordx4 v5, s[8:11], s64 offen lds
v_mfma_f32_16x16x32_bf16 v[248:251], a[176:179], a[104:107], v[248:251]
v_mfma_f32_16x16x32_bf16 v[244:247], a[168:171], a[104:107], v[244:247]
ds_read_b128 a[88:91], v9 offset:6144
v_mfma_f32_16x16x32_bf16 v[244:247], a[172:175], a[108:111], v[244:247]
v_mfma_f32_16x16x32_bf16 v[240:243], a[164:167], a[108:111], v[240:243]
v_mfma_f32_16x16x32_bf16 v[240:243], a[160:163], a[104:107], v[240:243]
buffer_load_dwordx4 v6, s[8:11], s64 offen offset:1024 lds
v_mfma_f32_16x16x32_bf16 a[0:3], a[160:163], a[112:115], a[0:3]
ds_read_b64_tr_b16 a[156:157], v14 offset:8192
ds_read_b64_tr_b16 a[158:159], v14 offset:8704
v_mfma_f32_16x16x32_bf16 a[0:3], a[164:167], a[116:119], a[0:3]
v_mfma_f32_16x16x32_bf16 a[4:7], a[172:175], a[116:119], a[4:7]
s_add_u32 m0, s73, 34816
s_add_u32 s64, s71, 16384
ds_read_b128 a[92:95], v10 offset:6144
v_mfma_f32_16x16x32_bf16 a[4:7], a[168:171], a[112:115], a[4:7]
v_mfma_f32_16x16x32_bf16 a[8:11], a[176:179], a[112:115], a[8:11]
buffer_load_dwordx4 v5, s[8:11], s64 offen lds
v_mfma_f32_16x16x32_bf16 a[8:11], a[180:183], a[116:119], a[8:11]
v_mfma_f32_16x16x32_bf16 a[12:15], a[188:191], a[116:119], a[12:15]
v_mfma_f32_16x16x32_bf16 a[12:15], a[184:187], a[112:115], a[12:15]
v_mfma_f32_16x16x32_bf16 a[28:31], a[184:187], a[120:123], a[28:31]
v_mfma_f32_16x16x32_bf16 a[28:31], a[188:191], a[124:127], a[28:31]
buffer_load_dwordx4 v6, s[8:11], s64 offen offset:1024 lds
v_mfma_f32_16x16x32_bf16 a[24:27], a[180:183], a[124:127], a[24:27]
v_mfma_f32_16x16x32_bf16 a[24:27], a[176:179], a[120:123], a[24:27]
v_mfma_f32_16x16x32_bf16 a[20:23], a[168:171], a[120:123], a[20:23]
v_mfma_f32_16x16x32_bf16 a[20:23], a[172:175], a[124:127], a[20:23]
v_mfma_f32_16x16x32_bf16 a[16:19], a[164:167], a[124:127], a[16:19]
v_mfma_f32_16x16x32_bf16 a[16:19], a[160:163], a[120:123], a[16:19]
s_waitcnt lgkmcnt(0)
v_mfma_f32_16x16x32_bf16 v[32:35], a[64:67], a[128:131], v[32:35]
s_waitcnt vmcnt(21)
v_mfma_f32_16x16x32_bf16 v[32:35], a[68:71], a[132:135], v[32:35]
s_barrier
v_mfma_f32_16x16x32_bf16 v[40:43], a[68:71], a[140:143], v[40:43]
s_add_u32 s52, s81, 0
ds_read_b128 a[96:99], v9 offset:8192
v_mfma_f32_16x16x32_bf16 v[40:43], a[64:67], a[136:139], v[40:43]
s_xor_b32 s76, s75, 2097152
s_add_u32 s76, s74, s76
v_mfma_f32_16x16x32_bf16 v[48:51], a[64:67], a[144:147], v[48:51]
s_add_u32 m0, s77, 0
s_add_u32 s64, s76, 0
v_mfma_f32_16x16x32_bf16 v[48:51], a[68:71], a[148:151], v[48:51]
buffer_load_dwordx4 v7, s[56:59], s64 offen lds
v_mfma_f32_16x16x32_bf16 v[56:59], a[68:71], a[156:159], v[56:59]
ds_read_b128 a[100:103], v10 offset:8192
v_mfma_f32_16x16x32_bf16 v[56:59], a[64:67], a[152:155], v[56:59]
buffer_load_dwordx2 a[192:193], v26, s[28:31], s52 offen
v_mfma_f32_16x16x32_bf16 v[60:63], a[72:75], a[152:155], v[60:63]
ds_read_b128 a[104:107], v9 offset:10240
v_mfma_f32_16x16x32_bf16 v[60:63], a[76:79], a[156:159], v[60:63]
v_mfma_f32_16x16x32_bf16 v[52:55], a[76:79], a[148:151], v[52:55]
s_add_u32 s52, s81, 3456
v_mfma_f32_16x16x32_bf16 v[52:55], a[72:75], a[144:147], v[52:55]
buffer_load_dwordx4 v8, s[56:59], s64 offen offset:1024 lds
v_mfma_f32_16x16x32_bf16 v[44:47], a[72:75], a[136:139], v[44:47]
ds_read_b64_tr_b16 a[160:161], v11 offset:16384
ds_read_b64_tr_b16 a[162:163], v11 offset:16896
v_mfma_f32_16x16x32_bf16 v[44:47], a[76:79], a[140:143], v[44:47]
buffer_load_dwordx2 a[194:195], v26, s[28:31], s52 offen
v_mfma_f32_16x16x32_bf16 v[36:39], a[76:79], a[132:135], v[36:39]
v_mfma_f32_16x16x32_bf16 v[36:39], a[72:75], a[128:131], v[36:39]
ds_read_b128 a[108:111], v10 offset:10240
v_mfma_f32_16x16x32_bf16 v[64:67], a[80:83], a[128:131], v[64:67]
s_add_u32 m0, s77, 2048
s_add_u32 s64, s76, 131072
s_add_u32 s52, s81, 6912
v_mfma_f32_16x16x32_bf16 v[64:67], a[84:87], a[132:135], v[64:67]
buffer_load_dwordx2 a[196:197], v26, s[28:31], s52 offen
v_mfma_f32_16x16x32_bf16 v[72:75], a[84:87], a[140:143], v[72:75]
buffer_load_dwordx4 v7, s[56:59], s64 offen lds
v_mfma_f32_16x16x32_bf16 v[72:75], a[80:83], a[136:139], v[72:75]
ds_read_b64_tr_b16 a[164:165], v11 offset:24576
ds_read_b64_tr_b16 a[166:167], v11 offset:25088
v_mfma_f32_16x16x32_bf16 v[80:83], a[80:83], a[144:147], v[80:83]
s_add_u32 s52, s81, 10368
v_mfma_f32_16x16x32_bf16 v[80:83], a[84:87], a[148:151], v[80:83]
ds_read_b128 a[112:115], v9 offset:12288
v_mfma_f32_16x16x32_bf16 v[88:91], a[84:87], a[156:159], v[88:91]
buffer_load_dwordx2 a[198:199], v26, s[28:31], s52 offen
v_mfma_f32_16x16x32_bf16 v[88:91], a[80:83], a[152:155], v[88:91]
v_mfma_f32_16x16x32_bf16 v[92:95], a[88:91], a[152:155], v[92:95]
ds_read_b64_tr_b16 a[168:169], v12 offset:16384
ds_read_b64_tr_b16 a[170:171], v12 offset:16896
v_mfma_f32_16x16x32_bf16 v[92:95], a[92:95], a[156:159], v[92:95]
buffer_load_dwordx4 v8, s[56:59], s64 offen offset:1024 lds
v_mfma_f32_16x16x32_bf16 v[84:87], a[92:95], a[148:151], v[84:87]
s_add_u32 s52, s81, 13824
v_mfma_f32_16x16x32_bf16 v[84:87], a[88:91], a[144:147], v[84:87]
buffer_load_dwordx2 a[200:201], v26, s[28:31], s52 offen
v_mfma_f32_16x16x32_bf16 v[76:79], a[88:91], a[136:139], v[76:79]
ds_read_b128 a[116:119], v10 offset:12288
v_mfma_f32_16x16x32_bf16 v[76:79], a[92:95], a[140:143], v[76:79]
v_mfma_f32_16x16x32_bf16 v[68:71], a[92:95], a[132:135], v[68:71]
s_add_u32 s52, s81, 17280
v_mfma_f32_16x16x32_bf16 v[68:71], a[88:91], a[128:131], v[68:71]
s_add_u32 m0, s73, 36864
s_add_u32 s64, s71, 524288
s_waitcnt lgkmcnt(6)
v_mfma_f32_16x16x32_bf16 v[96:99], a[96:99], a[128:131], v[96:99]
ds_read_b64_tr_b16 a[172:173], v12 offset:24576
ds_read_b64_tr_b16 a[174:175], v12 offset:25088
v_mfma_f32_16x16x32_bf16 v[96:99], a[100:103], a[132:135], v[96:99]
buffer_load_dwordx4 v5, s[8:11], s64 offen lds
v_mfma_f32_16x16x32_bf16 v[104:107], a[100:103], a[140:143], v[104:107]
ds_read_b128 a[120:123], v9 offset:14336
v_mfma_f32_16x16x32_bf16 v[104:107], a[96:99], a[136:139], v[104:107]
buffer_load_dwordx2 a[202:203], v26, s[28:31], s52 offen
v_mfma_f32_16x16x32_bf16 v[112:115], a[96:99], a[144:147], v[112:115]
v_mfma_f32_16x16x32_bf16 v[112:115], a[100:103], a[148:151], v[112:115]
ds_read_b64_tr_b16 a[176:177], v13 offset:16384
ds_read_b64_tr_b16 a[178:179], v13 offset:16896
v_mfma_f32_16x16x32_bf16 v[120:123], a[100:103], a[156:159], v[120:123]
s_add_u32 s52, s81, 20736
v_mfma_f32_16x16x32_bf16 v[120:123], a[96:99], a[152:155], v[120:123]
buffer_load_dwordx2 a[204:205], v26, s[28:31], s52 offen
v_mfma_f32_16x16x32_bf16 v[124:127], a[104:107], a[152:155], v[124:127]
buffer_load_dwordx4 v6, s[8:11], s64 offen offset:1024 lds
v_mfma_f32_16x16x32_bf16 v[124:127], a[108:111], a[156:159], v[124:127]
ds_read_b128 a[124:127], v10 offset:14336
v_mfma_f32_16x16x32_bf16 v[116:119], a[108:111], a[148:151], v[116:119]
s_add_u32 s52, s81, 24192
v_add_u32 v9, -65536, v9
v_add_u32 v10, -65536, v10
v_mfma_f32_16x16x32_bf16 v[116:119], a[104:107], a[144:147], v[116:119]
buffer_load_dwordx2 a[206:207], v26, s[28:31], s52 offen
v_mfma_f32_16x16x32_bf16 v[108:111], a[104:107], a[136:139], v[108:111]
ds_read_b64_tr_b16 a[180:181], v13 offset:24576
ds_read_b64_tr_b16 a[182:183], v13 offset:25088
v_mfma_f32_16x16x32_bf16 v[108:111], a[108:111], a[140:143], v[108:111]
s_add_u32 m0, s73, 38912
s_add_u32 s64, s71, 540672
v_mfma_f32_16x16x32_bf16 v[100:103], a[108:111], a[132:135], v[100:103]
s_waitcnt lgkmcnt(2)
v_mfma_f32_16x16x32_bf16 v[100:103], a[104:107], a[128:131], v[100:103]
buffer_load_dwordx4 v5, s[8:11], s64 offen lds
v_mfma_f32_16x16x32_bf16 v[128:131], a[112:115], a[128:131], v[128:131]
ds_read_b64_tr_b16 a[184:185], v14 offset:16384
ds_read_b64_tr_b16 a[186:187], v14 offset:16896
v_mfma_f32_16x16x32_bf16 v[128:131], a[116:119], a[132:135], v[128:131]
buffer_load_dwordx4 a[208:211], v27, s[36:39], s83 offen
v_mfma_f32_16x16x32_bf16 v[136:139], a[116:119], a[140:143], v[136:139]
ds_read_b64_tr_b16 a[188:189], v14 offset:24576
ds_read_b64_tr_b16 a[190:191], v14 offset:25088
v_mfma_f32_16x16x32_bf16 v[136:139], a[112:115], a[136:139], v[136:139]
v_mfma_f32_16x16x32_bf16 v[144:147], a[112:115], a[144:147], v[144:147]
v_mfma_f32_16x16x32_bf16 v[144:147], a[116:119], a[148:151], v[144:147]
v_mfma_f32_16x16x32_bf16 v[152:155], a[116:119], a[156:159], v[152:155]
buffer_load_dwordx4 v6, s[8:11], s64 offen offset:1024 lds
v_mfma_f32_16x16x32_bf16 v[152:155], a[112:115], a[152:155], v[152:155]
v_mfma_f32_16x16x32_bf16 v[156:159], a[120:123], a[152:155], v[156:159]
v_mfma_f32_16x16x32_bf16 v[156:159], a[124:127], a[156:159], v[156:159]
v_mfma_f32_16x16x32_bf16 v[148:151], a[124:127], a[148:151], v[148:151]
v_mfma_f32_16x16x32_bf16 v[148:151], a[120:123], a[144:147], v[148:151]
v_mfma_f32_16x16x32_bf16 v[140:143], a[120:123], a[136:139], v[140:143]
v_mfma_f32_16x16x32_bf16 v[140:143], a[124:127], a[140:143], v[140:143]
v_mfma_f32_16x16x32_bf16 v[132:135], a[124:127], a[132:135], v[132:135]
v_mfma_f32_16x16x32_bf16 v[132:135], a[120:123], a[128:131], v[132:135]
s_waitcnt lgkmcnt(0)
v_mfma_f32_16x16x32_bf16 v[160:163], a[160:163], a[64:67], v[160:163]
s_waitcnt vmcnt(25)
v_mfma_f32_16x16x32_bf16 v[160:163], a[164:167], a[68:71], v[160:163]
s_barrier
v_mfma_f32_16x16x32_bf16 v[164:167], a[172:175], a[68:71], v[164:167]
ds_read_b64_tr_b16 a[128:129], v11 offset:32768
ds_read_b64_tr_b16 a[130:131], v11 offset:33280
v_mfma_f32_16x16x32_bf16 v[164:167], a[168:171], a[64:67], v[164:167]
s_add_u32 m0, s77, 16384
s_add_u32 s64, s76, 0
v_mfma_f32_16x16x32_bf16 v[168:171], a[176:179], a[64:67], v[168:171]
buffer_load_dwordx4 v7, s[16:19], s64 offen lds
v_mfma_f32_16x16x32_bf16 v[168:171], a[180:183], a[68:71], v[168:171]
L_PAD1:
s_cbranch_execz L_PAD5
v_mfma_f32_16x16x32_bf16 v[172:175], a[188:191], a[68:71], v[172:175]
v_mfma_f32_16x16x32_bf16 v[172:175], a[184:187], a[64:67], v[172:175]
ds_read_b128 a[64:67], v9 offset:0
v_mfma_f32_16x16x32_bf16 v[188:191], a[184:187], a[72:75], v[188:191]
ds_read_b64_tr_b16 a[132:133], v11 offset:40960
ds_read_b64_tr_b16 a[134:135], v11 offset:41472
v_mfma_f32_16x16x32_bf16 v[188:191], a[188:191], a[76:79], v[188:191]
v_mfma_f32_16x16x32_bf16 v[184:187], a[180:183], a[76:79], v[184:187]
v_mfma_f32_16x16x32_bf16 v[184:187], a[176:179], a[72:75], v[184:187]
buffer_load_dwordx4 v8, s[16:19], s64 offen offset:1024 lds
v_mfma_f32_16x16x32_bf16 v[180:183], a[168:171], a[72:75], v[180:183]
ds_read_b128 a[68:71], v10 offset:0
v_mfma_f32_16x16x32_bf16 v[180:183], a[172:175], a[76:79], v[180:183]
v_mfma_f32_16x16x32_bf16 v[176:179], a[164:167], a[76:79], v[176:179]
v_mfma_f32_16x16x32_bf16 v[176:179], a[160:163], a[72:75], v[176:179]
ds_read_b64_tr_b16 a[136:137], v12 offset:32768
ds_read_b64_tr_b16 a[138:139], v12 offset:33280
v_mfma_f32_16x16x32_bf16 v[192:195], a[160:163], a[80:83], v[192:195]
s_add_u32 m0, s77, 18432
s_add_u32 s64, s76, 131072
v_mfma_f32_16x16x32_bf16 v[192:195], a[164:167], a[84:87], v[192:195]
v_mfma_f32_16x16x32_bf16 v[196:199], a[172:175], a[84:87], v[196:199]
buffer_load_dwordx4 v7, s[16:19], s64 offen lds
v_mfma_f32_16x16x32_bf16 v[196:199], a[168:171], a[80:83], v[196:199]
ds_read_b128 a[72:75], v9 offset:2048
v_mfma_f32_16x16x32_bf16 v[200:203], a[176:179], a[80:83], v[200:203]
v_mfma_f32_16x16x32_bf16 v[200:203], a[180:183], a[84:87], v[200:203]
ds_read_b64_tr_b16 a[140:141], v12 offset:40960
ds_read_b64_tr_b16 a[142:143], v12 offset:41472
v_mfma_f32_16x16x32_bf16 v[204:207], a[188:191], a[84:87], v[204:207]
v_mfma_f32_16x16x32_bf16 v[204:207], a[184:187], a[80:83], v[204:207]
v_mfma_f32_16x16x32_bf16 v[220:223], a[184:187], a[88:91], v[220:223]
ds_read_b128 a[76:79], v10 offset:2048
v_mfma_f32_16x16x32_bf16 v[220:223], a[188:191], a[92:95], v[220:223]
buffer_load_dwordx4 v8, s[16:19], s64 offen offset:1024 lds
v_mfma_f32_16x16x32_bf16 v[216:219], a[180:183], a[92:95], v[216:219]
s_xor_b32 s71, s70, 640
s_add_u32 s71, s68, s71
v_mfma_f32_16x16x32_bf16 v[216:219], a[176:179], a[88:91], v[216:219]
v_mfma_f32_16x16x32_bf16 v[212:215], a[168:171], a[88:91], v[212:215]
ds_read_b64_tr_b16 a[144:145], v13 offset:32768
ds_read_b64_tr_b16 a[146:147], v13 offset:33280
v_mfma_f32_16x16x32_bf16 v[212:215], a[172:175], a[92:95], v[212:215]
v_mfma_f32_16x16x32_bf16 v[208:211], a[164:167], a[92:95], v[208:211]
v_mfma_f32_16x16x32_bf16 v[208:211], a[160:163], a[88:91], v[208:211]
s_add_u32 m0, s73, 65536
s_add_u32 s64, s71, 0
ds_read_b128 a[80:83], v9 offset:4096
v_mfma_f32_16x16x32_bf16 v[224:227], a[160:163], a[96:99], v[224:227]
v_mfma_f32_16x16x32_bf16 v[224:227], a[164:167], a[100:103], v[224:227]
buffer_load_dwordx4 v5, s[8:11], s64 offen lds
v_mfma_f32_16x16x32_bf16 v[228:231], a[172:175], a[100:103], v[228:231]
ds_read_b64_tr_b16 a[148:149], v13 offset:40960
ds_read_b64_tr_b16 a[150:151], v13 offset:41472
v_mfma_f32_16x16x32_bf16 v[228:231], a[168:171], a[96:99], v[228:231]
v_mfma_f32_16x16x32_bf16 v[232:235], a[176:179], a[96:99], v[232:235]
v_mfma_f32_16x16x32_bf16 v[232:235], a[180:183], a[100:103], v[232:235]
ds_read_b128 a[84:87], v10 offset:4096
v_mfma_f32_16x16x32_bf16 v[236:239], a[188:191], a[100:103], v[236:239]
v_mfma_f32_16x16x32_bf16 v[236:239], a[184:187], a[96:99], v[236:239]
v_mfma_f32_16x16x32_bf16 v[252:255], a[184:187], a[104:107], v[252:255]
buffer_load_dwordx4 v6, s[8:11], s64 offen offset:1024 lds
v_mfma_f32_16x16x32_bf16 v[252:255], a[188:191], a[108:111], v[252:255]
ds_read_b64_tr_b16 a[152:153], v14 offset:32768
ds_read_b64_tr_b16 a[154:155], v14 offset:33280
v_mfma_f32_16x16x32_bf16 v[248:251], a[180:183], a[108:111], v[248:251]
v_mfma_f32_16x16x32_bf16 v[248:251], a[176:179], a[104:107], v[248:251]
v_mfma_f32_16x16x32_bf16 v[244:247], a[168:171], a[104:107], v[244:247]
ds_read_b128 a[88:91], v9 offset:6144
v_mfma_f32_16x16x32_bf16 v[244:247], a[172:175], a[108:111], v[244:247]
s_add_u32 m0, s73, 67584
s_add_u32 s64, s71, 16384
v_mfma_f32_16x16x32_bf16 v[240:243], a[164:167], a[108:111], v[240:243]
v_mfma_f32_16x16x32_bf16 v[240:243], a[160:163], a[104:107], v[240:243]
buffer_load_dwordx4 v5, s[8:11], s64 offen lds
v_mfma_f32_16x16x32_bf16 a[0:3], a[160:163], a[112:115], a[0:3]
ds_read_b64_tr_b16 a[156:157], v14 offset:40960
ds_read_b64_tr_b16 a[158:159], v14 offset:41472
v_mfma_f32_16x16x32_bf16 a[0:3], a[164:167], a[116:119], a[0:3]
v_mfma_f32_16x16x32_bf16 a[4:7], a[172:175], a[116:119], a[4:7]
ds_read_b128 a[92:95], v10 offset:6144
v_mfma_f32_16x16x32_bf16 a[4:7], a[168:171], a[112:115], a[4:7]
v_mfma_f32_16x16x32_bf16 a[8:11], a[176:179], a[112:115], a[8:11]
v_mfma_f32_16x16x32_bf16 a[8:11], a[180:183], a[116:119], a[8:11]
v_mfma_f32_16x16x32_bf16 a[12:15], a[188:191], a[116:119], a[12:15]
buffer_load_dwordx4 v6, s[8:11], s64 offen offset:1024 lds
v_mfma_f32_16x16x32_bf16 a[12:15], a[184:187], a[112:115], a[12:15]
v_mfma_f32_16x16x32_bf16 a[28:31], a[184:187], a[120:123], a[28:31]
v_mfma_f32_16x16x32_bf16 a[28:31], a[188:191], a[124:127], a[28:31]
v_mfma_f32_16x16x32_bf16 a[24:27], a[180:183], a[124:127], a[24:27]
v_mfma_f32_16x16x32_bf16 a[24:27], a[176:179], a[120:123], a[24:27]
v_mfma_f32_16x16x32_bf16 a[20:23], a[168:171], a[120:123], a[20:23]
v_mfma_f32_16x16x32_bf16 a[20:23], a[172:175], a[124:127], a[20:23]
v_mfma_f32_16x16x32_bf16 a[16:19], a[164:167], a[124:127], a[16:19]
v_mfma_f32_16x16x32_bf16 a[16:19], a[160:163], a[120:123], a[16:19]
s_waitcnt lgkmcnt(0)
v_mfma_f32_16x16x32_bf16 v[32:35], a[64:67], a[128:131], v[32:35]
s_waitcnt vmcnt(29)
v_mfma_f32_16x16x32_bf16 v[32:35], a[68:71], a[132:135], v[32:35]
s_barrier
v_mfma_f32_16x16x32_bf16 v[40:43], a[68:71], a[140:143], v[40:43]
ds_read_b128 a[96:99], v9 offset:8192
v_mfma_f32_16x16x32_bf16 v[40:43], a[64:67], a[136:139], v[40:43]
s_xor_b32 s76, s75, 2621440
s_add_u32 s76, s74, s76
v_mfma_f32_16x16x32_bf16 v[48:51], a[64:67], a[144:147], v[48:51]
s_add_u32 m0, s77, 32768
s_add_u32 s64, s76, 0
v_mfma_f32_16x16x32_bf16 v[48:51], a[68:71], a[148:151], v[48:51]
buffer_load_dwordx4 v7, s[56:59], s64 offen lds
v_mfma_f32_16x16x32_bf16 v[56:59], a[68:71], a[156:159], v[56:59]
ds_read_b128 a[100:103], v10 offset:8192
v_mfma_f32_16x16x32_bf16 v[56:59], a[64:67], a[152:155], v[56:59]
v_mfma_f32_16x16x32_bf16 v[60:63], a[72:75], a[152:155], v[60:63]
ds_read_b128 a[104:107], v9 offset:10240
v_mfma_f32_16x16x32_bf16 v[60:63], a[76:79], a[156:159], v[60:63]
v_mfma_f32_16x16x32_bf16 v[52:55], a[76:79], a[148:151], v[52:55]
v_mfma_f32_16x16x32_bf16 v[52:55], a[72:75], a[144:147], v[52:55]
buffer_load_dwordx4 v8, s[56:59], s64 offen offset:1024 lds
v_mfma_f32_16x16x32_bf16 v[44:47], a[72:75], a[136:139], v[44:47]
ds_read_b64_tr_b16 a[160:161], v11 offset:49152
ds_read_b64_tr_b16 a[162:163], v11 offset:49664
v_mfma_f32_16x16x32_bf16 v[44:47], a[76:79], a[140:143], v[44:47]
v_mfma_f32_16x16x32_bf16 v[36:39], a[76:79], a[132:135], v[36:39]
v_mfma_f32_16x16x32_bf16 v[36:39], a[72:75], a[128:131], v[36:39]
ds_read_b128 a[108:111], v10 offset:10240
v_mfma_f32_16x16x32_bf16 v[64:67], a[80:83], a[128:131], v[64:67]
s_add_u32 m0, s77, 34816
s_add_u32 s64, s76, 131072
v_mfma_f32_16x16x32_bf16 v[64:67], a[84:87], a[132:135], v[64:67]
v_mfma_f32_16x16x32_bf16 v[72:75], a[84:87], a[140:143], v[72:75]
buffer_load_dwordx4 v7, s[56:59], s64 offen lds
v_mfma_f32_16x16x32_bf16 v[72:75], a[80:83], a[136:139], v[72:75]
ds_read_b64_tr_b16 a[164:165], v11 offset:57344
ds_read_b64_tr_b16 a[166:167], v11 offset:57856
v_mfma_f32_16x16x32_bf16 v[80:83], a[80:83], a[144:147], v[80:83]
v_mfma_f32_16x16x32_bf16 v[80:83], a[84:87], a[148:151], v[80:83]
s_waitcnt vmcnt(12)
ds_read_b128 a[112:115], v9 offset:12288
v_mfma_f32_16x16x32_bf16 v[88:91], a[84:87], a[156:159], v[88:91]
v_mfma_f32_16x16x32_bf16 v[88:91], a[80:83], a[152:155], v[88:91]
v_accvgpr_read_b32 v16, a192
v_accvgpr_read_b32 v17, a194
v_mfma_f32_16x16x32_bf16 v[92:95], a[88:91], a[152:155], v[92:95]
ds_read_b64_tr_b16 a[168:169], v12 offset:49152
ds_read_b64_tr_b16 a[170:171], v12 offset:49664
v_mfma_f32_16x16x32_bf16 v[92:95], a[92:95], a[156:159], v[92:95]
buffer_load_dwordx4 v8, s[56:59], s64 offen offset:1024 lds
v_mfma_f32_16x16x32_bf16 v[84:87], a[92:95], a[148:151], v[84:87]
v_accvgpr_read_b32 v18, a196
v_accvgpr_read_b32 v19, a198
v_mfma_f32_16x16x32_bf16 v[84:87], a[88:91], a[144:147], v[84:87]
v_perm_b32 v24, v17, v16, s85
v_perm_b32 v25, v19, v18, s85
v_mfma_f32_16x16x32_bf16 v[76:79], a[88:91], a[136:139], v[76:79]
ds_read_b128 a[116:119], v10 offset:12288
v_perm_b32 v28, v17, v16, s86
v_mfma_f32_16x16x32_bf16 v[76:79], a[92:95], a[140:143], v[76:79]
v_perm_b32 v29, v19, v18, s86
v_accvgpr_read_b32 v16, a200
v_mfma_f32_16x16x32_bf16 v[68:71], a[92:95], a[132:135], v[68:71]
v_accvgpr_read_b32 v17, a202
v_accvgpr_read_b32 v18, a204
v_mfma_f32_16x16x32_bf16 v[68:71], a[88:91], a[128:131], v[68:71]
s_add_u32 m0, s73, 69632
s_add_u32 s64, s71, 524288
s_waitcnt lgkmcnt(6)
v_mfma_f32_16x16x32_bf16 v[96:99], a[96:99], a[128:131], v[96:99]
ds_read_b64_tr_b16 a[172:173], v12 offset:57344
ds_read_b64_tr_b16 a[174:175], v12 offset:57856
v_mfma_f32_16x16x32_bf16 v[96:99], a[100:103], a[132:135], v[96:99]
buffer_load_dwordx4 v5, s[8:11], s64 offen lds
v_mfma_f32_16x16x32_bf16 v[104:107], a[100:103], a[140:143], v[104:107]
ds_read_b128 a[120:123], v9 offset:14336
v_accvgpr_read_b32 v19, a206
v_mfma_f32_16x16x32_bf16 v[104:107], a[96:99], a[136:139], v[104:107]
v_perm_b32 v26, v17, v16, s85
v_perm_b32 v27, v19, v18, s85
v_mfma_f32_16x16x32_bf16 v[112:115], a[96:99], a[144:147], v[112:115]
v_perm_b32 v30, v17, v16, s86
v_perm_b32 v31, v19, v18, s86
v_mfma_f32_16x16x32_bf16 v[112:115], a[100:103], a[148:151], v[112:115]
ds_read_b64_tr_b16 a[176:177], v13 offset:49152
ds_read_b64_tr_b16 a[178:179], v13 offset:49664
v_mfma_f32_16x16x32_bf16 v[120:123], a[100:103], a[156:159], v[120:123]
v_accvgpr_read_b32 v16, a208
v_accvgpr_read_b32 v17, a209
v_mfma_f32_16x16x32_bf16 v[120:123], a[96:99], a[152:155], v[120:123]
v_accvgpr_read_b32 v18, a210
v_accvgpr_read_b32 v19, a211
v_mfma_f32_16x16x32_bf16 v[124:127], a[104:107], a[152:155], v[124:127]
buffer_load_dwordx4 v6, s[8:11], s64 offen offset:1024 lds
v_mfma_f32_16x16x32_bf16 v[124:127], a[108:111], a[156:159], v[124:127]
ds_read_b128 a[124:127], v10 offset:14336
v_or_b32 v24, v24, v16
v_mfma_f32_16x16x32_bf16 v[116:119], a[108:111], a[148:151], v[116:119]
v_add_u32 v9, 32768, v9
v_add_u32 v10, 32768, v10
v_mfma_f32_16x16x32_bf16 v[116:119], a[104:107], a[144:147], v[116:119]
v_or_b32 v25, v25, v17
v_or_b32 v26, v26, v18
v_mfma_f32_16x16x32_bf16 v[108:111], a[104:107], a[136:139], v[108:111]
ds_read_b64_tr_b16 a[180:181], v13 offset:57344
ds_read_b64_tr_b16 a[182:183], v13 offset:57856
v_mfma_f32_16x16x32_bf16 v[108:111], a[108:111], a[140:143], v[108:111]
s_add_u32 m0, s73, 71680
s_add_u32 s64, s71, 540672
v_or_b32 v27, v27, v19
v_mfma_f32_16x16x32_bf16 v[100:103], a[108:111], a[132:135], v[100:103]
s_waitcnt lgkmcnt(2)
v_mfma_f32_16x16x32_bf16 v[100:103], a[104:107], a[128:131], v[100:103]
buffer_load_dwordx4 v5, s[8:11], s64 offen lds
v_mfma_f32_16x16x32_bf16 v[128:131], a[112:115], a[128:131], v[128:131]
ds_read_b64_tr_b16 a[184:185], v14 offset:49152
ds_read_b64_tr_b16 a[186:187], v14 offset:49664
v_mfma_f32_16x16x32_bf16 v[128:131], a[116:119], a[132:135], v[128:131]
buffer_store_dwordx4 v[24:27], v15, s[24:27], s82 offen offset:0 sc1
v_mfma_f32_16x16x32_bf16 v[136:139], a[116:119], a[140:143], v[136:139]
ds_read_b64_tr_b16 a[188:189], v14 offset:57344
ds_read_b64_tr_b16 a[190:191], v14 offset:57856
v_mfma_f32_16x16x32_bf16 v[136:139], a[112:115], a[136:139], v[136:139]
v_mfma_f32_16x16x32_bf16 v[144:147], a[112:115], a[144:147], v[144:147]
v_mfma_f32_16x16x32_bf16 v[144:147], a[116:119], a[148:151], v[144:147]
buffer_store_dwordx4 v[28:31], v15, s[24:27], s82 offen offset:1024 sc1
v_mfma_f32_16x16x32_bf16 v[152:155], a[116:119], a[156:159], v[152:155]
buffer_load_dwordx4 v6, s[8:11], s64 offen offset:1024 lds
v_mfma_f32_16x16x32_bf16 v[152:155], a[112:115], a[152:155], v[152:155]
v_accvgpr_read_b32 v16, a193
v_accvgpr_read_b32 v17, a195
v_mfma_f32_16x16x32_bf16 v[156:159], a[120:123], a[152:155], v[156:159]
v_accvgpr_read_b32 v18, a197
v_accvgpr_read_b32 v19, a199
v_mfma_f32_16x16x32_bf16 v[156:159], a[124:127], a[156:159], v[156:159]
v_perm_b32 v24, v17, v16, s85
v_perm_b32 v25, v19, v18, s85
v_mfma_f32_16x16x32_bf16 v[148:151], a[124:127], a[148:151], v[148:151]
v_perm_b32 v28, v17, v16, s86
v_perm_b32 v29, v19, v18, s86
v_mfma_f32_16x16x32_bf16 v[148:151], a[120:123], a[144:147], v[148:151]
v_accvgpr_read_b32 v16, a201
v_accvgpr_read_b32 v17, a203
v_mfma_f32_16x16x32_bf16 v[140:143], a[120:123], a[136:139], v[140:143]
v_accvgpr_read_b32 v18, a205
v_accvgpr_read_b32 v19, a207
v_mfma_f32_16x16x32_bf16 v[140:143], a[124:127], a[140:143], v[140:143]
v_perm_b32 v26, v17, v16, s85
v_perm_b32 v27, v19, v18, s85
v_mfma_f32_16x16x32_bf16 v[132:135], a[124:127], a[132:135], v[132:135]
v_perm_b32 v30, v17, v16, s86
v_perm_b32 v31, v19, v18, s86
v_mfma_f32_16x16x32_bf16 v[132:135], a[120:123], a[128:131], v[132:135]
s_waitcnt lgkmcnt(0)
v_mfma_f32_16x16x32_bf16 v[160:163], a[160:163], a[64:67], v[160:163]
s_waitcnt vmcnt(18)
v_mfma_f32_16x16x32_bf16 v[160:163], a[164:167], a[68:71], v[160:163]
s_barrier
v_mfma_f32_16x16x32_bf16 v[164:167], a[172:175], a[68:71], v[164:167]
ds_read_b64_tr_b16 a[128:129], v11 offset:0
ds_read_b64_tr_b16 a[130:131], v11 offset:512
v_mfma_f32_16x16x32_bf16 v[164:167], a[168:171], a[64:67], v[164:167]
s_add_u32 m0, s77, 49152
s_add_u32 s64, s76, 0
v_mfma_f32_16x16x32_bf16 v[168:171], a[176:179], a[64:67], v[168:171]
buffer_load_dwordx4 v7, s[16:19], s64 offen lds
v_mfma_f32_16x16x32_bf16 v[168:171], a[180:183], a[68:71], v[168:171]
buffer_store_dwordx4 v[24:27], v15, s[24:27], s82 offen offset:2048 sc1
v_mfma_f32_16x16x32_bf16 v[172:175], a[188:191], a[68:71], v[172:175]
v_mfma_f32_16x16x32_bf16 v[172:175], a[184:187], a[64:67], v[172:175]
ds_read_b128 a[64:67], v9 offset:0
v_mfma_f32_16x16x32_bf16 v[188:191], a[184:187], a[72:75], v[188:191]
ds_read_b64_tr_b16 a[132:133], v11 offset:8192
ds_read_b64_tr_b16 a[134:135], v11 offset:8704
v_mfma_f32_16x16x32_bf16 v[188:191], a[188:191], a[76:79], v[188:191]
buffer_store_dwordx4 v[28:31], v15, s[24:27], s82 offen offset:3072 sc1
v_mfma_f32_16x16x32_bf16 v[184:187], a[180:183], a[76:79], v[184:187]
s_lshl_b32 s52, s7, 4
v_and_b32 v22, 3, v1
v_lshl_add_u32 v22, v22, 2, s52
v_mfma_f32_16x16x32_bf16 v[184:187], a[176:179], a[72:75], v[184:187]
buffer_load_dwordx4 v8, s[16:19], s64 offen offset:1024 lds
v_mfma_f32_16x16x32_bf16 v[180:183], a[168:171], a[72:75], v[180:183]
ds_read_b128 a[68:71], v10 offset:0
v_mfma_f32_16x16x32_bf16 v[180:183], a[172:175], a[76:79], v[180:183]
buffer_load_dword v23, v22, s[40:43], 0 offen sc1
v_mfma_f32_16x16x32_bf16 v[176:179], a[164:167], a[76:79], v[176:179]
v_mfma_f32_16x16x32_bf16 v[176:179], a[160:163], a[72:75], v[176:179]
ds_read_b64_tr_b16 a[136:137], v12 offset:0
ds_read_b64_tr_b16 a[138:139], v12 offset:512
v_mfma_f32_16x16x32_bf16 v[192:195], a[160:163], a[80:83], v[192:195]
s_add_u32 m0, s77, 51200
s_add_u32 s64, s76, 131072
v_mfma_f32_16x16x32_bf16 v[192:195], a[164:167], a[84:87], v[192:195]
v_mfma_f32_16x16x32_bf16 v[196:199], a[172:175], a[84:87], v[196:199]
buffer_load_dwordx4 v7, s[16:19], s64 offen lds
v_mfma_f32_16x16x32_bf16 v[196:199], a[168:171], a[80:83], v[196:199]
ds_read_b128 a[72:75], v9 offset:2048
v_mfma_f32_16x16x32_bf16 v[200:203], a[176:179], a[80:83], v[200:203]
v_mfma_f32_16x16x32_bf16 v[200:203], a[180:183], a[84:87], v[200:203]
ds_read_b64_tr_b16 a[140:141], v12 offset:8192
ds_read_b64_tr_b16 a[142:143], v12 offset:8704
v_mfma_f32_16x16x32_bf16 v[204:207], a[188:191], a[84:87], v[204:207]
v_mfma_f32_16x16x32_bf16 v[204:207], a[184:187], a[80:83], v[204:207]
v_mfma_f32_16x16x32_bf16 v[220:223], a[184:187], a[88:91], v[220:223]
ds_read_b128 a[76:79], v10 offset:2048
v_mfma_f32_16x16x32_bf16 v[220:223], a[188:191], a[92:95], v[220:223]
buffer_load_dwordx4 v8, s[16:19], s64 offen offset:1024 lds
v_mfma_f32_16x16x32_bf16 v[216:219], a[180:183], a[92:95], v[216:219]
s_xor_b32 s71, s70, 768
s_add_u32 s71, s68, s71
v_mfma_f32_16x16x32_bf16 v[216:219], a[176:179], a[88:91], v[216:219]
v_mfma_f32_16x16x32_bf16 v[212:215], a[168:171], a[88:91], v[212:215]
ds_read_b64_tr_b16 a[144:145], v13 offset:0
ds_read_b64_tr_b16 a[146:147], v13 offset:512
v_mfma_f32_16x16x32_bf16 v[212:215], a[172:175], a[92:95], v[212:215]
v_mfma_f32_16x16x32_bf16 v[208:211], a[164:167], a[92:95], v[208:211]
v_mfma_f32_16x16x32_bf16 v[208:211], a[160:163], a[88:91], v[208:211]
s_add_u32 m0, s73, 0
s_add_u32 s64, s71, 0
ds_read_b128 a[80:83], v9 offset:4096
v_mfma_f32_16x16x32_bf16 v[224:227], a[160:163], a[96:99], v[224:227]
v_mfma_f32_16x16x32_bf16 v[224:227], a[164:167], a[100:103], v[224:227]
buffer_load_dwordx4 v5, s[8:11], s64 offen lds
v_mfma_f32_16x16x32_bf16 v[228:231], a[172:175], a[100:103], v[228:231]
ds_read_b64_tr_b16 a[148:149], v13 offset:8192
ds_read_b64_tr_b16 a[150:151], v13 offset:8704
v_mfma_f32_16x16x32_bf16 v[228:231], a[168:171], a[96:99], v[228:231]
v_mfma_f32_16x16x32_bf16 v[232:235], a[176:179], a[96:99], v[232:235]
v_mfma_f32_16x16x32_bf16 v[232:235], a[180:183], a[100:103], v[232:235]
ds_read_b128 a[84:87], v10 offset:4096
v_mfma_f32_16x16x32_bf16 v[236:239], a[188:191], a[100:103], v[236:239]
v_mfma_f32_16x16x32_bf16 v[236:239], a[184:187], a[96:99], v[236:239]
v_mfma_f32_16x16x32_bf16 v[252:255], a[184:187], a[104:107], v[252:255]
buffer_load_dwordx4 v6, s[8:11], s64 offen offset:1024 lds
v_mfma_f32_16x16x32_bf16 v[252:255], a[188:191], a[108:111], v[252:255]
ds_read_b64_tr_b16 a[152:153], v14 offset:0
ds_read_b64_tr_b16 a[154:155], v14 offset:512
v_mfma_f32_16x16x32_bf16 v[248:251], a[180:183], a[108:111], v[248:251]
v_mfma_f32_16x16x32_bf16 v[248:251], a[176:179], a[104:107], v[248:251]
v_mfma_f32_16x16x32_bf16 v[244:247], a[168:171], a[104:107], v[244:247]
ds_read_b128 a[88:91], v9 offset:6144
v_mfma_f32_16x16x32_bf16 v[244:247], a[172:175], a[108:111], v[244:247]
s_add_u32 m0, s73, 2048
s_add_u32 s64, s71, 16384
v_mfma_f32_16x16x32_bf16 v[240:243], a[164:167], a[108:111], v[240:243]
v_mfma_f32_16x16x32_bf16 v[240:243], a[160:163], a[104:107], v[240:243]
buffer_load_dwordx4 v5, s[8:11], s64 offen lds
v_mfma_f32_16x16x32_bf16 a[0:3], a[160:163], a[112:115], a[0:3]
ds_read_b64_tr_b16 a[156:157], v14 offset:8192
ds_read_b64_tr_b16 a[158:159], v14 offset:8704
v_mfma_f32_16x16x32_bf16 a[0:3], a[164:167], a[116:119], a[0:3]
v_mfma_f32_16x16x32_bf16 a[4:7], a[172:175], a[116:119], a[4:7]
ds_read_b128 a[92:95], v10 offset:6144
v_mfma_f32_16x16x32_bf16 a[4:7], a[168:171], a[112:115], a[4:7]
v_mfma_f32_16x16x32_bf16 a[8:11], a[176:179], a[112:115], a[8:11]
v_mfma_f32_16x16x32_bf16 a[8:11], a[180:183], a[116:119], a[8:11]
v_mfma_f32_16x16x32_bf16 a[12:15], a[188:191], a[116:119], a[12:15]
buffer_load_dwordx4 v6, s[8:11], s64 offen offset:1024 lds
v_mfma_f32_16x16x32_bf16 a[12:15], a[184:187], a[112:115], a[12:15]
v_mfma_f32_16x16x32_bf16 a[28:31], a[184:187], a[120:123], a[28:31]
v_mfma_f32_16x16x32_bf16 a[28:31], a[188:191], a[124:127], a[28:31]
v_mfma_f32_16x16x32_bf16 a[24:27], a[180:183], a[124:127], a[24:27]
v_mfma_f32_16x16x32_bf16 a[24:27], a[176:179], a[120:123], a[24:27]
v_mfma_f32_16x16x32_bf16 a[20:23], a[168:171], a[120:123], a[20:23]
v_mfma_f32_16x16x32_bf16 a[20:23], a[172:175], a[124:127], a[20:23]
v_mfma_f32_16x16x32_bf16 a[16:19], a[164:167], a[124:127], a[16:19]
v_mfma_f32_16x16x32_bf16 a[16:19], a[160:163], a[120:123], a[16:19]
s_waitcnt lgkmcnt(0)
v_mfma_f32_16x16x32_bf16 v[32:35], a[64:67], a[128:131], v[32:35]
s_waitcnt vmcnt(25)
v_mfma_f32_16x16x32_bf16 v[32:35], a[68:71], a[132:135], v[32:35]
s_barrier
v_mfma_f32_16x16x32_bf16 v[40:43], a[68:71], a[140:143], v[40:43]
ds_read_b128 a[96:99], v9 offset:8192
v_mfma_f32_16x16x32_bf16 v[40:43], a[64:67], a[136:139], v[40:43]
s_xor_b32 s76, s75, 3145728
s_add_u32 s76, s74, s76
v_mfma_f32_16x16x32_bf16 v[48:51], a[64:67], a[144:147], v[48:51]
s_add_u32 m0, s77, 0
s_add_u32 s64, s76, 0
v_mfma_f32_16x16x32_bf16 v[48:51], a[68:71], a[148:151], v[48:51]
buffer_load_dwordx4 v7, s[56:59], s64 offen lds
v_mfma_f32_16x16x32_bf16 v[56:59], a[68:71], a[156:159], v[56:59]
ds_read_b128 a[100:103], v10 offset:8192
v_mfma_f32_16x16x32_bf16 v[56:59], a[64:67], a[152:155], v[56:59]
v_mfma_f32_16x16x32_bf16 v[60:63], a[72:75], a[152:155], v[60:63]
ds_read_b128 a[104:107], v9 offset:10240
v_mfma_f32_16x16x32_bf16 v[60:63], a[76:79], a[156:159], v[60:63]
v_mfma_f32_16x16x32_bf16 v[52:55], a[76:79], a[148:151], v[52:55]
v_mfma_f32_16x16x32_bf16 v[52:55], a[72:75], a[144:147], v[52:55]
buffer_load_dwordx4 v8, s[56:59], s64 offen offset:1024 lds
v_mfma_f32_16x16x32_bf16 v[44:47], a[72:75], a[136:139], v[44:47]
ds_read_b64_tr_b16 a[160:161], v11 offset:16384
ds_read_b64_tr_b16 a[162:163], v11 offset:16896
v_mfma_f32_16x16x32_bf16 v[44:47], a[76:79], a[140:143], v[44:47]
v_mfma_f32_16x16x32_bf16 v[36:39], a[76:79], a[132:135], v[36:39]
v_mfma_f32_16x16x32_bf16 v[36:39], a[72:75], a[128:131], v[36:39]
ds_read_b128 a[108:111], v10 offset:10240
v_mfma_f32_16x16x32_bf16 v[64:67], a[80:83], a[128:131], v[64:67]
s_add_u32 m0, s77, 2048
s_add_u32 s64, s76, 131072
s_waitcnt vmcnt(8)
v_mfma_f32_16x16x32_bf16 v[64:67], a[84:87], a[132:135], v[64:67]
v_cmp_gt_u32 vcc, 1, v23
v_mfma_f32_16x16x32_bf16 v[72:75], a[84:87], a[140:143], v[72:75]
buffer_load_dwordx4 v7, s[56:59], s64 offen lds
v_mfma_f32_16x16x32_bf16 v[72:75], a[80:83], a[136:139], v[72:75]
ds_read_b64_tr_b16 a[164:165], v11 offset:24576
ds_read_b64_tr_b16 a[166:167], v11 offset:25088
v_mfma_f32_16x16x32_bf16 v[80:83], a[80:83], a[144:147], v[80:83]
v_mfma_f32_16x16x32_bf16 v[80:83], a[84:87], a[148:151], v[80:83]
ds_read_b128 a[112:115], v9 offset:12288
v_mfma_f32_16x16x32_bf16 v[88:91], a[84:87], a[156:159], v[88:91]
s_cbranch_vccnz CK_Z
CK_Z_R:
v_mfma_f32_16x16x32_bf16 v[88:91], a[80:83], a[152:155], v[88:91]
buffer_atomic_add v1, v0, s[24:27], s84 offen offset:0 sc1
v_mfma_f32_16x16x32_bf16 v[92:95], a[88:91], a[152:155], v[92:95]
ds_read_b64_tr_b16 a[168:169], v12 offset:16384
ds_read_b64_tr_b16 a[170:171], v12 offset:16896
v_mfma_f32_16x16x32_bf16 v[92:95], a[92:95], a[156:159], v[92:95]
buffer_load_dwordx4 v8, s[56:59], s64 offen offset:1024 lds
v_mfma_f32_16x16x32_bf16 v[84:87], a[92:95], a[148:151], v[84:87]
v_mov_b32 v29, 0
v_mfma_f32_16x16x32_bf16 v[84:87], a[88:91], a[144:147], v[84:87]
v_mfma_f32_16x16x32_bf16 v[76:79], a[88:91], a[136:139], v[76:79]
ds_read_b128 a[116:119], v10 offset:12288
v_mfma_f32_16x16x32_bf16 v[76:79], a[92:95], a[140:143], v[76:79]
v_mfma_f32_16x16x32_bf16 v[68:71], a[92:95], a[132:135], v[68:71]
v_mfma_f32_16x16x32_bf16 v[68:71], a[88:91], a[128:131], v[68:71]
s_add_u32 m0, s73, 4096
s_add_u32 s64, s71, 524288
s_waitcnt lgkmcnt(6)
v_mfma_f32_16x16x32_bf16 v[96:99], a[96:99], a[128:131], v[96:99]
ds_read_b64_tr_b16 a[172:173], v12 offset:24576
ds_read_b64_tr_b16 a[174:175], v12 offset:25088
v_mfma_f32_16x16x32_bf16 v[96:99], a[100:103], a[132:135], v[96:99]
buffer_load_dwordx4 v5, s[8:11], s64 offen lds
v_mfma_f32_16x16x32_bf16 v[104:107], a[100:103], a[140:143], v[104:107]
ds_read_b128 a[120:123], v9 offset:14336
v_mfma_f32_16x16x32_bf16 v[104:107], a[96:99], a[136:139], v[104:107]
v_mfma_f32_16x16x32_bf16 v[112:115], a[96:99], a[144:147], v[112:115]
v_mfma_f32_16x16x32_bf16 v[112:115], a[100:103], a[148:151], v[112:115]
ds_read_b64_tr_b16 a[176:177], v13 offset:16384
ds_read_b64_tr_b16 a[178:179], v13 offset:16896
v_mfma_f32_16x16x32_bf16 v[120:123], a[100:103], a[156:159], v[120:123]
v_mfma_f32_16x16x32_bf16 v[120:123], a[96:99], a[152:155], v[120:123]
v_mfma_f32_16x16x32_bf16 v[124:127], a[104:107], a[152:155], v[124:127]
buffer_load_dwordx4 v6, s[8:11], s64 offen offset:1024 lds
v_mfma_f32_16x16x32_bf16 v[124:127], a[108:111], a[156:159], v[124:127]
ds_read_b128 a[124:127], v10 offset:14336
v_mfma_f32_16x16x32_bf16 v[116:119], a[108:111], a[148:151], v[116:119]
v_add_u32 v9, 32768, v9
v_add_u32 v10, 32768, v10
v_mfma_f32_16x16x32_bf16 v[116:119], a[104:107], a[144:147], v[116:119]
v_mfma_f32_16x16x32_bf16 v[108:111], a[104:107], a[136:139], v[108:111]
ds_read_b64_tr_b16 a[180:181], v13 offset:24576
ds_read_b64_tr_b16 a[182:183], v13 offset:25088
v_mfma_f32_16x16x32_bf16 v[108:111], a[108:111], a[140:143], v[108:111]
s_add_u32 m0, s73, 6144
s_add_u32 s64, s71, 540672
v_mfma_f32_16x16x32_bf16 v[100:103], a[108:111], a[132:135], v[100:103]
s_waitcnt lgkmcnt(2)
v_mfma_f32_16x16x32_bf16 v[100:103], a[104:107], a[128:131], v[100:103]
buffer_load_dwordx4 v5, s[8:11], s64 offen lds
v_mfma_f32_16x16x32_bf16 v[128:131], a[112:115], a[128:131], v[128:131]
ds_read_b64_tr_b16 a[184:185], v14 offset:16384
ds_read_b64_tr_b16 a[186:187], v14 offset:16896
v_mfma_f32_16x16x32_bf16 v[128:131], a[116:119], a[132:135], v[128:131]
v_mfma_f32_16x16x32_bf16 v[136:139], a[116:119], a[140:143], v[136:139]
ds_read_b64_tr_b16 a[188:189], v14 offset:24576
ds_read_b64_tr_b16 a[190:191], v14 offset:25088
v_mfma_f32_16x16x32_bf16 v[136:139], a[112:115], a[136:139], v[136:139]
v_mfma_f32_16x16x32_bf16 v[144:147], a[112:115], a[144:147], v[144:147]
v_mfma_f32_16x16x32_bf16 v[144:147], a[116:119], a[148:151], v[144:147]
v_mfma_f32_16x16x32_bf16 v[152:155], a[116:119], a[156:159], v[152:155]
buffer_load_dwordx4 v6, s[8:11], s64 offen offset:1024 lds
v_mfma_f32_16x16x32_bf16 v[152:155], a[112:115], a[152:155], v[152:155]
v_mfma_f32_16x16x32_bf16 v[156:159], a[120:123], a[152:155], v[156:159]
v_mfma_f32_16x16x32_bf16 v[156:159], a[124:127], a[156:159], v[156:159]
v_mfma_f32_16x16x32_bf16 v[148:151], a[124:127], a[148:151], v[148:151]
v_mfma_f32_16x16x32_bf16 v[148:151], a[120:123], a[144:147], v[148:151]
v_mfma_f32_16x16x32_bf16 v[140:143], a[120:123], a[136:139], v[140:143]
v_mfma_f32_16x16x32_bf16 v[140:143], a[124:127], a[140:143], v[140:143]
v_mfma_f32_16x16x32_bf16 v[132:135], a[124:127], a[132:135], v[132:135]
v_mfma_f32_16x16x32_bf16 v[132:135], a[120:123], a[128:131], v[132:135]
s_waitcnt lgkmcnt(0)
v_mfma_f32_16x16x32_bf16 v[160:163], a[160:163], a[64:67], v[160:163]
s_waitcnt vmcnt(20)
v_mfma_f32_16x16x32_bf16 v[160:163], a[164:167], a[68:71], v[160:163]
s_barrier
v_mfma_f32_16x16x32_bf16 v[164:167], a[172:175], a[68:71], v[164:167]
ds_read_b64_tr_b16 a[128:129], v11 offset:32768
ds_read_b64_tr_b16 a[130:131], v11 offset:33280
v_mfma_f32_16x16x32_bf16 v[164:167], a[168:171], a[64:67], v[164:167]
s_add_u32 m0, s77, 16384
s_add_u32 s64, s76, 0
v_mfma_f32_16x16x32_bf16 v[168:171], a[176:179], a[64:67], v[168:171]
buffer_load_dwordx4 v7, s[16:19], s64 offen lds
v_mfma_f32_16x16x32_bf16 v[168:171], a[180:183], a[68:71], v[168:171]
buffer_load_dword a253, v20, s[12:15], s53 offen
v_mfma_f32_16x16x32_bf16 v[172:175], a[188:191], a[68:71], v[172:175]
v_mfma_f32_16x16x32_bf16 v[172:175], a[184:187], a[64:67], v[172:175]
ds_read_b128 a[64:67], v9 offset:0
v_mfma_f32_16x16x32_bf16 v[188:191], a[184:187], a[72:75], v[188:191]
ds_read_b64_tr_b16 a[132:133], v11 offset:40960
ds_read_b64_tr_b16 a[134:135], v11 offset:41472
v_mfma_f32_16x16x32_bf16 v[188:191], a[188:191], a[76:79], v[188:191]
v_mfma_f32_16x16x32_bf16 v[184:187], a[180:183], a[76:79], v[184:187]
v_mfma_f32_16x16x32_bf16 v[184:187], a[176:179], a[72:75], v[184:187]
buffer_load_dwordx4 v8, s[16:19], s64 offen offset:1024 lds
v_mfma_f32_16x16x32_bf16 v[180:183], a[168:171], a[72:75], v[180:183]
ds_read_b128 a[68:71], v10 offset:0
v_mfma_f32_16x16x32_bf16 v[180:183], a[172:175], a[76:79], v[180:183]
v_mfma_f32_16x16x32_bf16 v[176:179], a[164:167], a[76:79], v[176:179]
v_mfma_f32_16x16x32_bf16 v[176:179], a[160:163], a[72:75], v[176:179]
ds_read_b64_tr_b16 a[136:137], v12 offset:32768
ds_read_b64_tr_b16 a[138:139], v12 offset:33280
v_mfma_f32_16x16x32_bf16 v[192:195], a[160:163], a[80:83], v[192:195]
s_add_u32 m0, s77, 18432
s_add_u32 s64, s76, 131072
v_mfma_f32_16x16x32_bf16 v[192:195], a[164:167], a[84:87], v[192:195]
v_mfma_f32_16x16x32_bf16 v[196:199], a[172:175], a[84:87], v[196:199]
buffer_load_dwordx4 v7, s[16:19], s64 offen lds
v_mfma_f32_16x16x32_bf16 v[196:199], a[168:171], a[80:83], v[196:199]
ds_read_b128 a[72:75], v9 offset:2048
v_mfma_f32_16x16x32_bf16 v[200:203], a[176:179], a[80:83], v[200:203]
v_mfma_f32_16x16x32_bf16 v[200:203], a[180:183], a[84:87], v[200:203]
ds_read_b64_tr_b16 a[140:141], v12 offset:40960
ds_read_b64_tr_b16 a[142:143], v12 offset:41472
v_mfma_f32_16x16x32_bf16 v[204:207], a[188:191], a[84:87], v[204:207]
L_PAD2:
s_cbranch_execz L_PAD6
v_mfma_f32_16x16x32_bf16 v[204:207], a[184:187], a[80:83], v[204:207]
v_mfma_f32_16x16x32_bf16 v[220:223], a[184:187], a[88:91], v[220:223]
ds_read_b128 a[76:79], v10 offset:2048
v_mfma_f32_16x16x32_bf16 v[220:223], a[188:191], a[92:95], v[220:223]
buffer_load_dwordx4 v8, s[16:19], s64 offen offset:1024 lds
v_mfma_f32_16x16x32_bf16 v[216:219], a[180:183], a[92:95], v[216:219]
s_xor_b32 s71, s70, 896
s_add_u32 s71, s68, s71
v_mfma_f32_16x16x32_bf16 v[216:219], a[176:179], a[88:91], v[216:219]
v_mfma_f32_16x16x32_bf16 v[212:215], a[168:171], a[88:91], v[212:215]
ds_read_b64_tr_b16 a[144:145], v13 offset:32768
ds_read_b64_tr_b16 a[146:147], v13 offset:33280
v_mfma_f32_16x16x32_bf16 v[212:215], a[172:175], a[92:95], v[212:215]
v_mfma_f32_16x16x32_bf16 v[208:211], a[164:167], a[92:95], v[208:211]
v_mfma_f32_16x16x32_bf16 v[208:211], a[160:163], a[88:91], v[208:211]
s_add_u32 m0, s73, 32768
s_add_u32 s64, s71, 0
ds_read_b128 a[80:83], v9 offset:4096
v_mfma_f32_16x16x32_bf16 v[224:227], a[160:163], a[96:99], v[224:227]
v_mfma_f32_16x16x32_bf16 v[224:227], a[164:167], a[100:103], v[224:227]
buffer_load_dwordx4 v5, s[8:11], s64 offen lds
v_mfma_f32_16x16x32_bf16 v[228:231], a[172:175], a[100:103], v[228:231]
ds_read_b64_tr_b16 a[148:149], v13 offset:40960
ds_read_b64_tr_b16 a[150:151], v13 offset:41472
v_mfma_f32_16x16x32_bf16 v[228:231], a[168:171], a[96:99], v[228:231]
v_mfma_f32_16x16x32_bf16 v[232:235], a[176:179], a[96:99], v[232:235]
v_mfma_f32_16x16x32_bf16 v[232:235], a[180:183], a[100:103], v[232:235]
ds_read_b128 a[84:87], v10 offset:4096
v_mfma_f32_16x16x32_bf16 v[236:239], a[188:191], a[100:103], v[236:239]
v_mfma_f32_16x16x32_bf16 v[236:239], a[184:187], a[96:99], v[236:239]
v_mfma_f32_16x16x32_bf16 v[252:255], a[184:187], a[104:107], v[252:255]
buffer_load_dwordx4 v6, s[8:11], s64 offen offset:1024 lds
v_mfma_f32_16x16x32_bf16 v[252:255], a[188:191], a[108:111], v[252:255]
ds_read_b64_tr_b16 a[152:153], v14 offset:32768
ds_read_b64_tr_b16 a[154:155], v14 offset:33280
v_mfma_f32_16x16x32_bf16 v[248:251], a[180:183], a[108:111], v[248:251]
v_mfma_f32_16x16x32_bf16 v[248:251], a[176:179], a[104:107], v[248:251]
v_mfma_f32_16x16x32_bf16 v[244:247], a[168:171], a[104:107], v[244:247]
ds_read_b128 a[88:91], v9 offset:6144
v_mfma_f32_16x16x32_bf16 v[244:247], a[172:175], a[108:111], v[244:247]
s_add_u32 m0, s73, 34816
s_add_u32 s64, s71, 16384
v_mfma_f32_16x16x32_bf16 v[240:243], a[164:167], a[108:111], v[240:243]
v_mfma_f32_16x16x32_bf16 v[240:243], a[160:163], a[104:107], v[240:243]
buffer_load_dwordx4 v5, s[8:11], s64 offen lds
v_mfma_f32_16x16x32_bf16 a[0:3], a[160:163], a[112:115], a[0:3]
ds_read_b64_tr_b16 a[156:157], v14 offset:40960
ds_read_b64_tr_b16 a[158:159], v14 offset:41472
v_mfma_f32_16x16x32_bf16 a[0:3], a[164:167], a[116:119], a[0:3]
v_mfma_f32_16x16x32_bf16 a[4:7], a[172:175], a[116:119], a[4:7]
ds_read_b128 a[92:95], v10 offset:6144
v_mfma_f32_16x16x32_bf16 a[4:7], a[168:171], a[112:115], a[4:7]
v_mfma_f32_16x16x32_bf16 a[8:11], a[176:179], a[112:115], a[8:11]
v_mfma_f32_16x16x32_bf16 a[8:11], a[180:183], a[116:119], a[8:11]
v_mfma_f32_16x16x32_bf16 a[12:15], a[188:191], a[116:119], a[12:15]
buffer_load_dwordx4 v6, s[8:11], s64 offen offset:1024 lds
v_mfma_f32_16x16x32_bf16 a[12:15], a[184:187], a[112:115], a[12:15]
v_mfma_f32_16x16x32_bf16 a[28:31], a[184:187], a[120:123], a[28:31]
v_mfma_f32_16x16x32_bf16 a[28:31], a[188:191], a[124:127], a[28:31]
v_mfma_f32_16x16x32_bf16 a[24:27], a[180:183], a[124:127], a[24:27]
v_mfma_f32_16x16x32_bf16 a[24:27], a[176:179], a[120:123], a[24:27]
v_mfma_f32_16x16x32_bf16 a[20:23], a[168:171], a[120:123], a[20:23]
v_mfma_f32_16x16x32_bf16 a[20:23], a[172:175], a[124:127], a[20:23]
v_mfma_f32_16x16x32_bf16 a[16:19], a[164:167], a[124:127], a[16:19]
v_mfma_f32_16x16x32_bf16 a[16:19], a[160:163], a[120:123], a[16:19]
s_waitcnt lgkmcnt(0)
v_mfma_f32_16x16x32_bf16 v[32:35], a[64:67], a[128:131], v[32:35]
s_waitcnt vmcnt(22)
v_mfma_f32_16x16x32_bf16 v[32:35], a[68:71], a[132:135], v[32:35]
s_barrier
v_mfma_f32_16x16x32_bf16 v[40:43], a[68:71], a[140:143], v[40:43]
ds_read_b128 a[96:99], v9 offset:8192
v_mfma_f32_16x16x32_bf16 v[40:43], a[64:67], a[136:139], v[40:43]
s_xor_b32 s76, s75, 3670016
s_add_u32 s76, s74, s76
v_mfma_f32_16x16x32_bf16 v[48:51], a[64:67], a[144:147], v[48:51]
s_add_u32 m0, s77, 32768
s_add_u32 s64, s76, 0
v_mfma_f32_16x16x32_bf16 v[48:51], a[68:71], a[148:151], v[48:51]
buffer_load_dwordx4 v7, s[56:59], s64 offen lds
v_mfma_f32_16x16x32_bf16 v[56:59], a[68:71], a[156:159], v[56:59]
ds_read_b128 a[100:103], v10 offset:8192
v_mfma_f32_16x16x32_bf16 v[56:59], a[64:67], a[152:155], v[56:59]
buffer_load_dword a252, v21, s[20:23], s55 offen
v_mfma_f32_16x16x32_bf16 v[60:63], a[72:75], a[152:155], v[60:63]
s_add_u32 s55, s55, 24576
s_mul_i32 s54, s54, 896
ds_read_b128 a[104:107], v9 offset:10240
v_mfma_f32_16x16x32_bf16 v[60:63], a[76:79], a[156:159], v[60:63]
v_mfma_f32_16x16x32_bf16 v[52:55], a[76:79], a[148:151], v[52:55]
v_mfma_f32_16x16x32_bf16 v[52:55], a[72:75], a[144:147], v[52:55]
buffer_load_dwordx4 v8, s[56:59], s64 offen offset:1024 lds
v_mfma_f32_16x16x32_bf16 v[44:47], a[72:75], a[136:139], v[44:47]
ds_read_b64_tr_b16 a[160:161], v11 offset:49152
ds_read_b64_tr_b16 a[162:163], v11 offset:49664
v_mfma_f32_16x16x32_bf16 v[44:47], a[76:79], a[140:143], v[44:47]
v_mfma_f32_16x16x32_bf16 v[36:39], a[76:79], a[132:135], v[36:39]
v_mfma_f32_16x16x32_bf16 v[36:39], a[72:75], a[128:131], v[36:39]
ds_read_b128 a[108:111], v10 offset:10240
v_mfma_f32_16x16x32_bf16 v[64:67], a[80:83], a[128:131], v[64:67]
s_add_u32 m0, s77, 34816
s_add_u32 s64, s76, 131072
v_mfma_f32_16x16x32_bf16 v[64:67], a[84:87], a[132:135], v[64:67]
v_mfma_f32_16x16x32_bf16 v[72:75], a[84:87], a[140:143], v[72:75]
buffer_load_dwordx4 v7, s[56:59], s64 offen lds
v_mfma_f32_16x16x32_bf16 v[72:75], a[80:83], a[136:139], v[72:75]
ds_read_b64_tr_b16 a[164:165], v11 offset:57344
ds_read_b64_tr_b16 a[166:167], v11 offset:57856
v_mfma_f32_16x16x32_bf16 v[80:83], a[80:83], a[144:147], v[80:83]
v_mfma_f32_16x16x32_bf16 v[80:83], a[84:87], a[148:151], v[80:83]
ds_read_b128 a[112:115], v9 offset:12288
v_mfma_f32_16x16x32_bf16 v[88:91], a[84:87], a[156:159], v[88:91]
v_mfma_f32_16x16x32_bf16 v[88:91], a[80:83], a[152:155], v[88:91]
v_mfma_f32_16x16x32_bf16 v[92:95], a[88:91], a[152:155], v[92:95]
ds_read_b64_tr_b16 a[168:169], v12 offset:49152
ds_read_b64_tr_b16 a[170:171], v12 offset:49664
v_mfma_f32_16x16x32_bf16 v[92:95], a[92:95], a[156:159], v[92:95]
buffer_load_dwordx4 v8, s[56:59], s64 offen offset:1024 lds
v_mfma_f32_16x16x32_bf16 v[84:87], a[92:95], a[148:151], v[84:87]
v_mfma_f32_16x16x32_bf16 v[84:87], a[88:91], a[144:147], v[84:87]
v_mfma_f32_16x16x32_bf16 v[76:79], a[88:91], a[136:139], v[76:79]
ds_read_b128 a[116:119], v10 offset:12288
v_mfma_f32_16x16x32_bf16 v[76:79], a[92:95], a[140:143], v[76:79]
v_mfma_f32_16x16x32_bf16 v[68:71], a[92:95], a[132:135], v[68:71]
v_mfma_f32_16x16x32_bf16 v[68:71], a[88:91], a[128:131], v[68:71]
s_add_u32 m0, s73, 36864
s_add_u32 s64, s71, 524288
s_waitcnt lgkmcnt(6)
v_mfma_f32_16x16x32_bf16 v[96:99], a[96:99], a[128:131], v[96:99]
ds_read_b64_tr_b16 a[172:173], v12 offset:57344
ds_read_b64_tr_b16 a[174:175], v12 offset:57856
v_mfma_f32_16x16x32_bf16 v[96:99], a[100:103], a[132:135], v[96:99]
buffer_load_dwordx4 v5, s[8:11], s64 offen lds
v_mfma_f32_16x16x32_bf16 v[104:107], a[100:103], a[140:143], v[104:107]
ds_read_b128 a[120:123], v9 offset:14336
v_mfma_f32_16x16x32_bf16 v[104:107], a[96:99], a[136:139], v[104:107]
v_mfma_f32_16x16x32_bf16 v[112:115], a[96:99], a[144:147], v[112:115]
v_mfma_f32_16x16x32_bf16 v[112:115], a[100:103], a[148:151], v[112:115]
ds_read_b64_tr_b16 a[176:177], v13 offset:49152
ds_read_b64_tr_b16 a[178:179], v13 offset:49664
v_mfma_f32_16x16x32_bf16 v[120:123], a[100:103], a[156:159], v[120:123]
v_mfma_f32_16x16x32_bf16 v[120:123], a[96:99], a[152:155], v[120:123]
v_mfma_f32_16x16x32_bf16 v[124:127], a[104:107], a[152:155], v[124:127]
buffer_load_dwordx4 v6, s[8:11], s64 offen offset:1024 lds
v_mfma_f32_16x16x32_bf16 v[124:127], a[108:111], a[156:159], v[124:127]
ds_read_b128 a[124:127], v10 offset:14336
v_mfma_f32_16x16x32_bf16 v[116:119], a[108:111], a[148:151], v[116:119]
v_add_u32 v9, -65536, v9
v_add_u32 v10, -65536, v10
v_mfma_f32_16x16x32_bf16 v[116:119], a[104:107], a[144:147], v[116:119]
buffer_load_dword v30, v29, s[24:27], s89 offen sc1
v_mfma_f32_16x16x32_bf16 v[108:111], a[104:107], a[136:139], v[108:111]
ds_read_b64_tr_b16 a[180:181], v13 offset:57344
ds_read_b64_tr_b16 a[182:183], v13 offset:57856
v_mfma_f32_16x16x32_bf16 v[108:111], a[108:111], a[140:143], v[108:111]
s_add_u32 m0, s73, 38912
s_add_u32 s64, s71, 540672
v_mfma_f32_16x16x32_bf16 v[100:103], a[108:111], a[132:135], v[100:103]
s_waitcnt lgkmcnt(2)
v_mfma_f32_16x16x32_bf16 v[100:103], a[104:107], a[128:131], v[100:103]
buffer_load_dwordx4 v5, s[8:11], s64 offen lds
v_mfma_f32_16x16x32_bf16 v[128:131], a[112:115], a[128:131], v[128:131]
ds_read_b64_tr_b16 a[184:185], v14 offset:49152
ds_read_b64_tr_b16 a[186:187], v14 offset:49664
v_mfma_f32_16x16x32_bf16 v[128:131], a[116:119], a[132:135], v[128:131]
v_mfma_f32_16x16x32_bf16 v[136:139], a[116:119], a[140:143], v[136:139]
ds_read_b64_tr_b16 a[188:189], v14 offset:57344
ds_read_b64_tr_b16 a[190:191], v14 offset:57856
v_mfma_f32_16x16x32_bf16 v[136:139], a[112:115], a[136:139], v[136:139]
v_mfma_f32_16x16x32_bf16 v[144:147], a[112:115], a[144:147], v[144:147]
v_mfma_f32_16x16x32_bf16 v[144:147], a[116:119], a[148:151], v[144:147]
v_mfma_f32_16x16x32_bf16 v[152:155], a[116:119], a[156:159], v[152:155]
buffer_load_dwordx4 v6, s[8:11], s64 offen offset:1024 lds
v_mfma_f32_16x16x32_bf16 v[152:155], a[112:115], a[152:155], v[152:155]
v_mfma_f32_16x16x32_bf16 v[156:159], a[120:123], a[152:155], v[156:159]
v_mfma_f32_16x16x32_bf16 v[156:159], a[124:127], a[156:159], v[156:159]
v_mfma_f32_16x16x32_bf16 v[148:151], a[124:127], a[148:151], v[148:151]
v_mfma_f32_16x16x32_bf16 v[148:151], a[120:123], a[144:147], v[148:151]
v_mfma_f32_16x16x32_bf16 v[140:143], a[120:123], a[136:139], v[140:143]
v_mfma_f32_16x16x32_bf16 v[140:143], a[124:127], a[140:143], v[140:143]
v_mfma_f32_16x16x32_bf16 v[132:135], a[124:127], a[132:135], v[132:135]
v_mfma_f32_16x16x32_bf16 v[132:135], a[120:123], a[128:131], v[132:135]
s_waitcnt lgkmcnt(0)
v_mfma_f32_16x16x32_bf16 v[160:163], a[160:163], a[64:67], v[160:163]
s_waitcnt vmcnt(19)
v_mfma_f32_16x16x32_bf16 v[160:163], a[164:167], a[68:71], v[160:163]
s_barrier
v_mfma_f32_16x16x32_bf16 v[164:167], a[172:175], a[68:71], v[164:167]
ds_read_b64_tr_b16 a[128:129], v11 offset:0
ds_read_b64_tr_b16 a[130:131], v11 offset:512
v_mfma_f32_16x16x32_bf16 v[164:167], a[168:171], a[64:67], v[164:167]
s_add_u32 m0, s77, 49152
s_add_u32 s64, s76, 0
v_mfma_f32_16x16x32_bf16 v[168:171], a[176:179], a[64:67], v[168:171]
buffer_load_dwordx4 v7, s[16:19], s64 offen lds
v_mfma_f32_16x16x32_bf16 v[168:171], a[180:183], a[68:71], v[168:171]
buffer_load_dword a252, v21, s[20:23], s55 offen
v_mfma_f32_16x16x32_bf16 v[172:175], a[188:191], a[68:71], v[172:175]
s_lshr_b32 s55, s2, 1
s_lshl2_add_u32 s55, s55, s3
s_mul_i32 s55, s55, 9216
v_mfma_f32_16x16x32_bf16 v[172:175], a[184:187], a[64:67], v[172:175]
s_and_b32 s53, s2, 1
s_lshl_b32 s53, s53, 9
ds_read_b128 a[64:67], v9 offset:0
v_mfma_f32_16x16x32_bf16 v[188:191], a[184:187], a[72:75], v[188:191]
s_add_u32 s55, s55, s53
ds_read_b64_tr_b16 a[132:133], v11 offset:8192
ds_read_b64_tr_b16 a[134:135], v11 offset:8704
v_mfma_f32_16x16x32_bf16 v[188:191], a[188:191], a[76:79], v[188:191]
v_min_u32 v20, 39, v1
v_and_b32 v21, 7, v20
v_mfma_f32_16x16x32_bf16 v[184:187], a[180:183], a[76:79], v[184:187]
v_mul_u32_u24 v21, 1152, v21
v_lshrrev_b32 v20, 3, v20
v_mfma_f32_16x16x32_bf16 v[184:187], a[176:179], a[72:75], v[184:187]
buffer_load_dwordx4 v8, s[16:19], s64 offen offset:1024 lds
v_mfma_f32_16x16x32_bf16 v[180:183], a[168:171], a[72:75], v[180:183]
ds_read_b128 a[68:71], v10 offset:0
v_lshl_add_u32 v21, v20, 7, v21
v_mfma_f32_16x16x32_bf16 v[180:183], a[172:175], a[76:79], v[180:183]
v_min_u32 v20, 6, v1
v_lshlrev_b32 v20, 7, v20
v_mfma_f32_16x16x32_bf16 v[176:179], a[164:167], a[76:79], v[176:179]
v_mfma_f32_16x16x32_bf16 v[176:179], a[160:163], a[72:75], v[176:179]
ds_read_b64_tr_b16 a[136:137], v12 offset:0
ds_read_b64_tr_b16 a[138:139], v12 offset:512
v_mfma_f32_16x16x32_bf16 v[192:195], a[160:163], a[80:83], v[192:195]
s_add_u32 m0, s77, 51200
s_add_u32 s64, s76, 131072
v_mfma_f32_16x16x32_bf16 v[192:195], a[164:167], a[84:87], v[192:195]
v_mfma_f32_16x16x32_bf16 v[196:199], a[172:175], a[84:87], v[196:199]
buffer_load_dwordx4 v7, s[16:19], s64 offen lds
v_mfma_f32_16x16x32_bf16 v[196:199], a[168:171], a[80:83], v[196:199]
ds_read_b128 a[72:75], v9 offset:2048
v_mfma_f32_16x16x32_bf16 v[200:203], a[176:179], a[80:83], v[200:203]
v_mfma_f32_16x16x32_bf16 v[200:203], a[180:183], a[84:87], v[200:203]
ds_read_b64_tr_b16 a[140:141], v12 offset:8192
ds_read_b64_tr_b16 a[142:143], v12 offset:8704
v_mfma_f32_16x16x32_bf16 v[204:207], a[188:191], a[84:87], v[204:207]
v_mfma_f32_16x16x32_bf16 v[204:207], a[184:187], a[80:83], v[204:207]
v_mfma_f32_16x16x32_bf16 v[220:223], a[184:187], a[88:91], v[220:223]
ds_read_b128 a[76:79], v10 offset:2048
v_mfma_f32_16x16x32_bf16 v[220:223], a[188:191], a[92:95], v[220:223]
buffer_load_dwordx4 v8, s[16:19], s64 offen offset:1024 lds
v_mfma_f32_16x16x32_bf16 v[216:219], a[180:183], a[92:95], v[216:219]
s_lshl_b32 s70, s93, 7
s_mul_i32 s68, s66, 36864
s_mul_i32 s69, s67, 36864
v_mfma_f32_16x16x32_bf16 v[216:219], a[176:179], a[88:91], v[216:219]
v_lshrrev_b32 v31, 3, v1
v_lshl_add_u32 v5, v31, 7, v5
v_mfma_f32_16x16x32_bf16 v[212:215], a[168:171], a[88:91], v[212:215]
v_lshl_add_u32 v6, v31, 7, v6
v_add_u32 v6, 1024, v6
v_mfma_f32_16x16x32_bf16 v[212:215], a[172:175], a[92:95], v[212:215]
s_mov_b32 s65, 1024
s_add_u32 s71, s68, s65
s_add_u32 s72, s69, s65
v_mfma_f32_16x16x32_bf16 v[208:211], a[164:167], a[92:95], v[208:211]
ds_read_b64_tr_b16 a[144:145], v13 offset:0
ds_read_b64_tr_b16 a[146:147], v13 offset:512
v_mfma_f32_16x16x32_bf16 v[208:211], a[160:163], a[88:91], v[208:211]
s_add_u32 m0, s73, 65536
s_add_u32 s64, s71, 0
ds_read_b128 a[80:83], v9 offset:4096
v_mfma_f32_16x16x32_bf16 v[224:227], a[160:163], a[96:99], v[224:227]
v_mfma_f32_16x16x32_bf16 v[224:227], a[164:167], a[100:103], v[224:227]
buffer_load_dwordx4 v5, s[12:15], s64 offen lds
v_mfma_f32_16x16x32_bf16 v[228:231], a[172:175], a[100:103], v[228:231]
ds_read_b64_tr_b16 a[148:149], v13 offset:8192
ds_read_b64_tr_b16 a[150:151], v13 offset:8704
v_mfma_f32_16x16x32_bf16 v[228:231], a[168:171], a[96:99], v[228:231]
v_mfma_f32_16x16x32_bf16 v[232:235], a[176:179], a[96:99], v[232:235]
v_mfma_f32_16x16x32_bf16 v[232:235], a[180:183], a[100:103], v[232:235]
ds_read_b128 a[84:87], v10 offset:4096
v_mfma_f32_16x16x32_bf16 v[236:239], a[188:191], a[100:103], v[236:239]
v_mfma_f32_16x16x32_bf16 v[236:239], a[184:187], a[96:99], v[236:239]
v_mfma_f32_16x16x32_bf16 v[252:255], a[184:187], a[104:107], v[252:255]
buffer_load_dwordx4 v6, s[12:15], s64 offen offset:1024 lds
v_mfma_f32_16x16x32_bf16 v[252:255], a[188:191], a[108:111], v[252:255]
ds_read_b64_tr_b16 a[152:153], v14 offset:0
ds_read_b64_tr_b16 a[154:155], v14 offset:512
v_mfma_f32_16x16x32_bf16 v[248:251], a[180:183], a[108:111], v[248:251]
v_mfma_f32_16x16x32_bf16 v[248:251], a[176:179], a[104:107], v[248:251]
v_mfma_f32_16x16x32_bf16 v[244:247], a[168:171], a[104:107], v[244:247]
ds_read_b128 a[88:91], v9 offset:6144
v_mfma_f32_16x16x32_bf16 v[244:247], a[172:175], a[108:111], v[244:247]
s_add_u32 m0, s73, 67584
s_add_u32 s64, s71, 18432
v_mfma_f32_16x16x32_bf16 v[240:243], a[164:167], a[108:111], v[240:243]
v_mfma_f32_16x16x32_bf16 v[240:243], a[160:163], a[104:107], v[240:243]
buffer_load_dwordx4 v5, s[12:15], s64 offen lds
v_mfma_f32_16x16x32_bf16 a[0:3], a[160:163], a[112:115], a[0:3]
ds_read_b64_tr_b16 a[156:157], v14 offset:8192
ds_read_b64_tr_b16 a[158:159], v14 offset:8704
v_mfma_f32_16x16x32_bf16 a[0:3], a[164:167], a[116:119], a[0:3]
v_mfma_f32_16x16x32_bf16 a[4:7], a[172:175], a[116:119], a[4:7]
s_waitcnt vmcnt(10)
ds_read_b128 a[92:95], v10 offset:6144
v_mfma_f32_16x16x32_bf16 a[4:7], a[168:171], a[112:115], a[4:7]
v_cmp_gt_u32 vcc, 18, v30
v_mfma_f32_16x16x32_bf16 a[8:11], a[176:179], a[112:115], a[8:11]
v_mfma_f32_16x16x32_bf16 a[8:11], a[180:183], a[116:119], a[8:11]
v_mfma_f32_16x16x32_bf16 a[12:15], a[188:191], a[116:119], a[12:15]
buffer_load_dwordx4 v6, s[12:15], s64 offen offset:1024 lds
v_mfma_f32_16x16x32_bf16 a[12:15], a[184:187], a[112:115], a[12:15]
v_mfma_f32_16x16x32_bf16 a[28:31], a[184:187], a[120:123], a[28:31]
s_cbranch_vccnz CK_WA
CK_WA_R:
v_mfma_f32_16x16x32_bf16 a[28:31], a[188:191], a[124:127], a[28:31]
v_mfma_f32_16x16x32_bf16 a[24:27], a[180:183], a[124:127], a[24:27]
v_mfma_f32_16x16x32_bf16 a[24:27], a[176:179], a[120:123], a[24:27]
v_mfma_f32_16x16x32_bf16 a[20:23], a[168:171], a[120:123], a[20:23]
v_mfma_f32_16x16x32_bf16 a[20:23], a[172:175], a[124:127], a[20:23]
v_mfma_f32_16x16x32_bf16 a[16:19], a[164:167], a[124:127], a[16:19]
v_mfma_f32_16x16x32_bf16 a[16:19], a[160:163], a[120:123], a[16:19]
s_waitcnt lgkmcnt(0)
v_mfma_f32_16x16x32_bf16 v[32:35], a[64:67], a[128:131], v[32:35]
s_waitcnt vmcnt(23)
v_mfma_f32_16x16x32_bf16 v[32:35], a[68:71], a[132:135], v[32:35]
s_barrier
v_mfma_f32_16x16x32_bf16 v[40:43], a[68:71], a[140:143], v[40:43]
ds_read_b128 a[96:99], v9 offset:8192
v_mfma_f32_16x16x32_bf16 v[40:43], a[64:67], a[136:139], v[40:43]
s_lshl_b32 s77, s3, 11
s_lshl_b32 s74, s3, 9
s_add_u32 s74, s74, s4
v_mfma_f32_16x16x32_bf16 v[48:51], a[64:67], a[144:147], v[48:51]
s_lshl_b32 s74, s74, 8
v_mfma_f32_16x16x32_bf16 v[48:51], a[68:71], a[148:151], v[48:51]
s_mov_b32 s75, 8
s_lshl_b32 s76, s75, 19
s_add_u32 s76, s76, s74
v_mfma_f32_16x16x32_bf16 v[56:59], a[68:71], a[156:159], v[56:59]
s_lshl_b32 s79, s75, 13
s_add_u32 s79, s79, s78
ds_read_b128 a[100:103], v10 offset:8192
v_mfma_f32_16x16x32_bf16 v[56:59], a[64:67], a[152:155], v[56:59]
s_add_u32 m0, s77, 0
s_add_u32 s64, s76, 0
v_mfma_f32_16x16x32_bf16 v[60:63], a[72:75], a[152:155], v[60:63]
buffer_load_dwordx4 v7, s[20:23], s64 offen lds
v_mfma_f32_16x16x32_bf16 v[60:63], a[76:79], a[156:159], v[60:63]
ds_read_b128 a[104:107], v9 offset:10240
v_mfma_f32_16x16x32_bf16 v[52:55], a[76:79], a[148:151], v[52:55]
buffer_load_dword a252, v21, s[32:35], s55 offen
v_mfma_f32_16x16x32_bf16 v[52:55], a[72:75], a[144:147], v[52:55]
ds_read_b64_tr_b16 a[160:161], v11 offset:16384
ds_read_b64_tr_b16 a[162:163], v11 offset:16896
v_mfma_f32_16x16x32_bf16 v[44:47], a[72:75], a[136:139], v[44:47]
buffer_load_dwordx4 v8, s[20:23], s64 offen offset:1024 lds
v_mfma_f32_16x16x32_bf16 v[44:47], a[76:79], a[140:143], v[44:47]
buffer_load_dword a253, v20, s[48:51], s54 offen
v_mfma_f32_16x16x32_bf16 v[36:39], a[76:79], a[132:135], v[36:39]
v_mfma_f32_16x16x32_bf16 v[36:39], a[72:75], a[128:131], v[36:39]
ds_read_b128 a[108:111], v10 offset:10240
v_mfma_f32_16x16x32_bf16 v[64:67], a[80:83], a[128:131], v[64:67]
v_mfma_f32_16x16x32_bf16 v[64:67], a[84:87], a[132:135], v[64:67]
v_mfma_f32_16x16x32_bf16 v[72:75], a[84:87], a[140:143], v[72:75]
s_add_u32 m0, s80, 0
s_add_u32 s64, s79, 0
v_mfma_f32_16x16x32_bf16 v[72:75], a[80:83], a[136:139], v[72:75]
ds_read_b64_tr_b16 a[164:165], v11 offset:24576
ds_read_b64_tr_b16 a[166:167], v11 offset:25088
v_mfma_f32_16x16x32_bf16 v[80:83], a[80:83], a[144:147], v[80:83]
buffer_load_dwordx4 v15, s[24:27], s64 offen sc1 lds
v_mfma_f32_16x16x32_bf16 v[80:83], a[84:87], a[148:151], v[80:83]
ds_read_b128 a[112:115], v9 offset:12288
v_mfma_f32_16x16x32_bf16 v[88:91], a[84:87], a[156:159], v[88:91]
v_mfma_f32_16x16x32_bf16 v[88:91], a[80:83], a[152:155], v[88:91]
v_mfma_f32_16x16x32_bf16 v[92:95], a[88:91], a[152:155], v[92:95]
ds_read_b64_tr_b16 a[168:169], v12 offset:16384
ds_read_b64_tr_b16 a[170:171], v12 offset:16896
v_mfma_f32_16x16x32_bf16 v[92:95], a[92:95], a[156:159], v[92:95]
v_mfma_f32_16x16x32_bf16 v[84:87], a[92:95], a[148:151], v[84:87]
s_add_u32 m0, s73, 69632
s_add_u32 s64, s72, 0
v_mfma_f32_16x16x32_bf16 v[84:87], a[88:91], a[144:147], v[84:87]
v_mfma_f32_16x16x32_bf16 v[76:79], a[88:91], a[136:139], v[76:79]
buffer_load_dwordx4 v5, s[12:15], s64 offen lds
v_mfma_f32_16x16x32_bf16 v[76:79], a[92:95], a[140:143], v[76:79]
ds_read_b128 a[116:119], v10 offset:12288
v_mfma_f32_16x16x32_bf16 v[68:71], a[92:95], a[132:135], v[68:71]
v_mfma_f32_16x16x32_bf16 v[68:71], a[88:91], a[128:131], v[68:71]
s_waitcnt lgkmcnt(6)
ds_read_b64_tr_b16 a[172:173], v12 offset:24576
ds_read_b64_tr_b16 a[174:175], v12 offset:25088
v_mfma_f32_16x16x32_bf16 v[96:99], a[96:99], a[128:131], v[96:99]
v_mfma_f32_16x16x32_bf16 v[96:99], a[100:103], a[132:135], v[96:99]
v_mfma_f32_16x16x32_bf16 v[104:107], a[100:103], a[140:143], v[104:107]
ds_read_b128 a[120:123], v9 offset:14336
v_mfma_f32_16x16x32_bf16 v[104:107], a[96:99], a[136:139], v[104:107]
v_mfma_f32_16x16x32_bf16 v[112:115], a[96:99], a[144:147], v[112:115]
v_mfma_f32_16x16x32_bf16 v[112:115], a[100:103], a[148:151], v[112:115]
buffer_load_dwordx4 v6, s[12:15], s64 offen offset:1024 lds
v_mfma_f32_16x16x32_bf16 v[120:123], a[100:103], a[156:159], v[120:123]
ds_read_b64_tr_b16 a[176:177], v13 offset:16384
ds_read_b64_tr_b16 a[178:179], v13 offset:16896
v_mfma_f32_16x16x32_bf16 v[120:123], a[96:99], a[152:155], v[120:123]
v_mfma_f32_16x16x32_bf16 v[124:127], a[104:107], a[152:155], v[124:127]
v_mfma_f32_16x16x32_bf16 v[124:127], a[108:111], a[156:159], v[124:127]
ds_read_b128 a[124:127], v10 offset:14336
v_mfma_f32_16x16x32_bf16 v[116:119], a[108:111], a[148:151], v[116:119]
v_add_u32 v9, 32768, v9
v_add_u32 v10, 32768, v10
v_mfma_f32_16x16x32_bf16 v[116:119], a[104:107], a[144:147], v[116:119]
s_add_u32 m0, s73, 71680
s_add_u32 s64, s72, 18432
v_mfma_f32_16x16x32_bf16 v[108:111], a[104:107], a[136:139], v[108:111]
ds_read_b64_tr_b16 a[180:181], v13 offset:24576
ds_read_b64_tr_b16 a[182:183], v13 offset:25088
v_mfma_f32_16x16x32_bf16 v[108:111], a[108:111], a[140:143], v[108:111]
buffer_load_dwordx4 v5, s[12:15], s64 offen lds
v_mfma_f32_16x16x32_bf16 v[100:103], a[108:111], a[132:135], v[100:103]
v_mfma_f32_16x16x32_bf16 v[100:103], a[104:107], a[128:131], v[100:103]
s_waitcnt lgkmcnt(2)
ds_read_b64_tr_b16 a[184:185], v14 offset:16384
ds_read_b64_tr_b16 a[186:187], v14 offset:16896
v_mfma_f32_16x16x32_bf16 v[128:131], a[112:115], a[128:131], v[128:131]
v_mfma_f32_16x16x32_bf16 v[128:131], a[116:119], a[132:135], v[128:131]
v_mfma_f32_16x16x32_bf16 v[136:139], a[116:119], a[140:143], v[136:139]
ds_read_b64_tr_b16 a[188:189], v14 offset:24576
ds_read_b64_tr_b16 a[190:191], v14 offset:25088
v_mfma_f32_16x16x32_bf16 v[136:139], a[112:115], a[136:139], v[136:139]
v_mfma_f32_16x16x32_bf16 v[144:147], a[112:115], a[144:147], v[144:147]
v_mfma_f32_16x16x32_bf16 v[144:147], a[116:119], a[148:151], v[144:147]
buffer_load_dwordx4 v6, s[12:15], s64 offen offset:1024 lds
v_mfma_f32_16x16x32_bf16 v[152:155], a[116:119], a[156:159], v[152:155]
v_mfma_f32_16x16x32_bf16 v[152:155], a[112:115], a[152:155], v[152:155]
v_mfma_f32_16x16x32_bf16 v[156:159], a[120:123], a[152:155], v[156:159]
v_mfma_f32_16x16x32_bf16 v[156:159], a[124:127], a[156:159], v[156:159]
v_mfma_f32_16x16x32_bf16 v[148:151], a[124:127], a[148:151], v[148:151]
v_mfma_f32_16x16x32_bf16 v[148:151], a[120:123], a[144:147], v[148:151]
v_mfma_f32_16x16x32_bf16 v[140:143], a[120:123], a[136:139], v[140:143]
v_mfma_f32_16x16x32_bf16 v[140:143], a[124:127], a[140:143], v[140:143]
v_mfma_f32_16x16x32_bf16 v[132:135], a[124:127], a[132:135], v[132:135]
v_mfma_f32_16x16x32_bf16 v[132:135], a[120:123], a[128:131], v[132:135]
s_waitcnt lgkmcnt(0)
v_mfma_f32_16x16x32_bf16 v[160:163], a[160:163], a[64:67], v[160:163]
s_waitcnt vmcnt(18)
v_mfma_f32_16x16x32_bf16 v[160:163], a[164:167], a[68:71], v[160:163]
s_barrier
v_mfma_f32_16x16x32_bf16 v[164:167], a[172:175], a[68:71], v[164:167]
ds_read_b64_tr_b16 a[128:129], v11 offset:32768
ds_read_b64_tr_b16 a[130:131], v11 offset:33280
v_mfma_f32_16x16x32_bf16 v[164:167], a[168:171], a[64:67], v[164:167]
s_add_u32 m0, s77, 16384
s_add_u32 s64, s76, 128
v_mfma_f32_16x16x32_bf16 v[168:171], a[176:179], a[64:67], v[168:171]
buffer_load_dwordx4 v7, s[20:23], s64 offen lds
v_mfma_f32_16x16x32_bf16 v[168:171], a[180:183], a[68:71], v[168:171]
v_mfma_f32_16x16x32_bf16 v[172:175], a[188:191], a[68:71], v[172:175]
v_mfma_f32_16x16x32_bf16 v[172:175], a[184:187], a[64:67], v[172:175]
ds_read_b128 a[64:67], v9 offset:0
v_mfma_f32_16x16x32_bf16 v[188:191], a[184:187], a[72:75], v[188:191]
ds_read_b64_tr_b16 a[132:133], v11 offset:40960
ds_read_b64_tr_b16 a[134:135], v11 offset:41472
v_mfma_f32_16x16x32_bf16 v[188:191], a[188:191], a[76:79], v[188:191]
v_mfma_f32_16x16x32_bf16 v[184:187], a[180:183], a[76:79], v[184:187]
v_mfma_f32_16x16x32_bf16 v[184:187], a[176:179], a[72:75], v[184:187]
ds_read_b128 a[68:71], v10 offset:0
v_mfma_f32_16x16x32_bf16 v[180:183], a[168:171], a[72:75], v[180:183]
buffer_load_dwordx4 v8, s[20:23], s64 offen offset:1024 lds
v_mfma_f32_16x16x32_bf16 v[180:183], a[172:175], a[76:79], v[180:183]
v_mfma_f32_16x16x32_bf16 v[176:179], a[164:167], a[76:79], v[176:179]
v_mfma_f32_16x16x32_bf16 v[176:179], a[160:163], a[72:75], v[176:179]
ds_read_b64_tr_b16 a[136:137], v12 offset:32768
ds_read_b64_tr_b16 a[138:139], v12 offset:33280
v_mfma_f32_16x16x32_bf16 v[192:195], a[160:163], a[80:83], v[192:195]
v_mfma_f32_16x16x32_bf16 v[192:195], a[164:167], a[84:87], v[192:195]
v_mfma_f32_16x16x32_bf16 v[196:199], a[172:175], a[84:87], v[196:199]
s_add_u32 m0, s80, 16384
s_add_u32 s64, s79, 2048
ds_read_b128 a[72:75], v9 offset:2048
v_mfma_f32_16x16x32_bf16 v[196:199], a[168:171], a[80:83], v[196:199]
v_mfma_f32_16x16x32_bf16 v[200:203], a[176:179], a[80:83], v[200:203]
buffer_load_dwordx4 v15, s[24:27], s64 offen sc1 lds
v_mfma_f32_16x16x32_bf16 v[200:203], a[180:183], a[84:87], v[200:203]
s_xor_b32 s65, s70, 0
s_add_u32 s71, s68, s65
s_add_u32 s72, s69, s65
v_mfma_f32_16x16x32_bf16 v[204:207], a[188:191], a[84:87], v[204:207]
ds_read_b64_tr_b16 a[140:141], v12 offset:40960
ds_read_b64_tr_b16 a[142:143], v12 offset:41472
v_mfma_f32_16x16x32_bf16 v[204:207], a[184:187], a[80:83], v[204:207]
v_mfma_f32_16x16x32_bf16 v[220:223], a[184:187], a[88:91], v[220:223]
ds_read_b128 a[76:79], v10 offset:2048
v_mfma_f32_16x16x32_bf16 v[220:223], a[188:191], a[92:95], v[220:223]
v_mfma_f32_16x16x32_bf16 v[216:219], a[180:183], a[92:95], v[216:219]
s_add_u32 m0, s73, 0
s_add_u32 s64, s71, 0
v_mfma_f32_16x16x32_bf16 v[216:219], a[176:179], a[88:91], v[216:219]
v_mfma_f32_16x16x32_bf16 v[212:215], a[168:171], a[88:91], v[212:215]
buffer_load_dwordx4 v5, s[12:15], s64 offen lds
v_mfma_f32_16x16x32_bf16 v[212:215], a[172:175], a[92:95], v[212:215]
ds_read_b64_tr_b16 a[144:145], v13 offset:32768
ds_read_b64_tr_b16 a[146:147], v13 offset:33280
v_mfma_f32_16x16x32_bf16 v[208:211], a[164:167], a[92:95], v[208:211]
v_mfma_f32_16x16x32_bf16 v[208:211], a[160:163], a[88:91], v[208:211]
ds_read_b128 a[80:83], v9 offset:4096
v_mfma_f32_16x16x32_bf16 v[224:227], a[160:163], a[96:99], v[224:227]
v_mfma_f32_16x16x32_bf16 v[224:227], a[164:167], a[100:103], v[224:227]
v_mfma_f32_16x16x32_bf16 v[228:231], a[172:175], a[100:103], v[228:231]
ds_read_b64_tr_b16 a[148:149], v13 offset:40960
ds_read_b64_tr_b16 a[150:151], v13 offset:41472
v_mfma_f32_16x16x32_bf16 v[228:231], a[168:171], a[96:99], v[228:231]
v_mfma_f32_16x16x32_bf16 v[232:235], a[176:179], a[96:99], v[232:235]
v_mfma_f32_16x16x32_bf16 v[232:235], a[180:183], a[100:103], v[232:235]
buffer_load_dwordx4 v6, s[12:15], s64 offen offset:1024 lds
v_mfma_f32_16x16x32_bf16 v[236:239], a[188:191], a[100:103], v[236:239]
ds_read_b128 a[84:87], v10 offset:4096
v_mfma_f32_16x16x32_bf16 v[236:239], a[184:187], a[96:99], v[236:239]
v_mfma_f32_16x16x32_bf16 v[252:255], a[184:187], a[104:107], v[252:255]
v_mfma_f32_16x16x32_bf16 v[252:255], a[188:191], a[108:111], v[252:255]
ds_read_b64_tr_b16 a[152:153], v14 offset:32768
ds_read_b64_tr_b16 a[154:155], v14 offset:33280
v_mfma_f32_16x16x32_bf16 v[248:251], a[180:183], a[108:111], v[248:251]
v_mfma_f32_16x16x32_bf16 v[248:251], a[176:179], a[104:107], v[248:251]
s_add_u32 m0, s73, 2048
s_add_u32 s64, s71, 18432
v_mfma_f32_16x16x32_bf16 v[244:247], a[168:171], a[104:107], v[244:247]
ds_read_b128 a[88:91], v9 offset:6144
v_mfma_f32_16x16x32_bf16 v[244:247], a[172:175], a[108:111], v[244:247]
buffer_load_dwordx4 v5, s[12:15], s64 offen lds
v_mfma_f32_16x16x32_bf16 v[240:243], a[164:167], a[108:111], v[240:243]
v_mfma_f32_16x16x32_bf16 v[240:243], a[160:163], a[104:107], v[240:243]
ds_read_b64_tr_b16 a[156:157], v14 offset:40960
ds_read_b64_tr_b16 a[158:159], v14 offset:41472
v_mfma_f32_16x16x32_bf16 a[0:3], a[160:163], a[112:115], a[0:3]
v_mfma_f32_16x16x32_bf16 a[0:3], a[164:167], a[116:119], a[0:3]
v_mfma_f32_16x16x32_bf16 a[4:7], a[172:175], a[116:119], a[4:7]
ds_read_b128 a[92:95], v10 offset:6144
v_mfma_f32_16x16x32_bf16 a[4:7], a[168:171], a[112:115], a[4:7]
v_mfma_f32_16x16x32_bf16 a[8:11], a[176:179], a[112:115], a[8:11]
v_mfma_f32_16x16x32_bf16 a[8:11], a[180:183], a[116:119], a[8:11]
buffer_load_dwordx4 v6, s[12:15], s64 offen offset:1024 lds
v_mfma_f32_16x16x32_bf16 a[12:15], a[188:191], a[116:119], a[12:15]
v_mfma_f32_16x16x32_bf16 a[12:15], a[184:187], a[112:115], a[12:15]
v_mfma_f32_16x16x32_bf16 a[28:31], a[184:187], a[120:123], a[28:31]
v_mfma_f32_16x16x32_bf16 a[28:31], a[188:191], a[124:127], a[28:31]
v_mfma_f32_16x16x32_bf16 a[24:27], a[180:183], a[124:127], a[24:27]
L_PAD3:
s_cbranch_execz L_PAD7
v_mfma_f32_16x16x32_bf16 a[24:27], a[176:179], a[120:123], a[24:27]
v_mfma_f32_16x16x32_bf16 a[20:23], a[168:171], a[120:123], a[20:23]
v_mfma_f32_16x16x32_bf16 a[20:23], a[172:175], a[124:127], a[20:23]
v_mfma_f32_16x16x32_bf16 a[16:19], a[164:167], a[124:127], a[16:19]
v_mfma_f32_16x16x32_bf16 a[16:19], a[160:163], a[120:123], a[16:19]
s_waitcnt lgkmcnt(0)
v_mfma_f32_16x16x32_bf16 v[32:35], a[64:67], a[128:131], v[32:35]
s_waitcnt vmcnt(20)
v_mfma_f32_16x16x32_bf16 v[32:35], a[68:71], a[132:135], v[32:35]
s_barrier
v_mfma_f32_16x16x32_bf16 v[40:43], a[68:71], a[140:143], v[40:43]
ds_read_b128 a[96:99], v9 offset:8192
v_mfma_f32_16x16x32_bf16 v[40:43], a[64:67], a[136:139], v[40:43]
s_xor_b32 s75, s93, 0
s_lshl_b32 s76, s75, 19
s_add_u32 s76, s76, s74
v_mfma_f32_16x16x32_bf16 v[48:51], a[64:67], a[144:147], v[48:51]
s_lshl_b32 s79, s75, 13
s_add_u32 s79, s79, s78
v_mfma_f32_16x16x32_bf16 v[48:51], a[68:71], a[148:151], v[48:51]
s_add_u32 m0, s77, 32768
s_add_u32 s64, s76, 0
ds_read_b128 a[100:103], v10 offset:8192
v_mfma_f32_16x16x32_bf16 v[56:59], a[68:71], a[156:159], v[56:59]
buffer_load_dwordx4 v7, s[20:23], s64 offen lds
v_mfma_f32_16x16x32_bf16 v[56:59], a[64:67], a[152:155], v[56:59]
v_mfma_f32_16x16x32_bf16 v[60:63], a[72:75], a[152:155], v[60:63]
ds_read_b128 a[104:107], v9 offset:10240
v_mfma_f32_16x16x32_bf16 v[60:63], a[76:79], a[156:159], v[60:63]
v_mfma_f32_16x16x32_bf16 v[52:55], a[76:79], a[148:151], v[52:55]
v_mfma_f32_16x16x32_bf16 v[52:55], a[72:75], a[144:147], v[52:55]
ds_read_b64_tr_b16 a[160:161], v11 offset:49152
ds_read_b64_tr_b16 a[162:163], v11 offset:49664
v_mfma_f32_16x16x32_bf16 v[44:47], a[72:75], a[136:139], v[44:47]
buffer_load_dwordx4 v8, s[20:23], s64 offen offset:1024 lds
v_mfma_f32_16x16x32_bf16 v[44:47], a[76:79], a[140:143], v[44:47]
v_mfma_f32_16x16x32_bf16 v[36:39], a[76:79], a[132:135], v[36:39]
v_mfma_f32_16x16x32_bf16 v[36:39], a[72:75], a[128:131], v[36:39]
ds_read_b128 a[108:111], v10 offset:10240
v_mfma_f32_16x16x32_bf16 v[64:67], a[80:83], a[128:131], v[64:67]
v_mfma_f32_16x16x32_bf16 v[64:67], a[84:87], a[132:135], v[64:67]
v_mfma_f32_16x16x32_bf16 v[72:75], a[84:87], a[140:143], v[72:75]
s_add_u32 m0, s80, 32768
s_add_u32 s64, s79, 0
v_mfma_f32_16x16x32_bf16 v[72:75], a[80:83], a[136:139], v[72:75]
ds_read_b64_tr_b16 a[164:165], v11 offset:57344
ds_read_b64_tr_b16 a[166:167], v11 offset:57856
v_mfma_f32_16x16x32_bf16 v[80:83], a[80:83], a[144:147], v[80:83]
buffer_load_dwordx4 v15, s[24:27], s64 offen sc1 lds
v_mfma_f32_16x16x32_bf16 v[80:83], a[84:87], a[148:151], v[80:83]
ds_read_b128 a[112:115], v9 offset:12288
v_mfma_f32_16x16x32_bf16 v[88:91], a[84:87], a[156:159], v[88:91]
v_cvt_pk_bf16_f32 v32, v32, v33
v_cvt_pk_bf16_f32 v33, v34, v35
v_mfma_f32_16x16x32_bf16 v[88:91], a[80:83], a[152:155], v[88:91]
v_cvt_pk_bf16_f32 v34, v36, v37
v_cvt_pk_bf16_f32 v35, v38, v39
v_mfma_f32_16x16x32_bf16 v[92:95], a[88:91], a[152:155], v[92:95]
ds_read_b64_tr_b16 a[168:169], v12 offset:49152
ds_read_b64_tr_b16 a[170:171], v12 offset:49664
v_mfma_f32_16x16x32_bf16 v[92:95], a[92:95], a[156:159], v[92:95]
v_cvt_pk_bf16_f32 v40, v40, v41
v_cvt_pk_bf16_f32 v41, v42, v43
v_mfma_f32_16x16x32_bf16 v[84:87], a[92:95], a[148:151], v[84:87]
s_add_u32 m0, s73, 4096
s_add_u32 s64, s72, 0
s_lshr_b32 s55, s3, 1
v_mfma_f32_16x16x32_bf16 v[84:87], a[88:91], a[144:147], v[84:87]
s_lshl_b32 s55, s55, 14
s_lshl_b32 s54, s3, 13
s_sub_u32 s55, s54, s55
v_mfma_f32_16x16x32_bf16 v[76:79], a[88:91], a[136:139], v[76:79]
buffer_load_dwordx4 v5, s[12:15], s64 offen lds
v_mfma_f32_16x16x32_bf16 v[76:79], a[92:95], a[140:143], v[76:79]
s_and_b32 s54, s3, 1
s_lshl_b32 s54, s54, 12
ds_read_b128 a[116:119], v10 offset:12288
v_mfma_f32_16x16x32_bf16 v[68:71], a[92:95], a[132:135], v[68:71]
s_add_u32 s53, s88, 0
v_cvt_pk_bf16_f32 v42, v44, v45
v_cvt_pk_bf16_f32 v43, v46, v47
v_mfma_f32_16x16x32_bf16 v[68:71], a[88:91], a[128:131], v[68:71]
s_waitcnt lgkmcnt(6)
ds_read_b64_tr_b16 a[172:173], v12 offset:57344
ds_read_b64_tr_b16 a[174:175], v12 offset:57856
v_mfma_f32_16x16x32_bf16 v[96:99], a[96:99], a[128:131], v[96:99]
buffer_store_dwordx4 v[32:35], v15, s[24:27], s53 offen offset:0 sc1
v_mfma_f32_16x16x32_bf16 v[96:99], a[100:103], a[132:135], v[96:99]
v_cvt_pk_bf16_f32 v48, v48, v49
v_cvt_pk_bf16_f32 v49, v50, v51
v_mfma_f32_16x16x32_bf16 v[104:107], a[100:103], a[140:143], v[104:107]
ds_read_b128 a[120:123], v9 offset:14336
v_cvt_pk_bf16_f32 v50, v52, v53
v_mfma_f32_16x16x32_bf16 v[104:107], a[96:99], a[136:139], v[104:107]
v_cvt_pk_bf16_f32 v51, v54, v55
v_cvt_pk_bf16_f32 v56, v56, v57
v_mfma_f32_16x16x32_bf16 v[112:115], a[96:99], a[144:147], v[112:115]
v_cvt_pk_bf16_f32 v57, v58, v59
v_cvt_pk_bf16_f32 v58, v60, v61
v_mfma_f32_16x16x32_bf16 v[112:115], a[100:103], a[148:151], v[112:115]
buffer_load_dwordx4 v6, s[12:15], s64 offen offset:1024 lds
v_mfma_f32_16x16x32_bf16 v[120:123], a[100:103], a[156:159], v[120:123]
ds_read_b64_tr_b16 a[176:177], v13 offset:49152
ds_read_b64_tr_b16 a[178:179], v13 offset:49664
v_mfma_f32_16x16x32_bf16 v[120:123], a[96:99], a[152:155], v[120:123]
v_cvt_pk_bf16_f32 v59, v62, v63
v_cvt_pk_bf16_f32 v64, v64, v65
v_mfma_f32_16x16x32_bf16 v[124:127], a[104:107], a[152:155], v[124:127]
v_cvt_pk_bf16_f32 v65, v66, v67
v_cvt_pk_bf16_f32 v66, v68, v69
v_mfma_f32_16x16x32_bf16 v[124:127], a[108:111], a[156:159], v[124:127]
ds_read_b128 a[124:127], v10 offset:14336
v_cvt_pk_bf16_f32 v67, v70, v71
v_mfma_f32_16x16x32_bf16 v[116:119], a[108:111], a[148:151], v[116:119]
v_add_u32 v9, 32768, v9
v_add_u32 v10, 32768, v10
v_mfma_f32_16x16x32_bf16 v[116:119], a[104:107], a[144:147], v[116:119]
s_add_u32 m0, s73, 6144
s_add_u32 s64, s72, 18432
v_cvt_pk_bf16_f32 v72, v72, v73
v_mfma_f32_16x16x32_bf16 v[108:111], a[104:107], a[136:139], v[108:111]
ds_read_b64_tr_b16 a[180:181], v13 offset:57344
ds_read_b64_tr_b16 a[182:183], v13 offset:57856
v_mfma_f32_16x16x32_bf16 v[108:111], a[108:111], a[140:143], v[108:111]
buffer_load_dwordx4 v5, s[12:15], s64 offen lds
v_mfma_f32_16x16x32_bf16 v[100:103], a[108:111], a[132:135], v[100:103]
v_cvt_pk_bf16_f32 v73, v74, v75
v_cvt_pk_bf16_f32 v74, v76, v77
v_mfma_f32_16x16x32_bf16 v[100:103], a[104:107], a[128:131], v[100:103]
s_waitcnt lgkmcnt(2)
ds_read_b64_tr_b16 a[184:185], v14 offset:49152
ds_read_b64_tr_b16 a[186:187], v14 offset:49664
v_mfma_f32_16x16x32_bf16 v[128:131], a[112:115], a[128:131], v[128:131]
v_cvt_pk_bf16_f32 v75, v78, v79
v_cvt_pk_bf16_f32 v80, v80, v81
v_mfma_f32_16x16x32_bf16 v[128:131], a[116:119], a[132:135], v[128:131]
v_cvt_pk_bf16_f32 v81, v82, v83
v_cvt_pk_bf16_f32 v82, v84, v85
v_mfma_f32_16x16x32_bf16 v[136:139], a[116:119], a[140:143], v[136:139]
ds_read_b64_tr_b16 a[188:189], v14 offset:57344
ds_read_b64_tr_b16 a[190:191], v14 offset:57856
v_mfma_f32_16x16x32_bf16 v[136:139], a[112:115], a[136:139], v[136:139]
v_add_u32 v9, s55, v9
v_add_u32 v10, s55, v10
v_mfma_f32_16x16x32_bf16 v[144:147], a[112:115], a[144:147], v[144:147]
v_subrev_u32 v11, s54, v11
v_subrev_u32 v12, s54, v12
v_mfma_f32_16x16x32_bf16 v[144:147], a[116:119], a[148:151], v[144:147]
buffer_load_dwordx4 v6, s[12:15], s64 offen offset:1024 lds
v_mfma_f32_16x16x32_bf16 v[152:155], a[116:119], a[156:159], v[152:155]
v_subrev_u32 v13, s54, v13
v_subrev_u32 v14, s54, v14
v_mfma_f32_16x16x32_bf16 v[152:155], a[112:115], a[152:155], v[152:155]
v_cvt_pk_bf16_f32 v83, v86, v87
v_cvt_pk_bf16_f32 v88, v88, v89
v_mfma_f32_16x16x32_bf16 v[156:159], a[120:123], a[152:155], v[156:159]
v_cvt_pk_bf16_f32 v89, v90, v91
v_cvt_pk_bf16_f32 v90, v92, v93
v_mfma_f32_16x16x32_bf16 v[156:159], a[124:127], a[156:159], v[156:159]
s_add_u32 s53, s88, 0
v_cvt_pk_bf16_f32 v91, v94, v95
v_cvt_pk_bf16_f32 v96, v96, v97
v_mfma_f32_16x16x32_bf16 v[148:151], a[124:127], a[148:151], v[148:151]
buffer_store_dwordx4 v[40:43], v15, s[24:27], s53 offen offset:1024 sc1
v_mfma_f32_16x16x32_bf16 v[148:151], a[120:123], a[144:147], v[148:151]
v_cvt_pk_bf16_f32 v97, v98, v99
v_cvt_pk_bf16_f32 v98, v100, v101
v_mfma_f32_16x16x32_bf16 v[140:143], a[120:123], a[136:139], v[140:143]
v_cvt_pk_bf16_f32 v99, v102, v103
v_cvt_pk_bf16_f32 v104, v104, v105
v_mfma_f32_16x16x32_bf16 v[140:143], a[124:127], a[140:143], v[140:143]
v_cvt_pk_bf16_f32 v105, v106, v107
v_cvt_pk_bf16_f32 v106, v108, v109
v_mfma_f32_16x16x32_bf16 v[132:135], a[124:127], a[132:135], v[132:135]
v_cvt_pk_bf16_f32 v107, v110, v111
v_cvt_pk_bf16_f32 v112, v112, v113
v_mfma_f32_16x16x32_bf16 v[132:135], a[120:123], a[128:131], v[132:135]
s_waitcnt lgkmcnt(0)
v_cvt_pk_bf16_f32 v113, v114, v115
v_cvt_pk_bf16_f32 v114, v116, v117
v_mfma_f32_16x16x32_bf16 v[160:163], a[160:163], a[64:67], v[160:163]
s_waitcnt vmcnt(16)
v_cvt_pk_bf16_f32 v115, v118, v119
v_cvt_pk_bf16_f32 v120, v120, v121
v_mfma_f32_16x16x32_bf16 v[160:163], a[164:167], a[68:71], v[160:163]
s_barrier
v_mfma_f32_16x16x32_bf16 v[164:167], a[172:175], a[68:71], v[164:167]
ds_read_b64_tr_b16 a[128:129], v11 offset:0
ds_read_b64_tr_b16 a[130:131], v11 offset:512
v_mfma_f32_16x16x32_bf16 v[164:167], a[168:171], a[64:67], v[164:167]
s_add_u32 m0, s77, 49152
s_add_u32 s64, s76, 128
v_cvt_pk_bf16_f32 v121, v122, v123
v_mfma_f32_16x16x32_bf16 v[168:171], a[176:179], a[64:67], v[168:171]
buffer_load_dwordx4 v7, s[20:23], s64 offen lds
v_mfma_f32_16x16x32_bf16 v[168:171], a[180:183], a[68:71], v[168:171]
ds_read_b64_tr_b16 a[132:133], v11 offset:4096
ds_read_b64_tr_b16 a[134:135], v11 offset:4608
v_mfma_f32_16x16x32_bf16 v[172:175], a[188:191], a[68:71], v[172:175]
v_cvt_pk_bf16_f32 v122, v124, v125
v_cvt_pk_bf16_f32 v123, v126, v127
v_mfma_f32_16x16x32_bf16 v[172:175], a[184:187], a[64:67], v[172:175]
v_cvt_pk_bf16_f32 v128, v128, v129
v_cvt_pk_bf16_f32 v129, v130, v131
v_mfma_f32_16x16x32_bf16 v[188:191], a[184:187], a[72:75], v[188:191]
ds_read_b64_tr_b16 a[136:137], v12 offset:0
ds_read_b64_tr_b16 a[138:139], v12 offset:512
v_mfma_f32_16x16x32_bf16 v[188:191], a[188:191], a[76:79], v[188:191]
v_cvt_pk_bf16_f32 v130, v132, v133
v_cvt_pk_bf16_f32 v131, v134, v135
v_mfma_f32_16x16x32_bf16 v[184:187], a[180:183], a[76:79], v[184:187]
v_cvt_pk_bf16_f32 v136, v136, v137
v_cvt_pk_bf16_f32 v137, v138, v139
v_mfma_f32_16x16x32_bf16 v[184:187], a[176:179], a[72:75], v[184:187]
ds_read_b64_tr_b16 a[140:141], v12 offset:4096
ds_read_b64_tr_b16 a[142:143], v12 offset:4608
v_mfma_f32_16x16x32_bf16 v[180:183], a[168:171], a[72:75], v[180:183]
buffer_load_dwordx4 v8, s[20:23], s64 offen offset:1024 lds
v_mfma_f32_16x16x32_bf16 v[180:183], a[172:175], a[76:79], v[180:183]
v_cvt_pk_bf16_f32 v138, v140, v141
v_cvt_pk_bf16_f32 v139, v142, v143
v_mfma_f32_16x16x32_bf16 v[176:179], a[164:167], a[76:79], v[176:179]
v_cvt_pk_bf16_f32 v144, v144, v145
v_cvt_pk_bf16_f32 v145, v146, v147
v_mfma_f32_16x16x32_bf16 v[176:179], a[160:163], a[72:75], v[176:179]
ds_read_b64_tr_b16 a[144:145], v13 offset:0
ds_read_b64_tr_b16 a[146:147], v13 offset:512
v_mfma_f32_16x16x32_bf16 v[192:195], a[160:163], a[80:83], v[192:195]
v_cvt_pk_bf16_f32 v146, v148, v149
v_cvt_pk_bf16_f32 v147, v150, v151
v_mfma_f32_16x16x32_bf16 v[192:195], a[164:167], a[84:87], v[192:195]
v_cvt_pk_bf16_f32 v152, v152, v153
v_cvt_pk_bf16_f32 v153, v154, v155
v_mfma_f32_16x16x32_bf16 v[196:199], a[172:175], a[84:87], v[196:199]
s_add_u32 m0, s80, 49152
s_add_u32 s64, s79, 2048
v_cvt_pk_bf16_f32 v154, v156, v157
v_mfma_f32_16x16x32_bf16 v[196:199], a[168:171], a[80:83], v[196:199]
ds_read_b64_tr_b16 a[148:149], v13 offset:4096
ds_read_b64_tr_b16 a[150:151], v13 offset:4608
v_mfma_f32_16x16x32_bf16 v[200:203], a[176:179], a[80:83], v[200:203]
buffer_load_dwordx4 v15, s[24:27], s64 offen sc1 lds
v_mfma_f32_16x16x32_bf16 v[200:203], a[180:183], a[84:87], v[200:203]
s_xor_b32 s65, s70, 128
s_add_u32 s71, s68, s65
s_add_u32 s72, s69, s65
v_mfma_f32_16x16x32_bf16 v[204:207], a[188:191], a[84:87], v[204:207]
s_add_u32 s53, s88, 0
ds_read_b64_tr_b16 a[152:153], v14 offset:0
ds_read_b64_tr_b16 a[154:155], v14 offset:512
v_mfma_f32_16x16x32_bf16 v[204:207], a[184:187], a[80:83], v[204:207]
buffer_store_dwordx4 v[48:51], v15, s[24:27], s53 offen offset:2048 sc1
v_mfma_f32_16x16x32_bf16 v[220:223], a[184:187], a[88:91], v[220:223]
ds_read_b64_tr_b16 a[156:157], v14 offset:4096
ds_read_b64_tr_b16 a[158:159], v14 offset:4608
v_mfma_f32_16x16x32_bf16 v[220:223], a[188:191], a[92:95], v[220:223]
v_cvt_pk_bf16_f32 v155, v158, v159
v_mul_f32 v160, s91, v160
v_mfma_f32_16x16x32_bf16 v[216:219], a[180:183], a[92:95], v[216:219]
s_add_u32 m0, s73, 32768
s_add_u32 s64, s71, 0
v_mul_f32 v161, s91, v161
v_mfma_f32_16x16x32_bf16 v[216:219], a[176:179], a[88:91], v[216:219]
v_mul_f32 v162, s91, v162
v_mul_f32 v163, s91, v163
v_mfma_f32_16x16x32_bf16 v[212:215], a[168:171], a[88:91], v[212:215]
buffer_load_dwordx4 v5, s[12:15], s64 offen lds
v_mfma_f32_16x16x32_bf16 v[212:215], a[172:175], a[92:95], v[212:215]
ds_read_b128 a[68:71], v4 offset:10240
v_mul_f32 v164, s91, v164
v_mfma_f32_16x16x32_bf16 v[208:211], a[164:167], a[92:95], v[208:211]
v_mul_f32 v165, s91, v165
v_mul_f32 v166, s91, v166
v_mfma_f32_16x16x32_bf16 v[208:211], a[160:163], a[88:91], v[208:211]
ds_read_b128 a[64:67], v4 offset:8192
v_mul_f32 v167, s91, v167
v_mfma_f32_16x16x32_bf16 v[224:227], a[160:163], a[96:99], v[224:227]
v_cvt_pk_bf16_f32 v160, v160, v161
v_cvt_pk_bf16_f32 v161, v162, v163
v_mfma_f32_16x16x32_bf16 v[224:227], a[164:167], a[100:103], v[224:227]
v_cvt_pk_bf16_f32 v162, v164, v165
v_cvt_pk_bf16_f32 v163, v166, v167
v_mfma_f32_16x16x32_bf16 v[228:231], a[172:175], a[100:103], v[228:231]
ds_read_b128 a[76:79], v4 offset:11264
v_mul_f32 v168, s91, v168
v_mfma_f32_16x16x32_bf16 v[228:231], a[168:171], a[96:99], v[228:231]
v_mul_f32 v169, s91, v169
v_mul_f32 v170, s91, v170
v_mfma_f32_16x16x32_bf16 v[232:235], a[176:179], a[96:99], v[232:235]
v_mul_f32 v171, s91, v171
v_mul_f32 v172, s91, v172
v_mfma_f32_16x16x32_bf16 v[232:235], a[180:183], a[100:103], v[232:235]
buffer_load_dwordx4 v6, s[12:15], s64 offen offset:1024 lds
v_mfma_f32_16x16x32_bf16 v[236:239], a[188:191], a[100:103], v[236:239]
ds_read_b128 a[72:75], v4 offset:9216
v_mul_f32 v173, s91, v173
v_mfma_f32_16x16x32_bf16 v[236:239], a[184:187], a[96:99], v[236:239]
v_mul_f32 v174, s91, v174
v_mul_f32 v175, s91, v175
v_mfma_f32_16x16x32_bf16 v[252:255], a[184:187], a[104:107], v[252:255]
v_cvt_pk_bf16_f32 v168, v168, v169
v_cvt_pk_bf16_f32 v169, v170, v171
v_mfma_f32_16x16x32_bf16 v[252:255], a[188:191], a[108:111], v[252:255]
ds_read_b128 a[84:87], v10 offset:0
v_cvt_pk_bf16_f32 v170, v172, v173
v_mfma_f32_16x16x32_bf16 v[248:251], a[180:183], a[108:111], v[248:251]
v_cvt_pk_bf16_f32 v171, v174, v175
v_mul_f32 v176, s91, v176
v_mfma_f32_16x16x32_bf16 v[248:251], a[176:179], a[104:107], v[248:251]
s_add_u32 m0, s73, 34816
s_add_u32 s64, s71, 18432
v_mul_f32 v177, s91, v177
v_mfma_f32_16x16x32_bf16 v[244:247], a[168:171], a[104:107], v[244:247]
ds_read_b128 a[80:83], v9 offset:0
v_mul_f32 v178, s91, v178
v_mfma_f32_16x16x32_bf16 v[244:247], a[172:175], a[108:111], v[244:247]
buffer_load_dwordx4 v5, s[12:15], s64 offen lds
v_mfma_f32_16x16x32_bf16 v[240:243], a[164:167], a[108:111], v[240:243]
v_mul_f32 v179, s91, v179
v_mul_f32 v180, s91, v180
v_mfma_f32_16x16x32_bf16 v[240:243], a[160:163], a[104:107], v[240:243]
s_add_u32 s53, s88, 0
ds_read_b128 a[92:95], v10 offset:2048
v_mul_f32 v181, s91, v181
v_mfma_f32_16x16x32_bf16 a[0:3], a[160:163], a[112:115], a[0:3]
buffer_store_dwordx4 v[56:59], v15, s[24:27], s53 offen offset:3072 sc1
v_mfma_f32_16x16x32_bf16 a[0:3], a[164:167], a[116:119], a[0:3]
v_mul_f32 v182, s91, v182
v_mul_f32 v183, s91, v183
v_mfma_f32_16x16x32_bf16 a[4:7], a[172:175], a[116:119], a[4:7]
ds_read_b128 a[88:91], v9 offset:2048
v_cvt_pk_bf16_f32 v176, v176, v177
v_mfma_f32_16x16x32_bf16 a[4:7], a[168:171], a[112:115], a[4:7]
v_cvt_pk_bf16_f32 v177, v178, v179
v_cvt_pk_bf16_f32 v178, v180, v181
v_mfma_f32_16x16x32_bf16 a[8:11], a[176:179], a[112:115], a[8:11]
v_cvt_pk_bf16_f32 v179, v182, v183
v_mul_f32 v184, s91, v184
v_mfma_f32_16x16x32_bf16 a[8:11], a[180:183], a[116:119], a[8:11]
buffer_load_dwordx4 v6, s[12:15], s64 offen offset:1024 lds
v_mfma_f32_16x16x32_bf16 a[12:15], a[188:191], a[116:119], a[12:15]
v_mul_f32 v185, s91, v185
v_mul_f32 v186, s91, v186
v_mfma_f32_16x16x32_bf16 a[12:15], a[184:187], a[112:115], a[12:15]
v_mul_f32 v187, s91, v187
v_mul_f32 v188, s91, v188
v_mfma_f32_16x16x32_bf16 a[28:31], a[184:187], a[120:123], a[28:31]
v_mul_f32 v189, s91, v189
v_mul_f32 v190, s91, v190
v_mfma_f32_16x16x32_bf16 a[28:31], a[188:191], a[124:127], a[28:31]
v_mul_f32 v191, s91, v191
v_cvt_pk_bf16_f32 v184, v184, v185
v_mfma_f32_16x16x32_bf16 a[24:27], a[180:183], a[124:127], a[24:27]
v_cvt_pk_bf16_f32 v185, v186, v187
v_cvt_pk_bf16_f32 v186, v188, v189
v_mfma_f32_16x16x32_bf16 a[24:27], a[176:179], a[120:123], a[24:27]
v_cvt_pk_bf16_f32 v187, v190, v191
v_mul_f32 v192, s91, v192
v_mfma_f32_16x16x32_bf16 a[20:23], a[168:171], a[120:123], a[20:23]
v_mul_f32 v193, s91, v193
v_mul_f32 v194, s91, v194
v_mfma_f32_16x16x32_bf16 a[20:23], a[172:175], a[124:127], a[20:23]
v_mul_f32 v195, s91, v195
v_mul_f32 v196, s91, v196
v_mfma_f32_16x16x32_bf16 a[16:19], a[164:167], a[124:127], a[16:19]
v_mul_f32 v197, s91, v197
v_mul_f32 v198, s91, v198
v_mfma_f32_16x16x32_bf16 a[16:19], a[160:163], a[120:123], a[16:19]
s_waitcnt lgkmcnt(0)
v_mul_f32 v199, s91, v199
v_cvt_pk_bf16_f32 v192, v192, v193
v_mfma_f32_16x16x32_bf16 v[36:39], a[128:131], a[80:83], 0
s_waitcnt vmcnt(22)
v_cvt_pk_bf16_f32 v193, v194, v195
v_cvt_pk_bf16_f32 v194, v196, v197
v_mfma_f32_16x16x32_bf16 v[36:39], a[132:135], a[84:87], v[36:39]
s_barrier
v_mfma_f32_16x16x32_bf16 v[44:47], a[140:143], a[84:87], 0
ds_read_b128 a[96:99], v9 offset:4096
v_cvt_pk_bf16_f32 v195, v198, v199
v_mfma_f32_16x16x32_bf16 v[44:47], a[136:139], a[80:83], v[44:47]
s_xor_b32 s75, s93, 1
s_lshl_b32 s76, s75, 19
s_add_u32 s76, s76, s74
v_mfma_f32_16x16x32_bf16 v[32:35], a[144:147], a[80:83], 0
s_lshl_b32 s79, s75, 13
s_add_u32 s79, s79, s78
ds_read_b128 a[100:103], v10 offset:4096
v_mfma_f32_16x16x32_bf16 v[32:35], a[148:151], a[84:87], v[32:35]
s_add_u32 m0, s77, 0
s_add_u32 s64, s76, 0
ds_read_b128 a[104:107], v9 offset:6144
v_mfma_f32_16x16x32_bf16 v[52:55], a[156:159], a[84:87], 0
buffer_load_dwordx4 v7, s[20:23], s64 offen lds
v_mfma_f32_16x16x32_bf16 v[52:55], a[152:155], a[80:83], v[52:55]
ds_read_b64_tr_b16 a[160:161], v11 offset:16384
ds_read_b64_tr_b16 a[162:163], v11 offset:16896
v_mfma_f32_16x16x32_bf16 v[60:63], a[64:67], a[80:83], 0
v_mul_f32 v200, s91, v200
v_mul_f32 v201, s91, v201
v_mfma_f32_16x16x32_bf16 v[60:63], a[68:71], a[84:87], v[60:63]
ds_read_b128 a[108:111], v10 offset:6144
v_mul_f32 v202, s91, v202
v_mfma_f32_16x16x32_bf16 v[68:71], a[76:79], a[84:87], 0
buffer_load_dwordx4 v8, s[20:23], s64 offen offset:1024 lds
v_mfma_f32_16x16x32_bf16 v[68:71], a[72:75], a[80:83], v[68:71]
s_add_u32 s53, s88, 262144
ds_read_b64_tr_b16 a[164:165], v11 offset:20480
ds_read_b64_tr_b16 a[166:167], v11 offset:20992
v_mfma_f32_16x16x32_bf16 v[76:79], a[72:75], a[88:91], 0
v_add_u32 v9, -65536, v9
v_add_u32 v10, -65536, v10
v_mfma_f32_16x16x32_bf16 v[76:79], a[76:79], a[92:95], v[76:79]
ds_read_b64_tr_b16 a[168:169], v12 offset:16384
ds_read_b64_tr_b16 a[170:171], v12 offset:16896
v_mfma_f32_16x16x32_bf16 v[84:87], a[68:71], a[92:95], 0
s_add_u32 m0, s80, 0
s_add_u32 s64, s79, 0
v_mul_f32 v203, s91, v203
v_mfma_f32_16x16x32_bf16 v[84:87], a[64:67], a[88:91], v[84:87]
ds_read_b64_tr_b16 a[172:173], v12 offset:20480
ds_read_b64_tr_b16 a[174:175], v12 offset:20992
v_mfma_f32_16x16x32_bf16 v[92:95], a[152:155], a[88:91], 0
buffer_load_dwordx4 v15, s[24:27], s64 offen sc1 lds
v_mfma_f32_16x16x32_bf16 v[92:95], a[156:159], a[92:95], v[92:95]
buffer_store_dwordx4 v[64:67], v15, s[24:27], s53 offen offset:0 sc1
v_mfma_f32_16x16x32_bf16 v[40:43], a[148:151], a[92:95], 0
ds_read_b64_tr_b16 a[176:177], v13 offset:16384
ds_read_b64_tr_b16 a[178:179], v13 offset:16896
v_mfma_f32_16x16x32_bf16 v[40:43], a[144:147], a[88:91], v[40:43]
v_mul_f32 v204, s91, v204
v_mul_f32 v205, s91, v205
v_mfma_f32_16x16x32_bf16 v[100:103], a[136:139], a[88:91], 0
s_add_u32 m0, s73, 36864
s_add_u32 s64, s72, 0
v_mul_f32 v206, s91, v206
v_mfma_f32_16x16x32_bf16 v[100:103], a[140:143], a[92:95], v[100:103]
ds_read_b64_tr_b16 a[180:181], v13 offset:20480
ds_read_b64_tr_b16 a[182:183], v13 offset:20992
v_mfma_f32_16x16x32_bf16 v[108:111], a[132:135], a[92:95], 0
buffer_load_dwordx4 v5, s[12:15], s64 offen lds
v_mfma_f32_16x16x32_bf16 v[108:111], a[128:131], a[88:91], v[108:111]
s_waitcnt lgkmcnt(14)
ds_read_b64_tr_b16 a[184:185], v14 offset:16384
ds_read_b64_tr_b16 a[186:187], v14 offset:16896
v_mfma_f32_16x16x32_bf16 v[116:119], a[128:131], a[96:99], 0
ds_read_b64_tr_b16 a[188:189], v14 offset:20480
ds_read_b64_tr_b16 a[190:191], v14 offset:20992
v_mfma_f32_16x16x32_bf16 v[116:119], a[132:135], a[100:103], v[116:119]
v_mul_f32 v207, s91, v207
v_cvt_pk_bf16_f32 v200, v200, v201
v_mfma_f32_16x16x32_bf16 v[124:127], a[140:143], a[100:103], 0
v_cvt_pk_bf16_f32 v201, v202, v203
v_cvt_pk_bf16_f32 v202, v204, v205
v_mfma_f32_16x16x32_bf16 v[124:127], a[136:139], a[96:99], v[124:127]
ds_read_b128 a[112:115], v4 offset:24576
v_cvt_pk_bf16_f32 v203, v206, v207
v_mfma_f32_16x16x32_bf16 v[132:135], a[144:147], a[96:99], 0
buffer_load_dwordx4 v6, s[12:15], s64 offen offset:1024 lds
v_mfma_f32_16x16x32_bf16 v[132:135], a[148:151], a[100:103], v[132:135]
ds_read_b128 a[116:119], v4 offset:26624
v_mul_f32 v208, s91, v208
v_mfma_f32_16x16x32_bf16 v[140:143], a[156:159], a[100:103], 0
v_mul_f32 v209, s91, v209
v_mul_f32 v210, s91, v210
v_mfma_f32_16x16x32_bf16 v[140:143], a[152:155], a[96:99], v[140:143]
ds_read_b128 a[120:123], v4 offset:25600
v_mul_f32 v211, s91, v211
v_mfma_f32_16x16x32_bf16 v[148:151], a[64:67], a[96:99], 0
s_add_u32 m0, s73, 38912
s_add_u32 s64, s72, 18432
v_mul_f32 v212, s91, v212
v_mfma_f32_16x16x32_bf16 v[148:151], a[68:71], a[100:103], v[148:151]
ds_read_b128 a[124:127], v4 offset:27648
v_mul_f32 v213, s91, v213
v_mfma_f32_16x16x32_bf16 v[48:51], a[76:79], a[100:103], 0
buffer_load_dwordx4 v5, s[12:15], s64 offen lds
v_mfma_f32_16x16x32_bf16 v[48:51], a[72:75], a[96:99], v[48:51]
s_waitcnt lgkmcnt(15)
v_mul_f32 v214, s91, v214
v_mul_f32 v215, s91, v215
v_mfma_f32_16x16x32_bf16 v[156:159], a[72:75], a[104:107], 0
v_cvt_pk_bf16_f32 v208, v208, v209
v_cvt_pk_bf16_f32 v209, v210, v211
v_mfma_f32_16x16x32_bf16 v[156:159], a[76:79], a[108:111], v[156:159]
s_add_u32 s53, s88, 262144
v_cvt_pk_bf16_f32 v210, v212, v213
v_cvt_pk_bf16_f32 v211, v214, v215
v_mfma_f32_16x16x32_bf16 v[164:167], a[68:71], a[108:111], 0
buffer_store_dwordx4 v[72:75], v15, s[24:27], s53 offen offset:1024 sc1
v_mfma_f32_16x16x32_bf16 v[164:167], a[64:67], a[104:107], v[164:167]
v_mul_f32 v216, s91, v216
v_mul_f32 v217, s91, v217
v_mfma_f32_16x16x32_bf16 v[172:175], a[152:155], a[104:107], 0
buffer_load_dwordx4 v6, s[12:15], s64 offen offset:1024 lds
v_mfma_f32_16x16x32_bf16 v[172:175], a[156:159], a[108:111], v[172:175]
v_mul_f32 v218, s91, v218
v_mul_f32 v219, s91, v219
v_mfma_f32_16x16x32_bf16 v[56:59], a[148:151], a[108:111], 0
v_mul_f32 v220, s91, v220
v_mul_f32 v221, s91, v221
v_mfma_f32_16x16x32_bf16 v[56:59], a[144:147], a[104:107], v[56:59]
v_mul_f32 v222, s91, v222
v_mul_f32 v223, s91, v223
v_mfma_f32_16x16x32_bf16 v[180:183], a[136:139], a[104:107], 0
v_cvt_pk_bf16_f32 v216, v216, v217
v_cvt_pk_bf16_f32 v217, v218, v219
v_mfma_f32_16x16x32_bf16 v[180:183], a[140:143], a[108:111], v[180:183]
v_cvt_pk_bf16_f32 v218, v220, v221
v_cvt_pk_bf16_f32 v219, v222, v223
v_mfma_f32_16x16x32_bf16 v[188:191], a[132:135], a[108:111], 0
v_mul_f32 v224, s91, v224
v_mul_f32 v225, s91, v225
v_mfma_f32_16x16x32_bf16 v[188:191], a[128:131], a[104:107], v[188:191]
s_waitcnt lgkmcnt(0)
v_mul_f32 v226, s91, v226
v_mul_f32 v227, s91, v227
v_mfma_f32_16x16x32_bf16 v[196:199], a[160:163], a[80:83], 0
s_waitcnt vmcnt(19)
v_mul_f32 v228, s91, v228
v_mul_f32 v229, s91, v229
v_mfma_f32_16x16x32_bf16 v[196:199], a[164:167], a[84:87], v[196:199]
s_barrier
v_mfma_f32_16x16x32_bf16 v[64:67], a[172:175], a[84:87], 0
ds_read_b64_tr_b16 a[128:129], v11 offset:32768
ds_read_b64_tr_b16 a[130:131], v11 offset:33280
v_mfma_f32_16x16x32_bf16 v[64:67], a[168:171], a[80:83], v[64:67]
s_add_u32 m0, s77, 16384
s_add_u32 s64, s76, 128
v_mul_f32 v230, s91, v230
v_mfma_f32_16x16x32_bf16 v[204:207], a[176:179], a[80:83], 0
buffer_load_dwordx4 v7, s[20:23], s64 offen lds
v_mfma_f32_16x16x32_bf16 v[204:207], a[180:183], a[84:87], v[204:207]
ds_read_b64_tr_b16 a[132:133], v11 offset:36864
ds_read_b64_tr_b16 a[134:135], v11 offset:37376
v_mfma_f32_16x16x32_bf16 v[212:215], a[188:191], a[84:87], 0
ds_read_b64_tr_b16 a[136:137], v12 offset:32768
ds_read_b64_tr_b16 a[138:139], v12 offset:33280
v_mfma_f32_16x16x32_bf16 v[212:215], a[184:187], a[80:83], v[212:215]
ds_read_b64_tr_b16 a[140:141], v12 offset:36864
ds_read_b64_tr_b16 a[142:143], v12 offset:37376
v_mfma_f32_16x16x32_bf16 v[72:75], a[112:115], a[80:83], 0
v_mul_f32 v231, s91, v231
v_cvt_pk_bf16_f32 v224, v224, v225
v_mfma_f32_16x16x32_bf16 v[72:75], a[116:119], a[84:87], v[72:75]
ds_read_b64_tr_b16 a[144:145], v13 offset:32768
ds_read_b64_tr_b16 a[146:147], v13 offset:33280
v_mfma_f32_16x16x32_bf16 v[220:223], a[124:127], a[84:87], 0
buffer_load_dwordx4 v8, s[20:23], s64 offen offset:1024 lds
v_mfma_f32_16x16x32_bf16 v[220:223], a[120:123], a[80:83], v[220:223]
ds_read_b64_tr_b16 a[148:149], v13 offset:36864
ds_read_b64_tr_b16 a[150:151], v13 offset:37376
v_mfma_f32_16x16x32_bf16 a[32:35], a[120:123], a[88:91], 0
v_cvt_pk_bf16_f32 v225, v226, v227
v_cvt_pk_bf16_f32 v226, v228, v229
v_mfma_f32_16x16x32_bf16 a[32:35], a[124:127], a[92:95], a[32:35]
ds_read_b64_tr_b16 a[152:153], v14 offset:32768
ds_read_b64_tr_b16 a[154:155], v14 offset:33280
v_mfma_f32_16x16x32_bf16 a[36:39], a[116:119], a[92:95], 0
s_add_u32 m0, s80, 16384
s_add_u32 s64, s79, 2048
v_cvt_pk_bf16_f32 v227, v230, v231
v_mfma_f32_16x16x32_bf16 a[36:39], a[112:115], a[88:91], a[36:39]
ds_read_b64_tr_b16 a[156:157], v14 offset:36864
ds_read_b64_tr_b16 a[158:159], v14 offset:37376
v_mfma_f32_16x16x32_bf16 v[228:231], a[184:187], a[88:91], 0
buffer_load_dwordx4 v15, s[24:27], s64 offen sc1 lds
v_mfma_f32_16x16x32_bf16 v[228:231], a[188:191], a[92:95], v[228:231]
s_xor_b32 s65, s70, 256
s_add_u32 s71, s68, s65
s_add_u32 s72, s69, s65
v_mfma_f32_16x16x32_bf16 a[40:43], a[180:183], a[92:95], 0
s_add_u32 s53, s88, 262144
ds_read_b128 a[64:67], v4 offset:40960
v_mul_f32 v232, s91, v232
v_mfma_f32_16x16x32_bf16 a[40:43], a[176:179], a[88:91], a[40:43]
buffer_store_dwordx4 v[80:83], v15, s[24:27], s53 offen offset:2048 sc1
v_mfma_f32_16x16x32_bf16 a[44:47], a[168:171], a[88:91], 0
s_add_u32 m0, s73, 65536
s_add_u32 s64, s71, 0
ds_read_b128 a[80:83], v9 offset:0
L_PAD4:
s_cbranch_execz L_PAD8
v_mfma_f32_16x16x32_bf16 a[44:47], a[172:175], a[92:95], a[44:47]
v_mul_f32 v233, s91, v233
v_mul_f32 v234, s91, v234
v_mfma_f32_16x16x32_bf16 v[80:83], a[164:167], a[92:95], 0
buffer_load_dwordx4 v5, s[12:15], s64 offen lds
v_mfma_f32_16x16x32_bf16 v[80:83], a[160:163], a[88:91], v[80:83]
ds_read_b128 a[68:71], v4 offset:43008
v_mul_f32 v235, s91, v235
v_mfma_f32_16x16x32_bf16 a[48:51], a[160:163], a[96:99], 0
ds_read_b128 a[84:87], v10 offset:0
v_mul_f32 v236, s91, v236
v_mfma_f32_16x16x32_bf16 a[48:51], a[164:167], a[100:103], a[48:51]
v_mul_f32 v237, s91, v237
v_mul_f32 v238, s91, v238
v_mfma_f32_16x16x32_bf16 a[52:55], a[172:175], a[100:103], 0
v_mul_f32 v239, s91, v239
v_cvt_pk_bf16_f32 v232, v232, v233
v_mfma_f32_16x16x32_bf16 a[52:55], a[168:171], a[96:99], a[52:55]
ds_read_b128 a[72:75], v4 offset:41984
v_cvt_pk_bf16_f32 v233, v234, v235
v_mfma_f32_16x16x32_bf16 a[56:59], a[176:179], a[96:99], 0
buffer_load_dwordx4 v6, s[12:15], s64 offen offset:1024 lds
v_mfma_f32_16x16x32_bf16 a[56:59], a[180:183], a[100:103], a[56:59]
ds_read_b128 a[88:91], v9 offset:2048
v_cvt_pk_bf16_f32 v234, v236, v237
v_mfma_f32_16x16x32_bf16 a[60:63], a[188:191], a[100:103], 0
v_cvt_pk_bf16_f32 v235, v238, v239
v_mul_f32 v240, s91, v240
v_mfma_f32_16x16x32_bf16 a[60:63], a[184:187], a[96:99], a[60:63]
ds_read_b128 a[76:79], v4 offset:44032
v_mul_f32 v241, s91, v241
v_mfma_f32_16x16x32_bf16 v[236:239], a[112:115], a[96:99], 0
s_add_u32 m0, s73, 67584
s_add_u32 s64, s71, 18432
v_mul_f32 v242, s91, v242
v_mfma_f32_16x16x32_bf16 v[236:239], a[116:119], a[100:103], v[236:239]
ds_read_b128 a[92:95], v10 offset:2048
v_mul_f32 v243, s91, v243
v_mfma_f32_16x16x32_bf16 a[192:195], a[124:127], a[100:103], 0
buffer_load_dwordx4 v5, s[12:15], s64 offen lds
v_mfma_f32_16x16x32_bf16 a[192:195], a[120:123], a[96:99], a[192:195]
v_mul_f32 v244, s91, v244
v_mul_f32 v245, s91, v245
v_mfma_f32_16x16x32_bf16 a[196:199], a[120:123], a[104:107], 0
v_mul_f32 v246, s91, v246
v_mul_f32 v247, s91, v247
v_mfma_f32_16x16x32_bf16 a[196:199], a[124:127], a[108:111], a[196:199]
v_cvt_pk_bf16_f32 v240, v240, v241
v_cvt_pk_bf16_f32 v241, v242, v243
v_mfma_f32_16x16x32_bf16 a[200:203], a[116:119], a[108:111], 0
v_cvt_pk_bf16_f32 v242, v244, v245
v_cvt_pk_bf16_f32 v243, v246, v247
v_mfma_f32_16x16x32_bf16 a[200:203], a[112:115], a[104:107], a[200:203]
v_mul_f32 v248, s91, v248
v_mul_f32 v249, s91, v249
v_mfma_f32_16x16x32_bf16 v[244:247], a[184:187], a[104:107], 0
buffer_load_dwordx4 v6, s[12:15], s64 offen offset:1024 lds
v_mfma_f32_16x16x32_bf16 v[244:247], a[188:191], a[108:111], v[244:247]
v_mul_f32 v250, s91, v250
v_mul_f32 v251, s91, v251
v_mfma_f32_16x16x32_bf16 a[204:207], a[180:183], a[108:111], 0
v_mul_f32 v252, s91, v252
v_mul_f32 v253, s91, v253
v_mfma_f32_16x16x32_bf16 a[204:207], a[176:179], a[104:107], a[204:207]
s_add_u32 s53, s88, 262144
v_mul_f32 v254, s91, v254
v_mul_f32 v255, s91, v255
v_mfma_f32_16x16x32_bf16 a[208:211], a[168:171], a[104:107], 0
buffer_store_dwordx4 v[88:91], v15, s[24:27], s53 offen offset:3072 sc1
v_mfma_f32_16x16x32_bf16 a[208:211], a[172:175], a[108:111], a[208:211]
v_cvt_pk_bf16_f32 v248, v248, v249
v_cvt_pk_bf16_f32 v249, v250, v251
v_mfma_f32_16x16x32_bf16 v[88:91], a[164:167], a[108:111], 0
v_cvt_pk_bf16_f32 v250, v252, v253
v_cvt_pk_bf16_f32 v251, v254, v255
v_mfma_f32_16x16x32_bf16 v[88:91], a[160:163], a[104:107], v[88:91]
s_waitcnt lgkmcnt(0)
v_accvgpr_read_b32 v16, a0
v_accvgpr_read_b32 v17, a1
v_mfma_f32_16x16x32_bf16 v[36:39], a[128:131], a[80:83], v[36:39]
s_waitcnt vmcnt(24)
v_accvgpr_read_b32 v18, a2
v_accvgpr_read_b32 v19, a3
v_mfma_f32_16x16x32_bf16 v[36:39], a[132:135], a[84:87], v[36:39]
s_barrier
v_mfma_f32_16x16x32_bf16 v[44:47], a[140:143], a[84:87], v[44:47]
ds_read_b128 a[96:99], v9 offset:4096
v_accvgpr_read_b32 v20, a4
v_mfma_f32_16x16x32_bf16 v[44:47], a[136:139], a[80:83], v[44:47]
s_xor_b32 s75, s93, 2
s_lshl_b32 s76, s75, 19
s_add_u32 s76, s76, s74
v_mfma_f32_16x16x32_bf16 v[32:35], a[144:147], a[80:83], v[32:35]
s_lshl_b32 s79, s75, 13
s_add_u32 s79, s79, s78
ds_read_b128 a[100:103], v10 offset:4096
v_mfma_f32_16x16x32_bf16 v[32:35], a[148:151], a[84:87], v[32:35]
s_add_u32 m0, s77, 32768
s_add_u32 s64, s76, 0
ds_read_b128 a[104:107], v9 offset:6144
v_mfma_f32_16x16x32_bf16 v[52:55], a[156:159], a[84:87], v[52:55]
buffer_load_dwordx4 v7, s[20:23], s64 offen lds
v_mfma_f32_16x16x32_bf16 v[52:55], a[152:155], a[80:83], v[52:55]
ds_read_b64_tr_b16 a[160:161], v11 offset:49152
ds_read_b64_tr_b16 a[162:163], v11 offset:49664
v_mfma_f32_16x16x32_bf16 v[60:63], a[64:67], a[80:83], v[60:63]
v_accvgpr_read_b32 v21, a5
v_accvgpr_read_b32 v22, a6
v_mfma_f32_16x16x32_bf16 v[60:63], a[68:71], a[84:87], v[60:63]
ds_read_b128 a[108:111], v10 offset:6144
v_accvgpr_read_b32 v23, a7
v_mfma_f32_16x16x32_bf16 v[68:71], a[76:79], a[84:87], v[68:71]
buffer_load_dwordx4 v8, s[20:23], s64 offen offset:1024 lds
v_mfma_f32_16x16x32_bf16 v[68:71], a[72:75], a[80:83], v[68:71]
ds_read_b64_tr_b16 a[164:165], v11 offset:53248
ds_read_b64_tr_b16 a[166:167], v11 offset:53760
v_mfma_f32_16x16x32_bf16 v[76:79], a[72:75], a[88:91], v[76:79]
v_add_u32 v9, 32768, v9
v_add_u32 v10, 32768, v10
v_mfma_f32_16x16x32_bf16 v[76:79], a[76:79], a[92:95], v[76:79]
ds_read_b64_tr_b16 a[168:169], v12 offset:49152
ds_read_b64_tr_b16 a[170:171], v12 offset:49664
v_mfma_f32_16x16x32_bf16 v[84:87], a[68:71], a[92:95], v[84:87]
s_add_u32 m0, s80, 32768
s_add_u32 s64, s79, 0
v_mul_f32 v16, s91, v16
v_mfma_f32_16x16x32_bf16 v[84:87], a[64:67], a[88:91], v[84:87]
ds_read_b64_tr_b16 a[172:173], v12 offset:53248
ds_read_b64_tr_b16 a[174:175], v12 offset:53760
v_mfma_f32_16x16x32_bf16 v[92:95], a[152:155], a[88:91], v[92:95]
buffer_load_dwordx4 v15, s[24:27], s64 offen sc1 lds
v_mfma_f32_16x16x32_bf16 v[92:95], a[156:159], a[92:95], v[92:95]
v_mul_f32 v17, s91, v17
v_mul_f32 v18, s91, v18
v_mfma_f32_16x16x32_bf16 v[40:43], a[148:151], a[92:95], v[40:43]
ds_read_b64_tr_b16 a[176:177], v13 offset:49152
ds_read_b64_tr_b16 a[178:179], v13 offset:49664
v_mfma_f32_16x16x32_bf16 v[40:43], a[144:147], a[88:91], v[40:43]
v_mul_f32 v19, s91, v19
v_mul_f32 v20, s91, v20
v_mfma_f32_16x16x32_bf16 v[100:103], a[136:139], a[88:91], v[100:103]
s_add_u32 m0, s73, 69632
s_add_u32 s64, s72, 0
v_mul_f32 v21, s91, v21
v_mfma_f32_16x16x32_bf16 v[100:103], a[140:143], a[92:95], v[100:103]
ds_read_b64_tr_b16 a[180:181], v13 offset:53248
ds_read_b64_tr_b16 a[182:183], v13 offset:53760
v_mfma_f32_16x16x32_bf16 v[108:111], a[132:135], a[92:95], v[108:111]
buffer_load_dwordx4 v5, s[12:15], s64 offen lds
v_mfma_f32_16x16x32_bf16 v[108:111], a[128:131], a[88:91], v[108:111]
s_waitcnt lgkmcnt(14)
ds_read_b64_tr_b16 a[184:185], v14 offset:49152
ds_read_b64_tr_b16 a[186:187], v14 offset:49664
v_mfma_f32_16x16x32_bf16 v[116:119], a[128:131], a[96:99], v[116:119]
s_add_u32 s53, s87, 0
ds_read_b64_tr_b16 a[188:189], v14 offset:53248
ds_read_b64_tr_b16 a[190:191], v14 offset:53760
v_mfma_f32_16x16x32_bf16 v[116:119], a[132:135], a[100:103], v[116:119]
buffer_store_dwordx4 v[160:163], v15, s[24:27], s53 offen offset:0 sc1
v_mfma_f32_16x16x32_bf16 v[124:127], a[140:143], a[100:103], v[124:127]
v_mul_f32 v22, s91, v22
v_mul_f32 v23, s91, v23
v_mfma_f32_16x16x32_bf16 v[124:127], a[136:139], a[96:99], v[124:127]
ds_read_b128 a[112:115], v4 offset:57344
v_cvt_pk_bf16_f32 v16, v16, v17
v_mfma_f32_16x16x32_bf16 v[132:135], a[144:147], a[96:99], v[132:135]
buffer_load_dwordx4 v6, s[12:15], s64 offen offset:1024 lds
v_mfma_f32_16x16x32_bf16 v[132:135], a[148:151], a[100:103], v[132:135]
ds_read_b128 a[116:119], v4 offset:59392
v_cvt_pk_bf16_f32 v17, v18, v19
v_mfma_f32_16x16x32_bf16 v[140:143], a[156:159], a[100:103], v[140:143]
v_cvt_pk_bf16_f32 v18, v20, v21
v_cvt_pk_bf16_f32 v19, v22, v23
v_mfma_f32_16x16x32_bf16 v[140:143], a[152:155], a[96:99], v[140:143]
ds_read_b128 a[120:123], v4 offset:58368
v_accvgpr_write_b32 a0, v16
v_mfma_f32_16x16x32_bf16 v[148:151], a[64:67], a[96:99], v[148:151]
s_add_u32 m0, s73, 71680
s_add_u32 s64, s72, 18432
v_accvgpr_write_b32 a1, v17
v_mfma_f32_16x16x32_bf16 v[148:151], a[68:71], a[100:103], v[148:151]
ds_read_b128 a[124:127], v4 offset:60416
v_accvgpr_write_b32 a2, v18
v_mfma_f32_16x16x32_bf16 v[48:51], a[76:79], a[100:103], v[48:51]
buffer_load_dwordx4 v5, s[12:15], s64 offen lds
v_mfma_f32_16x16x32_bf16 v[48:51], a[72:75], a[96:99], v[48:51]
s_waitcnt lgkmcnt(15)
v_accvgpr_write_b32 a3, v19
v_accvgpr_read_b32 v16, a8
v_mfma_f32_16x16x32_bf16 v[156:159], a[72:75], a[104:107], v[156:159]
v_accvgpr_read_b32 v17, a9
v_accvgpr_read_b32 v18, a10
v_mfma_f32_16x16x32_bf16 v[156:159], a[76:79], a[108:111], v[156:159]
v_accvgpr_read_b32 v19, a11
v_accvgpr_read_b32 v20, a12
v_mfma_f32_16x16x32_bf16 v[164:167], a[68:71], a[108:111], v[164:167]
v_accvgpr_read_b32 v21, a13
v_accvgpr_read_b32 v22, a14
v_mfma_f32_16x16x32_bf16 v[164:167], a[64:67], a[104:107], v[164:167]
v_accvgpr_read_b32 v23, a15
v_mul_f32 v16, s91, v16
v_mfma_f32_16x16x32_bf16 v[172:175], a[152:155], a[104:107], v[172:175]
buffer_load_dwordx4 v6, s[12:15], s64 offen offset:1024 lds
v_mfma_f32_16x16x32_bf16 v[172:175], a[156:159], a[108:111], v[172:175]
v_mul_f32 v17, s91, v17
v_mul_f32 v18, s91, v18
v_mfma_f32_16x16x32_bf16 v[56:59], a[148:151], a[108:111], v[56:59]
v_mul_f32 v19, s91, v19
v_mul_f32 v20, s91, v20
v_mfma_f32_16x16x32_bf16 v[56:59], a[144:147], a[104:107], v[56:59]
v_mul_f32 v21, s91, v21
v_mul_f32 v22, s91, v22
v_mfma_f32_16x16x32_bf16 v[180:183], a[136:139], a[104:107], v[180:183]
v_mul_f32 v23, s91, v23
v_cvt_pk_bf16_f32 v16, v16, v17
v_mfma_f32_16x16x32_bf16 v[180:183], a[140:143], a[108:111], v[180:183]
v_cvt_pk_bf16_f32 v17, v18, v19
v_cvt_pk_bf16_f32 v18, v20, v21
v_mfma_f32_16x16x32_bf16 v[188:191], a[132:135], a[108:111], v[188:191]
v_cvt_pk_bf16_f32 v19, v22, v23
v_accvgpr_write_b32 a8, v16
v_mfma_f32_16x16x32_bf16 v[188:191], a[128:131], a[104:107], v[188:191]
s_waitcnt lgkmcnt(0)
v_accvgpr_write_b32 a9, v17
v_accvgpr_write_b32 a10, v18
v_mfma_f32_16x16x32_bf16 v[196:199], a[160:163], a[80:83], v[196:199]
s_waitcnt vmcnt(17)
v_accvgpr_write_b32 a11, v19
v_accvgpr_read_b32 v16, a16
v_mfma_f32_16x16x32_bf16 v[196:199], a[164:167], a[84:87], v[196:199]
s_barrier
v_mfma_f32_16x16x32_bf16 v[64:67], a[172:175], a[84:87], v[64:67]
s_add_u32 s53, s87, 0
ds_read_b64_tr_b16 a[128:129], v11 offset:0
ds_read_b64_tr_b16 a[130:131], v11 offset:512
v_mfma_f32_16x16x32_bf16 v[64:67], a[168:171], a[80:83], v[64:67]
s_add_u32 m0, s77, 49152
s_add_u32 s64, s76, 128
v_accvgpr_read_b32 v17, a17
v_mfma_f32_16x16x32_bf16 v[204:207], a[176:179], a[80:83], v[204:207]
buffer_load_dwordx4 v7, s[20:23], s64 offen lds
v_mfma_f32_16x16x32_bf16 v[204:207], a[180:183], a[84:87], v[204:207]
ds_read_b64_tr_b16 a[132:133], v11 offset:4096
ds_read_b64_tr_b16 a[134:135], v11 offset:4608
v_mfma_f32_16x16x32_bf16 v[212:215], a[188:191], a[84:87], v[212:215]
ds_read_b64_tr_b16 a[136:137], v12 offset:0
ds_read_b64_tr_b16 a[138:139], v12 offset:512
v_mfma_f32_16x16x32_bf16 v[212:215], a[184:187], a[80:83], v[212:215]
ds_read_b64_tr_b16 a[140:141], v12 offset:4096
ds_read_b64_tr_b16 a[142:143], v12 offset:4608
v_mfma_f32_16x16x32_bf16 v[72:75], a[112:115], a[80:83], v[72:75]
buffer_store_dwordx4 v[168:171], v15, s[24:27], s53 offen offset:1024 sc1
v_mfma_f32_16x16x32_bf16 v[72:75], a[116:119], a[84:87], v[72:75]
ds_read_b64_tr_b16 a[144:145], v13 offset:0
ds_read_b64_tr_b16 a[146:147], v13 offset:512
v_mfma_f32_16x16x32_bf16 v[220:223], a[124:127], a[84:87], v[220:223]
buffer_load_dwordx4 v8, s[20:23], s64 offen offset:1024 lds
v_mfma_f32_16x16x32_bf16 v[220:223], a[120:123], a[80:83], v[220:223]
ds_read_b64_tr_b16 a[148:149], v13 offset:4096
ds_read_b64_tr_b16 a[150:151], v13 offset:4608
v_mfma_f32_16x16x32_bf16 a[32:35], a[120:123], a[88:91], a[32:35]
v_accvgpr_read_b32 v18, a18
v_accvgpr_read_b32 v19, a19
v_mfma_f32_16x16x32_bf16 a[32:35], a[124:127], a[92:95], a[32:35]
ds_read_b64_tr_b16 a[152:153], v14 offset:0
ds_read_b64_tr_b16 a[154:155], v14 offset:512
v_mfma_f32_16x16x32_bf16 a[36:39], a[116:119], a[92:95], a[36:39]
s_add_u32 m0, s80, 49152
s_add_u32 s64, s79, 2048
v_accvgpr_read_b32 v20, a20
v_mfma_f32_16x16x32_bf16 a[36:39], a[112:115], a[88:91], a[36:39]
ds_read_b64_tr_b16 a[156:157], v14 offset:4096
ds_read_b64_tr_b16 a[158:159], v14 offset:4608
v_mfma_f32_16x16x32_bf16 v[228:231], a[184:187], a[88:91], v[228:231]
buffer_load_dwordx4 v15, s[24:27], s64 offen sc1 lds
v_mfma_f32_16x16x32_bf16 v[228:231], a[188:191], a[92:95], v[228:231]
s_xor_b32 s65, s70, 384
s_add_u32 s71, s68, s65
s_add_u32 s72, s69, s65
v_mfma_f32_16x16x32_bf16 a[40:43], a[180:183], a[92:95], a[40:43]
ds_read_b128 a[64:67], v4 offset:8192
v_accvgpr_read_b32 v21, a21
v_mfma_f32_16x16x32_bf16 a[40:43], a[176:179], a[88:91], a[40:43]
v_accvgpr_read_b32 v22, a22
v_accvgpr_read_b32 v23, a23
v_mfma_f32_16x16x32_bf16 a[44:47], a[168:171], a[88:91], a[44:47]
s_add_u32 m0, s73, 0
s_add_u32 s64, s71, 0
ds_read_b128 a[80:83], v9 offset:0
v_mfma_f32_16x16x32_bf16 a[44:47], a[172:175], a[92:95], a[44:47]
v_mul_f32 v16, s91, v16
v_mul_f32 v17, s91, v17
v_mfma_f32_16x16x32_bf16 v[80:83], a[164:167], a[92:95], v[80:83]
buffer_load_dwordx4 v5, s[12:15], s64 offen lds
v_mfma_f32_16x16x32_bf16 v[80:83], a[160:163], a[88:91], v[80:83]
ds_read_b128 a[68:71], v4 offset:10240
v_mul_f32 v18, s91, v18
v_mfma_f32_16x16x32_bf16 a[48:51], a[160:163], a[96:99], a[48:51]
ds_read_b128 a[84:87], v10 offset:0
v_mul_f32 v19, s91, v19
v_mfma_f32_16x16x32_bf16 a[48:51], a[164:167], a[100:103], a[48:51]
v_mul_f32 v20, s91, v20
v_mul_f32 v21, s91, v21
v_mfma_f32_16x16x32_bf16 a[52:55], a[172:175], a[100:103], a[52:55]
v_mul_f32 v22, s91, v22
v_mul_f32 v23, s91, v23
v_mfma_f32_16x16x32_bf16 a[52:55], a[168:171], a[96:99], a[52:55]
ds_read_b128 a[72:75], v4 offset:9216
v_cvt_pk_bf16_f32 v16, v16, v17
v_mfma_f32_16x16x32_bf16 a[56:59], a[176:179], a[96:99], a[56:59]
buffer_load_dwordx4 v6, s[12:15], s64 offen offset:1024 lds
v_mfma_f32_16x16x32_bf16 a[56:59], a[180:183], a[100:103], a[56:59]
s_add_u32 s53, s87, 4096
ds_read_b128 a[88:91], v9 offset:2048
v_cvt_pk_bf16_f32 v17, v18, v19
v_mfma_f32_16x16x32_bf16 a[60:63], a[188:191], a[100:103], a[60:63]
buffer_store_dwordx4 v[176:179], v15, s[24:27], s53 offen offset:0 sc1
v_mfma_f32_16x16x32_bf16 a[60:63], a[184:187], a[96:99], a[60:63]
ds_read_b128 a[76:79], v4 offset:11264
v_cvt_pk_bf16_f32 v18, v20, v21
v_mfma_f32_16x16x32_bf16 v[236:239], a[112:115], a[96:99], v[236:239]
s_add_u32 m0, s73, 2048
s_add_u32 s64, s71, 18432
v_cvt_pk_bf16_f32 v19, v22, v23
v_mfma_f32_16x16x32_bf16 v[236:239], a[116:119], a[100:103], v[236:239]
ds_read_b128 a[92:95], v10 offset:2048
v_accvgpr_write_b32 a16, v16
v_mfma_f32_16x16x32_bf16 a[192:195], a[124:127], a[100:103], a[192:195]
buffer_load_dwordx4 v5, s[12:15], s64 offen lds
v_mfma_f32_16x16x32_bf16 a[192:195], a[120:123], a[96:99], a[192:195]
v_accvgpr_write_b32 a17, v17
v_accvgpr_write_b32 a18, v18
v_mfma_f32_16x16x32_bf16 a[196:199], a[120:123], a[104:107], a[196:199]
v_accvgpr_write_b32 a19, v19
v_accvgpr_read_b32 v16, a24
v_mfma_f32_16x16x32_bf16 a[196:199], a[124:127], a[108:111], a[196:199]
v_accvgpr_read_b32 v17, a25
v_accvgpr_read_b32 v18, a26
v_mfma_f32_16x16x32_bf16 a[200:203], a[116:119], a[108:111], a[200:203]
v_accvgpr_read_b32 v19, a27
v_accvgpr_read_b32 v20, a28
v_mfma_f32_16x16x32_bf16 a[200:203], a[112:115], a[104:107], a[200:203]
v_accvgpr_read_b32 v21, a29
v_accvgpr_read_b32 v22, a30
v_mfma_f32_16x16x32_bf16 v[244:247], a[184:187], a[104:107], v[244:247]
buffer_load_dwordx4 v6, s[12:15], s64 offen offset:1024 lds
v_mfma_f32_16x16x32_bf16 v[244:247], a[188:191], a[108:111], v[244:247]
v_accvgpr_read_b32 v23, a31
v_mul_f32 v16, s91, v16
v_mfma_f32_16x16x32_bf16 a[204:207], a[180:183], a[108:111], a[204:207]
v_mul_f32 v17, s91, v17
v_mul_f32 v18, s91, v18
v_mfma_f32_16x16x32_bf16 a[204:207], a[176:179], a[104:107], a[204:207]
v_mul_f32 v19, s91, v19
v_mul_f32 v20, s91, v20
v_mfma_f32_16x16x32_bf16 a[208:211], a[168:171], a[104:107], a[208:211]
v_mul_f32 v21, s91, v21
v_mul_f32 v22, s91, v22
v_mfma_f32_16x16x32_bf16 a[208:211], a[172:175], a[108:111], a[208:211]
v_mul_f32 v23, s91, v23
v_cvt_pk_bf16_f32 v16, v16, v17
v_mfma_f32_16x16x32_bf16 v[88:91], a[164:167], a[108:111], v[88:91]
v_cvt_pk_bf16_f32 v17, v18, v19
v_cvt_pk_bf16_f32 v18, v20, v21
v_mfma_f32_16x16x32_bf16 v[88:91], a[160:163], a[104:107], v[88:91]
s_waitcnt lgkmcnt(0)
v_cvt_pk_bf16_f32 v19, v22, v23
v_accvgpr_write_b32 a24, v16
v_mfma_f32_16x16x32_bf16 v[36:39], a[128:131], a[80:83], v[36:39]
s_waitcnt vmcnt(23)
v_accvgpr_write_b32 a25, v17
v_accvgpr_write_b32 a26, v18
v_mfma_f32_16x16x32_bf16 v[36:39], a[132:135], a[84:87], v[36:39]
s_barrier
v_mfma_f32_16x16x32_bf16 v[44:47], a[140:143], a[84:87], v[44:47]
ds_read_b128 a[96:99], v9 offset:4096
v_accvgpr_write_b32 a27, v19
v_mfma_f32_16x16x32_bf16 v[44:47], a[136:139], a[80:83], v[44:47]
s_xor_b32 s75, s93, 3
s_lshl_b32 s76, s75, 19
s_add_u32 s76, s76, s74
v_mfma_f32_16x16x32_bf16 v[32:35], a[144:147], a[80:83], v[32:35]
s_lshl_b32 s79, s75, 13
s_add_u32 s79, s79, s78
ds_read_b128 a[100:103], v10 offset:4096
v_mfma_f32_16x16x32_bf16 v[32:35], a[148:151], a[84:87], v[32:35]
s_add_u32 m0, s77, 0
s_add_u32 s64, s76, 0
ds_read_b128 a[104:107], v9 offset:6144
v_mfma_f32_16x16x32_bf16 v[52:55], a[156:159], a[84:87], v[52:55]
buffer_load_dwordx4 v7, s[20:23], s64 offen lds
v_mfma_f32_16x16x32_bf16 v[52:55], a[152:155], a[80:83], v[52:55]
s_add_u32 s53, s87, 4096
ds_read_b64_tr_b16 a[160:161], v11 offset:16384
ds_read_b64_tr_b16 a[162:163], v11 offset:16896
v_mfma_f32_16x16x32_bf16 v[60:63], a[64:67], a[80:83], v[60:63]
buffer_store_dwordx4 v[184:187], v15, s[24:27], s53 offen offset:1024 sc1
v_mfma_f32_16x16x32_bf16 v[60:63], a[68:71], a[84:87], v[60:63]
ds_read_b128 a[108:111], v10 offset:6144
v_accvgpr_write_b32 a4, v248
v_mfma_f32_16x16x32_bf16 v[68:71], a[76:79], a[84:87], v[68:71]
buffer_load_dwordx4 v8, s[20:23], s64 offen offset:1024 lds
v_mfma_f32_16x16x32_bf16 v[68:71], a[72:75], a[80:83], v[68:71]
ds_read_b64_tr_b16 a[164:165], v11 offset:20480
ds_read_b64_tr_b16 a[166:167], v11 offset:20992
v_mfma_f32_16x16x32_bf16 v[76:79], a[72:75], a[88:91], v[76:79]
v_add_u32 v9, 32768, v9
v_add_u32 v10, 32768, v10
v_mfma_f32_16x16x32_bf16 v[76:79], a[76:79], a[92:95], v[76:79]
ds_read_b64_tr_b16 a[168:169], v12 offset:16384
ds_read_b64_tr_b16 a[170:171], v12 offset:16896
v_mfma_f32_16x16x32_bf16 v[84:87], a[68:71], a[92:95], v[84:87]
s_add_u32 m0, s80, 0
s_add_u32 s64, s79, 0
v_accvgpr_write_b32 a5, v249
v_mfma_f32_16x16x32_bf16 v[84:87], a[64:67], a[88:91], v[84:87]
ds_read_b64_tr_b16 a[172:173], v12 offset:20480
ds_read_b64_tr_b16 a[174:175], v12 offset:20992
v_mfma_f32_16x16x32_bf16 v[92:95], a[152:155], a[88:91], v[92:95]
buffer_load_dwordx4 v15, s[24:27], s64 offen sc1 lds
v_mfma_f32_16x16x32_bf16 v[92:95], a[156:159], a[92:95], v[92:95]
v_accvgpr_write_b32 a6, v250
v_accvgpr_write_b32 a7, v251
v_mfma_f32_16x16x32_bf16 v[40:43], a[148:151], a[92:95], v[40:43]
ds_read_b64_tr_b16 a[176:177], v13 offset:16384
ds_read_b64_tr_b16 a[178:179], v13 offset:16896
v_mfma_f32_16x16x32_bf16 v[40:43], a[144:147], a[88:91], v[40:43]
v_accvgpr_write_b32 a12, v240
v_accvgpr_write_b32 a13, v241
v_mfma_f32_16x16x32_bf16 v[100:103], a[136:139], a[88:91], v[100:103]
s_add_u32 m0, s73, 4096
s_add_u32 s64, s72, 0
v_accvgpr_write_b32 a14, v242
v_mfma_f32_16x16x32_bf16 v[100:103], a[140:143], a[92:95], v[100:103]
ds_read_b64_tr_b16 a[180:181], v13 offset:20480
ds_read_b64_tr_b16 a[182:183], v13 offset:20992
v_mfma_f32_16x16x32_bf16 v[108:111], a[132:135], a[92:95], v[108:111]
buffer_load_dwordx4 v5, s[12:15], s64 offen lds
v_mfma_f32_16x16x32_bf16 v[108:111], a[128:131], a[88:91], v[108:111]
s_waitcnt lgkmcnt(14)
ds_read_b64_tr_b16 a[184:185], v14 offset:16384
ds_read_b64_tr_b16 a[186:187], v14 offset:16896
v_mfma_f32_16x16x32_bf16 v[116:119], a[128:131], a[96:99], v[116:119]
ds_read_b64_tr_b16 a[188:189], v14 offset:20480
ds_read_b64_tr_b16 a[190:191], v14 offset:20992
v_mfma_f32_16x16x32_bf16 v[116:119], a[132:135], a[100:103], v[116:119]
v_accvgpr_write_b32 a15, v243
v_accvgpr_write_b32 a20, v232
v_mfma_f32_16x16x32_bf16 v[124:127], a[140:143], a[100:103], v[124:127]
v_accvgpr_write_b32 a21, v233
v_accvgpr_write_b32 a22, v234
v_mfma_f32_16x16x32_bf16 v[124:127], a[136:139], a[96:99], v[124:127]
ds_read_b128 a[112:115], v4 offset:24576
v_accvgpr_write_b32 a23, v235
v_mfma_f32_16x16x32_bf16 v[132:135], a[144:147], a[96:99], v[132:135]
buffer_load_dwordx4 v6, s[12:15], s64 offen offset:1024 lds
v_mfma_f32_16x16x32_bf16 v[132:135], a[148:151], a[100:103], v[132:135]
ds_read_b128 a[116:119], v4 offset:26624
v_accvgpr_write_b32 a28, v224
v_mfma_f32_16x16x32_bf16 v[140:143], a[156:159], a[100:103], v[140:143]
v_accvgpr_write_b32 a29, v225
v_accvgpr_write_b32 a30, v226
v_mfma_f32_16x16x32_bf16 v[140:143], a[152:155], a[96:99], v[140:143]
ds_read_b128 a[120:123], v4 offset:25600
v_accvgpr_write_b32 a31, v227
v_mfma_f32_16x16x32_bf16 v[148:151], a[64:67], a[96:99], v[148:151]
s_add_u32 m0, s73, 6144
s_add_u32 s64, s72, 18432
v_accvgpr_read_b32 v252, a32
v_mfma_f32_16x16x32_bf16 v[148:151], a[68:71], a[100:103], v[148:151]
ds_read_b128 a[124:127], v4 offset:27648
v_accvgpr_read_b32 v253, a33
v_mfma_f32_16x16x32_bf16 v[48:51], a[76:79], a[100:103], v[48:51]
buffer_load_dwordx4 v5, s[12:15], s64 offen lds
v_mfma_f32_16x16x32_bf16 v[48:51], a[72:75], a[96:99], v[48:51]
s_waitcnt lgkmcnt(15)
s_add_u32 s53, s87, 262144
v_accvgpr_read_b32 v254, a34
v_mfma_f32_16x16x32_bf16 v[156:159], a[72:75], a[104:107], v[156:159]
buffer_store_dwordx4 v[192:195], v15, s[24:27], s53 offen offset:0 sc1
v_mfma_f32_16x16x32_bf16 v[156:159], a[76:79], a[108:111], v[156:159]
v_accvgpr_read_b32 v255, a35
v_accvgpr_read_b32 v160, a36
v_mfma_f32_16x16x32_bf16 v[164:167], a[68:71], a[108:111], v[164:167]
v_accvgpr_read_b32 v161, a37
v_accvgpr_read_b32 v162, a38
v_mfma_f32_16x16x32_bf16 v[164:167], a[64:67], a[104:107], v[164:167]
v_accvgpr_read_b32 v163, a39
v_accvgpr_read_b32 v168, a40
v_mfma_f32_16x16x32_bf16 v[172:175], a[152:155], a[104:107], v[172:175]
buffer_load_dwordx4 v6, s[12:15], s64 offen offset:1024 lds
v_mfma_f32_16x16x32_bf16 v[172:175], a[156:159], a[108:111], v[172:175]
v_accvgpr_read_b32 v169, a41
v_accvgpr_read_b32 v170, a42
v_mfma_f32_16x16x32_bf16 v[56:59], a[148:151], a[108:111], v[56:59]
v_accvgpr_read_b32 v171, a43
v_accvgpr_read_b32 v176, a44
v_mfma_f32_16x16x32_bf16 v[56:59], a[144:147], a[104:107], v[56:59]
v_accvgpr_read_b32 v177, a45
v_accvgpr_read_b32 v178, a46
v_mfma_f32_16x16x32_bf16 v[180:183], a[136:139], a[104:107], v[180:183]
v_accvgpr_read_b32 v179, a47
v_accvgpr_read_b32 v184, a48
v_mfma_f32_16x16x32_bf16 v[180:183], a[140:143], a[108:111], v[180:183]
v_accvgpr_read_b32 v185, a49
v_accvgpr_read_b32 v186, a50
v_mfma_f32_16x16x32_bf16 v[188:191], a[132:135], a[108:111], v[188:191]
v_accvgpr_read_b32 v187, a51
v_accvgpr_read_b32 v248, a52
v_mfma_f32_16x16x32_bf16 v[188:191], a[128:131], a[104:107], v[188:191]
s_waitcnt lgkmcnt(0)
v_accvgpr_read_b32 v249, a53
v_accvgpr_read_b32 v250, a54
v_mfma_f32_16x16x32_bf16 v[196:199], a[160:163], a[80:83], v[196:199]
s_waitcnt vmcnt(18)
v_accvgpr_read_b32 v251, a55
v_accvgpr_read_b32 v240, a56
v_mfma_f32_16x16x32_bf16 v[196:199], a[164:167], a[84:87], v[196:199]
s_barrier
v_mfma_f32_16x16x32_bf16 v[64:67], a[172:175], a[84:87], v[64:67]
ds_read_b64_tr_b16 a[128:129], v11 offset:32768
ds_read_b64_tr_b16 a[130:131], v11 offset:33280
v_mfma_f32_16x16x32_bf16 v[64:67], a[168:171], a[80:83], v[64:67]
s_add_u32 m0, s77, 16384
s_add_u32 s64, s76, 128
v_accvgpr_read_b32 v241, a57
v_mfma_f32_16x16x32_bf16 v[204:207], a[176:179], a[80:83], v[204:207]
buffer_load_dwordx4 v7, s[20:23], s64 offen lds
v_mfma_f32_16x16x32_bf16 v[204:207], a[180:183], a[84:87], v[204:207]
ds_read_b64_tr_b16 a[132:133], v11 offset:36864
ds_read_b64_tr_b16 a[134:135], v11 offset:37376
v_mfma_f32_16x16x32_bf16 v[212:215], a[188:191], a[84:87], v[212:215]
ds_read_b64_tr_b16 a[136:137], v12 offset:32768
ds_read_b64_tr_b16 a[138:139], v12 offset:33280
v_mfma_f32_16x16x32_bf16 v[212:215], a[184:187], a[80:83], v[212:215]
ds_read_b64_tr_b16 a[140:141], v12 offset:36864
ds_read_b64_tr_b16 a[142:143], v12 offset:37376
v_mfma_f32_16x16x32_bf16 v[72:75], a[112:115], a[80:83], v[72:75]
v_accvgpr_read_b32 v242, a58
v_accvgpr_read_b32 v243, a59
v_mfma_f32_16x16x32_bf16 v[72:75], a[116:119], a[84:87], v[72:75]
ds_read_b64_tr_b16 a[144:145], v13 offset:32768
ds_read_b64_tr_b16 a[146:147], v13 offset:33280
v_mfma_f32_16x16x32_bf16 v[220:223], a[124:127], a[84:87], v[220:223]
buffer_load_dwordx4 v8, s[20:23], s64 offen offset:1024 lds
v_mfma_f32_16x16x32_bf16 v[220:223], a[120:123], a[80:83], v[220:223]
ds_read_b64_tr_b16 a[148:149], v13 offset:36864
ds_read_b64_tr_b16 a[150:151], v13 offset:37376
v_mfma_f32_16x16x32_bf16 v[252:255], a[120:123], a[88:91], v[252:255]
v_accvgpr_read_b32 v232, a60
v_accvgpr_read_b32 v233, a61
v_mfma_f32_16x16x32_bf16 v[252:255], a[124:127], a[92:95], v[252:255]
s_add_u32 s53, s87, 262144
ds_read_b64_tr_b16 a[152:153], v14 offset:32768
ds_read_b64_tr_b16 a[154:155], v14 offset:33280
v_mfma_f32_16x16x32_bf16 v[160:163], a[116:119], a[92:95], v[160:163]
s_add_u32 m0, s80, 16384
s_add_u32 s64, s79, 2048
v_accvgpr_read_b32 v234, a62
L_PAD5:
s_cbranch_execz L_PAD9
v_mfma_f32_16x16x32_bf16 v[160:163], a[112:115], a[88:91], v[160:163]
ds_read_b64_tr_b16 a[156:157], v14 offset:36864
ds_read_b64_tr_b16 a[158:159], v14 offset:37376
v_mfma_f32_16x16x32_bf16 v[228:231], a[184:187], a[88:91], v[228:231]
buffer_load_dwordx4 v15, s[24:27], s64 offen sc1 lds
v_mfma_f32_16x16x32_bf16 v[228:231], a[188:191], a[92:95], v[228:231]
s_xor_b32 s65, s70, 512
s_add_u32 s71, s68, s65
s_add_u32 s72, s69, s65
v_mfma_f32_16x16x32_bf16 v[168:171], a[180:183], a[92:95], v[168:171]
ds_read_b128 a[64:67], v4 offset:40960
v_accvgpr_read_b32 v235, a63
v_mfma_f32_16x16x32_bf16 v[168:171], a[176:179], a[88:91], v[168:171]
buffer_store_dwordx4 v[200:203], v15, s[24:27], s53 offen offset:1024 sc1
v_mfma_f32_16x16x32_bf16 v[176:179], a[168:171], a[88:91], v[176:179]
s_add_u32 m0, s73, 32768
s_add_u32 s64, s71, 0
ds_read_b128 a[80:83], v9 offset:0
v_mfma_f32_16x16x32_bf16 v[176:179], a[172:175], a[92:95], v[176:179]
v_accvgpr_read_b32 v224, a192
v_accvgpr_read_b32 v225, a193
v_mfma_f32_16x16x32_bf16 v[80:83], a[164:167], a[92:95], v[80:83]
buffer_load_dwordx4 v5, s[12:15], s64 offen lds
v_mfma_f32_16x16x32_bf16 v[80:83], a[160:163], a[88:91], v[80:83]
ds_read_b128 a[68:71], v4 offset:43008
v_accvgpr_read_b32 v226, a194
v_mfma_f32_16x16x32_bf16 v[184:187], a[160:163], a[96:99], v[184:187]
ds_read_b128 a[84:87], v10 offset:0
v_accvgpr_read_b32 v227, a195
v_mfma_f32_16x16x32_bf16 v[184:187], a[164:167], a[100:103], v[184:187]
v_accvgpr_read_b32 v192, a204
v_accvgpr_read_b32 v193, a205
v_mfma_f32_16x16x32_bf16 v[248:251], a[172:175], a[100:103], v[248:251]
v_accvgpr_read_b32 v194, a206
v_accvgpr_read_b32 v195, a207
v_mfma_f32_16x16x32_bf16 v[248:251], a[168:171], a[96:99], v[248:251]
ds_read_b128 a[72:75], v4 offset:41984
v_accvgpr_read_b32 v200, a208
v_mfma_f32_16x16x32_bf16 v[240:243], a[176:179], a[96:99], v[240:243]
buffer_load_dwordx4 v6, s[12:15], s64 offen offset:1024 lds
v_mfma_f32_16x16x32_bf16 v[240:243], a[180:183], a[100:103], v[240:243]
ds_read_b128 a[88:91], v9 offset:2048
v_accvgpr_read_b32 v201, a209
v_mfma_f32_16x16x32_bf16 v[232:235], a[188:191], a[100:103], v[232:235]
v_accvgpr_read_b32 v202, a210
v_accvgpr_read_b32 v203, a211
v_mfma_f32_16x16x32_bf16 v[232:235], a[184:187], a[96:99], v[232:235]
ds_read_b128 a[76:79], v4 offset:44032
v_and_b32 v28, 31, v1
v_mfma_f32_16x16x32_bf16 v[236:239], a[112:115], a[96:99], v[236:239]
s_add_u32 m0, s73, 34816
s_add_u32 s64, s71, 18432
v_lshlrev_b32 v28, 2, v28
v_mfma_f32_16x16x32_bf16 v[236:239], a[116:119], a[100:103], v[236:239]
ds_read_b128 a[92:95], v10 offset:2048
v_mfma_f32_16x16x32_bf16 v[224:227], a[124:127], a[100:103], v[224:227]
buffer_load_dwordx4 v5, s[12:15], s64 offen lds
v_mfma_f32_16x16x32_bf16 v[224:227], a[120:123], a[96:99], v[224:227]
buffer_load_dword v30, v28, s[40:43], 0 offen sc1
v_mfma_f32_16x16x32_bf16 a[196:199], a[120:123], a[104:107], a[196:199]
v_mfma_f32_16x16x32_bf16 a[196:199], a[124:127], a[108:111], a[196:199]
v_mfma_f32_16x16x32_bf16 a[200:203], a[116:119], a[108:111], a[200:203]
v_mfma_f32_16x16x32_bf16 a[200:203], a[112:115], a[104:107], a[200:203]
v_mfma_f32_16x16x32_bf16 v[244:247], a[184:187], a[104:107], v[244:247]
buffer_load_dwordx4 v6, s[12:15], s64 offen offset:1024 lds
v_mfma_f32_16x16x32_bf16 v[244:247], a[188:191], a[108:111], v[244:247]
s_add_u32 s53, s87, 266240
v_mfma_f32_16x16x32_bf16 v[192:195], a[180:183], a[108:111], v[192:195]
buffer_store_dwordx4 v[208:211], v15, s[24:27], s53 offen offset:0 sc1
v_mfma_f32_16x16x32_bf16 v[192:195], a[176:179], a[104:107], v[192:195]
v_mfma_f32_16x16x32_bf16 v[200:203], a[168:171], a[104:107], v[200:203]
v_mfma_f32_16x16x32_bf16 v[200:203], a[172:175], a[108:111], v[200:203]
v_accvgpr_read_b32 v208, a196
v_accvgpr_read_b32 v209, a197
v_mfma_f32_16x16x32_bf16 v[88:91], a[164:167], a[108:111], v[88:91]
v_accvgpr_read_b32 v210, a198
v_accvgpr_read_b32 v211, a199
v_mfma_f32_16x16x32_bf16 v[88:91], a[160:163], a[104:107], v[88:91]
s_waitcnt lgkmcnt(0)
v_mfma_f32_16x16x32_bf16 v[36:39], a[128:131], a[80:83], v[36:39]
s_waitcnt vmcnt(24)
v_mfma_f32_16x16x32_bf16 v[36:39], a[132:135], a[84:87], v[36:39]
s_barrier
v_mfma_f32_16x16x32_bf16 v[44:47], a[140:143], a[84:87], v[44:47]
ds_read_b128 a[96:99], v9 offset:4096
v_mfma_f32_16x16x32_bf16 v[44:47], a[136:139], a[80:83], v[44:47]
s_xor_b32 s75, s93, 4
s_lshl_b32 s76, s75, 19
s_add_u32 s76, s76, s74
v_mfma_f32_16x16x32_bf16 v[32:35], a[144:147], a[80:83], v[32:35]
s_lshl_b32 s79, s75, 13
s_add_u32 s79, s79, s78
ds_read_b128 a[100:103], v10 offset:4096
v_mfma_f32_16x16x32_bf16 v[32:35], a[148:151], a[84:87], v[32:35]
s_add_u32 m0, s77, 32768
s_add_u32 s64, s76, 0
ds_read_b128 a[104:107], v9 offset:6144
v_mfma_f32_16x16x32_bf16 v[52:55], a[156:159], a[84:87], v[52:55]
buffer_load_dwordx4 v7, s[20:23], s64 offen lds
v_mfma_f32_16x16x32_bf16 v[52:55], a[152:155], a[80:83], v[52:55]
ds_read_b64_tr_b16 a[160:161], v11 offset:49152
ds_read_b64_tr_b16 a[162:163], v11 offset:49664
v_mfma_f32_16x16x32_bf16 v[60:63], a[64:67], a[80:83], v[60:63]
v_mfma_f32_16x16x32_bf16 v[60:63], a[68:71], a[84:87], v[60:63]
ds_read_b128 a[108:111], v10 offset:6144
v_mfma_f32_16x16x32_bf16 v[68:71], a[76:79], a[84:87], v[68:71]
buffer_load_dwordx4 v8, s[20:23], s64 offen offset:1024 lds
v_mfma_f32_16x16x32_bf16 v[68:71], a[72:75], a[80:83], v[68:71]
ds_read_b64_tr_b16 a[164:165], v11 offset:53248
ds_read_b64_tr_b16 a[166:167], v11 offset:53760
v_mfma_f32_16x16x32_bf16 v[76:79], a[72:75], a[88:91], v[76:79]
v_add_u32 v9, -65536, v9
v_add_u32 v10, -65536, v10
v_mfma_f32_16x16x32_bf16 v[76:79], a[76:79], a[92:95], v[76:79]
ds_read_b64_tr_b16 a[168:169], v12 offset:49152
ds_read_b64_tr_b16 a[170:171], v12 offset:49664
v_mfma_f32_16x16x32_bf16 v[84:87], a[68:71], a[92:95], v[84:87]
s_add_u32 m0, s80, 32768
s_add_u32 s64, s79, 0
v_mfma_f32_16x16x32_bf16 v[84:87], a[64:67], a[88:91], v[84:87]
ds_read_b64_tr_b16 a[172:173], v12 offset:53248
ds_read_b64_tr_b16 a[174:175], v12 offset:53760
v_mfma_f32_16x16x32_bf16 v[92:95], a[152:155], a[88:91], v[92:95]
buffer_load_dwordx4 v15, s[24:27], s64 offen sc1 lds
v_mfma_f32_16x16x32_bf16 v[92:95], a[156:159], a[92:95], v[92:95]
v_mfma_f32_16x16x32_bf16 v[40:43], a[148:151], a[92:95], v[40:43]
ds_read_b64_tr_b16 a[176:177], v13 offset:49152
ds_read_b64_tr_b16 a[178:179], v13 offset:49664
v_mfma_f32_16x16x32_bf16 v[40:43], a[144:147], a[88:91], v[40:43]
s_add_u32 s53, s87, 266240
v_mfma_f32_16x16x32_bf16 v[100:103], a[136:139], a[88:91], v[100:103]
s_add_u32 m0, s73, 36864
s_add_u32 s64, s72, 0
v_mfma_f32_16x16x32_bf16 v[100:103], a[140:143], a[92:95], v[100:103]
ds_read_b64_tr_b16 a[180:181], v13 offset:53248
ds_read_b64_tr_b16 a[182:183], v13 offset:53760
v_mfma_f32_16x16x32_bf16 v[108:111], a[132:135], a[92:95], v[108:111]
buffer_load_dwordx4 v5, s[12:15], s64 offen lds
v_mfma_f32_16x16x32_bf16 v[108:111], a[128:131], a[88:91], v[108:111]
s_waitcnt lgkmcnt(14)
ds_read_b64_tr_b16 a[184:185], v14 offset:49152
ds_read_b64_tr_b16 a[186:187], v14 offset:49664
v_mfma_f32_16x16x32_bf16 v[116:119], a[128:131], a[96:99], v[116:119]
ds_read_b64_tr_b16 a[188:189], v14 offset:53248
ds_read_b64_tr_b16 a[190:191], v14 offset:53760
v_mfma_f32_16x16x32_bf16 v[116:119], a[132:135], a[100:103], v[116:119]
buffer_store_dwordx4 v[216:219], v15, s[24:27], s53 offen offset:1024 sc1
v_mfma_f32_16x16x32_bf16 v[124:127], a[140:143], a[100:103], v[124:127]
v_mfma_f32_16x16x32_bf16 v[124:127], a[136:139], a[96:99], v[124:127]
ds_read_b128 a[112:115], v4 offset:57344
v_accvgpr_read_b32 v216, a200
v_mfma_f32_16x16x32_bf16 v[132:135], a[144:147], a[96:99], v[132:135]
buffer_load_dwordx4 v6, s[12:15], s64 offen offset:1024 lds
v_mfma_f32_16x16x32_bf16 v[132:135], a[148:151], a[100:103], v[132:135]
ds_read_b128 a[116:119], v4 offset:59392
v_accvgpr_read_b32 v217, a201
v_mfma_f32_16x16x32_bf16 v[140:143], a[156:159], a[100:103], v[140:143]
v_accvgpr_read_b32 v218, a202
v_accvgpr_read_b32 v219, a203
v_mfma_f32_16x16x32_bf16 v[140:143], a[152:155], a[96:99], v[140:143]
s_lshr_b32 s84, s7, 1
s_and_b32 s85, s7, 1
ds_read_b128 a[120:123], v4 offset:58368
v_mfma_f32_16x16x32_bf16 v[148:151], a[64:67], a[96:99], v[148:151]
s_add_u32 m0, s73, 38912
s_add_u32 s64, s72, 18432
s_xor_b32 s52, s5, 0
v_mfma_f32_16x16x32_bf16 v[148:151], a[68:71], a[100:103], v[148:151]
s_lshl1_add_u32 s85, s52, s85
s_and_b32 s86, s6, 3
ds_read_b128 a[124:127], v4 offset:60416
v_mfma_f32_16x16x32_bf16 v[48:51], a[76:79], a[100:103], v[48:51]
buffer_load_dwordx4 v5, s[12:15], s64 offen lds
v_mfma_f32_16x16x32_bf16 v[48:51], a[72:75], a[96:99], v[48:51]
s_waitcnt lgkmcnt(15)
s_lshl_b32 s83, s3, 13
s_add_u32 s83, s83, 131072
v_mfma_f32_16x16x32_bf16 v[156:159], a[72:75], a[104:107], v[156:159]
s_mul_i32 s52, s2, 5462
s_lshr_b32 s52, s52, 16
s_mul_i32 s54, s52, 12
v_mfma_f32_16x16x32_bf16 v[156:159], a[76:79], a[108:111], v[156:159]
s_sub_u32 s54, s2, s54
s_mul_i32 s54, s54, 3
s_add_u32 s54, s54, s3
v_mfma_f32_16x16x32_bf16 v[164:167], a[68:71], a[108:111], v[164:167]
s_mul_i32 s55, s52, 13108
s_lshr_b32 s55, s55, 16
s_mul_i32 s82, s55, 5
v_mfma_f32_16x16x32_bf16 v[164:167], a[64:67], a[104:107], v[164:167]
s_sub_u32 s52, s52, s82
v_mfma_f32_16x16x32_bf16 v[172:175], a[152:155], a[104:107], v[172:175]
buffer_load_dwordx4 v6, s[12:15], s64 offen offset:1024 lds
v_mfma_f32_16x16x32_bf16 v[172:175], a[156:159], a[108:111], v[172:175]
v_lshrrev_b32 v16, 1, v1
v_and_b32 v17, 1, v1
v_mfma_f32_16x16x32_bf16 v[56:59], a[148:151], a[108:111], v[56:59]
v_mul_u32_u24 v18, 1152, v16
v_lshl_add_u32 v18, v17, 4, v18
v_mfma_f32_16x16x32_bf16 v[56:59], a[144:147], a[104:107], v[56:59]
v_mov_b32 v24, v18
v_lshrrev_b32 v18, 4, v16
v_mfma_f32_16x16x32_bf16 v[180:183], a[136:139], a[104:107], v[180:183]
v_bfe_u32 v19, v16, 2, 2
v_and_b32 v16, 3, v16
v_mfma_f32_16x16x32_bf16 v[180:183], a[140:143], a[108:111], v[180:183]
v_lshrrev_b32 v20, 1, v19
v_mul_u32_u24 v20, 18, v20
v_mfma_f32_16x16x32_bf16 v[188:191], a[132:135], a[108:111], v[188:191]
s_add_u32 s53, s88, 524288
v_and_b32 v21, 1, v19
v_lshl_add_u32 v20, v21, 1, v20
v_mfma_f32_16x16x32_bf16 v[188:191], a[128:131], a[104:107], v[188:191]
s_waitcnt lgkmcnt(0)
v_lshl_add_u32 v20, v16, 2, v20
v_add_u32 v20, v20, v18
v_mfma_f32_16x16x32_bf16 v[196:199], a[160:163], a[80:83], v[196:199]
s_waitcnt vmcnt(18)
v_mad_u32_u24 v20, s52, 36, v20
v_lshlrev_b32 v21, 1, v18
v_mfma_f32_16x16x32_bf16 v[196:199], a[164:167], a[84:87], v[196:199]
s_barrier
v_mfma_f32_16x16x32_bf16 v[64:67], a[172:175], a[84:87], v[64:67]
ds_read_b64_tr_b16 a[128:129], v11 offset:0
ds_read_b64_tr_b16 a[130:131], v11 offset:512
v_mfma_f32_16x16x32_bf16 v[64:67], a[168:171], a[80:83], v[64:67]
s_add_u32 m0, s77, 49152
s_add_u32 s64, s76, 128
v_lshl_add_u32 v21, v19, 2, v21
v_mfma_f32_16x16x32_bf16 v[204:207], a[176:179], a[80:83], v[204:207]
buffer_load_dwordx4 v7, s[20:23], s64 offen lds
v_mfma_f32_16x16x32_bf16 v[204:207], a[180:183], a[84:87], v[204:207]
ds_read_b64_tr_b16 a[132:133], v11 offset:4096
ds_read_b64_tr_b16 a[134:135], v11 offset:4608
v_mfma_f32_16x16x32_bf16 v[212:215], a[188:191], a[84:87], v[212:215]
ds_read_b64_tr_b16 a[136:137], v12 offset:0
ds_read_b64_tr_b16 a[138:139], v12 offset:512
v_mfma_f32_16x16x32_bf16 v[212:215], a[184:187], a[80:83], v[212:215]
ds_read_b64_tr_b16 a[140:141], v12 offset:4096
ds_read_b64_tr_b16 a[142:143], v12 offset:4608
v_mfma_f32_16x16x32_bf16 v[72:75], a[112:115], a[80:83], v[72:75]
buffer_store_dwordx4 v[96:99], v15, s[24:27], s53 offen offset:0 sc1
v_mfma_f32_16x16x32_bf16 v[72:75], a[116:119], a[84:87], v[72:75]
ds_read_b64_tr_b16 a[144:145], v13 offset:0
ds_read_b64_tr_b16 a[146:147], v13 offset:512
v_mfma_f32_16x16x32_bf16 v[220:223], a[124:127], a[84:87], v[220:223]
buffer_load_dwordx4 v8, s[20:23], s64 offen offset:1024 lds
v_mfma_f32_16x16x32_bf16 v[220:223], a[120:123], a[80:83], v[220:223]
ds_read_b64_tr_b16 a[148:149], v13 offset:4096
ds_read_b64_tr_b16 a[150:151], v13 offset:4608
v_mfma_f32_16x16x32_bf16 v[252:255], a[120:123], a[88:91], v[252:255]
v_lshrrev_b32 v22, 1, v16
v_add_u32 v21, v21, v22
v_mfma_f32_16x16x32_bf16 v[252:255], a[124:127], a[92:95], v[252:255]
ds_read_b64_tr_b16 a[152:153], v14 offset:0
ds_read_b64_tr_b16 a[154:155], v14 offset:512
v_mfma_f32_16x16x32_bf16 v[160:163], a[116:119], a[92:95], v[160:163]
s_add_u32 m0, s80, 49152
s_add_u32 s64, s79, 2048
v_mul_u32_u24 v21, 18, v21
v_mfma_f32_16x16x32_bf16 v[160:163], a[112:115], a[88:91], v[160:163]
ds_read_b64_tr_b16 a[156:157], v14 offset:4096
ds_read_b64_tr_b16 a[158:159], v14 offset:4608
v_mfma_f32_16x16x32_bf16 v[228:231], a[184:187], a[88:91], v[228:231]
buffer_load_dwordx4 v15, s[24:27], s64 offen sc1 lds
v_mfma_f32_16x16x32_bf16 v[228:231], a[188:191], a[92:95], v[228:231]
s_xor_b32 s65, s70, 640
s_add_u32 s71, s68, s65
s_add_u32 s72, s69, s65
v_mfma_f32_16x16x32_bf16 v[168:171], a[180:183], a[92:95], v[168:171]
ds_read_b128 a[64:67], v4 offset:8192
v_and_b32 v22, 1, v16
v_mfma_f32_16x16x32_bf16 v[168:171], a[176:179], a[88:91], v[168:171]
v_add3_u32 v21, v21, v22, 16
v_cmp_lt_u32 s[96:97], 1, v19
v_mfma_f32_16x16x32_bf16 v[176:179], a[168:171], a[88:91], v[176:179]
s_add_u32 m0, s73, 65536
s_add_u32 s64, s71, 0
ds_read_b128 a[80:83], v9 offset:0
v_mfma_f32_16x16x32_bf16 v[176:179], a[172:175], a[92:95], v[176:179]
v_mov_b32 v22, 0x100000
v_mul_u32_u24 v23, 1, v23
v_mfma_f32_16x16x32_bf16 v[80:83], a[164:167], a[92:95], v[80:83]
buffer_load_dwordx4 v5, s[12:15], s64 offen lds
v_mfma_f32_16x16x32_bf16 v[80:83], a[160:163], a[88:91], v[80:83]
ds_read_b128 a[68:71], v4 offset:10240
v_cndmask_b32 v21, v21, v22, s[96:97]
v_mfma_f32_16x16x32_bf16 v[184:187], a[160:163], a[96:99], v[184:187]
ds_read_b128 a[84:87], v10 offset:0
v_mov_b32 v22, s52
v_mfma_f32_16x16x32_bf16 v[184:187], a[164:167], a[100:103], v[184:187]
s_add_u32 s53, s88, 524288
v_cmp_eq_u32 s[96:97], 4, v22
v_mfma_f32_16x16x32_bf16 v[248:251], a[172:175], a[100:103], v[248:251]
buffer_store_dwordx4 v[104:107], v15, s[24:27], s53 offen offset:1024 sc1
v_mfma_f32_16x16x32_bf16 v[248:251], a[168:171], a[96:99], v[248:251]
ds_read_b128 a[72:75], v4 offset:9216
v_cndmask_b32 v20, v20, v21, s[96:97]
v_mfma_f32_16x16x32_bf16 v[240:243], a[176:179], a[96:99], v[240:243]
buffer_load_dwordx4 v6, s[12:15], s64 offen offset:1024 lds
v_mfma_f32_16x16x32_bf16 v[240:243], a[180:183], a[100:103], v[240:243]
ds_read_b128 a[88:91], v9 offset:2048
v_mul_u32_u24 v20, 1152, v20
v_mfma_f32_16x16x32_bf16 v[232:235], a[188:191], a[100:103], v[232:235]
v_lshl_add_u32 v20, v17, 4, v20
v_mov_b32 v25, v20
v_mfma_f32_16x16x32_bf16 v[232:235], a[184:187], a[96:99], v[232:235]
ds_read_b128 a[76:79], v4 offset:11264
v_mov_b32 v16, s54
v_mfma_f32_16x16x32_bf16 v[236:239], a[112:115], a[96:99], v[236:239]
s_add_u32 m0, s73, 67584
s_add_u32 s64, s71, 18432
v_mov_b32 v17, s55
v_mfma_f32_16x16x32_bf16 v[236:239], a[116:119], a[100:103], v[236:239]
ds_read_b128 a[92:95], v10 offset:2048
v_add_u32 v18, 32, v22
v_mfma_f32_16x16x32_bf16 v[224:227], a[124:127], a[100:103], v[224:227]
buffer_load_dwordx4 v5, s[12:15], s64 offen lds
v_mfma_f32_16x16x32_bf16 v[224:227], a[120:123], a[96:99], v[224:227]
s_mul_i32 s82, s55, 165888
s_lshl_b32 s54, s54, 5
s_add_u32 s82, s82, s54
v_mfma_f32_16x16x32_bf16 v[208:211], a[120:123], a[104:107], v[208:211]
s_and_b32 s52, s2, 1
s_lshr_b32 s54, s3, 1
s_lshl1_add_u32 s52, s52, s54
v_mfma_f32_16x16x32_bf16 v[208:211], a[124:127], a[108:111], v[208:211]
s_mul_i32 s52, s52, 9
s_and_b32 s54, s3, 1
s_mul_i32 s55, s54, 5
v_mfma_f32_16x16x32_bf16 v[216:219], a[116:119], a[108:111], v[216:219]
s_add_u32 s52, s52, s55
s_lshr_b32 s55, s2, 1
s_mul_i32 s81, s55, 1152
v_mfma_f32_16x16x32_bf16 v[216:219], a[112:115], a[104:107], v[216:219]
s_add_u32 s81, s81, s52
s_lshl_b32 s81, s81, 5
v_mfma_f32_16x16x32_bf16 v[244:247], a[184:187], a[104:107], v[244:247]
buffer_load_dwordx4 v6, s[12:15], s64 offen offset:1024 lds
v_mfma_f32_16x16x32_bf16 v[244:247], a[188:191], a[108:111], v[244:247]
v_cmp_gt_u32 s[96:97], 5, v1
v_add_u32 v19, s52, v1
v_mfma_f32_16x16x32_bf16 v[192:195], a[180:183], a[108:111], v[192:195]
v_lshrrev_b32 v20, 5, s55
v_and_b32 v21, 31, s55
v_mfma_f32_16x16x32_bf16 v[192:195], a[176:179], a[104:107], v[192:195]
v_cndmask_b32 v16, v16, v19, s[96:97]
v_cndmask_b32 v17, v17, v20, s[96:97]
v_mfma_f32_16x16x32_bf16 v[200:203], a[168:171], a[104:107], v[200:203]
v_cndmask_b32 v18, v18, v21, s[96:97]
v_mul_u32_u24 v19, 7282, v16
v_mfma_f32_16x16x32_bf16 v[200:203], a[172:175], a[108:111], v[200:203]
v_lshrrev_b32 v19, 16, v19
v_mul_u32_u24 v20, 9, v19
v_mfma_f32_16x16x32_bf16 v[88:91], a[164:167], a[108:111], v[88:91]
v_sub_u32 v16, v16, v20
v_and_b32 v20, 1, v19
v_mfma_f32_16x16x32_bf16 v[88:91], a[160:163], a[104:107], v[88:91]
s_waitcnt lgkmcnt(0)
v_lshlrev_b32 v20, 2, v20
v_cndmask_b32 v20, 0, v20, s[96:97]
v_mfma_f32_16x16x32_bf16 v[36:39], a[128:131], a[80:83], v[36:39]
s_waitcnt vmcnt(24)
v_xor_b32 v18, v18, v20
v_lshl_add_u32 v19, v19, 2, v17
v_mfma_f32_16x16x32_bf16 v[36:39], a[132:135], a[84:87], v[36:39]
s_barrier
v_mfma_f32_16x16x32_bf16 v[44:47], a[140:143], a[84:87], v[44:47]
ds_read_b128 a[96:99], v9 offset:4096
v_mul_u32_u24 v19, 344064, v19
v_mfma_f32_16x16x32_bf16 v[44:47], a[136:139], a[80:83], v[44:47]
s_xor_b32 s75, s93, 5
s_lshl_b32 s76, s75, 19
s_add_u32 s76, s76, s74
v_mfma_f32_16x16x32_bf16 v[32:35], a[144:147], a[80:83], v[32:35]
s_lshl_b32 s79, s75, 13
s_add_u32 s79, s79, s78
ds_read_b128 a[100:103], v10 offset:4096
v_mfma_f32_16x16x32_bf16 v[32:35], a[148:151], a[84:87], v[32:35]
s_add_u32 m0, s77, 0
s_add_u32 s64, s76, 0
ds_read_b128 a[104:107], v9 offset:6144
v_mfma_f32_16x16x32_bf16 v[52:55], a[156:159], a[84:87], v[52:55]
buffer_load_dwordx4 v7, s[20:23], s64 offen lds
v_mfma_f32_16x16x32_bf16 v[52:55], a[152:155], a[80:83], v[52:55]
s_add_u32 s53, s88, 524288
ds_read_b64_tr_b16 a[160:161], v11 offset:16384
ds_read_b64_tr_b16 a[162:163], v11 offset:16896
v_mfma_f32_16x16x32_bf16 v[60:63], a[64:67], a[80:83], v[60:63]
buffer_store_dwordx4 v[112:115], v15, s[24:27], s53 offen offset:2048 sc1
v_mfma_f32_16x16x32_bf16 v[60:63], a[68:71], a[84:87], v[60:63]
ds_read_b128 a[108:111], v10 offset:6144
v_lshrrev_b32 v20, 1, v16
v_mfma_f32_16x16x32_bf16 v[68:71], a[76:79], a[84:87], v[68:71]
buffer_load_dwordx4 v8, s[20:23], s64 offen offset:1024 lds
v_mfma_f32_16x16x32_bf16 v[68:71], a[72:75], a[80:83], v[68:71]
ds_read_b64_tr_b16 a[164:165], v11 offset:20480
ds_read_b64_tr_b16 a[166:167], v11 offset:20992
v_mfma_f32_16x16x32_bf16 v[76:79], a[72:75], a[88:91], v[76:79]
v_add_u32 v9, 32768, v9
v_add_u32 v10, 32768, v10
v_mfma_f32_16x16x32_bf16 v[76:79], a[76:79], a[92:95], v[76:79]
ds_read_b64_tr_b16 a[168:169], v12 offset:16384
ds_read_b64_tr_b16 a[170:171], v12 offset:16896
v_mfma_f32_16x16x32_bf16 v[84:87], a[68:71], a[92:95], v[84:87]
s_add_u32 m0, s80, 0
s_add_u32 s64, s79, 0
v_sub_u32 v20, v20, v17
v_mfma_f32_16x16x32_bf16 v[84:87], a[64:67], a[88:91], v[84:87]
ds_read_b64_tr_b16 a[172:173], v12 offset:20480
ds_read_b64_tr_b16 a[174:175], v12 offset:20992
v_mfma_f32_16x16x32_bf16 v[92:95], a[152:155], a[88:91], v[92:95]
buffer_load_dwordx4 v15, s[24:27], s64 offen sc1 lds
v_mfma_f32_16x16x32_bf16 v[92:95], a[156:159], a[92:95], v[92:95]
v_add_u32 v20, 3, v20
v_and_b32 v20, 3, v20
v_mfma_f32_16x16x32_bf16 v[40:43], a[148:151], a[92:95], v[40:43]
s_waitcnt vmcnt(23)
ds_read_b64_tr_b16 a[176:177], v13 offset:16384
ds_read_b64_tr_b16 a[178:179], v13 offset:16896
v_mfma_f32_16x16x32_bf16 v[40:43], a[144:147], a[88:91], v[40:43]
v_cmp_gt_u32 vcc, 1, v30
v_cmp_eq_u32 s[96:97], 8, v16
v_mfma_f32_16x16x32_bf16 v[100:103], a[136:139], a[88:91], v[100:103]
s_add_u32 m0, s73, 69632
s_add_u32 s64, s72, 0
v_and_b32 v16, 1, v16
v_mfma_f32_16x16x32_bf16 v[100:103], a[140:143], a[92:95], v[100:103]
ds_read_b64_tr_b16 a[180:181], v13 offset:20480
ds_read_b64_tr_b16 a[182:183], v13 offset:20992
v_mfma_f32_16x16x32_bf16 v[108:111], a[132:135], a[92:95], v[108:111]
buffer_load_dwordx4 v5, s[12:15], s64 offen lds
v_mfma_f32_16x16x32_bf16 v[108:111], a[128:131], a[88:91], v[108:111]
s_waitcnt lgkmcnt(14)
ds_read_b64_tr_b16 a[184:185], v14 offset:16384
ds_read_b64_tr_b16 a[186:187], v14 offset:16896
v_mfma_f32_16x16x32_bf16 v[116:119], a[128:131], a[96:99], v[116:119]
ds_read_b64_tr_b16 a[188:189], v14 offset:20480
ds_read_b64_tr_b16 a[190:191], v14 offset:20992
v_mfma_f32_16x16x32_bf16 v[116:119], a[132:135], a[100:103], v[116:119]
s_cbranch_vccnz CK_ZA
CK_ZA_R:
v_mfma_f32_16x16x32_bf16 v[124:127], a[140:143], a[100:103], v[124:127]
v_lshl_add_u32 v21, v20, 1, v16
v_and_b32 v22, 1, v18
v_mfma_f32_16x16x32_bf16 v[124:127], a[136:139], a[96:99], v[124:127]
ds_read_b128 a[112:115], v4 offset:24576
v_lshl_add_u32 v19, v22, 10, v19
v_mfma_f32_16x16x32_bf16 v[132:135], a[144:147], a[96:99], v[132:135]
buffer_load_dwordx4 v6, s[12:15], s64 offen offset:1024 lds
v_mfma_f32_16x16x32_bf16 v[132:135], a[148:151], a[100:103], v[132:135]
ds_read_b128 a[116:119], v4 offset:26624
v_and_b32 v18, -2, v18
v_mfma_f32_16x16x32_bf16 v[140:143], a[156:159], a[100:103], v[140:143]
v_add_u32 v21, 1, v21
v_cndmask_b32 v21, v21, 0, s[96:97]
v_mfma_f32_16x16x32_bf16 v[140:143], a[152:155], a[96:99], v[140:143]
s_add_u32 s53, s88, 524288
ds_read_b128 a[120:123], v4 offset:25600
v_cndmask_b32 v20, v20, 0, s[96:97]
v_mfma_f32_16x16x32_bf16 v[148:151], a[64:67], a[96:99], v[148:151]
s_add_u32 m0, s73, 71680
s_add_u32 s64, s72, 18432
v_sub_u32 v17, 37, v18
v_mfma_f32_16x16x32_bf16 v[148:151], a[68:71], a[100:103], v[148:151]
ds_read_b128 a[124:127], v4 offset:27648
v_min_u32 v17, 2, v17
v_mfma_f32_16x16x32_bf16 v[48:51], a[76:79], a[100:103], v[48:51]
buffer_load_dwordx4 v5, s[12:15], s64 offen lds
v_mfma_f32_16x16x32_bf16 v[48:51], a[72:75], a[96:99], v[48:51]
s_waitcnt lgkmcnt(15)
v_mul_u32_u24 v21, v21, v17
v_mul_u32_u24 v22, v16, v17
v_mfma_f32_16x16x32_bf16 v[156:159], a[72:75], a[104:107], v[156:159]
buffer_store_dwordx4 v[120:123], v15, s[24:27], s53 offen offset:3072 sc1
v_mfma_f32_16x16x32_bf16 v[156:159], a[76:79], a[108:111], v[156:159]
v_min_u32 v23, 8, v18
v_mad_u32_u24 v21, v18, 5, v21
v_mfma_f32_16x16x32_bf16 v[164:167], a[68:71], a[108:111], v[164:167]
v_lshl_add_u32 v21, v23, 1, v21
v_lshl_add_u32 v22, v18, 1, v22
v_mfma_f32_16x16x32_bf16 v[164:167], a[64:67], a[104:107], v[164:167]
v_mad_u32_u24 v22, v20, 37, v22
v_mad_u32_u24 v22, v20, 37, v22
v_mfma_f32_16x16x32_bf16 v[172:175], a[152:155], a[104:107], v[172:175]
buffer_load_dwordx4 v6, s[12:15], s64 offen offset:1024 lds
v_mfma_f32_16x16x32_bf16 v[172:175], a[156:159], a[108:111], v[172:175]
v_lshl_add_u32 v20, v20, 6, v18
v_mov_b32 v23, 136
v_mfma_f32_16x16x32_bf16 v[56:59], a[148:151], a[108:111], v[56:59]
v_cmp_gt_u32 s[96:97], v23, v20
v_add_u32 v22, 37, v22
v_mfma_f32_16x16x32_bf16 v[56:59], a[144:147], a[104:107], v[56:59]
v_add_u32 v19, 38797312, v19
v_mfma_f32_16x16x32_bf16 v[180:183], a[136:139], a[104:107], v[180:183]
v_cndmask_b32 v21, v22, v21, s[96:97]
v_lshl_add_u32 v19, v21, 10, v19
v_mfma_f32_16x16x32_bf16 v[180:183], a[140:143], a[108:111], v[180:183]
s_cmp_eq_u32 s54, 1
s_cselect_b32 s96, 16, 0
v_mfma_f32_16x16x32_bf16 v[188:191], a[132:135], a[108:111], v[188:191]
s_cmp_eq_u32 s3, 3
s_cselect_b32 s52, 32, 0
s_or_b32 s96, s96, s52
v_mfma_f32_16x16x32_bf16 v[188:191], a[128:131], a[104:107], v[188:191]
s_waitcnt lgkmcnt(0)
s_cmp_ge_u32 s2, 240
s_cselect_b32 s52, 32, 0
v_mfma_f32_16x16x32_bf16 v[196:199], a[160:163], a[80:83], v[196:199]
s_waitcnt vmcnt(18)
s_or_b32 s96, s96, s52
s_mov_b32 s97, 0
v_mfma_f32_16x16x32_bf16 v[196:199], a[164:167], a[84:87], v[196:199]
s_barrier
v_mfma_f32_16x16x32_bf16 v[64:67], a[172:175], a[84:87], v[64:67]
ds_read_b64_tr_b16 a[128:129], v11 offset:32768
ds_read_b64_tr_b16 a[130:131], v11 offset:33280
v_mfma_f32_16x16x32_bf16 v[64:67], a[168:171], a[80:83], v[64:67]
s_add_u32 m0, s77, 16384
s_add_u32 s64, s76, 128
v_mov_b32 v20, 2147418112
v_mfma_f32_16x16x32_bf16 v[204:207], a[176:179], a[80:83], v[204:207]
buffer_load_dwordx4 v7, s[20:23], s64 offen lds
v_mfma_f32_16x16x32_bf16 v[204:207], a[180:183], a[84:87], v[204:207]
ds_read_b64_tr_b16 a[132:133], v11 offset:36864
ds_read_b64_tr_b16 a[134:135], v11 offset:37376
v_mfma_f32_16x16x32_bf16 v[212:215], a[188:191], a[84:87], v[212:215]
ds_read_b64_tr_b16 a[136:137], v12 offset:32768
ds_read_b64_tr_b16 a[138:139], v12 offset:33280
v_mfma_f32_16x16x32_bf16 v[212:215], a[184:187], a[80:83], v[212:215]
ds_read_b64_tr_b16 a[140:141], v12 offset:36864
ds_read_b64_tr_b16 a[142:143], v12 offset:37376
v_mfma_f32_16x16x32_bf16 v[72:75], a[112:115], a[80:83], v[72:75]
buffer_atomic_add v1, v0, s[24:27], s90 offen offset:4 sc1
v_mfma_f32_16x16x32_bf16 v[72:75], a[116:119], a[84:87], v[72:75]
ds_read_b64_tr_b16 a[144:145], v13 offset:32768
ds_read_b64_tr_b16 a[146:147], v13 offset:33280
v_mfma_f32_16x16x32_bf16 v[220:223], a[124:127], a[84:87], v[220:223]
buffer_load_dwordx4 v8, s[20:23], s64 offen offset:1024 lds
v_mfma_f32_16x16x32_bf16 v[220:223], a[120:123], a[80:83], v[220:223]
s_add_u32 s53, s88, 786432
ds_read_b64_tr_b16 a[148:149], v13 offset:36864
ds_read_b64_tr_b16 a[150:151], v13 offset:37376
v_mfma_f32_16x16x32_bf16 v[252:255], a[120:123], a[88:91], v[252:255]
buffer_store_dwordx4 v[128:131], v15, s[24:27], s53 offen offset:0 sc1
v_mfma_f32_16x16x32_bf16 v[252:255], a[124:127], a[92:95], v[252:255]
ds_read_b64_tr_b16 a[152:153], v14 offset:32768
ds_read_b64_tr_b16 a[154:155], v14 offset:33280
v_mfma_f32_16x16x32_bf16 v[160:163], a[116:119], a[92:95], v[160:163]
s_add_u32 m0, s80, 16384
s_add_u32 s64, s79, 2048
v_cndmask_b32 v26, v19, v20, s[96:97]
v_mfma_f32_16x16x32_bf16 v[160:163], a[112:115], a[88:91], v[160:163]
ds_read_b64_tr_b16 a[156:157], v14 offset:36864
ds_read_b64_tr_b16 a[158:159], v14 offset:37376
v_mfma_f32_16x16x32_bf16 v[228:231], a[184:187], a[88:91], v[228:231]
buffer_load_dwordx4 v15, s[24:27], s64 offen sc1 lds
v_mfma_f32_16x16x32_bf16 v[228:231], a[188:191], a[92:95], v[228:231]
s_xor_b32 s65, s70, 768
s_add_u32 s71, s68, s65
s_add_u32 s72, s69, s65
v_mfma_f32_16x16x32_bf16 v[168:171], a[180:183], a[92:95], v[168:171]
ds_read_b128 a[64:67], v4 offset:40960
v_lshlrev_b32 v27, 3, v1
v_mfma_f32_16x16x32_bf16 v[168:171], a[176:179], a[88:91], v[168:171]
v_add_u32 v27, s83, v27
v_lshrrev_b32 v22, 3, v1
v_mfma_f32_16x16x32_bf16 v[176:179], a[168:171], a[88:91], v[176:179]
s_add_u32 m0, s73, 0
s_add_u32 s64, s71, 0
ds_read_b128 a[80:83], v9 offset:0
v_mfma_f32_16x16x32_bf16 v[176:179], a[172:175], a[92:95], v[176:179]
L_PAD6:
s_cbranch_execz L_PAD10
v_mul_u32_u24 v22, 1152, v22
v_and_b32 v23, 7, v1
v_mfma_f32_16x16x32_bf16 v[80:83], a[164:167], a[92:95], v[80:83]
buffer_load_dwordx4 v5, s[12:15], s64 offen lds
v_mfma_f32_16x16x32_bf16 v[80:83], a[160:163], a[88:91], v[80:83]
ds_read_b128 a[68:71], v4 offset:43008
v_lshl_add_u32 v22, v23, 4, v22
v_mfma_f32_16x16x32_bf16 v[184:187], a[160:163], a[96:99], v[184:187]
ds_read_b128 a[84:87], v10 offset:0
v_lshrrev_b32 v23, 2, v1
v_mfma_f32_16x16x32_bf16 v[184:187], a[164:167], a[100:103], v[184:187]
v_mul_u32_u24 v23, 96, v23
v_add_u32 v23, v23, v27
v_mfma_f32_16x16x32_bf16 v[248:251], a[172:175], a[100:103], v[248:251]
v_and_b32 v16, 3, v1
v_cmp_eq_u32 s[96:97], 0, v16
v_mfma_f32_16x16x32_bf16 v[248:251], a[168:171], a[96:99], v[248:251]
ds_read_b128 a[72:75], v4 offset:41984
v_mov_b32 v16, 0x3f803f80
v_mfma_f32_16x16x32_bf16 v[240:243], a[176:179], a[96:99], v[240:243]
buffer_load_dwordx4 v6, s[12:15], s64 offen offset:1024 lds
v_mfma_f32_16x16x32_bf16 v[240:243], a[180:183], a[100:103], v[240:243]
ds_read_b128 a[88:91], v9 offset:2048
v_cndmask_b32 v16, 0, v16, s[96:97]
v_mfma_f32_16x16x32_bf16 v[232:235], a[188:191], a[100:103], v[232:235]
v_accvgpr_write_b32 a240, v16
v_accvgpr_write_b32 a241, v16
v_mfma_f32_16x16x32_bf16 v[232:235], a[184:187], a[96:99], v[232:235]
ds_read_b128 a[76:79], v4 offset:44032
v_accvgpr_write_b32 a242, v16
v_mfma_f32_16x16x32_bf16 v[236:239], a[112:115], a[96:99], v[236:239]
s_add_u32 m0, s73, 2048
s_add_u32 s64, s71, 18432
v_accvgpr_write_b32 a243, v16
v_mfma_f32_16x16x32_bf16 v[236:239], a[116:119], a[100:103], v[236:239]
ds_read_b128 a[92:95], v10 offset:2048
v_accvgpr_write_b32 a232, 0
v_mfma_f32_16x16x32_bf16 v[224:227], a[124:127], a[100:103], v[224:227]
buffer_load_dwordx4 v5, s[12:15], s64 offen lds
v_mfma_f32_16x16x32_bf16 v[224:227], a[120:123], a[96:99], v[224:227]
v_accvgpr_write_b32 a233, 0
v_accvgpr_write_b32 a234, 0
v_mfma_f32_16x16x32_bf16 v[208:211], a[120:123], a[104:107], v[208:211]
v_accvgpr_write_b32 a235, 0
v_accvgpr_write_b32 a236, 0
v_mfma_f32_16x16x32_bf16 v[208:211], a[124:127], a[108:111], v[208:211]
s_add_u32 s53, s88, 786432
v_accvgpr_write_b32 a237, 0
v_accvgpr_write_b32 a238, 0
v_mfma_f32_16x16x32_bf16 v[216:219], a[116:119], a[108:111], v[216:219]
buffer_store_dwordx4 v[136:139], v15, s[24:27], s53 offen offset:1024 sc1
v_mfma_f32_16x16x32_bf16 v[216:219], a[112:115], a[104:107], v[216:219]
v_accvgpr_write_b32 a239, 0
v_lshlrev_b32 v16, 2, v3
v_mfma_f32_16x16x32_bf16 v[244:247], a[184:187], a[104:107], v[244:247]
buffer_load_dwordx4 v6, s[12:15], s64 offen offset:1024 lds
v_mfma_f32_16x16x32_bf16 v[244:247], a[188:191], a[108:111], v[244:247]
v_sub_u32 v16, v2, v16
v_cmp_gt_i32 s[56:57], 0, v16
v_mfma_f32_16x16x32_bf16 v[192:195], a[180:183], a[108:111], v[192:195]
v_cmp_gt_i32 s[58:59], 1, v16
v_cmp_gt_i32 s[60:61], 2, v16
v_mfma_f32_16x16x32_bf16 v[192:195], a[176:179], a[104:107], v[192:195]
v_cmp_gt_i32 s[62:63], 3, v16
v_cmp_eq_u32 s[96:97], 3, v3
v_mfma_f32_16x16x32_bf16 v[200:203], a[168:171], a[104:107], v[200:203]
v_add_u32 v17, 48, v2
v_lshlrev_b32 v17, 2, v17
v_mfma_f32_16x16x32_bf16 v[200:203], a[172:175], a[108:111], v[200:203]
v_lshlrev_b32 v18, 16, v3
v_lshl_add_u32 v18, v2, 4, v18
v_mfma_f32_16x16x32_bf16 v[88:91], a[164:167], a[108:111], v[88:91]
v_add_u32 v19, 0x8000, v18
v_cndmask_b32 v19, v19, v20, s[96:97]
v_mfma_f32_16x16x32_bf16 v[88:91], a[160:163], a[104:107], v[88:91]
s_waitcnt lgkmcnt(0)
v_cmp_eq_u32 s[96:97], 0, v3
v_mfma_f32_16x16x32_bf16 v[36:39], a[128:131], a[80:83], v[36:39]
s_waitcnt vmcnt(24)
v_mfma_f32_16x16x32_bf16 v[36:39], a[132:135], a[84:87], v[36:39]
s_barrier
v_mfma_f32_16x16x32_bf16 v[44:47], a[140:143], a[84:87], v[44:47]
ds_read_b128 a[96:99], v9 offset:4096
v_cndmask_b32 v18, v18, v20, s[96:97]
v_mfma_f32_16x16x32_bf16 v[44:47], a[136:139], a[80:83], v[44:47]
s_xor_b32 s75, s93, 6
s_lshl_b32 s76, s75, 19
s_add_u32 s76, s76, s74
v_mfma_f32_16x16x32_bf16 v[32:35], a[144:147], a[80:83], v[32:35]
s_lshl_b32 s79, s75, 13
s_add_u32 s79, s79, s78
ds_read_b128 a[100:103], v10 offset:4096
v_mfma_f32_16x16x32_bf16 v[32:35], a[148:151], a[84:87], v[32:35]
s_add_u32 m0, s77, 32768
s_add_u32 s64, s76, 0
ds_read_b128 a[104:107], v9 offset:6144
v_mfma_f32_16x16x32_bf16 v[52:55], a[156:159], a[84:87], v[52:55]
buffer_load_dwordx4 v7, s[20:23], s64 offen lds
v_mfma_f32_16x16x32_bf16 v[52:55], a[152:155], a[80:83], v[52:55]
ds_read_b64_tr_b16 a[160:161], v11 offset:49152
ds_read_b64_tr_b16 a[162:163], v11 offset:49664
v_mfma_f32_16x16x32_bf16 v[60:63], a[64:67], a[80:83], v[60:63]
v_cndmask_b32 v19, v19, v20, s[96:97]
v_mfma_f32_16x16x32_bf16 v[60:63], a[68:71], a[84:87], v[60:63]
ds_read_b128 a[108:111], v10 offset:6144
v_mfma_f32_16x16x32_bf16 v[68:71], a[76:79], a[84:87], v[68:71]
buffer_load_dwordx4 v8, s[20:23], s64 offen offset:1024 lds
v_mfma_f32_16x16x32_bf16 v[68:71], a[72:75], a[80:83], v[68:71]
ds_read_b64_tr_b16 a[164:165], v11 offset:53248
ds_read_b64_tr_b16 a[166:167], v11 offset:53760
v_mfma_f32_16x16x32_bf16 v[76:79], a[72:75], a[88:91], v[76:79]
v_add_u32 v9, 32768, v9
v_add_u32 v10, 32768, v10
v_mfma_f32_16x16x32_bf16 v[76:79], a[76:79], a[92:95], v[76:79]
ds_read_b64_tr_b16 a[168:169], v12 offset:49152
ds_read_b64_tr_b16 a[170:171], v12 offset:49664
v_mfma_f32_16x16x32_bf16 v[84:87], a[68:71], a[92:95], v[84:87]
s_add_u32 m0, s80, 32768
s_add_u32 s64, s79, 0
v_mfma_f32_16x16x32_bf16 v[84:87], a[64:67], a[88:91], v[84:87]
ds_read_b64_tr_b16 a[172:173], v12 offset:53248
ds_read_b64_tr_b16 a[174:175], v12 offset:53760
v_mfma_f32_16x16x32_bf16 v[92:95], a[152:155], a[88:91], v[92:95]
buffer_load_dwordx4 v15, s[24:27], s64 offen sc1 lds
v_mfma_f32_16x16x32_bf16 v[92:95], a[156:159], a[92:95], v[92:95]
s_add_u32 s53, s88, 786432
v_mfma_f32_16x16x32_bf16 v[40:43], a[148:151], a[92:95], v[40:43]
ds_read_b64_tr_b16 a[176:177], v13 offset:49152
ds_read_b64_tr_b16 a[178:179], v13 offset:49664
v_mfma_f32_16x16x32_bf16 v[40:43], a[144:147], a[88:91], v[40:43]
buffer_store_dwordx4 v[144:147], v15, s[24:27], s53 offen offset:2048 sc1
v_mfma_f32_16x16x32_bf16 v[100:103], a[136:139], a[88:91], v[100:103]
s_add_u32 m0, s73, 4096
s_add_u32 s64, s72, 0
v_mfma_f32_16x16x32_bf16 v[100:103], a[140:143], a[92:95], v[100:103]
ds_read_b64_tr_b16 a[180:181], v13 offset:53248
ds_read_b64_tr_b16 a[182:183], v13 offset:53760
v_mfma_f32_16x16x32_bf16 v[108:111], a[132:135], a[92:95], v[108:111]
buffer_load_dwordx4 v5, s[12:15], s64 offen lds
v_mfma_f32_16x16x32_bf16 v[108:111], a[128:131], a[88:91], v[108:111]
s_waitcnt lgkmcnt(14)
ds_read_b64_tr_b16 a[184:185], v14 offset:49152
ds_read_b64_tr_b16 a[186:187], v14 offset:49664
v_mfma_f32_16x16x32_bf16 v[116:119], a[128:131], a[96:99], v[116:119]
ds_read_b64_tr_b16 a[188:189], v14 offset:53248
ds_read_b64_tr_b16 a[190:191], v14 offset:53760
v_mfma_f32_16x16x32_bf16 v[116:119], a[132:135], a[100:103], v[116:119]
v_mfma_f32_16x16x32_bf16 v[124:127], a[140:143], a[100:103], v[124:127]
v_mfma_f32_16x16x32_bf16 v[124:127], a[136:139], a[96:99], v[124:127]
ds_read_b128 a[112:115], v4 offset:57344
v_mfma_f32_16x16x32_bf16 v[132:135], a[144:147], a[96:99], v[132:135]
buffer_load_dwordx4 v6, s[12:15], s64 offen offset:1024 lds
v_mfma_f32_16x16x32_bf16 v[132:135], a[148:151], a[100:103], v[132:135]
ds_read_b128 a[116:119], v4 offset:59392
v_mfma_f32_16x16x32_bf16 v[140:143], a[156:159], a[100:103], v[140:143]
v_mfma_f32_16x16x32_bf16 v[140:143], a[152:155], a[96:99], v[140:143]
ds_read_b128 a[120:123], v4 offset:58368
v_mfma_f32_16x16x32_bf16 v[148:151], a[64:67], a[96:99], v[148:151]
s_add_u32 m0, s73, 6144
s_add_u32 s64, s72, 18432
v_mfma_f32_16x16x32_bf16 v[148:151], a[68:71], a[100:103], v[148:151]
ds_read_b128 a[124:127], v4 offset:60416
v_mfma_f32_16x16x32_bf16 v[48:51], a[76:79], a[100:103], v[48:51]
buffer_load_dwordx4 v5, s[12:15], s64 offen lds
v_mfma_f32_16x16x32_bf16 v[48:51], a[72:75], a[96:99], v[48:51]
s_waitcnt lgkmcnt(15)
v_mfma_f32_16x16x32_bf16 v[156:159], a[72:75], a[104:107], v[156:159]
v_mfma_f32_16x16x32_bf16 v[156:159], a[76:79], a[108:111], v[156:159]
v_mfma_f32_16x16x32_bf16 v[164:167], a[68:71], a[108:111], v[164:167]
v_mfma_f32_16x16x32_bf16 v[164:167], a[64:67], a[104:107], v[164:167]
v_mfma_f32_16x16x32_bf16 v[172:175], a[152:155], a[104:107], v[172:175]
buffer_load_dwordx4 v6, s[12:15], s64 offen offset:1024 lds
v_mfma_f32_16x16x32_bf16 v[172:175], a[156:159], a[108:111], v[172:175]
v_mfma_f32_16x16x32_bf16 v[56:59], a[148:151], a[108:111], v[56:59]
v_mfma_f32_16x16x32_bf16 v[56:59], a[144:147], a[104:107], v[56:59]
s_add_u32 s53, s88, 786432
v_mfma_f32_16x16x32_bf16 v[180:183], a[136:139], a[104:107], v[180:183]
buffer_store_dwordx4 v[152:155], v15, s[24:27], s53 offen offset:3072 sc1
v_mfma_f32_16x16x32_bf16 v[180:183], a[140:143], a[108:111], v[180:183]
v_mfma_f32_16x16x32_bf16 v[188:191], a[132:135], a[108:111], v[188:191]
v_mfma_f32_16x16x32_bf16 v[188:191], a[128:131], a[104:107], v[188:191]
s_waitcnt lgkmcnt(0)
v_mov_b32 v96, 0
v_mov_b32 v97, 0
v_mfma_f32_16x16x32_bf16 v[196:199], a[160:163], a[80:83], v[196:199]
s_waitcnt vmcnt(19)
v_mov_b32 v98, 0
v_mov_b32 v99, 0
v_mfma_f32_16x16x32_bf16 v[196:199], a[164:167], a[84:87], v[196:199]
s_barrier
v_mfma_f32_16x16x32_bf16 v[64:67], a[172:175], a[84:87], v[64:67]
ds_read_b64_tr_b16 a[128:129], v11 offset:0
ds_read_b64_tr_b16 a[130:131], v11 offset:512
v_mfma_f32_16x16x32_bf16 v[64:67], a[168:171], a[80:83], v[64:67]
s_add_u32 m0, s77, 49152
s_add_u32 s64, s76, 128
v_mov_b32 v104, 0
v_mfma_f32_16x16x32_bf16 v[204:207], a[176:179], a[80:83], v[204:207]
buffer_load_dwordx4 v7, s[20:23], s64 offen lds
v_mfma_f32_16x16x32_bf16 v[204:207], a[180:183], a[84:87], v[204:207]
ds_read_b64_tr_b16 a[132:133], v11 offset:4096
ds_read_b64_tr_b16 a[134:135], v11 offset:4608
v_mfma_f32_16x16x32_bf16 v[212:215], a[188:191], a[84:87], v[212:215]
ds_read_b64_tr_b16 a[136:137], v12 offset:0
ds_read_b64_tr_b16 a[138:139], v12 offset:512
v_mfma_f32_16x16x32_bf16 v[212:215], a[184:187], a[80:83], v[212:215]
ds_read_b64_tr_b16 a[140:141], v12 offset:4096
ds_read_b64_tr_b16 a[142:143], v12 offset:4608
v_mfma_f32_16x16x32_bf16 v[72:75], a[112:115], a[80:83], v[72:75]
buffer_load_dword v30, v29, s[24:27], s89 offen offset:4 sc1
v_mfma_f32_16x16x32_bf16 v[72:75], a[116:119], a[84:87], v[72:75]
ds_read_b64_tr_b16 a[144:145], v13 offset:0
ds_read_b64_tr_b16 a[146:147], v13 offset:512
v_mfma_f32_16x16x32_bf16 v[220:223], a[124:127], a[84:87], v[220:223]
buffer_load_dwordx4 v8, s[20:23], s64 offen offset:1024 lds
v_mfma_f32_16x16x32_bf16 v[220:223], a[120:123], a[80:83], v[220:223]
ds_read_b64_tr_b16 a[148:149], v13 offset:4096
ds_read_b64_tr_b16 a[150:151], v13 offset:4608
v_mfma_f32_16x16x32_bf16 v[252:255], a[120:123], a[88:91], v[252:255]
v_mov_b32 v105, 0
v_mov_b32 v106, 0
v_mfma_f32_16x16x32_bf16 v[252:255], a[124:127], a[92:95], v[252:255]
ds_read_b64_tr_b16 a[152:153], v14 offset:0
ds_read_b64_tr_b16 a[154:155], v14 offset:512
v_mfma_f32_16x16x32_bf16 v[160:163], a[116:119], a[92:95], v[160:163]
s_add_u32 m0, s80, 49152
s_add_u32 s64, s79, 2048
v_mov_b32 v107, 0
v_mfma_f32_16x16x32_bf16 v[160:163], a[112:115], a[88:91], v[160:163]
ds_read_b64_tr_b16 a[156:157], v14 offset:4096
ds_read_b64_tr_b16 a[158:159], v14 offset:4608
v_mfma_f32_16x16x32_bf16 v[228:231], a[184:187], a[88:91], v[228:231]
buffer_load_dwordx4 v15, s[24:27], s64 offen sc1 lds
v_mfma_f32_16x16x32_bf16 v[228:231], a[188:191], a[92:95], v[228:231]
s_xor_b32 s65, s70, 896
s_add_u32 s71, s68, s65
s_add_u32 s72, s69, s65
v_mfma_f32_16x16x32_bf16 v[168:171], a[180:183], a[92:95], v[168:171]
ds_read_b128 a[64:67], v4 offset:8192
v_mov_b32 v112, 0
v_mfma_f32_16x16x32_bf16 v[168:171], a[176:179], a[88:91], v[168:171]
v_mov_b32 v113, 0
v_mov_b32 v114, 0
v_mfma_f32_16x16x32_bf16 v[176:179], a[168:171], a[88:91], v[176:179]
s_add_u32 m0, s73, 32768
s_add_u32 s64, s71, 0
ds_read_b128 a[80:83], v9 offset:0
v_mfma_f32_16x16x32_bf16 v[176:179], a[172:175], a[92:95], v[176:179]
v_mov_b32 v115, 0
v_mov_b32 v120, 0
v_mfma_f32_16x16x32_bf16 v[80:83], a[164:167], a[92:95], v[80:83]
buffer_load_dwordx4 v5, s[12:15], s64 offen lds
v_mfma_f32_16x16x32_bf16 v[80:83], a[160:163], a[88:91], v[80:83]
s_add_u32 s53, s87, 524288
ds_read_b128 a[68:71], v4 offset:10240
v_mov_b32 v121, 0
v_mfma_f32_16x16x32_bf16 v[184:187], a[160:163], a[96:99], v[184:187]
ds_read_b128 a[84:87], v10 offset:0
v_mov_b32 v122, 0
v_mfma_f32_16x16x32_bf16 v[184:187], a[164:167], a[100:103], v[184:187]
buffer_store_dwordx4 a[28:31], v15, s[24:27], s53 offen offset:0 sc1
v_mfma_f32_16x16x32_bf16 v[248:251], a[172:175], a[100:103], v[248:251]
v_mov_b32 v123, 0
v_mov_b32 v128, 0
v_mfma_f32_16x16x32_bf16 v[248:251], a[168:171], a[96:99], v[248:251]
ds_read_b128 a[72:75], v4 offset:9216
v_mov_b32 v129, 0
v_mfma_f32_16x16x32_bf16 v[240:243], a[176:179], a[96:99], v[240:243]
buffer_load_dwordx4 v6, s[12:15], s64 offen offset:1024 lds
v_mfma_f32_16x16x32_bf16 v[240:243], a[180:183], a[100:103], v[240:243]
ds_read_b128 a[88:91], v9 offset:2048
v_mov_b32 v130, 0
v_mfma_f32_16x16x32_bf16 v[232:235], a[188:191], a[100:103], v[232:235]
v_mov_b32 v131, 0
v_mov_b32 v136, 0
v_mfma_f32_16x16x32_bf16 v[232:235], a[184:187], a[96:99], v[232:235]
ds_read_b128 a[76:79], v4 offset:11264
v_mov_b32 v137, 0
v_mfma_f32_16x16x32_bf16 v[236:239], a[112:115], a[96:99], v[236:239]
s_add_u32 m0, s73, 34816
s_add_u32 s64, s71, 18432
v_mov_b32 v138, 0
v_mfma_f32_16x16x32_bf16 v[236:239], a[116:119], a[100:103], v[236:239]
ds_read_b128 a[92:95], v10 offset:2048
v_mov_b32 v139, 0
v_mfma_f32_16x16x32_bf16 v[224:227], a[124:127], a[100:103], v[224:227]
buffer_load_dwordx4 v5, s[12:15], s64 offen lds
v_mfma_f32_16x16x32_bf16 v[224:227], a[120:123], a[96:99], v[224:227]
v_mov_b32 v144, 0
v_mov_b32 v145, 0
v_mfma_f32_16x16x32_bf16 v[208:211], a[120:123], a[104:107], v[208:211]
v_mov_b32 v146, 0
v_mov_b32 v147, 0
v_mfma_f32_16x16x32_bf16 v[208:211], a[124:127], a[108:111], v[208:211]
v_mov_b32 v152, 0
v_mov_b32 v153, 0
v_mfma_f32_16x16x32_bf16 v[216:219], a[116:119], a[108:111], v[216:219]
v_mov_b32 v154, 0
v_mov_b32 v155, 0
v_mfma_f32_16x16x32_bf16 v[216:219], a[112:115], a[104:107], v[216:219]
v_mfma_f32_16x16x32_bf16 v[244:247], a[184:187], a[104:107], v[244:247]
buffer_load_dwordx4 v6, s[12:15], s64 offen offset:1024 lds
v_mfma_f32_16x16x32_bf16 v[244:247], a[188:191], a[108:111], v[244:247]
v_mfma_f32_16x16x32_bf16 v[192:195], a[180:183], a[108:111], v[192:195]
v_mfma_f32_16x16x32_bf16 v[192:195], a[176:179], a[104:107], v[192:195]
v_mfma_f32_16x16x32_bf16 v[200:203], a[168:171], a[104:107], v[200:203]
v_mfma_f32_16x16x32_bf16 v[200:203], a[172:175], a[108:111], v[200:203]
v_mfma_f32_16x16x32_bf16 v[88:91], a[164:167], a[108:111], v[88:91]
v_mfma_f32_16x16x32_bf16 v[88:91], a[160:163], a[104:107], v[88:91]
s_waitcnt lgkmcnt(0)
v_mfma_f32_16x16x32_bf16 v[36:39], a[128:131], a[80:83], v[36:39]
s_waitcnt vmcnt(23)
v_mfma_f32_16x16x32_bf16 v[36:39], a[132:135], a[84:87], v[36:39]
s_barrier
v_mfma_f32_16x16x32_bf16 v[44:47], a[140:143], a[84:87], v[44:47]
s_add_u32 s53, s87, 524288
ds_read_b128 a[96:99], v9 offset:4096
v_mfma_f32_16x16x32_bf16 v[44:47], a[136:139], a[80:83], v[44:47]
s_xor_b32 s75, s93, 7
s_lshl_b32 s76, s75, 19
s_add_u32 s76, s76, s74
v_mfma_f32_16x16x32_bf16 v[32:35], a[144:147], a[80:83], v[32:35]
s_lshl_b32 s79, s75, 13
s_add_u32 s79, s79, s78
ds_read_b128 a[100:103], v10 offset:4096
v_mfma_f32_16x16x32_bf16 v[32:35], a[148:151], a[84:87], v[32:35]
s_add_u32 m0, s77, 0
s_add_u32 s64, s76, 0
ds_read_b128 a[104:107], v9 offset:6144
v_mfma_f32_16x16x32_bf16 v[52:55], a[156:159], a[84:87], v[52:55]
buffer_load_dwordx4 v7, s[20:23], s64 offen lds
v_mfma_f32_16x16x32_bf16 v[52:55], a[152:155], a[80:83], v[52:55]
ds_read_b64_tr_b16 a[160:161], v11 offset:16384
ds_read_b64_tr_b16 a[162:163], v11 offset:16896
v_mfma_f32_16x16x32_bf16 v[60:63], a[64:67], a[80:83], v[60:63]
buffer_store_dwordx4 a[20:23], v15, s[24:27], s53 offen offset:1024 sc1
v_mfma_f32_16x16x32_bf16 v[60:63], a[68:71], a[84:87], v[60:63]
ds_read_b128 a[108:111], v10 offset:6144
v_mfma_f32_16x16x32_bf16 v[68:71], a[76:79], a[84:87], v[68:71]
buffer_load_dwordx4 v8, s[20:23], s64 offen offset:1024 lds
v_mfma_f32_16x16x32_bf16 v[68:71], a[72:75], a[80:83], v[68:71]
ds_read_b64_tr_b16 a[164:165], v11 offset:20480
ds_read_b64_tr_b16 a[166:167], v11 offset:20992
v_mfma_f32_16x16x32_bf16 v[76:79], a[72:75], a[88:91], v[76:79]
v_add_u32 v9, -65536, v9
v_add_u32 v10, -65536, v10
v_mfma_f32_16x16x32_bf16 v[76:79], a[76:79], a[92:95], v[76:79]
ds_read_b64_tr_b16 a[168:169], v12 offset:16384
ds_read_b64_tr_b16 a[170:171], v12 offset:16896
v_mfma_f32_16x16x32_bf16 v[84:87], a[68:71], a[92:95], v[84:87]
s_add_u32 m0, s80, 0
s_add_u32 s64, s79, 0
v_mfma_f32_16x16x32_bf16 v[84:87], a[64:67], a[88:91], v[84:87]
ds_read_b64_tr_b16 a[172:173], v12 offset:20480
ds_read_b64_tr_b16 a[174:175], v12 offset:20992
v_mfma_f32_16x16x32_bf16 v[92:95], a[152:155], a[88:91], v[92:95]
buffer_load_dwordx4 v15, s[24:27], s64 offen sc1 lds
v_mfma_f32_16x16x32_bf16 v[92:95], a[156:159], a[92:95], v[92:95]
v_mfma_f32_16x16x32_bf16 v[40:43], a[148:151], a[92:95], v[40:43]
ds_read_b64_tr_b16 a[176:177], v13 offset:16384
ds_read_b64_tr_b16 a[178:179], v13 offset:16896
v_mfma_f32_16x16x32_bf16 v[40:43], a[144:147], a[88:91], v[40:43]
v_mfma_f32_16x16x32_bf16 v[100:103], a[136:139], a[88:91], v[100:103]
s_add_u32 m0, s73, 36864
s_add_u32 s64, s72, 0
v_mfma_f32_16x16x32_bf16 v[100:103], a[140:143], a[92:95], v[100:103]
ds_read_b64_tr_b16 a[180:181], v13 offset:20480
ds_read_b64_tr_b16 a[182:183], v13 offset:20992
v_mfma_f32_16x16x32_bf16 v[108:111], a[132:135], a[92:95], v[108:111]
buffer_load_dwordx4 v5, s[12:15], s64 offen lds
v_mfma_f32_16x16x32_bf16 v[108:111], a[128:131], a[88:91], v[108:111]
s_waitcnt lgkmcnt(14)
ds_read_b64_tr_b16 a[184:185], v14 offset:16384
ds_read_b64_tr_b16 a[186:187], v14 offset:16896
v_mfma_f32_16x16x32_bf16 v[116:119], a[128:131], a[96:99], v[116:119]
ds_read_b64_tr_b16 a[188:189], v14 offset:20480
ds_read_b64_tr_b16 a[190:191], v14 offset:20992
v_mfma_f32_16x16x32_bf16 v[116:119], a[132:135], a[100:103], v[116:119]
v_mfma_f32_16x16x32_bf16 v[124:127], a[140:143], a[100:103], v[124:127]
v_mfma_f32_16x16x32_bf16 v[124:127], a[136:139], a[96:99], v[124:127]
ds_read_b128 a[112:115], v4 offset:24576
v_mfma_f32_16x16x32_bf16 v[132:135], a[144:147], a[96:99], v[132:135]
buffer_load_dwordx4 v6, s[12:15], s64 offen offset:1024 lds
v_mfma_f32_16x16x32_bf16 v[132:135], a[148:151], a[100:103], v[132:135]
s_add_u32 s53, s87, 528384
ds_read_b128 a[116:119], v4 offset:26624
v_mfma_f32_16x16x32_bf16 v[140:143], a[156:159], a[100:103], v[140:143]
buffer_store_dwordx4 a[12:15], v15, s[24:27], s53 offen offset:0 sc1
v_mfma_f32_16x16x32_bf16 v[140:143], a[152:155], a[96:99], v[140:143]
ds_read_b128 a[120:123], v4 offset:25600
v_mfma_f32_16x16x32_bf16 v[148:151], a[64:67], a[96:99], v[148:151]
s_add_u32 m0, s73, 38912
s_add_u32 s64, s72, 18432
v_mfma_f32_16x16x32_bf16 v[148:151], a[68:71], a[100:103], v[148:151]
ds_read_b128 a[124:127], v4 offset:27648
v_mfma_f32_16x16x32_bf16 v[48:51], a[76:79], a[100:103], v[48:51]
buffer_load_dwordx4 v5, s[12:15], s64 offen lds
v_mfma_f32_16x16x32_bf16 v[48:51], a[72:75], a[96:99], v[48:51]
s_waitcnt lgkmcnt(15)
v_mfma_f32_16x16x32_bf16 v[156:159], a[72:75], a[104:107], v[156:159]
v_mfma_f32_16x16x32_bf16 v[156:159], a[76:79], a[108:111], v[156:159]
v_mfma_f32_16x16x32_bf16 v[164:167], a[68:71], a[108:111], v[164:167]
v_mfma_f32_16x16x32_bf16 v[164:167], a[64:67], a[104:107], v[164:167]
v_mfma_f32_16x16x32_bf16 v[172:175], a[152:155], a[104:107], v[172:175]
buffer_load_dwordx4 v6, s[12:15], s64 offen offset:1024 lds
v_mfma_f32_16x16x32_bf16 v[172:175], a[156:159], a[108:111], v[172:175]
v_mfma_f32_16x16x32_bf16 v[56:59], a[148:151], a[108:111], v[56:59]
v_mfma_f32_16x16x32_bf16 v[56:59], a[144:147], a[104:107], v[56:59]
v_mfma_f32_16x16x32_bf16 v[180:183], a[136:139], a[104:107], v[180:183]
v_mfma_f32_16x16x32_bf16 v[180:183], a[140:143], a[108:111], v[180:183]
v_mfma_f32_16x16x32_bf16 v[188:191], a[132:135], a[108:111], v[188:191]
v_mfma_f32_16x16x32_bf16 v[188:191], a[128:131], a[104:107], v[188:191]
s_waitcnt lgkmcnt(0)
v_mfma_f32_16x16x32_bf16 v[196:199], a[160:163], a[80:83], v[196:199]
s_waitcnt vmcnt(19)
v_mfma_f32_16x16x32_bf16 v[196:199], a[164:167], a[84:87], v[196:199]
s_barrier
v_mfma_f32_16x16x32_bf16 v[64:67], a[172:175], a[84:87], v[64:67]
ds_read_b64_tr_b16 a[128:129], v11 offset:32768
ds_read_b64_tr_b16 a[130:131], v11 offset:33280
v_mfma_f32_16x16x32_bf16 v[64:67], a[168:171], a[80:83], v[64:67]
s_add_u32 m0, s77, 16384
s_add_u32 s64, s76, 128
v_mfma_f32_16x16x32_bf16 v[204:207], a[176:179], a[80:83], v[204:207]
buffer_load_dwordx4 v7, s[20:23], s64 offen lds
v_mfma_f32_16x16x32_bf16 v[204:207], a[180:183], a[84:87], v[204:207]
ds_read_b64_tr_b16 a[132:133], v11 offset:36864
ds_read_b64_tr_b16 a[134:135], v11 offset:37376
v_mfma_f32_16x16x32_bf16 v[212:215], a[188:191], a[84:87], v[212:215]
ds_read_b64_tr_b16 a[136:137], v12 offset:32768
ds_read_b64_tr_b16 a[138:139], v12 offset:33280
v_mfma_f32_16x16x32_bf16 v[212:215], a[184:187], a[80:83], v[212:215]
s_add_u32 s53, s87, 528384
ds_read_b64_tr_b16 a[140:141], v12 offset:36864
ds_read_b64_tr_b16 a[142:143], v12 offset:37376
v_mfma_f32_16x16x32_bf16 v[72:75], a[112:115], a[80:83], v[72:75]
buffer_load_dwordx4 v8, s[20:23], s64 offen offset:1024 lds
v_mfma_f32_16x16x32_bf16 v[72:75], a[116:119], a[84:87], v[72:75]
ds_read_b64_tr_b16 a[144:145], v13 offset:32768
ds_read_b64_tr_b16 a[146:147], v13 offset:33280
v_mfma_f32_16x16x32_bf16 v[220:223], a[124:127], a[84:87], v[220:223]
buffer_store_dwordx4 a[4:7], v15, s[24:27], s53 offen offset:1024 sc1
v_mfma_f32_16x16x32_bf16 v[220:223], a[120:123], a[80:83], v[220:223]
s_add_u32 m0, s80, 16384
s_add_u32 s64, s79, 2048
v_mfma_f32_16x16x32_bf16 v[252:255], a[120:123], a[88:91], v[252:255]
ds_read_b64_tr_b16 a[148:149], v13 offset:36864
ds_read_b64_tr_b16 a[150:151], v13 offset:37376
v_mfma_f32_16x16x32_bf16 v[252:255], a[124:127], a[92:95], v[252:255]
buffer_load_dwordx4 v15, s[24:27], s64 offen sc1 lds
v_mfma_f32_16x16x32_bf16 v[160:163], a[116:119], a[92:95], v[160:163]
ds_read_b64_tr_b16 a[152:153], v14 offset:32768
ds_read_b64_tr_b16 a[154:155], v14 offset:33280
v_mfma_f32_16x16x32_bf16 v[160:163], a[112:115], a[88:91], v[160:163]
ds_read_b64_tr_b16 a[156:157], v14 offset:36864
ds_read_b64_tr_b16 a[158:159], v14 offset:37376
v_mfma_f32_16x16x32_bf16 v[228:231], a[184:187], a[88:91], v[228:231]
s_add_u32 m0, s83, 0
s_add_u32 s64, s81, 0
v_mfma_f32_16x16x32_bf16 v[228:231], a[188:191], a[92:95], v[228:231]
v_mfma_f32_16x16x32_bf16 v[168:171], a[180:183], a[92:95], v[168:171]
buffer_load_dwordx4 v22, s[32:35], s64 offen lds
v_mfma_f32_16x16x32_bf16 v[168:171], a[176:179], a[88:91], v[168:171]
ds_read_b128 a[64:67], v4 offset:40960
v_mfma_f32_16x16x32_bf16 v[176:179], a[168:171], a[88:91], v[176:179]
s_add_u32 m0, s83, 1024
s_add_u32 s64, s81, 9216
ds_read_b128 a[80:83], v9 offset:0
v_mfma_f32_16x16x32_bf16 v[176:179], a[172:175], a[92:95], v[176:179]
v_mfma_f32_16x16x32_bf16 v[80:83], a[164:167], a[92:95], v[80:83]
buffer_load_dwordx4 v22, s[32:35], s64 offen lds
v_mfma_f32_16x16x32_bf16 v[80:83], a[160:163], a[88:91], v[80:83]
ds_read_b128 a[68:71], v4 offset:43008
v_mfma_f32_16x16x32_bf16 v[184:187], a[160:163], a[96:99], v[184:187]
ds_read_b128 a[84:87], v10 offset:0
v_mfma_f32_16x16x32_bf16 v[184:187], a[164:167], a[100:103], v[184:187]
s_add_u32 m0, s83, 2048
s_add_u32 s64, s81, 18432
v_mfma_f32_16x16x32_bf16 v[248:251], a[172:175], a[100:103], v[248:251]
v_mfma_f32_16x16x32_bf16 v[248:251], a[168:171], a[96:99], v[248:251]
buffer_load_dwordx4 v22, s[32:35], s64 offen lds
v_mfma_f32_16x16x32_bf16 v[240:243], a[176:179], a[96:99], v[240:243]
ds_read_b128 a[72:75], v4 offset:41984
v_mfma_f32_16x16x32_bf16 v[240:243], a[180:183], a[100:103], v[240:243]
ds_read_b128 a[88:91], v9 offset:2048
v_mfma_f32_16x16x32_bf16 v[232:235], a[188:191], a[100:103], v[232:235]
s_add_u32 m0, s83, 3072
s_add_u32 s64, s81, 27648
v_mfma_f32_16x16x32_bf16 v[232:235], a[184:187], a[96:99], v[232:235]
ds_read_b128 a[76:79], v4 offset:44032
v_mfma_f32_16x16x32_bf16 v[236:239], a[112:115], a[96:99], v[236:239]
buffer_load_dwordx4 v22, s[32:35], s64 offen lds
v_mfma_f32_16x16x32_bf16 v[236:239], a[116:119], a[100:103], v[236:239]
ds_read_b128 a[92:95], v10 offset:2048
v_mfma_f32_16x16x32_bf16 v[224:227], a[124:127], a[100:103], v[224:227]
s_add_u32 m0, s83, 4096
s_add_u32 s64, s81, 128
s_add_u32 s53, s87, 786432
v_mfma_f32_16x16x32_bf16 v[224:227], a[120:123], a[96:99], v[224:227]
buffer_store_dwordx4 a[0:3], v15, s[24:27], s53 offen offset:0 sc1
v_mfma_f32_16x16x32_bf16 v[208:211], a[120:123], a[104:107], v[208:211]
buffer_load_dwordx4 v24, s[32:35], s64 offen lds
v_mfma_f32_16x16x32_bf16 v[208:211], a[124:127], a[108:111], v[208:211]
s_waitcnt vmcnt(26)
v_mfma_f32_16x16x32_bf16 v[216:219], a[116:119], a[108:111], v[216:219]
v_cmp_gt_u32 vcc, 8, v30
v_mfma_f32_16x16x32_bf16 v[216:219], a[112:115], a[104:107], v[216:219]
s_add_u32 m0, s83, 5120
s_add_u32 s64, s82, 0
v_mfma_f32_16x16x32_bf16 v[244:247], a[184:187], a[104:107], v[244:247]
v_mfma_f32_16x16x32_bf16 v[244:247], a[188:191], a[108:111], v[244:247]
buffer_load_dwordx4 v25, s[48:51], s64 offen lds
v_mfma_f32_16x16x32_bf16 v[192:195], a[180:183], a[108:111], v[192:195]
v_mfma_f32_16x16x32_bf16 v[192:195], a[176:179], a[104:107], v[192:195]
s_cbranch_vccnz CK_KV
CK_KV_R:
v_mfma_f32_16x16x32_bf16 v[200:203], a[168:171], a[104:107], v[200:203]
v_mfma_f32_16x16x32_bf16 v[200:203], a[172:175], a[108:111], v[200:203]
v_mfma_f32_16x16x32_bf16 v[88:91], a[164:167], a[108:111], v[88:91]
v_mfma_f32_16x16x32_bf16 v[88:91], a[160:163], a[104:107], v[88:91]
s_waitcnt lgkmcnt(0)
v_mfma_f32_16x16x32_bf16 v[36:39], a[128:131], a[80:83], v[36:39]
s_waitcnt vmcnt(25)
v_mov_b32 v6, 0xf149f2ca
v_mfma_f32_16x16x32_bf16 v[36:39], a[132:135], a[84:87], v[36:39]
s_barrier
v_mfma_f32_16x16x32_bf16 v[44:47], a[140:143], a[84:87], v[44:47]
ds_read_b128 a[96:99], v9 offset:4096
v_mfma_f32_16x16x32_bf16 v[44:47], a[136:139], a[80:83], v[44:47]
s_lshl_b32 s70, s3, 12
s_add_u32 s68, s70, s94
ds_read_b128 a[100:103], v10 offset:4096
v_mfma_f32_16x16x32_bf16 v[32:35], a[144:147], a[80:83], v[32:35]
s_add_u32 m0, s70, 32768
s_cmp_lt_u32 s3, 2
s_cselect_b32 s64, s68, 2147418112
v_mfma_f32_16x16x32_bf16 v[32:35], a[148:151], a[84:87], v[32:35]
buffer_load_dwordx4 v15, s[24:27], s64 offen offset:0 sc1 lds
v_mfma_f32_16x16x32_bf16 v[52:55], a[156:159], a[84:87], v[52:55]
ds_read_b128 a[104:107], v9 offset:6144
v_mfma_f32_16x16x32_bf16 v[52:55], a[152:155], a[80:83], v[52:55]
ds_read_b64_tr_b16 a[160:161], v11 offset:49152
ds_read_b64_tr_b16 a[162:163], v11 offset:49664
v_mfma_f32_16x16x32_bf16 v[60:63], a[64:67], a[80:83], v[60:63]
s_cmp_eq_u32 s66, 0
s_cbranch_scc1 D0
D0_R:
v_mfma_f32_16x16x32_bf16 v[60:63], a[68:71], a[84:87], v[60:63]
s_lshl_b32 s52, s4, 18
s_add_u32 s52, s52, 45088768
ds_read_b128 a[108:111], v10 offset:6144
v_mfma_f32_16x16x32_bf16 v[68:71], a[76:79], a[84:87], v[68:71]
s_lshl_b32 s54, s66, 9
v_add_u32 v9, 32768, v9
v_add_u32 v10, 32768, v10
v_mfma_f32_16x16x32_bf16 v[68:71], a[72:75], a[80:83], v[68:71]
s_add_u32 s54, s54, s52
ds_read_b64_tr_b16 a[164:165], v11 offset:53248
ds_read_b64_tr_b16 a[166:167], v11 offset:53760
v_mfma_f32_16x16x32_bf16 v[76:79], a[72:75], a[88:91], v[76:79]
s_lshl_b32 s55, s67, 9
s_add_u32 s55, s55, s52
v_mfma_f32_16x16x32_bf16 v[76:79], a[76:79], a[92:95], v[76:79]
s_add_u32 s53, s87, 786432
ds_read_b64_tr_b16 a[168:169], v12 offset:49152
ds_read_b64_tr_b16 a[170:171], v12 offset:49664
L_PAD7:
s_cbranch_execz L_PAD11
v_mfma_f32_16x16x32_bf16 v[84:87], a[68:71], a[92:95], v[84:87]
buffer_load_dwordx4 v15, s[24:27], s64 offen offset:1024 sc1 lds
v_mfma_f32_16x16x32_bf16 v[84:87], a[64:67], a[88:91], v[84:87]
s_max_u32 s65, s66, 1
ds_read_b64_tr_b16 a[172:173], v12 offset:53248
ds_read_b64_tr_b16 a[174:175], v12 offset:53760
v_mfma_f32_16x16x32_bf16 v[92:95], a[152:155], a[88:91], v[92:95]
buffer_store_dwordx4 a[8:11], v15, s[24:27], s53 offen offset:1024 sc1
v_mfma_f32_16x16x32_bf16 v[92:95], a[156:159], a[92:95], v[92:95]
s_lshl_b32 s65, s65, 9
s_add_u32 s52, s52, s65
s_sub_u32 s65, s55, s52
v_mfma_f32_16x16x32_bf16 v[40:43], a[148:151], a[92:95], v[40:43]
s_sub_u32 s65, s65, 163840
ds_read_b64_tr_b16 a[176:177], v13 offset:49152
ds_read_b64_tr_b16 a[178:179], v13 offset:49664
v_mfma_f32_16x16x32_bf16 v[40:43], a[144:147], a[88:91], v[40:43]
s_add_u32 s52, s52, 65280
v_mfma_f32_16x16x32_bf16 v[100:103], a[136:139], a[88:91], v[100:103]
ds_read_b64_tr_b16 a[180:181], v13 offset:53248
ds_read_b64_tr_b16 a[182:183], v13 offset:53760
v_mfma_f32_16x16x32_bf16 v[100:103], a[140:143], a[92:95], v[100:103]
v_cmp_lt_u32 s[96:97], 0, v3
v_lshlrev_b32 v16, 15, v3
v_mfma_f32_16x16x32_bf16 v[108:111], a[132:135], a[92:95], v[108:111]
ds_read_b64_tr_b16 a[184:185], v14 offset:49152
ds_read_b64_tr_b16 a[186:187], v14 offset:49664
v_mfma_f32_16x16x32_bf16 v[108:111], a[128:131], a[88:91], v[108:111]
s_waitcnt lgkmcnt(15)
v_lshl_add_u32 v16, v2, 4, v16
v_add_u32 v16, s52, v16
v_mfma_f32_16x16x32_bf16 v[116:119], a[128:131], a[96:99], v[116:119]
ds_read_b64_tr_b16 a[188:189], v14 offset:53248
ds_read_b64_tr_b16 a[190:191], v14 offset:53760
v_mfma_f32_16x16x32_bf16 v[116:119], a[132:135], a[100:103], v[116:119]
buffer_load_dwordx4 v15, s[24:27], s64 offen offset:2048 sc1 lds
v_mfma_f32_16x16x32_bf16 v[124:127], a[140:143], a[100:103], v[124:127]
v_accvgpr_write_b32 a244, v16
v_add_u32 v16, 131072, v16
v_mfma_f32_16x16x32_bf16 v[124:127], a[136:139], a[96:99], v[124:127]
ds_read_b128 a[112:115], v4 offset:57344
v_add_u32 v21, s65, v16
v_mfma_f32_16x16x32_bf16 v[132:135], a[144:147], a[96:99], v[132:135]
v_cndmask_b32 v16, v16, v21, s[96:97]
v_accvgpr_write_b32 a248, v16
v_mfma_f32_16x16x32_bf16 v[132:135], a[148:151], a[100:103], v[132:135]
ds_read_b128 a[116:119], v4 offset:59392
v_cmp_lt_u32 s[96:97], 1, v3
v_mfma_f32_16x16x32_bf16 v[140:143], a[156:159], a[100:103], v[140:143]
v_add_u32 v21, 131072, v21
v_mfma_f32_16x16x32_bf16 v[140:143], a[152:155], a[96:99], v[140:143]
ds_read_b128 a[120:123], v4 offset:58368
v_cndmask_b32 v21, v21, v20, s[96:97]
v_mfma_f32_16x16x32_bf16 v[148:151], a[64:67], a[96:99], v[148:151]
v_accvgpr_write_b32 a252, v21
v_mfma_f32_16x16x32_bf16 v[148:151], a[68:71], a[100:103], v[148:151]
s_lshr_b32 s52, s4, 3
s_mul_i32 s52, s52, 75776
ds_read_b128 a[124:127], v4 offset:60416
v_mfma_f32_16x16x32_bf16 v[48:51], a[76:79], a[100:103], v[48:51]
s_waitcnt lgkmcnt(15)
s_add_u32 s52, s52, 54525952
s_and_b32 s65, s4, 7
v_mfma_f32_16x16x32_bf16 v[48:51], a[72:75], a[96:99], v[48:51]
buffer_load_dwordx4 v15, s[24:27], s64 offen offset:3072 sc1 lds
v_mfma_f32_16x16x32_bf16 v[156:159], a[72:75], a[104:107], v[156:159]
s_mul_i32 s65, s65, 8192
s_add_u32 s52, s52, s65
s_mul_i32 s78, s66, 303104
v_mfma_f32_16x16x32_bf16 v[156:159], a[76:79], a[108:111], v[156:159]
s_add_u32 s78, s78, s52
s_mul_i32 s79, s67, 303104
s_add_u32 s79, s79, s52
v_mfma_f32_16x16x32_bf16 v[164:167], a[68:71], a[108:111], v[164:167]
s_cmp_lt_u32 s4, 16
s_cselect_b32 s90, s66, s67
s_and_b32 s52, s4, 15
v_mfma_f32_16x16x32_bf16 v[164:167], a[64:67], a[104:107], v[164:167]
s_lshl4_add_u32 s90, s90, s52
s_mul_i32 s90, s90, 2304
s_mov_b32 s76, 0
v_mfma_f32_16x16x32_bf16 v[172:175], a[152:155], a[104:107], v[172:175]
s_add_u32 s53, s87, 790528
v_mov_b32 v7, 0x5d800000
v_and_b32 v28, 31, v1
v_mfma_f32_16x16x32_bf16 v[172:175], a[156:159], a[108:111], v[172:175]
buffer_store_dwordx4 a[16:19], v15, s[24:27], s53 offen offset:0 sc1
v_mfma_f32_16x16x32_bf16 v[56:59], a[148:151], a[108:111], v[56:59]
v_lshlrev_b32 v28, 10, v28
v_add_u32 v28, 75497992, v28
v_mfma_f32_16x16x32_bf16 v[56:59], a[144:147], a[104:107], v[56:59]
v_lshlrev_b32 v31, 2, v1
v_mfma_f32_16x16x32_bf16 v[180:183], a[136:139], a[104:107], v[180:183]
v_mfma_f32_16x16x32_bf16 v[180:183], a[140:143], a[108:111], v[180:183]
v_mfma_f32_16x16x32_bf16 v[188:191], a[132:135], a[108:111], v[188:191]
v_mfma_f32_16x16x32_bf16 v[188:191], a[128:131], a[104:107], v[188:191]
s_waitcnt lgkmcnt(0)
v_mfma_f32_16x16x32_bf16 v[196:199], a[160:163], a[80:83], v[196:199]
s_waitcnt vmcnt(17)
v_mfma_f32_16x16x32_bf16 v[196:199], a[164:167], a[84:87], v[196:199]
s_barrier
v_mfma_f32_16x16x32_bf16 v[64:67], a[172:175], a[84:87], v[64:67]
ds_read_b64_tr_b16 a[128:129], v11 offset:0
ds_read_b64_tr_b16 a[130:131], v11 offset:512
v_mfma_f32_16x16x32_bf16 v[64:67], a[168:171], a[80:83], v[64:67]
s_add_u32 m0, s70, 49152
s_add_u32 s64, s68, 16384
s_waitcnt vmcnt(6)
v_mfma_f32_16x16x32_bf16 v[204:207], a[176:179], a[80:83], v[204:207]
buffer_load_dwordx4 v15, s[24:27], s64 offen offset:0 sc1 lds
v_mfma_f32_16x16x32_bf16 v[204:207], a[180:183], a[84:87], v[204:207]
ds_read_b64_tr_b16 a[132:133], v11 offset:4096
ds_read_b64_tr_b16 a[134:135], v11 offset:4608
v_mfma_f32_16x16x32_bf16 v[212:215], a[188:191], a[84:87], v[212:215]
ds_read_b64_tr_b16 a[136:137], v12 offset:0
ds_read_b64_tr_b16 a[138:139], v12 offset:512
v_mfma_f32_16x16x32_bf16 v[212:215], a[184:187], a[80:83], v[212:215]
ds_read_b64_tr_b16 a[140:141], v12 offset:4096
ds_read_b64_tr_b16 a[142:143], v12 offset:4608
v_mfma_f32_16x16x32_bf16 v[72:75], a[112:115], a[80:83], v[72:75]
ds_read_b64_tr_b16 a[192:193], v23 offset:0
ds_read_b64_tr_b16 a[194:195], v23 offset:2048
v_mfma_f32_16x16x32_bf16 v[72:75], a[116:119], a[84:87], v[72:75]
ds_read_b64_tr_b16 a[144:145], v13 offset:0
ds_read_b64_tr_b16 a[146:147], v13 offset:512
v_mfma_f32_16x16x32_bf16 v[220:223], a[124:127], a[84:87], v[220:223]
ds_read_b64_tr_b16 a[196:197], v23 offset:32
ds_read_b64_tr_b16 a[198:199], v23 offset:2080
v_mfma_f32_16x16x32_bf16 v[220:223], a[120:123], a[80:83], v[220:223]
ds_read_b64_tr_b16 a[148:149], v13 offset:4096
ds_read_b64_tr_b16 a[150:151], v13 offset:4608
v_mfma_f32_16x16x32_bf16 v[252:255], a[120:123], a[88:91], v[252:255]
ds_read_b64_tr_b16 a[200:201], v23 offset:64
ds_read_b64_tr_b16 a[202:203], v23 offset:2112
v_mfma_f32_16x16x32_bf16 v[252:255], a[124:127], a[92:95], v[252:255]
ds_read_b64_tr_b16 a[152:153], v14 offset:0
ds_read_b64_tr_b16 a[154:155], v14 offset:512
v_mfma_f32_16x16x32_bf16 v[160:163], a[116:119], a[92:95], v[160:163]
buffer_load_dwordx4 v15, s[24:27], s64 offen offset:1024 sc1 lds
v_mfma_f32_16x16x32_bf16 v[160:163], a[112:115], a[88:91], v[160:163]
ds_read_b64_tr_b16 a[156:157], v14 offset:4096
ds_read_b64_tr_b16 a[158:159], v14 offset:4608
v_mfma_f32_16x16x32_bf16 v[228:231], a[184:187], a[88:91], v[228:231]
ds_read_b64_tr_b16 a[204:205], v23 offset:96
ds_read_b64_tr_b16 a[206:207], v23 offset:2144
v_mfma_f32_16x16x32_bf16 v[228:231], a[188:191], a[92:95], v[228:231]
ds_read_b64_tr_b16 a[208:209], v27 offset:4096
ds_read_b64_tr_b16 a[210:211], v27 offset:4608
v_mfma_f32_16x16x32_bf16 v[168:171], a[180:183], a[92:95], v[168:171]
ds_read_b128 a[64:67], v4 offset:8192
v_mfma_f32_16x16x32_bf16 v[168:171], a[176:179], a[88:91], v[168:171]
s_add_u32 s53, s87, 790528
ds_read_b64_tr_b16 a[212:213], v27 offset:5120
ds_read_b64_tr_b16 a[214:215], v27 offset:5632
v_mfma_f32_16x16x32_bf16 v[176:179], a[168:171], a[88:91], v[176:179]
ds_read_b128 a[80:83], v9 offset:0
v_readlane_b32 s81, v26, 0
v_mfma_f32_16x16x32_bf16 v[176:179], a[172:175], a[92:95], v[176:179]
buffer_store_dwordx4 a[24:27], v15, s[24:27], s53 offen offset:1024 sc1
v_mfma_f32_16x16x32_bf16 v[80:83], a[164:167], a[92:95], v[80:83]
ds_read_b128 a[68:71], v4 offset:10240
v_readlane_b32 s82, v26, 1
v_mfma_f32_16x16x32_bf16 v[80:83], a[160:163], a[88:91], v[80:83]
v_readlane_b32 s71, v26, 2
v_readlane_b32 s72, v26, 3
v_mfma_f32_16x16x32_bf16 v[184:187], a[160:163], a[96:99], v[184:187]
ds_read_b128 a[84:87], v10 offset:0
v_readlane_b32 s74, v26, 4
v_mfma_f32_16x16x32_bf16 v[184:187], a[164:167], a[100:103], v[184:187]
buffer_load_dwordx4 v15, s[24:27], s64 offen offset:2048 sc1 lds
v_mfma_f32_16x16x32_bf16 v[248:251], a[172:175], a[100:103], v[248:251]
v_readlane_b32 s75, v26, 5
v_mfma_f32_16x16x32_bf16 v[248:251], a[168:171], a[96:99], v[248:251]
ds_read_b128 a[72:75], v4 offset:9216
v_mfma_f32_16x16x32_bf16 v[240:243], a[176:179], a[96:99], v[240:243]
v_mfma_f32_16x16x32_bf16 v[240:243], a[180:183], a[100:103], v[240:243]
ds_read_b128 a[88:91], v9 offset:2048
v_mfma_f32_16x16x32_bf16 v[232:235], a[188:191], a[100:103], v[232:235]
v_mfma_f32_16x16x32_bf16 v[232:235], a[184:187], a[96:99], v[232:235]
ds_read_b128 a[76:79], v4 offset:11264
v_mfma_f32_16x16x32_bf16 v[236:239], a[112:115], a[96:99], v[236:239]
v_mfma_f32_16x16x32_bf16 v[236:239], a[116:119], a[100:103], v[236:239]
ds_read_b128 a[92:95], v10 offset:2048
v_mfma_f32_16x16x32_bf16 v[224:227], a[124:127], a[100:103], v[224:227]
v_mfma_f32_16x16x32_bf16 v[224:227], a[120:123], a[96:99], v[224:227]
buffer_load_dwordx4 v15, s[24:27], s64 offen offset:3072 sc1 lds
v_mfma_f32_16x16x32_bf16 v[208:211], a[120:123], a[104:107], v[208:211]
v_mfma_f32_16x16x32_bf16 v[208:211], a[124:127], a[108:111], v[208:211]
v_mfma_f32_16x16x32_bf16 v[216:219], a[116:119], a[108:111], v[216:219]
v_mfma_f32_16x16x32_bf16 v[216:219], a[112:115], a[104:107], v[216:219]
v_mfma_f32_16x16x32_bf16 v[244:247], a[184:187], a[104:107], v[244:247]
v_mfma_f32_16x16x32_bf16 v[244:247], a[188:191], a[108:111], v[244:247]
v_mfma_f32_16x16x32_bf16 v[192:195], a[180:183], a[108:111], v[192:195]
v_mfma_f32_16x16x32_bf16 v[192:195], a[176:179], a[104:107], v[192:195]
v_mfma_f32_16x16x32_bf16 v[200:203], a[168:171], a[104:107], v[200:203]
v_mfma_f32_16x16x32_bf16 v[200:203], a[172:175], a[108:111], v[200:203]
v_mfma_f32_16x16x32_bf16 v[88:91], a[164:167], a[108:111], v[88:91]
v_mfma_f32_16x16x32_bf16 v[88:91], a[160:163], a[104:107], v[88:91]
s_waitcnt lgkmcnt(0)
v_mfma_f32_16x16x32_bf16 v[36:39], a[128:131], a[80:83], v[36:39]
s_waitcnt vmcnt(18)
v_mfma_f32_16x16x32_bf16 v[36:39], a[132:135], a[84:87], v[36:39]
s_barrier
v_mfma_f32_16x16x32_bf16 v[44:47], a[140:143], a[84:87], v[44:47]
ds_read_b128 a[96:99], v9 offset:4096
v_mfma_f32_16x16x32_bf16 v[44:47], a[136:139], a[80:83], v[44:47]
s_add_u32 m0, s70, 65536
s_add_u32 s64, s68, 32768
ds_read_b128 a[100:103], v10 offset:4096
v_mfma_f32_16x16x32_bf16 v[32:35], a[144:147], a[80:83], v[32:35]
buffer_load_dwordx4 v15, s[24:27], s64 offen offset:0 sc1 lds
v_mfma_f32_16x16x32_bf16 v[32:35], a[148:151], a[84:87], v[32:35]
ds_read_b128 a[104:107], v9 offset:6144
v_mfma_f32_16x16x32_bf16 v[52:55], a[156:159], a[84:87], v[52:55]
ds_read_b64_tr_b16 a[160:161], v11 offset:16384
ds_read_b64_tr_b16 a[162:163], v11 offset:16896
v_mfma_f32_16x16x32_bf16 v[52:55], a[152:155], a[80:83], v[52:55]
buffer_store_dwordx4 a[192:195], v15, s[24:27], s81 offen sc1
v_mfma_f32_16x16x32_bf16 v[60:63], a[64:67], a[80:83], v[60:63]
v_mfma_f32_16x16x32_bf16 v[60:63], a[68:71], a[84:87], v[60:63]
ds_read_b128 a[108:111], v10 offset:6144
v_mfma_f32_16x16x32_bf16 v[68:71], a[76:79], a[84:87], v[68:71]
v_cvt_pk_bf16_f32 v36, v36, v37
v_cvt_pk_bf16_f32 v37, v38, v39
v_mfma_f32_16x16x32_bf16 v[68:71], a[72:75], a[80:83], v[68:71]
ds_read_b64_tr_b16 a[164:165], v11 offset:20480
ds_read_b64_tr_b16 a[166:167], v11 offset:20992
v_mfma_f32_16x16x32_bf16 v[76:79], a[72:75], a[88:91], v[76:79]
buffer_store_dwordx4 a[196:199], v15, s[24:27], s82 offen sc1
v_mfma_f32_16x16x32_bf16 v[76:79], a[76:79], a[92:95], v[76:79]
ds_read_b64_tr_b16 a[168:169], v12 offset:16384
ds_read_b64_tr_b16 a[170:171], v12 offset:16896
v_mfma_f32_16x16x32_bf16 v[84:87], a[68:71], a[92:95], v[84:87]
buffer_load_dwordx4 v15, s[24:27], s64 offen offset:1024 sc1 lds
v_mfma_f32_16x16x32_bf16 v[84:87], a[64:67], a[88:91], v[84:87]
ds_read_b64_tr_b16 a[172:173], v12 offset:20480
ds_read_b64_tr_b16 a[174:175], v12 offset:20992
v_mfma_f32_16x16x32_bf16 v[92:95], a[152:155], a[88:91], v[92:95]
v_cvt_pk_bf16_f32 v38, v44, v45
v_cvt_pk_bf16_f32 v39, v46, v47
v_mfma_f32_16x16x32_bf16 v[92:95], a[156:159], a[92:95], v[92:95]
buffer_store_dwordx4 a[200:203], v15, s[24:27], s71 offen sc1
v_mfma_f32_16x16x32_bf16 v[40:43], a[148:151], a[92:95], v[40:43]
ds_read_b64_tr_b16 a[176:177], v13 offset:16384
ds_read_b64_tr_b16 a[178:179], v13 offset:16896
v_mfma_f32_16x16x32_bf16 v[40:43], a[144:147], a[88:91], v[40:43]
v_accvgpr_write_b32 a32, v36
v_accvgpr_write_b32 a33, v37
v_mfma_f32_16x16x32_bf16 v[100:103], a[136:139], a[88:91], v[100:103]
ds_read_b64_tr_b16 a[180:181], v13 offset:20480
ds_read_b64_tr_b16 a[182:183], v13 offset:20992
v_mfma_f32_16x16x32_bf16 v[100:103], a[140:143], a[92:95], v[100:103]
v_accvgpr_write_b32 a34, v38
v_accvgpr_write_b32 a35, v39
v_mfma_f32_16x16x32_bf16 v[108:111], a[132:135], a[92:95], v[108:111]
ds_read_b64_tr_b16 a[184:185], v14 offset:16384
ds_read_b64_tr_b16 a[186:187], v14 offset:16896
v_mfma_f32_16x16x32_bf16 v[108:111], a[128:131], a[88:91], v[108:111]
s_waitcnt lgkmcnt(15)
v_cvt_pk_bf16_f32 v32, v32, v33
v_cvt_pk_bf16_f32 v33, v34, v35
v_mfma_f32_16x16x32_bf16 v[116:119], a[128:131], a[96:99], v[116:119]
ds_read_b64_tr_b16 a[188:189], v14 offset:20480
ds_read_b64_tr_b16 a[190:191], v14 offset:20992
v_mfma_f32_16x16x32_bf16 v[116:119], a[132:135], a[100:103], v[116:119]
buffer_load_dwordx4 v15, s[24:27], s64 offen offset:2048 sc1 lds
v_mfma_f32_16x16x32_bf16 v[124:127], a[140:143], a[100:103], v[124:127]
buffer_store_dwordx4 a[204:207], v15, s[24:27], s72 offen sc1
v_mfma_f32_16x16x32_bf16 v[124:127], a[136:139], a[96:99], v[124:127]
ds_read_b128 a[112:115], v4 offset:24576
v_cvt_pk_bf16_f32 v34, v52, v53
v_mfma_f32_16x16x32_bf16 v[132:135], a[144:147], a[96:99], v[132:135]
v_cvt_pk_bf16_f32 v35, v54, v55
v_accvgpr_write_b32 a36, v32
v_mfma_f32_16x16x32_bf16 v[132:135], a[148:151], a[100:103], v[132:135]
ds_read_b128 a[116:119], v4 offset:26624
v_accvgpr_write_b32 a37, v33
v_mfma_f32_16x16x32_bf16 v[140:143], a[156:159], a[100:103], v[140:143]
v_accvgpr_write_b32 a38, v34
v_accvgpr_write_b32 a39, v35
v_mfma_f32_16x16x32_bf16 v[140:143], a[152:155], a[96:99], v[140:143]
ds_read_b128 a[120:123], v4 offset:25600
v_cvt_pk_bf16_f32 v40, v40, v41
v_mfma_f32_16x16x32_bf16 v[148:151], a[64:67], a[96:99], v[148:151]
buffer_store_dwordx4 a[208:211], v15, s[24:27], s74 offen sc1
v_mfma_f32_16x16x32_bf16 v[148:151], a[68:71], a[100:103], v[148:151]
ds_read_b128 a[124:127], v4 offset:27648
v_cvt_pk_bf16_f32 v41, v42, v43
v_mfma_f32_16x16x32_bf16 v[48:51], a[76:79], a[100:103], v[48:51]
s_waitcnt lgkmcnt(15)
v_cvt_pk_bf16_f32 v42, v92, v93
v_cvt_pk_bf16_f32 v43, v94, v95
v_mfma_f32_16x16x32_bf16 v[48:51], a[72:75], a[96:99], v[48:51]
buffer_load_dwordx4 v15, s[24:27], s64 offen offset:3072 sc1 lds
v_mfma_f32_16x16x32_bf16 v[156:159], a[72:75], a[104:107], v[156:159]
v_accvgpr_write_b32 a40, v40
v_accvgpr_write_b32 a41, v41
v_mfma_f32_16x16x32_bf16 v[156:159], a[76:79], a[108:111], v[156:159]
buffer_store_dwordx4 a[212:215], v15, s[24:27], s75 offen sc1
v_mfma_f32_16x16x32_bf16 v[164:167], a[68:71], a[108:111], v[164:167]
v_accvgpr_write_b32 a42, v42
v_accvgpr_write_b32 a43, v43
v_mfma_f32_16x16x32_bf16 v[164:167], a[64:67], a[104:107], v[164:167]
v_cvt_pk_bf16_f32 v108, v108, v109
v_cvt_pk_bf16_f32 v109, v110, v111
v_mfma_f32_16x16x32_bf16 v[172:175], a[152:155], a[104:107], v[172:175]
v_cvt_pk_bf16_f32 v110, v100, v101
v_cvt_pk_bf16_f32 v111, v102, v103
v_mfma_f32_16x16x32_bf16 v[172:175], a[156:159], a[108:111], v[172:175]
v_accvgpr_write_b32 a44, v108
v_accvgpr_write_b32 a45, v109
v_mfma_f32_16x16x32_bf16 v[56:59], a[148:151], a[108:111], v[56:59]
v_accvgpr_write_b32 a46, v110
v_accvgpr_write_b32 a47, v111
v_mfma_f32_16x16x32_bf16 v[56:59], a[144:147], a[104:107], v[56:59]
v_cvt_pk_bf16_f32 v116, v116, v117
v_cvt_pk_bf16_f32 v117, v118, v119
v_mfma_f32_16x16x32_bf16 v[180:183], a[136:139], a[104:107], v[180:183]
v_cvt_pk_bf16_f32 v118, v124, v125
v_cvt_pk_bf16_f32 v119, v126, v127
v_mfma_f32_16x16x32_bf16 v[180:183], a[140:143], a[108:111], v[180:183]
v_accvgpr_write_b32 a48, v116
v_accvgpr_write_b32 a49, v117
v_mfma_f32_16x16x32_bf16 v[188:191], a[132:135], a[108:111], v[188:191]
v_accvgpr_write_b32 a50, v118
v_accvgpr_write_b32 a51, v119
v_mfma_f32_16x16x32_bf16 v[188:191], a[128:131], a[104:107], v[188:191]
s_waitcnt lgkmcnt(0)
v_cvt_pk_bf16_f32 v132, v132, v133
v_cvt_pk_bf16_f32 v133, v134, v135
v_mfma_f32_16x16x32_bf16 v[196:199], a[160:163], a[80:83], v[196:199]
s_waitcnt vmcnt(16)
v_cvt_pk_bf16_f32 v134, v140, v141
v_cvt_pk_bf16_f32 v135, v142, v143
v_mfma_f32_16x16x32_bf16 v[196:199], a[164:167], a[84:87], v[196:199]
s_barrier
v_mfma_f32_16x16x32_bf16 v[64:67], a[172:175], a[84:87], v[64:67]
ds_read_b128 a[192:195], v4 offset:32768
v_accvgpr_write_b32 a52, v132
v_mfma_f32_16x16x32_bf16 v[64:67], a[168:171], a[80:83], v[64:67]
s_add_u32 m0, s70, 81920
s_add_u32 s64, s68, 49152
v_accvgpr_write_b32 a53, v133
v_mfma_f32_16x16x32_bf16 v[204:207], a[176:179], a[80:83], v[204:207]
buffer_load_dwordx4 v15, s[24:27], s64 offen offset:0 sc1 lds
v_mfma_f32_16x16x32_bf16 v[204:207], a[180:183], a[84:87], v[204:207]
ds_read_b128 a[196:199], v4 offset:33792
v_accvgpr_write_b32 a54, v134
v_mfma_f32_16x16x32_bf16 v[212:215], a[188:191], a[84:87], v[212:215]
v_accvgpr_write_b32 a55, v135
v_cvt_pk_bf16_f32 v56, v56, v57
v_mfma_f32_16x16x32_bf16 v[212:215], a[184:187], a[80:83], v[212:215]
ds_read_b128 a[200:203], v4 offset:34816
v_cvt_pk_bf16_f32 v57, v58, v59
v_mfma_f32_16x16x32_bf16 v[80:83], a[160:163], a[88:91], v[80:83]
v_cvt_pk_bf16_f32 v58, v172, v173
v_cvt_pk_bf16_f32 v59, v174, v175
v_mfma_f32_16x16x32_bf16 v[80:83], a[164:167], a[92:95], v[80:83]
ds_read_b128 a[204:207], v4 offset:35840
v_accvgpr_write_b32 a56, v56
v_mfma_f32_16x16x32_bf16 v[176:179], a[172:175], a[92:95], v[176:179]
v_accvgpr_write_b32 a57, v57
v_accvgpr_write_b32 a58, v58
v_mfma_f32_16x16x32_bf16 v[176:179], a[168:171], a[88:91], v[176:179]
ds_read_b128 a[208:211], v4 offset:36864
v_accvgpr_write_b32 a59, v59
v_mfma_f32_16x16x32_bf16 v[168:171], a[176:179], a[88:91], v[168:171]
v_cvt_pk_bf16_f32 v188, v188, v189
v_cvt_pk_bf16_f32 v189, v190, v191
v_mfma_f32_16x16x32_bf16 v[168:171], a[180:183], a[92:95], v[168:171]
ds_read_b128 a[212:215], v4 offset:37888
v_cvt_pk_bf16_f32 v190, v180, v181
v_mfma_f32_16x16x32_bf16 v[228:231], a[188:191], a[92:95], v[228:231]
buffer_load_dwordx4 v15, s[24:27], s64 offen offset:1024 sc1 lds
v_mfma_f32_16x16x32_bf16 v[228:231], a[184:187], a[88:91], v[228:231]
ds_read_b128 a[216:219], v4 offset:38912
v_cvt_pk_bf16_f32 v191, v182, v183
v_mfma_f32_16x16x32_bf16 v[184:187], a[160:163], a[96:99], v[184:187]
v_accvgpr_write_b32 a60, v188
v_accvgpr_write_b32 a61, v189
v_mfma_f32_16x16x32_bf16 v[184:187], a[164:167], a[100:103], v[184:187]
ds_read_b128 a[220:223], v4 offset:39936
v_accvgpr_write_b32 a62, v190
v_mfma_f32_16x16x32_bf16 v[248:251], a[172:175], a[100:103], v[248:251]
v_accvgpr_write_b32 a63, v191
v_cvt_pk_bf16_f32 v196, v196, v197
v_mfma_f32_16x16x32_bf16 v[248:251], a[168:171], a[96:99], v[248:251]
v_cvt_pk_bf16_f32 v197, v198, v199
v_cvt_pk_bf16_f32 v198, v64, v65
v_mfma_f32_16x16x32_bf16 v[240:243], a[176:179], a[96:99], v[240:243]
v_cvt_pk_bf16_f32 v199, v66, v67
v_accvgpr_write_b32 a28, v196
v_mfma_f32_16x16x32_bf16 v[240:243], a[180:183], a[100:103], v[240:243]
v_accvgpr_write_b32 a29, v197
v_accvgpr_write_b32 a30, v198
v_mfma_f32_16x16x32_bf16 v[232:235], a[188:191], a[100:103], v[232:235]
v_accvgpr_write_b32 a31, v199
v_cvt_pk_bf16_f32 v204, v204, v205
v_mfma_f32_16x16x32_bf16 v[232:235], a[184:187], a[96:99], v[232:235]
v_cvt_pk_bf16_f32 v205, v206, v207
v_cvt_pk_bf16_f32 v206, v212, v213
v_mfma_f32_16x16x32_bf16 v[88:91], a[160:163], a[104:107], v[88:91]
v_cvt_pk_bf16_f32 v207, v214, v215
v_accvgpr_write_b32 a20, v204
v_mfma_f32_16x16x32_bf16 v[88:91], a[164:167], a[108:111], v[88:91]
buffer_load_dwordx4 v15, s[24:27], s64 offen offset:2048 sc1 lds
v_mfma_f32_16x16x32_bf16 v[200:203], a[172:175], a[108:111], v[200:203]
v_accvgpr_write_b32 a21, v205
v_accvgpr_write_b32 a22, v206
v_mfma_f32_16x16x32_bf16 v[200:203], a[168:171], a[104:107], v[200:203]
v_accvgpr_write_b32 a23, v207
v_cvt_pk_bf16_f32 v80, v80, v81
v_mfma_f32_16x16x32_bf16 v[192:195], a[176:179], a[104:107], v[192:195]
v_cvt_pk_bf16_f32 v81, v82, v83
v_cvt_pk_bf16_f32 v82, v176, v177
v_mfma_f32_16x16x32_bf16 v[192:195], a[180:183], a[108:111], v[192:195]
v_cvt_pk_bf16_f32 v83, v178, v179
v_accvgpr_write_b32 a12, v80
v_mfma_f32_16x16x32_bf16 v[244:247], a[188:191], a[108:111], v[244:247]
v_accvgpr_write_b32 a13, v81
v_accvgpr_write_b32 a14, v82
v_mfma_f32_16x16x32_bf16 v[244:247], a[184:187], a[104:107], v[244:247]
v_accvgpr_write_b32 a15, v83
v_cvt_pk_bf16_f32 v168, v168, v169
v_mfma_f32_16x16x32_bf16 v[72:75], a[112:115], a[80:83], v[72:75]
v_cvt_pk_bf16_f32 v169, v170, v171
v_cvt_pk_bf16_f32 v170, v228, v229
v_mfma_f32_16x16x32_bf16 v[72:75], a[116:119], a[84:87], v[72:75]
v_cvt_pk_bf16_f32 v171, v230, v231
v_accvgpr_write_b32 a4, v168
v_mfma_f32_16x16x32_bf16 v[220:223], a[124:127], a[84:87], v[220:223]
v_accvgpr_write_b32 a5, v169
v_accvgpr_write_b32 a6, v170
v_mfma_f32_16x16x32_bf16 v[220:223], a[120:123], a[80:83], v[220:223]
buffer_load_dwordx4 v15, s[24:27], s64 offen offset:3072 sc1 lds
v_mfma_f32_16x16x32_bf16 v[160:163], a[112:115], a[88:91], v[160:163]
v_accvgpr_write_b32 a7, v171
v_cvt_pk_bf16_f32 v184, v184, v185
v_mfma_f32_16x16x32_bf16 v[160:163], a[116:119], a[92:95], v[160:163]
v_cvt_pk_bf16_f32 v185, v186, v187
v_cvt_pk_bf16_f32 v186, v248, v249
v_mfma_f32_16x16x32_bf16 v[252:255], a[124:127], a[92:95], v[252:255]
v_cvt_pk_bf16_f32 v187, v250, v251
v_accvgpr_write_b32 a0, v184
v_mfma_f32_16x16x32_bf16 v[252:255], a[120:123], a[88:91], v[252:255]
v_accvgpr_write_b32 a1, v185
v_accvgpr_write_b32 a2, v186
v_mfma_f32_16x16x32_bf16 v[236:239], a[112:115], a[96:99], v[236:239]
v_accvgpr_write_b32 a3, v187
v_cvt_pk_bf16_f32 v240, v240, v241
v_mfma_f32_16x16x32_bf16 v[236:239], a[116:119], a[100:103], v[236:239]
v_cvt_pk_bf16_f32 v241, v242, v243
v_cvt_pk_bf16_f32 v242, v232, v233
v_mfma_f32_16x16x32_bf16 v[224:227], a[124:127], a[100:103], v[224:227]
v_cvt_pk_bf16_f32 v243, v234, v235
v_accvgpr_write_b32 a8, v240
v_mfma_f32_16x16x32_bf16 v[224:227], a[120:123], a[96:99], v[224:227]
v_accvgpr_write_b32 a9, v241
v_accvgpr_write_b32 a10, v242
v_mfma_f32_16x16x32_bf16 v[216:219], a[112:115], a[104:107], v[216:219]
v_accvgpr_write_b32 a11, v243
v_cvt_pk_bf16_f32 v88, v88, v89
v_mfma_f32_16x16x32_bf16 v[216:219], a[116:119], a[108:111], v[216:219]
v_cvt_pk_bf16_f32 v89, v90, v91
v_cvt_pk_bf16_f32 v90, v200, v201
v_mfma_f32_16x16x32_bf16 v[208:211], a[124:127], a[108:111], v[208:211]
v_cvt_pk_bf16_f32 v91, v202, v203
v_accvgpr_write_b32 a16, v88
v_mfma_f32_16x16x32_bf16 v[208:211], a[120:123], a[104:107], v[208:211]
s_waitcnt lgkmcnt(0)
v_accvgpr_write_b32 a17, v89
v_accvgpr_write_b32 a18, v90
v_mfma_f32_16x16x32_bf16 v[44:47], a[192:195], a[32:35], v[96:99]
v_accvgpr_write_b32 a19, v91
v_cvt_pk_bf16_f32 v192, v192, v193
v_mfma_f32_16x16x32_bf16 v[44:47], a[196:199], a[36:39], v[44:47]
v_cvt_pk_bf16_f32 v193, v194, v195
v_cvt_pk_bf16_f32 v194, v244, v245
v_mfma_f32_16x16x32_bf16 v[44:47], a[200:203], a[28:31], v[44:47]
v_cvt_pk_bf16_f32 v195, v246, v247
v_accvgpr_write_b32 a24, v192
v_mfma_f32_16x16x32_bf16 v[44:47], a[204:207], a[20:23], v[44:47]
v_accvgpr_write_b32 a25, v193
v_accvgpr_write_b32 a26, v194
v_mfma_f32_16x16x32_bf16 v[52:55], a[192:195], a[44:47], v[104:107]
ds_bpermute_b32 v8, v17, v63
v_accvgpr_write_b32 a27, v195
v_mfma_f32_16x16x32_bf16 v[52:55], a[196:199], a[40:43], v[52:55]
v_cvt_pk_bf16_f32 v60, v60, v61
v_cvt_pk_bf16_f32 v61, v62, v63
v_mfma_f32_16x16x32_bf16 v[52:55], a[200:203], a[12:15], v[52:55]
v_cvt_pk_bf16_f32 v62, v68, v69
v_cvt_pk_bf16_f32 v63, v70, v71
v_mfma_f32_16x16x32_bf16 v[52:55], a[204:207], a[4:7], v[52:55]
v_accvgpr_write_b32 a128, v60
v_accvgpr_write_b32 a129, v61
v_mfma_f32_16x16x32_bf16 v[64:67], a[208:211], a[32:35], v[112:115]
v_accvgpr_write_b32 a130, v62
v_accvgpr_write_b32 a131, v63
v_mfma_f32_16x16x32_bf16 v[64:67], a[212:215], a[36:39], v[64:67]
ds_bpermute_b32 v9, v17, v87
v_cvt_pk_bf16_f32 v84, v84, v85
v_mfma_f32_16x16x32_bf16 v[64:67], a[216:219], a[28:31], v[64:67]
v_cvt_pk_bf16_f32 v85, v86, v87
v_cvt_pk_bf16_f32 v86, v76, v77
v_mfma_f32_16x16x32_bf16 v[64:67], a[220:223], a[20:23], v[64:67]
v_cvt_pk_bf16_f32 v87, v78, v79
v_mfma_f32_16x16x32_bf16 v[212:215], a[208:211], a[44:47], v[120:123]
buffer_store_dwordx4 v[84:87], v18, s[24:27], s54 offen offset:256 sc1
v_mfma_f32_16x16x32_bf16 v[212:215], a[212:215], a[40:43], v[212:215]
v_accvgpr_write_b32 a136, v84
v_accvgpr_write_b32 a137, v85
v_mfma_f32_16x16x32_bf16 v[212:215], a[216:219], a[12:15], v[212:215]
v_accvgpr_write_b32 a138, v86
v_accvgpr_write_b32 a139, v87
v_mfma_f32_16x16x32_bf16 v[212:215], a[220:223], a[4:7], v[212:215]
s_waitcnt vmcnt(15)
ds_bpermute_b32 v10, v17, v151
v_cvt_pk_bf16_f32 v148, v148, v149
v_mfma_f32_16x16x32_bf16 v[100:103], a[192:195], a[48:51], v[128:131]
s_barrier
v_cvt_pk_bf16_f32 v149, v150, v151
v_cvt_pk_bf16_f32 v150, v48, v49
v_mfma_f32_16x16x32_bf16 v[100:103], a[196:199], a[52:55], v[100:103]
v_cvt_pk_bf16_f32 v151, v50, v51
v_accvgpr_write_b32 a144, v148
v_mfma_f32_16x16x32_bf16 v[100:103], a[200:203], a[0:3], v[100:103]
L_PAD8:
s_cbranch_execz L_PAD12
ds_bpermute_b32 v11, v17, v167
v_accvgpr_write_b32 a145, v149
v_mfma_f32_16x16x32_bf16 v[100:103], a[204:207], a[8:11], v[100:103]
v_cvt_pk_bf16_f32 v164, v164, v165
v_cvt_pk_bf16_f32 v165, v166, v167
v_mfma_f32_16x16x32_bf16 v[92:95], a[192:195], a[60:63], v[136:139]
v_cvt_pk_bf16_f32 v166, v156, v157
v_cvt_pk_bf16_f32 v167, v158, v159
v_mfma_f32_16x16x32_bf16 v[92:95], a[196:199], a[56:59], v[92:95]
buffer_store_dwordx4 v[164:167], v18, s[24:27], s55 offen offset:256 sc1
v_mfma_f32_16x16x32_bf16 v[92:95], a[200:203], a[16:19], v[92:95]
v_cvt_pk_bf16_f32 v72, v72, v73
v_cvt_pk_bf16_f32 v73, v74, v75
v_mfma_f32_16x16x32_bf16 v[92:95], a[204:207], a[24:27], v[92:95]
v_cvt_pk_bf16_f32 v74, v220, v221
v_cvt_pk_bf16_f32 v75, v222, v223
v_mfma_f32_16x16x32_bf16 v[176:179], a[208:211], a[48:51], v[144:147]
v_cvt_pk_bf16_f32 v160, v160, v161
v_cvt_pk_bf16_f32 v161, v162, v163
v_mfma_f32_16x16x32_bf16 v[176:179], a[212:215], a[52:55], v[176:179]
v_cvt_pk_bf16_f32 v162, v252, v253
v_cvt_pk_bf16_f32 v163, v254, v255
v_mfma_f32_16x16x32_bf16 v[176:179], a[216:219], a[0:3], v[176:179]
buffer_store_dwordx4 v[160:163], v19, s[24:27], s54 offen offset:256 sc1
v_mfma_f32_16x16x32_bf16 v[176:179], a[220:223], a[8:11], v[176:179]
v_cvt_pk_bf16_f32 v236, v236, v237
v_cvt_pk_bf16_f32 v237, v238, v239
v_mfma_f32_16x16x32_bf16 v[228:231], a[208:211], a[60:63], v[152:155]
v_cvt_pk_bf16_f32 v238, v224, v225
v_cvt_pk_bf16_f32 v239, v226, v227
v_mfma_f32_16x16x32_bf16 v[228:231], a[212:215], a[56:59], v[228:231]
v_cvt_pk_bf16_f32 v216, v216, v217
v_cvt_pk_bf16_f32 v217, v218, v219
v_mfma_f32_16x16x32_bf16 v[228:231], a[216:219], a[16:19], v[228:231]
v_cvt_pk_bf16_f32 v218, v208, v209
v_cvt_pk_bf16_f32 v219, v210, v211
v_mfma_f32_16x16x32_bf16 v[228:231], a[220:223], a[24:27], v[228:231]
buffer_store_dwordx4 v[216:219], v19, s[24:27], s55 offen offset:256 sc1
ds_read_b128 a[64:67], v4 offset:57344
ds_read_b128 a[68:71], v4 offset:58368
ds_read_b128 a[72:75], v4 offset:59392
ds_read_b128 a[76:79], v4 offset:60416
ds_read_b128 a[80:83], v4 offset:61440
ds_read_b128 a[84:87], v4 offset:62464
ds_read_b128 a[88:91], v4 offset:63488
ds_read_b128 a[92:95], v4 offset:64512
s_add_u32 m0, s70, 98304
s_add_u32 s64, s68, 65536
buffer_load_dwordx4 v15, s[24:27], s64 offen offset:0 sc1 lds
v_max3_f32 v24, v44, v45, v46
v_max3_f32 v25, v47, v64, v65
v_max3_f32 v26, v52, v53, v54
v_max3_f32 v27, v55, v212, v213
v_max3_f32 v24, v24, v66, v67
v_max_f32 v24, v24, v25
v_max3_f32 v26, v26, v214, v215
v_max_f32 v26, v26, v27
v_mov_b32 v25, v24
buffer_load_dwordx4 v15, s[24:27], s64 offen offset:1024 sc1 lds
v_mov_b32 v27, v26
s_nop 1
v_permlane32_swap_b32 v25, v24
v_permlane32_swap_b32 v27, v26
s_nop 0
v_max_f32 v24, v24, v25
v_max_f32 v26, v26, v27
v_mov_b32 v25, v24
v_mov_b32 v27, v26
buffer_load_dwordx4 v15, s[24:27], s64 offen offset:2048 sc1 lds
s_nop 1
v_permlane16_swap_b32 v25, v24
v_permlane16_swap_b32 v27, v26
s_nop 0
v_max_f32 v24, v24, v25
v_max_f32 v26, v26, v27
v_pk_add_f32 v[44:45], v[44:45], v[24:25] op_sel_hi:[1,0] neg_lo:[0,1] neg_hi:[0,1]
v_pk_add_f32 v[46:47], v[46:47], v[24:25] op_sel_hi:[1,0] neg_lo:[0,1] neg_hi:[0,1]
v_pk_add_f32 v[52:53], v[52:53], v[26:27] op_sel_hi:[1,0] neg_lo:[0,1] neg_hi:[0,1]
buffer_load_dwordx4 v15, s[24:27], s64 offen offset:3072 sc1 lds
v_pk_add_f32 v[54:55], v[54:55], v[26:27] op_sel_hi:[1,0] neg_lo:[0,1] neg_hi:[0,1]
v_pk_add_f32 v[64:65], v[64:65], v[24:25] op_sel_hi:[1,0] neg_lo:[0,1] neg_hi:[0,1]
v_pk_add_f32 v[66:67], v[66:67], v[24:25] op_sel_hi:[1,0] neg_lo:[0,1] neg_hi:[0,1]
v_pk_add_f32 v[212:213], v[212:213], v[26:27] op_sel_hi:[1,0] neg_lo:[0,1] neg_hi:[0,1]
v_pk_add_f32 v[214:215], v[214:215], v[26:27] op_sel_hi:[1,0] neg_lo:[0,1] neg_hi:[0,1]
v_pk_add_f32 v[96:97], v[96:97], v[24:25] op_sel_hi:[1,0] neg_lo:[0,1] neg_hi:[0,1]
v_pk_add_f32 v[98:99], v[98:99], v[24:25] op_sel_hi:[1,0] neg_lo:[0,1] neg_hi:[0,1]
v_pk_add_f32 v[104:105], v[104:105], v[26:27] op_sel_hi:[1,0] neg_lo:[0,1] neg_hi:[0,1]
v_pk_add_f32 v[106:107], v[106:107], v[26:27] op_sel_hi:[1,0] neg_lo:[0,1] neg_hi:[0,1]
s_add_u32 m0, s70, 114688
s_add_u32 s64, s68, 81920
buffer_load_dwordx4 v15, s[24:27], s64 offen offset:0 sc1 lds
v_pk_add_f32 v[112:113], v[112:113], v[24:25] op_sel_hi:[1,0] neg_lo:[0,1] neg_hi:[0,1]
v_pk_add_f32 v[114:115], v[114:115], v[24:25] op_sel_hi:[1,0] neg_lo:[0,1] neg_hi:[0,1]
v_pk_add_f32 v[120:121], v[120:121], v[26:27] op_sel_hi:[1,0] neg_lo:[0,1] neg_hi:[0,1]
v_pk_add_f32 v[122:123], v[122:123], v[26:27] op_sel_hi:[1,0] neg_lo:[0,1] neg_hi:[0,1]
v_exp_f32 v44, v44
v_exp_f32 v45, v45
v_exp_f32 v46, v46
v_exp_f32 v47, v47
v_cvt_pk_bf16_f32 v124, v44, v45
buffer_load_dwordx4 v15, s[24:27], s64 offen offset:1024 sc1 lds
v_exp_f32 v52, v52
v_exp_f32 v53, v53
v_cvt_pk_bf16_f32 v125, v46, v47
v_exp_f32 v54, v54
v_exp_f32 v55, v55
v_cvt_pk_bf16_f32 v140, v52, v53
v_exp_f32 v64, v64
v_exp_f32 v65, v65
v_cvt_pk_bf16_f32 v141, v54, v55
buffer_load_dwordx4 v15, s[24:27], s64 offen offset:2048 sc1 lds
v_exp_f32 v66, v66
v_exp_f32 v67, v67
v_cvt_pk_bf16_f32 v126, v64, v65
v_exp_f32 v212, v212
v_exp_f32 v213, v213
v_cvt_pk_bf16_f32 v127, v66, v67
v_exp_f32 v214, v214
v_exp_f32 v215, v215
v_cvt_pk_bf16_f32 v142, v212, v213
buffer_load_dwordx4 v15, s[24:27], s64 offen offset:3072 sc1 lds
v_max3_f32 v24, v100, v101, v102
v_cvt_pk_bf16_f32 v143, v214, v215
v_max3_f32 v25, v103, v176, v177
v_max3_f32 v26, v92, v93, v94
v_max3_f32 v27, v95, v228, v229
v_max3_f32 v24, v24, v178, v179
v_max_f32 v24, v24, v25
v_max3_f32 v26, v26, v230, v231
v_max_f32 v26, v26, v27
v_mov_b32 v25, v24
v_mov_b32 v27, v26
s_nop 1
v_permlane32_swap_b32 v25, v24
v_permlane32_swap_b32 v27, v26
s_nop 0
v_max_f32 v24, v24, v25
s_cmp_lt_u32 s3, 1
s_cbranch_scc1 L_SK5
s_add_u32 m0, s70, 131072
s_add_u32 s64, s68, 98304
buffer_load_dwordx4 v15, s[24:27], s64 offen offset:0 sc1 lds
buffer_load_dwordx4 v15, s[24:27], s64 offen offset:1024 sc1 lds
buffer_load_dwordx4 v15, s[24:27], s64 offen offset:2048 sc1 lds
buffer_load_dwordx4 v15, s[24:27], s64 offen offset:3072 sc1 lds
L_SK5:
v_max_f32 v26, v26, v27
v_mov_b32 v25, v24
v_mov_b32 v27, v26
s_nop 1
v_permlane16_swap_b32 v25, v24
v_permlane16_swap_b32 v27, v26
s_nop 0
v_max_f32 v24, v24, v25
v_max_f32 v26, v26, v27
v_pk_add_f32 v[100:101], v[100:101], v[24:25] op_sel_hi:[1,0] neg_lo:[0,1] neg_hi:[0,1]
v_pk_add_f32 v[102:103], v[102:103], v[24:25] op_sel_hi:[1,0] neg_lo:[0,1] neg_hi:[0,1]
v_pk_add_f32 v[92:93], v[92:93], v[26:27] op_sel_hi:[1,0] neg_lo:[0,1] neg_hi:[0,1]
v_pk_add_f32 v[94:95], v[94:95], v[26:27] op_sel_hi:[1,0] neg_lo:[0,1] neg_hi:[0,1]
v_pk_add_f32 v[176:177], v[176:177], v[24:25] op_sel_hi:[1,0] neg_lo:[0,1] neg_hi:[0,1]
v_pk_add_f32 v[178:179], v[178:179], v[24:25] op_sel_hi:[1,0] neg_lo:[0,1] neg_hi:[0,1]
v_pk_add_f32 v[228:229], v[228:229], v[26:27] op_sel_hi:[1,0] neg_lo:[0,1] neg_hi:[0,1]
v_pk_add_f32 v[230:231], v[230:231], v[26:27] op_sel_hi:[1,0] neg_lo:[0,1] neg_hi:[0,1]
v_pk_add_f32 v[128:129], v[128:129], v[24:25] op_sel_hi:[1,0] neg_lo:[0,1] neg_hi:[0,1]
v_pk_add_f32 v[130:131], v[130:131], v[24:25] op_sel_hi:[1,0] neg_lo:[0,1] neg_hi:[0,1]
v_pk_add_f32 v[136:137], v[136:137], v[26:27] op_sel_hi:[1,0] neg_lo:[0,1] neg_hi:[0,1]
v_pk_add_f32 v[138:139], v[138:139], v[26:27] op_sel_hi:[1,0] neg_lo:[0,1] neg_hi:[0,1]
v_pk_add_f32 v[144:145], v[144:145], v[24:25] op_sel_hi:[1,0] neg_lo:[0,1] neg_hi:[0,1]
v_pk_add_f32 v[146:147], v[146:147], v[24:25] op_sel_hi:[1,0] neg_lo:[0,1] neg_hi:[0,1]
v_pk_add_f32 v[152:153], v[152:153], v[26:27] op_sel_hi:[1,0] neg_lo:[0,1] neg_hi:[0,1]
v_pk_add_f32 v[154:155], v[154:155], v[26:27] op_sel_hi:[1,0] neg_lo:[0,1] neg_hi:[0,1]
v_accvgpr_write_b32 a146, v150
s_cmp_lt_u32 s3, 2
s_cbranch_scc1 L_SK6
s_add_u32 m0, s70, 147456
s_add_u32 s64, s68, 114688
buffer_load_dwordx4 v15, s[24:27], s64 offen offset:0 sc1 lds
buffer_load_dwordx4 v15, s[24:27], s64 offen offset:1024 sc1 lds
buffer_load_dwordx4 v15, s[24:27], s64 offen offset:2048 sc1 lds
buffer_load_dwordx4 v15, s[24:27], s64 offen offset:3072 sc1 lds
L_SK6:
v_accvgpr_write_b32 a147, v151
v_accvgpr_write_b32 a152, v164
v_accvgpr_write_b32 a153, v165
v_accvgpr_write_b32 a154, v166
v_accvgpr_write_b32 a155, v167
v_accvgpr_write_b32 a132, v72
v_accvgpr_write_b32 a133, v73
v_accvgpr_write_b32 a134, v74
v_accvgpr_write_b32 a135, v75
v_accvgpr_write_b32 a140, v160
v_accvgpr_write_b32 a141, v161
v_accvgpr_write_b32 a142, v162
v_accvgpr_write_b32 a143, v163
v_accvgpr_write_b32 a148, v236
v_accvgpr_write_b32 a149, v237
v_accvgpr_write_b32 a150, v238
v_accvgpr_write_b32 a151, v239
v_accvgpr_write_b32 a156, v216
v_accvgpr_write_b32 a157, v217
v_accvgpr_write_b32 a158, v218
v_accvgpr_write_b32 a159, v219
v_mov_b64 v[60:61], 0
v_mov_b64 v[62:63], 0
v_mov_b64 v[68:69], 0
v_mov_b64 v[70:71], 0
v_mov_b64 v[72:73], 0
s_cmp_lt_u32 s3, 3
s_cbranch_scc1 L_SK7
s_add_u32 m0, s70, 0
s_add_u32 s64, s68, 131072
buffer_load_dwordx4 v15, s[24:27], s64 offen offset:0 sc1 lds
buffer_load_dwordx4 v15, s[24:27], s64 offen offset:1024 sc1 lds
buffer_load_dwordx4 v15, s[24:27], s64 offen offset:2048 sc1 lds
buffer_load_dwordx4 v15, s[24:27], s64 offen offset:3072 sc1 lds
L_SK7:
v_mov_b64 v[74:75], 0
v_mov_b64 v[220:221], 0
v_mov_b64 v[222:223], 0
v_mov_b64 v[84:85], 0
v_mov_b64 v[86:87], 0
v_mov_b64 v[76:77], 0
v_mov_b64 v[78:79], 0
v_mov_b64 v[160:161], 0
v_mov_b64 v[162:163], 0
v_mov_b64 v[252:253], 0
v_mov_b64 v[254:255], 0
v_mov_b64 v[148:149], 0
v_mov_b64 v[150:151], 0
v_mov_b64 v[48:49], 0
v_mov_b64 v[50:51], 0
v_mov_b64 v[236:237], 0
v_mov_b64 v[238:239], 0
v_mov_b64 v[224:225], 0
v_mov_b64 v[226:227], 0
v_mov_b64 v[164:165], 0
v_mov_b64 v[166:167], 0
v_mov_b64 v[156:157], 0
v_mov_b64 v[158:159], 0
v_mov_b64 v[216:217], 0
v_mov_b64 v[218:219], 0
v_mov_b64 v[208:209], 0
v_mov_b64 v[210:211], 0
ds_read_b128 a[192:195], v4 offset:49152
ds_read_b128 a[196:199], v4 offset:50176
ds_read_b128 a[200:203], v4 offset:51200
ds_read_b128 a[204:207], v4 offset:52224
ds_read_b128 a[208:211], v4 offset:53248
ds_read_b128 a[212:215], v4 offset:54272
ds_read_b128 a[216:219], v4 offset:55296
ds_read_b128 a[220:223], v4 offset:56320
s_waitcnt lgkmcnt(8)
s_lshl2_add_u32 s77, s86, s84
s_mul_i32 s77, s77, 344064
s_mov_b32 s80, s70
s_cmp_lt_u32 s3, 2
s_cselect_b32 s53, 8, -2
s_add_u32 s53, s53, s3
v_mfma_f32_16x16x32_bf16 v[36:39], a[64:67], v[124:127], 0
s_mul_i32 s52, s5, 65536
v_exp_f32 v100, v100
v_mfma_f32_16x16x32_bf16 v[116:119], a[64:67], v[140:143], 0
s_sub_u32 s52, 1064960, s52
v_exp_f32 v101, v101
v_mfma_f32_16x16x32_bf16 v[132:135], a[68:71], v[140:143], 0
s_add_u32 s71, s68, s52
v_exp_f32 v102, v102
v_mfma_f32_16x16x32_bf16 v[32:35], a[68:71], v[124:127], 0
s_add_u32 s77, s77, s80
v_exp_f32 v103, v103
v_mfma_f32_16x16x32_bf16 v[196:199], a[72:75], v[124:127], 0
s_add_u32 s77, s77, 38797312
v_cvt_pk_bf16_f32 v248, v100, v101
v_cvt_pk_bf16_f32 v249, v102, v103
v_mfma_f32_16x16x32_bf16 v[184:187], a[72:75], v[140:143], 0
s_add_u32 s52, s3, 6
v_exp_f32 v92, v92
v_mfma_f32_16x16x32_bf16 v[240:243], a[76:79], v[140:143], 0
s_mul_i32 s52, s52, 16384
v_exp_f32 v93, v93
v_mfma_f32_16x16x32_bf16 v[204:207], a[76:79], v[124:127], 0
s_add_u32 s68, s68, s52
v_exp_f32 v94, v94
v_mfma_f32_16x16x32_bf16 v[108:111], a[80:83], v[124:127], 0
s_lshl_b32 s53, s53, 14
v_exp_f32 v95, v95
v_mfma_f32_16x16x32_bf16 v[188:191], a[80:83], v[140:143], 0
s_add_u32 s70, s70, s53
v_cvt_pk_bf16_f32 v232, v92, v93
v_cvt_pk_bf16_f32 v233, v94, v95
v_mfma_f32_16x16x32_bf16 v[56:59], a[84:87], v[140:143], 0
s_mov_b32 s75, 65536
v_exp_f32 v176, v176
v_mfma_f32_16x16x32_bf16 v[40:43], a[84:87], v[124:127], 0
s_mov_b32 s72, 1
v_exp_f32 v177, v177
v_mfma_f32_16x16x32_bf16 v[80:83], a[88:91], v[124:127], 0
s_mov_b32 s73, 9
v_exp_f32 v178, v178
v_mfma_f32_16x16x32_bf16 v[88:91], a[88:91], v[140:143], 0
s_lshl2_add_u32 s69, s5, 4
v_exp_f32 v179, v179
v_mfma_f32_16x16x32_bf16 v[192:195], a[92:95], v[140:143], 0
s_max_u32 s69, s69, 12
v_cvt_pk_bf16_f32 v250, v176, v177
v_cvt_pk_bf16_f32 v251, v178, v179
v_mfma_f32_16x16x32_bf16 v[168:171], a[92:95], v[124:127], 0
s_min_u32 s74, s73, s66
v_exp_f32 v228, v228
v_mfma_f32_16x16x32_bf16 a[224:227], a[240:243], v[124:127], 0
s_mov_b32 s93, 9
s_waitcnt vmcnt(8) lgkmcnt(0)
v_mfma_f32_16x16x32_bf16 a[228:231], a[240:243], v[140:143], 0
s_cmp_lt_u32 s66, 2
buffer_atomic_add v1, v0, s[24:27], s89 offen offset:8 sc1
s_cbranch_scc1 L_NE
L_DUAL:
v_mfma_f32_16x16x32_bf16 v[44:47], a[192:195], a[32:35], v[96:99]
s_barrier
v_mfma_f32_16x16x32_bf16 v[44:47], a[196:199], a[36:39], v[44:47]
s_cmp_eq_u32 s68, s71
v_exp_f32 v229, v229
v_mfma_f32_16x16x32_bf16 v[44:47], a[200:203], a[28:31], v[44:47]
s_cselect_b32 s64, s77, s68
v_add_u32 v5, s75, v4
v_cvt_pk_bf16_f32 v234, v228, v229
v_mfma_f32_16x16x32_bf16 v[44:47], a[204:207], a[20:23], v[44:47]
s_mov_b32 m0, s70
v_exp_f32 v230, v230
v_mfma_f32_16x16x32_bf16 v[52:55], a[192:195], a[44:47], v[104:107]
buffer_load_dwordx4 v15, s[24:27], s64 offen offset:0 sc1 lds
v_mfma_f32_16x16x32_bf16 v[52:55], a[196:199], a[40:43], v[52:55]
s_add_u32 s75, s75, 16384
v_exp_f32 v231, v231
v_mfma_f32_16x16x32_bf16 v[52:55], a[200:203], a[12:15], v[52:55]
v_cvt_pk_bf16_f32 v235, v230, v231
v_mfma_f32_16x16x32_bf16 v[52:55], a[204:207], a[4:7], v[52:55]
s_cmp_ge_u32 s75, 163840
v_exp_f32 v44, v44
v_mfma_f32_16x16x32_bf16 v[64:67], a[208:211], a[32:35], v[112:115]
v_mfma_f32_16x16x32_bf16 v[64:67], a[212:215], a[36:39], v[64:67]
s_cselect_b32 s75, 0, s75
v_exp_f32 v45, v45
v_mfma_f32_16x16x32_bf16 v[64:67], a[216:219], a[28:31], v[64:67]
v_cvt_pk_bf16_f32 v124, v44, v45
v_mfma_f32_16x16x32_bf16 v[64:67], a[220:223], a[20:23], v[64:67]
s_add_u32 s68, s64, 16384
v_exp_f32 v46, v46
v_mfma_f32_16x16x32_bf16 v[212:215], a[208:211], a[44:47], v[120:123]
buffer_load_dwordx4 v15, s[24:27], s64 offen offset:1024 sc1 lds
v_mfma_f32_16x16x32_bf16 v[212:215], a[212:215], a[40:43], v[212:215]
s_add_u32 s70, s70, 16384
v_exp_f32 v47, v47
v_mfma_f32_16x16x32_bf16 v[212:215], a[216:219], a[12:15], v[212:215]
v_cvt_pk_bf16_f32 v125, v46, v47
v_mfma_f32_16x16x32_bf16 v[212:215], a[220:223], a[4:7], v[212:215]
v_exp_f32 v52, v52
v_mfma_f32_16x16x32_bf16 v[60:63], a[64:67], v[248:251], v[60:63]
v_mfma_f32_16x16x32_bf16 v[148:151], a[64:67], v[232:235], v[148:151]
s_cmp_ge_u32 s70, 163840
v_exp_f32 v53, v53
v_mfma_f32_16x16x32_bf16 v[48:51], a[68:71], v[232:235], v[48:51]
ds_read_b128 a[64:67], v5 offset:8192
v_cvt_pk_bf16_f32 v140, v52, v53
v_mfma_f32_16x16x32_bf16 v[68:71], a[68:71], v[248:251], v[68:71]
s_cselect_b32 s70, s80, s70
v_exp_f32 v54, v54
v_mfma_f32_16x16x32_bf16 v[72:75], a[72:75], v[248:251], v[72:75]
buffer_load_dwordx4 v15, s[24:27], s64 offen offset:2048 sc1 lds
v_mfma_f32_16x16x32_bf16 v[236:239], a[72:75], v[232:235], v[236:239]
v_exp_f32 v55, v55
v_mfma_f32_16x16x32_bf16 v[224:227], a[76:79], v[232:235], v[224:227]
ds_read_b128 a[68:71], v5 offset:9216
v_cvt_pk_bf16_f32 v141, v54, v55
v_mfma_f32_16x16x32_bf16 v[220:223], a[76:79], v[248:251], v[220:223]
v_exp_f32 v64, v64
v_mfma_f32_16x16x32_bf16 v[84:87], a[80:83], v[248:251], v[84:87]
ds_read_b128 a[72:75], v5 offset:10240
v_mfma_f32_16x16x32_bf16 v[164:167], a[80:83], v[232:235], v[164:167]
v_exp_f32 v65, v65
v_mfma_f32_16x16x32_bf16 v[156:159], a[84:87], v[232:235], v[156:159]
ds_read_b128 a[76:79], v5 offset:11264
v_cvt_pk_bf16_f32 v126, v64, v65
v_mfma_f32_16x16x32_bf16 v[76:79], a[84:87], v[248:251], v[76:79]
v_exp_f32 v66, v66
v_mfma_f32_16x16x32_bf16 v[160:163], a[88:91], v[248:251], v[160:163]
buffer_load_dwordx4 v15, s[24:27], s64 offen offset:3072 sc1 lds
v_mfma_f32_16x16x32_bf16 v[216:219], a[88:91], v[232:235], v[216:219]
v_exp_f32 v67, v67
v_mfma_f32_16x16x32_bf16 v[208:211], a[92:95], v[232:235], v[208:211]
ds_read_b128 a[80:83], v5 offset:12288
v_cvt_pk_bf16_f32 v127, v66, v67
v_mfma_f32_16x16x32_bf16 v[252:255], a[92:95], v[248:251], v[252:255]
v_exp_f32 v212, v212
v_mfma_f32_16x16x32_bf16 a[232:235], a[240:243], v[248:251], a[232:235]
ds_read_b128 a[84:87], v5 offset:13312
v_mfma_f32_16x16x32_bf16 a[236:239], a[240:243], v[232:235], a[236:239]
ds_read_b128 a[88:91], v5 offset:14336
v_mfma_f32_16x16x32_bf16 v[100:103], a[192:195], a[48:51], v[128:131]
ds_read_b128 a[92:95], v5 offset:15360
v_mfma_f32_16x16x32_bf16 v[100:103], a[196:199], a[52:55], v[100:103]
v_exp_f32 v213, v213
v_mfma_f32_16x16x32_bf16 v[100:103], a[200:203], a[0:3], v[100:103]
v_cvt_pk_bf16_f32 v142, v212, v213
v_mfma_f32_16x16x32_bf16 v[100:103], a[204:207], a[8:11], v[100:103]
v_exp_f32 v214, v214
v_mfma_f32_16x16x32_bf16 v[92:95], a[192:195], a[60:63], v[136:139]
s_nop 0
v_mfma_f32_16x16x32_bf16 v[92:95], a[196:199], a[56:59], v[92:95]
v_exp_f32 v215, v215
v_mfma_f32_16x16x32_bf16 v[92:95], a[200:203], a[16:19], v[92:95]
ds_read_b128 a[192:195], v5 offset:0
v_cvt_pk_bf16_f32 v143, v214, v215
v_mfma_f32_16x16x32_bf16 v[92:95], a[204:207], a[24:27], v[92:95]
v_exp_f32 v100, v100
v_mfma_f32_16x16x32_bf16 v[176:179], a[208:211], a[48:51], v[144:147]
ds_read_b128 a[196:199], v5 offset:1024
v_mfma_f32_16x16x32_bf16 v[176:179], a[212:215], a[52:55], v[176:179]
v_exp_f32 v101, v101
v_mfma_f32_16x16x32_bf16 v[176:179], a[216:219], a[0:3], v[176:179]
ds_read_b128 a[200:203], v5 offset:2048
v_cvt_pk_bf16_f32 v248, v100, v101
v_mfma_f32_16x16x32_bf16 v[176:179], a[220:223], a[8:11], v[176:179]
v_exp_f32 v102, v102
v_mfma_f32_16x16x32_bf16 v[228:231], a[208:211], a[60:63], v[152:155]
ds_read_b128 a[204:207], v5 offset:3072
v_mfma_f32_16x16x32_bf16 v[228:231], a[212:215], a[56:59], v[228:231]
v_exp_f32 v103, v103
v_mfma_f32_16x16x32_bf16 v[228:231], a[216:219], a[16:19], v[228:231]
ds_read_b128 a[208:211], v5 offset:4096
v_cvt_pk_bf16_f32 v249, v102, v103
v_mfma_f32_16x16x32_bf16 v[228:231], a[220:223], a[24:27], v[228:231]
s_waitcnt lgkmcnt(5)
v_exp_f32 v92, v92
v_mfma_f32_16x16x32_bf16 v[36:39], a[64:67], v[124:127], v[36:39]
ds_read_b128 a[212:215], v5 offset:5120
v_mfma_f32_16x16x32_bf16 v[116:119], a[64:67], v[140:143], v[116:119]
v_exp_f32 v93, v93
v_mfma_f32_16x16x32_bf16 v[132:135], a[68:71], v[140:143], v[132:135]
ds_read_b128 a[216:219], v5 offset:6144
v_cvt_pk_bf16_f32 v232, v92, v93
v_mfma_f32_16x16x32_bf16 v[32:35], a[68:71], v[124:127], v[32:35]
v_exp_f32 v94, v94
v_mfma_f32_16x16x32_bf16 v[196:199], a[72:75], v[124:127], v[196:199]
ds_read_b128 a[220:223], v5 offset:7168
v_mfma_f32_16x16x32_bf16 v[184:187], a[72:75], v[140:143], v[184:187]
s_add_u32 s72, s72, 1
v_exp_f32 v95, v95
v_mfma_f32_16x16x32_bf16 v[240:243], a[76:79], v[140:143], v[240:243]
v_cvt_pk_bf16_f32 v233, v94, v95
v_mfma_f32_16x16x32_bf16 v[204:207], a[76:79], v[124:127], v[204:207]
v_exp_f32 v176, v176
v_mfma_f32_16x16x32_bf16 v[108:111], a[80:83], v[124:127], v[108:111]
v_mfma_f32_16x16x32_bf16 v[188:191], a[80:83], v[140:143], v[188:191]
v_exp_f32 v177, v177
v_mfma_f32_16x16x32_bf16 v[56:59], a[84:87], v[140:143], v[56:59]
v_cvt_pk_bf16_f32 v250, v176, v177
v_mfma_f32_16x16x32_bf16 v[40:43], a[84:87], v[124:127], v[40:43]
v_exp_f32 v178, v178
v_mfma_f32_16x16x32_bf16 v[80:83], a[88:91], v[124:127], v[80:83]
v_mfma_f32_16x16x32_bf16 v[88:91], a[88:91], v[140:143], v[88:91]
s_cmp_lt_u32 s72, s74
v_exp_f32 v179, v179
v_mfma_f32_16x16x32_bf16 v[192:195], a[92:95], v[140:143], v[192:195]
v_cvt_pk_bf16_f32 v251, v178, v179
v_mfma_f32_16x16x32_bf16 v[168:171], a[92:95], v[124:127], v[168:171]
s_waitcnt vmcnt(8) lgkmcnt(0)
v_exp_f32 v228, v228
v_mfma_f32_16x16x32_bf16 a[224:227], a[240:243], v[124:127], a[224:227]
v_mfma_f32_16x16x32_bf16 a[228:231], a[240:243], v[140:143], a[228:231]
s_cbranch_scc1 L_DUAL
L_DISP:
s_cmp_eq_u32 s72, s93
s_cbranch_scc1 L_STOP
L_NE:
s_mov_b32 s74, s93
s_cmp_gt_u32 s72, s66
s_cbranch_scc1 L_SINGLE
v_cndmask_b32 v96, v96, v6, s[56:57]
v_cndmask_b32 v120, v120, v6, s[56:57]
v_mov_b32 v112, v6
v_cndmask_b32 v97, v97, v6, s[58:59]
v_cndmask_b32 v121, v121, v6, s[58:59]
v_mov_b32 v113, v6
v_cndmask_b32 v98, v98, v6, s[60:61]
v_cndmask_b32 v122, v122, v6, s[60:61]
v_mov_b32 v114, v6
v_cndmask_b32 v99, v99, v6, s[62:63]
v_cndmask_b32 v123, v123, v6, s[62:63]
v_mov_b32 v115, v6
s_mov_b32 s74, 0
s_branch L_DUAL
L_STOP:
s_cmp_eq_u32 s72, 9
s_cbranch_scc1 L_E1
s_cmp_lg_u32 s72, 11
s_cbranch_scc1 L_SE
v_cmp_gt_u32 vcc, 32, v172
s_mov_b32 s73, 32
s_min_u32 s93, s73, s69
s_min_u32 s74, s93, s66
v_accvgpr_read_b32 v16, a244
v_accvgpr_read_b32 v17, a248
v_accvgpr_read_b32 v18, a252
s_cbranch_vccnz CK_Q
CK_Q_R:
buffer_load_dwordx4 a[244:247], v16, s[24:27], 0 offen sc1
buffer_load_dwordx4 a[248:251], v17, s[24:27], 0 offen sc1
buffer_load_dwordx4 a[252:255], v18, s[24:27], 0 offen sc1
s_add_u32 s53, s77, 163840
buffer_load_dwordx4 a[96:99], v15, s[24:27], s53 offen offset:0 sc1
buffer_load_dwordx4 a[100:103], v15, s[24:27], s53 offen offset:1024 sc1
buffer_load_dwordx4 a[104:107], v15, s[24:27], s53 offen offset:2048 sc1
buffer_load_dwordx4 a[108:111], v15, s[24:27], s53 offen offset:3072 sc1
s_cmp_lt_u32 s72, s66
s_cbranch_scc1 L_DUAL
s_mov_b32 s74, s93
s_cmp_gt_u32 s72, s66
s_cbranch_scc1 L_SINGLE
s_branch L_NE
L_E1:
buffer_load_dword v172, v28, s[24:27], 0 offen sc1
s_mov_b32 s73, 11
buffer_store_dwordx4 v[0:3], v4, s[44:47], s90 offen sc1
buffer_store_dwordx4 v[0:3], v4, s[44:47], s90 offen offset:1024 sc1
buffer_store_dword v0, v31, s[44:47], s90 offen offset:2048 sc1
s_min_u32 s93, s73, s69
s_min_u32 s74, s93, s66
s_cmp_lt_u32 s72, s66
s_cbranch_scc1 L_DUAL
s_mov_b32 s74, s93
s_cmp_gt_u32 s72, s66
s_cbranch_scc1 L_SINGLE
s_branch L_NE
L_SE:
s_mov_b32 s69, 64
s_nop 1
v_accvgpr_read_b32 v180, a224
v_accvgpr_read_b32 v182, a228
v_cmp_nle_f32 vcc, v180, v7
v_cmp_nle_f32 s[96:97], v182, v7
s_nop 3
s_or_b64 vcc, vcc, s[96:97]
s_cbranch_vccnz L_NS
s_add_u32 s53, s77, 180224
buffer_load_dwordx4 a[112:115], v15, s[24:27], s53 offen offset:0 sc1
v_mul_f32 v8, 0x3fb8aa3b, v8
v_mul_f32 v9, 0x3fb8aa3b, v9
v_exp_f32 v8, v8
v_exp_f32 v9, v9
s_nop 0
v_fma_f32 v180, v180, v8, v180
v_fma_f32 v182, v182, v9, v182
v_rcp_f32 v180, v180
v_rcp_f32 v182, v182
s_add_u32 s52, s78, 4096
v_mov_b32 v181, v180
v_mov_b32 v183, v182
v_pk_mul_f32 v[36:37], v[36:37], v[180:181]
v_pk_mul_f32 v[38:39], v[38:39], v[180:181]
v_pk_mul_f32 v[32:33], v[32:33], v[180:181]
v_pk_mul_f32 v[34:35], v[34:35], v[180:181]
v_cvt_pk_bf16_f32 v36, v36, v37
v_cvt_pk_bf16_f32 v37, v38, v39
v_cvt_pk_bf16_f32 v38, v32, v33
v_cvt_pk_bf16_f32 v39, v34, v35
buffer_store_dwordx4 v[36:39], v15, s[24:27], s78 offen offset:0 sc1
buffer_load_dwordx4 a[116:119], v15, s[24:27], s53 offen offset:1024 sc1
v_pk_mul_f32 v[116:117], v[116:117], v[182:183]
v_pk_mul_f32 v[118:119], v[118:119], v[182:183]
v_pk_mul_f32 v[132:133], v[132:133], v[182:183]
v_pk_mul_f32 v[134:135], v[134:135], v[182:183]
v_cvt_pk_bf16_f32 v116, v116, v117
v_cvt_pk_bf16_f32 v117, v118, v119
v_cvt_pk_bf16_f32 v118, v132, v133
v_cvt_pk_bf16_f32 v119, v134, v135
buffer_store_dwordx4 v[116:119], v15, s[24:27], s78 offen offset:1024 sc1
v_pk_mul_f32 v[196:197], v[196:197], v[180:181]
v_pk_mul_f32 v[198:199], v[198:199], v[180:181]
v_pk_mul_f32 v[204:205], v[204:205], v[180:181]
v_pk_mul_f32 v[206:207], v[206:207], v[180:181]
v_cvt_pk_bf16_f32 v196, v196, v197
v_cvt_pk_bf16_f32 v197, v198, v199
v_cvt_pk_bf16_f32 v198, v204, v205
v_cvt_pk_bf16_f32 v199, v206, v207
buffer_store_dwordx4 v[196:199], v15, s[24:27], s78 offen offset:2048 sc1
v_pk_mul_f32 v[184:185], v[184:185], v[182:183]
v_pk_mul_f32 v[186:187], v[186:187], v[182:183]
v_pk_mul_f32 v[240:241], v[240:241], v[182:183]
buffer_load_dwordx4 a[120:123], v15, s[24:27], s53 offen offset:2048 sc1
v_pk_mul_f32 v[242:243], v[242:243], v[182:183]
v_cvt_pk_bf16_f32 v184, v184, v185
v_cvt_pk_bf16_f32 v185, v186, v187
v_cvt_pk_bf16_f32 v186, v240, v241
v_cvt_pk_bf16_f32 v187, v242, v243
buffer_store_dwordx4 v[184:187], v15, s[24:27], s78 offen offset:3072 sc1
v_pk_mul_f32 v[108:109], v[108:109], v[180:181]
v_pk_mul_f32 v[110:111], v[110:111], v[180:181]
v_pk_mul_f32 v[40:41], v[40:41], v[180:181]
v_pk_mul_f32 v[42:43], v[42:43], v[180:181]
v_cvt_pk_bf16_f32 v108, v108, v109
v_cvt_pk_bf16_f32 v109, v110, v111
v_cvt_pk_bf16_f32 v110, v40, v41
v_cvt_pk_bf16_f32 v111, v42, v43
buffer_store_dwordx4 v[108:111], v15, s[24:27], s52 offen offset:0 sc1
v_pk_mul_f32 v[188:189], v[188:189], v[182:183]
v_pk_mul_f32 v[190:191], v[190:191], v[182:183]
v_pk_mul_f32 v[56:57], v[56:57], v[182:183]
v_pk_mul_f32 v[58:59], v[58:59], v[182:183]
v_cvt_pk_bf16_f32 v188, v188, v189
v_cvt_pk_bf16_f32 v189, v190, v191
buffer_load_dwordx4 a[124:127], v15, s[24:27], s53 offen offset:3072 sc1
v_cvt_pk_bf16_f32 v190, v56, v57
v_cvt_pk_bf16_f32 v191, v58, v59
buffer_store_dwordx4 v[188:191], v15, s[24:27], s52 offen offset:1024 sc1
v_pk_mul_f32 v[80:81], v[80:81], v[180:181]
v_pk_mul_f32 v[82:83], v[82:83], v[180:181]
v_pk_mul_f32 v[168:169], v[168:169], v[180:181]
v_pk_mul_f32 v[170:171], v[170:171], v[180:181]
v_cvt_pk_bf16_f32 v80, v80, v81
v_cvt_pk_bf16_f32 v81, v82, v83
v_cvt_pk_bf16_f32 v82, v168, v169
v_cvt_pk_bf16_f32 v83, v170, v171
buffer_store_dwordx4 v[80:83], v15, s[24:27], s52 offen offset:2048 sc1
v_pk_mul_f32 v[88:89], v[88:89], v[182:183]
v_pk_mul_f32 v[90:91], v[90:91], v[182:183]
v_pk_mul_f32 v[192:193], v[192:193], v[182:183]
v_pk_mul_f32 v[194:195], v[194:195], v[182:183]
v_cvt_pk_bf16_f32 v88, v88, v89
v_cvt_pk_bf16_f32 v89, v90, v91
v_cvt_pk_bf16_f32 v90, v192, v193
v_cvt_pk_bf16_f32 v91, v194, v195
buffer_store_dwordx4 v[88:91], v15, s[24:27], s52 offen offset:3072 sc1
L_PAD9:
s_cbranch_execz L_PAD13
s_mov_b32 s76, 1
L_NS:
s_mov_b32 s74, s73
s_mov_b32 s93, s73
s_cmp_eq_u32 s72, 32
s_cbranch_scc1 L_FIN
L_SINGLE:
v_mfma_f32_16x16x32_bf16 v[44:47], a[192:195], a[48:51], v[128:131]
s_barrier
v_mfma_f32_16x16x32_bf16 v[44:47], a[196:199], a[52:55], v[44:47]
s_cmp_eq_u32 s68, s71
v_exp_f32 v229, v229
v_mfma_f32_16x16x32_bf16 v[44:47], a[200:203], a[0:3], v[44:47]
s_cselect_b32 s64, s77, s68
v_add_u32 v5, s75, v4
v_cvt_pk_bf16_f32 v234, v228, v229
v_mfma_f32_16x16x32_bf16 v[44:47], a[204:207], a[8:11], v[44:47]
s_mov_b32 m0, s70
v_exp_f32 v230, v230
v_mfma_f32_16x16x32_bf16 v[52:55], a[192:195], a[60:63], v[136:139]
buffer_load_dwordx4 v15, s[24:27], s64 offen offset:0 sc1 lds
v_mfma_f32_16x16x32_bf16 v[52:55], a[196:199], a[56:59], v[52:55]
s_add_u32 s75, s75, 16384
v_exp_f32 v231, v231
v_mfma_f32_16x16x32_bf16 v[52:55], a[200:203], a[16:19], v[52:55]
ds_read_b128 a[192:195], v5 offset:0
v_cvt_pk_bf16_f32 v235, v230, v231
v_mfma_f32_16x16x32_bf16 v[52:55], a[204:207], a[24:27], v[52:55]
s_cmp_ge_u32 s75, 163840
v_exp_f32 v44, v44
v_mfma_f32_16x16x32_bf16 v[64:67], a[208:211], a[48:51], v[144:147]
ds_read_b128 a[196:199], v5 offset:1024
ds_read_b128 a[200:203], v5 offset:2048
v_mfma_f32_16x16x32_bf16 v[64:67], a[212:215], a[52:55], v[64:67]
s_cselect_b32 s75, 0, s75
v_exp_f32 v45, v45
v_mfma_f32_16x16x32_bf16 v[64:67], a[216:219], a[0:3], v[64:67]
ds_read_b128 a[204:207], v5 offset:3072
v_cvt_pk_bf16_f32 v124, v44, v45
v_mfma_f32_16x16x32_bf16 v[64:67], a[220:223], a[8:11], v[64:67]
s_add_u32 s68, s64, 16384
v_exp_f32 v46, v46
v_mfma_f32_16x16x32_bf16 v[212:215], a[208:211], a[60:63], v[152:155]
buffer_load_dwordx4 v15, s[24:27], s64 offen offset:1024 sc1 lds
v_mfma_f32_16x16x32_bf16 v[212:215], a[212:215], a[56:59], v[212:215]
s_add_u32 s70, s70, 16384
v_exp_f32 v47, v47
v_mfma_f32_16x16x32_bf16 v[212:215], a[216:219], a[16:19], v[212:215]
ds_read_b128 a[208:211], v5 offset:4096
v_cvt_pk_bf16_f32 v125, v46, v47
v_mfma_f32_16x16x32_bf16 v[212:215], a[220:223], a[24:27], v[212:215]
s_waitcnt lgkmcnt(5)
v_exp_f32 v52, v52
v_mfma_f32_16x16x32_bf16 v[60:63], a[64:67], v[248:251], v[60:63]
ds_read_b128 a[212:215], v5 offset:5120
ds_read_b128 a[216:219], v5 offset:6144
v_mfma_f32_16x16x32_bf16 v[148:151], a[64:67], v[232:235], v[148:151]
s_cmp_ge_u32 s70, 163840
v_exp_f32 v53, v53
v_mfma_f32_16x16x32_bf16 v[48:51], a[68:71], v[232:235], v[48:51]
ds_read_b128 a[220:223], v5 offset:7168
v_cvt_pk_bf16_f32 v140, v52, v53
v_mfma_f32_16x16x32_bf16 v[68:71], a[68:71], v[248:251], v[68:71]
s_cselect_b32 s70, s80, s70
v_exp_f32 v54, v54
v_mfma_f32_16x16x32_bf16 v[72:75], a[72:75], v[248:251], v[72:75]
buffer_load_dwordx4 v15, s[24:27], s64 offen offset:2048 sc1 lds
v_mfma_f32_16x16x32_bf16 v[236:239], a[72:75], v[232:235], v[236:239]
v_exp_f32 v55, v55
v_mfma_f32_16x16x32_bf16 v[224:227], a[76:79], v[232:235], v[224:227]
ds_read_b128 a[64:67], v5 offset:8192
v_cvt_pk_bf16_f32 v141, v54, v55
v_mfma_f32_16x16x32_bf16 v[220:223], a[76:79], v[248:251], v[220:223]
v_exp_f32 v64, v64
v_mfma_f32_16x16x32_bf16 v[84:87], a[80:83], v[248:251], v[84:87]
ds_read_b128 a[68:71], v5 offset:9216
ds_read_b128 a[72:75], v5 offset:10240
v_mfma_f32_16x16x32_bf16 v[164:167], a[80:83], v[232:235], v[164:167]
v_exp_f32 v65, v65
v_mfma_f32_16x16x32_bf16 v[156:159], a[84:87], v[232:235], v[156:159]
ds_read_b128 a[76:79], v5 offset:11264
v_cvt_pk_bf16_f32 v126, v64, v65
v_mfma_f32_16x16x32_bf16 v[76:79], a[84:87], v[248:251], v[76:79]
s_cmp_eq_u32 s68, s71
v_exp_f32 v66, v66
v_mfma_f32_16x16x32_bf16 v[160:163], a[88:91], v[248:251], v[160:163]
buffer_load_dwordx4 v15, s[24:27], s64 offen offset:3072 sc1 lds
v_mfma_f32_16x16x32_bf16 v[216:219], a[88:91], v[232:235], v[216:219]
s_cselect_b32 s64, s77, s68
v_exp_f32 v67, v67
v_mfma_f32_16x16x32_bf16 v[208:211], a[92:95], v[232:235], v[208:211]
ds_read_b128 a[80:83], v5 offset:12288
v_cvt_pk_bf16_f32 v127, v66, v67
v_mfma_f32_16x16x32_bf16 v[252:255], a[92:95], v[248:251], v[252:255]
s_waitcnt lgkmcnt(5)
v_exp_f32 v212, v212
v_mfma_f32_16x16x32_bf16 a[232:235], a[240:243], v[248:251], a[232:235]
ds_read_b128 a[84:87], v5 offset:13312
ds_read_b128 a[88:91], v5 offset:14336
v_mfma_f32_16x16x32_bf16 a[236:239], a[240:243], v[232:235], a[236:239]
s_mov_b32 m0, s70
ds_read_b128 a[92:95], v5 offset:15360
v_mfma_f32_16x16x32_bf16 v[100:103], a[192:195], a[48:51], v[128:131]
buffer_load_dwordx4 v15, s[24:27], s64 offen offset:0 sc1 lds
v_mfma_f32_16x16x32_bf16 v[100:103], a[196:199], a[52:55], v[100:103]
v_exp_f32 v213, v213
v_mfma_f32_16x16x32_bf16 v[100:103], a[200:203], a[0:3], v[100:103]
v_add_u32 v5, s75, v4
v_cvt_pk_bf16_f32 v142, v212, v213
v_mfma_f32_16x16x32_bf16 v[100:103], a[204:207], a[8:11], v[100:103]
v_exp_f32 v214, v214
v_mfma_f32_16x16x32_bf16 v[92:95], a[192:195], a[60:63], v[136:139]
buffer_load_dwordx4 v15, s[24:27], s64 offen offset:1024 sc1 lds
v_mfma_f32_16x16x32_bf16 v[92:95], a[196:199], a[56:59], v[92:95]
s_add_u32 s75, s75, 16384
v_exp_f32 v215, v215
v_mfma_f32_16x16x32_bf16 v[92:95], a[200:203], a[16:19], v[92:95]
ds_read_b128 a[192:195], v5 offset:0
v_cvt_pk_bf16_f32 v143, v214, v215
v_mfma_f32_16x16x32_bf16 v[92:95], a[204:207], a[24:27], v[92:95]
s_cmp_ge_u32 s75, 163840
v_exp_f32 v100, v100
v_mfma_f32_16x16x32_bf16 v[176:179], a[208:211], a[48:51], v[144:147]
ds_read_b128 a[196:199], v5 offset:1024
ds_read_b128 a[200:203], v5 offset:2048
v_mfma_f32_16x16x32_bf16 v[176:179], a[212:215], a[52:55], v[176:179]
s_cselect_b32 s75, 0, s75
v_exp_f32 v101, v101
v_mfma_f32_16x16x32_bf16 v[176:179], a[216:219], a[0:3], v[176:179]
ds_read_b128 a[204:207], v5 offset:3072
v_cvt_pk_bf16_f32 v248, v100, v101
v_mfma_f32_16x16x32_bf16 v[176:179], a[220:223], a[8:11], v[176:179]
s_add_u32 s68, s64, 16384
v_exp_f32 v102, v102
v_mfma_f32_16x16x32_bf16 v[228:231], a[208:211], a[60:63], v[152:155]
buffer_load_dwordx4 v15, s[24:27], s64 offen offset:2048 sc1 lds
v_mfma_f32_16x16x32_bf16 v[228:231], a[212:215], a[56:59], v[228:231]
s_add_u32 s70, s70, 16384
v_exp_f32 v103, v103
v_mfma_f32_16x16x32_bf16 v[228:231], a[216:219], a[16:19], v[228:231]
ds_read_b128 a[208:211], v5 offset:4096
v_cvt_pk_bf16_f32 v249, v102, v103
v_mfma_f32_16x16x32_bf16 v[228:231], a[220:223], a[24:27], v[228:231]
s_waitcnt lgkmcnt(5)
v_exp_f32 v92, v92
v_mfma_f32_16x16x32_bf16 v[60:63], a[64:67], v[124:127], v[60:63]
ds_read_b128 a[212:215], v5 offset:5120
ds_read_b128 a[216:219], v5 offset:6144
v_mfma_f32_16x16x32_bf16 v[148:151], a[64:67], v[140:143], v[148:151]
s_cmp_ge_u32 s70, 163840
v_exp_f32 v93, v93
v_mfma_f32_16x16x32_bf16 v[48:51], a[68:71], v[140:143], v[48:51]
ds_read_b128 a[220:223], v5 offset:7168
v_cvt_pk_bf16_f32 v232, v92, v93
v_mfma_f32_16x16x32_bf16 v[68:71], a[68:71], v[124:127], v[68:71]
s_cselect_b32 s70, s80, s70
v_exp_f32 v94, v94
v_mfma_f32_16x16x32_bf16 v[72:75], a[72:75], v[124:127], v[72:75]
buffer_load_dwordx4 v15, s[24:27], s64 offen offset:3072 sc1 lds
v_mfma_f32_16x16x32_bf16 v[236:239], a[72:75], v[140:143], v[236:239]
s_add_u32 s72, s72, 1
v_exp_f32 v95, v95
v_mfma_f32_16x16x32_bf16 v[224:227], a[76:79], v[140:143], v[224:227]
ds_read_b128 a[64:67], v5 offset:8192
v_cvt_pk_bf16_f32 v233, v94, v95
v_mfma_f32_16x16x32_bf16 v[220:223], a[76:79], v[124:127], v[220:223]
v_exp_f32 v176, v176
v_mfma_f32_16x16x32_bf16 v[84:87], a[80:83], v[124:127], v[84:87]
ds_read_b128 a[68:71], v5 offset:9216
ds_read_b128 a[72:75], v5 offset:10240
v_mfma_f32_16x16x32_bf16 v[164:167], a[80:83], v[140:143], v[164:167]
v_exp_f32 v177, v177
v_mfma_f32_16x16x32_bf16 v[156:159], a[84:87], v[140:143], v[156:159]
ds_read_b128 a[76:79], v5 offset:11264
v_cvt_pk_bf16_f32 v250, v176, v177
v_mfma_f32_16x16x32_bf16 v[76:79], a[84:87], v[124:127], v[76:79]
v_exp_f32 v178, v178
v_mfma_f32_16x16x32_bf16 v[160:163], a[88:91], v[124:127], v[160:163]
ds_read_b128 a[80:83], v5 offset:12288
ds_read_b128 a[84:87], v5 offset:13312
v_mfma_f32_16x16x32_bf16 v[216:219], a[88:91], v[140:143], v[216:219]
s_cmp_lt_u32 s72, s74
v_exp_f32 v179, v179
v_mfma_f32_16x16x32_bf16 v[208:211], a[92:95], v[140:143], v[208:211]
ds_read_b128 a[88:91], v5 offset:14336
v_cvt_pk_bf16_f32 v251, v178, v179
v_mfma_f32_16x16x32_bf16 v[252:255], a[92:95], v[124:127], v[252:255]
s_waitcnt vmcnt(8) lgkmcnt(7)
v_exp_f32 v228, v228
v_mfma_f32_16x16x32_bf16 a[232:235], a[240:243], v[124:127], a[232:235]
ds_read_b128 a[92:95], v5 offset:15360
v_mfma_f32_16x16x32_bf16 a[236:239], a[240:243], v[140:143], a[236:239]
s_cbranch_scc1 L_SINGLE
s_cmp_eq_u32 s72, s69
s_cbranch_scc1 L_SE
s_cmp_lt_u32 s72, 32
s_cbranch_scc1 L_STOP
L_FIN:
s_add_u32 s53, s77, 196608
buffer_load_dwordx4 a[160:163], v15, s[24:27], s53 offen offset:0 sc1
v_cndmask_b32 v128, v128, v6, s[56:57]
v_cndmask_b32 v152, v152, v6, s[56:57]
v_mov_b32 v144, v6
buffer_load_dwordx4 a[164:167], v15, s[24:27], s53 offen offset:1024 sc1
v_cndmask_b32 v129, v129, v6, s[58:59]
v_cndmask_b32 v153, v153, v6, s[58:59]
v_mov_b32 v145, v6
buffer_load_dwordx4 a[168:171], v15, s[24:27], s53 offen offset:2048 sc1
v_cndmask_b32 v130, v130, v6, s[60:61]
v_cndmask_b32 v154, v154, v6, s[60:61]
v_mov_b32 v146, v6
buffer_load_dwordx4 a[172:175], v15, s[24:27], s53 offen offset:3072 sc1
v_cndmask_b32 v131, v131, v6, s[62:63]
v_cndmask_b32 v155, v155, v6, s[62:63]
v_mov_b32 v147, v6
s_mov_b32 s83, s75
s_sub_u32 s91, s70, s80
v_mfma_f32_16x16x32_bf16 v[44:47], a[192:195], a[48:51], v[128:131]
s_barrier
v_mfma_f32_16x16x32_bf16 v[44:47], a[196:199], a[52:55], v[44:47]
s_mov_b32 m0, s70
v_exp_f32 v229, v229
v_mfma_f32_16x16x32_bf16 v[44:47], a[200:203], a[0:3], v[44:47]
s_mov_b32 s64, s68
v_add_u32 v5, s75, v4
v_cvt_pk_bf16_f32 v234, v228, v229
v_mfma_f32_16x16x32_bf16 v[44:47], a[204:207], a[8:11], v[44:47]
s_add_u32 s68, s68, 16384
v_exp_f32 v230, v230
v_mfma_f32_16x16x32_bf16 v[52:55], a[192:195], a[60:63], v[136:139]
buffer_load_dwordx4 v15, s[24:27], s64 offen offset:0 sc1 lds
v_mfma_f32_16x16x32_bf16 v[52:55], a[196:199], a[56:59], v[52:55]
s_add_u32 s70, s70, 16384
v_exp_f32 v231, v231
v_mfma_f32_16x16x32_bf16 v[52:55], a[200:203], a[16:19], v[52:55]
v_cvt_pk_bf16_f32 v235, v230, v231
v_mul_f32 v10, 0x3fb8aa3b, v10
v_mfma_f32_16x16x32_bf16 v[52:55], a[204:207], a[24:27], v[52:55]
s_cmp_ge_u32 s70, 163840
v_exp_f32 v44, v44
v_mfma_f32_16x16x32_bf16 v[64:67], a[208:211], a[48:51], v[144:147]
buffer_load_dwordx4 v15, s[24:27], s64 offen offset:1024 sc1 lds
v_mfma_f32_16x16x32_bf16 v[64:67], a[212:215], a[52:55], v[64:67]
s_cselect_b32 s70, s80, s70
v_exp_f32 v45, v45
v_mfma_f32_16x16x32_bf16 v[64:67], a[216:219], a[0:3], v[64:67]
v_cvt_pk_bf16_f32 v124, v44, v45
v_mul_f32 v11, 0x3fb8aa3b, v11
v_mfma_f32_16x16x32_bf16 v[64:67], a[220:223], a[8:11], v[64:67]
v_exp_f32 v46, v46
v_mfma_f32_16x16x32_bf16 v[212:215], a[208:211], a[60:63], v[152:155]
buffer_load_dwordx4 v15, s[24:27], s64 offen offset:2048 sc1 lds
v_mfma_f32_16x16x32_bf16 v[212:215], a[212:215], a[56:59], v[212:215]
v_exp_f32 v47, v47
v_mfma_f32_16x16x32_bf16 v[212:215], a[216:219], a[16:19], v[212:215]
v_cvt_pk_bf16_f32 v125, v46, v47
v_mfma_f32_16x16x32_bf16 v[212:215], a[220:223], a[24:27], v[212:215]
s_waitcnt lgkmcnt(0)
v_exp_f32 v52, v52
v_mfma_f32_16x16x32_bf16 v[60:63], a[64:67], v[248:251], v[60:63]
buffer_load_dwordx4 v15, s[24:27], s64 offen offset:3072 sc1 lds
v_mfma_f32_16x16x32_bf16 v[148:151], a[64:67], v[232:235], v[148:151]
s_mov_b32 m0, s70
v_exp_f32 v53, v53
v_mfma_f32_16x16x32_bf16 v[48:51], a[68:71], v[232:235], v[48:51]
s_mov_b32 s64, s68
ds_read_b128 a[64:67], v5 offset:8192
v_cvt_pk_bf16_f32 v140, v52, v53
v_mfma_f32_16x16x32_bf16 v[68:71], a[68:71], v[248:251], v[68:71]
s_add_u32 s68, s68, 16384
v_exp_f32 v54, v54
v_mfma_f32_16x16x32_bf16 v[72:75], a[72:75], v[248:251], v[72:75]
buffer_load_dwordx4 v15, s[24:27], s64 offen offset:0 sc1 lds
v_mfma_f32_16x16x32_bf16 v[236:239], a[72:75], v[232:235], v[236:239]
s_add_u32 s70, s70, 16384
v_exp_f32 v55, v55
v_mfma_f32_16x16x32_bf16 v[224:227], a[76:79], v[232:235], v[224:227]
ds_read_b128 a[68:71], v5 offset:9216
v_cvt_pk_bf16_f32 v141, v54, v55
v_mfma_f32_16x16x32_bf16 v[220:223], a[76:79], v[248:251], v[220:223]
s_cmp_ge_u32 s70, 163840
v_exp_f32 v64, v64
v_mfma_f32_16x16x32_bf16 v[84:87], a[80:83], v[248:251], v[84:87]
ds_read_b128 a[72:75], v5 offset:10240
v_mfma_f32_16x16x32_bf16 v[164:167], a[80:83], v[232:235], v[164:167]
s_cselect_b32 s70, s80, s70
v_exp_f32 v65, v65
v_mfma_f32_16x16x32_bf16 v[156:159], a[84:87], v[232:235], v[156:159]
ds_read_b128 a[76:79], v5 offset:11264
v_cvt_pk_bf16_f32 v126, v64, v65
v_mfma_f32_16x16x32_bf16 v[76:79], a[84:87], v[248:251], v[76:79]
v_exp_f32 v66, v66
v_mfma_f32_16x16x32_bf16 v[160:163], a[88:91], v[248:251], v[160:163]
buffer_load_dwordx4 v15, s[24:27], s64 offen offset:1024 sc1 lds
v_mfma_f32_16x16x32_bf16 v[216:219], a[88:91], v[232:235], v[216:219]
s_add_u32 s52, s79, 4096
v_exp_f32 v67, v67
v_mfma_f32_16x16x32_bf16 v[208:211], a[92:95], v[232:235], v[208:211]
ds_read_b128 a[80:83], v5 offset:12288
v_cvt_pk_bf16_f32 v127, v66, v67
v_mfma_f32_16x16x32_bf16 v[252:255], a[92:95], v[248:251], v[252:255]
v_exp_f32 v212, v212
v_mfma_f32_16x16x32_bf16 a[232:235], a[240:243], v[248:251], a[232:235]
ds_read_b128 a[84:87], v5 offset:13312
ds_read_b128 a[88:91], v5 offset:14336
v_mfma_f32_16x16x32_bf16 a[236:239], a[240:243], v[232:235], a[236:239]
ds_read_b128 a[92:95], v5 offset:15360
v_exp_f32 v213, v213
v_exp_f32 v214, v214
v_exp_f32 v215, v215
v_exp_f32 v10, v10
v_cvt_pk_bf16_f32 v142, v212, v213
v_cvt_pk_bf16_f32 v143, v214, v215
v_exp_f32 v11, v11
s_waitcnt lgkmcnt(0)
v_mfma_f32_16x16x32_bf16 a[232:235], a[240:243], v[124:127], a[232:235]
buffer_load_dwordx4 v15, s[24:27], s64 offen offset:2048 sc1 lds
v_mfma_f32_16x16x32_bf16 a[236:239], a[240:243], v[140:143], a[236:239]
s_barrier
v_mfma_f32_16x16x32_bf16 v[60:63], a[64:67], v[124:127], v[60:63]
v_cmp_eq_u32 vcc, 0, v3
v_mul_u32_u24 v244, 1536, v3
v_mfma_f32_16x16x32_bf16 v[148:151], a[64:67], v[140:143], v[148:151]
v_mov_b32 v246, 9728
v_cndmask_b32 v244, v244, v246, vcc
v_mfma_f32_16x16x32_bf16 v[48:51], a[68:71], v[140:143], v[48:51]
buffer_load_dwordx4 v15, s[24:27], s64 offen offset:3072 sc1 lds
v_mfma_f32_16x16x32_bf16 v[68:71], a[68:71], v[124:127], v[68:71]
v_lshl_add_u32 v247, v2, 4, s83
v_mov_b32 v246, 10496
v_mfma_f32_16x16x32_bf16 v[72:75], a[72:75], v[124:127], v[72:75]
v_accvgpr_read_b32 v180, a232
v_accvgpr_read_b32 v182, a236
v_mfma_f32_16x16x32_bf16 v[236:239], a[72:75], v[140:143], v[236:239]
v_cmp_nle_f32 vcc, v180, v7
v_cmp_nle_f32 s[96:97], v182, v7
v_mfma_f32_16x16x32_bf16 v[224:227], a[76:79], v[140:143], v[224:227]
v_fma_f32 v180, v180, v10, v180
v_fma_f32 v182, v182, v11, v182
v_mfma_f32_16x16x32_bf16 v[220:223], a[76:79], v[124:127], v[220:223]
v_rcp_f32 v180, v180
v_mfma_f32_16x16x32_bf16 v[84:87], a[80:83], v[124:127], v[84:87]
s_or_b64 vcc, vcc, s[96:97]
v_rcp_f32 v182, v182
v_mfma_f32_16x16x32_bf16 v[164:167], a[80:83], v[140:143], v[164:167]
v_mul_f32 v60, v180, v60
v_mul_f32 v61, v180, v61
v_mfma_f32_16x16x32_bf16 v[156:159], a[84:87], v[140:143], v[156:159]
v_mul_f32 v62, v180, v62
v_mul_f32 v63, v180, v63
v_mfma_f32_16x16x32_bf16 v[76:79], a[84:87], v[124:127], v[76:79]
v_mul_f32 v68, v180, v68
v_mul_f32 v69, v180, v69
v_mfma_f32_16x16x32_bf16 v[160:163], a[88:91], v[124:127], v[160:163]
v_mul_f32 v70, v180, v70
v_mul_f32 v71, v180, v71
v_mfma_f32_16x16x32_bf16 v[216:219], a[88:91], v[140:143], v[216:219]
v_cvt_pk_bf16_f32 v60, v60, v61
v_cvt_pk_bf16_f32 v61, v62, v63
v_mfma_f32_16x16x32_bf16 v[208:211], a[92:95], v[140:143], v[208:211]
v_cvt_pk_bf16_f32 v62, v68, v69
v_cvt_pk_bf16_f32 v63, v70, v71
v_mfma_f32_16x16x32_bf16 v[252:255], a[92:95], v[124:127], v[252:255]
s_cbranch_vccnz SLOW1
L_EP:
buffer_store_dwordx4 v[60:63], v15, s[24:27], s79 offen offset:0 sc1
v_pk_mul_f32 v[148:149], v[148:149], v[182:183] op_sel_hi:[1,0]
v_pk_mul_f32 v[150:151], v[150:151], v[182:183] op_sel_hi:[1,0]
v_pk_mul_f32 v[48:49], v[48:49], v[182:183] op_sel_hi:[1,0]
v_pk_mul_f32 v[50:51], v[50:51], v[182:183] op_sel_hi:[1,0]
v_cvt_pk_bf16_f32 v148, v148, v149
v_cvt_pk_bf16_f32 v149, v150, v151
v_cvt_pk_bf16_f32 v150, v48, v49
v_cvt_pk_bf16_f32 v151, v50, v51
buffer_store_dwordx4 v[148:151], v15, s[24:27], s79 offen offset:1024 sc1
v_pk_mul_f32 v[72:73], v[72:73], v[180:181] op_sel_hi:[1,0]
v_pk_mul_f32 v[74:75], v[74:75], v[180:181] op_sel_hi:[1,0]
v_pk_mul_f32 v[220:221], v[220:221], v[180:181] op_sel_hi:[1,0]
v_pk_mul_f32 v[222:223], v[222:223], v[180:181] op_sel_hi:[1,0]
v_cvt_pk_bf16_f32 v72, v72, v73
v_cvt_pk_bf16_f32 v73, v74, v75
v_cvt_pk_bf16_f32 v74, v220, v221
v_cvt_pk_bf16_f32 v75, v222, v223
buffer_store_dwordx4 v[72:75], v15, s[24:27], s79 offen offset:2048 sc1
v_pk_mul_f32 v[236:237], v[236:237], v[182:183] op_sel_hi:[1,0]
v_pk_mul_f32 v[238:239], v[238:239], v[182:183] op_sel_hi:[1,0]
v_pk_mul_f32 v[224:225], v[224:225], v[182:183] op_sel_hi:[1,0]
v_pk_mul_f32 v[226:227], v[226:227], v[182:183] op_sel_hi:[1,0]
v_cvt_pk_bf16_f32 v236, v236, v237
v_cvt_pk_bf16_f32 v237, v238, v239
v_cvt_pk_bf16_f32 v238, v224, v225
v_cvt_pk_bf16_f32 v239, v226, v227
buffer_store_dwordx4 v[236:239], v15, s[24:27], s79 offen offset:3072 sc1
v_pk_mul_f32 v[84:85], v[84:85], v[180:181] op_sel_hi:[1,0]
v_pk_mul_f32 v[86:87], v[86:87], v[180:181] op_sel_hi:[1,0]
v_pk_mul_f32 v[76:77], v[76:77], v[180:181] op_sel_hi:[1,0]
v_pk_mul_f32 v[78:79], v[78:79], v[180:181] op_sel_hi:[1,0]
v_cvt_pk_bf16_f32 v84, v84, v85
v_cvt_pk_bf16_f32 v85, v86, v87
v_cvt_pk_bf16_f32 v86, v76, v77
v_cvt_pk_bf16_f32 v87, v78, v79
buffer_store_dwordx4 v[84:87], v15, s[24:27], s52 offen offset:0 sc1
v_pk_mul_f32 v[164:165], v[164:165], v[182:183] op_sel_hi:[1,0]
v_pk_mul_f32 v[166:167], v[166:167], v[182:183] op_sel_hi:[1,0]
v_pk_mul_f32 v[156:157], v[156:157], v[182:183] op_sel_hi:[1,0]
v_pk_mul_f32 v[158:159], v[158:159], v[182:183] op_sel_hi:[1,0]
v_cvt_pk_bf16_f32 v164, v164, v165
v_cvt_pk_bf16_f32 v165, v166, v167
v_cvt_pk_bf16_f32 v166, v156, v157
v_cvt_pk_bf16_f32 v167, v158, v159
buffer_store_dwordx4 v[164:167], v15, s[24:27], s52 offen offset:1024 sc1
v_pk_mul_f32 v[160:161], v[160:161], v[180:181] op_sel_hi:[1,0]
v_pk_mul_f32 v[162:163], v[162:163], v[180:181] op_sel_hi:[1,0]
v_pk_mul_f32 v[252:253], v[252:253], v[180:181] op_sel_hi:[1,0]
v_pk_mul_f32 v[254:255], v[254:255], v[180:181] op_sel_hi:[1,0]
v_cvt_pk_bf16_f32 v160, v160, v161
v_cvt_pk_bf16_f32 v161, v162, v163
v_cvt_pk_bf16_f32 v162, v252, v253
v_cvt_pk_bf16_f32 v163, v254, v255
buffer_store_dwordx4 v[160:163], v15, s[24:27], s52 offen offset:2048 sc1
v_pk_mul_f32 v[216:217], v[216:217], v[182:183] op_sel_hi:[1,0]
v_pk_mul_f32 v[218:219], v[218:219], v[182:183] op_sel_hi:[1,0]
v_pk_mul_f32 v[208:209], v[208:209], v[182:183] op_sel_hi:[1,0]
v_pk_mul_f32 v[210:211], v[210:211], v[182:183] op_sel_hi:[1,0]
v_cvt_pk_bf16_f32 v216, v216, v217
v_cvt_pk_bf16_f32 v217, v218, v219
v_cvt_pk_bf16_f32 v218, v208, v209
v_cvt_pk_bf16_f32 v219, v210, v211
buffer_store_dwordx4 v[216:219], v15, s[24:27], s52 offen offset:3072 sc1
v_cmp_eq_u32 vcc, 3, v3
v_mul_u32_u24 v200, 768, v3
v_add_u32 v200, v200, v247
ds_write_b128 v200, a[244:247] offset:0
v_cndmask_b32 v245, v244, v246, vcc
ds_write_b128 v200, a[248:251] offset:3072
v_add_u32 v247, -1280, v247
ds_write_b128 v200, a[252:255] offset:6144
v_add_u32 v244, v244, v247
v_add_u32 v245, v245, v247
ds_write_b128 v244, a[128:131] offset:0
v_cmp_lt_u32 vcc, 31, v1
ds_write_b128 v245, a[132:135] offset:768
v_and_b32 v202, 31, v1
ds_write_b128 v244, a[136:139] offset:256
v_mov_b32 v200, s66
ds_write_b128 v245, a[140:143] offset:1024
v_mov_b32 v203, s67
ds_write_b128 v244, a[144:147] offset:3840
v_cndmask_b32 v200, v200, v203, vcc
ds_write_b128 v245, a[148:151] offset:4608
v_lshl_add_u32 v200, v200, 5, v202
ds_write_b128 v244, a[152:155] offset:4096
v_lshrrev_b32 v201, 5, v1
ds_write_b128 v245, a[156:159] offset:4864
v_mul_u32_u24 v201, 3840, v201
v_lshl_add_u32 v201, v202, 4, v201
v_add_u32 v201, s83, v201
s_cmp_eq_u32 s76, 0
s_cbranch_scc1 L_SE2
L_LA:
v_mov_b32 v5, v200
v_mov_b32 v6, v201
v_mov_b32 v13, 0
s_lshl_b32 s74, s66, 10
s_lshr_b32 s52, s4, 3
s_lshl_b32 s52, s52, 8
s_add_u32 s74, s74, s52
s_add_u32 s74, s74, 75530240
ds_read_b128 v[16:19], v6 offset:8448
ds_read_b128 v[20:23], v6 offset:9216
ds_read_b128 v[96:99], v6 offset:3328
ds_read_b128 v[32:35], v6 offset:256
ds_read_b128 v[36:39], v6 offset:1024
ds_read_b128 v[100:103], v6 offset:3296
ds_read_b128 v[40:43], v6 offset:224
ds_read_b128 v[44:47], v6 offset:992
ds_read_b128 v[104:107], v6 offset:3264
ds_read_b128 v[48:51], v6 offset:192
ds_read_b128 v[52:55], v6 offset:960
ds_read_b128 v[108:111], v6 offset:3232
ds_read_b128 v[56:59], v6 offset:160
ds_read_b128 v[60:63], v6 offset:928
ds_read_b128 v[112:115], v6 offset:3200
ds_read_b128 v[64:67], v6 offset:128
ds_read_b128 v[68:71], v6 offset:896
ds_read_b128 v[116:119], v6 offset:3168
ds_read_b128 v[72:75], v6 offset:96
ds_read_b128 v[76:79], v6 offset:864
ds_read_b128 v[120:123], v6 offset:3136
ds_read_b128 v[80:83], v6 offset:64
ds_read_b128 v[84:87], v6 offset:832
ds_read_b128 v[124:127], v6 offset:3104
ds_read_b128 v[88:91], v6 offset:32
ds_read_b128 v[92:95], v6 offset:800
ds_read_b128 v[128:131], v6 offset:1792
ds_read_b128 v[132:135], v6 offset:2560
s_waitcnt vmcnt(0)
buffer_atomic_add v1, v0, s[24:27], s74 offen offset:0 sc1
ds_read_b128 v[136:139], v6 offset:1760
ds_read_b128 v[140:143], v6 offset:2528
ds_read_b128 v[144:147], v6 offset:1728
ds_read_b128 v[148:151], v6 offset:2496
ds_read_b128 v[152:155], v6 offset:1696
ds_read_b128 v[156:159], v6 offset:2464
ds_read_b128 v[160:163], v6 offset:1664
ds_read_b128 v[164:167], v6 offset:2432
ds_read_b128 v[168:171], v6 offset:1632
ds_read_b128 v[172:175], v6 offset:2400
ds_read_b128 v[176:179], v6 offset:1600
ds_read_b128 v[180:183], v6 offset:2368
ds_read_b128 v[184:187], v6 offset:1568
ds_read_b128 v[188:191], v6 offset:2336
s_lshr_b32 s52, s3, 1
s_lshl1_add_u32 s72, s85, s52
s_lshl2_add_u32 s75, s72, s84
s_lshl_b32 s75, s75, 8
s_add_u32 s75, s75, 75530240
s_and_b32 s82, s86, 1
s_lshl_b32 s82, s82, 13
s_lshr_b32 s53, s4, 3
s_mul_i32 s53, s53, 75776
s_add_u32 s53, s53, 54525952
s_and_b32 s52, s3, 1
s_lshl_b32 s52, s52, 10
s_add_u32 s52, s52, s53
s_sub_u32 s54, 63, s72
s_mul_i32 s77, s72, 303104
s_add_u32 s77, s77, s52
s_mul_i32 s81, s54, 303104
s_add_u32 s81, s81, s52
s_add_u32 s91, s91, 114688
s_sub_u32 s52, s91, 163840
s_cmp_ge_u32 s91, 163840
s_cselect_b32 s91, s52, s91
v_add_u32 v14, 4096, v15
v_add_u32 v7, s91, v4
s_waitcnt lgkmcnt(0)
s_barrier
s_mov_b32 m0, s70
s_mov_b32 s64, s68
s_add_u32 s68, s68, 16384
s_add_u32 s70, s70, 16384
s_cmp_ge_u32 s70, 163840
s_cselect_b32 s70, s80, s70
buffer_load_dwordx4 v15, s[24:27], s64 offen offset:0 sc1 lds
v_and_b32 v9, 0xffff, v97
v_and_b32 v11, 0xffff0000, v97
v_dot2_f32_bf16 v24, v98, v99, 0
v_dot2_f32_bf16 v25, v102, v99, 0
v_dot2_f32_bf16 v26, v106, v99, 0
v_dot2_f32_bf16 v27, v110, v99, 0
v_dot2_f32_bf16 v28, v114, v99, 0
v_dot2_f32_bf16 v29, v118, v99, 0
v_dot2_f32_bf16 v30, v122, v99, 0
v_dot2_f32_bf16 v31, v126, v99, 0
v_dot2c_f32_bf16 v24, v96, v9
buffer_load_dwordx4 v15, s[24:27], s64 offen offset:1024 sc1 lds
v_dot2c_f32_bf16 v25, v100, v9
v_dot2c_f32_bf16 v26, v104, v9
v_dot2c_f32_bf16 v27, v108, v9
v_dot2c_f32_bf16 v28, v112, v9
v_dot2c_f32_bf16 v29, v116, v9
v_dot2c_f32_bf16 v30, v120, v9
v_dot2c_f32_bf16 v31, v124, v9
v_dot2c_f32_bf16 v24, v16, v32
v_dot2c_f32_bf16 v25, v16, v40
v_dot2c_f32_bf16 v26, v16, v48
v_dot2c_f32_bf16 v27, v16, v56
buffer_load_dwordx4 v15, s[24:27], s64 offen offset:2048 sc1 lds
v_dot2c_f32_bf16 v28, v16, v64
v_dot2c_f32_bf16 v29, v16, v72
v_dot2c_f32_bf16 v30, v16, v80
v_dot2c_f32_bf16 v31, v16, v88
v_dot2c_f32_bf16 v24, v17, v33
v_dot2c_f32_bf16 v25, v17, v41
v_dot2c_f32_bf16 v26, v17, v49
v_dot2c_f32_bf16 v27, v17, v57
v_dot2c_f32_bf16 v28, v17, v65
v_dot2c_f32_bf16 v29, v17, v73
v_dot2c_f32_bf16 v30, v17, v81
buffer_load_dwordx4 v15, s[24:27], s64 offen offset:3072 sc1 lds
v_dot2c_f32_bf16 v31, v17, v89
v_dot2c_f32_bf16 v24, v18, v34
v_dot2c_f32_bf16 v25, v18, v42
v_dot2c_f32_bf16 v26, v18, v50
v_dot2c_f32_bf16 v27, v18, v58
v_dot2c_f32_bf16 v28, v18, v66
v_dot2c_f32_bf16 v29, v18, v74
v_dot2c_f32_bf16 v30, v18, v82
v_dot2c_f32_bf16 v31, v18, v90
v_dot2c_f32_bf16 v24, v19, v35
v_dot2c_f32_bf16 v25, v19, v43
s_mov_b32 m0, s70
s_mov_b32 s64, s68
s_add_u32 s68, s68, 16384
s_add_u32 s70, s70, 16384
s_cmp_ge_u32 s70, 163840
s_cselect_b32 s70, s80, s70
buffer_load_dwordx4 v15, s[24:27], s64 offen offset:0 sc1 lds
v_dot2c_f32_bf16 v26, v19, v51
v_dot2c_f32_bf16 v27, v19, v59
v_dot2c_f32_bf16 v28, v19, v67
v_dot2c_f32_bf16 v29, v19, v75
v_dot2c_f32_bf16 v30, v19, v83
v_dot2c_f32_bf16 v31, v19, v91
v_dot2c_f32_bf16 v24, v20, v36
v_dot2c_f32_bf16 v25, v20, v44
v_dot2c_f32_bf16 v26, v20, v52
v_dot2c_f32_bf16 v27, v20, v60
v_dot2c_f32_bf16 v28, v20, v68
buffer_load_dwordx4 v15, s[24:27], s64 offen offset:1024 sc1 lds
v_dot2c_f32_bf16 v29, v20, v76
v_dot2c_f32_bf16 v30, v20, v84
v_dot2c_f32_bf16 v31, v20, v92
v_dot2c_f32_bf16 v24, v21, v37
v_dot2c_f32_bf16 v25, v21, v45
v_dot2c_f32_bf16 v26, v21, v53
v_dot2c_f32_bf16 v27, v21, v61
v_dot2c_f32_bf16 v28, v21, v69
v_dot2c_f32_bf16 v29, v21, v77
v_dot2c_f32_bf16 v30, v21, v85
v_dot2c_f32_bf16 v31, v21, v93
buffer_load_dwordx4 v15, s[24:27], s64 offen offset:2048 sc1 lds
v_dot2c_f32_bf16 v24, v22, v38
v_dot2c_f32_bf16 v25, v22, v46
L_PAD10:
s_cbranch_execz L_MAIN
v_dot2c_f32_bf16 v26, v22, v54
v_dot2c_f32_bf16 v27, v22, v62
v_dot2c_f32_bf16 v28, v22, v70
v_dot2c_f32_bf16 v29, v22, v78
v_dot2c_f32_bf16 v30, v22, v86
v_dot2c_f32_bf16 v31, v22, v94
v_dot2c_f32_bf16 v24, v23, v39
v_dot2c_f32_bf16 v25, v23, v47
v_dot2c_f32_bf16 v26, v23, v55
buffer_load_dwordx4 v15, s[24:27], s64 offen offset:3072 sc1 lds
v_dot2c_f32_bf16 v27, v23, v63
v_dot2c_f32_bf16 v28, v23, v71
v_dot2c_f32_bf16 v29, v23, v79
v_dot2c_f32_bf16 v30, v23, v87
v_dot2c_f32_bf16 v31, v23, v95
v_mov_b32 v9, 0xf149f2ca
v_mul_f32 v11, 0xbfb8aa3b, v11
v_exp_f32 v11, v11
v_cmp_gt_u32 vcc, 2, v5
v_cmp_gt_u32 s[56:57], 4, v5
s_nop 0
s_mov_b32 m0, s70
s_mov_b32 s64, s68
s_add_u32 s68, s68, 16384
s_add_u32 s70, s70, 16384
s_cmp_ge_u32 s70, 163840
s_cselect_b32 s70, s80, s70
buffer_load_dwordx4 v15, s[24:27], s64 offen offset:0 sc1 lds
v_cndmask_b32 v25, v25, v9, vcc
v_cndmask_b32 v26, v26, v9, s[56:57]
v_cmp_gt_u32 vcc, 6, v5
v_cmp_gt_u32 s[56:57], 8, v5
s_nop 0
v_cndmask_b32 v27, v27, v9, vcc
v_cndmask_b32 v28, v28, v9, s[56:57]
v_cmp_gt_u32 vcc, 10, v5
v_cmp_gt_u32 s[56:57], 12, v5
s_nop 0
v_cndmask_b32 v29, v29, v9, vcc
buffer_load_dwordx4 v15, s[24:27], s64 offen offset:1024 sc1 lds
v_cndmask_b32 v30, v30, v9, s[56:57]
v_cmp_gt_u32 vcc, 14, v5
s_nop 0
s_nop 0
v_cndmask_b32 v31, v31, v9, vcc
v_max3_f32 v10, v24, v25, v26
v_max3_f32 v10, v10, v27, v28
v_max3_f32 v10, v10, v29, v30
v_max_f32 v10, v10, v31
s_mov_b32 s52, 0x3eae1a93
v_sub_f32 v24, v24, v10
buffer_load_dwordx4 v15, s[24:27], s64 offen offset:2048 sc1 lds
v_sub_f32 v25, v25, v10
v_sub_f32 v26, v26, v10
v_sub_f32 v27, v27, v10
v_sub_f32 v28, v28, v10
v_sub_f32 v29, v29, v10
v_sub_f32 v30, v30, v10
v_sub_f32 v31, v31, v10
v_mul_f32 v24, s52, v24
v_mul_f32 v25, s52, v25
v_mul_f32 v26, s52, v26
v_mul_f32 v27, s52, v27
buffer_load_dwordx4 v15, s[24:27], s64 offen offset:3072 sc1 lds
v_mul_f32 v28, s52, v28
v_mul_f32 v29, s52, v29
v_mul_f32 v30, s52, v30
v_mul_f32 v31, s52, v31
v_exp_f32 v24, v24
v_exp_f32 v25, v25
v_exp_f32 v26, v26
v_exp_f32 v27, v27
v_exp_f32 v28, v28
v_exp_f32 v29, v29
v_exp_f32 v30, v30
s_mov_b32 m0, s70
s_mov_b32 s64, s68
s_add_u32 s68, s68, 16384
s_add_u32 s70, s70, 16384
s_cmp_ge_u32 s70, 163840
s_cselect_b32 s70, s80, s70
buffer_load_dwordx4 v15, s[24:27], s64 offen offset:0 sc1 lds
v_exp_f32 v31, v31
v_cvt_pk_bf16_f32 v32, v24, 0
v_cvt_pk_bf16_f32 v40, v25, 0
v_cvt_pk_bf16_f32 v48, v26, 0
v_cvt_pk_bf16_f32 v56, v27, 0
v_cvt_pk_bf16_f32 v64, v28, 0
v_cvt_pk_bf16_f32 v72, v29, 0
v_cvt_pk_bf16_f32 v80, v30, 0
v_cvt_pk_bf16_f32 v88, v31, 0
v_lshlrev_b32 v33, 16, v32
v_lshlrev_b32 v41, 16, v40
buffer_load_dwordx4 v15, s[24:27], s64 offen offset:1024 sc1 lds
v_lshlrev_b32 v49, 16, v48
v_lshlrev_b32 v57, 16, v56
v_lshlrev_b32 v65, 16, v64
v_lshlrev_b32 v73, 16, v72
v_lshlrev_b32 v81, 16, v80
v_lshlrev_b32 v89, 16, v88
v_add_f32 v10, v33, v41
v_add_f32 v10, v10, v49
v_add_f32 v10, v10, v57
v_add_f32 v10, v10, v65
v_add_f32 v10, v10, v73
buffer_load_dwordx4 v15, s[24:27], s64 offen offset:2048 sc1 lds
v_add_f32 v10, v10, v81
v_add_f32 v10, v10, v89
v_fmac_f32 v10, v10, v11
v_rcp_f32 v10, v10
v_dot2_f32_bf16 v192, v128, v32, 0
v_dot2_f32_bf16 v193, v128, v33, 0
v_dot2_f32_bf16 v194, v129, v32, 0
v_dot2_f32_bf16 v195, v129, v33, 0
v_dot2_f32_bf16 v196, v130, v32, 0
v_dot2_f32_bf16 v197, v130, v33, 0
v_dot2_f32_bf16 v198, v131, v32, 0
buffer_load_dwordx4 v15, s[24:27], s64 offen offset:3072 sc1 lds
v_dot2_f32_bf16 v199, v131, v33, 0
v_dot2_f32_bf16 v200, v132, v32, 0
v_dot2_f32_bf16 v201, v132, v33, 0
v_dot2_f32_bf16 v202, v133, v32, 0
v_dot2_f32_bf16 v203, v133, v33, 0
v_dot2_f32_bf16 v204, v134, v32, 0
v_dot2_f32_bf16 v205, v134, v33, 0
v_dot2_f32_bf16 v206, v135, v32, 0
v_dot2_f32_bf16 v207, v135, v33, 0
v_dot2_f32_bf16 v208, v96, v33, 0
v_dot2_f32_bf16 v209, v98, v33, 0
buffer_load_dword v12, v13, s[24:27], s75 offen sc1
v_dot2c_f32_bf16 v192, v136, v40
v_dot2c_f32_bf16 v193, v136, v41
v_dot2c_f32_bf16 v194, v137, v40
v_dot2c_f32_bf16 v195, v137, v41
v_dot2c_f32_bf16 v196, v138, v40
v_dot2c_f32_bf16 v197, v138, v41
v_dot2c_f32_bf16 v198, v139, v40
v_dot2c_f32_bf16 v199, v139, v41
v_dot2c_f32_bf16 v200, v140, v40
v_dot2c_f32_bf16 v201, v140, v41
v_dot2c_f32_bf16 v202, v141, v40
s_mov_b32 m0, s70
s_mov_b32 s64, s68
s_add_u32 s68, s68, 16384
s_add_u32 s70, s70, 16384
s_cmp_ge_u32 s70, 163840
s_cselect_b32 s70, s80, s70
buffer_load_dwordx4 v15, s[24:27], s64 offen offset:0 sc1 lds
v_dot2c_f32_bf16 v203, v141, v41
v_dot2c_f32_bf16 v204, v142, v40
v_dot2c_f32_bf16 v205, v142, v41
v_dot2c_f32_bf16 v206, v143, v40
v_dot2c_f32_bf16 v207, v143, v41
v_dot2c_f32_bf16 v208, v100, v41
v_dot2c_f32_bf16 v209, v102, v41
v_dot2c_f32_bf16 v192, v144, v48
v_dot2c_f32_bf16 v193, v144, v49
v_dot2c_f32_bf16 v194, v145, v48
v_dot2c_f32_bf16 v195, v145, v49
buffer_load_dwordx4 v15, s[24:27], s64 offen offset:1024 sc1 lds
v_dot2c_f32_bf16 v196, v146, v48
v_dot2c_f32_bf16 v197, v146, v49
v_dot2c_f32_bf16 v198, v147, v48
v_dot2c_f32_bf16 v199, v147, v49
v_dot2c_f32_bf16 v200, v148, v48
v_dot2c_f32_bf16 v201, v148, v49
v_dot2c_f32_bf16 v202, v149, v48
v_dot2c_f32_bf16 v203, v149, v49
v_dot2c_f32_bf16 v204, v150, v48
v_dot2c_f32_bf16 v205, v150, v49
v_dot2c_f32_bf16 v206, v151, v48
buffer_load_dwordx4 v15, s[24:27], s64 offen offset:2048 sc1 lds
v_dot2c_f32_bf16 v207, v151, v49
v_dot2c_f32_bf16 v208, v104, v49
v_dot2c_f32_bf16 v209, v106, v49
v_dot2c_f32_bf16 v192, v152, v56
v_dot2c_f32_bf16 v193, v152, v57
v_dot2c_f32_bf16 v194, v153, v56
v_dot2c_f32_bf16 v195, v153, v57
v_dot2c_f32_bf16 v196, v154, v56
v_dot2c_f32_bf16 v197, v154, v57
v_dot2c_f32_bf16 v198, v155, v56
v_dot2c_f32_bf16 v199, v155, v57
buffer_load_dwordx4 v15, s[24:27], s64 offen offset:3072 sc1 lds
v_dot2c_f32_bf16 v200, v156, v56
v_dot2c_f32_bf16 v201, v156, v57
v_dot2c_f32_bf16 v202, v157, v56
v_dot2c_f32_bf16 v203, v157, v57
v_dot2c_f32_bf16 v204, v158, v56
v_dot2c_f32_bf16 v205, v158, v57
v_dot2c_f32_bf16 v206, v159, v56
v_dot2c_f32_bf16 v207, v159, v57
v_dot2c_f32_bf16 v208, v108, v57
v_dot2c_f32_bf16 v209, v110, v57
v_dot2c_f32_bf16 v192, v160, v64
s_waitcnt vmcnt(4)
v_cmp_gt_u32 s[96:97], 8, v12
s_nop 3
s_cmp_eq_u64 s[96:97], 0
s_cselect_b32 s78, s77, 2147418112
s_cselect_b32 s79, s81, 2147418112
s_xor_b32 s65, s82, 0
s_add_u32 s65, s65, s78
buffer_load_dwordx4 a[0:3], v15, s[24:27], s65 offen offset:0 sc1
v_dot2c_f32_bf16 v193, v160, v65
v_dot2c_f32_bf16 v194, v161, v64
v_dot2c_f32_bf16 v195, v161, v65
v_dot2c_f32_bf16 v196, v162, v64
v_dot2c_f32_bf16 v197, v162, v65
v_dot2c_f32_bf16 v198, v163, v64
v_dot2c_f32_bf16 v199, v163, v65
v_dot2c_f32_bf16 v200, v164, v64
v_dot2c_f32_bf16 v201, v164, v65
v_dot2c_f32_bf16 v202, v165, v64
v_dot2c_f32_bf16 v203, v165, v65
buffer_load_dwordx4 a[8:11], v15, s[24:27], s65 offen offset:2048 sc1
v_dot2c_f32_bf16 v204, v166, v64
v_dot2c_f32_bf16 v205, v166, v65
v_dot2c_f32_bf16 v206, v167, v64
v_dot2c_f32_bf16 v207, v167, v65
v_dot2c_f32_bf16 v208, v112, v65
v_dot2c_f32_bf16 v209, v114, v65
v_dot2c_f32_bf16 v192, v168, v72
v_dot2c_f32_bf16 v193, v168, v73
v_dot2c_f32_bf16 v194, v169, v72
v_dot2c_f32_bf16 v195, v169, v73
v_dot2c_f32_bf16 v196, v170, v72
s_xor_b32 s93, s82, 0
s_add_u32 s93, s93, s79
buffer_load_dwordx4 a[4:7], v15, s[24:27], s93 offen offset:0 sc1
v_dot2c_f32_bf16 v197, v170, v73
v_dot2c_f32_bf16 v198, v171, v72
v_dot2c_f32_bf16 v199, v171, v73
v_dot2c_f32_bf16 v200, v172, v72
v_dot2c_f32_bf16 v201, v172, v73
v_dot2c_f32_bf16 v202, v173, v72
v_dot2c_f32_bf16 v203, v173, v73
v_dot2c_f32_bf16 v204, v174, v72
v_dot2c_f32_bf16 v205, v174, v73
v_dot2c_f32_bf16 v206, v175, v72
v_dot2c_f32_bf16 v207, v175, v73
buffer_load_dwordx4 a[12:15], v15, s[24:27], s93 offen offset:2048 sc1
v_dot2c_f32_bf16 v208, v116, v73
v_dot2c_f32_bf16 v209, v118, v73
v_dot2c_f32_bf16 v192, v176, v80
v_dot2c_f32_bf16 v193, v176, v81
v_dot2c_f32_bf16 v194, v177, v80
v_dot2c_f32_bf16 v195, v177, v81
v_dot2c_f32_bf16 v196, v178, v80
v_dot2c_f32_bf16 v197, v178, v81
v_dot2c_f32_bf16 v198, v179, v80
v_dot2c_f32_bf16 v199, v179, v81
v_dot2c_f32_bf16 v200, v180, v80
buffer_load_dwordx4 a[16:19], v14, s[24:27], s65 offen offset:0 sc1
v_dot2c_f32_bf16 v201, v180, v81
v_dot2c_f32_bf16 v202, v181, v80
v_dot2c_f32_bf16 v203, v181, v81
v_dot2c_f32_bf16 v204, v182, v80
v_dot2c_f32_bf16 v205, v182, v81
v_dot2c_f32_bf16 v206, v183, v80
v_dot2c_f32_bf16 v207, v183, v81
v_dot2c_f32_bf16 v208, v120, v81
v_dot2c_f32_bf16 v209, v122, v81
v_dot2c_f32_bf16 v192, v184, v88
v_dot2c_f32_bf16 v193, v184, v89
buffer_load_dwordx4 a[24:27], v14, s[24:27], s65 offen offset:2048 sc1
v_dot2c_f32_bf16 v194, v185, v88
v_dot2c_f32_bf16 v195, v185, v89
v_dot2c_f32_bf16 v196, v186, v88
v_dot2c_f32_bf16 v197, v186, v89
v_dot2c_f32_bf16 v198, v187, v88
v_dot2c_f32_bf16 v199, v187, v89
v_dot2c_f32_bf16 v200, v188, v88
v_dot2c_f32_bf16 v201, v188, v89
v_dot2c_f32_bf16 v202, v189, v88
v_dot2c_f32_bf16 v203, v189, v89
v_dot2c_f32_bf16 v204, v190, v88
buffer_load_dwordx4 a[20:23], v14, s[24:27], s93 offen offset:0 sc1
v_dot2c_f32_bf16 v205, v190, v89
v_dot2c_f32_bf16 v206, v191, v88
v_dot2c_f32_bf16 v207, v191, v89
v_dot2c_f32_bf16 v208, v124, v89
v_dot2c_f32_bf16 v209, v126, v89
v_lshrrev_b32 v9, 5, v5
v_mul_u32_u24 v9, 303104, v9
v_and_b32 v11, 1, v3
v_lshl_add_u32 v9, v11, 10, v9
v_lshl_add_u32 v9, v2, 4, v9
v_lshrrev_b32 v11, 3, v2
buffer_load_dwordx4 a[28:31], v14, s[24:27], s93 offen offset:2048 sc1
s_bitcmp0_b32 s4, 0
s_cselect_b32 s52, 100663168, 0
v_mul_lo_u32 v6, v11, s52
v_add_u32 v6, v6, v9
s_bitcmp1_b32 s4, 2
s_cselect_b32 s52, 100663168, 0
v_mul_lo_u32 v11, v11, s52
v_add_u32 v11, v11, v9
v_mul_f32 v192, v10, v192
v_mul_f32 v193, v10, v193
v_mul_f32 v194, v10, v194
v_mul_f32 v195, v10, v195
v_mul_f32 v196, v10, v196
buffer_load_dword v12, v13, s[24:27], s75 offen sc1
v_mul_f32 v197, v10, v197
v_mul_f32 v198, v10, v198
v_mul_f32 v199, v10, v199
v_mul_f32 v200, v10, v200
v_mul_f32 v201, v10, v201
v_mul_f32 v202, v10, v202
v_mul_f32 v203, v10, v203
v_mul_f32 v204, v10, v204
v_mul_f32 v205, v10, v205
v_mul_f32 v206, v10, v206
v_mul_f32 v207, v10, v207
v_mul_f32 v208, v10, v208
v_mul_f32 v209, v10, v209
v_cvt_pk_bf16_f32 v192, v192, v193
v_cvt_pk_bf16_f32 v193, v194, v195
v_cvt_pk_bf16_f32 v194, v196, v197
v_cvt_pk_bf16_f32 v195, v198, v199
v_cvt_pk_bf16_f32 v196, v200, v201
v_cvt_pk_bf16_f32 v197, v202, v203
v_cvt_pk_bf16_f32 v198, v204, v205
v_cvt_pk_bf16_f32 v199, v206, v207
v_cvt_pk_bf16_f32 v200, v208, v209
s_add_u32 s53, s53, 65536
s_bfe_u32 s54, s4, 131073
s_lshl_b32 s54, s54, 11
s_add_u32 s54, s54, s53
s_and_b32 s55, s4, 1
s_lshl_b32 s55, s55, 9
s_add_u32 s54, s54, s55
s_lshl2_add_u32 s52, s85, s86
s_lshl2_add_u32 s52, s52, s3
s_mul_i32 s69, s52, 28672
s_add_u32 s69, s69, 76546048
s_mul_i32 s73, s52, 640
s_add_u32 s73, s73, 75563008
ds_read_b128 v[144:147], v7 offset:0
ds_read_b128 v[148:151], v7 offset:1024
ds_read_b128 v[152:155], v7 offset:2048
ds_read_b128 v[156:159], v7 offset:3072
ds_read_b128 v[160:163], v7 offset:4096
ds_read_b128 v[164:167], v7 offset:5120
ds_read_b128 v[168:171], v7 offset:6144
ds_read_b128 v[172:175], v7 offset:7168
v_mov_b32 v10, 0
s_mov_b32 s92, 0
s_cmp_eq_u32 s78, s77
s_cbranch_scc1 L_ZBX
s_branch L_ZB1
L_ZB:
s_sleep 2
buffer_load_dword v12, v13, s[24:27], s75 offen sc1
L_ZB1:
s_add_u32 s92, s92, 1
s_waitcnt vmcnt(0)
v_cmp_gt_u32 vcc, 8, v12
s_cmp_gt_u32 s92, 1048576
s_cbranch_scc1 L_ZBY
s_nop 2
s_cbranch_vccnz L_ZB
L_ZBY:
s_xor_b32 s65, s82, 0
s_add_u32 s65, s65, s77
buffer_load_dwordx4 a[0:3], v15, s[24:27], s65 offen offset:0 sc1
buffer_load_dwordx4 a[8:11], v15, s[24:27], s65 offen offset:2048 sc1
s_xor_b32 s93, s82, 0
s_add_u32 s93, s93, s81
buffer_load_dwordx4 a[4:7], v15, s[24:27], s93 offen offset:0 sc1
buffer_load_dwordx4 a[12:15], v15, s[24:27], s93 offen offset:2048 sc1
buffer_load_dwordx4 a[16:19], v14, s[24:27], s65 offen offset:0 sc1
buffer_load_dwordx4 a[24:27], v14, s[24:27], s65 offen offset:2048 sc1
buffer_load_dwordx4 a[20:23], v14, s[24:27], s93 offen offset:0 sc1
buffer_load_dwordx4 a[28:31], v14, s[24:27], s93 offen offset:2048 sc1
L_ZBX:
buffer_store_dwordx4 v[192:195], v9, s[24:27], s54 offen sc1
buffer_store_dwordx4 v[196:199], v6, s[24:27], s54 offen offset:256 sc1
s_bfe_u32 s55, s4, 65538
s_lshl_b32 s55, s55, 8
s_add_u32 s54, s53, s55
s_and_b32 s55, s4, 3
s_lshl2_add_u32 s54, s55, s54
s_add_u32 s54, s54, 8192
buffer_store_dword v200, v11, s[24:27], s54 offen sc1
s_waitcnt vmcnt(9) lgkmcnt(6)
v_mfma_f32_16x16x32_bf16 v[120:123], v[144:147], a[0:3], 0
s_waitcnt vmcnt(7)
s_add_u32 s91, s91, 16384
ds_read_b128 v[176:179], v7 offset:8192
v_mfma_f32_16x16x32_bf16 v[120:123], v[148:151], a[8:11], v[120:123]
s_xor_b32 s65, s82, 8192
s_add_u32 s65, s65, s77
ds_read_b128 v[180:183], v7 offset:9216
v_mfma_f32_16x16x32_bf16 v[124:127], v[148:151], a[12:15], 0
s_waitcnt lgkmcnt(6)
ds_read_b128 v[184:187], v7 offset:10240
v_mfma_f32_16x16x32_bf16 v[124:127], v[144:147], a[4:7], v[124:127]
buffer_load_dwordx4 a[32:35], v15, s[24:27], s65 offen offset:0 sc1
v_mfma_f32_16x16x32_bf16 v[72:75], v[152:155], a[0:3], 0
s_cmp_ge_u32 s91, 163840
s_cselect_b32 s91, 0, s91
ds_read_b128 v[188:191], v7 offset:11264
v_mfma_f32_16x16x32_bf16 v[72:75], v[156:159], a[8:11], v[72:75]
s_waitcnt lgkmcnt(6)
v_add_u32 v8, s91, v4
v_mfma_f32_16x16x32_bf16 v[76:79], v[156:159], a[12:15], 0
buffer_load_dwordx4 a[40:43], v15, s[24:27], s65 offen offset:2048 sc1
v_mfma_f32_16x16x32_bf16 v[76:79], v[152:155], a[4:7], v[76:79]
s_xor_b32 s93, s82, 8192
s_add_u32 s93, s93, s81
ds_read_b128 v[144:147], v7 offset:12288
v_mfma_f32_16x16x32_bf16 v[80:83], v[160:163], a[0:3], 0
ds_read_b128 v[148:151], v7 offset:13312
v_mfma_f32_16x16x32_bf16 v[80:83], v[164:167], a[8:11], v[80:83]
buffer_load_dwordx4 a[36:39], v15, s[24:27], s93 offen offset:0 sc1
v_mfma_f32_16x16x32_bf16 v[84:87], v[164:167], a[12:15], 0
ds_read_b128 v[152:155], v7 offset:14336
v_mfma_f32_16x16x32_bf16 v[84:87], v[160:163], a[4:7], v[84:87]
s_waitcnt lgkmcnt(7)
v_mfma_f32_16x16x32_bf16 v[88:91], v[168:171], a[0:3], 0
buffer_load_dwordx4 a[44:47], v15, s[24:27], s93 offen offset:2048 sc1
v_mfma_f32_16x16x32_bf16 v[88:91], v[172:175], a[8:11], v[88:91]
ds_read_b128 v[156:159], v7 offset:15360
v_mfma_f32_16x16x32_bf16 v[92:95], v[172:175], a[12:15], 0
s_waitcnt lgkmcnt(6)
s_add_u32 s91, s91, 16384
ds_read_b128 v[160:163], v8 offset:0
v_mfma_f32_16x16x32_bf16 v[92:95], v[168:171], a[4:7], v[92:95]
buffer_load_dwordx4 a[48:51], v14, s[24:27], s65 offen offset:0 sc1
v_mfma_f32_16x16x32_bf16 v[96:99], v[176:179], a[0:3], 0
s_cmp_ge_u32 s91, 163840
s_cselect_b32 s91, 0, s91
ds_read_b128 v[164:167], v8 offset:1024
v_mfma_f32_16x16x32_bf16 v[96:99], v[180:183], a[8:11], v[96:99]
v_add_u32 v7, s91, v4
v_mfma_f32_16x16x32_bf16 v[100:103], v[180:183], a[12:15], 0
buffer_load_dwordx4 a[56:59], v14, s[24:27], s65 offen offset:2048 sc1
v_mfma_f32_16x16x32_bf16 v[100:103], v[176:179], a[4:7], v[100:103]
s_waitcnt lgkmcnt(6)
ds_read_b128 v[168:171], v8 offset:2048
v_mfma_f32_16x16x32_bf16 v[104:107], v[184:187], a[0:3], 0
ds_read_b128 v[172:175], v8 offset:3072
v_mfma_f32_16x16x32_bf16 v[104:107], v[188:191], a[8:11], v[104:107]
v_mfma_f32_16x16x32_bf16 v[108:111], v[188:191], a[12:15], 0
buffer_load_dwordx4 a[52:55], v14, s[24:27], s93 offen offset:0 sc1
v_mfma_f32_16x16x32_bf16 v[108:111], v[184:187], a[4:7], v[108:111]
s_waitcnt lgkmcnt(6)
ds_read_b128 v[176:179], v8 offset:4096
v_mfma_f32_16x16x32_bf16 v[112:115], v[144:147], a[0:3], 0
ds_read_b128 v[180:183], v8 offset:5120
v_mfma_f32_16x16x32_bf16 v[112:115], v[148:151], a[8:11], v[112:115]
v_mfma_f32_16x16x32_bf16 v[116:119], v[148:151], a[12:15], 0
buffer_load_dwordx4 a[60:63], v14, s[24:27], s93 offen offset:2048 sc1
v_mfma_f32_16x16x32_bf16 v[116:119], v[144:147], a[4:7], v[116:119]
s_waitcnt lgkmcnt(6) vmcnt(13)
ds_read_b128 v[184:187], v8 offset:6144
v_mfma_f32_16x16x32_bf16 v[120:123], v[152:155], a[16:19], v[120:123]
ds_read_b128 v[188:191], v8 offset:7168
v_mfma_f32_16x16x32_bf16 v[120:123], v[156:159], a[24:27], v[120:123]
s_waitcnt vmcnt(11)
v_mfma_f32_16x16x32_bf16 v[124:127], v[156:159], a[28:31], v[124:127]
ds_read_b128 v[144:147], v8 offset:8192
v_mfma_f32_16x16x32_bf16 v[124:127], v[152:155], a[20:23], v[124:127]
s_waitcnt lgkmcnt(7)
v_mfma_f32_16x16x32_bf16 v[72:75], v[160:163], a[16:19], v[72:75]
ds_read_b128 v[148:151], v8 offset:9216
v_mfma_f32_16x16x32_bf16 v[72:75], v[164:167], a[24:27], v[72:75]
v_mfma_f32_16x16x32_bf16 v[76:79], v[164:167], a[28:31], v[76:79]
ds_read_b128 v[152:155], v8 offset:10240
v_mfma_f32_16x16x32_bf16 v[76:79], v[160:163], a[20:23], v[76:79]
s_waitcnt lgkmcnt(7)
v_mfma_f32_16x16x32_bf16 v[80:83], v[168:171], a[16:19], v[80:83]
ds_read_b128 v[156:159], v8 offset:11264
v_mfma_f32_16x16x32_bf16 v[80:83], v[172:175], a[24:27], v[80:83]
v_mfma_f32_16x16x32_bf16 v[84:87], v[172:175], a[28:31], v[84:87]
ds_read_b128 v[160:163], v8 offset:12288
v_mfma_f32_16x16x32_bf16 v[84:87], v[168:171], a[20:23], v[84:87]
s_waitcnt lgkmcnt(7)
v_mfma_f32_16x16x32_bf16 v[88:91], v[176:179], a[16:19], v[88:91]
s_xor_b32 s65, s82, 16384
s_add_u32 s65, s65, s77
ds_read_b128 v[164:167], v8 offset:13312
v_mfma_f32_16x16x32_bf16 v[88:91], v[180:183], a[24:27], v[88:91]
v_mfma_f32_16x16x32_bf16 v[92:95], v[180:183], a[28:31], v[92:95]
s_waitcnt lgkmcnt(6)
ds_read_b128 v[168:171], v8 offset:14336
v_add_u32 v11, s70, v4
v_mfma_f32_16x16x32_bf16 v[92:95], v[176:179], a[20:23], v[92:95]
s_add_u32 s70, s70, 16384
s_cmp_ge_u32 s70, 163840
s_cselect_b32 s70, s80, s70
v_mfma_f32_16x16x32_bf16 v[96:99], v[184:187], a[16:19], v[96:99]
buffer_load_dwordx4 a[64:67], v15, s[24:27], s65 offen offset:0 sc1
v_mfma_f32_16x16x32_bf16 v[96:99], v[188:191], a[24:27], v[96:99]
s_barrier
v_mfma_f32_16x16x32_bf16 v[100:103], v[188:191], a[28:31], v[100:103]
s_waitcnt lgkmcnt(5)
ds_read_b128 v[172:175], v8 offset:15360
v_mfma_f32_16x16x32_bf16 v[100:103], v[184:187], a[20:23], v[100:103]
buffer_load_dwordx4 a[72:75], v15, s[24:27], s65 offen offset:2048 sc1
v_mfma_f32_16x16x32_bf16 v[104:107], v[144:147], a[16:19], v[104:107]
ds_write_b64 v11, a[96:97] offset:0
v_mfma_f32_16x16x32_bf16 v[104:107], v[148:151], a[24:27], v[104:107]
s_xor_b32 s93, s82, 16384
s_add_u32 s93, s93, s81
ds_read_b128 v[176:179], v7 offset:0
v_mfma_f32_16x16x32_bf16 v[108:111], v[148:151], a[28:31], v[108:111]
buffer_load_dwordx4 a[68:71], v15, s[24:27], s93 offen offset:0 sc1
v_mfma_f32_16x16x32_bf16 v[108:111], v[144:147], a[20:23], v[108:111]
s_waitcnt lgkmcnt(6)
s_add_u32 s91, s91, 16384
ds_read_b128 v[180:183], v7 offset:1024
v_mfma_f32_16x16x32_bf16 v[112:115], v[152:155], a[16:19], v[112:115]
ds_write_b64 v11, a[98:99] offset:8
v_mfma_f32_16x16x32_bf16 v[112:115], v[156:159], a[24:27], v[112:115]
s_cmp_ge_u32 s91, 163840
s_cselect_b32 s91, 0, s91
ds_read_b128 v[184:187], v7 offset:2048
v_mfma_f32_16x16x32_bf16 v[116:119], v[156:159], a[28:31], v[116:119]
buffer_load_dwordx4 a[76:79], v15, s[24:27], s93 offen offset:2048 sc1
v_mfma_f32_16x16x32_bf16 v[116:119], v[152:155], a[20:23], v[116:119]
s_waitcnt lgkmcnt(7) vmcnt(10)
ds_read_b128 v[188:191], v7 offset:3072
v_add_u32 v8, s91, v4
v_mfma_f32_16x16x32_bf16 v[120:123], v[160:163], a[32:35], v[120:123]
s_waitcnt vmcnt(12)
s_waitcnt vmcnt(8)
ds_read_b128 v[144:147], v7 offset:4096
v_mfma_f32_16x16x32_bf16 v[120:123], v[164:167], a[40:43], v[120:123]
buffer_atomic_add v1, v0, s[24:27], s74 offen offset:128 sc1
v_mfma_f32_16x16x32_bf16 v[124:127], v[164:167], a[44:47], v[124:127]
ds_write_b64 v11, a[100:101] offset:1024
v_mfma_f32_16x16x32_bf16 v[124:127], v[160:163], a[36:39], v[124:127]
s_waitcnt lgkmcnt(8)
ds_read_b128 v[148:151], v7 offset:5120
v_mfma_f32_16x16x32_bf16 v[72:75], v[168:171], a[32:35], v[72:75]
ds_read_b128 v[152:155], v7 offset:6144
v_mfma_f32_16x16x32_bf16 v[72:75], v[172:175], a[40:43], v[72:75]
s_waitcnt lgkmcnt(7)
ds_read_b128 v[156:159], v7 offset:7168
v_mfma_f32_16x16x32_bf16 v[76:79], v[172:175], a[44:47], v[76:79]
ds_write_b64 v11, a[102:103] offset:1032
v_mfma_f32_16x16x32_bf16 v[76:79], v[168:171], a[36:39], v[76:79]
buffer_load_dwordx4 a[80:83], v14, s[24:27], s65 offen offset:0 sc1
v_mfma_f32_16x16x32_bf16 v[80:83], v[176:179], a[32:35], v[80:83]
ds_read_b128 v[160:163], v7 offset:8192
v_mfma_f32_16x16x32_bf16 v[80:83], v[180:183], a[40:43], v[80:83]
s_waitcnt lgkmcnt(7)
ds_read_b128 v[164:167], v7 offset:9216
v_mfma_f32_16x16x32_bf16 v[84:87], v[180:183], a[44:47], v[84:87]
ds_write_b64 v11, a[104:105] offset:2048
v_mfma_f32_16x16x32_bf16 v[84:87], v[176:179], a[36:39], v[84:87]
buffer_load_dwordx4 a[88:91], v14, s[24:27], s65 offen offset:2048 sc1
v_mfma_f32_16x16x32_bf16 v[88:91], v[184:187], a[32:35], v[88:91]
ds_read_b128 v[168:171], v7 offset:10240
v_mfma_f32_16x16x32_bf16 v[88:91], v[188:191], a[40:43], v[88:91]
s_waitcnt lgkmcnt(7)
ds_read_b128 v[172:175], v7 offset:11264
v_mfma_f32_16x16x32_bf16 v[92:95], v[188:191], a[44:47], v[92:95]
ds_write_b64 v11, a[106:107] offset:2056
v_mfma_f32_16x16x32_bf16 v[92:95], v[184:187], a[36:39], v[92:95]
buffer_load_dwordx4 a[84:87], v14, s[24:27], s93 offen offset:0 sc1
v_mfma_f32_16x16x32_bf16 v[96:99], v[144:147], a[32:35], v[96:99]
ds_read_b128 v[176:179], v7 offset:12288
v_mfma_f32_16x16x32_bf16 v[96:99], v[148:151], a[40:43], v[96:99]
s_waitcnt lgkmcnt(8)
ds_read_b128 v[180:183], v7 offset:13312
v_mfma_f32_16x16x32_bf16 v[100:103], v[148:151], a[44:47], v[100:103]
ds_write_b64 v11, a[108:109] offset:3072
v_mfma_f32_16x16x32_bf16 v[100:103], v[144:147], a[36:39], v[100:103]
buffer_load_dwordx4 a[92:95], v14, s[24:27], s93 offen offset:2048 sc1
v_mfma_f32_16x16x32_bf16 v[104:107], v[152:155], a[32:35], v[104:107]
ds_read_b128 v[184:187], v7 offset:14336
v_mfma_f32_16x16x32_bf16 v[104:107], v[156:159], a[40:43], v[104:107]
ds_read_b128 v[188:191], v7 offset:15360
v_mfma_f32_16x16x32_bf16 v[108:111], v[156:159], a[44:47], v[108:111]
ds_write_b64 v11, a[110:111] offset:3080
v_mfma_f32_16x16x32_bf16 v[108:111], v[152:155], a[36:39], v[108:111]
s_waitcnt lgkmcnt(10)
s_add_u32 s91, s91, 16384
ds_read_b128 v[144:147], v8 offset:0
v_mfma_f32_16x16x32_bf16 v[112:115], v[160:163], a[32:35], v[112:115]
s_xor_b32 s65, s82, 24576
s_add_u32 s65, s65, s77
ds_read_b128 v[148:151], v8 offset:1024
v_mfma_f32_16x16x32_bf16 v[112:115], v[164:167], a[40:43], v[112:115]
s_cmp_ge_u32 s91, 163840
s_cselect_b32 s91, 0, s91
v_add_u32 v7, s91, v4
v_mfma_f32_16x16x32_bf16 v[116:119], v[164:167], a[44:47], v[116:119]
buffer_load_dwordx4 a[192:195], v15, s[24:27], s65 offen offset:0 sc1
v_mfma_f32_16x16x32_bf16 v[116:119], v[160:163], a[36:39], v[116:119]
s_waitcnt lgkmcnt(9) vmcnt(12)
ds_read_b128 v[152:155], v8 offset:2048
v_mfma_f32_16x16x32_bf16 v[120:123], v[168:171], a[48:51], v[120:123]
ds_read_b128 v[156:159], v8 offset:3072
v_mfma_f32_16x16x32_bf16 v[120:123], v[172:175], a[56:59], v[120:123]
s_waitcnt vmcnt(10)
v_mfma_f32_16x16x32_bf16 v[124:127], v[172:175], a[60:63], v[124:127]
buffer_load_dwordx4 a[200:203], v15, s[24:27], s65 offen offset:2048 sc1
v_mfma_f32_16x16x32_bf16 v[124:127], v[168:171], a[52:55], v[124:127]
s_waitcnt lgkmcnt(8)
ds_read_b128 v[160:163], v8 offset:4096
v_mfma_f32_16x16x32_bf16 v[72:75], v[176:179], a[48:51], v[72:75]
s_xor_b32 s93, s82, 24576
s_add_u32 s93, s93, s81
ds_read_b128 v[164:167], v8 offset:5120
v_mfma_f32_16x16x32_bf16 v[72:75], v[180:183], a[56:59], v[72:75]
v_mfma_f32_16x16x32_bf16 v[76:79], v[180:183], a[60:63], v[76:79]
buffer_load_dwordx4 a[196:199], v15, s[24:27], s93 offen offset:0 sc1
v_mfma_f32_16x16x32_bf16 v[76:79], v[176:179], a[52:55], v[76:79]
s_waitcnt lgkmcnt(7)
ds_read_b128 v[168:171], v8 offset:6144
v_mfma_f32_16x16x32_bf16 v[80:83], v[184:187], a[48:51], v[80:83]
ds_read_b128 v[172:175], v8 offset:7168
v_mfma_f32_16x16x32_bf16 v[80:83], v[188:191], a[56:59], v[80:83]
v_mfma_f32_16x16x32_bf16 v[84:87], v[188:191], a[60:63], v[84:87]
buffer_load_dwordx4 a[204:207], v15, s[24:27], s93 offen offset:2048 sc1
v_mfma_f32_16x16x32_bf16 v[84:87], v[184:187], a[52:55], v[84:87]
s_waitcnt lgkmcnt(6)
ds_read_b128 v[176:179], v8 offset:8192
v_mfma_f32_16x16x32_bf16 v[88:91], v[144:147], a[48:51], v[88:91]
ds_read_b128 v[180:183], v8 offset:9216
v_mfma_f32_16x16x32_bf16 v[88:91], v[148:151], a[56:59], v[88:91]
v_mfma_f32_16x16x32_bf16 v[92:95], v[148:151], a[60:63], v[92:95]
ds_read_b128 v[184:187], v8 offset:10240
v_mfma_f32_16x16x32_bf16 v[92:95], v[144:147], a[52:55], v[92:95]
s_waitcnt lgkmcnt(7)
v_mfma_f32_16x16x32_bf16 v[96:99], v[152:155], a[48:51], v[96:99]
s_add_u32 s52, s84, 1
ds_read_b128 v[188:191], v8 offset:11264
v_mfma_f32_16x16x32_bf16 v[96:99], v[156:159], a[56:59], v[96:99]
v_mfma_f32_16x16x32_bf16 v[100:103], v[156:159], a[60:63], v[100:103]
buffer_load_dwordx4 a[208:211], v14, s[24:27], s65 offen offset:0 sc1
v_mfma_f32_16x16x32_bf16 v[100:103], v[152:155], a[52:55], v[100:103]
s_and_b32 s52, s52, 3
s_waitcnt lgkmcnt(6)
ds_read_b128 v[144:147], v8 offset:12288
v_mfma_f32_16x16x32_bf16 v[104:107], v[160:163], a[48:51], v[104:107]
ds_read_b128 v[148:151], v8 offset:13312
v_mfma_f32_16x16x32_bf16 v[104:107], v[164:167], a[56:59], v[104:107]
s_waitcnt lgkmcnt(6)
v_mfma_f32_16x16x32_bf16 v[108:111], v[164:167], a[60:63], v[108:111]
s_mul_i32 s52, s52, 6144
ds_read_b128 v[152:155], v8 offset:14336
v_add_u32 v11, s70, v4
v_mfma_f32_16x16x32_bf16 v[108:111], v[160:163], a[52:55], v[108:111]
s_add_u32 s70, s70, 16384
s_cmp_ge_u32 s70, 163840
s_cselect_b32 s70, s80, s70
v_mfma_f32_16x16x32_bf16 v[112:115], v[168:171], a[48:51], v[112:115]
s_waitcnt vmcnt(51)
ds_read_b128 v[156:159], v8 offset:15360
v_mfma_f32_16x16x32_bf16 v[112:115], v[172:175], a[56:59], v[112:115]
s_barrier
v_mfma_f32_16x16x32_bf16 v[116:119], v[172:175], a[60:63], v[116:119]
s_add_u32 s52, s52, s69
s_waitcnt lgkmcnt(6) vmcnt(12)
ds_read_b128 v[160:163], v7 offset:0
v_mfma_f32_16x16x32_bf16 v[116:119], v[168:171], a[52:55], v[116:119]
buffer_load_dwordx4 a[216:219], v14, s[24:27], s65 offen offset:2048 sc1
v_mfma_f32_16x16x32_bf16 v[120:123], v[176:179], a[64:67], v[120:123]
ds_write_b64 v11, a[112:113] offset:0
v_mfma_f32_16x16x32_bf16 v[120:123], v[180:183], a[72:75], v[120:123]
s_add_u32 s52, s52, 0
s_waitcnt vmcnt(11)
ds_read_b128 v[164:167], v7 offset:1024
v_mfma_f32_16x16x32_bf16 v[124:127], v[180:183], a[76:79], v[124:127]
buffer_load_dwordx4 a[212:215], v14, s[24:27], s93 offen offset:0 sc1
v_mfma_f32_16x16x32_bf16 v[124:127], v[176:179], a[68:71], v[124:127]
s_waitcnt lgkmcnt(7)
s_add_u32 s91, s91, 16384
ds_read_b128 v[168:171], v7 offset:2048
v_mfma_f32_16x16x32_bf16 v[72:75], v[184:187], a[64:67], v[72:75]
s_add_u32 s53, s84, 2
ds_read_b128 v[172:175], v7 offset:3072
v_mfma_f32_16x16x32_bf16 v[72:75], v[188:191], a[72:75], v[72:75]
L_PAD11:
s_cbranch_execz L_MAIN
ds_write_b64 v11, a[114:115] offset:8
v_mfma_f32_16x16x32_bf16 v[76:79], v[188:191], a[76:79], v[76:79]
buffer_load_dwordx4 a[220:223], v14, s[24:27], s93 offen offset:2048 sc1
v_mfma_f32_16x16x32_bf16 v[76:79], v[184:187], a[68:71], v[76:79]
s_and_b32 s53, s53, 3
s_waitcnt lgkmcnt(8)
ds_read_b128 v[176:179], v7 offset:4096
v_mfma_f32_16x16x32_bf16 v[80:83], v[144:147], a[64:67], v[80:83]
s_xor_b32 s65, s82, 32768
s_add_u32 s65, s65, s77
ds_read_b128 v[180:183], v7 offset:5120
v_mfma_f32_16x16x32_bf16 v[80:83], v[148:151], a[72:75], v[80:83]
ds_write_b64 v11, a[116:117] offset:1024
v_mfma_f32_16x16x32_bf16 v[84:87], v[148:151], a[76:79], v[84:87]
s_mul_i32 s53, s53, 6144
s_waitcnt lgkmcnt(9)
ds_read_b128 v[184:187], v7 offset:6144
v_mfma_f32_16x16x32_bf16 v[84:87], v[144:147], a[68:71], v[84:87]
buffer_load_dwordx4 a[224:227], v15, s[24:27], s65 offen offset:0 sc1
v_mfma_f32_16x16x32_bf16 v[88:91], v[152:155], a[64:67], v[88:91]
s_cmp_ge_u32 s91, 163840
s_cselect_b32 s91, 0, s91
ds_read_b128 v[188:191], v7 offset:7168
v_mfma_f32_16x16x32_bf16 v[88:91], v[156:159], a[72:75], v[88:91]
s_add_u32 s53, s53, s69
s_waitcnt lgkmcnt(8)
v_add_u32 v8, s91, v4
v_mfma_f32_16x16x32_bf16 v[92:95], v[156:159], a[76:79], v[92:95]
ds_write_b64 v11, a[118:119] offset:1032
v_mfma_f32_16x16x32_bf16 v[92:95], v[152:155], a[68:71], v[92:95]
buffer_load_dwordx4 a[232:235], v15, s[24:27], s65 offen offset:2048 sc1
v_mfma_f32_16x16x32_bf16 v[96:99], v[160:163], a[64:67], v[96:99]
s_add_u32 s53, s53, 2048
s_xor_b32 s93, s82, 32768
s_add_u32 s93, s93, s81
v_mfma_f32_16x16x32_bf16 v[96:99], v[164:167], a[72:75], v[96:99]
ds_read_b128 v[144:147], v7 offset:8192
v_mfma_f32_16x16x32_bf16 v[100:103], v[164:167], a[76:79], v[100:103]
ds_write_b64 v11, a[120:121] offset:2048
v_mfma_f32_16x16x32_bf16 v[100:103], v[160:163], a[68:71], v[100:103]
s_add_u32 s54, s84, 3
s_waitcnt lgkmcnt(9) vmcnt(12)
ds_read_b128 v[148:151], v7 offset:9216
v_mfma_f32_16x16x32_bf16 v[120:123], v[168:171], a[80:83], v[120:123]
buffer_load_dwordx4 a[228:231], v15, s[24:27], s93 offen offset:0 sc1
v_mfma_f32_16x16x32_bf16 v[120:123], v[172:175], a[88:91], v[120:123]
s_waitcnt vmcnt(11)
ds_read_b128 v[152:155], v7 offset:10240
v_mfma_f32_16x16x32_bf16 v[124:127], v[172:175], a[92:95], v[124:127]
s_and_b32 s54, s54, 3
s_waitcnt lgkmcnt(8)
ds_read_b128 v[156:159], v7 offset:11264
v_mfma_f32_16x16x32_bf16 v[124:127], v[168:171], a[84:87], v[124:127]
ds_write_b64 v11, a[122:123] offset:2056
v_mfma_f32_16x16x32_bf16 v[72:75], v[176:179], a[80:83], v[72:75]
buffer_load_dwordx4 a[236:239], v15, s[24:27], s93 offen offset:2048 sc1
v_mfma_f32_16x16x32_bf16 v[72:75], v[180:183], a[88:91], v[72:75]
s_mul_i32 s54, s54, 6144
ds_read_b128 v[160:163], v7 offset:12288
v_mfma_f32_16x16x32_bf16 v[76:79], v[180:183], a[92:95], v[76:79]
s_waitcnt lgkmcnt(8)
ds_read_b128 v[164:167], v7 offset:13312
v_mfma_f32_16x16x32_bf16 v[76:79], v[176:179], a[84:87], v[76:79]
ds_write_b64 v11, a[124:125] offset:3072
v_mfma_f32_16x16x32_bf16 v[80:83], v[184:187], a[80:83], v[80:83]
s_add_u32 s54, s54, s69
ds_read_b128 v[168:171], v7 offset:14336
v_mfma_f32_16x16x32_bf16 v[80:83], v[188:191], a[88:91], v[80:83]
ds_read_b128 v[172:175], v7 offset:15360
v_mfma_f32_16x16x32_bf16 v[84:87], v[188:191], a[92:95], v[84:87]
buffer_load_dwordx4 a[240:243], v14, s[24:27], s65 offen offset:0 sc1
v_mfma_f32_16x16x32_bf16 v[84:87], v[184:187], a[84:87], v[84:87]
s_add_u32 s54, s54, 4096
s_waitcnt lgkmcnt(8)
ds_read_b128 v[176:179], v8 offset:0
v_mfma_f32_16x16x32_bf16 v[88:91], v[144:147], a[80:83], v[88:91]
ds_write_b64 v11, a[126:127] offset:3080
v_mfma_f32_16x16x32_bf16 v[88:91], v[148:151], a[88:91], v[88:91]
s_add_u32 s91, s91, 16384
ds_read_b128 v[180:183], v8 offset:1024
v_add_u32 v11, s70, v4
v_mfma_f32_16x16x32_bf16 v[92:95], v[148:151], a[92:95], v[92:95]
s_sub_u32 s55, s3, s84
s_add_u32 s70, s70, 16384
ds_read_b128 v[184:187], v8 offset:2048
v_mfma_f32_16x16x32_bf16 v[92:95], v[144:147], a[84:87], v[92:95]
s_cmp_ge_u32 s70, 163840
s_cselect_b32 s70, s80, s70
s_waitcnt lgkmcnt(10)
v_mfma_f32_16x16x32_bf16 v[96:99], v[152:155], a[80:83], v[96:99]
buffer_load_dwordx4 a[248:251], v14, s[24:27], s65 offen offset:2048 sc1
v_mfma_f32_16x16x32_bf16 v[96:99], v[156:159], a[88:91], v[96:99]
s_and_b32 s55, s55, 3
s_waitcnt lgkmcnt(7) vmcnt(12)
ds_read_b128 v[188:191], v8 offset:3072
v_mfma_f32_16x16x32_bf16 v[100:103], v[156:159], a[92:95], v[100:103]
ds_write_b64 v11, a[160:161] offset:0
v_mfma_f32_16x16x32_bf16 v[100:103], v[152:155], a[84:87], v[100:103]
buffer_load_dwordx4 a[244:247], v14, s[24:27], s93 offen offset:0 sc1
v_mfma_f32_16x16x32_bf16 v[120:123], v[160:163], a[192:195], v[120:123]
s_lshl_b32 s55, s55, 10
ds_read_b128 v[144:147], v8 offset:4096
v_mfma_f32_16x16x32_bf16 v[120:123], v[164:167], a[200:203], v[120:123]
s_waitcnt vmcnt(11)
ds_read_b128 v[148:151], v8 offset:5120
v_mfma_f32_16x16x32_bf16 v[124:127], v[164:167], a[204:207], v[124:127]
ds_write_b64 v11, a[162:163] offset:8
v_mfma_f32_16x16x32_bf16 v[124:127], v[160:163], a[196:199], v[124:127]
s_add_u32 s55, s55, s69
s_waitcnt lgkmcnt(9)
ds_read_b128 v[152:155], v8 offset:6144
v_mfma_f32_16x16x32_bf16 v[72:75], v[168:171], a[192:195], v[72:75]
buffer_load_dwordx4 a[252:255], v14, s[24:27], s93 offen offset:2048 sc1
v_mfma_f32_16x16x32_bf16 v[72:75], v[172:175], a[200:203], v[72:75]
s_cmp_ge_u32 s91, 163840
s_cselect_b32 s91, 0, s91
ds_read_b128 v[156:159], v8 offset:7168
v_mfma_f32_16x16x32_bf16 v[76:79], v[172:175], a[204:207], v[76:79]
s_add_u32 s55, s55, 23552
s_waitcnt lgkmcnt(8)
ds_read_b128 v[160:163], v8 offset:8192
v_mfma_f32_16x16x32_bf16 v[76:79], v[168:171], a[196:199], v[76:79]
ds_write_b64 v11, a[164:165] offset:1024
v_mfma_f32_16x16x32_bf16 v[80:83], v[176:179], a[192:195], v[80:83]
s_xor_b32 s65, s82, 40960
s_add_u32 s65, s65, s77
ds_read_b128 v[164:167], v8 offset:9216
v_mfma_f32_16x16x32_bf16 v[80:83], v[180:183], a[200:203], v[80:83]
s_add_u32 s71, s69, 24576
s_waitcnt lgkmcnt(9)
v_add_u32 v7, s91, v4
v_mfma_f32_16x16x32_bf16 v[84:87], v[180:183], a[204:207], v[84:87]
buffer_load_dwordx4 a[96:99], v15, s[24:27], s65 offen offset:0 sc1
v_mfma_f32_16x16x32_bf16 v[84:87], v[176:179], a[196:199], v[84:87]
ds_write_b64 v11, a[166:167] offset:1032
v_mfma_f32_16x16x32_bf16 v[88:91], v[184:187], a[192:195], v[88:91]
s_cmp_eq_u32 s3, s84
s_cselect_b32 s55, 2147418112, s55
s_cselect_b32 s71, s71, 2147418112
v_mfma_f32_16x16x32_bf16 v[88:91], v[188:191], a[200:203], v[88:91]
ds_read_b128 v[168:171], v8 offset:10240
v_mfma_f32_16x16x32_bf16 v[92:95], v[188:191], a[204:207], v[92:95]
buffer_load_dwordx4 a[104:107], v15, s[24:27], s65 offen offset:2048 sc1
v_mfma_f32_16x16x32_bf16 v[92:95], v[184:187], a[196:199], v[92:95]
s_mul_i32 s83, s84, 6144
s_waitcnt lgkmcnt(8)
ds_read_b128 v[172:175], v8 offset:11264
v_mfma_f32_16x16x32_bf16 v[96:99], v[144:147], a[192:195], v[96:99]
ds_write_b64 v11, a[168:169] offset:2048
v_mfma_f32_16x16x32_bf16 v[96:99], v[148:151], a[200:203], v[96:99]
s_xor_b32 s93, s82, 40960
s_add_u32 s93, s93, s81
ds_read_b128 v[176:179], v8 offset:12288
v_mfma_f32_16x16x32_bf16 v[100:103], v[148:151], a[204:207], v[100:103]
s_add_u32 s69, s69, s83
s_waitcnt lgkmcnt(8) vmcnt(12)
ds_read_b128 v[180:183], v8 offset:13312
v_mfma_f32_16x16x32_bf16 v[100:103], v[144:147], a[196:199], v[100:103]
buffer_load_dwordx4 a[100:103], v15, s[24:27], s93 offen offset:0 sc1
v_mfma_f32_16x16x32_bf16 v[120:123], v[152:155], a[208:211], v[120:123]
s_waitcnt vmcnt(57)
s_waitcnt vmcnt(11)
ds_read_b128 v[184:187], v8 offset:14336
v_mfma_f32_16x16x32_bf16 v[120:123], v[156:159], a[216:219], v[120:123]
s_barrier
v_mfma_f32_16x16x32_bf16 v[124:127], v[156:159], a[220:223], v[124:127]
s_add_u32 s83, s69, 4096
s_waitcnt lgkmcnt(7)
ds_read_b128 v[188:191], v8 offset:15360
v_mfma_f32_16x16x32_bf16 v[124:127], v[152:155], a[212:215], v[124:127]
ds_write_b64 v11, a[170:171] offset:2056
v_mfma_f32_16x16x32_bf16 v[72:75], v[160:163], a[208:211], v[72:75]
buffer_load_dwordx4 a[108:111], v15, s[24:27], s93 offen offset:2048 sc1
v_mfma_f32_16x16x32_bf16 v[72:75], v[164:167], a[216:219], v[72:75]
s_add_u32 s91, s91, 16384
ds_read_b128 v[144:147], v7 offset:0
v_mfma_f32_16x16x32_bf16 v[76:79], v[164:167], a[220:223], v[76:79]
s_waitcnt lgkmcnt(7)
ds_read_b128 v[148:151], v7 offset:1024
v_mfma_f32_16x16x32_bf16 v[76:79], v[160:163], a[212:215], v[76:79]
ds_write_b64 v11, a[172:173] offset:3072
v_mfma_f32_16x16x32_bf16 v[80:83], v[168:171], a[208:211], v[80:83]
s_cmp_ge_u32 s91, 163840
s_cselect_b32 s91, 0, s91
ds_read_b128 v[152:155], v7 offset:2048
v_mfma_f32_16x16x32_bf16 v[80:83], v[172:175], a[216:219], v[80:83]
s_waitcnt lgkmcnt(7)
ds_read_b128 v[156:159], v7 offset:3072
v_add_u32 v8, s91, v4
v_mfma_f32_16x16x32_bf16 v[84:87], v[172:175], a[220:223], v[84:87]
buffer_load_dwordx4 a[112:115], v14, s[24:27], s65 offen offset:0 sc1
v_mfma_f32_16x16x32_bf16 v[84:87], v[168:171], a[212:215], v[84:87]
ds_write_b64 v11, a[174:175] offset:3080
v_mfma_f32_16x16x32_bf16 v[88:91], v[176:179], a[208:211], v[88:91]
s_add_u32 s68, s68, 49152
ds_read_b128 v[160:163], v7 offset:4096
v_mfma_f32_16x16x32_bf16 v[88:91], v[180:183], a[216:219], v[88:91]
ds_read_b128 v[164:167], v7 offset:5120
v_mfma_f32_16x16x32_bf16 v[92:95], v[180:183], a[220:223], v[92:95]
buffer_load_dwordx4 a[120:123], v14, s[24:27], s65 offen offset:2048 sc1
v_mfma_f32_16x16x32_bf16 v[92:95], v[176:179], a[212:215], v[92:95]
s_waitcnt lgkmcnt(9)
ds_read_b128 v[168:171], v7 offset:6144
v_mfma_f32_16x16x32_bf16 v[96:99], v[184:187], a[208:211], v[96:99]
ds_read_b128 v[172:175], v7 offset:7168
v_mfma_f32_16x16x32_bf16 v[96:99], v[188:191], a[216:219], v[96:99]
v_mfma_f32_16x16x32_bf16 v[100:103], v[188:191], a[220:223], v[100:103]
buffer_load_dwordx4 a[116:119], v14, s[24:27], s93 offen offset:0 sc1
v_mfma_f32_16x16x32_bf16 v[100:103], v[184:187], a[212:215], v[100:103]
s_waitcnt lgkmcnt(8) vmcnt(13)
ds_read_b128 v[176:179], v7 offset:8192
v_mfma_f32_16x16x32_bf16 v[120:123], v[144:147], a[224:227], v[120:123]
ds_read_b128 v[180:183], v7 offset:9216
v_mfma_f32_16x16x32_bf16 v[120:123], v[148:151], a[232:235], v[120:123]
s_waitcnt vmcnt(11)
v_mfma_f32_16x16x32_bf16 v[124:127], v[148:151], a[236:239], v[124:127]
buffer_load_dwordx4 a[124:127], v14, s[24:27], s93 offen offset:2048 sc1
v_mfma_f32_16x16x32_bf16 v[124:127], v[144:147], a[228:231], v[124:127]
s_waitcnt lgkmcnt(7)
ds_read_b128 v[184:187], v7 offset:10240
v_mfma_f32_16x16x32_bf16 v[72:75], v[152:155], a[224:227], v[72:75]
ds_read_b128 v[188:191], v7 offset:11264
v_mfma_f32_16x16x32_bf16 v[72:75], v[156:159], a[232:235], v[72:75]
v_mfma_f32_16x16x32_bf16 v[76:79], v[156:159], a[236:239], v[76:79]
ds_read_b128 v[144:147], v7 offset:12288
v_mfma_f32_16x16x32_bf16 v[76:79], v[152:155], a[228:231], v[76:79]
s_waitcnt lgkmcnt(7)
v_mfma_f32_16x16x32_bf16 v[80:83], v[160:163], a[224:227], v[80:83]
s_xor_b32 s65, s82, 49152
s_add_u32 s65, s65, s77
ds_read_b128 v[148:151], v7 offset:13312
v_mfma_f32_16x16x32_bf16 v[80:83], v[164:167], a[232:235], v[80:83]
v_mov_b32 v13, 0xffff0000
v_mul_u32_u24 v5, 1152, v2
v_mfma_f32_16x16x32_bf16 v[84:87], v[164:167], a[236:239], v[84:87]
buffer_load_dwordx4 a[128:131], v15, s[24:27], s65 offen offset:0 sc1
v_mfma_f32_16x16x32_bf16 v[84:87], v[160:163], a[228:231], v[84:87]
s_waitcnt lgkmcnt(6)
ds_read_b128 v[152:155], v7 offset:14336
v_lshl_add_u32 v6, v3, 3, v5
v_mfma_f32_16x16x32_bf16 v[88:91], v[168:171], a[224:227], v[88:91]
ds_read_b128 v[156:159], v7 offset:15360
v_and_b32 v9, 1, v3
v_mfma_f32_16x16x32_bf16 v[88:91], v[172:175], a[232:235], v[88:91]
s_add_u32 s91, s91, 16384
s_cmp_ge_u32 s91, 163840
s_cselect_b32 s91, 0, s91
v_mfma_f32_16x16x32_bf16 v[92:95], v[172:175], a[236:239], v[92:95]
buffer_load_dwordx4 a[136:139], v15, s[24:27], s65 offen offset:2048 sc1
v_mfma_f32_16x16x32_bf16 v[92:95], v[168:171], a[228:231], v[92:95]
s_waitcnt lgkmcnt(6)
ds_read_b128 v[160:163], v8 offset:0
v_add_u32 v7, s91, v4
v_mfma_f32_16x16x32_bf16 v[96:99], v[176:179], a[224:227], v[96:99]
s_xor_b32 s93, s82, 49152
s_add_u32 s93, s93, s81
ds_read_b128 v[164:167], v8 offset:1024
v_mfma_f32_16x16x32_bf16 v[96:99], v[180:183], a[232:235], v[96:99]
v_lshl_add_u32 v5, v9, 5, v5
v_lshrrev_b32 v9, 1, v3
v_mfma_f32_16x16x32_bf16 v[100:103], v[180:183], a[236:239], v[100:103]
buffer_load_dwordx4 a[132:135], v15, s[24:27], s93 offen offset:0 sc1
v_mfma_f32_16x16x32_bf16 v[100:103], v[176:179], a[228:231], v[100:103]
s_waitcnt lgkmcnt(6) vmcnt(13)
ds_read_b128 v[168:171], v8 offset:2048
v_lshl_add_u32 v5, v9, 4, v5
v_mfma_f32_16x16x32_bf16 v[120:123], v[184:187], a[240:243], v[120:123]
ds_read_b128 v[172:175], v8 offset:3072
v_mfma_f32_16x16x32_bf16 v[120:123], v[188:191], a[248:251], v[120:123]
s_waitcnt vmcnt(11)
v_mfma_f32_16x16x32_bf16 v[124:127], v[188:191], a[252:255], v[124:127]
buffer_load_dwordx4 a[140:143], v15, s[24:27], s93 offen offset:2048 sc1
v_mfma_f32_16x16x32_bf16 v[124:127], v[184:187], a[244:247], v[124:127]
s_waitcnt lgkmcnt(6)
ds_read_b128 v[176:179], v8 offset:4096
v_mfma_f32_16x16x32_bf16 v[72:75], v[144:147], a[240:243], v[72:75]
ds_read_b128 v[180:183], v8 offset:5120
v_mfma_f32_16x16x32_bf16 v[72:75], v[148:151], a[248:251], v[72:75]
v_mfma_f32_16x16x32_bf16 v[76:79], v[148:151], a[252:255], v[76:79]
ds_read_b128 v[184:187], v8 offset:6144
v_mfma_f32_16x16x32_bf16 v[76:79], v[144:147], a[244:247], v[76:79]
s_waitcnt lgkmcnt(7)
v_mfma_f32_16x16x32_bf16 v[80:83], v[152:155], a[240:243], v[80:83]
ds_read_b128 v[188:191], v8 offset:7168
v_mfma_f32_16x16x32_bf16 v[80:83], v[156:159], a[248:251], v[80:83]
s_waitcnt lgkmcnt(6)
v_mfma_f32_16x16x32_bf16 v[84:87], v[156:159], a[252:255], v[84:87]
buffer_load_dword v12, v10, s[24:27], s75 offen offset:128 sc1
v_mfma_f32_16x16x32_bf16 v[84:87], v[152:155], a[244:247], v[84:87]
buffer_load_dwordx4 a[144:147], v14, s[24:27], s65 offen offset:0 sc1
v_mfma_f32_16x16x32_bf16 v[88:91], v[160:163], a[240:243], v[88:91]
ds_read_b128 v[144:147], v8 offset:8192
v_mfma_f32_16x16x32_bf16 v[88:91], v[164:167], a[248:251], v[88:91]
ds_read_b128 v[148:151], v8 offset:9216
v_mfma_f32_16x16x32_bf16 v[92:95], v[164:167], a[252:255], v[92:95]
buffer_load_dwordx4 a[152:155], v14, s[24:27], s65 offen offset:2048 sc1
v_mfma_f32_16x16x32_bf16 v[92:95], v[160:163], a[244:247], v[92:95]
s_waitcnt lgkmcnt(6)
ds_read_b128 v[152:155], v8 offset:10240
v_mfma_f32_16x16x32_bf16 v[96:99], v[168:171], a[240:243], v[96:99]
ds_read_b128 v[156:159], v8 offset:11264
v_mfma_f32_16x16x32_bf16 v[96:99], v[172:175], a[248:251], v[96:99]
v_mfma_f32_16x16x32_bf16 v[100:103], v[172:175], a[252:255], v[100:103]
buffer_load_dwordx4 a[148:151], v14, s[24:27], s93 offen offset:0 sc1
v_mfma_f32_16x16x32_bf16 v[100:103], v[168:171], a[244:247], v[100:103]
s_waitcnt lgkmcnt(6) vmcnt(14)
ds_read_b128 v[160:163], v8 offset:12288
v_mfma_f32_16x16x32_bf16 v[120:123], v[176:179], a[96:99], v[120:123]
ds_read_b128 v[164:167], v8 offset:13312
v_mfma_f32_16x16x32_bf16 v[120:123], v[180:183], a[104:107], v[120:123]
s_waitcnt vmcnt(12)
v_mfma_f32_16x16x32_bf16 v[124:127], v[180:183], a[108:111], v[124:127]
buffer_load_dwordx4 a[156:159], v14, s[24:27], s93 offen offset:2048 sc1
v_mfma_f32_16x16x32_bf16 v[124:127], v[176:179], a[100:103], v[124:127]
s_waitcnt lgkmcnt(6)
ds_read_b128 v[168:171], v8 offset:14336
v_mfma_f32_16x16x32_bf16 v[72:75], v[184:187], a[96:99], v[72:75]
s_waitcnt vmcnt(62)
ds_read_b128 v[172:175], v8 offset:15360
v_mfma_f32_16x16x32_bf16 v[72:75], v[188:191], a[104:107], v[72:75]
s_barrier
v_mfma_f32_16x16x32_bf16 v[76:79], v[188:191], a[108:111], v[76:79]
s_add_u32 s91, s91, 16384
ds_read_b128 v[176:179], v7 offset:0
v_mfma_f32_16x16x32_bf16 v[76:79], v[184:187], a[100:103], v[76:79]
s_waitcnt lgkmcnt(7)
s_cmp_ge_u32 s91, 163840
s_cselect_b32 s91, 0, s91
v_mfma_f32_16x16x32_bf16 v[80:83], v[144:147], a[96:99], v[80:83]
s_xor_b32 s65, s82, 57344
s_add_u32 s65, s65, s77
ds_read_b128 v[180:183], v7 offset:1024
v_mfma_f32_16x16x32_bf16 v[80:83], v[148:151], a[104:107], v[80:83]
v_add_u32 v8, s91, v4
v_mfma_f32_16x16x32_bf16 v[84:87], v[148:151], a[108:111], v[84:87]
buffer_load_dwordx4 a[160:163], v15, s[24:27], s65 offen offset:0 sc1
v_mfma_f32_16x16x32_bf16 v[84:87], v[144:147], a[100:103], v[84:87]
s_waitcnt lgkmcnt(6)
ds_read_b128 v[184:187], v7 offset:2048
v_mfma_f32_16x16x32_bf16 v[88:91], v[152:155], a[96:99], v[88:91]
ds_read_b128 v[188:191], v7 offset:3072
v_mfma_f32_16x16x32_bf16 v[88:91], v[156:159], a[104:107], v[88:91]
v_mfma_f32_16x16x32_bf16 v[92:95], v[156:159], a[108:111], v[92:95]
buffer_load_dwordx4 a[168:171], v15, s[24:27], s65 offen offset:2048 sc1
v_mfma_f32_16x16x32_bf16 v[92:95], v[152:155], a[100:103], v[92:95]
s_waitcnt lgkmcnt(6)
ds_read_b128 v[144:147], v7 offset:4096
v_mfma_f32_16x16x32_bf16 v[96:99], v[160:163], a[96:99], v[96:99]
s_xor_b32 s93, s82, 57344
s_add_u32 s93, s93, s81
ds_read_b128 v[148:151], v7 offset:5120
v_mfma_f32_16x16x32_bf16 v[96:99], v[164:167], a[104:107], v[96:99]
v_mfma_f32_16x16x32_bf16 v[100:103], v[164:167], a[108:111], v[100:103]
buffer_load_dwordx4 a[164:167], v15, s[24:27], s93 offen offset:0 sc1
v_mfma_f32_16x16x32_bf16 v[100:103], v[160:163], a[100:103], v[100:103]
s_waitcnt lgkmcnt(6) vmcnt(14)
ds_read_b128 v[152:155], v7 offset:6144
v_mfma_f32_16x16x32_bf16 v[120:123], v[168:171], a[112:115], v[120:123]
ds_read_b128 v[156:159], v7 offset:7168
v_mfma_f32_16x16x32_bf16 v[120:123], v[172:175], a[120:123], v[120:123]
s_waitcnt vmcnt(12)
v_mfma_f32_16x16x32_bf16 v[124:127], v[172:175], a[124:127], v[124:127]
buffer_load_dwordx4 a[172:175], v15, s[24:27], s93 offen offset:2048 sc1
v_mfma_f32_16x16x32_bf16 v[124:127], v[168:171], a[116:119], v[124:127]
s_waitcnt lgkmcnt(6)
ds_read_b128 v[160:163], v7 offset:8192
v_mfma_f32_16x16x32_bf16 v[72:75], v[176:179], a[112:115], v[72:75]
ds_read_b128 v[164:167], v7 offset:9216
v_mfma_f32_16x16x32_bf16 v[72:75], v[180:183], a[120:123], v[72:75]
v_mfma_f32_16x16x32_bf16 v[76:79], v[180:183], a[124:127], v[76:79]
ds_read_b128 v[168:171], v7 offset:10240
v_mfma_f32_16x16x32_bf16 v[76:79], v[176:179], a[116:119], v[76:79]
s_waitcnt lgkmcnt(7)
v_mfma_f32_16x16x32_bf16 v[80:83], v[184:187], a[112:115], v[80:83]
ds_read_b128 v[172:175], v7 offset:11264
v_mfma_f32_16x16x32_bf16 v[80:83], v[188:191], a[120:123], v[80:83]
v_mfma_f32_16x16x32_bf16 v[84:87], v[188:191], a[124:127], v[84:87]
buffer_load_dwordx4 a[176:179], v14, s[24:27], s65 offen offset:0 sc1
v_mfma_f32_16x16x32_bf16 v[84:87], v[184:187], a[116:119], v[84:87]
s_waitcnt lgkmcnt(6)
ds_read_b128 v[176:179], v7 offset:12288
v_mfma_f32_16x16x32_bf16 v[88:91], v[144:147], a[112:115], v[88:91]
ds_read_b128 v[180:183], v7 offset:13312
v_mfma_f32_16x16x32_bf16 v[88:91], v[148:151], a[120:123], v[88:91]
v_mfma_f32_16x16x32_bf16 v[92:95], v[148:151], a[124:127], v[92:95]
buffer_load_dwordx4 a[184:187], v14, s[24:27], s65 offen offset:2048 sc1
v_mfma_f32_16x16x32_bf16 v[92:95], v[144:147], a[116:119], v[92:95]
s_waitcnt lgkmcnt(6)
ds_read_b128 v[184:187], v7 offset:14336
v_mfma_f32_16x16x32_bf16 v[96:99], v[152:155], a[112:115], v[96:99]
s_waitcnt vmcnt(10)
ds_read_b128 v[188:191], v7 offset:15360
v_mfma_f32_16x16x32_bf16 v[96:99], v[156:159], a[120:123], v[96:99]
s_add_u32 s91, s91, 16384
v_cmp_gt_u32 vcc, 8, v12
v_mfma_f32_16x16x32_bf16 v[100:103], v[156:159], a[124:127], v[100:103]
buffer_load_dwordx4 a[180:183], v14, s[24:27], s93 offen offset:0 sc1
v_mfma_f32_16x16x32_bf16 v[100:103], v[152:155], a[116:119], v[100:103]
s_waitcnt lgkmcnt(6) vmcnt(14)
ds_read_b128 v[144:147], v8 offset:0
v_mfma_f32_16x16x32_bf16 v[120:123], v[160:163], a[128:131], v[120:123]
s_cmp_ge_u32 s91, 163840
s_cselect_b32 s91, 0, s91
ds_read_b128 v[148:151], v8 offset:1024
v_mfma_f32_16x16x32_bf16 v[120:123], v[164:167], a[136:139], v[120:123]
s_waitcnt lgkmcnt(6) vmcnt(12)
v_add_u32 v7, s91, v4
v_mfma_f32_16x16x32_bf16 v[124:127], v[164:167], a[140:143], v[124:127]
s_cbranch_vccnz CK_ZAA
CK_ZAA_R:
v_mfma_f32_16x16x32_bf16 v[124:127], v[160:163], a[132:135], v[124:127]
buffer_load_dwordx4 a[188:191], v14, s[24:27], s93 offen offset:2048 sc1
v_mfma_f32_16x16x32_bf16 v[72:75], v[168:171], a[128:131], v[72:75]
ds_read_b128 v[152:155], v8 offset:2048
v_mfma_f32_16x16x32_bf16 v[72:75], v[172:175], a[136:139], v[72:75]
ds_read_b128 v[156:159], v8 offset:3072
v_mfma_f32_16x16x32_bf16 v[76:79], v[172:175], a[140:143], v[76:79]
ds_read_b128 v[160:163], v8 offset:4096
v_mfma_f32_16x16x32_bf16 v[76:79], v[168:171], a[132:135], v[76:79]
s_waitcnt lgkmcnt(7)
v_mfma_f32_16x16x32_bf16 v[80:83], v[176:179], a[128:131], v[80:83]
s_add_u32 s65, s77, 65536
ds_read_b128 v[164:167], v8 offset:5120
v_mfma_f32_16x16x32_bf16 v[80:83], v[180:183], a[136:139], v[80:83]
v_mfma_f32_16x16x32_bf16 v[84:87], v[180:183], a[140:143], v[84:87]
buffer_load_dwordx4 v[32:35], v15, s[24:27], s65 offen offset:0 sc1
v_mfma_f32_16x16x32_bf16 v[84:87], v[176:179], a[132:135], v[84:87]
s_waitcnt lgkmcnt(6)
ds_read_b128 v[168:171], v8 offset:6144
v_mfma_f32_16x16x32_bf16 v[88:91], v[184:187], a[128:131], v[88:91]
ds_read_b128 v[172:175], v8 offset:7168
v_mfma_f32_16x16x32_bf16 v[88:91], v[188:191], a[136:139], v[88:91]
v_mfma_f32_16x16x32_bf16 v[92:95], v[188:191], a[140:143], v[92:95]
buffer_load_dwordx4 v[40:43], v15, s[24:27], s65 offen offset:2048 sc1
v_mfma_f32_16x16x32_bf16 v[92:95], v[184:187], a[132:135], v[92:95]
s_waitcnt lgkmcnt(6)
ds_read_b128 v[176:179], v8 offset:8192
v_mfma_f32_16x16x32_bf16 v[96:99], v[144:147], a[128:131], v[96:99]
s_add_u32 s93, s81, 65536
ds_read_b128 v[180:183], v8 offset:9216
v_mfma_f32_16x16x32_bf16 v[96:99], v[148:151], a[136:139], v[96:99]
s_waitcnt lgkmcnt(6) vmcnt(12)
v_mfma_f32_16x16x32_bf16 v[100:103], v[148:151], a[140:143], v[100:103]
buffer_load_dwordx4 v[36:39], v15, s[24:27], s93 offen offset:0 sc1
v_mfma_f32_16x16x32_bf16 v[100:103], v[144:147], a[132:135], v[100:103]
s_mov_b32 m0, s70
s_mov_b32 s64, s68
s_add_u32 s68, s68, 16384
v_mfma_f32_16x16x32_bf16 v[120:123], v[152:155], a[144:147], v[120:123]
s_waitcnt vmcnt(11)
ds_read_b128 v[184:187], v8 offset:10240
v_mfma_f32_16x16x32_bf16 v[120:123], v[156:159], a[152:155], v[120:123]
s_add_u32 s70, s70, 16384
s_cmp_ge_u32 s70, 163840
s_cselect_b32 s70, s80, s70
v_mfma_f32_16x16x32_bf16 v[124:127], v[156:159], a[156:159], v[124:127]
buffer_load_dwordx4 v15, s[24:27], s64 offen offset:0 sc1 lds
v_mfma_f32_16x16x32_bf16 v[124:127], v[152:155], a[148:151], v[124:127]
s_waitcnt lgkmcnt(5)
ds_read_b128 v[188:191], v8 offset:11264
v_mfma_f32_16x16x32_bf16 v[72:75], v[160:163], a[144:147], v[72:75]
ds_read_b128 v[144:147], v8 offset:12288
v_mfma_f32_16x16x32_bf16 v[72:75], v[164:167], a[152:155], v[72:75]
buffer_load_dwordx4 v15, s[24:27], s64 offen offset:1024 sc1 lds
v_mfma_f32_16x16x32_bf16 v[76:79], v[164:167], a[156:159], v[76:79]
ds_read_b128 v[148:151], v8 offset:13312
v_mfma_f32_16x16x32_bf16 v[76:79], v[160:163], a[148:151], v[76:79]
s_waitcnt lgkmcnt(6)
ds_read_b128 v[152:155], v8 offset:14336
v_mfma_f32_16x16x32_bf16 v[80:83], v[168:171], a[144:147], v[80:83]
buffer_load_dwordx4 v[44:47], v15, s[24:27], s93 offen offset:2048 sc1
v_mfma_f32_16x16x32_bf16 v[80:83], v[172:175], a[152:155], v[80:83]
s_barrier
v_mfma_f32_16x16x32_bf16 v[84:87], v[172:175], a[156:159], v[84:87]
s_waitcnt lgkmcnt(5)
ds_read_b128 v[156:159], v8 offset:15360
v_mfma_f32_16x16x32_bf16 v[84:87], v[168:171], a[148:151], v[84:87]
buffer_load_dwordx4 v15, s[24:27], s64 offen offset:2048 sc1 lds
v_mfma_f32_16x16x32_bf16 v[88:91], v[176:179], a[144:147], v[88:91]
s_add_u32 s91, s91, 16384
ds_read_b128 v[160:163], v7 offset:0
v_mfma_f32_16x16x32_bf16 v[88:91], v[180:183], a[152:155], v[88:91]
s_cmp_ge_u32 s91, 163840
s_cselect_b32 s91, 0, s91
ds_read_b128 v[164:167], v7 offset:1024
v_mfma_f32_16x16x32_bf16 v[92:95], v[180:183], a[156:159], v[92:95]
buffer_load_dwordx4 v15, s[24:27], s64 offen offset:3072 sc1 lds
v_mfma_f32_16x16x32_bf16 v[92:95], v[176:179], a[148:151], v[92:95]
s_waitcnt lgkmcnt(6)
ds_read_b128 v[168:171], v7 offset:2048
v_add_u32 v8, s91, v4
v_mfma_f32_16x16x32_bf16 v[96:99], v[184:187], a[144:147], v[96:99]
ds_read_b128 v[172:175], v7 offset:3072
v_mfma_f32_16x16x32_bf16 v[96:99], v[188:191], a[152:155], v[96:99]
buffer_load_dwordx4 v[48:51], v14, s[24:27], s65 offen offset:0 sc1
v_mfma_f32_16x16x32_bf16 v[100:103], v[188:191], a[156:159], v[100:103]
ds_read_b128 v[176:179], v7 offset:4096
v_mfma_f32_16x16x32_bf16 v[100:103], v[184:187], a[148:151], v[100:103]
s_waitcnt lgkmcnt(7) vmcnt(15)
v_mfma_f32_16x16x32_bf16 v[120:123], v[144:147], a[160:163], v[120:123]
buffer_load_dwordx4 v[56:59], v14, s[24:27], s65 offen offset:2048 sc1
v_mfma_f32_16x16x32_bf16 v[120:123], v[148:151], a[168:171], v[120:123]
s_waitcnt vmcnt(14)
ds_read_b128 v[180:183], v7 offset:5120
v_mfma_f32_16x16x32_bf16 v[124:127], v[148:151], a[172:175], v[124:127]
s_waitcnt lgkmcnt(6)
ds_read_b128 v[184:187], v7 offset:6144
v_mfma_f32_16x16x32_bf16 v[124:127], v[144:147], a[164:167], v[124:127]
buffer_load_dwordx4 v[52:55], v14, s[24:27], s93 offen offset:0 sc1
v_mfma_f32_16x16x32_bf16 v[72:75], v[152:155], a[160:163], v[72:75]
ds_read_b128 v[188:191], v7 offset:7168
v_mfma_f32_16x16x32_bf16 v[72:75], v[156:159], a[168:171], v[72:75]
v_mfma_f32_16x16x32_bf16 v[76:79], v[156:159], a[172:175], v[76:79]
buffer_load_dwordx4 v[60:63], v14, s[24:27], s93 offen offset:2048 sc1
v_mfma_f32_16x16x32_bf16 v[76:79], v[152:155], a[164:167], v[76:79]
s_waitcnt lgkmcnt(6)
ds_read_b128 v[144:147], v7 offset:8192
v_mfma_f32_16x16x32_bf16 v[80:83], v[160:163], a[160:163], v[80:83]
ds_read_b128 v[148:151], v7 offset:9216
v_mfma_f32_16x16x32_bf16 v[80:83], v[164:167], a[168:171], v[80:83]
v_mfma_f32_16x16x32_bf16 v[84:87], v[164:167], a[172:175], v[84:87]
ds_read_b128 v[152:155], v7 offset:10240
v_mfma_f32_16x16x32_bf16 v[84:87], v[160:163], a[164:167], v[84:87]
s_waitcnt lgkmcnt(7)
v_mfma_f32_16x16x32_bf16 v[88:91], v[168:171], a[160:163], v[88:91]
s_add_u32 s65, s77, 73728
ds_read_b128 v[156:159], v7 offset:11264
v_mfma_f32_16x16x32_bf16 v[88:91], v[172:175], a[168:171], v[88:91]
v_mfma_f32_16x16x32_bf16 v[92:95], v[172:175], a[172:175], v[92:95]
buffer_load_dwordx4 v[64:67], v15, s[24:27], s65 offen offset:0 sc1
v_mfma_f32_16x16x32_bf16 v[92:95], v[168:171], a[164:167], v[92:95]
s_waitcnt lgkmcnt(6)
ds_read_b128 v[160:163], v7 offset:12288
v_mfma_f32_16x16x32_bf16 v[96:99], v[176:179], a[160:163], v[96:99]
ds_read_b128 v[164:167], v7 offset:13312
v_mfma_f32_16x16x32_bf16 v[96:99], v[180:183], a[168:171], v[96:99]
v_mfma_f32_16x16x32_bf16 v[100:103], v[180:183], a[172:175], v[100:103]
ds_read_b128 v[168:171], v7 offset:14336
v_mfma_f32_16x16x32_bf16 v[100:103], v[176:179], a[164:167], v[100:103]
s_add_u32 s93, s81, 73728
s_waitcnt lgkmcnt(7) vmcnt(15)
v_mfma_f32_16x16x32_bf16 v[120:123], v[184:187], a[176:179], v[120:123]
s_waitcnt vmcnt(13)
ds_read_b128 v[172:175], v7 offset:15360
v_mfma_f32_16x16x32_bf16 v[120:123], v[188:191], a[184:187], v[120:123]
buffer_load_dwordx4 v[68:71], v15, s[24:27], s93 offen offset:0 sc1
v_mfma_f32_16x16x32_bf16 v[124:127], v[188:191], a[188:191], v[124:127]
s_add_u32 s91, s91, 16384
ds_read_b128 v[176:179], v8 offset:0
v_mfma_f32_16x16x32_bf16 v[124:127], v[184:187], a[180:183], v[124:127]
s_waitcnt lgkmcnt(7)
s_cmp_ge_u32 s91, 163840
s_cselect_b32 s91, 0, s91
v_mfma_f32_16x16x32_bf16 v[72:75], v[144:147], a[176:179], v[72:75]
ds_read_b128 v[180:183], v8 offset:1024
v_add_u32 v7, s91, v4
v_mfma_f32_16x16x32_bf16 v[72:75], v[148:151], a[184:187], v[72:75]
v_mfma_f32_16x16x32_bf16 v[76:79], v[148:151], a[188:191], v[76:79]
s_mov_b32 m0, s70
s_mov_b32 s64, s68
s_add_u32 s68, s68, 16384
v_mfma_f32_16x16x32_bf16 v[76:79], v[144:147], a[180:183], v[76:79]
s_waitcnt lgkmcnt(6)
ds_read_b128 v[184:187], v8 offset:2048
v_mfma_f32_16x16x32_bf16 v[80:83], v[152:155], a[176:179], v[80:83]
s_add_u32 s70, s70, 16384
s_cmp_ge_u32 s70, 163840
s_cselect_b32 s70, s80, s70
v_mfma_f32_16x16x32_bf16 v[80:83], v[156:159], a[184:187], v[80:83]
buffer_load_dwordx4 v15, s[24:27], s64 offen offset:0 sc1 lds
v_mfma_f32_16x16x32_bf16 v[84:87], v[156:159], a[188:191], v[84:87]
L_PAD12:
s_cbranch_execz L_MAIN
ds_read_b128 v[188:191], v8 offset:3072
v_mfma_f32_16x16x32_bf16 v[84:87], v[152:155], a[180:183], v[84:87]
s_waitcnt lgkmcnt(6)
ds_read_b128 v[144:147], v8 offset:4096
v_mfma_f32_16x16x32_bf16 v[88:91], v[160:163], a[176:179], v[88:91]
buffer_load_dwordx4 v15, s[24:27], s64 offen offset:1024 sc1 lds
v_mfma_f32_16x16x32_bf16 v[88:91], v[164:167], a[184:187], v[88:91]
ds_read_b128 v[148:151], v8 offset:5120
v_mfma_f32_16x16x32_bf16 v[92:95], v[164:167], a[188:191], v[92:95]
s_waitcnt lgkmcnt(6)
ds_read_b128 v[152:155], v8 offset:6144
v_mfma_f32_16x16x32_bf16 v[92:95], v[160:163], a[180:183], v[92:95]
buffer_load_dwordx4 v15, s[24:27], s64 offen offset:2048 sc1 lds
v_mfma_f32_16x16x32_bf16 v[96:99], v[168:171], a[176:179], v[96:99]
ds_read_b128 v[156:159], v8 offset:7168
v_mfma_f32_16x16x32_bf16 v[96:99], v[172:175], a[184:187], v[96:99]
v_mfma_f32_16x16x32_bf16 v[100:103], v[172:175], a[188:191], v[100:103]
buffer_load_dwordx4 v15, s[24:27], s64 offen offset:3072 sc1 lds
v_mfma_f32_16x16x32_bf16 v[100:103], v[168:171], a[180:183], v[100:103]
s_waitcnt lgkmcnt(6) vmcnt(16)
ds_read_b128 v[160:163], v8 offset:8192
v_mfma_f32_16x16x32_bf16 v[120:123], v[176:179], v[32:35], v[120:123]
s_mov_b32 m0, s70
s_mov_b32 s64, s68
s_add_u32 s68, s68, 16384
v_mfma_f32_16x16x32_bf16 v[120:123], v[180:183], v[40:43], v[120:123]
s_waitcnt lgkmcnt(5) vmcnt(12)
ds_read_b128 v[164:167], v8 offset:9216
v_mfma_f32_16x16x32_bf16 v[124:127], v[180:183], v[44:47], v[124:127]
s_add_u32 s70, s70, 16384
s_cmp_ge_u32 s70, 163840
s_cselect_b32 s70, s80, s70
v_mfma_f32_16x16x32_bf16 v[124:127], v[176:179], v[36:39], v[124:127]
buffer_load_dwordx4 v15, s[24:27], s64 offen offset:0 sc1 lds
v_mfma_f32_16x16x32_bf16 v[72:75], v[184:187], v[32:35], v[72:75]
ds_read_b128 v[168:171], v8 offset:10240
v_mfma_f32_16x16x32_bf16 v[72:75], v[188:191], v[40:43], v[72:75]
ds_read_b128 v[172:175], v8 offset:11264
v_mfma_f32_16x16x32_bf16 v[76:79], v[188:191], v[44:47], v[76:79]
buffer_load_dwordx4 v15, s[24:27], s64 offen offset:1024 sc1 lds
v_mfma_f32_16x16x32_bf16 v[76:79], v[184:187], v[36:39], v[76:79]
s_waitcnt lgkmcnt(6)
ds_read_b128 v[176:179], v8 offset:12288
v_mfma_f32_16x16x32_bf16 v[80:83], v[144:147], v[32:35], v[80:83]
ds_read_b128 v[180:183], v8 offset:13312
v_mfma_f32_16x16x32_bf16 v[80:83], v[148:151], v[40:43], v[80:83]
buffer_load_dwordx4 v15, s[24:27], s64 offen offset:2048 sc1 lds
v_mfma_f32_16x16x32_bf16 v[84:87], v[148:151], v[44:47], v[84:87]
ds_read_b128 v[184:187], v8 offset:14336
v_mfma_f32_16x16x32_bf16 v[84:87], v[144:147], v[36:39], v[84:87]
s_waitcnt lgkmcnt(7)
v_mfma_f32_16x16x32_bf16 v[88:91], v[152:155], v[32:35], v[88:91]
s_waitcnt vmcnt(13)
ds_read_b128 v[188:191], v8 offset:15360
v_mfma_f32_16x16x32_bf16 v[88:91], v[156:159], v[40:43], v[88:91]
s_barrier
v_mfma_f32_16x16x32_bf16 v[92:95], v[156:159], v[44:47], v[92:95]
buffer_load_dwordx4 v15, s[24:27], s64 offen offset:3072 sc1 lds
v_mfma_f32_16x16x32_bf16 v[92:95], v[152:155], v[36:39], v[92:95]
s_waitcnt lgkmcnt(6)
s_add_u32 s91, s91, 16384
ds_read_b128 v[144:147], v7 offset:0
v_mfma_f32_16x16x32_bf16 v[96:99], v[160:163], v[32:35], v[96:99]
s_cmp_ge_u32 s91, 163840
s_cselect_b32 s91, 0, s91
ds_read_b128 v[148:151], v7 offset:1024
v_mfma_f32_16x16x32_bf16 v[96:99], v[164:167], v[40:43], v[96:99]
v_add_u32 v8, s91, v4
v_mfma_f32_16x16x32_bf16 v[100:103], v[164:167], v[44:47], v[100:103]
ds_read_b128 v[152:155], v7 offset:2048
v_mfma_f32_16x16x32_bf16 v[100:103], v[160:163], v[36:39], v[100:103]
s_waitcnt lgkmcnt(7) vmcnt(12)
v_mfma_f32_16x16x32_bf16 v[120:123], v[168:171], v[48:51], v[120:123]
ds_read_b128 v[156:159], v7 offset:3072
v_mfma_f32_16x16x32_bf16 v[120:123], v[172:175], v[56:59], v[120:123]
s_waitcnt vmcnt(10)
v_mfma_f32_16x16x32_bf16 v[124:127], v[172:175], v[60:63], v[124:127]
ds_read_b128 v[160:163], v7 offset:4096
v_mfma_f32_16x16x32_bf16 v[124:127], v[168:171], v[52:55], v[124:127]
s_waitcnt lgkmcnt(7)
v_mfma_f32_16x16x32_bf16 v[72:75], v[176:179], v[48:51], v[72:75]
ds_read_b128 v[164:167], v7 offset:5120
v_mfma_f32_16x16x32_bf16 v[72:75], v[180:183], v[56:59], v[72:75]
v_mfma_f32_16x16x32_bf16 v[76:79], v[180:183], v[60:63], v[76:79]
ds_read_b128 v[168:171], v7 offset:6144
v_mfma_f32_16x16x32_bf16 v[76:79], v[176:179], v[52:55], v[76:79]
s_waitcnt lgkmcnt(7)
v_mfma_f32_16x16x32_bf16 v[80:83], v[184:187], v[48:51], v[80:83]
ds_read_b128 v[172:175], v7 offset:7168
v_mfma_f32_16x16x32_bf16 v[80:83], v[188:191], v[56:59], v[80:83]
v_mfma_f32_16x16x32_bf16 v[84:87], v[188:191], v[60:63], v[84:87]
ds_read_b128 v[176:179], v7 offset:8192
v_mfma_f32_16x16x32_bf16 v[84:87], v[184:187], v[52:55], v[84:87]
s_waitcnt lgkmcnt(7)
v_mfma_f32_16x16x32_bf16 v[88:91], v[144:147], v[48:51], v[88:91]
ds_read_b128 v[180:183], v7 offset:9216
v_mfma_f32_16x16x32_bf16 v[88:91], v[148:151], v[56:59], v[88:91]
v_mfma_f32_16x16x32_bf16 v[92:95], v[148:151], v[60:63], v[92:95]
ds_read_b128 v[184:187], v7 offset:10240
v_mfma_f32_16x16x32_bf16 v[92:95], v[144:147], v[52:55], v[92:95]
s_waitcnt lgkmcnt(7)
v_mfma_f32_16x16x32_bf16 v[96:99], v[152:155], v[48:51], v[96:99]
ds_read_b128 v[188:191], v7 offset:11264
v_mfma_f32_16x16x32_bf16 v[96:99], v[156:159], v[56:59], v[96:99]
v_mfma_f32_16x16x32_bf16 v[100:103], v[156:159], v[60:63], v[100:103]
ds_read_b128 v[144:147], v7 offset:12288
v_mfma_f32_16x16x32_bf16 v[100:103], v[152:155], v[52:55], v[100:103]
s_waitcnt lgkmcnt(7) vmcnt(9)
v_mfma_f32_16x16x32_bf16 v[120:123], v[160:163], v[64:67], v[120:123]
s_waitcnt vmcnt(8)
ds_read_b128 v[148:151], v7 offset:13312
v_mfma_f32_16x16x32_bf16 v[124:127], v[160:163], v[68:71], v[124:127]
v_mfma_f32_16x16x32_bf16 v[72:75], v[164:167], v[64:67], v[72:75]
ds_read_b128 v[152:155], v7 offset:14336
v_mfma_f32_16x16x32_bf16 v[76:79], v[164:167], v[68:71], v[76:79]
s_waitcnt lgkmcnt(7)
v_mfma_f32_16x16x32_bf16 v[80:83], v[168:171], v[64:67], v[80:83]
ds_read_b128 v[156:159], v7 offset:15360
v_mfma_f32_16x16x32_bf16 v[84:87], v[168:171], v[68:71], v[84:87]
s_add_u32 s91, s91, 16384
s_cmp_ge_u32 s91, 163840
s_cselect_b32 s91, 0, s91
v_mfma_f32_16x16x32_bf16 v[88:91], v[172:175], v[64:67], v[88:91]
ds_read_b128 v[160:163], v8 offset:0
v_add_u32 v7, s91, v4
v_mfma_f32_16x16x32_bf16 v[92:95], v[172:175], v[68:71], v[92:95]
s_waitcnt lgkmcnt(7)
v_mfma_f32_16x16x32_bf16 v[96:99], v[176:179], v[64:67], v[96:99]
ds_read_b128 v[164:167], v8 offset:1024
v_cvt_pk_bf16_f32 v228, v120, v121
v_mfma_f32_16x16x32_bf16 v[100:103], v[176:179], v[68:71], v[100:103]
v_cvt_pk_bf16_f32 v229, v122, v123
v_mfma_f32_16x16x32_bf16 v[104:107], v[180:183], a[64:67], v[104:107]
s_waitcnt lgkmcnt(6)
ds_read_b128 v[168:171], v8 offset:2048
v_cvt_pk_bf16_f32 v230, v124, v125
v_mfma_f32_16x16x32_bf16 v[104:107], v[184:187], a[72:75], v[104:107]
v_cvt_pk_bf16_f32 v231, v126, v127
v_mfma_f32_16x16x32_bf16 v[108:111], v[184:187], a[76:79], v[108:111]
buffer_store_dwordx4 v[228:231], v15, s[24:27], s55 offen offset:0 sc1
v_mfma_f32_16x16x32_bf16 v[108:111], v[180:183], a[68:71], v[108:111]
ds_read_b128 v[172:175], v8 offset:3072
v_cvt_pk_bf16_f32 v72, v72, v73
v_mfma_f32_16x16x32_bf16 v[112:115], v[188:191], a[64:67], v[112:115]
s_waitcnt lgkmcnt(6)
ds_read_b128 v[176:179], v8 offset:4096
v_cvt_pk_bf16_f32 v73, v74, v75
v_mfma_f32_16x16x32_bf16 v[112:115], v[144:147], a[72:75], v[112:115]
v_cvt_pk_bf16_f32 v74, v80, v81
v_mfma_f32_16x16x32_bf16 v[116:119], v[144:147], a[76:79], v[116:119]
ds_read_b128 v[180:183], v8 offset:5120
v_cvt_pk_bf16_f32 v75, v82, v83
v_mfma_f32_16x16x32_bf16 v[116:119], v[188:191], a[68:71], v[116:119]
buffer_store_dwordx4 v[72:75], v15, s[24:27], s52 offen offset:0 sc1
v_mfma_f32_16x16x32_bf16 v[104:107], v[148:151], a[80:83], v[104:107]
s_waitcnt lgkmcnt(6)
ds_read_b128 v[184:187], v8 offset:6144
v_cvt_pk_bf16_f32 v76, v76, v77
v_mfma_f32_16x16x32_bf16 v[104:107], v[152:155], a[88:91], v[104:107]
v_cvt_pk_bf16_f32 v77, v78, v79
v_mfma_f32_16x16x32_bf16 v[108:111], v[152:155], a[92:95], v[108:111]
ds_read_b128 v[188:191], v8 offset:7168
v_cvt_pk_bf16_f32 v78, v84, v85
v_mfma_f32_16x16x32_bf16 v[108:111], v[148:151], a[84:87], v[108:111]
s_waitcnt lgkmcnt(6)
v_cvt_pk_bf16_f32 v79, v86, v87
v_mfma_f32_16x16x32_bf16 v[112:115], v[156:159], a[80:83], v[112:115]
buffer_store_dwordx4 v[76:79], v15, s[24:27], s52 offen offset:1024 sc1
v_mfma_f32_16x16x32_bf16 v[112:115], v[160:163], a[88:91], v[112:115]
ds_read_b128 v[144:147], v8 offset:8192
v_cvt_pk_bf16_f32 v88, v88, v89
v_mfma_f32_16x16x32_bf16 v[116:119], v[160:163], a[92:95], v[116:119]
ds_read_b128 v[148:151], v8 offset:9216
v_cvt_pk_bf16_f32 v89, v90, v91
v_mfma_f32_16x16x32_bf16 v[116:119], v[156:159], a[84:87], v[116:119]
v_cvt_pk_bf16_f32 v90, v96, v97
v_mfma_f32_16x16x32_bf16 v[104:107], v[164:167], a[192:195], v[104:107]
s_waitcnt lgkmcnt(6)
ds_read_b128 v[152:155], v8 offset:10240
v_cvt_pk_bf16_f32 v91, v98, v99
v_mfma_f32_16x16x32_bf16 v[104:107], v[168:171], a[200:203], v[104:107]
buffer_store_dwordx4 v[88:91], v15, s[24:27], s53 offen offset:0 sc1
v_mfma_f32_16x16x32_bf16 v[108:111], v[168:171], a[204:207], v[108:111]
ds_read_b128 v[156:159], v8 offset:11264
v_cvt_pk_bf16_f32 v92, v92, v93
v_mfma_f32_16x16x32_bf16 v[108:111], v[164:167], a[196:199], v[108:111]
v_cvt_pk_bf16_f32 v93, v94, v95
v_mfma_f32_16x16x32_bf16 v[112:115], v[172:175], a[192:195], v[112:115]
s_waitcnt lgkmcnt(6)
ds_read_b128 v[160:163], v8 offset:12288
v_cvt_pk_bf16_f32 v94, v100, v101
v_mfma_f32_16x16x32_bf16 v[112:115], v[176:179], a[200:203], v[112:115]
s_waitcnt lgkmcnt(5)
v_cvt_pk_bf16_f32 v95, v102, v103
v_mfma_f32_16x16x32_bf16 v[116:119], v[176:179], a[204:207], v[116:119]
buffer_store_dwordx4 v[92:95], v15, s[24:27], s53 offen offset:1024 sc1
v_mfma_f32_16x16x32_bf16 v[116:119], v[172:175], a[196:199], v[116:119]
s_mov_b32 m0, s70
s_mov_b32 s64, s68
s_add_u32 s68, s68, 16384
v_mfma_f32_16x16x32_bf16 v[104:107], v[180:183], a[208:211], v[104:107]
s_add_u32 s70, s70, 16384
s_cmp_ge_u32 s70, 163840
s_cselect_b32 s70, s80, s70
v_mfma_f32_16x16x32_bf16 v[104:107], v[184:187], a[216:219], v[104:107]
buffer_load_dwordx4 v15, s[24:27], s64 offen offset:0 sc1 lds
v_mfma_f32_16x16x32_bf16 v[108:111], v[184:187], a[220:223], v[108:111]
s_waitcnt vmcnt(6) lgkmcnt(3)
ds_read_b128 v[164:167], v8 offset:13312
v_mfma_f32_16x16x32_bf16 v[108:111], v[180:183], a[212:215], v[108:111]
s_barrier
v_mfma_f32_16x16x32_bf16 v[112:115], v[188:191], a[208:211], v[112:115]
buffer_load_dwordx4 v15, s[24:27], s64 offen offset:1024 sc1 lds
v_mfma_f32_16x16x32_bf16 v[112:115], v[144:147], a[216:219], v[112:115]
ds_read_b128 v[168:171], v8 offset:14336
v_mfma_f32_16x16x32_bf16 v[116:119], v[144:147], a[220:223], v[116:119]
ds_read_b128 v[172:175], v8 offset:15360
v_mfma_f32_16x16x32_bf16 v[116:119], v[188:191], a[212:215], v[116:119]
buffer_load_dwordx4 v15, s[24:27], s64 offen offset:2048 sc1 lds
v_mfma_f32_16x16x32_bf16 v[104:107], v[148:151], a[224:227], v[104:107]
s_waitcnt lgkmcnt(4)
s_add_u32 s91, s91, 16384
ds_read_b128 v[176:179], v7 offset:0
v_mfma_f32_16x16x32_bf16 v[104:107], v[152:155], a[232:235], v[104:107]
s_cmp_ge_u32 s91, 163840
s_cselect_b32 s91, 0, s91
ds_read_b128 v[180:183], v7 offset:1024
v_mfma_f32_16x16x32_bf16 v[108:111], v[152:155], a[236:239], v[108:111]
buffer_load_dwordx4 v15, s[24:27], s64 offen offset:3072 sc1 lds
v_mfma_f32_16x16x32_bf16 v[108:111], v[148:151], a[228:231], v[108:111]
s_mov_b32 m0, s70
s_mov_b32 s64, s68
s_add_u32 s68, s68, 16384
v_mfma_f32_16x16x32_bf16 v[112:115], v[156:159], a[224:227], v[112:115]
s_waitcnt lgkmcnt(4)
ds_read_b128 v[184:187], v7 offset:2048
v_add_u32 v8, s91, v4
v_mfma_f32_16x16x32_bf16 v[112:115], v[160:163], a[232:235], v[112:115]
s_add_u32 s70, s70, 16384
s_cmp_ge_u32 s70, 163840
s_cselect_b32 s70, s80, s70
v_mfma_f32_16x16x32_bf16 v[116:119], v[160:163], a[236:239], v[116:119]
buffer_load_dwordx4 v15, s[24:27], s64 offen offset:0 sc1 lds
v_mfma_f32_16x16x32_bf16 v[116:119], v[156:159], a[228:231], v[116:119]
ds_read_b128 v[188:191], v7 offset:3072
v_mfma_f32_16x16x32_bf16 v[104:107], v[164:167], a[240:243], v[104:107]
s_waitcnt lgkmcnt(4)
ds_read_b128 v[144:147], v7 offset:4096
v_mfma_f32_16x16x32_bf16 v[104:107], v[168:171], a[248:251], v[104:107]
buffer_load_dwordx4 v15, s[24:27], s64 offen offset:1024 sc1 lds
v_mfma_f32_16x16x32_bf16 v[108:111], v[168:171], a[252:255], v[108:111]
ds_read_b128 v[148:151], v7 offset:5120
v_mfma_f32_16x16x32_bf16 v[108:111], v[164:167], a[244:247], v[108:111]
s_waitcnt lgkmcnt(4)
ds_read_b128 v[152:155], v7 offset:6144
v_mfma_f32_16x16x32_bf16 v[112:115], v[172:175], a[240:243], v[112:115]
buffer_load_dwordx4 v15, s[24:27], s64 offen offset:2048 sc1 lds
v_mfma_f32_16x16x32_bf16 v[112:115], v[176:179], a[248:251], v[112:115]
ds_read_b128 v[156:159], v7 offset:7168
v_mfma_f32_16x16x32_bf16 v[116:119], v[176:179], a[252:255], v[116:119]
ds_read_b128 v[160:163], v7 offset:8192
v_mfma_f32_16x16x32_bf16 v[116:119], v[172:175], a[244:247], v[116:119]
buffer_load_dwordx4 v15, s[24:27], s64 offen offset:3072 sc1 lds
v_mfma_f32_16x16x32_bf16 v[104:107], v[180:183], a[96:99], v[104:107]
s_waitcnt lgkmcnt(5)
ds_read_b128 v[164:167], v7 offset:9216
v_mfma_f32_16x16x32_bf16 v[104:107], v[184:187], a[104:107], v[104:107]
ds_read_b128 v[168:171], v7 offset:10240
v_mfma_f32_16x16x32_bf16 v[108:111], v[184:187], a[108:111], v[108:111]
ds_read_b128 v[172:175], v7 offset:11264
v_mfma_f32_16x16x32_bf16 v[108:111], v[180:183], a[100:103], v[108:111]
v_mfma_f32_16x16x32_bf16 v[112:115], v[188:191], a[96:99], v[112:115]
s_waitcnt lgkmcnt(6)
ds_read_b128 v[176:179], v7 offset:12288
v_mfma_f32_16x16x32_bf16 v[112:115], v[144:147], a[104:107], v[112:115]
v_mfma_f32_16x16x32_bf16 v[116:119], v[144:147], a[108:111], v[116:119]
ds_read_b128 v[180:183], v7 offset:13312
v_mfma_f32_16x16x32_bf16 v[116:119], v[188:191], a[100:103], v[116:119]
v_mfma_f32_16x16x32_bf16 v[104:107], v[148:151], a[112:115], v[104:107]
s_waitcnt lgkmcnt(6)
ds_read_b128 v[184:187], v7 offset:14336
v_mfma_f32_16x16x32_bf16 v[104:107], v[152:155], a[120:123], v[104:107]
v_mfma_f32_16x16x32_bf16 v[108:111], v[152:155], a[124:127], v[108:111]
ds_read_b128 v[188:191], v7 offset:15360
v_mfma_f32_16x16x32_bf16 v[108:111], v[148:151], a[116:119], v[108:111]
s_add_u32 s91, s91, 16384
s_cmp_ge_u32 s91, 163840
s_cselect_b32 s91, 0, s91
v_mfma_f32_16x16x32_bf16 v[112:115], v[156:159], a[112:115], v[112:115]
s_waitcnt lgkmcnt(6)
ds_read_b128 v[144:147], v8 offset:0
v_add_u32 v7, s91, v4
v_mfma_f32_16x16x32_bf16 v[112:115], v[160:163], a[120:123], v[112:115]
v_mfma_f32_16x16x32_bf16 v[116:119], v[160:163], a[124:127], v[116:119]
ds_read_b128 v[148:151], v8 offset:1024
v_mfma_f32_16x16x32_bf16 v[116:119], v[156:159], a[116:119], v[116:119]
s_waitcnt lgkmcnt(6)
v_mfma_f32_16x16x32_bf16 v[104:107], v[164:167], a[128:131], v[104:107]
s_mov_b32 m0, s70
s_mov_b32 s64, s68
s_add_u32 s68, s68, 16384
v_mfma_f32_16x16x32_bf16 v[104:107], v[168:171], a[136:139], v[104:107]
ds_read_b128 v[152:155], v8 offset:2048
v_mfma_f32_16x16x32_bf16 v[108:111], v[168:171], a[140:143], v[108:111]
s_add_u32 s70, s70, 16384
s_cmp_ge_u32 s70, 163840
s_cselect_b32 s70, s80, s70
v_mfma_f32_16x16x32_bf16 v[108:111], v[164:167], a[132:135], v[108:111]
buffer_load_dwordx4 v15, s[24:27], s64 offen offset:0 sc1 lds
v_mfma_f32_16x16x32_bf16 v[112:115], v[172:175], a[128:131], v[112:115]
s_waitcnt lgkmcnt(5)
ds_read_b128 v[156:159], v8 offset:3072
v_mfma_f32_16x16x32_bf16 v[112:115], v[176:179], a[136:139], v[112:115]
ds_read_b128 v[160:163], v8 offset:4096
v_mfma_f32_16x16x32_bf16 v[116:119], v[176:179], a[140:143], v[116:119]
buffer_load_dwordx4 v15, s[24:27], s64 offen offset:1024 sc1 lds
v_mfma_f32_16x16x32_bf16 v[116:119], v[172:175], a[132:135], v[116:119]
ds_read_b128 v[164:167], v8 offset:5120
v_mfma_f32_16x16x32_bf16 v[104:107], v[180:183], a[144:147], v[104:107]
s_waitcnt vmcnt(10) lgkmcnt(6)
ds_read_b128 v[168:171], v8 offset:6144
v_mfma_f32_16x16x32_bf16 v[104:107], v[184:187], a[152:155], v[104:107]
buffer_atomic_add v1, v0, s[24:27], s73 offen offset:0 sc1
v_mfma_f32_16x16x32_bf16 v[108:111], v[184:187], a[156:159], v[108:111]
buffer_load_dwordx4 v15, s[24:27], s64 offen offset:2048 sc1 lds
v_mfma_f32_16x16x32_bf16 v[108:111], v[180:183], a[148:151], v[108:111]
ds_read_b128 v[172:175], v8 offset:7168
v_mfma_f32_16x16x32_bf16 v[112:115], v[188:191], a[144:147], v[112:115]
s_waitcnt lgkmcnt(6)
ds_read_b128 v[176:179], v8 offset:8192
v_mfma_f32_16x16x32_bf16 v[112:115], v[144:147], a[152:155], v[112:115]
buffer_load_dwordx4 v15, s[24:27], s64 offen offset:3072 sc1 lds
v_mfma_f32_16x16x32_bf16 v[116:119], v[144:147], a[156:159], v[116:119]
s_mov_b32 m0, s70
s_mov_b32 s64, s68
s_add_u32 s68, s68, 16384
v_mfma_f32_16x16x32_bf16 v[116:119], v[188:191], a[148:151], v[116:119]
s_waitcnt lgkmcnt(5)
ds_read_b128 v[180:183], v8 offset:9216
v_mfma_f32_16x16x32_bf16 v[104:107], v[148:151], a[160:163], v[104:107]
s_add_u32 s70, s70, 16384
s_cmp_ge_u32 s70, 163840
s_cselect_b32 s70, s80, s70
v_mfma_f32_16x16x32_bf16 v[104:107], v[152:155], a[168:171], v[104:107]
buffer_load_dwordx4 v15, s[24:27], s64 offen offset:0 sc1 lds
v_mfma_f32_16x16x32_bf16 v[108:111], v[152:155], a[172:175], v[108:111]
ds_read_b128 v[184:187], v8 offset:10240
v_mfma_f32_16x16x32_bf16 v[108:111], v[148:151], a[164:167], v[108:111]
s_waitcnt lgkmcnt(5)
ds_read_b128 v[188:191], v8 offset:11264
v_mfma_f32_16x16x32_bf16 v[112:115], v[156:159], a[160:163], v[112:115]
buffer_load_dwordx4 v15, s[24:27], s64 offen offset:1024 sc1 lds
v_mfma_f32_16x16x32_bf16 v[112:115], v[160:163], a[168:171], v[112:115]
ds_read_b128 v[144:147], v8 offset:12288
v_mfma_f32_16x16x32_bf16 v[116:119], v[160:163], a[172:175], v[116:119]
s_add_u32 s82, s84, 3
ds_read_b128 v[148:151], v8 offset:13312
v_mfma_f32_16x16x32_bf16 v[116:119], v[156:159], a[164:167], v[116:119]
buffer_load_dwordx4 v15, s[24:27], s64 offen offset:2048 sc1 lds
v_mfma_f32_16x16x32_bf16 v[104:107], v[164:167], a[176:179], v[104:107]
s_and_b32 s82, s82, 3
s_waitcnt lgkmcnt(6)
ds_read_b128 v[152:155], v8 offset:14336
v_mfma_f32_16x16x32_bf16 v[104:107], v[168:171], a[184:187], v[104:107]
v_mfma_f32_16x16x32_bf16 v[108:111], v[168:171], a[188:191], v[108:111]
s_waitcnt vmcnt(8)
s_lshl_b32 s82, s82, 7
ds_read_b128 v[156:159], v8 offset:15360
v_mfma_f32_16x16x32_bf16 v[108:111], v[164:167], a[180:183], v[108:111]
s_barrier
v_mfma_f32_16x16x32_bf16 v[112:115], v[172:175], a[176:179], v[112:115]
s_add_u32 s82, s82, s73
s_waitcnt lgkmcnt(6)
ds_read_b128 v[160:163], v7 offset:0
v_mfma_f32_16x16x32_bf16 v[112:115], v[176:179], a[184:187], v[112:115]
buffer_load_dwordx4 v15, s[24:27], s64 offen offset:3072 sc1 lds
v_mfma_f32_16x16x32_bf16 v[116:119], v[176:179], a[188:191], v[116:119]
s_lshl_b32 s75, s84, 7
s_add_u32 s91, s91, 16384
ds_read_b128 v[164:167], v7 offset:1024
v_mfma_f32_16x16x32_bf16 v[116:119], v[172:175], a[180:183], v[116:119]
s_cmp_ge_u32 s91, 163840
s_cselect_b32 s91, 0, s91
v_add_u32 v8, s91, v4
v_mfma_f32_16x16x32_bf16 v[104:107], v[180:183], v[32:35], v[104:107]
s_add_u32 s75, s75, s73
s_waitcnt lgkmcnt(6)
ds_read_b128 v[168:171], v7 offset:2048
v_mfma_f32_16x16x32_bf16 v[104:107], v[184:187], v[40:43], v[104:107]
v_mfma_f32_16x16x32_bf16 v[108:111], v[184:187], v[44:47], v[108:111]
ds_read_b128 v[172:175], v7 offset:3072
v_mfma_f32_16x16x32_bf16 v[108:111], v[180:183], v[36:39], v[108:111]
v_mfma_f32_16x16x32_bf16 v[112:115], v[188:191], v[32:35], v[112:115]
s_waitcnt lgkmcnt(6)
ds_read_b128 v[176:179], v7 offset:4096
v_mfma_f32_16x16x32_bf16 v[112:115], v[144:147], v[40:43], v[112:115]
v_mfma_f32_16x16x32_bf16 v[116:119], v[144:147], v[44:47], v[116:119]
ds_read_b128 v[180:183], v7 offset:5120
v_mfma_f32_16x16x32_bf16 v[116:119], v[188:191], v[36:39], v[116:119]
v_mfma_f32_16x16x32_bf16 v[104:107], v[148:151], v[48:51], v[104:107]
s_waitcnt lgkmcnt(6)
ds_read_b128 v[184:187], v7 offset:6144
v_mfma_f32_16x16x32_bf16 v[104:107], v[152:155], v[56:59], v[104:107]
v_mfma_f32_16x16x32_bf16 v[108:111], v[152:155], v[60:63], v[108:111]
ds_read_b128 v[188:191], v7 offset:7168
v_mfma_f32_16x16x32_bf16 v[108:111], v[148:151], v[52:55], v[108:111]
v_mfma_f32_16x16x32_bf16 v[112:115], v[156:159], v[48:51], v[112:115]
s_waitcnt lgkmcnt(6)
ds_read_b128 v[144:147], v7 offset:8192
v_mfma_f32_16x16x32_bf16 v[112:115], v[160:163], v[56:59], v[112:115]
v_mfma_f32_16x16x32_bf16 v[116:119], v[160:163], v[60:63], v[116:119]
ds_read_b128 v[148:151], v7 offset:9216
v_mfma_f32_16x16x32_bf16 v[116:119], v[156:159], v[52:55], v[116:119]
v_mfma_f32_16x16x32_bf16 v[104:107], v[164:167], v[64:67], v[104:107]
ds_read_b128 v[152:155], v7 offset:10240
v_mfma_f32_16x16x32_bf16 v[108:111], v[164:167], v[68:71], v[108:111]
s_waitcnt lgkmcnt(7)
v_mfma_f32_16x16x32_bf16 v[112:115], v[168:171], v[64:67], v[112:115]
ds_read_b128 v[156:159], v7 offset:11264
v_mfma_f32_16x16x32_bf16 v[116:119], v[168:171], v[68:71], v[116:119]
v_mfma_f32_16x16x32_bf16 v[128:131], v[172:175], a[0:3], 0
s_waitcnt lgkmcnt(6)
ds_read_b128 v[160:163], v7 offset:12288
v_mfma_f32_16x16x32_bf16 v[128:131], v[176:179], a[8:11], v[128:131]
v_mfma_f32_16x16x32_bf16 v[132:135], v[176:179], a[12:15], 0
ds_read_b128 v[164:167], v7 offset:13312
v_mfma_f32_16x16x32_bf16 v[132:135], v[172:175], a[4:7], v[132:135]
v_mfma_f32_16x16x32_bf16 v[136:139], v[180:183], a[0:3], 0
s_waitcnt lgkmcnt(6)
ds_read_b128 v[168:171], v7 offset:14336
v_mfma_f32_16x16x32_bf16 v[136:139], v[184:187], a[8:11], v[136:139]
v_cvt_pk_bf16_f32 v104, v104, v105
v_mfma_f32_16x16x32_bf16 v[140:143], v[184:187], a[12:15], 0
ds_read_b128 v[172:175], v7 offset:15360
v_cvt_pk_bf16_f32 v105, v106, v107
v_mfma_f32_16x16x32_bf16 v[140:143], v[180:183], a[4:7], v[140:143]
s_add_u32 s91, s91, 16384
v_cvt_pk_bf16_f32 v106, v112, v113
v_mfma_f32_16x16x32_bf16 v[128:131], v[188:191], a[16:19], v[128:131]
s_waitcnt lgkmcnt(6)
ds_read_b128 v[176:179], v8 offset:0
v_cvt_pk_bf16_f32 v107, v114, v115
v_mfma_f32_16x16x32_bf16 v[128:131], v[144:147], a[24:27], v[128:131]
buffer_store_dwordx4 v[104:107], v15, s[24:27], s54 offen offset:0 sc1
v_mfma_f32_16x16x32_bf16 v[132:135], v[144:147], a[28:31], v[132:135]
ds_read_b128 v[180:183], v8 offset:1024
v_cvt_pk_bf16_f32 v108, v108, v109
v_mfma_f32_16x16x32_bf16 v[132:135], v[188:191], a[20:23], v[132:135]
s_cmp_ge_u32 s91, 163840
s_cselect_b32 s91, 0, s91
v_cvt_pk_bf16_f32 v109, v110, v111
v_mfma_f32_16x16x32_bf16 v[136:139], v[148:151], a[16:19], v[136:139]
s_waitcnt lgkmcnt(6)
ds_read_b128 v[184:187], v8 offset:2048
v_cvt_pk_bf16_f32 v110, v116, v117
v_mfma_f32_16x16x32_bf16 v[136:139], v[152:155], a[24:27], v[136:139]
s_waitcnt lgkmcnt(5)
v_cvt_pk_bf16_f32 v111, v118, v119
v_add_u32 v7, s91, v4
v_mfma_f32_16x16x32_bf16 v[140:143], v[152:155], a[28:31], v[140:143]
buffer_store_dwordx4 v[108:111], v15, s[24:27], s54 offen offset:1024 sc1
v_mfma_f32_16x16x32_bf16 v[140:143], v[148:151], a[20:23], v[140:143]
s_mov_b32 m0, s70
s_mov_b32 s64, s68
s_add_u32 s68, s68, 16384
v_mfma_f32_16x16x32_bf16 v[128:131], v[156:159], a[32:35], v[128:131]
s_cmp_lt_u32 s3, 3
s_cselect_b32 s68, s64, 2147418112
ds_read_b128 v[188:191], v8 offset:3072
v_mfma_f32_16x16x32_bf16 v[128:131], v[160:163], a[40:43], v[128:131]
buffer_load_dwordx4 v15, s[24:27], s64 offen offset:0 sc1 lds
v_mfma_f32_16x16x32_bf16 v[132:135], v[160:163], a[44:47], v[132:135]
ds_read_b128 v[144:147], v8 offset:4096
v_mfma_f32_16x16x32_bf16 v[132:135], v[156:159], a[36:39], v[132:135]
s_waitcnt lgkmcnt(5)
ds_read_b128 v[148:151], v8 offset:5120
v_mfma_f32_16x16x32_bf16 v[136:139], v[164:167], a[32:35], v[136:139]
buffer_load_dwordx4 v15, s[24:27], s68 offen offset:1024 sc1 lds
v_mfma_f32_16x16x32_bf16 v[136:139], v[168:171], a[40:43], v[136:139]
ds_read_b128 v[152:155], v8 offset:6144
v_mfma_f32_16x16x32_bf16 v[140:143], v[168:171], a[44:47], v[140:143]
ds_read_b128 v[156:159], v8 offset:7168
v_mfma_f32_16x16x32_bf16 v[140:143], v[164:167], a[36:39], v[140:143]
buffer_load_dwordx4 v15, s[24:27], s68 offen offset:2048 sc1 lds
v_mfma_f32_16x16x32_bf16 v[128:131], v[172:175], a[48:51], v[128:131]
s_waitcnt lgkmcnt(6)
ds_read_b128 v[160:163], v8 offset:8192
v_mfma_f32_16x16x32_bf16 v[128:131], v[176:179], a[56:59], v[128:131]
v_mfma_f32_16x16x32_bf16 v[132:135], v[176:179], a[60:63], v[132:135]
buffer_load_dwordx4 v15, s[24:27], s68 offen offset:3072 sc1 lds
v_mfma_f32_16x16x32_bf16 v[132:135], v[172:175], a[52:55], v[132:135]
buffer_load_dword v12, v10, s[24:27], s73 offen sc1
v_mfma_f32_16x16x32_bf16 v[136:139], v[180:183], a[48:51], v[136:139]
s_waitcnt lgkmcnt(5)
ds_read_b128 v[164:167], v8 offset:9216
v_mfma_f32_16x16x32_bf16 v[136:139], v[184:187], a[56:59], v[136:139]
ds_read_b128 v[168:171], v8 offset:10240
v_mfma_f32_16x16x32_bf16 v[140:143], v[184:187], a[60:63], v[140:143]
ds_read_b128 v[172:175], v8 offset:11264
v_mfma_f32_16x16x32_bf16 v[140:143], v[180:183], a[52:55], v[140:143]
v_mfma_f32_16x16x32_bf16 v[128:131], v[188:191], a[64:67], v[128:131]
s_waitcnt lgkmcnt(6)
ds_read_b128 v[176:179], v8 offset:12288
v_mfma_f32_16x16x32_bf16 v[128:131], v[144:147], a[72:75], v[128:131]
v_mfma_f32_16x16x32_bf16 v[132:135], v[144:147], a[76:79], v[132:135]
ds_read_b128 v[180:183], v8 offset:13312
v_mfma_f32_16x16x32_bf16 v[132:135], v[188:191], a[68:71], v[132:135]
v_mfma_f32_16x16x32_bf16 v[136:139], v[148:151], a[64:67], v[136:139]
s_waitcnt lgkmcnt(6)
ds_read_b128 v[184:187], v8 offset:14336
v_mfma_f32_16x16x32_bf16 v[136:139], v[152:155], a[72:75], v[136:139]
v_mfma_f32_16x16x32_bf16 v[140:143], v[152:155], a[76:79], v[140:143]
s_waitcnt vmcnt(7)
ds_read_b128 v[188:191], v8 offset:15360
v_mfma_f32_16x16x32_bf16 v[140:143], v[148:151], a[68:71], v[140:143]
s_barrier
v_mfma_f32_16x16x32_bf16 v[128:131], v[156:159], a[80:83], v[128:131]
s_waitcnt lgkmcnt(6)
s_add_u32 s91, s91, 16384
ds_read_b128 v[144:147], v7 offset:0
v_mfma_f32_16x16x32_bf16 v[128:131], v[160:163], a[88:91], v[128:131]
s_cmp_ge_u32 s91, 163840
s_cselect_b32 s91, 0, s91
v_add_u32 v8, s91, v4
v_mfma_f32_16x16x32_bf16 v[132:135], v[160:163], a[92:95], v[132:135]
ds_read_b128 v[148:151], v7 offset:1024
v_mfma_f32_16x16x32_bf16 v[132:135], v[156:159], a[84:87], v[132:135]
v_mfma_f32_16x16x32_bf16 v[136:139], v[164:167], a[80:83], v[136:139]
s_waitcnt vmcnt(5) lgkmcnt(6)
ds_read_b128 v[152:155], v7 offset:2048
v_mfma_f32_16x16x32_bf16 v[136:139], v[168:171], a[88:91], v[136:139]
buffer_atomic_add v1, v0, s[24:27], s82 offen offset:128 sc1
v_mfma_f32_16x16x32_bf16 v[140:143], v[168:171], a[92:95], v[140:143]
s_and_b32 s54, s3, 1
ds_read_b128 v[156:159], v7 offset:3072
v_mfma_f32_16x16x32_bf16 v[140:143], v[164:167], a[84:87], v[140:143]
s_mul_i32 s54, s54, 18432
v_mfma_f32_16x16x32_bf16 v[128:131], v[172:175], a[192:195], v[128:131]
s_waitcnt lgkmcnt(6)
s_mul_i32 s55, s86, 288
ds_read_b128 v[160:163], v7 offset:4096
v_mfma_f32_16x16x32_bf16 v[128:131], v[176:179], a[200:203], v[128:131]
s_add_u32 s54, s54, s55
v_mfma_f32_16x16x32_bf16 v[132:135], v[176:179], a[204:207], v[132:135]
s_add_u32 s54, s54, 256
ds_read_b128 v[164:167], v7 offset:5120
v_mfma_f32_16x16x32_bf16 v[132:135], v[172:175], a[196:199], v[132:135]
s_sub_u32 s55, 63, s72
v_mfma_f32_16x16x32_bf16 v[136:139], v[180:183], a[192:195], v[136:139]
s_waitcnt lgkmcnt(6)
s_mul_i32 s55, s55, 36864
ds_read_b128 v[168:171], v7 offset:6144
v_mfma_f32_16x16x32_bf16 v[136:139], v[184:187], a[200:203], v[136:139]
s_waitcnt vmcnt(1)
s_add_u32 s55, s55, s54
v_cmp_gt_u32 vcc, 4, v12
v_mfma_f32_16x16x32_bf16 v[140:143], v[184:187], a[204:207], v[140:143]
s_mul_i32 s52, s72, 36864
ds_read_b128 v[172:175], v7 offset:7168
v_mfma_f32_16x16x32_bf16 v[140:143], v[180:183], a[196:199], v[140:143]
s_waitcnt lgkmcnt(6)
s_add_u32 s54, s54, s52
v_mfma_f32_16x16x32_bf16 v[128:131], v[188:191], a[208:211], v[128:131]
s_cmp_eq_u64 vcc, 0
s_cselect_b32 s81, s69, 2147418112
s_cselect_b32 s93, s71, 2147418112
v_mfma_f32_16x16x32_bf16 v[128:131], v[144:147], a[216:219], v[128:131]
s_lshl_b32 s53, s84, 6
ds_read_b128 v[176:179], v7 offset:8192
v_mfma_f32_16x16x32_bf16 v[132:135], v[144:147], a[220:223], v[132:135]
L_PAD13:
s_cbranch_execz L_MAIN
s_sub_u32 s53, s53, 256
ds_read_b128 v[180:183], v7 offset:9216
v_mfma_f32_16x16x32_bf16 v[132:135], v[188:191], a[212:215], v[132:135]
buffer_load_dwordx4 v[192:195], v15, s[24:27], s81 offen offset:0 sc1
v_mfma_f32_16x16x32_bf16 v[136:139], v[148:151], a[208:211], v[136:139]
s_waitcnt lgkmcnt(6)
s_add_u32 s52, s54, s53
ds_read_b128 v[184:187], v7 offset:10240
v_mfma_f32_16x16x32_bf16 v[136:139], v[152:155], a[216:219], v[136:139]
s_add_u32 s53, s55, s53
v_mfma_f32_16x16x32_bf16 v[140:143], v[152:155], a[220:223], v[140:143]
buffer_load_dwordx4 v[196:199], v15, s[24:27], s81 offen offset:1024 sc1
v_mfma_f32_16x16x32_bf16 v[140:143], v[148:151], a[212:215], v[140:143]
ds_read_b128 v[188:191], v7 offset:11264
v_mfma_f32_16x16x32_bf16 v[128:131], v[156:159], a[224:227], v[128:131]
s_waitcnt lgkmcnt(6)
ds_read_b128 v[144:147], v7 offset:12288
v_mfma_f32_16x16x32_bf16 v[128:131], v[160:163], a[232:235], v[128:131]
buffer_load_dwordx4 v[200:203], v15, s[24:27], s81 offen offset:2048 sc1
v_mfma_f32_16x16x32_bf16 v[132:135], v[160:163], a[236:239], v[132:135]
ds_read_b128 v[148:151], v7 offset:13312
v_mfma_f32_16x16x32_bf16 v[132:135], v[156:159], a[228:231], v[132:135]
s_waitcnt lgkmcnt(6)
v_mfma_f32_16x16x32_bf16 v[136:139], v[164:167], a[224:227], v[136:139]
buffer_load_dwordx4 v[204:207], v15, s[24:27], s81 offen offset:3072 sc1
v_mfma_f32_16x16x32_bf16 v[136:139], v[168:171], a[232:235], v[136:139]
ds_read_b128 v[152:155], v7 offset:14336
v_mfma_f32_16x16x32_bf16 v[140:143], v[168:171], a[236:239], v[140:143]
ds_read_b128 v[156:159], v7 offset:15360
v_mfma_f32_16x16x32_bf16 v[140:143], v[164:167], a[228:231], v[140:143]
buffer_load_dwordx4 v[208:211], v15, s[24:27], s93 offen offset:0 sc1
v_mfma_f32_16x16x32_bf16 v[128:131], v[172:175], a[240:243], v[128:131]
s_waitcnt lgkmcnt(6)
s_add_u32 s91, s91, 16384
ds_read_b128 v[160:163], v8 offset:0
v_mfma_f32_16x16x32_bf16 v[128:131], v[176:179], a[248:251], v[128:131]
s_cmp_ge_u32 s91, 163840
s_cselect_b32 s91, 0, s91
v_add_u32 v7, s91, v4
v_mfma_f32_16x16x32_bf16 v[132:135], v[176:179], a[252:255], v[132:135]
buffer_load_dwordx4 v[212:215], v15, s[24:27], s93 offen offset:1024 sc1
v_mfma_f32_16x16x32_bf16 v[132:135], v[172:175], a[244:247], v[132:135]
ds_read_b128 v[164:167], v8 offset:1024
v_mfma_f32_16x16x32_bf16 v[136:139], v[180:183], a[240:243], v[136:139]
s_waitcnt lgkmcnt(6)
ds_read_b128 v[168:171], v8 offset:2048
v_mfma_f32_16x16x32_bf16 v[136:139], v[184:187], a[248:251], v[136:139]
buffer_load_dwordx4 v[216:219], v15, s[24:27], s93 offen offset:2048 sc1
v_mfma_f32_16x16x32_bf16 v[140:143], v[184:187], a[252:255], v[140:143]
ds_read_b128 v[172:175], v8 offset:3072
v_mfma_f32_16x16x32_bf16 v[140:143], v[180:183], a[244:247], v[140:143]
v_mfma_f32_16x16x32_bf16 v[128:131], v[188:191], a[96:99], v[128:131]
s_waitcnt lgkmcnt(6)
ds_read_b128 v[176:179], v8 offset:4096
v_mfma_f32_16x16x32_bf16 v[128:131], v[144:147], a[104:107], v[128:131]
v_mfma_f32_16x16x32_bf16 v[132:135], v[144:147], a[108:111], v[132:135]
ds_read_b128 v[180:183], v8 offset:5120
v_mfma_f32_16x16x32_bf16 v[132:135], v[188:191], a[100:103], v[132:135]
v_mfma_f32_16x16x32_bf16 v[136:139], v[148:151], a[96:99], v[136:139]
s_waitcnt lgkmcnt(6)
ds_read_b128 v[184:187], v8 offset:6144
v_mfma_f32_16x16x32_bf16 v[136:139], v[152:155], a[104:107], v[136:139]
v_mfma_f32_16x16x32_bf16 v[140:143], v[152:155], a[108:111], v[140:143]
ds_read_b128 v[188:191], v8 offset:7168
v_mfma_f32_16x16x32_bf16 v[140:143], v[148:151], a[100:103], v[140:143]
v_mfma_f32_16x16x32_bf16 v[128:131], v[156:159], a[112:115], v[128:131]
s_waitcnt lgkmcnt(6)
ds_read_b128 v[144:147], v8 offset:8192
v_mfma_f32_16x16x32_bf16 v[128:131], v[160:163], a[120:123], v[128:131]
v_mfma_f32_16x16x32_bf16 v[132:135], v[160:163], a[124:127], v[132:135]
ds_read_b128 v[148:151], v8 offset:9216
v_mfma_f32_16x16x32_bf16 v[132:135], v[156:159], a[116:119], v[132:135]
s_waitcnt lgkmcnt(6)
v_mfma_f32_16x16x32_bf16 v[136:139], v[164:167], a[112:115], v[136:139]
buffer_load_dword v12, v10, s[24:27], s75 offen offset:128 sc1
v_mfma_f32_16x16x32_bf16 v[136:139], v[168:171], a[120:123], v[136:139]
ds_read_b128 v[152:155], v8 offset:10240
v_mfma_f32_16x16x32_bf16 v[140:143], v[168:171], a[124:127], v[140:143]
ds_read_b128 v[156:159], v8 offset:11264
v_mfma_f32_16x16x32_bf16 v[140:143], v[164:167], a[116:119], v[140:143]
v_mfma_f32_16x16x32_bf16 v[128:131], v[172:175], a[128:131], v[128:131]
s_waitcnt lgkmcnt(6)
ds_read_b128 v[160:163], v8 offset:12288
v_mfma_f32_16x16x32_bf16 v[128:131], v[176:179], a[136:139], v[128:131]
v_mfma_f32_16x16x32_bf16 v[132:135], v[176:179], a[140:143], v[132:135]
ds_read_b128 v[164:167], v8 offset:13312
v_mfma_f32_16x16x32_bf16 v[132:135], v[172:175], a[132:135], v[132:135]
v_mfma_f32_16x16x32_bf16 v[136:139], v[180:183], a[128:131], v[136:139]
s_waitcnt lgkmcnt(6)
ds_read_b128 v[168:171], v8 offset:14336
v_mfma_f32_16x16x32_bf16 v[136:139], v[184:187], a[136:139], v[136:139]
v_mfma_f32_16x16x32_bf16 v[140:143], v[184:187], a[140:143], v[140:143]
s_waitcnt vmcnt(10)
ds_read_b128 v[172:175], v8 offset:15360
v_mfma_f32_16x16x32_bf16 v[140:143], v[180:183], a[132:135], v[140:143]
s_barrier
v_mfma_f32_16x16x32_bf16 v[128:131], v[188:191], a[144:147], v[128:131]
s_waitcnt lgkmcnt(6)
ds_read_b128 v[176:179], v7 offset:0
v_mfma_f32_16x16x32_bf16 v[128:131], v[144:147], a[152:155], v[128:131]
v_mfma_f32_16x16x32_bf16 v[132:135], v[144:147], a[156:159], v[132:135]
ds_read_b128 v[180:183], v7 offset:1024
v_mfma_f32_16x16x32_bf16 v[132:135], v[188:191], a[148:151], v[132:135]
v_mfma_f32_16x16x32_bf16 v[136:139], v[148:151], a[144:147], v[136:139]
s_waitcnt lgkmcnt(6)
ds_read_b128 v[184:187], v7 offset:2048
v_mfma_f32_16x16x32_bf16 v[136:139], v[152:155], a[152:155], v[136:139]
v_mfma_f32_16x16x32_bf16 v[140:143], v[152:155], a[156:159], v[140:143]
ds_read_b128 v[188:191], v7 offset:3072
v_mfma_f32_16x16x32_bf16 v[140:143], v[148:151], a[148:151], v[140:143]
v_mfma_f32_16x16x32_bf16 v[128:131], v[156:159], a[160:163], v[128:131]
s_waitcnt lgkmcnt(6)
ds_read_b128 v[144:147], v7 offset:4096
v_mfma_f32_16x16x32_bf16 v[128:131], v[160:163], a[168:171], v[128:131]
v_mfma_f32_16x16x32_bf16 v[132:135], v[160:163], a[172:175], v[132:135]
ds_read_b128 v[148:151], v7 offset:5120
v_mfma_f32_16x16x32_bf16 v[132:135], v[156:159], a[164:167], v[132:135]
v_mfma_f32_16x16x32_bf16 v[136:139], v[164:167], a[160:163], v[136:139]
s_waitcnt lgkmcnt(6)
ds_read_b128 v[152:155], v7 offset:6144
v_mfma_f32_16x16x32_bf16 v[136:139], v[168:171], a[168:171], v[136:139]
v_mfma_f32_16x16x32_bf16 v[140:143], v[168:171], a[172:175], v[140:143]
s_waitcnt vmcnt(0)
ds_read_b128 v[156:159], v7 offset:7168
v_cmp_gt_u32 vcc, 1, v12
v_mfma_f32_16x16x32_bf16 v[140:143], v[164:167], a[164:167], v[140:143]
v_lshlrev_b32 v72, 16, v192
v_and_b32 v73, v13, v192
v_mfma_f32_16x16x32_bf16 v[128:131], v[172:175], a[176:179], v[128:131]
s_waitcnt lgkmcnt(6)
ds_read_b128 v[160:163], v7 offset:8192
v_lshlrev_b32 v74, 16, v193
v_mfma_f32_16x16x32_bf16 v[128:131], v[176:179], a[184:187], v[128:131]
s_cmp_eq_u64 vcc, 0
s_cselect_b32 s77, s83, 2147418112
v_and_b32 v75, v13, v193
v_mfma_f32_16x16x32_bf16 v[132:135], v[176:179], a[188:191], v[132:135]
buffer_load_dwordx4 v[220:223], v15, s[24:27], s77 offen offset:0 sc1
v_mfma_f32_16x16x32_bf16 v[132:135], v[172:175], a[180:183], v[132:135]
s_waitcnt lgkmcnt(5)
ds_read_b128 v[164:167], v7 offset:9216
v_lshlrev_b32 v80, 16, v194
v_mfma_f32_16x16x32_bf16 v[136:139], v[180:183], a[176:179], v[136:139]
buffer_load_dwordx4 v[224:227], v15, s[24:27], s77 offen offset:1024 sc1
v_mfma_f32_16x16x32_bf16 v[136:139], v[184:187], a[184:187], v[136:139]
ds_read_b128 v[168:171], v7 offset:10240
v_and_b32 v81, v13, v194
v_mfma_f32_16x16x32_bf16 v[140:143], v[184:187], a[188:191], v[140:143]
ds_read_b128 v[172:175], v7 offset:11264
v_lshlrev_b32 v82, 16, v195
v_mfma_f32_16x16x32_bf16 v[140:143], v[180:183], a[180:183], v[140:143]
s_waitcnt lgkmcnt(6)
v_and_b32 v83, v13, v195
v_lshlrev_b32 v76, 16, v196
v_mfma_f32_16x16x32_bf16 v[128:131], v[188:191], v[32:35], v[128:131]
buffer_load_dword v11, v10, s[24:27], s73 offen sc1
v_mfma_f32_16x16x32_bf16 v[128:131], v[144:147], v[40:43], v[128:131]
ds_read_b128 v[176:179], v7 offset:12288
v_and_b32 v77, v13, v196
v_mfma_f32_16x16x32_bf16 v[132:135], v[144:147], v[44:47], v[132:135]
buffer_load_dword v12, v10, s[24:27], s75 offen offset:128 sc1
v_mfma_f32_16x16x32_bf16 v[132:135], v[188:191], v[36:39], v[132:135]
v_lshlrev_b32 v78, 16, v197
v_and_b32 v79, v13, v197
v_mfma_f32_16x16x32_bf16 v[136:139], v[148:151], v[32:35], v[136:139]
s_waitcnt lgkmcnt(5)
v_lshlrev_b32 v84, 16, v198
v_and_b32 v85, v13, v198
v_mfma_f32_16x16x32_bf16 v[136:139], v[152:155], v[40:43], v[136:139]
v_lshlrev_b32 v86, 16, v199
v_and_b32 v87, v13, v199
v_mfma_f32_16x16x32_bf16 v[140:143], v[152:155], v[44:47], v[140:143]
v_lshlrev_b32 v88, 16, v200
v_and_b32 v89, v13, v200
v_mfma_f32_16x16x32_bf16 v[140:143], v[148:151], v[36:39], v[140:143]
v_lshlrev_b32 v90, 16, v201
v_and_b32 v91, v13, v201
v_mfma_f32_16x16x32_bf16 v[128:131], v[156:159], v[48:51], v[128:131]
s_waitcnt lgkmcnt(3)
v_lshlrev_b32 v96, 16, v202
v_and_b32 v97, v13, v202
v_mfma_f32_16x16x32_bf16 v[128:131], v[160:163], v[56:59], v[128:131]
v_lshlrev_b32 v98, 16, v203
v_and_b32 v99, v13, v203
v_mfma_f32_16x16x32_bf16 v[132:135], v[160:163], v[60:63], v[132:135]
v_lshlrev_b32 v92, 16, v204
v_and_b32 v93, v13, v204
v_mfma_f32_16x16x32_bf16 v[132:135], v[156:159], v[52:55], v[132:135]
v_lshlrev_b32 v94, 16, v205
v_and_b32 v95, v13, v205
v_mfma_f32_16x16x32_bf16 v[136:139], v[164:167], v[48:51], v[136:139]
s_waitcnt lgkmcnt(1)
v_lshlrev_b32 v100, 16, v206
v_and_b32 v101, v13, v206
v_mfma_f32_16x16x32_bf16 v[136:139], v[168:171], v[56:59], v[136:139]
v_lshlrev_b32 v102, 16, v207
v_and_b32 v103, v13, v207
v_mfma_f32_16x16x32_bf16 v[140:143], v[168:171], v[60:63], v[140:143]
v_mfma_f32_16x16x32_bf16 v[140:143], v[164:167], v[52:55], v[140:143]
v_mfma_f32_16x16x32_bf16 v[128:131], v[172:175], v[64:67], v[128:131]
v_mfma_f32_16x16x32_bf16 v[132:135], v[172:175], v[68:71], v[132:135]
s_waitcnt lgkmcnt(0)
v_mfma_f32_16x16x32_bf16 v[136:139], v[176:179], v[64:67], v[136:139]
v_mfma_f32_16x16x32_bf16 v[140:143], v[176:179], v[68:71], v[140:143]
s_max_u32 s92, s81, s77
s_cmp_lt_u32 s92, 2147418112
s_cbranch_scc1 L_P1
s_mov_b32 s92, 0
s_branch L_S1
L_S0:
s_sleep 8
buffer_load_dword v11, v10, s[24:27], s73 offen sc1
buffer_load_dword v12, v10, s[24:27], s75 offen offset:128 sc1
L_S1:
s_waitcnt vmcnt(0)
v_cmp_gt_u32 vcc, 4, v11
s_add_u32 s92, s92, 1
s_cmp_gt_u32 s92, 1048576
s_cbranch_scc1 L_S2
s_nop 1
s_cbranch_vccnz L_S0
L_S2:
s_cmp_eq_u32 s81, s69
s_cbranch_scc1 L_S4
buffer_load_dwordx4 v[192:195], v15, s[24:27], s69 offen offset:0 sc1
buffer_load_dwordx4 v[196:199], v15, s[24:27], s69 offen offset:1024 sc1
buffer_load_dwordx4 v[200:203], v15, s[24:27], s69 offen offset:2048 sc1
buffer_load_dwordx4 v[204:207], v15, s[24:27], s69 offen offset:3072 sc1
buffer_load_dwordx4 v[208:211], v15, s[24:27], s71 offen offset:0 sc1
buffer_load_dwordx4 v[212:215], v15, s[24:27], s71 offen offset:1024 sc1
buffer_load_dwordx4 v[216:219], v15, s[24:27], s71 offen offset:2048 sc1
s_branch L_S4
L_S3:
s_sleep 2
buffer_load_dword v12, v10, s[24:27], s75 offen offset:128 sc1
s_waitcnt vmcnt(0)
L_S4:
v_cmp_gt_u32 vcc, 1, v12
s_add_u32 s92, s92, 1
s_cmp_gt_u32 s92, 1048576
s_cbranch_scc1 L_S5
s_nop 1
s_cbranch_vccnz L_S3
L_S5:
buffer_load_dwordx4 v[220:223], v15, s[24:27], s83 offen offset:0 sc1
buffer_load_dwordx4 v[224:227], v15, s[24:27], s83 offen offset:1024 sc1
s_cmp_eq_u32 s81, s69
s_cbranch_scc1 L_P1
s_waitcnt vmcnt(2)
v_lshlrev_b32 v72, 16, v192
v_and_b32 v73, v13, v192
v_lshlrev_b32 v74, 16, v193
v_and_b32 v75, v13, v193
v_lshlrev_b32 v80, 16, v194
v_and_b32 v81, v13, v194
v_lshlrev_b32 v82, 16, v195
v_and_b32 v83, v13, v195
v_lshlrev_b32 v76, 16, v196
v_and_b32 v77, v13, v196
v_lshlrev_b32 v78, 16, v197
v_and_b32 v79, v13, v197
v_lshlrev_b32 v84, 16, v198
v_and_b32 v85, v13, v198
v_lshlrev_b32 v86, 16, v199
v_and_b32 v87, v13, v199
v_lshlrev_b32 v88, 16, v200
v_and_b32 v89, v13, v200
v_lshlrev_b32 v90, 16, v201
v_and_b32 v91, v13, v201
v_lshlrev_b32 v96, 16, v202
v_and_b32 v97, v13, v202
v_lshlrev_b32 v98, 16, v203
v_and_b32 v99, v13, v203
v_lshlrev_b32 v92, 16, v204
v_and_b32 v93, v13, v204
v_lshlrev_b32 v94, 16, v205
v_and_b32 v95, v13, v205
v_lshlrev_b32 v100, 16, v206
v_and_b32 v101, v13, v206
v_lshlrev_b32 v102, 16, v207
v_and_b32 v103, v13, v207
L_P1:
s_nop 1
v_pk_add_f32 v[72:73], v[72:73], v[88:89]
v_pk_add_f32 v[74:75], v[74:75], v[90:91]
v_pk_add_f32 v[76:77], v[76:77], v[92:93]
v_pk_add_f32 v[78:79], v[78:79], v[94:95]
v_pk_add_f32 v[80:81], v[80:81], v[96:97]
v_pk_add_f32 v[82:83], v[82:83], v[98:99]
v_pk_add_f32 v[84:85], v[84:85], v[100:101]
v_pk_add_f32 v[86:87], v[86:87], v[102:103]
v_pk_add_f32 v[128:129], v[128:129], v[72:73]
v_pk_add_f32 v[130:131], v[130:131], v[74:75]
v_pk_add_f32 v[132:133], v[132:133], v[76:77]
v_pk_add_f32 v[134:135], v[134:135], v[78:79]
v_pk_add_f32 v[136:137], v[136:137], v[80:81]
v_pk_add_f32 v[138:139], v[138:139], v[82:83]
v_pk_add_f32 v[140:141], v[140:141], v[84:85]
v_pk_add_f32 v[142:143], v[142:143], v[86:87]
s_cmp_lg_u32 s3, s84
s_cbranch_scc1 L_NO9
v_lshlrev_b32 v16, 16, v208
v_and_b32 v17, v13, v208
v_lshlrev_b32 v18, 16, v209
v_and_b32 v19, v13, v209
v_lshlrev_b32 v20, 16, v210
v_and_b32 v21, v13, v210
v_lshlrev_b32 v22, 16, v211
v_and_b32 v23, v13, v211
v_pk_add_f32 v[120:121], v[120:121], v[16:17]
v_pk_add_f32 v[122:123], v[122:123], v[18:19]
v_pk_add_f32 v[124:125], v[124:125], v[20:21]
v_pk_add_f32 v[126:127], v[126:127], v[22:23]
v_lshlrev_b32 v16, 16, v212
v_and_b32 v17, v13, v212
v_lshlrev_b32 v18, 16, v213
v_and_b32 v19, v13, v213
v_lshlrev_b32 v20, 16, v214
v_and_b32 v21, v13, v214
v_lshlrev_b32 v22, 16, v215
v_and_b32 v23, v13, v215
v_pk_add_f32 v[120:121], v[120:121], v[16:17]
v_pk_add_f32 v[122:123], v[122:123], v[18:19]
v_pk_add_f32 v[124:125], v[124:125], v[20:21]
v_pk_add_f32 v[126:127], v[126:127], v[22:23]
v_lshlrev_b32 v16, 16, v216
v_and_b32 v17, v13, v216
v_lshlrev_b32 v18, 16, v217
v_and_b32 v19, v13, v217
v_lshlrev_b32 v20, 16, v218
v_and_b32 v21, v13, v218
v_lshlrev_b32 v22, 16, v219
v_and_b32 v23, v13, v219
v_pk_add_f32 v[120:121], v[120:121], v[16:17]
v_pk_add_f32 v[122:123], v[122:123], v[18:19]
v_pk_add_f32 v[124:125], v[124:125], v[20:21]
v_pk_add_f32 v[126:127], v[126:127], v[22:23]
v_cvt_pk_bf16_f32 v228, v120, v121
v_cvt_pk_bf16_f32 v229, v122, v123
v_cvt_pk_bf16_f32 v230, v124, v125
v_cvt_pk_bf16_f32 v231, v126, v127
s_waitcnt vmcnt(0)
buffer_store_dwordx2 v[228:229], v6, s[44:47], s54 offen sc1
buffer_store_dwordx2 v[230:231], v6, s[44:47], s55 offen sc1
s_branch L_9D
L_NO9:
s_waitcnt vmcnt(0)
L_9D:
v_lshlrev_b32 v16, 16, v220
v_and_b32 v17, v13, v220
v_lshlrev_b32 v18, 16, v221
v_and_b32 v19, v13, v221
v_lshlrev_b32 v20, 16, v222
v_and_b32 v21, v13, v222
v_lshlrev_b32 v22, 16, v223
v_and_b32 v23, v13, v223
v_pk_add_f32 v[128:129], v[128:129], v[16:17]
v_pk_add_f32 v[130:131], v[130:131], v[18:19]
v_pk_add_f32 v[136:137], v[136:137], v[20:21]
v_pk_add_f32 v[138:139], v[138:139], v[22:23]
v_cvt_pk_bf16_f32 v128, v128, v129
v_cvt_pk_bf16_f32 v129, v130, v131
v_cvt_pk_bf16_f32 v130, v136, v137
v_cvt_pk_bf16_f32 v131, v138, v139
s_nop 1
v_permlane16_swap_b32 v128, v130
v_permlane16_swap_b32 v129, v131
buffer_store_dwordx4 v[128:131], v5, s[44:47], s52 offen sc1
v_lshlrev_b32 v16, 16, v224
v_and_b32 v17, v13, v224
v_lshlrev_b32 v18, 16, v225
v_and_b32 v19, v13, v225
v_lshlrev_b32 v20, 16, v226
v_and_b32 v21, v13, v226
v_lshlrev_b32 v22, 16, v227
v_and_b32 v23, v13, v227
v_pk_add_f32 v[132:133], v[132:133], v[16:17]
v_pk_add_f32 v[134:135], v[134:135], v[18:19]
v_pk_add_f32 v[140:141], v[140:141], v[20:21]
v_pk_add_f32 v[142:143], v[142:143], v[22:23]
v_cvt_pk_bf16_f32 v132, v132, v133
v_cvt_pk_bf16_f32 v133, v134, v135
v_cvt_pk_bf16_f32 v134, v140, v141
v_cvt_pk_bf16_f32 v135, v142, v143
s_nop 1
v_permlane16_swap_b32 v132, v134
v_permlane16_swap_b32 v133, v135
buffer_store_dwordx4 v[132:135], v5, s[44:47], s53 offen sc1
L_END:
s_endpgm
L_SE2:
v_accvgpr_read_b32 v180, a224
v_accvgpr_read_b32 v182, a228
v_cmp_nle_f32 vcc, v180, v7
v_cmp_nle_f32 s[96:97], v182, v7
s_nop 3
s_or_b64 vcc, vcc, s[96:97]
s_cbranch_vccnz SLOW0
SLOW0_R:
s_add_u32 s53, s77, 180224
buffer_load_dwordx4 a[112:115], v15, s[24:27], s53 offen offset:0 sc1
v_mul_f32 v8, 0x3fb8aa3b, v8
v_mul_f32 v9, 0x3fb8aa3b, v9
v_exp_f32 v8, v8
v_exp_f32 v9, v9
s_nop 0
v_fma_f32 v180, v180, v8, v180
v_fma_f32 v182, v182, v9, v182
v_rcp_f32 v180, v180
v_rcp_f32 v182, v182
s_add_u32 s52, s78, 4096
v_mov_b32 v181, v180
v_mov_b32 v183, v182
v_pk_mul_f32 v[36:37], v[36:37], v[180:181]
v_pk_mul_f32 v[38:39], v[38:39], v[180:181]
v_pk_mul_f32 v[32:33], v[32:33], v[180:181]
v_pk_mul_f32 v[34:35], v[34:35], v[180:181]
v_cvt_pk_bf16_f32 v36, v36, v37
v_cvt_pk_bf16_f32 v37, v38, v39
v_cvt_pk_bf16_f32 v38, v32, v33
v_cvt_pk_bf16_f32 v39, v34, v35
buffer_store_dwordx4 v[36:39], v15, s[24:27], s78 offen offset:0 sc1
buffer_load_dwordx4 a[116:119], v15, s[24:27], s53 offen offset:1024 sc1
v_pk_mul_f32 v[116:117], v[116:117], v[182:183]
v_pk_mul_f32 v[118:119], v[118:119], v[182:183]
v_pk_mul_f32 v[132:133], v[132:133], v[182:183]
v_pk_mul_f32 v[134:135], v[134:135], v[182:183]
v_cvt_pk_bf16_f32 v116, v116, v117
v_cvt_pk_bf16_f32 v117, v118, v119
v_cvt_pk_bf16_f32 v118, v132, v133
v_cvt_pk_bf16_f32 v119, v134, v135
buffer_store_dwordx4 v[116:119], v15, s[24:27], s78 offen offset:1024 sc1
v_pk_mul_f32 v[196:197], v[196:197], v[180:181]
v_pk_mul_f32 v[198:199], v[198:199], v[180:181]
v_pk_mul_f32 v[204:205], v[204:205], v[180:181]
v_pk_mul_f32 v[206:207], v[206:207], v[180:181]
v_cvt_pk_bf16_f32 v196, v196, v197
v_cvt_pk_bf16_f32 v197, v198, v199
v_cvt_pk_bf16_f32 v198, v204, v205
v_cvt_pk_bf16_f32 v199, v206, v207
buffer_store_dwordx4 v[196:199], v15, s[24:27], s78 offen offset:2048 sc1
v_pk_mul_f32 v[184:185], v[184:185], v[182:183]
v_pk_mul_f32 v[186:187], v[186:187], v[182:183]
v_pk_mul_f32 v[240:241], v[240:241], v[182:183]
buffer_load_dwordx4 a[120:123], v15, s[24:27], s53 offen offset:2048 sc1
v_pk_mul_f32 v[242:243], v[242:243], v[182:183]
v_cvt_pk_bf16_f32 v184, v184, v185
v_cvt_pk_bf16_f32 v185, v186, v187
v_cvt_pk_bf16_f32 v186, v240, v241
v_cvt_pk_bf16_f32 v187, v242, v243
buffer_store_dwordx4 v[184:187], v15, s[24:27], s78 offen offset:3072 sc1
v_pk_mul_f32 v[108:109], v[108:109], v[180:181]
v_pk_mul_f32 v[110:111], v[110:111], v[180:181]
v_pk_mul_f32 v[40:41], v[40:41], v[180:181]
v_pk_mul_f32 v[42:43], v[42:43], v[180:181]
v_cvt_pk_bf16_f32 v108, v108, v109
v_cvt_pk_bf16_f32 v109, v110, v111
v_cvt_pk_bf16_f32 v110, v40, v41
v_cvt_pk_bf16_f32 v111, v42, v43
buffer_store_dwordx4 v[108:111], v15, s[24:27], s52 offen offset:0 sc1
v_pk_mul_f32 v[188:189], v[188:189], v[182:183]
v_pk_mul_f32 v[190:191], v[190:191], v[182:183]
v_pk_mul_f32 v[56:57], v[56:57], v[182:183]
v_pk_mul_f32 v[58:59], v[58:59], v[182:183]
v_cvt_pk_bf16_f32 v188, v188, v189
v_cvt_pk_bf16_f32 v189, v190, v191
buffer_load_dwordx4 a[124:127], v15, s[24:27], s53 offen offset:3072 sc1
v_cvt_pk_bf16_f32 v190, v56, v57
v_cvt_pk_bf16_f32 v191, v58, v59
buffer_store_dwordx4 v[188:191], v15, s[24:27], s52 offen offset:1024 sc1
v_pk_mul_f32 v[80:81], v[80:81], v[180:181]
v_pk_mul_f32 v[82:83], v[82:83], v[180:181]
v_pk_mul_f32 v[168:169], v[168:169], v[180:181]
v_pk_mul_f32 v[170:171], v[170:171], v[180:181]
v_cvt_pk_bf16_f32 v80, v80, v81
v_cvt_pk_bf16_f32 v81, v82, v83
v_cvt_pk_bf16_f32 v82, v168, v169
v_cvt_pk_bf16_f32 v83, v170, v171
buffer_store_dwordx4 v[80:83], v15, s[24:27], s52 offen offset:2048 sc1
v_pk_mul_f32 v[88:89], v[88:89], v[182:183]
v_pk_mul_f32 v[90:91], v[90:91], v[182:183]
v_pk_mul_f32 v[192:193], v[192:193], v[182:183]
v_pk_mul_f32 v[194:195], v[194:195], v[182:183]
v_cvt_pk_bf16_f32 v88, v88, v89
v_cvt_pk_bf16_f32 v89, v90, v91
v_cvt_pk_bf16_f32 v90, v192, v193
v_cvt_pk_bf16_f32 v91, v194, v195
buffer_store_dwordx4 v[88:91], v15, s[24:27], s52 offen offset:3072 sc1
s_branch L_LA
CK_Z:
s_mov_b32 s92, 0
CK_Z_L:
s_sleep 1
buffer_load_dword v23, v22, s[40:43], 0 offen sc1
s_add_u32 s92, s92, 1
s_waitcnt vmcnt(0)
v_cmp_gt_u32 vcc, 1, v23
s_cmp_gt_u32 s92, 1048576
s_cbranch_scc1 CK_Z_R
s_nop 3
s_cbranch_vccnz CK_Z_L
s_branch CK_Z_R
CK_WA:
s_mov_b32 s92, 0
CK_WA_L:
s_sleep 1
buffer_load_dword v30, v29, s[24:27], s89 offen sc1
s_add_u32 s92, s92, 1
s_waitcnt vmcnt(0)
v_cmp_gt_u32 vcc, 18, v30
s_cmp_gt_u32 s92, 1048576
s_cbranch_scc1 CK_WA_R
s_nop 3
s_cbranch_vccnz CK_WA_L
s_branch CK_WA_R
CK_ZA:
s_mov_b32 s92, 0
CK_ZA_L:
s_sleep 1
buffer_load_dword v30, v28, s[40:43], 0 offen sc1
s_add_u32 s92, s92, 1
s_waitcnt vmcnt(0)
v_cmp_gt_u32 vcc, 1, v30
s_cmp_gt_u32 s92, 1048576
s_cbranch_scc1 CK_ZA_R
s_nop 3
s_cbranch_vccnz CK_ZA_L
s_branch CK_ZA_R
CK_KV:
s_mov_b32 s92, 0
CK_KV_L:
s_sleep 1
buffer_load_dword v30, v29, s[24:27], s89 offen offset:4 sc1
s_add_u32 s92, s92, 1
s_waitcnt vmcnt(0)
v_cmp_gt_u32 vcc, 8, v30
s_cmp_gt_u32 s92, 1048576
s_cbranch_scc1 CK_KV_R
s_nop 3
s_cbranch_vccnz CK_KV_L
s_branch CK_KV_R
D0:
v_cndmask_b32 v96, v96, v6, s[56:57]
v_cndmask_b32 v120, v120, v6, s[56:57]
v_mov_b32 v112, v6
v_cndmask_b32 v97, v97, v6, s[58:59]
v_cndmask_b32 v121, v121, v6, s[58:59]
v_mov_b32 v113, v6
v_cndmask_b32 v98, v98, v6, s[60:61]
v_cndmask_b32 v122, v122, v6, s[60:61]
v_mov_b32 v114, v6
v_cndmask_b32 v99, v99, v6, s[62:63]
v_cndmask_b32 v123, v123, v6, s[62:63]
v_mov_b32 v115, v6
s_branch D0_R
CK_Q:
s_mov_b32 s92, 0
CK_Q_L:
s_sleep 1
buffer_load_dword v172, v28, s[24:27], 0 offen sc1
s_add_u32 s92, s92, 1
s_waitcnt vmcnt(0)
v_cmp_gt_u32 vcc, 32, v172
s_cmp_gt_u32 s92, 1048576
s_cbranch_scc1 CK_Q_R
s_nop 3
s_cbranch_vccnz CK_Q_L
s_branch CK_Q_R
CK_ZAA:
s_mov_b32 s92, 0
CK_ZAA_L:
s_sleep 1
buffer_load_dword v12, v10, s[24:27], s75 offen offset:128 sc1
s_add_u32 s92, s92, 1
s_waitcnt vmcnt(0)
v_cmp_gt_u32 vcc, 8, v12
s_cmp_gt_u32 s92, 1048576
s_cbranch_scc1 CK_ZAA_R
s_nop 3
s_cbranch_vccnz CK_ZAA_L
s_branch CK_ZAA_R
SLOW0:
v_add_u32 v20, 4096, v15
s_mov_b32 s54, 0
v_mov_b32 v16, v6
v_mov_b32 v18, v6
SLOW0_P:
s_mov_b32 s53, 0
s_mov_b32 s52, s94
SLOW0_T:
s_add_u32 s55, s52, 24576
buffer_load_dwordx4 a[192:195], v15, s[24:27], s52 offen offset:0 sc1
buffer_load_dwordx4 a[196:199], v15, s[24:27], s52 offen offset:1024 sc1
buffer_load_dwordx4 a[200:203], v15, s[24:27], s52 offen offset:2048 sc1
buffer_load_dwordx4 a[204:207], v15, s[24:27], s52 offen offset:3072 sc1
buffer_load_dwordx4 a[208:211], v20, s[24:27], s52 offen offset:0 sc1
buffer_load_dwordx4 a[212:215], v20, s[24:27], s52 offen offset:1024 sc1
buffer_load_dwordx4 a[216:219], v20, s[24:27], s52 offen offset:2048 sc1
buffer_load_dwordx4 a[220:223], v20, s[24:27], s52 offen offset:3072 sc1
buffer_load_dwordx4 a[64:67], v15, s[24:27], s55 offen offset:0 sc1
buffer_load_dwordx4 a[68:71], v15, s[24:27], s55 offen offset:1024 sc1
buffer_load_dwordx4 a[72:75], v15, s[24:27], s55 offen offset:2048 sc1
buffer_load_dwordx4 a[76:79], v15, s[24:27], s55 offen offset:3072 sc1
buffer_load_dwordx4 a[80:83], v20, s[24:27], s55 offen offset:0 sc1
buffer_load_dwordx4 a[84:87], v20, s[24:27], s55 offen offset:1024 sc1
buffer_load_dwordx4 a[88:91], v20, s[24:27], s55 offen offset:2048 sc1
buffer_load_dwordx4 a[92:95], v20, s[24:27], s55 offen offset:3072 sc1
s_waitcnt vmcnt(0)
v_mfma_f32_16x16x32_bf16 v[44:47], a[192:195], a[32:35], 0
v_mfma_f32_16x16x32_bf16 v[44:47], a[196:199], a[36:39], v[44:47]
v_mfma_f32_16x16x32_bf16 v[44:47], a[200:203], a[28:31], v[44:47]
v_mfma_f32_16x16x32_bf16 v[44:47], a[204:207], a[20:23], v[44:47]
v_mfma_f32_16x16x32_bf16 v[52:55], a[192:195], a[44:47], 0
v_mfma_f32_16x16x32_bf16 v[52:55], a[196:199], a[40:43], v[52:55]
v_mfma_f32_16x16x32_bf16 v[52:55], a[200:203], a[12:15], v[52:55]
v_mfma_f32_16x16x32_bf16 v[52:55], a[204:207], a[4:7], v[52:55]
v_mfma_f32_16x16x32_bf16 v[64:67], a[208:211], a[32:35], 0
v_mfma_f32_16x16x32_bf16 v[64:67], a[212:215], a[36:39], v[64:67]
v_mfma_f32_16x16x32_bf16 v[64:67], a[216:219], a[28:31], v[64:67]
v_mfma_f32_16x16x32_bf16 v[64:67], a[220:223], a[20:23], v[64:67]
v_mfma_f32_16x16x32_bf16 v[212:215], a[208:211], a[44:47], 0
v_mfma_f32_16x16x32_bf16 v[212:215], a[212:215], a[40:43], v[212:215]
v_mfma_f32_16x16x32_bf16 v[212:215], a[216:219], a[12:15], v[212:215]
v_mfma_f32_16x16x32_bf16 v[212:215], a[220:223], a[4:7], v[212:215]
s_nop 7
s_cmp_lg_u32 s53, s66
s_cbranch_scc1 SLOW0_U
v_cndmask_b32 v44, v44, v6, s[56:57]
v_cndmask_b32 v212, v212, v6, s[56:57]
v_mov_b32 v64, v6
v_cndmask_b32 v45, v45, v6, s[58:59]
v_cndmask_b32 v213, v213, v6, s[58:59]
v_mov_b32 v65, v6
v_cndmask_b32 v46, v46, v6, s[60:61]
v_cndmask_b32 v214, v214, v6, s[60:61]
v_mov_b32 v66, v6
v_cndmask_b32 v47, v47, v6, s[62:63]
v_cndmask_b32 v215, v215, v6, s[62:63]
v_mov_b32 v67, v6
SLOW0_U:
s_cmp_lg_u32 s54, 0
s_cbranch_scc1 SLOW0_A
v_max3_f32 v16, v16, v44, v45
v_max3_f32 v16, v16, v46, v47
v_max3_f32 v18, v18, v52, v53
v_max3_f32 v18, v18, v54, v55
v_max3_f32 v16, v16, v64, v65
v_max3_f32 v16, v16, v66, v67
v_max3_f32 v18, v18, v212, v213
v_max3_f32 v18, v18, v214, v215
s_branch SLOW0_N
SLOW0_A:
v_sub_f32 v44, v44, v16
v_sub_f32 v45, v45, v16
v_sub_f32 v46, v46, v16
v_sub_f32 v47, v47, v16
v_sub_f32 v52, v52, v18
v_sub_f32 v53, v53, v18
v_sub_f32 v54, v54, v18
v_sub_f32 v55, v55, v18
v_sub_f32 v64, v64, v16
v_sub_f32 v65, v65, v16
v_sub_f32 v66, v66, v16
v_sub_f32 v67, v67, v16
v_sub_f32 v212, v212, v18
v_sub_f32 v213, v213, v18
v_sub_f32 v214, v214, v18
v_sub_f32 v215, v215, v18
v_exp_f32 v44, v44
v_exp_f32 v45, v45
v_exp_f32 v46, v46
v_exp_f32 v47, v47
v_exp_f32 v52, v52
v_exp_f32 v53, v53
v_exp_f32 v54, v54
v_exp_f32 v55, v55
v_exp_f32 v64, v64
v_exp_f32 v65, v65
v_exp_f32 v66, v66
v_exp_f32 v67, v67
v_exp_f32 v212, v212
v_exp_f32 v213, v213
v_exp_f32 v214, v214
v_exp_f32 v215, v215
s_nop 0
v_cvt_pk_bf16_f32 v124, v44, v45
v_cvt_pk_bf16_f32 v125, v46, v47
v_cvt_pk_bf16_f32 v140, v52, v53
v_cvt_pk_bf16_f32 v141, v54, v55
v_cvt_pk_bf16_f32 v126, v64, v65
v_cvt_pk_bf16_f32 v127, v66, v67
v_cvt_pk_bf16_f32 v142, v212, v213
v_cvt_pk_bf16_f32 v143, v214, v215
s_nop 1
v_mfma_f32_16x16x32_bf16 v[36:39], a[64:67], v[124:127], v[36:39]
v_mfma_f32_16x16x32_bf16 v[116:119], a[64:67], v[140:143], v[116:119]
v_mfma_f32_16x16x32_bf16 v[132:135], a[68:71], v[140:143], v[132:135]
v_mfma_f32_16x16x32_bf16 v[32:35], a[68:71], v[124:127], v[32:35]
v_mfma_f32_16x16x32_bf16 v[196:199], a[72:75], v[124:127], v[196:199]
v_mfma_f32_16x16x32_bf16 v[184:187], a[72:75], v[140:143], v[184:187]
v_mfma_f32_16x16x32_bf16 v[240:243], a[76:79], v[140:143], v[240:243]
v_mfma_f32_16x16x32_bf16 v[204:207], a[76:79], v[124:127], v[204:207]
v_mfma_f32_16x16x32_bf16 v[108:111], a[80:83], v[124:127], v[108:111]
v_mfma_f32_16x16x32_bf16 v[188:191], a[80:83], v[140:143], v[188:191]
v_mfma_f32_16x16x32_bf16 v[56:59], a[84:87], v[140:143], v[56:59]
v_mfma_f32_16x16x32_bf16 v[40:43], a[84:87], v[124:127], v[40:43]
v_mfma_f32_16x16x32_bf16 v[80:83], a[88:91], v[124:127], v[80:83]
v_mfma_f32_16x16x32_bf16 v[88:91], a[88:91], v[140:143], v[88:91]
v_mfma_f32_16x16x32_bf16 v[192:195], a[92:95], v[140:143], v[192:195]
v_mfma_f32_16x16x32_bf16 v[168:171], a[92:95], v[124:127], v[168:171]
v_mfma_f32_16x16x32_bf16 a[224:227], a[240:243], v[124:127], a[224:227]
v_mfma_f32_16x16x32_bf16 a[228:231], a[240:243], v[140:143], a[228:231]
SLOW0_N:
s_add_u32 s52, s52, 16384
s_add_u32 s53, s53, 1
s_cmp_le_u32 s53, s66
s_cbranch_scc1 SLOW0_T
s_cmp_lg_u32 s54, 0
s_cbranch_scc1 SLOW0_E
v_mov_b32 v17, v16
v_mov_b32 v19, v18
s_nop 1
v_permlane32_swap_b32 v17, v16
v_permlane32_swap_b32 v19, v18
s_nop 1
v_max_f32 v16, v16, v17
v_max_f32 v18, v18, v19
v_mov_b32 v17, v16
v_mov_b32 v19, v18
s_nop 1
v_permlane16_swap_b32 v17, v16
v_permlane16_swap_b32 v19, v18
s_nop 1
v_max_f32 v16, v16, v17
v_max_f32 v18, v18, v19
v_mov_b32 v36, 0
v_mov_b32 v37, 0
v_mov_b32 v38, 0
v_mov_b32 v39, 0
v_mov_b32 v32, 0
v_mov_b32 v33, 0
v_mov_b32 v34, 0
v_mov_b32 v35, 0
v_mov_b32 v196, 0
v_mov_b32 v197, 0
v_mov_b32 v198, 0
v_mov_b32 v199, 0
v_mov_b32 v204, 0
v_mov_b32 v205, 0
v_mov_b32 v206, 0
v_mov_b32 v207, 0
v_mov_b32 v108, 0
v_mov_b32 v109, 0
v_mov_b32 v110, 0
v_mov_b32 v111, 0
v_mov_b32 v40, 0
v_mov_b32 v41, 0
v_mov_b32 v42, 0
v_mov_b32 v43, 0
v_mov_b32 v80, 0
v_mov_b32 v81, 0
v_mov_b32 v82, 0
v_mov_b32 v83, 0
v_mov_b32 v168, 0
v_mov_b32 v169, 0
v_mov_b32 v170, 0
v_mov_b32 v171, 0
v_mov_b32 v116, 0
v_mov_b32 v117, 0
v_mov_b32 v118, 0
v_mov_b32 v119, 0
v_mov_b32 v132, 0
v_mov_b32 v133, 0
v_mov_b32 v134, 0
v_mov_b32 v135, 0
v_mov_b32 v184, 0
v_mov_b32 v185, 0
v_mov_b32 v186, 0
v_mov_b32 v187, 0
v_mov_b32 v240, 0
v_mov_b32 v241, 0
v_mov_b32 v242, 0
v_mov_b32 v243, 0
v_mov_b32 v188, 0
v_mov_b32 v189, 0
v_mov_b32 v190, 0
v_mov_b32 v191, 0
v_mov_b32 v56, 0
v_mov_b32 v57, 0
v_mov_b32 v58, 0
v_mov_b32 v59, 0
v_mov_b32 v88, 0
v_mov_b32 v89, 0
v_mov_b32 v90, 0
v_mov_b32 v91, 0
v_mov_b32 v192, 0
v_mov_b32 v193, 0
v_mov_b32 v194, 0
v_mov_b32 v195, 0
v_accvgpr_write_b32 a224, 0
v_accvgpr_write_b32 a225, 0
v_accvgpr_write_b32 a226, 0
v_accvgpr_write_b32 a227, 0
v_accvgpr_write_b32 a228, 0
v_accvgpr_write_b32 a229, 0
v_accvgpr_write_b32 a230, 0
v_accvgpr_write_b32 a231, 0
s_mov_b32 s54, 1
s_branch SLOW0_P
SLOW0_E:
s_nop 7
v_accvgpr_read_b32 v180, a224
v_accvgpr_read_b32 v182, a228
s_branch SLOW0_R
SLOW1:
v_add_u32 v20, 4096, v15
s_mov_b32 s54, 0
v_mov_b32 v16, v6
v_mov_b32 v18, v6
SLOW1_P:
s_mov_b32 s53, 0
s_mov_b32 s52, s94
SLOW1_T:
s_add_u32 s55, s52, 24576
buffer_load_dwordx4 a[192:195], v15, s[24:27], s52 offen offset:0 sc1
buffer_load_dwordx4 a[196:199], v15, s[24:27], s52 offen offset:1024 sc1
buffer_load_dwordx4 a[200:203], v15, s[24:27], s52 offen offset:2048 sc1
buffer_load_dwordx4 a[204:207], v15, s[24:27], s52 offen offset:3072 sc1
buffer_load_dwordx4 a[208:211], v20, s[24:27], s52 offen offset:0 sc1
buffer_load_dwordx4 a[212:215], v20, s[24:27], s52 offen offset:1024 sc1
buffer_load_dwordx4 a[216:219], v20, s[24:27], s52 offen offset:2048 sc1
buffer_load_dwordx4 a[220:223], v20, s[24:27], s52 offen offset:3072 sc1
buffer_load_dwordx4 a[64:67], v15, s[24:27], s55 offen offset:0 sc1
buffer_load_dwordx4 a[68:71], v15, s[24:27], s55 offen offset:1024 sc1
buffer_load_dwordx4 a[72:75], v15, s[24:27], s55 offen offset:2048 sc1
buffer_load_dwordx4 a[76:79], v15, s[24:27], s55 offen offset:3072 sc1
buffer_load_dwordx4 a[80:83], v20, s[24:27], s55 offen offset:0 sc1
buffer_load_dwordx4 a[84:87], v20, s[24:27], s55 offen offset:1024 sc1
buffer_load_dwordx4 a[88:91], v20, s[24:27], s55 offen offset:2048 sc1
buffer_load_dwordx4 a[92:95], v20, s[24:27], s55 offen offset:3072 sc1
s_waitcnt vmcnt(0)
v_mfma_f32_16x16x32_bf16 v[44:47], a[192:195], a[48:51], 0
v_mfma_f32_16x16x32_bf16 v[44:47], a[196:199], a[52:55], v[44:47]
v_mfma_f32_16x16x32_bf16 v[44:47], a[200:203], a[0:3], v[44:47]
v_mfma_f32_16x16x32_bf16 v[44:47], a[204:207], a[8:11], v[44:47]
v_mfma_f32_16x16x32_bf16 v[52:55], a[192:195], a[60:63], 0
v_mfma_f32_16x16x32_bf16 v[52:55], a[196:199], a[56:59], v[52:55]
v_mfma_f32_16x16x32_bf16 v[52:55], a[200:203], a[16:19], v[52:55]
v_mfma_f32_16x16x32_bf16 v[52:55], a[204:207], a[24:27], v[52:55]
v_mfma_f32_16x16x32_bf16 v[64:67], a[208:211], a[48:51], 0
v_mfma_f32_16x16x32_bf16 v[64:67], a[212:215], a[52:55], v[64:67]
v_mfma_f32_16x16x32_bf16 v[64:67], a[216:219], a[0:3], v[64:67]
v_mfma_f32_16x16x32_bf16 v[64:67], a[220:223], a[8:11], v[64:67]
v_mfma_f32_16x16x32_bf16 v[212:215], a[208:211], a[60:63], 0
v_mfma_f32_16x16x32_bf16 v[212:215], a[212:215], a[56:59], v[212:215]
v_mfma_f32_16x16x32_bf16 v[212:215], a[216:219], a[16:19], v[212:215]
v_mfma_f32_16x16x32_bf16 v[212:215], a[220:223], a[24:27], v[212:215]
s_nop 7
s_cmp_lg_u32 s53, s67
s_cbranch_scc1 SLOW1_U
v_cndmask_b32 v44, v44, v6, s[56:57]
v_cndmask_b32 v212, v212, v6, s[56:57]
v_mov_b32 v64, v6
v_cndmask_b32 v45, v45, v6, s[58:59]
v_cndmask_b32 v213, v213, v6, s[58:59]
v_mov_b32 v65, v6
v_cndmask_b32 v46, v46, v6, s[60:61]
v_cndmask_b32 v214, v214, v6, s[60:61]
v_mov_b32 v66, v6
v_cndmask_b32 v47, v47, v6, s[62:63]
v_cndmask_b32 v215, v215, v6, s[62:63]
v_mov_b32 v67, v6
SLOW1_U:
s_cmp_lg_u32 s54, 0
s_cbranch_scc1 SLOW1_A
v_max3_f32 v16, v16, v44, v45
v_max3_f32 v16, v16, v46, v47
v_max3_f32 v18, v18, v52, v53
v_max3_f32 v18, v18, v54, v55
v_max3_f32 v16, v16, v64, v65
v_max3_f32 v16, v16, v66, v67
v_max3_f32 v18, v18, v212, v213
v_max3_f32 v18, v18, v214, v215
s_branch SLOW1_N
SLOW1_A:
v_sub_f32 v44, v44, v16
v_sub_f32 v45, v45, v16
v_sub_f32 v46, v46, v16
v_sub_f32 v47, v47, v16
v_sub_f32 v52, v52, v18
v_sub_f32 v53, v53, v18
v_sub_f32 v54, v54, v18
v_sub_f32 v55, v55, v18
v_sub_f32 v64, v64, v16
v_sub_f32 v65, v65, v16
v_sub_f32 v66, v66, v16
v_sub_f32 v67, v67, v16
v_sub_f32 v212, v212, v18
v_sub_f32 v213, v213, v18
v_sub_f32 v214, v214, v18
v_sub_f32 v215, v215, v18
v_exp_f32 v44, v44
v_exp_f32 v45, v45
v_exp_f32 v46, v46
v_exp_f32 v47, v47
v_exp_f32 v52, v52
v_exp_f32 v53, v53
v_exp_f32 v54, v54
v_exp_f32 v55, v55
v_exp_f32 v64, v64
v_exp_f32 v65, v65
v_exp_f32 v66, v66
v_exp_f32 v67, v67
v_exp_f32 v212, v212
v_exp_f32 v213, v213
v_exp_f32 v214, v214
v_exp_f32 v215, v215
s_nop 0
v_cvt_pk_bf16_f32 v124, v44, v45
v_cvt_pk_bf16_f32 v125, v46, v47
v_cvt_pk_bf16_f32 v140, v52, v53
v_cvt_pk_bf16_f32 v141, v54, v55
v_cvt_pk_bf16_f32 v126, v64, v65
v_cvt_pk_bf16_f32 v127, v66, v67
v_cvt_pk_bf16_f32 v142, v212, v213
v_cvt_pk_bf16_f32 v143, v214, v215
s_nop 1
v_mfma_f32_16x16x32_bf16 v[60:63], a[64:67], v[124:127], v[60:63]
v_mfma_f32_16x16x32_bf16 v[148:151], a[64:67], v[140:143], v[148:151]
v_mfma_f32_16x16x32_bf16 v[48:51], a[68:71], v[140:143], v[48:51]
v_mfma_f32_16x16x32_bf16 v[68:71], a[68:71], v[124:127], v[68:71]
v_mfma_f32_16x16x32_bf16 v[72:75], a[72:75], v[124:127], v[72:75]
v_mfma_f32_16x16x32_bf16 v[236:239], a[72:75], v[140:143], v[236:239]
v_mfma_f32_16x16x32_bf16 v[224:227], a[76:79], v[140:143], v[224:227]
v_mfma_f32_16x16x32_bf16 v[220:223], a[76:79], v[124:127], v[220:223]
v_mfma_f32_16x16x32_bf16 v[84:87], a[80:83], v[124:127], v[84:87]
v_mfma_f32_16x16x32_bf16 v[164:167], a[80:83], v[140:143], v[164:167]
v_mfma_f32_16x16x32_bf16 v[156:159], a[84:87], v[140:143], v[156:159]
v_mfma_f32_16x16x32_bf16 v[76:79], a[84:87], v[124:127], v[76:79]
v_mfma_f32_16x16x32_bf16 v[160:163], a[88:91], v[124:127], v[160:163]
v_mfma_f32_16x16x32_bf16 v[216:219], a[88:91], v[140:143], v[216:219]
v_mfma_f32_16x16x32_bf16 v[208:211], a[92:95], v[140:143], v[208:211]
v_mfma_f32_16x16x32_bf16 v[252:255], a[92:95], v[124:127], v[252:255]
v_mfma_f32_16x16x32_bf16 a[232:235], a[240:243], v[124:127], a[232:235]
v_mfma_f32_16x16x32_bf16 a[236:239], a[240:243], v[140:143], a[236:239]
SLOW1_N:
s_add_u32 s52, s52, 16384
s_add_u32 s53, s53, 1
s_cmp_le_u32 s53, s67
s_cbranch_scc1 SLOW1_T
s_cmp_lg_u32 s54, 0
s_cbranch_scc1 SLOW1_E
v_mov_b32 v17, v16
v_mov_b32 v19, v18
s_nop 1
v_permlane32_swap_b32 v17, v16
v_permlane32_swap_b32 v19, v18
s_nop 1
v_max_f32 v16, v16, v17
v_max_f32 v18, v18, v19
v_mov_b32 v17, v16
v_mov_b32 v19, v18
s_nop 1
v_permlane16_swap_b32 v17, v16
v_permlane16_swap_b32 v19, v18
s_nop 1
v_max_f32 v16, v16, v17
v_max_f32 v18, v18, v19
v_mov_b32 v60, 0
v_mov_b32 v61, 0
v_mov_b32 v62, 0
v_mov_b32 v63, 0
v_mov_b32 v68, 0
v_mov_b32 v69, 0
v_mov_b32 v70, 0
v_mov_b32 v71, 0
v_mov_b32 v72, 0
v_mov_b32 v73, 0
v_mov_b32 v74, 0
v_mov_b32 v75, 0
v_mov_b32 v220, 0
v_mov_b32 v221, 0
v_mov_b32 v222, 0
v_mov_b32 v223, 0
v_mov_b32 v84, 0
v_mov_b32 v85, 0
v_mov_b32 v86, 0
v_mov_b32 v87, 0
v_mov_b32 v76, 0
v_mov_b32 v77, 0
v_mov_b32 v78, 0
v_mov_b32 v79, 0
v_mov_b32 v160, 0
v_mov_b32 v161, 0
v_mov_b32 v162, 0
v_mov_b32 v163, 0
v_mov_b32 v252, 0
v_mov_b32 v253, 0
v_mov_b32 v254, 0
v_mov_b32 v255, 0
v_mov_b32 v148, 0
v_mov_b32 v149, 0
v_mov_b32 v150, 0
v_mov_b32 v151, 0
v_mov_b32 v48, 0
v_mov_b32 v49, 0
v_mov_b32 v50, 0
v_mov_b32 v51, 0
v_mov_b32 v236, 0
v_mov_b32 v237, 0
v_mov_b32 v238, 0
v_mov_b32 v239, 0
v_mov_b32 v224, 0
v_mov_b32 v225, 0
v_mov_b32 v226, 0
v_mov_b32 v227, 0
v_mov_b32 v164, 0
v_mov_b32 v165, 0
v_mov_b32 v166, 0
v_mov_b32 v167, 0
v_mov_b32 v156, 0
v_mov_b32 v157, 0
v_mov_b32 v158, 0
v_mov_b32 v159, 0
v_mov_b32 v216, 0
v_mov_b32 v217, 0
v_mov_b32 v218, 0
v_mov_b32 v219, 0
v_mov_b32 v208, 0
v_mov_b32 v209, 0
v_mov_b32 v210, 0
v_mov_b32 v211, 0
v_accvgpr_write_b32 a232, 0
v_accvgpr_write_b32 a233, 0
v_accvgpr_write_b32 a234, 0
v_accvgpr_write_b32 a235, 0
v_accvgpr_write_b32 a236, 0
v_accvgpr_write_b32 a237, 0
v_accvgpr_write_b32 a238, 0
v_accvgpr_write_b32 a239, 0
s_mov_b32 s54, 1
s_branch SLOW1_P
SLOW1_E:
s_nop 7
v_accvgpr_read_b32 v180, a232
v_accvgpr_read_b32 v182, a236
s_add_u32 s52, s79, 4096
v_fma_f32 v180, v180, v10, v180
v_fma_f32 v182, v182, v11, v182
v_rcp_f32 v180, v180
v_rcp_f32 v182, v182
s_nop 0
v_pk_mul_f32 v[60:61], v[60:61], v[180:181] op_sel_hi:[1,0]
v_pk_mul_f32 v[62:63], v[62:63], v[180:181] op_sel_hi:[1,0]
v_pk_mul_f32 v[68:69], v[68:69], v[180:181] op_sel_hi:[1,0]
v_pk_mul_f32 v[70:71], v[70:71], v[180:181] op_sel_hi:[1,0]
v_cvt_pk_bf16_f32 v60, v60, v61
v_cvt_pk_bf16_f32 v61, v62, v63
v_cvt_pk_bf16_f32 v62, v68, v69
v_cvt_pk_bf16_f32 v63, v70, v71
s_branch L_EP
.section .rodata,"a"
.p2align 6
.amdhsa_kernel gated_mix__sliding_local_dilated__compressed_kv_cla__prompt_kernel
  .amdhsa_next_free_vgpr 512
  .amdhsa_next_free_sgpr 102
  .amdhsa_accum_offset 256
  .amdhsa_group_segment_fixed_size 0
  .amdhsa_kernarg_size 104
  .amdhsa_user_sgpr_count 2
  .amdhsa_user_sgpr_kernarg_segment_ptr 1
  .amdhsa_system_sgpr_workgroup_id_x 1
.end_amdhsa_kernel
```

```asm
; @launch grid=(256,1,1) block=(256,1,1) lds=163840
.amdgcn_target "amdgcn-amd-amdhsa--gfx950"
.text

.globl gated_mix__sliding_local_dilated__compressed_kv_cla__prompt_kernel
.p2align 8
.type gated_mix__sliding_local_dilated__compressed_kv_cla__prompt_kernel,@function
gated_mix__sliding_local_dilated__compressed_kv_cla__prompt_kernel:
s_cmp_ge_u32 s2, 256
s_cbranch_scc1 L_END
s_load_dwordx2 s[8:9], s[0:1], 32
s_load_dwordx2 s[56:57], s[0:1], 56
s_load_dwordx2 s[16:17], s[0:1], 48
s_load_dwordx2 s[24:25], s[0:1], 96
s_load_dwordx2 s[12:13], s[0:1], 0
s_load_dwordx2 s[20:21], s[0:1], 40
s_load_dwordx2 s[28:29], s[0:1], 8
s_load_dwordx2 s[48:49], s[0:1], 16
s_load_dwordx2 s[32:33], s[0:1], 64
s_load_dwordx2 s[36:37], s[0:1], 72
s_load_dwordx2 s[40:41], s[0:1], 88
s_load_dwordx2 s[44:45], s[0:1], 80
s_getpc_b64 s[96:97]
L_PC:
s_lshr_b32 s6, s2, 3
s_lshl_b32 s98, s6, 11
s_add_u32 s98, s98, L_MAIN-L_PC
s_add_u32 s96, s96, s98
s_addc_u32 s97, s97, 0
v_lshlrev_b32 v16, 3, v0
v_mov_b32 v17, s97
v_add_co_u32 v16, vcc, s96, v16
v_lshrrev_b32 v5, 6, v0
v_and_b32 v1, 63, v0
v_addc_co_u32 v17, vcc, 0, v17, vcc
v_readfirstlane_b32 s3, v5
global_load_dwordx2 a[252:253], v[16:17], off
v_and_b32 v2, 15, v0
v_lshrrev_b32 v3, 4, v1
v_lshlrev_b32 v4, 4, v1
s_and_b32 s7, s2, 7
s_and_b32 s65, s6, 3
s_lshl2_add_u32 s4, s7, s65
s_lshr_b32 s5, s6, 2
s_lshl2_add_u32 s66, s5, s3
s_sub_u32 s67, 63, s66
v_lshrrev_b32 v16, 3, v1
v_and_b32 v17, 7, v1
v_xor_b32 v18, v17, v3
v_lshlrev_b32 v19, 10, v16
v_lshl_add_u32 v5, v18, 4, v19
v_xor_b32 v18, 4, v18
v_lshl_add_u32 v6, v18, 4, v19
v_add_u32 v6, 7168, v6
v_and_b32 v18, 1, v3
v_lshlrev_b32 v18, 1, v18
v_xor_b32 v18, v17, v18
v_lshlrev_b32 v19, 13, v16
v_lshl_add_u32 v7, v18, 4, v19
v_xor_b32 v18, 4, v18
v_lshl_add_u32 v8, v18, 4, v19
v_add_u32 v8, 64512, v8
s_add_u32 s69, s65, s5
s_and_b32 s69, s69, 1
s_mul_i32 s64, s7, 2
s_and_b32 s64, s64, 7
s_or_b32 s69, s69, s64
s_add_u32 s93, s65, s5
s_and_b32 s93, s93, 0
s_mul_i32 s64, s7, 1
s_and_b32 s64, s64, 7
s_or_b32 s93, s93, s64
s_lshl_b32 s70, s69, 7
s_lshl_b32 s75, s69, 19
s_lshr_b32 s54, s3, 1
s_and_b32 s55, s3, 1
s_lshl3_add_u32 s87, s54, s5
s_lshl_b32 s64, s55, 5
s_add_u32 s68, s87, s64
s_lshl_b32 s68, s68, 15
s_lshl_b32 s73, s3, 13
s_add_u32 s73, s73, 65536
s_lshl1_add_u32 s74, s4, s55
s_lshl_b32 s74, s74, 7
s_lshl_b32 s64, s54, 18
s_add_u32 s74, s74, s64
s_lshl_b32 s77, s3, 12
s_add_u32 s71, s68, s70
s_add_u32 s76, s74, s75
s_mov_b32 s10, 2097152
s_mov_b32 s11, 0x20000
s_mov_b32 s58, 4194304
s_mov_b32 s59, 0x20000
s_waitcnt lgkmcnt(0)
s_add_u32 m0, s73, 0
s_add_u32 s64, s71, 0
buffer_load_dwordx4 v5, s[8:11], s64 offen lds
buffer_load_dwordx4 v6, s[8:11], s64 offen offset:1024 lds
s_add_u32 m0, s73, 2048
s_add_u32 s64, s71, 16384
buffer_load_dwordx4 v5, s[8:11], s64 offen lds
buffer_load_dwordx4 v6, s[8:11], s64 offen offset:1024 lds
s_add_u32 m0, s77, 0
s_add_u32 s64, s76, 0
buffer_load_dwordx4 v7, s[56:59], s64 offen lds
buffer_load_dwordx4 v8, s[56:59], s64 offen offset:1024 lds
s_add_u32 m0, s77, 2048
s_add_u32 s64, s76, 131072
buffer_load_dwordx4 v7, s[56:59], s64 offen lds
buffer_load_dwordx4 v8, s[56:59], s64 offen offset:1024 lds
s_add_u32 m0, s73, 4096
s_add_u32 s64, s71, 524288
buffer_load_dwordx4 v5, s[8:11], s64 offen lds
buffer_load_dwordx4 v6, s[8:11], s64 offen offset:1024 lds
s_add_u32 m0, s73, 6144
s_add_u32 s64, s71, 540672
buffer_load_dwordx4 v5, s[8:11], s64 offen lds
buffer_load_dwordx4 v6, s[8:11], s64 offen offset:1024 lds
s_mov_b32 s18, 4194304
s_mov_b32 s19, 0x20000
s_lshl_b32 s65, s54, 7
s_lshl_b32 s53, s55, 12
v_lshrrev_b32 v16, 1, v2
v_xor_b32 v16, v16, v3
v_add_u32 v17, s65, v2
v_lshlrev_b32 v17, 7, v17
v_add_u32 v17, 65536, v17
v_lshl_add_u32 v9, v16, 4, v17
v_xor_b32 v10, 64, v9
v_bfe_u32 v16, v1, 2, 2
v_lshl_add_u32 v17, v3, 3, v16
v_lshlrev_b32 v17, 7, v17
v_and_b32 v18, 3, v1
v_lshl_add_u32 v17, v18, 3, v17
v_add_u32 v17, s53, v17
v_lshrrev_b32 v16, 1, v16
v_and_b32 v18, 1, v3
v_lshl_add_u32 v16, v18, 1, v16
v_xor_b32 v18, 0, v16
v_lshl_add_u32 v11, v18, 5, v17
v_xor_b32 v18, 1, v16
v_lshl_add_u32 v12, v18, 5, v17
v_xor_b32 v18, 2, v16
v_lshl_add_u32 v13, v18, 5, v17
v_xor_b32 v18, 3, v16
v_lshl_add_u32 v14, v18, 5, v17
s_add_u32 m0, s77, 16384
s_add_u32 s64, s76, 0
buffer_load_dwordx4 v7, s[16:19], s64 offen lds
buffer_load_dwordx4 v8, s[16:19], s64 offen offset:1024 lds
s_add_u32 m0, s77, 18432
s_add_u32 s64, s76, 131072
buffer_load_dwordx4 v7, s[16:19], s64 offen lds
buffer_load_dwordx4 v8, s[16:19], s64 offen offset:1024 lds
s_mov_b64 exec, 0
s_cmp_eq_u32 s3, 0
s_cbranch_scc1 L_PAD0
s_cmp_eq_u32 s3, 1
s_cbranch_scc1 L_PAD1
s_cmp_eq_u32 s3, 2
s_cbranch_scc1 L_PAD2
s_branch L_PAD3
.p2align 12
.fill 605, 4, 0xbf800000
L_MAIN:
s_mov_b64 exec, -1
s_xor_b32 s71, s70, 128
s_add_u32 s71, s68, s71
s_add_u32 m0, s73, 32768
s_add_u32 s64, s71, 0
buffer_load_dwordx4 v5, s[8:11], s64 offen lds
buffer_load_dwordx4 v6, s[8:11], s64 offen offset:1024 lds
s_add_u32 m0, s73, 34816
s_add_u32 s64, s71, 16384
buffer_load_dwordx4 v5, s[8:11], s64 offen lds
buffer_load_dwordx4 v6, s[8:11], s64 offen offset:1024 lds
s_add_u32 m0, s73, 36864
s_add_u32 s64, s71, 524288
buffer_load_dwordx4 v5, s[8:11], s64 offen lds
buffer_load_dwordx4 v6, s[8:11], s64 offen offset:1024 lds
s_add_u32 m0, s73, 38912
s_add_u32 s64, s71, 540672
buffer_load_dwordx4 v5, s[8:11], s64 offen lds
buffer_load_dwordx4 v6, s[8:11], s64 offen offset:1024 lds
s_waitcnt vmcnt(12)
s_barrier
ds_read_b128 a[64:67], v9 offset:0
ds_read_b128 a[68:71], v10 offset:0
ds_read_b64_tr_b16 a[128:129], v11 offset:0
ds_read_b64_tr_b16 a[130:131], v11 offset:512
ds_read_b64_tr_b16 a[132:133], v11 offset:8192
ds_read_b64_tr_b16 a[134:135], v11 offset:8704
ds_read_b64_tr_b16 a[136:137], v12 offset:0
ds_read_b64_tr_b16 a[138:139], v12 offset:512
ds_read_b64_tr_b16 a[140:141], v12 offset:8192
ds_read_b64_tr_b16 a[142:143], v12 offset:8704
ds_read_b64_tr_b16 a[144:145], v13 offset:0
ds_read_b64_tr_b16 a[146:147], v13 offset:512
ds_read_b64_tr_b16 a[148:149], v13 offset:8192
ds_read_b64_tr_b16 a[150:151], v13 offset:8704
ds_read_b64_tr_b16 a[152:153], v14 offset:0
ds_read_b64_tr_b16 a[154:155], v14 offset:512
ds_read_b64_tr_b16 a[156:157], v14 offset:8192
ds_read_b64_tr_b16 a[158:159], v14 offset:8704
ds_read_b128 a[72:75], v9 offset:2048
ds_read_b128 a[76:79], v10 offset:2048
ds_read_b128 a[80:83], v9 offset:4096
ds_read_b128 a[84:87], v10 offset:4096
ds_read_b128 a[88:91], v9 offset:6144
ds_read_b128 a[92:95], v10 offset:6144
s_waitcnt lgkmcnt(0)
v_mfma_f32_16x16x32_bf16 v[32:35], a[64:67], a[128:131], 0
s_waitcnt vmcnt(8)
v_mfma_f32_16x16x32_bf16 v[32:35], a[68:71], a[132:135], v[32:35]
s_barrier
v_mfma_f32_16x16x32_bf16 v[40:43], a[68:71], a[140:143], 0
s_mov_b32 s26, 268435456
s_mov_b32 s27, 0x20000
ds_read_b128 a[96:99], v9 offset:8192
v_mfma_f32_16x16x32_bf16 v[40:43], a[64:67], a[136:139], v[40:43]
s_xor_b32 s76, s75, 524288
s_add_u32 s76, s74, s76
s_mov_b32 s14, 2359296
v_mfma_f32_16x16x32_bf16 v[48:51], a[64:67], a[144:147], 0
s_add_u32 m0, s77, 32768
s_add_u32 s64, s76, 0
s_mov_b32 s15, 0x20000
v_mfma_f32_16x16x32_bf16 v[48:51], a[68:71], a[148:151], v[48:51]
buffer_load_dwordx4 v7, s[56:59], s64 offen lds
v_mfma_f32_16x16x32_bf16 v[56:59], a[68:71], a[156:159], 0
s_mov_b32 s22, 4718592
s_mov_b32 s23, 0x20000
ds_read_b128 a[100:103], v10 offset:8192
v_mfma_f32_16x16x32_bf16 v[56:59], a[64:67], a[152:155], v[56:59]
buffer_load_dwordx4 v8, s[56:59], s64 offen offset:1024 lds
v_mfma_f32_16x16x32_bf16 v[60:63], a[72:75], a[152:155], 0
s_add_u32 m0, s77, 34816
s_add_u32 s64, s76, 131072
ds_read_b128 a[104:107], v9 offset:10240
v_mfma_f32_16x16x32_bf16 v[60:63], a[76:79], a[156:159], v[60:63]
s_mov_b32 s30, 1990656
s_mov_b32 s31, 0x20000
s_mov_b32 s34, 4718592
v_mfma_f32_16x16x32_bf16 v[52:55], a[76:79], a[148:151], 0
buffer_load_dwordx4 v7, s[56:59], s64 offen lds
v_mfma_f32_16x16x32_bf16 v[52:55], a[72:75], a[144:147], v[52:55]
s_mov_b32 s35, 0x20000
ds_read_b64_tr_b16 a[160:161], v11 offset:16384
ds_read_b64_tr_b16 a[162:163], v11 offset:16896
v_mfma_f32_16x16x32_bf16 v[44:47], a[72:75], a[136:139], 0
s_mov_b32 s38, 1152
s_mov_b32 s39, 0x20000
s_mov_b32 s42, 256
v_mfma_f32_16x16x32_bf16 v[44:47], a[76:79], a[140:143], v[44:47]
buffer_load_dwordx4 v8, s[56:59], s64 offen offset:1024 lds
v_mfma_f32_16x16x32_bf16 v[36:39], a[76:79], a[132:135], 0
s_mov_b32 s43, 0x20000
s_mov_b32 s46, 2359296
s_mov_b32 s47, 0x20000
v_mfma_f32_16x16x32_bf16 v[36:39], a[72:75], a[128:131], v[36:39]
s_add_u32 m0, s77, 49152
s_add_u32 s64, s76, 0
ds_read_b128 a[108:111], v10 offset:10240
v_mfma_f32_16x16x32_bf16 v[64:67], a[80:83], a[128:131], 0
s_mov_b32 s50, 663552
s_mov_b32 s51, 0x20000
s_lshl_b32 s89, s4, 10
v_mfma_f32_16x16x32_bf16 v[64:67], a[84:87], a[132:135], v[64:67]
buffer_load_dwordx4 v7, s[16:19], s64 offen lds
v_mfma_f32_16x16x32_bf16 v[72:75], a[84:87], a[140:143], 0
s_add_u32 s89, s89, 75497472
ds_read_b64_tr_b16 a[164:165], v11 offset:24576
ds_read_b64_tr_b16 a[166:167], v11 offset:25088
v_mfma_f32_16x16x32_bf16 v[72:75], a[80:83], a[136:139], v[72:75]
s_mul_i32 s94, s4, 1064960
s_lshl_b32 s52, s5, 15
s_add_u32 s52, s52, s89
v_mfma_f32_16x16x32_bf16 v[80:83], a[80:83], a[144:147], 0
buffer_load_dwordx4 v8, s[16:19], s64 offen offset:1024 lds
v_mfma_f32_16x16x32_bf16 v[80:83], a[84:87], a[148:151], v[80:83]
s_add_u32 m0, s77, 51200
s_add_u32 s64, s76, 131072
ds_read_b128 a[112:115], v9 offset:12288
v_mfma_f32_16x16x32_bf16 v[88:91], a[84:87], a[156:159], 0
s_lshl_b32 s53, s5, 10
s_add_u32 s53, s53, s94
s_add_u32 s53, s53, 1048576
v_mfma_f32_16x16x32_bf16 v[88:91], a[80:83], a[152:155], v[88:91]
buffer_load_dwordx4 v7, s[16:19], s64 offen lds
v_mfma_f32_16x16x32_bf16 v[92:95], a[88:91], a[152:155], 0
ds_read_b64_tr_b16 a[168:169], v12 offset:16384
ds_read_b64_tr_b16 a[170:171], v12 offset:16896
v_mfma_f32_16x16x32_bf16 v[92:95], a[92:95], a[156:159], v[92:95]
s_cmp_eq_u32 s3, 1
s_cselect_b32 s52, s53, s52
s_mul_i32 s53, s2, 74
v_mfma_f32_16x16x32_bf16 v[84:87], a[92:95], a[148:151], 0
buffer_load_dwordx4 v8, s[16:19], s64 offen offset:1024 lds
v_mfma_f32_16x16x32_bf16 v[84:87], a[88:91], a[144:147], v[84:87]
s_add_u32 s53, s53, s55
s_lshl_b32 s53, s53, 10
s_add_u32 s53, s53, 54599680
v_mfma_f32_16x16x32_bf16 v[76:79], a[88:91], a[136:139], 0
s_cmp_ge_u32 s3, 2
s_cselect_b32 s52, s53, s52
ds_read_b128 a[116:119], v10 offset:12288
v_mfma_f32_16x16x32_bf16 v[76:79], a[92:95], a[140:143], v[76:79]
v_mov_b32 v16, 0
v_mov_b32 v17, 0
v_mfma_f32_16x16x32_bf16 v[68:71], a[92:95], a[132:135], 0
v_mov_b32 v18, 0
v_mov_b32 v19, 0
v_mfma_f32_16x16x32_bf16 v[68:71], a[88:91], a[128:131], v[68:71]
s_waitcnt lgkmcnt(6)
ds_read_b64_tr_b16 a[172:173], v12 offset:24576
ds_read_b64_tr_b16 a[174:175], v12 offset:25088
v_mfma_f32_16x16x32_bf16 v[96:99], a[96:99], a[128:131], 0
v_lshrrev_b32 v20, 3, v1
v_cmp_eq_u32 vcc, 3, v20
v_mfma_f32_16x16x32_bf16 v[96:99], a[100:103], a[132:135], v[96:99]
v_add_u32 v20, 100663168, v4
v_mov_b32 v21, s3
v_mfma_f32_16x16x32_bf16 v[104:107], a[100:103], a[140:143], 0
ds_read_b128 a[120:123], v9 offset:14336
v_cndmask_b32 v15, v4, v20, vcc
v_mfma_f32_16x16x32_bf16 v[104:107], a[96:99], a[136:139], v[104:107]
v_cmp_eq_u32 vcc, 0, v21
v_mov_b32 v21, 0
v_mfma_f32_16x16x32_bf16 v[112:115], a[96:99], a[144:147], 0
v_mov_b32 v21, 0
v_cndmask_b32 v20, v15, v4, vcc
v_mfma_f32_16x16x32_bf16 v[112:115], a[100:103], a[148:151], v[112:115]
ds_read_b64_tr_b16 a[176:177], v13 offset:16384
ds_read_b64_tr_b16 a[178:179], v13 offset:16896
v_mfma_f32_16x16x32_bf16 v[120:123], a[100:103], a[156:159], 0
v_mfma_f32_16x16x32_bf16 v[120:123], a[96:99], a[152:155], v[120:123]
v_mfma_f32_16x16x32_bf16 v[124:127], a[104:107], a[152:155], 0
v_mfma_f32_16x16x32_bf16 v[124:127], a[108:111], a[156:159], v[124:127]
ds_read_b128 a[124:127], v10 offset:14336
v_mfma_f32_16x16x32_bf16 v[116:119], a[108:111], a[148:151], 0
v_add_u32 v9, 32768, v9
v_add_u32 v10, 32768, v10
v_mfma_f32_16x16x32_bf16 v[116:119], a[104:107], a[144:147], v[116:119]
v_mfma_f32_16x16x32_bf16 v[108:111], a[104:107], a[136:139], 0
ds_read_b64_tr_b16 a[180:181], v13 offset:24576
ds_read_b64_tr_b16 a[182:183], v13 offset:25088
v_mfma_f32_16x16x32_bf16 v[108:111], a[108:111], a[140:143], v[108:111]
v_mfma_f32_16x16x32_bf16 v[100:103], a[108:111], a[132:135], 0
v_mfma_f32_16x16x32_bf16 v[100:103], a[104:107], a[128:131], v[100:103]
s_waitcnt lgkmcnt(2)
ds_read_b64_tr_b16 a[184:185], v14 offset:16384
ds_read_b64_tr_b16 a[186:187], v14 offset:16896
v_mfma_f32_16x16x32_bf16 v[128:131], a[112:115], a[128:131], 0
v_mfma_f32_16x16x32_bf16 v[128:131], a[116:119], a[132:135], v[128:131]
v_mfma_f32_16x16x32_bf16 v[136:139], a[116:119], a[140:143], 0
ds_read_b64_tr_b16 a[188:189], v14 offset:24576
ds_read_b64_tr_b16 a[190:191], v14 offset:25088
v_mfma_f32_16x16x32_bf16 v[136:139], a[112:115], a[136:139], v[136:139]
v_mfma_f32_16x16x32_bf16 v[144:147], a[112:115], a[144:147], 0
v_mfma_f32_16x16x32_bf16 v[144:147], a[116:119], a[148:151], v[144:147]
v_mfma_f32_16x16x32_bf16 v[152:155], a[116:119], a[156:159], 0
v_mfma_f32_16x16x32_bf16 v[152:155], a[112:115], a[152:155], v[152:155]
v_mfma_f32_16x16x32_bf16 v[156:159], a[120:123], a[152:155], 0
v_mfma_f32_16x16x32_bf16 v[156:159], a[124:127], a[156:159], v[156:159]
v_mfma_f32_16x16x32_bf16 v[148:151], a[124:127], a[148:151], 0
v_mfma_f32_16x16x32_bf16 v[148:151], a[120:123], a[144:147], v[148:151]
v_mfma_f32_16x16x32_bf16 v[140:143], a[120:123], a[136:139], 0
v_mfma_f32_16x16x32_bf16 v[140:143], a[124:127], a[140:143], v[140:143]
v_mfma_f32_16x16x32_bf16 v[132:135], a[124:127], a[132:135], 0
v_mfma_f32_16x16x32_bf16 v[132:135], a[120:123], a[128:131], v[132:135]
s_waitcnt lgkmcnt(0)
v_mfma_f32_16x16x32_bf16 v[160:163], a[160:163], a[64:67], 0
s_waitcnt vmcnt(4)
v_mfma_f32_16x16x32_bf16 v[160:163], a[164:167], a[68:71], v[160:163]
s_barrier
v_mfma_f32_16x16x32_bf16 v[164:167], a[172:175], a[68:71], 0
ds_read_b64_tr_b16 a[128:129], v11 offset:32768
ds_read_b64_tr_b16 a[130:131], v11 offset:33280
v_mfma_f32_16x16x32_bf16 v[164:167], a[168:171], a[64:67], v[164:167]
s_xor_b32 s71, s70, 256
s_add_u32 s71, s68, s71
v_mfma_f32_16x16x32_bf16 v[168:171], a[176:179], a[64:67], 0
s_add_u32 m0, s73, 65536
s_add_u32 s64, s71, 0
v_mfma_f32_16x16x32_bf16 v[168:171], a[180:183], a[68:71], v[168:171]
buffer_load_dwordx4 v5, s[8:11], s64 offen lds
v_mfma_f32_16x16x32_bf16 v[172:175], a[188:191], a[68:71], 0
v_mfma_f32_16x16x32_bf16 v[172:175], a[184:187], a[64:67], v[172:175]
ds_read_b128 a[64:67], v9 offset:0
v_mfma_f32_16x16x32_bf16 v[188:191], a[184:187], a[72:75], 0
buffer_load_dwordx4 v6, s[8:11], s64 offen offset:1024 lds
v_mfma_f32_16x16x32_bf16 v[188:191], a[188:191], a[76:79], v[188:191]
ds_read_b64_tr_b16 a[132:133], v11 offset:40960
ds_read_b64_tr_b16 a[134:135], v11 offset:41472
v_mfma_f32_16x16x32_bf16 v[184:187], a[180:183], a[76:79], 0
L_PAD0:
s_cbranch_execz L_PAD4
v_mfma_f32_16x16x32_bf16 v[184:187], a[176:179], a[72:75], v[184:187]
s_add_u32 m0, s73, 67584
s_add_u32 s64, s71, 16384
ds_read_b128 a[68:71], v10 offset:0
v_mfma_f32_16x16x32_bf16 v[180:183], a[168:171], a[72:75], 0
v_mfma_f32_16x16x32_bf16 v[180:183], a[172:175], a[76:79], v[180:183]
buffer_load_dwordx4 v5, s[8:11], s64 offen lds
v_mfma_f32_16x16x32_bf16 v[176:179], a[164:167], a[76:79], 0
v_mfma_f32_16x16x32_bf16 v[176:179], a[160:163], a[72:75], v[176:179]
ds_read_b64_tr_b16 a[136:137], v12 offset:32768
ds_read_b64_tr_b16 a[138:139], v12 offset:33280
v_mfma_f32_16x16x32_bf16 v[192:195], a[160:163], a[80:83], 0
v_mfma_f32_16x16x32_bf16 v[192:195], a[164:167], a[84:87], v[192:195]
v_mfma_f32_16x16x32_bf16 v[196:199], a[172:175], a[84:87], 0
buffer_load_dwordx4 v6, s[8:11], s64 offen offset:1024 lds
v_mfma_f32_16x16x32_bf16 v[196:199], a[168:171], a[80:83], v[196:199]
s_xor_b32 s76, s75, 1048576
s_add_u32 s76, s74, s76
ds_read_b128 a[72:75], v9 offset:2048
v_mfma_f32_16x16x32_bf16 v[200:203], a[176:179], a[80:83], 0
v_mfma_f32_16x16x32_bf16 v[200:203], a[180:183], a[84:87], v[200:203]
s_add_u32 m0, s77, 0
s_add_u32 s64, s76, 0
v_mfma_f32_16x16x32_bf16 v[204:207], a[188:191], a[84:87], 0
ds_read_b64_tr_b16 a[140:141], v12 offset:40960
ds_read_b64_tr_b16 a[142:143], v12 offset:41472
v_mfma_f32_16x16x32_bf16 v[204:207], a[184:187], a[80:83], v[204:207]
buffer_load_dwordx4 v7, s[56:59], s64 offen lds
v_mfma_f32_16x16x32_bf16 v[220:223], a[184:187], a[88:91], 0
ds_read_b128 a[76:79], v10 offset:2048
v_mfma_f32_16x16x32_bf16 v[220:223], a[188:191], a[92:95], v[220:223]
v_mfma_f32_16x16x32_bf16 v[216:219], a[180:183], a[92:95], 0
v_mfma_f32_16x16x32_bf16 v[216:219], a[176:179], a[88:91], v[216:219]
v_mfma_f32_16x16x32_bf16 v[212:215], a[168:171], a[88:91], 0
buffer_load_dwordx4 v8, s[56:59], s64 offen offset:1024 lds
v_mfma_f32_16x16x32_bf16 v[212:215], a[172:175], a[92:95], v[212:215]
ds_read_b64_tr_b16 a[144:145], v13 offset:32768
ds_read_b64_tr_b16 a[146:147], v13 offset:33280
v_mfma_f32_16x16x32_bf16 v[208:211], a[164:167], a[92:95], 0
v_mfma_f32_16x16x32_bf16 v[208:211], a[160:163], a[88:91], v[208:211]
s_add_u32 m0, s77, 2048
s_add_u32 s64, s76, 131072
ds_read_b128 a[80:83], v9 offset:4096
v_mfma_f32_16x16x32_bf16 v[224:227], a[160:163], a[96:99], 0
v_mfma_f32_16x16x32_bf16 v[224:227], a[164:167], a[100:103], v[224:227]
buffer_load_dwordx4 v7, s[56:59], s64 offen lds
v_mfma_f32_16x16x32_bf16 v[228:231], a[172:175], a[100:103], 0
ds_read_b64_tr_b16 a[148:149], v13 offset:40960
ds_read_b64_tr_b16 a[150:151], v13 offset:41472
v_mfma_f32_16x16x32_bf16 v[228:231], a[168:171], a[96:99], v[228:231]
v_mfma_f32_16x16x32_bf16 v[232:235], a[176:179], a[96:99], 0
buffer_store_dwordx4 v[16:19], v20, s[24:27], s52 offen sc1
v_mfma_f32_16x16x32_bf16 v[232:235], a[180:183], a[100:103], v[232:235]
buffer_load_dwordx4 v8, s[56:59], s64 offen offset:1024 lds
v_mfma_f32_16x16x32_bf16 v[236:239], a[188:191], a[100:103], 0
s_add_u32 s89, s89, 512
ds_read_b128 a[84:87], v10 offset:4096
v_mfma_f32_16x16x32_bf16 v[236:239], a[184:187], a[96:99], v[236:239]
s_cmp_eq_u32 s3, 0
s_cselect_b32 s90, s89, 2147418112
v_mov_b32 v24, 2147418112
v_mfma_f32_16x16x32_bf16 v[252:255], a[184:187], a[104:107], 0
s_add_u32 m0, s73, 69632
s_add_u32 s64, s71, 524288
v_cmp_eq_u32 vcc, 1, v1
v_mfma_f32_16x16x32_bf16 v[252:255], a[188:191], a[108:111], v[252:255]
s_lshl_b32 s53, s55, 12
ds_read_b64_tr_b16 a[152:153], v14 offset:32768
ds_read_b64_tr_b16 a[154:155], v14 offset:33280
v_mfma_f32_16x16x32_bf16 v[248:251], a[180:183], a[108:111], 0
buffer_load_dwordx4 v5, s[8:11], s64 offen lds
v_mfma_f32_16x16x32_bf16 v[248:251], a[176:179], a[104:107], v[248:251]
v_cndmask_b32 v0, v24, 0, vcc
v_mfma_f32_16x16x32_bf16 v[244:247], a[168:171], a[104:107], 0
s_mul_i32 s87, s87, 16384
s_add_u32 s87, s87, s94
ds_read_b128 a[88:91], v9 offset:6144
v_mfma_f32_16x16x32_bf16 v[244:247], a[172:175], a[108:111], v[244:247]
s_add_u32 s88, s87, s53
s_add_u32 s88, s88, 24576
s_lshr_b32 s53, s53, 1
v_mfma_f32_16x16x32_bf16 v[240:243], a[164:167], a[108:111], 0
s_add_u32 s87, s87, s53
s_lshl_b32 s80, s3, 10
s_mul_i32 s78, s4, 18
v_mfma_f32_16x16x32_bf16 v[240:243], a[160:163], a[104:107], v[240:243]
buffer_load_dwordx4 v6, s[8:11], s64 offen offset:1024 lds
v_mfma_f32_16x16x32_bf16 a[0:3], a[160:163], a[112:115], 0
s_add_u32 s78, s78, s54
ds_read_b64_tr_b16 a[156:157], v14 offset:40960
ds_read_b64_tr_b16 a[158:159], v14 offset:41472
v_mfma_f32_16x16x32_bf16 a[0:3], a[164:167], a[116:119], a[0:3]
s_lshl2_add_u32 s78, s78, s55
s_lshl_b32 s78, s78, 10
s_add_u32 s78, s78, 35651584
v_mfma_f32_16x16x32_bf16 a[4:7], a[172:175], a[116:119], 0
s_add_u32 m0, s73, 71680
s_add_u32 s64, s71, 540672
ds_read_b128 a[92:95], v10 offset:6144
v_mfma_f32_16x16x32_bf16 a[4:7], a[168:171], a[112:115], a[4:7]
s_add_u32 s80, s80, 8192
s_mov_b32 s91, 0x3e0293ee
s_mov_b32 s85, 0x05040100
v_mfma_f32_16x16x32_bf16 a[8:11], a[176:179], a[112:115], 0
buffer_load_dwordx4 v5, s[8:11], s64 offen lds
v_mfma_f32_16x16x32_bf16 a[8:11], a[180:183], a[116:119], a[8:11]
s_mov_b32 s86, 0x07060302
s_lshl2_add_u32 s52, s7, s3
s_and_b32 s65, s6, 3
v_mfma_f32_16x16x32_bf16 a[12:15], a[188:191], a[116:119], 0
s_max_u32 s95, s65, 1
s_mul_i32 s92, s5, 3
s_add_u32 s95, s95, s92
v_mfma_f32_16x16x32_bf16 a[12:15], a[184:187], a[112:115], a[12:15]
s_sub_u32 s95, 24, s95
s_cmp_eq_u32 s65, 1
s_cselect_b32 s95, 63, s95
v_mfma_f32_16x16x32_bf16 a[28:31], a[184:187], a[120:123], 0
s_mov_b32 s92, s95
s_mul_i32 s81, s92, 110592
s_mul_i32 s65, s52, 36
v_mfma_f32_16x16x32_bf16 a[28:31], a[188:191], a[124:127], a[28:31]
buffer_load_dwordx4 v6, s[8:11], s64 offen offset:1024 lds
v_mfma_f32_16x16x32_bf16 a[24:27], a[180:183], a[124:127], 0
s_add_u32 s81, s81, s65
s_mul_i32 s82, s52, 18
s_add_u32 s82, s82, s92
v_mfma_f32_16x16x32_bf16 a[24:27], a[176:179], a[120:123], a[24:27]
s_lshl_b32 s82, s82, 12
s_add_u32 s82, s82, 35651584
s_lshl_b32 s83, s92, 6
v_mfma_f32_16x16x32_bf16 a[20:23], a[168:171], a[120:123], 0
s_lshl_b32 s84, s52, 10
s_add_u32 s84, s84, 75497984
v_mfma_f32_16x16x32_bf16 a[20:23], a[172:175], a[124:127], a[20:23]
s_cmp_lt_u32 s92, 18
s_cselect_b32 s82, s82, 2147418112
s_cselect_b32 s84, s84, 2147418112
v_mfma_f32_16x16x32_bf16 a[16:19], a[164:167], a[124:127], 0
v_lshrrev_b32 v18, 2, v2
v_and_b32 v19, 3, v2
v_mfma_f32_16x16x32_bf16 a[16:19], a[160:163], a[120:123], a[16:19]
s_waitcnt lgkmcnt(0)
v_mul_u32_u24 v20, 1152, v18
v_cmp_eq_u32 vcc, 2, v19
v_mfma_f32_16x16x32_bf16 v[32:35], a[64:67], a[128:131], v[32:35]
s_waitcnt vmcnt(13)
v_lshl_add_u32 v20, v19, 3, v20
v_add_u32 v21, 1, v19
v_mfma_f32_16x16x32_bf16 v[32:35], a[68:71], a[132:135], v[32:35]
s_barrier
v_mfma_f32_16x16x32_bf16 v[40:43], a[68:71], a[140:143], v[40:43]
ds_read_b128 a[96:99], v9 offset:8192
v_cndmask_b32 v21, v21, 0, vcc
v_mfma_f32_16x16x32_bf16 v[40:43], a[64:67], a[136:139], v[40:43]
s_add_u32 m0, s77, 16384
s_add_u32 s64, s76, 0
v_cmp_eq_u32 vcc, 3, v18
v_mfma_f32_16x16x32_bf16 v[48:51], a[64:67], a[144:147], v[48:51]
buffer_load_dwordx4 v7, s[16:19], s64 offen lds
v_mfma_f32_16x16x32_bf16 v[48:51], a[68:71], a[148:151], v[48:51]
ds_read_b128 a[100:103], v10 offset:8192
v_mul_u32_u24 v21, 1152, v21
v_mfma_f32_16x16x32_bf16 v[56:59], a[68:71], a[156:159], v[56:59]
v_add_u32 v21, 32, v21
v_cndmask_b32 v20, v20, v21, vcc
v_mfma_f32_16x16x32_bf16 v[56:59], a[64:67], a[152:155], v[56:59]
v_cmp_eq_u32 vcc, 15, v2
v_mul_u32_u24 v21, 27648, v3
v_mfma_f32_16x16x32_bf16 v[60:63], a[72:75], a[152:155], v[60:63]
buffer_load_dwordx4 v8, s[16:19], s64 offen offset:1024 lds
v_mfma_f32_16x16x32_bf16 v[60:63], a[76:79], a[156:159], v[60:63]
ds_read_b128 a[104:107], v9 offset:10240
v_add_u32 v20, v20, v21
v_mfma_f32_16x16x32_bf16 v[52:55], a[76:79], a[148:151], v[52:55]
v_lshlrev_b32 v21, 4, v3
v_cndmask_b32 v26, v20, v24, vcc
v_mfma_f32_16x16x32_bf16 v[52:55], a[72:75], a[144:147], v[52:55]
s_add_u32 m0, s77, 18432
s_add_u32 s64, s76, 131072
v_cndmask_b32 v27, v24, v21, vcc
v_mfma_f32_16x16x32_bf16 v[44:47], a[72:75], a[136:139], v[44:47]
s_lshl_b32 s52, s4, 2
ds_read_b64_tr_b16 a[160:161], v11 offset:49152
ds_read_b64_tr_b16 a[162:163], v11 offset:49664
v_mfma_f32_16x16x32_bf16 v[44:47], a[76:79], a[140:143], v[44:47]
buffer_load_dwordx4 v7, s[16:19], s64 offen lds
v_mfma_f32_16x16x32_bf16 v[36:39], a[76:79], a[132:135], v[36:39]
s_cmp_eq_u32 s66, 0
s_cselect_b32 s52, s52, 2147418112
v_mfma_f32_16x16x32_bf16 v[36:39], a[72:75], a[128:131], v[36:39]
ds_read_b128 a[108:111], v10 offset:10240
v_mfma_f32_16x16x32_bf16 v[64:67], a[80:83], a[128:131], v[64:67]
v_mfma_f32_16x16x32_bf16 v[64:67], a[84:87], a[132:135], v[64:67]
v_mfma_f32_16x16x32_bf16 v[72:75], a[84:87], a[140:143], v[72:75]
buffer_load_dwordx4 v8, s[16:19], s64 offen offset:1024 lds
v_mfma_f32_16x16x32_bf16 v[72:75], a[80:83], a[136:139], v[72:75]
s_xor_b32 s71, s70, 384
s_add_u32 s71, s68, s71
v_mfma_f32_16x16x32_bf16 v[80:83], a[80:83], a[144:147], v[80:83]
ds_read_b64_tr_b16 a[164:165], v11 offset:57344
ds_read_b64_tr_b16 a[166:167], v11 offset:57856
v_mfma_f32_16x16x32_bf16 v[80:83], a[84:87], a[148:151], v[80:83]
s_add_u32 m0, s73, 0
s_add_u32 s64, s71, 0
ds_read_b128 a[112:115], v9 offset:12288
v_mfma_f32_16x16x32_bf16 v[88:91], a[84:87], a[156:159], v[88:91]
v_mfma_f32_16x16x32_bf16 v[88:91], a[80:83], a[152:155], v[88:91]
buffer_load_dwordx4 v5, s[8:11], s64 offen lds
v_mfma_f32_16x16x32_bf16 v[92:95], a[88:91], a[152:155], v[92:95]
ds_read_b64_tr_b16 a[168:169], v12 offset:49152
ds_read_b64_tr_b16 a[170:171], v12 offset:49664
v_mfma_f32_16x16x32_bf16 v[92:95], a[92:95], a[156:159], v[92:95]
v_mfma_f32_16x16x32_bf16 v[84:87], a[92:95], a[148:151], v[84:87]
v_mfma_f32_16x16x32_bf16 v[84:87], a[88:91], a[144:147], v[84:87]
v_mfma_f32_16x16x32_bf16 v[76:79], a[88:91], a[136:139], v[76:79]
buffer_load_dwordx4 v6, s[8:11], s64 offen offset:1024 lds
v_mfma_f32_16x16x32_bf16 v[76:79], a[92:95], a[140:143], v[76:79]
ds_read_b128 a[116:119], v10 offset:12288
v_mfma_f32_16x16x32_bf16 v[68:71], a[92:95], a[132:135], v[68:71]
v_mfma_f32_16x16x32_bf16 v[68:71], a[88:91], a[128:131], v[68:71]
s_add_u32 m0, s73, 2048
s_add_u32 s64, s71, 16384
s_waitcnt lgkmcnt(6)
v_mfma_f32_16x16x32_bf16 v[96:99], a[96:99], a[128:131], v[96:99]
ds_read_b64_tr_b16 a[172:173], v12 offset:57344
ds_read_b64_tr_b16 a[174:175], v12 offset:57856
v_mfma_f32_16x16x32_bf16 v[96:99], a[100:103], a[132:135], v[96:99]
buffer_load_dwordx4 v5, s[8:11], s64 offen lds
v_mfma_f32_16x16x32_bf16 v[104:107], a[100:103], a[140:143], v[104:107]
ds_read_b128 a[120:123], v9 offset:14336
v_mfma_f32_16x16x32_bf16 v[104:107], a[96:99], a[136:139], v[104:107]
v_mfma_f32_16x16x32_bf16 v[112:115], a[96:99], a[144:147], v[112:115]
v_mfma_f32_16x16x32_bf16 v[112:115], a[100:103], a[148:151], v[112:115]
buffer_load_dwordx4 v6, s[8:11], s64 offen offset:1024 lds
v_mfma_f32_16x16x32_bf16 v[120:123], a[100:103], a[156:159], v[120:123]
s_xor_b32 s76, s75, 1572864
s_add_u32 s76, s74, s76
v_mfma_f32_16x16x32_bf16 v[120:123], a[96:99], a[152:155], v[120:123]
ds_read_b64_tr_b16 a[176:177], v13 offset:49152
ds_read_b64_tr_b16 a[178:179], v13 offset:49664
v_mfma_f32_16x16x32_bf16 v[124:127], a[104:107], a[152:155], v[124:127]
s_add_u32 m0, s77, 32768
s_add_u32 s64, s76, 0
v_mfma_f32_16x16x32_bf16 v[124:127], a[108:111], a[156:159], v[124:127]
ds_read_b128 a[124:127], v10 offset:14336
v_mfma_f32_16x16x32_bf16 v[116:119], a[108:111], a[148:151], v[116:119]
buffer_load_dwordx4 v7, s[56:59], s64 offen lds
v_mfma_f32_16x16x32_bf16 v[116:119], a[104:107], a[144:147], v[116:119]
s_waitcnt vmcnt(14)
v_add_u32 v9, 32768, v9
v_add_u32 v10, 32768, v10
v_mfma_f32_16x16x32_bf16 v[108:111], a[104:107], a[136:139], v[108:111]
ds_read_b64_tr_b16 a[180:181], v13 offset:57344
ds_read_b64_tr_b16 a[182:183], v13 offset:57856
v_mfma_f32_16x16x32_bf16 v[108:111], a[108:111], a[140:143], v[108:111]
buffer_store_dword v1, v0, s[40:43], s52 offen sc1
v_mfma_f32_16x16x32_bf16 v[100:103], a[108:111], a[132:135], v[100:103]
s_waitcnt lgkmcnt(2)
s_lshl2_add_u32 s55, s95, s3
s_lshl3_add_u32 s54, s55, s7
v_mfma_f32_16x16x32_bf16 v[100:103], a[104:107], a[128:131], v[100:103]
buffer_load_dwordx4 v8, s[56:59], s64 offen offset:1024 lds
v_mfma_f32_16x16x32_bf16 v[128:131], a[112:115], a[128:131], v[128:131]
s_mul_i32 s53, s54, 3072
ds_read_b64_tr_b16 a[184:185], v14 offset:49152
ds_read_b64_tr_b16 a[186:187], v14 offset:49664
v_mfma_f32_16x16x32_bf16 v[128:131], a[116:119], a[132:135], v[128:131]
s_mul_i32 s55, s55, 48
s_add_u32 s55, s55, s7
s_lshl_b32 s55, s55, 10
v_mfma_f32_16x16x32_bf16 v[136:139], a[116:119], a[140:143], v[136:139]
s_add_u32 m0, s77, 34816
s_add_u32 s64, s76, 131072
v_min_u32 v20, 23, v1
v_mfma_f32_16x16x32_bf16 v[136:139], a[112:115], a[136:139], v[136:139]
ds_read_b64_tr_b16 a[188:189], v14 offset:57344
ds_read_b64_tr_b16 a[190:191], v14 offset:57856
v_mfma_f32_16x16x32_bf16 v[144:147], a[112:115], a[144:147], v[144:147]
buffer_load_dwordx4 v7, s[56:59], s64 offen lds
v_mfma_f32_16x16x32_bf16 v[144:147], a[116:119], a[148:151], v[144:147]
v_lshrrev_b32 v21, 3, v20
v_mul_u32_u24 v21, 7168, v21
v_mfma_f32_16x16x32_bf16 v[152:155], a[116:119], a[156:159], v[152:155]
v_lshlrev_b32 v20, 7, v20
v_add_u32 v21, v21, v20
v_mfma_f32_16x16x32_bf16 v[152:155], a[112:115], a[152:155], v[152:155]
v_mfma_f32_16x16x32_bf16 v[156:159], a[120:123], a[152:155], v[156:159]
v_mfma_f32_16x16x32_bf16 v[156:159], a[124:127], a[156:159], v[156:159]
buffer_load_dwordx4 v8, s[56:59], s64 offen offset:1024 lds
v_mfma_f32_16x16x32_bf16 v[148:151], a[124:127], a[148:151], v[148:151]
v_mfma_f32_16x16x32_bf16 v[148:151], a[120:123], a[144:147], v[148:151]
v_mfma_f32_16x16x32_bf16 v[140:143], a[120:123], a[136:139], v[140:143]
v_mfma_f32_16x16x32_bf16 v[140:143], a[124:127], a[140:143], v[140:143]
v_mfma_f32_16x16x32_bf16 v[132:135], a[124:127], a[132:135], v[132:135]
v_mfma_f32_16x16x32_bf16 v[132:135], a[120:123], a[128:131], v[132:135]
s_waitcnt lgkmcnt(0)
v_mfma_f32_16x16x32_bf16 v[160:163], a[160:163], a[64:67], v[160:163]
s_waitcnt vmcnt(13)
v_mfma_f32_16x16x32_bf16 v[160:163], a[164:167], a[68:71], v[160:163]
s_barrier
v_mfma_f32_16x16x32_bf16 v[164:167], a[172:175], a[68:71], v[164:167]
ds_read_b64_tr_b16 a[128:129], v11 offset:0
ds_read_b64_tr_b16 a[130:131], v11 offset:512
v_mfma_f32_16x16x32_bf16 v[164:167], a[168:171], a[64:67], v[164:167]
s_add_u32 m0, s73, 4096
s_add_u32 s64, s71, 524288
v_mfma_f32_16x16x32_bf16 v[168:171], a[176:179], a[64:67], v[168:171]
buffer_load_dwordx4 v5, s[8:11], s64 offen lds
v_mfma_f32_16x16x32_bf16 v[168:171], a[180:183], a[68:71], v[168:171]
v_mfma_f32_16x16x32_bf16 v[172:175], a[188:191], a[68:71], v[172:175]
v_mfma_f32_16x16x32_bf16 v[172:175], a[184:187], a[64:67], v[172:175]
ds_read_b128 a[64:67], v9 offset:0
v_mfma_f32_16x16x32_bf16 v[188:191], a[184:187], a[72:75], v[188:191]
buffer_load_dwordx4 v6, s[8:11], s64 offen offset:1024 lds
v_mfma_f32_16x16x32_bf16 v[188:191], a[188:191], a[76:79], v[188:191]
ds_read_b64_tr_b16 a[132:133], v11 offset:8192
ds_read_b64_tr_b16 a[134:135], v11 offset:8704
v_mfma_f32_16x16x32_bf16 v[184:187], a[180:183], a[76:79], v[184:187]
v_mfma_f32_16x16x32_bf16 v[184:187], a[176:179], a[72:75], v[184:187]
s_add_u32 m0, s73, 6144
s_add_u32 s64, s71, 540672
ds_read_b128 a[68:71], v10 offset:0
v_mfma_f32_16x16x32_bf16 v[180:183], a[168:171], a[72:75], v[180:183]
v_mfma_f32_16x16x32_bf16 v[180:183], a[172:175], a[76:79], v[180:183]
buffer_load_dwordx4 v5, s[8:11], s64 offen lds
v_mfma_f32_16x16x32_bf16 v[176:179], a[164:167], a[76:79], v[176:179]
v_mfma_f32_16x16x32_bf16 v[176:179], a[160:163], a[72:75], v[176:179]
ds_read_b64_tr_b16 a[136:137], v12 offset:0
ds_read_b64_tr_b16 a[138:139], v12 offset:512
v_mfma_f32_16x16x32_bf16 v[192:195], a[160:163], a[80:83], v[192:195]
v_mfma_f32_16x16x32_bf16 v[192:195], a[164:167], a[84:87], v[192:195]
v_mfma_f32_16x16x32_bf16 v[196:199], a[172:175], a[84:87], v[196:199]
buffer_load_dwordx4 v6, s[8:11], s64 offen offset:1024 lds
v_mfma_f32_16x16x32_bf16 v[196:199], a[168:171], a[80:83], v[196:199]
ds_read_b128 a[72:75], v9 offset:2048
v_mfma_f32_16x16x32_bf16 v[200:203], a[176:179], a[80:83], v[200:203]
v_mfma_f32_16x16x32_bf16 v[200:203], a[180:183], a[84:87], v[200:203]
s_add_u32 m0, s77, 49152
s_add_u32 s64, s76, 0
v_mfma_f32_16x16x32_bf16 v[204:207], a[188:191], a[84:87], v[204:207]
ds_read_b64_tr_b16 a[140:141], v12 offset:8192
ds_read_b64_tr_b16 a[142:143], v12 offset:8704
v_mfma_f32_16x16x32_bf16 v[204:207], a[184:187], a[80:83], v[204:207]
buffer_load_dwordx4 v7, s[16:19], s64 offen lds
v_mfma_f32_16x16x32_bf16 v[220:223], a[184:187], a[88:91], v[220:223]
ds_read_b128 a[76:79], v10 offset:2048
v_mfma_f32_16x16x32_bf16 v[220:223], a[188:191], a[92:95], v[220:223]
v_mfma_f32_16x16x32_bf16 v[216:219], a[180:183], a[92:95], v[216:219]
v_mfma_f32_16x16x32_bf16 v[216:219], a[176:179], a[88:91], v[216:219]
v_mfma_f32_16x16x32_bf16 v[212:215], a[168:171], a[88:91], v[212:215]
buffer_load_dwordx4 v8, s[16:19], s64 offen offset:1024 lds
v_mfma_f32_16x16x32_bf16 v[212:215], a[172:175], a[92:95], v[212:215]
ds_read_b64_tr_b16 a[144:145], v13 offset:0
ds_read_b64_tr_b16 a[146:147], v13 offset:512
v_mfma_f32_16x16x32_bf16 v[208:211], a[164:167], a[92:95], v[208:211]
v_mfma_f32_16x16x32_bf16 v[208:211], a[160:163], a[88:91], v[208:211]
s_add_u32 m0, s77, 51200
s_add_u32 s64, s76, 131072
ds_read_b128 a[80:83], v9 offset:4096
v_mfma_f32_16x16x32_bf16 v[224:227], a[160:163], a[96:99], v[224:227]
v_mfma_f32_16x16x32_bf16 v[224:227], a[164:167], a[100:103], v[224:227]
buffer_load_dwordx4 v7, s[16:19], s64 offen lds
v_mfma_f32_16x16x32_bf16 v[228:231], a[172:175], a[100:103], v[228:231]
ds_read_b64_tr_b16 a[148:149], v13 offset:8192
ds_read_b64_tr_b16 a[150:151], v13 offset:8704
v_mfma_f32_16x16x32_bf16 v[228:231], a[168:171], a[96:99], v[228:231]
v_mfma_f32_16x16x32_bf16 v[232:235], a[176:179], a[96:99], v[232:235]
v_mfma_f32_16x16x32_bf16 v[232:235], a[180:183], a[100:103], v[232:235]
buffer_load_dwordx4 v8, s[16:19], s64 offen offset:1024 lds
v_mfma_f32_16x16x32_bf16 v[236:239], a[188:191], a[100:103], v[236:239]
s_xor_b32 s71, s70, 512
s_add_u32 s71, s68, s71
ds_read_b128 a[84:87], v10 offset:4096
v_mfma_f32_16x16x32_bf16 v[236:239], a[184:187], a[96:99], v[236:239]
v_mfma_f32_16x16x32_bf16 v[252:255], a[184:187], a[104:107], v[252:255]
s_add_u32 m0, s73, 32768
s_add_u32 s64, s71, 0
v_mfma_f32_16x16x32_bf16 v[252:255], a[188:191], a[108:111], v[252:255]
ds_read_b64_tr_b16 a[152:153], v14 offset:0
ds_read_b64_tr_b16 a[154:155], v14 offset:512
v_mfma_f32_16x16x32_bf16 v[248:251], a[180:183], a[108:111], v[248:251]
buffer_load_dwordx4 v5, s[8:11], s64 offen lds
v_mfma_f32_16x16x32_bf16 v[248:251], a[176:179], a[104:107], v[248:251]
v_mfma_f32_16x16x32_bf16 v[244:247], a[168:171], a[104:107], v[244:247]
ds_read_b128 a[88:91], v9 offset:6144
v_mfma_f32_16x16x32_bf16 v[244:247], a[172:175], a[108:111], v[244:247]
v_mfma_f32_16x16x32_bf16 v[240:243], a[164:167], a[108:111], v[240:243]
v_mfma_f32_16x16x32_bf16 v[240:243], a[160:163], a[104:107], v[240:243]
buffer_load_dwordx4 v6, s[8:11], s64 offen offset:1024 lds
v_mfma_f32_16x16x32_bf16 a[0:3], a[160:163], a[112:115], a[0:3]
ds_read_b64_tr_b16 a[156:157], v14 offset:8192
ds_read_b64_tr_b16 a[158:159], v14 offset:8704
v_mfma_f32_16x16x32_bf16 a[0:3], a[164:167], a[116:119], a[0:3]
v_mfma_f32_16x16x32_bf16 a[4:7], a[172:175], a[116:119], a[4:7]
s_add_u32 m0, s73, 34816
s_add_u32 s64, s71, 16384
ds_read_b128 a[92:95], v10 offset:6144
v_mfma_f32_16x16x32_bf16 a[4:7], a[168:171], a[112:115], a[4:7]
v_mfma_f32_16x16x32_bf16 a[8:11], a[176:179], a[112:115], a[8:11]
buffer_load_dwordx4 v5, s[8:11], s64 offen lds
v_mfma_f32_16x16x32_bf16 a[8:11], a[180:183], a[116:119], a[8:11]
v_mfma_f32_16x16x32_bf16 a[12:15], a[188:191], a[116:119], a[12:15]
v_mfma_f32_16x16x32_bf16 a[12:15], a[184:187], a[112:115], a[12:15]
v_mfma_f32_16x16x32_bf16 a[28:31], a[184:187], a[120:123], a[28:31]
v_mfma_f32_16x16x32_bf16 a[28:31], a[188:191], a[124:127], a[28:31]
buffer_load_dwordx4 v6, s[8:11], s64 offen offset:1024 lds
v_mfma_f32_16x16x32_bf16 a[24:27], a[180:183], a[124:127], a[24:27]
v_mfma_f32_16x16x32_bf16 a[24:27], a[176:179], a[120:123], a[24:27]
v_mfma_f32_16x16x32_bf16 a[20:23], a[168:171], a[120:123], a[20:23]
v_mfma_f32_16x16x32_bf16 a[20:23], a[172:175], a[124:127], a[20:23]
v_mfma_f32_16x16x32_bf16 a[16:19], a[164:167], a[124:127], a[16:19]
v_mfma_f32_16x16x32_bf16 a[16:19], a[160:163], a[120:123], a[16:19]
s_waitcnt lgkmcnt(0)
v_mfma_f32_16x16x32_bf16 v[32:35], a[64:67], a[128:131], v[32:35]
s_waitcnt vmcnt(21)
v_mfma_f32_16x16x32_bf16 v[32:35], a[68:71], a[132:135], v[32:35]
s_barrier
v_mfma_f32_16x16x32_bf16 v[40:43], a[68:71], a[140:143], v[40:43]
s_add_u32 s52, s81, 0
ds_read_b128 a[96:99], v9 offset:8192
v_mfma_f32_16x16x32_bf16 v[40:43], a[64:67], a[136:139], v[40:43]
s_xor_b32 s76, s75, 2097152
s_add_u32 s76, s74, s76
v_mfma_f32_16x16x32_bf16 v[48:51], a[64:67], a[144:147], v[48:51]
s_add_u32 m0, s77, 0
s_add_u32 s64, s76, 0
v_mfma_f32_16x16x32_bf16 v[48:51], a[68:71], a[148:151], v[48:51]
buffer_load_dwordx4 v7, s[56:59], s64 offen lds
v_mfma_f32_16x16x32_bf16 v[56:59], a[68:71], a[156:159], v[56:59]
ds_read_b128 a[100:103], v10 offset:8192
v_mfma_f32_16x16x32_bf16 v[56:59], a[64:67], a[152:155], v[56:59]
buffer_load_dwordx2 a[192:193], v26, s[28:31], s52 offen
v_mfma_f32_16x16x32_bf16 v[60:63], a[72:75], a[152:155], v[60:63]
ds_read_b128 a[104:107], v9 offset:10240
v_mfma_f32_16x16x32_bf16 v[60:63], a[76:79], a[156:159], v[60:63]
v_mfma_f32_16x16x32_bf16 v[52:55], a[76:79], a[148:151], v[52:55]
s_add_u32 s52, s81, 3456
v_mfma_f32_16x16x32_bf16 v[52:55], a[72:75], a[144:147], v[52:55]
buffer_load_dwordx4 v8, s[56:59], s64 offen offset:1024 lds
v_mfma_f32_16x16x32_bf16 v[44:47], a[72:75], a[136:139], v[44:47]
ds_read_b64_tr_b16 a[160:161], v11 offset:16384
ds_read_b64_tr_b16 a[162:163], v11 offset:16896
v_mfma_f32_16x16x32_bf16 v[44:47], a[76:79], a[140:143], v[44:47]
buffer_load_dwordx2 a[194:195], v26, s[28:31], s52 offen
v_mfma_f32_16x16x32_bf16 v[36:39], a[76:79], a[132:135], v[36:39]
v_mfma_f32_16x16x32_bf16 v[36:39], a[72:75], a[128:131], v[36:39]
ds_read_b128 a[108:111], v10 offset:10240
v_mfma_f32_16x16x32_bf16 v[64:67], a[80:83], a[128:131], v[64:67]
s_add_u32 m0, s77, 2048
s_add_u32 s64, s76, 131072
s_add_u32 s52, s81, 6912
v_mfma_f32_16x16x32_bf16 v[64:67], a[84:87], a[132:135], v[64:67]
buffer_load_dwordx2 a[196:197], v26, s[28:31], s52 offen
v_mfma_f32_16x16x32_bf16 v[72:75], a[84:87], a[140:143], v[72:75]
buffer_load_dwordx4 v7, s[56:59], s64 offen lds
v_mfma_f32_16x16x32_bf16 v[72:75], a[80:83], a[136:139], v[72:75]
ds_read_b64_tr_b16 a[164:165], v11 offset:24576
ds_read_b64_tr_b16 a[166:167], v11 offset:25088
v_mfma_f32_16x16x32_bf16 v[80:83], a[80:83], a[144:147], v[80:83]
s_add_u32 s52, s81, 10368
v_mfma_f32_16x16x32_bf16 v[80:83], a[84:87], a[148:151], v[80:83]
ds_read_b128 a[112:115], v9 offset:12288
v_mfma_f32_16x16x32_bf16 v[88:91], a[84:87], a[156:159], v[88:91]
buffer_load_dwordx2 a[198:199], v26, s[28:31], s52 offen
v_mfma_f32_16x16x32_bf16 v[88:91], a[80:83], a[152:155], v[88:91]
v_mfma_f32_16x16x32_bf16 v[92:95], a[88:91], a[152:155], v[92:95]
ds_read_b64_tr_b16 a[168:169], v12 offset:16384
ds_read_b64_tr_b16 a[170:171], v12 offset:16896
v_mfma_f32_16x16x32_bf16 v[92:95], a[92:95], a[156:159], v[92:95]
buffer_load_dwordx4 v8, s[56:59], s64 offen offset:1024 lds
v_mfma_f32_16x16x32_bf16 v[84:87], a[92:95], a[148:151], v[84:87]
s_add_u32 s52, s81, 13824
v_mfma_f32_16x16x32_bf16 v[84:87], a[88:91], a[144:147], v[84:87]
buffer_load_dwordx2 a[200:201], v26, s[28:31], s52 offen
v_mfma_f32_16x16x32_bf16 v[76:79], a[88:91], a[136:139], v[76:79]
ds_read_b128 a[116:119], v10 offset:12288
v_mfma_f32_16x16x32_bf16 v[76:79], a[92:95], a[140:143], v[76:79]
v_mfma_f32_16x16x32_bf16 v[68:71], a[92:95], a[132:135], v[68:71]
s_add_u32 s52, s81, 17280
v_mfma_f32_16x16x32_bf16 v[68:71], a[88:91], a[128:131], v[68:71]
s_add_u32 m0, s73, 36864
s_add_u32 s64, s71, 524288
s_waitcnt lgkmcnt(6)
v_mfma_f32_16x16x32_bf16 v[96:99], a[96:99], a[128:131], v[96:99]
ds_read_b64_tr_b16 a[172:173], v12 offset:24576
ds_read_b64_tr_b16 a[174:175], v12 offset:25088
v_mfma_f32_16x16x32_bf16 v[96:99], a[100:103], a[132:135], v[96:99]
buffer_load_dwordx4 v5, s[8:11], s64 offen lds
v_mfma_f32_16x16x32_bf16 v[104:107], a[100:103], a[140:143], v[104:107]
ds_read_b128 a[120:123], v9 offset:14336
v_mfma_f32_16x16x32_bf16 v[104:107], a[96:99], a[136:139], v[104:107]
buffer_load_dwordx2 a[202:203], v26, s[28:31], s52 offen
v_mfma_f32_16x16x32_bf16 v[112:115], a[96:99], a[144:147], v[112:115]
v_mfma_f32_16x16x32_bf16 v[112:115], a[100:103], a[148:151], v[112:115]
ds_read_b64_tr_b16 a[176:177], v13 offset:16384
ds_read_b64_tr_b16 a[178:179], v13 offset:16896
v_mfma_f32_16x16x32_bf16 v[120:123], a[100:103], a[156:159], v[120:123]
s_add_u32 s52, s81, 20736
v_mfma_f32_16x16x32_bf16 v[120:123], a[96:99], a[152:155], v[120:123]
buffer_load_dwordx2 a[204:205], v26, s[28:31], s52 offen
v_mfma_f32_16x16x32_bf16 v[124:127], a[104:107], a[152:155], v[124:127]
buffer_load_dwordx4 v6, s[8:11], s64 offen offset:1024 lds
v_mfma_f32_16x16x32_bf16 v[124:127], a[108:111], a[156:159], v[124:127]
ds_read_b128 a[124:127], v10 offset:14336
v_mfma_f32_16x16x32_bf16 v[116:119], a[108:111], a[148:151], v[116:119]
s_add_u32 s52, s81, 24192
v_add_u32 v9, -65536, v9
v_add_u32 v10, -65536, v10
v_mfma_f32_16x16x32_bf16 v[116:119], a[104:107], a[144:147], v[116:119]
buffer_load_dwordx2 a[206:207], v26, s[28:31], s52 offen
v_mfma_f32_16x16x32_bf16 v[108:111], a[104:107], a[136:139], v[108:111]
ds_read_b64_tr_b16 a[180:181], v13 offset:24576
ds_read_b64_tr_b16 a[182:183], v13 offset:25088
v_mfma_f32_16x16x32_bf16 v[108:111], a[108:111], a[140:143], v[108:111]
s_add_u32 m0, s73, 38912
s_add_u32 s64, s71, 540672
v_mfma_f32_16x16x32_bf16 v[100:103], a[108:111], a[132:135], v[100:103]
s_waitcnt lgkmcnt(2)
v_mfma_f32_16x16x32_bf16 v[100:103], a[104:107], a[128:131], v[100:103]
buffer_load_dwordx4 v5, s[8:11], s64 offen lds
v_mfma_f32_16x16x32_bf16 v[128:131], a[112:115], a[128:131], v[128:131]
ds_read_b64_tr_b16 a[184:185], v14 offset:16384
ds_read_b64_tr_b16 a[186:187], v14 offset:16896
v_mfma_f32_16x16x32_bf16 v[128:131], a[116:119], a[132:135], v[128:131]
buffer_load_dwordx4 a[208:211], v27, s[36:39], s83 offen
v_mfma_f32_16x16x32_bf16 v[136:139], a[116:119], a[140:143], v[136:139]
ds_read_b64_tr_b16 a[188:189], v14 offset:24576
ds_read_b64_tr_b16 a[190:191], v14 offset:25088
v_mfma_f32_16x16x32_bf16 v[136:139], a[112:115], a[136:139], v[136:139]
v_mfma_f32_16x16x32_bf16 v[144:147], a[112:115], a[144:147], v[144:147]
v_mfma_f32_16x16x32_bf16 v[144:147], a[116:119], a[148:151], v[144:147]
v_mfma_f32_16x16x32_bf16 v[152:155], a[116:119], a[156:159], v[152:155]
buffer_load_dwordx4 v6, s[8:11], s64 offen offset:1024 lds
v_mfma_f32_16x16x32_bf16 v[152:155], a[112:115], a[152:155], v[152:155]
v_mfma_f32_16x16x32_bf16 v[156:159], a[120:123], a[152:155], v[156:159]
v_mfma_f32_16x16x32_bf16 v[156:159], a[124:127], a[156:159], v[156:159]
v_mfma_f32_16x16x32_bf16 v[148:151], a[124:127], a[148:151], v[148:151]
v_mfma_f32_16x16x32_bf16 v[148:151], a[120:123], a[144:147], v[148:151]
v_mfma_f32_16x16x32_bf16 v[140:143], a[120:123], a[136:139], v[140:143]
v_mfma_f32_16x16x32_bf16 v[140:143], a[124:127], a[140:143], v[140:143]
v_mfma_f32_16x16x32_bf16 v[132:135], a[124:127], a[132:135], v[132:135]
v_mfma_f32_16x16x32_bf16 v[132:135], a[120:123], a[128:131], v[132:135]
s_waitcnt lgkmcnt(0)
v_mfma_f32_16x16x32_bf16 v[160:163], a[160:163], a[64:67], v[160:163]
s_waitcnt vmcnt(25)
v_mfma_f32_16x16x32_bf16 v[160:163], a[164:167], a[68:71], v[160:163]
s_barrier
v_mfma_f32_16x16x32_bf16 v[164:167], a[172:175], a[68:71], v[164:167]
ds_read_b64_tr_b16 a[128:129], v11 offset:32768
ds_read_b64_tr_b16 a[130:131], v11 offset:33280
v_mfma_f32_16x16x32_bf16 v[164:167], a[168:171], a[64:67], v[164:167]
s_add_u32 m0, s77, 16384
s_add_u32 s64, s76, 0
v_mfma_f32_16x16x32_bf16 v[168:171], a[176:179], a[64:67], v[168:171]
buffer_load_dwordx4 v7, s[16:19], s64 offen lds
v_mfma_f32_16x16x32_bf16 v[168:171], a[180:183], a[68:71], v[168:171]
L_PAD1:
s_cbranch_execz L_PAD5
v_mfma_f32_16x16x32_bf16 v[172:175], a[188:191], a[68:71], v[172:175]
v_mfma_f32_16x16x32_bf16 v[172:175], a[184:187], a[64:67], v[172:175]
ds_read_b128 a[64:67], v9 offset:0
v_mfma_f32_16x16x32_bf16 v[188:191], a[184:187], a[72:75], v[188:191]
ds_read_b64_tr_b16 a[132:133], v11 offset:40960
ds_read_b64_tr_b16 a[134:135], v11 offset:41472
v_mfma_f32_16x16x32_bf16 v[188:191], a[188:191], a[76:79], v[188:191]
v_mfma_f32_16x16x32_bf16 v[184:187], a[180:183], a[76:79], v[184:187]
v_mfma_f32_16x16x32_bf16 v[184:187], a[176:179], a[72:75], v[184:187]
buffer_load_dwordx4 v8, s[16:19], s64 offen offset:1024 lds
v_mfma_f32_16x16x32_bf16 v[180:183], a[168:171], a[72:75], v[180:183]
ds_read_b128 a[68:71], v10 offset:0
v_mfma_f32_16x16x32_bf16 v[180:183], a[172:175], a[76:79], v[180:183]
v_mfma_f32_16x16x32_bf16 v[176:179], a[164:167], a[76:79], v[176:179]
v_mfma_f32_16x16x32_bf16 v[176:179], a[160:163], a[72:75], v[176:179]
ds_read_b64_tr_b16 a[136:137], v12 offset:32768
ds_read_b64_tr_b16 a[138:139], v12 offset:33280
v_mfma_f32_16x16x32_bf16 v[192:195], a[160:163], a[80:83], v[192:195]
s_add_u32 m0, s77, 18432
s_add_u32 s64, s76, 131072
v_mfma_f32_16x16x32_bf16 v[192:195], a[164:167], a[84:87], v[192:195]
v_mfma_f32_16x16x32_bf16 v[196:199], a[172:175], a[84:87], v[196:199]
buffer_load_dwordx4 v7, s[16:19], s64 offen lds
v_mfma_f32_16x16x32_bf16 v[196:199], a[168:171], a[80:83], v[196:199]
ds_read_b128 a[72:75], v9 offset:2048
v_mfma_f32_16x16x32_bf16 v[200:203], a[176:179], a[80:83], v[200:203]
v_mfma_f32_16x16x32_bf16 v[200:203], a[180:183], a[84:87], v[200:203]
ds_read_b64_tr_b16 a[140:141], v12 offset:40960
ds_read_b64_tr_b16 a[142:143], v12 offset:41472
v_mfma_f32_16x16x32_bf16 v[204:207], a[188:191], a[84:87], v[204:207]
v_mfma_f32_16x16x32_bf16 v[204:207], a[184:187], a[80:83], v[204:207]
v_mfma_f32_16x16x32_bf16 v[220:223], a[184:187], a[88:91], v[220:223]
ds_read_b128 a[76:79], v10 offset:2048
v_mfma_f32_16x16x32_bf16 v[220:223], a[188:191], a[92:95], v[220:223]
buffer_load_dwordx4 v8, s[16:19], s64 offen offset:1024 lds
v_mfma_f32_16x16x32_bf16 v[216:219], a[180:183], a[92:95], v[216:219]
s_xor_b32 s71, s70, 640
s_add_u32 s71, s68, s71
v_mfma_f32_16x16x32_bf16 v[216:219], a[176:179], a[88:91], v[216:219]
v_mfma_f32_16x16x32_bf16 v[212:215], a[168:171], a[88:91], v[212:215]
ds_read_b64_tr_b16 a[144:145], v13 offset:32768
ds_read_b64_tr_b16 a[146:147], v13 offset:33280
v_mfma_f32_16x16x32_bf16 v[212:215], a[172:175], a[92:95], v[212:215]
v_mfma_f32_16x16x32_bf16 v[208:211], a[164:167], a[92:95], v[208:211]
v_mfma_f32_16x16x32_bf16 v[208:211], a[160:163], a[88:91], v[208:211]
s_add_u32 m0, s73, 65536
s_add_u32 s64, s71, 0
ds_read_b128 a[80:83], v9 offset:4096
v_mfma_f32_16x16x32_bf16 v[224:227], a[160:163], a[96:99], v[224:227]
v_mfma_f32_16x16x32_bf16 v[224:227], a[164:167], a[100:103], v[224:227]
buffer_load_dwordx4 v5, s[8:11], s64 offen lds
v_mfma_f32_16x16x32_bf16 v[228:231], a[172:175], a[100:103], v[228:231]
ds_read_b64_tr_b16 a[148:149], v13 offset:40960
ds_read_b64_tr_b16 a[150:151], v13 offset:41472
v_mfma_f32_16x16x32_bf16 v[228:231], a[168:171], a[96:99], v[228:231]
v_mfma_f32_16x16x32_bf16 v[232:235], a[176:179], a[96:99], v[232:235]
v_mfma_f32_16x16x32_bf16 v[232:235], a[180:183], a[100:103], v[232:235]
ds_read_b128 a[84:87], v10 offset:4096
v_mfma_f32_16x16x32_bf16 v[236:239], a[188:191], a[100:103], v[236:239]
v_mfma_f32_16x16x32_bf16 v[236:239], a[184:187], a[96:99], v[236:239]
v_mfma_f32_16x16x32_bf16 v[252:255], a[184:187], a[104:107], v[252:255]
buffer_load_dwordx4 v6, s[8:11], s64 offen offset:1024 lds
v_mfma_f32_16x16x32_bf16 v[252:255], a[188:191], a[108:111], v[252:255]
ds_read_b64_tr_b16 a[152:153], v14 offset:32768
ds_read_b64_tr_b16 a[154:155], v14 offset:33280
v_mfma_f32_16x16x32_bf16 v[248:251], a[180:183], a[108:111], v[248:251]
v_mfma_f32_16x16x32_bf16 v[248:251], a[176:179], a[104:107], v[248:251]
v_mfma_f32_16x16x32_bf16 v[244:247], a[168:171], a[104:107], v[244:247]
ds_read_b128 a[88:91], v9 offset:6144
v_mfma_f32_16x16x32_bf16 v[244:247], a[172:175], a[108:111], v[244:247]
s_add_u32 m0, s73, 67584
s_add_u32 s64, s71, 16384
v_mfma_f32_16x16x32_bf16 v[240:243], a[164:167], a[108:111], v[240:243]
v_mfma_f32_16x16x32_bf16 v[240:243], a[160:163], a[104:107], v[240:243]
buffer_load_dwordx4 v5, s[8:11], s64 offen lds
v_mfma_f32_16x16x32_bf16 a[0:3], a[160:163], a[112:115], a[0:3]
ds_read_b64_tr_b16 a[156:157], v14 offset:40960
ds_read_b64_tr_b16 a[158:159], v14 offset:41472
v_mfma_f32_16x16x32_bf16 a[0:3], a[164:167], a[116:119], a[0:3]
v_mfma_f32_16x16x32_bf16 a[4:7], a[172:175], a[116:119], a[4:7]
ds_read_b128 a[92:95], v10 offset:6144
v_mfma_f32_16x16x32_bf16 a[4:7], a[168:171], a[112:115], a[4:7]
v_mfma_f32_16x16x32_bf16 a[8:11], a[176:179], a[112:115], a[8:11]
v_mfma_f32_16x16x32_bf16 a[8:11], a[180:183], a[116:119], a[8:11]
v_mfma_f32_16x16x32_bf16 a[12:15], a[188:191], a[116:119], a[12:15]
buffer_load_dwordx4 v6, s[8:11], s64 offen offset:1024 lds
v_mfma_f32_16x16x32_bf16 a[12:15], a[184:187], a[112:115], a[12:15]
v_mfma_f32_16x16x32_bf16 a[28:31], a[184:187], a[120:123], a[28:31]
v_mfma_f32_16x16x32_bf16 a[28:31], a[188:191], a[124:127], a[28:31]
v_mfma_f32_16x16x32_bf16 a[24:27], a[180:183], a[124:127], a[24:27]
v_mfma_f32_16x16x32_bf16 a[24:27], a[176:179], a[120:123], a[24:27]
v_mfma_f32_16x16x32_bf16 a[20:23], a[168:171], a[120:123], a[20:23]
v_mfma_f32_16x16x32_bf16 a[20:23], a[172:175], a[124:127], a[20:23]
v_mfma_f32_16x16x32_bf16 a[16:19], a[164:167], a[124:127], a[16:19]
v_mfma_f32_16x16x32_bf16 a[16:19], a[160:163], a[120:123], a[16:19]
s_waitcnt lgkmcnt(0)
v_mfma_f32_16x16x32_bf16 v[32:35], a[64:67], a[128:131], v[32:35]
s_waitcnt vmcnt(29)
v_mfma_f32_16x16x32_bf16 v[32:35], a[68:71], a[132:135], v[32:35]
s_barrier
v_mfma_f32_16x16x32_bf16 v[40:43], a[68:71], a[140:143], v[40:43]
ds_read_b128 a[96:99], v9 offset:8192
v_mfma_f32_16x16x32_bf16 v[40:43], a[64:67], a[136:139], v[40:43]
s_xor_b32 s76, s75, 2621440
s_add_u32 s76, s74, s76
v_mfma_f32_16x16x32_bf16 v[48:51], a[64:67], a[144:147], v[48:51]
s_add_u32 m0, s77, 32768
s_add_u32 s64, s76, 0
v_mfma_f32_16x16x32_bf16 v[48:51], a[68:71], a[148:151], v[48:51]
buffer_load_dwordx4 v7, s[56:59], s64 offen lds
v_mfma_f32_16x16x32_bf16 v[56:59], a[68:71], a[156:159], v[56:59]
ds_read_b128 a[100:103], v10 offset:8192
v_mfma_f32_16x16x32_bf16 v[56:59], a[64:67], a[152:155], v[56:59]
v_mfma_f32_16x16x32_bf16 v[60:63], a[72:75], a[152:155], v[60:63]
ds_read_b128 a[104:107], v9 offset:10240
v_mfma_f32_16x16x32_bf16 v[60:63], a[76:79], a[156:159], v[60:63]
v_mfma_f32_16x16x32_bf16 v[52:55], a[76:79], a[148:151], v[52:55]
v_mfma_f32_16x16x32_bf16 v[52:55], a[72:75], a[144:147], v[52:55]
buffer_load_dwordx4 v8, s[56:59], s64 offen offset:1024 lds
v_mfma_f32_16x16x32_bf16 v[44:47], a[72:75], a[136:139], v[44:47]
ds_read_b64_tr_b16 a[160:161], v11 offset:49152
ds_read_b64_tr_b16 a[162:163], v11 offset:49664
v_mfma_f32_16x16x32_bf16 v[44:47], a[76:79], a[140:143], v[44:47]
v_mfma_f32_16x16x32_bf16 v[36:39], a[76:79], a[132:135], v[36:39]
v_mfma_f32_16x16x32_bf16 v[36:39], a[72:75], a[128:131], v[36:39]
ds_read_b128 a[108:111], v10 offset:10240
v_mfma_f32_16x16x32_bf16 v[64:67], a[80:83], a[128:131], v[64:67]
s_add_u32 m0, s77, 34816
s_add_u32 s64, s76, 131072
v_mfma_f32_16x16x32_bf16 v[64:67], a[84:87], a[132:135], v[64:67]
v_mfma_f32_16x16x32_bf16 v[72:75], a[84:87], a[140:143], v[72:75]
buffer_load_dwordx4 v7, s[56:59], s64 offen lds
v_mfma_f32_16x16x32_bf16 v[72:75], a[80:83], a[136:139], v[72:75]
ds_read_b64_tr_b16 a[164:165], v11 offset:57344
ds_read_b64_tr_b16 a[166:167], v11 offset:57856
v_mfma_f32_16x16x32_bf16 v[80:83], a[80:83], a[144:147], v[80:83]
v_mfma_f32_16x16x32_bf16 v[80:83], a[84:87], a[148:151], v[80:83]
s_waitcnt vmcnt(12)
ds_read_b128 a[112:115], v9 offset:12288
v_mfma_f32_16x16x32_bf16 v[88:91], a[84:87], a[156:159], v[88:91]
v_mfma_f32_16x16x32_bf16 v[88:91], a[80:83], a[152:155], v[88:91]
v_accvgpr_read_b32 v16, a192
v_accvgpr_read_b32 v17, a194
v_mfma_f32_16x16x32_bf16 v[92:95], a[88:91], a[152:155], v[92:95]
ds_read_b64_tr_b16 a[168:169], v12 offset:49152
ds_read_b64_tr_b16 a[170:171], v12 offset:49664
v_mfma_f32_16x16x32_bf16 v[92:95], a[92:95], a[156:159], v[92:95]
buffer_load_dwordx4 v8, s[56:59], s64 offen offset:1024 lds
v_mfma_f32_16x16x32_bf16 v[84:87], a[92:95], a[148:151], v[84:87]
v_accvgpr_read_b32 v18, a196
v_accvgpr_read_b32 v19, a198
v_mfma_f32_16x16x32_bf16 v[84:87], a[88:91], a[144:147], v[84:87]
v_perm_b32 v24, v17, v16, s85
v_perm_b32 v25, v19, v18, s85
v_mfma_f32_16x16x32_bf16 v[76:79], a[88:91], a[136:139], v[76:79]
ds_read_b128 a[116:119], v10 offset:12288
v_perm_b32 v28, v17, v16, s86
v_mfma_f32_16x16x32_bf16 v[76:79], a[92:95], a[140:143], v[76:79]
v_perm_b32 v29, v19, v18, s86
v_accvgpr_read_b32 v16, a200
v_mfma_f32_16x16x32_bf16 v[68:71], a[92:95], a[132:135], v[68:71]
v_accvgpr_read_b32 v17, a202
v_accvgpr_read_b32 v18, a204
v_mfma_f32_16x16x32_bf16 v[68:71], a[88:91], a[128:131], v[68:71]
s_add_u32 m0, s73, 69632
s_add_u32 s64, s71, 524288
s_waitcnt lgkmcnt(6)
v_mfma_f32_16x16x32_bf16 v[96:99], a[96:99], a[128:131], v[96:99]
ds_read_b64_tr_b16 a[172:173], v12 offset:57344
ds_read_b64_tr_b16 a[174:175], v12 offset:57856
v_mfma_f32_16x16x32_bf16 v[96:99], a[100:103], a[132:135], v[96:99]
buffer_load_dwordx4 v5, s[8:11], s64 offen lds
v_mfma_f32_16x16x32_bf16 v[104:107], a[100:103], a[140:143], v[104:107]
ds_read_b128 a[120:123], v9 offset:14336
v_accvgpr_read_b32 v19, a206
v_mfma_f32_16x16x32_bf16 v[104:107], a[96:99], a[136:139], v[104:107]
v_perm_b32 v26, v17, v16, s85
v_perm_b32 v27, v19, v18, s85
v_mfma_f32_16x16x32_bf16 v[112:115], a[96:99], a[144:147], v[112:115]
v_perm_b32 v30, v17, v16, s86
v_perm_b32 v31, v19, v18, s86
v_mfma_f32_16x16x32_bf16 v[112:115], a[100:103], a[148:151], v[112:115]
ds_read_b64_tr_b16 a[176:177], v13 offset:49152
ds_read_b64_tr_b16 a[178:179], v13 offset:49664
v_mfma_f32_16x16x32_bf16 v[120:123], a[100:103], a[156:159], v[120:123]
v_accvgpr_read_b32 v16, a208
v_accvgpr_read_b32 v17, a209
v_mfma_f32_16x16x32_bf16 v[120:123], a[96:99], a[152:155], v[120:123]
v_accvgpr_read_b32 v18, a210
v_accvgpr_read_b32 v19, a211
v_mfma_f32_16x16x32_bf16 v[124:127], a[104:107], a[152:155], v[124:127]
buffer_load_dwordx4 v6, s[8:11], s64 offen offset:1024 lds
v_mfma_f32_16x16x32_bf16 v[124:127], a[108:111], a[156:159], v[124:127]
ds_read_b128 a[124:127], v10 offset:14336
v_or_b32 v24, v24, v16
v_mfma_f32_16x16x32_bf16 v[116:119], a[108:111], a[148:151], v[116:119]
v_add_u32 v9, 32768, v9
v_add_u32 v10, 32768, v10
v_mfma_f32_16x16x32_bf16 v[116:119], a[104:107], a[144:147], v[116:119]
v_or_b32 v25, v25, v17
v_or_b32 v26, v26, v18
v_mfma_f32_16x16x32_bf16 v[108:111], a[104:107], a[136:139], v[108:111]
ds_read_b64_tr_b16 a[180:181], v13 offset:57344
ds_read_b64_tr_b16 a[182:183], v13 offset:57856
v_mfma_f32_16x16x32_bf16 v[108:111], a[108:111], a[140:143], v[108:111]
s_add_u32 m0, s73, 71680
s_add_u32 s64, s71, 540672
v_or_b32 v27, v27, v19
v_mfma_f32_16x16x32_bf16 v[100:103], a[108:111], a[132:135], v[100:103]
s_waitcnt lgkmcnt(2)
v_mfma_f32_16x16x32_bf16 v[100:103], a[104:107], a[128:131], v[100:103]
buffer_load_dwordx4 v5, s[8:11], s64 offen lds
v_mfma_f32_16x16x32_bf16 v[128:131], a[112:115], a[128:131], v[128:131]
ds_read_b64_tr_b16 a[184:185], v14 offset:49152
ds_read_b64_tr_b16 a[186:187], v14 offset:49664
v_mfma_f32_16x16x32_bf16 v[128:131], a[116:119], a[132:135], v[128:131]
buffer_store_dwordx4 v[24:27], v15, s[24:27], s82 offen offset:0 sc1
v_mfma_f32_16x16x32_bf16 v[136:139], a[116:119], a[140:143], v[136:139]
ds_read_b64_tr_b16 a[188:189], v14 offset:57344
ds_read_b64_tr_b16 a[190:191], v14 offset:57856
v_mfma_f32_16x16x32_bf16 v[136:139], a[112:115], a[136:139], v[136:139]
v_mfma_f32_16x16x32_bf16 v[144:147], a[112:115], a[144:147], v[144:147]
v_mfma_f32_16x16x32_bf16 v[144:147], a[116:119], a[148:151], v[144:147]
buffer_store_dwordx4 v[28:31], v15, s[24:27], s82 offen offset:1024 sc1
v_mfma_f32_16x16x32_bf16 v[152:155], a[116:119], a[156:159], v[152:155]
buffer_load_dwordx4 v6, s[8:11], s64 offen offset:1024 lds
v_mfma_f32_16x16x32_bf16 v[152:155], a[112:115], a[152:155], v[152:155]
v_accvgpr_read_b32 v16, a193
v_accvgpr_read_b32 v17, a195
v_mfma_f32_16x16x32_bf16 v[156:159], a[120:123], a[152:155], v[156:159]
v_accvgpr_read_b32 v18, a197
v_accvgpr_read_b32 v19, a199
v_mfma_f32_16x16x32_bf16 v[156:159], a[124:127], a[156:159], v[156:159]
v_perm_b32 v24, v17, v16, s85
v_perm_b32 v25, v19, v18, s85
v_mfma_f32_16x16x32_bf16 v[148:151], a[124:127], a[148:151], v[148:151]
v_perm_b32 v28, v17, v16, s86
v_perm_b32 v29, v19, v18, s86
v_mfma_f32_16x16x32_bf16 v[148:151], a[120:123], a[144:147], v[148:151]
v_accvgpr_read_b32 v16, a201
v_accvgpr_read_b32 v17, a203
v_mfma_f32_16x16x32_bf16 v[140:143], a[120:123], a[136:139], v[140:143]
v_accvgpr_read_b32 v18, a205
v_accvgpr_read_b32 v19, a207
v_mfma_f32_16x16x32_bf16 v[140:143], a[124:127], a[140:143], v[140:143]
v_perm_b32 v26, v17, v16, s85
v_perm_b32 v27, v19, v18, s85
v_mfma_f32_16x16x32_bf16 v[132:135], a[124:127], a[132:135], v[132:135]
v_perm_b32 v30, v17, v16, s86
v_perm_b32 v31, v19, v18, s86
v_mfma_f32_16x16x32_bf16 v[132:135], a[120:123], a[128:131], v[132:135]
s_waitcnt lgkmcnt(0)
v_mfma_f32_16x16x32_bf16 v[160:163], a[160:163], a[64:67], v[160:163]
s_waitcnt vmcnt(18)
v_mfma_f32_16x16x32_bf16 v[160:163], a[164:167], a[68:71], v[160:163]
s_barrier
v_mfma_f32_16x16x32_bf16 v[164:167], a[172:175], a[68:71], v[164:167]
ds_read_b64_tr_b16 a[128:129], v11 offset:0
ds_read_b64_tr_b16 a[130:131], v11 offset:512
v_mfma_f32_16x16x32_bf16 v[164:167], a[168:171], a[64:67], v[164:167]
s_add_u32 m0, s77, 49152
s_add_u32 s64, s76, 0
v_mfma_f32_16x16x32_bf16 v[168:171], a[176:179], a[64:67], v[168:171]
buffer_load_dwordx4 v7, s[16:19], s64 offen lds
v_mfma_f32_16x16x32_bf16 v[168:171], a[180:183], a[68:71], v[168:171]
buffer_store_dwordx4 v[24:27], v15, s[24:27], s82 offen offset:2048 sc1
v_mfma_f32_16x16x32_bf16 v[172:175], a[188:191], a[68:71], v[172:175]
v_mfma_f32_16x16x32_bf16 v[172:175], a[184:187], a[64:67], v[172:175]
ds_read_b128 a[64:67], v9 offset:0
v_mfma_f32_16x16x32_bf16 v[188:191], a[184:187], a[72:75], v[188:191]
ds_read_b64_tr_b16 a[132:133], v11 offset:8192
ds_read_b64_tr_b16 a[134:135], v11 offset:8704
v_mfma_f32_16x16x32_bf16 v[188:191], a[188:191], a[76:79], v[188:191]
buffer_store_dwordx4 v[28:31], v15, s[24:27], s82 offen offset:3072 sc1
v_mfma_f32_16x16x32_bf16 v[184:187], a[180:183], a[76:79], v[184:187]
s_lshl_b32 s52, s7, 4
v_and_b32 v22, 3, v1
v_lshl_add_u32 v22, v22, 2, s52
v_mfma_f32_16x16x32_bf16 v[184:187], a[176:179], a[72:75], v[184:187]
buffer_load_dwordx4 v8, s[16:19], s64 offen offset:1024 lds
v_mfma_f32_16x16x32_bf16 v[180:183], a[168:171], a[72:75], v[180:183]
ds_read_b128 a[68:71], v10 offset:0
v_mfma_f32_16x16x32_bf16 v[180:183], a[172:175], a[76:79], v[180:183]
buffer_load_dword v23, v22, s[40:43], 0 offen sc1
v_mfma_f32_16x16x32_bf16 v[176:179], a[164:167], a[76:79], v[176:179]
v_mfma_f32_16x16x32_bf16 v[176:179], a[160:163], a[72:75], v[176:179]
ds_read_b64_tr_b16 a[136:137], v12 offset:0
ds_read_b64_tr_b16 a[138:139], v12 offset:512
v_mfma_f32_16x16x32_bf16 v[192:195], a[160:163], a[80:83], v[192:195]
s_add_u32 m0, s77, 51200
s_add_u32 s64, s76, 131072
v_mfma_f32_16x16x32_bf16 v[192:195], a[164:167], a[84:87], v[192:195]
v_mfma_f32_16x16x32_bf16 v[196:199], a[172:175], a[84:87], v[196:199]
buffer_load_dwordx4 v7, s[16:19], s64 offen lds
v_mfma_f32_16x16x32_bf16 v[196:199], a[168:171], a[80:83], v[196:199]
ds_read_b128 a[72:75], v9 offset:2048
v_mfma_f32_16x16x32_bf16 v[200:203], a[176:179], a[80:83], v[200:203]
v_mfma_f32_16x16x32_bf16 v[200:203], a[180:183], a[84:87], v[200:203]
ds_read_b64_tr_b16 a[140:141], v12 offset:8192
ds_read_b64_tr_b16 a[142:143], v12 offset:8704
v_mfma_f32_16x16x32_bf16 v[204:207], a[188:191], a[84:87], v[204:207]
v_mfma_f32_16x16x32_bf16 v[204:207], a[184:187], a[80:83], v[204:207]
v_mfma_f32_16x16x32_bf16 v[220:223], a[184:187], a[88:91], v[220:223]
ds_read_b128 a[76:79], v10 offset:2048
v_mfma_f32_16x16x32_bf16 v[220:223], a[188:191], a[92:95], v[220:223]
buffer_load_dwordx4 v8, s[16:19], s64 offen offset:1024 lds
v_mfma_f32_16x16x32_bf16 v[216:219], a[180:183], a[92:95], v[216:219]
s_xor_b32 s71, s70, 768
s_add_u32 s71, s68, s71
v_mfma_f32_16x16x32_bf16 v[216:219], a[176:179], a[88:91], v[216:219]
v_mfma_f32_16x16x32_bf16 v[212:215], a[168:171], a[88:91], v[212:215]
ds_read_b64_tr_b16 a[144:145], v13 offset:0
ds_read_b64_tr_b16 a[146:147], v13 offset:512
v_mfma_f32_16x16x32_bf16 v[212:215], a[172:175], a[92:95], v[212:215]
v_mfma_f32_16x16x32_bf16 v[208:211], a[164:167], a[92:95], v[208:211]
v_mfma_f32_16x16x32_bf16 v[208:211], a[160:163], a[88:91], v[208:211]
s_add_u32 m0, s73, 0
s_add_u32 s64, s71, 0
ds_read_b128 a[80:83], v9 offset:4096
v_mfma_f32_16x16x32_bf16 v[224:227], a[160:163], a[96:99], v[224:227]
v_mfma_f32_16x16x32_bf16 v[224:227], a[164:167], a[100:103], v[224:227]
buffer_load_dwordx4 v5, s[8:11], s64 offen lds
v_mfma_f32_16x16x32_bf16 v[228:231], a[172:175], a[100:103], v[228:231]
ds_read_b64_tr_b16 a[148:149], v13 offset:8192
ds_read_b64_tr_b16 a[150:151], v13 offset:8704
v_mfma_f32_16x16x32_bf16 v[228:231], a[168:171], a[96:99], v[228:231]
v_mfma_f32_16x16x32_bf16 v[232:235], a[176:179], a[96:99], v[232:235]
v_mfma_f32_16x16x32_bf16 v[232:235], a[180:183], a[100:103], v[232:235]
ds_read_b128 a[84:87], v10 offset:4096
v_mfma_f32_16x16x32_bf16 v[236:239], a[188:191], a[100:103], v[236:239]
v_mfma_f32_16x16x32_bf16 v[236:239], a[184:187], a[96:99], v[236:239]
v_mfma_f32_16x16x32_bf16 v[252:255], a[184:187], a[104:107], v[252:255]
buffer_load_dwordx4 v6, s[8:11], s64 offen offset:1024 lds
v_mfma_f32_16x16x32_bf16 v[252:255], a[188:191], a[108:111], v[252:255]
ds_read_b64_tr_b16 a[152:153], v14 offset:0
ds_read_b64_tr_b16 a[154:155], v14 offset:512
v_mfma_f32_16x16x32_bf16 v[248:251], a[180:183], a[108:111], v[248:251]
v_mfma_f32_16x16x32_bf16 v[248:251], a[176:179], a[104:107], v[248:251]
v_mfma_f32_16x16x32_bf16 v[244:247], a[168:171], a[104:107], v[244:247]
ds_read_b128 a[88:91], v9 offset:6144
v_mfma_f32_16x16x32_bf16 v[244:247], a[172:175], a[108:111], v[244:247]
s_add_u32 m0, s73, 2048
s_add_u32 s64, s71, 16384
v_mfma_f32_16x16x32_bf16 v[240:243], a[164:167], a[108:111], v[240:243]
v_mfma_f32_16x16x32_bf16 v[240:243], a[160:163], a[104:107], v[240:243]
buffer_load_dwordx4 v5, s[8:11], s64 offen lds
v_mfma_f32_16x16x32_bf16 a[0:3], a[160:163], a[112:115], a[0:3]
ds_read_b64_tr_b16 a[156:157], v14 offset:8192
ds_read_b64_tr_b16 a[158:159], v14 offset:8704
v_mfma_f32_16x16x32_bf16 a[0:3], a[164:167], a[116:119], a[0:3]
v_mfma_f32_16x16x32_bf16 a[4:7], a[172:175], a[116:119], a[4:7]
ds_read_b128 a[92:95], v10 offset:6144
v_mfma_f32_16x16x32_bf16 a[4:7], a[168:171], a[112:115], a[4:7]
v_mfma_f32_16x16x32_bf16 a[8:11], a[176:179], a[112:115], a[8:11]
v_mfma_f32_16x16x32_bf16 a[8:11], a[180:183], a[116:119], a[8:11]
v_mfma_f32_16x16x32_bf16 a[12:15], a[188:191], a[116:119], a[12:15]
buffer_load_dwordx4 v6, s[8:11], s64 offen offset:1024 lds
v_mfma_f32_16x16x32_bf16 a[12:15], a[184:187], a[112:115], a[12:15]
v_mfma_f32_16x16x32_bf16 a[28:31], a[184:187], a[120:123], a[28:31]
v_mfma_f32_16x16x32_bf16 a[28:31], a[188:191], a[124:127], a[28:31]
v_mfma_f32_16x16x32_bf16 a[24:27], a[180:183], a[124:127], a[24:27]
v_mfma_f32_16x16x32_bf16 a[24:27], a[176:179], a[120:123], a[24:27]
v_mfma_f32_16x16x32_bf16 a[20:23], a[168:171], a[120:123], a[20:23]
v_mfma_f32_16x16x32_bf16 a[20:23], a[172:175], a[124:127], a[20:23]
v_mfma_f32_16x16x32_bf16 a[16:19], a[164:167], a[124:127], a[16:19]
v_mfma_f32_16x16x32_bf16 a[16:19], a[160:163], a[120:123], a[16:19]
s_waitcnt lgkmcnt(0)
v_mfma_f32_16x16x32_bf16 v[32:35], a[64:67], a[128:131], v[32:35]
s_waitcnt vmcnt(25)
v_mfma_f32_16x16x32_bf16 v[32:35], a[68:71], a[132:135], v[32:35]
s_barrier
v_mfma_f32_16x16x32_bf16 v[40:43], a[68:71], a[140:143], v[40:43]
ds_read_b128 a[96:99], v9 offset:8192
v_mfma_f32_16x16x32_bf16 v[40:43], a[64:67], a[136:139], v[40:43]
s_xor_b32 s76, s75, 3145728
s_add_u32 s76, s74, s76
v_mfma_f32_16x16x32_bf16 v[48:51], a[64:67], a[144:147], v[48:51]
s_add_u32 m0, s77, 0
s_add_u32 s64, s76, 0
v_mfma_f32_16x16x32_bf16 v[48:51], a[68:71], a[148:151], v[48:51]
buffer_load_dwordx4 v7, s[56:59], s64 offen lds
v_mfma_f32_16x16x32_bf16 v[56:59], a[68:71], a[156:159], v[56:59]
ds_read_b128 a[100:103], v10 offset:8192
v_mfma_f32_16x16x32_bf16 v[56:59], a[64:67], a[152:155], v[56:59]
v_mfma_f32_16x16x32_bf16 v[60:63], a[72:75], a[152:155], v[60:63]
ds_read_b128 a[104:107], v9 offset:10240
v_mfma_f32_16x16x32_bf16 v[60:63], a[76:79], a[156:159], v[60:63]
v_mfma_f32_16x16x32_bf16 v[52:55], a[76:79], a[148:151], v[52:55]
v_mfma_f32_16x16x32_bf16 v[52:55], a[72:75], a[144:147], v[52:55]
buffer_load_dwordx4 v8, s[56:59], s64 offen offset:1024 lds
v_mfma_f32_16x16x32_bf16 v[44:47], a[72:75], a[136:139], v[44:47]
ds_read_b64_tr_b16 a[160:161], v11 offset:16384
ds_read_b64_tr_b16 a[162:163], v11 offset:16896
v_mfma_f32_16x16x32_bf16 v[44:47], a[76:79], a[140:143], v[44:47]
v_mfma_f32_16x16x32_bf16 v[36:39], a[76:79], a[132:135], v[36:39]
v_mfma_f32_16x16x32_bf16 v[36:39], a[72:75], a[128:131], v[36:39]
ds_read_b128 a[108:111], v10 offset:10240
v_mfma_f32_16x16x32_bf16 v[64:67], a[80:83], a[128:131], v[64:67]
s_add_u32 m0, s77, 2048
s_add_u32 s64, s76, 131072
s_waitcnt vmcnt(8)
v_mfma_f32_16x16x32_bf16 v[64:67], a[84:87], a[132:135], v[64:67]
v_cmp_gt_u32 vcc, 1, v23
v_mfma_f32_16x16x32_bf16 v[72:75], a[84:87], a[140:143], v[72:75]
buffer_load_dwordx4 v7, s[56:59], s64 offen lds
v_mfma_f32_16x16x32_bf16 v[72:75], a[80:83], a[136:139], v[72:75]
ds_read_b64_tr_b16 a[164:165], v11 offset:24576
ds_read_b64_tr_b16 a[166:167], v11 offset:25088
v_mfma_f32_16x16x32_bf16 v[80:83], a[80:83], a[144:147], v[80:83]
v_mfma_f32_16x16x32_bf16 v[80:83], a[84:87], a[148:151], v[80:83]
ds_read_b128 a[112:115], v9 offset:12288
v_mfma_f32_16x16x32_bf16 v[88:91], a[84:87], a[156:159], v[88:91]
s_cbranch_vccnz CK_Z
CK_Z_R:
v_mfma_f32_16x16x32_bf16 v[88:91], a[80:83], a[152:155], v[88:91]
buffer_atomic_add v1, v0, s[24:27], s84 offen offset:0 sc1
v_mfma_f32_16x16x32_bf16 v[92:95], a[88:91], a[152:155], v[92:95]
ds_read_b64_tr_b16 a[168:169], v12 offset:16384
ds_read_b64_tr_b16 a[170:171], v12 offset:16896
v_mfma_f32_16x16x32_bf16 v[92:95], a[92:95], a[156:159], v[92:95]
buffer_load_dwordx4 v8, s[56:59], s64 offen offset:1024 lds
v_mfma_f32_16x16x32_bf16 v[84:87], a[92:95], a[148:151], v[84:87]
v_mov_b32 v29, 0
v_mfma_f32_16x16x32_bf16 v[84:87], a[88:91], a[144:147], v[84:87]
v_mfma_f32_16x16x32_bf16 v[76:79], a[88:91], a[136:139], v[76:79]
ds_read_b128 a[116:119], v10 offset:12288
v_mfma_f32_16x16x32_bf16 v[76:79], a[92:95], a[140:143], v[76:79]
v_mfma_f32_16x16x32_bf16 v[68:71], a[92:95], a[132:135], v[68:71]
v_mfma_f32_16x16x32_bf16 v[68:71], a[88:91], a[128:131], v[68:71]
s_add_u32 m0, s73, 4096
s_add_u32 s64, s71, 524288
s_waitcnt lgkmcnt(6)
v_mfma_f32_16x16x32_bf16 v[96:99], a[96:99], a[128:131], v[96:99]
ds_read_b64_tr_b16 a[172:173], v12 offset:24576
ds_read_b64_tr_b16 a[174:175], v12 offset:25088
v_mfma_f32_16x16x32_bf16 v[96:99], a[100:103], a[132:135], v[96:99]
buffer_load_dwordx4 v5, s[8:11], s64 offen lds
v_mfma_f32_16x16x32_bf16 v[104:107], a[100:103], a[140:143], v[104:107]
ds_read_b128 a[120:123], v9 offset:14336
v_mfma_f32_16x16x32_bf16 v[104:107], a[96:99], a[136:139], v[104:107]
v_mfma_f32_16x16x32_bf16 v[112:115], a[96:99], a[144:147], v[112:115]
v_mfma_f32_16x16x32_bf16 v[112:115], a[100:103], a[148:151], v[112:115]
ds_read_b64_tr_b16 a[176:177], v13 offset:16384
ds_read_b64_tr_b16 a[178:179], v13 offset:16896
v_mfma_f32_16x16x32_bf16 v[120:123], a[100:103], a[156:159], v[120:123]
v_mfma_f32_16x16x32_bf16 v[120:123], a[96:99], a[152:155], v[120:123]
v_mfma_f32_16x16x32_bf16 v[124:127], a[104:107], a[152:155], v[124:127]
buffer_load_dwordx4 v6, s[8:11], s64 offen offset:1024 lds
v_mfma_f32_16x16x32_bf16 v[124:127], a[108:111], a[156:159], v[124:127]
ds_read_b128 a[124:127], v10 offset:14336
v_mfma_f32_16x16x32_bf16 v[116:119], a[108:111], a[148:151], v[116:119]
v_add_u32 v9, 32768, v9
v_add_u32 v10, 32768, v10
v_mfma_f32_16x16x32_bf16 v[116:119], a[104:107], a[144:147], v[116:119]
v_mfma_f32_16x16x32_bf16 v[108:111], a[104:107], a[136:139], v[108:111]
ds_read_b64_tr_b16 a[180:181], v13 offset:24576
ds_read_b64_tr_b16 a[182:183], v13 offset:25088
v_mfma_f32_16x16x32_bf16 v[108:111], a[108:111], a[140:143], v[108:111]
s_add_u32 m0, s73, 6144
s_add_u32 s64, s71, 540672
v_mfma_f32_16x16x32_bf16 v[100:103], a[108:111], a[132:135], v[100:103]
s_waitcnt lgkmcnt(2)
v_mfma_f32_16x16x32_bf16 v[100:103], a[104:107], a[128:131], v[100:103]
buffer_load_dwordx4 v5, s[8:11], s64 offen lds
v_mfma_f32_16x16x32_bf16 v[128:131], a[112:115], a[128:131], v[128:131]
ds_read_b64_tr_b16 a[184:185], v14 offset:16384
ds_read_b64_tr_b16 a[186:187], v14 offset:16896
v_mfma_f32_16x16x32_bf16 v[128:131], a[116:119], a[132:135], v[128:131]
v_mfma_f32_16x16x32_bf16 v[136:139], a[116:119], a[140:143], v[136:139]
ds_read_b64_tr_b16 a[188:189], v14 offset:24576
ds_read_b64_tr_b16 a[190:191], v14 offset:25088
v_mfma_f32_16x16x32_bf16 v[136:139], a[112:115], a[136:139], v[136:139]
v_mfma_f32_16x16x32_bf16 v[144:147], a[112:115], a[144:147], v[144:147]
v_mfma_f32_16x16x32_bf16 v[144:147], a[116:119], a[148:151], v[144:147]
v_mfma_f32_16x16x32_bf16 v[152:155], a[116:119], a[156:159], v[152:155]
buffer_load_dwordx4 v6, s[8:11], s64 offen offset:1024 lds
v_mfma_f32_16x16x32_bf16 v[152:155], a[112:115], a[152:155], v[152:155]
v_mfma_f32_16x16x32_bf16 v[156:159], a[120:123], a[152:155], v[156:159]
v_mfma_f32_16x16x32_bf16 v[156:159], a[124:127], a[156:159], v[156:159]
v_mfma_f32_16x16x32_bf16 v[148:151], a[124:127], a[148:151], v[148:151]
v_mfma_f32_16x16x32_bf16 v[148:151], a[120:123], a[144:147], v[148:151]
v_mfma_f32_16x16x32_bf16 v[140:143], a[120:123], a[136:139], v[140:143]
v_mfma_f32_16x16x32_bf16 v[140:143], a[124:127], a[140:143], v[140:143]
v_mfma_f32_16x16x32_bf16 v[132:135], a[124:127], a[132:135], v[132:135]
v_mfma_f32_16x16x32_bf16 v[132:135], a[120:123], a[128:131], v[132:135]
s_waitcnt lgkmcnt(0)
v_mfma_f32_16x16x32_bf16 v[160:163], a[160:163], a[64:67], v[160:163]
s_waitcnt vmcnt(20)
v_mfma_f32_16x16x32_bf16 v[160:163], a[164:167], a[68:71], v[160:163]
s_barrier
v_mfma_f32_16x16x32_bf16 v[164:167], a[172:175], a[68:71], v[164:167]
ds_read_b64_tr_b16 a[128:129], v11 offset:32768
ds_read_b64_tr_b16 a[130:131], v11 offset:33280
v_mfma_f32_16x16x32_bf16 v[164:167], a[168:171], a[64:67], v[164:167]
s_add_u32 m0, s77, 16384
s_add_u32 s64, s76, 0
v_mfma_f32_16x16x32_bf16 v[168:171], a[176:179], a[64:67], v[168:171]
buffer_load_dwordx4 v7, s[16:19], s64 offen lds
v_mfma_f32_16x16x32_bf16 v[168:171], a[180:183], a[68:71], v[168:171]
buffer_load_dword a253, v20, s[12:15], s53 offen
v_mfma_f32_16x16x32_bf16 v[172:175], a[188:191], a[68:71], v[172:175]
v_mfma_f32_16x16x32_bf16 v[172:175], a[184:187], a[64:67], v[172:175]
ds_read_b128 a[64:67], v9 offset:0
v_mfma_f32_16x16x32_bf16 v[188:191], a[184:187], a[72:75], v[188:191]
ds_read_b64_tr_b16 a[132:133], v11 offset:40960
ds_read_b64_tr_b16 a[134:135], v11 offset:41472
v_mfma_f32_16x16x32_bf16 v[188:191], a[188:191], a[76:79], v[188:191]
v_mfma_f32_16x16x32_bf16 v[184:187], a[180:183], a[76:79], v[184:187]
v_mfma_f32_16x16x32_bf16 v[184:187], a[176:179], a[72:75], v[184:187]
buffer_load_dwordx4 v8, s[16:19], s64 offen offset:1024 lds
v_mfma_f32_16x16x32_bf16 v[180:183], a[168:171], a[72:75], v[180:183]
ds_read_b128 a[68:71], v10 offset:0
v_mfma_f32_16x16x32_bf16 v[180:183], a[172:175], a[76:79], v[180:183]
v_mfma_f32_16x16x32_bf16 v[176:179], a[164:167], a[76:79], v[176:179]
v_mfma_f32_16x16x32_bf16 v[176:179], a[160:163], a[72:75], v[176:179]
ds_read_b64_tr_b16 a[136:137], v12 offset:32768
ds_read_b64_tr_b16 a[138:139], v12 offset:33280
v_mfma_f32_16x16x32_bf16 v[192:195], a[160:163], a[80:83], v[192:195]
s_add_u32 m0, s77, 18432
s_add_u32 s64, s76, 131072
v_mfma_f32_16x16x32_bf16 v[192:195], a[164:167], a[84:87], v[192:195]
v_mfma_f32_16x16x32_bf16 v[196:199], a[172:175], a[84:87], v[196:199]
buffer_load_dwordx4 v7, s[16:19], s64 offen lds
v_mfma_f32_16x16x32_bf16 v[196:199], a[168:171], a[80:83], v[196:199]
ds_read_b128 a[72:75], v9 offset:2048
v_mfma_f32_16x16x32_bf16 v[200:203], a[176:179], a[80:83], v[200:203]
v_mfma_f32_16x16x32_bf16 v[200:203], a[180:183], a[84:87], v[200:203]
ds_read_b64_tr_b16 a[140:141], v12 offset:40960
ds_read_b64_tr_b16 a[142:143], v12 offset:41472
v_mfma_f32_16x16x32_bf16 v[204:207], a[188:191], a[84:87], v[204:207]
L_PAD2:
s_cbranch_execz L_PAD6
v_mfma_f32_16x16x32_bf16 v[204:207], a[184:187], a[80:83], v[204:207]
v_mfma_f32_16x16x32_bf16 v[220:223], a[184:187], a[88:91], v[220:223]
ds_read_b128 a[76:79], v10 offset:2048
v_mfma_f32_16x16x32_bf16 v[220:223], a[188:191], a[92:95], v[220:223]
buffer_load_dwordx4 v8, s[16:19], s64 offen offset:1024 lds
v_mfma_f32_16x16x32_bf16 v[216:219], a[180:183], a[92:95], v[216:219]
s_xor_b32 s71, s70, 896
s_add_u32 s71, s68, s71
v_mfma_f32_16x16x32_bf16 v[216:219], a[176:179], a[88:91], v[216:219]
v_mfma_f32_16x16x32_bf16 v[212:215], a[168:171], a[88:91], v[212:215]
ds_read_b64_tr_b16 a[144:145], v13 offset:32768
ds_read_b64_tr_b16 a[146:147], v13 offset:33280
v_mfma_f32_16x16x32_bf16 v[212:215], a[172:175], a[92:95], v[212:215]
v_mfma_f32_16x16x32_bf16 v[208:211], a[164:167], a[92:95], v[208:211]
v_mfma_f32_16x16x32_bf16 v[208:211], a[160:163], a[88:91], v[208:211]
s_add_u32 m0, s73, 32768
s_add_u32 s64, s71, 0
ds_read_b128 a[80:83], v9 offset:4096
v_mfma_f32_16x16x32_bf16 v[224:227], a[160:163], a[96:99], v[224:227]
v_mfma_f32_16x16x32_bf16 v[224:227], a[164:167], a[100:103], v[224:227]
buffer_load_dwordx4 v5, s[8:11], s64 offen lds
v_mfma_f32_16x16x32_bf16 v[228:231], a[172:175], a[100:103], v[228:231]
ds_read_b64_tr_b16 a[148:149], v13 offset:40960
ds_read_b64_tr_b16 a[150:151], v13 offset:41472
v_mfma_f32_16x16x32_bf16 v[228:231], a[168:171], a[96:99], v[228:231]
v_mfma_f32_16x16x32_bf16 v[232:235], a[176:179], a[96:99], v[232:235]
v_mfma_f32_16x16x32_bf16 v[232:235], a[180:183], a[100:103], v[232:235]
ds_read_b128 a[84:87], v10 offset:4096
v_mfma_f32_16x16x32_bf16 v[236:239], a[188:191], a[100:103], v[236:239]
v_mfma_f32_16x16x32_bf16 v[236:239], a[184:187], a[96:99], v[236:239]
v_mfma_f32_16x16x32_bf16 v[252:255], a[184:187], a[104:107], v[252:255]
buffer_load_dwordx4 v6, s[8:11], s64 offen offset:1024 lds
v_mfma_f32_16x16x32_bf16 v[252:255], a[188:191], a[108:111], v[252:255]
ds_read_b64_tr_b16 a[152:153], v14 offset:32768
ds_read_b64_tr_b16 a[154:155], v14 offset:33280
v_mfma_f32_16x16x32_bf16 v[248:251], a[180:183], a[108:111], v[248:251]
v_mfma_f32_16x16x32_bf16 v[248:251], a[176:179], a[104:107], v[248:251]
v_mfma_f32_16x16x32_bf16 v[244:247], a[168:171], a[104:107], v[244:247]
ds_read_b128 a[88:91], v9 offset:6144
v_mfma_f32_16x16x32_bf16 v[244:247], a[172:175], a[108:111], v[244:247]
s_add_u32 m0, s73, 34816
s_add_u32 s64, s71, 16384
v_mfma_f32_16x16x32_bf16 v[240:243], a[164:167], a[108:111], v[240:243]
v_mfma_f32_16x16x32_bf16 v[240:243], a[160:163], a[104:107], v[240:243]
buffer_load_dwordx4 v5, s[8:11], s64 offen lds
v_mfma_f32_16x16x32_bf16 a[0:3], a[160:163], a[112:115], a[0:3]
ds_read_b64_tr_b16 a[156:157], v14 offset:40960
ds_read_b64_tr_b16 a[158:159], v14 offset:41472
v_mfma_f32_16x16x32_bf16 a[0:3], a[164:167], a[116:119], a[0:3]
v_mfma_f32_16x16x32_bf16 a[4:7], a[172:175], a[116:119], a[4:7]
ds_read_b128 a[92:95], v10 offset:6144
v_mfma_f32_16x16x32_bf16 a[4:7], a[168:171], a[112:115], a[4:7]
v_mfma_f32_16x16x32_bf16 a[8:11], a[176:179], a[112:115], a[8:11]
v_mfma_f32_16x16x32_bf16 a[8:11], a[180:183], a[116:119], a[8:11]
v_mfma_f32_16x16x32_bf16 a[12:15], a[188:191], a[116:119], a[12:15]
buffer_load_dwordx4 v6, s[8:11], s64 offen offset:1024 lds
v_mfma_f32_16x16x32_bf16 a[12:15], a[184:187], a[112:115], a[12:15]
v_mfma_f32_16x16x32_bf16 a[28:31], a[184:187], a[120:123], a[28:31]
v_mfma_f32_16x16x32_bf16 a[28:31], a[188:191], a[124:127], a[28:31]
v_mfma_f32_16x16x32_bf16 a[24:27], a[180:183], a[124:127], a[24:27]
v_mfma_f32_16x16x32_bf16 a[24:27], a[176:179], a[120:123], a[24:27]
v_mfma_f32_16x16x32_bf16 a[20:23], a[168:171], a[120:123], a[20:23]
v_mfma_f32_16x16x32_bf16 a[20:23], a[172:175], a[124:127], a[20:23]
v_mfma_f32_16x16x32_bf16 a[16:19], a[164:167], a[124:127], a[16:19]
v_mfma_f32_16x16x32_bf16 a[16:19], a[160:163], a[120:123], a[16:19]
s_waitcnt lgkmcnt(0)
v_mfma_f32_16x16x32_bf16 v[32:35], a[64:67], a[128:131], v[32:35]
s_waitcnt vmcnt(22)
v_mfma_f32_16x16x32_bf16 v[32:35], a[68:71], a[132:135], v[32:35]
s_barrier
v_mfma_f32_16x16x32_bf16 v[40:43], a[68:71], a[140:143], v[40:43]
ds_read_b128 a[96:99], v9 offset:8192
v_mfma_f32_16x16x32_bf16 v[40:43], a[64:67], a[136:139], v[40:43]
s_xor_b32 s76, s75, 3670016
s_add_u32 s76, s74, s76
v_mfma_f32_16x16x32_bf16 v[48:51], a[64:67], a[144:147], v[48:51]
s_add_u32 m0, s77, 32768
s_add_u32 s64, s76, 0
v_mfma_f32_16x16x32_bf16 v[48:51], a[68:71], a[148:151], v[48:51]
buffer_load_dwordx4 v7, s[56:59], s64 offen lds
v_mfma_f32_16x16x32_bf16 v[56:59], a[68:71], a[156:159], v[56:59]
ds_read_b128 a[100:103], v10 offset:8192
v_mfma_f32_16x16x32_bf16 v[56:59], a[64:67], a[152:155], v[56:59]
buffer_load_dword a252, v21, s[20:23], s55 offen
v_mfma_f32_16x16x32_bf16 v[60:63], a[72:75], a[152:155], v[60:63]
s_add_u32 s55, s55, 24576
s_mul_i32 s54, s54, 896
ds_read_b128 a[104:107], v9 offset:10240
v_mfma_f32_16x16x32_bf16 v[60:63], a[76:79], a[156:159], v[60:63]
v_mfma_f32_16x16x32_bf16 v[52:55], a[76:79], a[148:151], v[52:55]
v_mfma_f32_16x16x32_bf16 v[52:55], a[72:75], a[144:147], v[52:55]
buffer_load_dwordx4 v8, s[56:59], s64 offen offset:1024 lds
v_mfma_f32_16x16x32_bf16 v[44:47], a[72:75], a[136:139], v[44:47]
ds_read_b64_tr_b16 a[160:161], v11 offset:49152
ds_read_b64_tr_b16 a[162:163], v11 offset:49664
v_mfma_f32_16x16x32_bf16 v[44:47], a[76:79], a[140:143], v[44:47]
v_mfma_f32_16x16x32_bf16 v[36:39], a[76:79], a[132:135], v[36:39]
v_mfma_f32_16x16x32_bf16 v[36:39], a[72:75], a[128:131], v[36:39]
ds_read_b128 a[108:111], v10 offset:10240
v_mfma_f32_16x16x32_bf16 v[64:67], a[80:83], a[128:131], v[64:67]
s_add_u32 m0, s77, 34816
s_add_u32 s64, s76, 131072
v_mfma_f32_16x16x32_bf16 v[64:67], a[84:87], a[132:135], v[64:67]
v_mfma_f32_16x16x32_bf16 v[72:75], a[84:87], a[140:143], v[72:75]
buffer_load_dwordx4 v7, s[56:59], s64 offen lds
v_mfma_f32_16x16x32_bf16 v[72:75], a[80:83], a[136:139], v[72:75]
ds_read_b64_tr_b16 a[164:165], v11 offset:57344
ds_read_b64_tr_b16 a[166:167], v11 offset:57856
v_mfma_f32_16x16x32_bf16 v[80:83], a[80:83], a[144:147], v[80:83]
v_mfma_f32_16x16x32_bf16 v[80:83], a[84:87], a[148:151], v[80:83]
ds_read_b128 a[112:115], v9 offset:12288
v_mfma_f32_16x16x32_bf16 v[88:91], a[84:87], a[156:159], v[88:91]
v_mfma_f32_16x16x32_bf16 v[88:91], a[80:83], a[152:155], v[88:91]
v_mfma_f32_16x16x32_bf16 v[92:95], a[88:91], a[152:155], v[92:95]
ds_read_b64_tr_b16 a[168:169], v12 offset:49152
ds_read_b64_tr_b16 a[170:171], v12 offset:49664
v_mfma_f32_16x16x32_bf16 v[92:95], a[92:95], a[156:159], v[92:95]
buffer_load_dwordx4 v8, s[56:59], s64 offen offset:1024 lds
v_mfma_f32_16x16x32_bf16 v[84:87], a[92:95], a[148:151], v[84:87]
v_mfma_f32_16x16x32_bf16 v[84:87], a[88:91], a[144:147], v[84:87]
v_mfma_f32_16x16x32_bf16 v[76:79], a[88:91], a[136:139], v[76:79]
ds_read_b128 a[116:119], v10 offset:12288
v_mfma_f32_16x16x32_bf16 v[76:79], a[92:95], a[140:143], v[76:79]
v_mfma_f32_16x16x32_bf16 v[68:71], a[92:95], a[132:135], v[68:71]
v_mfma_f32_16x16x32_bf16 v[68:71], a[88:91], a[128:131], v[68:71]
s_add_u32 m0, s73, 36864
s_add_u32 s64, s71, 524288
s_waitcnt lgkmcnt(6)
v_mfma_f32_16x16x32_bf16 v[96:99], a[96:99], a[128:131], v[96:99]
ds_read_b64_tr_b16 a[172:173], v12 offset:57344
ds_read_b64_tr_b16 a[174:175], v12 offset:57856
v_mfma_f32_16x16x32_bf16 v[96:99], a[100:103], a[132:135], v[96:99]
buffer_load_dwordx4 v5, s[8:11], s64 offen lds
v_mfma_f32_16x16x32_bf16 v[104:107], a[100:103], a[140:143], v[104:107]
ds_read_b128 a[120:123], v9 offset:14336
v_mfma_f32_16x16x32_bf16 v[104:107], a[96:99], a[136:139], v[104:107]
v_mfma_f32_16x16x32_bf16 v[112:115], a[96:99], a[144:147], v[112:115]
v_mfma_f32_16x16x32_bf16 v[112:115], a[100:103], a[148:151], v[112:115]
ds_read_b64_tr_b16 a[176:177], v13 offset:49152
ds_read_b64_tr_b16 a[178:179], v13 offset:49664
v_mfma_f32_16x16x32_bf16 v[120:123], a[100:103], a[156:159], v[120:123]
v_mfma_f32_16x16x32_bf16 v[120:123], a[96:99], a[152:155], v[120:123]
v_mfma_f32_16x16x32_bf16 v[124:127], a[104:107], a[152:155], v[124:127]
buffer_load_dwordx4 v6, s[8:11], s64 offen offset:1024 lds
v_mfma_f32_16x16x32_bf16 v[124:127], a[108:111], a[156:159], v[124:127]
ds_read_b128 a[124:127], v10 offset:14336
v_mfma_f32_16x16x32_bf16 v[116:119], a[108:111], a[148:151], v[116:119]
v_add_u32 v9, -65536, v9
v_add_u32 v10, -65536, v10
v_mfma_f32_16x16x32_bf16 v[116:119], a[104:107], a[144:147], v[116:119]
buffer_load_dword v30, v29, s[24:27], s89 offen sc1
v_mfma_f32_16x16x32_bf16 v[108:111], a[104:107], a[136:139], v[108:111]
ds_read_b64_tr_b16 a[180:181], v13 offset:57344
ds_read_b64_tr_b16 a[182:183], v13 offset:57856
v_mfma_f32_16x16x32_bf16 v[108:111], a[108:111], a[140:143], v[108:111]
s_add_u32 m0, s73, 38912
s_add_u32 s64, s71, 540672
v_mfma_f32_16x16x32_bf16 v[100:103], a[108:111], a[132:135], v[100:103]
s_waitcnt lgkmcnt(2)
v_mfma_f32_16x16x32_bf16 v[100:103], a[104:107], a[128:131], v[100:103]
buffer_load_dwordx4 v5, s[8:11], s64 offen lds
v_mfma_f32_16x16x32_bf16 v[128:131], a[112:115], a[128:131], v[128:131]
ds_read_b64_tr_b16 a[184:185], v14 offset:49152
ds_read_b64_tr_b16 a[186:187], v14 offset:49664
v_mfma_f32_16x16x32_bf16 v[128:131], a[116:119], a[132:135], v[128:131]
v_mfma_f32_16x16x32_bf16 v[136:139], a[116:119], a[140:143], v[136:139]
ds_read_b64_tr_b16 a[188:189], v14 offset:57344
ds_read_b64_tr_b16 a[190:191], v14 offset:57856
v_mfma_f32_16x16x32_bf16 v[136:139], a[112:115], a[136:139], v[136:139]
v_mfma_f32_16x16x32_bf16 v[144:147], a[112:115], a[144:147], v[144:147]
v_mfma_f32_16x16x32_bf16 v[144:147], a[116:119], a[148:151], v[144:147]
v_mfma_f32_16x16x32_bf16 v[152:155], a[116:119], a[156:159], v[152:155]
buffer_load_dwordx4 v6, s[8:11], s64 offen offset:1024 lds
v_mfma_f32_16x16x32_bf16 v[152:155], a[112:115], a[152:155], v[152:155]
v_mfma_f32_16x16x32_bf16 v[156:159], a[120:123], a[152:155], v[156:159]
v_mfma_f32_16x16x32_bf16 v[156:159], a[124:127], a[156:159], v[156:159]
v_mfma_f32_16x16x32_bf16 v[148:151], a[124:127], a[148:151], v[148:151]
v_mfma_f32_16x16x32_bf16 v[148:151], a[120:123], a[144:147], v[148:151]
v_mfma_f32_16x16x32_bf16 v[140:143], a[120:123], a[136:139], v[140:143]
v_mfma_f32_16x16x32_bf16 v[140:143], a[124:127], a[140:143], v[140:143]
v_mfma_f32_16x16x32_bf16 v[132:135], a[124:127], a[132:135], v[132:135]
v_mfma_f32_16x16x32_bf16 v[132:135], a[120:123], a[128:131], v[132:135]
s_waitcnt lgkmcnt(0)
v_mfma_f32_16x16x32_bf16 v[160:163], a[160:163], a[64:67], v[160:163]
s_waitcnt vmcnt(19)
v_mfma_f32_16x16x32_bf16 v[160:163], a[164:167], a[68:71], v[160:163]
s_barrier
v_mfma_f32_16x16x32_bf16 v[164:167], a[172:175], a[68:71], v[164:167]
ds_read_b64_tr_b16 a[128:129], v11 offset:0
ds_read_b64_tr_b16 a[130:131], v11 offset:512
v_mfma_f32_16x16x32_bf16 v[164:167], a[168:171], a[64:67], v[164:167]
s_add_u32 m0, s77, 49152
s_add_u32 s64, s76, 0
v_mfma_f32_16x16x32_bf16 v[168:171], a[176:179], a[64:67], v[168:171]
buffer_load_dwordx4 v7, s[16:19], s64 offen lds
v_mfma_f32_16x16x32_bf16 v[168:171], a[180:183], a[68:71], v[168:171]
buffer_load_dword a252, v21, s[20:23], s55 offen
v_mfma_f32_16x16x32_bf16 v[172:175], a[188:191], a[68:71], v[172:175]
s_lshr_b32 s55, s2, 1
s_lshl2_add_u32 s55, s55, s3
s_mul_i32 s55, s55, 9216
v_mfma_f32_16x16x32_bf16 v[172:175], a[184:187], a[64:67], v[172:175]
s_and_b32 s53, s2, 1
s_lshl_b32 s53, s53, 9
ds_read_b128 a[64:67], v9 offset:0
v_mfma_f32_16x16x32_bf16 v[188:191], a[184:187], a[72:75], v[188:191]
s_add_u32 s55, s55, s53
ds_read_b64_tr_b16 a[132:133], v11 offset:8192
ds_read_b64_tr_b16 a[134:135], v11 offset:8704
v_mfma_f32_16x16x32_bf16 v[188:191], a[188:191], a[76:79], v[188:191]
v_min_u32 v20, 39, v1
v_and_b32 v21, 7, v20
v_mfma_f32_16x16x32_bf16 v[184:187], a[180:183], a[76:79], v[184:187]
v_mul_u32_u24 v21, 1152, v21
v_lshrrev_b32 v20, 3, v20
v_mfma_f32_16x16x32_bf16 v[184:187], a[176:179], a[72:75], v[184:187]
buffer_load_dwordx4 v8, s[16:19], s64 offen offset:1024 lds
v_mfma_f32_16x16x32_bf16 v[180:183], a[168:171], a[72:75], v[180:183]
ds_read_b128 a[68:71], v10 offset:0
v_lshl_add_u32 v21, v20, 7, v21
v_mfma_f32_16x16x32_bf16 v[180:183], a[172:175], a[76:79], v[180:183]
v_min_u32 v20, 6, v1
v_lshlrev_b32 v20, 7, v20
v_mfma_f32_16x16x32_bf16 v[176:179], a[164:167], a[76:79], v[176:179]
v_mfma_f32_16x16x32_bf16 v[176:179], a[160:163], a[72:75], v[176:179]
ds_read_b64_tr_b16 a[136:137], v12 offset:0
ds_read_b64_tr_b16 a[138:139], v12 offset:512
v_mfma_f32_16x16x32_bf16 v[192:195], a[160:163], a[80:83], v[192:195]
s_add_u32 m0, s77, 51200
s_add_u32 s64, s76, 131072
v_mfma_f32_16x16x32_bf16 v[192:195], a[164:167], a[84:87], v[192:195]
v_mfma_f32_16x16x32_bf16 v[196:199], a[172:175], a[84:87], v[196:199]
buffer_load_dwordx4 v7, s[16:19], s64 offen lds
v_mfma_f32_16x16x32_bf16 v[196:199], a[168:171], a[80:83], v[196:199]
ds_read_b128 a[72:75], v9 offset:2048
v_mfma_f32_16x16x32_bf16 v[200:203], a[176:179], a[80:83], v[200:203]
v_mfma_f32_16x16x32_bf16 v[200:203], a[180:183], a[84:87], v[200:203]
ds_read_b64_tr_b16 a[140:141], v12 offset:8192
ds_read_b64_tr_b16 a[142:143], v12 offset:8704
v_mfma_f32_16x16x32_bf16 v[204:207], a[188:191], a[84:87], v[204:207]
v_mfma_f32_16x16x32_bf16 v[204:207], a[184:187], a[80:83], v[204:207]
v_mfma_f32_16x16x32_bf16 v[220:223], a[184:187], a[88:91], v[220:223]
ds_read_b128 a[76:79], v10 offset:2048
v_mfma_f32_16x16x32_bf16 v[220:223], a[188:191], a[92:95], v[220:223]
buffer_load_dwordx4 v8, s[16:19], s64 offen offset:1024 lds
v_mfma_f32_16x16x32_bf16 v[216:219], a[180:183], a[92:95], v[216:219]
s_lshl_b32 s70, s93, 7
s_mul_i32 s68, s66, 36864
s_mul_i32 s69, s67, 36864
v_mfma_f32_16x16x32_bf16 v[216:219], a[176:179], a[88:91], v[216:219]
v_lshrrev_b32 v31, 3, v1
v_lshl_add_u32 v5, v31, 7, v5
v_mfma_f32_16x16x32_bf16 v[212:215], a[168:171], a[88:91], v[212:215]
v_lshl_add_u32 v6, v31, 7, v6
v_add_u32 v6, 1024, v6
v_mfma_f32_16x16x32_bf16 v[212:215], a[172:175], a[92:95], v[212:215]
s_mov_b32 s65, 1024
s_add_u32 s71, s68, s65
s_add_u32 s72, s69, s65
v_mfma_f32_16x16x32_bf16 v[208:211], a[164:167], a[92:95], v[208:211]
ds_read_b64_tr_b16 a[144:145], v13 offset:0
ds_read_b64_tr_b16 a[146:147], v13 offset:512
v_mfma_f32_16x16x32_bf16 v[208:211], a[160:163], a[88:91], v[208:211]
s_add_u32 m0, s73, 65536
s_add_u32 s64, s71, 0
ds_read_b128 a[80:83], v9 offset:4096
v_mfma_f32_16x16x32_bf16 v[224:227], a[160:163], a[96:99], v[224:227]
v_mfma_f32_16x16x32_bf16 v[224:227], a[164:167], a[100:103], v[224:227]
buffer_load_dwordx4 v5, s[12:15], s64 offen lds
v_mfma_f32_16x16x32_bf16 v[228:231], a[172:175], a[100:103], v[228:231]
ds_read_b64_tr_b16 a[148:149], v13 offset:8192
ds_read_b64_tr_b16 a[150:151], v13 offset:8704
v_mfma_f32_16x16x32_bf16 v[228:231], a[168:171], a[96:99], v[228:231]
v_mfma_f32_16x16x32_bf16 v[232:235], a[176:179], a[96:99], v[232:235]
v_mfma_f32_16x16x32_bf16 v[232:235], a[180:183], a[100:103], v[232:235]
ds_read_b128 a[84:87], v10 offset:4096
v_mfma_f32_16x16x32_bf16 v[236:239], a[188:191], a[100:103], v[236:239]
v_mfma_f32_16x16x32_bf16 v[236:239], a[184:187], a[96:99], v[236:239]
v_mfma_f32_16x16x32_bf16 v[252:255], a[184:187], a[104:107], v[252:255]
buffer_load_dwordx4 v6, s[12:15], s64 offen offset:1024 lds
v_mfma_f32_16x16x32_bf16 v[252:255], a[188:191], a[108:111], v[252:255]
ds_read_b64_tr_b16 a[152:153], v14 offset:0
ds_read_b64_tr_b16 a[154:155], v14 offset:512
v_mfma_f32_16x16x32_bf16 v[248:251], a[180:183], a[108:111], v[248:251]
v_mfma_f32_16x16x32_bf16 v[248:251], a[176:179], a[104:107], v[248:251]
v_mfma_f32_16x16x32_bf16 v[244:247], a[168:171], a[104:107], v[244:247]
ds_read_b128 a[88:91], v9 offset:6144
v_mfma_f32_16x16x32_bf16 v[244:247], a[172:175], a[108:111], v[244:247]
s_add_u32 m0, s73, 67584
s_add_u32 s64, s71, 18432
v_mfma_f32_16x16x32_bf16 v[240:243], a[164:167], a[108:111], v[240:243]
v_mfma_f32_16x16x32_bf16 v[240:243], a[160:163], a[104:107], v[240:243]
buffer_load_dwordx4 v5, s[12:15], s64 offen lds
v_mfma_f32_16x16x32_bf16 a[0:3], a[160:163], a[112:115], a[0:3]
ds_read_b64_tr_b16 a[156:157], v14 offset:8192
ds_read_b64_tr_b16 a[158:159], v14 offset:8704
v_mfma_f32_16x16x32_bf16 a[0:3], a[164:167], a[116:119], a[0:3]
v_mfma_f32_16x16x32_bf16 a[4:7], a[172:175], a[116:119], a[4:7]
s_waitcnt vmcnt(10)
ds_read_b128 a[92:95], v10 offset:6144
v_mfma_f32_16x16x32_bf16 a[4:7], a[168:171], a[112:115], a[4:7]
v_cmp_gt_u32 vcc, 18, v30
v_mfma_f32_16x16x32_bf16 a[8:11], a[176:179], a[112:115], a[8:11]
v_mfma_f32_16x16x32_bf16 a[8:11], a[180:183], a[116:119], a[8:11]
v_mfma_f32_16x16x32_bf16 a[12:15], a[188:191], a[116:119], a[12:15]
buffer_load_dwordx4 v6, s[12:15], s64 offen offset:1024 lds
v_mfma_f32_16x16x32_bf16 a[12:15], a[184:187], a[112:115], a[12:15]
v_mfma_f32_16x16x32_bf16 a[28:31], a[184:187], a[120:123], a[28:31]
s_cbranch_vccnz CK_WA
CK_WA_R:
v_mfma_f32_16x16x32_bf16 a[28:31], a[188:191], a[124:127], a[28:31]
v_mfma_f32_16x16x32_bf16 a[24:27], a[180:183], a[124:127], a[24:27]
v_mfma_f32_16x16x32_bf16 a[24:27], a[176:179], a[120:123], a[24:27]
v_mfma_f32_16x16x32_bf16 a[20:23], a[168:171], a[120:123], a[20:23]
v_mfma_f32_16x16x32_bf16 a[20:23], a[172:175], a[124:127], a[20:23]
v_mfma_f32_16x16x32_bf16 a[16:19], a[164:167], a[124:127], a[16:19]
v_mfma_f32_16x16x32_bf16 a[16:19], a[160:163], a[120:123], a[16:19]
s_waitcnt lgkmcnt(0)
v_mfma_f32_16x16x32_bf16 v[32:35], a[64:67], a[128:131], v[32:35]
s_waitcnt vmcnt(23)
v_mfma_f32_16x16x32_bf16 v[32:35], a[68:71], a[132:135], v[32:35]
s_barrier
v_mfma_f32_16x16x32_bf16 v[40:43], a[68:71], a[140:143], v[40:43]
ds_read_b128 a[96:99], v9 offset:8192
v_mfma_f32_16x16x32_bf16 v[40:43], a[64:67], a[136:139], v[40:43]
s_lshl_b32 s77, s3, 11
s_lshl_b32 s74, s3, 9
s_add_u32 s74, s74, s4
v_mfma_f32_16x16x32_bf16 v[48:51], a[64:67], a[144:147], v[48:51]
s_lshl_b32 s74, s74, 8
v_mfma_f32_16x16x32_bf16 v[48:51], a[68:71], a[148:151], v[48:51]
s_mov_b32 s75, 8
s_lshl_b32 s76, s75, 19
s_add_u32 s76, s76, s74
v_mfma_f32_16x16x32_bf16 v[56:59], a[68:71], a[156:159], v[56:59]
s_lshl_b32 s79, s75, 13
s_add_u32 s79, s79, s78
ds_read_b128 a[100:103], v10 offset:8192
v_mfma_f32_16x16x32_bf16 v[56:59], a[64:67], a[152:155], v[56:59]
s_add_u32 m0, s77, 0
s_add_u32 s64, s76, 0
v_mfma_f32_16x16x32_bf16 v[60:63], a[72:75], a[152:155], v[60:63]
buffer_load_dwordx4 v7, s[20:23], s64 offen lds
v_mfma_f32_16x16x32_bf16 v[60:63], a[76:79], a[156:159], v[60:63]
ds_read_b128 a[104:107], v9 offset:10240
v_mfma_f32_16x16x32_bf16 v[52:55], a[76:79], a[148:151], v[52:55]
buffer_load_dword a252, v21, s[32:35], s55 offen
v_mfma_f32_16x16x32_bf16 v[52:55], a[72:75], a[144:147], v[52:55]
ds_read_b64_tr_b16 a[160:161], v11 offset:16384
ds_read_b64_tr_b16 a[162:163], v11 offset:16896
v_mfma_f32_16x16x32_bf16 v[44:47], a[72:75], a[136:139], v[44:47]
buffer_load_dwordx4 v8, s[20:23], s64 offen offset:1024 lds
v_mfma_f32_16x16x32_bf16 v[44:47], a[76:79], a[140:143], v[44:47]
buffer_load_dword a253, v20, s[48:51], s54 offen
v_mfma_f32_16x16x32_bf16 v[36:39], a[76:79], a[132:135], v[36:39]
v_mfma_f32_16x16x32_bf16 v[36:39], a[72:75], a[128:131], v[36:39]
ds_read_b128 a[108:111], v10 offset:10240
v_mfma_f32_16x16x32_bf16 v[64:67], a[80:83], a[128:131], v[64:67]
v_mfma_f32_16x16x32_bf16 v[64:67], a[84:87], a[132:135], v[64:67]
v_mfma_f32_16x16x32_bf16 v[72:75], a[84:87], a[140:143], v[72:75]
s_add_u32 m0, s80, 0
s_add_u32 s64, s79, 0
v_mfma_f32_16x16x32_bf16 v[72:75], a[80:83], a[136:139], v[72:75]
ds_read_b64_tr_b16 a[164:165], v11 offset:24576
ds_read_b64_tr_b16 a[166:167], v11 offset:25088
v_mfma_f32_16x16x32_bf16 v[80:83], a[80:83], a[144:147], v[80:83]
buffer_load_dwordx4 v15, s[24:27], s64 offen sc1 lds
v_mfma_f32_16x16x32_bf16 v[80:83], a[84:87], a[148:151], v[80:83]
ds_read_b128 a[112:115], v9 offset:12288
v_mfma_f32_16x16x32_bf16 v[88:91], a[84:87], a[156:159], v[88:91]
v_mfma_f32_16x16x32_bf16 v[88:91], a[80:83], a[152:155], v[88:91]
v_mfma_f32_16x16x32_bf16 v[92:95], a[88:91], a[152:155], v[92:95]
ds_read_b64_tr_b16 a[168:169], v12 offset:16384
ds_read_b64_tr_b16 a[170:171], v12 offset:16896
v_mfma_f32_16x16x32_bf16 v[92:95], a[92:95], a[156:159], v[92:95]
v_mfma_f32_16x16x32_bf16 v[84:87], a[92:95], a[148:151], v[84:87]
s_add_u32 m0, s73, 69632
s_add_u32 s64, s72, 0
v_mfma_f32_16x16x32_bf16 v[84:87], a[88:91], a[144:147], v[84:87]
v_mfma_f32_16x16x32_bf16 v[76:79], a[88:91], a[136:139], v[76:79]
buffer_load_dwordx4 v5, s[12:15], s64 offen lds
v_mfma_f32_16x16x32_bf16 v[76:79], a[92:95], a[140:143], v[76:79]
ds_read_b128 a[116:119], v10 offset:12288
v_mfma_f32_16x16x32_bf16 v[68:71], a[92:95], a[132:135], v[68:71]
v_mfma_f32_16x16x32_bf16 v[68:71], a[88:91], a[128:131], v[68:71]
s_waitcnt lgkmcnt(6)
ds_read_b64_tr_b16 a[172:173], v12 offset:24576
ds_read_b64_tr_b16 a[174:175], v12 offset:25088
v_mfma_f32_16x16x32_bf16 v[96:99], a[96:99], a[128:131], v[96:99]
v_mfma_f32_16x16x32_bf16 v[96:99], a[100:103], a[132:135], v[96:99]
v_mfma_f32_16x16x32_bf16 v[104:107], a[100:103], a[140:143], v[104:107]
ds_read_b128 a[120:123], v9 offset:14336
v_mfma_f32_16x16x32_bf16 v[104:107], a[96:99], a[136:139], v[104:107]
v_mfma_f32_16x16x32_bf16 v[112:115], a[96:99], a[144:147], v[112:115]
v_mfma_f32_16x16x32_bf16 v[112:115], a[100:103], a[148:151], v[112:115]
buffer_load_dwordx4 v6, s[12:15], s64 offen offset:1024 lds
v_mfma_f32_16x16x32_bf16 v[120:123], a[100:103], a[156:159], v[120:123]
ds_read_b64_tr_b16 a[176:177], v13 offset:16384
ds_read_b64_tr_b16 a[178:179], v13 offset:16896
v_mfma_f32_16x16x32_bf16 v[120:123], a[96:99], a[152:155], v[120:123]
v_mfma_f32_16x16x32_bf16 v[124:127], a[104:107], a[152:155], v[124:127]
v_mfma_f32_16x16x32_bf16 v[124:127], a[108:111], a[156:159], v[124:127]
ds_read_b128 a[124:127], v10 offset:14336
v_mfma_f32_16x16x32_bf16 v[116:119], a[108:111], a[148:151], v[116:119]
v_add_u32 v9, 32768, v9
v_add_u32 v10, 32768, v10
v_mfma_f32_16x16x32_bf16 v[116:119], a[104:107], a[144:147], v[116:119]
s_add_u32 m0, s73, 71680
s_add_u32 s64, s72, 18432
v_mfma_f32_16x16x32_bf16 v[108:111], a[104:107], a[136:139], v[108:111]
ds_read_b64_tr_b16 a[180:181], v13 offset:24576
ds_read_b64_tr_b16 a[182:183], v13 offset:25088
v_mfma_f32_16x16x32_bf16 v[108:111], a[108:111], a[140:143], v[108:111]
buffer_load_dwordx4 v5, s[12:15], s64 offen lds
v_mfma_f32_16x16x32_bf16 v[100:103], a[108:111], a[132:135], v[100:103]
v_mfma_f32_16x16x32_bf16 v[100:103], a[104:107], a[128:131], v[100:103]
s_waitcnt lgkmcnt(2)
ds_read_b64_tr_b16 a[184:185], v14 offset:16384
ds_read_b64_tr_b16 a[186:187], v14 offset:16896
v_mfma_f32_16x16x32_bf16 v[128:131], a[112:115], a[128:131], v[128:131]
v_mfma_f32_16x16x32_bf16 v[128:131], a[116:119], a[132:135], v[128:131]
v_mfma_f32_16x16x32_bf16 v[136:139], a[116:119], a[140:143], v[136:139]
ds_read_b64_tr_b16 a[188:189], v14 offset:24576
ds_read_b64_tr_b16 a[190:191], v14 offset:25088
v_mfma_f32_16x16x32_bf16 v[136:139], a[112:115], a[136:139], v[136:139]
v_mfma_f32_16x16x32_bf16 v[144:147], a[112:115], a[144:147], v[144:147]
v_mfma_f32_16x16x32_bf16 v[144:147], a[116:119], a[148:151], v[144:147]
buffer_load_dwordx4 v6, s[12:15], s64 offen offset:1024 lds
v_mfma_f32_16x16x32_bf16 v[152:155], a[116:119], a[156:159], v[152:155]
v_mfma_f32_16x16x32_bf16 v[152:155], a[112:115], a[152:155], v[152:155]
v_mfma_f32_16x16x32_bf16 v[156:159], a[120:123], a[152:155], v[156:159]
v_mfma_f32_16x16x32_bf16 v[156:159], a[124:127], a[156:159], v[156:159]
v_mfma_f32_16x16x32_bf16 v[148:151], a[124:127], a[148:151], v[148:151]
v_mfma_f32_16x16x32_bf16 v[148:151], a[120:123], a[144:147], v[148:151]
v_mfma_f32_16x16x32_bf16 v[140:143], a[120:123], a[136:139], v[140:143]
v_mfma_f32_16x16x32_bf16 v[140:143], a[124:127], a[140:143], v[140:143]
v_mfma_f32_16x16x32_bf16 v[132:135], a[124:127], a[132:135], v[132:135]
v_mfma_f32_16x16x32_bf16 v[132:135], a[120:123], a[128:131], v[132:135]
s_waitcnt lgkmcnt(0)
v_mfma_f32_16x16x32_bf16 v[160:163], a[160:163], a[64:67], v[160:163]
s_waitcnt vmcnt(18)
v_mfma_f32_16x16x32_bf16 v[160:163], a[164:167], a[68:71], v[160:163]
s_barrier
v_mfma_f32_16x16x32_bf16 v[164:167], a[172:175], a[68:71], v[164:167]
ds_read_b64_tr_b16 a[128:129], v11 offset:32768
ds_read_b64_tr_b16 a[130:131], v11 offset:33280
v_mfma_f32_16x16x32_bf16 v[164:167], a[168:171], a[64:67], v[164:167]
s_add_u32 m0, s77, 16384
s_add_u32 s64, s76, 128
v_mfma_f32_16x16x32_bf16 v[168:171], a[176:179], a[64:67], v[168:171]
buffer_load_dwordx4 v7, s[20:23], s64 offen lds
v_mfma_f32_16x16x32_bf16 v[168:171], a[180:183], a[68:71], v[168:171]
v_mfma_f32_16x16x32_bf16 v[172:175], a[188:191], a[68:71], v[172:175]
v_mfma_f32_16x16x32_bf16 v[172:175], a[184:187], a[64:67], v[172:175]
ds_read_b128 a[64:67], v9 offset:0
v_mfma_f32_16x16x32_bf16 v[188:191], a[184:187], a[72:75], v[188:191]
ds_read_b64_tr_b16 a[132:133], v11 offset:40960
ds_read_b64_tr_b16 a[134:135], v11 offset:41472
v_mfma_f32_16x16x32_bf16 v[188:191], a[188:191], a[76:79], v[188:191]
v_mfma_f32_16x16x32_bf16 v[184:187], a[180:183], a[76:79], v[184:187]
v_mfma_f32_16x16x32_bf16 v[184:187], a[176:179], a[72:75], v[184:187]
ds_read_b128 a[68:71], v10 offset:0
v_mfma_f32_16x16x32_bf16 v[180:183], a[168:171], a[72:75], v[180:183]
buffer_load_dwordx4 v8, s[20:23], s64 offen offset:1024 lds
v_mfma_f32_16x16x32_bf16 v[180:183], a[172:175], a[76:79], v[180:183]
v_mfma_f32_16x16x32_bf16 v[176:179], a[164:167], a[76:79], v[176:179]
v_mfma_f32_16x16x32_bf16 v[176:179], a[160:163], a[72:75], v[176:179]
ds_read_b64_tr_b16 a[136:137], v12 offset:32768
ds_read_b64_tr_b16 a[138:139], v12 offset:33280
v_mfma_f32_16x16x32_bf16 v[192:195], a[160:163], a[80:83], v[192:195]
v_mfma_f32_16x16x32_bf16 v[192:195], a[164:167], a[84:87], v[192:195]
v_mfma_f32_16x16x32_bf16 v[196:199], a[172:175], a[84:87], v[196:199]
s_add_u32 m0, s80, 16384
s_add_u32 s64, s79, 2048
ds_read_b128 a[72:75], v9 offset:2048
v_mfma_f32_16x16x32_bf16 v[196:199], a[168:171], a[80:83], v[196:199]
v_mfma_f32_16x16x32_bf16 v[200:203], a[176:179], a[80:83], v[200:203]
buffer_load_dwordx4 v15, s[24:27], s64 offen sc1 lds
v_mfma_f32_16x16x32_bf16 v[200:203], a[180:183], a[84:87], v[200:203]
s_xor_b32 s65, s70, 0
s_add_u32 s71, s68, s65
s_add_u32 s72, s69, s65
v_mfma_f32_16x16x32_bf16 v[204:207], a[188:191], a[84:87], v[204:207]
ds_read_b64_tr_b16 a[140:141], v12 offset:40960
ds_read_b64_tr_b16 a[142:143], v12 offset:41472
v_mfma_f32_16x16x32_bf16 v[204:207], a[184:187], a[80:83], v[204:207]
v_mfma_f32_16x16x32_bf16 v[220:223], a[184:187], a[88:91], v[220:223]
ds_read_b128 a[76:79], v10 offset:2048
v_mfma_f32_16x16x32_bf16 v[220:223], a[188:191], a[92:95], v[220:223]
v_mfma_f32_16x16x32_bf16 v[216:219], a[180:183], a[92:95], v[216:219]
s_add_u32 m0, s73, 0
s_add_u32 s64, s71, 0
v_mfma_f32_16x16x32_bf16 v[216:219], a[176:179], a[88:91], v[216:219]
v_mfma_f32_16x16x32_bf16 v[212:215], a[168:171], a[88:91], v[212:215]
buffer_load_dwordx4 v5, s[12:15], s64 offen lds
v_mfma_f32_16x16x32_bf16 v[212:215], a[172:175], a[92:95], v[212:215]
ds_read_b64_tr_b16 a[144:145], v13 offset:32768
ds_read_b64_tr_b16 a[146:147], v13 offset:33280
v_mfma_f32_16x16x32_bf16 v[208:211], a[164:167], a[92:95], v[208:211]
v_mfma_f32_16x16x32_bf16 v[208:211], a[160:163], a[88:91], v[208:211]
ds_read_b128 a[80:83], v9 offset:4096
v_mfma_f32_16x16x32_bf16 v[224:227], a[160:163], a[96:99], v[224:227]
v_mfma_f32_16x16x32_bf16 v[224:227], a[164:167], a[100:103], v[224:227]
v_mfma_f32_16x16x32_bf16 v[228:231], a[172:175], a[100:103], v[228:231]
ds_read_b64_tr_b16 a[148:149], v13 offset:40960
ds_read_b64_tr_b16 a[150:151], v13 offset:41472
v_mfma_f32_16x16x32_bf16 v[228:231], a[168:171], a[96:99], v[228:231]
v_mfma_f32_16x16x32_bf16 v[232:235], a[176:179], a[96:99], v[232:235]
v_mfma_f32_16x16x32_bf16 v[232:235], a[180:183], a[100:103], v[232:235]
buffer_load_dwordx4 v6, s[12:15], s64 offen offset:1024 lds
v_mfma_f32_16x16x32_bf16 v[236:239], a[188:191], a[100:103], v[236:239]
ds_read_b128 a[84:87], v10 offset:4096
v_mfma_f32_16x16x32_bf16 v[236:239], a[184:187], a[96:99], v[236:239]
v_mfma_f32_16x16x32_bf16 v[252:255], a[184:187], a[104:107], v[252:255]
v_mfma_f32_16x16x32_bf16 v[252:255], a[188:191], a[108:111], v[252:255]
ds_read_b64_tr_b16 a[152:153], v14 offset:32768
ds_read_b64_tr_b16 a[154:155], v14 offset:33280
v_mfma_f32_16x16x32_bf16 v[248:251], a[180:183], a[108:111], v[248:251]
v_mfma_f32_16x16x32_bf16 v[248:251], a[176:179], a[104:107], v[248:251]
s_add_u32 m0, s73, 2048
s_add_u32 s64, s71, 18432
v_mfma_f32_16x16x32_bf16 v[244:247], a[168:171], a[104:107], v[244:247]
ds_read_b128 a[88:91], v9 offset:6144
v_mfma_f32_16x16x32_bf16 v[244:247], a[172:175], a[108:111], v[244:247]
buffer_load_dwordx4 v5, s[12:15], s64 offen lds
v_mfma_f32_16x16x32_bf16 v[240:243], a[164:167], a[108:111], v[240:243]
v_mfma_f32_16x16x32_bf16 v[240:243], a[160:163], a[104:107], v[240:243]
ds_read_b64_tr_b16 a[156:157], v14 offset:40960
ds_read_b64_tr_b16 a[158:159], v14 offset:41472
v_mfma_f32_16x16x32_bf16 a[0:3], a[160:163], a[112:115], a[0:3]
v_mfma_f32_16x16x32_bf16 a[0:3], a[164:167], a[116:119], a[0:3]
v_mfma_f32_16x16x32_bf16 a[4:7], a[172:175], a[116:119], a[4:7]
ds_read_b128 a[92:95], v10 offset:6144
v_mfma_f32_16x16x32_bf16 a[4:7], a[168:171], a[112:115], a[4:7]
v_mfma_f32_16x16x32_bf16 a[8:11], a[176:179], a[112:115], a[8:11]
v_mfma_f32_16x16x32_bf16 a[8:11], a[180:183], a[116:119], a[8:11]
buffer_load_dwordx4 v6, s[12:15], s64 offen offset:1024 lds
v_mfma_f32_16x16x32_bf16 a[12:15], a[188:191], a[116:119], a[12:15]
v_mfma_f32_16x16x32_bf16 a[12:15], a[184:187], a[112:115], a[12:15]
v_mfma_f32_16x16x32_bf16 a[28:31], a[184:187], a[120:123], a[28:31]
v_mfma_f32_16x16x32_bf16 a[28:31], a[188:191], a[124:127], a[28:31]
L_PAD3:
s_cbranch_execz L_PAD7
v_mfma_f32_16x16x32_bf16 a[24:27], a[180:183], a[124:127], a[24:27]
v_mfma_f32_16x16x32_bf16 a[24:27], a[176:179], a[120:123], a[24:27]
v_mfma_f32_16x16x32_bf16 a[20:23], a[168:171], a[120:123], a[20:23]
v_mfma_f32_16x16x32_bf16 a[20:23], a[172:175], a[124:127], a[20:23]
v_mfma_f32_16x16x32_bf16 a[16:19], a[164:167], a[124:127], a[16:19]
v_mfma_f32_16x16x32_bf16 a[16:19], a[160:163], a[120:123], a[16:19]
s_waitcnt lgkmcnt(0)
v_mfma_f32_16x16x32_bf16 v[32:35], a[64:67], a[128:131], v[32:35]
s_waitcnt vmcnt(20)
v_mfma_f32_16x16x32_bf16 v[32:35], a[68:71], a[132:135], v[32:35]
s_barrier
v_mfma_f32_16x16x32_bf16 v[40:43], a[68:71], a[140:143], v[40:43]
ds_read_b128 a[96:99], v9 offset:8192
v_mfma_f32_16x16x32_bf16 v[40:43], a[64:67], a[136:139], v[40:43]
s_xor_b32 s75, s93, 0
s_lshl_b32 s76, s75, 19
s_add_u32 s76, s76, s74
v_mfma_f32_16x16x32_bf16 v[48:51], a[64:67], a[144:147], v[48:51]
s_lshl_b32 s79, s75, 13
s_add_u32 s79, s79, s78
v_mfma_f32_16x16x32_bf16 v[48:51], a[68:71], a[148:151], v[48:51]
s_add_u32 m0, s77, 32768
s_add_u32 s64, s76, 0
ds_read_b128 a[100:103], v10 offset:8192
v_mfma_f32_16x16x32_bf16 v[56:59], a[68:71], a[156:159], v[56:59]
buffer_load_dwordx4 v7, s[20:23], s64 offen lds
v_mfma_f32_16x16x32_bf16 v[56:59], a[64:67], a[152:155], v[56:59]
v_mfma_f32_16x16x32_bf16 v[60:63], a[72:75], a[152:155], v[60:63]
ds_read_b128 a[104:107], v9 offset:10240
v_mfma_f32_16x16x32_bf16 v[60:63], a[76:79], a[156:159], v[60:63]
v_mfma_f32_16x16x32_bf16 v[52:55], a[76:79], a[148:151], v[52:55]
v_mfma_f32_16x16x32_bf16 v[52:55], a[72:75], a[144:147], v[52:55]
ds_read_b64_tr_b16 a[160:161], v11 offset:49152
ds_read_b64_tr_b16 a[162:163], v11 offset:49664
v_mfma_f32_16x16x32_bf16 v[44:47], a[72:75], a[136:139], v[44:47]
buffer_load_dwordx4 v8, s[20:23], s64 offen offset:1024 lds
v_mfma_f32_16x16x32_bf16 v[44:47], a[76:79], a[140:143], v[44:47]
v_mfma_f32_16x16x32_bf16 v[36:39], a[76:79], a[132:135], v[36:39]
v_mfma_f32_16x16x32_bf16 v[36:39], a[72:75], a[128:131], v[36:39]
ds_read_b128 a[108:111], v10 offset:10240
v_mfma_f32_16x16x32_bf16 v[64:67], a[80:83], a[128:131], v[64:67]
v_mfma_f32_16x16x32_bf16 v[64:67], a[84:87], a[132:135], v[64:67]
v_mfma_f32_16x16x32_bf16 v[72:75], a[84:87], a[140:143], v[72:75]
s_add_u32 m0, s80, 32768
s_add_u32 s64, s79, 0
v_mfma_f32_16x16x32_bf16 v[72:75], a[80:83], a[136:139], v[72:75]
ds_read_b64_tr_b16 a[164:165], v11 offset:57344
ds_read_b64_tr_b16 a[166:167], v11 offset:57856
v_mfma_f32_16x16x32_bf16 v[80:83], a[80:83], a[144:147], v[80:83]
buffer_load_dwordx4 v15, s[24:27], s64 offen sc1 lds
v_mfma_f32_16x16x32_bf16 v[80:83], a[84:87], a[148:151], v[80:83]
ds_read_b128 a[112:115], v9 offset:12288
v_mfma_f32_16x16x32_bf16 v[88:91], a[84:87], a[156:159], v[88:91]
v_cvt_pk_bf16_f32 v32, v32, v33
v_cvt_pk_bf16_f32 v33, v34, v35
v_mfma_f32_16x16x32_bf16 v[88:91], a[80:83], a[152:155], v[88:91]
v_cvt_pk_bf16_f32 v34, v36, v37
v_cvt_pk_bf16_f32 v35, v38, v39
v_mfma_f32_16x16x32_bf16 v[92:95], a[88:91], a[152:155], v[92:95]
ds_read_b64_tr_b16 a[168:169], v12 offset:49152
ds_read_b64_tr_b16 a[170:171], v12 offset:49664
v_mfma_f32_16x16x32_bf16 v[92:95], a[92:95], a[156:159], v[92:95]
v_cvt_pk_bf16_f32 v40, v40, v41
v_cvt_pk_bf16_f32 v41, v42, v43
v_mfma_f32_16x16x32_bf16 v[84:87], a[92:95], a[148:151], v[84:87]
s_add_u32 m0, s73, 4096
s_add_u32 s64, s72, 0
s_lshr_b32 s55, s3, 1
v_mfma_f32_16x16x32_bf16 v[84:87], a[88:91], a[144:147], v[84:87]
s_lshl_b32 s55, s55, 14
s_lshl_b32 s54, s3, 13
s_sub_u32 s55, s54, s55
v_mfma_f32_16x16x32_bf16 v[76:79], a[88:91], a[136:139], v[76:79]
buffer_load_dwordx4 v5, s[12:15], s64 offen lds
v_mfma_f32_16x16x32_bf16 v[76:79], a[92:95], a[140:143], v[76:79]
s_and_b32 s54, s3, 1
s_lshl_b32 s54, s54, 12
ds_read_b128 a[116:119], v10 offset:12288
v_mfma_f32_16x16x32_bf16 v[68:71], a[92:95], a[132:135], v[68:71]
s_add_u32 s53, s88, 0
v_cvt_pk_bf16_f32 v42, v44, v45
v_cvt_pk_bf16_f32 v43, v46, v47
v_mfma_f32_16x16x32_bf16 v[68:71], a[88:91], a[128:131], v[68:71]
s_waitcnt lgkmcnt(6)
ds_read_b64_tr_b16 a[172:173], v12 offset:57344
ds_read_b64_tr_b16 a[174:175], v12 offset:57856
v_mfma_f32_16x16x32_bf16 v[96:99], a[96:99], a[128:131], v[96:99]
buffer_store_dwordx4 v[32:35], v15, s[24:27], s53 offen offset:0 sc1
v_mfma_f32_16x16x32_bf16 v[96:99], a[100:103], a[132:135], v[96:99]
v_cvt_pk_bf16_f32 v48, v48, v49
v_cvt_pk_bf16_f32 v49, v50, v51
v_mfma_f32_16x16x32_bf16 v[104:107], a[100:103], a[140:143], v[104:107]
ds_read_b128 a[120:123], v9 offset:14336
v_cvt_pk_bf16_f32 v50, v52, v53
v_mfma_f32_16x16x32_bf16 v[104:107], a[96:99], a[136:139], v[104:107]
v_cvt_pk_bf16_f32 v51, v54, v55
v_cvt_pk_bf16_f32 v56, v56, v57
v_mfma_f32_16x16x32_bf16 v[112:115], a[96:99], a[144:147], v[112:115]
v_cvt_pk_bf16_f32 v57, v58, v59
v_cvt_pk_bf16_f32 v58, v60, v61
v_mfma_f32_16x16x32_bf16 v[112:115], a[100:103], a[148:151], v[112:115]
buffer_load_dwordx4 v6, s[12:15], s64 offen offset:1024 lds
v_mfma_f32_16x16x32_bf16 v[120:123], a[100:103], a[156:159], v[120:123]
ds_read_b64_tr_b16 a[176:177], v13 offset:49152
ds_read_b64_tr_b16 a[178:179], v13 offset:49664
v_mfma_f32_16x16x32_bf16 v[120:123], a[96:99], a[152:155], v[120:123]
v_cvt_pk_bf16_f32 v59, v62, v63
v_cvt_pk_bf16_f32 v64, v64, v65
v_mfma_f32_16x16x32_bf16 v[124:127], a[104:107], a[152:155], v[124:127]
v_cvt_pk_bf16_f32 v65, v66, v67
v_cvt_pk_bf16_f32 v66, v68, v69
v_mfma_f32_16x16x32_bf16 v[124:127], a[108:111], a[156:159], v[124:127]
ds_read_b128 a[124:127], v10 offset:14336
v_cvt_pk_bf16_f32 v67, v70, v71
v_mfma_f32_16x16x32_bf16 v[116:119], a[108:111], a[148:151], v[116:119]
v_add_u32 v9, 32768, v9
v_add_u32 v10, 32768, v10
v_mfma_f32_16x16x32_bf16 v[116:119], a[104:107], a[144:147], v[116:119]
s_add_u32 m0, s73, 6144
s_add_u32 s64, s72, 18432
v_cvt_pk_bf16_f32 v72, v72, v73
v_mfma_f32_16x16x32_bf16 v[108:111], a[104:107], a[136:139], v[108:111]
ds_read_b64_tr_b16 a[180:181], v13 offset:57344
ds_read_b64_tr_b16 a[182:183], v13 offset:57856
v_mfma_f32_16x16x32_bf16 v[108:111], a[108:111], a[140:143], v[108:111]
buffer_load_dwordx4 v5, s[12:15], s64 offen lds
v_mfma_f32_16x16x32_bf16 v[100:103], a[108:111], a[132:135], v[100:103]
v_cvt_pk_bf16_f32 v73, v74, v75
v_cvt_pk_bf16_f32 v74, v76, v77
v_mfma_f32_16x16x32_bf16 v[100:103], a[104:107], a[128:131], v[100:103]
s_waitcnt lgkmcnt(2)
ds_read_b64_tr_b16 a[184:185], v14 offset:49152
ds_read_b64_tr_b16 a[186:187], v14 offset:49664
v_mfma_f32_16x16x32_bf16 v[128:131], a[112:115], a[128:131], v[128:131]
v_cvt_pk_bf16_f32 v75, v78, v79
v_cvt_pk_bf16_f32 v80, v80, v81
v_mfma_f32_16x16x32_bf16 v[128:131], a[116:119], a[132:135], v[128:131]
v_cvt_pk_bf16_f32 v81, v82, v83
v_cvt_pk_bf16_f32 v82, v84, v85
v_mfma_f32_16x16x32_bf16 v[136:139], a[116:119], a[140:143], v[136:139]
ds_read_b64_tr_b16 a[188:189], v14 offset:57344
ds_read_b64_tr_b16 a[190:191], v14 offset:57856
v_mfma_f32_16x16x32_bf16 v[136:139], a[112:115], a[136:139], v[136:139]
v_add_u32 v9, s55, v9
v_add_u32 v10, s55, v10
v_mfma_f32_16x16x32_bf16 v[144:147], a[112:115], a[144:147], v[144:147]
v_subrev_u32 v11, s54, v11
v_subrev_u32 v12, s54, v12
v_mfma_f32_16x16x32_bf16 v[144:147], a[116:119], a[148:151], v[144:147]
buffer_load_dwordx4 v6, s[12:15], s64 offen offset:1024 lds
v_mfma_f32_16x16x32_bf16 v[152:155], a[116:119], a[156:159], v[152:155]
v_subrev_u32 v13, s54, v13
v_subrev_u32 v14, s54, v14
v_mfma_f32_16x16x32_bf16 v[152:155], a[112:115], a[152:155], v[152:155]
v_cvt_pk_bf16_f32 v83, v86, v87
v_cvt_pk_bf16_f32 v88, v88, v89
v_mfma_f32_16x16x32_bf16 v[156:159], a[120:123], a[152:155], v[156:159]
v_cvt_pk_bf16_f32 v89, v90, v91
v_cvt_pk_bf16_f32 v90, v92, v93
v_mfma_f32_16x16x32_bf16 v[156:159], a[124:127], a[156:159], v[156:159]
s_add_u32 s53, s88, 0
v_cvt_pk_bf16_f32 v91, v94, v95
v_cvt_pk_bf16_f32 v96, v96, v97
v_mfma_f32_16x16x32_bf16 v[148:151], a[124:127], a[148:151], v[148:151]
buffer_store_dwordx4 v[40:43], v15, s[24:27], s53 offen offset:1024 sc1
v_mfma_f32_16x16x32_bf16 v[148:151], a[120:123], a[144:147], v[148:151]
v_cvt_pk_bf16_f32 v97, v98, v99
v_cvt_pk_bf16_f32 v98, v100, v101
v_mfma_f32_16x16x32_bf16 v[140:143], a[120:123], a[136:139], v[140:143]
v_cvt_pk_bf16_f32 v99, v102, v103
v_cvt_pk_bf16_f32 v104, v104, v105
v_mfma_f32_16x16x32_bf16 v[140:143], a[124:127], a[140:143], v[140:143]
v_cvt_pk_bf16_f32 v105, v106, v107
v_cvt_pk_bf16_f32 v106, v108, v109
v_mfma_f32_16x16x32_bf16 v[132:135], a[124:127], a[132:135], v[132:135]
v_cvt_pk_bf16_f32 v107, v110, v111
v_cvt_pk_bf16_f32 v112, v112, v113
v_mfma_f32_16x16x32_bf16 v[132:135], a[120:123], a[128:131], v[132:135]
s_waitcnt lgkmcnt(0)
v_cvt_pk_bf16_f32 v113, v114, v115
v_cvt_pk_bf16_f32 v114, v116, v117
v_mfma_f32_16x16x32_bf16 v[160:163], a[160:163], a[64:67], v[160:163]
s_waitcnt vmcnt(16)
v_cvt_pk_bf16_f32 v115, v118, v119
v_cvt_pk_bf16_f32 v120, v120, v121
v_mfma_f32_16x16x32_bf16 v[160:163], a[164:167], a[68:71], v[160:163]
s_barrier
v_mfma_f32_16x16x32_bf16 v[164:167], a[172:175], a[68:71], v[164:167]
ds_read_b64_tr_b16 a[128:129], v11 offset:0
ds_read_b64_tr_b16 a[130:131], v11 offset:512
v_mfma_f32_16x16x32_bf16 v[164:167], a[168:171], a[64:67], v[164:167]
s_add_u32 m0, s77, 49152
s_add_u32 s64, s76, 128
v_cvt_pk_bf16_f32 v121, v122, v123
v_mfma_f32_16x16x32_bf16 v[168:171], a[176:179], a[64:67], v[168:171]
buffer_load_dwordx4 v7, s[20:23], s64 offen lds
v_mfma_f32_16x16x32_bf16 v[168:171], a[180:183], a[68:71], v[168:171]
ds_read_b64_tr_b16 a[132:133], v11 offset:4096
ds_read_b64_tr_b16 a[134:135], v11 offset:4608
v_mfma_f32_16x16x32_bf16 v[172:175], a[188:191], a[68:71], v[172:175]
v_cvt_pk_bf16_f32 v122, v124, v125
v_cvt_pk_bf16_f32 v123, v126, v127
v_mfma_f32_16x16x32_bf16 v[172:175], a[184:187], a[64:67], v[172:175]
v_cvt_pk_bf16_f32 v128, v128, v129
v_cvt_pk_bf16_f32 v129, v130, v131
v_mfma_f32_16x16x32_bf16 v[188:191], a[184:187], a[72:75], v[188:191]
ds_read_b64_tr_b16 a[136:137], v12 offset:0
ds_read_b64_tr_b16 a[138:139], v12 offset:512
v_mfma_f32_16x16x32_bf16 v[188:191], a[188:191], a[76:79], v[188:191]
v_cvt_pk_bf16_f32 v130, v132, v133
v_cvt_pk_bf16_f32 v131, v134, v135
v_mfma_f32_16x16x32_bf16 v[184:187], a[180:183], a[76:79], v[184:187]
v_cvt_pk_bf16_f32 v136, v136, v137
v_cvt_pk_bf16_f32 v137, v138, v139
v_mfma_f32_16x16x32_bf16 v[184:187], a[176:179], a[72:75], v[184:187]
ds_read_b64_tr_b16 a[140:141], v12 offset:4096
ds_read_b64_tr_b16 a[142:143], v12 offset:4608
v_mfma_f32_16x16x32_bf16 v[180:183], a[168:171], a[72:75], v[180:183]
buffer_load_dwordx4 v8, s[20:23], s64 offen offset:1024 lds
v_mfma_f32_16x16x32_bf16 v[180:183], a[172:175], a[76:79], v[180:183]
v_cvt_pk_bf16_f32 v138, v140, v141
v_cvt_pk_bf16_f32 v139, v142, v143
v_mfma_f32_16x16x32_bf16 v[176:179], a[164:167], a[76:79], v[176:179]
v_cvt_pk_bf16_f32 v144, v144, v145
v_cvt_pk_bf16_f32 v145, v146, v147
v_mfma_f32_16x16x32_bf16 v[176:179], a[160:163], a[72:75], v[176:179]
ds_read_b64_tr_b16 a[144:145], v13 offset:0
ds_read_b64_tr_b16 a[146:147], v13 offset:512
v_mfma_f32_16x16x32_bf16 v[192:195], a[160:163], a[80:83], v[192:195]
v_cvt_pk_bf16_f32 v146, v148, v149
v_cvt_pk_bf16_f32 v147, v150, v151
v_mfma_f32_16x16x32_bf16 v[192:195], a[164:167], a[84:87], v[192:195]
v_cvt_pk_bf16_f32 v152, v152, v153
v_cvt_pk_bf16_f32 v153, v154, v155
v_mfma_f32_16x16x32_bf16 v[196:199], a[172:175], a[84:87], v[196:199]
s_add_u32 m0, s80, 49152
s_add_u32 s64, s79, 2048
v_cvt_pk_bf16_f32 v154, v156, v157
v_mfma_f32_16x16x32_bf16 v[196:199], a[168:171], a[80:83], v[196:199]
ds_read_b64_tr_b16 a[148:149], v13 offset:4096
ds_read_b64_tr_b16 a[150:151], v13 offset:4608
v_mfma_f32_16x16x32_bf16 v[200:203], a[176:179], a[80:83], v[200:203]
buffer_load_dwordx4 v15, s[24:27], s64 offen sc1 lds
v_mfma_f32_16x16x32_bf16 v[200:203], a[180:183], a[84:87], v[200:203]
s_xor_b32 s65, s70, 128
s_add_u32 s71, s68, s65
s_add_u32 s72, s69, s65
v_mfma_f32_16x16x32_bf16 v[204:207], a[188:191], a[84:87], v[204:207]
s_add_u32 s53, s88, 0
ds_read_b64_tr_b16 a[152:153], v14 offset:0
ds_read_b64_tr_b16 a[154:155], v14 offset:512
v_mfma_f32_16x16x32_bf16 v[204:207], a[184:187], a[80:83], v[204:207]
buffer_store_dwordx4 v[48:51], v15, s[24:27], s53 offen offset:2048 sc1
v_mfma_f32_16x16x32_bf16 v[220:223], a[184:187], a[88:91], v[220:223]
ds_read_b64_tr_b16 a[156:157], v14 offset:4096
ds_read_b64_tr_b16 a[158:159], v14 offset:4608
v_mfma_f32_16x16x32_bf16 v[220:223], a[188:191], a[92:95], v[220:223]
v_cvt_pk_bf16_f32 v155, v158, v159
v_mul_f32 v160, s91, v160
v_mfma_f32_16x16x32_bf16 v[216:219], a[180:183], a[92:95], v[216:219]
s_add_u32 m0, s73, 32768
s_add_u32 s64, s71, 0
v_mul_f32 v161, s91, v161
v_mfma_f32_16x16x32_bf16 v[216:219], a[176:179], a[88:91], v[216:219]
v_mul_f32 v162, s91, v162
v_mul_f32 v163, s91, v163
v_mfma_f32_16x16x32_bf16 v[212:215], a[168:171], a[88:91], v[212:215]
buffer_load_dwordx4 v5, s[12:15], s64 offen lds
v_mfma_f32_16x16x32_bf16 v[212:215], a[172:175], a[92:95], v[212:215]
ds_read_b128 a[68:71], v4 offset:10240
v_mul_f32 v164, s91, v164
v_mfma_f32_16x16x32_bf16 v[208:211], a[164:167], a[92:95], v[208:211]
v_mul_f32 v165, s91, v165
v_mul_f32 v166, s91, v166
v_mfma_f32_16x16x32_bf16 v[208:211], a[160:163], a[88:91], v[208:211]
ds_read_b128 a[64:67], v4 offset:8192
v_mul_f32 v167, s91, v167
v_mfma_f32_16x16x32_bf16 v[224:227], a[160:163], a[96:99], v[224:227]
v_cvt_pk_bf16_f32 v160, v160, v161
v_cvt_pk_bf16_f32 v161, v162, v163
v_mfma_f32_16x16x32_bf16 v[224:227], a[164:167], a[100:103], v[224:227]
v_cvt_pk_bf16_f32 v162, v164, v165
v_cvt_pk_bf16_f32 v163, v166, v167
v_mfma_f32_16x16x32_bf16 v[228:231], a[172:175], a[100:103], v[228:231]
ds_read_b128 a[76:79], v4 offset:11264
v_mul_f32 v168, s91, v168
v_mfma_f32_16x16x32_bf16 v[228:231], a[168:171], a[96:99], v[228:231]
v_mul_f32 v169, s91, v169
v_mul_f32 v170, s91, v170
v_mfma_f32_16x16x32_bf16 v[232:235], a[176:179], a[96:99], v[232:235]
v_mul_f32 v171, s91, v171
v_mul_f32 v172, s91, v172
v_mfma_f32_16x16x32_bf16 v[232:235], a[180:183], a[100:103], v[232:235]
buffer_load_dwordx4 v6, s[12:15], s64 offen offset:1024 lds
v_mfma_f32_16x16x32_bf16 v[236:239], a[188:191], a[100:103], v[236:239]
ds_read_b128 a[72:75], v4 offset:9216
v_mul_f32 v173, s91, v173
v_mfma_f32_16x16x32_bf16 v[236:239], a[184:187], a[96:99], v[236:239]
v_mul_f32 v174, s91, v174
v_mul_f32 v175, s91, v175
v_mfma_f32_16x16x32_bf16 v[252:255], a[184:187], a[104:107], v[252:255]
v_cvt_pk_bf16_f32 v168, v168, v169
v_cvt_pk_bf16_f32 v169, v170, v171
v_mfma_f32_16x16x32_bf16 v[252:255], a[188:191], a[108:111], v[252:255]
ds_read_b128 a[84:87], v10 offset:0
v_cvt_pk_bf16_f32 v170, v172, v173
v_mfma_f32_16x16x32_bf16 v[248:251], a[180:183], a[108:111], v[248:251]
v_cvt_pk_bf16_f32 v171, v174, v175
v_mul_f32 v176, s91, v176
v_mfma_f32_16x16x32_bf16 v[248:251], a[176:179], a[104:107], v[248:251]
s_add_u32 m0, s73, 34816
s_add_u32 s64, s71, 18432
v_mul_f32 v177, s91, v177
v_mfma_f32_16x16x32_bf16 v[244:247], a[168:171], a[104:107], v[244:247]
ds_read_b128 a[80:83], v9 offset:0
v_mul_f32 v178, s91, v178
v_mfma_f32_16x16x32_bf16 v[244:247], a[172:175], a[108:111], v[244:247]
buffer_load_dwordx4 v5, s[12:15], s64 offen lds
v_mfma_f32_16x16x32_bf16 v[240:243], a[164:167], a[108:111], v[240:243]
v_mul_f32 v179, s91, v179
v_mul_f32 v180, s91, v180
v_mfma_f32_16x16x32_bf16 v[240:243], a[160:163], a[104:107], v[240:243]
s_add_u32 s53, s88, 0
ds_read_b128 a[92:95], v10 offset:2048
v_mul_f32 v181, s91, v181
v_mfma_f32_16x16x32_bf16 a[0:3], a[160:163], a[112:115], a[0:3]
buffer_store_dwordx4 v[56:59], v15, s[24:27], s53 offen offset:3072 sc1
v_mfma_f32_16x16x32_bf16 a[0:3], a[164:167], a[116:119], a[0:3]
v_mul_f32 v182, s91, v182
v_mul_f32 v183, s91, v183
v_mfma_f32_16x16x32_bf16 a[4:7], a[172:175], a[116:119], a[4:7]
ds_read_b128 a[88:91], v9 offset:2048
v_cvt_pk_bf16_f32 v176, v176, v177
v_mfma_f32_16x16x32_bf16 a[4:7], a[168:171], a[112:115], a[4:7]
v_cvt_pk_bf16_f32 v177, v178, v179
v_cvt_pk_bf16_f32 v178, v180, v181
v_mfma_f32_16x16x32_bf16 a[8:11], a[176:179], a[112:115], a[8:11]
v_cvt_pk_bf16_f32 v179, v182, v183
v_mul_f32 v184, s91, v184
v_mfma_f32_16x16x32_bf16 a[8:11], a[180:183], a[116:119], a[8:11]
buffer_load_dwordx4 v6, s[12:15], s64 offen offset:1024 lds
v_mfma_f32_16x16x32_bf16 a[12:15], a[188:191], a[116:119], a[12:15]
v_mul_f32 v185, s91, v185
v_mul_f32 v186, s91, v186
v_mfma_f32_16x16x32_bf16 a[12:15], a[184:187], a[112:115], a[12:15]
v_mul_f32 v187, s91, v187
v_mul_f32 v188, s91, v188
v_mfma_f32_16x16x32_bf16 a[28:31], a[184:187], a[120:123], a[28:31]
v_mul_f32 v189, s91, v189
v_mul_f32 v190, s91, v190
v_mfma_f32_16x16x32_bf16 a[28:31], a[188:191], a[124:127], a[28:31]
v_mul_f32 v191, s91, v191
v_cvt_pk_bf16_f32 v184, v184, v185
v_mfma_f32_16x16x32_bf16 a[24:27], a[180:183], a[124:127], a[24:27]
v_cvt_pk_bf16_f32 v185, v186, v187
v_cvt_pk_bf16_f32 v186, v188, v189
v_mfma_f32_16x16x32_bf16 a[24:27], a[176:179], a[120:123], a[24:27]
v_cvt_pk_bf16_f32 v187, v190, v191
v_mul_f32 v192, s91, v192
v_mfma_f32_16x16x32_bf16 a[20:23], a[168:171], a[120:123], a[20:23]
v_mul_f32 v193, s91, v193
v_mul_f32 v194, s91, v194
v_mfma_f32_16x16x32_bf16 a[20:23], a[172:175], a[124:127], a[20:23]
v_mul_f32 v195, s91, v195
v_mul_f32 v196, s91, v196
v_mfma_f32_16x16x32_bf16 a[16:19], a[164:167], a[124:127], a[16:19]
v_mul_f32 v197, s91, v197
v_mul_f32 v198, s91, v198
v_mfma_f32_16x16x32_bf16 a[16:19], a[160:163], a[120:123], a[16:19]
s_waitcnt lgkmcnt(0)
v_mul_f32 v199, s91, v199
v_cvt_pk_bf16_f32 v192, v192, v193
v_mfma_f32_16x16x32_bf16 v[36:39], a[128:131], a[80:83], 0
s_waitcnt vmcnt(22)
v_cvt_pk_bf16_f32 v193, v194, v195
v_cvt_pk_bf16_f32 v194, v196, v197
v_mfma_f32_16x16x32_bf16 v[36:39], a[132:135], a[84:87], v[36:39]
s_barrier
v_mfma_f32_16x16x32_bf16 v[44:47], a[140:143], a[84:87], 0
ds_read_b128 a[96:99], v9 offset:4096
v_cvt_pk_bf16_f32 v195, v198, v199
v_mfma_f32_16x16x32_bf16 v[44:47], a[136:139], a[80:83], v[44:47]
s_xor_b32 s75, s93, 1
s_lshl_b32 s76, s75, 19
s_add_u32 s76, s76, s74
v_mfma_f32_16x16x32_bf16 v[32:35], a[144:147], a[80:83], 0
s_lshl_b32 s79, s75, 13
s_add_u32 s79, s79, s78
ds_read_b128 a[100:103], v10 offset:4096
v_mfma_f32_16x16x32_bf16 v[32:35], a[148:151], a[84:87], v[32:35]
s_add_u32 m0, s77, 0
s_add_u32 s64, s76, 0
ds_read_b128 a[104:107], v9 offset:6144
v_mfma_f32_16x16x32_bf16 v[52:55], a[156:159], a[84:87], 0
buffer_load_dwordx4 v7, s[20:23], s64 offen lds
v_mfma_f32_16x16x32_bf16 v[52:55], a[152:155], a[80:83], v[52:55]
ds_read_b64_tr_b16 a[160:161], v11 offset:16384
ds_read_b64_tr_b16 a[162:163], v11 offset:16896
v_mfma_f32_16x16x32_bf16 v[60:63], a[64:67], a[80:83], 0
v_mul_f32 v200, s91, v200
v_mul_f32 v201, s91, v201
v_mfma_f32_16x16x32_bf16 v[60:63], a[68:71], a[84:87], v[60:63]
ds_read_b128 a[108:111], v10 offset:6144
v_mul_f32 v202, s91, v202
v_mfma_f32_16x16x32_bf16 v[68:71], a[76:79], a[84:87], 0
buffer_load_dwordx4 v8, s[20:23], s64 offen offset:1024 lds
v_mfma_f32_16x16x32_bf16 v[68:71], a[72:75], a[80:83], v[68:71]
s_add_u32 s53, s88, 262144
ds_read_b64_tr_b16 a[164:165], v11 offset:20480
ds_read_b64_tr_b16 a[166:167], v11 offset:20992
v_mfma_f32_16x16x32_bf16 v[76:79], a[72:75], a[88:91], 0
v_add_u32 v9, -65536, v9
v_add_u32 v10, -65536, v10
v_mfma_f32_16x16x32_bf16 v[76:79], a[76:79], a[92:95], v[76:79]
ds_read_b64_tr_b16 a[168:169], v12 offset:16384
ds_read_b64_tr_b16 a[170:171], v12 offset:16896
v_mfma_f32_16x16x32_bf16 v[84:87], a[68:71], a[92:95], 0
s_add_u32 m0, s80, 0
s_add_u32 s64, s79, 0
v_mul_f32 v203, s91, v203
v_mfma_f32_16x16x32_bf16 v[84:87], a[64:67], a[88:91], v[84:87]
ds_read_b64_tr_b16 a[172:173], v12 offset:20480
ds_read_b64_tr_b16 a[174:175], v12 offset:20992
v_mfma_f32_16x16x32_bf16 v[92:95], a[152:155], a[88:91], 0
buffer_load_dwordx4 v15, s[24:27], s64 offen sc1 lds
v_mfma_f32_16x16x32_bf16 v[92:95], a[156:159], a[92:95], v[92:95]
buffer_store_dwordx4 v[64:67], v15, s[24:27], s53 offen offset:0 sc1
v_mfma_f32_16x16x32_bf16 v[40:43], a[148:151], a[92:95], 0
ds_read_b64_tr_b16 a[176:177], v13 offset:16384
ds_read_b64_tr_b16 a[178:179], v13 offset:16896
v_mfma_f32_16x16x32_bf16 v[40:43], a[144:147], a[88:91], v[40:43]
v_mul_f32 v204, s91, v204
v_mul_f32 v205, s91, v205
v_mfma_f32_16x16x32_bf16 v[100:103], a[136:139], a[88:91], 0
s_add_u32 m0, s73, 36864
s_add_u32 s64, s72, 0
v_mul_f32 v206, s91, v206
v_mfma_f32_16x16x32_bf16 v[100:103], a[140:143], a[92:95], v[100:103]
ds_read_b64_tr_b16 a[180:181], v13 offset:20480
ds_read_b64_tr_b16 a[182:183], v13 offset:20992
v_mfma_f32_16x16x32_bf16 v[108:111], a[132:135], a[92:95], 0
buffer_load_dwordx4 v5, s[12:15], s64 offen lds
v_mfma_f32_16x16x32_bf16 v[108:111], a[128:131], a[88:91], v[108:111]
s_waitcnt lgkmcnt(14)
ds_read_b64_tr_b16 a[184:185], v14 offset:16384
ds_read_b64_tr_b16 a[186:187], v14 offset:16896
v_mfma_f32_16x16x32_bf16 v[116:119], a[128:131], a[96:99], 0
ds_read_b64_tr_b16 a[188:189], v14 offset:20480
ds_read_b64_tr_b16 a[190:191], v14 offset:20992
v_mfma_f32_16x16x32_bf16 v[116:119], a[132:135], a[100:103], v[116:119]
v_mul_f32 v207, s91, v207
v_cvt_pk_bf16_f32 v200, v200, v201
v_mfma_f32_16x16x32_bf16 v[124:127], a[140:143], a[100:103], 0
v_cvt_pk_bf16_f32 v201, v202, v203
v_cvt_pk_bf16_f32 v202, v204, v205
v_mfma_f32_16x16x32_bf16 v[124:127], a[136:139], a[96:99], v[124:127]
ds_read_b128 a[112:115], v4 offset:24576
v_cvt_pk_bf16_f32 v203, v206, v207
v_mfma_f32_16x16x32_bf16 v[132:135], a[144:147], a[96:99], 0
buffer_load_dwordx4 v6, s[12:15], s64 offen offset:1024 lds
v_mfma_f32_16x16x32_bf16 v[132:135], a[148:151], a[100:103], v[132:135]
ds_read_b128 a[116:119], v4 offset:26624
v_mul_f32 v208, s91, v208
v_mfma_f32_16x16x32_bf16 v[140:143], a[156:159], a[100:103], 0
v_mul_f32 v209, s91, v209
v_mul_f32 v210, s91, v210
v_mfma_f32_16x16x32_bf16 v[140:143], a[152:155], a[96:99], v[140:143]
ds_read_b128 a[120:123], v4 offset:25600
v_mul_f32 v211, s91, v211
v_mfma_f32_16x16x32_bf16 v[148:151], a[64:67], a[96:99], 0
s_add_u32 m0, s73, 38912
s_add_u32 s64, s72, 18432
v_mul_f32 v212, s91, v212
v_mfma_f32_16x16x32_bf16 v[148:151], a[68:71], a[100:103], v[148:151]
ds_read_b128 a[124:127], v4 offset:27648
v_mul_f32 v213, s91, v213
v_mfma_f32_16x16x32_bf16 v[48:51], a[76:79], a[100:103], 0
buffer_load_dwordx4 v5, s[12:15], s64 offen lds
v_mfma_f32_16x16x32_bf16 v[48:51], a[72:75], a[96:99], v[48:51]
s_waitcnt lgkmcnt(15)
v_mul_f32 v214, s91, v214
v_mul_f32 v215, s91, v215
v_mfma_f32_16x16x32_bf16 v[156:159], a[72:75], a[104:107], 0
v_cvt_pk_bf16_f32 v208, v208, v209
v_cvt_pk_bf16_f32 v209, v210, v211
v_mfma_f32_16x16x32_bf16 v[156:159], a[76:79], a[108:111], v[156:159]
s_add_u32 s53, s88, 262144
v_cvt_pk_bf16_f32 v210, v212, v213
v_cvt_pk_bf16_f32 v211, v214, v215
v_mfma_f32_16x16x32_bf16 v[164:167], a[68:71], a[108:111], 0
buffer_store_dwordx4 v[72:75], v15, s[24:27], s53 offen offset:1024 sc1
v_mfma_f32_16x16x32_bf16 v[164:167], a[64:67], a[104:107], v[164:167]
v_mul_f32 v216, s91, v216
v_mul_f32 v217, s91, v217
v_mfma_f32_16x16x32_bf16 v[172:175], a[152:155], a[104:107], 0
buffer_load_dwordx4 v6, s[12:15], s64 offen offset:1024 lds
v_mfma_f32_16x16x32_bf16 v[172:175], a[156:159], a[108:111], v[172:175]
v_mul_f32 v218, s91, v218
v_mul_f32 v219, s91, v219
v_mfma_f32_16x16x32_bf16 v[56:59], a[148:151], a[108:111], 0
v_mul_f32 v220, s91, v220
v_mul_f32 v221, s91, v221
v_mfma_f32_16x16x32_bf16 v[56:59], a[144:147], a[104:107], v[56:59]
v_mul_f32 v222, s91, v222
v_mul_f32 v223, s91, v223
v_mfma_f32_16x16x32_bf16 v[180:183], a[136:139], a[104:107], 0
v_cvt_pk_bf16_f32 v216, v216, v217
v_cvt_pk_bf16_f32 v217, v218, v219
v_mfma_f32_16x16x32_bf16 v[180:183], a[140:143], a[108:111], v[180:183]
v_cvt_pk_bf16_f32 v218, v220, v221
v_cvt_pk_bf16_f32 v219, v222, v223
v_mfma_f32_16x16x32_bf16 v[188:191], a[132:135], a[108:111], 0
v_mul_f32 v224, s91, v224
v_mul_f32 v225, s91, v225
v_mfma_f32_16x16x32_bf16 v[188:191], a[128:131], a[104:107], v[188:191]
s_waitcnt lgkmcnt(0)
v_mul_f32 v226, s91, v226
v_mul_f32 v227, s91, v227
v_mfma_f32_16x16x32_bf16 v[196:199], a[160:163], a[80:83], 0
s_waitcnt vmcnt(19)
v_mul_f32 v228, s91, v228
v_mul_f32 v229, s91, v229
v_mfma_f32_16x16x32_bf16 v[196:199], a[164:167], a[84:87], v[196:199]
s_barrier
v_mfma_f32_16x16x32_bf16 v[64:67], a[172:175], a[84:87], 0
ds_read_b64_tr_b16 a[128:129], v11 offset:32768
ds_read_b64_tr_b16 a[130:131], v11 offset:33280
v_mfma_f32_16x16x32_bf16 v[64:67], a[168:171], a[80:83], v[64:67]
s_add_u32 m0, s77, 16384
s_add_u32 s64, s76, 128
v_mul_f32 v230, s91, v230
v_mfma_f32_16x16x32_bf16 v[204:207], a[176:179], a[80:83], 0
buffer_load_dwordx4 v7, s[20:23], s64 offen lds
v_mfma_f32_16x16x32_bf16 v[204:207], a[180:183], a[84:87], v[204:207]
ds_read_b64_tr_b16 a[132:133], v11 offset:36864
ds_read_b64_tr_b16 a[134:135], v11 offset:37376
v_mfma_f32_16x16x32_bf16 v[212:215], a[188:191], a[84:87], 0
ds_read_b64_tr_b16 a[136:137], v12 offset:32768
ds_read_b64_tr_b16 a[138:139], v12 offset:33280
v_mfma_f32_16x16x32_bf16 v[212:215], a[184:187], a[80:83], v[212:215]
ds_read_b64_tr_b16 a[140:141], v12 offset:36864
ds_read_b64_tr_b16 a[142:143], v12 offset:37376
v_mfma_f32_16x16x32_bf16 v[72:75], a[112:115], a[80:83], 0
v_mul_f32 v231, s91, v231
v_cvt_pk_bf16_f32 v224, v224, v225
v_mfma_f32_16x16x32_bf16 v[72:75], a[116:119], a[84:87], v[72:75]
ds_read_b64_tr_b16 a[144:145], v13 offset:32768
ds_read_b64_tr_b16 a[146:147], v13 offset:33280
v_mfma_f32_16x16x32_bf16 v[220:223], a[124:127], a[84:87], 0
buffer_load_dwordx4 v8, s[20:23], s64 offen offset:1024 lds
v_mfma_f32_16x16x32_bf16 v[220:223], a[120:123], a[80:83], v[220:223]
ds_read_b64_tr_b16 a[148:149], v13 offset:36864
ds_read_b64_tr_b16 a[150:151], v13 offset:37376
v_mfma_f32_16x16x32_bf16 a[32:35], a[120:123], a[88:91], 0
v_cvt_pk_bf16_f32 v225, v226, v227
v_cvt_pk_bf16_f32 v226, v228, v229
v_mfma_f32_16x16x32_bf16 a[32:35], a[124:127], a[92:95], a[32:35]
ds_read_b64_tr_b16 a[152:153], v14 offset:32768
ds_read_b64_tr_b16 a[154:155], v14 offset:33280
v_mfma_f32_16x16x32_bf16 a[36:39], a[116:119], a[92:95], 0
s_add_u32 m0, s80, 16384
s_add_u32 s64, s79, 2048
v_cvt_pk_bf16_f32 v227, v230, v231
v_mfma_f32_16x16x32_bf16 a[36:39], a[112:115], a[88:91], a[36:39]
ds_read_b64_tr_b16 a[156:157], v14 offset:36864
ds_read_b64_tr_b16 a[158:159], v14 offset:37376
v_mfma_f32_16x16x32_bf16 v[228:231], a[184:187], a[88:91], 0
buffer_load_dwordx4 v15, s[24:27], s64 offen sc1 lds
v_mfma_f32_16x16x32_bf16 v[228:231], a[188:191], a[92:95], v[228:231]
s_xor_b32 s65, s70, 256
s_add_u32 s71, s68, s65
s_add_u32 s72, s69, s65
v_mfma_f32_16x16x32_bf16 a[40:43], a[180:183], a[92:95], 0
s_add_u32 s53, s88, 262144
ds_read_b128 a[64:67], v4 offset:40960
v_mul_f32 v232, s91, v232
v_mfma_f32_16x16x32_bf16 a[40:43], a[176:179], a[88:91], a[40:43]
buffer_store_dwordx4 v[80:83], v15, s[24:27], s53 offen offset:2048 sc1
v_mfma_f32_16x16x32_bf16 a[44:47], a[168:171], a[88:91], 0
s_add_u32 m0, s73, 65536
s_add_u32 s64, s71, 0
L_PAD4:
s_cbranch_execz L_PAD8
ds_read_b128 a[80:83], v9 offset:0
v_mfma_f32_16x16x32_bf16 a[44:47], a[172:175], a[92:95], a[44:47]
v_mul_f32 v233, s91, v233
v_mul_f32 v234, s91, v234
v_mfma_f32_16x16x32_bf16 v[80:83], a[164:167], a[92:95], 0
buffer_load_dwordx4 v5, s[12:15], s64 offen lds
v_mfma_f32_16x16x32_bf16 v[80:83], a[160:163], a[88:91], v[80:83]
ds_read_b128 a[68:71], v4 offset:43008
v_mul_f32 v235, s91, v235
v_mfma_f32_16x16x32_bf16 a[48:51], a[160:163], a[96:99], 0
ds_read_b128 a[84:87], v10 offset:0
v_mul_f32 v236, s91, v236
v_mfma_f32_16x16x32_bf16 a[48:51], a[164:167], a[100:103], a[48:51]
v_mul_f32 v237, s91, v237
v_mul_f32 v238, s91, v238
v_mfma_f32_16x16x32_bf16 a[52:55], a[172:175], a[100:103], 0
v_mul_f32 v239, s91, v239
v_cvt_pk_bf16_f32 v232, v232, v233
v_mfma_f32_16x16x32_bf16 a[52:55], a[168:171], a[96:99], a[52:55]
ds_read_b128 a[72:75], v4 offset:41984
v_cvt_pk_bf16_f32 v233, v234, v235
v_mfma_f32_16x16x32_bf16 a[56:59], a[176:179], a[96:99], 0
buffer_load_dwordx4 v6, s[12:15], s64 offen offset:1024 lds
v_mfma_f32_16x16x32_bf16 a[56:59], a[180:183], a[100:103], a[56:59]
ds_read_b128 a[88:91], v9 offset:2048
v_cvt_pk_bf16_f32 v234, v236, v237
v_mfma_f32_16x16x32_bf16 a[60:63], a[188:191], a[100:103], 0
v_cvt_pk_bf16_f32 v235, v238, v239
v_mul_f32 v240, s91, v240
v_mfma_f32_16x16x32_bf16 a[60:63], a[184:187], a[96:99], a[60:63]
ds_read_b128 a[76:79], v4 offset:44032
v_mul_f32 v241, s91, v241
v_mfma_f32_16x16x32_bf16 v[236:239], a[112:115], a[96:99], 0
s_add_u32 m0, s73, 67584
s_add_u32 s64, s71, 18432
v_mul_f32 v242, s91, v242
v_mfma_f32_16x16x32_bf16 v[236:239], a[116:119], a[100:103], v[236:239]
ds_read_b128 a[92:95], v10 offset:2048
v_mul_f32 v243, s91, v243
v_mfma_f32_16x16x32_bf16 a[192:195], a[124:127], a[100:103], 0
buffer_load_dwordx4 v5, s[12:15], s64 offen lds
v_mfma_f32_16x16x32_bf16 a[192:195], a[120:123], a[96:99], a[192:195]
v_mul_f32 v244, s91, v244
v_mul_f32 v245, s91, v245
v_mfma_f32_16x16x32_bf16 a[196:199], a[120:123], a[104:107], 0
v_mul_f32 v246, s91, v246
v_mul_f32 v247, s91, v247
v_mfma_f32_16x16x32_bf16 a[196:199], a[124:127], a[108:111], a[196:199]
v_cvt_pk_bf16_f32 v240, v240, v241
v_cvt_pk_bf16_f32 v241, v242, v243
v_mfma_f32_16x16x32_bf16 a[200:203], a[116:119], a[108:111], 0
v_cvt_pk_bf16_f32 v242, v244, v245
v_cvt_pk_bf16_f32 v243, v246, v247
v_mfma_f32_16x16x32_bf16 a[200:203], a[112:115], a[104:107], a[200:203]
v_mul_f32 v248, s91, v248
v_mul_f32 v249, s91, v249
v_mfma_f32_16x16x32_bf16 v[244:247], a[184:187], a[104:107], 0
buffer_load_dwordx4 v6, s[12:15], s64 offen offset:1024 lds
v_mfma_f32_16x16x32_bf16 v[244:247], a[188:191], a[108:111], v[244:247]
v_mul_f32 v250, s91, v250
v_mul_f32 v251, s91, v251
v_mfma_f32_16x16x32_bf16 a[204:207], a[180:183], a[108:111], 0
v_mul_f32 v252, s91, v252
v_mul_f32 v253, s91, v253
v_mfma_f32_16x16x32_bf16 a[204:207], a[176:179], a[104:107], a[204:207]
s_add_u32 s53, s88, 262144
v_mul_f32 v254, s91, v254
v_mul_f32 v255, s91, v255
v_mfma_f32_16x16x32_bf16 a[208:211], a[168:171], a[104:107], 0
buffer_store_dwordx4 v[88:91], v15, s[24:27], s53 offen offset:3072 sc1
v_mfma_f32_16x16x32_bf16 a[208:211], a[172:175], a[108:111], a[208:211]
v_cvt_pk_bf16_f32 v248, v248, v249
v_cvt_pk_bf16_f32 v249, v250, v251
v_mfma_f32_16x16x32_bf16 v[88:91], a[164:167], a[108:111], 0
v_cvt_pk_bf16_f32 v250, v252, v253
v_cvt_pk_bf16_f32 v251, v254, v255
v_mfma_f32_16x16x32_bf16 v[88:91], a[160:163], a[104:107], v[88:91]
s_waitcnt lgkmcnt(0)
v_accvgpr_read_b32 v16, a0
v_accvgpr_read_b32 v17, a1
v_mfma_f32_16x16x32_bf16 v[36:39], a[128:131], a[80:83], v[36:39]
s_waitcnt vmcnt(24)
v_accvgpr_read_b32 v18, a2
v_accvgpr_read_b32 v19, a3
v_mfma_f32_16x16x32_bf16 v[36:39], a[132:135], a[84:87], v[36:39]
s_barrier
v_mfma_f32_16x16x32_bf16 v[44:47], a[140:143], a[84:87], v[44:47]
ds_read_b128 a[96:99], v9 offset:4096
v_accvgpr_read_b32 v20, a4
v_mfma_f32_16x16x32_bf16 v[44:47], a[136:139], a[80:83], v[44:47]
s_xor_b32 s75, s93, 2
s_lshl_b32 s76, s75, 19
s_add_u32 s76, s76, s74
v_mfma_f32_16x16x32_bf16 v[32:35], a[144:147], a[80:83], v[32:35]
s_lshl_b32 s79, s75, 13
s_add_u32 s79, s79, s78
ds_read_b128 a[100:103], v10 offset:4096
v_mfma_f32_16x16x32_bf16 v[32:35], a[148:151], a[84:87], v[32:35]
s_add_u32 m0, s77, 32768
s_add_u32 s64, s76, 0
ds_read_b128 a[104:107], v9 offset:6144
v_mfma_f32_16x16x32_bf16 v[52:55], a[156:159], a[84:87], v[52:55]
buffer_load_dwordx4 v7, s[20:23], s64 offen lds
v_mfma_f32_16x16x32_bf16 v[52:55], a[152:155], a[80:83], v[52:55]
ds_read_b64_tr_b16 a[160:161], v11 offset:49152
ds_read_b64_tr_b16 a[162:163], v11 offset:49664
v_mfma_f32_16x16x32_bf16 v[60:63], a[64:67], a[80:83], v[60:63]
v_accvgpr_read_b32 v21, a5
v_accvgpr_read_b32 v22, a6
v_mfma_f32_16x16x32_bf16 v[60:63], a[68:71], a[84:87], v[60:63]
ds_read_b128 a[108:111], v10 offset:6144
v_accvgpr_read_b32 v23, a7
v_mfma_f32_16x16x32_bf16 v[68:71], a[76:79], a[84:87], v[68:71]
buffer_load_dwordx4 v8, s[20:23], s64 offen offset:1024 lds
v_mfma_f32_16x16x32_bf16 v[68:71], a[72:75], a[80:83], v[68:71]
ds_read_b64_tr_b16 a[164:165], v11 offset:53248
ds_read_b64_tr_b16 a[166:167], v11 offset:53760
v_mfma_f32_16x16x32_bf16 v[76:79], a[72:75], a[88:91], v[76:79]
v_add_u32 v9, 32768, v9
v_add_u32 v10, 32768, v10
v_mfma_f32_16x16x32_bf16 v[76:79], a[76:79], a[92:95], v[76:79]
ds_read_b64_tr_b16 a[168:169], v12 offset:49152
ds_read_b64_tr_b16 a[170:171], v12 offset:49664
v_mfma_f32_16x16x32_bf16 v[84:87], a[68:71], a[92:95], v[84:87]
s_add_u32 m0, s80, 32768
s_add_u32 s64, s79, 0
v_mul_f32 v16, s91, v16
v_mfma_f32_16x16x32_bf16 v[84:87], a[64:67], a[88:91], v[84:87]
ds_read_b64_tr_b16 a[172:173], v12 offset:53248
ds_read_b64_tr_b16 a[174:175], v12 offset:53760
v_mfma_f32_16x16x32_bf16 v[92:95], a[152:155], a[88:91], v[92:95]
buffer_load_dwordx4 v15, s[24:27], s64 offen sc1 lds
v_mfma_f32_16x16x32_bf16 v[92:95], a[156:159], a[92:95], v[92:95]
v_mul_f32 v17, s91, v17
v_mul_f32 v18, s91, v18
v_mfma_f32_16x16x32_bf16 v[40:43], a[148:151], a[92:95], v[40:43]
ds_read_b64_tr_b16 a[176:177], v13 offset:49152
ds_read_b64_tr_b16 a[178:179], v13 offset:49664
v_mfma_f32_16x16x32_bf16 v[40:43], a[144:147], a[88:91], v[40:43]
v_mul_f32 v19, s91, v19
v_mul_f32 v20, s91, v20
v_mfma_f32_16x16x32_bf16 v[100:103], a[136:139], a[88:91], v[100:103]
s_add_u32 m0, s73, 69632
s_add_u32 s64, s72, 0
v_mul_f32 v21, s91, v21
v_mfma_f32_16x16x32_bf16 v[100:103], a[140:143], a[92:95], v[100:103]
ds_read_b64_tr_b16 a[180:181], v13 offset:53248
ds_read_b64_tr_b16 a[182:183], v13 offset:53760
v_mfma_f32_16x16x32_bf16 v[108:111], a[132:135], a[92:95], v[108:111]
buffer_load_dwordx4 v5, s[12:15], s64 offen lds
v_mfma_f32_16x16x32_bf16 v[108:111], a[128:131], a[88:91], v[108:111]
s_waitcnt lgkmcnt(14)
ds_read_b64_tr_b16 a[184:185], v14 offset:49152
ds_read_b64_tr_b16 a[186:187], v14 offset:49664
v_mfma_f32_16x16x32_bf16 v[116:119], a[128:131], a[96:99], v[116:119]
s_add_u32 s53, s87, 0
ds_read_b64_tr_b16 a[188:189], v14 offset:53248
ds_read_b64_tr_b16 a[190:191], v14 offset:53760
v_mfma_f32_16x16x32_bf16 v[116:119], a[132:135], a[100:103], v[116:119]
buffer_store_dwordx4 v[160:163], v15, s[24:27], s53 offen offset:0 sc1
v_mfma_f32_16x16x32_bf16 v[124:127], a[140:143], a[100:103], v[124:127]
v_mul_f32 v22, s91, v22
v_mul_f32 v23, s91, v23
v_mfma_f32_16x16x32_bf16 v[124:127], a[136:139], a[96:99], v[124:127]
ds_read_b128 a[112:115], v4 offset:57344
v_cvt_pk_bf16_f32 v16, v16, v17
v_mfma_f32_16x16x32_bf16 v[132:135], a[144:147], a[96:99], v[132:135]
buffer_load_dwordx4 v6, s[12:15], s64 offen offset:1024 lds
v_mfma_f32_16x16x32_bf16 v[132:135], a[148:151], a[100:103], v[132:135]
ds_read_b128 a[116:119], v4 offset:59392
v_cvt_pk_bf16_f32 v17, v18, v19
v_mfma_f32_16x16x32_bf16 v[140:143], a[156:159], a[100:103], v[140:143]
v_cvt_pk_bf16_f32 v18, v20, v21
v_cvt_pk_bf16_f32 v19, v22, v23
v_mfma_f32_16x16x32_bf16 v[140:143], a[152:155], a[96:99], v[140:143]
ds_read_b128 a[120:123], v4 offset:58368
v_accvgpr_write_b32 a0, v16
v_mfma_f32_16x16x32_bf16 v[148:151], a[64:67], a[96:99], v[148:151]
s_add_u32 m0, s73, 71680
s_add_u32 s64, s72, 18432
v_accvgpr_write_b32 a1, v17
v_mfma_f32_16x16x32_bf16 v[148:151], a[68:71], a[100:103], v[148:151]
ds_read_b128 a[124:127], v4 offset:60416
v_accvgpr_write_b32 a2, v18
v_mfma_f32_16x16x32_bf16 v[48:51], a[76:79], a[100:103], v[48:51]
buffer_load_dwordx4 v5, s[12:15], s64 offen lds
v_mfma_f32_16x16x32_bf16 v[48:51], a[72:75], a[96:99], v[48:51]
s_waitcnt lgkmcnt(15)
v_accvgpr_write_b32 a3, v19
v_accvgpr_read_b32 v16, a8
v_mfma_f32_16x16x32_bf16 v[156:159], a[72:75], a[104:107], v[156:159]
v_accvgpr_read_b32 v17, a9
v_accvgpr_read_b32 v18, a10
v_mfma_f32_16x16x32_bf16 v[156:159], a[76:79], a[108:111], v[156:159]
v_accvgpr_read_b32 v19, a11
v_accvgpr_read_b32 v20, a12
v_mfma_f32_16x16x32_bf16 v[164:167], a[68:71], a[108:111], v[164:167]
v_accvgpr_read_b32 v21, a13
v_accvgpr_read_b32 v22, a14
v_mfma_f32_16x16x32_bf16 v[164:167], a[64:67], a[104:107], v[164:167]
v_accvgpr_read_b32 v23, a15
v_mul_f32 v16, s91, v16
v_mfma_f32_16x16x32_bf16 v[172:175], a[152:155], a[104:107], v[172:175]
buffer_load_dwordx4 v6, s[12:15], s64 offen offset:1024 lds
v_mfma_f32_16x16x32_bf16 v[172:175], a[156:159], a[108:111], v[172:175]
v_mul_f32 v17, s91, v17
v_mul_f32 v18, s91, v18
v_mfma_f32_16x16x32_bf16 v[56:59], a[148:151], a[108:111], v[56:59]
v_mul_f32 v19, s91, v19
v_mul_f32 v20, s91, v20
v_mfma_f32_16x16x32_bf16 v[56:59], a[144:147], a[104:107], v[56:59]
v_mul_f32 v21, s91, v21
v_mul_f32 v22, s91, v22
v_mfma_f32_16x16x32_bf16 v[180:183], a[136:139], a[104:107], v[180:183]
v_mul_f32 v23, s91, v23
v_cvt_pk_bf16_f32 v16, v16, v17
v_mfma_f32_16x16x32_bf16 v[180:183], a[140:143], a[108:111], v[180:183]
v_cvt_pk_bf16_f32 v17, v18, v19
v_cvt_pk_bf16_f32 v18, v20, v21
v_mfma_f32_16x16x32_bf16 v[188:191], a[132:135], a[108:111], v[188:191]
v_cvt_pk_bf16_f32 v19, v22, v23
v_accvgpr_write_b32 a8, v16
v_mfma_f32_16x16x32_bf16 v[188:191], a[128:131], a[104:107], v[188:191]
s_waitcnt lgkmcnt(0)
v_accvgpr_write_b32 a9, v17
v_accvgpr_write_b32 a10, v18
v_mfma_f32_16x16x32_bf16 v[196:199], a[160:163], a[80:83], v[196:199]
s_waitcnt vmcnt(17)
v_accvgpr_write_b32 a11, v19
v_accvgpr_read_b32 v16, a16
v_mfma_f32_16x16x32_bf16 v[196:199], a[164:167], a[84:87], v[196:199]
s_barrier
v_mfma_f32_16x16x32_bf16 v[64:67], a[172:175], a[84:87], v[64:67]
s_add_u32 s53, s87, 0
ds_read_b64_tr_b16 a[128:129], v11 offset:0
ds_read_b64_tr_b16 a[130:131], v11 offset:512
v_mfma_f32_16x16x32_bf16 v[64:67], a[168:171], a[80:83], v[64:67]
s_add_u32 m0, s77, 49152
s_add_u32 s64, s76, 128
v_accvgpr_read_b32 v17, a17
v_mfma_f32_16x16x32_bf16 v[204:207], a[176:179], a[80:83], v[204:207]
buffer_load_dwordx4 v7, s[20:23], s64 offen lds
v_mfma_f32_16x16x32_bf16 v[204:207], a[180:183], a[84:87], v[204:207]
ds_read_b64_tr_b16 a[132:133], v11 offset:4096
ds_read_b64_tr_b16 a[134:135], v11 offset:4608
v_mfma_f32_16x16x32_bf16 v[212:215], a[188:191], a[84:87], v[212:215]
ds_read_b64_tr_b16 a[136:137], v12 offset:0
ds_read_b64_tr_b16 a[138:139], v12 offset:512
v_mfma_f32_16x16x32_bf16 v[212:215], a[184:187], a[80:83], v[212:215]
ds_read_b64_tr_b16 a[140:141], v12 offset:4096
ds_read_b64_tr_b16 a[142:143], v12 offset:4608
v_mfma_f32_16x16x32_bf16 v[72:75], a[112:115], a[80:83], v[72:75]
buffer_store_dwordx4 v[168:171], v15, s[24:27], s53 offen offset:1024 sc1
v_mfma_f32_16x16x32_bf16 v[72:75], a[116:119], a[84:87], v[72:75]
ds_read_b64_tr_b16 a[144:145], v13 offset:0
ds_read_b64_tr_b16 a[146:147], v13 offset:512
v_mfma_f32_16x16x32_bf16 v[220:223], a[124:127], a[84:87], v[220:223]
buffer_load_dwordx4 v8, s[20:23], s64 offen offset:1024 lds
v_mfma_f32_16x16x32_bf16 v[220:223], a[120:123], a[80:83], v[220:223]
ds_read_b64_tr_b16 a[148:149], v13 offset:4096
ds_read_b64_tr_b16 a[150:151], v13 offset:4608
v_mfma_f32_16x16x32_bf16 a[32:35], a[120:123], a[88:91], a[32:35]
v_accvgpr_read_b32 v18, a18
v_accvgpr_read_b32 v19, a19
v_mfma_f32_16x16x32_bf16 a[32:35], a[124:127], a[92:95], a[32:35]
ds_read_b64_tr_b16 a[152:153], v14 offset:0
ds_read_b64_tr_b16 a[154:155], v14 offset:512
v_mfma_f32_16x16x32_bf16 a[36:39], a[116:119], a[92:95], a[36:39]
s_add_u32 m0, s80, 49152
s_add_u32 s64, s79, 2048
v_accvgpr_read_b32 v20, a20
v_mfma_f32_16x16x32_bf16 a[36:39], a[112:115], a[88:91], a[36:39]
ds_read_b64_tr_b16 a[156:157], v14 offset:4096
ds_read_b64_tr_b16 a[158:159], v14 offset:4608
v_mfma_f32_16x16x32_bf16 v[228:231], a[184:187], a[88:91], v[228:231]
buffer_load_dwordx4 v15, s[24:27], s64 offen sc1 lds
v_mfma_f32_16x16x32_bf16 v[228:231], a[188:191], a[92:95], v[228:231]
s_xor_b32 s65, s70, 384
s_add_u32 s71, s68, s65
s_add_u32 s72, s69, s65
v_mfma_f32_16x16x32_bf16 a[40:43], a[180:183], a[92:95], a[40:43]
ds_read_b128 a[64:67], v4 offset:8192
v_accvgpr_read_b32 v21, a21
v_mfma_f32_16x16x32_bf16 a[40:43], a[176:179], a[88:91], a[40:43]
v_accvgpr_read_b32 v22, a22
v_accvgpr_read_b32 v23, a23
v_mfma_f32_16x16x32_bf16 a[44:47], a[168:171], a[88:91], a[44:47]
s_add_u32 m0, s73, 0
s_add_u32 s64, s71, 0
ds_read_b128 a[80:83], v9 offset:0
v_mfma_f32_16x16x32_bf16 a[44:47], a[172:175], a[92:95], a[44:47]
v_mul_f32 v16, s91, v16
v_mul_f32 v17, s91, v17
v_mfma_f32_16x16x32_bf16 v[80:83], a[164:167], a[92:95], v[80:83]
buffer_load_dwordx4 v5, s[12:15], s64 offen lds
v_mfma_f32_16x16x32_bf16 v[80:83], a[160:163], a[88:91], v[80:83]
ds_read_b128 a[68:71], v4 offset:10240
v_mul_f32 v18, s91, v18
v_mfma_f32_16x16x32_bf16 a[48:51], a[160:163], a[96:99], a[48:51]
ds_read_b128 a[84:87], v10 offset:0
v_mul_f32 v19, s91, v19
v_mfma_f32_16x16x32_bf16 a[48:51], a[164:167], a[100:103], a[48:51]
v_mul_f32 v20, s91, v20
v_mul_f32 v21, s91, v21
v_mfma_f32_16x16x32_bf16 a[52:55], a[172:175], a[100:103], a[52:55]
v_mul_f32 v22, s91, v22
v_mul_f32 v23, s91, v23
v_mfma_f32_16x16x32_bf16 a[52:55], a[168:171], a[96:99], a[52:55]
ds_read_b128 a[72:75], v4 offset:9216
v_cvt_pk_bf16_f32 v16, v16, v17
v_mfma_f32_16x16x32_bf16 a[56:59], a[176:179], a[96:99], a[56:59]
buffer_load_dwordx4 v6, s[12:15], s64 offen offset:1024 lds
v_mfma_f32_16x16x32_bf16 a[56:59], a[180:183], a[100:103], a[56:59]
s_add_u32 s53, s87, 4096
ds_read_b128 a[88:91], v9 offset:2048
v_cvt_pk_bf16_f32 v17, v18, v19
v_mfma_f32_16x16x32_bf16 a[60:63], a[188:191], a[100:103], a[60:63]
buffer_store_dwordx4 v[176:179], v15, s[24:27], s53 offen offset:0 sc1
v_mfma_f32_16x16x32_bf16 a[60:63], a[184:187], a[96:99], a[60:63]
ds_read_b128 a[76:79], v4 offset:11264
v_cvt_pk_bf16_f32 v18, v20, v21
v_mfma_f32_16x16x32_bf16 v[236:239], a[112:115], a[96:99], v[236:239]
s_add_u32 m0, s73, 2048
s_add_u32 s64, s71, 18432
v_cvt_pk_bf16_f32 v19, v22, v23
v_mfma_f32_16x16x32_bf16 v[236:239], a[116:119], a[100:103], v[236:239]
ds_read_b128 a[92:95], v10 offset:2048
v_accvgpr_write_b32 a16, v16
v_mfma_f32_16x16x32_bf16 a[192:195], a[124:127], a[100:103], a[192:195]
buffer_load_dwordx4 v5, s[12:15], s64 offen lds
v_mfma_f32_16x16x32_bf16 a[192:195], a[120:123], a[96:99], a[192:195]
v_accvgpr_write_b32 a17, v17
v_accvgpr_write_b32 a18, v18
v_mfma_f32_16x16x32_bf16 a[196:199], a[120:123], a[104:107], a[196:199]
v_accvgpr_write_b32 a19, v19
v_accvgpr_read_b32 v16, a24
v_mfma_f32_16x16x32_bf16 a[196:199], a[124:127], a[108:111], a[196:199]
v_accvgpr_read_b32 v17, a25
v_accvgpr_read_b32 v18, a26
v_mfma_f32_16x16x32_bf16 a[200:203], a[116:119], a[108:111], a[200:203]
v_accvgpr_read_b32 v19, a27
v_accvgpr_read_b32 v20, a28
v_mfma_f32_16x16x32_bf16 a[200:203], a[112:115], a[104:107], a[200:203]
v_accvgpr_read_b32 v21, a29
v_accvgpr_read_b32 v22, a30
v_mfma_f32_16x16x32_bf16 v[244:247], a[184:187], a[104:107], v[244:247]
buffer_load_dwordx4 v6, s[12:15], s64 offen offset:1024 lds
v_mfma_f32_16x16x32_bf16 v[244:247], a[188:191], a[108:111], v[244:247]
v_accvgpr_read_b32 v23, a31
v_mul_f32 v16, s91, v16
v_mfma_f32_16x16x32_bf16 a[204:207], a[180:183], a[108:111], a[204:207]
v_mul_f32 v17, s91, v17
v_mul_f32 v18, s91, v18
v_mfma_f32_16x16x32_bf16 a[204:207], a[176:179], a[104:107], a[204:207]
v_mul_f32 v19, s91, v19
v_mul_f32 v20, s91, v20
v_mfma_f32_16x16x32_bf16 a[208:211], a[168:171], a[104:107], a[208:211]
v_mul_f32 v21, s91, v21
v_mul_f32 v22, s91, v22
v_mfma_f32_16x16x32_bf16 a[208:211], a[172:175], a[108:111], a[208:211]
v_mul_f32 v23, s91, v23
v_cvt_pk_bf16_f32 v16, v16, v17
v_mfma_f32_16x16x32_bf16 v[88:91], a[164:167], a[108:111], v[88:91]
v_cvt_pk_bf16_f32 v17, v18, v19
v_cvt_pk_bf16_f32 v18, v20, v21
v_mfma_f32_16x16x32_bf16 v[88:91], a[160:163], a[104:107], v[88:91]
s_waitcnt lgkmcnt(0)
v_cvt_pk_bf16_f32 v19, v22, v23
v_accvgpr_write_b32 a24, v16
v_mfma_f32_16x16x32_bf16 v[36:39], a[128:131], a[80:83], v[36:39]
s_waitcnt vmcnt(23)
v_accvgpr_write_b32 a25, v17
v_accvgpr_write_b32 a26, v18
v_mfma_f32_16x16x32_bf16 v[36:39], a[132:135], a[84:87], v[36:39]
s_barrier
v_mfma_f32_16x16x32_bf16 v[44:47], a[140:143], a[84:87], v[44:47]
ds_read_b128 a[96:99], v9 offset:4096
v_accvgpr_write_b32 a27, v19
v_mfma_f32_16x16x32_bf16 v[44:47], a[136:139], a[80:83], v[44:47]
s_xor_b32 s75, s93, 3
s_lshl_b32 s76, s75, 19
s_add_u32 s76, s76, s74
v_mfma_f32_16x16x32_bf16 v[32:35], a[144:147], a[80:83], v[32:35]
s_lshl_b32 s79, s75, 13
s_add_u32 s79, s79, s78
ds_read_b128 a[100:103], v10 offset:4096
v_mfma_f32_16x16x32_bf16 v[32:35], a[148:151], a[84:87], v[32:35]
s_add_u32 m0, s77, 0
s_add_u32 s64, s76, 0
ds_read_b128 a[104:107], v9 offset:6144
v_mfma_f32_16x16x32_bf16 v[52:55], a[156:159], a[84:87], v[52:55]
buffer_load_dwordx4 v7, s[20:23], s64 offen lds
v_mfma_f32_16x16x32_bf16 v[52:55], a[152:155], a[80:83], v[52:55]
s_add_u32 s53, s87, 4096
ds_read_b64_tr_b16 a[160:161], v11 offset:16384
ds_read_b64_tr_b16 a[162:163], v11 offset:16896
v_mfma_f32_16x16x32_bf16 v[60:63], a[64:67], a[80:83], v[60:63]
buffer_store_dwordx4 v[184:187], v15, s[24:27], s53 offen offset:1024 sc1
v_mfma_f32_16x16x32_bf16 v[60:63], a[68:71], a[84:87], v[60:63]
ds_read_b128 a[108:111], v10 offset:6144
v_accvgpr_write_b32 a4, v248
v_mfma_f32_16x16x32_bf16 v[68:71], a[76:79], a[84:87], v[68:71]
buffer_load_dwordx4 v8, s[20:23], s64 offen offset:1024 lds
v_mfma_f32_16x16x32_bf16 v[68:71], a[72:75], a[80:83], v[68:71]
ds_read_b64_tr_b16 a[164:165], v11 offset:20480
ds_read_b64_tr_b16 a[166:167], v11 offset:20992
v_mfma_f32_16x16x32_bf16 v[76:79], a[72:75], a[88:91], v[76:79]
v_add_u32 v9, 32768, v9
v_add_u32 v10, 32768, v10
v_mfma_f32_16x16x32_bf16 v[76:79], a[76:79], a[92:95], v[76:79]
ds_read_b64_tr_b16 a[168:169], v12 offset:16384
ds_read_b64_tr_b16 a[170:171], v12 offset:16896
v_mfma_f32_16x16x32_bf16 v[84:87], a[68:71], a[92:95], v[84:87]
s_add_u32 m0, s80, 0
s_add_u32 s64, s79, 0
v_accvgpr_write_b32 a5, v249
v_mfma_f32_16x16x32_bf16 v[84:87], a[64:67], a[88:91], v[84:87]
ds_read_b64_tr_b16 a[172:173], v12 offset:20480
ds_read_b64_tr_b16 a[174:175], v12 offset:20992
v_mfma_f32_16x16x32_bf16 v[92:95], a[152:155], a[88:91], v[92:95]
buffer_load_dwordx4 v15, s[24:27], s64 offen sc1 lds
v_mfma_f32_16x16x32_bf16 v[92:95], a[156:159], a[92:95], v[92:95]
v_accvgpr_write_b32 a6, v250
v_accvgpr_write_b32 a7, v251
v_mfma_f32_16x16x32_bf16 v[40:43], a[148:151], a[92:95], v[40:43]
ds_read_b64_tr_b16 a[176:177], v13 offset:16384
ds_read_b64_tr_b16 a[178:179], v13 offset:16896
v_mfma_f32_16x16x32_bf16 v[40:43], a[144:147], a[88:91], v[40:43]
v_accvgpr_write_b32 a12, v240
v_accvgpr_write_b32 a13, v241
v_mfma_f32_16x16x32_bf16 v[100:103], a[136:139], a[88:91], v[100:103]
s_add_u32 m0, s73, 4096
s_add_u32 s64, s72, 0
v_accvgpr_write_b32 a14, v242
v_mfma_f32_16x16x32_bf16 v[100:103], a[140:143], a[92:95], v[100:103]
ds_read_b64_tr_b16 a[180:181], v13 offset:20480
ds_read_b64_tr_b16 a[182:183], v13 offset:20992
v_mfma_f32_16x16x32_bf16 v[108:111], a[132:135], a[92:95], v[108:111]
buffer_load_dwordx4 v5, s[12:15], s64 offen lds
v_mfma_f32_16x16x32_bf16 v[108:111], a[128:131], a[88:91], v[108:111]
s_waitcnt lgkmcnt(14)
ds_read_b64_tr_b16 a[184:185], v14 offset:16384
ds_read_b64_tr_b16 a[186:187], v14 offset:16896
v_mfma_f32_16x16x32_bf16 v[116:119], a[128:131], a[96:99], v[116:119]
ds_read_b64_tr_b16 a[188:189], v14 offset:20480
ds_read_b64_tr_b16 a[190:191], v14 offset:20992
v_mfma_f32_16x16x32_bf16 v[116:119], a[132:135], a[100:103], v[116:119]
v_accvgpr_write_b32 a15, v243
v_accvgpr_write_b32 a20, v232
v_mfma_f32_16x16x32_bf16 v[124:127], a[140:143], a[100:103], v[124:127]
v_accvgpr_write_b32 a21, v233
v_accvgpr_write_b32 a22, v234
v_mfma_f32_16x16x32_bf16 v[124:127], a[136:139], a[96:99], v[124:127]
ds_read_b128 a[112:115], v4 offset:24576
v_accvgpr_write_b32 a23, v235
v_mfma_f32_16x16x32_bf16 v[132:135], a[144:147], a[96:99], v[132:135]
buffer_load_dwordx4 v6, s[12:15], s64 offen offset:1024 lds
v_mfma_f32_16x16x32_bf16 v[132:135], a[148:151], a[100:103], v[132:135]
ds_read_b128 a[116:119], v4 offset:26624
v_accvgpr_write_b32 a28, v224
v_mfma_f32_16x16x32_bf16 v[140:143], a[156:159], a[100:103], v[140:143]
v_accvgpr_write_b32 a29, v225
v_accvgpr_write_b32 a30, v226
v_mfma_f32_16x16x32_bf16 v[140:143], a[152:155], a[96:99], v[140:143]
ds_read_b128 a[120:123], v4 offset:25600
v_accvgpr_write_b32 a31, v227
v_mfma_f32_16x16x32_bf16 v[148:151], a[64:67], a[96:99], v[148:151]
s_add_u32 m0, s73, 6144
s_add_u32 s64, s72, 18432
v_accvgpr_read_b32 v252, a32
v_mfma_f32_16x16x32_bf16 v[148:151], a[68:71], a[100:103], v[148:151]
ds_read_b128 a[124:127], v4 offset:27648
v_accvgpr_read_b32 v253, a33
v_mfma_f32_16x16x32_bf16 v[48:51], a[76:79], a[100:103], v[48:51]
buffer_load_dwordx4 v5, s[12:15], s64 offen lds
v_mfma_f32_16x16x32_bf16 v[48:51], a[72:75], a[96:99], v[48:51]
s_waitcnt lgkmcnt(15)
s_add_u32 s53, s87, 262144
v_accvgpr_read_b32 v254, a34
v_mfma_f32_16x16x32_bf16 v[156:159], a[72:75], a[104:107], v[156:159]
buffer_store_dwordx4 v[192:195], v15, s[24:27], s53 offen offset:0 sc1
v_mfma_f32_16x16x32_bf16 v[156:159], a[76:79], a[108:111], v[156:159]
v_accvgpr_read_b32 v255, a35
v_accvgpr_read_b32 v160, a36
v_mfma_f32_16x16x32_bf16 v[164:167], a[68:71], a[108:111], v[164:167]
v_accvgpr_read_b32 v161, a37
v_accvgpr_read_b32 v162, a38
v_mfma_f32_16x16x32_bf16 v[164:167], a[64:67], a[104:107], v[164:167]
v_accvgpr_read_b32 v163, a39
v_accvgpr_read_b32 v168, a40
v_mfma_f32_16x16x32_bf16 v[172:175], a[152:155], a[104:107], v[172:175]
buffer_load_dwordx4 v6, s[12:15], s64 offen offset:1024 lds
v_mfma_f32_16x16x32_bf16 v[172:175], a[156:159], a[108:111], v[172:175]
v_accvgpr_read_b32 v169, a41
v_accvgpr_read_b32 v170, a42
v_mfma_f32_16x16x32_bf16 v[56:59], a[148:151], a[108:111], v[56:59]
v_accvgpr_read_b32 v171, a43
v_accvgpr_read_b32 v176, a44
v_mfma_f32_16x16x32_bf16 v[56:59], a[144:147], a[104:107], v[56:59]
v_accvgpr_read_b32 v177, a45
v_accvgpr_read_b32 v178, a46
v_mfma_f32_16x16x32_bf16 v[180:183], a[136:139], a[104:107], v[180:183]
v_accvgpr_read_b32 v179, a47
v_accvgpr_read_b32 v184, a48
v_mfma_f32_16x16x32_bf16 v[180:183], a[140:143], a[108:111], v[180:183]
v_accvgpr_read_b32 v185, a49
v_accvgpr_read_b32 v186, a50
v_mfma_f32_16x16x32_bf16 v[188:191], a[132:135], a[108:111], v[188:191]
v_accvgpr_read_b32 v187, a51
v_accvgpr_read_b32 v248, a52
v_mfma_f32_16x16x32_bf16 v[188:191], a[128:131], a[104:107], v[188:191]
s_waitcnt lgkmcnt(0)
v_accvgpr_read_b32 v249, a53
v_accvgpr_read_b32 v250, a54
v_mfma_f32_16x16x32_bf16 v[196:199], a[160:163], a[80:83], v[196:199]
s_waitcnt vmcnt(18)
v_accvgpr_read_b32 v251, a55
v_accvgpr_read_b32 v240, a56
v_mfma_f32_16x16x32_bf16 v[196:199], a[164:167], a[84:87], v[196:199]
s_barrier
v_mfma_f32_16x16x32_bf16 v[64:67], a[172:175], a[84:87], v[64:67]
ds_read_b64_tr_b16 a[128:129], v11 offset:32768
ds_read_b64_tr_b16 a[130:131], v11 offset:33280
v_mfma_f32_16x16x32_bf16 v[64:67], a[168:171], a[80:83], v[64:67]
s_add_u32 m0, s77, 16384
s_add_u32 s64, s76, 128
v_accvgpr_read_b32 v241, a57
v_mfma_f32_16x16x32_bf16 v[204:207], a[176:179], a[80:83], v[204:207]
buffer_load_dwordx4 v7, s[20:23], s64 offen lds
v_mfma_f32_16x16x32_bf16 v[204:207], a[180:183], a[84:87], v[204:207]
ds_read_b64_tr_b16 a[132:133], v11 offset:36864
ds_read_b64_tr_b16 a[134:135], v11 offset:37376
v_mfma_f32_16x16x32_bf16 v[212:215], a[188:191], a[84:87], v[212:215]
ds_read_b64_tr_b16 a[136:137], v12 offset:32768
ds_read_b64_tr_b16 a[138:139], v12 offset:33280
v_mfma_f32_16x16x32_bf16 v[212:215], a[184:187], a[80:83], v[212:215]
ds_read_b64_tr_b16 a[140:141], v12 offset:36864
ds_read_b64_tr_b16 a[142:143], v12 offset:37376
v_mfma_f32_16x16x32_bf16 v[72:75], a[112:115], a[80:83], v[72:75]
v_accvgpr_read_b32 v242, a58
v_accvgpr_read_b32 v243, a59
v_mfma_f32_16x16x32_bf16 v[72:75], a[116:119], a[84:87], v[72:75]
ds_read_b64_tr_b16 a[144:145], v13 offset:32768
ds_read_b64_tr_b16 a[146:147], v13 offset:33280
v_mfma_f32_16x16x32_bf16 v[220:223], a[124:127], a[84:87], v[220:223]
buffer_load_dwordx4 v8, s[20:23], s64 offen offset:1024 lds
v_mfma_f32_16x16x32_bf16 v[220:223], a[120:123], a[80:83], v[220:223]
ds_read_b64_tr_b16 a[148:149], v13 offset:36864
ds_read_b64_tr_b16 a[150:151], v13 offset:37376
v_mfma_f32_16x16x32_bf16 v[252:255], a[120:123], a[88:91], v[252:255]
v_accvgpr_read_b32 v232, a60
v_accvgpr_read_b32 v233, a61
v_mfma_f32_16x16x32_bf16 v[252:255], a[124:127], a[92:95], v[252:255]
s_add_u32 s53, s87, 262144
ds_read_b64_tr_b16 a[152:153], v14 offset:32768
ds_read_b64_tr_b16 a[154:155], v14 offset:33280
v_mfma_f32_16x16x32_bf16 v[160:163], a[116:119], a[92:95], v[160:163]
s_add_u32 m0, s80, 16384
s_add_u32 s64, s79, 2048
L_PAD5:
s_cbranch_execz L_PAD9
v_accvgpr_read_b32 v234, a62
v_mfma_f32_16x16x32_bf16 v[160:163], a[112:115], a[88:91], v[160:163]
ds_read_b64_tr_b16 a[156:157], v14 offset:36864
ds_read_b64_tr_b16 a[158:159], v14 offset:37376
v_mfma_f32_16x16x32_bf16 v[228:231], a[184:187], a[88:91], v[228:231]
buffer_load_dwordx4 v15, s[24:27], s64 offen sc1 lds
v_mfma_f32_16x16x32_bf16 v[228:231], a[188:191], a[92:95], v[228:231]
s_xor_b32 s65, s70, 512
s_add_u32 s71, s68, s65
s_add_u32 s72, s69, s65
v_mfma_f32_16x16x32_bf16 v[168:171], a[180:183], a[92:95], v[168:171]
ds_read_b128 a[64:67], v4 offset:40960
v_accvgpr_read_b32 v235, a63
v_mfma_f32_16x16x32_bf16 v[168:171], a[176:179], a[88:91], v[168:171]
buffer_store_dwordx4 v[200:203], v15, s[24:27], s53 offen offset:1024 sc1
v_mfma_f32_16x16x32_bf16 v[176:179], a[168:171], a[88:91], v[176:179]
s_add_u32 m0, s73, 32768
s_add_u32 s64, s71, 0
ds_read_b128 a[80:83], v9 offset:0
v_mfma_f32_16x16x32_bf16 v[176:179], a[172:175], a[92:95], v[176:179]
v_accvgpr_read_b32 v224, a192
v_accvgpr_read_b32 v225, a193
v_mfma_f32_16x16x32_bf16 v[80:83], a[164:167], a[92:95], v[80:83]
buffer_load_dwordx4 v5, s[12:15], s64 offen lds
v_mfma_f32_16x16x32_bf16 v[80:83], a[160:163], a[88:91], v[80:83]
ds_read_b128 a[68:71], v4 offset:43008
v_accvgpr_read_b32 v226, a194
v_mfma_f32_16x16x32_bf16 v[184:187], a[160:163], a[96:99], v[184:187]
ds_read_b128 a[84:87], v10 offset:0
v_accvgpr_read_b32 v227, a195
v_mfma_f32_16x16x32_bf16 v[184:187], a[164:167], a[100:103], v[184:187]
v_accvgpr_read_b32 v192, a204
v_accvgpr_read_b32 v193, a205
v_mfma_f32_16x16x32_bf16 v[248:251], a[172:175], a[100:103], v[248:251]
v_accvgpr_read_b32 v194, a206
v_accvgpr_read_b32 v195, a207
v_mfma_f32_16x16x32_bf16 v[248:251], a[168:171], a[96:99], v[248:251]
ds_read_b128 a[72:75], v4 offset:41984
v_accvgpr_read_b32 v200, a208
v_mfma_f32_16x16x32_bf16 v[240:243], a[176:179], a[96:99], v[240:243]
buffer_load_dwordx4 v6, s[12:15], s64 offen offset:1024 lds
v_mfma_f32_16x16x32_bf16 v[240:243], a[180:183], a[100:103], v[240:243]
ds_read_b128 a[88:91], v9 offset:2048
v_accvgpr_read_b32 v201, a209
v_mfma_f32_16x16x32_bf16 v[232:235], a[188:191], a[100:103], v[232:235]
v_accvgpr_read_b32 v202, a210
v_accvgpr_read_b32 v203, a211
v_mfma_f32_16x16x32_bf16 v[232:235], a[184:187], a[96:99], v[232:235]
ds_read_b128 a[76:79], v4 offset:44032
v_and_b32 v28, 31, v1
v_mfma_f32_16x16x32_bf16 v[236:239], a[112:115], a[96:99], v[236:239]
s_add_u32 m0, s73, 34816
s_add_u32 s64, s71, 18432
v_lshlrev_b32 v28, 2, v28
v_mfma_f32_16x16x32_bf16 v[236:239], a[116:119], a[100:103], v[236:239]
ds_read_b128 a[92:95], v10 offset:2048
v_mfma_f32_16x16x32_bf16 v[224:227], a[124:127], a[100:103], v[224:227]
buffer_load_dwordx4 v5, s[12:15], s64 offen lds
v_mfma_f32_16x16x32_bf16 v[224:227], a[120:123], a[96:99], v[224:227]
buffer_load_dword v30, v28, s[40:43], 0 offen sc1
v_mfma_f32_16x16x32_bf16 a[196:199], a[120:123], a[104:107], a[196:199]
v_mfma_f32_16x16x32_bf16 a[196:199], a[124:127], a[108:111], a[196:199]
v_mfma_f32_16x16x32_bf16 a[200:203], a[116:119], a[108:111], a[200:203]
v_mfma_f32_16x16x32_bf16 a[200:203], a[112:115], a[104:107], a[200:203]
v_mfma_f32_16x16x32_bf16 v[244:247], a[184:187], a[104:107], v[244:247]
buffer_load_dwordx4 v6, s[12:15], s64 offen offset:1024 lds
v_mfma_f32_16x16x32_bf16 v[244:247], a[188:191], a[108:111], v[244:247]
s_add_u32 s53, s87, 266240
v_mfma_f32_16x16x32_bf16 v[192:195], a[180:183], a[108:111], v[192:195]
buffer_store_dwordx4 v[208:211], v15, s[24:27], s53 offen offset:0 sc1
v_mfma_f32_16x16x32_bf16 v[192:195], a[176:179], a[104:107], v[192:195]
v_mfma_f32_16x16x32_bf16 v[200:203], a[168:171], a[104:107], v[200:203]
v_mfma_f32_16x16x32_bf16 v[200:203], a[172:175], a[108:111], v[200:203]
v_accvgpr_read_b32 v208, a196
v_accvgpr_read_b32 v209, a197
v_mfma_f32_16x16x32_bf16 v[88:91], a[164:167], a[108:111], v[88:91]
v_accvgpr_read_b32 v210, a198
v_accvgpr_read_b32 v211, a199
v_mfma_f32_16x16x32_bf16 v[88:91], a[160:163], a[104:107], v[88:91]
s_waitcnt lgkmcnt(0)
v_mfma_f32_16x16x32_bf16 v[36:39], a[128:131], a[80:83], v[36:39]
s_waitcnt vmcnt(24)
v_mfma_f32_16x16x32_bf16 v[36:39], a[132:135], a[84:87], v[36:39]
s_barrier
v_mfma_f32_16x16x32_bf16 v[44:47], a[140:143], a[84:87], v[44:47]
ds_read_b128 a[96:99], v9 offset:4096
v_mfma_f32_16x16x32_bf16 v[44:47], a[136:139], a[80:83], v[44:47]
s_xor_b32 s75, s93, 4
s_lshl_b32 s76, s75, 19
s_add_u32 s76, s76, s74
v_mfma_f32_16x16x32_bf16 v[32:35], a[144:147], a[80:83], v[32:35]
s_lshl_b32 s79, s75, 13
s_add_u32 s79, s79, s78
ds_read_b128 a[100:103], v10 offset:4096
v_mfma_f32_16x16x32_bf16 v[32:35], a[148:151], a[84:87], v[32:35]
s_add_u32 m0, s77, 32768
s_add_u32 s64, s76, 0
ds_read_b128 a[104:107], v9 offset:6144
v_mfma_f32_16x16x32_bf16 v[52:55], a[156:159], a[84:87], v[52:55]
buffer_load_dwordx4 v7, s[20:23], s64 offen lds
v_mfma_f32_16x16x32_bf16 v[52:55], a[152:155], a[80:83], v[52:55]
ds_read_b64_tr_b16 a[160:161], v11 offset:49152
ds_read_b64_tr_b16 a[162:163], v11 offset:49664
v_mfma_f32_16x16x32_bf16 v[60:63], a[64:67], a[80:83], v[60:63]
v_mfma_f32_16x16x32_bf16 v[60:63], a[68:71], a[84:87], v[60:63]
ds_read_b128 a[108:111], v10 offset:6144
v_mfma_f32_16x16x32_bf16 v[68:71], a[76:79], a[84:87], v[68:71]
buffer_load_dwordx4 v8, s[20:23], s64 offen offset:1024 lds
v_mfma_f32_16x16x32_bf16 v[68:71], a[72:75], a[80:83], v[68:71]
ds_read_b64_tr_b16 a[164:165], v11 offset:53248
ds_read_b64_tr_b16 a[166:167], v11 offset:53760
v_mfma_f32_16x16x32_bf16 v[76:79], a[72:75], a[88:91], v[76:79]
v_add_u32 v9, -65536, v9
v_add_u32 v10, -65536, v10
v_mfma_f32_16x16x32_bf16 v[76:79], a[76:79], a[92:95], v[76:79]
ds_read_b64_tr_b16 a[168:169], v12 offset:49152
ds_read_b64_tr_b16 a[170:171], v12 offset:49664
v_mfma_f32_16x16x32_bf16 v[84:87], a[68:71], a[92:95], v[84:87]
s_add_u32 m0, s80, 32768
s_add_u32 s64, s79, 0
v_mfma_f32_16x16x32_bf16 v[84:87], a[64:67], a[88:91], v[84:87]
ds_read_b64_tr_b16 a[172:173], v12 offset:53248
ds_read_b64_tr_b16 a[174:175], v12 offset:53760
v_mfma_f32_16x16x32_bf16 v[92:95], a[152:155], a[88:91], v[92:95]
buffer_load_dwordx4 v15, s[24:27], s64 offen sc1 lds
v_mfma_f32_16x16x32_bf16 v[92:95], a[156:159], a[92:95], v[92:95]
v_mfma_f32_16x16x32_bf16 v[40:43], a[148:151], a[92:95], v[40:43]
ds_read_b64_tr_b16 a[176:177], v13 offset:49152
ds_read_b64_tr_b16 a[178:179], v13 offset:49664
v_mfma_f32_16x16x32_bf16 v[40:43], a[144:147], a[88:91], v[40:43]
s_add_u32 s53, s87, 266240
v_mfma_f32_16x16x32_bf16 v[100:103], a[136:139], a[88:91], v[100:103]
s_add_u32 m0, s73, 36864
s_add_u32 s64, s72, 0
v_mfma_f32_16x16x32_bf16 v[100:103], a[140:143], a[92:95], v[100:103]
ds_read_b64_tr_b16 a[180:181], v13 offset:53248
ds_read_b64_tr_b16 a[182:183], v13 offset:53760
v_mfma_f32_16x16x32_bf16 v[108:111], a[132:135], a[92:95], v[108:111]
buffer_load_dwordx4 v5, s[12:15], s64 offen lds
v_mfma_f32_16x16x32_bf16 v[108:111], a[128:131], a[88:91], v[108:111]
s_waitcnt lgkmcnt(14)
ds_read_b64_tr_b16 a[184:185], v14 offset:49152
ds_read_b64_tr_b16 a[186:187], v14 offset:49664
v_mfma_f32_16x16x32_bf16 v[116:119], a[128:131], a[96:99], v[116:119]
ds_read_b64_tr_b16 a[188:189], v14 offset:53248
ds_read_b64_tr_b16 a[190:191], v14 offset:53760
v_mfma_f32_16x16x32_bf16 v[116:119], a[132:135], a[100:103], v[116:119]
buffer_store_dwordx4 v[216:219], v15, s[24:27], s53 offen offset:1024 sc1
v_mfma_f32_16x16x32_bf16 v[124:127], a[140:143], a[100:103], v[124:127]
v_mfma_f32_16x16x32_bf16 v[124:127], a[136:139], a[96:99], v[124:127]
ds_read_b128 a[112:115], v4 offset:57344
v_accvgpr_read_b32 v216, a200
v_mfma_f32_16x16x32_bf16 v[132:135], a[144:147], a[96:99], v[132:135]
buffer_load_dwordx4 v6, s[12:15], s64 offen offset:1024 lds
v_mfma_f32_16x16x32_bf16 v[132:135], a[148:151], a[100:103], v[132:135]
ds_read_b128 a[116:119], v4 offset:59392
v_accvgpr_read_b32 v217, a201
v_mfma_f32_16x16x32_bf16 v[140:143], a[156:159], a[100:103], v[140:143]
v_accvgpr_read_b32 v218, a202
v_accvgpr_read_b32 v219, a203
v_mfma_f32_16x16x32_bf16 v[140:143], a[152:155], a[96:99], v[140:143]
s_lshr_b32 s84, s7, 1
s_and_b32 s85, s7, 1
ds_read_b128 a[120:123], v4 offset:58368
v_mfma_f32_16x16x32_bf16 v[148:151], a[64:67], a[96:99], v[148:151]
s_add_u32 m0, s73, 38912
s_add_u32 s64, s72, 18432
s_xor_b32 s52, s5, 0
v_mfma_f32_16x16x32_bf16 v[148:151], a[68:71], a[100:103], v[148:151]
s_lshl1_add_u32 s85, s52, s85
s_and_b32 s86, s6, 3
ds_read_b128 a[124:127], v4 offset:60416
v_mfma_f32_16x16x32_bf16 v[48:51], a[76:79], a[100:103], v[48:51]
buffer_load_dwordx4 v5, s[12:15], s64 offen lds
v_mfma_f32_16x16x32_bf16 v[48:51], a[72:75], a[96:99], v[48:51]
s_waitcnt lgkmcnt(15)
s_lshl_b32 s83, s3, 13
s_add_u32 s83, s83, 131072
v_mfma_f32_16x16x32_bf16 v[156:159], a[72:75], a[104:107], v[156:159]
s_mul_i32 s52, s2, 5462
s_lshr_b32 s52, s52, 16
s_mul_i32 s54, s52, 12
v_mfma_f32_16x16x32_bf16 v[156:159], a[76:79], a[108:111], v[156:159]
s_sub_u32 s54, s2, s54
s_mul_i32 s54, s54, 3
s_add_u32 s54, s54, s3
v_mfma_f32_16x16x32_bf16 v[164:167], a[68:71], a[108:111], v[164:167]
s_mul_i32 s55, s52, 13108
s_lshr_b32 s55, s55, 16
s_mul_i32 s82, s55, 5
v_mfma_f32_16x16x32_bf16 v[164:167], a[64:67], a[104:107], v[164:167]
s_sub_u32 s52, s52, s82
v_mfma_f32_16x16x32_bf16 v[172:175], a[152:155], a[104:107], v[172:175]
buffer_load_dwordx4 v6, s[12:15], s64 offen offset:1024 lds
v_mfma_f32_16x16x32_bf16 v[172:175], a[156:159], a[108:111], v[172:175]
v_lshrrev_b32 v16, 1, v1
v_and_b32 v17, 1, v1
v_mfma_f32_16x16x32_bf16 v[56:59], a[148:151], a[108:111], v[56:59]
v_mul_u32_u24 v18, 1152, v16
v_lshl_add_u32 v18, v17, 4, v18
v_mfma_f32_16x16x32_bf16 v[56:59], a[144:147], a[104:107], v[56:59]
v_mov_b32 v24, v18
v_lshrrev_b32 v18, 4, v16
v_mfma_f32_16x16x32_bf16 v[180:183], a[136:139], a[104:107], v[180:183]
v_bfe_u32 v19, v16, 2, 2
v_and_b32 v16, 3, v16
v_mfma_f32_16x16x32_bf16 v[180:183], a[140:143], a[108:111], v[180:183]
v_lshrrev_b32 v20, 1, v19
v_mul_u32_u24 v20, 18, v20
v_mfma_f32_16x16x32_bf16 v[188:191], a[132:135], a[108:111], v[188:191]
s_add_u32 s53, s88, 524288
v_and_b32 v21, 1, v19
v_lshl_add_u32 v20, v21, 1, v20
v_mfma_f32_16x16x32_bf16 v[188:191], a[128:131], a[104:107], v[188:191]
s_waitcnt lgkmcnt(0)
v_lshl_add_u32 v20, v16, 2, v20
v_add_u32 v20, v20, v18
v_mfma_f32_16x16x32_bf16 v[196:199], a[160:163], a[80:83], v[196:199]
s_waitcnt vmcnt(18)
v_mad_u32_u24 v20, s52, 36, v20
v_lshlrev_b32 v21, 1, v18
v_mfma_f32_16x16x32_bf16 v[196:199], a[164:167], a[84:87], v[196:199]
s_barrier
v_mfma_f32_16x16x32_bf16 v[64:67], a[172:175], a[84:87], v[64:67]
ds_read_b64_tr_b16 a[128:129], v11 offset:0
ds_read_b64_tr_b16 a[130:131], v11 offset:512
v_mfma_f32_16x16x32_bf16 v[64:67], a[168:171], a[80:83], v[64:67]
s_add_u32 m0, s77, 49152
s_add_u32 s64, s76, 128
v_lshl_add_u32 v21, v19, 2, v21
v_mfma_f32_16x16x32_bf16 v[204:207], a[176:179], a[80:83], v[204:207]
buffer_load_dwordx4 v7, s[20:23], s64 offen lds
v_mfma_f32_16x16x32_bf16 v[204:207], a[180:183], a[84:87], v[204:207]
ds_read_b64_tr_b16 a[132:133], v11 offset:4096
ds_read_b64_tr_b16 a[134:135], v11 offset:4608
v_mfma_f32_16x16x32_bf16 v[212:215], a[188:191], a[84:87], v[212:215]
ds_read_b64_tr_b16 a[136:137], v12 offset:0
ds_read_b64_tr_b16 a[138:139], v12 offset:512
v_mfma_f32_16x16x32_bf16 v[212:215], a[184:187], a[80:83], v[212:215]
ds_read_b64_tr_b16 a[140:141], v12 offset:4096
ds_read_b64_tr_b16 a[142:143], v12 offset:4608
v_mfma_f32_16x16x32_bf16 v[72:75], a[112:115], a[80:83], v[72:75]
buffer_store_dwordx4 v[96:99], v15, s[24:27], s53 offen offset:0 sc1
v_mfma_f32_16x16x32_bf16 v[72:75], a[116:119], a[84:87], v[72:75]
ds_read_b64_tr_b16 a[144:145], v13 offset:0
ds_read_b64_tr_b16 a[146:147], v13 offset:512
v_mfma_f32_16x16x32_bf16 v[220:223], a[124:127], a[84:87], v[220:223]
buffer_load_dwordx4 v8, s[20:23], s64 offen offset:1024 lds
v_mfma_f32_16x16x32_bf16 v[220:223], a[120:123], a[80:83], v[220:223]
ds_read_b64_tr_b16 a[148:149], v13 offset:4096
ds_read_b64_tr_b16 a[150:151], v13 offset:4608
v_mfma_f32_16x16x32_bf16 v[252:255], a[120:123], a[88:91], v[252:255]
v_lshrrev_b32 v22, 1, v16
v_add_u32 v21, v21, v22
v_mfma_f32_16x16x32_bf16 v[252:255], a[124:127], a[92:95], v[252:255]
ds_read_b64_tr_b16 a[152:153], v14 offset:0
ds_read_b64_tr_b16 a[154:155], v14 offset:512
v_mfma_f32_16x16x32_bf16 v[160:163], a[116:119], a[92:95], v[160:163]
s_add_u32 m0, s80, 49152
s_add_u32 s64, s79, 2048
v_mul_u32_u24 v21, 18, v21
v_mfma_f32_16x16x32_bf16 v[160:163], a[112:115], a[88:91], v[160:163]
ds_read_b64_tr_b16 a[156:157], v14 offset:4096
ds_read_b64_tr_b16 a[158:159], v14 offset:4608
v_mfma_f32_16x16x32_bf16 v[228:231], a[184:187], a[88:91], v[228:231]
buffer_load_dwordx4 v15, s[24:27], s64 offen sc1 lds
v_mfma_f32_16x16x32_bf16 v[228:231], a[188:191], a[92:95], v[228:231]
s_xor_b32 s65, s70, 640
s_add_u32 s71, s68, s65
s_add_u32 s72, s69, s65
v_mfma_f32_16x16x32_bf16 v[168:171], a[180:183], a[92:95], v[168:171]
ds_read_b128 a[64:67], v4 offset:8192
v_and_b32 v22, 1, v16
v_mfma_f32_16x16x32_bf16 v[168:171], a[176:179], a[88:91], v[168:171]
v_add3_u32 v21, v21, v22, 16
v_cmp_lt_u32 s[96:97], 1, v19
v_mfma_f32_16x16x32_bf16 v[176:179], a[168:171], a[88:91], v[176:179]
s_add_u32 m0, s73, 65536
s_add_u32 s64, s71, 0
ds_read_b128 a[80:83], v9 offset:0
v_mfma_f32_16x16x32_bf16 v[176:179], a[172:175], a[92:95], v[176:179]
v_mov_b32 v22, 0x100000
v_mul_u32_u24 v23, 1, v23
v_mfma_f32_16x16x32_bf16 v[80:83], a[164:167], a[92:95], v[80:83]
buffer_load_dwordx4 v5, s[12:15], s64 offen lds
v_mfma_f32_16x16x32_bf16 v[80:83], a[160:163], a[88:91], v[80:83]
ds_read_b128 a[68:71], v4 offset:10240
v_cndmask_b32 v21, v21, v22, s[96:97]
v_mfma_f32_16x16x32_bf16 v[184:187], a[160:163], a[96:99], v[184:187]
ds_read_b128 a[84:87], v10 offset:0
v_mov_b32 v22, s52
v_mfma_f32_16x16x32_bf16 v[184:187], a[164:167], a[100:103], v[184:187]
s_add_u32 s53, s88, 524288
v_cmp_eq_u32 s[96:97], 4, v22
v_mfma_f32_16x16x32_bf16 v[248:251], a[172:175], a[100:103], v[248:251]
buffer_store_dwordx4 v[104:107], v15, s[24:27], s53 offen offset:1024 sc1
v_mfma_f32_16x16x32_bf16 v[248:251], a[168:171], a[96:99], v[248:251]
ds_read_b128 a[72:75], v4 offset:9216
v_cndmask_b32 v20, v20, v21, s[96:97]
v_mfma_f32_16x16x32_bf16 v[240:243], a[176:179], a[96:99], v[240:243]
buffer_load_dwordx4 v6, s[12:15], s64 offen offset:1024 lds
v_mfma_f32_16x16x32_bf16 v[240:243], a[180:183], a[100:103], v[240:243]
ds_read_b128 a[88:91], v9 offset:2048
v_mul_u32_u24 v20, 1152, v20
v_mfma_f32_16x16x32_bf16 v[232:235], a[188:191], a[100:103], v[232:235]
v_lshl_add_u32 v20, v17, 4, v20
v_mov_b32 v25, v20
v_mfma_f32_16x16x32_bf16 v[232:235], a[184:187], a[96:99], v[232:235]
ds_read_b128 a[76:79], v4 offset:11264
v_mov_b32 v16, s54
v_mfma_f32_16x16x32_bf16 v[236:239], a[112:115], a[96:99], v[236:239]
s_add_u32 m0, s73, 67584
s_add_u32 s64, s71, 18432
v_mov_b32 v17, s55
v_mfma_f32_16x16x32_bf16 v[236:239], a[116:119], a[100:103], v[236:239]
ds_read_b128 a[92:95], v10 offset:2048
v_add_u32 v18, 32, v22
v_mfma_f32_16x16x32_bf16 v[224:227], a[124:127], a[100:103], v[224:227]
buffer_load_dwordx4 v5, s[12:15], s64 offen lds
v_mfma_f32_16x16x32_bf16 v[224:227], a[120:123], a[96:99], v[224:227]
s_mul_i32 s82, s55, 165888
s_lshl_b32 s54, s54, 5
s_add_u32 s82, s82, s54
v_mfma_f32_16x16x32_bf16 v[208:211], a[120:123], a[104:107], v[208:211]
s_and_b32 s52, s2, 1
s_lshr_b32 s54, s3, 1
s_lshl1_add_u32 s52, s52, s54
v_mfma_f32_16x16x32_bf16 v[208:211], a[124:127], a[108:111], v[208:211]
s_mul_i32 s52, s52, 9
s_and_b32 s54, s3, 1
s_mul_i32 s55, s54, 5
v_mfma_f32_16x16x32_bf16 v[216:219], a[116:119], a[108:111], v[216:219]
s_add_u32 s52, s52, s55
s_lshr_b32 s55, s2, 1
s_mul_i32 s81, s55, 1152
v_mfma_f32_16x16x32_bf16 v[216:219], a[112:115], a[104:107], v[216:219]
s_add_u32 s81, s81, s52
s_lshl_b32 s81, s81, 5
v_mfma_f32_16x16x32_bf16 v[244:247], a[184:187], a[104:107], v[244:247]
buffer_load_dwordx4 v6, s[12:15], s64 offen offset:1024 lds
v_mfma_f32_16x16x32_bf16 v[244:247], a[188:191], a[108:111], v[244:247]
v_cmp_gt_u32 s[96:97], 5, v1
v_add_u32 v19, s52, v1
v_mfma_f32_16x16x32_bf16 v[192:195], a[180:183], a[108:111], v[192:195]
v_lshrrev_b32 v20, 5, s55
v_and_b32 v21, 31, s55
v_mfma_f32_16x16x32_bf16 v[192:195], a[176:179], a[104:107], v[192:195]
v_cndmask_b32 v16, v16, v19, s[96:97]
v_cndmask_b32 v17, v17, v20, s[96:97]
v_mfma_f32_16x16x32_bf16 v[200:203], a[168:171], a[104:107], v[200:203]
v_cndmask_b32 v18, v18, v21, s[96:97]
v_mul_u32_u24 v19, 7282, v16
v_mfma_f32_16x16x32_bf16 v[200:203], a[172:175], a[108:111], v[200:203]
v_lshrrev_b32 v19, 16, v19
v_mul_u32_u24 v20, 9, v19
v_mfma_f32_16x16x32_bf16 v[88:91], a[164:167], a[108:111], v[88:91]
v_sub_u32 v16, v16, v20
v_and_b32 v20, 1, v19
v_mfma_f32_16x16x32_bf16 v[88:91], a[160:163], a[104:107], v[88:91]
s_waitcnt lgkmcnt(0)
v_lshlrev_b32 v20, 2, v20
v_cndmask_b32 v20, 0, v20, s[96:97]
v_mfma_f32_16x16x32_bf16 v[36:39], a[128:131], a[80:83], v[36:39]
s_waitcnt vmcnt(24)
v_xor_b32 v18, v18, v20
v_lshl_add_u32 v19, v19, 2, v17
v_mfma_f32_16x16x32_bf16 v[36:39], a[132:135], a[84:87], v[36:39]
s_barrier
v_mfma_f32_16x16x32_bf16 v[44:47], a[140:143], a[84:87], v[44:47]
ds_read_b128 a[96:99], v9 offset:4096
v_mul_u32_u24 v19, 344064, v19
v_mfma_f32_16x16x32_bf16 v[44:47], a[136:139], a[80:83], v[44:47]
s_xor_b32 s75, s93, 5
s_lshl_b32 s76, s75, 19
s_add_u32 s76, s76, s74
v_mfma_f32_16x16x32_bf16 v[32:35], a[144:147], a[80:83], v[32:35]
s_lshl_b32 s79, s75, 13
s_add_u32 s79, s79, s78
ds_read_b128 a[100:103], v10 offset:4096
v_mfma_f32_16x16x32_bf16 v[32:35], a[148:151], a[84:87], v[32:35]
s_add_u32 m0, s77, 0
s_add_u32 s64, s76, 0
ds_read_b128 a[104:107], v9 offset:6144
v_mfma_f32_16x16x32_bf16 v[52:55], a[156:159], a[84:87], v[52:55]
buffer_load_dwordx4 v7, s[20:23], s64 offen lds
v_mfma_f32_16x16x32_bf16 v[52:55], a[152:155], a[80:83], v[52:55]
s_add_u32 s53, s88, 524288
ds_read_b64_tr_b16 a[160:161], v11 offset:16384
ds_read_b64_tr_b16 a[162:163], v11 offset:16896
v_mfma_f32_16x16x32_bf16 v[60:63], a[64:67], a[80:83], v[60:63]
buffer_store_dwordx4 v[112:115], v15, s[24:27], s53 offen offset:2048 sc1
v_mfma_f32_16x16x32_bf16 v[60:63], a[68:71], a[84:87], v[60:63]
ds_read_b128 a[108:111], v10 offset:6144
v_lshrrev_b32 v20, 1, v16
v_mfma_f32_16x16x32_bf16 v[68:71], a[76:79], a[84:87], v[68:71]
buffer_load_dwordx4 v8, s[20:23], s64 offen offset:1024 lds
v_mfma_f32_16x16x32_bf16 v[68:71], a[72:75], a[80:83], v[68:71]
ds_read_b64_tr_b16 a[164:165], v11 offset:20480
ds_read_b64_tr_b16 a[166:167], v11 offset:20992
v_mfma_f32_16x16x32_bf16 v[76:79], a[72:75], a[88:91], v[76:79]
v_add_u32 v9, 32768, v9
v_add_u32 v10, 32768, v10
v_mfma_f32_16x16x32_bf16 v[76:79], a[76:79], a[92:95], v[76:79]
ds_read_b64_tr_b16 a[168:169], v12 offset:16384
ds_read_b64_tr_b16 a[170:171], v12 offset:16896
v_mfma_f32_16x16x32_bf16 v[84:87], a[68:71], a[92:95], v[84:87]
s_add_u32 m0, s80, 0
s_add_u32 s64, s79, 0
v_sub_u32 v20, v20, v17
v_mfma_f32_16x16x32_bf16 v[84:87], a[64:67], a[88:91], v[84:87]
ds_read_b64_tr_b16 a[172:173], v12 offset:20480
ds_read_b64_tr_b16 a[174:175], v12 offset:20992
v_mfma_f32_16x16x32_bf16 v[92:95], a[152:155], a[88:91], v[92:95]
buffer_load_dwordx4 v15, s[24:27], s64 offen sc1 lds
v_mfma_f32_16x16x32_bf16 v[92:95], a[156:159], a[92:95], v[92:95]
v_add_u32 v20, 3, v20
v_and_b32 v20, 3, v20
v_mfma_f32_16x16x32_bf16 v[40:43], a[148:151], a[92:95], v[40:43]
s_waitcnt vmcnt(23)
ds_read_b64_tr_b16 a[176:177], v13 offset:16384
ds_read_b64_tr_b16 a[178:179], v13 offset:16896
v_mfma_f32_16x16x32_bf16 v[40:43], a[144:147], a[88:91], v[40:43]
v_cmp_gt_u32 vcc, 1, v30
v_cmp_eq_u32 s[96:97], 8, v16
v_mfma_f32_16x16x32_bf16 v[100:103], a[136:139], a[88:91], v[100:103]
s_add_u32 m0, s73, 69632
s_add_u32 s64, s72, 0
v_and_b32 v16, 1, v16
v_mfma_f32_16x16x32_bf16 v[100:103], a[140:143], a[92:95], v[100:103]
ds_read_b64_tr_b16 a[180:181], v13 offset:20480
ds_read_b64_tr_b16 a[182:183], v13 offset:20992
v_mfma_f32_16x16x32_bf16 v[108:111], a[132:135], a[92:95], v[108:111]
buffer_load_dwordx4 v5, s[12:15], s64 offen lds
v_mfma_f32_16x16x32_bf16 v[108:111], a[128:131], a[88:91], v[108:111]
s_waitcnt lgkmcnt(14)
ds_read_b64_tr_b16 a[184:185], v14 offset:16384
ds_read_b64_tr_b16 a[186:187], v14 offset:16896
v_mfma_f32_16x16x32_bf16 v[116:119], a[128:131], a[96:99], v[116:119]
ds_read_b64_tr_b16 a[188:189], v14 offset:20480
ds_read_b64_tr_b16 a[190:191], v14 offset:20992
v_mfma_f32_16x16x32_bf16 v[116:119], a[132:135], a[100:103], v[116:119]
s_cbranch_vccnz CK_ZA
CK_ZA_R:
v_mfma_f32_16x16x32_bf16 v[124:127], a[140:143], a[100:103], v[124:127]
v_lshl_add_u32 v21, v20, 1, v16
v_and_b32 v22, 1, v18
v_mfma_f32_16x16x32_bf16 v[124:127], a[136:139], a[96:99], v[124:127]
ds_read_b128 a[112:115], v4 offset:24576
v_lshl_add_u32 v19, v22, 10, v19
v_mfma_f32_16x16x32_bf16 v[132:135], a[144:147], a[96:99], v[132:135]
buffer_load_dwordx4 v6, s[12:15], s64 offen offset:1024 lds
v_mfma_f32_16x16x32_bf16 v[132:135], a[148:151], a[100:103], v[132:135]
ds_read_b128 a[116:119], v4 offset:26624
v_and_b32 v18, -2, v18
v_mfma_f32_16x16x32_bf16 v[140:143], a[156:159], a[100:103], v[140:143]
v_add_u32 v21, 1, v21
v_cndmask_b32 v21, v21, 0, s[96:97]
v_mfma_f32_16x16x32_bf16 v[140:143], a[152:155], a[96:99], v[140:143]
s_add_u32 s53, s88, 524288
ds_read_b128 a[120:123], v4 offset:25600
v_cndmask_b32 v20, v20, 0, s[96:97]
v_mfma_f32_16x16x32_bf16 v[148:151], a[64:67], a[96:99], v[148:151]
s_add_u32 m0, s73, 71680
s_add_u32 s64, s72, 18432
v_sub_u32 v17, 37, v18
v_mfma_f32_16x16x32_bf16 v[148:151], a[68:71], a[100:103], v[148:151]
ds_read_b128 a[124:127], v4 offset:27648
v_min_u32 v17, 2, v17
v_mfma_f32_16x16x32_bf16 v[48:51], a[76:79], a[100:103], v[48:51]
buffer_load_dwordx4 v5, s[12:15], s64 offen lds
v_mfma_f32_16x16x32_bf16 v[48:51], a[72:75], a[96:99], v[48:51]
s_waitcnt lgkmcnt(15)
v_mul_u32_u24 v21, v21, v17
v_mul_u32_u24 v22, v16, v17
v_mfma_f32_16x16x32_bf16 v[156:159], a[72:75], a[104:107], v[156:159]
buffer_store_dwordx4 v[120:123], v15, s[24:27], s53 offen offset:3072 sc1
v_mfma_f32_16x16x32_bf16 v[156:159], a[76:79], a[108:111], v[156:159]
v_min_u32 v23, 8, v18
v_mad_u32_u24 v21, v18, 5, v21
v_mfma_f32_16x16x32_bf16 v[164:167], a[68:71], a[108:111], v[164:167]
v_lshl_add_u32 v21, v23, 1, v21
v_lshl_add_u32 v22, v18, 1, v22
v_mfma_f32_16x16x32_bf16 v[164:167], a[64:67], a[104:107], v[164:167]
v_mad_u32_u24 v22, v20, 37, v22
v_mad_u32_u24 v22, v20, 37, v22
v_mfma_f32_16x16x32_bf16 v[172:175], a[152:155], a[104:107], v[172:175]
buffer_load_dwordx4 v6, s[12:15], s64 offen offset:1024 lds
v_mfma_f32_16x16x32_bf16 v[172:175], a[156:159], a[108:111], v[172:175]
v_lshl_add_u32 v20, v20, 6, v18
v_mov_b32 v23, 136
v_mfma_f32_16x16x32_bf16 v[56:59], a[148:151], a[108:111], v[56:59]
v_cmp_gt_u32 s[96:97], v23, v20
v_add_u32 v22, 37, v22
v_mfma_f32_16x16x32_bf16 v[56:59], a[144:147], a[104:107], v[56:59]
v_add_u32 v19, 38797312, v19
v_mfma_f32_16x16x32_bf16 v[180:183], a[136:139], a[104:107], v[180:183]
v_cndmask_b32 v21, v22, v21, s[96:97]
v_lshl_add_u32 v19, v21, 10, v19
v_mfma_f32_16x16x32_bf16 v[180:183], a[140:143], a[108:111], v[180:183]
s_cmp_eq_u32 s54, 1
s_cselect_b32 s96, 16, 0
v_mfma_f32_16x16x32_bf16 v[188:191], a[132:135], a[108:111], v[188:191]
s_cmp_eq_u32 s3, 3
s_cselect_b32 s52, 32, 0
s_or_b32 s96, s96, s52
v_mfma_f32_16x16x32_bf16 v[188:191], a[128:131], a[104:107], v[188:191]
s_waitcnt lgkmcnt(0)
s_cmp_ge_u32 s2, 240
s_cselect_b32 s52, 32, 0
v_mfma_f32_16x16x32_bf16 v[196:199], a[160:163], a[80:83], v[196:199]
s_waitcnt vmcnt(18)
s_or_b32 s96, s96, s52
s_mov_b32 s97, 0
v_mfma_f32_16x16x32_bf16 v[196:199], a[164:167], a[84:87], v[196:199]
s_barrier
v_mfma_f32_16x16x32_bf16 v[64:67], a[172:175], a[84:87], v[64:67]
ds_read_b64_tr_b16 a[128:129], v11 offset:32768
ds_read_b64_tr_b16 a[130:131], v11 offset:33280
v_mfma_f32_16x16x32_bf16 v[64:67], a[168:171], a[80:83], v[64:67]
s_add_u32 m0, s77, 16384
s_add_u32 s64, s76, 128
v_mov_b32 v20, 2147418112
v_mfma_f32_16x16x32_bf16 v[204:207], a[176:179], a[80:83], v[204:207]
buffer_load_dwordx4 v7, s[20:23], s64 offen lds
v_mfma_f32_16x16x32_bf16 v[204:207], a[180:183], a[84:87], v[204:207]
ds_read_b64_tr_b16 a[132:133], v11 offset:36864
ds_read_b64_tr_b16 a[134:135], v11 offset:37376
v_mfma_f32_16x16x32_bf16 v[212:215], a[188:191], a[84:87], v[212:215]
ds_read_b64_tr_b16 a[136:137], v12 offset:32768
ds_read_b64_tr_b16 a[138:139], v12 offset:33280
v_mfma_f32_16x16x32_bf16 v[212:215], a[184:187], a[80:83], v[212:215]
ds_read_b64_tr_b16 a[140:141], v12 offset:36864
ds_read_b64_tr_b16 a[142:143], v12 offset:37376
v_mfma_f32_16x16x32_bf16 v[72:75], a[112:115], a[80:83], v[72:75]
buffer_atomic_add v1, v0, s[24:27], s90 offen offset:4 sc1
v_mfma_f32_16x16x32_bf16 v[72:75], a[116:119], a[84:87], v[72:75]
ds_read_b64_tr_b16 a[144:145], v13 offset:32768
ds_read_b64_tr_b16 a[146:147], v13 offset:33280
v_mfma_f32_16x16x32_bf16 v[220:223], a[124:127], a[84:87], v[220:223]
buffer_load_dwordx4 v8, s[20:23], s64 offen offset:1024 lds
v_mfma_f32_16x16x32_bf16 v[220:223], a[120:123], a[80:83], v[220:223]
s_add_u32 s53, s88, 786432
ds_read_b64_tr_b16 a[148:149], v13 offset:36864
ds_read_b64_tr_b16 a[150:151], v13 offset:37376
v_mfma_f32_16x16x32_bf16 v[252:255], a[120:123], a[88:91], v[252:255]
buffer_store_dwordx4 v[128:131], v15, s[24:27], s53 offen offset:0 sc1
v_mfma_f32_16x16x32_bf16 v[252:255], a[124:127], a[92:95], v[252:255]
ds_read_b64_tr_b16 a[152:153], v14 offset:32768
ds_read_b64_tr_b16 a[154:155], v14 offset:33280
v_mfma_f32_16x16x32_bf16 v[160:163], a[116:119], a[92:95], v[160:163]
s_add_u32 m0, s80, 16384
s_add_u32 s64, s79, 2048
v_cndmask_b32 v26, v19, v20, s[96:97]
v_mfma_f32_16x16x32_bf16 v[160:163], a[112:115], a[88:91], v[160:163]
ds_read_b64_tr_b16 a[156:157], v14 offset:36864
ds_read_b64_tr_b16 a[158:159], v14 offset:37376
v_mfma_f32_16x16x32_bf16 v[228:231], a[184:187], a[88:91], v[228:231]
buffer_load_dwordx4 v15, s[24:27], s64 offen sc1 lds
v_mfma_f32_16x16x32_bf16 v[228:231], a[188:191], a[92:95], v[228:231]
s_xor_b32 s65, s70, 768
s_add_u32 s71, s68, s65
s_add_u32 s72, s69, s65
v_mfma_f32_16x16x32_bf16 v[168:171], a[180:183], a[92:95], v[168:171]
ds_read_b128 a[64:67], v4 offset:40960
v_lshlrev_b32 v27, 3, v1
v_mfma_f32_16x16x32_bf16 v[168:171], a[176:179], a[88:91], v[168:171]
v_add_u32 v27, s83, v27
v_lshrrev_b32 v22, 3, v1
v_mfma_f32_16x16x32_bf16 v[176:179], a[168:171], a[88:91], v[176:179]
s_add_u32 m0, s73, 0
s_add_u32 s64, s71, 0
ds_read_b128 a[80:83], v9 offset:0
v_mfma_f32_16x16x32_bf16 v[176:179], a[172:175], a[92:95], v[176:179]
L_PAD6:
s_cbranch_execz L_PAD10
v_mul_u32_u24 v22, 1152, v22
v_and_b32 v23, 7, v1
v_mfma_f32_16x16x32_bf16 v[80:83], a[164:167], a[92:95], v[80:83]
buffer_load_dwordx4 v5, s[12:15], s64 offen lds
v_mfma_f32_16x16x32_bf16 v[80:83], a[160:163], a[88:91], v[80:83]
ds_read_b128 a[68:71], v4 offset:43008
v_lshl_add_u32 v22, v23, 4, v22
v_mfma_f32_16x16x32_bf16 v[184:187], a[160:163], a[96:99], v[184:187]
ds_read_b128 a[84:87], v10 offset:0
v_lshrrev_b32 v23, 2, v1
v_mfma_f32_16x16x32_bf16 v[184:187], a[164:167], a[100:103], v[184:187]
v_mul_u32_u24 v23, 96, v23
v_add_u32 v23, v23, v27
v_mfma_f32_16x16x32_bf16 v[248:251], a[172:175], a[100:103], v[248:251]
v_and_b32 v16, 3, v1
v_cmp_eq_u32 s[96:97], 0, v16
v_mfma_f32_16x16x32_bf16 v[248:251], a[168:171], a[96:99], v[248:251]
ds_read_b128 a[72:75], v4 offset:41984
v_mov_b32 v16, 0x3f803f80
v_mfma_f32_16x16x32_bf16 v[240:243], a[176:179], a[96:99], v[240:243]
buffer_load_dwordx4 v6, s[12:15], s64 offen offset:1024 lds
v_mfma_f32_16x16x32_bf16 v[240:243], a[180:183], a[100:103], v[240:243]
ds_read_b128 a[88:91], v9 offset:2048
v_cndmask_b32 v16, 0, v16, s[96:97]
v_mfma_f32_16x16x32_bf16 v[232:235], a[188:191], a[100:103], v[232:235]
v_accvgpr_write_b32 a240, v16
v_accvgpr_write_b32 a241, v16
v_mfma_f32_16x16x32_bf16 v[232:235], a[184:187], a[96:99], v[232:235]
ds_read_b128 a[76:79], v4 offset:44032
v_accvgpr_write_b32 a242, v16
v_mfma_f32_16x16x32_bf16 v[236:239], a[112:115], a[96:99], v[236:239]
s_add_u32 m0, s73, 2048
s_add_u32 s64, s71, 18432
v_accvgpr_write_b32 a243, v16
v_mfma_f32_16x16x32_bf16 v[236:239], a[116:119], a[100:103], v[236:239]
ds_read_b128 a[92:95], v10 offset:2048
v_accvgpr_write_b32 a232, 0
v_mfma_f32_16x16x32_bf16 v[224:227], a[124:127], a[100:103], v[224:227]
buffer_load_dwordx4 v5, s[12:15], s64 offen lds
v_mfma_f32_16x16x32_bf16 v[224:227], a[120:123], a[96:99], v[224:227]
v_accvgpr_write_b32 a233, 0
v_accvgpr_write_b32 a234, 0
v_mfma_f32_16x16x32_bf16 v[208:211], a[120:123], a[104:107], v[208:211]
v_accvgpr_write_b32 a235, 0
v_accvgpr_write_b32 a236, 0
v_mfma_f32_16x16x32_bf16 v[208:211], a[124:127], a[108:111], v[208:211]
s_add_u32 s53, s88, 786432
v_accvgpr_write_b32 a237, 0
v_accvgpr_write_b32 a238, 0
v_mfma_f32_16x16x32_bf16 v[216:219], a[116:119], a[108:111], v[216:219]
buffer_store_dwordx4 v[136:139], v15, s[24:27], s53 offen offset:1024 sc1
v_mfma_f32_16x16x32_bf16 v[216:219], a[112:115], a[104:107], v[216:219]
v_accvgpr_write_b32 a239, 0
v_lshlrev_b32 v16, 2, v3
v_mfma_f32_16x16x32_bf16 v[244:247], a[184:187], a[104:107], v[244:247]
buffer_load_dwordx4 v6, s[12:15], s64 offen offset:1024 lds
v_mfma_f32_16x16x32_bf16 v[244:247], a[188:191], a[108:111], v[244:247]
v_sub_u32 v16, v2, v16
v_cmp_gt_i32 s[56:57], 0, v16
v_mfma_f32_16x16x32_bf16 v[192:195], a[180:183], a[108:111], v[192:195]
v_cmp_gt_i32 s[58:59], 1, v16
v_cmp_gt_i32 s[60:61], 2, v16
v_mfma_f32_16x16x32_bf16 v[192:195], a[176:179], a[104:107], v[192:195]
v_cmp_gt_i32 s[62:63], 3, v16
v_cmp_eq_u32 s[96:97], 3, v3
v_mfma_f32_16x16x32_bf16 v[200:203], a[168:171], a[104:107], v[200:203]
v_add_u32 v17, 48, v2
v_lshlrev_b32 v17, 2, v17
v_mfma_f32_16x16x32_bf16 v[200:203], a[172:175], a[108:111], v[200:203]
v_lshlrev_b32 v18, 16, v3
v_lshl_add_u32 v18, v2, 4, v18
v_mfma_f32_16x16x32_bf16 v[88:91], a[164:167], a[108:111], v[88:91]
v_add_u32 v19, 0x8000, v18
v_cndmask_b32 v19, v19, v20, s[96:97]
v_mfma_f32_16x16x32_bf16 v[88:91], a[160:163], a[104:107], v[88:91]
s_waitcnt lgkmcnt(0)
v_cmp_eq_u32 s[96:97], 0, v3
v_mfma_f32_16x16x32_bf16 v[36:39], a[128:131], a[80:83], v[36:39]
s_waitcnt vmcnt(24)
v_mfma_f32_16x16x32_bf16 v[36:39], a[132:135], a[84:87], v[36:39]
s_barrier
v_mfma_f32_16x16x32_bf16 v[44:47], a[140:143], a[84:87], v[44:47]
ds_read_b128 a[96:99], v9 offset:4096
v_cndmask_b32 v18, v18, v20, s[96:97]
v_mfma_f32_16x16x32_bf16 v[44:47], a[136:139], a[80:83], v[44:47]
s_xor_b32 s75, s93, 6
s_lshl_b32 s76, s75, 19
s_add_u32 s76, s76, s74
v_mfma_f32_16x16x32_bf16 v[32:35], a[144:147], a[80:83], v[32:35]
s_lshl_b32 s79, s75, 13
s_add_u32 s79, s79, s78
ds_read_b128 a[100:103], v10 offset:4096
v_mfma_f32_16x16x32_bf16 v[32:35], a[148:151], a[84:87], v[32:35]
s_add_u32 m0, s77, 32768
s_add_u32 s64, s76, 0
ds_read_b128 a[104:107], v9 offset:6144
v_mfma_f32_16x16x32_bf16 v[52:55], a[156:159], a[84:87], v[52:55]
buffer_load_dwordx4 v7, s[20:23], s64 offen lds
v_mfma_f32_16x16x32_bf16 v[52:55], a[152:155], a[80:83], v[52:55]
ds_read_b64_tr_b16 a[160:161], v11 offset:49152
ds_read_b64_tr_b16 a[162:163], v11 offset:49664
v_mfma_f32_16x16x32_bf16 v[60:63], a[64:67], a[80:83], v[60:63]
v_cndmask_b32 v19, v19, v20, s[96:97]
v_mfma_f32_16x16x32_bf16 v[60:63], a[68:71], a[84:87], v[60:63]
ds_read_b128 a[108:111], v10 offset:6144
v_mfma_f32_16x16x32_bf16 v[68:71], a[76:79], a[84:87], v[68:71]
buffer_load_dwordx4 v8, s[20:23], s64 offen offset:1024 lds
v_mfma_f32_16x16x32_bf16 v[68:71], a[72:75], a[80:83], v[68:71]
ds_read_b64_tr_b16 a[164:165], v11 offset:53248
ds_read_b64_tr_b16 a[166:167], v11 offset:53760
v_mfma_f32_16x16x32_bf16 v[76:79], a[72:75], a[88:91], v[76:79]
v_add_u32 v9, 32768, v9
v_add_u32 v10, 32768, v10
v_mfma_f32_16x16x32_bf16 v[76:79], a[76:79], a[92:95], v[76:79]
ds_read_b64_tr_b16 a[168:169], v12 offset:49152
ds_read_b64_tr_b16 a[170:171], v12 offset:49664
v_mfma_f32_16x16x32_bf16 v[84:87], a[68:71], a[92:95], v[84:87]
s_add_u32 m0, s80, 32768
s_add_u32 s64, s79, 0
v_mfma_f32_16x16x32_bf16 v[84:87], a[64:67], a[88:91], v[84:87]
ds_read_b64_tr_b16 a[172:173], v12 offset:53248
ds_read_b64_tr_b16 a[174:175], v12 offset:53760
v_mfma_f32_16x16x32_bf16 v[92:95], a[152:155], a[88:91], v[92:95]
buffer_load_dwordx4 v15, s[24:27], s64 offen sc1 lds
v_mfma_f32_16x16x32_bf16 v[92:95], a[156:159], a[92:95], v[92:95]
s_add_u32 s53, s88, 786432
v_mfma_f32_16x16x32_bf16 v[40:43], a[148:151], a[92:95], v[40:43]
ds_read_b64_tr_b16 a[176:177], v13 offset:49152
ds_read_b64_tr_b16 a[178:179], v13 offset:49664
v_mfma_f32_16x16x32_bf16 v[40:43], a[144:147], a[88:91], v[40:43]
buffer_store_dwordx4 v[144:147], v15, s[24:27], s53 offen offset:2048 sc1
v_mfma_f32_16x16x32_bf16 v[100:103], a[136:139], a[88:91], v[100:103]
s_add_u32 m0, s73, 4096
s_add_u32 s64, s72, 0
v_mfma_f32_16x16x32_bf16 v[100:103], a[140:143], a[92:95], v[100:103]
ds_read_b64_tr_b16 a[180:181], v13 offset:53248
ds_read_b64_tr_b16 a[182:183], v13 offset:53760
v_mfma_f32_16x16x32_bf16 v[108:111], a[132:135], a[92:95], v[108:111]
buffer_load_dwordx4 v5, s[12:15], s64 offen lds
v_mfma_f32_16x16x32_bf16 v[108:111], a[128:131], a[88:91], v[108:111]
s_waitcnt lgkmcnt(14)
ds_read_b64_tr_b16 a[184:185], v14 offset:49152
ds_read_b64_tr_b16 a[186:187], v14 offset:49664
v_mfma_f32_16x16x32_bf16 v[116:119], a[128:131], a[96:99], v[116:119]
ds_read_b64_tr_b16 a[188:189], v14 offset:53248
ds_read_b64_tr_b16 a[190:191], v14 offset:53760
v_mfma_f32_16x16x32_bf16 v[116:119], a[132:135], a[100:103], v[116:119]
v_mfma_f32_16x16x32_bf16 v[124:127], a[140:143], a[100:103], v[124:127]
v_mfma_f32_16x16x32_bf16 v[124:127], a[136:139], a[96:99], v[124:127]
ds_read_b128 a[112:115], v4 offset:57344
v_mfma_f32_16x16x32_bf16 v[132:135], a[144:147], a[96:99], v[132:135]
buffer_load_dwordx4 v6, s[12:15], s64 offen offset:1024 lds
v_mfma_f32_16x16x32_bf16 v[132:135], a[148:151], a[100:103], v[132:135]
ds_read_b128 a[116:119], v4 offset:59392
v_mfma_f32_16x16x32_bf16 v[140:143], a[156:159], a[100:103], v[140:143]
v_mfma_f32_16x16x32_bf16 v[140:143], a[152:155], a[96:99], v[140:143]
ds_read_b128 a[120:123], v4 offset:58368
v_mfma_f32_16x16x32_bf16 v[148:151], a[64:67], a[96:99], v[148:151]
s_add_u32 m0, s73, 6144
s_add_u32 s64, s72, 18432
v_mfma_f32_16x16x32_bf16 v[148:151], a[68:71], a[100:103], v[148:151]
ds_read_b128 a[124:127], v4 offset:60416
v_mfma_f32_16x16x32_bf16 v[48:51], a[76:79], a[100:103], v[48:51]
buffer_load_dwordx4 v5, s[12:15], s64 offen lds
v_mfma_f32_16x16x32_bf16 v[48:51], a[72:75], a[96:99], v[48:51]
s_waitcnt lgkmcnt(15)
v_mfma_f32_16x16x32_bf16 v[156:159], a[72:75], a[104:107], v[156:159]
v_mfma_f32_16x16x32_bf16 v[156:159], a[76:79], a[108:111], v[156:159]
v_mfma_f32_16x16x32_bf16 v[164:167], a[68:71], a[108:111], v[164:167]
v_mfma_f32_16x16x32_bf16 v[164:167], a[64:67], a[104:107], v[164:167]
v_mfma_f32_16x16x32_bf16 v[172:175], a[152:155], a[104:107], v[172:175]
buffer_load_dwordx4 v6, s[12:15], s64 offen offset:1024 lds
v_mfma_f32_16x16x32_bf16 v[172:175], a[156:159], a[108:111], v[172:175]
v_mfma_f32_16x16x32_bf16 v[56:59], a[148:151], a[108:111], v[56:59]
v_mfma_f32_16x16x32_bf16 v[56:59], a[144:147], a[104:107], v[56:59]
s_add_u32 s53, s88, 786432
v_mfma_f32_16x16x32_bf16 v[180:183], a[136:139], a[104:107], v[180:183]
buffer_store_dwordx4 v[152:155], v15, s[24:27], s53 offen offset:3072 sc1
v_mfma_f32_16x16x32_bf16 v[180:183], a[140:143], a[108:111], v[180:183]
v_mfma_f32_16x16x32_bf16 v[188:191], a[132:135], a[108:111], v[188:191]
v_mfma_f32_16x16x32_bf16 v[188:191], a[128:131], a[104:107], v[188:191]
s_waitcnt lgkmcnt(0)
v_mov_b32 v96, 0
v_mov_b32 v97, 0
v_mfma_f32_16x16x32_bf16 v[196:199], a[160:163], a[80:83], v[196:199]
s_waitcnt vmcnt(19)
v_mov_b32 v98, 0
v_mov_b32 v99, 0
v_mfma_f32_16x16x32_bf16 v[196:199], a[164:167], a[84:87], v[196:199]
s_barrier
v_mfma_f32_16x16x32_bf16 v[64:67], a[172:175], a[84:87], v[64:67]
ds_read_b64_tr_b16 a[128:129], v11 offset:0
ds_read_b64_tr_b16 a[130:131], v11 offset:512
v_mfma_f32_16x16x32_bf16 v[64:67], a[168:171], a[80:83], v[64:67]
s_add_u32 m0, s77, 49152
s_add_u32 s64, s76, 128
v_mov_b32 v104, 0
v_mfma_f32_16x16x32_bf16 v[204:207], a[176:179], a[80:83], v[204:207]
buffer_load_dwordx4 v7, s[20:23], s64 offen lds
v_mfma_f32_16x16x32_bf16 v[204:207], a[180:183], a[84:87], v[204:207]
ds_read_b64_tr_b16 a[132:133], v11 offset:4096
ds_read_b64_tr_b16 a[134:135], v11 offset:4608
v_mfma_f32_16x16x32_bf16 v[212:215], a[188:191], a[84:87], v[212:215]
ds_read_b64_tr_b16 a[136:137], v12 offset:0
ds_read_b64_tr_b16 a[138:139], v12 offset:512
v_mfma_f32_16x16x32_bf16 v[212:215], a[184:187], a[80:83], v[212:215]
ds_read_b64_tr_b16 a[140:141], v12 offset:4096
ds_read_b64_tr_b16 a[142:143], v12 offset:4608
v_mfma_f32_16x16x32_bf16 v[72:75], a[112:115], a[80:83], v[72:75]
buffer_load_dword v30, v29, s[24:27], s89 offen offset:4 sc1
v_mfma_f32_16x16x32_bf16 v[72:75], a[116:119], a[84:87], v[72:75]
ds_read_b64_tr_b16 a[144:145], v13 offset:0
ds_read_b64_tr_b16 a[146:147], v13 offset:512
v_mfma_f32_16x16x32_bf16 v[220:223], a[124:127], a[84:87], v[220:223]
buffer_load_dwordx4 v8, s[20:23], s64 offen offset:1024 lds
v_mfma_f32_16x16x32_bf16 v[220:223], a[120:123], a[80:83], v[220:223]
ds_read_b64_tr_b16 a[148:149], v13 offset:4096
ds_read_b64_tr_b16 a[150:151], v13 offset:4608
v_mfma_f32_16x16x32_bf16 v[252:255], a[120:123], a[88:91], v[252:255]
v_mov_b32 v105, 0
v_mov_b32 v106, 0
v_mfma_f32_16x16x32_bf16 v[252:255], a[124:127], a[92:95], v[252:255]
ds_read_b64_tr_b16 a[152:153], v14 offset:0
ds_read_b64_tr_b16 a[154:155], v14 offset:512
v_mfma_f32_16x16x32_bf16 v[160:163], a[116:119], a[92:95], v[160:163]
s_add_u32 m0, s80, 49152
s_add_u32 s64, s79, 2048
v_mov_b32 v107, 0
v_mfma_f32_16x16x32_bf16 v[160:163], a[112:115], a[88:91], v[160:163]
ds_read_b64_tr_b16 a[156:157], v14 offset:4096
ds_read_b64_tr_b16 a[158:159], v14 offset:4608
v_mfma_f32_16x16x32_bf16 v[228:231], a[184:187], a[88:91], v[228:231]
buffer_load_dwordx4 v15, s[24:27], s64 offen sc1 lds
v_mfma_f32_16x16x32_bf16 v[228:231], a[188:191], a[92:95], v[228:231]
s_xor_b32 s65, s70, 896
s_add_u32 s71, s68, s65
s_add_u32 s72, s69, s65
v_mfma_f32_16x16x32_bf16 v[168:171], a[180:183], a[92:95], v[168:171]
ds_read_b128 a[64:67], v4 offset:8192
v_mov_b32 v112, 0
v_mfma_f32_16x16x32_bf16 v[168:171], a[176:179], a[88:91], v[168:171]
v_mov_b32 v113, 0
v_mov_b32 v114, 0
v_mfma_f32_16x16x32_bf16 v[176:179], a[168:171], a[88:91], v[176:179]
s_add_u32 m0, s73, 32768
s_add_u32 s64, s71, 0
ds_read_b128 a[80:83], v9 offset:0
v_mfma_f32_16x16x32_bf16 v[176:179], a[172:175], a[92:95], v[176:179]
v_mov_b32 v115, 0
v_mov_b32 v120, 0
v_mfma_f32_16x16x32_bf16 v[80:83], a[164:167], a[92:95], v[80:83]
buffer_load_dwordx4 v5, s[12:15], s64 offen lds
v_mfma_f32_16x16x32_bf16 v[80:83], a[160:163], a[88:91], v[80:83]
s_add_u32 s53, s87, 524288
ds_read_b128 a[68:71], v4 offset:10240
v_mov_b32 v121, 0
v_mfma_f32_16x16x32_bf16 v[184:187], a[160:163], a[96:99], v[184:187]
ds_read_b128 a[84:87], v10 offset:0
v_mov_b32 v122, 0
v_mfma_f32_16x16x32_bf16 v[184:187], a[164:167], a[100:103], v[184:187]
buffer_store_dwordx4 a[28:31], v15, s[24:27], s53 offen offset:0 sc1
v_mfma_f32_16x16x32_bf16 v[248:251], a[172:175], a[100:103], v[248:251]
v_mov_b32 v123, 0
v_mov_b32 v128, 0
v_mfma_f32_16x16x32_bf16 v[248:251], a[168:171], a[96:99], v[248:251]
ds_read_b128 a[72:75], v4 offset:9216
v_mov_b32 v129, 0
v_mfma_f32_16x16x32_bf16 v[240:243], a[176:179], a[96:99], v[240:243]
buffer_load_dwordx4 v6, s[12:15], s64 offen offset:1024 lds
v_mfma_f32_16x16x32_bf16 v[240:243], a[180:183], a[100:103], v[240:243]
ds_read_b128 a[88:91], v9 offset:2048
v_mov_b32 v130, 0
v_mfma_f32_16x16x32_bf16 v[232:235], a[188:191], a[100:103], v[232:235]
v_mov_b32 v131, 0
v_mov_b32 v136, 0
v_mfma_f32_16x16x32_bf16 v[232:235], a[184:187], a[96:99], v[232:235]
ds_read_b128 a[76:79], v4 offset:11264
v_mov_b32 v137, 0
v_mfma_f32_16x16x32_bf16 v[236:239], a[112:115], a[96:99], v[236:239]
s_add_u32 m0, s73, 34816
s_add_u32 s64, s71, 18432
v_mov_b32 v138, 0
v_mfma_f32_16x16x32_bf16 v[236:239], a[116:119], a[100:103], v[236:239]
ds_read_b128 a[92:95], v10 offset:2048
v_mov_b32 v139, 0
v_mfma_f32_16x16x32_bf16 v[224:227], a[124:127], a[100:103], v[224:227]
buffer_load_dwordx4 v5, s[12:15], s64 offen lds
v_mfma_f32_16x16x32_bf16 v[224:227], a[120:123], a[96:99], v[224:227]
v_mov_b32 v144, 0
v_mov_b32 v145, 0
v_mfma_f32_16x16x32_bf16 v[208:211], a[120:123], a[104:107], v[208:211]
v_mov_b32 v146, 0
v_mov_b32 v147, 0
v_mfma_f32_16x16x32_bf16 v[208:211], a[124:127], a[108:111], v[208:211]
v_mov_b32 v152, 0
v_mov_b32 v153, 0
v_mfma_f32_16x16x32_bf16 v[216:219], a[116:119], a[108:111], v[216:219]
v_mov_b32 v154, 0
v_mov_b32 v155, 0
v_mfma_f32_16x16x32_bf16 v[216:219], a[112:115], a[104:107], v[216:219]
v_mfma_f32_16x16x32_bf16 v[244:247], a[184:187], a[104:107], v[244:247]
buffer_load_dwordx4 v6, s[12:15], s64 offen offset:1024 lds
v_mfma_f32_16x16x32_bf16 v[244:247], a[188:191], a[108:111], v[244:247]
v_mfma_f32_16x16x32_bf16 v[192:195], a[180:183], a[108:111], v[192:195]
v_mfma_f32_16x16x32_bf16 v[192:195], a[176:179], a[104:107], v[192:195]
v_mfma_f32_16x16x32_bf16 v[200:203], a[168:171], a[104:107], v[200:203]
v_mfma_f32_16x16x32_bf16 v[200:203], a[172:175], a[108:111], v[200:203]
v_mfma_f32_16x16x32_bf16 v[88:91], a[164:167], a[108:111], v[88:91]
v_mfma_f32_16x16x32_bf16 v[88:91], a[160:163], a[104:107], v[88:91]
s_waitcnt lgkmcnt(0)
v_mfma_f32_16x16x32_bf16 v[36:39], a[128:131], a[80:83], v[36:39]
s_waitcnt vmcnt(23)
v_mfma_f32_16x16x32_bf16 v[36:39], a[132:135], a[84:87], v[36:39]
s_barrier
v_mfma_f32_16x16x32_bf16 v[44:47], a[140:143], a[84:87], v[44:47]
s_add_u32 s53, s87, 524288
ds_read_b128 a[96:99], v9 offset:4096
v_mfma_f32_16x16x32_bf16 v[44:47], a[136:139], a[80:83], v[44:47]
s_xor_b32 s75, s93, 7
s_lshl_b32 s76, s75, 19
s_add_u32 s76, s76, s74
v_mfma_f32_16x16x32_bf16 v[32:35], a[144:147], a[80:83], v[32:35]
s_lshl_b32 s79, s75, 13
s_add_u32 s79, s79, s78
ds_read_b128 a[100:103], v10 offset:4096
v_mfma_f32_16x16x32_bf16 v[32:35], a[148:151], a[84:87], v[32:35]
s_add_u32 m0, s77, 0
s_add_u32 s64, s76, 0
ds_read_b128 a[104:107], v9 offset:6144
v_mfma_f32_16x16x32_bf16 v[52:55], a[156:159], a[84:87], v[52:55]
buffer_load_dwordx4 v7, s[20:23], s64 offen lds
v_mfma_f32_16x16x32_bf16 v[52:55], a[152:155], a[80:83], v[52:55]
ds_read_b64_tr_b16 a[160:161], v11 offset:16384
ds_read_b64_tr_b16 a[162:163], v11 offset:16896
v_mfma_f32_16x16x32_bf16 v[60:63], a[64:67], a[80:83], v[60:63]
buffer_store_dwordx4 a[20:23], v15, s[24:27], s53 offen offset:1024 sc1
v_mfma_f32_16x16x32_bf16 v[60:63], a[68:71], a[84:87], v[60:63]
ds_read_b128 a[108:111], v10 offset:6144
v_mfma_f32_16x16x32_bf16 v[68:71], a[76:79], a[84:87], v[68:71]
buffer_load_dwordx4 v8, s[20:23], s64 offen offset:1024 lds
v_mfma_f32_16x16x32_bf16 v[68:71], a[72:75], a[80:83], v[68:71]
ds_read_b64_tr_b16 a[164:165], v11 offset:20480
ds_read_b64_tr_b16 a[166:167], v11 offset:20992
v_mfma_f32_16x16x32_bf16 v[76:79], a[72:75], a[88:91], v[76:79]
v_add_u32 v9, -65536, v9
v_add_u32 v10, -65536, v10
v_mfma_f32_16x16x32_bf16 v[76:79], a[76:79], a[92:95], v[76:79]
ds_read_b64_tr_b16 a[168:169], v12 offset:16384
ds_read_b64_tr_b16 a[170:171], v12 offset:16896
v_mfma_f32_16x16x32_bf16 v[84:87], a[68:71], a[92:95], v[84:87]
s_add_u32 m0, s80, 0
s_add_u32 s64, s79, 0
v_mfma_f32_16x16x32_bf16 v[84:87], a[64:67], a[88:91], v[84:87]
ds_read_b64_tr_b16 a[172:173], v12 offset:20480
ds_read_b64_tr_b16 a[174:175], v12 offset:20992
v_mfma_f32_16x16x32_bf16 v[92:95], a[152:155], a[88:91], v[92:95]
buffer_load_dwordx4 v15, s[24:27], s64 offen sc1 lds
v_mfma_f32_16x16x32_bf16 v[92:95], a[156:159], a[92:95], v[92:95]
v_mfma_f32_16x16x32_bf16 v[40:43], a[148:151], a[92:95], v[40:43]
ds_read_b64_tr_b16 a[176:177], v13 offset:16384
ds_read_b64_tr_b16 a[178:179], v13 offset:16896
v_mfma_f32_16x16x32_bf16 v[40:43], a[144:147], a[88:91], v[40:43]
v_mfma_f32_16x16x32_bf16 v[100:103], a[136:139], a[88:91], v[100:103]
s_add_u32 m0, s73, 36864
s_add_u32 s64, s72, 0
v_mfma_f32_16x16x32_bf16 v[100:103], a[140:143], a[92:95], v[100:103]
ds_read_b64_tr_b16 a[180:181], v13 offset:20480
ds_read_b64_tr_b16 a[182:183], v13 offset:20992
v_mfma_f32_16x16x32_bf16 v[108:111], a[132:135], a[92:95], v[108:111]
buffer_load_dwordx4 v5, s[12:15], s64 offen lds
v_mfma_f32_16x16x32_bf16 v[108:111], a[128:131], a[88:91], v[108:111]
s_waitcnt lgkmcnt(14)
ds_read_b64_tr_b16 a[184:185], v14 offset:16384
ds_read_b64_tr_b16 a[186:187], v14 offset:16896
v_mfma_f32_16x16x32_bf16 v[116:119], a[128:131], a[96:99], v[116:119]
ds_read_b64_tr_b16 a[188:189], v14 offset:20480
ds_read_b64_tr_b16 a[190:191], v14 offset:20992
v_mfma_f32_16x16x32_bf16 v[116:119], a[132:135], a[100:103], v[116:119]
v_mfma_f32_16x16x32_bf16 v[124:127], a[140:143], a[100:103], v[124:127]
v_mfma_f32_16x16x32_bf16 v[124:127], a[136:139], a[96:99], v[124:127]
ds_read_b128 a[112:115], v4 offset:24576
v_mfma_f32_16x16x32_bf16 v[132:135], a[144:147], a[96:99], v[132:135]
buffer_load_dwordx4 v6, s[12:15], s64 offen offset:1024 lds
v_mfma_f32_16x16x32_bf16 v[132:135], a[148:151], a[100:103], v[132:135]
s_add_u32 s53, s87, 528384
ds_read_b128 a[116:119], v4 offset:26624
v_mfma_f32_16x16x32_bf16 v[140:143], a[156:159], a[100:103], v[140:143]
buffer_store_dwordx4 a[12:15], v15, s[24:27], s53 offen offset:0 sc1
v_mfma_f32_16x16x32_bf16 v[140:143], a[152:155], a[96:99], v[140:143]
ds_read_b128 a[120:123], v4 offset:25600
v_mfma_f32_16x16x32_bf16 v[148:151], a[64:67], a[96:99], v[148:151]
s_add_u32 m0, s73, 38912
s_add_u32 s64, s72, 18432
v_mfma_f32_16x16x32_bf16 v[148:151], a[68:71], a[100:103], v[148:151]
ds_read_b128 a[124:127], v4 offset:27648
v_mfma_f32_16x16x32_bf16 v[48:51], a[76:79], a[100:103], v[48:51]
buffer_load_dwordx4 v5, s[12:15], s64 offen lds
v_mfma_f32_16x16x32_bf16 v[48:51], a[72:75], a[96:99], v[48:51]
s_waitcnt lgkmcnt(15)
v_mfma_f32_16x16x32_bf16 v[156:159], a[72:75], a[104:107], v[156:159]
v_mfma_f32_16x16x32_bf16 v[156:159], a[76:79], a[108:111], v[156:159]
v_mfma_f32_16x16x32_bf16 v[164:167], a[68:71], a[108:111], v[164:167]
v_mfma_f32_16x16x32_bf16 v[164:167], a[64:67], a[104:107], v[164:167]
v_mfma_f32_16x16x32_bf16 v[172:175], a[152:155], a[104:107], v[172:175]
buffer_load_dwordx4 v6, s[12:15], s64 offen offset:1024 lds
v_mfma_f32_16x16x32_bf16 v[172:175], a[156:159], a[108:111], v[172:175]
v_mfma_f32_16x16x32_bf16 v[56:59], a[148:151], a[108:111], v[56:59]
v_mfma_f32_16x16x32_bf16 v[56:59], a[144:147], a[104:107], v[56:59]
v_mfma_f32_16x16x32_bf16 v[180:183], a[136:139], a[104:107], v[180:183]
v_mfma_f32_16x16x32_bf16 v[180:183], a[140:143], a[108:111], v[180:183]
v_mfma_f32_16x16x32_bf16 v[188:191], a[132:135], a[108:111], v[188:191]
v_mfma_f32_16x16x32_bf16 v[188:191], a[128:131], a[104:107], v[188:191]
s_waitcnt lgkmcnt(0)
v_mfma_f32_16x16x32_bf16 v[196:199], a[160:163], a[80:83], v[196:199]
s_waitcnt vmcnt(19)
v_mfma_f32_16x16x32_bf16 v[196:199], a[164:167], a[84:87], v[196:199]
s_barrier
v_mfma_f32_16x16x32_bf16 v[64:67], a[172:175], a[84:87], v[64:67]
ds_read_b64_tr_b16 a[128:129], v11 offset:32768
ds_read_b64_tr_b16 a[130:131], v11 offset:33280
v_mfma_f32_16x16x32_bf16 v[64:67], a[168:171], a[80:83], v[64:67]
s_add_u32 m0, s77, 16384
s_add_u32 s64, s76, 128
v_mfma_f32_16x16x32_bf16 v[204:207], a[176:179], a[80:83], v[204:207]
buffer_load_dwordx4 v7, s[20:23], s64 offen lds
v_mfma_f32_16x16x32_bf16 v[204:207], a[180:183], a[84:87], v[204:207]
ds_read_b64_tr_b16 a[132:133], v11 offset:36864
ds_read_b64_tr_b16 a[134:135], v11 offset:37376
v_mfma_f32_16x16x32_bf16 v[212:215], a[188:191], a[84:87], v[212:215]
ds_read_b64_tr_b16 a[136:137], v12 offset:32768
ds_read_b64_tr_b16 a[138:139], v12 offset:33280
v_mfma_f32_16x16x32_bf16 v[212:215], a[184:187], a[80:83], v[212:215]
s_add_u32 s53, s87, 528384
ds_read_b64_tr_b16 a[140:141], v12 offset:36864
ds_read_b64_tr_b16 a[142:143], v12 offset:37376
v_mfma_f32_16x16x32_bf16 v[72:75], a[112:115], a[80:83], v[72:75]
buffer_load_dwordx4 v8, s[20:23], s64 offen offset:1024 lds
v_mfma_f32_16x16x32_bf16 v[72:75], a[116:119], a[84:87], v[72:75]
ds_read_b64_tr_b16 a[144:145], v13 offset:32768
ds_read_b64_tr_b16 a[146:147], v13 offset:33280
v_mfma_f32_16x16x32_bf16 v[220:223], a[124:127], a[84:87], v[220:223]
buffer_store_dwordx4 a[4:7], v15, s[24:27], s53 offen offset:1024 sc1
v_mfma_f32_16x16x32_bf16 v[220:223], a[120:123], a[80:83], v[220:223]
s_add_u32 m0, s80, 16384
s_add_u32 s64, s79, 2048
v_mfma_f32_16x16x32_bf16 v[252:255], a[120:123], a[88:91], v[252:255]
ds_read_b64_tr_b16 a[148:149], v13 offset:36864
ds_read_b64_tr_b16 a[150:151], v13 offset:37376
v_mfma_f32_16x16x32_bf16 v[252:255], a[124:127], a[92:95], v[252:255]
buffer_load_dwordx4 v15, s[24:27], s64 offen sc1 lds
v_mfma_f32_16x16x32_bf16 v[160:163], a[116:119], a[92:95], v[160:163]
ds_read_b64_tr_b16 a[152:153], v14 offset:32768
ds_read_b64_tr_b16 a[154:155], v14 offset:33280
v_mfma_f32_16x16x32_bf16 v[160:163], a[112:115], a[88:91], v[160:163]
ds_read_b64_tr_b16 a[156:157], v14 offset:36864
ds_read_b64_tr_b16 a[158:159], v14 offset:37376
v_mfma_f32_16x16x32_bf16 v[228:231], a[184:187], a[88:91], v[228:231]
s_add_u32 m0, s83, 0
s_add_u32 s64, s81, 0
v_mfma_f32_16x16x32_bf16 v[228:231], a[188:191], a[92:95], v[228:231]
v_mfma_f32_16x16x32_bf16 v[168:171], a[180:183], a[92:95], v[168:171]
buffer_load_dwordx4 v22, s[32:35], s64 offen lds
v_mfma_f32_16x16x32_bf16 v[168:171], a[176:179], a[88:91], v[168:171]
ds_read_b128 a[64:67], v4 offset:40960
v_mfma_f32_16x16x32_bf16 v[176:179], a[168:171], a[88:91], v[176:179]
s_add_u32 m0, s83, 1024
s_add_u32 s64, s81, 9216
ds_read_b128 a[80:83], v9 offset:0
v_mfma_f32_16x16x32_bf16 v[176:179], a[172:175], a[92:95], v[176:179]
v_mfma_f32_16x16x32_bf16 v[80:83], a[164:167], a[92:95], v[80:83]
buffer_load_dwordx4 v22, s[32:35], s64 offen lds
v_mfma_f32_16x16x32_bf16 v[80:83], a[160:163], a[88:91], v[80:83]
ds_read_b128 a[68:71], v4 offset:43008
v_mfma_f32_16x16x32_bf16 v[184:187], a[160:163], a[96:99], v[184:187]
ds_read_b128 a[84:87], v10 offset:0
v_mfma_f32_16x16x32_bf16 v[184:187], a[164:167], a[100:103], v[184:187]
s_add_u32 m0, s83, 2048
s_add_u32 s64, s81, 18432
v_mfma_f32_16x16x32_bf16 v[248:251], a[172:175], a[100:103], v[248:251]
v_mfma_f32_16x16x32_bf16 v[248:251], a[168:171], a[96:99], v[248:251]
buffer_load_dwordx4 v22, s[32:35], s64 offen lds
v_mfma_f32_16x16x32_bf16 v[240:243], a[176:179], a[96:99], v[240:243]
ds_read_b128 a[72:75], v4 offset:41984
v_mfma_f32_16x16x32_bf16 v[240:243], a[180:183], a[100:103], v[240:243]
ds_read_b128 a[88:91], v9 offset:2048
v_mfma_f32_16x16x32_bf16 v[232:235], a[188:191], a[100:103], v[232:235]
s_add_u32 m0, s83, 3072
s_add_u32 s64, s81, 27648
v_mfma_f32_16x16x32_bf16 v[232:235], a[184:187], a[96:99], v[232:235]
ds_read_b128 a[76:79], v4 offset:44032
v_mfma_f32_16x16x32_bf16 v[236:239], a[112:115], a[96:99], v[236:239]
buffer_load_dwordx4 v22, s[32:35], s64 offen lds
v_mfma_f32_16x16x32_bf16 v[236:239], a[116:119], a[100:103], v[236:239]
ds_read_b128 a[92:95], v10 offset:2048
v_mfma_f32_16x16x32_bf16 v[224:227], a[124:127], a[100:103], v[224:227]
s_add_u32 m0, s83, 4096
s_add_u32 s64, s81, 128
s_add_u32 s53, s87, 786432
v_mfma_f32_16x16x32_bf16 v[224:227], a[120:123], a[96:99], v[224:227]
buffer_store_dwordx4 a[0:3], v15, s[24:27], s53 offen offset:0 sc1
v_mfma_f32_16x16x32_bf16 v[208:211], a[120:123], a[104:107], v[208:211]
buffer_load_dwordx4 v24, s[32:35], s64 offen lds
v_mfma_f32_16x16x32_bf16 v[208:211], a[124:127], a[108:111], v[208:211]
s_waitcnt vmcnt(26)
v_mfma_f32_16x16x32_bf16 v[216:219], a[116:119], a[108:111], v[216:219]
v_cmp_gt_u32 vcc, 8, v30
v_mfma_f32_16x16x32_bf16 v[216:219], a[112:115], a[104:107], v[216:219]
s_add_u32 m0, s83, 5120
s_add_u32 s64, s82, 0
v_mfma_f32_16x16x32_bf16 v[244:247], a[184:187], a[104:107], v[244:247]
v_mfma_f32_16x16x32_bf16 v[244:247], a[188:191], a[108:111], v[244:247]
buffer_load_dwordx4 v25, s[48:51], s64 offen lds
v_mfma_f32_16x16x32_bf16 v[192:195], a[180:183], a[108:111], v[192:195]
v_mfma_f32_16x16x32_bf16 v[192:195], a[176:179], a[104:107], v[192:195]
s_cbranch_vccnz CK_KV
CK_KV_R:
v_mfma_f32_16x16x32_bf16 v[200:203], a[168:171], a[104:107], v[200:203]
v_mfma_f32_16x16x32_bf16 v[200:203], a[172:175], a[108:111], v[200:203]
v_mfma_f32_16x16x32_bf16 v[88:91], a[164:167], a[108:111], v[88:91]
v_mfma_f32_16x16x32_bf16 v[88:91], a[160:163], a[104:107], v[88:91]
s_waitcnt lgkmcnt(0)
v_mfma_f32_16x16x32_bf16 v[36:39], a[128:131], a[80:83], v[36:39]
s_waitcnt vmcnt(25)
v_mov_b32 v6, 0xf149f2ca
v_mfma_f32_16x16x32_bf16 v[36:39], a[132:135], a[84:87], v[36:39]
s_barrier
v_mfma_f32_16x16x32_bf16 v[44:47], a[140:143], a[84:87], v[44:47]
ds_read_b128 a[96:99], v9 offset:4096
v_mfma_f32_16x16x32_bf16 v[44:47], a[136:139], a[80:83], v[44:47]
s_lshl_b32 s70, s3, 12
s_add_u32 s68, s70, s94
ds_read_b128 a[100:103], v10 offset:4096
v_mfma_f32_16x16x32_bf16 v[32:35], a[144:147], a[80:83], v[32:35]
s_add_u32 m0, s70, 32768
s_cmp_lt_u32 s3, 2
s_cselect_b32 s64, s68, 2147418112
v_mfma_f32_16x16x32_bf16 v[32:35], a[148:151], a[84:87], v[32:35]
buffer_load_dwordx4 v15, s[24:27], s64 offen offset:0 sc1 lds
v_mfma_f32_16x16x32_bf16 v[52:55], a[156:159], a[84:87], v[52:55]
ds_read_b128 a[104:107], v9 offset:6144
v_mfma_f32_16x16x32_bf16 v[52:55], a[152:155], a[80:83], v[52:55]
ds_read_b64_tr_b16 a[160:161], v11 offset:49152
ds_read_b64_tr_b16 a[162:163], v11 offset:49664
v_mfma_f32_16x16x32_bf16 v[60:63], a[64:67], a[80:83], v[60:63]
s_cmp_eq_u32 s66, 0
s_cbranch_scc1 D0
D0_R:
v_mfma_f32_16x16x32_bf16 v[60:63], a[68:71], a[84:87], v[60:63]
s_lshl_b32 s52, s4, 18
s_add_u32 s52, s52, 45088768
ds_read_b128 a[108:111], v10 offset:6144
v_mfma_f32_16x16x32_bf16 v[68:71], a[76:79], a[84:87], v[68:71]
s_lshl_b32 s54, s66, 9
v_add_u32 v9, 32768, v9
v_add_u32 v10, 32768, v10
v_mfma_f32_16x16x32_bf16 v[68:71], a[72:75], a[80:83], v[68:71]
s_add_u32 s54, s54, s52
ds_read_b64_tr_b16 a[164:165], v11 offset:53248
ds_read_b64_tr_b16 a[166:167], v11 offset:53760
v_mfma_f32_16x16x32_bf16 v[76:79], a[72:75], a[88:91], v[76:79]
s_lshl_b32 s55, s67, 9
s_add_u32 s55, s55, s52
v_mfma_f32_16x16x32_bf16 v[76:79], a[76:79], a[92:95], v[76:79]
s_add_u32 s53, s87, 786432
ds_read_b64_tr_b16 a[168:169], v12 offset:49152
L_PAD7:
s_cbranch_execz L_PAD11
ds_read_b64_tr_b16 a[170:171], v12 offset:49664
v_mfma_f32_16x16x32_bf16 v[84:87], a[68:71], a[92:95], v[84:87]
buffer_load_dwordx4 v15, s[24:27], s64 offen offset:1024 sc1 lds
v_mfma_f32_16x16x32_bf16 v[84:87], a[64:67], a[88:91], v[84:87]
s_max_u32 s65, s66, 1
ds_read_b64_tr_b16 a[172:173], v12 offset:53248
ds_read_b64_tr_b16 a[174:175], v12 offset:53760
v_mfma_f32_16x16x32_bf16 v[92:95], a[152:155], a[88:91], v[92:95]
buffer_store_dwordx4 a[8:11], v15, s[24:27], s53 offen offset:1024 sc1
v_mfma_f32_16x16x32_bf16 v[92:95], a[156:159], a[92:95], v[92:95]
s_lshl_b32 s65, s65, 9
s_add_u32 s52, s52, s65
s_sub_u32 s65, s55, s52
v_mfma_f32_16x16x32_bf16 v[40:43], a[148:151], a[92:95], v[40:43]
s_sub_u32 s65, s65, 163840
ds_read_b64_tr_b16 a[176:177], v13 offset:49152
ds_read_b64_tr_b16 a[178:179], v13 offset:49664
v_mfma_f32_16x16x32_bf16 v[40:43], a[144:147], a[88:91], v[40:43]
s_add_u32 s52, s52, 65280
v_mfma_f32_16x16x32_bf16 v[100:103], a[136:139], a[88:91], v[100:103]
ds_read_b64_tr_b16 a[180:181], v13 offset:53248
ds_read_b64_tr_b16 a[182:183], v13 offset:53760
v_mfma_f32_16x16x32_bf16 v[100:103], a[140:143], a[92:95], v[100:103]
v_cmp_lt_u32 s[96:97], 0, v3
v_lshlrev_b32 v16, 15, v3
v_mfma_f32_16x16x32_bf16 v[108:111], a[132:135], a[92:95], v[108:111]
ds_read_b64_tr_b16 a[184:185], v14 offset:49152
ds_read_b64_tr_b16 a[186:187], v14 offset:49664
v_mfma_f32_16x16x32_bf16 v[108:111], a[128:131], a[88:91], v[108:111]
s_waitcnt lgkmcnt(15)
v_lshl_add_u32 v16, v2, 4, v16
v_add_u32 v16, s52, v16
v_mfma_f32_16x16x32_bf16 v[116:119], a[128:131], a[96:99], v[116:119]
ds_read_b64_tr_b16 a[188:189], v14 offset:53248
ds_read_b64_tr_b16 a[190:191], v14 offset:53760
v_mfma_f32_16x16x32_bf16 v[116:119], a[132:135], a[100:103], v[116:119]
buffer_load_dwordx4 v15, s[24:27], s64 offen offset:2048 sc1 lds
v_mfma_f32_16x16x32_bf16 v[124:127], a[140:143], a[100:103], v[124:127]
v_accvgpr_write_b32 a244, v16
v_add_u32 v16, 131072, v16
v_mfma_f32_16x16x32_bf16 v[124:127], a[136:139], a[96:99], v[124:127]
ds_read_b128 a[112:115], v4 offset:57344
v_add_u32 v21, s65, v16
v_mfma_f32_16x16x32_bf16 v[132:135], a[144:147], a[96:99], v[132:135]
v_cndmask_b32 v16, v16, v21, s[96:97]
v_accvgpr_write_b32 a248, v16
v_mfma_f32_16x16x32_bf16 v[132:135], a[148:151], a[100:103], v[132:135]
ds_read_b128 a[116:119], v4 offset:59392
v_cmp_lt_u32 s[96:97], 1, v3
v_mfma_f32_16x16x32_bf16 v[140:143], a[156:159], a[100:103], v[140:143]
v_add_u32 v21, 131072, v21
v_mfma_f32_16x16x32_bf16 v[140:143], a[152:155], a[96:99], v[140:143]
ds_read_b128 a[120:123], v4 offset:58368
v_cndmask_b32 v21, v21, v20, s[96:97]
v_mfma_f32_16x16x32_bf16 v[148:151], a[64:67], a[96:99], v[148:151]
v_accvgpr_write_b32 a252, v21
v_mfma_f32_16x16x32_bf16 v[148:151], a[68:71], a[100:103], v[148:151]
s_lshr_b32 s52, s4, 3
s_mul_i32 s52, s52, 75776
ds_read_b128 a[124:127], v4 offset:60416
v_mfma_f32_16x16x32_bf16 v[48:51], a[76:79], a[100:103], v[48:51]
s_waitcnt lgkmcnt(15)
s_add_u32 s52, s52, 54525952
s_and_b32 s65, s4, 7
v_mfma_f32_16x16x32_bf16 v[48:51], a[72:75], a[96:99], v[48:51]
buffer_load_dwordx4 v15, s[24:27], s64 offen offset:3072 sc1 lds
v_mfma_f32_16x16x32_bf16 v[156:159], a[72:75], a[104:107], v[156:159]
s_mul_i32 s65, s65, 8192
s_add_u32 s52, s52, s65
s_mul_i32 s78, s66, 303104
v_mfma_f32_16x16x32_bf16 v[156:159], a[76:79], a[108:111], v[156:159]
s_add_u32 s78, s78, s52
s_mul_i32 s79, s67, 303104
s_add_u32 s79, s79, s52
v_mfma_f32_16x16x32_bf16 v[164:167], a[68:71], a[108:111], v[164:167]
s_cmp_lt_u32 s4, 16
s_cselect_b32 s90, s66, s67
s_and_b32 s52, s4, 15
v_mfma_f32_16x16x32_bf16 v[164:167], a[64:67], a[104:107], v[164:167]
s_lshl4_add_u32 s90, s90, s52
s_mul_i32 s90, s90, 2304
s_mov_b32 s76, 0
v_mfma_f32_16x16x32_bf16 v[172:175], a[152:155], a[104:107], v[172:175]
s_add_u32 s53, s87, 790528
v_mov_b32 v7, 0x5d800000
v_and_b32 v28, 31, v1
v_mfma_f32_16x16x32_bf16 v[172:175], a[156:159], a[108:111], v[172:175]
buffer_store_dwordx4 a[16:19], v15, s[24:27], s53 offen offset:0 sc1
v_mfma_f32_16x16x32_bf16 v[56:59], a[148:151], a[108:111], v[56:59]
v_lshlrev_b32 v28, 10, v28
v_add_u32 v28, 75497992, v28
v_mfma_f32_16x16x32_bf16 v[56:59], a[144:147], a[104:107], v[56:59]
v_lshlrev_b32 v31, 2, v1
v_mfma_f32_16x16x32_bf16 v[180:183], a[136:139], a[104:107], v[180:183]
v_mfma_f32_16x16x32_bf16 v[180:183], a[140:143], a[108:111], v[180:183]
v_mfma_f32_16x16x32_bf16 v[188:191], a[132:135], a[108:111], v[188:191]
v_mfma_f32_16x16x32_bf16 v[188:191], a[128:131], a[104:107], v[188:191]
s_waitcnt lgkmcnt(0)
v_mfma_f32_16x16x32_bf16 v[196:199], a[160:163], a[80:83], v[196:199]
s_waitcnt vmcnt(17)
v_mfma_f32_16x16x32_bf16 v[196:199], a[164:167], a[84:87], v[196:199]
s_barrier
v_mfma_f32_16x16x32_bf16 v[64:67], a[172:175], a[84:87], v[64:67]
ds_read_b64_tr_b16 a[128:129], v11 offset:0
ds_read_b64_tr_b16 a[130:131], v11 offset:512
v_mfma_f32_16x16x32_bf16 v[64:67], a[168:171], a[80:83], v[64:67]
s_add_u32 m0, s70, 49152
s_add_u32 s64, s68, 16384
s_waitcnt vmcnt(6)
v_mfma_f32_16x16x32_bf16 v[204:207], a[176:179], a[80:83], v[204:207]
buffer_load_dwordx4 v15, s[24:27], s64 offen offset:0 sc1 lds
v_mfma_f32_16x16x32_bf16 v[204:207], a[180:183], a[84:87], v[204:207]
ds_read_b64_tr_b16 a[132:133], v11 offset:4096
ds_read_b64_tr_b16 a[134:135], v11 offset:4608
v_mfma_f32_16x16x32_bf16 v[212:215], a[188:191], a[84:87], v[212:215]
ds_read_b64_tr_b16 a[136:137], v12 offset:0
ds_read_b64_tr_b16 a[138:139], v12 offset:512
v_mfma_f32_16x16x32_bf16 v[212:215], a[184:187], a[80:83], v[212:215]
ds_read_b64_tr_b16 a[140:141], v12 offset:4096
ds_read_b64_tr_b16 a[142:143], v12 offset:4608
v_mfma_f32_16x16x32_bf16 v[72:75], a[112:115], a[80:83], v[72:75]
ds_read_b64_tr_b16 a[192:193], v23 offset:0
ds_read_b64_tr_b16 a[194:195], v23 offset:2048
v_mfma_f32_16x16x32_bf16 v[72:75], a[116:119], a[84:87], v[72:75]
ds_read_b64_tr_b16 a[144:145], v13 offset:0
ds_read_b64_tr_b16 a[146:147], v13 offset:512
v_mfma_f32_16x16x32_bf16 v[220:223], a[124:127], a[84:87], v[220:223]
ds_read_b64_tr_b16 a[196:197], v23 offset:32
ds_read_b64_tr_b16 a[198:199], v23 offset:2080
v_mfma_f32_16x16x32_bf16 v[220:223], a[120:123], a[80:83], v[220:223]
ds_read_b64_tr_b16 a[148:149], v13 offset:4096
ds_read_b64_tr_b16 a[150:151], v13 offset:4608
v_mfma_f32_16x16x32_bf16 v[252:255], a[120:123], a[88:91], v[252:255]
ds_read_b64_tr_b16 a[200:201], v23 offset:64
ds_read_b64_tr_b16 a[202:203], v23 offset:2112
v_mfma_f32_16x16x32_bf16 v[252:255], a[124:127], a[92:95], v[252:255]
ds_read_b64_tr_b16 a[152:153], v14 offset:0
ds_read_b64_tr_b16 a[154:155], v14 offset:512
v_mfma_f32_16x16x32_bf16 v[160:163], a[116:119], a[92:95], v[160:163]
buffer_load_dwordx4 v15, s[24:27], s64 offen offset:1024 sc1 lds
v_mfma_f32_16x16x32_bf16 v[160:163], a[112:115], a[88:91], v[160:163]
ds_read_b64_tr_b16 a[156:157], v14 offset:4096
ds_read_b64_tr_b16 a[158:159], v14 offset:4608
v_mfma_f32_16x16x32_bf16 v[228:231], a[184:187], a[88:91], v[228:231]
ds_read_b64_tr_b16 a[204:205], v23 offset:96
ds_read_b64_tr_b16 a[206:207], v23 offset:2144
v_mfma_f32_16x16x32_bf16 v[228:231], a[188:191], a[92:95], v[228:231]
ds_read_b64_tr_b16 a[208:209], v27 offset:4096
ds_read_b64_tr_b16 a[210:211], v27 offset:4608
v_mfma_f32_16x16x32_bf16 v[168:171], a[180:183], a[92:95], v[168:171]
ds_read_b128 a[64:67], v4 offset:8192
v_mfma_f32_16x16x32_bf16 v[168:171], a[176:179], a[88:91], v[168:171]
s_add_u32 s53, s87, 790528
ds_read_b64_tr_b16 a[212:213], v27 offset:5120
ds_read_b64_tr_b16 a[214:215], v27 offset:5632
v_mfma_f32_16x16x32_bf16 v[176:179], a[168:171], a[88:91], v[176:179]
ds_read_b128 a[80:83], v9 offset:0
v_readlane_b32 s81, v26, 0
v_mfma_f32_16x16x32_bf16 v[176:179], a[172:175], a[92:95], v[176:179]
buffer_store_dwordx4 a[24:27], v15, s[24:27], s53 offen offset:1024 sc1
v_mfma_f32_16x16x32_bf16 v[80:83], a[164:167], a[92:95], v[80:83]
ds_read_b128 a[68:71], v4 offset:10240
v_readlane_b32 s82, v26, 1
v_mfma_f32_16x16x32_bf16 v[80:83], a[160:163], a[88:91], v[80:83]
v_readlane_b32 s71, v26, 2
v_readlane_b32 s72, v26, 3
v_mfma_f32_16x16x32_bf16 v[184:187], a[160:163], a[96:99], v[184:187]
ds_read_b128 a[84:87], v10 offset:0
v_readlane_b32 s74, v26, 4
v_mfma_f32_16x16x32_bf16 v[184:187], a[164:167], a[100:103], v[184:187]
buffer_load_dwordx4 v15, s[24:27], s64 offen offset:2048 sc1 lds
v_mfma_f32_16x16x32_bf16 v[248:251], a[172:175], a[100:103], v[248:251]
v_readlane_b32 s75, v26, 5
v_mfma_f32_16x16x32_bf16 v[248:251], a[168:171], a[96:99], v[248:251]
ds_read_b128 a[72:75], v4 offset:9216
v_mfma_f32_16x16x32_bf16 v[240:243], a[176:179], a[96:99], v[240:243]
v_mfma_f32_16x16x32_bf16 v[240:243], a[180:183], a[100:103], v[240:243]
ds_read_b128 a[88:91], v9 offset:2048
v_mfma_f32_16x16x32_bf16 v[232:235], a[188:191], a[100:103], v[232:235]
v_mfma_f32_16x16x32_bf16 v[232:235], a[184:187], a[96:99], v[232:235]
ds_read_b128 a[76:79], v4 offset:11264
v_mfma_f32_16x16x32_bf16 v[236:239], a[112:115], a[96:99], v[236:239]
v_mfma_f32_16x16x32_bf16 v[236:239], a[116:119], a[100:103], v[236:239]
ds_read_b128 a[92:95], v10 offset:2048
v_mfma_f32_16x16x32_bf16 v[224:227], a[124:127], a[100:103], v[224:227]
v_mfma_f32_16x16x32_bf16 v[224:227], a[120:123], a[96:99], v[224:227]
buffer_load_dwordx4 v15, s[24:27], s64 offen offset:3072 sc1 lds
v_mfma_f32_16x16x32_bf16 v[208:211], a[120:123], a[104:107], v[208:211]
v_mfma_f32_16x16x32_bf16 v[208:211], a[124:127], a[108:111], v[208:211]
v_mfma_f32_16x16x32_bf16 v[216:219], a[116:119], a[108:111], v[216:219]
v_mfma_f32_16x16x32_bf16 v[216:219], a[112:115], a[104:107], v[216:219]
v_mfma_f32_16x16x32_bf16 v[244:247], a[184:187], a[104:107], v[244:247]
v_mfma_f32_16x16x32_bf16 v[244:247], a[188:191], a[108:111], v[244:247]
v_mfma_f32_16x16x32_bf16 v[192:195], a[180:183], a[108:111], v[192:195]
v_mfma_f32_16x16x32_bf16 v[192:195], a[176:179], a[104:107], v[192:195]
v_mfma_f32_16x16x32_bf16 v[200:203], a[168:171], a[104:107], v[200:203]
v_mfma_f32_16x16x32_bf16 v[200:203], a[172:175], a[108:111], v[200:203]
v_mfma_f32_16x16x32_bf16 v[88:91], a[164:167], a[108:111], v[88:91]
v_mfma_f32_16x16x32_bf16 v[88:91], a[160:163], a[104:107], v[88:91]
s_waitcnt lgkmcnt(0)
v_mfma_f32_16x16x32_bf16 v[36:39], a[128:131], a[80:83], v[36:39]
s_waitcnt vmcnt(18)
v_mfma_f32_16x16x32_bf16 v[36:39], a[132:135], a[84:87], v[36:39]
s_barrier
v_mfma_f32_16x16x32_bf16 v[44:47], a[140:143], a[84:87], v[44:47]
ds_read_b128 a[96:99], v9 offset:4096
v_mfma_f32_16x16x32_bf16 v[44:47], a[136:139], a[80:83], v[44:47]
s_add_u32 m0, s70, 65536
s_add_u32 s64, s68, 32768
ds_read_b128 a[100:103], v10 offset:4096
v_mfma_f32_16x16x32_bf16 v[32:35], a[144:147], a[80:83], v[32:35]
buffer_load_dwordx4 v15, s[24:27], s64 offen offset:0 sc1 lds
v_mfma_f32_16x16x32_bf16 v[32:35], a[148:151], a[84:87], v[32:35]
ds_read_b128 a[104:107], v9 offset:6144
v_mfma_f32_16x16x32_bf16 v[52:55], a[156:159], a[84:87], v[52:55]
ds_read_b64_tr_b16 a[160:161], v11 offset:16384
ds_read_b64_tr_b16 a[162:163], v11 offset:16896
v_mfma_f32_16x16x32_bf16 v[52:55], a[152:155], a[80:83], v[52:55]
buffer_store_dwordx4 a[192:195], v15, s[24:27], s81 offen sc1
v_mfma_f32_16x16x32_bf16 v[60:63], a[64:67], a[80:83], v[60:63]
v_mfma_f32_16x16x32_bf16 v[60:63], a[68:71], a[84:87], v[60:63]
ds_read_b128 a[108:111], v10 offset:6144
v_mfma_f32_16x16x32_bf16 v[68:71], a[76:79], a[84:87], v[68:71]
v_cvt_pk_bf16_f32 v36, v36, v37
v_cvt_pk_bf16_f32 v37, v38, v39
v_mfma_f32_16x16x32_bf16 v[68:71], a[72:75], a[80:83], v[68:71]
ds_read_b64_tr_b16 a[164:165], v11 offset:20480
ds_read_b64_tr_b16 a[166:167], v11 offset:20992
v_mfma_f32_16x16x32_bf16 v[76:79], a[72:75], a[88:91], v[76:79]
buffer_store_dwordx4 a[196:199], v15, s[24:27], s82 offen sc1
v_mfma_f32_16x16x32_bf16 v[76:79], a[76:79], a[92:95], v[76:79]
ds_read_b64_tr_b16 a[168:169], v12 offset:16384
ds_read_b64_tr_b16 a[170:171], v12 offset:16896
v_mfma_f32_16x16x32_bf16 v[84:87], a[68:71], a[92:95], v[84:87]
buffer_load_dwordx4 v15, s[24:27], s64 offen offset:1024 sc1 lds
v_mfma_f32_16x16x32_bf16 v[84:87], a[64:67], a[88:91], v[84:87]
ds_read_b64_tr_b16 a[172:173], v12 offset:20480
ds_read_b64_tr_b16 a[174:175], v12 offset:20992
v_mfma_f32_16x16x32_bf16 v[92:95], a[152:155], a[88:91], v[92:95]
v_cvt_pk_bf16_f32 v38, v44, v45
v_cvt_pk_bf16_f32 v39, v46, v47
v_mfma_f32_16x16x32_bf16 v[92:95], a[156:159], a[92:95], v[92:95]
buffer_store_dwordx4 a[200:203], v15, s[24:27], s71 offen sc1
v_mfma_f32_16x16x32_bf16 v[40:43], a[148:151], a[92:95], v[40:43]
ds_read_b64_tr_b16 a[176:177], v13 offset:16384
ds_read_b64_tr_b16 a[178:179], v13 offset:16896
v_mfma_f32_16x16x32_bf16 v[40:43], a[144:147], a[88:91], v[40:43]
v_cvt_pk_bf16_f32 v32, v32, v33
v_cvt_pk_bf16_f32 v33, v34, v35
v_mfma_f32_16x16x32_bf16 v[100:103], a[136:139], a[88:91], v[100:103]
ds_read_b64_tr_b16 a[180:181], v13 offset:20480
ds_read_b64_tr_b16 a[182:183], v13 offset:20992
v_mfma_f32_16x16x32_bf16 v[100:103], a[140:143], a[92:95], v[100:103]
v_cvt_pk_bf16_f32 v34, v52, v53
v_cvt_pk_bf16_f32 v35, v54, v55
v_mfma_f32_16x16x32_bf16 v[108:111], a[132:135], a[92:95], v[108:111]
ds_read_b64_tr_b16 a[184:185], v14 offset:16384
ds_read_b64_tr_b16 a[186:187], v14 offset:16896
v_mfma_f32_16x16x32_bf16 v[108:111], a[128:131], a[88:91], v[108:111]
s_waitcnt lgkmcnt(15)
v_mfma_f32_16x16x32_bf16 v[116:119], a[128:131], a[96:99], v[116:119]
ds_read_b64_tr_b16 a[188:189], v14 offset:20480
ds_read_b64_tr_b16 a[190:191], v14 offset:20992
v_mfma_f32_16x16x32_bf16 v[116:119], a[132:135], a[100:103], v[116:119]
buffer_load_dwordx4 v15, s[24:27], s64 offen offset:2048 sc1 lds
v_mfma_f32_16x16x32_bf16 v[124:127], a[140:143], a[100:103], v[124:127]
buffer_store_dwordx4 a[204:207], v15, s[24:27], s72 offen sc1
v_mfma_f32_16x16x32_bf16 v[124:127], a[136:139], a[96:99], v[124:127]
ds_read_b128 a[112:115], v4 offset:24576
v_cvt_pk_bf16_f32 v40, v40, v41
v_mfma_f32_16x16x32_bf16 v[132:135], a[144:147], a[96:99], v[132:135]
v_cvt_pk_bf16_f32 v41, v42, v43
v_cvt_pk_bf16_f32 v42, v92, v93
v_mfma_f32_16x16x32_bf16 v[132:135], a[148:151], a[100:103], v[132:135]
ds_read_b128 a[116:119], v4 offset:26624
v_cvt_pk_bf16_f32 v43, v94, v95
v_mfma_f32_16x16x32_bf16 v[140:143], a[156:159], a[100:103], v[140:143]
v_cvt_pk_bf16_f32 v108, v108, v109
v_cvt_pk_bf16_f32 v109, v110, v111
v_mfma_f32_16x16x32_bf16 v[140:143], a[152:155], a[96:99], v[140:143]
ds_read_b128 a[120:123], v4 offset:25600
v_cvt_pk_bf16_f32 v110, v100, v101
v_mfma_f32_16x16x32_bf16 v[148:151], a[64:67], a[96:99], v[148:151]
buffer_store_dwordx4 a[208:211], v15, s[24:27], s74 offen sc1
v_mfma_f32_16x16x32_bf16 v[148:151], a[68:71], a[100:103], v[148:151]
ds_read_b128 a[124:127], v4 offset:27648
v_cvt_pk_bf16_f32 v111, v102, v103
v_mfma_f32_16x16x32_bf16 v[48:51], a[76:79], a[100:103], v[48:51]
s_waitcnt lgkmcnt(15)
v_cvt_pk_bf16_f32 v116, v116, v117
v_cvt_pk_bf16_f32 v117, v118, v119
v_mfma_f32_16x16x32_bf16 v[48:51], a[72:75], a[96:99], v[48:51]
buffer_load_dwordx4 v15, s[24:27], s64 offen offset:3072 sc1 lds
v_mfma_f32_16x16x32_bf16 v[156:159], a[72:75], a[104:107], v[156:159]
v_cvt_pk_bf16_f32 v118, v124, v125
v_cvt_pk_bf16_f32 v119, v126, v127
v_mfma_f32_16x16x32_bf16 v[156:159], a[76:79], a[108:111], v[156:159]
buffer_store_dwordx4 a[212:215], v15, s[24:27], s75 offen sc1
v_mfma_f32_16x16x32_bf16 v[164:167], a[68:71], a[108:111], v[164:167]
v_cvt_pk_bf16_f32 v132, v132, v133
v_cvt_pk_bf16_f32 v133, v134, v135
v_mfma_f32_16x16x32_bf16 v[164:167], a[64:67], a[104:107], v[164:167]
v_cvt_pk_bf16_f32 v134, v140, v141
v_cvt_pk_bf16_f32 v135, v142, v143
v_mfma_f32_16x16x32_bf16 v[172:175], a[152:155], a[104:107], v[172:175]
v_mfma_f32_16x16x32_bf16 v[172:175], a[156:159], a[108:111], v[172:175]
v_mfma_f32_16x16x32_bf16 v[56:59], a[148:151], a[108:111], v[56:59]
v_mfma_f32_16x16x32_bf16 v[56:59], a[144:147], a[104:107], v[56:59]
v_mfma_f32_16x16x32_bf16 v[180:183], a[136:139], a[104:107], v[180:183]
v_mfma_f32_16x16x32_bf16 v[180:183], a[140:143], a[108:111], v[180:183]
v_mfma_f32_16x16x32_bf16 v[188:191], a[132:135], a[108:111], v[188:191]
v_mfma_f32_16x16x32_bf16 v[188:191], a[128:131], a[104:107], v[188:191]
s_waitcnt lgkmcnt(0)
v_mfma_f32_16x16x32_bf16 v[196:199], a[160:163], a[80:83], v[196:199]
s_waitcnt vmcnt(16)
v_mfma_f32_16x16x32_bf16 v[196:199], a[164:167], a[84:87], v[196:199]
s_barrier
v_mfma_f32_16x16x32_bf16 v[64:67], a[172:175], a[84:87], v[64:67]
ds_read_b128 a[192:195], v4 offset:32768
v_cvt_pk_bf16_f32 v56, v56, v57
v_mfma_f32_16x16x32_bf16 v[64:67], a[168:171], a[80:83], v[64:67]
s_add_u32 m0, s70, 81920
s_add_u32 s64, s68, 49152
v_cvt_pk_bf16_f32 v57, v58, v59
v_mfma_f32_16x16x32_bf16 v[204:207], a[176:179], a[80:83], v[204:207]
buffer_load_dwordx4 v15, s[24:27], s64 offen offset:0 sc1 lds
v_mfma_f32_16x16x32_bf16 v[204:207], a[180:183], a[84:87], v[204:207]
ds_read_b128 a[196:199], v4 offset:33792
v_cvt_pk_bf16_f32 v58, v172, v173
v_mfma_f32_16x16x32_bf16 v[212:215], a[188:191], a[84:87], v[212:215]
v_cvt_pk_bf16_f32 v59, v174, v175
v_cvt_pk_bf16_f32 v188, v188, v189
v_mfma_f32_16x16x32_bf16 v[212:215], a[184:187], a[80:83], v[212:215]
ds_read_b128 a[200:203], v4 offset:34816
v_cvt_pk_bf16_f32 v189, v190, v191
v_mfma_f32_16x16x32_bf16 v[80:83], a[160:163], a[88:91], v[80:83]
v_cvt_pk_bf16_f32 v190, v180, v181
v_cvt_pk_bf16_f32 v191, v182, v183
v_mfma_f32_16x16x32_bf16 v[80:83], a[164:167], a[92:95], v[80:83]
ds_read_b128 a[204:207], v4 offset:35840
ds_bpermute_b32 v8, v17, v63
v_mfma_f32_16x16x32_bf16 v[176:179], a[172:175], a[92:95], v[176:179]
v_cvt_pk_bf16_f32 v196, v196, v197
v_cvt_pk_bf16_f32 v197, v198, v199
v_mfma_f32_16x16x32_bf16 v[176:179], a[168:171], a[88:91], v[176:179]
ds_read_b128 a[208:211], v4 offset:36864
v_cvt_pk_bf16_f32 v198, v64, v65
v_mfma_f32_16x16x32_bf16 v[168:171], a[176:179], a[88:91], v[168:171]
v_cvt_pk_bf16_f32 v199, v66, v67
v_cvt_pk_bf16_f32 v60, v60, v61
v_mfma_f32_16x16x32_bf16 v[168:171], a[180:183], a[92:95], v[168:171]
ds_read_b128 a[212:215], v4 offset:37888
v_cvt_pk_bf16_f32 v61, v62, v63
v_mfma_f32_16x16x32_bf16 v[228:231], a[188:191], a[92:95], v[228:231]
buffer_load_dwordx4 v15, s[24:27], s64 offen offset:1024 sc1 lds
v_mfma_f32_16x16x32_bf16 v[228:231], a[184:187], a[88:91], v[228:231]
ds_read_b128 a[216:219], v4 offset:38912
v_cvt_pk_bf16_f32 v204, v204, v205
v_mfma_f32_16x16x32_bf16 v[184:187], a[160:163], a[96:99], v[184:187]
v_cvt_pk_bf16_f32 v205, v206, v207
v_cvt_pk_bf16_f32 v206, v212, v213
v_mfma_f32_16x16x32_bf16 v[184:187], a[164:167], a[100:103], v[184:187]
ds_read_b128 a[220:223], v4 offset:39936
v_cvt_pk_bf16_f32 v207, v214, v215
v_mfma_f32_16x16x32_bf16 v[248:251], a[172:175], a[100:103], v[248:251]
v_cvt_pk_bf16_f32 v80, v80, v81
v_cvt_pk_bf16_f32 v81, v82, v83
v_mfma_f32_16x16x32_bf16 v[248:251], a[168:171], a[96:99], v[248:251]
v_cvt_pk_bf16_f32 v82, v176, v177
v_cvt_pk_bf16_f32 v83, v178, v179
v_mfma_f32_16x16x32_bf16 v[240:243], a[176:179], a[96:99], v[240:243]
v_cvt_pk_bf16_f32 v62, v68, v69
v_cvt_pk_bf16_f32 v63, v70, v71
v_mfma_f32_16x16x32_bf16 v[240:243], a[180:183], a[100:103], v[240:243]
v_accvgpr_write_b32 a128, v60
v_accvgpr_write_b32 a129, v61
v_mfma_f32_16x16x32_bf16 v[232:235], a[188:191], a[100:103], v[232:235]
v_cvt_pk_bf16_f32 v168, v168, v169
v_cvt_pk_bf16_f32 v169, v170, v171
v_mfma_f32_16x16x32_bf16 v[232:235], a[184:187], a[96:99], v[232:235]
v_cvt_pk_bf16_f32 v170, v228, v229
v_cvt_pk_bf16_f32 v171, v230, v231
v_mfma_f32_16x16x32_bf16 v[88:91], a[160:163], a[104:107], v[88:91]
v_accvgpr_write_b32 a130, v62
v_accvgpr_write_b32 a131, v63
v_mfma_f32_16x16x32_bf16 v[88:91], a[164:167], a[108:111], v[88:91]
buffer_load_dwordx4 v15, s[24:27], s64 offen offset:2048 sc1 lds
v_mfma_f32_16x16x32_bf16 v[200:203], a[172:175], a[108:111], v[200:203]
v_cvt_pk_bf16_f32 v184, v184, v185
v_cvt_pk_bf16_f32 v185, v186, v187
v_mfma_f32_16x16x32_bf16 v[200:203], a[168:171], a[104:107], v[200:203]
v_cvt_pk_bf16_f32 v186, v248, v249
v_cvt_pk_bf16_f32 v187, v250, v251
v_mfma_f32_16x16x32_bf16 v[192:195], a[176:179], a[104:107], v[192:195]
ds_bpermute_b32 v9, v17, v87
v_cvt_pk_bf16_f32 v84, v84, v85
v_mfma_f32_16x16x32_bf16 v[192:195], a[180:183], a[108:111], v[192:195]
v_cvt_pk_bf16_f32 v85, v86, v87
v_cvt_pk_bf16_f32 v86, v76, v77
v_mfma_f32_16x16x32_bf16 v[244:247], a[188:191], a[108:111], v[244:247]
v_cvt_pk_bf16_f32 v240, v240, v241
v_cvt_pk_bf16_f32 v241, v242, v243
v_mfma_f32_16x16x32_bf16 v[244:247], a[184:187], a[104:107], v[244:247]
v_cvt_pk_bf16_f32 v242, v232, v233
v_cvt_pk_bf16_f32 v243, v234, v235
v_mfma_f32_16x16x32_bf16 v[72:75], a[112:115], a[80:83], v[72:75]
v_cvt_pk_bf16_f32 v87, v78, v79
v_mov_b32 v68, 0
v_mfma_f32_16x16x32_bf16 v[72:75], a[116:119], a[84:87], v[72:75]
buffer_store_dwordx4 v[84:87], v18, s[24:27], s54 offen offset:256 sc1
v_mfma_f32_16x16x32_bf16 v[220:223], a[124:127], a[84:87], v[220:223]
v_cvt_pk_bf16_f32 v88, v88, v89
v_cvt_pk_bf16_f32 v89, v90, v91
v_mfma_f32_16x16x32_bf16 v[220:223], a[120:123], a[80:83], v[220:223]
buffer_load_dwordx4 v15, s[24:27], s64 offen offset:3072 sc1 lds
v_mfma_f32_16x16x32_bf16 v[160:163], a[112:115], a[88:91], v[160:163]
v_cvt_pk_bf16_f32 v90, v200, v201
v_cvt_pk_bf16_f32 v91, v202, v203
v_mfma_f32_16x16x32_bf16 v[160:163], a[116:119], a[92:95], v[160:163]
v_accvgpr_write_b32 a136, v84
v_accvgpr_write_b32 a137, v85
v_mfma_f32_16x16x32_bf16 v[252:255], a[124:127], a[92:95], v[252:255]
v_cvt_pk_bf16_f32 v192, v192, v193
v_cvt_pk_bf16_f32 v193, v194, v195
v_mfma_f32_16x16x32_bf16 v[252:255], a[120:123], a[88:91], v[252:255]
v_cvt_pk_bf16_f32 v194, v244, v245
v_cvt_pk_bf16_f32 v195, v246, v247
v_mfma_f32_16x16x32_bf16 v[236:239], a[112:115], a[96:99], v[236:239]
v_accvgpr_write_b32 a138, v86
v_accvgpr_write_b32 a139, v87
v_mfma_f32_16x16x32_bf16 v[236:239], a[116:119], a[100:103], v[236:239]
ds_bpermute_b32 v10, v17, v151
v_cvt_pk_bf16_f32 v148, v148, v149
v_mfma_f32_16x16x32_bf16 v[224:227], a[124:127], a[100:103], v[224:227]
v_cvt_pk_bf16_f32 v149, v150, v151
v_cvt_pk_bf16_f32 v150, v48, v49
v_mfma_f32_16x16x32_bf16 v[224:227], a[120:123], a[96:99], v[224:227]
v_cvt_pk_bf16_f32 v151, v50, v51
v_accvgpr_write_b32 a144, v148
v_mfma_f32_16x16x32_bf16 v[216:219], a[112:115], a[104:107], v[216:219]
v_accvgpr_write_b32 a145, v149
v_accvgpr_write_b32 a146, v150
v_mfma_f32_16x16x32_bf16 v[216:219], a[116:119], a[108:111], v[216:219]
ds_bpermute_b32 v11, v17, v167
v_accvgpr_write_b32 a147, v151
v_mfma_f32_16x16x32_bf16 v[208:211], a[124:127], a[108:111], v[208:211]
v_cvt_pk_bf16_f32 v164, v164, v165
v_cvt_pk_bf16_f32 v165, v166, v167
v_mfma_f32_16x16x32_bf16 v[208:211], a[120:123], a[104:107], v[208:211]
s_waitcnt lgkmcnt(0)
v_cvt_pk_bf16_f32 v166, v156, v157
v_cvt_pk_bf16_f32 v167, v158, v159
v_mfma_f32_16x16x32_bf16 v[44:47], a[192:195], v[36:39], v[96:99]
buffer_store_dwordx4 v[164:167], v18, s[24:27], s55 offen offset:256 sc1
v_mfma_f32_16x16x32_bf16 v[44:47], a[196:199], v[32:35], v[44:47]
v_accvgpr_write_b32 a152, v164
v_accvgpr_write_b32 a153, v165
v_mfma_f32_16x16x32_bf16 v[44:47], a[200:203], v[196:199], v[44:47]
v_accvgpr_write_b32 a154, v166
v_accvgpr_write_b32 a155, v167
v_mfma_f32_16x16x32_bf16 v[44:47], a[204:207], v[204:207], v[44:47]
v_cvt_pk_bf16_f32 v72, v72, v73
v_cvt_pk_bf16_f32 v73, v74, v75
v_mfma_f32_16x16x32_bf16 v[52:55], a[192:195], v[108:111], v[104:107]
v_cvt_pk_bf16_f32 v74, v220, v221
v_cvt_pk_bf16_f32 v75, v222, v223
v_mfma_f32_16x16x32_bf16 v[52:55], a[196:199], v[40:43], v[52:55]
v_accvgpr_write_b32 a132, v72
v_accvgpr_write_b32 a133, v73
v_mfma_f32_16x16x32_bf16 v[52:55], a[200:203], v[80:83], v[52:55]
v_accvgpr_write_b32 a134, v74
v_accvgpr_write_b32 a135, v75
v_mfma_f32_16x16x32_bf16 v[52:55], a[204:207], v[168:171], v[52:55]
v_cvt_pk_bf16_f32 v160, v160, v161
v_cvt_pk_bf16_f32 v161, v162, v163
v_mfma_f32_16x16x32_bf16 v[64:67], a[208:211], v[36:39], v[112:115]
v_cvt_pk_bf16_f32 v162, v252, v253
v_cvt_pk_bf16_f32 v163, v254, v255
v_mfma_f32_16x16x32_bf16 v[64:67], a[212:215], v[32:35], v[64:67]
buffer_store_dwordx4 v[160:163], v19, s[24:27], s54 offen offset:256 sc1
v_mfma_f32_16x16x32_bf16 v[64:67], a[216:219], v[196:199], v[64:67]
v_accvgpr_write_b32 a140, v160
v_accvgpr_write_b32 a141, v161
v_mfma_f32_16x16x32_bf16 v[64:67], a[220:223], v[204:207], v[64:67]
v_accvgpr_write_b32 a142, v162
v_accvgpr_write_b32 a143, v163
v_mfma_f32_16x16x32_bf16 v[212:215], a[208:211], v[108:111], v[120:123]
v_cvt_pk_bf16_f32 v236, v236, v237
v_cvt_pk_bf16_f32 v237, v238, v239
v_mfma_f32_16x16x32_bf16 v[212:215], a[212:215], v[40:43], v[212:215]
v_cvt_pk_bf16_f32 v238, v224, v225
v_cvt_pk_bf16_f32 v239, v226, v227
v_mfma_f32_16x16x32_bf16 v[212:215], a[216:219], v[80:83], v[212:215]
v_accvgpr_write_b32 a148, v236
v_accvgpr_write_b32 a149, v237
v_mfma_f32_16x16x32_bf16 v[212:215], a[220:223], v[168:171], v[212:215]
s_waitcnt vmcnt(17)
v_accvgpr_write_b32 a150, v238
v_accvgpr_write_b32 a151, v239
v_mfma_f32_16x16x32_bf16 v[100:103], a[192:195], v[116:119], v[128:131]
s_barrier
v_cvt_pk_bf16_f32 v216, v216, v217
v_cvt_pk_bf16_f32 v217, v218, v219
v_mfma_f32_16x16x32_bf16 v[100:103], a[196:199], v[132:135], v[100:103]
v_cvt_pk_bf16_f32 v218, v208, v209
v_cvt_pk_bf16_f32 v219, v210, v211
v_mfma_f32_16x16x32_bf16 v[100:103], a[200:203], v[184:187], v[100:103]
buffer_store_dwordx4 v[216:219], v19, s[24:27], s55 offen offset:256 sc1
v_mfma_f32_16x16x32_bf16 v[100:103], a[204:207], v[240:243], v[100:103]
v_accvgpr_write_b32 a156, v216
v_accvgpr_write_b32 a157, v217
v_mfma_f32_16x16x32_bf16 v[92:95], a[192:195], v[188:191], v[136:139]
v_accvgpr_write_b32 a158, v218
v_accvgpr_write_b32 a159, v219
v_mfma_f32_16x16x32_bf16 v[92:95], a[196:199], v[56:59], v[92:95]
v_max3_f32 v24, v44, v45, v46
v_max3_f32 v25, v47, v64, v65
v_mfma_f32_16x16x32_bf16 v[92:95], a[200:203], v[88:91], v[92:95]
v_max3_f32 v26, v52, v53, v54
v_max3_f32 v27, v55, v212, v213
v_mfma_f32_16x16x32_bf16 v[92:95], a[204:207], v[192:195], v[92:95]
v_max3_f32 v24, v24, v66, v67
v_max_f32 v24, v24, v25
v_mfma_f32_16x16x32_bf16 v[176:179], a[208:211], v[116:119], v[144:147]
v_max3_f32 v26, v26, v214, v215
v_max_f32 v26, v26, v27
v_mfma_f32_16x16x32_bf16 v[176:179], a[212:215], v[132:135], v[176:179]
L_PAD8:
s_cbranch_execz L_PAD12
v_mov_b32 v25, v24
v_mov_b32 v27, v26
v_mfma_f32_16x16x32_bf16 v[176:179], a[216:219], v[184:187], v[176:179]
v_mov_b32 v69, 0
v_mov_b32 v70, 0
v_mfma_f32_16x16x32_bf16 v[176:179], a[220:223], v[240:243], v[176:179]
v_permlane32_swap_b32 v25, v24
v_permlane32_swap_b32 v27, v26
v_mfma_f32_16x16x32_bf16 v[228:231], a[208:211], v[188:191], v[152:155]
v_max_f32 v24, v24, v25
v_max_f32 v26, v26, v27
v_mfma_f32_16x16x32_bf16 v[228:231], a[212:215], v[56:59], v[228:231]
v_mov_b32 v25, v24
v_mov_b32 v27, v26
v_mfma_f32_16x16x32_bf16 v[228:231], a[216:219], v[88:91], v[228:231]
v_mov_b32 v71, 0
v_mfma_f32_16x16x32_bf16 v[228:231], a[220:223], v[192:195], v[228:231]
v_permlane16_swap_b32 v25, v24
v_permlane16_swap_b32 v27, v26
ds_read_b128 a[64:67], v4 offset:57344
ds_read_b128 a[68:71], v4 offset:58368
ds_read_b128 a[72:75], v4 offset:59392
ds_read_b128 a[76:79], v4 offset:60416
ds_read_b128 a[80:83], v4 offset:61440
ds_read_b128 a[84:87], v4 offset:62464
ds_read_b128 a[88:91], v4 offset:63488
ds_read_b128 a[92:95], v4 offset:64512
s_add_u32 m0, s70, 98304
s_add_u32 s64, s68, 65536
buffer_load_dwordx4 v15, s[24:27], s64 offen offset:0 sc1 lds
s_nop 1
v_max_f32 v24, v24, v25
v_max_f32 v26, v26, v27
v_pk_add_f32 v[44:45], v[44:45], v[24:25] op_sel_hi:[1,0] neg_lo:[0,1] neg_hi:[0,1]
v_pk_add_f32 v[46:47], v[46:47], v[24:25] op_sel_hi:[1,0] neg_lo:[0,1] neg_hi:[0,1]
v_pk_add_f32 v[52:53], v[52:53], v[26:27] op_sel_hi:[1,0] neg_lo:[0,1] neg_hi:[0,1]
v_pk_add_f32 v[54:55], v[54:55], v[26:27] op_sel_hi:[1,0] neg_lo:[0,1] neg_hi:[0,1]
buffer_load_dwordx4 v15, s[24:27], s64 offen offset:1024 sc1 lds
v_pk_add_f32 v[64:65], v[64:65], v[24:25] op_sel_hi:[1,0] neg_lo:[0,1] neg_hi:[0,1]
v_pk_add_f32 v[66:67], v[66:67], v[24:25] op_sel_hi:[1,0] neg_lo:[0,1] neg_hi:[0,1]
v_pk_add_f32 v[212:213], v[212:213], v[26:27] op_sel_hi:[1,0] neg_lo:[0,1] neg_hi:[0,1]
v_pk_add_f32 v[214:215], v[214:215], v[26:27] op_sel_hi:[1,0] neg_lo:[0,1] neg_hi:[0,1]
v_pk_add_f32 v[96:97], v[96:97], v[24:25] op_sel_hi:[1,0] neg_lo:[0,1] neg_hi:[0,1]
v_pk_add_f32 v[98:99], v[98:99], v[24:25] op_sel_hi:[1,0] neg_lo:[0,1] neg_hi:[0,1]
v_pk_add_f32 v[104:105], v[104:105], v[26:27] op_sel_hi:[1,0] neg_lo:[0,1] neg_hi:[0,1]
buffer_load_dwordx4 v15, s[24:27], s64 offen offset:2048 sc1 lds
v_pk_add_f32 v[106:107], v[106:107], v[26:27] op_sel_hi:[1,0] neg_lo:[0,1] neg_hi:[0,1]
v_pk_add_f32 v[112:113], v[112:113], v[24:25] op_sel_hi:[1,0] neg_lo:[0,1] neg_hi:[0,1]
v_pk_add_f32 v[114:115], v[114:115], v[24:25] op_sel_hi:[1,0] neg_lo:[0,1] neg_hi:[0,1]
v_pk_add_f32 v[120:121], v[120:121], v[26:27] op_sel_hi:[1,0] neg_lo:[0,1] neg_hi:[0,1]
v_pk_add_f32 v[122:123], v[122:123], v[26:27] op_sel_hi:[1,0] neg_lo:[0,1] neg_hi:[0,1]
v_exp_f32 v44, v44
v_exp_f32 v45, v45
buffer_load_dwordx4 v15, s[24:27], s64 offen offset:3072 sc1 lds
v_exp_f32 v46, v46
v_exp_f32 v47, v47
v_cvt_pk_bf16_f32 v124, v44, v45
v_exp_f32 v52, v52
v_exp_f32 v53, v53
v_cvt_pk_bf16_f32 v125, v46, v47
v_exp_f32 v54, v54
s_add_u32 m0, s70, 114688
s_add_u32 s64, s68, 81920
buffer_load_dwordx4 v15, s[24:27], s64 offen offset:0 sc1 lds
v_exp_f32 v55, v55
v_cvt_pk_bf16_f32 v140, v52, v53
v_exp_f32 v64, v64
v_exp_f32 v65, v65
v_cvt_pk_bf16_f32 v141, v54, v55
v_exp_f32 v66, v66
v_exp_f32 v67, v67
buffer_load_dwordx4 v15, s[24:27], s64 offen offset:1024 sc1 lds
v_cvt_pk_bf16_f32 v126, v64, v65
v_exp_f32 v212, v212
v_exp_f32 v213, v213
v_cvt_pk_bf16_f32 v127, v66, v67
v_exp_f32 v214, v214
v_exp_f32 v215, v215
v_cvt_pk_bf16_f32 v142, v212, v213
buffer_load_dwordx4 v15, s[24:27], s64 offen offset:2048 sc1 lds
v_max3_f32 v24, v100, v101, v102
v_cvt_pk_bf16_f32 v143, v214, v215
v_max3_f32 v25, v103, v176, v177
v_max3_f32 v26, v92, v93, v94
v_max3_f32 v27, v95, v228, v229
v_max3_f32 v24, v24, v178, v179
v_max_f32 v24, v24, v25
buffer_load_dwordx4 v15, s[24:27], s64 offen offset:3072 sc1 lds
v_max3_f32 v26, v26, v230, v231
v_max_f32 v26, v26, v27
v_mov_b32 v25, v24
v_mov_b32 v27, v26
s_nop 1
v_permlane32_swap_b32 v25, v24
v_permlane32_swap_b32 v27, v26
s_cmp_lt_u32 s3, 1
s_cbranch_scc1 L_SK5
s_add_u32 m0, s70, 131072
s_add_u32 s64, s68, 98304
buffer_load_dwordx4 v15, s[24:27], s64 offen offset:0 sc1 lds
buffer_load_dwordx4 v15, s[24:27], s64 offen offset:1024 sc1 lds
buffer_load_dwordx4 v15, s[24:27], s64 offen offset:2048 sc1 lds
buffer_load_dwordx4 v15, s[24:27], s64 offen offset:3072 sc1 lds
L_SK5:
s_nop 0
v_max_f32 v24, v24, v25
v_max_f32 v26, v26, v27
v_mov_b32 v25, v24
v_mov_b32 v27, v26
s_nop 1
v_permlane16_swap_b32 v25, v24
v_permlane16_swap_b32 v27, v26
s_nop 0
v_max_f32 v24, v24, v25
v_max_f32 v26, v26, v27
v_pk_add_f32 v[100:101], v[100:101], v[24:25] op_sel_hi:[1,0] neg_lo:[0,1] neg_hi:[0,1]
v_pk_add_f32 v[102:103], v[102:103], v[24:25] op_sel_hi:[1,0] neg_lo:[0,1] neg_hi:[0,1]
v_pk_add_f32 v[92:93], v[92:93], v[26:27] op_sel_hi:[1,0] neg_lo:[0,1] neg_hi:[0,1]
v_pk_add_f32 v[94:95], v[94:95], v[26:27] op_sel_hi:[1,0] neg_lo:[0,1] neg_hi:[0,1]
v_pk_add_f32 v[176:177], v[176:177], v[24:25] op_sel_hi:[1,0] neg_lo:[0,1] neg_hi:[0,1]
v_pk_add_f32 v[178:179], v[178:179], v[24:25] op_sel_hi:[1,0] neg_lo:[0,1] neg_hi:[0,1]
v_pk_add_f32 v[228:229], v[228:229], v[26:27] op_sel_hi:[1,0] neg_lo:[0,1] neg_hi:[0,1]
v_pk_add_f32 v[230:231], v[230:231], v[26:27] op_sel_hi:[1,0] neg_lo:[0,1] neg_hi:[0,1]
s_cmp_lt_u32 s3, 2
s_cbranch_scc1 L_SK6
s_add_u32 m0, s70, 147456
s_add_u32 s64, s68, 114688
buffer_load_dwordx4 v15, s[24:27], s64 offen offset:0 sc1 lds
buffer_load_dwordx4 v15, s[24:27], s64 offen offset:1024 sc1 lds
buffer_load_dwordx4 v15, s[24:27], s64 offen offset:2048 sc1 lds
buffer_load_dwordx4 v15, s[24:27], s64 offen offset:3072 sc1 lds
L_SK6:
v_pk_add_f32 v[128:129], v[128:129], v[24:25] op_sel_hi:[1,0] neg_lo:[0,1] neg_hi:[0,1]
v_pk_add_f32 v[130:131], v[130:131], v[24:25] op_sel_hi:[1,0] neg_lo:[0,1] neg_hi:[0,1]
v_pk_add_f32 v[136:137], v[136:137], v[26:27] op_sel_hi:[1,0] neg_lo:[0,1] neg_hi:[0,1]
v_pk_add_f32 v[138:139], v[138:139], v[26:27] op_sel_hi:[1,0] neg_lo:[0,1] neg_hi:[0,1]
v_pk_add_f32 v[144:145], v[144:145], v[24:25] op_sel_hi:[1,0] neg_lo:[0,1] neg_hi:[0,1]
v_pk_add_f32 v[146:147], v[146:147], v[24:25] op_sel_hi:[1,0] neg_lo:[0,1] neg_hi:[0,1]
v_pk_add_f32 v[152:153], v[152:153], v[26:27] op_sel_hi:[1,0] neg_lo:[0,1] neg_hi:[0,1]
v_pk_add_f32 v[154:155], v[154:155], v[26:27] op_sel_hi:[1,0] neg_lo:[0,1] neg_hi:[0,1]
v_mov_b64 v[60:61], 0
v_mov_b64 v[62:63], 0
v_mov_b64 v[72:73], 0
v_mov_b64 v[74:75], 0
v_mov_b64 v[220:221], 0
v_mov_b64 v[222:223], 0
v_mov_b64 v[84:85], 0
v_mov_b64 v[86:87], 0
v_mov_b64 v[76:77], 0
v_mov_b64 v[78:79], 0
v_mov_b64 v[160:161], 0
s_cmp_lt_u32 s3, 3
s_cbranch_scc1 L_SK7
s_add_u32 m0, s70, 0
s_add_u32 s64, s68, 131072
buffer_load_dwordx4 v15, s[24:27], s64 offen offset:0 sc1 lds
buffer_load_dwordx4 v15, s[24:27], s64 offen offset:1024 sc1 lds
buffer_load_dwordx4 v15, s[24:27], s64 offen offset:2048 sc1 lds
buffer_load_dwordx4 v15, s[24:27], s64 offen offset:3072 sc1 lds
L_SK7:
v_mov_b64 v[162:163], 0
v_mov_b64 v[252:253], 0
v_mov_b64 v[254:255], 0
v_mov_b64 v[148:149], 0
v_mov_b64 v[150:151], 0
v_mov_b64 v[48:49], 0
v_mov_b64 v[50:51], 0
v_mov_b64 v[236:237], 0
v_mov_b64 v[238:239], 0
v_mov_b64 v[224:225], 0
v_mov_b64 v[226:227], 0
v_mov_b64 v[164:165], 0
v_mov_b64 v[166:167], 0
v_mov_b64 v[156:157], 0
v_mov_b64 v[158:159], 0
v_mov_b64 v[216:217], 0
v_mov_b64 v[218:219], 0
v_mov_b64 v[208:209], 0
v_mov_b64 v[210:211], 0
ds_read_b128 a[192:195], v4 offset:49152
ds_read_b128 a[196:199], v4 offset:50176
ds_read_b128 a[200:203], v4 offset:51200
ds_read_b128 a[204:207], v4 offset:52224
ds_read_b128 a[208:211], v4 offset:53248
ds_read_b128 a[212:215], v4 offset:54272
ds_read_b128 a[216:219], v4 offset:55296
ds_read_b128 a[220:223], v4 offset:56320
s_waitcnt lgkmcnt(8)
s_lshl2_add_u32 s77, s86, s84
s_mul_i32 s77, s77, 344064
s_mov_b32 s80, s70
s_cmp_lt_u32 s3, 2
s_cselect_b32 s53, 8, -2
s_add_u32 s53, s53, s3
v_mfma_f32_16x16x32_bf16 a[0:3], a[64:67], v[124:127], 0
s_mul_i32 s52, s5, 65536
v_exp_f32 v100, v100
v_mfma_f32_16x16x32_bf16 a[32:35], a[64:67], v[140:143], 0
s_sub_u32 s52, 1064960, s52
v_exp_f32 v101, v101
v_mfma_f32_16x16x32_bf16 a[36:39], a[68:71], v[140:143], 0
s_add_u32 s71, s68, s52
v_exp_f32 v102, v102
v_mfma_f32_16x16x32_bf16 a[4:7], a[68:71], v[124:127], 0
s_add_u32 s77, s77, s80
v_exp_f32 v103, v103
v_mfma_f32_16x16x32_bf16 a[8:11], a[72:75], v[124:127], 0
s_add_u32 s77, s77, 38797312
v_cvt_pk_bf16_f32 v248, v100, v101
v_cvt_pk_bf16_f32 v249, v102, v103
v_mfma_f32_16x16x32_bf16 a[40:43], a[72:75], v[140:143], 0
s_add_u32 s52, s3, 6
v_exp_f32 v92, v92
v_mfma_f32_16x16x32_bf16 a[44:47], a[76:79], v[140:143], 0
s_mul_i32 s52, s52, 16384
v_exp_f32 v93, v93
v_mfma_f32_16x16x32_bf16 a[12:15], a[76:79], v[124:127], 0
s_add_u32 s68, s68, s52
v_exp_f32 v94, v94
v_mfma_f32_16x16x32_bf16 a[16:19], a[80:83], v[124:127], 0
s_lshl_b32 s53, s53, 14
v_exp_f32 v95, v95
v_mfma_f32_16x16x32_bf16 a[48:51], a[80:83], v[140:143], 0
s_add_u32 s70, s70, s53
v_cvt_pk_bf16_f32 v232, v92, v93
v_cvt_pk_bf16_f32 v233, v94, v95
v_mfma_f32_16x16x32_bf16 a[52:55], a[84:87], v[140:143], 0
s_mov_b32 s75, 65536
v_exp_f32 v176, v176
v_mfma_f32_16x16x32_bf16 a[20:23], a[84:87], v[124:127], 0
s_mov_b32 s72, 1
v_exp_f32 v177, v177
v_mfma_f32_16x16x32_bf16 a[24:27], a[88:91], v[124:127], 0
s_mov_b32 s73, 9
v_exp_f32 v178, v178
v_mfma_f32_16x16x32_bf16 a[56:59], a[88:91], v[140:143], 0
s_lshl2_add_u32 s69, s5, 4
v_exp_f32 v179, v179
v_mfma_f32_16x16x32_bf16 a[60:63], a[92:95], v[140:143], 0
s_max_u32 s69, s69, 12
v_cvt_pk_bf16_f32 v250, v176, v177
v_cvt_pk_bf16_f32 v251, v178, v179
v_mfma_f32_16x16x32_bf16 a[28:31], a[92:95], v[124:127], 0
s_min_u32 s74, s73, s66
v_exp_f32 v228, v228
v_mfma_f32_16x16x32_bf16 a[224:227], a[240:243], v[124:127], 0
s_mov_b32 s93, 9
s_waitcnt vmcnt(8) lgkmcnt(0)
v_mfma_f32_16x16x32_bf16 a[228:231], a[240:243], v[140:143], 0
s_cmp_lt_u32 s66, 2
buffer_atomic_add v1, v0, s[24:27], s89 offen offset:8 sc1
s_cbranch_scc1 L_NE
L_DUAL:
v_mfma_f32_16x16x32_bf16 v[44:47], a[192:195], v[36:39], v[96:99]
s_barrier
v_mfma_f32_16x16x32_bf16 v[44:47], a[196:199], v[32:35], v[44:47]
s_cmp_eq_u32 s68, s71
v_exp_f32 v229, v229
v_mfma_f32_16x16x32_bf16 v[44:47], a[200:203], v[196:199], v[44:47]
s_cselect_b32 s64, s77, s68
v_add_u32 v5, s75, v4
v_cvt_pk_bf16_f32 v234, v228, v229
v_mfma_f32_16x16x32_bf16 v[44:47], a[204:207], v[204:207], v[44:47]
s_mov_b32 m0, s70
v_exp_f32 v230, v230
v_mfma_f32_16x16x32_bf16 v[52:55], a[192:195], v[108:111], v[104:107]
buffer_load_dwordx4 v15, s[24:27], s64 offen offset:0 sc1 lds
v_mfma_f32_16x16x32_bf16 v[52:55], a[196:199], v[40:43], v[52:55]
s_add_u32 s75, s75, 16384
v_exp_f32 v231, v231
v_mfma_f32_16x16x32_bf16 v[52:55], a[200:203], v[80:83], v[52:55]
v_cvt_pk_bf16_f32 v235, v230, v231
v_mfma_f32_16x16x32_bf16 v[52:55], a[204:207], v[168:171], v[52:55]
s_cmp_ge_u32 s75, 163840
v_exp_f32 v44, v44
v_mfma_f32_16x16x32_bf16 v[64:67], a[208:211], v[36:39], v[112:115]
v_mfma_f32_16x16x32_bf16 v[64:67], a[212:215], v[32:35], v[64:67]
s_cselect_b32 s75, 0, s75
v_exp_f32 v45, v45
v_mfma_f32_16x16x32_bf16 v[64:67], a[216:219], v[196:199], v[64:67]
v_cvt_pk_bf16_f32 v124, v44, v45
v_mfma_f32_16x16x32_bf16 v[64:67], a[220:223], v[204:207], v[64:67]
s_add_u32 s68, s64, 16384
v_exp_f32 v46, v46
v_mfma_f32_16x16x32_bf16 v[212:215], a[208:211], v[108:111], v[120:123]
buffer_load_dwordx4 v15, s[24:27], s64 offen offset:1024 sc1 lds
v_mfma_f32_16x16x32_bf16 v[212:215], a[212:215], v[40:43], v[212:215]
s_add_u32 s70, s70, 16384
v_exp_f32 v47, v47
v_mfma_f32_16x16x32_bf16 v[212:215], a[216:219], v[80:83], v[212:215]
v_cvt_pk_bf16_f32 v125, v46, v47
v_mfma_f32_16x16x32_bf16 v[212:215], a[220:223], v[168:171], v[212:215]
v_exp_f32 v52, v52
v_mfma_f32_16x16x32_bf16 v[60:63], a[64:67], v[248:251], v[60:63]
v_mfma_f32_16x16x32_bf16 v[148:151], a[64:67], v[232:235], v[148:151]
s_cmp_ge_u32 s70, 163840
v_exp_f32 v53, v53
v_mfma_f32_16x16x32_bf16 v[48:51], a[68:71], v[232:235], v[48:51]
ds_read_b128 a[64:67], v5 offset:8192
v_cvt_pk_bf16_f32 v140, v52, v53
v_mfma_f32_16x16x32_bf16 v[68:71], a[68:71], v[248:251], v[68:71]
s_cselect_b32 s70, s80, s70
v_exp_f32 v54, v54
v_mfma_f32_16x16x32_bf16 v[72:75], a[72:75], v[248:251], v[72:75]
buffer_load_dwordx4 v15, s[24:27], s64 offen offset:2048 sc1 lds
v_mfma_f32_16x16x32_bf16 v[236:239], a[72:75], v[232:235], v[236:239]
v_exp_f32 v55, v55
v_mfma_f32_16x16x32_bf16 v[224:227], a[76:79], v[232:235], v[224:227]
ds_read_b128 a[68:71], v5 offset:9216
v_cvt_pk_bf16_f32 v141, v54, v55
v_mfma_f32_16x16x32_bf16 v[220:223], a[76:79], v[248:251], v[220:223]
v_exp_f32 v64, v64
v_mfma_f32_16x16x32_bf16 v[84:87], a[80:83], v[248:251], v[84:87]
ds_read_b128 a[72:75], v5 offset:10240
v_mfma_f32_16x16x32_bf16 v[164:167], a[80:83], v[232:235], v[164:167]
v_exp_f32 v65, v65
v_mfma_f32_16x16x32_bf16 v[156:159], a[84:87], v[232:235], v[156:159]
ds_read_b128 a[76:79], v5 offset:11264
v_cvt_pk_bf16_f32 v126, v64, v65
v_mfma_f32_16x16x32_bf16 v[76:79], a[84:87], v[248:251], v[76:79]
v_exp_f32 v66, v66
v_mfma_f32_16x16x32_bf16 v[160:163], a[88:91], v[248:251], v[160:163]
buffer_load_dwordx4 v15, s[24:27], s64 offen offset:3072 sc1 lds
v_mfma_f32_16x16x32_bf16 v[216:219], a[88:91], v[232:235], v[216:219]
v_exp_f32 v67, v67
v_mfma_f32_16x16x32_bf16 v[208:211], a[92:95], v[232:235], v[208:211]
ds_read_b128 a[80:83], v5 offset:12288
v_cvt_pk_bf16_f32 v127, v66, v67
v_mfma_f32_16x16x32_bf16 v[252:255], a[92:95], v[248:251], v[252:255]
v_exp_f32 v212, v212
v_mfma_f32_16x16x32_bf16 a[232:235], a[240:243], v[248:251], a[232:235]
ds_read_b128 a[84:87], v5 offset:13312
v_mfma_f32_16x16x32_bf16 a[236:239], a[240:243], v[232:235], a[236:239]
ds_read_b128 a[88:91], v5 offset:14336
v_mfma_f32_16x16x32_bf16 v[100:103], a[192:195], v[116:119], v[128:131]
ds_read_b128 a[92:95], v5 offset:15360
v_mfma_f32_16x16x32_bf16 v[100:103], a[196:199], v[132:135], v[100:103]
v_exp_f32 v213, v213
v_mfma_f32_16x16x32_bf16 v[100:103], a[200:203], v[184:187], v[100:103]
v_cvt_pk_bf16_f32 v142, v212, v213
v_mfma_f32_16x16x32_bf16 v[100:103], a[204:207], v[240:243], v[100:103]
v_exp_f32 v214, v214
v_mfma_f32_16x16x32_bf16 v[92:95], a[192:195], v[188:191], v[136:139]
s_nop 0
v_mfma_f32_16x16x32_bf16 v[92:95], a[196:199], v[56:59], v[92:95]
v_exp_f32 v215, v215
v_mfma_f32_16x16x32_bf16 v[92:95], a[200:203], v[88:91], v[92:95]
ds_read_b128 a[192:195], v5 offset:0
v_cvt_pk_bf16_f32 v143, v214, v215
v_mfma_f32_16x16x32_bf16 v[92:95], a[204:207], v[192:195], v[92:95]
v_exp_f32 v100, v100
v_mfma_f32_16x16x32_bf16 v[176:179], a[208:211], v[116:119], v[144:147]
ds_read_b128 a[196:199], v5 offset:1024
v_mfma_f32_16x16x32_bf16 v[176:179], a[212:215], v[132:135], v[176:179]
v_exp_f32 v101, v101
v_mfma_f32_16x16x32_bf16 v[176:179], a[216:219], v[184:187], v[176:179]
ds_read_b128 a[200:203], v5 offset:2048
v_cvt_pk_bf16_f32 v248, v100, v101
v_mfma_f32_16x16x32_bf16 v[176:179], a[220:223], v[240:243], v[176:179]
v_exp_f32 v102, v102
v_mfma_f32_16x16x32_bf16 v[228:231], a[208:211], v[188:191], v[152:155]
ds_read_b128 a[204:207], v5 offset:3072
v_mfma_f32_16x16x32_bf16 v[228:231], a[212:215], v[56:59], v[228:231]
v_exp_f32 v103, v103
v_mfma_f32_16x16x32_bf16 v[228:231], a[216:219], v[88:91], v[228:231]
ds_read_b128 a[208:211], v5 offset:4096
v_cvt_pk_bf16_f32 v249, v102, v103
v_mfma_f32_16x16x32_bf16 v[228:231], a[220:223], v[192:195], v[228:231]
s_waitcnt lgkmcnt(5)
v_exp_f32 v92, v92
v_mfma_f32_16x16x32_bf16 a[0:3], a[64:67], v[124:127], a[0:3]
ds_read_b128 a[212:215], v5 offset:5120
v_mfma_f32_16x16x32_bf16 a[32:35], a[64:67], v[140:143], a[32:35]
v_exp_f32 v93, v93
v_mfma_f32_16x16x32_bf16 a[36:39], a[68:71], v[140:143], a[36:39]
ds_read_b128 a[216:219], v5 offset:6144
v_cvt_pk_bf16_f32 v232, v92, v93
v_mfma_f32_16x16x32_bf16 a[4:7], a[68:71], v[124:127], a[4:7]
v_exp_f32 v94, v94
v_mfma_f32_16x16x32_bf16 a[8:11], a[72:75], v[124:127], a[8:11]
ds_read_b128 a[220:223], v5 offset:7168
v_mfma_f32_16x16x32_bf16 a[40:43], a[72:75], v[140:143], a[40:43]
s_add_u32 s72, s72, 1
v_exp_f32 v95, v95
v_mfma_f32_16x16x32_bf16 a[44:47], a[76:79], v[140:143], a[44:47]
v_cvt_pk_bf16_f32 v233, v94, v95
v_mfma_f32_16x16x32_bf16 a[12:15], a[76:79], v[124:127], a[12:15]
v_exp_f32 v176, v176
v_mfma_f32_16x16x32_bf16 a[16:19], a[80:83], v[124:127], a[16:19]
v_mfma_f32_16x16x32_bf16 a[48:51], a[80:83], v[140:143], a[48:51]
v_exp_f32 v177, v177
v_mfma_f32_16x16x32_bf16 a[52:55], a[84:87], v[140:143], a[52:55]
v_cvt_pk_bf16_f32 v250, v176, v177
v_mfma_f32_16x16x32_bf16 a[20:23], a[84:87], v[124:127], a[20:23]
v_exp_f32 v178, v178
v_mfma_f32_16x16x32_bf16 a[24:27], a[88:91], v[124:127], a[24:27]
v_mfma_f32_16x16x32_bf16 a[56:59], a[88:91], v[140:143], a[56:59]
s_cmp_lt_u32 s72, s74
v_exp_f32 v179, v179
v_mfma_f32_16x16x32_bf16 a[60:63], a[92:95], v[140:143], a[60:63]
v_cvt_pk_bf16_f32 v251, v178, v179
v_mfma_f32_16x16x32_bf16 a[28:31], a[92:95], v[124:127], a[28:31]
s_waitcnt vmcnt(8) lgkmcnt(0)
v_exp_f32 v228, v228
v_mfma_f32_16x16x32_bf16 a[224:227], a[240:243], v[124:127], a[224:227]
v_mfma_f32_16x16x32_bf16 a[228:231], a[240:243], v[140:143], a[228:231]
s_cbranch_scc1 L_DUAL
L_DISP:
s_cmp_eq_u32 s72, s93
s_cbranch_scc1 L_STOP
L_NE:
s_mov_b32 s74, s93
s_cmp_gt_u32 s72, s66
s_cbranch_scc1 L_SINGLE
v_cndmask_b32 v96, v96, v6, s[56:57]
v_cndmask_b32 v120, v120, v6, s[56:57]
v_mov_b32 v112, v6
v_cndmask_b32 v97, v97, v6, s[58:59]
v_cndmask_b32 v121, v121, v6, s[58:59]
v_mov_b32 v113, v6
v_cndmask_b32 v98, v98, v6, s[60:61]
v_cndmask_b32 v122, v122, v6, s[60:61]
v_mov_b32 v114, v6
v_cndmask_b32 v99, v99, v6, s[62:63]
v_cndmask_b32 v123, v123, v6, s[62:63]
v_mov_b32 v115, v6
s_mov_b32 s74, 0
s_branch L_DUAL
L_STOP:
s_cmp_eq_u32 s72, 9
s_cbranch_scc1 L_E1
s_cmp_lg_u32 s72, 11
s_cbranch_scc1 L_SE
v_cmp_gt_u32 vcc, 32, v172
s_mov_b32 s73, 32
s_min_u32 s93, s73, s69
s_min_u32 s74, s93, s66
v_accvgpr_read_b32 v16, a244
v_accvgpr_read_b32 v17, a248
v_accvgpr_read_b32 v18, a252
s_cbranch_vccnz CK_Q
CK_Q_R:
buffer_load_dwordx4 a[244:247], v16, s[24:27], 0 offen sc1
buffer_load_dwordx4 a[248:251], v17, s[24:27], 0 offen sc1
buffer_load_dwordx4 a[252:255], v18, s[24:27], 0 offen sc1
s_cmp_lt_u32 s72, s66
s_cbranch_scc1 L_DUAL
s_mov_b32 s74, s93
s_cmp_gt_u32 s72, s66
s_cbranch_scc1 L_SINGLE
s_branch L_NE
L_E1:
buffer_load_dword v172, v28, s[24:27], 0 offen sc1
s_mov_b32 s73, 11
buffer_store_dwordx4 v[0:3], v4, s[44:47], s90 offen sc1
buffer_store_dwordx4 v[0:3], v4, s[44:47], s90 offen offset:1024 sc1
buffer_store_dword v0, v31, s[44:47], s90 offen offset:2048 sc1
s_min_u32 s93, s73, s69
s_min_u32 s74, s93, s66
s_cmp_lt_u32 s72, s66
s_cbranch_scc1 L_DUAL
s_mov_b32 s74, s93
s_cmp_gt_u32 s72, s66
s_cbranch_scc1 L_SINGLE
s_branch L_NE
L_SE:
s_mov_b32 s69, 64
s_nop 1
v_accvgpr_read_b32 v180, a224
v_accvgpr_read_b32 v182, a228
v_cmp_nle_f32 vcc, v180, v7
v_cmp_nle_f32 s[96:97], v182, v7
s_nop 3
s_or_b64 vcc, vcc, s[96:97]
s_cbranch_vccnz L_NS
s_add_u32 s53, s77, 163840
buffer_load_dwordx4 a[96:99], v15, s[24:27], s53 offen offset:0 sc1
v_mul_f32 v8, 0x3fb8aa3b, v8
v_mul_f32 v9, 0x3fb8aa3b, v9
v_exp_f32 v8, v8
v_exp_f32 v9, v9
s_nop 0
v_fma_f32 v180, v180, v8, v180
v_fma_f32 v182, v182, v9, v182
v_rcp_f32 v180, v180
v_rcp_f32 v182, v182
s_add_u32 s52, s78, 4096
v_mov_b32 v181, v180
v_mov_b32 v183, v182
v_accvgpr_read_b32 v16, a0
v_accvgpr_read_b32 v17, a1
v_accvgpr_read_b32 v18, a2
v_accvgpr_read_b32 v19, a3
v_accvgpr_read_b32 v20, a4
v_accvgpr_read_b32 v21, a5
buffer_load_dwordx4 a[100:103], v15, s[24:27], s53 offen offset:1024 sc1
v_accvgpr_read_b32 v22, a6
v_accvgpr_read_b32 v23, a7
v_pk_mul_f32 v[16:17], v[16:17], v[180:181]
v_pk_mul_f32 v[18:19], v[18:19], v[180:181]
v_pk_mul_f32 v[20:21], v[20:21], v[180:181]
v_pk_mul_f32 v[22:23], v[22:23], v[180:181]
v_cvt_pk_bf16_f32 v16, v16, v17
v_cvt_pk_bf16_f32 v17, v18, v19
v_cvt_pk_bf16_f32 v18, v20, v21
v_cvt_pk_bf16_f32 v19, v22, v23
buffer_store_dwordx4 v[16:19], v15, s[24:27], s78 offen offset:0 sc1
v_accvgpr_read_b32 v24, a32
v_accvgpr_read_b32 v25, a33
v_accvgpr_read_b32 v26, a34
v_accvgpr_read_b32 v27, a35
v_accvgpr_read_b32 v28, a36
v_accvgpr_read_b32 v29, a37
v_accvgpr_read_b32 v30, a38
buffer_load_dwordx4 a[104:107], v15, s[24:27], s53 offen offset:2048 sc1
v_accvgpr_read_b32 v31, a39
v_pk_mul_f32 v[24:25], v[24:25], v[182:183]
v_pk_mul_f32 v[26:27], v[26:27], v[182:183]
v_pk_mul_f32 v[28:29], v[28:29], v[182:183]
v_pk_mul_f32 v[30:31], v[30:31], v[182:183]
v_cvt_pk_bf16_f32 v24, v24, v25
v_cvt_pk_bf16_f32 v25, v26, v27
v_cvt_pk_bf16_f32 v26, v28, v29
v_cvt_pk_bf16_f32 v27, v30, v31
buffer_store_dwordx4 v[24:27], v15, s[24:27], s78 offen offset:1024 sc1
v_accvgpr_read_b32 v16, a8
v_accvgpr_read_b32 v17, a9
v_accvgpr_read_b32 v18, a10
v_accvgpr_read_b32 v19, a11
v_accvgpr_read_b32 v20, a12
v_accvgpr_read_b32 v21, a13
v_accvgpr_read_b32 v22, a14
v_accvgpr_read_b32 v23, a15
buffer_load_dwordx4 a[108:111], v15, s[24:27], s53 offen offset:3072 sc1
v_pk_mul_f32 v[16:17], v[16:17], v[180:181]
v_pk_mul_f32 v[18:19], v[18:19], v[180:181]
v_pk_mul_f32 v[20:21], v[20:21], v[180:181]
v_pk_mul_f32 v[22:23], v[22:23], v[180:181]
v_cvt_pk_bf16_f32 v16, v16, v17
v_cvt_pk_bf16_f32 v17, v18, v19
v_cvt_pk_bf16_f32 v18, v20, v21
v_cvt_pk_bf16_f32 v19, v22, v23
buffer_store_dwordx4 v[16:19], v15, s[24:27], s78 offen offset:2048 sc1
v_accvgpr_read_b32 v24, a40
v_accvgpr_read_b32 v25, a41
v_accvgpr_read_b32 v26, a42
v_accvgpr_read_b32 v27, a43
v_accvgpr_read_b32 v28, a44
v_accvgpr_read_b32 v29, a45
v_accvgpr_read_b32 v30, a46
v_accvgpr_read_b32 v31, a47
v_pk_mul_f32 v[24:25], v[24:25], v[182:183]
s_add_u32 s53, s77, 180224
buffer_load_dwordx4 a[112:115], v15, s[24:27], s53 offen offset:0 sc1
v_pk_mul_f32 v[26:27], v[26:27], v[182:183]
v_pk_mul_f32 v[28:29], v[28:29], v[182:183]
v_pk_mul_f32 v[30:31], v[30:31], v[182:183]
v_cvt_pk_bf16_f32 v24, v24, v25
v_cvt_pk_bf16_f32 v25, v26, v27
v_cvt_pk_bf16_f32 v26, v28, v29
v_cvt_pk_bf16_f32 v27, v30, v31
buffer_store_dwordx4 v[24:27], v15, s[24:27], s78 offen offset:3072 sc1
v_accvgpr_read_b32 v16, a16
v_accvgpr_read_b32 v17, a17
v_accvgpr_read_b32 v18, a18
v_accvgpr_read_b32 v19, a19
v_accvgpr_read_b32 v20, a20
v_accvgpr_read_b32 v21, a21
v_accvgpr_read_b32 v22, a22
v_accvgpr_read_b32 v23, a23
v_pk_mul_f32 v[16:17], v[16:17], v[180:181]
v_pk_mul_f32 v[18:19], v[18:19], v[180:181]
buffer_load_dwordx4 a[116:119], v15, s[24:27], s53 offen offset:1024 sc1
v_pk_mul_f32 v[20:21], v[20:21], v[180:181]
v_pk_mul_f32 v[22:23], v[22:23], v[180:181]
v_cvt_pk_bf16_f32 v16, v16, v17
v_cvt_pk_bf16_f32 v17, v18, v19
v_cvt_pk_bf16_f32 v18, v20, v21
v_cvt_pk_bf16_f32 v19, v22, v23
buffer_store_dwordx4 v[16:19], v15, s[24:27], s52 offen offset:0 sc1
v_accvgpr_read_b32 v24, a48
v_accvgpr_read_b32 v25, a49
v_accvgpr_read_b32 v26, a50
v_accvgpr_read_b32 v27, a51
v_accvgpr_read_b32 v28, a52
v_accvgpr_read_b32 v29, a53
v_accvgpr_read_b32 v30, a54
v_accvgpr_read_b32 v31, a55
v_pk_mul_f32 v[24:25], v[24:25], v[182:183]
v_pk_mul_f32 v[26:27], v[26:27], v[182:183]
v_pk_mul_f32 v[28:29], v[28:29], v[182:183]
buffer_load_dwordx4 a[120:123], v15, s[24:27], s53 offen offset:2048 sc1
v_pk_mul_f32 v[30:31], v[30:31], v[182:183]
v_cvt_pk_bf16_f32 v24, v24, v25
v_cvt_pk_bf16_f32 v25, v26, v27
v_cvt_pk_bf16_f32 v26, v28, v29
v_cvt_pk_bf16_f32 v27, v30, v31
buffer_store_dwordx4 v[24:27], v15, s[24:27], s52 offen offset:1024 sc1
v_accvgpr_read_b32 v16, a24
v_accvgpr_read_b32 v17, a25
v_accvgpr_read_b32 v18, a26
v_accvgpr_read_b32 v19, a27
v_accvgpr_read_b32 v20, a28
v_accvgpr_read_b32 v21, a29
v_accvgpr_read_b32 v22, a30
v_accvgpr_read_b32 v23, a31
v_pk_mul_f32 v[16:17], v[16:17], v[180:181]
v_pk_mul_f32 v[18:19], v[18:19], v[180:181]
v_pk_mul_f32 v[20:21], v[20:21], v[180:181]
v_pk_mul_f32 v[22:23], v[22:23], v[180:181]
buffer_load_dwordx4 a[124:127], v15, s[24:27], s53 offen offset:3072 sc1
v_cvt_pk_bf16_f32 v16, v16, v17
v_cvt_pk_bf16_f32 v17, v18, v19
v_cvt_pk_bf16_f32 v18, v20, v21
v_cvt_pk_bf16_f32 v19, v22, v23
buffer_store_dwordx4 v[16:19], v15, s[24:27], s52 offen offset:2048 sc1
v_accvgpr_read_b32 v24, a56
v_accvgpr_read_b32 v25, a57
v_accvgpr_read_b32 v26, a58
v_accvgpr_read_b32 v27, a59
v_accvgpr_read_b32 v28, a60
v_accvgpr_read_b32 v29, a61
v_accvgpr_read_b32 v30, a62
v_accvgpr_read_b32 v31, a63
v_pk_mul_f32 v[24:25], v[24:25], v[182:183]
v_pk_mul_f32 v[26:27], v[26:27], v[182:183]
v_pk_mul_f32 v[28:29], v[28:29], v[182:183]
v_pk_mul_f32 v[30:31], v[30:31], v[182:183]
v_cvt_pk_bf16_f32 v24, v24, v25
v_cvt_pk_bf16_f32 v25, v26, v27
v_cvt_pk_bf16_f32 v26, v28, v29
v_cvt_pk_bf16_f32 v27, v30, v31
buffer_store_dwordx4 v[24:27], v15, s[24:27], s52 offen offset:3072 sc1
L_PAD9:
s_cbranch_execz L_PAD13
s_mov_b32 s76, 1
L_NS:
s_mov_b32 s74, s73
s_mov_b32 s93, s73
s_cmp_eq_u32 s72, 32
s_cbranch_scc1 L_FIN
L_SINGLE:
v_mfma_f32_16x16x32_bf16 v[44:47], a[192:195], v[116:119], v[128:131]
s_barrier
v_mfma_f32_16x16x32_bf16 v[44:47], a[196:199], v[132:135], v[44:47]
s_cmp_eq_u32 s68, s71
v_exp_f32 v229, v229
v_mfma_f32_16x16x32_bf16 v[44:47], a[200:203], v[184:187], v[44:47]
s_cselect_b32 s64, s77, s68
v_add_u32 v5, s75, v4
v_cvt_pk_bf16_f32 v234, v228, v229
v_mfma_f32_16x16x32_bf16 v[44:47], a[204:207], v[240:243], v[44:47]
s_mov_b32 m0, s70
v_exp_f32 v230, v230
v_mfma_f32_16x16x32_bf16 v[52:55], a[192:195], v[188:191], v[136:139]
buffer_load_dwordx4 v15, s[24:27], s64 offen offset:0 sc1 lds
v_mfma_f32_16x16x32_bf16 v[52:55], a[196:199], v[56:59], v[52:55]
s_add_u32 s75, s75, 16384
v_exp_f32 v231, v231
v_mfma_f32_16x16x32_bf16 v[52:55], a[200:203], v[88:91], v[52:55]
ds_read_b128 a[192:195], v5 offset:0
v_cvt_pk_bf16_f32 v235, v230, v231
v_mfma_f32_16x16x32_bf16 v[52:55], a[204:207], v[192:195], v[52:55]
s_cmp_ge_u32 s75, 163840
v_exp_f32 v44, v44
v_mfma_f32_16x16x32_bf16 v[64:67], a[208:211], v[116:119], v[144:147]
ds_read_b128 a[196:199], v5 offset:1024
ds_read_b128 a[200:203], v5 offset:2048
v_mfma_f32_16x16x32_bf16 v[64:67], a[212:215], v[132:135], v[64:67]
s_cselect_b32 s75, 0, s75
v_exp_f32 v45, v45
v_mfma_f32_16x16x32_bf16 v[64:67], a[216:219], v[184:187], v[64:67]
ds_read_b128 a[204:207], v5 offset:3072
v_cvt_pk_bf16_f32 v124, v44, v45
v_mfma_f32_16x16x32_bf16 v[64:67], a[220:223], v[240:243], v[64:67]
s_add_u32 s68, s64, 16384
v_exp_f32 v46, v46
v_mfma_f32_16x16x32_bf16 v[212:215], a[208:211], v[188:191], v[152:155]
buffer_load_dwordx4 v15, s[24:27], s64 offen offset:1024 sc1 lds
v_mfma_f32_16x16x32_bf16 v[212:215], a[212:215], v[56:59], v[212:215]
s_add_u32 s70, s70, 16384
v_exp_f32 v47, v47
v_mfma_f32_16x16x32_bf16 v[212:215], a[216:219], v[88:91], v[212:215]
ds_read_b128 a[208:211], v5 offset:4096
v_cvt_pk_bf16_f32 v125, v46, v47
v_mfma_f32_16x16x32_bf16 v[212:215], a[220:223], v[192:195], v[212:215]
s_waitcnt lgkmcnt(5)
v_exp_f32 v52, v52
v_mfma_f32_16x16x32_bf16 v[60:63], a[64:67], v[248:251], v[60:63]
ds_read_b128 a[212:215], v5 offset:5120
ds_read_b128 a[216:219], v5 offset:6144
v_mfma_f32_16x16x32_bf16 v[148:151], a[64:67], v[232:235], v[148:151]
s_cmp_ge_u32 s70, 163840
v_exp_f32 v53, v53
v_mfma_f32_16x16x32_bf16 v[48:51], a[68:71], v[232:235], v[48:51]
ds_read_b128 a[220:223], v5 offset:7168
v_cvt_pk_bf16_f32 v140, v52, v53
v_mfma_f32_16x16x32_bf16 v[68:71], a[68:71], v[248:251], v[68:71]
s_cselect_b32 s70, s80, s70
v_exp_f32 v54, v54
v_mfma_f32_16x16x32_bf16 v[72:75], a[72:75], v[248:251], v[72:75]
buffer_load_dwordx4 v15, s[24:27], s64 offen offset:2048 sc1 lds
v_mfma_f32_16x16x32_bf16 v[236:239], a[72:75], v[232:235], v[236:239]
v_exp_f32 v55, v55
v_mfma_f32_16x16x32_bf16 v[224:227], a[76:79], v[232:235], v[224:227]
ds_read_b128 a[64:67], v5 offset:8192
v_cvt_pk_bf16_f32 v141, v54, v55
v_mfma_f32_16x16x32_bf16 v[220:223], a[76:79], v[248:251], v[220:223]
v_exp_f32 v64, v64
v_mfma_f32_16x16x32_bf16 v[84:87], a[80:83], v[248:251], v[84:87]
ds_read_b128 a[68:71], v5 offset:9216
ds_read_b128 a[72:75], v5 offset:10240
v_mfma_f32_16x16x32_bf16 v[164:167], a[80:83], v[232:235], v[164:167]
v_exp_f32 v65, v65
v_mfma_f32_16x16x32_bf16 v[156:159], a[84:87], v[232:235], v[156:159]
ds_read_b128 a[76:79], v5 offset:11264
v_cvt_pk_bf16_f32 v126, v64, v65
v_mfma_f32_16x16x32_bf16 v[76:79], a[84:87], v[248:251], v[76:79]
s_cmp_eq_u32 s68, s71
v_exp_f32 v66, v66
v_mfma_f32_16x16x32_bf16 v[160:163], a[88:91], v[248:251], v[160:163]
buffer_load_dwordx4 v15, s[24:27], s64 offen offset:3072 sc1 lds
v_mfma_f32_16x16x32_bf16 v[216:219], a[88:91], v[232:235], v[216:219]
s_cselect_b32 s64, s77, s68
v_exp_f32 v67, v67
v_mfma_f32_16x16x32_bf16 v[208:211], a[92:95], v[232:235], v[208:211]
ds_read_b128 a[80:83], v5 offset:12288
v_cvt_pk_bf16_f32 v127, v66, v67
v_mfma_f32_16x16x32_bf16 v[252:255], a[92:95], v[248:251], v[252:255]
s_waitcnt lgkmcnt(5)
v_exp_f32 v212, v212
v_mfma_f32_16x16x32_bf16 a[232:235], a[240:243], v[248:251], a[232:235]
ds_read_b128 a[84:87], v5 offset:13312
ds_read_b128 a[88:91], v5 offset:14336
v_mfma_f32_16x16x32_bf16 a[236:239], a[240:243], v[232:235], a[236:239]
s_mov_b32 m0, s70
ds_read_b128 a[92:95], v5 offset:15360
v_mfma_f32_16x16x32_bf16 v[100:103], a[192:195], v[116:119], v[128:131]
buffer_load_dwordx4 v15, s[24:27], s64 offen offset:0 sc1 lds
v_mfma_f32_16x16x32_bf16 v[100:103], a[196:199], v[132:135], v[100:103]
v_exp_f32 v213, v213
v_mfma_f32_16x16x32_bf16 v[100:103], a[200:203], v[184:187], v[100:103]
v_add_u32 v5, s75, v4
v_cvt_pk_bf16_f32 v142, v212, v213
v_mfma_f32_16x16x32_bf16 v[100:103], a[204:207], v[240:243], v[100:103]
v_exp_f32 v214, v214
v_mfma_f32_16x16x32_bf16 v[92:95], a[192:195], v[188:191], v[136:139]
buffer_load_dwordx4 v15, s[24:27], s64 offen offset:1024 sc1 lds
v_mfma_f32_16x16x32_bf16 v[92:95], a[196:199], v[56:59], v[92:95]
s_add_u32 s75, s75, 16384
v_exp_f32 v215, v215
v_mfma_f32_16x16x32_bf16 v[92:95], a[200:203], v[88:91], v[92:95]
ds_read_b128 a[192:195], v5 offset:0
v_cvt_pk_bf16_f32 v143, v214, v215
v_mfma_f32_16x16x32_bf16 v[92:95], a[204:207], v[192:195], v[92:95]
s_cmp_ge_u32 s75, 163840
v_exp_f32 v100, v100
v_mfma_f32_16x16x32_bf16 v[176:179], a[208:211], v[116:119], v[144:147]
ds_read_b128 a[196:199], v5 offset:1024
ds_read_b128 a[200:203], v5 offset:2048
v_mfma_f32_16x16x32_bf16 v[176:179], a[212:215], v[132:135], v[176:179]
s_cselect_b32 s75, 0, s75
v_exp_f32 v101, v101
v_mfma_f32_16x16x32_bf16 v[176:179], a[216:219], v[184:187], v[176:179]
ds_read_b128 a[204:207], v5 offset:3072
v_cvt_pk_bf16_f32 v248, v100, v101
v_mfma_f32_16x16x32_bf16 v[176:179], a[220:223], v[240:243], v[176:179]
s_add_u32 s68, s64, 16384
v_exp_f32 v102, v102
v_mfma_f32_16x16x32_bf16 v[228:231], a[208:211], v[188:191], v[152:155]
buffer_load_dwordx4 v15, s[24:27], s64 offen offset:2048 sc1 lds
v_mfma_f32_16x16x32_bf16 v[228:231], a[212:215], v[56:59], v[228:231]
s_add_u32 s70, s70, 16384
v_exp_f32 v103, v103
v_mfma_f32_16x16x32_bf16 v[228:231], a[216:219], v[88:91], v[228:231]
ds_read_b128 a[208:211], v5 offset:4096
v_cvt_pk_bf16_f32 v249, v102, v103
v_mfma_f32_16x16x32_bf16 v[228:231], a[220:223], v[192:195], v[228:231]
s_waitcnt lgkmcnt(5)
v_exp_f32 v92, v92
v_mfma_f32_16x16x32_bf16 v[60:63], a[64:67], v[124:127], v[60:63]
ds_read_b128 a[212:215], v5 offset:5120
ds_read_b128 a[216:219], v5 offset:6144
v_mfma_f32_16x16x32_bf16 v[148:151], a[64:67], v[140:143], v[148:151]
s_cmp_ge_u32 s70, 163840
v_exp_f32 v93, v93
v_mfma_f32_16x16x32_bf16 v[48:51], a[68:71], v[140:143], v[48:51]
ds_read_b128 a[220:223], v5 offset:7168
v_cvt_pk_bf16_f32 v232, v92, v93
v_mfma_f32_16x16x32_bf16 v[68:71], a[68:71], v[124:127], v[68:71]
s_cselect_b32 s70, s80, s70
v_exp_f32 v94, v94
v_mfma_f32_16x16x32_bf16 v[72:75], a[72:75], v[124:127], v[72:75]
buffer_load_dwordx4 v15, s[24:27], s64 offen offset:3072 sc1 lds
v_mfma_f32_16x16x32_bf16 v[236:239], a[72:75], v[140:143], v[236:239]
s_add_u32 s72, s72, 1
v_exp_f32 v95, v95
v_mfma_f32_16x16x32_bf16 v[224:227], a[76:79], v[140:143], v[224:227]
ds_read_b128 a[64:67], v5 offset:8192
v_cvt_pk_bf16_f32 v233, v94, v95
v_mfma_f32_16x16x32_bf16 v[220:223], a[76:79], v[124:127], v[220:223]
v_exp_f32 v176, v176
v_mfma_f32_16x16x32_bf16 v[84:87], a[80:83], v[124:127], v[84:87]
ds_read_b128 a[68:71], v5 offset:9216
ds_read_b128 a[72:75], v5 offset:10240
v_mfma_f32_16x16x32_bf16 v[164:167], a[80:83], v[140:143], v[164:167]
v_exp_f32 v177, v177
v_mfma_f32_16x16x32_bf16 v[156:159], a[84:87], v[140:143], v[156:159]
ds_read_b128 a[76:79], v5 offset:11264
v_cvt_pk_bf16_f32 v250, v176, v177
v_mfma_f32_16x16x32_bf16 v[76:79], a[84:87], v[124:127], v[76:79]
v_exp_f32 v178, v178
v_mfma_f32_16x16x32_bf16 v[160:163], a[88:91], v[124:127], v[160:163]
ds_read_b128 a[80:83], v5 offset:12288
ds_read_b128 a[84:87], v5 offset:13312
v_mfma_f32_16x16x32_bf16 v[216:219], a[88:91], v[140:143], v[216:219]
s_cmp_lt_u32 s72, s74
v_exp_f32 v179, v179
v_mfma_f32_16x16x32_bf16 v[208:211], a[92:95], v[140:143], v[208:211]
ds_read_b128 a[88:91], v5 offset:14336
v_cvt_pk_bf16_f32 v251, v178, v179
v_mfma_f32_16x16x32_bf16 v[252:255], a[92:95], v[124:127], v[252:255]
s_waitcnt vmcnt(8) lgkmcnt(7)
v_exp_f32 v228, v228
v_mfma_f32_16x16x32_bf16 a[232:235], a[240:243], v[124:127], a[232:235]
ds_read_b128 a[92:95], v5 offset:15360
v_mfma_f32_16x16x32_bf16 a[236:239], a[240:243], v[140:143], a[236:239]
s_cbranch_scc1 L_SINGLE
s_cmp_eq_u32 s72, s69
s_cbranch_scc1 L_SE
s_cmp_lt_u32 s72, 32
s_cbranch_scc1 L_STOP
L_FIN:
s_add_u32 s53, s77, 196608
buffer_load_dwordx4 a[160:163], v15, s[24:27], s53 offen offset:0 sc1
v_cndmask_b32 v128, v128, v6, s[56:57]
v_cndmask_b32 v152, v152, v6, s[56:57]
v_mov_b32 v144, v6
buffer_load_dwordx4 a[164:167], v15, s[24:27], s53 offen offset:1024 sc1
v_cndmask_b32 v129, v129, v6, s[58:59]
v_cndmask_b32 v153, v153, v6, s[58:59]
v_mov_b32 v145, v6
buffer_load_dwordx4 a[168:171], v15, s[24:27], s53 offen offset:2048 sc1
v_cndmask_b32 v130, v130, v6, s[60:61]
v_cndmask_b32 v154, v154, v6, s[60:61]
v_mov_b32 v146, v6
buffer_load_dwordx4 a[172:175], v15, s[24:27], s53 offen offset:3072 sc1
v_cndmask_b32 v131, v131, v6, s[62:63]
v_cndmask_b32 v155, v155, v6, s[62:63]
v_mov_b32 v147, v6
s_mov_b32 s83, s75
s_sub_u32 s91, s70, s80
v_mfma_f32_16x16x32_bf16 v[44:47], a[192:195], v[116:119], v[128:131]
s_barrier
v_mfma_f32_16x16x32_bf16 v[44:47], a[196:199], v[132:135], v[44:47]
s_mov_b32 m0, s70
v_exp_f32 v229, v229
v_mfma_f32_16x16x32_bf16 v[44:47], a[200:203], v[184:187], v[44:47]
s_mov_b32 s64, s68
v_add_u32 v5, s75, v4
v_cvt_pk_bf16_f32 v234, v228, v229
v_mfma_f32_16x16x32_bf16 v[44:47], a[204:207], v[240:243], v[44:47]
s_add_u32 s68, s68, 16384
v_exp_f32 v230, v230
v_mfma_f32_16x16x32_bf16 v[52:55], a[192:195], v[188:191], v[136:139]
buffer_load_dwordx4 v15, s[24:27], s64 offen offset:0 sc1 lds
v_mfma_f32_16x16x32_bf16 v[52:55], a[196:199], v[56:59], v[52:55]
s_add_u32 s70, s70, 16384
v_exp_f32 v231, v231
v_mfma_f32_16x16x32_bf16 v[52:55], a[200:203], v[88:91], v[52:55]
v_cvt_pk_bf16_f32 v235, v230, v231
v_mul_f32 v10, 0x3fb8aa3b, v10
v_mfma_f32_16x16x32_bf16 v[52:55], a[204:207], v[192:195], v[52:55]
s_cmp_ge_u32 s70, 163840
v_exp_f32 v44, v44
v_mfma_f32_16x16x32_bf16 v[64:67], a[208:211], v[116:119], v[144:147]
buffer_load_dwordx4 v15, s[24:27], s64 offen offset:1024 sc1 lds
v_mfma_f32_16x16x32_bf16 v[64:67], a[212:215], v[132:135], v[64:67]
s_cselect_b32 s70, s80, s70
v_exp_f32 v45, v45
v_mfma_f32_16x16x32_bf16 v[64:67], a[216:219], v[184:187], v[64:67]
v_cvt_pk_bf16_f32 v124, v44, v45
v_mul_f32 v11, 0x3fb8aa3b, v11
v_mfma_f32_16x16x32_bf16 v[64:67], a[220:223], v[240:243], v[64:67]
v_exp_f32 v46, v46
v_mfma_f32_16x16x32_bf16 v[212:215], a[208:211], v[188:191], v[152:155]
buffer_load_dwordx4 v15, s[24:27], s64 offen offset:2048 sc1 lds
v_mfma_f32_16x16x32_bf16 v[212:215], a[212:215], v[56:59], v[212:215]
v_exp_f32 v47, v47
v_mfma_f32_16x16x32_bf16 v[212:215], a[216:219], v[88:91], v[212:215]
v_cvt_pk_bf16_f32 v125, v46, v47
v_mfma_f32_16x16x32_bf16 v[212:215], a[220:223], v[192:195], v[212:215]
s_waitcnt lgkmcnt(0)
v_exp_f32 v52, v52
v_mfma_f32_16x16x32_bf16 v[60:63], a[64:67], v[248:251], v[60:63]
buffer_load_dwordx4 v15, s[24:27], s64 offen offset:3072 sc1 lds
v_mfma_f32_16x16x32_bf16 v[148:151], a[64:67], v[232:235], v[148:151]
s_mov_b32 m0, s70
v_exp_f32 v53, v53
v_mfma_f32_16x16x32_bf16 v[48:51], a[68:71], v[232:235], v[48:51]
s_mov_b32 s64, s68
ds_read_b128 a[64:67], v5 offset:8192
v_cvt_pk_bf16_f32 v140, v52, v53
v_mfma_f32_16x16x32_bf16 v[68:71], a[68:71], v[248:251], v[68:71]
s_add_u32 s68, s68, 16384
v_exp_f32 v54, v54
v_mfma_f32_16x16x32_bf16 v[72:75], a[72:75], v[248:251], v[72:75]
buffer_load_dwordx4 v15, s[24:27], s64 offen offset:0 sc1 lds
v_mfma_f32_16x16x32_bf16 v[236:239], a[72:75], v[232:235], v[236:239]
s_add_u32 s70, s70, 16384
v_exp_f32 v55, v55
v_mfma_f32_16x16x32_bf16 v[224:227], a[76:79], v[232:235], v[224:227]
ds_read_b128 a[68:71], v5 offset:9216
v_cvt_pk_bf16_f32 v141, v54, v55
v_mfma_f32_16x16x32_bf16 v[220:223], a[76:79], v[248:251], v[220:223]
s_cmp_ge_u32 s70, 163840
v_exp_f32 v64, v64
v_mfma_f32_16x16x32_bf16 v[84:87], a[80:83], v[248:251], v[84:87]
ds_read_b128 a[72:75], v5 offset:10240
v_mfma_f32_16x16x32_bf16 v[164:167], a[80:83], v[232:235], v[164:167]
s_cselect_b32 s70, s80, s70
v_exp_f32 v65, v65
v_mfma_f32_16x16x32_bf16 v[156:159], a[84:87], v[232:235], v[156:159]
ds_read_b128 a[76:79], v5 offset:11264
v_cvt_pk_bf16_f32 v126, v64, v65
v_mfma_f32_16x16x32_bf16 v[76:79], a[84:87], v[248:251], v[76:79]
v_exp_f32 v66, v66
v_mfma_f32_16x16x32_bf16 v[160:163], a[88:91], v[248:251], v[160:163]
buffer_load_dwordx4 v15, s[24:27], s64 offen offset:1024 sc1 lds
v_mfma_f32_16x16x32_bf16 v[216:219], a[88:91], v[232:235], v[216:219]
s_add_u32 s52, s79, 4096
v_exp_f32 v67, v67
v_mfma_f32_16x16x32_bf16 v[208:211], a[92:95], v[232:235], v[208:211]
ds_read_b128 a[80:83], v5 offset:12288
v_cvt_pk_bf16_f32 v127, v66, v67
v_mfma_f32_16x16x32_bf16 v[252:255], a[92:95], v[248:251], v[252:255]
v_exp_f32 v212, v212
v_mfma_f32_16x16x32_bf16 a[232:235], a[240:243], v[248:251], a[232:235]
ds_read_b128 a[84:87], v5 offset:13312
ds_read_b128 a[88:91], v5 offset:14336
v_mfma_f32_16x16x32_bf16 a[236:239], a[240:243], v[232:235], a[236:239]
ds_read_b128 a[92:95], v5 offset:15360
v_exp_f32 v213, v213
v_exp_f32 v214, v214
v_exp_f32 v215, v215
v_exp_f32 v10, v10
v_cvt_pk_bf16_f32 v142, v212, v213
v_cvt_pk_bf16_f32 v143, v214, v215
v_exp_f32 v11, v11
s_waitcnt lgkmcnt(0)
v_mfma_f32_16x16x32_bf16 a[232:235], a[240:243], v[124:127], a[232:235]
buffer_load_dwordx4 v15, s[24:27], s64 offen offset:2048 sc1 lds
v_mfma_f32_16x16x32_bf16 a[236:239], a[240:243], v[140:143], a[236:239]
s_barrier
v_mfma_f32_16x16x32_bf16 v[60:63], a[64:67], v[124:127], v[60:63]
v_cmp_eq_u32 vcc, 0, v3
v_mul_u32_u24 v244, 1536, v3
v_mfma_f32_16x16x32_bf16 v[148:151], a[64:67], v[140:143], v[148:151]
v_mov_b32 v246, 9728
v_cndmask_b32 v244, v244, v246, vcc
v_mfma_f32_16x16x32_bf16 v[48:51], a[68:71], v[140:143], v[48:51]
buffer_load_dwordx4 v15, s[24:27], s64 offen offset:3072 sc1 lds
v_mfma_f32_16x16x32_bf16 v[68:71], a[68:71], v[124:127], v[68:71]
v_lshl_add_u32 v247, v2, 4, s83
v_mov_b32 v246, 10496
v_mfma_f32_16x16x32_bf16 v[72:75], a[72:75], v[124:127], v[72:75]
v_accvgpr_read_b32 v180, a232
v_accvgpr_read_b32 v182, a236
v_mfma_f32_16x16x32_bf16 v[236:239], a[72:75], v[140:143], v[236:239]
v_cmp_nle_f32 vcc, v180, v7
v_cmp_nle_f32 s[96:97], v182, v7
v_mfma_f32_16x16x32_bf16 v[224:227], a[76:79], v[140:143], v[224:227]
v_fma_f32 v180, v180, v10, v180
v_fma_f32 v182, v182, v11, v182
v_mfma_f32_16x16x32_bf16 v[220:223], a[76:79], v[124:127], v[220:223]
v_rcp_f32 v180, v180
v_mfma_f32_16x16x32_bf16 v[84:87], a[80:83], v[124:127], v[84:87]
s_or_b64 vcc, vcc, s[96:97]
v_rcp_f32 v182, v182
v_mfma_f32_16x16x32_bf16 v[164:167], a[80:83], v[140:143], v[164:167]
v_mul_f32 v60, v180, v60
v_mul_f32 v61, v180, v61
v_mfma_f32_16x16x32_bf16 v[156:159], a[84:87], v[140:143], v[156:159]
v_mul_f32 v62, v180, v62
v_mul_f32 v63, v180, v63
v_mfma_f32_16x16x32_bf16 v[76:79], a[84:87], v[124:127], v[76:79]
v_mul_f32 v68, v180, v68
v_mul_f32 v69, v180, v69
v_mfma_f32_16x16x32_bf16 v[160:163], a[88:91], v[124:127], v[160:163]
v_mul_f32 v70, v180, v70
v_mul_f32 v71, v180, v71
v_mfma_f32_16x16x32_bf16 v[216:219], a[88:91], v[140:143], v[216:219]
v_cvt_pk_bf16_f32 v60, v60, v61
v_cvt_pk_bf16_f32 v61, v62, v63
v_mfma_f32_16x16x32_bf16 v[208:211], a[92:95], v[140:143], v[208:211]
v_cvt_pk_bf16_f32 v62, v68, v69
v_cvt_pk_bf16_f32 v63, v70, v71
v_mfma_f32_16x16x32_bf16 v[252:255], a[92:95], v[124:127], v[252:255]
s_cbranch_vccnz SLOW1
L_EP:
buffer_store_dwordx4 v[60:63], v15, s[24:27], s79 offen offset:0 sc1
v_pk_mul_f32 v[148:149], v[148:149], v[182:183] op_sel_hi:[1,0]
v_pk_mul_f32 v[150:151], v[150:151], v[182:183] op_sel_hi:[1,0]
v_pk_mul_f32 v[48:49], v[48:49], v[182:183] op_sel_hi:[1,0]
v_pk_mul_f32 v[50:51], v[50:51], v[182:183] op_sel_hi:[1,0]
v_cvt_pk_bf16_f32 v148, v148, v149
v_cvt_pk_bf16_f32 v149, v150, v151
v_cvt_pk_bf16_f32 v150, v48, v49
v_cvt_pk_bf16_f32 v151, v50, v51
buffer_store_dwordx4 v[148:151], v15, s[24:27], s79 offen offset:1024 sc1
v_pk_mul_f32 v[72:73], v[72:73], v[180:181] op_sel_hi:[1,0]
v_pk_mul_f32 v[74:75], v[74:75], v[180:181] op_sel_hi:[1,0]
v_pk_mul_f32 v[220:221], v[220:221], v[180:181] op_sel_hi:[1,0]
v_pk_mul_f32 v[222:223], v[222:223], v[180:181] op_sel_hi:[1,0]
v_cvt_pk_bf16_f32 v72, v72, v73
v_cvt_pk_bf16_f32 v73, v74, v75
v_cvt_pk_bf16_f32 v74, v220, v221
v_cvt_pk_bf16_f32 v75, v222, v223
buffer_store_dwordx4 v[72:75], v15, s[24:27], s79 offen offset:2048 sc1
v_pk_mul_f32 v[236:237], v[236:237], v[182:183] op_sel_hi:[1,0]
v_pk_mul_f32 v[238:239], v[238:239], v[182:183] op_sel_hi:[1,0]
v_pk_mul_f32 v[224:225], v[224:225], v[182:183] op_sel_hi:[1,0]
v_pk_mul_f32 v[226:227], v[226:227], v[182:183] op_sel_hi:[1,0]
v_cvt_pk_bf16_f32 v236, v236, v237
v_cvt_pk_bf16_f32 v237, v238, v239
v_cvt_pk_bf16_f32 v238, v224, v225
v_cvt_pk_bf16_f32 v239, v226, v227
buffer_store_dwordx4 v[236:239], v15, s[24:27], s79 offen offset:3072 sc1
v_pk_mul_f32 v[84:85], v[84:85], v[180:181] op_sel_hi:[1,0]
v_pk_mul_f32 v[86:87], v[86:87], v[180:181] op_sel_hi:[1,0]
v_pk_mul_f32 v[76:77], v[76:77], v[180:181] op_sel_hi:[1,0]
v_pk_mul_f32 v[78:79], v[78:79], v[180:181] op_sel_hi:[1,0]
v_cvt_pk_bf16_f32 v84, v84, v85
v_cvt_pk_bf16_f32 v85, v86, v87
v_cvt_pk_bf16_f32 v86, v76, v77
v_cvt_pk_bf16_f32 v87, v78, v79
buffer_store_dwordx4 v[84:87], v15, s[24:27], s52 offen offset:0 sc1
v_pk_mul_f32 v[164:165], v[164:165], v[182:183] op_sel_hi:[1,0]
v_pk_mul_f32 v[166:167], v[166:167], v[182:183] op_sel_hi:[1,0]
v_pk_mul_f32 v[156:157], v[156:157], v[182:183] op_sel_hi:[1,0]
v_pk_mul_f32 v[158:159], v[158:159], v[182:183] op_sel_hi:[1,0]
v_cvt_pk_bf16_f32 v164, v164, v165
v_cvt_pk_bf16_f32 v165, v166, v167
v_cvt_pk_bf16_f32 v166, v156, v157
v_cvt_pk_bf16_f32 v167, v158, v159
buffer_store_dwordx4 v[164:167], v15, s[24:27], s52 offen offset:1024 sc1
v_pk_mul_f32 v[160:161], v[160:161], v[180:181] op_sel_hi:[1,0]
v_pk_mul_f32 v[162:163], v[162:163], v[180:181] op_sel_hi:[1,0]
v_pk_mul_f32 v[252:253], v[252:253], v[180:181] op_sel_hi:[1,0]
v_pk_mul_f32 v[254:255], v[254:255], v[180:181] op_sel_hi:[1,0]
v_cvt_pk_bf16_f32 v160, v160, v161
v_cvt_pk_bf16_f32 v161, v162, v163
v_cvt_pk_bf16_f32 v162, v252, v253
v_cvt_pk_bf16_f32 v163, v254, v255
buffer_store_dwordx4 v[160:163], v15, s[24:27], s52 offen offset:2048 sc1
v_pk_mul_f32 v[216:217], v[216:217], v[182:183] op_sel_hi:[1,0]
v_pk_mul_f32 v[218:219], v[218:219], v[182:183] op_sel_hi:[1,0]
v_pk_mul_f32 v[208:209], v[208:209], v[182:183] op_sel_hi:[1,0]
v_pk_mul_f32 v[210:211], v[210:211], v[182:183] op_sel_hi:[1,0]
v_cvt_pk_bf16_f32 v216, v216, v217
v_cvt_pk_bf16_f32 v217, v218, v219
v_cvt_pk_bf16_f32 v218, v208, v209
v_cvt_pk_bf16_f32 v219, v210, v211
buffer_store_dwordx4 v[216:219], v15, s[24:27], s52 offen offset:3072 sc1
v_cmp_eq_u32 vcc, 3, v3
v_mul_u32_u24 v200, 768, v3
v_add_u32 v200, v200, v247
ds_write_b128 v200, a[244:247] offset:0
v_cndmask_b32 v245, v244, v246, vcc
ds_write_b128 v200, a[248:251] offset:3072
v_add_u32 v247, -1280, v247
ds_write_b128 v200, a[252:255] offset:6144
v_add_u32 v244, v244, v247
v_add_u32 v245, v245, v247
ds_write_b128 v244, a[128:131] offset:0
v_cmp_lt_u32 vcc, 31, v1
ds_write_b128 v245, a[132:135] offset:768
v_and_b32 v202, 31, v1
ds_write_b128 v244, a[136:139] offset:256
v_mov_b32 v200, s66
ds_write_b128 v245, a[140:143] offset:1024
v_mov_b32 v203, s67
ds_write_b128 v244, a[144:147] offset:3840
v_cndmask_b32 v200, v200, v203, vcc
ds_write_b128 v245, a[148:151] offset:4608
v_lshl_add_u32 v200, v200, 5, v202
ds_write_b128 v244, a[152:155] offset:4096
v_lshrrev_b32 v201, 5, v1
ds_write_b128 v245, a[156:159] offset:4864
v_mul_u32_u24 v201, 3840, v201
v_lshl_add_u32 v201, v202, 4, v201
v_add_u32 v201, s83, v201
s_cmp_eq_u32 s76, 0
s_cbranch_scc1 L_SE2
L_LA:
v_mov_b32 v5, v200
v_mov_b32 v6, v201
v_mov_b32 v13, 0
s_lshl_b32 s74, s66, 10
s_lshr_b32 s52, s4, 3
s_lshl_b32 s52, s52, 8
s_add_u32 s74, s74, s52
s_add_u32 s74, s74, 75530240
ds_read_b128 v[16:19], v6 offset:8448
ds_read_b128 v[20:23], v6 offset:9216
ds_read_b128 v[96:99], v6 offset:3328
ds_read_b128 v[32:35], v6 offset:256
ds_read_b128 v[36:39], v6 offset:1024
ds_read_b128 v[100:103], v6 offset:3296
ds_read_b128 v[40:43], v6 offset:224
ds_read_b128 v[44:47], v6 offset:992
ds_read_b128 v[104:107], v6 offset:3264
ds_read_b128 v[48:51], v6 offset:192
ds_read_b128 v[52:55], v6 offset:960
ds_read_b128 v[108:111], v6 offset:3232
ds_read_b128 v[56:59], v6 offset:160
ds_read_b128 v[60:63], v6 offset:928
ds_read_b128 v[112:115], v6 offset:3200
ds_read_b128 v[64:67], v6 offset:128
ds_read_b128 v[68:71], v6 offset:896
ds_read_b128 v[116:119], v6 offset:3168
ds_read_b128 v[72:75], v6 offset:96
ds_read_b128 v[76:79], v6 offset:864
ds_read_b128 v[120:123], v6 offset:3136
ds_read_b128 v[80:83], v6 offset:64
ds_read_b128 v[84:87], v6 offset:832
ds_read_b128 v[124:127], v6 offset:3104
ds_read_b128 v[88:91], v6 offset:32
ds_read_b128 v[92:95], v6 offset:800
ds_read_b128 v[128:131], v6 offset:1792
ds_read_b128 v[132:135], v6 offset:2560
s_waitcnt vmcnt(0)
buffer_atomic_add v1, v0, s[24:27], s74 offen offset:0 sc1
ds_read_b128 v[136:139], v6 offset:1760
ds_read_b128 v[140:143], v6 offset:2528
ds_read_b128 v[144:147], v6 offset:1728
ds_read_b128 v[148:151], v6 offset:2496
ds_read_b128 v[152:155], v6 offset:1696
ds_read_b128 v[156:159], v6 offset:2464
ds_read_b128 v[160:163], v6 offset:1664
ds_read_b128 v[164:167], v6 offset:2432
ds_read_b128 v[168:171], v6 offset:1632
ds_read_b128 v[172:175], v6 offset:2400
ds_read_b128 v[176:179], v6 offset:1600
ds_read_b128 v[180:183], v6 offset:2368
ds_read_b128 v[184:187], v6 offset:1568
ds_read_b128 v[188:191], v6 offset:2336
s_lshr_b32 s52, s3, 1
s_lshl1_add_u32 s72, s85, s52
s_lshl2_add_u32 s75, s72, s84
s_lshl_b32 s75, s75, 8
s_add_u32 s75, s75, 75530240
s_and_b32 s82, s86, 1
s_lshl_b32 s82, s82, 13
s_lshr_b32 s53, s4, 3
s_mul_i32 s53, s53, 75776
s_add_u32 s53, s53, 54525952
s_and_b32 s52, s3, 1
s_lshl_b32 s52, s52, 10
s_add_u32 s52, s52, s53
s_sub_u32 s54, 63, s72
s_mul_i32 s77, s72, 303104
s_add_u32 s77, s77, s52
s_mul_i32 s81, s54, 303104
s_add_u32 s81, s81, s52
s_add_u32 s91, s91, 114688
s_sub_u32 s52, s91, 163840
s_cmp_ge_u32 s91, 163840
s_cselect_b32 s91, s52, s91
v_add_u32 v14, 4096, v15
v_add_u32 v7, s91, v4
s_waitcnt lgkmcnt(0)
s_barrier
s_mov_b32 m0, s70
s_mov_b32 s64, s68
s_add_u32 s68, s68, 16384
s_add_u32 s70, s70, 16384
s_cmp_ge_u32 s70, 163840
s_cselect_b32 s70, s80, s70
buffer_load_dwordx4 v15, s[24:27], s64 offen offset:0 sc1 lds
v_and_b32 v9, 0xffff, v97
v_and_b32 v11, 0xffff0000, v97
v_dot2_f32_bf16 v24, v98, v99, 0
v_dot2_f32_bf16 v25, v102, v99, 0
v_dot2_f32_bf16 v26, v106, v99, 0
v_dot2_f32_bf16 v27, v110, v99, 0
v_dot2_f32_bf16 v28, v114, v99, 0
v_dot2_f32_bf16 v29, v118, v99, 0
v_dot2_f32_bf16 v30, v122, v99, 0
v_dot2_f32_bf16 v31, v126, v99, 0
v_dot2c_f32_bf16 v24, v96, v9
buffer_load_dwordx4 v15, s[24:27], s64 offen offset:1024 sc1 lds
v_dot2c_f32_bf16 v25, v100, v9
v_dot2c_f32_bf16 v26, v104, v9
v_dot2c_f32_bf16 v27, v108, v9
v_dot2c_f32_bf16 v28, v112, v9
v_dot2c_f32_bf16 v29, v116, v9
v_dot2c_f32_bf16 v30, v120, v9
v_dot2c_f32_bf16 v31, v124, v9
v_dot2c_f32_bf16 v24, v16, v32
v_dot2c_f32_bf16 v25, v16, v40
v_dot2c_f32_bf16 v26, v16, v48
v_dot2c_f32_bf16 v27, v16, v56
buffer_load_dwordx4 v15, s[24:27], s64 offen offset:2048 sc1 lds
v_dot2c_f32_bf16 v28, v16, v64
v_dot2c_f32_bf16 v29, v16, v72
v_dot2c_f32_bf16 v30, v16, v80
v_dot2c_f32_bf16 v31, v16, v88
v_dot2c_f32_bf16 v24, v17, v33
v_dot2c_f32_bf16 v25, v17, v41
v_dot2c_f32_bf16 v26, v17, v49
v_dot2c_f32_bf16 v27, v17, v57
v_dot2c_f32_bf16 v28, v17, v65
v_dot2c_f32_bf16 v29, v17, v73
v_dot2c_f32_bf16 v30, v17, v81
buffer_load_dwordx4 v15, s[24:27], s64 offen offset:3072 sc1 lds
v_dot2c_f32_bf16 v31, v17, v89
v_dot2c_f32_bf16 v24, v18, v34
v_dot2c_f32_bf16 v25, v18, v42
v_dot2c_f32_bf16 v26, v18, v50
v_dot2c_f32_bf16 v27, v18, v58
v_dot2c_f32_bf16 v28, v18, v66
v_dot2c_f32_bf16 v29, v18, v74
v_dot2c_f32_bf16 v30, v18, v82
v_dot2c_f32_bf16 v31, v18, v90
v_dot2c_f32_bf16 v24, v19, v35
v_dot2c_f32_bf16 v25, v19, v43
s_mov_b32 m0, s70
s_mov_b32 s64, s68
s_add_u32 s68, s68, 16384
s_add_u32 s70, s70, 16384
s_cmp_ge_u32 s70, 163840
s_cselect_b32 s70, s80, s70
buffer_load_dwordx4 v15, s[24:27], s64 offen offset:0 sc1 lds
v_dot2c_f32_bf16 v26, v19, v51
v_dot2c_f32_bf16 v27, v19, v59
v_dot2c_f32_bf16 v28, v19, v67
v_dot2c_f32_bf16 v29, v19, v75
v_dot2c_f32_bf16 v30, v19, v83
v_dot2c_f32_bf16 v31, v19, v91
v_dot2c_f32_bf16 v24, v20, v36
v_dot2c_f32_bf16 v25, v20, v44
v_dot2c_f32_bf16 v26, v20, v52
v_dot2c_f32_bf16 v27, v20, v60
v_dot2c_f32_bf16 v28, v20, v68
buffer_load_dwordx4 v15, s[24:27], s64 offen offset:1024 sc1 lds
v_dot2c_f32_bf16 v29, v20, v76
v_dot2c_f32_bf16 v30, v20, v84
v_dot2c_f32_bf16 v31, v20, v92
v_dot2c_f32_bf16 v24, v21, v37
v_dot2c_f32_bf16 v25, v21, v45
v_dot2c_f32_bf16 v26, v21, v53
v_dot2c_f32_bf16 v27, v21, v61
v_dot2c_f32_bf16 v28, v21, v69
v_dot2c_f32_bf16 v29, v21, v77
v_dot2c_f32_bf16 v30, v21, v85
v_dot2c_f32_bf16 v31, v21, v93
buffer_load_dwordx4 v15, s[24:27], s64 offen offset:2048 sc1 lds
v_dot2c_f32_bf16 v24, v22, v38
v_dot2c_f32_bf16 v25, v22, v46
L_PAD10:
s_cbranch_execz L_MAIN
v_dot2c_f32_bf16 v26, v22, v54
v_dot2c_f32_bf16 v27, v22, v62
v_dot2c_f32_bf16 v28, v22, v70
v_dot2c_f32_bf16 v29, v22, v78
v_dot2c_f32_bf16 v30, v22, v86
v_dot2c_f32_bf16 v31, v22, v94
v_dot2c_f32_bf16 v24, v23, v39
v_dot2c_f32_bf16 v25, v23, v47
v_dot2c_f32_bf16 v26, v23, v55
buffer_load_dwordx4 v15, s[24:27], s64 offen offset:3072 sc1 lds
v_dot2c_f32_bf16 v27, v23, v63
v_dot2c_f32_bf16 v28, v23, v71
v_dot2c_f32_bf16 v29, v23, v79
v_dot2c_f32_bf16 v30, v23, v87
v_dot2c_f32_bf16 v31, v23, v95
v_mov_b32 v9, 0xf149f2ca
v_mul_f32 v11, 0xbfb8aa3b, v11
v_exp_f32 v11, v11
v_cmp_gt_u32 vcc, 2, v5
v_cmp_gt_u32 s[56:57], 4, v5
s_nop 0
s_mov_b32 m0, s70
s_mov_b32 s64, s68
s_add_u32 s68, s68, 16384
s_add_u32 s70, s70, 16384
s_cmp_ge_u32 s70, 163840
s_cselect_b32 s70, s80, s70
buffer_load_dwordx4 v15, s[24:27], s64 offen offset:0 sc1 lds
v_cndmask_b32 v25, v25, v9, vcc
v_cndmask_b32 v26, v26, v9, s[56:57]
v_cmp_gt_u32 vcc, 6, v5
v_cmp_gt_u32 s[56:57], 8, v5
s_nop 0
v_cndmask_b32 v27, v27, v9, vcc
v_cndmask_b32 v28, v28, v9, s[56:57]
v_cmp_gt_u32 vcc, 10, v5
v_cmp_gt_u32 s[56:57], 12, v5
s_nop 0
v_cndmask_b32 v29, v29, v9, vcc
buffer_load_dwordx4 v15, s[24:27], s64 offen offset:1024 sc1 lds
v_cndmask_b32 v30, v30, v9, s[56:57]
v_cmp_gt_u32 vcc, 14, v5
s_nop 0
s_nop 0
v_cndmask_b32 v31, v31, v9, vcc
v_max3_f32 v10, v24, v25, v26
v_max3_f32 v10, v10, v27, v28
v_max3_f32 v10, v10, v29, v30
v_max_f32 v10, v10, v31
s_mov_b32 s52, 0x3eae1a93
v_sub_f32 v24, v24, v10
buffer_load_dwordx4 v15, s[24:27], s64 offen offset:2048 sc1 lds
v_sub_f32 v25, v25, v10
v_sub_f32 v26, v26, v10
v_sub_f32 v27, v27, v10
v_sub_f32 v28, v28, v10
v_sub_f32 v29, v29, v10
v_sub_f32 v30, v30, v10
v_sub_f32 v31, v31, v10
v_mul_f32 v24, s52, v24
v_mul_f32 v25, s52, v25
v_mul_f32 v26, s52, v26
v_mul_f32 v27, s52, v27
buffer_load_dwordx4 v15, s[24:27], s64 offen offset:3072 sc1 lds
v_mul_f32 v28, s52, v28
v_mul_f32 v29, s52, v29
v_mul_f32 v30, s52, v30
v_mul_f32 v31, s52, v31
v_exp_f32 v24, v24
v_exp_f32 v25, v25
v_exp_f32 v26, v26
v_exp_f32 v27, v27
v_exp_f32 v28, v28
v_exp_f32 v29, v29
v_exp_f32 v30, v30
s_mov_b32 m0, s70
s_mov_b32 s64, s68
s_add_u32 s68, s68, 16384
s_add_u32 s70, s70, 16384
s_cmp_ge_u32 s70, 163840
s_cselect_b32 s70, s80, s70
buffer_load_dwordx4 v15, s[24:27], s64 offen offset:0 sc1 lds
v_exp_f32 v31, v31
v_cvt_pk_bf16_f32 v32, v24, 0
v_cvt_pk_bf16_f32 v40, v25, 0
v_cvt_pk_bf16_f32 v48, v26, 0
v_cvt_pk_bf16_f32 v56, v27, 0
v_cvt_pk_bf16_f32 v64, v28, 0
v_cvt_pk_bf16_f32 v72, v29, 0
v_cvt_pk_bf16_f32 v80, v30, 0
v_cvt_pk_bf16_f32 v88, v31, 0
v_lshlrev_b32 v33, 16, v32
v_lshlrev_b32 v41, 16, v40
buffer_load_dwordx4 v15, s[24:27], s64 offen offset:1024 sc1 lds
v_lshlrev_b32 v49, 16, v48
v_lshlrev_b32 v57, 16, v56
v_lshlrev_b32 v65, 16, v64
v_lshlrev_b32 v73, 16, v72
v_lshlrev_b32 v81, 16, v80
v_lshlrev_b32 v89, 16, v88
v_add_f32 v10, v33, v41
v_add_f32 v10, v10, v49
v_add_f32 v10, v10, v57
v_add_f32 v10, v10, v65
v_add_f32 v10, v10, v73
buffer_load_dwordx4 v15, s[24:27], s64 offen offset:2048 sc1 lds
v_add_f32 v10, v10, v81
v_add_f32 v10, v10, v89
v_fmac_f32 v10, v10, v11
v_rcp_f32 v10, v10
v_dot2_f32_bf16 v192, v128, v32, 0
v_dot2_f32_bf16 v193, v128, v33, 0
v_dot2_f32_bf16 v194, v129, v32, 0
v_dot2_f32_bf16 v195, v129, v33, 0
v_dot2_f32_bf16 v196, v130, v32, 0
v_dot2_f32_bf16 v197, v130, v33, 0
v_dot2_f32_bf16 v198, v131, v32, 0
buffer_load_dwordx4 v15, s[24:27], s64 offen offset:3072 sc1 lds
v_dot2_f32_bf16 v199, v131, v33, 0
v_dot2_f32_bf16 v200, v132, v32, 0
v_dot2_f32_bf16 v201, v132, v33, 0
v_dot2_f32_bf16 v202, v133, v32, 0
v_dot2_f32_bf16 v203, v133, v33, 0
v_dot2_f32_bf16 v204, v134, v32, 0
v_dot2_f32_bf16 v205, v134, v33, 0
v_dot2_f32_bf16 v206, v135, v32, 0
v_dot2_f32_bf16 v207, v135, v33, 0
v_dot2_f32_bf16 v208, v96, v33, 0
v_dot2_f32_bf16 v209, v98, v33, 0
buffer_load_dword v12, v13, s[24:27], s75 offen sc1
v_dot2c_f32_bf16 v192, v136, v40
v_dot2c_f32_bf16 v193, v136, v41
v_dot2c_f32_bf16 v194, v137, v40
v_dot2c_f32_bf16 v195, v137, v41
v_dot2c_f32_bf16 v196, v138, v40
v_dot2c_f32_bf16 v197, v138, v41
v_dot2c_f32_bf16 v198, v139, v40
v_dot2c_f32_bf16 v199, v139, v41
v_dot2c_f32_bf16 v200, v140, v40
v_dot2c_f32_bf16 v201, v140, v41
v_dot2c_f32_bf16 v202, v141, v40
s_mov_b32 m0, s70
s_mov_b32 s64, s68
s_add_u32 s68, s68, 16384
s_add_u32 s70, s70, 16384
s_cmp_ge_u32 s70, 163840
s_cselect_b32 s70, s80, s70
buffer_load_dwordx4 v15, s[24:27], s64 offen offset:0 sc1 lds
v_dot2c_f32_bf16 v203, v141, v41
v_dot2c_f32_bf16 v204, v142, v40
v_dot2c_f32_bf16 v205, v142, v41
v_dot2c_f32_bf16 v206, v143, v40
v_dot2c_f32_bf16 v207, v143, v41
v_dot2c_f32_bf16 v208, v100, v41
v_dot2c_f32_bf16 v209, v102, v41
v_dot2c_f32_bf16 v192, v144, v48
v_dot2c_f32_bf16 v193, v144, v49
v_dot2c_f32_bf16 v194, v145, v48
v_dot2c_f32_bf16 v195, v145, v49
buffer_load_dwordx4 v15, s[24:27], s64 offen offset:1024 sc1 lds
v_dot2c_f32_bf16 v196, v146, v48
v_dot2c_f32_bf16 v197, v146, v49
v_dot2c_f32_bf16 v198, v147, v48
v_dot2c_f32_bf16 v199, v147, v49
v_dot2c_f32_bf16 v200, v148, v48
v_dot2c_f32_bf16 v201, v148, v49
v_dot2c_f32_bf16 v202, v149, v48
v_dot2c_f32_bf16 v203, v149, v49
v_dot2c_f32_bf16 v204, v150, v48
v_dot2c_f32_bf16 v205, v150, v49
v_dot2c_f32_bf16 v206, v151, v48
buffer_load_dwordx4 v15, s[24:27], s64 offen offset:2048 sc1 lds
v_dot2c_f32_bf16 v207, v151, v49
v_dot2c_f32_bf16 v208, v104, v49
v_dot2c_f32_bf16 v209, v106, v49
v_dot2c_f32_bf16 v192, v152, v56
v_dot2c_f32_bf16 v193, v152, v57
v_dot2c_f32_bf16 v194, v153, v56
v_dot2c_f32_bf16 v195, v153, v57
v_dot2c_f32_bf16 v196, v154, v56
v_dot2c_f32_bf16 v197, v154, v57
v_dot2c_f32_bf16 v198, v155, v56
v_dot2c_f32_bf16 v199, v155, v57
buffer_load_dwordx4 v15, s[24:27], s64 offen offset:3072 sc1 lds
v_dot2c_f32_bf16 v200, v156, v56
v_dot2c_f32_bf16 v201, v156, v57
v_dot2c_f32_bf16 v202, v157, v56
v_dot2c_f32_bf16 v203, v157, v57
v_dot2c_f32_bf16 v204, v158, v56
v_dot2c_f32_bf16 v205, v158, v57
v_dot2c_f32_bf16 v206, v159, v56
v_dot2c_f32_bf16 v207, v159, v57
v_dot2c_f32_bf16 v208, v108, v57
v_dot2c_f32_bf16 v209, v110, v57
v_dot2c_f32_bf16 v192, v160, v64
s_waitcnt vmcnt(4)
v_cmp_gt_u32 s[96:97], 8, v12
s_nop 3
s_cmp_eq_u64 s[96:97], 0
s_cselect_b32 s78, s77, 2147418112
s_cselect_b32 s79, s81, 2147418112
s_xor_b32 s65, s82, 0
s_add_u32 s65, s65, s78
buffer_load_dwordx4 a[0:3], v15, s[24:27], s65 offen offset:0 sc1
v_dot2c_f32_bf16 v193, v160, v65
v_dot2c_f32_bf16 v194, v161, v64
v_dot2c_f32_bf16 v195, v161, v65
v_dot2c_f32_bf16 v196, v162, v64
v_dot2c_f32_bf16 v197, v162, v65
v_dot2c_f32_bf16 v198, v163, v64
v_dot2c_f32_bf16 v199, v163, v65
v_dot2c_f32_bf16 v200, v164, v64
v_dot2c_f32_bf16 v201, v164, v65
v_dot2c_f32_bf16 v202, v165, v64
v_dot2c_f32_bf16 v203, v165, v65
buffer_load_dwordx4 a[8:11], v15, s[24:27], s65 offen offset:2048 sc1
v_dot2c_f32_bf16 v204, v166, v64
v_dot2c_f32_bf16 v205, v166, v65
v_dot2c_f32_bf16 v206, v167, v64
v_dot2c_f32_bf16 v207, v167, v65
v_dot2c_f32_bf16 v208, v112, v65
v_dot2c_f32_bf16 v209, v114, v65
v_dot2c_f32_bf16 v192, v168, v72
v_dot2c_f32_bf16 v193, v168, v73
v_dot2c_f32_bf16 v194, v169, v72
v_dot2c_f32_bf16 v195, v169, v73
v_dot2c_f32_bf16 v196, v170, v72
s_xor_b32 s93, s82, 0
s_add_u32 s93, s93, s79
buffer_load_dwordx4 a[4:7], v15, s[24:27], s93 offen offset:0 sc1
v_dot2c_f32_bf16 v197, v170, v73
v_dot2c_f32_bf16 v198, v171, v72
v_dot2c_f32_bf16 v199, v171, v73
v_dot2c_f32_bf16 v200, v172, v72
v_dot2c_f32_bf16 v201, v172, v73
v_dot2c_f32_bf16 v202, v173, v72
v_dot2c_f32_bf16 v203, v173, v73
v_dot2c_f32_bf16 v204, v174, v72
v_dot2c_f32_bf16 v205, v174, v73
v_dot2c_f32_bf16 v206, v175, v72
v_dot2c_f32_bf16 v207, v175, v73
buffer_load_dwordx4 a[12:15], v15, s[24:27], s93 offen offset:2048 sc1
v_dot2c_f32_bf16 v208, v116, v73
v_dot2c_f32_bf16 v209, v118, v73
v_dot2c_f32_bf16 v192, v176, v80
v_dot2c_f32_bf16 v193, v176, v81
v_dot2c_f32_bf16 v194, v177, v80
v_dot2c_f32_bf16 v195, v177, v81
v_dot2c_f32_bf16 v196, v178, v80
v_dot2c_f32_bf16 v197, v178, v81
v_dot2c_f32_bf16 v198, v179, v80
v_dot2c_f32_bf16 v199, v179, v81
v_dot2c_f32_bf16 v200, v180, v80
buffer_load_dwordx4 a[16:19], v14, s[24:27], s65 offen offset:0 sc1
v_dot2c_f32_bf16 v201, v180, v81
v_dot2c_f32_bf16 v202, v181, v80
v_dot2c_f32_bf16 v203, v181, v81
v_dot2c_f32_bf16 v204, v182, v80
v_dot2c_f32_bf16 v205, v182, v81
v_dot2c_f32_bf16 v206, v183, v80
v_dot2c_f32_bf16 v207, v183, v81
v_dot2c_f32_bf16 v208, v120, v81
v_dot2c_f32_bf16 v209, v122, v81
v_dot2c_f32_bf16 v192, v184, v88
v_dot2c_f32_bf16 v193, v184, v89
buffer_load_dwordx4 a[24:27], v14, s[24:27], s65 offen offset:2048 sc1
v_dot2c_f32_bf16 v194, v185, v88
v_dot2c_f32_bf16 v195, v185, v89
v_dot2c_f32_bf16 v196, v186, v88
v_dot2c_f32_bf16 v197, v186, v89
v_dot2c_f32_bf16 v198, v187, v88
v_dot2c_f32_bf16 v199, v187, v89
v_dot2c_f32_bf16 v200, v188, v88
v_dot2c_f32_bf16 v201, v188, v89
v_dot2c_f32_bf16 v202, v189, v88
v_dot2c_f32_bf16 v203, v189, v89
v_dot2c_f32_bf16 v204, v190, v88
buffer_load_dwordx4 a[20:23], v14, s[24:27], s93 offen offset:0 sc1
v_dot2c_f32_bf16 v205, v190, v89
v_dot2c_f32_bf16 v206, v191, v88
v_dot2c_f32_bf16 v207, v191, v89
v_dot2c_f32_bf16 v208, v124, v89
v_dot2c_f32_bf16 v209, v126, v89
v_lshrrev_b32 v9, 5, v5
v_mul_u32_u24 v9, 303104, v9
v_and_b32 v11, 1, v3
v_lshl_add_u32 v9, v11, 10, v9
v_lshl_add_u32 v9, v2, 4, v9
v_lshrrev_b32 v11, 3, v2
buffer_load_dwordx4 a[28:31], v14, s[24:27], s93 offen offset:2048 sc1
s_bitcmp0_b32 s4, 0
s_cselect_b32 s52, 100663168, 0
v_mul_lo_u32 v6, v11, s52
v_add_u32 v6, v6, v9
s_bitcmp1_b32 s4, 2
s_cselect_b32 s52, 100663168, 0
v_mul_lo_u32 v11, v11, s52
v_add_u32 v11, v11, v9
v_mul_f32 v192, v10, v192
v_mul_f32 v193, v10, v193
v_mul_f32 v194, v10, v194
v_mul_f32 v195, v10, v195
v_mul_f32 v196, v10, v196
buffer_load_dword v12, v13, s[24:27], s75 offen sc1
v_mul_f32 v197, v10, v197
v_mul_f32 v198, v10, v198
v_mul_f32 v199, v10, v199
v_mul_f32 v200, v10, v200
v_mul_f32 v201, v10, v201
v_mul_f32 v202, v10, v202
v_mul_f32 v203, v10, v203
v_mul_f32 v204, v10, v204
v_mul_f32 v205, v10, v205
v_mul_f32 v206, v10, v206
v_mul_f32 v207, v10, v207
v_mul_f32 v208, v10, v208
v_mul_f32 v209, v10, v209
v_cvt_pk_bf16_f32 v192, v192, v193
v_cvt_pk_bf16_f32 v193, v194, v195
v_cvt_pk_bf16_f32 v194, v196, v197
v_cvt_pk_bf16_f32 v195, v198, v199
v_cvt_pk_bf16_f32 v196, v200, v201
v_cvt_pk_bf16_f32 v197, v202, v203
v_cvt_pk_bf16_f32 v198, v204, v205
v_cvt_pk_bf16_f32 v199, v206, v207
v_cvt_pk_bf16_f32 v200, v208, v209
s_add_u32 s53, s53, 65536
s_bfe_u32 s54, s4, 131073
s_lshl_b32 s54, s54, 11
s_add_u32 s54, s54, s53
s_and_b32 s55, s4, 1
s_lshl_b32 s55, s55, 9
s_add_u32 s54, s54, s55
s_lshl2_add_u32 s52, s85, s86
s_lshl2_add_u32 s52, s52, s3
s_mul_i32 s69, s52, 28672
s_add_u32 s69, s69, 76546048
s_mul_i32 s73, s52, 640
s_add_u32 s73, s73, 75563008
ds_read_b128 v[144:147], v7 offset:0
ds_read_b128 v[148:151], v7 offset:1024
ds_read_b128 v[152:155], v7 offset:2048
ds_read_b128 v[156:159], v7 offset:3072
ds_read_b128 v[160:163], v7 offset:4096
ds_read_b128 v[164:167], v7 offset:5120
ds_read_b128 v[168:171], v7 offset:6144
ds_read_b128 v[172:175], v7 offset:7168
v_mov_b32 v10, 0
s_mov_b32 s92, 0
s_cmp_eq_u32 s78, s77
s_cbranch_scc1 L_ZBX
s_branch L_ZB1
L_ZB:
s_sleep 2
buffer_load_dword v12, v13, s[24:27], s75 offen sc1
L_ZB1:
s_add_u32 s92, s92, 1
s_waitcnt vmcnt(0)
v_cmp_gt_u32 vcc, 8, v12
s_cmp_gt_u32 s92, 1048576
s_cbranch_scc1 L_ZBY
s_nop 2
s_cbranch_vccnz L_ZB
L_ZBY:
s_xor_b32 s65, s82, 0
s_add_u32 s65, s65, s77
buffer_load_dwordx4 a[0:3], v15, s[24:27], s65 offen offset:0 sc1
buffer_load_dwordx4 a[8:11], v15, s[24:27], s65 offen offset:2048 sc1
s_xor_b32 s93, s82, 0
s_add_u32 s93, s93, s81
buffer_load_dwordx4 a[4:7], v15, s[24:27], s93 offen offset:0 sc1
buffer_load_dwordx4 a[12:15], v15, s[24:27], s93 offen offset:2048 sc1
buffer_load_dwordx4 a[16:19], v14, s[24:27], s65 offen offset:0 sc1
buffer_load_dwordx4 a[24:27], v14, s[24:27], s65 offen offset:2048 sc1
buffer_load_dwordx4 a[20:23], v14, s[24:27], s93 offen offset:0 sc1
buffer_load_dwordx4 a[28:31], v14, s[24:27], s93 offen offset:2048 sc1
L_ZBX:
buffer_store_dwordx4 v[192:195], v9, s[24:27], s54 offen sc1
buffer_store_dwordx4 v[196:199], v6, s[24:27], s54 offen offset:256 sc1
s_bfe_u32 s55, s4, 65538
s_lshl_b32 s55, s55, 8
s_add_u32 s54, s53, s55
s_and_b32 s55, s4, 3
s_lshl2_add_u32 s54, s55, s54
s_add_u32 s54, s54, 8192
buffer_store_dword v200, v11, s[24:27], s54 offen sc1
s_waitcnt vmcnt(9) lgkmcnt(6)
v_mfma_f32_16x16x32_bf16 v[120:123], v[144:147], a[0:3], 0
s_waitcnt vmcnt(7)
s_add_u32 s91, s91, 16384
ds_read_b128 v[176:179], v7 offset:8192
v_mfma_f32_16x16x32_bf16 v[120:123], v[148:151], a[8:11], v[120:123]
s_xor_b32 s65, s82, 8192
s_add_u32 s65, s65, s77
ds_read_b128 v[180:183], v7 offset:9216
v_mfma_f32_16x16x32_bf16 v[124:127], v[148:151], a[12:15], 0
s_waitcnt lgkmcnt(6)
ds_read_b128 v[184:187], v7 offset:10240
v_mfma_f32_16x16x32_bf16 v[124:127], v[144:147], a[4:7], v[124:127]
buffer_load_dwordx4 a[32:35], v15, s[24:27], s65 offen offset:0 sc1
v_mfma_f32_16x16x32_bf16 v[72:75], v[152:155], a[0:3], 0
s_cmp_ge_u32 s91, 163840
s_cselect_b32 s91, 0, s91
ds_read_b128 v[188:191], v7 offset:11264
v_mfma_f32_16x16x32_bf16 v[72:75], v[156:159], a[8:11], v[72:75]
s_waitcnt lgkmcnt(6)
v_add_u32 v8, s91, v4
v_mfma_f32_16x16x32_bf16 v[76:79], v[156:159], a[12:15], 0
buffer_load_dwordx4 a[40:43], v15, s[24:27], s65 offen offset:2048 sc1
v_mfma_f32_16x16x32_bf16 v[76:79], v[152:155], a[4:7], v[76:79]
s_xor_b32 s93, s82, 8192
s_add_u32 s93, s93, s81
ds_read_b128 v[144:147], v7 offset:12288
v_mfma_f32_16x16x32_bf16 v[80:83], v[160:163], a[0:3], 0
ds_read_b128 v[148:151], v7 offset:13312
v_mfma_f32_16x16x32_bf16 v[80:83], v[164:167], a[8:11], v[80:83]
buffer_load_dwordx4 a[36:39], v15, s[24:27], s93 offen offset:0 sc1
v_mfma_f32_16x16x32_bf16 v[84:87], v[164:167], a[12:15], 0
ds_read_b128 v[152:155], v7 offset:14336
v_mfma_f32_16x16x32_bf16 v[84:87], v[160:163], a[4:7], v[84:87]
s_waitcnt lgkmcnt(7)
v_mfma_f32_16x16x32_bf16 v[88:91], v[168:171], a[0:3], 0
buffer_load_dwordx4 a[44:47], v15, s[24:27], s93 offen offset:2048 sc1
v_mfma_f32_16x16x32_bf16 v[88:91], v[172:175], a[8:11], v[88:91]
ds_read_b128 v[156:159], v7 offset:15360
v_mfma_f32_16x16x32_bf16 v[92:95], v[172:175], a[12:15], 0
s_waitcnt lgkmcnt(6)
s_add_u32 s91, s91, 16384
ds_read_b128 v[160:163], v8 offset:0
v_mfma_f32_16x16x32_bf16 v[92:95], v[168:171], a[4:7], v[92:95]
buffer_load_dwordx4 a[48:51], v14, s[24:27], s65 offen offset:0 sc1
v_mfma_f32_16x16x32_bf16 v[96:99], v[176:179], a[0:3], 0
s_cmp_ge_u32 s91, 163840
s_cselect_b32 s91, 0, s91
ds_read_b128 v[164:167], v8 offset:1024
v_mfma_f32_16x16x32_bf16 v[96:99], v[180:183], a[8:11], v[96:99]
v_add_u32 v7, s91, v4
v_mfma_f32_16x16x32_bf16 v[100:103], v[180:183], a[12:15], 0
buffer_load_dwordx4 a[56:59], v14, s[24:27], s65 offen offset:2048 sc1
v_mfma_f32_16x16x32_bf16 v[100:103], v[176:179], a[4:7], v[100:103]
s_waitcnt lgkmcnt(6)
ds_read_b128 v[168:171], v8 offset:2048
v_mfma_f32_16x16x32_bf16 v[104:107], v[184:187], a[0:3], 0
ds_read_b128 v[172:175], v8 offset:3072
v_mfma_f32_16x16x32_bf16 v[104:107], v[188:191], a[8:11], v[104:107]
v_mfma_f32_16x16x32_bf16 v[108:111], v[188:191], a[12:15], 0
buffer_load_dwordx4 a[52:55], v14, s[24:27], s93 offen offset:0 sc1
v_mfma_f32_16x16x32_bf16 v[108:111], v[184:187], a[4:7], v[108:111]
s_waitcnt lgkmcnt(6)
ds_read_b128 v[176:179], v8 offset:4096
v_mfma_f32_16x16x32_bf16 v[112:115], v[144:147], a[0:3], 0
ds_read_b128 v[180:183], v8 offset:5120
v_mfma_f32_16x16x32_bf16 v[112:115], v[148:151], a[8:11], v[112:115]
v_mfma_f32_16x16x32_bf16 v[116:119], v[148:151], a[12:15], 0
buffer_load_dwordx4 a[60:63], v14, s[24:27], s93 offen offset:2048 sc1
v_mfma_f32_16x16x32_bf16 v[116:119], v[144:147], a[4:7], v[116:119]
s_waitcnt lgkmcnt(6) vmcnt(13)
ds_read_b128 v[184:187], v8 offset:6144
v_mfma_f32_16x16x32_bf16 v[120:123], v[152:155], a[16:19], v[120:123]
ds_read_b128 v[188:191], v8 offset:7168
v_mfma_f32_16x16x32_bf16 v[120:123], v[156:159], a[24:27], v[120:123]
s_waitcnt vmcnt(11)
v_mfma_f32_16x16x32_bf16 v[124:127], v[156:159], a[28:31], v[124:127]
ds_read_b128 v[144:147], v8 offset:8192
v_mfma_f32_16x16x32_bf16 v[124:127], v[152:155], a[20:23], v[124:127]
s_waitcnt lgkmcnt(7)
v_mfma_f32_16x16x32_bf16 v[72:75], v[160:163], a[16:19], v[72:75]
ds_read_b128 v[148:151], v8 offset:9216
v_mfma_f32_16x16x32_bf16 v[72:75], v[164:167], a[24:27], v[72:75]
v_mfma_f32_16x16x32_bf16 v[76:79], v[164:167], a[28:31], v[76:79]
ds_read_b128 v[152:155], v8 offset:10240
v_mfma_f32_16x16x32_bf16 v[76:79], v[160:163], a[20:23], v[76:79]
s_waitcnt lgkmcnt(7)
v_mfma_f32_16x16x32_bf16 v[80:83], v[168:171], a[16:19], v[80:83]
ds_read_b128 v[156:159], v8 offset:11264
v_mfma_f32_16x16x32_bf16 v[80:83], v[172:175], a[24:27], v[80:83]
v_mfma_f32_16x16x32_bf16 v[84:87], v[172:175], a[28:31], v[84:87]
ds_read_b128 v[160:163], v8 offset:12288
v_mfma_f32_16x16x32_bf16 v[84:87], v[168:171], a[20:23], v[84:87]
s_waitcnt lgkmcnt(7)
v_mfma_f32_16x16x32_bf16 v[88:91], v[176:179], a[16:19], v[88:91]
s_xor_b32 s65, s82, 16384
s_add_u32 s65, s65, s77
ds_read_b128 v[164:167], v8 offset:13312
v_mfma_f32_16x16x32_bf16 v[88:91], v[180:183], a[24:27], v[88:91]
v_mfma_f32_16x16x32_bf16 v[92:95], v[180:183], a[28:31], v[92:95]
s_waitcnt lgkmcnt(6)
ds_read_b128 v[168:171], v8 offset:14336
v_add_u32 v11, s70, v4
v_mfma_f32_16x16x32_bf16 v[92:95], v[176:179], a[20:23], v[92:95]
s_add_u32 s70, s70, 16384
s_cmp_ge_u32 s70, 163840
s_cselect_b32 s70, s80, s70
v_mfma_f32_16x16x32_bf16 v[96:99], v[184:187], a[16:19], v[96:99]
buffer_load_dwordx4 a[64:67], v15, s[24:27], s65 offen offset:0 sc1
v_mfma_f32_16x16x32_bf16 v[96:99], v[188:191], a[24:27], v[96:99]
s_barrier
v_mfma_f32_16x16x32_bf16 v[100:103], v[188:191], a[28:31], v[100:103]
s_waitcnt lgkmcnt(5)
ds_read_b128 v[172:175], v8 offset:15360
v_mfma_f32_16x16x32_bf16 v[100:103], v[184:187], a[20:23], v[100:103]
buffer_load_dwordx4 a[72:75], v15, s[24:27], s65 offen offset:2048 sc1
v_mfma_f32_16x16x32_bf16 v[104:107], v[144:147], a[16:19], v[104:107]
ds_write_b64 v11, a[96:97] offset:0
v_mfma_f32_16x16x32_bf16 v[104:107], v[148:151], a[24:27], v[104:107]
s_xor_b32 s93, s82, 16384
s_add_u32 s93, s93, s81
ds_read_b128 v[176:179], v7 offset:0
v_mfma_f32_16x16x32_bf16 v[108:111], v[148:151], a[28:31], v[108:111]
buffer_load_dwordx4 a[68:71], v15, s[24:27], s93 offen offset:0 sc1
v_mfma_f32_16x16x32_bf16 v[108:111], v[144:147], a[20:23], v[108:111]
s_waitcnt lgkmcnt(6)
s_add_u32 s91, s91, 16384
ds_read_b128 v[180:183], v7 offset:1024
v_mfma_f32_16x16x32_bf16 v[112:115], v[152:155], a[16:19], v[112:115]
ds_write_b64 v11, a[98:99] offset:8
v_mfma_f32_16x16x32_bf16 v[112:115], v[156:159], a[24:27], v[112:115]
s_cmp_ge_u32 s91, 163840
s_cselect_b32 s91, 0, s91
ds_read_b128 v[184:187], v7 offset:2048
v_mfma_f32_16x16x32_bf16 v[116:119], v[156:159], a[28:31], v[116:119]
buffer_load_dwordx4 a[76:79], v15, s[24:27], s93 offen offset:2048 sc1
v_mfma_f32_16x16x32_bf16 v[116:119], v[152:155], a[20:23], v[116:119]
s_waitcnt lgkmcnt(7) vmcnt(10)
ds_read_b128 v[188:191], v7 offset:3072
v_add_u32 v8, s91, v4
v_mfma_f32_16x16x32_bf16 v[120:123], v[160:163], a[32:35], v[120:123]
s_waitcnt vmcnt(12)
s_waitcnt vmcnt(8)
ds_read_b128 v[144:147], v7 offset:4096
v_mfma_f32_16x16x32_bf16 v[120:123], v[164:167], a[40:43], v[120:123]
buffer_atomic_add v1, v0, s[24:27], s74 offen offset:128 sc1
v_mfma_f32_16x16x32_bf16 v[124:127], v[164:167], a[44:47], v[124:127]
ds_write_b64 v11, a[100:101] offset:1024
v_mfma_f32_16x16x32_bf16 v[124:127], v[160:163], a[36:39], v[124:127]
s_waitcnt lgkmcnt(8)
ds_read_b128 v[148:151], v7 offset:5120
v_mfma_f32_16x16x32_bf16 v[72:75], v[168:171], a[32:35], v[72:75]
ds_read_b128 v[152:155], v7 offset:6144
v_mfma_f32_16x16x32_bf16 v[72:75], v[172:175], a[40:43], v[72:75]
s_waitcnt lgkmcnt(7)
ds_read_b128 v[156:159], v7 offset:7168
v_mfma_f32_16x16x32_bf16 v[76:79], v[172:175], a[44:47], v[76:79]
ds_write_b64 v11, a[102:103] offset:1032
v_mfma_f32_16x16x32_bf16 v[76:79], v[168:171], a[36:39], v[76:79]
buffer_load_dwordx4 a[80:83], v14, s[24:27], s65 offen offset:0 sc1
v_mfma_f32_16x16x32_bf16 v[80:83], v[176:179], a[32:35], v[80:83]
ds_read_b128 v[160:163], v7 offset:8192
v_mfma_f32_16x16x32_bf16 v[80:83], v[180:183], a[40:43], v[80:83]
s_waitcnt lgkmcnt(7)
ds_read_b128 v[164:167], v7 offset:9216
v_mfma_f32_16x16x32_bf16 v[84:87], v[180:183], a[44:47], v[84:87]
ds_write_b64 v11, a[104:105] offset:2048
v_mfma_f32_16x16x32_bf16 v[84:87], v[176:179], a[36:39], v[84:87]
buffer_load_dwordx4 a[88:91], v14, s[24:27], s65 offen offset:2048 sc1
v_mfma_f32_16x16x32_bf16 v[88:91], v[184:187], a[32:35], v[88:91]
ds_read_b128 v[168:171], v7 offset:10240
v_mfma_f32_16x16x32_bf16 v[88:91], v[188:191], a[40:43], v[88:91]
s_waitcnt lgkmcnt(7)
ds_read_b128 v[172:175], v7 offset:11264
v_mfma_f32_16x16x32_bf16 v[92:95], v[188:191], a[44:47], v[92:95]
ds_write_b64 v11, a[106:107] offset:2056
v_mfma_f32_16x16x32_bf16 v[92:95], v[184:187], a[36:39], v[92:95]
buffer_load_dwordx4 a[84:87], v14, s[24:27], s93 offen offset:0 sc1
v_mfma_f32_16x16x32_bf16 v[96:99], v[144:147], a[32:35], v[96:99]
ds_read_b128 v[176:179], v7 offset:12288
v_mfma_f32_16x16x32_bf16 v[96:99], v[148:151], a[40:43], v[96:99]
s_waitcnt lgkmcnt(8)
ds_read_b128 v[180:183], v7 offset:13312
v_mfma_f32_16x16x32_bf16 v[100:103], v[148:151], a[44:47], v[100:103]
ds_write_b64 v11, a[108:109] offset:3072
v_mfma_f32_16x16x32_bf16 v[100:103], v[144:147], a[36:39], v[100:103]
buffer_load_dwordx4 a[92:95], v14, s[24:27], s93 offen offset:2048 sc1
v_mfma_f32_16x16x32_bf16 v[104:107], v[152:155], a[32:35], v[104:107]
ds_read_b128 v[184:187], v7 offset:14336
v_mfma_f32_16x16x32_bf16 v[104:107], v[156:159], a[40:43], v[104:107]
ds_read_b128 v[188:191], v7 offset:15360
v_mfma_f32_16x16x32_bf16 v[108:111], v[156:159], a[44:47], v[108:111]
ds_write_b64 v11, a[110:111] offset:3080
v_mfma_f32_16x16x32_bf16 v[108:111], v[152:155], a[36:39], v[108:111]
s_waitcnt lgkmcnt(10)
s_add_u32 s91, s91, 16384
ds_read_b128 v[144:147], v8 offset:0
v_mfma_f32_16x16x32_bf16 v[112:115], v[160:163], a[32:35], v[112:115]
s_xor_b32 s65, s82, 24576
s_add_u32 s65, s65, s77
ds_read_b128 v[148:151], v8 offset:1024
v_mfma_f32_16x16x32_bf16 v[112:115], v[164:167], a[40:43], v[112:115]
s_cmp_ge_u32 s91, 163840
s_cselect_b32 s91, 0, s91
v_add_u32 v7, s91, v4
v_mfma_f32_16x16x32_bf16 v[116:119], v[164:167], a[44:47], v[116:119]
buffer_load_dwordx4 a[192:195], v15, s[24:27], s65 offen offset:0 sc1
v_mfma_f32_16x16x32_bf16 v[116:119], v[160:163], a[36:39], v[116:119]
s_waitcnt lgkmcnt(9) vmcnt(12)
ds_read_b128 v[152:155], v8 offset:2048
v_mfma_f32_16x16x32_bf16 v[120:123], v[168:171], a[48:51], v[120:123]
ds_read_b128 v[156:159], v8 offset:3072
v_mfma_f32_16x16x32_bf16 v[120:123], v[172:175], a[56:59], v[120:123]
s_waitcnt vmcnt(10)
v_mfma_f32_16x16x32_bf16 v[124:127], v[172:175], a[60:63], v[124:127]
buffer_load_dwordx4 a[200:203], v15, s[24:27], s65 offen offset:2048 sc1
v_mfma_f32_16x16x32_bf16 v[124:127], v[168:171], a[52:55], v[124:127]
s_waitcnt lgkmcnt(8)
ds_read_b128 v[160:163], v8 offset:4096
v_mfma_f32_16x16x32_bf16 v[72:75], v[176:179], a[48:51], v[72:75]
s_xor_b32 s93, s82, 24576
s_add_u32 s93, s93, s81
ds_read_b128 v[164:167], v8 offset:5120
v_mfma_f32_16x16x32_bf16 v[72:75], v[180:183], a[56:59], v[72:75]
v_mfma_f32_16x16x32_bf16 v[76:79], v[180:183], a[60:63], v[76:79]
buffer_load_dwordx4 a[196:199], v15, s[24:27], s93 offen offset:0 sc1
v_mfma_f32_16x16x32_bf16 v[76:79], v[176:179], a[52:55], v[76:79]
s_waitcnt lgkmcnt(7)
ds_read_b128 v[168:171], v8 offset:6144
v_mfma_f32_16x16x32_bf16 v[80:83], v[184:187], a[48:51], v[80:83]
ds_read_b128 v[172:175], v8 offset:7168
v_mfma_f32_16x16x32_bf16 v[80:83], v[188:191], a[56:59], v[80:83]
v_mfma_f32_16x16x32_bf16 v[84:87], v[188:191], a[60:63], v[84:87]
buffer_load_dwordx4 a[204:207], v15, s[24:27], s93 offen offset:2048 sc1
v_mfma_f32_16x16x32_bf16 v[84:87], v[184:187], a[52:55], v[84:87]
s_waitcnt lgkmcnt(6)
ds_read_b128 v[176:179], v8 offset:8192
v_mfma_f32_16x16x32_bf16 v[88:91], v[144:147], a[48:51], v[88:91]
ds_read_b128 v[180:183], v8 offset:9216
v_mfma_f32_16x16x32_bf16 v[88:91], v[148:151], a[56:59], v[88:91]
v_mfma_f32_16x16x32_bf16 v[92:95], v[148:151], a[60:63], v[92:95]
ds_read_b128 v[184:187], v8 offset:10240
v_mfma_f32_16x16x32_bf16 v[92:95], v[144:147], a[52:55], v[92:95]
s_waitcnt lgkmcnt(7)
v_mfma_f32_16x16x32_bf16 v[96:99], v[152:155], a[48:51], v[96:99]
s_add_u32 s52, s84, 1
ds_read_b128 v[188:191], v8 offset:11264
v_mfma_f32_16x16x32_bf16 v[96:99], v[156:159], a[56:59], v[96:99]
v_mfma_f32_16x16x32_bf16 v[100:103], v[156:159], a[60:63], v[100:103]
buffer_load_dwordx4 a[208:211], v14, s[24:27], s65 offen offset:0 sc1
v_mfma_f32_16x16x32_bf16 v[100:103], v[152:155], a[52:55], v[100:103]
s_and_b32 s52, s52, 3
s_waitcnt lgkmcnt(6)
ds_read_b128 v[144:147], v8 offset:12288
v_mfma_f32_16x16x32_bf16 v[104:107], v[160:163], a[48:51], v[104:107]
ds_read_b128 v[148:151], v8 offset:13312
v_mfma_f32_16x16x32_bf16 v[104:107], v[164:167], a[56:59], v[104:107]
s_waitcnt lgkmcnt(6)
v_mfma_f32_16x16x32_bf16 v[108:111], v[164:167], a[60:63], v[108:111]
s_mul_i32 s52, s52, 6144
ds_read_b128 v[152:155], v8 offset:14336
v_add_u32 v11, s70, v4
v_mfma_f32_16x16x32_bf16 v[108:111], v[160:163], a[52:55], v[108:111]
s_add_u32 s70, s70, 16384
s_cmp_ge_u32 s70, 163840
s_cselect_b32 s70, s80, s70
v_mfma_f32_16x16x32_bf16 v[112:115], v[168:171], a[48:51], v[112:115]
s_waitcnt vmcnt(51)
ds_read_b128 v[156:159], v8 offset:15360
v_mfma_f32_16x16x32_bf16 v[112:115], v[172:175], a[56:59], v[112:115]
s_barrier
v_mfma_f32_16x16x32_bf16 v[116:119], v[172:175], a[60:63], v[116:119]
s_add_u32 s52, s52, s69
s_waitcnt lgkmcnt(6) vmcnt(12)
ds_read_b128 v[160:163], v7 offset:0
v_mfma_f32_16x16x32_bf16 v[116:119], v[168:171], a[52:55], v[116:119]
buffer_load_dwordx4 a[216:219], v14, s[24:27], s65 offen offset:2048 sc1
v_mfma_f32_16x16x32_bf16 v[120:123], v[176:179], a[64:67], v[120:123]
ds_write_b64 v11, a[112:113] offset:0
v_mfma_f32_16x16x32_bf16 v[120:123], v[180:183], a[72:75], v[120:123]
s_add_u32 s52, s52, 0
s_waitcnt vmcnt(11)
ds_read_b128 v[164:167], v7 offset:1024
v_mfma_f32_16x16x32_bf16 v[124:127], v[180:183], a[76:79], v[124:127]
buffer_load_dwordx4 a[212:215], v14, s[24:27], s93 offen offset:0 sc1
v_mfma_f32_16x16x32_bf16 v[124:127], v[176:179], a[68:71], v[124:127]
s_waitcnt lgkmcnt(7)
s_add_u32 s91, s91, 16384
ds_read_b128 v[168:171], v7 offset:2048
v_mfma_f32_16x16x32_bf16 v[72:75], v[184:187], a[64:67], v[72:75]
s_add_u32 s53, s84, 2
ds_read_b128 v[172:175], v7 offset:3072
v_mfma_f32_16x16x32_bf16 v[72:75], v[188:191], a[72:75], v[72:75]
L_PAD11:
s_cbranch_execz L_MAIN
ds_write_b64 v11, a[114:115] offset:8
v_mfma_f32_16x16x32_bf16 v[76:79], v[188:191], a[76:79], v[76:79]
buffer_load_dwordx4 a[220:223], v14, s[24:27], s93 offen offset:2048 sc1
v_mfma_f32_16x16x32_bf16 v[76:79], v[184:187], a[68:71], v[76:79]
s_and_b32 s53, s53, 3
s_waitcnt lgkmcnt(8)
ds_read_b128 v[176:179], v7 offset:4096
v_mfma_f32_16x16x32_bf16 v[80:83], v[144:147], a[64:67], v[80:83]
s_xor_b32 s65, s82, 32768
s_add_u32 s65, s65, s77
ds_read_b128 v[180:183], v7 offset:5120
v_mfma_f32_16x16x32_bf16 v[80:83], v[148:151], a[72:75], v[80:83]
ds_write_b64 v11, a[116:117] offset:1024
v_mfma_f32_16x16x32_bf16 v[84:87], v[148:151], a[76:79], v[84:87]
s_mul_i32 s53, s53, 6144
s_waitcnt lgkmcnt(9)
ds_read_b128 v[184:187], v7 offset:6144
v_mfma_f32_16x16x32_bf16 v[84:87], v[144:147], a[68:71], v[84:87]
buffer_load_dwordx4 a[224:227], v15, s[24:27], s65 offen offset:0 sc1
v_mfma_f32_16x16x32_bf16 v[88:91], v[152:155], a[64:67], v[88:91]
s_cmp_ge_u32 s91, 163840
s_cselect_b32 s91, 0, s91
ds_read_b128 v[188:191], v7 offset:7168
v_mfma_f32_16x16x32_bf16 v[88:91], v[156:159], a[72:75], v[88:91]
s_add_u32 s53, s53, s69
s_waitcnt lgkmcnt(8)
v_add_u32 v8, s91, v4
v_mfma_f32_16x16x32_bf16 v[92:95], v[156:159], a[76:79], v[92:95]
ds_write_b64 v11, a[118:119] offset:1032
v_mfma_f32_16x16x32_bf16 v[92:95], v[152:155], a[68:71], v[92:95]
buffer_load_dwordx4 a[232:235], v15, s[24:27], s65 offen offset:2048 sc1
v_mfma_f32_16x16x32_bf16 v[96:99], v[160:163], a[64:67], v[96:99]
s_add_u32 s53, s53, 2048
s_xor_b32 s93, s82, 32768
s_add_u32 s93, s93, s81
v_mfma_f32_16x16x32_bf16 v[96:99], v[164:167], a[72:75], v[96:99]
ds_read_b128 v[144:147], v7 offset:8192
v_mfma_f32_16x16x32_bf16 v[100:103], v[164:167], a[76:79], v[100:103]
ds_write_b64 v11, a[120:121] offset:2048
v_mfma_f32_16x16x32_bf16 v[100:103], v[160:163], a[68:71], v[100:103]
s_add_u32 s54, s84, 3
s_waitcnt lgkmcnt(9) vmcnt(12)
ds_read_b128 v[148:151], v7 offset:9216
v_mfma_f32_16x16x32_bf16 v[120:123], v[168:171], a[80:83], v[120:123]
buffer_load_dwordx4 a[228:231], v15, s[24:27], s93 offen offset:0 sc1
v_mfma_f32_16x16x32_bf16 v[120:123], v[172:175], a[88:91], v[120:123]
s_waitcnt vmcnt(11)
ds_read_b128 v[152:155], v7 offset:10240
v_mfma_f32_16x16x32_bf16 v[124:127], v[172:175], a[92:95], v[124:127]
s_and_b32 s54, s54, 3
s_waitcnt lgkmcnt(8)
ds_read_b128 v[156:159], v7 offset:11264
v_mfma_f32_16x16x32_bf16 v[124:127], v[168:171], a[84:87], v[124:127]
ds_write_b64 v11, a[122:123] offset:2056
v_mfma_f32_16x16x32_bf16 v[72:75], v[176:179], a[80:83], v[72:75]
buffer_load_dwordx4 a[236:239], v15, s[24:27], s93 offen offset:2048 sc1
v_mfma_f32_16x16x32_bf16 v[72:75], v[180:183], a[88:91], v[72:75]
s_mul_i32 s54, s54, 6144
ds_read_b128 v[160:163], v7 offset:12288
v_mfma_f32_16x16x32_bf16 v[76:79], v[180:183], a[92:95], v[76:79]
s_waitcnt lgkmcnt(8)
ds_read_b128 v[164:167], v7 offset:13312
v_mfma_f32_16x16x32_bf16 v[76:79], v[176:179], a[84:87], v[76:79]
ds_write_b64 v11, a[124:125] offset:3072
v_mfma_f32_16x16x32_bf16 v[80:83], v[184:187], a[80:83], v[80:83]
s_add_u32 s54, s54, s69
ds_read_b128 v[168:171], v7 offset:14336
v_mfma_f32_16x16x32_bf16 v[80:83], v[188:191], a[88:91], v[80:83]
ds_read_b128 v[172:175], v7 offset:15360
v_mfma_f32_16x16x32_bf16 v[84:87], v[188:191], a[92:95], v[84:87]
buffer_load_dwordx4 a[240:243], v14, s[24:27], s65 offen offset:0 sc1
v_mfma_f32_16x16x32_bf16 v[84:87], v[184:187], a[84:87], v[84:87]
s_add_u32 s54, s54, 4096
s_waitcnt lgkmcnt(8)
ds_read_b128 v[176:179], v8 offset:0
v_mfma_f32_16x16x32_bf16 v[88:91], v[144:147], a[80:83], v[88:91]
ds_write_b64 v11, a[126:127] offset:3080
v_mfma_f32_16x16x32_bf16 v[88:91], v[148:151], a[88:91], v[88:91]
s_add_u32 s91, s91, 16384
ds_read_b128 v[180:183], v8 offset:1024
v_add_u32 v11, s70, v4
v_mfma_f32_16x16x32_bf16 v[92:95], v[148:151], a[92:95], v[92:95]
s_sub_u32 s55, s3, s84
s_add_u32 s70, s70, 16384
ds_read_b128 v[184:187], v8 offset:2048
v_mfma_f32_16x16x32_bf16 v[92:95], v[144:147], a[84:87], v[92:95]
s_cmp_ge_u32 s70, 163840
s_cselect_b32 s70, s80, s70
s_waitcnt lgkmcnt(10)
v_mfma_f32_16x16x32_bf16 v[96:99], v[152:155], a[80:83], v[96:99]
buffer_load_dwordx4 a[248:251], v14, s[24:27], s65 offen offset:2048 sc1
v_mfma_f32_16x16x32_bf16 v[96:99], v[156:159], a[88:91], v[96:99]
s_and_b32 s55, s55, 3
s_waitcnt lgkmcnt(7) vmcnt(12)
ds_read_b128 v[188:191], v8 offset:3072
v_mfma_f32_16x16x32_bf16 v[100:103], v[156:159], a[92:95], v[100:103]
ds_write_b64 v11, a[160:161] offset:0
v_mfma_f32_16x16x32_bf16 v[100:103], v[152:155], a[84:87], v[100:103]
buffer_load_dwordx4 a[244:247], v14, s[24:27], s93 offen offset:0 sc1
v_mfma_f32_16x16x32_bf16 v[120:123], v[160:163], a[192:195], v[120:123]
s_lshl_b32 s55, s55, 10
ds_read_b128 v[144:147], v8 offset:4096
v_mfma_f32_16x16x32_bf16 v[120:123], v[164:167], a[200:203], v[120:123]
s_waitcnt vmcnt(11)
ds_read_b128 v[148:151], v8 offset:5120
v_mfma_f32_16x16x32_bf16 v[124:127], v[164:167], a[204:207], v[124:127]
ds_write_b64 v11, a[162:163] offset:8
v_mfma_f32_16x16x32_bf16 v[124:127], v[160:163], a[196:199], v[124:127]
s_add_u32 s55, s55, s69
s_waitcnt lgkmcnt(9)
ds_read_b128 v[152:155], v8 offset:6144
v_mfma_f32_16x16x32_bf16 v[72:75], v[168:171], a[192:195], v[72:75]
buffer_load_dwordx4 a[252:255], v14, s[24:27], s93 offen offset:2048 sc1
v_mfma_f32_16x16x32_bf16 v[72:75], v[172:175], a[200:203], v[72:75]
s_cmp_ge_u32 s91, 163840
s_cselect_b32 s91, 0, s91
ds_read_b128 v[156:159], v8 offset:7168
v_mfma_f32_16x16x32_bf16 v[76:79], v[172:175], a[204:207], v[76:79]
s_add_u32 s55, s55, 23552
s_waitcnt lgkmcnt(8)
ds_read_b128 v[160:163], v8 offset:8192
v_mfma_f32_16x16x32_bf16 v[76:79], v[168:171], a[196:199], v[76:79]
ds_write_b64 v11, a[164:165] offset:1024
v_mfma_f32_16x16x32_bf16 v[80:83], v[176:179], a[192:195], v[80:83]
s_xor_b32 s65, s82, 40960
s_add_u32 s65, s65, s77
ds_read_b128 v[164:167], v8 offset:9216
v_mfma_f32_16x16x32_bf16 v[80:83], v[180:183], a[200:203], v[80:83]
s_add_u32 s71, s69, 24576
s_waitcnt lgkmcnt(9)
v_add_u32 v7, s91, v4
v_mfma_f32_16x16x32_bf16 v[84:87], v[180:183], a[204:207], v[84:87]
buffer_load_dwordx4 a[96:99], v15, s[24:27], s65 offen offset:0 sc1
v_mfma_f32_16x16x32_bf16 v[84:87], v[176:179], a[196:199], v[84:87]
ds_write_b64 v11, a[166:167] offset:1032
v_mfma_f32_16x16x32_bf16 v[88:91], v[184:187], a[192:195], v[88:91]
s_cmp_eq_u32 s3, s84
s_cselect_b32 s55, 2147418112, s55
s_cselect_b32 s71, s71, 2147418112
v_mfma_f32_16x16x32_bf16 v[88:91], v[188:191], a[200:203], v[88:91]
ds_read_b128 v[168:171], v8 offset:10240
v_mfma_f32_16x16x32_bf16 v[92:95], v[188:191], a[204:207], v[92:95]
buffer_load_dwordx4 a[104:107], v15, s[24:27], s65 offen offset:2048 sc1
v_mfma_f32_16x16x32_bf16 v[92:95], v[184:187], a[196:199], v[92:95]
s_mul_i32 s83, s84, 6144
s_waitcnt lgkmcnt(8)
ds_read_b128 v[172:175], v8 offset:11264
v_mfma_f32_16x16x32_bf16 v[96:99], v[144:147], a[192:195], v[96:99]
ds_write_b64 v11, a[168:169] offset:2048
v_mfma_f32_16x16x32_bf16 v[96:99], v[148:151], a[200:203], v[96:99]
s_xor_b32 s93, s82, 40960
s_add_u32 s93, s93, s81
ds_read_b128 v[176:179], v8 offset:12288
v_mfma_f32_16x16x32_bf16 v[100:103], v[148:151], a[204:207], v[100:103]
s_add_u32 s69, s69, s83
s_waitcnt lgkmcnt(8) vmcnt(12)
ds_read_b128 v[180:183], v8 offset:13312
v_mfma_f32_16x16x32_bf16 v[100:103], v[144:147], a[196:199], v[100:103]
buffer_load_dwordx4 a[100:103], v15, s[24:27], s93 offen offset:0 sc1
v_mfma_f32_16x16x32_bf16 v[120:123], v[152:155], a[208:211], v[120:123]
s_waitcnt vmcnt(57)
s_waitcnt vmcnt(11)
ds_read_b128 v[184:187], v8 offset:14336
v_mfma_f32_16x16x32_bf16 v[120:123], v[156:159], a[216:219], v[120:123]
s_barrier
v_mfma_f32_16x16x32_bf16 v[124:127], v[156:159], a[220:223], v[124:127]
s_add_u32 s83, s69, 4096
s_waitcnt lgkmcnt(7)
ds_read_b128 v[188:191], v8 offset:15360
v_mfma_f32_16x16x32_bf16 v[124:127], v[152:155], a[212:215], v[124:127]
ds_write_b64 v11, a[170:171] offset:2056
v_mfma_f32_16x16x32_bf16 v[72:75], v[160:163], a[208:211], v[72:75]
buffer_load_dwordx4 a[108:111], v15, s[24:27], s93 offen offset:2048 sc1
v_mfma_f32_16x16x32_bf16 v[72:75], v[164:167], a[216:219], v[72:75]
s_add_u32 s91, s91, 16384
ds_read_b128 v[144:147], v7 offset:0
v_mfma_f32_16x16x32_bf16 v[76:79], v[164:167], a[220:223], v[76:79]
s_waitcnt lgkmcnt(7)
ds_read_b128 v[148:151], v7 offset:1024
v_mfma_f32_16x16x32_bf16 v[76:79], v[160:163], a[212:215], v[76:79]
ds_write_b64 v11, a[172:173] offset:3072
v_mfma_f32_16x16x32_bf16 v[80:83], v[168:171], a[208:211], v[80:83]
s_cmp_ge_u32 s91, 163840
s_cselect_b32 s91, 0, s91
ds_read_b128 v[152:155], v7 offset:2048
v_mfma_f32_16x16x32_bf16 v[80:83], v[172:175], a[216:219], v[80:83]
s_waitcnt lgkmcnt(7)
ds_read_b128 v[156:159], v7 offset:3072
v_add_u32 v8, s91, v4
v_mfma_f32_16x16x32_bf16 v[84:87], v[172:175], a[220:223], v[84:87]
buffer_load_dwordx4 a[112:115], v14, s[24:27], s65 offen offset:0 sc1
v_mfma_f32_16x16x32_bf16 v[84:87], v[168:171], a[212:215], v[84:87]
ds_write_b64 v11, a[174:175] offset:3080
v_mfma_f32_16x16x32_bf16 v[88:91], v[176:179], a[208:211], v[88:91]
s_add_u32 s68, s68, 49152
ds_read_b128 v[160:163], v7 offset:4096
v_mfma_f32_16x16x32_bf16 v[88:91], v[180:183], a[216:219], v[88:91]
ds_read_b128 v[164:167], v7 offset:5120
v_mfma_f32_16x16x32_bf16 v[92:95], v[180:183], a[220:223], v[92:95]
buffer_load_dwordx4 a[120:123], v14, s[24:27], s65 offen offset:2048 sc1
v_mfma_f32_16x16x32_bf16 v[92:95], v[176:179], a[212:215], v[92:95]
s_waitcnt lgkmcnt(9)
ds_read_b128 v[168:171], v7 offset:6144
v_mfma_f32_16x16x32_bf16 v[96:99], v[184:187], a[208:211], v[96:99]
ds_read_b128 v[172:175], v7 offset:7168
v_mfma_f32_16x16x32_bf16 v[96:99], v[188:191], a[216:219], v[96:99]
v_mfma_f32_16x16x32_bf16 v[100:103], v[188:191], a[220:223], v[100:103]
buffer_load_dwordx4 a[116:119], v14, s[24:27], s93 offen offset:0 sc1
v_mfma_f32_16x16x32_bf16 v[100:103], v[184:187], a[212:215], v[100:103]
s_waitcnt lgkmcnt(8) vmcnt(13)
ds_read_b128 v[176:179], v7 offset:8192
v_mfma_f32_16x16x32_bf16 v[120:123], v[144:147], a[224:227], v[120:123]
ds_read_b128 v[180:183], v7 offset:9216
v_mfma_f32_16x16x32_bf16 v[120:123], v[148:151], a[232:235], v[120:123]
s_waitcnt vmcnt(11)
v_mfma_f32_16x16x32_bf16 v[124:127], v[148:151], a[236:239], v[124:127]
buffer_load_dwordx4 a[124:127], v14, s[24:27], s93 offen offset:2048 sc1
v_mfma_f32_16x16x32_bf16 v[124:127], v[144:147], a[228:231], v[124:127]
s_waitcnt lgkmcnt(7)
ds_read_b128 v[184:187], v7 offset:10240
v_mfma_f32_16x16x32_bf16 v[72:75], v[152:155], a[224:227], v[72:75]
ds_read_b128 v[188:191], v7 offset:11264
v_mfma_f32_16x16x32_bf16 v[72:75], v[156:159], a[232:235], v[72:75]
v_mfma_f32_16x16x32_bf16 v[76:79], v[156:159], a[236:239], v[76:79]
ds_read_b128 v[144:147], v7 offset:12288
v_mfma_f32_16x16x32_bf16 v[76:79], v[152:155], a[228:231], v[76:79]
s_waitcnt lgkmcnt(7)
v_mfma_f32_16x16x32_bf16 v[80:83], v[160:163], a[224:227], v[80:83]
s_xor_b32 s65, s82, 49152
s_add_u32 s65, s65, s77
ds_read_b128 v[148:151], v7 offset:13312
v_mfma_f32_16x16x32_bf16 v[80:83], v[164:167], a[232:235], v[80:83]
v_mov_b32 v13, 0xffff0000
v_mul_u32_u24 v5, 1152, v2
v_mfma_f32_16x16x32_bf16 v[84:87], v[164:167], a[236:239], v[84:87]
buffer_load_dwordx4 a[128:131], v15, s[24:27], s65 offen offset:0 sc1
v_mfma_f32_16x16x32_bf16 v[84:87], v[160:163], a[228:231], v[84:87]
s_waitcnt lgkmcnt(6)
ds_read_b128 v[152:155], v7 offset:14336
v_lshl_add_u32 v6, v3, 3, v5
v_mfma_f32_16x16x32_bf16 v[88:91], v[168:171], a[224:227], v[88:91]
ds_read_b128 v[156:159], v7 offset:15360
v_and_b32 v9, 1, v3
v_mfma_f32_16x16x32_bf16 v[88:91], v[172:175], a[232:235], v[88:91]
s_add_u32 s91, s91, 16384
s_cmp_ge_u32 s91, 163840
s_cselect_b32 s91, 0, s91
v_mfma_f32_16x16x32_bf16 v[92:95], v[172:175], a[236:239], v[92:95]
buffer_load_dwordx4 a[136:139], v15, s[24:27], s65 offen offset:2048 sc1
v_mfma_f32_16x16x32_bf16 v[92:95], v[168:171], a[228:231], v[92:95]
s_waitcnt lgkmcnt(6)
ds_read_b128 v[160:163], v8 offset:0
v_add_u32 v7, s91, v4
v_mfma_f32_16x16x32_bf16 v[96:99], v[176:179], a[224:227], v[96:99]
s_xor_b32 s93, s82, 49152
s_add_u32 s93, s93, s81
ds_read_b128 v[164:167], v8 offset:1024
v_mfma_f32_16x16x32_bf16 v[96:99], v[180:183], a[232:235], v[96:99]
v_lshl_add_u32 v5, v9, 5, v5
v_lshrrev_b32 v9, 1, v3
v_mfma_f32_16x16x32_bf16 v[100:103], v[180:183], a[236:239], v[100:103]
buffer_load_dwordx4 a[132:135], v15, s[24:27], s93 offen offset:0 sc1
v_mfma_f32_16x16x32_bf16 v[100:103], v[176:179], a[228:231], v[100:103]
s_waitcnt lgkmcnt(6) vmcnt(13)
ds_read_b128 v[168:171], v8 offset:2048
v_lshl_add_u32 v5, v9, 4, v5
v_mfma_f32_16x16x32_bf16 v[120:123], v[184:187], a[240:243], v[120:123]
ds_read_b128 v[172:175], v8 offset:3072
v_mfma_f32_16x16x32_bf16 v[120:123], v[188:191], a[248:251], v[120:123]
s_waitcnt vmcnt(11)
v_mfma_f32_16x16x32_bf16 v[124:127], v[188:191], a[252:255], v[124:127]
buffer_load_dwordx4 a[140:143], v15, s[24:27], s93 offen offset:2048 sc1
v_mfma_f32_16x16x32_bf16 v[124:127], v[184:187], a[244:247], v[124:127]
s_waitcnt lgkmcnt(6)
ds_read_b128 v[176:179], v8 offset:4096
v_mfma_f32_16x16x32_bf16 v[72:75], v[144:147], a[240:243], v[72:75]
ds_read_b128 v[180:183], v8 offset:5120
v_mfma_f32_16x16x32_bf16 v[72:75], v[148:151], a[248:251], v[72:75]
v_mfma_f32_16x16x32_bf16 v[76:79], v[148:151], a[252:255], v[76:79]
ds_read_b128 v[184:187], v8 offset:6144
v_mfma_f32_16x16x32_bf16 v[76:79], v[144:147], a[244:247], v[76:79]
s_waitcnt lgkmcnt(7)
v_mfma_f32_16x16x32_bf16 v[80:83], v[152:155], a[240:243], v[80:83]
ds_read_b128 v[188:191], v8 offset:7168
v_mfma_f32_16x16x32_bf16 v[80:83], v[156:159], a[248:251], v[80:83]
s_waitcnt lgkmcnt(6)
v_mfma_f32_16x16x32_bf16 v[84:87], v[156:159], a[252:255], v[84:87]
buffer_load_dword v12, v10, s[24:27], s75 offen offset:128 sc1
v_mfma_f32_16x16x32_bf16 v[84:87], v[152:155], a[244:247], v[84:87]
buffer_load_dwordx4 a[144:147], v14, s[24:27], s65 offen offset:0 sc1
v_mfma_f32_16x16x32_bf16 v[88:91], v[160:163], a[240:243], v[88:91]
ds_read_b128 v[144:147], v8 offset:8192
v_mfma_f32_16x16x32_bf16 v[88:91], v[164:167], a[248:251], v[88:91]
ds_read_b128 v[148:151], v8 offset:9216
v_mfma_f32_16x16x32_bf16 v[92:95], v[164:167], a[252:255], v[92:95]
buffer_load_dwordx4 a[152:155], v14, s[24:27], s65 offen offset:2048 sc1
v_mfma_f32_16x16x32_bf16 v[92:95], v[160:163], a[244:247], v[92:95]
s_waitcnt lgkmcnt(6)
ds_read_b128 v[152:155], v8 offset:10240
v_mfma_f32_16x16x32_bf16 v[96:99], v[168:171], a[240:243], v[96:99]
ds_read_b128 v[156:159], v8 offset:11264
v_mfma_f32_16x16x32_bf16 v[96:99], v[172:175], a[248:251], v[96:99]
v_mfma_f32_16x16x32_bf16 v[100:103], v[172:175], a[252:255], v[100:103]
buffer_load_dwordx4 a[148:151], v14, s[24:27], s93 offen offset:0 sc1
v_mfma_f32_16x16x32_bf16 v[100:103], v[168:171], a[244:247], v[100:103]
s_waitcnt lgkmcnt(6) vmcnt(14)
ds_read_b128 v[160:163], v8 offset:12288
v_mfma_f32_16x16x32_bf16 v[120:123], v[176:179], a[96:99], v[120:123]
ds_read_b128 v[164:167], v8 offset:13312
v_mfma_f32_16x16x32_bf16 v[120:123], v[180:183], a[104:107], v[120:123]
s_waitcnt vmcnt(12)
v_mfma_f32_16x16x32_bf16 v[124:127], v[180:183], a[108:111], v[124:127]
buffer_load_dwordx4 a[156:159], v14, s[24:27], s93 offen offset:2048 sc1
v_mfma_f32_16x16x32_bf16 v[124:127], v[176:179], a[100:103], v[124:127]
s_waitcnt lgkmcnt(6)
ds_read_b128 v[168:171], v8 offset:14336
v_mfma_f32_16x16x32_bf16 v[72:75], v[184:187], a[96:99], v[72:75]
s_waitcnt vmcnt(62)
ds_read_b128 v[172:175], v8 offset:15360
v_mfma_f32_16x16x32_bf16 v[72:75], v[188:191], a[104:107], v[72:75]
s_barrier
v_mfma_f32_16x16x32_bf16 v[76:79], v[188:191], a[108:111], v[76:79]
s_add_u32 s91, s91, 16384
ds_read_b128 v[176:179], v7 offset:0
v_mfma_f32_16x16x32_bf16 v[76:79], v[184:187], a[100:103], v[76:79]
s_waitcnt lgkmcnt(7)
s_cmp_ge_u32 s91, 163840
s_cselect_b32 s91, 0, s91
v_mfma_f32_16x16x32_bf16 v[80:83], v[144:147], a[96:99], v[80:83]
s_xor_b32 s65, s82, 57344
s_add_u32 s65, s65, s77
ds_read_b128 v[180:183], v7 offset:1024
v_mfma_f32_16x16x32_bf16 v[80:83], v[148:151], a[104:107], v[80:83]
v_add_u32 v8, s91, v4
v_mfma_f32_16x16x32_bf16 v[84:87], v[148:151], a[108:111], v[84:87]
buffer_load_dwordx4 a[160:163], v15, s[24:27], s65 offen offset:0 sc1
v_mfma_f32_16x16x32_bf16 v[84:87], v[144:147], a[100:103], v[84:87]
s_waitcnt lgkmcnt(6)
ds_read_b128 v[184:187], v7 offset:2048
v_mfma_f32_16x16x32_bf16 v[88:91], v[152:155], a[96:99], v[88:91]
ds_read_b128 v[188:191], v7 offset:3072
v_mfma_f32_16x16x32_bf16 v[88:91], v[156:159], a[104:107], v[88:91]
v_mfma_f32_16x16x32_bf16 v[92:95], v[156:159], a[108:111], v[92:95]
buffer_load_dwordx4 a[168:171], v15, s[24:27], s65 offen offset:2048 sc1
v_mfma_f32_16x16x32_bf16 v[92:95], v[152:155], a[100:103], v[92:95]
s_waitcnt lgkmcnt(6)
ds_read_b128 v[144:147], v7 offset:4096
v_mfma_f32_16x16x32_bf16 v[96:99], v[160:163], a[96:99], v[96:99]
s_xor_b32 s93, s82, 57344
s_add_u32 s93, s93, s81
ds_read_b128 v[148:151], v7 offset:5120
v_mfma_f32_16x16x32_bf16 v[96:99], v[164:167], a[104:107], v[96:99]
v_mfma_f32_16x16x32_bf16 v[100:103], v[164:167], a[108:111], v[100:103]
buffer_load_dwordx4 a[164:167], v15, s[24:27], s93 offen offset:0 sc1
v_mfma_f32_16x16x32_bf16 v[100:103], v[160:163], a[100:103], v[100:103]
s_waitcnt lgkmcnt(6) vmcnt(14)
ds_read_b128 v[152:155], v7 offset:6144
v_mfma_f32_16x16x32_bf16 v[120:123], v[168:171], a[112:115], v[120:123]
ds_read_b128 v[156:159], v7 offset:7168
v_mfma_f32_16x16x32_bf16 v[120:123], v[172:175], a[120:123], v[120:123]
s_waitcnt vmcnt(12)
v_mfma_f32_16x16x32_bf16 v[124:127], v[172:175], a[124:127], v[124:127]
buffer_load_dwordx4 a[172:175], v15, s[24:27], s93 offen offset:2048 sc1
v_mfma_f32_16x16x32_bf16 v[124:127], v[168:171], a[116:119], v[124:127]
s_waitcnt lgkmcnt(6)
ds_read_b128 v[160:163], v7 offset:8192
v_mfma_f32_16x16x32_bf16 v[72:75], v[176:179], a[112:115], v[72:75]
ds_read_b128 v[164:167], v7 offset:9216
v_mfma_f32_16x16x32_bf16 v[72:75], v[180:183], a[120:123], v[72:75]
v_mfma_f32_16x16x32_bf16 v[76:79], v[180:183], a[124:127], v[76:79]
ds_read_b128 v[168:171], v7 offset:10240
v_mfma_f32_16x16x32_bf16 v[76:79], v[176:179], a[116:119], v[76:79]
s_waitcnt lgkmcnt(7)
v_mfma_f32_16x16x32_bf16 v[80:83], v[184:187], a[112:115], v[80:83]
ds_read_b128 v[172:175], v7 offset:11264
v_mfma_f32_16x16x32_bf16 v[80:83], v[188:191], a[120:123], v[80:83]
v_mfma_f32_16x16x32_bf16 v[84:87], v[188:191], a[124:127], v[84:87]
buffer_load_dwordx4 a[176:179], v14, s[24:27], s65 offen offset:0 sc1
v_mfma_f32_16x16x32_bf16 v[84:87], v[184:187], a[116:119], v[84:87]
s_waitcnt lgkmcnt(6)
ds_read_b128 v[176:179], v7 offset:12288
v_mfma_f32_16x16x32_bf16 v[88:91], v[144:147], a[112:115], v[88:91]
ds_read_b128 v[180:183], v7 offset:13312
v_mfma_f32_16x16x32_bf16 v[88:91], v[148:151], a[120:123], v[88:91]
v_mfma_f32_16x16x32_bf16 v[92:95], v[148:151], a[124:127], v[92:95]
buffer_load_dwordx4 a[184:187], v14, s[24:27], s65 offen offset:2048 sc1
v_mfma_f32_16x16x32_bf16 v[92:95], v[144:147], a[116:119], v[92:95]
s_waitcnt lgkmcnt(6)
ds_read_b128 v[184:187], v7 offset:14336
v_mfma_f32_16x16x32_bf16 v[96:99], v[152:155], a[112:115], v[96:99]
s_waitcnt vmcnt(10)
ds_read_b128 v[188:191], v7 offset:15360
v_mfma_f32_16x16x32_bf16 v[96:99], v[156:159], a[120:123], v[96:99]
s_add_u32 s91, s91, 16384
v_cmp_gt_u32 vcc, 8, v12
v_mfma_f32_16x16x32_bf16 v[100:103], v[156:159], a[124:127], v[100:103]
buffer_load_dwordx4 a[180:183], v14, s[24:27], s93 offen offset:0 sc1
v_mfma_f32_16x16x32_bf16 v[100:103], v[152:155], a[116:119], v[100:103]
s_waitcnt lgkmcnt(6) vmcnt(14)
ds_read_b128 v[144:147], v8 offset:0
v_mfma_f32_16x16x32_bf16 v[120:123], v[160:163], a[128:131], v[120:123]
s_cmp_ge_u32 s91, 163840
s_cselect_b32 s91, 0, s91
ds_read_b128 v[148:151], v8 offset:1024
v_mfma_f32_16x16x32_bf16 v[120:123], v[164:167], a[136:139], v[120:123]
s_waitcnt lgkmcnt(6) vmcnt(12)
v_add_u32 v7, s91, v4
v_mfma_f32_16x16x32_bf16 v[124:127], v[164:167], a[140:143], v[124:127]
s_cbranch_vccnz CK_ZAA
CK_ZAA_R:
v_mfma_f32_16x16x32_bf16 v[124:127], v[160:163], a[132:135], v[124:127]
buffer_load_dwordx4 a[188:191], v14, s[24:27], s93 offen offset:2048 sc1
v_mfma_f32_16x16x32_bf16 v[72:75], v[168:171], a[128:131], v[72:75]
ds_read_b128 v[152:155], v8 offset:2048
v_mfma_f32_16x16x32_bf16 v[72:75], v[172:175], a[136:139], v[72:75]
ds_read_b128 v[156:159], v8 offset:3072
v_mfma_f32_16x16x32_bf16 v[76:79], v[172:175], a[140:143], v[76:79]
ds_read_b128 v[160:163], v8 offset:4096
v_mfma_f32_16x16x32_bf16 v[76:79], v[168:171], a[132:135], v[76:79]
s_waitcnt lgkmcnt(7)
v_mfma_f32_16x16x32_bf16 v[80:83], v[176:179], a[128:131], v[80:83]
s_add_u32 s65, s77, 65536
ds_read_b128 v[164:167], v8 offset:5120
v_mfma_f32_16x16x32_bf16 v[80:83], v[180:183], a[136:139], v[80:83]
v_mfma_f32_16x16x32_bf16 v[84:87], v[180:183], a[140:143], v[84:87]
buffer_load_dwordx4 v[32:35], v15, s[24:27], s65 offen offset:0 sc1
v_mfma_f32_16x16x32_bf16 v[84:87], v[176:179], a[132:135], v[84:87]
s_waitcnt lgkmcnt(6)
ds_read_b128 v[168:171], v8 offset:6144
v_mfma_f32_16x16x32_bf16 v[88:91], v[184:187], a[128:131], v[88:91]
ds_read_b128 v[172:175], v8 offset:7168
v_mfma_f32_16x16x32_bf16 v[88:91], v[188:191], a[136:139], v[88:91]
v_mfma_f32_16x16x32_bf16 v[92:95], v[188:191], a[140:143], v[92:95]
buffer_load_dwordx4 v[40:43], v15, s[24:27], s65 offen offset:2048 sc1
v_mfma_f32_16x16x32_bf16 v[92:95], v[184:187], a[132:135], v[92:95]
s_waitcnt lgkmcnt(6)
ds_read_b128 v[176:179], v8 offset:8192
v_mfma_f32_16x16x32_bf16 v[96:99], v[144:147], a[128:131], v[96:99]
s_add_u32 s93, s81, 65536
ds_read_b128 v[180:183], v8 offset:9216
v_mfma_f32_16x16x32_bf16 v[96:99], v[148:151], a[136:139], v[96:99]
s_waitcnt lgkmcnt(6) vmcnt(12)
v_mfma_f32_16x16x32_bf16 v[100:103], v[148:151], a[140:143], v[100:103]
buffer_load_dwordx4 v[36:39], v15, s[24:27], s93 offen offset:0 sc1
v_mfma_f32_16x16x32_bf16 v[100:103], v[144:147], a[132:135], v[100:103]
s_mov_b32 m0, s70
s_mov_b32 s64, s68
s_add_u32 s68, s68, 16384
v_mfma_f32_16x16x32_bf16 v[120:123], v[152:155], a[144:147], v[120:123]
s_waitcnt vmcnt(11)
ds_read_b128 v[184:187], v8 offset:10240
v_mfma_f32_16x16x32_bf16 v[120:123], v[156:159], a[152:155], v[120:123]
s_add_u32 s70, s70, 16384
s_cmp_ge_u32 s70, 163840
s_cselect_b32 s70, s80, s70
v_mfma_f32_16x16x32_bf16 v[124:127], v[156:159], a[156:159], v[124:127]
buffer_load_dwordx4 v15, s[24:27], s64 offen offset:0 sc1 lds
v_mfma_f32_16x16x32_bf16 v[124:127], v[152:155], a[148:151], v[124:127]
s_waitcnt lgkmcnt(5)
ds_read_b128 v[188:191], v8 offset:11264
v_mfma_f32_16x16x32_bf16 v[72:75], v[160:163], a[144:147], v[72:75]
ds_read_b128 v[144:147], v8 offset:12288
v_mfma_f32_16x16x32_bf16 v[72:75], v[164:167], a[152:155], v[72:75]
buffer_load_dwordx4 v15, s[24:27], s64 offen offset:1024 sc1 lds
v_mfma_f32_16x16x32_bf16 v[76:79], v[164:167], a[156:159], v[76:79]
ds_read_b128 v[148:151], v8 offset:13312
v_mfma_f32_16x16x32_bf16 v[76:79], v[160:163], a[148:151], v[76:79]
s_waitcnt lgkmcnt(6)
ds_read_b128 v[152:155], v8 offset:14336
v_mfma_f32_16x16x32_bf16 v[80:83], v[168:171], a[144:147], v[80:83]
buffer_load_dwordx4 v[44:47], v15, s[24:27], s93 offen offset:2048 sc1
v_mfma_f32_16x16x32_bf16 v[80:83], v[172:175], a[152:155], v[80:83]
s_barrier
v_mfma_f32_16x16x32_bf16 v[84:87], v[172:175], a[156:159], v[84:87]
s_waitcnt lgkmcnt(5)
ds_read_b128 v[156:159], v8 offset:15360
v_mfma_f32_16x16x32_bf16 v[84:87], v[168:171], a[148:151], v[84:87]
buffer_load_dwordx4 v15, s[24:27], s64 offen offset:2048 sc1 lds
v_mfma_f32_16x16x32_bf16 v[88:91], v[176:179], a[144:147], v[88:91]
s_add_u32 s91, s91, 16384
ds_read_b128 v[160:163], v7 offset:0
v_mfma_f32_16x16x32_bf16 v[88:91], v[180:183], a[152:155], v[88:91]
s_cmp_ge_u32 s91, 163840
s_cselect_b32 s91, 0, s91
ds_read_b128 v[164:167], v7 offset:1024
v_mfma_f32_16x16x32_bf16 v[92:95], v[180:183], a[156:159], v[92:95]
buffer_load_dwordx4 v15, s[24:27], s64 offen offset:3072 sc1 lds
v_mfma_f32_16x16x32_bf16 v[92:95], v[176:179], a[148:151], v[92:95]
s_waitcnt lgkmcnt(6)
ds_read_b128 v[168:171], v7 offset:2048
v_add_u32 v8, s91, v4
v_mfma_f32_16x16x32_bf16 v[96:99], v[184:187], a[144:147], v[96:99]
ds_read_b128 v[172:175], v7 offset:3072
v_mfma_f32_16x16x32_bf16 v[96:99], v[188:191], a[152:155], v[96:99]
buffer_load_dwordx4 v[48:51], v14, s[24:27], s65 offen offset:0 sc1
v_mfma_f32_16x16x32_bf16 v[100:103], v[188:191], a[156:159], v[100:103]
ds_read_b128 v[176:179], v7 offset:4096
v_mfma_f32_16x16x32_bf16 v[100:103], v[184:187], a[148:151], v[100:103]
s_waitcnt lgkmcnt(7) vmcnt(15)
v_mfma_f32_16x16x32_bf16 v[120:123], v[144:147], a[160:163], v[120:123]
buffer_load_dwordx4 v[56:59], v14, s[24:27], s65 offen offset:2048 sc1
v_mfma_f32_16x16x32_bf16 v[120:123], v[148:151], a[168:171], v[120:123]
s_waitcnt vmcnt(14)
ds_read_b128 v[180:183], v7 offset:5120
v_mfma_f32_16x16x32_bf16 v[124:127], v[148:151], a[172:175], v[124:127]
s_waitcnt lgkmcnt(6)
ds_read_b128 v[184:187], v7 offset:6144
v_mfma_f32_16x16x32_bf16 v[124:127], v[144:147], a[164:167], v[124:127]
buffer_load_dwordx4 v[52:55], v14, s[24:27], s93 offen offset:0 sc1
v_mfma_f32_16x16x32_bf16 v[72:75], v[152:155], a[160:163], v[72:75]
ds_read_b128 v[188:191], v7 offset:7168
v_mfma_f32_16x16x32_bf16 v[72:75], v[156:159], a[168:171], v[72:75]
v_mfma_f32_16x16x32_bf16 v[76:79], v[156:159], a[172:175], v[76:79]
buffer_load_dwordx4 v[60:63], v14, s[24:27], s93 offen offset:2048 sc1
v_mfma_f32_16x16x32_bf16 v[76:79], v[152:155], a[164:167], v[76:79]
s_waitcnt lgkmcnt(6)
ds_read_b128 v[144:147], v7 offset:8192
v_mfma_f32_16x16x32_bf16 v[80:83], v[160:163], a[160:163], v[80:83]
ds_read_b128 v[148:151], v7 offset:9216
v_mfma_f32_16x16x32_bf16 v[80:83], v[164:167], a[168:171], v[80:83]
v_mfma_f32_16x16x32_bf16 v[84:87], v[164:167], a[172:175], v[84:87]
ds_read_b128 v[152:155], v7 offset:10240
v_mfma_f32_16x16x32_bf16 v[84:87], v[160:163], a[164:167], v[84:87]
s_waitcnt lgkmcnt(7)
v_mfma_f32_16x16x32_bf16 v[88:91], v[168:171], a[160:163], v[88:91]
s_add_u32 s65, s77, 73728
ds_read_b128 v[156:159], v7 offset:11264
v_mfma_f32_16x16x32_bf16 v[88:91], v[172:175], a[168:171], v[88:91]
v_mfma_f32_16x16x32_bf16 v[92:95], v[172:175], a[172:175], v[92:95]
buffer_load_dwordx4 v[64:67], v15, s[24:27], s65 offen offset:0 sc1
v_mfma_f32_16x16x32_bf16 v[92:95], v[168:171], a[164:167], v[92:95]
s_waitcnt lgkmcnt(6)
ds_read_b128 v[160:163], v7 offset:12288
v_mfma_f32_16x16x32_bf16 v[96:99], v[176:179], a[160:163], v[96:99]
ds_read_b128 v[164:167], v7 offset:13312
v_mfma_f32_16x16x32_bf16 v[96:99], v[180:183], a[168:171], v[96:99]
v_mfma_f32_16x16x32_bf16 v[100:103], v[180:183], a[172:175], v[100:103]
ds_read_b128 v[168:171], v7 offset:14336
v_mfma_f32_16x16x32_bf16 v[100:103], v[176:179], a[164:167], v[100:103]
s_add_u32 s93, s81, 73728
s_waitcnt lgkmcnt(7) vmcnt(15)
v_mfma_f32_16x16x32_bf16 v[120:123], v[184:187], a[176:179], v[120:123]
s_waitcnt vmcnt(13)
ds_read_b128 v[172:175], v7 offset:15360
v_mfma_f32_16x16x32_bf16 v[120:123], v[188:191], a[184:187], v[120:123]
buffer_load_dwordx4 v[68:71], v15, s[24:27], s93 offen offset:0 sc1
v_mfma_f32_16x16x32_bf16 v[124:127], v[188:191], a[188:191], v[124:127]
s_add_u32 s91, s91, 16384
ds_read_b128 v[176:179], v8 offset:0
v_mfma_f32_16x16x32_bf16 v[124:127], v[184:187], a[180:183], v[124:127]
s_waitcnt lgkmcnt(7)
s_cmp_ge_u32 s91, 163840
s_cselect_b32 s91, 0, s91
v_mfma_f32_16x16x32_bf16 v[72:75], v[144:147], a[176:179], v[72:75]
ds_read_b128 v[180:183], v8 offset:1024
v_add_u32 v7, s91, v4
v_mfma_f32_16x16x32_bf16 v[72:75], v[148:151], a[184:187], v[72:75]
v_mfma_f32_16x16x32_bf16 v[76:79], v[148:151], a[188:191], v[76:79]
s_mov_b32 m0, s70
s_mov_b32 s64, s68
s_add_u32 s68, s68, 16384
v_mfma_f32_16x16x32_bf16 v[76:79], v[144:147], a[180:183], v[76:79]
s_waitcnt lgkmcnt(6)
ds_read_b128 v[184:187], v8 offset:2048
v_mfma_f32_16x16x32_bf16 v[80:83], v[152:155], a[176:179], v[80:83]
s_add_u32 s70, s70, 16384
s_cmp_ge_u32 s70, 163840
s_cselect_b32 s70, s80, s70
v_mfma_f32_16x16x32_bf16 v[80:83], v[156:159], a[184:187], v[80:83]
buffer_load_dwordx4 v15, s[24:27], s64 offen offset:0 sc1 lds
v_mfma_f32_16x16x32_bf16 v[84:87], v[156:159], a[188:191], v[84:87]
L_PAD12:
s_cbranch_execz L_MAIN
ds_read_b128 v[188:191], v8 offset:3072
v_mfma_f32_16x16x32_bf16 v[84:87], v[152:155], a[180:183], v[84:87]
s_waitcnt lgkmcnt(6)
ds_read_b128 v[144:147], v8 offset:4096
v_mfma_f32_16x16x32_bf16 v[88:91], v[160:163], a[176:179], v[88:91]
buffer_load_dwordx4 v15, s[24:27], s64 offen offset:1024 sc1 lds
v_mfma_f32_16x16x32_bf16 v[88:91], v[164:167], a[184:187], v[88:91]
ds_read_b128 v[148:151], v8 offset:5120
v_mfma_f32_16x16x32_bf16 v[92:95], v[164:167], a[188:191], v[92:95]
s_waitcnt lgkmcnt(6)
ds_read_b128 v[152:155], v8 offset:6144
v_mfma_f32_16x16x32_bf16 v[92:95], v[160:163], a[180:183], v[92:95]
buffer_load_dwordx4 v15, s[24:27], s64 offen offset:2048 sc1 lds
v_mfma_f32_16x16x32_bf16 v[96:99], v[168:171], a[176:179], v[96:99]
ds_read_b128 v[156:159], v8 offset:7168
v_mfma_f32_16x16x32_bf16 v[96:99], v[172:175], a[184:187], v[96:99]
v_mfma_f32_16x16x32_bf16 v[100:103], v[172:175], a[188:191], v[100:103]
buffer_load_dwordx4 v15, s[24:27], s64 offen offset:3072 sc1 lds
v_mfma_f32_16x16x32_bf16 v[100:103], v[168:171], a[180:183], v[100:103]
s_waitcnt lgkmcnt(6) vmcnt(16)
ds_read_b128 v[160:163], v8 offset:8192
v_mfma_f32_16x16x32_bf16 v[120:123], v[176:179], v[32:35], v[120:123]
s_mov_b32 m0, s70
s_mov_b32 s64, s68
s_add_u32 s68, s68, 16384
v_mfma_f32_16x16x32_bf16 v[120:123], v[180:183], v[40:43], v[120:123]
s_waitcnt lgkmcnt(5) vmcnt(12)
ds_read_b128 v[164:167], v8 offset:9216
v_mfma_f32_16x16x32_bf16 v[124:127], v[180:183], v[44:47], v[124:127]
s_add_u32 s70, s70, 16384
s_cmp_ge_u32 s70, 163840
s_cselect_b32 s70, s80, s70
v_mfma_f32_16x16x32_bf16 v[124:127], v[176:179], v[36:39], v[124:127]
buffer_load_dwordx4 v15, s[24:27], s64 offen offset:0 sc1 lds
v_mfma_f32_16x16x32_bf16 v[72:75], v[184:187], v[32:35], v[72:75]
ds_read_b128 v[168:171], v8 offset:10240
v_mfma_f32_16x16x32_bf16 v[72:75], v[188:191], v[40:43], v[72:75]
ds_read_b128 v[172:175], v8 offset:11264
v_mfma_f32_16x16x32_bf16 v[76:79], v[188:191], v[44:47], v[76:79]
buffer_load_dwordx4 v15, s[24:27], s64 offen offset:1024 sc1 lds
v_mfma_f32_16x16x32_bf16 v[76:79], v[184:187], v[36:39], v[76:79]
s_waitcnt lgkmcnt(6)
ds_read_b128 v[176:179], v8 offset:12288
v_mfma_f32_16x16x32_bf16 v[80:83], v[144:147], v[32:35], v[80:83]
ds_read_b128 v[180:183], v8 offset:13312
v_mfma_f32_16x16x32_bf16 v[80:83], v[148:151], v[40:43], v[80:83]
buffer_load_dwordx4 v15, s[24:27], s64 offen offset:2048 sc1 lds
v_mfma_f32_16x16x32_bf16 v[84:87], v[148:151], v[44:47], v[84:87]
ds_read_b128 v[184:187], v8 offset:14336
v_mfma_f32_16x16x32_bf16 v[84:87], v[144:147], v[36:39], v[84:87]
s_waitcnt lgkmcnt(7)
v_mfma_f32_16x16x32_bf16 v[88:91], v[152:155], v[32:35], v[88:91]
s_waitcnt vmcnt(13)
ds_read_b128 v[188:191], v8 offset:15360
v_mfma_f32_16x16x32_bf16 v[88:91], v[156:159], v[40:43], v[88:91]
s_barrier
v_mfma_f32_16x16x32_bf16 v[92:95], v[156:159], v[44:47], v[92:95]
buffer_load_dwordx4 v15, s[24:27], s64 offen offset:3072 sc1 lds
v_mfma_f32_16x16x32_bf16 v[92:95], v[152:155], v[36:39], v[92:95]
s_waitcnt lgkmcnt(6)
s_add_u32 s91, s91, 16384
ds_read_b128 v[144:147], v7 offset:0
v_mfma_f32_16x16x32_bf16 v[96:99], v[160:163], v[32:35], v[96:99]
s_cmp_ge_u32 s91, 163840
s_cselect_b32 s91, 0, s91
ds_read_b128 v[148:151], v7 offset:1024
v_mfma_f32_16x16x32_bf16 v[96:99], v[164:167], v[40:43], v[96:99]
v_add_u32 v8, s91, v4
v_mfma_f32_16x16x32_bf16 v[100:103], v[164:167], v[44:47], v[100:103]
ds_read_b128 v[152:155], v7 offset:2048
v_mfma_f32_16x16x32_bf16 v[100:103], v[160:163], v[36:39], v[100:103]
s_waitcnt lgkmcnt(7) vmcnt(12)
v_mfma_f32_16x16x32_bf16 v[120:123], v[168:171], v[48:51], v[120:123]
ds_read_b128 v[156:159], v7 offset:3072
v_mfma_f32_16x16x32_bf16 v[120:123], v[172:175], v[56:59], v[120:123]
s_waitcnt vmcnt(10)
v_mfma_f32_16x16x32_bf16 v[124:127], v[172:175], v[60:63], v[124:127]
ds_read_b128 v[160:163], v7 offset:4096
v_mfma_f32_16x16x32_bf16 v[124:127], v[168:171], v[52:55], v[124:127]
s_waitcnt lgkmcnt(7)
v_mfma_f32_16x16x32_bf16 v[72:75], v[176:179], v[48:51], v[72:75]
ds_read_b128 v[164:167], v7 offset:5120
v_mfma_f32_16x16x32_bf16 v[72:75], v[180:183], v[56:59], v[72:75]
v_mfma_f32_16x16x32_bf16 v[76:79], v[180:183], v[60:63], v[76:79]
ds_read_b128 v[168:171], v7 offset:6144
v_mfma_f32_16x16x32_bf16 v[76:79], v[176:179], v[52:55], v[76:79]
s_waitcnt lgkmcnt(7)
v_mfma_f32_16x16x32_bf16 v[80:83], v[184:187], v[48:51], v[80:83]
ds_read_b128 v[172:175], v7 offset:7168
v_mfma_f32_16x16x32_bf16 v[80:83], v[188:191], v[56:59], v[80:83]
v_mfma_f32_16x16x32_bf16 v[84:87], v[188:191], v[60:63], v[84:87]
ds_read_b128 v[176:179], v7 offset:8192
v_mfma_f32_16x16x32_bf16 v[84:87], v[184:187], v[52:55], v[84:87]
s_waitcnt lgkmcnt(7)
v_mfma_f32_16x16x32_bf16 v[88:91], v[144:147], v[48:51], v[88:91]
ds_read_b128 v[180:183], v7 offset:9216
v_mfma_f32_16x16x32_bf16 v[88:91], v[148:151], v[56:59], v[88:91]
v_mfma_f32_16x16x32_bf16 v[92:95], v[148:151], v[60:63], v[92:95]
ds_read_b128 v[184:187], v7 offset:10240
v_mfma_f32_16x16x32_bf16 v[92:95], v[144:147], v[52:55], v[92:95]
s_waitcnt lgkmcnt(7)
v_mfma_f32_16x16x32_bf16 v[96:99], v[152:155], v[48:51], v[96:99]
ds_read_b128 v[188:191], v7 offset:11264
v_mfma_f32_16x16x32_bf16 v[96:99], v[156:159], v[56:59], v[96:99]
v_mfma_f32_16x16x32_bf16 v[100:103], v[156:159], v[60:63], v[100:103]
ds_read_b128 v[144:147], v7 offset:12288
v_mfma_f32_16x16x32_bf16 v[100:103], v[152:155], v[52:55], v[100:103]
s_waitcnt lgkmcnt(7) vmcnt(9)
v_mfma_f32_16x16x32_bf16 v[120:123], v[160:163], v[64:67], v[120:123]
s_waitcnt vmcnt(8)
ds_read_b128 v[148:151], v7 offset:13312
v_mfma_f32_16x16x32_bf16 v[124:127], v[160:163], v[68:71], v[124:127]
v_mfma_f32_16x16x32_bf16 v[72:75], v[164:167], v[64:67], v[72:75]
ds_read_b128 v[152:155], v7 offset:14336
v_mfma_f32_16x16x32_bf16 v[76:79], v[164:167], v[68:71], v[76:79]
s_waitcnt lgkmcnt(7)
v_mfma_f32_16x16x32_bf16 v[80:83], v[168:171], v[64:67], v[80:83]
ds_read_b128 v[156:159], v7 offset:15360
v_mfma_f32_16x16x32_bf16 v[84:87], v[168:171], v[68:71], v[84:87]
s_add_u32 s91, s91, 16384
s_cmp_ge_u32 s91, 163840
s_cselect_b32 s91, 0, s91
v_mfma_f32_16x16x32_bf16 v[88:91], v[172:175], v[64:67], v[88:91]
ds_read_b128 v[160:163], v8 offset:0
v_add_u32 v7, s91, v4
v_mfma_f32_16x16x32_bf16 v[92:95], v[172:175], v[68:71], v[92:95]
s_waitcnt lgkmcnt(7)
v_mfma_f32_16x16x32_bf16 v[96:99], v[176:179], v[64:67], v[96:99]
ds_read_b128 v[164:167], v8 offset:1024
v_cvt_pk_bf16_f32 v228, v120, v121
v_mfma_f32_16x16x32_bf16 v[100:103], v[176:179], v[68:71], v[100:103]
v_cvt_pk_bf16_f32 v229, v122, v123
v_mfma_f32_16x16x32_bf16 v[104:107], v[180:183], a[64:67], v[104:107]
s_waitcnt lgkmcnt(6)
ds_read_b128 v[168:171], v8 offset:2048
v_cvt_pk_bf16_f32 v230, v124, v125
v_mfma_f32_16x16x32_bf16 v[104:107], v[184:187], a[72:75], v[104:107]
v_cvt_pk_bf16_f32 v231, v126, v127
v_mfma_f32_16x16x32_bf16 v[108:111], v[184:187], a[76:79], v[108:111]
buffer_store_dwordx4 v[228:231], v15, s[24:27], s55 offen offset:0 sc1
v_mfma_f32_16x16x32_bf16 v[108:111], v[180:183], a[68:71], v[108:111]
ds_read_b128 v[172:175], v8 offset:3072
v_cvt_pk_bf16_f32 v72, v72, v73
v_mfma_f32_16x16x32_bf16 v[112:115], v[188:191], a[64:67], v[112:115]
s_waitcnt lgkmcnt(6)
ds_read_b128 v[176:179], v8 offset:4096
v_cvt_pk_bf16_f32 v73, v74, v75
v_mfma_f32_16x16x32_bf16 v[112:115], v[144:147], a[72:75], v[112:115]
v_cvt_pk_bf16_f32 v74, v80, v81
v_mfma_f32_16x16x32_bf16 v[116:119], v[144:147], a[76:79], v[116:119]
ds_read_b128 v[180:183], v8 offset:5120
v_cvt_pk_bf16_f32 v75, v82, v83
v_mfma_f32_16x16x32_bf16 v[116:119], v[188:191], a[68:71], v[116:119]
buffer_store_dwordx4 v[72:75], v15, s[24:27], s52 offen offset:0 sc1
v_mfma_f32_16x16x32_bf16 v[104:107], v[148:151], a[80:83], v[104:107]
s_waitcnt lgkmcnt(6)
ds_read_b128 v[184:187], v8 offset:6144
v_cvt_pk_bf16_f32 v76, v76, v77
v_mfma_f32_16x16x32_bf16 v[104:107], v[152:155], a[88:91], v[104:107]
v_cvt_pk_bf16_f32 v77, v78, v79
v_mfma_f32_16x16x32_bf16 v[108:111], v[152:155], a[92:95], v[108:111]
ds_read_b128 v[188:191], v8 offset:7168
v_cvt_pk_bf16_f32 v78, v84, v85
v_mfma_f32_16x16x32_bf16 v[108:111], v[148:151], a[84:87], v[108:111]
s_waitcnt lgkmcnt(6)
v_cvt_pk_bf16_f32 v79, v86, v87
v_mfma_f32_16x16x32_bf16 v[112:115], v[156:159], a[80:83], v[112:115]
buffer_store_dwordx4 v[76:79], v15, s[24:27], s52 offen offset:1024 sc1
v_mfma_f32_16x16x32_bf16 v[112:115], v[160:163], a[88:91], v[112:115]
ds_read_b128 v[144:147], v8 offset:8192
v_cvt_pk_bf16_f32 v88, v88, v89
v_mfma_f32_16x16x32_bf16 v[116:119], v[160:163], a[92:95], v[116:119]
ds_read_b128 v[148:151], v8 offset:9216
v_cvt_pk_bf16_f32 v89, v90, v91
v_mfma_f32_16x16x32_bf16 v[116:119], v[156:159], a[84:87], v[116:119]
v_cvt_pk_bf16_f32 v90, v96, v97
v_mfma_f32_16x16x32_bf16 v[104:107], v[164:167], a[192:195], v[104:107]
s_waitcnt lgkmcnt(6)
ds_read_b128 v[152:155], v8 offset:10240
v_cvt_pk_bf16_f32 v91, v98, v99
v_mfma_f32_16x16x32_bf16 v[104:107], v[168:171], a[200:203], v[104:107]
buffer_store_dwordx4 v[88:91], v15, s[24:27], s53 offen offset:0 sc1
v_mfma_f32_16x16x32_bf16 v[108:111], v[168:171], a[204:207], v[108:111]
ds_read_b128 v[156:159], v8 offset:11264
v_cvt_pk_bf16_f32 v92, v92, v93
v_mfma_f32_16x16x32_bf16 v[108:111], v[164:167], a[196:199], v[108:111]
v_cvt_pk_bf16_f32 v93, v94, v95
v_mfma_f32_16x16x32_bf16 v[112:115], v[172:175], a[192:195], v[112:115]
s_waitcnt lgkmcnt(6)
ds_read_b128 v[160:163], v8 offset:12288
v_cvt_pk_bf16_f32 v94, v100, v101
v_mfma_f32_16x16x32_bf16 v[112:115], v[176:179], a[200:203], v[112:115]
s_waitcnt lgkmcnt(5)
v_cvt_pk_bf16_f32 v95, v102, v103
v_mfma_f32_16x16x32_bf16 v[116:119], v[176:179], a[204:207], v[116:119]
buffer_store_dwordx4 v[92:95], v15, s[24:27], s53 offen offset:1024 sc1
v_mfma_f32_16x16x32_bf16 v[116:119], v[172:175], a[196:199], v[116:119]
s_mov_b32 m0, s70
s_mov_b32 s64, s68
s_add_u32 s68, s68, 16384
v_mfma_f32_16x16x32_bf16 v[104:107], v[180:183], a[208:211], v[104:107]
s_add_u32 s70, s70, 16384
s_cmp_ge_u32 s70, 163840
s_cselect_b32 s70, s80, s70
v_mfma_f32_16x16x32_bf16 v[104:107], v[184:187], a[216:219], v[104:107]
buffer_load_dwordx4 v15, s[24:27], s64 offen offset:0 sc1 lds
v_mfma_f32_16x16x32_bf16 v[108:111], v[184:187], a[220:223], v[108:111]
s_waitcnt vmcnt(6) lgkmcnt(3)
ds_read_b128 v[164:167], v8 offset:13312
v_mfma_f32_16x16x32_bf16 v[108:111], v[180:183], a[212:215], v[108:111]
s_barrier
v_mfma_f32_16x16x32_bf16 v[112:115], v[188:191], a[208:211], v[112:115]
buffer_load_dwordx4 v15, s[24:27], s64 offen offset:1024 sc1 lds
v_mfma_f32_16x16x32_bf16 v[112:115], v[144:147], a[216:219], v[112:115]
ds_read_b128 v[168:171], v8 offset:14336
v_mfma_f32_16x16x32_bf16 v[116:119], v[144:147], a[220:223], v[116:119]
ds_read_b128 v[172:175], v8 offset:15360
v_mfma_f32_16x16x32_bf16 v[116:119], v[188:191], a[212:215], v[116:119]
buffer_load_dwordx4 v15, s[24:27], s64 offen offset:2048 sc1 lds
v_mfma_f32_16x16x32_bf16 v[104:107], v[148:151], a[224:227], v[104:107]
s_waitcnt lgkmcnt(4)
s_add_u32 s91, s91, 16384
ds_read_b128 v[176:179], v7 offset:0
v_mfma_f32_16x16x32_bf16 v[104:107], v[152:155], a[232:235], v[104:107]
s_cmp_ge_u32 s91, 163840
s_cselect_b32 s91, 0, s91
ds_read_b128 v[180:183], v7 offset:1024
v_mfma_f32_16x16x32_bf16 v[108:111], v[152:155], a[236:239], v[108:111]
buffer_load_dwordx4 v15, s[24:27], s64 offen offset:3072 sc1 lds
v_mfma_f32_16x16x32_bf16 v[108:111], v[148:151], a[228:231], v[108:111]
s_mov_b32 m0, s70
s_mov_b32 s64, s68
s_add_u32 s68, s68, 16384
v_mfma_f32_16x16x32_bf16 v[112:115], v[156:159], a[224:227], v[112:115]
s_waitcnt lgkmcnt(4)
ds_read_b128 v[184:187], v7 offset:2048
v_add_u32 v8, s91, v4
v_mfma_f32_16x16x32_bf16 v[112:115], v[160:163], a[232:235], v[112:115]
s_add_u32 s70, s70, 16384
s_cmp_ge_u32 s70, 163840
s_cselect_b32 s70, s80, s70
v_mfma_f32_16x16x32_bf16 v[116:119], v[160:163], a[236:239], v[116:119]
buffer_load_dwordx4 v15, s[24:27], s64 offen offset:0 sc1 lds
v_mfma_f32_16x16x32_bf16 v[116:119], v[156:159], a[228:231], v[116:119]
ds_read_b128 v[188:191], v7 offset:3072
v_mfma_f32_16x16x32_bf16 v[104:107], v[164:167], a[240:243], v[104:107]
s_waitcnt lgkmcnt(4)
ds_read_b128 v[144:147], v7 offset:4096
v_mfma_f32_16x16x32_bf16 v[104:107], v[168:171], a[248:251], v[104:107]
buffer_load_dwordx4 v15, s[24:27], s64 offen offset:1024 sc1 lds
v_mfma_f32_16x16x32_bf16 v[108:111], v[168:171], a[252:255], v[108:111]
ds_read_b128 v[148:151], v7 offset:5120
v_mfma_f32_16x16x32_bf16 v[108:111], v[164:167], a[244:247], v[108:111]
s_waitcnt lgkmcnt(4)
ds_read_b128 v[152:155], v7 offset:6144
v_mfma_f32_16x16x32_bf16 v[112:115], v[172:175], a[240:243], v[112:115]
buffer_load_dwordx4 v15, s[24:27], s64 offen offset:2048 sc1 lds
v_mfma_f32_16x16x32_bf16 v[112:115], v[176:179], a[248:251], v[112:115]
ds_read_b128 v[156:159], v7 offset:7168
v_mfma_f32_16x16x32_bf16 v[116:119], v[176:179], a[252:255], v[116:119]
ds_read_b128 v[160:163], v7 offset:8192
v_mfma_f32_16x16x32_bf16 v[116:119], v[172:175], a[244:247], v[116:119]
buffer_load_dwordx4 v15, s[24:27], s64 offen offset:3072 sc1 lds
v_mfma_f32_16x16x32_bf16 v[104:107], v[180:183], a[96:99], v[104:107]
s_waitcnt lgkmcnt(5)
ds_read_b128 v[164:167], v7 offset:9216
v_mfma_f32_16x16x32_bf16 v[104:107], v[184:187], a[104:107], v[104:107]
ds_read_b128 v[168:171], v7 offset:10240
v_mfma_f32_16x16x32_bf16 v[108:111], v[184:187], a[108:111], v[108:111]
ds_read_b128 v[172:175], v7 offset:11264
v_mfma_f32_16x16x32_bf16 v[108:111], v[180:183], a[100:103], v[108:111]
v_mfma_f32_16x16x32_bf16 v[112:115], v[188:191], a[96:99], v[112:115]
s_waitcnt lgkmcnt(6)
ds_read_b128 v[176:179], v7 offset:12288
v_mfma_f32_16x16x32_bf16 v[112:115], v[144:147], a[104:107], v[112:115]
v_mfma_f32_16x16x32_bf16 v[116:119], v[144:147], a[108:111], v[116:119]
ds_read_b128 v[180:183], v7 offset:13312
v_mfma_f32_16x16x32_bf16 v[116:119], v[188:191], a[100:103], v[116:119]
v_mfma_f32_16x16x32_bf16 v[104:107], v[148:151], a[112:115], v[104:107]
s_waitcnt lgkmcnt(6)
ds_read_b128 v[184:187], v7 offset:14336
v_mfma_f32_16x16x32_bf16 v[104:107], v[152:155], a[120:123], v[104:107]
v_mfma_f32_16x16x32_bf16 v[108:111], v[152:155], a[124:127], v[108:111]
ds_read_b128 v[188:191], v7 offset:15360
v_mfma_f32_16x16x32_bf16 v[108:111], v[148:151], a[116:119], v[108:111]
s_add_u32 s91, s91, 16384
s_cmp_ge_u32 s91, 163840
s_cselect_b32 s91, 0, s91
v_mfma_f32_16x16x32_bf16 v[112:115], v[156:159], a[112:115], v[112:115]
s_waitcnt lgkmcnt(6)
ds_read_b128 v[144:147], v8 offset:0
v_add_u32 v7, s91, v4
v_mfma_f32_16x16x32_bf16 v[112:115], v[160:163], a[120:123], v[112:115]
v_mfma_f32_16x16x32_bf16 v[116:119], v[160:163], a[124:127], v[116:119]
ds_read_b128 v[148:151], v8 offset:1024
v_mfma_f32_16x16x32_bf16 v[116:119], v[156:159], a[116:119], v[116:119]
s_waitcnt lgkmcnt(6)
v_mfma_f32_16x16x32_bf16 v[104:107], v[164:167], a[128:131], v[104:107]
s_mov_b32 m0, s70
s_mov_b32 s64, s68
s_add_u32 s68, s68, 16384
v_mfma_f32_16x16x32_bf16 v[104:107], v[168:171], a[136:139], v[104:107]
ds_read_b128 v[152:155], v8 offset:2048
v_mfma_f32_16x16x32_bf16 v[108:111], v[168:171], a[140:143], v[108:111]
s_add_u32 s70, s70, 16384
s_cmp_ge_u32 s70, 163840
s_cselect_b32 s70, s80, s70
v_mfma_f32_16x16x32_bf16 v[108:111], v[164:167], a[132:135], v[108:111]
buffer_load_dwordx4 v15, s[24:27], s64 offen offset:0 sc1 lds
v_mfma_f32_16x16x32_bf16 v[112:115], v[172:175], a[128:131], v[112:115]
s_waitcnt lgkmcnt(5)
ds_read_b128 v[156:159], v8 offset:3072
v_mfma_f32_16x16x32_bf16 v[112:115], v[176:179], a[136:139], v[112:115]
ds_read_b128 v[160:163], v8 offset:4096
v_mfma_f32_16x16x32_bf16 v[116:119], v[176:179], a[140:143], v[116:119]
buffer_load_dwordx4 v15, s[24:27], s64 offen offset:1024 sc1 lds
v_mfma_f32_16x16x32_bf16 v[116:119], v[172:175], a[132:135], v[116:119]
ds_read_b128 v[164:167], v8 offset:5120
v_mfma_f32_16x16x32_bf16 v[104:107], v[180:183], a[144:147], v[104:107]
s_waitcnt vmcnt(10) lgkmcnt(6)
ds_read_b128 v[168:171], v8 offset:6144
v_mfma_f32_16x16x32_bf16 v[104:107], v[184:187], a[152:155], v[104:107]
buffer_atomic_add v1, v0, s[24:27], s73 offen offset:0 sc1
v_mfma_f32_16x16x32_bf16 v[108:111], v[184:187], a[156:159], v[108:111]
buffer_load_dwordx4 v15, s[24:27], s64 offen offset:2048 sc1 lds
v_mfma_f32_16x16x32_bf16 v[108:111], v[180:183], a[148:151], v[108:111]
ds_read_b128 v[172:175], v8 offset:7168
v_mfma_f32_16x16x32_bf16 v[112:115], v[188:191], a[144:147], v[112:115]
s_waitcnt lgkmcnt(6)
ds_read_b128 v[176:179], v8 offset:8192
v_mfma_f32_16x16x32_bf16 v[112:115], v[144:147], a[152:155], v[112:115]
buffer_load_dwordx4 v15, s[24:27], s64 offen offset:3072 sc1 lds
v_mfma_f32_16x16x32_bf16 v[116:119], v[144:147], a[156:159], v[116:119]
s_mov_b32 m0, s70
s_mov_b32 s64, s68
s_add_u32 s68, s68, 16384
v_mfma_f32_16x16x32_bf16 v[116:119], v[188:191], a[148:151], v[116:119]
s_waitcnt lgkmcnt(5)
ds_read_b128 v[180:183], v8 offset:9216
v_mfma_f32_16x16x32_bf16 v[104:107], v[148:151], a[160:163], v[104:107]
s_add_u32 s70, s70, 16384
s_cmp_ge_u32 s70, 163840
s_cselect_b32 s70, s80, s70
v_mfma_f32_16x16x32_bf16 v[104:107], v[152:155], a[168:171], v[104:107]
buffer_load_dwordx4 v15, s[24:27], s64 offen offset:0 sc1 lds
v_mfma_f32_16x16x32_bf16 v[108:111], v[152:155], a[172:175], v[108:111]
ds_read_b128 v[184:187], v8 offset:10240
v_mfma_f32_16x16x32_bf16 v[108:111], v[148:151], a[164:167], v[108:111]
s_waitcnt lgkmcnt(5)
ds_read_b128 v[188:191], v8 offset:11264
v_mfma_f32_16x16x32_bf16 v[112:115], v[156:159], a[160:163], v[112:115]
buffer_load_dwordx4 v15, s[24:27], s64 offen offset:1024 sc1 lds
v_mfma_f32_16x16x32_bf16 v[112:115], v[160:163], a[168:171], v[112:115]
ds_read_b128 v[144:147], v8 offset:12288
v_mfma_f32_16x16x32_bf16 v[116:119], v[160:163], a[172:175], v[116:119]
s_add_u32 s82, s84, 3
ds_read_b128 v[148:151], v8 offset:13312
v_mfma_f32_16x16x32_bf16 v[116:119], v[156:159], a[164:167], v[116:119]
buffer_load_dwordx4 v15, s[24:27], s64 offen offset:2048 sc1 lds
v_mfma_f32_16x16x32_bf16 v[104:107], v[164:167], a[176:179], v[104:107]
s_and_b32 s82, s82, 3
s_waitcnt lgkmcnt(6)
ds_read_b128 v[152:155], v8 offset:14336
v_mfma_f32_16x16x32_bf16 v[104:107], v[168:171], a[184:187], v[104:107]
v_mfma_f32_16x16x32_bf16 v[108:111], v[168:171], a[188:191], v[108:111]
s_waitcnt vmcnt(8)
s_lshl_b32 s82, s82, 7
ds_read_b128 v[156:159], v8 offset:15360
v_mfma_f32_16x16x32_bf16 v[108:111], v[164:167], a[180:183], v[108:111]
s_barrier
v_mfma_f32_16x16x32_bf16 v[112:115], v[172:175], a[176:179], v[112:115]
s_add_u32 s82, s82, s73
s_waitcnt lgkmcnt(6)
ds_read_b128 v[160:163], v7 offset:0
v_mfma_f32_16x16x32_bf16 v[112:115], v[176:179], a[184:187], v[112:115]
buffer_load_dwordx4 v15, s[24:27], s64 offen offset:3072 sc1 lds
v_mfma_f32_16x16x32_bf16 v[116:119], v[176:179], a[188:191], v[116:119]
s_lshl_b32 s75, s84, 7
s_add_u32 s91, s91, 16384
ds_read_b128 v[164:167], v7 offset:1024
v_mfma_f32_16x16x32_bf16 v[116:119], v[172:175], a[180:183], v[116:119]
s_cmp_ge_u32 s91, 163840
s_cselect_b32 s91, 0, s91
v_add_u32 v8, s91, v4
v_mfma_f32_16x16x32_bf16 v[104:107], v[180:183], v[32:35], v[104:107]
s_add_u32 s75, s75, s73
s_waitcnt lgkmcnt(6)
ds_read_b128 v[168:171], v7 offset:2048
v_mfma_f32_16x16x32_bf16 v[104:107], v[184:187], v[40:43], v[104:107]
v_mfma_f32_16x16x32_bf16 v[108:111], v[184:187], v[44:47], v[108:111]
ds_read_b128 v[172:175], v7 offset:3072
v_mfma_f32_16x16x32_bf16 v[108:111], v[180:183], v[36:39], v[108:111]
v_mfma_f32_16x16x32_bf16 v[112:115], v[188:191], v[32:35], v[112:115]
s_waitcnt lgkmcnt(6)
ds_read_b128 v[176:179], v7 offset:4096
v_mfma_f32_16x16x32_bf16 v[112:115], v[144:147], v[40:43], v[112:115]
v_mfma_f32_16x16x32_bf16 v[116:119], v[144:147], v[44:47], v[116:119]
ds_read_b128 v[180:183], v7 offset:5120
v_mfma_f32_16x16x32_bf16 v[116:119], v[188:191], v[36:39], v[116:119]
v_mfma_f32_16x16x32_bf16 v[104:107], v[148:151], v[48:51], v[104:107]
s_waitcnt lgkmcnt(6)
ds_read_b128 v[184:187], v7 offset:6144
v_mfma_f32_16x16x32_bf16 v[104:107], v[152:155], v[56:59], v[104:107]
v_mfma_f32_16x16x32_bf16 v[108:111], v[152:155], v[60:63], v[108:111]
ds_read_b128 v[188:191], v7 offset:7168
v_mfma_f32_16x16x32_bf16 v[108:111], v[148:151], v[52:55], v[108:111]
v_mfma_f32_16x16x32_bf16 v[112:115], v[156:159], v[48:51], v[112:115]
s_waitcnt lgkmcnt(6)
ds_read_b128 v[144:147], v7 offset:8192
v_mfma_f32_16x16x32_bf16 v[112:115], v[160:163], v[56:59], v[112:115]
v_mfma_f32_16x16x32_bf16 v[116:119], v[160:163], v[60:63], v[116:119]
ds_read_b128 v[148:151], v7 offset:9216
v_mfma_f32_16x16x32_bf16 v[116:119], v[156:159], v[52:55], v[116:119]
v_mfma_f32_16x16x32_bf16 v[104:107], v[164:167], v[64:67], v[104:107]
ds_read_b128 v[152:155], v7 offset:10240
v_mfma_f32_16x16x32_bf16 v[108:111], v[164:167], v[68:71], v[108:111]
s_waitcnt lgkmcnt(7)
v_mfma_f32_16x16x32_bf16 v[112:115], v[168:171], v[64:67], v[112:115]
ds_read_b128 v[156:159], v7 offset:11264
v_mfma_f32_16x16x32_bf16 v[116:119], v[168:171], v[68:71], v[116:119]
v_mfma_f32_16x16x32_bf16 v[128:131], v[172:175], a[0:3], 0
s_waitcnt lgkmcnt(6)
ds_read_b128 v[160:163], v7 offset:12288
v_mfma_f32_16x16x32_bf16 v[128:131], v[176:179], a[8:11], v[128:131]
v_mfma_f32_16x16x32_bf16 v[132:135], v[176:179], a[12:15], 0
ds_read_b128 v[164:167], v7 offset:13312
v_mfma_f32_16x16x32_bf16 v[132:135], v[172:175], a[4:7], v[132:135]
v_mfma_f32_16x16x32_bf16 v[136:139], v[180:183], a[0:3], 0
s_waitcnt lgkmcnt(6)
ds_read_b128 v[168:171], v7 offset:14336
v_mfma_f32_16x16x32_bf16 v[136:139], v[184:187], a[8:11], v[136:139]
v_cvt_pk_bf16_f32 v104, v104, v105
v_mfma_f32_16x16x32_bf16 v[140:143], v[184:187], a[12:15], 0
ds_read_b128 v[172:175], v7 offset:15360
v_cvt_pk_bf16_f32 v105, v106, v107
v_mfma_f32_16x16x32_bf16 v[140:143], v[180:183], a[4:7], v[140:143]
s_add_u32 s91, s91, 16384
v_cvt_pk_bf16_f32 v106, v112, v113
v_mfma_f32_16x16x32_bf16 v[128:131], v[188:191], a[16:19], v[128:131]
s_waitcnt lgkmcnt(6)
ds_read_b128 v[176:179], v8 offset:0
v_cvt_pk_bf16_f32 v107, v114, v115
v_mfma_f32_16x16x32_bf16 v[128:131], v[144:147], a[24:27], v[128:131]
buffer_store_dwordx4 v[104:107], v15, s[24:27], s54 offen offset:0 sc1
v_mfma_f32_16x16x32_bf16 v[132:135], v[144:147], a[28:31], v[132:135]
ds_read_b128 v[180:183], v8 offset:1024
v_cvt_pk_bf16_f32 v108, v108, v109
v_mfma_f32_16x16x32_bf16 v[132:135], v[188:191], a[20:23], v[132:135]
s_cmp_ge_u32 s91, 163840
s_cselect_b32 s91, 0, s91
v_cvt_pk_bf16_f32 v109, v110, v111
v_mfma_f32_16x16x32_bf16 v[136:139], v[148:151], a[16:19], v[136:139]
s_waitcnt lgkmcnt(6)
ds_read_b128 v[184:187], v8 offset:2048
v_cvt_pk_bf16_f32 v110, v116, v117
v_mfma_f32_16x16x32_bf16 v[136:139], v[152:155], a[24:27], v[136:139]
s_waitcnt lgkmcnt(5)
v_cvt_pk_bf16_f32 v111, v118, v119
v_add_u32 v7, s91, v4
v_mfma_f32_16x16x32_bf16 v[140:143], v[152:155], a[28:31], v[140:143]
buffer_store_dwordx4 v[108:111], v15, s[24:27], s54 offen offset:1024 sc1
v_mfma_f32_16x16x32_bf16 v[140:143], v[148:151], a[20:23], v[140:143]
s_mov_b32 m0, s70
s_mov_b32 s64, s68
s_add_u32 s68, s68, 16384
v_mfma_f32_16x16x32_bf16 v[128:131], v[156:159], a[32:35], v[128:131]
s_cmp_lt_u32 s3, 3
s_cselect_b32 s68, s64, 2147418112
ds_read_b128 v[188:191], v8 offset:3072
v_mfma_f32_16x16x32_bf16 v[128:131], v[160:163], a[40:43], v[128:131]
buffer_load_dwordx4 v15, s[24:27], s64 offen offset:0 sc1 lds
v_mfma_f32_16x16x32_bf16 v[132:135], v[160:163], a[44:47], v[132:135]
ds_read_b128 v[144:147], v8 offset:4096
v_mfma_f32_16x16x32_bf16 v[132:135], v[156:159], a[36:39], v[132:135]
s_waitcnt lgkmcnt(5)
ds_read_b128 v[148:151], v8 offset:5120
v_mfma_f32_16x16x32_bf16 v[136:139], v[164:167], a[32:35], v[136:139]
buffer_load_dwordx4 v15, s[24:27], s68 offen offset:1024 sc1 lds
v_mfma_f32_16x16x32_bf16 v[136:139], v[168:171], a[40:43], v[136:139]
ds_read_b128 v[152:155], v8 offset:6144
v_mfma_f32_16x16x32_bf16 v[140:143], v[168:171], a[44:47], v[140:143]
ds_read_b128 v[156:159], v8 offset:7168
v_mfma_f32_16x16x32_bf16 v[140:143], v[164:167], a[36:39], v[140:143]
buffer_load_dwordx4 v15, s[24:27], s68 offen offset:2048 sc1 lds
v_mfma_f32_16x16x32_bf16 v[128:131], v[172:175], a[48:51], v[128:131]
s_waitcnt lgkmcnt(6)
ds_read_b128 v[160:163], v8 offset:8192
v_mfma_f32_16x16x32_bf16 v[128:131], v[176:179], a[56:59], v[128:131]
v_mfma_f32_16x16x32_bf16 v[132:135], v[176:179], a[60:63], v[132:135]
buffer_load_dwordx4 v15, s[24:27], s68 offen offset:3072 sc1 lds
v_mfma_f32_16x16x32_bf16 v[132:135], v[172:175], a[52:55], v[132:135]
buffer_load_dword v12, v10, s[24:27], s73 offen sc1
v_mfma_f32_16x16x32_bf16 v[136:139], v[180:183], a[48:51], v[136:139]
s_waitcnt lgkmcnt(5)
ds_read_b128 v[164:167], v8 offset:9216
v_mfma_f32_16x16x32_bf16 v[136:139], v[184:187], a[56:59], v[136:139]
ds_read_b128 v[168:171], v8 offset:10240
v_mfma_f32_16x16x32_bf16 v[140:143], v[184:187], a[60:63], v[140:143]
ds_read_b128 v[172:175], v8 offset:11264
v_mfma_f32_16x16x32_bf16 v[140:143], v[180:183], a[52:55], v[140:143]
v_mfma_f32_16x16x32_bf16 v[128:131], v[188:191], a[64:67], v[128:131]
s_waitcnt lgkmcnt(6)
ds_read_b128 v[176:179], v8 offset:12288
v_mfma_f32_16x16x32_bf16 v[128:131], v[144:147], a[72:75], v[128:131]
v_mfma_f32_16x16x32_bf16 v[132:135], v[144:147], a[76:79], v[132:135]
ds_read_b128 v[180:183], v8 offset:13312
v_mfma_f32_16x16x32_bf16 v[132:135], v[188:191], a[68:71], v[132:135]
v_mfma_f32_16x16x32_bf16 v[136:139], v[148:151], a[64:67], v[136:139]
s_waitcnt lgkmcnt(6)
ds_read_b128 v[184:187], v8 offset:14336
v_mfma_f32_16x16x32_bf16 v[136:139], v[152:155], a[72:75], v[136:139]
v_mfma_f32_16x16x32_bf16 v[140:143], v[152:155], a[76:79], v[140:143]
s_waitcnt vmcnt(7)
ds_read_b128 v[188:191], v8 offset:15360
v_mfma_f32_16x16x32_bf16 v[140:143], v[148:151], a[68:71], v[140:143]
s_barrier
v_mfma_f32_16x16x32_bf16 v[128:131], v[156:159], a[80:83], v[128:131]
s_waitcnt lgkmcnt(6)
s_add_u32 s91, s91, 16384
ds_read_b128 v[144:147], v7 offset:0
v_mfma_f32_16x16x32_bf16 v[128:131], v[160:163], a[88:91], v[128:131]
s_cmp_ge_u32 s91, 163840
s_cselect_b32 s91, 0, s91
v_add_u32 v8, s91, v4
v_mfma_f32_16x16x32_bf16 v[132:135], v[160:163], a[92:95], v[132:135]
ds_read_b128 v[148:151], v7 offset:1024
v_mfma_f32_16x16x32_bf16 v[132:135], v[156:159], a[84:87], v[132:135]
v_mfma_f32_16x16x32_bf16 v[136:139], v[164:167], a[80:83], v[136:139]
s_waitcnt vmcnt(5) lgkmcnt(6)
ds_read_b128 v[152:155], v7 offset:2048
v_mfma_f32_16x16x32_bf16 v[136:139], v[168:171], a[88:91], v[136:139]
buffer_atomic_add v1, v0, s[24:27], s82 offen offset:128 sc1
v_mfma_f32_16x16x32_bf16 v[140:143], v[168:171], a[92:95], v[140:143]
s_and_b32 s54, s3, 1
ds_read_b128 v[156:159], v7 offset:3072
v_mfma_f32_16x16x32_bf16 v[140:143], v[164:167], a[84:87], v[140:143]
s_mul_i32 s54, s54, 18432
v_mfma_f32_16x16x32_bf16 v[128:131], v[172:175], a[192:195], v[128:131]
s_waitcnt lgkmcnt(6)
s_mul_i32 s55, s86, 288
ds_read_b128 v[160:163], v7 offset:4096
v_mfma_f32_16x16x32_bf16 v[128:131], v[176:179], a[200:203], v[128:131]
s_add_u32 s54, s54, s55
v_mfma_f32_16x16x32_bf16 v[132:135], v[176:179], a[204:207], v[132:135]
s_add_u32 s54, s54, 256
ds_read_b128 v[164:167], v7 offset:5120
v_mfma_f32_16x16x32_bf16 v[132:135], v[172:175], a[196:199], v[132:135]
s_sub_u32 s55, 63, s72
v_mfma_f32_16x16x32_bf16 v[136:139], v[180:183], a[192:195], v[136:139]
s_waitcnt lgkmcnt(6)
s_mul_i32 s55, s55, 36864
ds_read_b128 v[168:171], v7 offset:6144
v_mfma_f32_16x16x32_bf16 v[136:139], v[184:187], a[200:203], v[136:139]
s_waitcnt vmcnt(1)
s_add_u32 s55, s55, s54
v_cmp_gt_u32 vcc, 4, v12
v_mfma_f32_16x16x32_bf16 v[140:143], v[184:187], a[204:207], v[140:143]
s_mul_i32 s52, s72, 36864
ds_read_b128 v[172:175], v7 offset:7168
v_mfma_f32_16x16x32_bf16 v[140:143], v[180:183], a[196:199], v[140:143]
s_waitcnt lgkmcnt(6)
s_add_u32 s54, s54, s52
v_mfma_f32_16x16x32_bf16 v[128:131], v[188:191], a[208:211], v[128:131]
s_cmp_eq_u64 vcc, 0
s_cselect_b32 s81, s69, 2147418112
s_cselect_b32 s93, s71, 2147418112
v_mfma_f32_16x16x32_bf16 v[128:131], v[144:147], a[216:219], v[128:131]
s_lshl_b32 s53, s84, 6
ds_read_b128 v[176:179], v7 offset:8192
v_mfma_f32_16x16x32_bf16 v[132:135], v[144:147], a[220:223], v[132:135]
L_PAD13:
s_cbranch_execz L_MAIN
s_sub_u32 s53, s53, 256
ds_read_b128 v[180:183], v7 offset:9216
v_mfma_f32_16x16x32_bf16 v[132:135], v[188:191], a[212:215], v[132:135]
buffer_load_dwordx4 v[192:195], v15, s[24:27], s81 offen offset:0 sc1
v_mfma_f32_16x16x32_bf16 v[136:139], v[148:151], a[208:211], v[136:139]
s_waitcnt lgkmcnt(6)
s_add_u32 s52, s54, s53
ds_read_b128 v[184:187], v7 offset:10240
v_mfma_f32_16x16x32_bf16 v[136:139], v[152:155], a[216:219], v[136:139]
s_add_u32 s53, s55, s53
v_mfma_f32_16x16x32_bf16 v[140:143], v[152:155], a[220:223], v[140:143]
buffer_load_dwordx4 v[196:199], v15, s[24:27], s81 offen offset:1024 sc1
v_mfma_f32_16x16x32_bf16 v[140:143], v[148:151], a[212:215], v[140:143]
ds_read_b128 v[188:191], v7 offset:11264
v_mfma_f32_16x16x32_bf16 v[128:131], v[156:159], a[224:227], v[128:131]
s_waitcnt lgkmcnt(6)
ds_read_b128 v[144:147], v7 offset:12288
v_mfma_f32_16x16x32_bf16 v[128:131], v[160:163], a[232:235], v[128:131]
buffer_load_dwordx4 v[200:203], v15, s[24:27], s81 offen offset:2048 sc1
v_mfma_f32_16x16x32_bf16 v[132:135], v[160:163], a[236:239], v[132:135]
ds_read_b128 v[148:151], v7 offset:13312
v_mfma_f32_16x16x32_bf16 v[132:135], v[156:159], a[228:231], v[132:135]
s_waitcnt lgkmcnt(6)
v_mfma_f32_16x16x32_bf16 v[136:139], v[164:167], a[224:227], v[136:139]
buffer_load_dwordx4 v[204:207], v15, s[24:27], s81 offen offset:3072 sc1
v_mfma_f32_16x16x32_bf16 v[136:139], v[168:171], a[232:235], v[136:139]
ds_read_b128 v[152:155], v7 offset:14336
v_mfma_f32_16x16x32_bf16 v[140:143], v[168:171], a[236:239], v[140:143]
ds_read_b128 v[156:159], v7 offset:15360
v_mfma_f32_16x16x32_bf16 v[140:143], v[164:167], a[228:231], v[140:143]
buffer_load_dwordx4 v[208:211], v15, s[24:27], s93 offen offset:0 sc1
v_mfma_f32_16x16x32_bf16 v[128:131], v[172:175], a[240:243], v[128:131]
s_waitcnt lgkmcnt(6)
s_add_u32 s91, s91, 16384
ds_read_b128 v[160:163], v8 offset:0
v_mfma_f32_16x16x32_bf16 v[128:131], v[176:179], a[248:251], v[128:131]
s_cmp_ge_u32 s91, 163840
s_cselect_b32 s91, 0, s91
v_add_u32 v7, s91, v4
v_mfma_f32_16x16x32_bf16 v[132:135], v[176:179], a[252:255], v[132:135]
buffer_load_dwordx4 v[212:215], v15, s[24:27], s93 offen offset:1024 sc1
v_mfma_f32_16x16x32_bf16 v[132:135], v[172:175], a[244:247], v[132:135]
ds_read_b128 v[164:167], v8 offset:1024
v_mfma_f32_16x16x32_bf16 v[136:139], v[180:183], a[240:243], v[136:139]
s_waitcnt lgkmcnt(6)
ds_read_b128 v[168:171], v8 offset:2048
v_mfma_f32_16x16x32_bf16 v[136:139], v[184:187], a[248:251], v[136:139]
buffer_load_dwordx4 v[216:219], v15, s[24:27], s93 offen offset:2048 sc1
v_mfma_f32_16x16x32_bf16 v[140:143], v[184:187], a[252:255], v[140:143]
ds_read_b128 v[172:175], v8 offset:3072
v_mfma_f32_16x16x32_bf16 v[140:143], v[180:183], a[244:247], v[140:143]
v_mfma_f32_16x16x32_bf16 v[128:131], v[188:191], a[96:99], v[128:131]
s_waitcnt lgkmcnt(6)
ds_read_b128 v[176:179], v8 offset:4096
v_mfma_f32_16x16x32_bf16 v[128:131], v[144:147], a[104:107], v[128:131]
v_mfma_f32_16x16x32_bf16 v[132:135], v[144:147], a[108:111], v[132:135]
ds_read_b128 v[180:183], v8 offset:5120
v_mfma_f32_16x16x32_bf16 v[132:135], v[188:191], a[100:103], v[132:135]
v_mfma_f32_16x16x32_bf16 v[136:139], v[148:151], a[96:99], v[136:139]
s_waitcnt lgkmcnt(6)
ds_read_b128 v[184:187], v8 offset:6144
v_mfma_f32_16x16x32_bf16 v[136:139], v[152:155], a[104:107], v[136:139]
v_mfma_f32_16x16x32_bf16 v[140:143], v[152:155], a[108:111], v[140:143]
ds_read_b128 v[188:191], v8 offset:7168
v_mfma_f32_16x16x32_bf16 v[140:143], v[148:151], a[100:103], v[140:143]
v_mfma_f32_16x16x32_bf16 v[128:131], v[156:159], a[112:115], v[128:131]
s_waitcnt lgkmcnt(6)
ds_read_b128 v[144:147], v8 offset:8192
v_mfma_f32_16x16x32_bf16 v[128:131], v[160:163], a[120:123], v[128:131]
v_mfma_f32_16x16x32_bf16 v[132:135], v[160:163], a[124:127], v[132:135]
ds_read_b128 v[148:151], v8 offset:9216
v_mfma_f32_16x16x32_bf16 v[132:135], v[156:159], a[116:119], v[132:135]
s_waitcnt lgkmcnt(6)
v_mfma_f32_16x16x32_bf16 v[136:139], v[164:167], a[112:115], v[136:139]
buffer_load_dword v12, v10, s[24:27], s75 offen offset:128 sc1
v_mfma_f32_16x16x32_bf16 v[136:139], v[168:171], a[120:123], v[136:139]
ds_read_b128 v[152:155], v8 offset:10240
v_mfma_f32_16x16x32_bf16 v[140:143], v[168:171], a[124:127], v[140:143]
ds_read_b128 v[156:159], v8 offset:11264
v_mfma_f32_16x16x32_bf16 v[140:143], v[164:167], a[116:119], v[140:143]
v_mfma_f32_16x16x32_bf16 v[128:131], v[172:175], a[128:131], v[128:131]
s_waitcnt lgkmcnt(6)
ds_read_b128 v[160:163], v8 offset:12288
v_mfma_f32_16x16x32_bf16 v[128:131], v[176:179], a[136:139], v[128:131]
v_mfma_f32_16x16x32_bf16 v[132:135], v[176:179], a[140:143], v[132:135]
ds_read_b128 v[164:167], v8 offset:13312
v_mfma_f32_16x16x32_bf16 v[132:135], v[172:175], a[132:135], v[132:135]
v_mfma_f32_16x16x32_bf16 v[136:139], v[180:183], a[128:131], v[136:139]
s_waitcnt lgkmcnt(6)
ds_read_b128 v[168:171], v8 offset:14336
v_mfma_f32_16x16x32_bf16 v[136:139], v[184:187], a[136:139], v[136:139]
v_mfma_f32_16x16x32_bf16 v[140:143], v[184:187], a[140:143], v[140:143]
s_waitcnt vmcnt(10)
ds_read_b128 v[172:175], v8 offset:15360
v_mfma_f32_16x16x32_bf16 v[140:143], v[180:183], a[132:135], v[140:143]
s_barrier
v_mfma_f32_16x16x32_bf16 v[128:131], v[188:191], a[144:147], v[128:131]
s_waitcnt lgkmcnt(6)
ds_read_b128 v[176:179], v7 offset:0
v_mfma_f32_16x16x32_bf16 v[128:131], v[144:147], a[152:155], v[128:131]
v_mfma_f32_16x16x32_bf16 v[132:135], v[144:147], a[156:159], v[132:135]
ds_read_b128 v[180:183], v7 offset:1024
v_mfma_f32_16x16x32_bf16 v[132:135], v[188:191], a[148:151], v[132:135]
v_mfma_f32_16x16x32_bf16 v[136:139], v[148:151], a[144:147], v[136:139]
s_waitcnt lgkmcnt(6)
ds_read_b128 v[184:187], v7 offset:2048
v_mfma_f32_16x16x32_bf16 v[136:139], v[152:155], a[152:155], v[136:139]
v_mfma_f32_16x16x32_bf16 v[140:143], v[152:155], a[156:159], v[140:143]
ds_read_b128 v[188:191], v7 offset:3072
v_mfma_f32_16x16x32_bf16 v[140:143], v[148:151], a[148:151], v[140:143]
v_mfma_f32_16x16x32_bf16 v[128:131], v[156:159], a[160:163], v[128:131]
s_waitcnt lgkmcnt(6)
ds_read_b128 v[144:147], v7 offset:4096
v_mfma_f32_16x16x32_bf16 v[128:131], v[160:163], a[168:171], v[128:131]
v_mfma_f32_16x16x32_bf16 v[132:135], v[160:163], a[172:175], v[132:135]
ds_read_b128 v[148:151], v7 offset:5120
v_mfma_f32_16x16x32_bf16 v[132:135], v[156:159], a[164:167], v[132:135]
v_mfma_f32_16x16x32_bf16 v[136:139], v[164:167], a[160:163], v[136:139]
s_waitcnt lgkmcnt(6)
ds_read_b128 v[152:155], v7 offset:6144
v_mfma_f32_16x16x32_bf16 v[136:139], v[168:171], a[168:171], v[136:139]
v_mfma_f32_16x16x32_bf16 v[140:143], v[168:171], a[172:175], v[140:143]
s_waitcnt vmcnt(0)
ds_read_b128 v[156:159], v7 offset:7168
v_cmp_gt_u32 vcc, 1, v12
v_mfma_f32_16x16x32_bf16 v[140:143], v[164:167], a[164:167], v[140:143]
v_lshlrev_b32 v72, 16, v192
v_and_b32 v73, v13, v192
v_mfma_f32_16x16x32_bf16 v[128:131], v[172:175], a[176:179], v[128:131]
s_waitcnt lgkmcnt(6)
ds_read_b128 v[160:163], v7 offset:8192
v_lshlrev_b32 v74, 16, v193
v_mfma_f32_16x16x32_bf16 v[128:131], v[176:179], a[184:187], v[128:131]
s_cmp_eq_u64 vcc, 0
s_cselect_b32 s77, s83, 2147418112
v_and_b32 v75, v13, v193
v_mfma_f32_16x16x32_bf16 v[132:135], v[176:179], a[188:191], v[132:135]
buffer_load_dwordx4 v[220:223], v15, s[24:27], s77 offen offset:0 sc1
v_mfma_f32_16x16x32_bf16 v[132:135], v[172:175], a[180:183], v[132:135]
s_waitcnt lgkmcnt(5)
ds_read_b128 v[164:167], v7 offset:9216
v_lshlrev_b32 v80, 16, v194
v_mfma_f32_16x16x32_bf16 v[136:139], v[180:183], a[176:179], v[136:139]
buffer_load_dwordx4 v[224:227], v15, s[24:27], s77 offen offset:1024 sc1
v_mfma_f32_16x16x32_bf16 v[136:139], v[184:187], a[184:187], v[136:139]
ds_read_b128 v[168:171], v7 offset:10240
v_and_b32 v81, v13, v194
v_mfma_f32_16x16x32_bf16 v[140:143], v[184:187], a[188:191], v[140:143]
ds_read_b128 v[172:175], v7 offset:11264
v_lshlrev_b32 v82, 16, v195
v_mfma_f32_16x16x32_bf16 v[140:143], v[180:183], a[180:183], v[140:143]
s_waitcnt lgkmcnt(6)
v_and_b32 v83, v13, v195
v_lshlrev_b32 v76, 16, v196
v_mfma_f32_16x16x32_bf16 v[128:131], v[188:191], v[32:35], v[128:131]
buffer_load_dword v11, v10, s[24:27], s73 offen sc1
v_mfma_f32_16x16x32_bf16 v[128:131], v[144:147], v[40:43], v[128:131]
ds_read_b128 v[176:179], v7 offset:12288
v_and_b32 v77, v13, v196
v_mfma_f32_16x16x32_bf16 v[132:135], v[144:147], v[44:47], v[132:135]
buffer_load_dword v12, v10, s[24:27], s75 offen offset:128 sc1
v_mfma_f32_16x16x32_bf16 v[132:135], v[188:191], v[36:39], v[132:135]
v_lshlrev_b32 v78, 16, v197
v_and_b32 v79, v13, v197
v_mfma_f32_16x16x32_bf16 v[136:139], v[148:151], v[32:35], v[136:139]
s_waitcnt lgkmcnt(5)
v_lshlrev_b32 v84, 16, v198
v_and_b32 v85, v13, v198
v_mfma_f32_16x16x32_bf16 v[136:139], v[152:155], v[40:43], v[136:139]
v_lshlrev_b32 v86, 16, v199
v_and_b32 v87, v13, v199
v_mfma_f32_16x16x32_bf16 v[140:143], v[152:155], v[44:47], v[140:143]
v_lshlrev_b32 v88, 16, v200
v_and_b32 v89, v13, v200
v_mfma_f32_16x16x32_bf16 v[140:143], v[148:151], v[36:39], v[140:143]
v_lshlrev_b32 v90, 16, v201
v_and_b32 v91, v13, v201
v_mfma_f32_16x16x32_bf16 v[128:131], v[156:159], v[48:51], v[128:131]
s_waitcnt lgkmcnt(3)
v_lshlrev_b32 v96, 16, v202
v_and_b32 v97, v13, v202
v_mfma_f32_16x16x32_bf16 v[128:131], v[160:163], v[56:59], v[128:131]
v_lshlrev_b32 v98, 16, v203
v_and_b32 v99, v13, v203
v_mfma_f32_16x16x32_bf16 v[132:135], v[160:163], v[60:63], v[132:135]
v_lshlrev_b32 v92, 16, v204
v_and_b32 v93, v13, v204
v_mfma_f32_16x16x32_bf16 v[132:135], v[156:159], v[52:55], v[132:135]
v_lshlrev_b32 v94, 16, v205
v_and_b32 v95, v13, v205
v_mfma_f32_16x16x32_bf16 v[136:139], v[164:167], v[48:51], v[136:139]
s_waitcnt lgkmcnt(1)
v_lshlrev_b32 v100, 16, v206
v_and_b32 v101, v13, v206
v_mfma_f32_16x16x32_bf16 v[136:139], v[168:171], v[56:59], v[136:139]
v_lshlrev_b32 v102, 16, v207
v_and_b32 v103, v13, v207
v_mfma_f32_16x16x32_bf16 v[140:143], v[168:171], v[60:63], v[140:143]
v_mfma_f32_16x16x32_bf16 v[140:143], v[164:167], v[52:55], v[140:143]
v_mfma_f32_16x16x32_bf16 v[128:131], v[172:175], v[64:67], v[128:131]
v_mfma_f32_16x16x32_bf16 v[132:135], v[172:175], v[68:71], v[132:135]
s_waitcnt lgkmcnt(0)
v_mfma_f32_16x16x32_bf16 v[136:139], v[176:179], v[64:67], v[136:139]
v_mfma_f32_16x16x32_bf16 v[140:143], v[176:179], v[68:71], v[140:143]
s_max_u32 s92, s81, s77
s_cmp_lt_u32 s92, 2147418112
s_cbranch_scc1 L_P1
s_mov_b32 s92, 0
s_branch L_S1
L_S0:
s_sleep 8
buffer_load_dword v11, v10, s[24:27], s73 offen sc1
buffer_load_dword v12, v10, s[24:27], s75 offen offset:128 sc1
L_S1:
s_waitcnt vmcnt(0)
v_cmp_gt_u32 vcc, 4, v11
s_add_u32 s92, s92, 1
s_cmp_gt_u32 s92, 1048576
s_cbranch_scc1 L_S2
s_nop 1
s_cbranch_vccnz L_S0
L_S2:
s_cmp_eq_u32 s81, s69
s_cbranch_scc1 L_S4
buffer_load_dwordx4 v[192:195], v15, s[24:27], s69 offen offset:0 sc1
buffer_load_dwordx4 v[196:199], v15, s[24:27], s69 offen offset:1024 sc1
buffer_load_dwordx4 v[200:203], v15, s[24:27], s69 offen offset:2048 sc1
buffer_load_dwordx4 v[204:207], v15, s[24:27], s69 offen offset:3072 sc1
buffer_load_dwordx4 v[208:211], v15, s[24:27], s71 offen offset:0 sc1
buffer_load_dwordx4 v[212:215], v15, s[24:27], s71 offen offset:1024 sc1
buffer_load_dwordx4 v[216:219], v15, s[24:27], s71 offen offset:2048 sc1
s_branch L_S4
L_S3:
s_sleep 2
buffer_load_dword v12, v10, s[24:27], s75 offen offset:128 sc1
s_waitcnt vmcnt(0)
L_S4:
v_cmp_gt_u32 vcc, 1, v12
s_add_u32 s92, s92, 1
s_cmp_gt_u32 s92, 1048576
s_cbranch_scc1 L_S5
s_nop 1
s_cbranch_vccnz L_S3
L_S5:
buffer_load_dwordx4 v[220:223], v15, s[24:27], s83 offen offset:0 sc1
buffer_load_dwordx4 v[224:227], v15, s[24:27], s83 offen offset:1024 sc1
s_cmp_eq_u32 s81, s69
s_cbranch_scc1 L_P1
s_waitcnt vmcnt(2)
v_lshlrev_b32 v72, 16, v192
v_and_b32 v73, v13, v192
v_lshlrev_b32 v74, 16, v193
v_and_b32 v75, v13, v193
v_lshlrev_b32 v80, 16, v194
v_and_b32 v81, v13, v194
v_lshlrev_b32 v82, 16, v195
v_and_b32 v83, v13, v195
v_lshlrev_b32 v76, 16, v196
v_and_b32 v77, v13, v196
v_lshlrev_b32 v78, 16, v197
v_and_b32 v79, v13, v197
v_lshlrev_b32 v84, 16, v198
v_and_b32 v85, v13, v198
v_lshlrev_b32 v86, 16, v199
v_and_b32 v87, v13, v199
v_lshlrev_b32 v88, 16, v200
v_and_b32 v89, v13, v200
v_lshlrev_b32 v90, 16, v201
v_and_b32 v91, v13, v201
v_lshlrev_b32 v96, 16, v202
v_and_b32 v97, v13, v202
v_lshlrev_b32 v98, 16, v203
v_and_b32 v99, v13, v203
v_lshlrev_b32 v92, 16, v204
v_and_b32 v93, v13, v204
v_lshlrev_b32 v94, 16, v205
v_and_b32 v95, v13, v205
v_lshlrev_b32 v100, 16, v206
v_and_b32 v101, v13, v206
v_lshlrev_b32 v102, 16, v207
v_and_b32 v103, v13, v207
L_P1:
s_nop 1
v_pk_add_f32 v[72:73], v[72:73], v[88:89]
v_pk_add_f32 v[74:75], v[74:75], v[90:91]
v_pk_add_f32 v[76:77], v[76:77], v[92:93]
v_pk_add_f32 v[78:79], v[78:79], v[94:95]
v_pk_add_f32 v[80:81], v[80:81], v[96:97]
v_pk_add_f32 v[82:83], v[82:83], v[98:99]
v_pk_add_f32 v[84:85], v[84:85], v[100:101]
v_pk_add_f32 v[86:87], v[86:87], v[102:103]
v_pk_add_f32 v[128:129], v[128:129], v[72:73]
v_pk_add_f32 v[130:131], v[130:131], v[74:75]
v_pk_add_f32 v[132:133], v[132:133], v[76:77]
v_pk_add_f32 v[134:135], v[134:135], v[78:79]
v_pk_add_f32 v[136:137], v[136:137], v[80:81]
v_pk_add_f32 v[138:139], v[138:139], v[82:83]
v_pk_add_f32 v[140:141], v[140:141], v[84:85]
v_pk_add_f32 v[142:143], v[142:143], v[86:87]
s_cmp_lg_u32 s3, s84
s_cbranch_scc1 L_NO9
v_lshlrev_b32 v16, 16, v208
v_and_b32 v17, v13, v208
v_lshlrev_b32 v18, 16, v209
v_and_b32 v19, v13, v209
v_lshlrev_b32 v20, 16, v210
v_and_b32 v21, v13, v210
v_lshlrev_b32 v22, 16, v211
v_and_b32 v23, v13, v211
v_pk_add_f32 v[120:121], v[120:121], v[16:17]
v_pk_add_f32 v[122:123], v[122:123], v[18:19]
v_pk_add_f32 v[124:125], v[124:125], v[20:21]
v_pk_add_f32 v[126:127], v[126:127], v[22:23]
v_lshlrev_b32 v16, 16, v212
v_and_b32 v17, v13, v212
v_lshlrev_b32 v18, 16, v213
v_and_b32 v19, v13, v213
v_lshlrev_b32 v20, 16, v214
v_and_b32 v21, v13, v214
v_lshlrev_b32 v22, 16, v215
v_and_b32 v23, v13, v215
v_pk_add_f32 v[120:121], v[120:121], v[16:17]
v_pk_add_f32 v[122:123], v[122:123], v[18:19]
v_pk_add_f32 v[124:125], v[124:125], v[20:21]
v_pk_add_f32 v[126:127], v[126:127], v[22:23]
v_lshlrev_b32 v16, 16, v216
v_and_b32 v17, v13, v216
v_lshlrev_b32 v18, 16, v217
v_and_b32 v19, v13, v217
v_lshlrev_b32 v20, 16, v218
v_and_b32 v21, v13, v218
v_lshlrev_b32 v22, 16, v219
v_and_b32 v23, v13, v219
v_pk_add_f32 v[120:121], v[120:121], v[16:17]
v_pk_add_f32 v[122:123], v[122:123], v[18:19]
v_pk_add_f32 v[124:125], v[124:125], v[20:21]
v_pk_add_f32 v[126:127], v[126:127], v[22:23]
v_cvt_pk_bf16_f32 v228, v120, v121
v_cvt_pk_bf16_f32 v229, v122, v123
v_cvt_pk_bf16_f32 v230, v124, v125
v_cvt_pk_bf16_f32 v231, v126, v127
s_waitcnt vmcnt(0)
buffer_store_dwordx2 v[228:229], v6, s[44:47], s54 offen sc1
buffer_store_dwordx2 v[230:231], v6, s[44:47], s55 offen sc1
s_branch L_9D
L_NO9:
s_waitcnt vmcnt(0)
L_9D:
v_lshlrev_b32 v16, 16, v220
v_and_b32 v17, v13, v220
v_lshlrev_b32 v18, 16, v221
v_and_b32 v19, v13, v221
v_lshlrev_b32 v20, 16, v222
v_and_b32 v21, v13, v222
v_lshlrev_b32 v22, 16, v223
v_and_b32 v23, v13, v223
v_pk_add_f32 v[128:129], v[128:129], v[16:17]
v_pk_add_f32 v[130:131], v[130:131], v[18:19]
v_pk_add_f32 v[136:137], v[136:137], v[20:21]
v_pk_add_f32 v[138:139], v[138:139], v[22:23]
v_cvt_pk_bf16_f32 v128, v128, v129
v_cvt_pk_bf16_f32 v129, v130, v131
v_cvt_pk_bf16_f32 v130, v136, v137
v_cvt_pk_bf16_f32 v131, v138, v139
s_nop 1
v_permlane16_swap_b32 v128, v130
v_permlane16_swap_b32 v129, v131
buffer_store_dwordx4 v[128:131], v5, s[44:47], s52 offen sc1
v_lshlrev_b32 v16, 16, v224
v_and_b32 v17, v13, v224
v_lshlrev_b32 v18, 16, v225
v_and_b32 v19, v13, v225
v_lshlrev_b32 v20, 16, v226
v_and_b32 v21, v13, v226
v_lshlrev_b32 v22, 16, v227
v_and_b32 v23, v13, v227
v_pk_add_f32 v[132:133], v[132:133], v[16:17]
v_pk_add_f32 v[134:135], v[134:135], v[18:19]
v_pk_add_f32 v[140:141], v[140:141], v[20:21]
v_pk_add_f32 v[142:143], v[142:143], v[22:23]
v_cvt_pk_bf16_f32 v132, v132, v133
v_cvt_pk_bf16_f32 v133, v134, v135
v_cvt_pk_bf16_f32 v134, v140, v141
v_cvt_pk_bf16_f32 v135, v142, v143
s_nop 1
v_permlane16_swap_b32 v132, v134
v_permlane16_swap_b32 v133, v135
buffer_store_dwordx4 v[132:135], v5, s[44:47], s53 offen sc1
L_END:
s_endpgm
L_SE2:
v_accvgpr_read_b32 v180, a224
v_accvgpr_read_b32 v182, a228
v_cmp_nle_f32 vcc, v180, v7
v_cmp_nle_f32 s[96:97], v182, v7
s_nop 3
s_or_b64 vcc, vcc, s[96:97]
s_cbranch_vccnz SLOW0
SLOW0_R:
s_add_u32 s53, s77, 163840
buffer_load_dwordx4 a[96:99], v15, s[24:27], s53 offen offset:0 sc1
v_mul_f32 v8, 0x3fb8aa3b, v8
v_mul_f32 v9, 0x3fb8aa3b, v9
v_exp_f32 v8, v8
v_exp_f32 v9, v9
s_nop 0
v_fma_f32 v180, v180, v8, v180
v_fma_f32 v182, v182, v9, v182
v_rcp_f32 v180, v180
v_rcp_f32 v182, v182
s_add_u32 s52, s78, 4096
v_mov_b32 v181, v180
v_mov_b32 v183, v182
v_accvgpr_read_b32 v16, a0
v_accvgpr_read_b32 v17, a1
v_accvgpr_read_b32 v18, a2
v_accvgpr_read_b32 v19, a3
v_accvgpr_read_b32 v20, a4
v_accvgpr_read_b32 v21, a5
buffer_load_dwordx4 a[100:103], v15, s[24:27], s53 offen offset:1024 sc1
v_accvgpr_read_b32 v22, a6
v_accvgpr_read_b32 v23, a7
v_pk_mul_f32 v[16:17], v[16:17], v[180:181]
v_pk_mul_f32 v[18:19], v[18:19], v[180:181]
v_pk_mul_f32 v[20:21], v[20:21], v[180:181]
v_pk_mul_f32 v[22:23], v[22:23], v[180:181]
v_cvt_pk_bf16_f32 v16, v16, v17
v_cvt_pk_bf16_f32 v17, v18, v19
v_cvt_pk_bf16_f32 v18, v20, v21
v_cvt_pk_bf16_f32 v19, v22, v23
buffer_store_dwordx4 v[16:19], v15, s[24:27], s78 offen offset:0 sc1
v_accvgpr_read_b32 v24, a32
v_accvgpr_read_b32 v25, a33
v_accvgpr_read_b32 v26, a34
v_accvgpr_read_b32 v27, a35
v_accvgpr_read_b32 v28, a36
v_accvgpr_read_b32 v29, a37
v_accvgpr_read_b32 v30, a38
buffer_load_dwordx4 a[104:107], v15, s[24:27], s53 offen offset:2048 sc1
v_accvgpr_read_b32 v31, a39
v_pk_mul_f32 v[24:25], v[24:25], v[182:183]
v_pk_mul_f32 v[26:27], v[26:27], v[182:183]
v_pk_mul_f32 v[28:29], v[28:29], v[182:183]
v_pk_mul_f32 v[30:31], v[30:31], v[182:183]
v_cvt_pk_bf16_f32 v24, v24, v25
v_cvt_pk_bf16_f32 v25, v26, v27
v_cvt_pk_bf16_f32 v26, v28, v29
v_cvt_pk_bf16_f32 v27, v30, v31
buffer_store_dwordx4 v[24:27], v15, s[24:27], s78 offen offset:1024 sc1
v_accvgpr_read_b32 v16, a8
v_accvgpr_read_b32 v17, a9
v_accvgpr_read_b32 v18, a10
v_accvgpr_read_b32 v19, a11
v_accvgpr_read_b32 v20, a12
v_accvgpr_read_b32 v21, a13
v_accvgpr_read_b32 v22, a14
v_accvgpr_read_b32 v23, a15
buffer_load_dwordx4 a[108:111], v15, s[24:27], s53 offen offset:3072 sc1
v_pk_mul_f32 v[16:17], v[16:17], v[180:181]
v_pk_mul_f32 v[18:19], v[18:19], v[180:181]
v_pk_mul_f32 v[20:21], v[20:21], v[180:181]
v_pk_mul_f32 v[22:23], v[22:23], v[180:181]
v_cvt_pk_bf16_f32 v16, v16, v17
v_cvt_pk_bf16_f32 v17, v18, v19
v_cvt_pk_bf16_f32 v18, v20, v21
v_cvt_pk_bf16_f32 v19, v22, v23
buffer_store_dwordx4 v[16:19], v15, s[24:27], s78 offen offset:2048 sc1
v_accvgpr_read_b32 v24, a40
v_accvgpr_read_b32 v25, a41
v_accvgpr_read_b32 v26, a42
v_accvgpr_read_b32 v27, a43
v_accvgpr_read_b32 v28, a44
v_accvgpr_read_b32 v29, a45
v_accvgpr_read_b32 v30, a46
v_accvgpr_read_b32 v31, a47
v_pk_mul_f32 v[24:25], v[24:25], v[182:183]
s_add_u32 s53, s77, 180224
buffer_load_dwordx4 a[112:115], v15, s[24:27], s53 offen offset:0 sc1
v_pk_mul_f32 v[26:27], v[26:27], v[182:183]
v_pk_mul_f32 v[28:29], v[28:29], v[182:183]
v_pk_mul_f32 v[30:31], v[30:31], v[182:183]
v_cvt_pk_bf16_f32 v24, v24, v25
v_cvt_pk_bf16_f32 v25, v26, v27
v_cvt_pk_bf16_f32 v26, v28, v29
v_cvt_pk_bf16_f32 v27, v30, v31
buffer_store_dwordx4 v[24:27], v15, s[24:27], s78 offen offset:3072 sc1
v_accvgpr_read_b32 v16, a16
v_accvgpr_read_b32 v17, a17
v_accvgpr_read_b32 v18, a18
v_accvgpr_read_b32 v19, a19
v_accvgpr_read_b32 v20, a20
v_accvgpr_read_b32 v21, a21
v_accvgpr_read_b32 v22, a22
v_accvgpr_read_b32 v23, a23
v_pk_mul_f32 v[16:17], v[16:17], v[180:181]
v_pk_mul_f32 v[18:19], v[18:19], v[180:181]
buffer_load_dwordx4 a[116:119], v15, s[24:27], s53 offen offset:1024 sc1
v_pk_mul_f32 v[20:21], v[20:21], v[180:181]
v_pk_mul_f32 v[22:23], v[22:23], v[180:181]
v_cvt_pk_bf16_f32 v16, v16, v17
v_cvt_pk_bf16_f32 v17, v18, v19
v_cvt_pk_bf16_f32 v18, v20, v21
v_cvt_pk_bf16_f32 v19, v22, v23
buffer_store_dwordx4 v[16:19], v15, s[24:27], s52 offen offset:0 sc1
v_accvgpr_read_b32 v24, a48
v_accvgpr_read_b32 v25, a49
v_accvgpr_read_b32 v26, a50
v_accvgpr_read_b32 v27, a51
v_accvgpr_read_b32 v28, a52
v_accvgpr_read_b32 v29, a53
v_accvgpr_read_b32 v30, a54
v_accvgpr_read_b32 v31, a55
v_pk_mul_f32 v[24:25], v[24:25], v[182:183]
v_pk_mul_f32 v[26:27], v[26:27], v[182:183]
v_pk_mul_f32 v[28:29], v[28:29], v[182:183]
buffer_load_dwordx4 a[120:123], v15, s[24:27], s53 offen offset:2048 sc1
v_pk_mul_f32 v[30:31], v[30:31], v[182:183]
v_cvt_pk_bf16_f32 v24, v24, v25
v_cvt_pk_bf16_f32 v25, v26, v27
v_cvt_pk_bf16_f32 v26, v28, v29
v_cvt_pk_bf16_f32 v27, v30, v31
buffer_store_dwordx4 v[24:27], v15, s[24:27], s52 offen offset:1024 sc1
v_accvgpr_read_b32 v16, a24
v_accvgpr_read_b32 v17, a25
v_accvgpr_read_b32 v18, a26
v_accvgpr_read_b32 v19, a27
v_accvgpr_read_b32 v20, a28
v_accvgpr_read_b32 v21, a29
v_accvgpr_read_b32 v22, a30
v_accvgpr_read_b32 v23, a31
v_pk_mul_f32 v[16:17], v[16:17], v[180:181]
v_pk_mul_f32 v[18:19], v[18:19], v[180:181]
v_pk_mul_f32 v[20:21], v[20:21], v[180:181]
v_pk_mul_f32 v[22:23], v[22:23], v[180:181]
buffer_load_dwordx4 a[124:127], v15, s[24:27], s53 offen offset:3072 sc1
v_cvt_pk_bf16_f32 v16, v16, v17
v_cvt_pk_bf16_f32 v17, v18, v19
v_cvt_pk_bf16_f32 v18, v20, v21
v_cvt_pk_bf16_f32 v19, v22, v23
buffer_store_dwordx4 v[16:19], v15, s[24:27], s52 offen offset:2048 sc1
v_accvgpr_read_b32 v24, a56
v_accvgpr_read_b32 v25, a57
v_accvgpr_read_b32 v26, a58
v_accvgpr_read_b32 v27, a59
v_accvgpr_read_b32 v28, a60
v_accvgpr_read_b32 v29, a61
v_accvgpr_read_b32 v30, a62
v_accvgpr_read_b32 v31, a63
v_pk_mul_f32 v[24:25], v[24:25], v[182:183]
v_pk_mul_f32 v[26:27], v[26:27], v[182:183]
v_pk_mul_f32 v[28:29], v[28:29], v[182:183]
v_pk_mul_f32 v[30:31], v[30:31], v[182:183]
v_cvt_pk_bf16_f32 v24, v24, v25
v_cvt_pk_bf16_f32 v25, v26, v27
v_cvt_pk_bf16_f32 v26, v28, v29
v_cvt_pk_bf16_f32 v27, v30, v31
buffer_store_dwordx4 v[24:27], v15, s[24:27], s52 offen offset:3072 sc1
s_branch L_LA
CK_Z:
s_mov_b32 s92, 0
CK_Z_L:
s_sleep 1
buffer_load_dword v23, v22, s[40:43], 0 offen sc1
s_add_u32 s92, s92, 1
s_waitcnt vmcnt(0)
v_cmp_gt_u32 vcc, 1, v23
s_cmp_gt_u32 s92, 1048576
s_cbranch_scc1 CK_Z_R
s_nop 3
s_cbranch_vccnz CK_Z_L
s_branch CK_Z_R
CK_WA:
s_mov_b32 s92, 0
CK_WA_L:
s_sleep 1
buffer_load_dword v30, v29, s[24:27], s89 offen sc1
s_add_u32 s92, s92, 1
s_waitcnt vmcnt(0)
v_cmp_gt_u32 vcc, 18, v30
s_cmp_gt_u32 s92, 1048576
s_cbranch_scc1 CK_WA_R
s_nop 3
s_cbranch_vccnz CK_WA_L
s_branch CK_WA_R
CK_ZA:
s_mov_b32 s92, 0
CK_ZA_L:
s_sleep 1
buffer_load_dword v30, v28, s[40:43], 0 offen sc1
s_add_u32 s92, s92, 1
s_waitcnt vmcnt(0)
v_cmp_gt_u32 vcc, 1, v30
s_cmp_gt_u32 s92, 1048576
s_cbranch_scc1 CK_ZA_R
s_nop 3
s_cbranch_vccnz CK_ZA_L
s_branch CK_ZA_R
CK_KV:
s_mov_b32 s92, 0
CK_KV_L:
s_sleep 1
buffer_load_dword v30, v29, s[24:27], s89 offen offset:4 sc1
s_add_u32 s92, s92, 1
s_waitcnt vmcnt(0)
v_cmp_gt_u32 vcc, 8, v30
s_cmp_gt_u32 s92, 1048576
s_cbranch_scc1 CK_KV_R
s_nop 3
s_cbranch_vccnz CK_KV_L
s_branch CK_KV_R
D0:
v_cndmask_b32 v96, v96, v6, s[56:57]
v_cndmask_b32 v120, v120, v6, s[56:57]
v_mov_b32 v112, v6
v_cndmask_b32 v97, v97, v6, s[58:59]
v_cndmask_b32 v121, v121, v6, s[58:59]
v_mov_b32 v113, v6
v_cndmask_b32 v98, v98, v6, s[60:61]
v_cndmask_b32 v122, v122, v6, s[60:61]
v_mov_b32 v114, v6
v_cndmask_b32 v99, v99, v6, s[62:63]
v_cndmask_b32 v123, v123, v6, s[62:63]
v_mov_b32 v115, v6
s_branch D0_R
CK_Q:
s_mov_b32 s92, 0
CK_Q_L:
s_sleep 1
buffer_load_dword v172, v28, s[24:27], 0 offen sc1
s_add_u32 s92, s92, 1
s_waitcnt vmcnt(0)
v_cmp_gt_u32 vcc, 32, v172
s_cmp_gt_u32 s92, 1048576
s_cbranch_scc1 CK_Q_R
s_nop 3
s_cbranch_vccnz CK_Q_L
s_branch CK_Q_R
CK_ZAA:
s_mov_b32 s92, 0
CK_ZAA_L:
s_sleep 1
buffer_load_dword v12, v10, s[24:27], s75 offen offset:128 sc1
s_add_u32 s92, s92, 1
s_waitcnt vmcnt(0)
v_cmp_gt_u32 vcc, 8, v12
s_cmp_gt_u32 s92, 1048576
s_cbranch_scc1 CK_ZAA_R
s_nop 3
s_cbranch_vccnz CK_ZAA_L
s_branch CK_ZAA_R
SLOW0:
v_add_u32 v20, 4096, v15
s_mov_b32 s54, 0
v_mov_b32 v16, v6
v_mov_b32 v18, v6
SLOW0_P:
s_mov_b32 s53, 0
s_mov_b32 s52, s94
SLOW0_T:
s_add_u32 s55, s52, 24576
buffer_load_dwordx4 a[192:195], v15, s[24:27], s52 offen offset:0 sc1
buffer_load_dwordx4 a[196:199], v15, s[24:27], s52 offen offset:1024 sc1
buffer_load_dwordx4 a[200:203], v15, s[24:27], s52 offen offset:2048 sc1
buffer_load_dwordx4 a[204:207], v15, s[24:27], s52 offen offset:3072 sc1
buffer_load_dwordx4 a[208:211], v20, s[24:27], s52 offen offset:0 sc1
buffer_load_dwordx4 a[212:215], v20, s[24:27], s52 offen offset:1024 sc1
buffer_load_dwordx4 a[216:219], v20, s[24:27], s52 offen offset:2048 sc1
buffer_load_dwordx4 a[220:223], v20, s[24:27], s52 offen offset:3072 sc1
buffer_load_dwordx4 a[64:67], v15, s[24:27], s55 offen offset:0 sc1
buffer_load_dwordx4 a[68:71], v15, s[24:27], s55 offen offset:1024 sc1
buffer_load_dwordx4 a[72:75], v15, s[24:27], s55 offen offset:2048 sc1
buffer_load_dwordx4 a[76:79], v15, s[24:27], s55 offen offset:3072 sc1
buffer_load_dwordx4 a[80:83], v20, s[24:27], s55 offen offset:0 sc1
buffer_load_dwordx4 a[84:87], v20, s[24:27], s55 offen offset:1024 sc1
buffer_load_dwordx4 a[88:91], v20, s[24:27], s55 offen offset:2048 sc1
buffer_load_dwordx4 a[92:95], v20, s[24:27], s55 offen offset:3072 sc1
s_waitcnt vmcnt(0)
v_mfma_f32_16x16x32_bf16 v[44:47], a[192:195], v[36:39], 0
v_mfma_f32_16x16x32_bf16 v[44:47], a[196:199], v[32:35], v[44:47]
v_mfma_f32_16x16x32_bf16 v[44:47], a[200:203], v[196:199], v[44:47]
v_mfma_f32_16x16x32_bf16 v[44:47], a[204:207], v[204:207], v[44:47]
v_mfma_f32_16x16x32_bf16 v[52:55], a[192:195], v[108:111], 0
v_mfma_f32_16x16x32_bf16 v[52:55], a[196:199], v[40:43], v[52:55]
v_mfma_f32_16x16x32_bf16 v[52:55], a[200:203], v[80:83], v[52:55]
v_mfma_f32_16x16x32_bf16 v[52:55], a[204:207], v[168:171], v[52:55]
v_mfma_f32_16x16x32_bf16 v[64:67], a[208:211], v[36:39], 0
v_mfma_f32_16x16x32_bf16 v[64:67], a[212:215], v[32:35], v[64:67]
v_mfma_f32_16x16x32_bf16 v[64:67], a[216:219], v[196:199], v[64:67]
v_mfma_f32_16x16x32_bf16 v[64:67], a[220:223], v[204:207], v[64:67]
v_mfma_f32_16x16x32_bf16 v[212:215], a[208:211], v[108:111], 0
v_mfma_f32_16x16x32_bf16 v[212:215], a[212:215], v[40:43], v[212:215]
v_mfma_f32_16x16x32_bf16 v[212:215], a[216:219], v[80:83], v[212:215]
v_mfma_f32_16x16x32_bf16 v[212:215], a[220:223], v[168:171], v[212:215]
s_nop 7
s_cmp_lg_u32 s53, s66
s_cbranch_scc1 SLOW0_U
v_cndmask_b32 v44, v44, v6, s[56:57]
v_cndmask_b32 v212, v212, v6, s[56:57]
v_mov_b32 v64, v6
v_cndmask_b32 v45, v45, v6, s[58:59]
v_cndmask_b32 v213, v213, v6, s[58:59]
v_mov_b32 v65, v6
v_cndmask_b32 v46, v46, v6, s[60:61]
v_cndmask_b32 v214, v214, v6, s[60:61]
v_mov_b32 v66, v6
v_cndmask_b32 v47, v47, v6, s[62:63]
v_cndmask_b32 v215, v215, v6, s[62:63]
v_mov_b32 v67, v6
SLOW0_U:
s_cmp_lg_u32 s54, 0
s_cbranch_scc1 SLOW0_A
v_max3_f32 v16, v16, v44, v45
v_max3_f32 v16, v16, v46, v47
v_max3_f32 v18, v18, v52, v53
v_max3_f32 v18, v18, v54, v55
v_max3_f32 v16, v16, v64, v65
v_max3_f32 v16, v16, v66, v67
v_max3_f32 v18, v18, v212, v213
v_max3_f32 v18, v18, v214, v215
s_branch SLOW0_N
SLOW0_A:
v_sub_f32 v44, v44, v16
v_sub_f32 v45, v45, v16
v_sub_f32 v46, v46, v16
v_sub_f32 v47, v47, v16
v_sub_f32 v52, v52, v18
v_sub_f32 v53, v53, v18
v_sub_f32 v54, v54, v18
v_sub_f32 v55, v55, v18
v_sub_f32 v64, v64, v16
v_sub_f32 v65, v65, v16
v_sub_f32 v66, v66, v16
v_sub_f32 v67, v67, v16
v_sub_f32 v212, v212, v18
v_sub_f32 v213, v213, v18
v_sub_f32 v214, v214, v18
v_sub_f32 v215, v215, v18
v_exp_f32 v44, v44
v_exp_f32 v45, v45
v_exp_f32 v46, v46
v_exp_f32 v47, v47
v_exp_f32 v52, v52
v_exp_f32 v53, v53
v_exp_f32 v54, v54
v_exp_f32 v55, v55
v_exp_f32 v64, v64
v_exp_f32 v65, v65
v_exp_f32 v66, v66
v_exp_f32 v67, v67
v_exp_f32 v212, v212
v_exp_f32 v213, v213
v_exp_f32 v214, v214
v_exp_f32 v215, v215
s_nop 0
v_cvt_pk_bf16_f32 v124, v44, v45
v_cvt_pk_bf16_f32 v125, v46, v47
v_cvt_pk_bf16_f32 v140, v52, v53
v_cvt_pk_bf16_f32 v141, v54, v55
v_cvt_pk_bf16_f32 v126, v64, v65
v_cvt_pk_bf16_f32 v127, v66, v67
v_cvt_pk_bf16_f32 v142, v212, v213
v_cvt_pk_bf16_f32 v143, v214, v215
s_nop 1
v_mfma_f32_16x16x32_bf16 a[0:3], a[64:67], v[124:127], a[0:3]
v_mfma_f32_16x16x32_bf16 a[32:35], a[64:67], v[140:143], a[32:35]
v_mfma_f32_16x16x32_bf16 a[36:39], a[68:71], v[140:143], a[36:39]
v_mfma_f32_16x16x32_bf16 a[4:7], a[68:71], v[124:127], a[4:7]
v_mfma_f32_16x16x32_bf16 a[8:11], a[72:75], v[124:127], a[8:11]
v_mfma_f32_16x16x32_bf16 a[40:43], a[72:75], v[140:143], a[40:43]
v_mfma_f32_16x16x32_bf16 a[44:47], a[76:79], v[140:143], a[44:47]
v_mfma_f32_16x16x32_bf16 a[12:15], a[76:79], v[124:127], a[12:15]
v_mfma_f32_16x16x32_bf16 a[16:19], a[80:83], v[124:127], a[16:19]
v_mfma_f32_16x16x32_bf16 a[48:51], a[80:83], v[140:143], a[48:51]
v_mfma_f32_16x16x32_bf16 a[52:55], a[84:87], v[140:143], a[52:55]
v_mfma_f32_16x16x32_bf16 a[20:23], a[84:87], v[124:127], a[20:23]
v_mfma_f32_16x16x32_bf16 a[24:27], a[88:91], v[124:127], a[24:27]
v_mfma_f32_16x16x32_bf16 a[56:59], a[88:91], v[140:143], a[56:59]
v_mfma_f32_16x16x32_bf16 a[60:63], a[92:95], v[140:143], a[60:63]
v_mfma_f32_16x16x32_bf16 a[28:31], a[92:95], v[124:127], a[28:31]
v_mfma_f32_16x16x32_bf16 a[224:227], a[240:243], v[124:127], a[224:227]
v_mfma_f32_16x16x32_bf16 a[228:231], a[240:243], v[140:143], a[228:231]
SLOW0_N:
s_add_u32 s52, s52, 16384
s_add_u32 s53, s53, 1
s_cmp_le_u32 s53, s66
s_cbranch_scc1 SLOW0_T
s_cmp_lg_u32 s54, 0
s_cbranch_scc1 SLOW0_E
v_mov_b32 v17, v16
v_mov_b32 v19, v18
s_nop 1
v_permlane32_swap_b32 v17, v16
v_permlane32_swap_b32 v19, v18
s_nop 1
v_max_f32 v16, v16, v17
v_max_f32 v18, v18, v19
v_mov_b32 v17, v16
v_mov_b32 v19, v18
s_nop 1
v_permlane16_swap_b32 v17, v16
v_permlane16_swap_b32 v19, v18
s_nop 1
v_max_f32 v16, v16, v17
v_max_f32 v18, v18, v19
v_accvgpr_write_b32 a0, 0
v_accvgpr_write_b32 a1, 0
v_accvgpr_write_b32 a2, 0
v_accvgpr_write_b32 a3, 0
v_accvgpr_write_b32 a4, 0
v_accvgpr_write_b32 a5, 0
v_accvgpr_write_b32 a6, 0
v_accvgpr_write_b32 a7, 0
v_accvgpr_write_b32 a8, 0
v_accvgpr_write_b32 a9, 0
v_accvgpr_write_b32 a10, 0
v_accvgpr_write_b32 a11, 0
v_accvgpr_write_b32 a12, 0
v_accvgpr_write_b32 a13, 0
v_accvgpr_write_b32 a14, 0
v_accvgpr_write_b32 a15, 0
v_accvgpr_write_b32 a16, 0
v_accvgpr_write_b32 a17, 0
v_accvgpr_write_b32 a18, 0
v_accvgpr_write_b32 a19, 0
v_accvgpr_write_b32 a20, 0
v_accvgpr_write_b32 a21, 0
v_accvgpr_write_b32 a22, 0
v_accvgpr_write_b32 a23, 0
v_accvgpr_write_b32 a24, 0
v_accvgpr_write_b32 a25, 0
v_accvgpr_write_b32 a26, 0
v_accvgpr_write_b32 a27, 0
v_accvgpr_write_b32 a28, 0
v_accvgpr_write_b32 a29, 0
v_accvgpr_write_b32 a30, 0
v_accvgpr_write_b32 a31, 0
v_accvgpr_write_b32 a32, 0
v_accvgpr_write_b32 a33, 0
v_accvgpr_write_b32 a34, 0
v_accvgpr_write_b32 a35, 0
v_accvgpr_write_b32 a36, 0
v_accvgpr_write_b32 a37, 0
v_accvgpr_write_b32 a38, 0
v_accvgpr_write_b32 a39, 0
v_accvgpr_write_b32 a40, 0
v_accvgpr_write_b32 a41, 0
v_accvgpr_write_b32 a42, 0
v_accvgpr_write_b32 a43, 0
v_accvgpr_write_b32 a44, 0
v_accvgpr_write_b32 a45, 0
v_accvgpr_write_b32 a46, 0
v_accvgpr_write_b32 a47, 0
v_accvgpr_write_b32 a48, 0
v_accvgpr_write_b32 a49, 0
v_accvgpr_write_b32 a50, 0
v_accvgpr_write_b32 a51, 0
v_accvgpr_write_b32 a52, 0
v_accvgpr_write_b32 a53, 0
v_accvgpr_write_b32 a54, 0
v_accvgpr_write_b32 a55, 0
v_accvgpr_write_b32 a56, 0
v_accvgpr_write_b32 a57, 0
v_accvgpr_write_b32 a58, 0
v_accvgpr_write_b32 a59, 0
v_accvgpr_write_b32 a60, 0
v_accvgpr_write_b32 a61, 0
v_accvgpr_write_b32 a62, 0
v_accvgpr_write_b32 a63, 0
v_accvgpr_write_b32 a224, 0
v_accvgpr_write_b32 a225, 0
v_accvgpr_write_b32 a226, 0
v_accvgpr_write_b32 a227, 0
v_accvgpr_write_b32 a228, 0
v_accvgpr_write_b32 a229, 0
v_accvgpr_write_b32 a230, 0
v_accvgpr_write_b32 a231, 0
s_mov_b32 s54, 1
s_branch SLOW0_P
SLOW0_E:
s_nop 7
v_accvgpr_read_b32 v180, a224
v_accvgpr_read_b32 v182, a228
s_branch SLOW0_R
SLOW1:
v_add_u32 v20, 4096, v15
s_mov_b32 s54, 0
v_mov_b32 v16, v6
v_mov_b32 v18, v6
SLOW1_P:
s_mov_b32 s53, 0
s_mov_b32 s52, s94
SLOW1_T:
s_add_u32 s55, s52, 24576
buffer_load_dwordx4 a[192:195], v15, s[24:27], s52 offen offset:0 sc1
buffer_load_dwordx4 a[196:199], v15, s[24:27], s52 offen offset:1024 sc1
buffer_load_dwordx4 a[200:203], v15, s[24:27], s52 offen offset:2048 sc1
buffer_load_dwordx4 a[204:207], v15, s[24:27], s52 offen offset:3072 sc1
buffer_load_dwordx4 a[208:211], v20, s[24:27], s52 offen offset:0 sc1
buffer_load_dwordx4 a[212:215], v20, s[24:27], s52 offen offset:1024 sc1
buffer_load_dwordx4 a[216:219], v20, s[24:27], s52 offen offset:2048 sc1
buffer_load_dwordx4 a[220:223], v20, s[24:27], s52 offen offset:3072 sc1
buffer_load_dwordx4 a[64:67], v15, s[24:27], s55 offen offset:0 sc1
buffer_load_dwordx4 a[68:71], v15, s[24:27], s55 offen offset:1024 sc1
buffer_load_dwordx4 a[72:75], v15, s[24:27], s55 offen offset:2048 sc1
buffer_load_dwordx4 a[76:79], v15, s[24:27], s55 offen offset:3072 sc1
buffer_load_dwordx4 a[80:83], v20, s[24:27], s55 offen offset:0 sc1
buffer_load_dwordx4 a[84:87], v20, s[24:27], s55 offen offset:1024 sc1
buffer_load_dwordx4 a[88:91], v20, s[24:27], s55 offen offset:2048 sc1
buffer_load_dwordx4 a[92:95], v20, s[24:27], s55 offen offset:3072 sc1
s_waitcnt vmcnt(0)
v_mfma_f32_16x16x32_bf16 v[44:47], a[192:195], v[116:119], 0
v_mfma_f32_16x16x32_bf16 v[44:47], a[196:199], v[132:135], v[44:47]
v_mfma_f32_16x16x32_bf16 v[44:47], a[200:203], v[184:187], v[44:47]
v_mfma_f32_16x16x32_bf16 v[44:47], a[204:207], v[240:243], v[44:47]
v_mfma_f32_16x16x32_bf16 v[52:55], a[192:195], v[188:191], 0
v_mfma_f32_16x16x32_bf16 v[52:55], a[196:199], v[56:59], v[52:55]
v_mfma_f32_16x16x32_bf16 v[52:55], a[200:203], v[88:91], v[52:55]
v_mfma_f32_16x16x32_bf16 v[52:55], a[204:207], v[192:195], v[52:55]
v_mfma_f32_16x16x32_bf16 v[64:67], a[208:211], v[116:119], 0
v_mfma_f32_16x16x32_bf16 v[64:67], a[212:215], v[132:135], v[64:67]
v_mfma_f32_16x16x32_bf16 v[64:67], a[216:219], v[184:187], v[64:67]
v_mfma_f32_16x16x32_bf16 v[64:67], a[220:223], v[240:243], v[64:67]
v_mfma_f32_16x16x32_bf16 v[212:215], a[208:211], v[188:191], 0
v_mfma_f32_16x16x32_bf16 v[212:215], a[212:215], v[56:59], v[212:215]
v_mfma_f32_16x16x32_bf16 v[212:215], a[216:219], v[88:91], v[212:215]
v_mfma_f32_16x16x32_bf16 v[212:215], a[220:223], v[192:195], v[212:215]
s_nop 7
s_cmp_lg_u32 s53, s67
s_cbranch_scc1 SLOW1_U
v_cndmask_b32 v44, v44, v6, s[56:57]
v_cndmask_b32 v212, v212, v6, s[56:57]
v_mov_b32 v64, v6
v_cndmask_b32 v45, v45, v6, s[58:59]
v_cndmask_b32 v213, v213, v6, s[58:59]
v_mov_b32 v65, v6
v_cndmask_b32 v46, v46, v6, s[60:61]
v_cndmask_b32 v214, v214, v6, s[60:61]
v_mov_b32 v66, v6
v_cndmask_b32 v47, v47, v6, s[62:63]
v_cndmask_b32 v215, v215, v6, s[62:63]
v_mov_b32 v67, v6
SLOW1_U:
s_cmp_lg_u32 s54, 0
s_cbranch_scc1 SLOW1_A
v_max3_f32 v16, v16, v44, v45
v_max3_f32 v16, v16, v46, v47
v_max3_f32 v18, v18, v52, v53
v_max3_f32 v18, v18, v54, v55
v_max3_f32 v16, v16, v64, v65
v_max3_f32 v16, v16, v66, v67
v_max3_f32 v18, v18, v212, v213
v_max3_f32 v18, v18, v214, v215
s_branch SLOW1_N
SLOW1_A:
v_sub_f32 v44, v44, v16
v_sub_f32 v45, v45, v16
v_sub_f32 v46, v46, v16
v_sub_f32 v47, v47, v16
v_sub_f32 v52, v52, v18
v_sub_f32 v53, v53, v18
v_sub_f32 v54, v54, v18
v_sub_f32 v55, v55, v18
v_sub_f32 v64, v64, v16
v_sub_f32 v65, v65, v16
v_sub_f32 v66, v66, v16
v_sub_f32 v67, v67, v16
v_sub_f32 v212, v212, v18
v_sub_f32 v213, v213, v18
v_sub_f32 v214, v214, v18
v_sub_f32 v215, v215, v18
v_exp_f32 v44, v44
v_exp_f32 v45, v45
v_exp_f32 v46, v46
v_exp_f32 v47, v47
v_exp_f32 v52, v52
v_exp_f32 v53, v53
v_exp_f32 v54, v54
v_exp_f32 v55, v55
v_exp_f32 v64, v64
v_exp_f32 v65, v65
v_exp_f32 v66, v66
v_exp_f32 v67, v67
v_exp_f32 v212, v212
v_exp_f32 v213, v213
v_exp_f32 v214, v214
v_exp_f32 v215, v215
s_nop 0
v_cvt_pk_bf16_f32 v124, v44, v45
v_cvt_pk_bf16_f32 v125, v46, v47
v_cvt_pk_bf16_f32 v140, v52, v53
v_cvt_pk_bf16_f32 v141, v54, v55
v_cvt_pk_bf16_f32 v126, v64, v65
v_cvt_pk_bf16_f32 v127, v66, v67
v_cvt_pk_bf16_f32 v142, v212, v213
v_cvt_pk_bf16_f32 v143, v214, v215
s_nop 1
v_mfma_f32_16x16x32_bf16 v[60:63], a[64:67], v[124:127], v[60:63]
v_mfma_f32_16x16x32_bf16 v[148:151], a[64:67], v[140:143], v[148:151]
v_mfma_f32_16x16x32_bf16 v[48:51], a[68:71], v[140:143], v[48:51]
v_mfma_f32_16x16x32_bf16 v[68:71], a[68:71], v[124:127], v[68:71]
v_mfma_f32_16x16x32_bf16 v[72:75], a[72:75], v[124:127], v[72:75]
v_mfma_f32_16x16x32_bf16 v[236:239], a[72:75], v[140:143], v[236:239]
v_mfma_f32_16x16x32_bf16 v[224:227], a[76:79], v[140:143], v[224:227]
v_mfma_f32_16x16x32_bf16 v[220:223], a[76:79], v[124:127], v[220:223]
v_mfma_f32_16x16x32_bf16 v[84:87], a[80:83], v[124:127], v[84:87]
v_mfma_f32_16x16x32_bf16 v[164:167], a[80:83], v[140:143], v[164:167]
v_mfma_f32_16x16x32_bf16 v[156:159], a[84:87], v[140:143], v[156:159]
v_mfma_f32_16x16x32_bf16 v[76:79], a[84:87], v[124:127], v[76:79]
v_mfma_f32_16x16x32_bf16 v[160:163], a[88:91], v[124:127], v[160:163]
v_mfma_f32_16x16x32_bf16 v[216:219], a[88:91], v[140:143], v[216:219]
v_mfma_f32_16x16x32_bf16 v[208:211], a[92:95], v[140:143], v[208:211]
v_mfma_f32_16x16x32_bf16 v[252:255], a[92:95], v[124:127], v[252:255]
v_mfma_f32_16x16x32_bf16 a[232:235], a[240:243], v[124:127], a[232:235]
v_mfma_f32_16x16x32_bf16 a[236:239], a[240:243], v[140:143], a[236:239]
SLOW1_N:
s_add_u32 s52, s52, 16384
s_add_u32 s53, s53, 1
s_cmp_le_u32 s53, s67
s_cbranch_scc1 SLOW1_T
s_cmp_lg_u32 s54, 0
s_cbranch_scc1 SLOW1_E
v_mov_b32 v17, v16
v_mov_b32 v19, v18
s_nop 1
v_permlane32_swap_b32 v17, v16
v_permlane32_swap_b32 v19, v18
s_nop 1
v_max_f32 v16, v16, v17
v_max_f32 v18, v18, v19
v_mov_b32 v17, v16
v_mov_b32 v19, v18
s_nop 1
v_permlane16_swap_b32 v17, v16
v_permlane16_swap_b32 v19, v18
s_nop 1
v_max_f32 v16, v16, v17
v_max_f32 v18, v18, v19
v_mov_b32 v60, 0
v_mov_b32 v61, 0
v_mov_b32 v62, 0
v_mov_b32 v63, 0
v_mov_b32 v68, 0
v_mov_b32 v69, 0
v_mov_b32 v70, 0
v_mov_b32 v71, 0
v_mov_b32 v72, 0
v_mov_b32 v73, 0
v_mov_b32 v74, 0
v_mov_b32 v75, 0
v_mov_b32 v220, 0
v_mov_b32 v221, 0
v_mov_b32 v222, 0
v_mov_b32 v223, 0
v_mov_b32 v84, 0
v_mov_b32 v85, 0
v_mov_b32 v86, 0
v_mov_b32 v87, 0
v_mov_b32 v76, 0
v_mov_b32 v77, 0
v_mov_b32 v78, 0
v_mov_b32 v79, 0
v_mov_b32 v160, 0
v_mov_b32 v161, 0
v_mov_b32 v162, 0
v_mov_b32 v163, 0
v_mov_b32 v252, 0
v_mov_b32 v253, 0
v_mov_b32 v254, 0
v_mov_b32 v255, 0
v_mov_b32 v148, 0
v_mov_b32 v149, 0
v_mov_b32 v150, 0
v_mov_b32 v151, 0
v_mov_b32 v48, 0
v_mov_b32 v49, 0
v_mov_b32 v50, 0
v_mov_b32 v51, 0
v_mov_b32 v236, 0
v_mov_b32 v237, 0
v_mov_b32 v238, 0
v_mov_b32 v239, 0
v_mov_b32 v224, 0
v_mov_b32 v225, 0
v_mov_b32 v226, 0
v_mov_b32 v227, 0
v_mov_b32 v164, 0
v_mov_b32 v165, 0
v_mov_b32 v166, 0
v_mov_b32 v167, 0
v_mov_b32 v156, 0
v_mov_b32 v157, 0
v_mov_b32 v158, 0
v_mov_b32 v159, 0
v_mov_b32 v216, 0
v_mov_b32 v217, 0
v_mov_b32 v218, 0
v_mov_b32 v219, 0
v_mov_b32 v208, 0
v_mov_b32 v209, 0
v_mov_b32 v210, 0
v_mov_b32 v211, 0
v_accvgpr_write_b32 a232, 0
v_accvgpr_write_b32 a233, 0
v_accvgpr_write_b32 a234, 0
v_accvgpr_write_b32 a235, 0
v_accvgpr_write_b32 a236, 0
v_accvgpr_write_b32 a237, 0
v_accvgpr_write_b32 a238, 0
v_accvgpr_write_b32 a239, 0
s_mov_b32 s54, 1
s_branch SLOW1_P
SLOW1_E:
s_nop 7
v_accvgpr_read_b32 v180, a232
v_accvgpr_read_b32 v182, a236
s_add_u32 s52, s79, 4096
v_fma_f32 v180, v180, v10, v180
v_fma_f32 v182, v182, v11, v182
v_rcp_f32 v180, v180
v_rcp_f32 v182, v182
s_nop 0
v_pk_mul_f32 v[60:61], v[60:61], v[180:181] op_sel_hi:[1,0]
v_pk_mul_f32 v[62:63], v[62:63], v[180:181] op_sel_hi:[1,0]
v_pk_mul_f32 v[68:69], v[68:69], v[180:181] op_sel_hi:[1,0]
v_pk_mul_f32 v[70:71], v[70:71], v[180:181] op_sel_hi:[1,0]
v_cvt_pk_bf16_f32 v60, v60, v61
v_cvt_pk_bf16_f32 v61, v62, v63
v_cvt_pk_bf16_f32 v62, v68, v69
v_cvt_pk_bf16_f32 v63, v70, v71
s_branch L_EP
.section .rodata,"a"
.p2align 6
.amdhsa_kernel gated_mix__sliding_local_dilated__compressed_kv_cla__prompt_kernel
  .amdhsa_next_free_vgpr 512
  .amdhsa_next_free_sgpr 102
  .amdhsa_accum_offset 256
  .amdhsa_group_segment_fixed_size 0
  .amdhsa_kernarg_size 104
  .amdhsa_user_sgpr_count 2
  .amdhsa_user_sgpr_kernarg_segment_ptr 1
  .amdhsa_system_sgpr_workgroup_id_x 1
.end_amdhsa_kernel
```

```asm
; @launch grid=(256,1,1) block=(256,1,1) lds=163840
.amdgcn_target "amdgcn-amd-amdhsa--gfx950"
.text

.globl gated_mix__sliding_local_dilated__compressed_kv_cla__prompt_kernel
.p2align 8
.type gated_mix__sliding_local_dilated__compressed_kv_cla__prompt_kernel,@function
gated_mix__sliding_local_dilated__compressed_kv_cla__prompt_kernel:
s_cmp_ge_u32 s2, 256
s_cbranch_scc1 L_END
s_load_dwordx2 s[8:9], s[0:1], 32
s_load_dwordx2 s[56:57], s[0:1], 56
s_load_dwordx2 s[16:17], s[0:1], 48
s_load_dwordx2 s[24:25], s[0:1], 96
s_load_dwordx2 s[12:13], s[0:1], 0
s_load_dwordx2 s[20:21], s[0:1], 40
s_load_dwordx2 s[28:29], s[0:1], 8
s_load_dwordx2 s[48:49], s[0:1], 16
s_load_dwordx2 s[32:33], s[0:1], 64
s_load_dwordx2 s[36:37], s[0:1], 72
s_load_dwordx2 s[40:41], s[0:1], 88
s_load_dwordx2 s[44:45], s[0:1], 80
s_getpc_b64 s[96:97]
L_PC:
s_lshr_b32 s6, s2, 3
s_lshl_b32 s98, s6, 11
s_add_u32 s98, s98, L_MAIN-L_PC
s_add_u32 s96, s96, s98
s_addc_u32 s97, s97, 0
v_lshlrev_b32 v16, 3, v0
v_mov_b32 v17, s97
v_add_co_u32 v16, vcc, s96, v16
v_lshrrev_b32 v5, 6, v0
v_and_b32 v1, 63, v0
v_addc_co_u32 v17, vcc, 0, v17, vcc
v_readfirstlane_b32 s3, v5
global_load_dwordx2 a[252:253], v[16:17], off
v_and_b32 v2, 15, v0
v_lshrrev_b32 v3, 4, v1
v_lshlrev_b32 v4, 4, v1
s_and_b32 s7, s2, 7
s_and_b32 s65, s6, 3
s_lshl2_add_u32 s4, s7, s65
s_lshr_b32 s5, s6, 2
s_lshl2_add_u32 s66, s5, s3
s_sub_u32 s67, 63, s66
v_lshrrev_b32 v16, 3, v1
v_and_b32 v17, 7, v1
v_xor_b32 v18, v17, v3
v_lshlrev_b32 v19, 10, v16
v_lshl_add_u32 v5, v18, 4, v19
v_xor_b32 v18, 4, v18
v_lshl_add_u32 v6, v18, 4, v19
v_add_u32 v6, 7168, v6
v_and_b32 v18, 1, v3
v_lshlrev_b32 v18, 1, v18
v_xor_b32 v18, v17, v18
v_lshlrev_b32 v19, 13, v16
v_lshl_add_u32 v7, v18, 4, v19
v_xor_b32 v18, 4, v18
v_lshl_add_u32 v8, v18, 4, v19
v_add_u32 v8, 64512, v8
s_add_u32 s69, s65, s5
s_and_b32 s69, s69, 1
s_mul_i32 s64, s7, 2
s_and_b32 s64, s64, 7
s_or_b32 s69, s69, s64
s_add_u32 s93, s65, s5
s_and_b32 s93, s93, 0
s_mul_i32 s64, s7, 1
s_and_b32 s64, s64, 7
s_or_b32 s93, s93, s64
s_lshl_b32 s70, s69, 7
s_lshl_b32 s75, s69, 19
s_lshr_b32 s54, s3, 1
s_and_b32 s55, s3, 1
s_lshl3_add_u32 s87, s54, s5
s_lshl_b32 s64, s55, 5
s_add_u32 s68, s87, s64
s_lshl_b32 s68, s68, 15
s_lshl_b32 s73, s3, 13
s_add_u32 s73, s73, 65536
s_lshl1_add_u32 s74, s4, s55
s_lshl_b32 s74, s74, 7
s_lshl_b32 s64, s54, 18
s_add_u32 s74, s74, s64
s_lshl_b32 s77, s3, 12
s_add_u32 s71, s68, s70
s_add_u32 s76, s74, s75
s_mov_b32 s10, 2097152
s_mov_b32 s11, 0x20000
s_mov_b32 s58, 4194304
s_mov_b32 s59, 0x20000
s_waitcnt lgkmcnt(0)
s_add_u32 m0, s73, 0
s_add_u32 s64, s71, 0
buffer_load_dwordx4 v5, s[8:11], s64 offen lds
buffer_load_dwordx4 v6, s[8:11], s64 offen offset:1024 lds
s_add_u32 m0, s73, 2048
s_add_u32 s64, s71, 16384
buffer_load_dwordx4 v5, s[8:11], s64 offen lds
buffer_load_dwordx4 v6, s[8:11], s64 offen offset:1024 lds
s_add_u32 m0, s77, 0
s_add_u32 s64, s76, 0
buffer_load_dwordx4 v7, s[56:59], s64 offen lds
buffer_load_dwordx4 v8, s[56:59], s64 offen offset:1024 lds
s_add_u32 m0, s77, 2048
s_add_u32 s64, s76, 131072
buffer_load_dwordx4 v7, s[56:59], s64 offen lds
buffer_load_dwordx4 v8, s[56:59], s64 offen offset:1024 lds
s_add_u32 m0, s73, 4096
s_add_u32 s64, s71, 524288
buffer_load_dwordx4 v5, s[8:11], s64 offen lds
buffer_load_dwordx4 v6, s[8:11], s64 offen offset:1024 lds
s_add_u32 m0, s73, 6144
s_add_u32 s64, s71, 540672
buffer_load_dwordx4 v5, s[8:11], s64 offen lds
buffer_load_dwordx4 v6, s[8:11], s64 offen offset:1024 lds
s_mov_b32 s18, 4194304
s_mov_b32 s19, 0x20000
s_lshl_b32 s65, s54, 7
s_lshl_b32 s53, s55, 12
v_lshrrev_b32 v16, 1, v2
v_xor_b32 v16, v16, v3
v_add_u32 v17, s65, v2
v_lshlrev_b32 v17, 7, v17
v_add_u32 v17, 65536, v17
v_lshl_add_u32 v9, v16, 4, v17
v_xor_b32 v10, 64, v9
v_bfe_u32 v16, v1, 2, 2
v_lshl_add_u32 v17, v3, 3, v16
v_lshlrev_b32 v17, 7, v17
v_and_b32 v18, 3, v1
v_lshl_add_u32 v17, v18, 3, v17
v_add_u32 v17, s53, v17
v_lshrrev_b32 v16, 1, v16
v_and_b32 v18, 1, v3
v_lshl_add_u32 v16, v18, 1, v16
v_xor_b32 v18, 0, v16
v_lshl_add_u32 v11, v18, 5, v17
v_xor_b32 v18, 1, v16
v_lshl_add_u32 v12, v18, 5, v17
v_xor_b32 v18, 2, v16
v_lshl_add_u32 v13, v18, 5, v17
v_xor_b32 v18, 3, v16
v_lshl_add_u32 v14, v18, 5, v17
s_add_u32 m0, s77, 16384
s_add_u32 s64, s76, 0
buffer_load_dwordx4 v7, s[16:19], s64 offen lds
buffer_load_dwordx4 v8, s[16:19], s64 offen offset:1024 lds
s_add_u32 m0, s77, 18432
s_add_u32 s64, s76, 131072
buffer_load_dwordx4 v7, s[16:19], s64 offen lds
buffer_load_dwordx4 v8, s[16:19], s64 offen offset:1024 lds
s_mov_b64 exec, 0
s_cmp_eq_u32 s3, 0
s_cbranch_scc1 L_PAD0
s_cmp_eq_u32 s3, 1
s_cbranch_scc1 L_PAD1
s_cmp_eq_u32 s3, 2
s_cbranch_scc1 L_PAD2
s_branch L_PAD3
.p2align 12
.fill 587, 4, 0xbf800000
L_MAIN:
s_mov_b64 exec, -1
s_xor_b32 s71, s70, 128
s_add_u32 s71, s68, s71
s_add_u32 m0, s73, 32768
s_add_u32 s64, s71, 0
buffer_load_dwordx4 v5, s[8:11], s64 offen lds
buffer_load_dwordx4 v6, s[8:11], s64 offen offset:1024 lds
s_add_u32 m0, s73, 34816
s_add_u32 s64, s71, 16384
buffer_load_dwordx4 v5, s[8:11], s64 offen lds
buffer_load_dwordx4 v6, s[8:11], s64 offen offset:1024 lds
s_add_u32 m0, s73, 36864
s_add_u32 s64, s71, 524288
buffer_load_dwordx4 v5, s[8:11], s64 offen lds
buffer_load_dwordx4 v6, s[8:11], s64 offen offset:1024 lds
s_add_u32 m0, s73, 38912
s_add_u32 s64, s71, 540672
buffer_load_dwordx4 v5, s[8:11], s64 offen lds
buffer_load_dwordx4 v6, s[8:11], s64 offen offset:1024 lds
s_waitcnt vmcnt(12)
s_barrier
ds_read_b128 a[64:67], v9 offset:0
ds_read_b128 a[68:71], v10 offset:0
ds_read_b64_tr_b16 a[128:129], v11 offset:0
ds_read_b64_tr_b16 a[130:131], v11 offset:512
ds_read_b64_tr_b16 a[132:133], v11 offset:8192
ds_read_b64_tr_b16 a[134:135], v11 offset:8704
ds_read_b64_tr_b16 a[136:137], v12 offset:0
ds_read_b64_tr_b16 a[138:139], v12 offset:512
ds_read_b64_tr_b16 a[140:141], v12 offset:8192
ds_read_b64_tr_b16 a[142:143], v12 offset:8704
ds_read_b64_tr_b16 a[144:145], v13 offset:0
ds_read_b64_tr_b16 a[146:147], v13 offset:512
ds_read_b64_tr_b16 a[148:149], v13 offset:8192
ds_read_b64_tr_b16 a[150:151], v13 offset:8704
ds_read_b64_tr_b16 a[152:153], v14 offset:0
ds_read_b64_tr_b16 a[154:155], v14 offset:512
ds_read_b64_tr_b16 a[156:157], v14 offset:8192
ds_read_b64_tr_b16 a[158:159], v14 offset:8704
ds_read_b128 a[72:75], v9 offset:2048
ds_read_b128 a[76:79], v10 offset:2048
ds_read_b128 a[80:83], v9 offset:4096
ds_read_b128 a[84:87], v10 offset:4096
ds_read_b128 a[88:91], v9 offset:6144
ds_read_b128 a[92:95], v10 offset:6144
s_waitcnt lgkmcnt(0)
v_mfma_f32_16x16x32_bf16 v[32:35], a[64:67], a[128:131], 0
s_waitcnt vmcnt(8)
v_mfma_f32_16x16x32_bf16 v[32:35], a[68:71], a[132:135], v[32:35]
s_barrier
v_mfma_f32_16x16x32_bf16 v[40:43], a[68:71], a[140:143], 0
s_mov_b32 s26, 268435456
s_mov_b32 s27, 0x20000
ds_read_b128 a[96:99], v9 offset:8192
v_mfma_f32_16x16x32_bf16 v[40:43], a[64:67], a[136:139], v[40:43]
s_xor_b32 s76, s75, 524288
s_add_u32 s76, s74, s76
s_mov_b32 s14, 2359296
v_mfma_f32_16x16x32_bf16 v[48:51], a[64:67], a[144:147], 0
s_add_u32 m0, s77, 32768
s_add_u32 s64, s76, 0
s_mov_b32 s15, 0x20000
v_mfma_f32_16x16x32_bf16 v[48:51], a[68:71], a[148:151], v[48:51]
buffer_load_dwordx4 v7, s[56:59], s64 offen lds
v_mfma_f32_16x16x32_bf16 v[56:59], a[68:71], a[156:159], 0
s_mov_b32 s22, 4718592
s_mov_b32 s23, 0x20000
ds_read_b128 a[100:103], v10 offset:8192
v_mfma_f32_16x16x32_bf16 v[56:59], a[64:67], a[152:155], v[56:59]
buffer_load_dwordx4 v8, s[56:59], s64 offen offset:1024 lds
v_mfma_f32_16x16x32_bf16 v[60:63], a[72:75], a[152:155], 0
s_add_u32 m0, s77, 34816
s_add_u32 s64, s76, 131072
ds_read_b128 a[104:107], v9 offset:10240
v_mfma_f32_16x16x32_bf16 v[60:63], a[76:79], a[156:159], v[60:63]
s_mov_b32 s30, 1990656
s_mov_b32 s31, 0x20000
s_mov_b32 s34, 4718592
v_mfma_f32_16x16x32_bf16 v[52:55], a[76:79], a[148:151], 0
buffer_load_dwordx4 v7, s[56:59], s64 offen lds
v_mfma_f32_16x16x32_bf16 v[52:55], a[72:75], a[144:147], v[52:55]
s_mov_b32 s35, 0x20000
ds_read_b64_tr_b16 a[160:161], v11 offset:16384
ds_read_b64_tr_b16 a[162:163], v11 offset:16896
v_mfma_f32_16x16x32_bf16 v[44:47], a[72:75], a[136:139], 0
s_mov_b32 s38, 1152
s_mov_b32 s39, 0x20000
s_mov_b32 s42, 256
v_mfma_f32_16x16x32_bf16 v[44:47], a[76:79], a[140:143], v[44:47]
buffer_load_dwordx4 v8, s[56:59], s64 offen offset:1024 lds
v_mfma_f32_16x16x32_bf16 v[36:39], a[76:79], a[132:135], 0
s_mov_b32 s43, 0x20000
s_mov_b32 s46, 2359296
s_mov_b32 s47, 0x20000
v_mfma_f32_16x16x32_bf16 v[36:39], a[72:75], a[128:131], v[36:39]
s_add_u32 m0, s77, 49152
s_add_u32 s64, s76, 0
ds_read_b128 a[108:111], v10 offset:10240
v_mfma_f32_16x16x32_bf16 v[64:67], a[80:83], a[128:131], 0
s_mov_b32 s50, 663552
s_mov_b32 s51, 0x20000
s_lshl_b32 s89, s4, 10
v_mfma_f32_16x16x32_bf16 v[64:67], a[84:87], a[132:135], v[64:67]
buffer_load_dwordx4 v7, s[16:19], s64 offen lds
v_mfma_f32_16x16x32_bf16 v[72:75], a[84:87], a[140:143], 0
s_add_u32 s89, s89, 75497472
ds_read_b64_tr_b16 a[164:165], v11 offset:24576
ds_read_b64_tr_b16 a[166:167], v11 offset:25088
v_mfma_f32_16x16x32_bf16 v[72:75], a[80:83], a[136:139], v[72:75]
s_mul_i32 s94, s4, 1064960
s_lshl_b32 s52, s5, 15
s_add_u32 s52, s52, s89
v_mfma_f32_16x16x32_bf16 v[80:83], a[80:83], a[144:147], 0
buffer_load_dwordx4 v8, s[16:19], s64 offen offset:1024 lds
v_mfma_f32_16x16x32_bf16 v[80:83], a[84:87], a[148:151], v[80:83]
s_add_u32 m0, s77, 51200
s_add_u32 s64, s76, 131072
ds_read_b128 a[112:115], v9 offset:12288
v_mfma_f32_16x16x32_bf16 v[88:91], a[84:87], a[156:159], 0
s_lshl_b32 s53, s5, 10
s_add_u32 s53, s53, s94
s_add_u32 s53, s53, 1048576
v_mfma_f32_16x16x32_bf16 v[88:91], a[80:83], a[152:155], v[88:91]
buffer_load_dwordx4 v7, s[16:19], s64 offen lds
v_mfma_f32_16x16x32_bf16 v[92:95], a[88:91], a[152:155], 0
ds_read_b64_tr_b16 a[168:169], v12 offset:16384
ds_read_b64_tr_b16 a[170:171], v12 offset:16896
v_mfma_f32_16x16x32_bf16 v[92:95], a[92:95], a[156:159], v[92:95]
s_cmp_eq_u32 s3, 1
s_cselect_b32 s52, s53, s52
s_mul_i32 s53, s2, 74
v_mfma_f32_16x16x32_bf16 v[84:87], a[92:95], a[148:151], 0
buffer_load_dwordx4 v8, s[16:19], s64 offen offset:1024 lds
v_mfma_f32_16x16x32_bf16 v[84:87], a[88:91], a[144:147], v[84:87]
s_add_u32 s53, s53, s55
s_lshl_b32 s53, s53, 10
s_add_u32 s53, s53, 54599680
v_mfma_f32_16x16x32_bf16 v[76:79], a[88:91], a[136:139], 0
s_cmp_ge_u32 s3, 2
s_cselect_b32 s52, s53, s52
ds_read_b128 a[116:119], v10 offset:12288
v_mfma_f32_16x16x32_bf16 v[76:79], a[92:95], a[140:143], v[76:79]
v_mov_b32 v16, 0
v_mov_b32 v17, 0
v_mfma_f32_16x16x32_bf16 v[68:71], a[92:95], a[132:135], 0
v_mov_b32 v18, 0
v_mov_b32 v19, 0
v_mfma_f32_16x16x32_bf16 v[68:71], a[88:91], a[128:131], v[68:71]
s_waitcnt lgkmcnt(6)
ds_read_b64_tr_b16 a[172:173], v12 offset:24576
ds_read_b64_tr_b16 a[174:175], v12 offset:25088
v_mfma_f32_16x16x32_bf16 v[96:99], a[96:99], a[128:131], 0
v_lshrrev_b32 v20, 3, v1
v_cmp_eq_u32 vcc, 3, v20
v_mfma_f32_16x16x32_bf16 v[96:99], a[100:103], a[132:135], v[96:99]
v_add_u32 v20, 100663168, v4
v_mov_b32 v21, s3
v_mfma_f32_16x16x32_bf16 v[104:107], a[100:103], a[140:143], 0
ds_read_b128 a[120:123], v9 offset:14336
v_cndmask_b32 v15, v4, v20, vcc
v_mfma_f32_16x16x32_bf16 v[104:107], a[96:99], a[136:139], v[104:107]
v_cmp_eq_u32 vcc, 0, v21
v_mov_b32 v21, 0
v_mfma_f32_16x16x32_bf16 v[112:115], a[96:99], a[144:147], 0
v_mov_b32 v21, 0
v_cndmask_b32 v20, v15, v4, vcc
v_mfma_f32_16x16x32_bf16 v[112:115], a[100:103], a[148:151], v[112:115]
ds_read_b64_tr_b16 a[176:177], v13 offset:16384
ds_read_b64_tr_b16 a[178:179], v13 offset:16896
v_mfma_f32_16x16x32_bf16 v[120:123], a[100:103], a[156:159], 0
v_mfma_f32_16x16x32_bf16 v[120:123], a[96:99], a[152:155], v[120:123]
v_mfma_f32_16x16x32_bf16 v[124:127], a[104:107], a[152:155], 0
v_mfma_f32_16x16x32_bf16 v[124:127], a[108:111], a[156:159], v[124:127]
ds_read_b128 a[124:127], v10 offset:14336
v_mfma_f32_16x16x32_bf16 v[116:119], a[108:111], a[148:151], 0
v_add_u32 v9, 32768, v9
v_add_u32 v10, 32768, v10
v_mfma_f32_16x16x32_bf16 v[116:119], a[104:107], a[144:147], v[116:119]
v_mfma_f32_16x16x32_bf16 v[108:111], a[104:107], a[136:139], 0
ds_read_b64_tr_b16 a[180:181], v13 offset:24576
ds_read_b64_tr_b16 a[182:183], v13 offset:25088
v_mfma_f32_16x16x32_bf16 v[108:111], a[108:111], a[140:143], v[108:111]
v_mfma_f32_16x16x32_bf16 v[100:103], a[108:111], a[132:135], 0
v_mfma_f32_16x16x32_bf16 v[100:103], a[104:107], a[128:131], v[100:103]
s_waitcnt lgkmcnt(2)
ds_read_b64_tr_b16 a[184:185], v14 offset:16384
ds_read_b64_tr_b16 a[186:187], v14 offset:16896
v_mfma_f32_16x16x32_bf16 v[128:131], a[112:115], a[128:131], 0
v_mfma_f32_16x16x32_bf16 v[128:131], a[116:119], a[132:135], v[128:131]
v_mfma_f32_16x16x32_bf16 v[136:139], a[116:119], a[140:143], 0
ds_read_b64_tr_b16 a[188:189], v14 offset:24576
ds_read_b64_tr_b16 a[190:191], v14 offset:25088
v_mfma_f32_16x16x32_bf16 v[136:139], a[112:115], a[136:139], v[136:139]
v_mfma_f32_16x16x32_bf16 v[144:147], a[112:115], a[144:147], 0
v_mfma_f32_16x16x32_bf16 v[144:147], a[116:119], a[148:151], v[144:147]
v_mfma_f32_16x16x32_bf16 v[152:155], a[116:119], a[156:159], 0
v_mfma_f32_16x16x32_bf16 v[152:155], a[112:115], a[152:155], v[152:155]
v_mfma_f32_16x16x32_bf16 v[156:159], a[120:123], a[152:155], 0
v_mfma_f32_16x16x32_bf16 v[156:159], a[124:127], a[156:159], v[156:159]
v_mfma_f32_16x16x32_bf16 v[148:151], a[124:127], a[148:151], 0
v_mfma_f32_16x16x32_bf16 v[148:151], a[120:123], a[144:147], v[148:151]
v_mfma_f32_16x16x32_bf16 v[140:143], a[120:123], a[136:139], 0
v_mfma_f32_16x16x32_bf16 v[140:143], a[124:127], a[140:143], v[140:143]
v_mfma_f32_16x16x32_bf16 v[132:135], a[124:127], a[132:135], 0
v_mfma_f32_16x16x32_bf16 v[132:135], a[120:123], a[128:131], v[132:135]
s_waitcnt lgkmcnt(0)
v_mfma_f32_16x16x32_bf16 v[160:163], a[160:163], a[64:67], 0
s_waitcnt vmcnt(4)
v_mfma_f32_16x16x32_bf16 v[160:163], a[164:167], a[68:71], v[160:163]
s_barrier
v_mfma_f32_16x16x32_bf16 v[164:167], a[172:175], a[68:71], 0
ds_read_b64_tr_b16 a[128:129], v11 offset:32768
ds_read_b64_tr_b16 a[130:131], v11 offset:33280
v_mfma_f32_16x16x32_bf16 v[164:167], a[168:171], a[64:67], v[164:167]
s_xor_b32 s71, s70, 256
s_add_u32 s71, s68, s71
v_mfma_f32_16x16x32_bf16 v[168:171], a[176:179], a[64:67], 0
s_add_u32 m0, s73, 65536
s_add_u32 s64, s71, 0
v_mfma_f32_16x16x32_bf16 v[168:171], a[180:183], a[68:71], v[168:171]
buffer_load_dwordx4 v5, s[8:11], s64 offen lds
v_mfma_f32_16x16x32_bf16 v[172:175], a[188:191], a[68:71], 0
v_mfma_f32_16x16x32_bf16 v[172:175], a[184:187], a[64:67], v[172:175]
ds_read_b128 a[64:67], v9 offset:0
v_mfma_f32_16x16x32_bf16 v[188:191], a[184:187], a[72:75], 0
buffer_load_dwordx4 v6, s[8:11], s64 offen offset:1024 lds
v_mfma_f32_16x16x32_bf16 v[188:191], a[188:191], a[76:79], v[188:191]
ds_read_b64_tr_b16 a[132:133], v11 offset:40960
ds_read_b64_tr_b16 a[134:135], v11 offset:41472
v_mfma_f32_16x16x32_bf16 v[184:187], a[180:183], a[76:79], 0
v_mfma_f32_16x16x32_bf16 v[184:187], a[176:179], a[72:75], v[184:187]
s_add_u32 m0, s73, 67584
s_add_u32 s64, s71, 16384
ds_read_b128 a[68:71], v10 offset:0
v_mfma_f32_16x16x32_bf16 v[180:183], a[168:171], a[72:75], 0
v_mfma_f32_16x16x32_bf16 v[180:183], a[172:175], a[76:79], v[180:183]
buffer_load_dwordx4 v5, s[8:11], s64 offen lds
v_mfma_f32_16x16x32_bf16 v[176:179], a[164:167], a[76:79], 0
v_mfma_f32_16x16x32_bf16 v[176:179], a[160:163], a[72:75], v[176:179]
L_PAD0:
s_cbranch_execz L_PAD4
ds_read_b64_tr_b16 a[136:137], v12 offset:32768
ds_read_b64_tr_b16 a[138:139], v12 offset:33280
v_mfma_f32_16x16x32_bf16 v[192:195], a[160:163], a[80:83], 0
v_mfma_f32_16x16x32_bf16 v[192:195], a[164:167], a[84:87], v[192:195]
v_mfma_f32_16x16x32_bf16 v[196:199], a[172:175], a[84:87], 0
buffer_load_dwordx4 v6, s[8:11], s64 offen offset:1024 lds
v_mfma_f32_16x16x32_bf16 v[196:199], a[168:171], a[80:83], v[196:199]
s_xor_b32 s76, s75, 1048576
s_add_u32 s76, s74, s76
ds_read_b128 a[72:75], v9 offset:2048
v_mfma_f32_16x16x32_bf16 v[200:203], a[176:179], a[80:83], 0
v_mfma_f32_16x16x32_bf16 v[200:203], a[180:183], a[84:87], v[200:203]
s_add_u32 m0, s77, 0
s_add_u32 s64, s76, 0
v_mfma_f32_16x16x32_bf16 v[204:207], a[188:191], a[84:87], 0
ds_read_b64_tr_b16 a[140:141], v12 offset:40960
ds_read_b64_tr_b16 a[142:143], v12 offset:41472
v_mfma_f32_16x16x32_bf16 v[204:207], a[184:187], a[80:83], v[204:207]
buffer_load_dwordx4 v7, s[56:59], s64 offen lds
v_mfma_f32_16x16x32_bf16 v[220:223], a[184:187], a[88:91], 0
ds_read_b128 a[76:79], v10 offset:2048
v_mfma_f32_16x16x32_bf16 v[220:223], a[188:191], a[92:95], v[220:223]
v_mfma_f32_16x16x32_bf16 v[216:219], a[180:183], a[92:95], 0
v_mfma_f32_16x16x32_bf16 v[216:219], a[176:179], a[88:91], v[216:219]
v_mfma_f32_16x16x32_bf16 v[212:215], a[168:171], a[88:91], 0
buffer_load_dwordx4 v8, s[56:59], s64 offen offset:1024 lds
v_mfma_f32_16x16x32_bf16 v[212:215], a[172:175], a[92:95], v[212:215]
ds_read_b64_tr_b16 a[144:145], v13 offset:32768
ds_read_b64_tr_b16 a[146:147], v13 offset:33280
v_mfma_f32_16x16x32_bf16 v[208:211], a[164:167], a[92:95], 0
v_mfma_f32_16x16x32_bf16 v[208:211], a[160:163], a[88:91], v[208:211]
s_add_u32 m0, s77, 2048
s_add_u32 s64, s76, 131072
ds_read_b128 a[80:83], v9 offset:4096
v_mfma_f32_16x16x32_bf16 v[224:227], a[160:163], a[96:99], 0
v_mfma_f32_16x16x32_bf16 v[224:227], a[164:167], a[100:103], v[224:227]
buffer_load_dwordx4 v7, s[56:59], s64 offen lds
v_mfma_f32_16x16x32_bf16 v[228:231], a[172:175], a[100:103], 0
ds_read_b64_tr_b16 a[148:149], v13 offset:40960
ds_read_b64_tr_b16 a[150:151], v13 offset:41472
v_mfma_f32_16x16x32_bf16 v[228:231], a[168:171], a[96:99], v[228:231]
v_mfma_f32_16x16x32_bf16 v[232:235], a[176:179], a[96:99], 0
buffer_store_dwordx4 v[16:19], v20, s[24:27], s52 offen sc1
v_mfma_f32_16x16x32_bf16 v[232:235], a[180:183], a[100:103], v[232:235]
buffer_load_dwordx4 v8, s[56:59], s64 offen offset:1024 lds
v_mfma_f32_16x16x32_bf16 v[236:239], a[188:191], a[100:103], 0
s_add_u32 s89, s89, 512
ds_read_b128 a[84:87], v10 offset:4096
v_mfma_f32_16x16x32_bf16 v[236:239], a[184:187], a[96:99], v[236:239]
s_cmp_eq_u32 s3, 0
s_cselect_b32 s90, s89, 2147418112
v_mov_b32 v24, 2147418112
v_mfma_f32_16x16x32_bf16 v[252:255], a[184:187], a[104:107], 0
s_add_u32 m0, s73, 69632
s_add_u32 s64, s71, 524288
v_cmp_eq_u32 vcc, 1, v1
v_mfma_f32_16x16x32_bf16 v[252:255], a[188:191], a[108:111], v[252:255]
s_lshl_b32 s53, s55, 12
ds_read_b64_tr_b16 a[152:153], v14 offset:32768
ds_read_b64_tr_b16 a[154:155], v14 offset:33280
v_mfma_f32_16x16x32_bf16 v[248:251], a[180:183], a[108:111], 0
buffer_load_dwordx4 v5, s[8:11], s64 offen lds
v_mfma_f32_16x16x32_bf16 v[248:251], a[176:179], a[104:107], v[248:251]
v_cndmask_b32 v0, v24, 0, vcc
v_mfma_f32_16x16x32_bf16 v[244:247], a[168:171], a[104:107], 0
s_mul_i32 s87, s87, 16384
s_add_u32 s87, s87, s94
ds_read_b128 a[88:91], v9 offset:6144
v_mfma_f32_16x16x32_bf16 v[244:247], a[172:175], a[108:111], v[244:247]
s_add_u32 s88, s87, s53
s_add_u32 s88, s88, 24576
s_lshr_b32 s53, s53, 1
v_mfma_f32_16x16x32_bf16 v[240:243], a[164:167], a[108:111], 0
s_add_u32 s87, s87, s53
s_lshl_b32 s80, s3, 10
s_mul_i32 s78, s4, 18
v_mfma_f32_16x16x32_bf16 v[240:243], a[160:163], a[104:107], v[240:243]
buffer_load_dwordx4 v6, s[8:11], s64 offen offset:1024 lds
v_mfma_f32_16x16x32_bf16 a[0:3], a[160:163], a[112:115], 0
s_add_u32 s78, s78, s54
ds_read_b64_tr_b16 a[156:157], v14 offset:40960
ds_read_b64_tr_b16 a[158:159], v14 offset:41472
v_mfma_f32_16x16x32_bf16 a[0:3], a[164:167], a[116:119], a[0:3]
s_lshl2_add_u32 s78, s78, s55
s_lshl_b32 s78, s78, 10
s_add_u32 s78, s78, 35651584
v_mfma_f32_16x16x32_bf16 a[4:7], a[172:175], a[116:119], 0
s_add_u32 m0, s73, 71680
s_add_u32 s64, s71, 540672
ds_read_b128 a[92:95], v10 offset:6144
v_mfma_f32_16x16x32_bf16 a[4:7], a[168:171], a[112:115], a[4:7]
s_add_u32 s80, s80, 8192
s_mov_b32 s91, 0x3e0293ee
s_mov_b32 s85, 0x05040100
v_mfma_f32_16x16x32_bf16 a[8:11], a[176:179], a[112:115], 0
buffer_load_dwordx4 v5, s[8:11], s64 offen lds
v_mfma_f32_16x16x32_bf16 a[8:11], a[180:183], a[116:119], a[8:11]
s_mov_b32 s86, 0x07060302
s_lshl2_add_u32 s52, s7, s3
s_and_b32 s65, s6, 3
v_mfma_f32_16x16x32_bf16 a[12:15], a[188:191], a[116:119], 0
s_max_u32 s95, s65, 1
s_mul_i32 s92, s5, 3
s_add_u32 s95, s95, s92
v_mfma_f32_16x16x32_bf16 a[12:15], a[184:187], a[112:115], a[12:15]
s_sub_u32 s95, 24, s95
s_cmp_eq_u32 s65, 1
s_cselect_b32 s95, 63, s95
v_mfma_f32_16x16x32_bf16 a[28:31], a[184:187], a[120:123], 0
s_mov_b32 s92, s95
s_mul_i32 s81, s92, 110592
s_mul_i32 s65, s52, 36
v_mfma_f32_16x16x32_bf16 a[28:31], a[188:191], a[124:127], a[28:31]
buffer_load_dwordx4 v6, s[8:11], s64 offen offset:1024 lds
v_mfma_f32_16x16x32_bf16 a[24:27], a[180:183], a[124:127], 0
s_add_u32 s81, s81, s65
s_mul_i32 s82, s52, 18
s_add_u32 s82, s82, s92
v_mfma_f32_16x16x32_bf16 a[24:27], a[176:179], a[120:123], a[24:27]
s_lshl_b32 s82, s82, 12
s_add_u32 s82, s82, 35651584
s_lshl_b32 s83, s92, 6
v_mfma_f32_16x16x32_bf16 a[20:23], a[168:171], a[120:123], 0
s_lshl_b32 s84, s52, 10
s_add_u32 s84, s84, 75497984
v_mfma_f32_16x16x32_bf16 a[20:23], a[172:175], a[124:127], a[20:23]
s_cmp_lt_u32 s92, 18
s_cselect_b32 s82, s82, 2147418112
s_cselect_b32 s84, s84, 2147418112
v_mfma_f32_16x16x32_bf16 a[16:19], a[164:167], a[124:127], 0
v_lshrrev_b32 v18, 2, v2
v_and_b32 v19, 3, v2
v_mfma_f32_16x16x32_bf16 a[16:19], a[160:163], a[120:123], a[16:19]
s_waitcnt lgkmcnt(0)
v_mul_u32_u24 v20, 1152, v18
v_cmp_eq_u32 vcc, 2, v19
v_mfma_f32_16x16x32_bf16 v[32:35], a[64:67], a[128:131], v[32:35]
s_waitcnt vmcnt(13)
v_lshl_add_u32 v20, v19, 3, v20
v_add_u32 v21, 1, v19
v_mfma_f32_16x16x32_bf16 v[32:35], a[68:71], a[132:135], v[32:35]
s_barrier
v_mfma_f32_16x16x32_bf16 v[40:43], a[68:71], a[140:143], v[40:43]
ds_read_b128 a[96:99], v9 offset:8192
v_cndmask_b32 v21, v21, 0, vcc
v_mfma_f32_16x16x32_bf16 v[40:43], a[64:67], a[136:139], v[40:43]
s_add_u32 m0, s77, 16384
s_add_u32 s64, s76, 0
v_cmp_eq_u32 vcc, 3, v18
v_mfma_f32_16x16x32_bf16 v[48:51], a[64:67], a[144:147], v[48:51]
buffer_load_dwordx4 v7, s[16:19], s64 offen lds
v_mfma_f32_16x16x32_bf16 v[48:51], a[68:71], a[148:151], v[48:51]
ds_read_b128 a[100:103], v10 offset:8192
v_mul_u32_u24 v21, 1152, v21
v_mfma_f32_16x16x32_bf16 v[56:59], a[68:71], a[156:159], v[56:59]
v_add_u32 v21, 32, v21
v_cndmask_b32 v20, v20, v21, vcc
v_mfma_f32_16x16x32_bf16 v[56:59], a[64:67], a[152:155], v[56:59]
v_cmp_eq_u32 vcc, 15, v2
v_mul_u32_u24 v21, 27648, v3
v_mfma_f32_16x16x32_bf16 v[60:63], a[72:75], a[152:155], v[60:63]
buffer_load_dwordx4 v8, s[16:19], s64 offen offset:1024 lds
v_mfma_f32_16x16x32_bf16 v[60:63], a[76:79], a[156:159], v[60:63]
ds_read_b128 a[104:107], v9 offset:10240
v_add_u32 v20, v20, v21
v_mfma_f32_16x16x32_bf16 v[52:55], a[76:79], a[148:151], v[52:55]
v_lshlrev_b32 v21, 4, v3
v_cndmask_b32 v26, v20, v24, vcc
v_mfma_f32_16x16x32_bf16 v[52:55], a[72:75], a[144:147], v[52:55]
s_add_u32 m0, s77, 18432
s_add_u32 s64, s76, 131072
v_cndmask_b32 v27, v24, v21, vcc
v_mfma_f32_16x16x32_bf16 v[44:47], a[72:75], a[136:139], v[44:47]
s_lshl_b32 s52, s4, 2
ds_read_b64_tr_b16 a[160:161], v11 offset:49152
ds_read_b64_tr_b16 a[162:163], v11 offset:49664
v_mfma_f32_16x16x32_bf16 v[44:47], a[76:79], a[140:143], v[44:47]
buffer_load_dwordx4 v7, s[16:19], s64 offen lds
v_mfma_f32_16x16x32_bf16 v[36:39], a[76:79], a[132:135], v[36:39]
s_cmp_eq_u32 s66, 0
s_cselect_b32 s52, s52, 2147418112
v_mfma_f32_16x16x32_bf16 v[36:39], a[72:75], a[128:131], v[36:39]
ds_read_b128 a[108:111], v10 offset:10240
v_mfma_f32_16x16x32_bf16 v[64:67], a[80:83], a[128:131], v[64:67]
v_mfma_f32_16x16x32_bf16 v[64:67], a[84:87], a[132:135], v[64:67]
v_mfma_f32_16x16x32_bf16 v[72:75], a[84:87], a[140:143], v[72:75]
buffer_load_dwordx4 v8, s[16:19], s64 offen offset:1024 lds
v_mfma_f32_16x16x32_bf16 v[72:75], a[80:83], a[136:139], v[72:75]
s_xor_b32 s71, s70, 384
s_add_u32 s71, s68, s71
v_mfma_f32_16x16x32_bf16 v[80:83], a[80:83], a[144:147], v[80:83]
ds_read_b64_tr_b16 a[164:165], v11 offset:57344
ds_read_b64_tr_b16 a[166:167], v11 offset:57856
v_mfma_f32_16x16x32_bf16 v[80:83], a[84:87], a[148:151], v[80:83]
s_add_u32 m0, s73, 0
s_add_u32 s64, s71, 0
ds_read_b128 a[112:115], v9 offset:12288
v_mfma_f32_16x16x32_bf16 v[88:91], a[84:87], a[156:159], v[88:91]
v_mfma_f32_16x16x32_bf16 v[88:91], a[80:83], a[152:155], v[88:91]
buffer_load_dwordx4 v5, s[8:11], s64 offen lds
v_mfma_f32_16x16x32_bf16 v[92:95], a[88:91], a[152:155], v[92:95]
ds_read_b64_tr_b16 a[168:169], v12 offset:49152
ds_read_b64_tr_b16 a[170:171], v12 offset:49664
v_mfma_f32_16x16x32_bf16 v[92:95], a[92:95], a[156:159], v[92:95]
v_mfma_f32_16x16x32_bf16 v[84:87], a[92:95], a[148:151], v[84:87]
v_mfma_f32_16x16x32_bf16 v[84:87], a[88:91], a[144:147], v[84:87]
v_mfma_f32_16x16x32_bf16 v[76:79], a[88:91], a[136:139], v[76:79]
buffer_load_dwordx4 v6, s[8:11], s64 offen offset:1024 lds
v_mfma_f32_16x16x32_bf16 v[76:79], a[92:95], a[140:143], v[76:79]
ds_read_b128 a[116:119], v10 offset:12288
v_mfma_f32_16x16x32_bf16 v[68:71], a[92:95], a[132:135], v[68:71]
v_mfma_f32_16x16x32_bf16 v[68:71], a[88:91], a[128:131], v[68:71]
s_add_u32 m0, s73, 2048
s_add_u32 s64, s71, 16384
s_waitcnt lgkmcnt(6)
v_mfma_f32_16x16x32_bf16 v[96:99], a[96:99], a[128:131], v[96:99]
ds_read_b64_tr_b16 a[172:173], v12 offset:57344
ds_read_b64_tr_b16 a[174:175], v12 offset:57856
v_mfma_f32_16x16x32_bf16 v[96:99], a[100:103], a[132:135], v[96:99]
buffer_load_dwordx4 v5, s[8:11], s64 offen lds
v_mfma_f32_16x16x32_bf16 v[104:107], a[100:103], a[140:143], v[104:107]
ds_read_b128 a[120:123], v9 offset:14336
v_mfma_f32_16x16x32_bf16 v[104:107], a[96:99], a[136:139], v[104:107]
v_mfma_f32_16x16x32_bf16 v[112:115], a[96:99], a[144:147], v[112:115]
v_mfma_f32_16x16x32_bf16 v[112:115], a[100:103], a[148:151], v[112:115]
buffer_load_dwordx4 v6, s[8:11], s64 offen offset:1024 lds
v_mfma_f32_16x16x32_bf16 v[120:123], a[100:103], a[156:159], v[120:123]
s_xor_b32 s76, s75, 1572864
s_add_u32 s76, s74, s76
v_mfma_f32_16x16x32_bf16 v[120:123], a[96:99], a[152:155], v[120:123]
ds_read_b64_tr_b16 a[176:177], v13 offset:49152
ds_read_b64_tr_b16 a[178:179], v13 offset:49664
v_mfma_f32_16x16x32_bf16 v[124:127], a[104:107], a[152:155], v[124:127]
s_add_u32 m0, s77, 32768
s_add_u32 s64, s76, 0
v_mfma_f32_16x16x32_bf16 v[124:127], a[108:111], a[156:159], v[124:127]
ds_read_b128 a[124:127], v10 offset:14336
v_mfma_f32_16x16x32_bf16 v[116:119], a[108:111], a[148:151], v[116:119]
buffer_load_dwordx4 v7, s[56:59], s64 offen lds
v_mfma_f32_16x16x32_bf16 v[116:119], a[104:107], a[144:147], v[116:119]
s_waitcnt vmcnt(14)
v_add_u32 v9, 32768, v9
v_add_u32 v10, 32768, v10
v_mfma_f32_16x16x32_bf16 v[108:111], a[104:107], a[136:139], v[108:111]
ds_read_b64_tr_b16 a[180:181], v13 offset:57344
ds_read_b64_tr_b16 a[182:183], v13 offset:57856
v_mfma_f32_16x16x32_bf16 v[108:111], a[108:111], a[140:143], v[108:111]
buffer_store_dword v1, v0, s[40:43], s52 offen sc1
v_mfma_f32_16x16x32_bf16 v[100:103], a[108:111], a[132:135], v[100:103]
s_waitcnt lgkmcnt(2)
s_lshl2_add_u32 s55, s95, s3
s_lshl3_add_u32 s54, s55, s7
v_mfma_f32_16x16x32_bf16 v[100:103], a[104:107], a[128:131], v[100:103]
buffer_load_dwordx4 v8, s[56:59], s64 offen offset:1024 lds
v_mfma_f32_16x16x32_bf16 v[128:131], a[112:115], a[128:131], v[128:131]
s_mul_i32 s53, s54, 3072
ds_read_b64_tr_b16 a[184:185], v14 offset:49152
ds_read_b64_tr_b16 a[186:187], v14 offset:49664
v_mfma_f32_16x16x32_bf16 v[128:131], a[116:119], a[132:135], v[128:131]
s_mul_i32 s55, s55, 48
s_add_u32 s55, s55, s7
s_lshl_b32 s55, s55, 10
v_mfma_f32_16x16x32_bf16 v[136:139], a[116:119], a[140:143], v[136:139]
s_add_u32 m0, s77, 34816
s_add_u32 s64, s76, 131072
v_min_u32 v20, 23, v1
v_mfma_f32_16x16x32_bf16 v[136:139], a[112:115], a[136:139], v[136:139]
ds_read_b64_tr_b16 a[188:189], v14 offset:57344
ds_read_b64_tr_b16 a[190:191], v14 offset:57856
v_mfma_f32_16x16x32_bf16 v[144:147], a[112:115], a[144:147], v[144:147]
buffer_load_dwordx4 v7, s[56:59], s64 offen lds
v_mfma_f32_16x16x32_bf16 v[144:147], a[116:119], a[148:151], v[144:147]
v_lshrrev_b32 v21, 3, v20
v_mul_u32_u24 v21, 7168, v21
v_mfma_f32_16x16x32_bf16 v[152:155], a[116:119], a[156:159], v[152:155]
v_lshlrev_b32 v20, 7, v20
v_add_u32 v21, v21, v20
v_mfma_f32_16x16x32_bf16 v[152:155], a[112:115], a[152:155], v[152:155]
v_mfma_f32_16x16x32_bf16 v[156:159], a[120:123], a[152:155], v[156:159]
v_mfma_f32_16x16x32_bf16 v[156:159], a[124:127], a[156:159], v[156:159]
buffer_load_dwordx4 v8, s[56:59], s64 offen offset:1024 lds
v_mfma_f32_16x16x32_bf16 v[148:151], a[124:127], a[148:151], v[148:151]
v_mfma_f32_16x16x32_bf16 v[148:151], a[120:123], a[144:147], v[148:151]
v_mfma_f32_16x16x32_bf16 v[140:143], a[120:123], a[136:139], v[140:143]
v_mfma_f32_16x16x32_bf16 v[140:143], a[124:127], a[140:143], v[140:143]
v_mfma_f32_16x16x32_bf16 v[132:135], a[124:127], a[132:135], v[132:135]
v_mfma_f32_16x16x32_bf16 v[132:135], a[120:123], a[128:131], v[132:135]
s_waitcnt lgkmcnt(0)
v_mfma_f32_16x16x32_bf16 v[160:163], a[160:163], a[64:67], v[160:163]
s_waitcnt vmcnt(13)
v_mfma_f32_16x16x32_bf16 v[160:163], a[164:167], a[68:71], v[160:163]
s_barrier
v_mfma_f32_16x16x32_bf16 v[164:167], a[172:175], a[68:71], v[164:167]
ds_read_b64_tr_b16 a[128:129], v11 offset:0
ds_read_b64_tr_b16 a[130:131], v11 offset:512
v_mfma_f32_16x16x32_bf16 v[164:167], a[168:171], a[64:67], v[164:167]
s_add_u32 m0, s73, 4096
s_add_u32 s64, s71, 524288
v_mfma_f32_16x16x32_bf16 v[168:171], a[176:179], a[64:67], v[168:171]
buffer_load_dwordx4 v5, s[8:11], s64 offen lds
v_mfma_f32_16x16x32_bf16 v[168:171], a[180:183], a[68:71], v[168:171]
v_mfma_f32_16x16x32_bf16 v[172:175], a[188:191], a[68:71], v[172:175]
v_mfma_f32_16x16x32_bf16 v[172:175], a[184:187], a[64:67], v[172:175]
ds_read_b128 a[64:67], v9 offset:0
v_mfma_f32_16x16x32_bf16 v[188:191], a[184:187], a[72:75], v[188:191]
buffer_load_dwordx4 v6, s[8:11], s64 offen offset:1024 lds
v_mfma_f32_16x16x32_bf16 v[188:191], a[188:191], a[76:79], v[188:191]
ds_read_b64_tr_b16 a[132:133], v11 offset:8192
ds_read_b64_tr_b16 a[134:135], v11 offset:8704
v_mfma_f32_16x16x32_bf16 v[184:187], a[180:183], a[76:79], v[184:187]
v_mfma_f32_16x16x32_bf16 v[184:187], a[176:179], a[72:75], v[184:187]
s_add_u32 m0, s73, 6144
s_add_u32 s64, s71, 540672
ds_read_b128 a[68:71], v10 offset:0
v_mfma_f32_16x16x32_bf16 v[180:183], a[168:171], a[72:75], v[180:183]
v_mfma_f32_16x16x32_bf16 v[180:183], a[172:175], a[76:79], v[180:183]
buffer_load_dwordx4 v5, s[8:11], s64 offen lds
v_mfma_f32_16x16x32_bf16 v[176:179], a[164:167], a[76:79], v[176:179]
v_mfma_f32_16x16x32_bf16 v[176:179], a[160:163], a[72:75], v[176:179]
ds_read_b64_tr_b16 a[136:137], v12 offset:0
ds_read_b64_tr_b16 a[138:139], v12 offset:512
v_mfma_f32_16x16x32_bf16 v[192:195], a[160:163], a[80:83], v[192:195]
v_mfma_f32_16x16x32_bf16 v[192:195], a[164:167], a[84:87], v[192:195]
v_mfma_f32_16x16x32_bf16 v[196:199], a[172:175], a[84:87], v[196:199]
buffer_load_dwordx4 v6, s[8:11], s64 offen offset:1024 lds
v_mfma_f32_16x16x32_bf16 v[196:199], a[168:171], a[80:83], v[196:199]
ds_read_b128 a[72:75], v9 offset:2048
v_mfma_f32_16x16x32_bf16 v[200:203], a[176:179], a[80:83], v[200:203]
v_mfma_f32_16x16x32_bf16 v[200:203], a[180:183], a[84:87], v[200:203]
s_add_u32 m0, s77, 49152
s_add_u32 s64, s76, 0
v_mfma_f32_16x16x32_bf16 v[204:207], a[188:191], a[84:87], v[204:207]
ds_read_b64_tr_b16 a[140:141], v12 offset:8192
ds_read_b64_tr_b16 a[142:143], v12 offset:8704
v_mfma_f32_16x16x32_bf16 v[204:207], a[184:187], a[80:83], v[204:207]
buffer_load_dwordx4 v7, s[16:19], s64 offen lds
v_mfma_f32_16x16x32_bf16 v[220:223], a[184:187], a[88:91], v[220:223]
ds_read_b128 a[76:79], v10 offset:2048
v_mfma_f32_16x16x32_bf16 v[220:223], a[188:191], a[92:95], v[220:223]
v_mfma_f32_16x16x32_bf16 v[216:219], a[180:183], a[92:95], v[216:219]
v_mfma_f32_16x16x32_bf16 v[216:219], a[176:179], a[88:91], v[216:219]
v_mfma_f32_16x16x32_bf16 v[212:215], a[168:171], a[88:91], v[212:215]
buffer_load_dwordx4 v8, s[16:19], s64 offen offset:1024 lds
v_mfma_f32_16x16x32_bf16 v[212:215], a[172:175], a[92:95], v[212:215]
ds_read_b64_tr_b16 a[144:145], v13 offset:0
ds_read_b64_tr_b16 a[146:147], v13 offset:512
v_mfma_f32_16x16x32_bf16 v[208:211], a[164:167], a[92:95], v[208:211]
v_mfma_f32_16x16x32_bf16 v[208:211], a[160:163], a[88:91], v[208:211]
s_add_u32 m0, s77, 51200
s_add_u32 s64, s76, 131072
ds_read_b128 a[80:83], v9 offset:4096
v_mfma_f32_16x16x32_bf16 v[224:227], a[160:163], a[96:99], v[224:227]
v_mfma_f32_16x16x32_bf16 v[224:227], a[164:167], a[100:103], v[224:227]
buffer_load_dwordx4 v7, s[16:19], s64 offen lds
v_mfma_f32_16x16x32_bf16 v[228:231], a[172:175], a[100:103], v[228:231]
ds_read_b64_tr_b16 a[148:149], v13 offset:8192
ds_read_b64_tr_b16 a[150:151], v13 offset:8704
v_mfma_f32_16x16x32_bf16 v[228:231], a[168:171], a[96:99], v[228:231]
v_mfma_f32_16x16x32_bf16 v[232:235], a[176:179], a[96:99], v[232:235]
v_mfma_f32_16x16x32_bf16 v[232:235], a[180:183], a[100:103], v[232:235]
buffer_load_dwordx4 v8, s[16:19], s64 offen offset:1024 lds
v_mfma_f32_16x16x32_bf16 v[236:239], a[188:191], a[100:103], v[236:239]
s_xor_b32 s71, s70, 512
s_add_u32 s71, s68, s71
ds_read_b128 a[84:87], v10 offset:4096
v_mfma_f32_16x16x32_bf16 v[236:239], a[184:187], a[96:99], v[236:239]
v_mfma_f32_16x16x32_bf16 v[252:255], a[184:187], a[104:107], v[252:255]
s_add_u32 m0, s73, 32768
s_add_u32 s64, s71, 0
v_mfma_f32_16x16x32_bf16 v[252:255], a[188:191], a[108:111], v[252:255]
ds_read_b64_tr_b16 a[152:153], v14 offset:0
ds_read_b64_tr_b16 a[154:155], v14 offset:512
v_mfma_f32_16x16x32_bf16 v[248:251], a[180:183], a[108:111], v[248:251]
buffer_load_dwordx4 v5, s[8:11], s64 offen lds
v_mfma_f32_16x16x32_bf16 v[248:251], a[176:179], a[104:107], v[248:251]
v_mfma_f32_16x16x32_bf16 v[244:247], a[168:171], a[104:107], v[244:247]
ds_read_b128 a[88:91], v9 offset:6144
v_mfma_f32_16x16x32_bf16 v[244:247], a[172:175], a[108:111], v[244:247]
v_mfma_f32_16x16x32_bf16 v[240:243], a[164:167], a[108:111], v[240:243]
v_mfma_f32_16x16x32_bf16 v[240:243], a[160:163], a[104:107], v[240:243]
buffer_load_dwordx4 v6, s[8:11], s64 offen offset:1024 lds
v_mfma_f32_16x16x32_bf16 a[0:3], a[160:163], a[112:115], a[0:3]
ds_read_b64_tr_b16 a[156:157], v14 offset:8192
ds_read_b64_tr_b16 a[158:159], v14 offset:8704
v_mfma_f32_16x16x32_bf16 a[0:3], a[164:167], a[116:119], a[0:3]
v_mfma_f32_16x16x32_bf16 a[4:7], a[172:175], a[116:119], a[4:7]
s_add_u32 m0, s73, 34816
s_add_u32 s64, s71, 16384
ds_read_b128 a[92:95], v10 offset:6144
v_mfma_f32_16x16x32_bf16 a[4:7], a[168:171], a[112:115], a[4:7]
v_mfma_f32_16x16x32_bf16 a[8:11], a[176:179], a[112:115], a[8:11]
buffer_load_dwordx4 v5, s[8:11], s64 offen lds
v_mfma_f32_16x16x32_bf16 a[8:11], a[180:183], a[116:119], a[8:11]
v_mfma_f32_16x16x32_bf16 a[12:15], a[188:191], a[116:119], a[12:15]
v_mfma_f32_16x16x32_bf16 a[12:15], a[184:187], a[112:115], a[12:15]
v_mfma_f32_16x16x32_bf16 a[28:31], a[184:187], a[120:123], a[28:31]
v_mfma_f32_16x16x32_bf16 a[28:31], a[188:191], a[124:127], a[28:31]
buffer_load_dwordx4 v6, s[8:11], s64 offen offset:1024 lds
v_mfma_f32_16x16x32_bf16 a[24:27], a[180:183], a[124:127], a[24:27]
v_mfma_f32_16x16x32_bf16 a[24:27], a[176:179], a[120:123], a[24:27]
v_mfma_f32_16x16x32_bf16 a[20:23], a[168:171], a[120:123], a[20:23]
v_mfma_f32_16x16x32_bf16 a[20:23], a[172:175], a[124:127], a[20:23]
v_mfma_f32_16x16x32_bf16 a[16:19], a[164:167], a[124:127], a[16:19]
v_mfma_f32_16x16x32_bf16 a[16:19], a[160:163], a[120:123], a[16:19]
s_waitcnt lgkmcnt(0)
v_mfma_f32_16x16x32_bf16 v[32:35], a[64:67], a[128:131], v[32:35]
s_waitcnt vmcnt(21)
v_mfma_f32_16x16x32_bf16 v[32:35], a[68:71], a[132:135], v[32:35]
s_barrier
v_mfma_f32_16x16x32_bf16 v[40:43], a[68:71], a[140:143], v[40:43]
s_add_u32 s52, s81, 0
ds_read_b128 a[96:99], v9 offset:8192
v_mfma_f32_16x16x32_bf16 v[40:43], a[64:67], a[136:139], v[40:43]
s_xor_b32 s76, s75, 2097152
s_add_u32 s76, s74, s76
v_mfma_f32_16x16x32_bf16 v[48:51], a[64:67], a[144:147], v[48:51]
s_add_u32 m0, s77, 0
s_add_u32 s64, s76, 0
v_mfma_f32_16x16x32_bf16 v[48:51], a[68:71], a[148:151], v[48:51]
buffer_load_dwordx4 v7, s[56:59], s64 offen lds
v_mfma_f32_16x16x32_bf16 v[56:59], a[68:71], a[156:159], v[56:59]
ds_read_b128 a[100:103], v10 offset:8192
v_mfma_f32_16x16x32_bf16 v[56:59], a[64:67], a[152:155], v[56:59]
buffer_load_dwordx2 a[192:193], v26, s[28:31], s52 offen
v_mfma_f32_16x16x32_bf16 v[60:63], a[72:75], a[152:155], v[60:63]
ds_read_b128 a[104:107], v9 offset:10240
v_mfma_f32_16x16x32_bf16 v[60:63], a[76:79], a[156:159], v[60:63]
v_mfma_f32_16x16x32_bf16 v[52:55], a[76:79], a[148:151], v[52:55]
s_add_u32 s52, s81, 3456
v_mfma_f32_16x16x32_bf16 v[52:55], a[72:75], a[144:147], v[52:55]
buffer_load_dwordx4 v8, s[56:59], s64 offen offset:1024 lds
v_mfma_f32_16x16x32_bf16 v[44:47], a[72:75], a[136:139], v[44:47]
ds_read_b64_tr_b16 a[160:161], v11 offset:16384
ds_read_b64_tr_b16 a[162:163], v11 offset:16896
v_mfma_f32_16x16x32_bf16 v[44:47], a[76:79], a[140:143], v[44:47]
buffer_load_dwordx2 a[194:195], v26, s[28:31], s52 offen
v_mfma_f32_16x16x32_bf16 v[36:39], a[76:79], a[132:135], v[36:39]
v_mfma_f32_16x16x32_bf16 v[36:39], a[72:75], a[128:131], v[36:39]
ds_read_b128 a[108:111], v10 offset:10240
v_mfma_f32_16x16x32_bf16 v[64:67], a[80:83], a[128:131], v[64:67]
s_add_u32 m0, s77, 2048
s_add_u32 s64, s76, 131072
s_add_u32 s52, s81, 6912
v_mfma_f32_16x16x32_bf16 v[64:67], a[84:87], a[132:135], v[64:67]
buffer_load_dwordx2 a[196:197], v26, s[28:31], s52 offen
v_mfma_f32_16x16x32_bf16 v[72:75], a[84:87], a[140:143], v[72:75]
buffer_load_dwordx4 v7, s[56:59], s64 offen lds
v_mfma_f32_16x16x32_bf16 v[72:75], a[80:83], a[136:139], v[72:75]
ds_read_b64_tr_b16 a[164:165], v11 offset:24576
ds_read_b64_tr_b16 a[166:167], v11 offset:25088
v_mfma_f32_16x16x32_bf16 v[80:83], a[80:83], a[144:147], v[80:83]
s_add_u32 s52, s81, 10368
v_mfma_f32_16x16x32_bf16 v[80:83], a[84:87], a[148:151], v[80:83]
ds_read_b128 a[112:115], v9 offset:12288
v_mfma_f32_16x16x32_bf16 v[88:91], a[84:87], a[156:159], v[88:91]
buffer_load_dwordx2 a[198:199], v26, s[28:31], s52 offen
v_mfma_f32_16x16x32_bf16 v[88:91], a[80:83], a[152:155], v[88:91]
v_mfma_f32_16x16x32_bf16 v[92:95], a[88:91], a[152:155], v[92:95]
ds_read_b64_tr_b16 a[168:169], v12 offset:16384
ds_read_b64_tr_b16 a[170:171], v12 offset:16896
v_mfma_f32_16x16x32_bf16 v[92:95], a[92:95], a[156:159], v[92:95]
buffer_load_dwordx4 v8, s[56:59], s64 offen offset:1024 lds
v_mfma_f32_16x16x32_bf16 v[84:87], a[92:95], a[148:151], v[84:87]
s_add_u32 s52, s81, 13824
v_mfma_f32_16x16x32_bf16 v[84:87], a[88:91], a[144:147], v[84:87]
buffer_load_dwordx2 a[200:201], v26, s[28:31], s52 offen
v_mfma_f32_16x16x32_bf16 v[76:79], a[88:91], a[136:139], v[76:79]
ds_read_b128 a[116:119], v10 offset:12288
v_mfma_f32_16x16x32_bf16 v[76:79], a[92:95], a[140:143], v[76:79]
v_mfma_f32_16x16x32_bf16 v[68:71], a[92:95], a[132:135], v[68:71]
s_add_u32 s52, s81, 17280
v_mfma_f32_16x16x32_bf16 v[68:71], a[88:91], a[128:131], v[68:71]
s_add_u32 m0, s73, 36864
s_add_u32 s64, s71, 524288
s_waitcnt lgkmcnt(6)
v_mfma_f32_16x16x32_bf16 v[96:99], a[96:99], a[128:131], v[96:99]
ds_read_b64_tr_b16 a[172:173], v12 offset:24576
ds_read_b64_tr_b16 a[174:175], v12 offset:25088
v_mfma_f32_16x16x32_bf16 v[96:99], a[100:103], a[132:135], v[96:99]
buffer_load_dwordx4 v5, s[8:11], s64 offen lds
v_mfma_f32_16x16x32_bf16 v[104:107], a[100:103], a[140:143], v[104:107]
ds_read_b128 a[120:123], v9 offset:14336
v_mfma_f32_16x16x32_bf16 v[104:107], a[96:99], a[136:139], v[104:107]
buffer_load_dwordx2 a[202:203], v26, s[28:31], s52 offen
v_mfma_f32_16x16x32_bf16 v[112:115], a[96:99], a[144:147], v[112:115]
v_mfma_f32_16x16x32_bf16 v[112:115], a[100:103], a[148:151], v[112:115]
ds_read_b64_tr_b16 a[176:177], v13 offset:16384
ds_read_b64_tr_b16 a[178:179], v13 offset:16896
v_mfma_f32_16x16x32_bf16 v[120:123], a[100:103], a[156:159], v[120:123]
s_add_u32 s52, s81, 20736
v_mfma_f32_16x16x32_bf16 v[120:123], a[96:99], a[152:155], v[120:123]
buffer_load_dwordx2 a[204:205], v26, s[28:31], s52 offen
v_mfma_f32_16x16x32_bf16 v[124:127], a[104:107], a[152:155], v[124:127]
buffer_load_dwordx4 v6, s[8:11], s64 offen offset:1024 lds
v_mfma_f32_16x16x32_bf16 v[124:127], a[108:111], a[156:159], v[124:127]
ds_read_b128 a[124:127], v10 offset:14336
v_mfma_f32_16x16x32_bf16 v[116:119], a[108:111], a[148:151], v[116:119]
s_add_u32 s52, s81, 24192
v_add_u32 v9, -65536, v9
v_add_u32 v10, -65536, v10
v_mfma_f32_16x16x32_bf16 v[116:119], a[104:107], a[144:147], v[116:119]
buffer_load_dwordx2 a[206:207], v26, s[28:31], s52 offen
v_mfma_f32_16x16x32_bf16 v[108:111], a[104:107], a[136:139], v[108:111]
ds_read_b64_tr_b16 a[180:181], v13 offset:24576
ds_read_b64_tr_b16 a[182:183], v13 offset:25088
v_mfma_f32_16x16x32_bf16 v[108:111], a[108:111], a[140:143], v[108:111]
s_add_u32 m0, s73, 38912
s_add_u32 s64, s71, 540672
v_mfma_f32_16x16x32_bf16 v[100:103], a[108:111], a[132:135], v[100:103]
s_waitcnt lgkmcnt(2)
v_mfma_f32_16x16x32_bf16 v[100:103], a[104:107], a[128:131], v[100:103]
buffer_load_dwordx4 v5, s[8:11], s64 offen lds
v_mfma_f32_16x16x32_bf16 v[128:131], a[112:115], a[128:131], v[128:131]
ds_read_b64_tr_b16 a[184:185], v14 offset:16384
ds_read_b64_tr_b16 a[186:187], v14 offset:16896
v_mfma_f32_16x16x32_bf16 v[128:131], a[116:119], a[132:135], v[128:131]
buffer_load_dwordx4 a[208:211], v27, s[36:39], s83 offen
v_mfma_f32_16x16x32_bf16 v[136:139], a[116:119], a[140:143], v[136:139]
ds_read_b64_tr_b16 a[188:189], v14 offset:24576
ds_read_b64_tr_b16 a[190:191], v14 offset:25088
v_mfma_f32_16x16x32_bf16 v[136:139], a[112:115], a[136:139], v[136:139]
v_mfma_f32_16x16x32_bf16 v[144:147], a[112:115], a[144:147], v[144:147]
v_mfma_f32_16x16x32_bf16 v[144:147], a[116:119], a[148:151], v[144:147]
v_mfma_f32_16x16x32_bf16 v[152:155], a[116:119], a[156:159], v[152:155]
buffer_load_dwordx4 v6, s[8:11], s64 offen offset:1024 lds
v_mfma_f32_16x16x32_bf16 v[152:155], a[112:115], a[152:155], v[152:155]
v_mfma_f32_16x16x32_bf16 v[156:159], a[120:123], a[152:155], v[156:159]
v_mfma_f32_16x16x32_bf16 v[156:159], a[124:127], a[156:159], v[156:159]
v_mfma_f32_16x16x32_bf16 v[148:151], a[124:127], a[148:151], v[148:151]
v_mfma_f32_16x16x32_bf16 v[148:151], a[120:123], a[144:147], v[148:151]
v_mfma_f32_16x16x32_bf16 v[140:143], a[120:123], a[136:139], v[140:143]
v_mfma_f32_16x16x32_bf16 v[140:143], a[124:127], a[140:143], v[140:143]
v_mfma_f32_16x16x32_bf16 v[132:135], a[124:127], a[132:135], v[132:135]
v_mfma_f32_16x16x32_bf16 v[132:135], a[120:123], a[128:131], v[132:135]
s_waitcnt lgkmcnt(0)
v_mfma_f32_16x16x32_bf16 v[160:163], a[160:163], a[64:67], v[160:163]
s_waitcnt vmcnt(25)
v_mfma_f32_16x16x32_bf16 v[160:163], a[164:167], a[68:71], v[160:163]
s_barrier
v_mfma_f32_16x16x32_bf16 v[164:167], a[172:175], a[68:71], v[164:167]
ds_read_b64_tr_b16 a[128:129], v11 offset:32768
ds_read_b64_tr_b16 a[130:131], v11 offset:33280
v_mfma_f32_16x16x32_bf16 v[164:167], a[168:171], a[64:67], v[164:167]
s_add_u32 m0, s77, 16384
s_add_u32 s64, s76, 0
v_mfma_f32_16x16x32_bf16 v[168:171], a[176:179], a[64:67], v[168:171]
buffer_load_dwordx4 v7, s[16:19], s64 offen lds
v_mfma_f32_16x16x32_bf16 v[168:171], a[180:183], a[68:71], v[168:171]
v_mfma_f32_16x16x32_bf16 v[172:175], a[188:191], a[68:71], v[172:175]
v_mfma_f32_16x16x32_bf16 v[172:175], a[184:187], a[64:67], v[172:175]
ds_read_b128 a[64:67], v9 offset:0
v_mfma_f32_16x16x32_bf16 v[188:191], a[184:187], a[72:75], v[188:191]
ds_read_b64_tr_b16 a[132:133], v11 offset:40960
ds_read_b64_tr_b16 a[134:135], v11 offset:41472
v_mfma_f32_16x16x32_bf16 v[188:191], a[188:191], a[76:79], v[188:191]
L_PAD1:
s_cbranch_execz L_PAD5
v_mfma_f32_16x16x32_bf16 v[184:187], a[180:183], a[76:79], v[184:187]
v_mfma_f32_16x16x32_bf16 v[184:187], a[176:179], a[72:75], v[184:187]
buffer_load_dwordx4 v8, s[16:19], s64 offen offset:1024 lds
v_mfma_f32_16x16x32_bf16 v[180:183], a[168:171], a[72:75], v[180:183]
ds_read_b128 a[68:71], v10 offset:0
v_mfma_f32_16x16x32_bf16 v[180:183], a[172:175], a[76:79], v[180:183]
v_mfma_f32_16x16x32_bf16 v[176:179], a[164:167], a[76:79], v[176:179]
v_mfma_f32_16x16x32_bf16 v[176:179], a[160:163], a[72:75], v[176:179]
ds_read_b64_tr_b16 a[136:137], v12 offset:32768
ds_read_b64_tr_b16 a[138:139], v12 offset:33280
v_mfma_f32_16x16x32_bf16 v[192:195], a[160:163], a[80:83], v[192:195]
s_add_u32 m0, s77, 18432
s_add_u32 s64, s76, 131072
v_mfma_f32_16x16x32_bf16 v[192:195], a[164:167], a[84:87], v[192:195]
v_mfma_f32_16x16x32_bf16 v[196:199], a[172:175], a[84:87], v[196:199]
buffer_load_dwordx4 v7, s[16:19], s64 offen lds
v_mfma_f32_16x16x32_bf16 v[196:199], a[168:171], a[80:83], v[196:199]
ds_read_b128 a[72:75], v9 offset:2048
v_mfma_f32_16x16x32_bf16 v[200:203], a[176:179], a[80:83], v[200:203]
v_mfma_f32_16x16x32_bf16 v[200:203], a[180:183], a[84:87], v[200:203]
ds_read_b64_tr_b16 a[140:141], v12 offset:40960
ds_read_b64_tr_b16 a[142:143], v12 offset:41472
v_mfma_f32_16x16x32_bf16 v[204:207], a[188:191], a[84:87], v[204:207]
v_mfma_f32_16x16x32_bf16 v[204:207], a[184:187], a[80:83], v[204:207]
v_mfma_f32_16x16x32_bf16 v[220:223], a[184:187], a[88:91], v[220:223]
ds_read_b128 a[76:79], v10 offset:2048
v_mfma_f32_16x16x32_bf16 v[220:223], a[188:191], a[92:95], v[220:223]
buffer_load_dwordx4 v8, s[16:19], s64 offen offset:1024 lds
v_mfma_f32_16x16x32_bf16 v[216:219], a[180:183], a[92:95], v[216:219]
s_xor_b32 s71, s70, 640
s_add_u32 s71, s68, s71
v_mfma_f32_16x16x32_bf16 v[216:219], a[176:179], a[88:91], v[216:219]
v_mfma_f32_16x16x32_bf16 v[212:215], a[168:171], a[88:91], v[212:215]
ds_read_b64_tr_b16 a[144:145], v13 offset:32768
ds_read_b64_tr_b16 a[146:147], v13 offset:33280
v_mfma_f32_16x16x32_bf16 v[212:215], a[172:175], a[92:95], v[212:215]
v_mfma_f32_16x16x32_bf16 v[208:211], a[164:167], a[92:95], v[208:211]
v_mfma_f32_16x16x32_bf16 v[208:211], a[160:163], a[88:91], v[208:211]
s_add_u32 m0, s73, 65536
s_add_u32 s64, s71, 0
ds_read_b128 a[80:83], v9 offset:4096
v_mfma_f32_16x16x32_bf16 v[224:227], a[160:163], a[96:99], v[224:227]
v_mfma_f32_16x16x32_bf16 v[224:227], a[164:167], a[100:103], v[224:227]
buffer_load_dwordx4 v5, s[8:11], s64 offen lds
v_mfma_f32_16x16x32_bf16 v[228:231], a[172:175], a[100:103], v[228:231]
ds_read_b64_tr_b16 a[148:149], v13 offset:40960
ds_read_b64_tr_b16 a[150:151], v13 offset:41472
v_mfma_f32_16x16x32_bf16 v[228:231], a[168:171], a[96:99], v[228:231]
v_mfma_f32_16x16x32_bf16 v[232:235], a[176:179], a[96:99], v[232:235]
v_mfma_f32_16x16x32_bf16 v[232:235], a[180:183], a[100:103], v[232:235]
ds_read_b128 a[84:87], v10 offset:4096
v_mfma_f32_16x16x32_bf16 v[236:239], a[188:191], a[100:103], v[236:239]
v_mfma_f32_16x16x32_bf16 v[236:239], a[184:187], a[96:99], v[236:239]
v_mfma_f32_16x16x32_bf16 v[252:255], a[184:187], a[104:107], v[252:255]
buffer_load_dwordx4 v6, s[8:11], s64 offen offset:1024 lds
v_mfma_f32_16x16x32_bf16 v[252:255], a[188:191], a[108:111], v[252:255]
ds_read_b64_tr_b16 a[152:153], v14 offset:32768
ds_read_b64_tr_b16 a[154:155], v14 offset:33280
v_mfma_f32_16x16x32_bf16 v[248:251], a[180:183], a[108:111], v[248:251]
v_mfma_f32_16x16x32_bf16 v[248:251], a[176:179], a[104:107], v[248:251]
v_mfma_f32_16x16x32_bf16 v[244:247], a[168:171], a[104:107], v[244:247]
ds_read_b128 a[88:91], v9 offset:6144
v_mfma_f32_16x16x32_bf16 v[244:247], a[172:175], a[108:111], v[244:247]
s_add_u32 m0, s73, 67584
s_add_u32 s64, s71, 16384
v_mfma_f32_16x16x32_bf16 v[240:243], a[164:167], a[108:111], v[240:243]
v_mfma_f32_16x16x32_bf16 v[240:243], a[160:163], a[104:107], v[240:243]
buffer_load_dwordx4 v5, s[8:11], s64 offen lds
v_mfma_f32_16x16x32_bf16 a[0:3], a[160:163], a[112:115], a[0:3]
ds_read_b64_tr_b16 a[156:157], v14 offset:40960
ds_read_b64_tr_b16 a[158:159], v14 offset:41472
v_mfma_f32_16x16x32_bf16 a[0:3], a[164:167], a[116:119], a[0:3]
v_mfma_f32_16x16x32_bf16 a[4:7], a[172:175], a[116:119], a[4:7]
ds_read_b128 a[92:95], v10 offset:6144
v_mfma_f32_16x16x32_bf16 a[4:7], a[168:171], a[112:115], a[4:7]
v_mfma_f32_16x16x32_bf16 a[8:11], a[176:179], a[112:115], a[8:11]
v_mfma_f32_16x16x32_bf16 a[8:11], a[180:183], a[116:119], a[8:11]
v_mfma_f32_16x16x32_bf16 a[12:15], a[188:191], a[116:119], a[12:15]
buffer_load_dwordx4 v6, s[8:11], s64 offen offset:1024 lds
v_mfma_f32_16x16x32_bf16 a[12:15], a[184:187], a[112:115], a[12:15]
v_mfma_f32_16x16x32_bf16 a[28:31], a[184:187], a[120:123], a[28:31]
v_mfma_f32_16x16x32_bf16 a[28:31], a[188:191], a[124:127], a[28:31]
v_mfma_f32_16x16x32_bf16 a[24:27], a[180:183], a[124:127], a[24:27]
v_mfma_f32_16x16x32_bf16 a[24:27], a[176:179], a[120:123], a[24:27]
v_mfma_f32_16x16x32_bf16 a[20:23], a[168:171], a[120:123], a[20:23]
v_mfma_f32_16x16x32_bf16 a[20:23], a[172:175], a[124:127], a[20:23]
v_mfma_f32_16x16x32_bf16 a[16:19], a[164:167], a[124:127], a[16:19]
v_mfma_f32_16x16x32_bf16 a[16:19], a[160:163], a[120:123], a[16:19]
s_waitcnt lgkmcnt(0)
v_mfma_f32_16x16x32_bf16 v[32:35], a[64:67], a[128:131], v[32:35]
s_waitcnt vmcnt(29)
v_mfma_f32_16x16x32_bf16 v[32:35], a[68:71], a[132:135], v[32:35]
s_barrier
v_mfma_f32_16x16x32_bf16 v[40:43], a[68:71], a[140:143], v[40:43]
ds_read_b128 a[96:99], v9 offset:8192
v_mfma_f32_16x16x32_bf16 v[40:43], a[64:67], a[136:139], v[40:43]
s_xor_b32 s76, s75, 2621440
s_add_u32 s76, s74, s76
v_mfma_f32_16x16x32_bf16 v[48:51], a[64:67], a[144:147], v[48:51]
s_add_u32 m0, s77, 32768
s_add_u32 s64, s76, 0
v_mfma_f32_16x16x32_bf16 v[48:51], a[68:71], a[148:151], v[48:51]
buffer_load_dwordx4 v7, s[56:59], s64 offen lds
v_mfma_f32_16x16x32_bf16 v[56:59], a[68:71], a[156:159], v[56:59]
ds_read_b128 a[100:103], v10 offset:8192
v_mfma_f32_16x16x32_bf16 v[56:59], a[64:67], a[152:155], v[56:59]
v_mfma_f32_16x16x32_bf16 v[60:63], a[72:75], a[152:155], v[60:63]
ds_read_b128 a[104:107], v9 offset:10240
v_mfma_f32_16x16x32_bf16 v[60:63], a[76:79], a[156:159], v[60:63]
v_mfma_f32_16x16x32_bf16 v[52:55], a[76:79], a[148:151], v[52:55]
v_mfma_f32_16x16x32_bf16 v[52:55], a[72:75], a[144:147], v[52:55]
buffer_load_dwordx4 v8, s[56:59], s64 offen offset:1024 lds
v_mfma_f32_16x16x32_bf16 v[44:47], a[72:75], a[136:139], v[44:47]
ds_read_b64_tr_b16 a[160:161], v11 offset:49152
ds_read_b64_tr_b16 a[162:163], v11 offset:49664
v_mfma_f32_16x16x32_bf16 v[44:47], a[76:79], a[140:143], v[44:47]
v_mfma_f32_16x16x32_bf16 v[36:39], a[76:79], a[132:135], v[36:39]
v_mfma_f32_16x16x32_bf16 v[36:39], a[72:75], a[128:131], v[36:39]
ds_read_b128 a[108:111], v10 offset:10240
v_mfma_f32_16x16x32_bf16 v[64:67], a[80:83], a[128:131], v[64:67]
s_add_u32 m0, s77, 34816
s_add_u32 s64, s76, 131072
v_mfma_f32_16x16x32_bf16 v[64:67], a[84:87], a[132:135], v[64:67]
v_mfma_f32_16x16x32_bf16 v[72:75], a[84:87], a[140:143], v[72:75]
buffer_load_dwordx4 v7, s[56:59], s64 offen lds
v_mfma_f32_16x16x32_bf16 v[72:75], a[80:83], a[136:139], v[72:75]
ds_read_b64_tr_b16 a[164:165], v11 offset:57344
ds_read_b64_tr_b16 a[166:167], v11 offset:57856
v_mfma_f32_16x16x32_bf16 v[80:83], a[80:83], a[144:147], v[80:83]
v_mfma_f32_16x16x32_bf16 v[80:83], a[84:87], a[148:151], v[80:83]
s_waitcnt vmcnt(12)
ds_read_b128 a[112:115], v9 offset:12288
v_mfma_f32_16x16x32_bf16 v[88:91], a[84:87], a[156:159], v[88:91]
v_mfma_f32_16x16x32_bf16 v[88:91], a[80:83], a[152:155], v[88:91]
v_accvgpr_read_b32 v16, a192
v_accvgpr_read_b32 v17, a194
v_mfma_f32_16x16x32_bf16 v[92:95], a[88:91], a[152:155], v[92:95]
ds_read_b64_tr_b16 a[168:169], v12 offset:49152
ds_read_b64_tr_b16 a[170:171], v12 offset:49664
v_mfma_f32_16x16x32_bf16 v[92:95], a[92:95], a[156:159], v[92:95]
buffer_load_dwordx4 v8, s[56:59], s64 offen offset:1024 lds
v_mfma_f32_16x16x32_bf16 v[84:87], a[92:95], a[148:151], v[84:87]
v_accvgpr_read_b32 v18, a196
v_accvgpr_read_b32 v19, a198
v_mfma_f32_16x16x32_bf16 v[84:87], a[88:91], a[144:147], v[84:87]
v_perm_b32 v24, v17, v16, s85
v_perm_b32 v25, v19, v18, s85
v_mfma_f32_16x16x32_bf16 v[76:79], a[88:91], a[136:139], v[76:79]
ds_read_b128 a[116:119], v10 offset:12288
v_perm_b32 v28, v17, v16, s86
v_mfma_f32_16x16x32_bf16 v[76:79], a[92:95], a[140:143], v[76:79]
v_perm_b32 v29, v19, v18, s86
v_accvgpr_read_b32 v16, a200
v_mfma_f32_16x16x32_bf16 v[68:71], a[92:95], a[132:135], v[68:71]
v_accvgpr_read_b32 v17, a202
v_accvgpr_read_b32 v18, a204
v_mfma_f32_16x16x32_bf16 v[68:71], a[88:91], a[128:131], v[68:71]
s_add_u32 m0, s73, 69632
s_add_u32 s64, s71, 524288
s_waitcnt lgkmcnt(6)
v_mfma_f32_16x16x32_bf16 v[96:99], a[96:99], a[128:131], v[96:99]
ds_read_b64_tr_b16 a[172:173], v12 offset:57344
ds_read_b64_tr_b16 a[174:175], v12 offset:57856
v_mfma_f32_16x16x32_bf16 v[96:99], a[100:103], a[132:135], v[96:99]
buffer_load_dwordx4 v5, s[8:11], s64 offen lds
v_mfma_f32_16x16x32_bf16 v[104:107], a[100:103], a[140:143], v[104:107]
ds_read_b128 a[120:123], v9 offset:14336
v_accvgpr_read_b32 v19, a206
v_mfma_f32_16x16x32_bf16 v[104:107], a[96:99], a[136:139], v[104:107]
v_perm_b32 v26, v17, v16, s85
v_perm_b32 v27, v19, v18, s85
v_mfma_f32_16x16x32_bf16 v[112:115], a[96:99], a[144:147], v[112:115]
v_perm_b32 v30, v17, v16, s86
v_perm_b32 v31, v19, v18, s86
v_mfma_f32_16x16x32_bf16 v[112:115], a[100:103], a[148:151], v[112:115]
ds_read_b64_tr_b16 a[176:177], v13 offset:49152
ds_read_b64_tr_b16 a[178:179], v13 offset:49664
v_mfma_f32_16x16x32_bf16 v[120:123], a[100:103], a[156:159], v[120:123]
v_accvgpr_read_b32 v16, a208
v_accvgpr_read_b32 v17, a209
v_mfma_f32_16x16x32_bf16 v[120:123], a[96:99], a[152:155], v[120:123]
v_accvgpr_read_b32 v18, a210
v_accvgpr_read_b32 v19, a211
v_mfma_f32_16x16x32_bf16 v[124:127], a[104:107], a[152:155], v[124:127]
buffer_load_dwordx4 v6, s[8:11], s64 offen offset:1024 lds
v_mfma_f32_16x16x32_bf16 v[124:127], a[108:111], a[156:159], v[124:127]
ds_read_b128 a[124:127], v10 offset:14336
v_or_b32 v24, v24, v16
v_mfma_f32_16x16x32_bf16 v[116:119], a[108:111], a[148:151], v[116:119]
v_add_u32 v9, 32768, v9
v_add_u32 v10, 32768, v10
v_mfma_f32_16x16x32_bf16 v[116:119], a[104:107], a[144:147], v[116:119]
v_or_b32 v25, v25, v17
v_or_b32 v26, v26, v18
v_mfma_f32_16x16x32_bf16 v[108:111], a[104:107], a[136:139], v[108:111]
ds_read_b64_tr_b16 a[180:181], v13 offset:57344
ds_read_b64_tr_b16 a[182:183], v13 offset:57856
v_mfma_f32_16x16x32_bf16 v[108:111], a[108:111], a[140:143], v[108:111]
s_add_u32 m0, s73, 71680
s_add_u32 s64, s71, 540672
v_or_b32 v27, v27, v19
v_mfma_f32_16x16x32_bf16 v[100:103], a[108:111], a[132:135], v[100:103]
s_waitcnt lgkmcnt(2)
v_mfma_f32_16x16x32_bf16 v[100:103], a[104:107], a[128:131], v[100:103]
buffer_load_dwordx4 v5, s[8:11], s64 offen lds
v_mfma_f32_16x16x32_bf16 v[128:131], a[112:115], a[128:131], v[128:131]
ds_read_b64_tr_b16 a[184:185], v14 offset:49152
ds_read_b64_tr_b16 a[186:187], v14 offset:49664
v_mfma_f32_16x16x32_bf16 v[128:131], a[116:119], a[132:135], v[128:131]
buffer_store_dwordx4 v[24:27], v15, s[24:27], s82 offen offset:0 sc1
v_mfma_f32_16x16x32_bf16 v[136:139], a[116:119], a[140:143], v[136:139]
ds_read_b64_tr_b16 a[188:189], v14 offset:57344
ds_read_b64_tr_b16 a[190:191], v14 offset:57856
v_mfma_f32_16x16x32_bf16 v[136:139], a[112:115], a[136:139], v[136:139]
v_mfma_f32_16x16x32_bf16 v[144:147], a[112:115], a[144:147], v[144:147]
v_mfma_f32_16x16x32_bf16 v[144:147], a[116:119], a[148:151], v[144:147]
buffer_store_dwordx4 v[28:31], v15, s[24:27], s82 offen offset:1024 sc1
v_mfma_f32_16x16x32_bf16 v[152:155], a[116:119], a[156:159], v[152:155]
buffer_load_dwordx4 v6, s[8:11], s64 offen offset:1024 lds
v_mfma_f32_16x16x32_bf16 v[152:155], a[112:115], a[152:155], v[152:155]
v_accvgpr_read_b32 v16, a193
v_accvgpr_read_b32 v17, a195
v_mfma_f32_16x16x32_bf16 v[156:159], a[120:123], a[152:155], v[156:159]
v_accvgpr_read_b32 v18, a197
v_accvgpr_read_b32 v19, a199
v_mfma_f32_16x16x32_bf16 v[156:159], a[124:127], a[156:159], v[156:159]
v_perm_b32 v24, v17, v16, s85
v_perm_b32 v25, v19, v18, s85
v_mfma_f32_16x16x32_bf16 v[148:151], a[124:127], a[148:151], v[148:151]
v_perm_b32 v28, v17, v16, s86
v_perm_b32 v29, v19, v18, s86
v_mfma_f32_16x16x32_bf16 v[148:151], a[120:123], a[144:147], v[148:151]
v_accvgpr_read_b32 v16, a201
v_accvgpr_read_b32 v17, a203
v_mfma_f32_16x16x32_bf16 v[140:143], a[120:123], a[136:139], v[140:143]
v_accvgpr_read_b32 v18, a205
v_accvgpr_read_b32 v19, a207
v_mfma_f32_16x16x32_bf16 v[140:143], a[124:127], a[140:143], v[140:143]
v_perm_b32 v26, v17, v16, s85
v_perm_b32 v27, v19, v18, s85
v_mfma_f32_16x16x32_bf16 v[132:135], a[124:127], a[132:135], v[132:135]
v_perm_b32 v30, v17, v16, s86
v_perm_b32 v31, v19, v18, s86
v_mfma_f32_16x16x32_bf16 v[132:135], a[120:123], a[128:131], v[132:135]
s_waitcnt lgkmcnt(0)
v_cmp_gt_u32 s[96:97], 12, v2
v_mfma_f32_16x16x32_bf16 v[160:163], a[160:163], a[64:67], v[160:163]
s_waitcnt vmcnt(18)
v_mfma_f32_16x16x32_bf16 v[160:163], a[164:167], a[68:71], v[160:163]
s_barrier
v_mfma_f32_16x16x32_bf16 v[164:167], a[172:175], a[68:71], v[164:167]
ds_read_b64_tr_b16 a[128:129], v11 offset:0
ds_read_b64_tr_b16 a[130:131], v11 offset:512
v_mfma_f32_16x16x32_bf16 v[164:167], a[168:171], a[64:67], v[164:167]
s_add_u32 m0, s77, 49152
s_add_u32 s64, s76, 0
v_cndmask_b32 v24, 0, v24, s[96:97]
v_mfma_f32_16x16x32_bf16 v[168:171], a[176:179], a[64:67], v[168:171]
buffer_load_dwordx4 v7, s[16:19], s64 offen lds
v_mfma_f32_16x16x32_bf16 v[168:171], a[180:183], a[68:71], v[168:171]
v_cndmask_b32 v25, 0, v25, s[96:97]
v_cndmask_b32 v26, 0, v26, s[96:97]
v_mfma_f32_16x16x32_bf16 v[172:175], a[188:191], a[68:71], v[172:175]
v_cndmask_b32 v27, 0, v27, s[96:97]
v_cndmask_b32 v28, 0, v28, s[96:97]
v_mfma_f32_16x16x32_bf16 v[172:175], a[184:187], a[64:67], v[172:175]
ds_read_b128 a[64:67], v9 offset:0
v_cndmask_b32 v29, 0, v29, s[96:97]
v_mfma_f32_16x16x32_bf16 v[188:191], a[184:187], a[72:75], v[188:191]
ds_read_b64_tr_b16 a[132:133], v11 offset:8192
ds_read_b64_tr_b16 a[134:135], v11 offset:8704
v_mfma_f32_16x16x32_bf16 v[188:191], a[188:191], a[76:79], v[188:191]
v_cndmask_b32 v30, 0, v30, s[96:97]
v_cndmask_b32 v31, 0, v31, s[96:97]
v_mfma_f32_16x16x32_bf16 v[184:187], a[180:183], a[76:79], v[184:187]
buffer_store_dwordx4 v[24:27], v15, s[24:27], s82 offen offset:2048 sc1
v_mfma_f32_16x16x32_bf16 v[184:187], a[176:179], a[72:75], v[184:187]
buffer_load_dwordx4 v8, s[16:19], s64 offen offset:1024 lds
v_mfma_f32_16x16x32_bf16 v[180:183], a[168:171], a[72:75], v[180:183]
ds_read_b128 a[68:71], v10 offset:0
v_mfma_f32_16x16x32_bf16 v[180:183], a[172:175], a[76:79], v[180:183]
v_mfma_f32_16x16x32_bf16 v[176:179], a[164:167], a[76:79], v[176:179]
buffer_store_dwordx4 v[28:31], v15, s[24:27], s82 offen offset:3072 sc1
v_mfma_f32_16x16x32_bf16 v[176:179], a[160:163], a[72:75], v[176:179]
s_lshl_b32 s52, s7, 4
ds_read_b64_tr_b16 a[136:137], v12 offset:0
ds_read_b64_tr_b16 a[138:139], v12 offset:512
v_mfma_f32_16x16x32_bf16 v[192:195], a[160:163], a[80:83], v[192:195]
s_add_u32 m0, s77, 51200
s_add_u32 s64, s76, 131072
v_and_b32 v22, 3, v1
v_mfma_f32_16x16x32_bf16 v[192:195], a[164:167], a[84:87], v[192:195]
v_lshl_add_u32 v22, v22, 2, s52
v_mfma_f32_16x16x32_bf16 v[196:199], a[172:175], a[84:87], v[196:199]
buffer_load_dwordx4 v7, s[16:19], s64 offen lds
v_mfma_f32_16x16x32_bf16 v[196:199], a[168:171], a[80:83], v[196:199]
ds_read_b128 a[72:75], v9 offset:2048
v_mfma_f32_16x16x32_bf16 v[200:203], a[176:179], a[80:83], v[200:203]
buffer_load_dword v23, v22, s[40:43], 0 offen sc1
v_mfma_f32_16x16x32_bf16 v[200:203], a[180:183], a[84:87], v[200:203]
ds_read_b64_tr_b16 a[140:141], v12 offset:8192
ds_read_b64_tr_b16 a[142:143], v12 offset:8704
v_mfma_f32_16x16x32_bf16 v[204:207], a[188:191], a[84:87], v[204:207]
v_mfma_f32_16x16x32_bf16 v[204:207], a[184:187], a[80:83], v[204:207]
v_mfma_f32_16x16x32_bf16 v[220:223], a[184:187], a[88:91], v[220:223]
ds_read_b128 a[76:79], v10 offset:2048
v_mfma_f32_16x16x32_bf16 v[220:223], a[188:191], a[92:95], v[220:223]
buffer_load_dwordx4 v8, s[16:19], s64 offen offset:1024 lds
v_mfma_f32_16x16x32_bf16 v[216:219], a[180:183], a[92:95], v[216:219]
s_xor_b32 s71, s70, 768
s_add_u32 s71, s68, s71
v_mfma_f32_16x16x32_bf16 v[216:219], a[176:179], a[88:91], v[216:219]
v_mfma_f32_16x16x32_bf16 v[212:215], a[168:171], a[88:91], v[212:215]
ds_read_b64_tr_b16 a[144:145], v13 offset:0
ds_read_b64_tr_b16 a[146:147], v13 offset:512
v_mfma_f32_16x16x32_bf16 v[212:215], a[172:175], a[92:95], v[212:215]
v_mfma_f32_16x16x32_bf16 v[208:211], a[164:167], a[92:95], v[208:211]
v_mfma_f32_16x16x32_bf16 v[208:211], a[160:163], a[88:91], v[208:211]
s_add_u32 m0, s73, 0
s_add_u32 s64, s71, 0
ds_read_b128 a[80:83], v9 offset:4096
v_mfma_f32_16x16x32_bf16 v[224:227], a[160:163], a[96:99], v[224:227]
v_mfma_f32_16x16x32_bf16 v[224:227], a[164:167], a[100:103], v[224:227]
buffer_load_dwordx4 v5, s[8:11], s64 offen lds
v_mfma_f32_16x16x32_bf16 v[228:231], a[172:175], a[100:103], v[228:231]
ds_read_b64_tr_b16 a[148:149], v13 offset:8192
ds_read_b64_tr_b16 a[150:151], v13 offset:8704
v_mfma_f32_16x16x32_bf16 v[228:231], a[168:171], a[96:99], v[228:231]
v_mfma_f32_16x16x32_bf16 v[232:235], a[176:179], a[96:99], v[232:235]
v_mfma_f32_16x16x32_bf16 v[232:235], a[180:183], a[100:103], v[232:235]
ds_read_b128 a[84:87], v10 offset:4096
v_mfma_f32_16x16x32_bf16 v[236:239], a[188:191], a[100:103], v[236:239]
v_mfma_f32_16x16x32_bf16 v[236:239], a[184:187], a[96:99], v[236:239]
v_mfma_f32_16x16x32_bf16 v[252:255], a[184:187], a[104:107], v[252:255]
buffer_load_dwordx4 v6, s[8:11], s64 offen offset:1024 lds
v_mfma_f32_16x16x32_bf16 v[252:255], a[188:191], a[108:111], v[252:255]
ds_read_b64_tr_b16 a[152:153], v14 offset:0
ds_read_b64_tr_b16 a[154:155], v14 offset:512
v_mfma_f32_16x16x32_bf16 v[248:251], a[180:183], a[108:111], v[248:251]
v_mfma_f32_16x16x32_bf16 v[248:251], a[176:179], a[104:107], v[248:251]
v_mfma_f32_16x16x32_bf16 v[244:247], a[168:171], a[104:107], v[244:247]
ds_read_b128 a[88:91], v9 offset:6144
v_mfma_f32_16x16x32_bf16 v[244:247], a[172:175], a[108:111], v[244:247]
s_add_u32 m0, s73, 2048
s_add_u32 s64, s71, 16384
v_mfma_f32_16x16x32_bf16 v[240:243], a[164:167], a[108:111], v[240:243]
v_mfma_f32_16x16x32_bf16 v[240:243], a[160:163], a[104:107], v[240:243]
buffer_load_dwordx4 v5, s[8:11], s64 offen lds
v_mfma_f32_16x16x32_bf16 a[0:3], a[160:163], a[112:115], a[0:3]
ds_read_b64_tr_b16 a[156:157], v14 offset:8192
ds_read_b64_tr_b16 a[158:159], v14 offset:8704
v_mfma_f32_16x16x32_bf16 a[0:3], a[164:167], a[116:119], a[0:3]
v_mfma_f32_16x16x32_bf16 a[4:7], a[172:175], a[116:119], a[4:7]
ds_read_b128 a[92:95], v10 offset:6144
v_mfma_f32_16x16x32_bf16 a[4:7], a[168:171], a[112:115], a[4:7]
v_mfma_f32_16x16x32_bf16 a[8:11], a[176:179], a[112:115], a[8:11]
v_mfma_f32_16x16x32_bf16 a[8:11], a[180:183], a[116:119], a[8:11]
v_mfma_f32_16x16x32_bf16 a[12:15], a[188:191], a[116:119], a[12:15]
buffer_load_dwordx4 v6, s[8:11], s64 offen offset:1024 lds
v_mfma_f32_16x16x32_bf16 a[12:15], a[184:187], a[112:115], a[12:15]
v_mfma_f32_16x16x32_bf16 a[28:31], a[184:187], a[120:123], a[28:31]
v_mfma_f32_16x16x32_bf16 a[28:31], a[188:191], a[124:127], a[28:31]
v_mfma_f32_16x16x32_bf16 a[24:27], a[180:183], a[124:127], a[24:27]
v_mfma_f32_16x16x32_bf16 a[24:27], a[176:179], a[120:123], a[24:27]
v_mfma_f32_16x16x32_bf16 a[20:23], a[168:171], a[120:123], a[20:23]
v_mfma_f32_16x16x32_bf16 a[20:23], a[172:175], a[124:127], a[20:23]
v_mfma_f32_16x16x32_bf16 a[16:19], a[164:167], a[124:127], a[16:19]
v_mfma_f32_16x16x32_bf16 a[16:19], a[160:163], a[120:123], a[16:19]
s_waitcnt lgkmcnt(0)
v_mfma_f32_16x16x32_bf16 v[32:35], a[64:67], a[128:131], v[32:35]
s_waitcnt vmcnt(25)
v_mfma_f32_16x16x32_bf16 v[32:35], a[68:71], a[132:135], v[32:35]
s_barrier
v_mfma_f32_16x16x32_bf16 v[40:43], a[68:71], a[140:143], v[40:43]
ds_read_b128 a[96:99], v9 offset:8192
v_mfma_f32_16x16x32_bf16 v[40:43], a[64:67], a[136:139], v[40:43]
s_xor_b32 s76, s75, 3145728
s_add_u32 s76, s74, s76
v_mfma_f32_16x16x32_bf16 v[48:51], a[64:67], a[144:147], v[48:51]
s_add_u32 m0, s77, 0
s_add_u32 s64, s76, 0
v_mfma_f32_16x16x32_bf16 v[48:51], a[68:71], a[148:151], v[48:51]
buffer_load_dwordx4 v7, s[56:59], s64 offen lds
v_mfma_f32_16x16x32_bf16 v[56:59], a[68:71], a[156:159], v[56:59]
ds_read_b128 a[100:103], v10 offset:8192
v_mfma_f32_16x16x32_bf16 v[56:59], a[64:67], a[152:155], v[56:59]
v_mfma_f32_16x16x32_bf16 v[60:63], a[72:75], a[152:155], v[60:63]
ds_read_b128 a[104:107], v9 offset:10240
v_mfma_f32_16x16x32_bf16 v[60:63], a[76:79], a[156:159], v[60:63]
v_mfma_f32_16x16x32_bf16 v[52:55], a[76:79], a[148:151], v[52:55]
v_mfma_f32_16x16x32_bf16 v[52:55], a[72:75], a[144:147], v[52:55]
buffer_load_dwordx4 v8, s[56:59], s64 offen offset:1024 lds
v_mfma_f32_16x16x32_bf16 v[44:47], a[72:75], a[136:139], v[44:47]
ds_read_b64_tr_b16 a[160:161], v11 offset:16384
ds_read_b64_tr_b16 a[162:163], v11 offset:16896
v_mfma_f32_16x16x32_bf16 v[44:47], a[76:79], a[140:143], v[44:47]
v_mfma_f32_16x16x32_bf16 v[36:39], a[76:79], a[132:135], v[36:39]
v_mfma_f32_16x16x32_bf16 v[36:39], a[72:75], a[128:131], v[36:39]
ds_read_b128 a[108:111], v10 offset:10240
v_mfma_f32_16x16x32_bf16 v[64:67], a[80:83], a[128:131], v[64:67]
s_add_u32 m0, s77, 2048
s_add_u32 s64, s76, 131072
v_mfma_f32_16x16x32_bf16 v[64:67], a[84:87], a[132:135], v[64:67]
v_mfma_f32_16x16x32_bf16 v[72:75], a[84:87], a[140:143], v[72:75]
buffer_load_dwordx4 v7, s[56:59], s64 offen lds
v_mfma_f32_16x16x32_bf16 v[72:75], a[80:83], a[136:139], v[72:75]
ds_read_b64_tr_b16 a[164:165], v11 offset:24576
ds_read_b64_tr_b16 a[166:167], v11 offset:25088
v_mfma_f32_16x16x32_bf16 v[80:83], a[80:83], a[144:147], v[80:83]
v_mfma_f32_16x16x32_bf16 v[80:83], a[84:87], a[148:151], v[80:83]
ds_read_b128 a[112:115], v9 offset:12288
v_mfma_f32_16x16x32_bf16 v[88:91], a[84:87], a[156:159], v[88:91]
v_mfma_f32_16x16x32_bf16 v[88:91], a[80:83], a[152:155], v[88:91]
s_waitcnt vmcnt(8)
v_mfma_f32_16x16x32_bf16 v[92:95], a[88:91], a[152:155], v[92:95]
ds_read_b64_tr_b16 a[168:169], v12 offset:16384
ds_read_b64_tr_b16 a[170:171], v12 offset:16896
v_mfma_f32_16x16x32_bf16 v[92:95], a[92:95], a[156:159], v[92:95]
buffer_load_dwordx4 v8, s[56:59], s64 offen offset:1024 lds
v_mfma_f32_16x16x32_bf16 v[84:87], a[92:95], a[148:151], v[84:87]
v_cmp_gt_u32 vcc, 1, v23
v_mfma_f32_16x16x32_bf16 v[84:87], a[88:91], a[144:147], v[84:87]
v_mfma_f32_16x16x32_bf16 v[76:79], a[88:91], a[136:139], v[76:79]
ds_read_b128 a[116:119], v10 offset:12288
v_mfma_f32_16x16x32_bf16 v[76:79], a[92:95], a[140:143], v[76:79]
v_mfma_f32_16x16x32_bf16 v[68:71], a[92:95], a[132:135], v[68:71]
v_mfma_f32_16x16x32_bf16 v[68:71], a[88:91], a[128:131], v[68:71]
s_add_u32 m0, s73, 4096
s_add_u32 s64, s71, 524288
s_waitcnt lgkmcnt(6)
v_mfma_f32_16x16x32_bf16 v[96:99], a[96:99], a[128:131], v[96:99]
ds_read_b64_tr_b16 a[172:173], v12 offset:24576
ds_read_b64_tr_b16 a[174:175], v12 offset:25088
v_mfma_f32_16x16x32_bf16 v[96:99], a[100:103], a[132:135], v[96:99]
buffer_load_dwordx4 v5, s[8:11], s64 offen lds
v_mfma_f32_16x16x32_bf16 v[104:107], a[100:103], a[140:143], v[104:107]
ds_read_b128 a[120:123], v9 offset:14336
v_mfma_f32_16x16x32_bf16 v[104:107], a[96:99], a[136:139], v[104:107]
s_cbranch_vccnz CK_Z
CK_Z_R:
v_mfma_f32_16x16x32_bf16 v[112:115], a[96:99], a[144:147], v[112:115]
buffer_atomic_add v1, v0, s[24:27], s84 offen offset:0 sc1
v_mfma_f32_16x16x32_bf16 v[112:115], a[100:103], a[148:151], v[112:115]
ds_read_b64_tr_b16 a[176:177], v13 offset:16384
ds_read_b64_tr_b16 a[178:179], v13 offset:16896
v_mfma_f32_16x16x32_bf16 v[120:123], a[100:103], a[156:159], v[120:123]
v_mov_b32 v29, 0
v_mfma_f32_16x16x32_bf16 v[120:123], a[96:99], a[152:155], v[120:123]
v_mfma_f32_16x16x32_bf16 v[124:127], a[104:107], a[152:155], v[124:127]
buffer_load_dwordx4 v6, s[8:11], s64 offen offset:1024 lds
v_mfma_f32_16x16x32_bf16 v[124:127], a[108:111], a[156:159], v[124:127]
ds_read_b128 a[124:127], v10 offset:14336
v_mfma_f32_16x16x32_bf16 v[116:119], a[108:111], a[148:151], v[116:119]
v_add_u32 v9, 32768, v9
v_add_u32 v10, 32768, v10
v_mfma_f32_16x16x32_bf16 v[116:119], a[104:107], a[144:147], v[116:119]
v_mfma_f32_16x16x32_bf16 v[108:111], a[104:107], a[136:139], v[108:111]
ds_read_b64_tr_b16 a[180:181], v13 offset:24576
ds_read_b64_tr_b16 a[182:183], v13 offset:25088
v_mfma_f32_16x16x32_bf16 v[108:111], a[108:111], a[140:143], v[108:111]
s_add_u32 m0, s73, 6144
s_add_u32 s64, s71, 540672
v_mfma_f32_16x16x32_bf16 v[100:103], a[108:111], a[132:135], v[100:103]
s_waitcnt lgkmcnt(2)
v_mfma_f32_16x16x32_bf16 v[100:103], a[104:107], a[128:131], v[100:103]
buffer_load_dwordx4 v5, s[8:11], s64 offen lds
v_mfma_f32_16x16x32_bf16 v[128:131], a[112:115], a[128:131], v[128:131]
ds_read_b64_tr_b16 a[184:185], v14 offset:16384
ds_read_b64_tr_b16 a[186:187], v14 offset:16896
v_mfma_f32_16x16x32_bf16 v[128:131], a[116:119], a[132:135], v[128:131]
v_mfma_f32_16x16x32_bf16 v[136:139], a[116:119], a[140:143], v[136:139]
ds_read_b64_tr_b16 a[188:189], v14 offset:24576
ds_read_b64_tr_b16 a[190:191], v14 offset:25088
v_mfma_f32_16x16x32_bf16 v[136:139], a[112:115], a[136:139], v[136:139]
v_mfma_f32_16x16x32_bf16 v[144:147], a[112:115], a[144:147], v[144:147]
v_mfma_f32_16x16x32_bf16 v[144:147], a[116:119], a[148:151], v[144:147]
v_mfma_f32_16x16x32_bf16 v[152:155], a[116:119], a[156:159], v[152:155]
buffer_load_dwordx4 v6, s[8:11], s64 offen offset:1024 lds
v_mfma_f32_16x16x32_bf16 v[152:155], a[112:115], a[152:155], v[152:155]
v_mfma_f32_16x16x32_bf16 v[156:159], a[120:123], a[152:155], v[156:159]
v_mfma_f32_16x16x32_bf16 v[156:159], a[124:127], a[156:159], v[156:159]
v_mfma_f32_16x16x32_bf16 v[148:151], a[124:127], a[148:151], v[148:151]
v_mfma_f32_16x16x32_bf16 v[148:151], a[120:123], a[144:147], v[148:151]
v_mfma_f32_16x16x32_bf16 v[140:143], a[120:123], a[136:139], v[140:143]
v_mfma_f32_16x16x32_bf16 v[140:143], a[124:127], a[140:143], v[140:143]
v_mfma_f32_16x16x32_bf16 v[132:135], a[124:127], a[132:135], v[132:135]
v_mfma_f32_16x16x32_bf16 v[132:135], a[120:123], a[128:131], v[132:135]
s_waitcnt lgkmcnt(0)
v_mfma_f32_16x16x32_bf16 v[160:163], a[160:163], a[64:67], v[160:163]
s_waitcnt vmcnt(20)
v_mfma_f32_16x16x32_bf16 v[160:163], a[164:167], a[68:71], v[160:163]
s_barrier
v_mfma_f32_16x16x32_bf16 v[164:167], a[172:175], a[68:71], v[164:167]
ds_read_b64_tr_b16 a[128:129], v11 offset:32768
ds_read_b64_tr_b16 a[130:131], v11 offset:33280
v_mfma_f32_16x16x32_bf16 v[164:167], a[168:171], a[64:67], v[164:167]
s_add_u32 m0, s77, 16384
s_add_u32 s64, s76, 0
v_mfma_f32_16x16x32_bf16 v[168:171], a[176:179], a[64:67], v[168:171]
buffer_load_dwordx4 v7, s[16:19], s64 offen lds
v_mfma_f32_16x16x32_bf16 v[168:171], a[180:183], a[68:71], v[168:171]
buffer_load_dword a253, v20, s[12:15], s53 offen
v_mfma_f32_16x16x32_bf16 v[172:175], a[188:191], a[68:71], v[172:175]
v_mfma_f32_16x16x32_bf16 v[172:175], a[184:187], a[64:67], v[172:175]
ds_read_b128 a[64:67], v9 offset:0
v_mfma_f32_16x16x32_bf16 v[188:191], a[184:187], a[72:75], v[188:191]
ds_read_b64_tr_b16 a[132:133], v11 offset:40960
ds_read_b64_tr_b16 a[134:135], v11 offset:41472
v_mfma_f32_16x16x32_bf16 v[188:191], a[188:191], a[76:79], v[188:191]
v_mfma_f32_16x16x32_bf16 v[184:187], a[180:183], a[76:79], v[184:187]
v_mfma_f32_16x16x32_bf16 v[184:187], a[176:179], a[72:75], v[184:187]
buffer_load_dwordx4 v8, s[16:19], s64 offen offset:1024 lds
v_mfma_f32_16x16x32_bf16 v[180:183], a[168:171], a[72:75], v[180:183]
ds_read_b128 a[68:71], v10 offset:0
v_mfma_f32_16x16x32_bf16 v[180:183], a[172:175], a[76:79], v[180:183]
v_mfma_f32_16x16x32_bf16 v[176:179], a[164:167], a[76:79], v[176:179]
v_mfma_f32_16x16x32_bf16 v[176:179], a[160:163], a[72:75], v[176:179]
ds_read_b64_tr_b16 a[136:137], v12 offset:32768
ds_read_b64_tr_b16 a[138:139], v12 offset:33280
v_mfma_f32_16x16x32_bf16 v[192:195], a[160:163], a[80:83], v[192:195]
s_add_u32 m0, s77, 18432
s_add_u32 s64, s76, 131072
v_mfma_f32_16x16x32_bf16 v[192:195], a[164:167], a[84:87], v[192:195]
v_mfma_f32_16x16x32_bf16 v[196:199], a[172:175], a[84:87], v[196:199]
buffer_load_dwordx4 v7, s[16:19], s64 offen lds
v_mfma_f32_16x16x32_bf16 v[196:199], a[168:171], a[80:83], v[196:199]
ds_read_b128 a[72:75], v9 offset:2048
v_mfma_f32_16x16x32_bf16 v[200:203], a[176:179], a[80:83], v[200:203]
v_mfma_f32_16x16x32_bf16 v[200:203], a[180:183], a[84:87], v[200:203]
ds_read_b64_tr_b16 a[140:141], v12 offset:40960
ds_read_b64_tr_b16 a[142:143], v12 offset:41472
v_mfma_f32_16x16x32_bf16 v[204:207], a[188:191], a[84:87], v[204:207]
L_PAD2:
s_cbranch_execz L_PAD6
v_mfma_f32_16x16x32_bf16 v[204:207], a[184:187], a[80:83], v[204:207]
v_mfma_f32_16x16x32_bf16 v[220:223], a[184:187], a[88:91], v[220:223]
ds_read_b128 a[76:79], v10 offset:2048
v_mfma_f32_16x16x32_bf16 v[220:223], a[188:191], a[92:95], v[220:223]
buffer_load_dwordx4 v8, s[16:19], s64 offen offset:1024 lds
v_mfma_f32_16x16x32_bf16 v[216:219], a[180:183], a[92:95], v[216:219]
s_xor_b32 s71, s70, 896
s_add_u32 s71, s68, s71
v_mfma_f32_16x16x32_bf16 v[216:219], a[176:179], a[88:91], v[216:219]
v_mfma_f32_16x16x32_bf16 v[212:215], a[168:171], a[88:91], v[212:215]
ds_read_b64_tr_b16 a[144:145], v13 offset:32768
ds_read_b64_tr_b16 a[146:147], v13 offset:33280
v_mfma_f32_16x16x32_bf16 v[212:215], a[172:175], a[92:95], v[212:215]
v_mfma_f32_16x16x32_bf16 v[208:211], a[164:167], a[92:95], v[208:211]
v_mfma_f32_16x16x32_bf16 v[208:211], a[160:163], a[88:91], v[208:211]
s_add_u32 m0, s73, 32768
s_add_u32 s64, s71, 0
ds_read_b128 a[80:83], v9 offset:4096
v_mfma_f32_16x16x32_bf16 v[224:227], a[160:163], a[96:99], v[224:227]
v_mfma_f32_16x16x32_bf16 v[224:227], a[164:167], a[100:103], v[224:227]
buffer_load_dwordx4 v5, s[8:11], s64 offen lds
v_mfma_f32_16x16x32_bf16 v[228:231], a[172:175], a[100:103], v[228:231]
ds_read_b64_tr_b16 a[148:149], v13 offset:40960
ds_read_b64_tr_b16 a[150:151], v13 offset:41472
v_mfma_f32_16x16x32_bf16 v[228:231], a[168:171], a[96:99], v[228:231]
v_mfma_f32_16x16x32_bf16 v[232:235], a[176:179], a[96:99], v[232:235]
v_mfma_f32_16x16x32_bf16 v[232:235], a[180:183], a[100:103], v[232:235]
ds_read_b128 a[84:87], v10 offset:4096
v_mfma_f32_16x16x32_bf16 v[236:239], a[188:191], a[100:103], v[236:239]
v_mfma_f32_16x16x32_bf16 v[236:239], a[184:187], a[96:99], v[236:239]
v_mfma_f32_16x16x32_bf16 v[252:255], a[184:187], a[104:107], v[252:255]
buffer_load_dwordx4 v6, s[8:11], s64 offen offset:1024 lds
v_mfma_f32_16x16x32_bf16 v[252:255], a[188:191], a[108:111], v[252:255]
ds_read_b64_tr_b16 a[152:153], v14 offset:32768
ds_read_b64_tr_b16 a[154:155], v14 offset:33280
v_mfma_f32_16x16x32_bf16 v[248:251], a[180:183], a[108:111], v[248:251]
v_mfma_f32_16x16x32_bf16 v[248:251], a[176:179], a[104:107], v[248:251]
v_mfma_f32_16x16x32_bf16 v[244:247], a[168:171], a[104:107], v[244:247]
ds_read_b128 a[88:91], v9 offset:6144
v_mfma_f32_16x16x32_bf16 v[244:247], a[172:175], a[108:111], v[244:247]
s_add_u32 m0, s73, 34816
s_add_u32 s64, s71, 16384
v_mfma_f32_16x16x32_bf16 v[240:243], a[164:167], a[108:111], v[240:243]
v_mfma_f32_16x16x32_bf16 v[240:243], a[160:163], a[104:107], v[240:243]
buffer_load_dwordx4 v5, s[8:11], s64 offen lds
v_mfma_f32_16x16x32_bf16 a[0:3], a[160:163], a[112:115], a[0:3]
ds_read_b64_tr_b16 a[156:157], v14 offset:40960
ds_read_b64_tr_b16 a[158:159], v14 offset:41472
v_mfma_f32_16x16x32_bf16 a[0:3], a[164:167], a[116:119], a[0:3]
v_mfma_f32_16x16x32_bf16 a[4:7], a[172:175], a[116:119], a[4:7]
ds_read_b128 a[92:95], v10 offset:6144
v_mfma_f32_16x16x32_bf16 a[4:7], a[168:171], a[112:115], a[4:7]
v_mfma_f32_16x16x32_bf16 a[8:11], a[176:179], a[112:115], a[8:11]
v_mfma_f32_16x16x32_bf16 a[8:11], a[180:183], a[116:119], a[8:11]
v_mfma_f32_16x16x32_bf16 a[12:15], a[188:191], a[116:119], a[12:15]
buffer_load_dwordx4 v6, s[8:11], s64 offen offset:1024 lds
v_mfma_f32_16x16x32_bf16 a[12:15], a[184:187], a[112:115], a[12:15]
v_mfma_f32_16x16x32_bf16 a[28:31], a[184:187], a[120:123], a[28:31]
v_mfma_f32_16x16x32_bf16 a[28:31], a[188:191], a[124:127], a[28:31]
v_mfma_f32_16x16x32_bf16 a[24:27], a[180:183], a[124:127], a[24:27]
v_mfma_f32_16x16x32_bf16 a[24:27], a[176:179], a[120:123], a[24:27]
v_mfma_f32_16x16x32_bf16 a[20:23], a[168:171], a[120:123], a[20:23]
v_mfma_f32_16x16x32_bf16 a[20:23], a[172:175], a[124:127], a[20:23]
v_mfma_f32_16x16x32_bf16 a[16:19], a[164:167], a[124:127], a[16:19]
v_mfma_f32_16x16x32_bf16 a[16:19], a[160:163], a[120:123], a[16:19]
s_waitcnt lgkmcnt(0)
v_mfma_f32_16x16x32_bf16 v[32:35], a[64:67], a[128:131], v[32:35]
s_waitcnt vmcnt(22)
v_mfma_f32_16x16x32_bf16 v[32:35], a[68:71], a[132:135], v[32:35]
s_barrier
v_mfma_f32_16x16x32_bf16 v[40:43], a[68:71], a[140:143], v[40:43]
ds_read_b128 a[96:99], v9 offset:8192
v_mfma_f32_16x16x32_bf16 v[40:43], a[64:67], a[136:139], v[40:43]
s_xor_b32 s76, s75, 3670016
s_add_u32 s76, s74, s76
v_mfma_f32_16x16x32_bf16 v[48:51], a[64:67], a[144:147], v[48:51]
s_add_u32 m0, s77, 32768
s_add_u32 s64, s76, 0
v_mfma_f32_16x16x32_bf16 v[48:51], a[68:71], a[148:151], v[48:51]
buffer_load_dwordx4 v7, s[56:59], s64 offen lds
v_mfma_f32_16x16x32_bf16 v[56:59], a[68:71], a[156:159], v[56:59]
ds_read_b128 a[100:103], v10 offset:8192
v_mfma_f32_16x16x32_bf16 v[56:59], a[64:67], a[152:155], v[56:59]
buffer_load_dword a252, v21, s[20:23], s55 offen
v_mfma_f32_16x16x32_bf16 v[60:63], a[72:75], a[152:155], v[60:63]
s_add_u32 s55, s55, 24576
s_mul_i32 s54, s54, 896
ds_read_b128 a[104:107], v9 offset:10240
v_mfma_f32_16x16x32_bf16 v[60:63], a[76:79], a[156:159], v[60:63]
v_mfma_f32_16x16x32_bf16 v[52:55], a[76:79], a[148:151], v[52:55]
v_mfma_f32_16x16x32_bf16 v[52:55], a[72:75], a[144:147], v[52:55]
buffer_load_dwordx4 v8, s[56:59], s64 offen offset:1024 lds
v_mfma_f32_16x16x32_bf16 v[44:47], a[72:75], a[136:139], v[44:47]
ds_read_b64_tr_b16 a[160:161], v11 offset:49152
ds_read_b64_tr_b16 a[162:163], v11 offset:49664
v_mfma_f32_16x16x32_bf16 v[44:47], a[76:79], a[140:143], v[44:47]
v_mfma_f32_16x16x32_bf16 v[36:39], a[76:79], a[132:135], v[36:39]
v_mfma_f32_16x16x32_bf16 v[36:39], a[72:75], a[128:131], v[36:39]
ds_read_b128 a[108:111], v10 offset:10240
v_mfma_f32_16x16x32_bf16 v[64:67], a[80:83], a[128:131], v[64:67]
s_add_u32 m0, s77, 34816
s_add_u32 s64, s76, 131072
v_mfma_f32_16x16x32_bf16 v[64:67], a[84:87], a[132:135], v[64:67]
v_mfma_f32_16x16x32_bf16 v[72:75], a[84:87], a[140:143], v[72:75]
buffer_load_dwordx4 v7, s[56:59], s64 offen lds
v_mfma_f32_16x16x32_bf16 v[72:75], a[80:83], a[136:139], v[72:75]
ds_read_b64_tr_b16 a[164:165], v11 offset:57344
ds_read_b64_tr_b16 a[166:167], v11 offset:57856
v_mfma_f32_16x16x32_bf16 v[80:83], a[80:83], a[144:147], v[80:83]
v_mfma_f32_16x16x32_bf16 v[80:83], a[84:87], a[148:151], v[80:83]
ds_read_b128 a[112:115], v9 offset:12288
v_mfma_f32_16x16x32_bf16 v[88:91], a[84:87], a[156:159], v[88:91]
v_mfma_f32_16x16x32_bf16 v[88:91], a[80:83], a[152:155], v[88:91]
v_mfma_f32_16x16x32_bf16 v[92:95], a[88:91], a[152:155], v[92:95]
ds_read_b64_tr_b16 a[168:169], v12 offset:49152
ds_read_b64_tr_b16 a[170:171], v12 offset:49664
v_mfma_f32_16x16x32_bf16 v[92:95], a[92:95], a[156:159], v[92:95]
buffer_load_dwordx4 v8, s[56:59], s64 offen offset:1024 lds
v_mfma_f32_16x16x32_bf16 v[84:87], a[92:95], a[148:151], v[84:87]
v_mfma_f32_16x16x32_bf16 v[84:87], a[88:91], a[144:147], v[84:87]
v_mfma_f32_16x16x32_bf16 v[76:79], a[88:91], a[136:139], v[76:79]
ds_read_b128 a[116:119], v10 offset:12288
v_mfma_f32_16x16x32_bf16 v[76:79], a[92:95], a[140:143], v[76:79]
v_mfma_f32_16x16x32_bf16 v[68:71], a[92:95], a[132:135], v[68:71]
v_mfma_f32_16x16x32_bf16 v[68:71], a[88:91], a[128:131], v[68:71]
s_add_u32 m0, s73, 36864
s_add_u32 s64, s71, 524288
s_waitcnt lgkmcnt(6)
v_mfma_f32_16x16x32_bf16 v[96:99], a[96:99], a[128:131], v[96:99]
ds_read_b64_tr_b16 a[172:173], v12 offset:57344
ds_read_b64_tr_b16 a[174:175], v12 offset:57856
v_mfma_f32_16x16x32_bf16 v[96:99], a[100:103], a[132:135], v[96:99]
buffer_load_dwordx4 v5, s[8:11], s64 offen lds
v_mfma_f32_16x16x32_bf16 v[104:107], a[100:103], a[140:143], v[104:107]
ds_read_b128 a[120:123], v9 offset:14336
v_mfma_f32_16x16x32_bf16 v[104:107], a[96:99], a[136:139], v[104:107]
v_mfma_f32_16x16x32_bf16 v[112:115], a[96:99], a[144:147], v[112:115]
v_mfma_f32_16x16x32_bf16 v[112:115], a[100:103], a[148:151], v[112:115]
ds_read_b64_tr_b16 a[176:177], v13 offset:49152
ds_read_b64_tr_b16 a[178:179], v13 offset:49664
v_mfma_f32_16x16x32_bf16 v[120:123], a[100:103], a[156:159], v[120:123]
v_mfma_f32_16x16x32_bf16 v[120:123], a[96:99], a[152:155], v[120:123]
v_mfma_f32_16x16x32_bf16 v[124:127], a[104:107], a[152:155], v[124:127]
buffer_load_dwordx4 v6, s[8:11], s64 offen offset:1024 lds
v_mfma_f32_16x16x32_bf16 v[124:127], a[108:111], a[156:159], v[124:127]
ds_read_b128 a[124:127], v10 offset:14336
v_mfma_f32_16x16x32_bf16 v[116:119], a[108:111], a[148:151], v[116:119]
v_add_u32 v9, -65536, v9
v_add_u32 v10, -65536, v10
v_mfma_f32_16x16x32_bf16 v[116:119], a[104:107], a[144:147], v[116:119]
buffer_load_dword v30, v29, s[24:27], s89 offen sc1
v_mfma_f32_16x16x32_bf16 v[108:111], a[104:107], a[136:139], v[108:111]
ds_read_b64_tr_b16 a[180:181], v13 offset:57344
ds_read_b64_tr_b16 a[182:183], v13 offset:57856
v_mfma_f32_16x16x32_bf16 v[108:111], a[108:111], a[140:143], v[108:111]
s_add_u32 m0, s73, 38912
s_add_u32 s64, s71, 540672
v_mfma_f32_16x16x32_bf16 v[100:103], a[108:111], a[132:135], v[100:103]
s_waitcnt lgkmcnt(2)
v_mfma_f32_16x16x32_bf16 v[100:103], a[104:107], a[128:131], v[100:103]
buffer_load_dwordx4 v5, s[8:11], s64 offen lds
v_mfma_f32_16x16x32_bf16 v[128:131], a[112:115], a[128:131], v[128:131]
ds_read_b64_tr_b16 a[184:185], v14 offset:49152
ds_read_b64_tr_b16 a[186:187], v14 offset:49664
v_mfma_f32_16x16x32_bf16 v[128:131], a[116:119], a[132:135], v[128:131]
v_mfma_f32_16x16x32_bf16 v[136:139], a[116:119], a[140:143], v[136:139]
ds_read_b64_tr_b16 a[188:189], v14 offset:57344
ds_read_b64_tr_b16 a[190:191], v14 offset:57856
v_mfma_f32_16x16x32_bf16 v[136:139], a[112:115], a[136:139], v[136:139]
v_mfma_f32_16x16x32_bf16 v[144:147], a[112:115], a[144:147], v[144:147]
v_mfma_f32_16x16x32_bf16 v[144:147], a[116:119], a[148:151], v[144:147]
v_mfma_f32_16x16x32_bf16 v[152:155], a[116:119], a[156:159], v[152:155]
buffer_load_dwordx4 v6, s[8:11], s64 offen offset:1024 lds
v_mfma_f32_16x16x32_bf16 v[152:155], a[112:115], a[152:155], v[152:155]
v_mfma_f32_16x16x32_bf16 v[156:159], a[120:123], a[152:155], v[156:159]
v_mfma_f32_16x16x32_bf16 v[156:159], a[124:127], a[156:159], v[156:159]
v_mfma_f32_16x16x32_bf16 v[148:151], a[124:127], a[148:151], v[148:151]
v_mfma_f32_16x16x32_bf16 v[148:151], a[120:123], a[144:147], v[148:151]
v_mfma_f32_16x16x32_bf16 v[140:143], a[120:123], a[136:139], v[140:143]
v_mfma_f32_16x16x32_bf16 v[140:143], a[124:127], a[140:143], v[140:143]
v_mfma_f32_16x16x32_bf16 v[132:135], a[124:127], a[132:135], v[132:135]
v_mfma_f32_16x16x32_bf16 v[132:135], a[120:123], a[128:131], v[132:135]
s_waitcnt lgkmcnt(0)
v_mfma_f32_16x16x32_bf16 v[160:163], a[160:163], a[64:67], v[160:163]
s_waitcnt vmcnt(19)
v_mfma_f32_16x16x32_bf16 v[160:163], a[164:167], a[68:71], v[160:163]
s_barrier
v_mfma_f32_16x16x32_bf16 v[164:167], a[172:175], a[68:71], v[164:167]
ds_read_b64_tr_b16 a[128:129], v11 offset:0
ds_read_b64_tr_b16 a[130:131], v11 offset:512
v_mfma_f32_16x16x32_bf16 v[164:167], a[168:171], a[64:67], v[164:167]
s_add_u32 m0, s77, 49152
s_add_u32 s64, s76, 0
v_mfma_f32_16x16x32_bf16 v[168:171], a[176:179], a[64:67], v[168:171]
buffer_load_dwordx4 v7, s[16:19], s64 offen lds
v_mfma_f32_16x16x32_bf16 v[168:171], a[180:183], a[68:71], v[168:171]
buffer_load_dword a252, v21, s[20:23], s55 offen
v_mfma_f32_16x16x32_bf16 v[172:175], a[188:191], a[68:71], v[172:175]
s_lshr_b32 s55, s2, 1
s_lshl2_add_u32 s55, s55, s3
s_mul_i32 s55, s55, 9216
v_mfma_f32_16x16x32_bf16 v[172:175], a[184:187], a[64:67], v[172:175]
s_and_b32 s53, s2, 1
s_lshl_b32 s53, s53, 9
ds_read_b128 a[64:67], v9 offset:0
v_mfma_f32_16x16x32_bf16 v[188:191], a[184:187], a[72:75], v[188:191]
s_add_u32 s55, s55, s53
ds_read_b64_tr_b16 a[132:133], v11 offset:8192
ds_read_b64_tr_b16 a[134:135], v11 offset:8704
v_mfma_f32_16x16x32_bf16 v[188:191], a[188:191], a[76:79], v[188:191]
v_min_u32 v20, 39, v1
v_and_b32 v21, 7, v20
v_mfma_f32_16x16x32_bf16 v[184:187], a[180:183], a[76:79], v[184:187]
v_mul_u32_u24 v21, 1152, v21
v_lshrrev_b32 v20, 3, v20
v_mfma_f32_16x16x32_bf16 v[184:187], a[176:179], a[72:75], v[184:187]
buffer_load_dwordx4 v8, s[16:19], s64 offen offset:1024 lds
v_mfma_f32_16x16x32_bf16 v[180:183], a[168:171], a[72:75], v[180:183]
ds_read_b128 a[68:71], v10 offset:0
v_lshl_add_u32 v21, v20, 7, v21
v_mfma_f32_16x16x32_bf16 v[180:183], a[172:175], a[76:79], v[180:183]
v_min_u32 v20, 6, v1
v_lshlrev_b32 v20, 7, v20
v_mfma_f32_16x16x32_bf16 v[176:179], a[164:167], a[76:79], v[176:179]
v_mfma_f32_16x16x32_bf16 v[176:179], a[160:163], a[72:75], v[176:179]
ds_read_b64_tr_b16 a[136:137], v12 offset:0
ds_read_b64_tr_b16 a[138:139], v12 offset:512
v_mfma_f32_16x16x32_bf16 v[192:195], a[160:163], a[80:83], v[192:195]
s_add_u32 m0, s77, 51200
s_add_u32 s64, s76, 131072
v_mfma_f32_16x16x32_bf16 v[192:195], a[164:167], a[84:87], v[192:195]
v_mfma_f32_16x16x32_bf16 v[196:199], a[172:175], a[84:87], v[196:199]
buffer_load_dwordx4 v7, s[16:19], s64 offen lds
v_mfma_f32_16x16x32_bf16 v[196:199], a[168:171], a[80:83], v[196:199]
ds_read_b128 a[72:75], v9 offset:2048
v_mfma_f32_16x16x32_bf16 v[200:203], a[176:179], a[80:83], v[200:203]
v_mfma_f32_16x16x32_bf16 v[200:203], a[180:183], a[84:87], v[200:203]
ds_read_b64_tr_b16 a[140:141], v12 offset:8192
ds_read_b64_tr_b16 a[142:143], v12 offset:8704
v_mfma_f32_16x16x32_bf16 v[204:207], a[188:191], a[84:87], v[204:207]
v_mfma_f32_16x16x32_bf16 v[204:207], a[184:187], a[80:83], v[204:207]
v_mfma_f32_16x16x32_bf16 v[220:223], a[184:187], a[88:91], v[220:223]
ds_read_b128 a[76:79], v10 offset:2048
v_mfma_f32_16x16x32_bf16 v[220:223], a[188:191], a[92:95], v[220:223]
buffer_load_dwordx4 v8, s[16:19], s64 offen offset:1024 lds
v_mfma_f32_16x16x32_bf16 v[216:219], a[180:183], a[92:95], v[216:219]
s_lshl_b32 s70, s93, 7
s_mul_i32 s68, s66, 36864
s_mul_i32 s69, s67, 36864
v_mfma_f32_16x16x32_bf16 v[216:219], a[176:179], a[88:91], v[216:219]
v_lshrrev_b32 v31, 3, v1
v_lshl_add_u32 v5, v31, 7, v5
v_mfma_f32_16x16x32_bf16 v[212:215], a[168:171], a[88:91], v[212:215]
v_lshl_add_u32 v6, v31, 7, v6
v_add_u32 v6, 1024, v6
v_mfma_f32_16x16x32_bf16 v[212:215], a[172:175], a[92:95], v[212:215]
s_mov_b32 s65, 1024
s_add_u32 s71, s68, s65
s_add_u32 s72, s69, s65
v_mfma_f32_16x16x32_bf16 v[208:211], a[164:167], a[92:95], v[208:211]
ds_read_b64_tr_b16 a[144:145], v13 offset:0
ds_read_b64_tr_b16 a[146:147], v13 offset:512
v_mfma_f32_16x16x32_bf16 v[208:211], a[160:163], a[88:91], v[208:211]
s_add_u32 m0, s73, 65536
s_add_u32 s64, s71, 0
ds_read_b128 a[80:83], v9 offset:4096
v_mfma_f32_16x16x32_bf16 v[224:227], a[160:163], a[96:99], v[224:227]
v_mfma_f32_16x16x32_bf16 v[224:227], a[164:167], a[100:103], v[224:227]
buffer_load_dwordx4 v5, s[12:15], s64 offen lds
v_mfma_f32_16x16x32_bf16 v[228:231], a[172:175], a[100:103], v[228:231]
ds_read_b64_tr_b16 a[148:149], v13 offset:8192
ds_read_b64_tr_b16 a[150:151], v13 offset:8704
v_mfma_f32_16x16x32_bf16 v[228:231], a[168:171], a[96:99], v[228:231]
v_mfma_f32_16x16x32_bf16 v[232:235], a[176:179], a[96:99], v[232:235]
v_mfma_f32_16x16x32_bf16 v[232:235], a[180:183], a[100:103], v[232:235]
ds_read_b128 a[84:87], v10 offset:4096
v_mfma_f32_16x16x32_bf16 v[236:239], a[188:191], a[100:103], v[236:239]
v_mfma_f32_16x16x32_bf16 v[236:239], a[184:187], a[96:99], v[236:239]
v_mfma_f32_16x16x32_bf16 v[252:255], a[184:187], a[104:107], v[252:255]
buffer_load_dwordx4 v6, s[12:15], s64 offen offset:1024 lds
v_mfma_f32_16x16x32_bf16 v[252:255], a[188:191], a[108:111], v[252:255]
ds_read_b64_tr_b16 a[152:153], v14 offset:0
ds_read_b64_tr_b16 a[154:155], v14 offset:512
v_mfma_f32_16x16x32_bf16 v[248:251], a[180:183], a[108:111], v[248:251]
v_mfma_f32_16x16x32_bf16 v[248:251], a[176:179], a[104:107], v[248:251]
v_mfma_f32_16x16x32_bf16 v[244:247], a[168:171], a[104:107], v[244:247]
ds_read_b128 a[88:91], v9 offset:6144
v_mfma_f32_16x16x32_bf16 v[244:247], a[172:175], a[108:111], v[244:247]
s_add_u32 m0, s73, 67584
s_add_u32 s64, s71, 18432
v_mfma_f32_16x16x32_bf16 v[240:243], a[164:167], a[108:111], v[240:243]
v_mfma_f32_16x16x32_bf16 v[240:243], a[160:163], a[104:107], v[240:243]
buffer_load_dwordx4 v5, s[12:15], s64 offen lds
v_mfma_f32_16x16x32_bf16 a[0:3], a[160:163], a[112:115], a[0:3]
ds_read_b64_tr_b16 a[156:157], v14 offset:8192
ds_read_b64_tr_b16 a[158:159], v14 offset:8704
v_mfma_f32_16x16x32_bf16 a[0:3], a[164:167], a[116:119], a[0:3]
v_mfma_f32_16x16x32_bf16 a[4:7], a[172:175], a[116:119], a[4:7]
s_waitcnt vmcnt(10)
ds_read_b128 a[92:95], v10 offset:6144
v_mfma_f32_16x16x32_bf16 a[4:7], a[168:171], a[112:115], a[4:7]
v_cmp_gt_u32 vcc, 18, v30
v_mfma_f32_16x16x32_bf16 a[8:11], a[176:179], a[112:115], a[8:11]
v_mfma_f32_16x16x32_bf16 a[8:11], a[180:183], a[116:119], a[8:11]
v_mfma_f32_16x16x32_bf16 a[12:15], a[188:191], a[116:119], a[12:15]
buffer_load_dwordx4 v6, s[12:15], s64 offen offset:1024 lds
v_mfma_f32_16x16x32_bf16 a[12:15], a[184:187], a[112:115], a[12:15]
v_mfma_f32_16x16x32_bf16 a[28:31], a[184:187], a[120:123], a[28:31]
s_cbranch_vccnz CK_WA
CK_WA_R:
v_mfma_f32_16x16x32_bf16 a[28:31], a[188:191], a[124:127], a[28:31]
v_mfma_f32_16x16x32_bf16 a[24:27], a[180:183], a[124:127], a[24:27]
v_mfma_f32_16x16x32_bf16 a[24:27], a[176:179], a[120:123], a[24:27]
v_mfma_f32_16x16x32_bf16 a[20:23], a[168:171], a[120:123], a[20:23]
v_mfma_f32_16x16x32_bf16 a[20:23], a[172:175], a[124:127], a[20:23]
v_mfma_f32_16x16x32_bf16 a[16:19], a[164:167], a[124:127], a[16:19]
v_mfma_f32_16x16x32_bf16 a[16:19], a[160:163], a[120:123], a[16:19]
s_waitcnt lgkmcnt(0)
v_mfma_f32_16x16x32_bf16 v[32:35], a[64:67], a[128:131], v[32:35]
s_waitcnt vmcnt(23)
v_mfma_f32_16x16x32_bf16 v[32:35], a[68:71], a[132:135], v[32:35]
s_barrier
v_mfma_f32_16x16x32_bf16 v[40:43], a[68:71], a[140:143], v[40:43]
ds_read_b128 a[96:99], v9 offset:8192
v_mfma_f32_16x16x32_bf16 v[40:43], a[64:67], a[136:139], v[40:43]
s_lshl_b32 s77, s3, 11
s_lshl_b32 s74, s3, 9
s_add_u32 s74, s74, s4
v_mfma_f32_16x16x32_bf16 v[48:51], a[64:67], a[144:147], v[48:51]
s_lshl_b32 s74, s74, 8
v_mfma_f32_16x16x32_bf16 v[48:51], a[68:71], a[148:151], v[48:51]
s_mov_b32 s75, 8
s_lshl_b32 s76, s75, 19
s_add_u32 s76, s76, s74
v_mfma_f32_16x16x32_bf16 v[56:59], a[68:71], a[156:159], v[56:59]
s_lshl_b32 s79, s75, 13
s_add_u32 s79, s79, s78
ds_read_b128 a[100:103], v10 offset:8192
v_mfma_f32_16x16x32_bf16 v[56:59], a[64:67], a[152:155], v[56:59]
s_add_u32 m0, s77, 0
s_add_u32 s64, s76, 0
v_mfma_f32_16x16x32_bf16 v[60:63], a[72:75], a[152:155], v[60:63]
buffer_load_dwordx4 v7, s[20:23], s64 offen lds
v_mfma_f32_16x16x32_bf16 v[60:63], a[76:79], a[156:159], v[60:63]
ds_read_b128 a[104:107], v9 offset:10240
v_mfma_f32_16x16x32_bf16 v[52:55], a[76:79], a[148:151], v[52:55]
buffer_load_dword a252, v21, s[32:35], s55 offen
v_mfma_f32_16x16x32_bf16 v[52:55], a[72:75], a[144:147], v[52:55]
ds_read_b64_tr_b16 a[160:161], v11 offset:16384
ds_read_b64_tr_b16 a[162:163], v11 offset:16896
v_mfma_f32_16x16x32_bf16 v[44:47], a[72:75], a[136:139], v[44:47]
buffer_load_dwordx4 v8, s[20:23], s64 offen offset:1024 lds
v_mfma_f32_16x16x32_bf16 v[44:47], a[76:79], a[140:143], v[44:47]
buffer_load_dword a253, v20, s[48:51], s54 offen
v_mfma_f32_16x16x32_bf16 v[36:39], a[76:79], a[132:135], v[36:39]
v_mfma_f32_16x16x32_bf16 v[36:39], a[72:75], a[128:131], v[36:39]
ds_read_b128 a[108:111], v10 offset:10240
v_mfma_f32_16x16x32_bf16 v[64:67], a[80:83], a[128:131], v[64:67]
v_mfma_f32_16x16x32_bf16 v[64:67], a[84:87], a[132:135], v[64:67]
v_mfma_f32_16x16x32_bf16 v[72:75], a[84:87], a[140:143], v[72:75]
s_add_u32 m0, s80, 0
s_add_u32 s64, s79, 0
v_mfma_f32_16x16x32_bf16 v[72:75], a[80:83], a[136:139], v[72:75]
ds_read_b64_tr_b16 a[164:165], v11 offset:24576
ds_read_b64_tr_b16 a[166:167], v11 offset:25088
v_mfma_f32_16x16x32_bf16 v[80:83], a[80:83], a[144:147], v[80:83]
buffer_load_dwordx4 v15, s[24:27], s64 offen sc1 lds
v_mfma_f32_16x16x32_bf16 v[80:83], a[84:87], a[148:151], v[80:83]
ds_read_b128 a[112:115], v9 offset:12288
v_mfma_f32_16x16x32_bf16 v[88:91], a[84:87], a[156:159], v[88:91]
v_mfma_f32_16x16x32_bf16 v[88:91], a[80:83], a[152:155], v[88:91]
v_mfma_f32_16x16x32_bf16 v[92:95], a[88:91], a[152:155], v[92:95]
ds_read_b64_tr_b16 a[168:169], v12 offset:16384
ds_read_b64_tr_b16 a[170:171], v12 offset:16896
v_mfma_f32_16x16x32_bf16 v[92:95], a[92:95], a[156:159], v[92:95]
v_mfma_f32_16x16x32_bf16 v[84:87], a[92:95], a[148:151], v[84:87]
s_add_u32 m0, s73, 69632
s_add_u32 s64, s72, 0
v_mfma_f32_16x16x32_bf16 v[84:87], a[88:91], a[144:147], v[84:87]
v_mfma_f32_16x16x32_bf16 v[76:79], a[88:91], a[136:139], v[76:79]
buffer_load_dwordx4 v5, s[12:15], s64 offen lds
v_mfma_f32_16x16x32_bf16 v[76:79], a[92:95], a[140:143], v[76:79]
ds_read_b128 a[116:119], v10 offset:12288
v_mfma_f32_16x16x32_bf16 v[68:71], a[92:95], a[132:135], v[68:71]
v_mfma_f32_16x16x32_bf16 v[68:71], a[88:91], a[128:131], v[68:71]
s_waitcnt lgkmcnt(6)
ds_read_b64_tr_b16 a[172:173], v12 offset:24576
ds_read_b64_tr_b16 a[174:175], v12 offset:25088
v_mfma_f32_16x16x32_bf16 v[96:99], a[96:99], a[128:131], v[96:99]
v_mfma_f32_16x16x32_bf16 v[96:99], a[100:103], a[132:135], v[96:99]
v_mfma_f32_16x16x32_bf16 v[104:107], a[100:103], a[140:143], v[104:107]
ds_read_b128 a[120:123], v9 offset:14336
v_mfma_f32_16x16x32_bf16 v[104:107], a[96:99], a[136:139], v[104:107]
v_mfma_f32_16x16x32_bf16 v[112:115], a[96:99], a[144:147], v[112:115]
v_mfma_f32_16x16x32_bf16 v[112:115], a[100:103], a[148:151], v[112:115]
buffer_load_dwordx4 v6, s[12:15], s64 offen offset:1024 lds
v_mfma_f32_16x16x32_bf16 v[120:123], a[100:103], a[156:159], v[120:123]
ds_read_b64_tr_b16 a[176:177], v13 offset:16384
ds_read_b64_tr_b16 a[178:179], v13 offset:16896
v_mfma_f32_16x16x32_bf16 v[120:123], a[96:99], a[152:155], v[120:123]
v_mfma_f32_16x16x32_bf16 v[124:127], a[104:107], a[152:155], v[124:127]
v_mfma_f32_16x16x32_bf16 v[124:127], a[108:111], a[156:159], v[124:127]
ds_read_b128 a[124:127], v10 offset:14336
v_mfma_f32_16x16x32_bf16 v[116:119], a[108:111], a[148:151], v[116:119]
v_add_u32 v9, 32768, v9
v_add_u32 v10, 32768, v10
v_mfma_f32_16x16x32_bf16 v[116:119], a[104:107], a[144:147], v[116:119]
s_add_u32 m0, s73, 71680
s_add_u32 s64, s72, 18432
v_mfma_f32_16x16x32_bf16 v[108:111], a[104:107], a[136:139], v[108:111]
ds_read_b64_tr_b16 a[180:181], v13 offset:24576
ds_read_b64_tr_b16 a[182:183], v13 offset:25088
v_mfma_f32_16x16x32_bf16 v[108:111], a[108:111], a[140:143], v[108:111]
buffer_load_dwordx4 v5, s[12:15], s64 offen lds
v_mfma_f32_16x16x32_bf16 v[100:103], a[108:111], a[132:135], v[100:103]
v_mfma_f32_16x16x32_bf16 v[100:103], a[104:107], a[128:131], v[100:103]
s_waitcnt lgkmcnt(2)
ds_read_b64_tr_b16 a[184:185], v14 offset:16384
ds_read_b64_tr_b16 a[186:187], v14 offset:16896
v_mfma_f32_16x16x32_bf16 v[128:131], a[112:115], a[128:131], v[128:131]
v_mfma_f32_16x16x32_bf16 v[128:131], a[116:119], a[132:135], v[128:131]
v_mfma_f32_16x16x32_bf16 v[136:139], a[116:119], a[140:143], v[136:139]
ds_read_b64_tr_b16 a[188:189], v14 offset:24576
ds_read_b64_tr_b16 a[190:191], v14 offset:25088
v_mfma_f32_16x16x32_bf16 v[136:139], a[112:115], a[136:139], v[136:139]
v_mfma_f32_16x16x32_bf16 v[144:147], a[112:115], a[144:147], v[144:147]
v_mfma_f32_16x16x32_bf16 v[144:147], a[116:119], a[148:151], v[144:147]
buffer_load_dwordx4 v6, s[12:15], s64 offen offset:1024 lds
v_mfma_f32_16x16x32_bf16 v[152:155], a[116:119], a[156:159], v[152:155]
v_mfma_f32_16x16x32_bf16 v[152:155], a[112:115], a[152:155], v[152:155]
v_mfma_f32_16x16x32_bf16 v[156:159], a[120:123], a[152:155], v[156:159]
v_mfma_f32_16x16x32_bf16 v[156:159], a[124:127], a[156:159], v[156:159]
v_mfma_f32_16x16x32_bf16 v[148:151], a[124:127], a[148:151], v[148:151]
v_mfma_f32_16x16x32_bf16 v[148:151], a[120:123], a[144:147], v[148:151]
v_mfma_f32_16x16x32_bf16 v[140:143], a[120:123], a[136:139], v[140:143]
v_mfma_f32_16x16x32_bf16 v[140:143], a[124:127], a[140:143], v[140:143]
v_mfma_f32_16x16x32_bf16 v[132:135], a[124:127], a[132:135], v[132:135]
v_mfma_f32_16x16x32_bf16 v[132:135], a[120:123], a[128:131], v[132:135]
s_waitcnt lgkmcnt(0)
v_mfma_f32_16x16x32_bf16 v[160:163], a[160:163], a[64:67], v[160:163]
s_waitcnt vmcnt(18)
v_mfma_f32_16x16x32_bf16 v[160:163], a[164:167], a[68:71], v[160:163]
s_barrier
v_mfma_f32_16x16x32_bf16 v[164:167], a[172:175], a[68:71], v[164:167]
ds_read_b64_tr_b16 a[128:129], v11 offset:32768
ds_read_b64_tr_b16 a[130:131], v11 offset:33280
v_mfma_f32_16x16x32_bf16 v[164:167], a[168:171], a[64:67], v[164:167]
s_add_u32 m0, s77, 16384
s_add_u32 s64, s76, 128
v_mfma_f32_16x16x32_bf16 v[168:171], a[176:179], a[64:67], v[168:171]
buffer_load_dwordx4 v7, s[20:23], s64 offen lds
v_mfma_f32_16x16x32_bf16 v[168:171], a[180:183], a[68:71], v[168:171]
v_mfma_f32_16x16x32_bf16 v[172:175], a[188:191], a[68:71], v[172:175]
v_mfma_f32_16x16x32_bf16 v[172:175], a[184:187], a[64:67], v[172:175]
ds_read_b128 a[64:67], v9 offset:0
v_mfma_f32_16x16x32_bf16 v[188:191], a[184:187], a[72:75], v[188:191]
ds_read_b64_tr_b16 a[132:133], v11 offset:40960
ds_read_b64_tr_b16 a[134:135], v11 offset:41472
v_mfma_f32_16x16x32_bf16 v[188:191], a[188:191], a[76:79], v[188:191]
v_mfma_f32_16x16x32_bf16 v[184:187], a[180:183], a[76:79], v[184:187]
v_mfma_f32_16x16x32_bf16 v[184:187], a[176:179], a[72:75], v[184:187]
ds_read_b128 a[68:71], v10 offset:0
v_mfma_f32_16x16x32_bf16 v[180:183], a[168:171], a[72:75], v[180:183]
buffer_load_dwordx4 v8, s[20:23], s64 offen offset:1024 lds
v_mfma_f32_16x16x32_bf16 v[180:183], a[172:175], a[76:79], v[180:183]
v_mfma_f32_16x16x32_bf16 v[176:179], a[164:167], a[76:79], v[176:179]
v_mfma_f32_16x16x32_bf16 v[176:179], a[160:163], a[72:75], v[176:179]
ds_read_b64_tr_b16 a[136:137], v12 offset:32768
ds_read_b64_tr_b16 a[138:139], v12 offset:33280
v_mfma_f32_16x16x32_bf16 v[192:195], a[160:163], a[80:83], v[192:195]
v_mfma_f32_16x16x32_bf16 v[192:195], a[164:167], a[84:87], v[192:195]
v_mfma_f32_16x16x32_bf16 v[196:199], a[172:175], a[84:87], v[196:199]
s_add_u32 m0, s80, 16384
s_add_u32 s64, s79, 2048
ds_read_b128 a[72:75], v9 offset:2048
v_mfma_f32_16x16x32_bf16 v[196:199], a[168:171], a[80:83], v[196:199]
v_mfma_f32_16x16x32_bf16 v[200:203], a[176:179], a[80:83], v[200:203]
buffer_load_dwordx4 v15, s[24:27], s64 offen sc1 lds
v_mfma_f32_16x16x32_bf16 v[200:203], a[180:183], a[84:87], v[200:203]
s_xor_b32 s65, s70, 0
s_add_u32 s71, s68, s65
s_add_u32 s72, s69, s65
v_mfma_f32_16x16x32_bf16 v[204:207], a[188:191], a[84:87], v[204:207]
ds_read_b64_tr_b16 a[140:141], v12 offset:40960
ds_read_b64_tr_b16 a[142:143], v12 offset:41472
v_mfma_f32_16x16x32_bf16 v[204:207], a[184:187], a[80:83], v[204:207]
v_mfma_f32_16x16x32_bf16 v[220:223], a[184:187], a[88:91], v[220:223]
ds_read_b128 a[76:79], v10 offset:2048
v_mfma_f32_16x16x32_bf16 v[220:223], a[188:191], a[92:95], v[220:223]
v_mfma_f32_16x16x32_bf16 v[216:219], a[180:183], a[92:95], v[216:219]
s_add_u32 m0, s73, 0
s_add_u32 s64, s71, 0
v_mfma_f32_16x16x32_bf16 v[216:219], a[176:179], a[88:91], v[216:219]
v_mfma_f32_16x16x32_bf16 v[212:215], a[168:171], a[88:91], v[212:215]
buffer_load_dwordx4 v5, s[12:15], s64 offen lds
v_mfma_f32_16x16x32_bf16 v[212:215], a[172:175], a[92:95], v[212:215]
ds_read_b64_tr_b16 a[144:145], v13 offset:32768
ds_read_b64_tr_b16 a[146:147], v13 offset:33280
v_mfma_f32_16x16x32_bf16 v[208:211], a[164:167], a[92:95], v[208:211]
v_mfma_f32_16x16x32_bf16 v[208:211], a[160:163], a[88:91], v[208:211]
ds_read_b128 a[80:83], v9 offset:4096
v_mfma_f32_16x16x32_bf16 v[224:227], a[160:163], a[96:99], v[224:227]
v_mfma_f32_16x16x32_bf16 v[224:227], a[164:167], a[100:103], v[224:227]
v_mfma_f32_16x16x32_bf16 v[228:231], a[172:175], a[100:103], v[228:231]
ds_read_b64_tr_b16 a[148:149], v13 offset:40960
ds_read_b64_tr_b16 a[150:151], v13 offset:41472
v_mfma_f32_16x16x32_bf16 v[228:231], a[168:171], a[96:99], v[228:231]
v_mfma_f32_16x16x32_bf16 v[232:235], a[176:179], a[96:99], v[232:235]
v_mfma_f32_16x16x32_bf16 v[232:235], a[180:183], a[100:103], v[232:235]
buffer_load_dwordx4 v6, s[12:15], s64 offen offset:1024 lds
v_mfma_f32_16x16x32_bf16 v[236:239], a[188:191], a[100:103], v[236:239]
ds_read_b128 a[84:87], v10 offset:4096
v_mfma_f32_16x16x32_bf16 v[236:239], a[184:187], a[96:99], v[236:239]
v_mfma_f32_16x16x32_bf16 v[252:255], a[184:187], a[104:107], v[252:255]
v_mfma_f32_16x16x32_bf16 v[252:255], a[188:191], a[108:111], v[252:255]
ds_read_b64_tr_b16 a[152:153], v14 offset:32768
ds_read_b64_tr_b16 a[154:155], v14 offset:33280
v_mfma_f32_16x16x32_bf16 v[248:251], a[180:183], a[108:111], v[248:251]
v_mfma_f32_16x16x32_bf16 v[248:251], a[176:179], a[104:107], v[248:251]
s_add_u32 m0, s73, 2048
s_add_u32 s64, s71, 18432
v_mfma_f32_16x16x32_bf16 v[244:247], a[168:171], a[104:107], v[244:247]
ds_read_b128 a[88:91], v9 offset:6144
v_mfma_f32_16x16x32_bf16 v[244:247], a[172:175], a[108:111], v[244:247]
buffer_load_dwordx4 v5, s[12:15], s64 offen lds
v_mfma_f32_16x16x32_bf16 v[240:243], a[164:167], a[108:111], v[240:243]
v_mfma_f32_16x16x32_bf16 v[240:243], a[160:163], a[104:107], v[240:243]
ds_read_b64_tr_b16 a[156:157], v14 offset:40960
ds_read_b64_tr_b16 a[158:159], v14 offset:41472
v_mfma_f32_16x16x32_bf16 a[0:3], a[160:163], a[112:115], a[0:3]
v_mfma_f32_16x16x32_bf16 a[0:3], a[164:167], a[116:119], a[0:3]
v_mfma_f32_16x16x32_bf16 a[4:7], a[172:175], a[116:119], a[4:7]
ds_read_b128 a[92:95], v10 offset:6144
v_mfma_f32_16x16x32_bf16 a[4:7], a[168:171], a[112:115], a[4:7]
v_mfma_f32_16x16x32_bf16 a[8:11], a[176:179], a[112:115], a[8:11]
v_mfma_f32_16x16x32_bf16 a[8:11], a[180:183], a[116:119], a[8:11]
buffer_load_dwordx4 v6, s[12:15], s64 offen offset:1024 lds
v_mfma_f32_16x16x32_bf16 a[12:15], a[188:191], a[116:119], a[12:15]
v_mfma_f32_16x16x32_bf16 a[12:15], a[184:187], a[112:115], a[12:15]
v_mfma_f32_16x16x32_bf16 a[28:31], a[184:187], a[120:123], a[28:31]
v_mfma_f32_16x16x32_bf16 a[28:31], a[188:191], a[124:127], a[28:31]
L_PAD3:
s_cbranch_execz L_PAD7
v_mfma_f32_16x16x32_bf16 a[24:27], a[180:183], a[124:127], a[24:27]
v_mfma_f32_16x16x32_bf16 a[24:27], a[176:179], a[120:123], a[24:27]
v_mfma_f32_16x16x32_bf16 a[20:23], a[168:171], a[120:123], a[20:23]
v_mfma_f32_16x16x32_bf16 a[20:23], a[172:175], a[124:127], a[20:23]
v_mfma_f32_16x16x32_bf16 a[16:19], a[164:167], a[124:127], a[16:19]
v_mfma_f32_16x16x32_bf16 a[16:19], a[160:163], a[120:123], a[16:19]
s_waitcnt lgkmcnt(0)
v_mfma_f32_16x16x32_bf16 v[32:35], a[64:67], a[128:131], v[32:35]
s_waitcnt vmcnt(20)
v_mfma_f32_16x16x32_bf16 v[32:35], a[68:71], a[132:135], v[32:35]
s_barrier
v_mfma_f32_16x16x32_bf16 v[40:43], a[68:71], a[140:143], v[40:43]
ds_read_b128 a[96:99], v9 offset:8192
v_mfma_f32_16x16x32_bf16 v[40:43], a[64:67], a[136:139], v[40:43]
s_xor_b32 s75, s93, 0
s_lshl_b32 s76, s75, 19
s_add_u32 s76, s76, s74
v_mfma_f32_16x16x32_bf16 v[48:51], a[64:67], a[144:147], v[48:51]
s_lshl_b32 s79, s75, 13
s_add_u32 s79, s79, s78
v_mfma_f32_16x16x32_bf16 v[48:51], a[68:71], a[148:151], v[48:51]
s_add_u32 m0, s77, 32768
s_add_u32 s64, s76, 0
ds_read_b128 a[100:103], v10 offset:8192
v_mfma_f32_16x16x32_bf16 v[56:59], a[68:71], a[156:159], v[56:59]
buffer_load_dwordx4 v7, s[20:23], s64 offen lds
v_mfma_f32_16x16x32_bf16 v[56:59], a[64:67], a[152:155], v[56:59]
v_mfma_f32_16x16x32_bf16 v[60:63], a[72:75], a[152:155], v[60:63]
ds_read_b128 a[104:107], v9 offset:10240
v_mfma_f32_16x16x32_bf16 v[60:63], a[76:79], a[156:159], v[60:63]
v_mfma_f32_16x16x32_bf16 v[52:55], a[76:79], a[148:151], v[52:55]
v_mfma_f32_16x16x32_bf16 v[52:55], a[72:75], a[144:147], v[52:55]
ds_read_b64_tr_b16 a[160:161], v11 offset:49152
ds_read_b64_tr_b16 a[162:163], v11 offset:49664
v_mfma_f32_16x16x32_bf16 v[44:47], a[72:75], a[136:139], v[44:47]
buffer_load_dwordx4 v8, s[20:23], s64 offen offset:1024 lds
v_mfma_f32_16x16x32_bf16 v[44:47], a[76:79], a[140:143], v[44:47]
v_mfma_f32_16x16x32_bf16 v[36:39], a[76:79], a[132:135], v[36:39]
v_mfma_f32_16x16x32_bf16 v[36:39], a[72:75], a[128:131], v[36:39]
ds_read_b128 a[108:111], v10 offset:10240
v_mfma_f32_16x16x32_bf16 v[64:67], a[80:83], a[128:131], v[64:67]
v_mfma_f32_16x16x32_bf16 v[64:67], a[84:87], a[132:135], v[64:67]
v_mfma_f32_16x16x32_bf16 v[72:75], a[84:87], a[140:143], v[72:75]
s_add_u32 m0, s80, 32768
s_add_u32 s64, s79, 0
v_mfma_f32_16x16x32_bf16 v[72:75], a[80:83], a[136:139], v[72:75]
ds_read_b64_tr_b16 a[164:165], v11 offset:57344
ds_read_b64_tr_b16 a[166:167], v11 offset:57856
v_mfma_f32_16x16x32_bf16 v[80:83], a[80:83], a[144:147], v[80:83]
buffer_load_dwordx4 v15, s[24:27], s64 offen sc1 lds
v_mfma_f32_16x16x32_bf16 v[80:83], a[84:87], a[148:151], v[80:83]
ds_read_b128 a[112:115], v9 offset:12288
v_mfma_f32_16x16x32_bf16 v[88:91], a[84:87], a[156:159], v[88:91]
v_cvt_pk_bf16_f32 v32, v32, v33
v_cvt_pk_bf16_f32 v33, v34, v35
v_mfma_f32_16x16x32_bf16 v[88:91], a[80:83], a[152:155], v[88:91]
v_cvt_pk_bf16_f32 v34, v36, v37
v_cvt_pk_bf16_f32 v35, v38, v39
v_mfma_f32_16x16x32_bf16 v[92:95], a[88:91], a[152:155], v[92:95]
ds_read_b64_tr_b16 a[168:169], v12 offset:49152
ds_read_b64_tr_b16 a[170:171], v12 offset:49664
v_mfma_f32_16x16x32_bf16 v[92:95], a[92:95], a[156:159], v[92:95]
v_cvt_pk_bf16_f32 v40, v40, v41
v_cvt_pk_bf16_f32 v41, v42, v43
v_mfma_f32_16x16x32_bf16 v[84:87], a[92:95], a[148:151], v[84:87]
s_add_u32 m0, s73, 4096
s_add_u32 s64, s72, 0
s_lshr_b32 s55, s3, 1
v_mfma_f32_16x16x32_bf16 v[84:87], a[88:91], a[144:147], v[84:87]
s_lshl_b32 s55, s55, 14
s_lshl_b32 s54, s3, 13
s_sub_u32 s55, s54, s55
v_mfma_f32_16x16x32_bf16 v[76:79], a[88:91], a[136:139], v[76:79]
buffer_load_dwordx4 v5, s[12:15], s64 offen lds
v_mfma_f32_16x16x32_bf16 v[76:79], a[92:95], a[140:143], v[76:79]
s_and_b32 s54, s3, 1
s_lshl_b32 s54, s54, 12
ds_read_b128 a[116:119], v10 offset:12288
v_mfma_f32_16x16x32_bf16 v[68:71], a[92:95], a[132:135], v[68:71]
s_add_u32 s53, s88, 0
v_cvt_pk_bf16_f32 v42, v44, v45
v_cvt_pk_bf16_f32 v43, v46, v47
v_mfma_f32_16x16x32_bf16 v[68:71], a[88:91], a[128:131], v[68:71]
s_waitcnt lgkmcnt(6)
ds_read_b64_tr_b16 a[172:173], v12 offset:57344
ds_read_b64_tr_b16 a[174:175], v12 offset:57856
v_mfma_f32_16x16x32_bf16 v[96:99], a[96:99], a[128:131], v[96:99]
buffer_store_dwordx4 v[32:35], v15, s[24:27], s53 offen offset:0 sc1
v_mfma_f32_16x16x32_bf16 v[96:99], a[100:103], a[132:135], v[96:99]
v_cvt_pk_bf16_f32 v48, v48, v49
v_cvt_pk_bf16_f32 v49, v50, v51
v_mfma_f32_16x16x32_bf16 v[104:107], a[100:103], a[140:143], v[104:107]
ds_read_b128 a[120:123], v9 offset:14336
v_cvt_pk_bf16_f32 v50, v52, v53
v_mfma_f32_16x16x32_bf16 v[104:107], a[96:99], a[136:139], v[104:107]
v_cvt_pk_bf16_f32 v51, v54, v55
v_cvt_pk_bf16_f32 v56, v56, v57
v_mfma_f32_16x16x32_bf16 v[112:115], a[96:99], a[144:147], v[112:115]
v_cvt_pk_bf16_f32 v57, v58, v59
v_cvt_pk_bf16_f32 v58, v60, v61
v_mfma_f32_16x16x32_bf16 v[112:115], a[100:103], a[148:151], v[112:115]
buffer_load_dwordx4 v6, s[12:15], s64 offen offset:1024 lds
v_mfma_f32_16x16x32_bf16 v[120:123], a[100:103], a[156:159], v[120:123]
ds_read_b64_tr_b16 a[176:177], v13 offset:49152
ds_read_b64_tr_b16 a[178:179], v13 offset:49664
v_mfma_f32_16x16x32_bf16 v[120:123], a[96:99], a[152:155], v[120:123]
v_cvt_pk_bf16_f32 v59, v62, v63
v_cvt_pk_bf16_f32 v64, v64, v65
v_mfma_f32_16x16x32_bf16 v[124:127], a[104:107], a[152:155], v[124:127]
v_cvt_pk_bf16_f32 v65, v66, v67
v_cvt_pk_bf16_f32 v66, v68, v69
v_mfma_f32_16x16x32_bf16 v[124:127], a[108:111], a[156:159], v[124:127]
ds_read_b128 a[124:127], v10 offset:14336
v_cvt_pk_bf16_f32 v67, v70, v71
v_mfma_f32_16x16x32_bf16 v[116:119], a[108:111], a[148:151], v[116:119]
v_add_u32 v9, 32768, v9
v_add_u32 v10, 32768, v10
v_mfma_f32_16x16x32_bf16 v[116:119], a[104:107], a[144:147], v[116:119]
s_add_u32 m0, s73, 6144
s_add_u32 s64, s72, 18432
v_cvt_pk_bf16_f32 v72, v72, v73
v_mfma_f32_16x16x32_bf16 v[108:111], a[104:107], a[136:139], v[108:111]
ds_read_b64_tr_b16 a[180:181], v13 offset:57344
ds_read_b64_tr_b16 a[182:183], v13 offset:57856
v_mfma_f32_16x16x32_bf16 v[108:111], a[108:111], a[140:143], v[108:111]
buffer_load_dwordx4 v5, s[12:15], s64 offen lds
v_mfma_f32_16x16x32_bf16 v[100:103], a[108:111], a[132:135], v[100:103]
v_cvt_pk_bf16_f32 v73, v74, v75
v_cvt_pk_bf16_f32 v74, v76, v77
v_mfma_f32_16x16x32_bf16 v[100:103], a[104:107], a[128:131], v[100:103]
s_waitcnt lgkmcnt(2)
ds_read_b64_tr_b16 a[184:185], v14 offset:49152
ds_read_b64_tr_b16 a[186:187], v14 offset:49664
v_mfma_f32_16x16x32_bf16 v[128:131], a[112:115], a[128:131], v[128:131]
v_cvt_pk_bf16_f32 v75, v78, v79
v_cvt_pk_bf16_f32 v80, v80, v81
v_mfma_f32_16x16x32_bf16 v[128:131], a[116:119], a[132:135], v[128:131]
v_cvt_pk_bf16_f32 v81, v82, v83
v_cvt_pk_bf16_f32 v82, v84, v85
v_mfma_f32_16x16x32_bf16 v[136:139], a[116:119], a[140:143], v[136:139]
ds_read_b64_tr_b16 a[188:189], v14 offset:57344
ds_read_b64_tr_b16 a[190:191], v14 offset:57856
v_mfma_f32_16x16x32_bf16 v[136:139], a[112:115], a[136:139], v[136:139]
v_add_u32 v9, s55, v9
v_add_u32 v10, s55, v10
v_mfma_f32_16x16x32_bf16 v[144:147], a[112:115], a[144:147], v[144:147]
v_subrev_u32 v11, s54, v11
v_subrev_u32 v12, s54, v12
v_mfma_f32_16x16x32_bf16 v[144:147], a[116:119], a[148:151], v[144:147]
buffer_load_dwordx4 v6, s[12:15], s64 offen offset:1024 lds
v_mfma_f32_16x16x32_bf16 v[152:155], a[116:119], a[156:159], v[152:155]
v_subrev_u32 v13, s54, v13
v_subrev_u32 v14, s54, v14
v_mfma_f32_16x16x32_bf16 v[152:155], a[112:115], a[152:155], v[152:155]
v_cvt_pk_bf16_f32 v83, v86, v87
v_cvt_pk_bf16_f32 v88, v88, v89
v_mfma_f32_16x16x32_bf16 v[156:159], a[120:123], a[152:155], v[156:159]
v_cvt_pk_bf16_f32 v89, v90, v91
v_cvt_pk_bf16_f32 v90, v92, v93
v_mfma_f32_16x16x32_bf16 v[156:159], a[124:127], a[156:159], v[156:159]
s_add_u32 s53, s88, 0
v_cvt_pk_bf16_f32 v91, v94, v95
v_cvt_pk_bf16_f32 v96, v96, v97
v_mfma_f32_16x16x32_bf16 v[148:151], a[124:127], a[148:151], v[148:151]
buffer_store_dwordx4 v[40:43], v15, s[24:27], s53 offen offset:1024 sc1
v_mfma_f32_16x16x32_bf16 v[148:151], a[120:123], a[144:147], v[148:151]
v_cvt_pk_bf16_f32 v97, v98, v99
v_cvt_pk_bf16_f32 v98, v100, v101
v_mfma_f32_16x16x32_bf16 v[140:143], a[120:123], a[136:139], v[140:143]
v_cvt_pk_bf16_f32 v99, v102, v103
v_cvt_pk_bf16_f32 v104, v104, v105
v_mfma_f32_16x16x32_bf16 v[140:143], a[124:127], a[140:143], v[140:143]
v_cvt_pk_bf16_f32 v105, v106, v107
v_cvt_pk_bf16_f32 v106, v108, v109
v_mfma_f32_16x16x32_bf16 v[132:135], a[124:127], a[132:135], v[132:135]
v_cvt_pk_bf16_f32 v107, v110, v111
v_cvt_pk_bf16_f32 v112, v112, v113
v_mfma_f32_16x16x32_bf16 v[132:135], a[120:123], a[128:131], v[132:135]
s_waitcnt lgkmcnt(0)
v_cvt_pk_bf16_f32 v113, v114, v115
v_cvt_pk_bf16_f32 v114, v116, v117
v_mfma_f32_16x16x32_bf16 v[160:163], a[160:163], a[64:67], v[160:163]
s_waitcnt vmcnt(16)
v_cvt_pk_bf16_f32 v115, v118, v119
v_cvt_pk_bf16_f32 v120, v120, v121
v_mfma_f32_16x16x32_bf16 v[160:163], a[164:167], a[68:71], v[160:163]
s_barrier
v_mfma_f32_16x16x32_bf16 v[164:167], a[172:175], a[68:71], v[164:167]
ds_read_b64_tr_b16 a[128:129], v11 offset:0
ds_read_b64_tr_b16 a[130:131], v11 offset:512
v_mfma_f32_16x16x32_bf16 v[164:167], a[168:171], a[64:67], v[164:167]
s_add_u32 m0, s77, 49152
s_add_u32 s64, s76, 128
v_cvt_pk_bf16_f32 v121, v122, v123
v_mfma_f32_16x16x32_bf16 v[168:171], a[176:179], a[64:67], v[168:171]
buffer_load_dwordx4 v7, s[20:23], s64 offen lds
v_mfma_f32_16x16x32_bf16 v[168:171], a[180:183], a[68:71], v[168:171]
ds_read_b64_tr_b16 a[132:133], v11 offset:4096
ds_read_b64_tr_b16 a[134:135], v11 offset:4608
v_mfma_f32_16x16x32_bf16 v[172:175], a[188:191], a[68:71], v[172:175]
v_cvt_pk_bf16_f32 v122, v124, v125
v_cvt_pk_bf16_f32 v123, v126, v127
v_mfma_f32_16x16x32_bf16 v[172:175], a[184:187], a[64:67], v[172:175]
v_cvt_pk_bf16_f32 v128, v128, v129
v_cvt_pk_bf16_f32 v129, v130, v131
v_mfma_f32_16x16x32_bf16 v[188:191], a[184:187], a[72:75], v[188:191]
ds_read_b64_tr_b16 a[136:137], v12 offset:0
ds_read_b64_tr_b16 a[138:139], v12 offset:512
v_mfma_f32_16x16x32_bf16 v[188:191], a[188:191], a[76:79], v[188:191]
v_cvt_pk_bf16_f32 v130, v132, v133
v_cvt_pk_bf16_f32 v131, v134, v135
v_mfma_f32_16x16x32_bf16 v[184:187], a[180:183], a[76:79], v[184:187]
v_cvt_pk_bf16_f32 v136, v136, v137
v_cvt_pk_bf16_f32 v137, v138, v139
v_mfma_f32_16x16x32_bf16 v[184:187], a[176:179], a[72:75], v[184:187]
ds_read_b64_tr_b16 a[140:141], v12 offset:4096
ds_read_b64_tr_b16 a[142:143], v12 offset:4608
v_mfma_f32_16x16x32_bf16 v[180:183], a[168:171], a[72:75], v[180:183]
buffer_load_dwordx4 v8, s[20:23], s64 offen offset:1024 lds
v_mfma_f32_16x16x32_bf16 v[180:183], a[172:175], a[76:79], v[180:183]
v_cvt_pk_bf16_f32 v138, v140, v141
v_cvt_pk_bf16_f32 v139, v142, v143
v_mfma_f32_16x16x32_bf16 v[176:179], a[164:167], a[76:79], v[176:179]
v_cvt_pk_bf16_f32 v144, v144, v145
v_cvt_pk_bf16_f32 v145, v146, v147
v_mfma_f32_16x16x32_bf16 v[176:179], a[160:163], a[72:75], v[176:179]
ds_read_b64_tr_b16 a[144:145], v13 offset:0
ds_read_b64_tr_b16 a[146:147], v13 offset:512
v_mfma_f32_16x16x32_bf16 v[192:195], a[160:163], a[80:83], v[192:195]
v_cvt_pk_bf16_f32 v146, v148, v149
v_cvt_pk_bf16_f32 v147, v150, v151
v_mfma_f32_16x16x32_bf16 v[192:195], a[164:167], a[84:87], v[192:195]
v_cvt_pk_bf16_f32 v152, v152, v153
v_cvt_pk_bf16_f32 v153, v154, v155
v_mfma_f32_16x16x32_bf16 v[196:199], a[172:175], a[84:87], v[196:199]
s_add_u32 m0, s80, 49152
s_add_u32 s64, s79, 2048
v_cvt_pk_bf16_f32 v154, v156, v157
v_mfma_f32_16x16x32_bf16 v[196:199], a[168:171], a[80:83], v[196:199]
ds_read_b64_tr_b16 a[148:149], v13 offset:4096
ds_read_b64_tr_b16 a[150:151], v13 offset:4608
v_mfma_f32_16x16x32_bf16 v[200:203], a[176:179], a[80:83], v[200:203]
buffer_load_dwordx4 v15, s[24:27], s64 offen sc1 lds
v_mfma_f32_16x16x32_bf16 v[200:203], a[180:183], a[84:87], v[200:203]
s_xor_b32 s65, s70, 128
s_add_u32 s71, s68, s65
s_add_u32 s72, s69, s65
v_mfma_f32_16x16x32_bf16 v[204:207], a[188:191], a[84:87], v[204:207]
s_add_u32 s53, s88, 0
ds_read_b64_tr_b16 a[152:153], v14 offset:0
ds_read_b64_tr_b16 a[154:155], v14 offset:512
v_mfma_f32_16x16x32_bf16 v[204:207], a[184:187], a[80:83], v[204:207]
buffer_store_dwordx4 v[48:51], v15, s[24:27], s53 offen offset:2048 sc1
v_mfma_f32_16x16x32_bf16 v[220:223], a[184:187], a[88:91], v[220:223]
ds_read_b64_tr_b16 a[156:157], v14 offset:4096
ds_read_b64_tr_b16 a[158:159], v14 offset:4608
v_mfma_f32_16x16x32_bf16 v[220:223], a[188:191], a[92:95], v[220:223]
v_cvt_pk_bf16_f32 v155, v158, v159
v_mul_f32 v160, s91, v160
v_mfma_f32_16x16x32_bf16 v[216:219], a[180:183], a[92:95], v[216:219]
s_add_u32 m0, s73, 32768
s_add_u32 s64, s71, 0
v_mul_f32 v161, s91, v161
v_mfma_f32_16x16x32_bf16 v[216:219], a[176:179], a[88:91], v[216:219]
v_mul_f32 v162, s91, v162
v_mul_f32 v163, s91, v163
v_mfma_f32_16x16x32_bf16 v[212:215], a[168:171], a[88:91], v[212:215]
buffer_load_dwordx4 v5, s[12:15], s64 offen lds
v_mfma_f32_16x16x32_bf16 v[212:215], a[172:175], a[92:95], v[212:215]
ds_read_b128 a[68:71], v4 offset:10240
v_mul_f32 v164, s91, v164
v_mfma_f32_16x16x32_bf16 v[208:211], a[164:167], a[92:95], v[208:211]
v_mul_f32 v165, s91, v165
v_mul_f32 v166, s91, v166
v_mfma_f32_16x16x32_bf16 v[208:211], a[160:163], a[88:91], v[208:211]
ds_read_b128 a[64:67], v4 offset:8192
v_mul_f32 v167, s91, v167
v_mfma_f32_16x16x32_bf16 v[224:227], a[160:163], a[96:99], v[224:227]
v_cvt_pk_bf16_f32 v160, v160, v161
v_cvt_pk_bf16_f32 v161, v162, v163
v_mfma_f32_16x16x32_bf16 v[224:227], a[164:167], a[100:103], v[224:227]
v_cvt_pk_bf16_f32 v162, v164, v165
v_cvt_pk_bf16_f32 v163, v166, v167
v_mfma_f32_16x16x32_bf16 v[228:231], a[172:175], a[100:103], v[228:231]
ds_read_b128 a[76:79], v4 offset:11264
v_mul_f32 v168, s91, v168
v_mfma_f32_16x16x32_bf16 v[228:231], a[168:171], a[96:99], v[228:231]
v_mul_f32 v169, s91, v169
v_mul_f32 v170, s91, v170
v_mfma_f32_16x16x32_bf16 v[232:235], a[176:179], a[96:99], v[232:235]
v_mul_f32 v171, s91, v171
v_mul_f32 v172, s91, v172
v_mfma_f32_16x16x32_bf16 v[232:235], a[180:183], a[100:103], v[232:235]
buffer_load_dwordx4 v6, s[12:15], s64 offen offset:1024 lds
v_mfma_f32_16x16x32_bf16 v[236:239], a[188:191], a[100:103], v[236:239]
ds_read_b128 a[72:75], v4 offset:9216
v_mul_f32 v173, s91, v173
v_mfma_f32_16x16x32_bf16 v[236:239], a[184:187], a[96:99], v[236:239]
v_mul_f32 v174, s91, v174
v_mul_f32 v175, s91, v175
v_mfma_f32_16x16x32_bf16 v[252:255], a[184:187], a[104:107], v[252:255]
v_cvt_pk_bf16_f32 v168, v168, v169
v_cvt_pk_bf16_f32 v169, v170, v171
v_mfma_f32_16x16x32_bf16 v[252:255], a[188:191], a[108:111], v[252:255]
ds_read_b128 a[84:87], v10 offset:0
v_cvt_pk_bf16_f32 v170, v172, v173
v_mfma_f32_16x16x32_bf16 v[248:251], a[180:183], a[108:111], v[248:251]
v_cvt_pk_bf16_f32 v171, v174, v175
v_mul_f32 v176, s91, v176
v_mfma_f32_16x16x32_bf16 v[248:251], a[176:179], a[104:107], v[248:251]
s_add_u32 m0, s73, 34816
s_add_u32 s64, s71, 18432
v_mul_f32 v177, s91, v177
v_mfma_f32_16x16x32_bf16 v[244:247], a[168:171], a[104:107], v[244:247]
ds_read_b128 a[80:83], v9 offset:0
v_mul_f32 v178, s91, v178
v_mfma_f32_16x16x32_bf16 v[244:247], a[172:175], a[108:111], v[244:247]
buffer_load_dwordx4 v5, s[12:15], s64 offen lds
v_mfma_f32_16x16x32_bf16 v[240:243], a[164:167], a[108:111], v[240:243]
v_mul_f32 v179, s91, v179
v_mul_f32 v180, s91, v180
v_mfma_f32_16x16x32_bf16 v[240:243], a[160:163], a[104:107], v[240:243]
s_add_u32 s53, s88, 0
ds_read_b128 a[92:95], v10 offset:2048
v_mul_f32 v181, s91, v181
v_mfma_f32_16x16x32_bf16 a[0:3], a[160:163], a[112:115], a[0:3]
buffer_store_dwordx4 v[56:59], v15, s[24:27], s53 offen offset:3072 sc1
v_mfma_f32_16x16x32_bf16 a[0:3], a[164:167], a[116:119], a[0:3]
v_mul_f32 v182, s91, v182
v_mul_f32 v183, s91, v183
v_mfma_f32_16x16x32_bf16 a[4:7], a[172:175], a[116:119], a[4:7]
ds_read_b128 a[88:91], v9 offset:2048
v_cvt_pk_bf16_f32 v176, v176, v177
v_mfma_f32_16x16x32_bf16 a[4:7], a[168:171], a[112:115], a[4:7]
v_cvt_pk_bf16_f32 v177, v178, v179
v_cvt_pk_bf16_f32 v178, v180, v181
v_mfma_f32_16x16x32_bf16 a[8:11], a[176:179], a[112:115], a[8:11]
v_cvt_pk_bf16_f32 v179, v182, v183
v_mul_f32 v184, s91, v184
v_mfma_f32_16x16x32_bf16 a[8:11], a[180:183], a[116:119], a[8:11]
buffer_load_dwordx4 v6, s[12:15], s64 offen offset:1024 lds
v_mfma_f32_16x16x32_bf16 a[12:15], a[188:191], a[116:119], a[12:15]
v_mul_f32 v185, s91, v185
v_mul_f32 v186, s91, v186
v_mfma_f32_16x16x32_bf16 a[12:15], a[184:187], a[112:115], a[12:15]
v_mul_f32 v187, s91, v187
v_mul_f32 v188, s91, v188
v_mfma_f32_16x16x32_bf16 a[28:31], a[184:187], a[120:123], a[28:31]
v_mul_f32 v189, s91, v189
v_mul_f32 v190, s91, v190
v_mfma_f32_16x16x32_bf16 a[28:31], a[188:191], a[124:127], a[28:31]
v_mul_f32 v191, s91, v191
v_cvt_pk_bf16_f32 v184, v184, v185
v_mfma_f32_16x16x32_bf16 a[24:27], a[180:183], a[124:127], a[24:27]
v_cvt_pk_bf16_f32 v185, v186, v187
v_cvt_pk_bf16_f32 v186, v188, v189
v_mfma_f32_16x16x32_bf16 a[24:27], a[176:179], a[120:123], a[24:27]
v_cvt_pk_bf16_f32 v187, v190, v191
v_mul_f32 v192, s91, v192
v_mfma_f32_16x16x32_bf16 a[20:23], a[168:171], a[120:123], a[20:23]
v_mul_f32 v193, s91, v193
v_mul_f32 v194, s91, v194
v_mfma_f32_16x16x32_bf16 a[20:23], a[172:175], a[124:127], a[20:23]
v_mul_f32 v195, s91, v195
v_mul_f32 v196, s91, v196
v_mfma_f32_16x16x32_bf16 a[16:19], a[164:167], a[124:127], a[16:19]
v_mul_f32 v197, s91, v197
v_mul_f32 v198, s91, v198
v_mfma_f32_16x16x32_bf16 a[16:19], a[160:163], a[120:123], a[16:19]
s_waitcnt lgkmcnt(0)
v_mul_f32 v199, s91, v199
v_cvt_pk_bf16_f32 v192, v192, v193
v_mfma_f32_16x16x32_bf16 v[36:39], a[128:131], a[80:83], 0
s_waitcnt vmcnt(22)
v_cvt_pk_bf16_f32 v193, v194, v195
v_cvt_pk_bf16_f32 v194, v196, v197
v_mfma_f32_16x16x32_bf16 v[36:39], a[132:135], a[84:87], v[36:39]
s_barrier
v_mfma_f32_16x16x32_bf16 v[44:47], a[140:143], a[84:87], 0
ds_read_b128 a[96:99], v9 offset:4096
v_cvt_pk_bf16_f32 v195, v198, v199
v_mfma_f32_16x16x32_bf16 v[44:47], a[136:139], a[80:83], v[44:47]
s_xor_b32 s75, s93, 1
s_lshl_b32 s76, s75, 19
s_add_u32 s76, s76, s74
v_mfma_f32_16x16x32_bf16 v[32:35], a[144:147], a[80:83], 0
s_lshl_b32 s79, s75, 13
s_add_u32 s79, s79, s78
ds_read_b128 a[100:103], v10 offset:4096
v_mfma_f32_16x16x32_bf16 v[32:35], a[148:151], a[84:87], v[32:35]
s_add_u32 m0, s77, 0
s_add_u32 s64, s76, 0
ds_read_b128 a[104:107], v9 offset:6144
v_mfma_f32_16x16x32_bf16 v[52:55], a[156:159], a[84:87], 0
buffer_load_dwordx4 v7, s[20:23], s64 offen lds
v_mfma_f32_16x16x32_bf16 v[52:55], a[152:155], a[80:83], v[52:55]
ds_read_b64_tr_b16 a[160:161], v11 offset:16384
ds_read_b64_tr_b16 a[162:163], v11 offset:16896
v_mfma_f32_16x16x32_bf16 v[60:63], a[64:67], a[80:83], 0
v_mul_f32 v200, s91, v200
v_mul_f32 v201, s91, v201
v_mfma_f32_16x16x32_bf16 v[60:63], a[68:71], a[84:87], v[60:63]
ds_read_b128 a[108:111], v10 offset:6144
v_mul_f32 v202, s91, v202
v_mfma_f32_16x16x32_bf16 v[68:71], a[76:79], a[84:87], 0
buffer_load_dwordx4 v8, s[20:23], s64 offen offset:1024 lds
v_mfma_f32_16x16x32_bf16 v[68:71], a[72:75], a[80:83], v[68:71]
s_add_u32 s53, s88, 262144
ds_read_b64_tr_b16 a[164:165], v11 offset:20480
ds_read_b64_tr_b16 a[166:167], v11 offset:20992
v_mfma_f32_16x16x32_bf16 v[76:79], a[72:75], a[88:91], 0
v_add_u32 v9, -65536, v9
v_add_u32 v10, -65536, v10
v_mfma_f32_16x16x32_bf16 v[76:79], a[76:79], a[92:95], v[76:79]
ds_read_b64_tr_b16 a[168:169], v12 offset:16384
ds_read_b64_tr_b16 a[170:171], v12 offset:16896
v_mfma_f32_16x16x32_bf16 v[84:87], a[68:71], a[92:95], 0
s_add_u32 m0, s80, 0
s_add_u32 s64, s79, 0
v_mul_f32 v203, s91, v203
v_mfma_f32_16x16x32_bf16 v[84:87], a[64:67], a[88:91], v[84:87]
ds_read_b64_tr_b16 a[172:173], v12 offset:20480
ds_read_b64_tr_b16 a[174:175], v12 offset:20992
v_mfma_f32_16x16x32_bf16 v[92:95], a[152:155], a[88:91], 0
buffer_load_dwordx4 v15, s[24:27], s64 offen sc1 lds
v_mfma_f32_16x16x32_bf16 v[92:95], a[156:159], a[92:95], v[92:95]
buffer_store_dwordx4 v[64:67], v15, s[24:27], s53 offen offset:0 sc1
v_mfma_f32_16x16x32_bf16 v[40:43], a[148:151], a[92:95], 0
ds_read_b64_tr_b16 a[176:177], v13 offset:16384
ds_read_b64_tr_b16 a[178:179], v13 offset:16896
v_mfma_f32_16x16x32_bf16 v[40:43], a[144:147], a[88:91], v[40:43]
v_mul_f32 v204, s91, v204
v_mul_f32 v205, s91, v205
v_mfma_f32_16x16x32_bf16 v[100:103], a[136:139], a[88:91], 0
s_add_u32 m0, s73, 36864
s_add_u32 s64, s72, 0
v_mul_f32 v206, s91, v206
v_mfma_f32_16x16x32_bf16 v[100:103], a[140:143], a[92:95], v[100:103]
ds_read_b64_tr_b16 a[180:181], v13 offset:20480
ds_read_b64_tr_b16 a[182:183], v13 offset:20992
v_mfma_f32_16x16x32_bf16 v[108:111], a[132:135], a[92:95], 0
buffer_load_dwordx4 v5, s[12:15], s64 offen lds
v_mfma_f32_16x16x32_bf16 v[108:111], a[128:131], a[88:91], v[108:111]
s_waitcnt lgkmcnt(14)
ds_read_b64_tr_b16 a[184:185], v14 offset:16384
ds_read_b64_tr_b16 a[186:187], v14 offset:16896
v_mfma_f32_16x16x32_bf16 v[116:119], a[128:131], a[96:99], 0
ds_read_b64_tr_b16 a[188:189], v14 offset:20480
ds_read_b64_tr_b16 a[190:191], v14 offset:20992
v_mfma_f32_16x16x32_bf16 v[116:119], a[132:135], a[100:103], v[116:119]
v_mul_f32 v207, s91, v207
v_cvt_pk_bf16_f32 v200, v200, v201
v_mfma_f32_16x16x32_bf16 v[124:127], a[140:143], a[100:103], 0
v_cvt_pk_bf16_f32 v201, v202, v203
v_cvt_pk_bf16_f32 v202, v204, v205
v_mfma_f32_16x16x32_bf16 v[124:127], a[136:139], a[96:99], v[124:127]
ds_read_b128 a[112:115], v4 offset:24576
v_cvt_pk_bf16_f32 v203, v206, v207
v_mfma_f32_16x16x32_bf16 v[132:135], a[144:147], a[96:99], 0
buffer_load_dwordx4 v6, s[12:15], s64 offen offset:1024 lds
v_mfma_f32_16x16x32_bf16 v[132:135], a[148:151], a[100:103], v[132:135]
ds_read_b128 a[116:119], v4 offset:26624
v_mul_f32 v208, s91, v208
v_mfma_f32_16x16x32_bf16 v[140:143], a[156:159], a[100:103], 0
v_mul_f32 v209, s91, v209
v_mul_f32 v210, s91, v210
v_mfma_f32_16x16x32_bf16 v[140:143], a[152:155], a[96:99], v[140:143]
ds_read_b128 a[120:123], v4 offset:25600
v_mul_f32 v211, s91, v211
v_mfma_f32_16x16x32_bf16 v[148:151], a[64:67], a[96:99], 0
s_add_u32 m0, s73, 38912
s_add_u32 s64, s72, 18432
v_mul_f32 v212, s91, v212
v_mfma_f32_16x16x32_bf16 v[148:151], a[68:71], a[100:103], v[148:151]
ds_read_b128 a[124:127], v4 offset:27648
v_mul_f32 v213, s91, v213
v_mfma_f32_16x16x32_bf16 v[48:51], a[76:79], a[100:103], 0
buffer_load_dwordx4 v5, s[12:15], s64 offen lds
v_mfma_f32_16x16x32_bf16 v[48:51], a[72:75], a[96:99], v[48:51]
s_waitcnt lgkmcnt(15)
v_mul_f32 v214, s91, v214
v_mul_f32 v215, s91, v215
v_mfma_f32_16x16x32_bf16 v[156:159], a[72:75], a[104:107], 0
v_cvt_pk_bf16_f32 v208, v208, v209
v_cvt_pk_bf16_f32 v209, v210, v211
v_mfma_f32_16x16x32_bf16 v[156:159], a[76:79], a[108:111], v[156:159]
s_add_u32 s53, s88, 262144
v_cvt_pk_bf16_f32 v210, v212, v213
v_cvt_pk_bf16_f32 v211, v214, v215
v_mfma_f32_16x16x32_bf16 v[164:167], a[68:71], a[108:111], 0
buffer_store_dwordx4 v[72:75], v15, s[24:27], s53 offen offset:1024 sc1
v_mfma_f32_16x16x32_bf16 v[164:167], a[64:67], a[104:107], v[164:167]
v_mul_f32 v216, s91, v216
v_mul_f32 v217, s91, v217
v_mfma_f32_16x16x32_bf16 v[172:175], a[152:155], a[104:107], 0
buffer_load_dwordx4 v6, s[12:15], s64 offen offset:1024 lds
v_mfma_f32_16x16x32_bf16 v[172:175], a[156:159], a[108:111], v[172:175]
v_mul_f32 v218, s91, v218
v_mul_f32 v219, s91, v219
v_mfma_f32_16x16x32_bf16 v[56:59], a[148:151], a[108:111], 0
v_mul_f32 v220, s91, v220
v_mul_f32 v221, s91, v221
v_mfma_f32_16x16x32_bf16 v[56:59], a[144:147], a[104:107], v[56:59]
v_mul_f32 v222, s91, v222
v_mul_f32 v223, s91, v223
v_mfma_f32_16x16x32_bf16 v[180:183], a[136:139], a[104:107], 0
v_cvt_pk_bf16_f32 v216, v216, v217
v_cvt_pk_bf16_f32 v217, v218, v219
v_mfma_f32_16x16x32_bf16 v[180:183], a[140:143], a[108:111], v[180:183]
v_cvt_pk_bf16_f32 v218, v220, v221
v_cvt_pk_bf16_f32 v219, v222, v223
v_mfma_f32_16x16x32_bf16 v[188:191], a[132:135], a[108:111], 0
v_mul_f32 v224, s91, v224
v_mul_f32 v225, s91, v225
v_mfma_f32_16x16x32_bf16 v[188:191], a[128:131], a[104:107], v[188:191]
s_waitcnt lgkmcnt(0)
v_mul_f32 v226, s91, v226
v_mul_f32 v227, s91, v227
v_mfma_f32_16x16x32_bf16 v[196:199], a[160:163], a[80:83], 0
s_waitcnt vmcnt(19)
v_mul_f32 v228, s91, v228
v_mul_f32 v229, s91, v229
v_mfma_f32_16x16x32_bf16 v[196:199], a[164:167], a[84:87], v[196:199]
s_barrier
v_mfma_f32_16x16x32_bf16 v[64:67], a[172:175], a[84:87], 0
ds_read_b64_tr_b16 a[128:129], v11 offset:32768
ds_read_b64_tr_b16 a[130:131], v11 offset:33280
v_mfma_f32_16x16x32_bf16 v[64:67], a[168:171], a[80:83], v[64:67]
s_add_u32 m0, s77, 16384
s_add_u32 s64, s76, 128
v_mul_f32 v230, s91, v230
v_mfma_f32_16x16x32_bf16 v[204:207], a[176:179], a[80:83], 0
buffer_load_dwordx4 v7, s[20:23], s64 offen lds
v_mfma_f32_16x16x32_bf16 v[204:207], a[180:183], a[84:87], v[204:207]
ds_read_b64_tr_b16 a[132:133], v11 offset:36864
ds_read_b64_tr_b16 a[134:135], v11 offset:37376
v_mfma_f32_16x16x32_bf16 v[212:215], a[188:191], a[84:87], 0
ds_read_b64_tr_b16 a[136:137], v12 offset:32768
ds_read_b64_tr_b16 a[138:139], v12 offset:33280
v_mfma_f32_16x16x32_bf16 v[212:215], a[184:187], a[80:83], v[212:215]
ds_read_b64_tr_b16 a[140:141], v12 offset:36864
ds_read_b64_tr_b16 a[142:143], v12 offset:37376
v_mfma_f32_16x16x32_bf16 v[72:75], a[112:115], a[80:83], 0
v_mul_f32 v231, s91, v231
v_cvt_pk_bf16_f32 v224, v224, v225
v_mfma_f32_16x16x32_bf16 v[72:75], a[116:119], a[84:87], v[72:75]
ds_read_b64_tr_b16 a[144:145], v13 offset:32768
ds_read_b64_tr_b16 a[146:147], v13 offset:33280
v_mfma_f32_16x16x32_bf16 v[220:223], a[124:127], a[84:87], 0
buffer_load_dwordx4 v8, s[20:23], s64 offen offset:1024 lds
v_mfma_f32_16x16x32_bf16 v[220:223], a[120:123], a[80:83], v[220:223]
ds_read_b64_tr_b16 a[148:149], v13 offset:36864
ds_read_b64_tr_b16 a[150:151], v13 offset:37376
v_mfma_f32_16x16x32_bf16 a[32:35], a[120:123], a[88:91], 0
v_cvt_pk_bf16_f32 v225, v226, v227
v_cvt_pk_bf16_f32 v226, v228, v229
v_mfma_f32_16x16x32_bf16 a[32:35], a[124:127], a[92:95], a[32:35]
ds_read_b64_tr_b16 a[152:153], v14 offset:32768
ds_read_b64_tr_b16 a[154:155], v14 offset:33280
v_mfma_f32_16x16x32_bf16 a[36:39], a[116:119], a[92:95], 0
s_add_u32 m0, s80, 16384
s_add_u32 s64, s79, 2048
v_cvt_pk_bf16_f32 v227, v230, v231
v_mfma_f32_16x16x32_bf16 a[36:39], a[112:115], a[88:91], a[36:39]
ds_read_b64_tr_b16 a[156:157], v14 offset:36864
ds_read_b64_tr_b16 a[158:159], v14 offset:37376
v_mfma_f32_16x16x32_bf16 v[228:231], a[184:187], a[88:91], 0
buffer_load_dwordx4 v15, s[24:27], s64 offen sc1 lds
v_mfma_f32_16x16x32_bf16 v[228:231], a[188:191], a[92:95], v[228:231]
s_xor_b32 s65, s70, 256
s_add_u32 s71, s68, s65
s_add_u32 s72, s69, s65
v_mfma_f32_16x16x32_bf16 a[40:43], a[180:183], a[92:95], 0
s_add_u32 s53, s88, 262144
ds_read_b128 a[64:67], v4 offset:40960
v_mul_f32 v232, s91, v232
v_mfma_f32_16x16x32_bf16 a[40:43], a[176:179], a[88:91], a[40:43]
buffer_store_dwordx4 v[80:83], v15, s[24:27], s53 offen offset:2048 sc1
v_mfma_f32_16x16x32_bf16 a[44:47], a[168:171], a[88:91], 0
s_add_u32 m0, s73, 65536
s_add_u32 s64, s71, 0
L_PAD4:
s_cbranch_execz L_PAD8
ds_read_b128 a[80:83], v9 offset:0
v_mfma_f32_16x16x32_bf16 a[44:47], a[172:175], a[92:95], a[44:47]
v_mul_f32 v233, s91, v233
v_mul_f32 v234, s91, v234
v_mfma_f32_16x16x32_bf16 v[80:83], a[164:167], a[92:95], 0
buffer_load_dwordx4 v5, s[12:15], s64 offen lds
v_mfma_f32_16x16x32_bf16 v[80:83], a[160:163], a[88:91], v[80:83]
ds_read_b128 a[68:71], v4 offset:43008
v_mul_f32 v235, s91, v235
v_mfma_f32_16x16x32_bf16 a[48:51], a[160:163], a[96:99], 0
ds_read_b128 a[84:87], v10 offset:0
v_mul_f32 v236, s91, v236
v_mfma_f32_16x16x32_bf16 a[48:51], a[164:167], a[100:103], a[48:51]
v_mul_f32 v237, s91, v237
v_mul_f32 v238, s91, v238
v_mfma_f32_16x16x32_bf16 a[52:55], a[172:175], a[100:103], 0
v_mul_f32 v239, s91, v239
v_cvt_pk_bf16_f32 v232, v232, v233
v_mfma_f32_16x16x32_bf16 a[52:55], a[168:171], a[96:99], a[52:55]
ds_read_b128 a[72:75], v4 offset:41984
v_cvt_pk_bf16_f32 v233, v234, v235
v_mfma_f32_16x16x32_bf16 a[56:59], a[176:179], a[96:99], 0
buffer_load_dwordx4 v6, s[12:15], s64 offen offset:1024 lds
v_mfma_f32_16x16x32_bf16 a[56:59], a[180:183], a[100:103], a[56:59]
ds_read_b128 a[88:91], v9 offset:2048
v_cvt_pk_bf16_f32 v234, v236, v237
v_mfma_f32_16x16x32_bf16 a[60:63], a[188:191], a[100:103], 0
v_cvt_pk_bf16_f32 v235, v238, v239
v_mul_f32 v240, s91, v240
v_mfma_f32_16x16x32_bf16 a[60:63], a[184:187], a[96:99], a[60:63]
ds_read_b128 a[76:79], v4 offset:44032
v_mul_f32 v241, s91, v241
v_mfma_f32_16x16x32_bf16 v[236:239], a[112:115], a[96:99], 0
s_add_u32 m0, s73, 67584
s_add_u32 s64, s71, 18432
v_mul_f32 v242, s91, v242
v_mfma_f32_16x16x32_bf16 v[236:239], a[116:119], a[100:103], v[236:239]
ds_read_b128 a[92:95], v10 offset:2048
v_mul_f32 v243, s91, v243
v_mfma_f32_16x16x32_bf16 a[192:195], a[124:127], a[100:103], 0
buffer_load_dwordx4 v5, s[12:15], s64 offen lds
v_mfma_f32_16x16x32_bf16 a[192:195], a[120:123], a[96:99], a[192:195]
v_mul_f32 v244, s91, v244
v_mul_f32 v245, s91, v245
v_mfma_f32_16x16x32_bf16 a[196:199], a[120:123], a[104:107], 0
v_mul_f32 v246, s91, v246
v_mul_f32 v247, s91, v247
v_mfma_f32_16x16x32_bf16 a[196:199], a[124:127], a[108:111], a[196:199]
v_cvt_pk_bf16_f32 v240, v240, v241
v_cvt_pk_bf16_f32 v241, v242, v243
v_mfma_f32_16x16x32_bf16 a[200:203], a[116:119], a[108:111], 0
v_cvt_pk_bf16_f32 v242, v244, v245
v_cvt_pk_bf16_f32 v243, v246, v247
v_mfma_f32_16x16x32_bf16 a[200:203], a[112:115], a[104:107], a[200:203]
v_mul_f32 v248, s91, v248
v_mul_f32 v249, s91, v249
v_mfma_f32_16x16x32_bf16 v[244:247], a[184:187], a[104:107], 0
buffer_load_dwordx4 v6, s[12:15], s64 offen offset:1024 lds
v_mfma_f32_16x16x32_bf16 v[244:247], a[188:191], a[108:111], v[244:247]
v_mul_f32 v250, s91, v250
v_mul_f32 v251, s91, v251
v_mfma_f32_16x16x32_bf16 a[204:207], a[180:183], a[108:111], 0
v_mul_f32 v252, s91, v252
v_mul_f32 v253, s91, v253
v_mfma_f32_16x16x32_bf16 a[204:207], a[176:179], a[104:107], a[204:207]
s_add_u32 s53, s88, 262144
v_mul_f32 v254, s91, v254
v_mul_f32 v255, s91, v255
v_mfma_f32_16x16x32_bf16 a[208:211], a[168:171], a[104:107], 0
buffer_store_dwordx4 v[88:91], v15, s[24:27], s53 offen offset:3072 sc1
v_mfma_f32_16x16x32_bf16 a[208:211], a[172:175], a[108:111], a[208:211]
v_cvt_pk_bf16_f32 v248, v248, v249
v_cvt_pk_bf16_f32 v249, v250, v251
v_mfma_f32_16x16x32_bf16 v[88:91], a[164:167], a[108:111], 0
v_cvt_pk_bf16_f32 v250, v252, v253
v_cvt_pk_bf16_f32 v251, v254, v255
v_mfma_f32_16x16x32_bf16 v[88:91], a[160:163], a[104:107], v[88:91]
s_waitcnt lgkmcnt(0)
v_accvgpr_read_b32 v16, a0
v_accvgpr_read_b32 v17, a1
v_mfma_f32_16x16x32_bf16 v[36:39], a[128:131], a[80:83], v[36:39]
s_waitcnt vmcnt(24)
v_accvgpr_read_b32 v18, a2
v_accvgpr_read_b32 v19, a3
v_mfma_f32_16x16x32_bf16 v[36:39], a[132:135], a[84:87], v[36:39]
s_barrier
v_mfma_f32_16x16x32_bf16 v[44:47], a[140:143], a[84:87], v[44:47]
ds_read_b128 a[96:99], v9 offset:4096
v_accvgpr_read_b32 v20, a4
v_mfma_f32_16x16x32_bf16 v[44:47], a[136:139], a[80:83], v[44:47]
s_xor_b32 s75, s93, 2
s_lshl_b32 s76, s75, 19
s_add_u32 s76, s76, s74
v_mfma_f32_16x16x32_bf16 v[32:35], a[144:147], a[80:83], v[32:35]
s_lshl_b32 s79, s75, 13
s_add_u32 s79, s79, s78
ds_read_b128 a[100:103], v10 offset:4096
v_mfma_f32_16x16x32_bf16 v[32:35], a[148:151], a[84:87], v[32:35]
s_add_u32 m0, s77, 32768
s_add_u32 s64, s76, 0
ds_read_b128 a[104:107], v9 offset:6144
v_mfma_f32_16x16x32_bf16 v[52:55], a[156:159], a[84:87], v[52:55]
buffer_load_dwordx4 v7, s[20:23], s64 offen lds
v_mfma_f32_16x16x32_bf16 v[52:55], a[152:155], a[80:83], v[52:55]
ds_read_b64_tr_b16 a[160:161], v11 offset:49152
ds_read_b64_tr_b16 a[162:163], v11 offset:49664
v_mfma_f32_16x16x32_bf16 v[60:63], a[64:67], a[80:83], v[60:63]
v_accvgpr_read_b32 v21, a5
v_accvgpr_read_b32 v22, a6
v_mfma_f32_16x16x32_bf16 v[60:63], a[68:71], a[84:87], v[60:63]
ds_read_b128 a[108:111], v10 offset:6144
v_accvgpr_read_b32 v23, a7
v_mfma_f32_16x16x32_bf16 v[68:71], a[76:79], a[84:87], v[68:71]
buffer_load_dwordx4 v8, s[20:23], s64 offen offset:1024 lds
v_mfma_f32_16x16x32_bf16 v[68:71], a[72:75], a[80:83], v[68:71]
ds_read_b64_tr_b16 a[164:165], v11 offset:53248
ds_read_b64_tr_b16 a[166:167], v11 offset:53760
v_mfma_f32_16x16x32_bf16 v[76:79], a[72:75], a[88:91], v[76:79]
v_add_u32 v9, 32768, v9
v_add_u32 v10, 32768, v10
v_mfma_f32_16x16x32_bf16 v[76:79], a[76:79], a[92:95], v[76:79]
ds_read_b64_tr_b16 a[168:169], v12 offset:49152
ds_read_b64_tr_b16 a[170:171], v12 offset:49664
v_mfma_f32_16x16x32_bf16 v[84:87], a[68:71], a[92:95], v[84:87]
s_add_u32 m0, s80, 32768
s_add_u32 s64, s79, 0
v_mul_f32 v16, s91, v16
v_mfma_f32_16x16x32_bf16 v[84:87], a[64:67], a[88:91], v[84:87]
ds_read_b64_tr_b16 a[172:173], v12 offset:53248
ds_read_b64_tr_b16 a[174:175], v12 offset:53760
v_mfma_f32_16x16x32_bf16 v[92:95], a[152:155], a[88:91], v[92:95]
buffer_load_dwordx4 v15, s[24:27], s64 offen sc1 lds
v_mfma_f32_16x16x32_bf16 v[92:95], a[156:159], a[92:95], v[92:95]
v_mul_f32 v17, s91, v17
v_mul_f32 v18, s91, v18
v_mfma_f32_16x16x32_bf16 v[40:43], a[148:151], a[92:95], v[40:43]
ds_read_b64_tr_b16 a[176:177], v13 offset:49152
ds_read_b64_tr_b16 a[178:179], v13 offset:49664
v_mfma_f32_16x16x32_bf16 v[40:43], a[144:147], a[88:91], v[40:43]
v_mul_f32 v19, s91, v19
v_mul_f32 v20, s91, v20
v_mfma_f32_16x16x32_bf16 v[100:103], a[136:139], a[88:91], v[100:103]
s_add_u32 m0, s73, 69632
s_add_u32 s64, s72, 0
v_mul_f32 v21, s91, v21
v_mfma_f32_16x16x32_bf16 v[100:103], a[140:143], a[92:95], v[100:103]
ds_read_b64_tr_b16 a[180:181], v13 offset:53248
ds_read_b64_tr_b16 a[182:183], v13 offset:53760
v_mfma_f32_16x16x32_bf16 v[108:111], a[132:135], a[92:95], v[108:111]
buffer_load_dwordx4 v5, s[12:15], s64 offen lds
v_mfma_f32_16x16x32_bf16 v[108:111], a[128:131], a[88:91], v[108:111]
s_waitcnt lgkmcnt(14)
ds_read_b64_tr_b16 a[184:185], v14 offset:49152
ds_read_b64_tr_b16 a[186:187], v14 offset:49664
v_mfma_f32_16x16x32_bf16 v[116:119], a[128:131], a[96:99], v[116:119]
s_add_u32 s53, s87, 0
ds_read_b64_tr_b16 a[188:189], v14 offset:53248
ds_read_b64_tr_b16 a[190:191], v14 offset:53760
v_mfma_f32_16x16x32_bf16 v[116:119], a[132:135], a[100:103], v[116:119]
buffer_store_dwordx4 v[160:163], v15, s[24:27], s53 offen offset:0 sc1
v_mfma_f32_16x16x32_bf16 v[124:127], a[140:143], a[100:103], v[124:127]
v_mul_f32 v22, s91, v22
v_mul_f32 v23, s91, v23
v_mfma_f32_16x16x32_bf16 v[124:127], a[136:139], a[96:99], v[124:127]
ds_read_b128 a[112:115], v4 offset:57344
v_cvt_pk_bf16_f32 v16, v16, v17
v_mfma_f32_16x16x32_bf16 v[132:135], a[144:147], a[96:99], v[132:135]
buffer_load_dwordx4 v6, s[12:15], s64 offen offset:1024 lds
v_mfma_f32_16x16x32_bf16 v[132:135], a[148:151], a[100:103], v[132:135]
ds_read_b128 a[116:119], v4 offset:59392
v_cvt_pk_bf16_f32 v17, v18, v19
v_mfma_f32_16x16x32_bf16 v[140:143], a[156:159], a[100:103], v[140:143]
v_cvt_pk_bf16_f32 v18, v20, v21
v_cvt_pk_bf16_f32 v19, v22, v23
v_mfma_f32_16x16x32_bf16 v[140:143], a[152:155], a[96:99], v[140:143]
ds_read_b128 a[120:123], v4 offset:58368
v_accvgpr_write_b32 a0, v16
v_mfma_f32_16x16x32_bf16 v[148:151], a[64:67], a[96:99], v[148:151]
s_add_u32 m0, s73, 71680
s_add_u32 s64, s72, 18432
v_accvgpr_write_b32 a1, v17
v_mfma_f32_16x16x32_bf16 v[148:151], a[68:71], a[100:103], v[148:151]
ds_read_b128 a[124:127], v4 offset:60416
v_accvgpr_write_b32 a2, v18
v_mfma_f32_16x16x32_bf16 v[48:51], a[76:79], a[100:103], v[48:51]
buffer_load_dwordx4 v5, s[12:15], s64 offen lds
v_mfma_f32_16x16x32_bf16 v[48:51], a[72:75], a[96:99], v[48:51]
s_waitcnt lgkmcnt(15)
v_accvgpr_write_b32 a3, v19
v_accvgpr_read_b32 v16, a8
v_mfma_f32_16x16x32_bf16 v[156:159], a[72:75], a[104:107], v[156:159]
v_accvgpr_read_b32 v17, a9
v_accvgpr_read_b32 v18, a10
v_mfma_f32_16x16x32_bf16 v[156:159], a[76:79], a[108:111], v[156:159]
v_accvgpr_read_b32 v19, a11
v_accvgpr_read_b32 v20, a12
v_mfma_f32_16x16x32_bf16 v[164:167], a[68:71], a[108:111], v[164:167]
v_accvgpr_read_b32 v21, a13
v_accvgpr_read_b32 v22, a14
v_mfma_f32_16x16x32_bf16 v[164:167], a[64:67], a[104:107], v[164:167]
v_accvgpr_read_b32 v23, a15
v_mul_f32 v16, s91, v16
v_mfma_f32_16x16x32_bf16 v[172:175], a[152:155], a[104:107], v[172:175]
buffer_load_dwordx4 v6, s[12:15], s64 offen offset:1024 lds
v_mfma_f32_16x16x32_bf16 v[172:175], a[156:159], a[108:111], v[172:175]
v_mul_f32 v17, s91, v17
v_mul_f32 v18, s91, v18
v_mfma_f32_16x16x32_bf16 v[56:59], a[148:151], a[108:111], v[56:59]
v_mul_f32 v19, s91, v19
v_mul_f32 v20, s91, v20
v_mfma_f32_16x16x32_bf16 v[56:59], a[144:147], a[104:107], v[56:59]
v_mul_f32 v21, s91, v21
v_mul_f32 v22, s91, v22
v_mfma_f32_16x16x32_bf16 v[180:183], a[136:139], a[104:107], v[180:183]
v_mul_f32 v23, s91, v23
v_cvt_pk_bf16_f32 v16, v16, v17
v_mfma_f32_16x16x32_bf16 v[180:183], a[140:143], a[108:111], v[180:183]
v_cvt_pk_bf16_f32 v17, v18, v19
v_cvt_pk_bf16_f32 v18, v20, v21
v_mfma_f32_16x16x32_bf16 v[188:191], a[132:135], a[108:111], v[188:191]
v_cvt_pk_bf16_f32 v19, v22, v23
v_accvgpr_write_b32 a8, v16
v_mfma_f32_16x16x32_bf16 v[188:191], a[128:131], a[104:107], v[188:191]
s_waitcnt lgkmcnt(0)
v_accvgpr_write_b32 a9, v17
v_accvgpr_write_b32 a10, v18
v_mfma_f32_16x16x32_bf16 v[196:199], a[160:163], a[80:83], v[196:199]
s_waitcnt vmcnt(17)
v_accvgpr_write_b32 a11, v19
v_accvgpr_read_b32 v16, a16
v_mfma_f32_16x16x32_bf16 v[196:199], a[164:167], a[84:87], v[196:199]
s_barrier
v_mfma_f32_16x16x32_bf16 v[64:67], a[172:175], a[84:87], v[64:67]
s_add_u32 s53, s87, 0
ds_read_b64_tr_b16 a[128:129], v11 offset:0
ds_read_b64_tr_b16 a[130:131], v11 offset:512
v_mfma_f32_16x16x32_bf16 v[64:67], a[168:171], a[80:83], v[64:67]
s_add_u32 m0, s77, 49152
s_add_u32 s64, s76, 128
v_accvgpr_read_b32 v17, a17
v_mfma_f32_16x16x32_bf16 v[204:207], a[176:179], a[80:83], v[204:207]
buffer_load_dwordx4 v7, s[20:23], s64 offen lds
v_mfma_f32_16x16x32_bf16 v[204:207], a[180:183], a[84:87], v[204:207]
ds_read_b64_tr_b16 a[132:133], v11 offset:4096
ds_read_b64_tr_b16 a[134:135], v11 offset:4608
v_mfma_f32_16x16x32_bf16 v[212:215], a[188:191], a[84:87], v[212:215]
ds_read_b64_tr_b16 a[136:137], v12 offset:0
ds_read_b64_tr_b16 a[138:139], v12 offset:512
v_mfma_f32_16x16x32_bf16 v[212:215], a[184:187], a[80:83], v[212:215]
ds_read_b64_tr_b16 a[140:141], v12 offset:4096
ds_read_b64_tr_b16 a[142:143], v12 offset:4608
v_mfma_f32_16x16x32_bf16 v[72:75], a[112:115], a[80:83], v[72:75]
buffer_store_dwordx4 v[168:171], v15, s[24:27], s53 offen offset:1024 sc1
v_mfma_f32_16x16x32_bf16 v[72:75], a[116:119], a[84:87], v[72:75]
ds_read_b64_tr_b16 a[144:145], v13 offset:0
ds_read_b64_tr_b16 a[146:147], v13 offset:512
v_mfma_f32_16x16x32_bf16 v[220:223], a[124:127], a[84:87], v[220:223]
buffer_load_dwordx4 v8, s[20:23], s64 offen offset:1024 lds
v_mfma_f32_16x16x32_bf16 v[220:223], a[120:123], a[80:83], v[220:223]
ds_read_b64_tr_b16 a[148:149], v13 offset:4096
ds_read_b64_tr_b16 a[150:151], v13 offset:4608
v_mfma_f32_16x16x32_bf16 a[32:35], a[120:123], a[88:91], a[32:35]
v_accvgpr_read_b32 v18, a18
v_accvgpr_read_b32 v19, a19
v_mfma_f32_16x16x32_bf16 a[32:35], a[124:127], a[92:95], a[32:35]
ds_read_b64_tr_b16 a[152:153], v14 offset:0
ds_read_b64_tr_b16 a[154:155], v14 offset:512
v_mfma_f32_16x16x32_bf16 a[36:39], a[116:119], a[92:95], a[36:39]
s_add_u32 m0, s80, 49152
s_add_u32 s64, s79, 2048
v_accvgpr_read_b32 v20, a20
v_mfma_f32_16x16x32_bf16 a[36:39], a[112:115], a[88:91], a[36:39]
ds_read_b64_tr_b16 a[156:157], v14 offset:4096
ds_read_b64_tr_b16 a[158:159], v14 offset:4608
v_mfma_f32_16x16x32_bf16 v[228:231], a[184:187], a[88:91], v[228:231]
buffer_load_dwordx4 v15, s[24:27], s64 offen sc1 lds
v_mfma_f32_16x16x32_bf16 v[228:231], a[188:191], a[92:95], v[228:231]
s_xor_b32 s65, s70, 384
s_add_u32 s71, s68, s65
s_add_u32 s72, s69, s65
v_mfma_f32_16x16x32_bf16 a[40:43], a[180:183], a[92:95], a[40:43]
ds_read_b128 a[64:67], v4 offset:8192
v_accvgpr_read_b32 v21, a21
v_mfma_f32_16x16x32_bf16 a[40:43], a[176:179], a[88:91], a[40:43]
v_accvgpr_read_b32 v22, a22
v_accvgpr_read_b32 v23, a23
v_mfma_f32_16x16x32_bf16 a[44:47], a[168:171], a[88:91], a[44:47]
s_add_u32 m0, s73, 0
s_add_u32 s64, s71, 0
ds_read_b128 a[80:83], v9 offset:0
v_mfma_f32_16x16x32_bf16 a[44:47], a[172:175], a[92:95], a[44:47]
v_mul_f32 v16, s91, v16
v_mul_f32 v17, s91, v17
v_mfma_f32_16x16x32_bf16 v[80:83], a[164:167], a[92:95], v[80:83]
buffer_load_dwordx4 v5, s[12:15], s64 offen lds
v_mfma_f32_16x16x32_bf16 v[80:83], a[160:163], a[88:91], v[80:83]
ds_read_b128 a[68:71], v4 offset:10240
v_mul_f32 v18, s91, v18
v_mfma_f32_16x16x32_bf16 a[48:51], a[160:163], a[96:99], a[48:51]
ds_read_b128 a[84:87], v10 offset:0
v_mul_f32 v19, s91, v19
v_mfma_f32_16x16x32_bf16 a[48:51], a[164:167], a[100:103], a[48:51]
v_mul_f32 v20, s91, v20
v_mul_f32 v21, s91, v21
v_mfma_f32_16x16x32_bf16 a[52:55], a[172:175], a[100:103], a[52:55]
v_mul_f32 v22, s91, v22
v_mul_f32 v23, s91, v23
v_mfma_f32_16x16x32_bf16 a[52:55], a[168:171], a[96:99], a[52:55]
ds_read_b128 a[72:75], v4 offset:9216
v_cvt_pk_bf16_f32 v16, v16, v17
v_mfma_f32_16x16x32_bf16 a[56:59], a[176:179], a[96:99], a[56:59]
buffer_load_dwordx4 v6, s[12:15], s64 offen offset:1024 lds
v_mfma_f32_16x16x32_bf16 a[56:59], a[180:183], a[100:103], a[56:59]
s_add_u32 s53, s87, 4096
ds_read_b128 a[88:91], v9 offset:2048
v_cvt_pk_bf16_f32 v17, v18, v19
v_mfma_f32_16x16x32_bf16 a[60:63], a[188:191], a[100:103], a[60:63]
buffer_store_dwordx4 v[176:179], v15, s[24:27], s53 offen offset:0 sc1
v_mfma_f32_16x16x32_bf16 a[60:63], a[184:187], a[96:99], a[60:63]
ds_read_b128 a[76:79], v4 offset:11264
v_cvt_pk_bf16_f32 v18, v20, v21
v_mfma_f32_16x16x32_bf16 v[236:239], a[112:115], a[96:99], v[236:239]
s_add_u32 m0, s73, 2048
s_add_u32 s64, s71, 18432
v_cvt_pk_bf16_f32 v19, v22, v23
v_mfma_f32_16x16x32_bf16 v[236:239], a[116:119], a[100:103], v[236:239]
ds_read_b128 a[92:95], v10 offset:2048
v_accvgpr_write_b32 a16, v16
v_mfma_f32_16x16x32_bf16 a[192:195], a[124:127], a[100:103], a[192:195]
buffer_load_dwordx4 v5, s[12:15], s64 offen lds
v_mfma_f32_16x16x32_bf16 a[192:195], a[120:123], a[96:99], a[192:195]
v_accvgpr_write_b32 a17, v17
v_accvgpr_write_b32 a18, v18
v_mfma_f32_16x16x32_bf16 a[196:199], a[120:123], a[104:107], a[196:199]
v_accvgpr_write_b32 a19, v19
v_accvgpr_read_b32 v16, a24
v_mfma_f32_16x16x32_bf16 a[196:199], a[124:127], a[108:111], a[196:199]
v_accvgpr_read_b32 v17, a25
v_accvgpr_read_b32 v18, a26
v_mfma_f32_16x16x32_bf16 a[200:203], a[116:119], a[108:111], a[200:203]
v_accvgpr_read_b32 v19, a27
v_accvgpr_read_b32 v20, a28
v_mfma_f32_16x16x32_bf16 a[200:203], a[112:115], a[104:107], a[200:203]
v_accvgpr_read_b32 v21, a29
v_accvgpr_read_b32 v22, a30
v_mfma_f32_16x16x32_bf16 v[244:247], a[184:187], a[104:107], v[244:247]
buffer_load_dwordx4 v6, s[12:15], s64 offen offset:1024 lds
v_mfma_f32_16x16x32_bf16 v[244:247], a[188:191], a[108:111], v[244:247]
v_accvgpr_read_b32 v23, a31
v_mul_f32 v16, s91, v16
v_mfma_f32_16x16x32_bf16 a[204:207], a[180:183], a[108:111], a[204:207]
v_mul_f32 v17, s91, v17
v_mul_f32 v18, s91, v18
v_mfma_f32_16x16x32_bf16 a[204:207], a[176:179], a[104:107], a[204:207]
v_mul_f32 v19, s91, v19
v_mul_f32 v20, s91, v20
v_mfma_f32_16x16x32_bf16 a[208:211], a[168:171], a[104:107], a[208:211]
v_mul_f32 v21, s91, v21
v_mul_f32 v22, s91, v22
v_mfma_f32_16x16x32_bf16 a[208:211], a[172:175], a[108:111], a[208:211]
v_mul_f32 v23, s91, v23
v_cvt_pk_bf16_f32 v16, v16, v17
v_mfma_f32_16x16x32_bf16 v[88:91], a[164:167], a[108:111], v[88:91]
v_cvt_pk_bf16_f32 v17, v18, v19
v_cvt_pk_bf16_f32 v18, v20, v21
v_mfma_f32_16x16x32_bf16 v[88:91], a[160:163], a[104:107], v[88:91]
s_waitcnt lgkmcnt(0)
v_cvt_pk_bf16_f32 v19, v22, v23
v_accvgpr_write_b32 a24, v16
v_mfma_f32_16x16x32_bf16 v[36:39], a[128:131], a[80:83], v[36:39]
s_waitcnt vmcnt(23)
v_accvgpr_write_b32 a25, v17
v_accvgpr_write_b32 a26, v18
v_mfma_f32_16x16x32_bf16 v[36:39], a[132:135], a[84:87], v[36:39]
s_barrier
v_mfma_f32_16x16x32_bf16 v[44:47], a[140:143], a[84:87], v[44:47]
ds_read_b128 a[96:99], v9 offset:4096
v_accvgpr_write_b32 a27, v19
v_mfma_f32_16x16x32_bf16 v[44:47], a[136:139], a[80:83], v[44:47]
s_xor_b32 s75, s93, 3
s_lshl_b32 s76, s75, 19
s_add_u32 s76, s76, s74
v_mfma_f32_16x16x32_bf16 v[32:35], a[144:147], a[80:83], v[32:35]
s_lshl_b32 s79, s75, 13
s_add_u32 s79, s79, s78
ds_read_b128 a[100:103], v10 offset:4096
v_mfma_f32_16x16x32_bf16 v[32:35], a[148:151], a[84:87], v[32:35]
s_add_u32 m0, s77, 0
s_add_u32 s64, s76, 0
ds_read_b128 a[104:107], v9 offset:6144
v_mfma_f32_16x16x32_bf16 v[52:55], a[156:159], a[84:87], v[52:55]
buffer_load_dwordx4 v7, s[20:23], s64 offen lds
v_mfma_f32_16x16x32_bf16 v[52:55], a[152:155], a[80:83], v[52:55]
s_add_u32 s53, s87, 4096
ds_read_b64_tr_b16 a[160:161], v11 offset:16384
ds_read_b64_tr_b16 a[162:163], v11 offset:16896
v_mfma_f32_16x16x32_bf16 v[60:63], a[64:67], a[80:83], v[60:63]
buffer_store_dwordx4 v[184:187], v15, s[24:27], s53 offen offset:1024 sc1
v_mfma_f32_16x16x32_bf16 v[60:63], a[68:71], a[84:87], v[60:63]
ds_read_b128 a[108:111], v10 offset:6144
v_accvgpr_write_b32 a4, v248
v_mfma_f32_16x16x32_bf16 v[68:71], a[76:79], a[84:87], v[68:71]
buffer_load_dwordx4 v8, s[20:23], s64 offen offset:1024 lds
v_mfma_f32_16x16x32_bf16 v[68:71], a[72:75], a[80:83], v[68:71]
ds_read_b64_tr_b16 a[164:165], v11 offset:20480
ds_read_b64_tr_b16 a[166:167], v11 offset:20992
v_mfma_f32_16x16x32_bf16 v[76:79], a[72:75], a[88:91], v[76:79]
v_add_u32 v9, 32768, v9
v_add_u32 v10, 32768, v10
v_mfma_f32_16x16x32_bf16 v[76:79], a[76:79], a[92:95], v[76:79]
ds_read_b64_tr_b16 a[168:169], v12 offset:16384
ds_read_b64_tr_b16 a[170:171], v12 offset:16896
v_mfma_f32_16x16x32_bf16 v[84:87], a[68:71], a[92:95], v[84:87]
s_add_u32 m0, s80, 0
s_add_u32 s64, s79, 0
v_accvgpr_write_b32 a5, v249
v_mfma_f32_16x16x32_bf16 v[84:87], a[64:67], a[88:91], v[84:87]
ds_read_b64_tr_b16 a[172:173], v12 offset:20480
ds_read_b64_tr_b16 a[174:175], v12 offset:20992
v_mfma_f32_16x16x32_bf16 v[92:95], a[152:155], a[88:91], v[92:95]
buffer_load_dwordx4 v15, s[24:27], s64 offen sc1 lds
v_mfma_f32_16x16x32_bf16 v[92:95], a[156:159], a[92:95], v[92:95]
v_accvgpr_write_b32 a6, v250
v_accvgpr_write_b32 a7, v251
v_mfma_f32_16x16x32_bf16 v[40:43], a[148:151], a[92:95], v[40:43]
ds_read_b64_tr_b16 a[176:177], v13 offset:16384
ds_read_b64_tr_b16 a[178:179], v13 offset:16896
v_mfma_f32_16x16x32_bf16 v[40:43], a[144:147], a[88:91], v[40:43]
v_accvgpr_write_b32 a12, v240
v_accvgpr_write_b32 a13, v241
v_mfma_f32_16x16x32_bf16 v[100:103], a[136:139], a[88:91], v[100:103]
s_add_u32 m0, s73, 4096
s_add_u32 s64, s72, 0
v_accvgpr_write_b32 a14, v242
v_mfma_f32_16x16x32_bf16 v[100:103], a[140:143], a[92:95], v[100:103]
ds_read_b64_tr_b16 a[180:181], v13 offset:20480
ds_read_b64_tr_b16 a[182:183], v13 offset:20992
v_mfma_f32_16x16x32_bf16 v[108:111], a[132:135], a[92:95], v[108:111]
buffer_load_dwordx4 v5, s[12:15], s64 offen lds
v_mfma_f32_16x16x32_bf16 v[108:111], a[128:131], a[88:91], v[108:111]
s_waitcnt lgkmcnt(14)
ds_read_b64_tr_b16 a[184:185], v14 offset:16384
ds_read_b64_tr_b16 a[186:187], v14 offset:16896
v_mfma_f32_16x16x32_bf16 v[116:119], a[128:131], a[96:99], v[116:119]
ds_read_b64_tr_b16 a[188:189], v14 offset:20480
ds_read_b64_tr_b16 a[190:191], v14 offset:20992
v_mfma_f32_16x16x32_bf16 v[116:119], a[132:135], a[100:103], v[116:119]
v_accvgpr_write_b32 a15, v243
v_accvgpr_write_b32 a20, v232
v_mfma_f32_16x16x32_bf16 v[124:127], a[140:143], a[100:103], v[124:127]
v_accvgpr_write_b32 a21, v233
v_accvgpr_write_b32 a22, v234
v_mfma_f32_16x16x32_bf16 v[124:127], a[136:139], a[96:99], v[124:127]
ds_read_b128 a[112:115], v4 offset:24576
v_accvgpr_write_b32 a23, v235
v_mfma_f32_16x16x32_bf16 v[132:135], a[144:147], a[96:99], v[132:135]
buffer_load_dwordx4 v6, s[12:15], s64 offen offset:1024 lds
v_mfma_f32_16x16x32_bf16 v[132:135], a[148:151], a[100:103], v[132:135]
ds_read_b128 a[116:119], v4 offset:26624
v_accvgpr_write_b32 a28, v224
v_mfma_f32_16x16x32_bf16 v[140:143], a[156:159], a[100:103], v[140:143]
v_accvgpr_write_b32 a29, v225
v_accvgpr_write_b32 a30, v226
v_mfma_f32_16x16x32_bf16 v[140:143], a[152:155], a[96:99], v[140:143]
ds_read_b128 a[120:123], v4 offset:25600
v_accvgpr_write_b32 a31, v227
v_mfma_f32_16x16x32_bf16 v[148:151], a[64:67], a[96:99], v[148:151]
s_add_u32 m0, s73, 6144
s_add_u32 s64, s72, 18432
v_accvgpr_read_b32 v252, a32
v_mfma_f32_16x16x32_bf16 v[148:151], a[68:71], a[100:103], v[148:151]
ds_read_b128 a[124:127], v4 offset:27648
v_accvgpr_read_b32 v253, a33
v_mfma_f32_16x16x32_bf16 v[48:51], a[76:79], a[100:103], v[48:51]
buffer_load_dwordx4 v5, s[12:15], s64 offen lds
v_mfma_f32_16x16x32_bf16 v[48:51], a[72:75], a[96:99], v[48:51]
s_waitcnt lgkmcnt(15)
s_add_u32 s53, s87, 262144
v_accvgpr_read_b32 v254, a34
v_mfma_f32_16x16x32_bf16 v[156:159], a[72:75], a[104:107], v[156:159]
buffer_store_dwordx4 v[192:195], v15, s[24:27], s53 offen offset:0 sc1
v_mfma_f32_16x16x32_bf16 v[156:159], a[76:79], a[108:111], v[156:159]
v_accvgpr_read_b32 v255, a35
v_accvgpr_read_b32 v160, a36
v_mfma_f32_16x16x32_bf16 v[164:167], a[68:71], a[108:111], v[164:167]
v_accvgpr_read_b32 v161, a37
v_accvgpr_read_b32 v162, a38
v_mfma_f32_16x16x32_bf16 v[164:167], a[64:67], a[104:107], v[164:167]
v_accvgpr_read_b32 v163, a39
v_accvgpr_read_b32 v168, a40
v_mfma_f32_16x16x32_bf16 v[172:175], a[152:155], a[104:107], v[172:175]
buffer_load_dwordx4 v6, s[12:15], s64 offen offset:1024 lds
v_mfma_f32_16x16x32_bf16 v[172:175], a[156:159], a[108:111], v[172:175]
v_accvgpr_read_b32 v169, a41
v_accvgpr_read_b32 v170, a42
v_mfma_f32_16x16x32_bf16 v[56:59], a[148:151], a[108:111], v[56:59]
v_accvgpr_read_b32 v171, a43
v_accvgpr_read_b32 v176, a44
v_mfma_f32_16x16x32_bf16 v[56:59], a[144:147], a[104:107], v[56:59]
v_accvgpr_read_b32 v177, a45
v_accvgpr_read_b32 v178, a46
v_mfma_f32_16x16x32_bf16 v[180:183], a[136:139], a[104:107], v[180:183]
v_accvgpr_read_b32 v179, a47
v_accvgpr_read_b32 v184, a48
v_mfma_f32_16x16x32_bf16 v[180:183], a[140:143], a[108:111], v[180:183]
v_accvgpr_read_b32 v185, a49
v_accvgpr_read_b32 v186, a50
v_mfma_f32_16x16x32_bf16 v[188:191], a[132:135], a[108:111], v[188:191]
v_accvgpr_read_b32 v187, a51
v_accvgpr_read_b32 v248, a52
v_mfma_f32_16x16x32_bf16 v[188:191], a[128:131], a[104:107], v[188:191]
s_waitcnt lgkmcnt(0)
v_accvgpr_read_b32 v249, a53
v_accvgpr_read_b32 v250, a54
v_mfma_f32_16x16x32_bf16 v[196:199], a[160:163], a[80:83], v[196:199]
s_waitcnt vmcnt(18)
v_accvgpr_read_b32 v251, a55
v_accvgpr_read_b32 v240, a56
v_mfma_f32_16x16x32_bf16 v[196:199], a[164:167], a[84:87], v[196:199]
s_barrier
v_mfma_f32_16x16x32_bf16 v[64:67], a[172:175], a[84:87], v[64:67]
ds_read_b64_tr_b16 a[128:129], v11 offset:32768
ds_read_b64_tr_b16 a[130:131], v11 offset:33280
v_mfma_f32_16x16x32_bf16 v[64:67], a[168:171], a[80:83], v[64:67]
s_add_u32 m0, s77, 16384
s_add_u32 s64, s76, 128
v_accvgpr_read_b32 v241, a57
v_mfma_f32_16x16x32_bf16 v[204:207], a[176:179], a[80:83], v[204:207]
buffer_load_dwordx4 v7, s[20:23], s64 offen lds
v_mfma_f32_16x16x32_bf16 v[204:207], a[180:183], a[84:87], v[204:207]
ds_read_b64_tr_b16 a[132:133], v11 offset:36864
ds_read_b64_tr_b16 a[134:135], v11 offset:37376
v_mfma_f32_16x16x32_bf16 v[212:215], a[188:191], a[84:87], v[212:215]
ds_read_b64_tr_b16 a[136:137], v12 offset:32768
ds_read_b64_tr_b16 a[138:139], v12 offset:33280
v_mfma_f32_16x16x32_bf16 v[212:215], a[184:187], a[80:83], v[212:215]
ds_read_b64_tr_b16 a[140:141], v12 offset:36864
ds_read_b64_tr_b16 a[142:143], v12 offset:37376
v_mfma_f32_16x16x32_bf16 v[72:75], a[112:115], a[80:83], v[72:75]
v_accvgpr_read_b32 v242, a58
v_accvgpr_read_b32 v243, a59
v_mfma_f32_16x16x32_bf16 v[72:75], a[116:119], a[84:87], v[72:75]
ds_read_b64_tr_b16 a[144:145], v13 offset:32768
ds_read_b64_tr_b16 a[146:147], v13 offset:33280
v_mfma_f32_16x16x32_bf16 v[220:223], a[124:127], a[84:87], v[220:223]
buffer_load_dwordx4 v8, s[20:23], s64 offen offset:1024 lds
v_mfma_f32_16x16x32_bf16 v[220:223], a[120:123], a[80:83], v[220:223]
ds_read_b64_tr_b16 a[148:149], v13 offset:36864
ds_read_b64_tr_b16 a[150:151], v13 offset:37376
v_mfma_f32_16x16x32_bf16 v[252:255], a[120:123], a[88:91], v[252:255]
v_accvgpr_read_b32 v232, a60
v_accvgpr_read_b32 v233, a61
v_mfma_f32_16x16x32_bf16 v[252:255], a[124:127], a[92:95], v[252:255]
s_add_u32 s53, s87, 262144
ds_read_b64_tr_b16 a[152:153], v14 offset:32768
ds_read_b64_tr_b16 a[154:155], v14 offset:33280
v_mfma_f32_16x16x32_bf16 v[160:163], a[116:119], a[92:95], v[160:163]
s_add_u32 m0, s80, 16384
s_add_u32 s64, s79, 2048
L_PAD5:
s_cbranch_execz L_PAD9
v_accvgpr_read_b32 v234, a62
v_mfma_f32_16x16x32_bf16 v[160:163], a[112:115], a[88:91], v[160:163]
ds_read_b64_tr_b16 a[156:157], v14 offset:36864
ds_read_b64_tr_b16 a[158:159], v14 offset:37376
v_mfma_f32_16x16x32_bf16 v[228:231], a[184:187], a[88:91], v[228:231]
buffer_load_dwordx4 v15, s[24:27], s64 offen sc1 lds
v_mfma_f32_16x16x32_bf16 v[228:231], a[188:191], a[92:95], v[228:231]
s_xor_b32 s65, s70, 512
s_add_u32 s71, s68, s65
s_add_u32 s72, s69, s65
v_mfma_f32_16x16x32_bf16 v[168:171], a[180:183], a[92:95], v[168:171]
ds_read_b128 a[64:67], v4 offset:40960
v_accvgpr_read_b32 v235, a63
v_mfma_f32_16x16x32_bf16 v[168:171], a[176:179], a[88:91], v[168:171]
buffer_store_dwordx4 v[200:203], v15, s[24:27], s53 offen offset:1024 sc1
v_mfma_f32_16x16x32_bf16 v[176:179], a[168:171], a[88:91], v[176:179]
s_add_u32 m0, s73, 32768
s_add_u32 s64, s71, 0
ds_read_b128 a[80:83], v9 offset:0
v_mfma_f32_16x16x32_bf16 v[176:179], a[172:175], a[92:95], v[176:179]
v_accvgpr_read_b32 v224, a192
v_accvgpr_read_b32 v225, a193
v_mfma_f32_16x16x32_bf16 v[80:83], a[164:167], a[92:95], v[80:83]
buffer_load_dwordx4 v5, s[12:15], s64 offen lds
v_mfma_f32_16x16x32_bf16 v[80:83], a[160:163], a[88:91], v[80:83]
ds_read_b128 a[68:71], v4 offset:43008
v_accvgpr_read_b32 v226, a194
v_mfma_f32_16x16x32_bf16 v[184:187], a[160:163], a[96:99], v[184:187]
ds_read_b128 a[84:87], v10 offset:0
v_accvgpr_read_b32 v227, a195
v_mfma_f32_16x16x32_bf16 v[184:187], a[164:167], a[100:103], v[184:187]
v_accvgpr_read_b32 v192, a204
v_accvgpr_read_b32 v193, a205
v_mfma_f32_16x16x32_bf16 v[248:251], a[172:175], a[100:103], v[248:251]
v_accvgpr_read_b32 v194, a206
v_accvgpr_read_b32 v195, a207
v_mfma_f32_16x16x32_bf16 v[248:251], a[168:171], a[96:99], v[248:251]
ds_read_b128 a[72:75], v4 offset:41984
v_accvgpr_read_b32 v200, a208
v_mfma_f32_16x16x32_bf16 v[240:243], a[176:179], a[96:99], v[240:243]
buffer_load_dwordx4 v6, s[12:15], s64 offen offset:1024 lds
v_mfma_f32_16x16x32_bf16 v[240:243], a[180:183], a[100:103], v[240:243]
ds_read_b128 a[88:91], v9 offset:2048
v_accvgpr_read_b32 v201, a209
v_mfma_f32_16x16x32_bf16 v[232:235], a[188:191], a[100:103], v[232:235]
v_accvgpr_read_b32 v202, a210
v_accvgpr_read_b32 v203, a211
v_mfma_f32_16x16x32_bf16 v[232:235], a[184:187], a[96:99], v[232:235]
ds_read_b128 a[76:79], v4 offset:44032
v_and_b32 v28, 31, v1
v_mfma_f32_16x16x32_bf16 v[236:239], a[112:115], a[96:99], v[236:239]
s_add_u32 m0, s73, 34816
s_add_u32 s64, s71, 18432
v_lshlrev_b32 v28, 2, v28
v_mfma_f32_16x16x32_bf16 v[236:239], a[116:119], a[100:103], v[236:239]
ds_read_b128 a[92:95], v10 offset:2048
v_mfma_f32_16x16x32_bf16 v[224:227], a[124:127], a[100:103], v[224:227]
buffer_load_dwordx4 v5, s[12:15], s64 offen lds
v_mfma_f32_16x16x32_bf16 v[224:227], a[120:123], a[96:99], v[224:227]
buffer_load_dword v30, v28, s[40:43], 0 offen sc1
v_mfma_f32_16x16x32_bf16 a[196:199], a[120:123], a[104:107], a[196:199]
v_mfma_f32_16x16x32_bf16 a[196:199], a[124:127], a[108:111], a[196:199]
v_mfma_f32_16x16x32_bf16 a[200:203], a[116:119], a[108:111], a[200:203]
v_mfma_f32_16x16x32_bf16 a[200:203], a[112:115], a[104:107], a[200:203]
v_mfma_f32_16x16x32_bf16 v[244:247], a[184:187], a[104:107], v[244:247]
buffer_load_dwordx4 v6, s[12:15], s64 offen offset:1024 lds
v_mfma_f32_16x16x32_bf16 v[244:247], a[188:191], a[108:111], v[244:247]
s_add_u32 s53, s87, 266240
v_mfma_f32_16x16x32_bf16 v[192:195], a[180:183], a[108:111], v[192:195]
buffer_store_dwordx4 v[208:211], v15, s[24:27], s53 offen offset:0 sc1
v_mfma_f32_16x16x32_bf16 v[192:195], a[176:179], a[104:107], v[192:195]
v_mfma_f32_16x16x32_bf16 v[200:203], a[168:171], a[104:107], v[200:203]
v_mfma_f32_16x16x32_bf16 v[200:203], a[172:175], a[108:111], v[200:203]
v_accvgpr_read_b32 v208, a196
v_accvgpr_read_b32 v209, a197
v_mfma_f32_16x16x32_bf16 v[88:91], a[164:167], a[108:111], v[88:91]
v_accvgpr_read_b32 v210, a198
v_accvgpr_read_b32 v211, a199
v_mfma_f32_16x16x32_bf16 v[88:91], a[160:163], a[104:107], v[88:91]
s_waitcnt lgkmcnt(0)
v_mfma_f32_16x16x32_bf16 v[36:39], a[128:131], a[80:83], v[36:39]
s_waitcnt vmcnt(24)
v_mfma_f32_16x16x32_bf16 v[36:39], a[132:135], a[84:87], v[36:39]
s_barrier
v_mfma_f32_16x16x32_bf16 v[44:47], a[140:143], a[84:87], v[44:47]
ds_read_b128 a[96:99], v9 offset:4096
v_mfma_f32_16x16x32_bf16 v[44:47], a[136:139], a[80:83], v[44:47]
s_xor_b32 s75, s93, 4
s_lshl_b32 s76, s75, 19
s_add_u32 s76, s76, s74
v_mfma_f32_16x16x32_bf16 v[32:35], a[144:147], a[80:83], v[32:35]
s_lshl_b32 s79, s75, 13
s_add_u32 s79, s79, s78
ds_read_b128 a[100:103], v10 offset:4096
v_mfma_f32_16x16x32_bf16 v[32:35], a[148:151], a[84:87], v[32:35]
s_add_u32 m0, s77, 32768
s_add_u32 s64, s76, 0
ds_read_b128 a[104:107], v9 offset:6144
v_mfma_f32_16x16x32_bf16 v[52:55], a[156:159], a[84:87], v[52:55]
buffer_load_dwordx4 v7, s[20:23], s64 offen lds
v_mfma_f32_16x16x32_bf16 v[52:55], a[152:155], a[80:83], v[52:55]
ds_read_b64_tr_b16 a[160:161], v11 offset:49152
ds_read_b64_tr_b16 a[162:163], v11 offset:49664
v_mfma_f32_16x16x32_bf16 v[60:63], a[64:67], a[80:83], v[60:63]
v_mfma_f32_16x16x32_bf16 v[60:63], a[68:71], a[84:87], v[60:63]
ds_read_b128 a[108:111], v10 offset:6144
v_mfma_f32_16x16x32_bf16 v[68:71], a[76:79], a[84:87], v[68:71]
buffer_load_dwordx4 v8, s[20:23], s64 offen offset:1024 lds
v_mfma_f32_16x16x32_bf16 v[68:71], a[72:75], a[80:83], v[68:71]
ds_read_b64_tr_b16 a[164:165], v11 offset:53248
ds_read_b64_tr_b16 a[166:167], v11 offset:53760
v_mfma_f32_16x16x32_bf16 v[76:79], a[72:75], a[88:91], v[76:79]
v_add_u32 v9, -65536, v9
v_add_u32 v10, -65536, v10
v_mfma_f32_16x16x32_bf16 v[76:79], a[76:79], a[92:95], v[76:79]
ds_read_b64_tr_b16 a[168:169], v12 offset:49152
ds_read_b64_tr_b16 a[170:171], v12 offset:49664
v_mfma_f32_16x16x32_bf16 v[84:87], a[68:71], a[92:95], v[84:87]
s_add_u32 m0, s80, 32768
s_add_u32 s64, s79, 0
v_mfma_f32_16x16x32_bf16 v[84:87], a[64:67], a[88:91], v[84:87]
ds_read_b64_tr_b16 a[172:173], v12 offset:53248
ds_read_b64_tr_b16 a[174:175], v12 offset:53760
v_mfma_f32_16x16x32_bf16 v[92:95], a[152:155], a[88:91], v[92:95]
buffer_load_dwordx4 v15, s[24:27], s64 offen sc1 lds
v_mfma_f32_16x16x32_bf16 v[92:95], a[156:159], a[92:95], v[92:95]
v_mfma_f32_16x16x32_bf16 v[40:43], a[148:151], a[92:95], v[40:43]
ds_read_b64_tr_b16 a[176:177], v13 offset:49152
ds_read_b64_tr_b16 a[178:179], v13 offset:49664
v_mfma_f32_16x16x32_bf16 v[40:43], a[144:147], a[88:91], v[40:43]
s_add_u32 s53, s87, 266240
v_mfma_f32_16x16x32_bf16 v[100:103], a[136:139], a[88:91], v[100:103]
s_add_u32 m0, s73, 36864
s_add_u32 s64, s72, 0
v_mfma_f32_16x16x32_bf16 v[100:103], a[140:143], a[92:95], v[100:103]
ds_read_b64_tr_b16 a[180:181], v13 offset:53248
ds_read_b64_tr_b16 a[182:183], v13 offset:53760
v_mfma_f32_16x16x32_bf16 v[108:111], a[132:135], a[92:95], v[108:111]
buffer_load_dwordx4 v5, s[12:15], s64 offen lds
v_mfma_f32_16x16x32_bf16 v[108:111], a[128:131], a[88:91], v[108:111]
s_waitcnt lgkmcnt(14)
ds_read_b64_tr_b16 a[184:185], v14 offset:49152
ds_read_b64_tr_b16 a[186:187], v14 offset:49664
v_mfma_f32_16x16x32_bf16 v[116:119], a[128:131], a[96:99], v[116:119]
ds_read_b64_tr_b16 a[188:189], v14 offset:53248
ds_read_b64_tr_b16 a[190:191], v14 offset:53760
v_mfma_f32_16x16x32_bf16 v[116:119], a[132:135], a[100:103], v[116:119]
buffer_store_dwordx4 v[216:219], v15, s[24:27], s53 offen offset:1024 sc1
v_mfma_f32_16x16x32_bf16 v[124:127], a[140:143], a[100:103], v[124:127]
v_mfma_f32_16x16x32_bf16 v[124:127], a[136:139], a[96:99], v[124:127]
ds_read_b128 a[112:115], v4 offset:57344
v_accvgpr_read_b32 v216, a200
v_mfma_f32_16x16x32_bf16 v[132:135], a[144:147], a[96:99], v[132:135]
buffer_load_dwordx4 v6, s[12:15], s64 offen offset:1024 lds
v_mfma_f32_16x16x32_bf16 v[132:135], a[148:151], a[100:103], v[132:135]
ds_read_b128 a[116:119], v4 offset:59392
v_accvgpr_read_b32 v217, a201
v_mfma_f32_16x16x32_bf16 v[140:143], a[156:159], a[100:103], v[140:143]
v_accvgpr_read_b32 v218, a202
v_accvgpr_read_b32 v219, a203
v_mfma_f32_16x16x32_bf16 v[140:143], a[152:155], a[96:99], v[140:143]
s_lshr_b32 s84, s7, 1
s_and_b32 s85, s7, 1
ds_read_b128 a[120:123], v4 offset:58368
v_mfma_f32_16x16x32_bf16 v[148:151], a[64:67], a[96:99], v[148:151]
s_add_u32 m0, s73, 38912
s_add_u32 s64, s72, 18432
s_xor_b32 s52, s5, 0
v_mfma_f32_16x16x32_bf16 v[148:151], a[68:71], a[100:103], v[148:151]
s_lshl1_add_u32 s85, s52, s85
s_and_b32 s86, s6, 3
ds_read_b128 a[124:127], v4 offset:60416
v_mfma_f32_16x16x32_bf16 v[48:51], a[76:79], a[100:103], v[48:51]
buffer_load_dwordx4 v5, s[12:15], s64 offen lds
v_mfma_f32_16x16x32_bf16 v[48:51], a[72:75], a[96:99], v[48:51]
s_waitcnt lgkmcnt(15)
s_lshl_b32 s83, s3, 13
s_add_u32 s83, s83, 131072
v_mfma_f32_16x16x32_bf16 v[156:159], a[72:75], a[104:107], v[156:159]
s_mul_i32 s52, s2, 5462
s_lshr_b32 s52, s52, 16
s_mul_i32 s54, s52, 12
v_mfma_f32_16x16x32_bf16 v[156:159], a[76:79], a[108:111], v[156:159]
s_sub_u32 s54, s2, s54
s_mul_i32 s54, s54, 3
s_add_u32 s54, s54, s3
v_mfma_f32_16x16x32_bf16 v[164:167], a[68:71], a[108:111], v[164:167]
s_mul_i32 s55, s52, 13108
s_lshr_b32 s55, s55, 16
s_mul_i32 s82, s55, 5
v_mfma_f32_16x16x32_bf16 v[164:167], a[64:67], a[104:107], v[164:167]
s_sub_u32 s52, s52, s82
v_mfma_f32_16x16x32_bf16 v[172:175], a[152:155], a[104:107], v[172:175]
buffer_load_dwordx4 v6, s[12:15], s64 offen offset:1024 lds
v_mfma_f32_16x16x32_bf16 v[172:175], a[156:159], a[108:111], v[172:175]
v_lshrrev_b32 v16, 1, v1
v_and_b32 v17, 1, v1
v_mfma_f32_16x16x32_bf16 v[56:59], a[148:151], a[108:111], v[56:59]
v_mul_u32_u24 v18, 1152, v16
v_lshl_add_u32 v18, v17, 4, v18
v_mfma_f32_16x16x32_bf16 v[56:59], a[144:147], a[104:107], v[56:59]
v_mov_b32 v24, v18
v_lshrrev_b32 v18, 4, v16
v_mfma_f32_16x16x32_bf16 v[180:183], a[136:139], a[104:107], v[180:183]
v_bfe_u32 v19, v16, 2, 2
v_and_b32 v16, 3, v16
v_mfma_f32_16x16x32_bf16 v[180:183], a[140:143], a[108:111], v[180:183]
v_lshrrev_b32 v20, 1, v19
v_mul_u32_u24 v20, 18, v20
v_mfma_f32_16x16x32_bf16 v[188:191], a[132:135], a[108:111], v[188:191]
s_add_u32 s53, s88, 524288
v_and_b32 v21, 1, v19
v_lshl_add_u32 v20, v21, 1, v20
v_mfma_f32_16x16x32_bf16 v[188:191], a[128:131], a[104:107], v[188:191]
s_waitcnt lgkmcnt(0)
v_lshl_add_u32 v20, v16, 2, v20
v_add_u32 v20, v20, v18
v_mfma_f32_16x16x32_bf16 v[196:199], a[160:163], a[80:83], v[196:199]
s_waitcnt vmcnt(18)
v_mad_u32_u24 v20, s52, 36, v20
v_lshlrev_b32 v21, 1, v18
v_mfma_f32_16x16x32_bf16 v[196:199], a[164:167], a[84:87], v[196:199]
s_barrier
v_mfma_f32_16x16x32_bf16 v[64:67], a[172:175], a[84:87], v[64:67]
ds_read_b64_tr_b16 a[128:129], v11 offset:0
ds_read_b64_tr_b16 a[130:131], v11 offset:512
v_mfma_f32_16x16x32_bf16 v[64:67], a[168:171], a[80:83], v[64:67]
s_add_u32 m0, s77, 49152
s_add_u32 s64, s76, 128
v_lshl_add_u32 v21, v19, 2, v21
v_mfma_f32_16x16x32_bf16 v[204:207], a[176:179], a[80:83], v[204:207]
buffer_load_dwordx4 v7, s[20:23], s64 offen lds
v_mfma_f32_16x16x32_bf16 v[204:207], a[180:183], a[84:87], v[204:207]
ds_read_b64_tr_b16 a[132:133], v11 offset:4096
ds_read_b64_tr_b16 a[134:135], v11 offset:4608
v_mfma_f32_16x16x32_bf16 v[212:215], a[188:191], a[84:87], v[212:215]
ds_read_b64_tr_b16 a[136:137], v12 offset:0
ds_read_b64_tr_b16 a[138:139], v12 offset:512
v_mfma_f32_16x16x32_bf16 v[212:215], a[184:187], a[80:83], v[212:215]
ds_read_b64_tr_b16 a[140:141], v12 offset:4096
ds_read_b64_tr_b16 a[142:143], v12 offset:4608
v_mfma_f32_16x16x32_bf16 v[72:75], a[112:115], a[80:83], v[72:75]
buffer_store_dwordx4 v[96:99], v15, s[24:27], s53 offen offset:0 sc1
v_mfma_f32_16x16x32_bf16 v[72:75], a[116:119], a[84:87], v[72:75]
ds_read_b64_tr_b16 a[144:145], v13 offset:0
ds_read_b64_tr_b16 a[146:147], v13 offset:512
v_mfma_f32_16x16x32_bf16 v[220:223], a[124:127], a[84:87], v[220:223]
buffer_load_dwordx4 v8, s[20:23], s64 offen offset:1024 lds
v_mfma_f32_16x16x32_bf16 v[220:223], a[120:123], a[80:83], v[220:223]
ds_read_b64_tr_b16 a[148:149], v13 offset:4096
ds_read_b64_tr_b16 a[150:151], v13 offset:4608
v_mfma_f32_16x16x32_bf16 v[252:255], a[120:123], a[88:91], v[252:255]
v_lshrrev_b32 v22, 1, v16
v_add_u32 v21, v21, v22
v_mfma_f32_16x16x32_bf16 v[252:255], a[124:127], a[92:95], v[252:255]
ds_read_b64_tr_b16 a[152:153], v14 offset:0
ds_read_b64_tr_b16 a[154:155], v14 offset:512
v_mfma_f32_16x16x32_bf16 v[160:163], a[116:119], a[92:95], v[160:163]
s_add_u32 m0, s80, 49152
s_add_u32 s64, s79, 2048
v_mul_u32_u24 v21, 18, v21
v_mfma_f32_16x16x32_bf16 v[160:163], a[112:115], a[88:91], v[160:163]
ds_read_b64_tr_b16 a[156:157], v14 offset:4096
ds_read_b64_tr_b16 a[158:159], v14 offset:4608
v_mfma_f32_16x16x32_bf16 v[228:231], a[184:187], a[88:91], v[228:231]
buffer_load_dwordx4 v15, s[24:27], s64 offen sc1 lds
v_mfma_f32_16x16x32_bf16 v[228:231], a[188:191], a[92:95], v[228:231]
s_xor_b32 s65, s70, 640
s_add_u32 s71, s68, s65
s_add_u32 s72, s69, s65
v_mfma_f32_16x16x32_bf16 v[168:171], a[180:183], a[92:95], v[168:171]
ds_read_b128 a[64:67], v4 offset:8192
v_and_b32 v22, 1, v16
v_mfma_f32_16x16x32_bf16 v[168:171], a[176:179], a[88:91], v[168:171]
v_add3_u32 v21, v21, v22, 16
v_cmp_lt_u32 s[96:97], 1, v19
v_mfma_f32_16x16x32_bf16 v[176:179], a[168:171], a[88:91], v[176:179]
s_add_u32 m0, s73, 65536
s_add_u32 s64, s71, 0
ds_read_b128 a[80:83], v9 offset:0
v_mfma_f32_16x16x32_bf16 v[176:179], a[172:175], a[92:95], v[176:179]
v_mov_b32 v22, 0x100000
v_mul_u32_u24 v23, 1, v23
v_mfma_f32_16x16x32_bf16 v[80:83], a[164:167], a[92:95], v[80:83]
buffer_load_dwordx4 v5, s[12:15], s64 offen lds
v_mfma_f32_16x16x32_bf16 v[80:83], a[160:163], a[88:91], v[80:83]
ds_read_b128 a[68:71], v4 offset:10240
v_cndmask_b32 v21, v21, v22, s[96:97]
v_mfma_f32_16x16x32_bf16 v[184:187], a[160:163], a[96:99], v[184:187]
ds_read_b128 a[84:87], v10 offset:0
v_mov_b32 v22, s52
v_mfma_f32_16x16x32_bf16 v[184:187], a[164:167], a[100:103], v[184:187]
s_add_u32 s53, s88, 524288
v_cmp_eq_u32 s[96:97], 4, v22
v_mfma_f32_16x16x32_bf16 v[248:251], a[172:175], a[100:103], v[248:251]
buffer_store_dwordx4 v[104:107], v15, s[24:27], s53 offen offset:1024 sc1
v_mfma_f32_16x16x32_bf16 v[248:251], a[168:171], a[96:99], v[248:251]
ds_read_b128 a[72:75], v4 offset:9216
v_cndmask_b32 v20, v20, v21, s[96:97]
v_mfma_f32_16x16x32_bf16 v[240:243], a[176:179], a[96:99], v[240:243]
buffer_load_dwordx4 v6, s[12:15], s64 offen offset:1024 lds
v_mfma_f32_16x16x32_bf16 v[240:243], a[180:183], a[100:103], v[240:243]
ds_read_b128 a[88:91], v9 offset:2048
v_mul_u32_u24 v20, 1152, v20
v_mfma_f32_16x16x32_bf16 v[232:235], a[188:191], a[100:103], v[232:235]
v_lshl_add_u32 v20, v17, 4, v20
v_mov_b32 v25, v20
v_mfma_f32_16x16x32_bf16 v[232:235], a[184:187], a[96:99], v[232:235]
ds_read_b128 a[76:79], v4 offset:11264
v_mov_b32 v16, s54
v_mfma_f32_16x16x32_bf16 v[236:239], a[112:115], a[96:99], v[236:239]
s_add_u32 m0, s73, 67584
s_add_u32 s64, s71, 18432
v_mov_b32 v17, s55
v_mfma_f32_16x16x32_bf16 v[236:239], a[116:119], a[100:103], v[236:239]
ds_read_b128 a[92:95], v10 offset:2048
v_add_u32 v18, 32, v22
v_mfma_f32_16x16x32_bf16 v[224:227], a[124:127], a[100:103], v[224:227]
buffer_load_dwordx4 v5, s[12:15], s64 offen lds
v_mfma_f32_16x16x32_bf16 v[224:227], a[120:123], a[96:99], v[224:227]
s_mul_i32 s82, s55, 165888
s_lshl_b32 s54, s54, 5
s_add_u32 s82, s82, s54
v_mfma_f32_16x16x32_bf16 v[208:211], a[120:123], a[104:107], v[208:211]
s_and_b32 s52, s2, 1
s_lshr_b32 s54, s3, 1
s_lshl1_add_u32 s52, s52, s54
v_mfma_f32_16x16x32_bf16 v[208:211], a[124:127], a[108:111], v[208:211]
s_mul_i32 s52, s52, 9
s_and_b32 s54, s3, 1
s_mul_i32 s55, s54, 5
v_mfma_f32_16x16x32_bf16 v[216:219], a[116:119], a[108:111], v[216:219]
s_add_u32 s52, s52, s55
s_lshr_b32 s55, s2, 1
s_mul_i32 s81, s55, 1152
v_mfma_f32_16x16x32_bf16 v[216:219], a[112:115], a[104:107], v[216:219]
s_add_u32 s81, s81, s52
s_lshl_b32 s81, s81, 5
v_mfma_f32_16x16x32_bf16 v[244:247], a[184:187], a[104:107], v[244:247]
buffer_load_dwordx4 v6, s[12:15], s64 offen offset:1024 lds
v_mfma_f32_16x16x32_bf16 v[244:247], a[188:191], a[108:111], v[244:247]
v_cmp_gt_u32 s[96:97], 5, v1
v_add_u32 v19, s52, v1
v_mfma_f32_16x16x32_bf16 v[192:195], a[180:183], a[108:111], v[192:195]
v_lshrrev_b32 v20, 5, s55
v_and_b32 v21, 31, s55
v_mfma_f32_16x16x32_bf16 v[192:195], a[176:179], a[104:107], v[192:195]
v_cndmask_b32 v16, v16, v19, s[96:97]
v_cndmask_b32 v17, v17, v20, s[96:97]
v_mfma_f32_16x16x32_bf16 v[200:203], a[168:171], a[104:107], v[200:203]
v_cndmask_b32 v18, v18, v21, s[96:97]
v_mul_u32_u24 v19, 7282, v16
v_mfma_f32_16x16x32_bf16 v[200:203], a[172:175], a[108:111], v[200:203]
v_lshrrev_b32 v19, 16, v19
v_mul_u32_u24 v20, 9, v19
v_mfma_f32_16x16x32_bf16 v[88:91], a[164:167], a[108:111], v[88:91]
v_sub_u32 v16, v16, v20
v_and_b32 v20, 1, v19
v_mfma_f32_16x16x32_bf16 v[88:91], a[160:163], a[104:107], v[88:91]
s_waitcnt lgkmcnt(0)
v_lshlrev_b32 v20, 2, v20
v_cndmask_b32 v20, 0, v20, s[96:97]
v_mfma_f32_16x16x32_bf16 v[36:39], a[128:131], a[80:83], v[36:39]
s_waitcnt vmcnt(24)
v_xor_b32 v18, v18, v20
v_lshl_add_u32 v19, v19, 2, v17
v_mfma_f32_16x16x32_bf16 v[36:39], a[132:135], a[84:87], v[36:39]
s_barrier
v_mfma_f32_16x16x32_bf16 v[44:47], a[140:143], a[84:87], v[44:47]
ds_read_b128 a[96:99], v9 offset:4096
v_mul_u32_u24 v19, 344064, v19
v_mfma_f32_16x16x32_bf16 v[44:47], a[136:139], a[80:83], v[44:47]
s_xor_b32 s75, s93, 5
s_lshl_b32 s76, s75, 19
s_add_u32 s76, s76, s74
v_mfma_f32_16x16x32_bf16 v[32:35], a[144:147], a[80:83], v[32:35]
s_lshl_b32 s79, s75, 13
s_add_u32 s79, s79, s78
ds_read_b128 a[100:103], v10 offset:4096
v_mfma_f32_16x16x32_bf16 v[32:35], a[148:151], a[84:87], v[32:35]
s_add_u32 m0, s77, 0
s_add_u32 s64, s76, 0
ds_read_b128 a[104:107], v9 offset:6144
v_mfma_f32_16x16x32_bf16 v[52:55], a[156:159], a[84:87], v[52:55]
buffer_load_dwordx4 v7, s[20:23], s64 offen lds
v_mfma_f32_16x16x32_bf16 v[52:55], a[152:155], a[80:83], v[52:55]
s_add_u32 s53, s88, 524288
ds_read_b64_tr_b16 a[160:161], v11 offset:16384
ds_read_b64_tr_b16 a[162:163], v11 offset:16896
v_mfma_f32_16x16x32_bf16 v[60:63], a[64:67], a[80:83], v[60:63]
buffer_store_dwordx4 v[112:115], v15, s[24:27], s53 offen offset:2048 sc1
v_mfma_f32_16x16x32_bf16 v[60:63], a[68:71], a[84:87], v[60:63]
ds_read_b128 a[108:111], v10 offset:6144
v_lshrrev_b32 v20, 1, v16
v_mfma_f32_16x16x32_bf16 v[68:71], a[76:79], a[84:87], v[68:71]
buffer_load_dwordx4 v8, s[20:23], s64 offen offset:1024 lds
v_mfma_f32_16x16x32_bf16 v[68:71], a[72:75], a[80:83], v[68:71]
ds_read_b64_tr_b16 a[164:165], v11 offset:20480
ds_read_b64_tr_b16 a[166:167], v11 offset:20992
v_mfma_f32_16x16x32_bf16 v[76:79], a[72:75], a[88:91], v[76:79]
v_add_u32 v9, 32768, v9
v_add_u32 v10, 32768, v10
v_mfma_f32_16x16x32_bf16 v[76:79], a[76:79], a[92:95], v[76:79]
ds_read_b64_tr_b16 a[168:169], v12 offset:16384
ds_read_b64_tr_b16 a[170:171], v12 offset:16896
v_mfma_f32_16x16x32_bf16 v[84:87], a[68:71], a[92:95], v[84:87]
s_add_u32 m0, s80, 0
s_add_u32 s64, s79, 0
v_sub_u32 v20, v20, v17
v_mfma_f32_16x16x32_bf16 v[84:87], a[64:67], a[88:91], v[84:87]
ds_read_b64_tr_b16 a[172:173], v12 offset:20480
ds_read_b64_tr_b16 a[174:175], v12 offset:20992
v_mfma_f32_16x16x32_bf16 v[92:95], a[152:155], a[88:91], v[92:95]
buffer_load_dwordx4 v15, s[24:27], s64 offen sc1 lds
v_mfma_f32_16x16x32_bf16 v[92:95], a[156:159], a[92:95], v[92:95]
v_add_u32 v20, 3, v20
v_and_b32 v20, 3, v20
v_mfma_f32_16x16x32_bf16 v[40:43], a[148:151], a[92:95], v[40:43]
s_waitcnt vmcnt(23)
ds_read_b64_tr_b16 a[176:177], v13 offset:16384
ds_read_b64_tr_b16 a[178:179], v13 offset:16896
v_mfma_f32_16x16x32_bf16 v[40:43], a[144:147], a[88:91], v[40:43]
v_cmp_gt_u32 vcc, 1, v30
v_cmp_eq_u32 s[96:97], 8, v16
v_mfma_f32_16x16x32_bf16 v[100:103], a[136:139], a[88:91], v[100:103]
s_add_u32 m0, s73, 69632
s_add_u32 s64, s72, 0
v_and_b32 v16, 1, v16
v_mfma_f32_16x16x32_bf16 v[100:103], a[140:143], a[92:95], v[100:103]
ds_read_b64_tr_b16 a[180:181], v13 offset:20480
ds_read_b64_tr_b16 a[182:183], v13 offset:20992
v_mfma_f32_16x16x32_bf16 v[108:111], a[132:135], a[92:95], v[108:111]
buffer_load_dwordx4 v5, s[12:15], s64 offen lds
v_mfma_f32_16x16x32_bf16 v[108:111], a[128:131], a[88:91], v[108:111]
s_waitcnt lgkmcnt(14)
ds_read_b64_tr_b16 a[184:185], v14 offset:16384
ds_read_b64_tr_b16 a[186:187], v14 offset:16896
v_mfma_f32_16x16x32_bf16 v[116:119], a[128:131], a[96:99], v[116:119]
ds_read_b64_tr_b16 a[188:189], v14 offset:20480
ds_read_b64_tr_b16 a[190:191], v14 offset:20992
v_mfma_f32_16x16x32_bf16 v[116:119], a[132:135], a[100:103], v[116:119]
s_cbranch_vccnz CK_ZA
CK_ZA_R:
v_mfma_f32_16x16x32_bf16 v[124:127], a[140:143], a[100:103], v[124:127]
v_lshl_add_u32 v21, v20, 1, v16
v_and_b32 v22, 1, v18
v_mfma_f32_16x16x32_bf16 v[124:127], a[136:139], a[96:99], v[124:127]
ds_read_b128 a[112:115], v4 offset:24576
v_lshl_add_u32 v19, v22, 10, v19
v_mfma_f32_16x16x32_bf16 v[132:135], a[144:147], a[96:99], v[132:135]
buffer_load_dwordx4 v6, s[12:15], s64 offen offset:1024 lds
v_mfma_f32_16x16x32_bf16 v[132:135], a[148:151], a[100:103], v[132:135]
ds_read_b128 a[116:119], v4 offset:26624
v_and_b32 v18, -2, v18
v_mfma_f32_16x16x32_bf16 v[140:143], a[156:159], a[100:103], v[140:143]
v_add_u32 v21, 1, v21
v_cndmask_b32 v21, v21, 0, s[96:97]
v_mfma_f32_16x16x32_bf16 v[140:143], a[152:155], a[96:99], v[140:143]
s_add_u32 s53, s88, 524288
ds_read_b128 a[120:123], v4 offset:25600
v_cndmask_b32 v20, v20, 0, s[96:97]
v_mfma_f32_16x16x32_bf16 v[148:151], a[64:67], a[96:99], v[148:151]
s_add_u32 m0, s73, 71680
s_add_u32 s64, s72, 18432
v_sub_u32 v17, 37, v18
v_mfma_f32_16x16x32_bf16 v[148:151], a[68:71], a[100:103], v[148:151]
ds_read_b128 a[124:127], v4 offset:27648
v_min_u32 v17, 2, v17
v_mfma_f32_16x16x32_bf16 v[48:51], a[76:79], a[100:103], v[48:51]
buffer_load_dwordx4 v5, s[12:15], s64 offen lds
v_mfma_f32_16x16x32_bf16 v[48:51], a[72:75], a[96:99], v[48:51]
s_waitcnt lgkmcnt(15)
v_mul_u32_u24 v21, v21, v17
v_mul_u32_u24 v22, v16, v17
v_mfma_f32_16x16x32_bf16 v[156:159], a[72:75], a[104:107], v[156:159]
buffer_store_dwordx4 v[120:123], v15, s[24:27], s53 offen offset:3072 sc1
v_mfma_f32_16x16x32_bf16 v[156:159], a[76:79], a[108:111], v[156:159]
v_min_u32 v23, 8, v18
v_mad_u32_u24 v21, v18, 5, v21
v_mfma_f32_16x16x32_bf16 v[164:167], a[68:71], a[108:111], v[164:167]
v_lshl_add_u32 v21, v23, 1, v21
v_lshl_add_u32 v22, v18, 1, v22
v_mfma_f32_16x16x32_bf16 v[164:167], a[64:67], a[104:107], v[164:167]
v_mad_u32_u24 v22, v20, 37, v22
v_mad_u32_u24 v22, v20, 37, v22
v_mfma_f32_16x16x32_bf16 v[172:175], a[152:155], a[104:107], v[172:175]
buffer_load_dwordx4 v6, s[12:15], s64 offen offset:1024 lds
v_mfma_f32_16x16x32_bf16 v[172:175], a[156:159], a[108:111], v[172:175]
v_lshl_add_u32 v20, v20, 6, v18
v_mov_b32 v23, 136
v_mfma_f32_16x16x32_bf16 v[56:59], a[148:151], a[108:111], v[56:59]
v_cmp_gt_u32 s[96:97], v23, v20
v_add_u32 v22, 37, v22
v_mfma_f32_16x16x32_bf16 v[56:59], a[144:147], a[104:107], v[56:59]
v_add_u32 v19, 38797312, v19
v_mfma_f32_16x16x32_bf16 v[180:183], a[136:139], a[104:107], v[180:183]
v_cndmask_b32 v21, v22, v21, s[96:97]
v_lshl_add_u32 v19, v21, 10, v19
v_mfma_f32_16x16x32_bf16 v[180:183], a[140:143], a[108:111], v[180:183]
s_cmp_eq_u32 s54, 1
s_cselect_b32 s96, 16, 0
v_mfma_f32_16x16x32_bf16 v[188:191], a[132:135], a[108:111], v[188:191]
s_cmp_eq_u32 s3, 3
s_cselect_b32 s52, 32, 0
s_or_b32 s96, s96, s52
v_mfma_f32_16x16x32_bf16 v[188:191], a[128:131], a[104:107], v[188:191]
s_waitcnt lgkmcnt(0)
s_cmp_ge_u32 s2, 240
s_cselect_b32 s52, 32, 0
v_mfma_f32_16x16x32_bf16 v[196:199], a[160:163], a[80:83], v[196:199]
s_waitcnt vmcnt(18)
s_or_b32 s96, s96, s52
s_mov_b32 s97, 0
v_mfma_f32_16x16x32_bf16 v[196:199], a[164:167], a[84:87], v[196:199]
s_barrier
v_mfma_f32_16x16x32_bf16 v[64:67], a[172:175], a[84:87], v[64:67]
ds_read_b64_tr_b16 a[128:129], v11 offset:32768
ds_read_b64_tr_b16 a[130:131], v11 offset:33280
v_mfma_f32_16x16x32_bf16 v[64:67], a[168:171], a[80:83], v[64:67]
s_add_u32 m0, s77, 16384
s_add_u32 s64, s76, 128
v_mov_b32 v20, 2147418112
v_mfma_f32_16x16x32_bf16 v[204:207], a[176:179], a[80:83], v[204:207]
buffer_load_dwordx4 v7, s[20:23], s64 offen lds
v_mfma_f32_16x16x32_bf16 v[204:207], a[180:183], a[84:87], v[204:207]
ds_read_b64_tr_b16 a[132:133], v11 offset:36864
ds_read_b64_tr_b16 a[134:135], v11 offset:37376
v_mfma_f32_16x16x32_bf16 v[212:215], a[188:191], a[84:87], v[212:215]
ds_read_b64_tr_b16 a[136:137], v12 offset:32768
ds_read_b64_tr_b16 a[138:139], v12 offset:33280
v_mfma_f32_16x16x32_bf16 v[212:215], a[184:187], a[80:83], v[212:215]
ds_read_b64_tr_b16 a[140:141], v12 offset:36864
ds_read_b64_tr_b16 a[142:143], v12 offset:37376
v_mfma_f32_16x16x32_bf16 v[72:75], a[112:115], a[80:83], v[72:75]
buffer_atomic_add v1, v0, s[24:27], s90 offen offset:4 sc1
v_mfma_f32_16x16x32_bf16 v[72:75], a[116:119], a[84:87], v[72:75]
ds_read_b64_tr_b16 a[144:145], v13 offset:32768
ds_read_b64_tr_b16 a[146:147], v13 offset:33280
v_mfma_f32_16x16x32_bf16 v[220:223], a[124:127], a[84:87], v[220:223]
buffer_load_dwordx4 v8, s[20:23], s64 offen offset:1024 lds
v_mfma_f32_16x16x32_bf16 v[220:223], a[120:123], a[80:83], v[220:223]
s_add_u32 s53, s88, 786432
ds_read_b64_tr_b16 a[148:149], v13 offset:36864
ds_read_b64_tr_b16 a[150:151], v13 offset:37376
v_mfma_f32_16x16x32_bf16 v[252:255], a[120:123], a[88:91], v[252:255]
buffer_store_dwordx4 v[128:131], v15, s[24:27], s53 offen offset:0 sc1
v_mfma_f32_16x16x32_bf16 v[252:255], a[124:127], a[92:95], v[252:255]
ds_read_b64_tr_b16 a[152:153], v14 offset:32768
ds_read_b64_tr_b16 a[154:155], v14 offset:33280
v_mfma_f32_16x16x32_bf16 v[160:163], a[116:119], a[92:95], v[160:163]
s_add_u32 m0, s80, 16384
s_add_u32 s64, s79, 2048
v_cndmask_b32 v26, v19, v20, s[96:97]
v_mfma_f32_16x16x32_bf16 v[160:163], a[112:115], a[88:91], v[160:163]
ds_read_b64_tr_b16 a[156:157], v14 offset:36864
ds_read_b64_tr_b16 a[158:159], v14 offset:37376
v_mfma_f32_16x16x32_bf16 v[228:231], a[184:187], a[88:91], v[228:231]
buffer_load_dwordx4 v15, s[24:27], s64 offen sc1 lds
v_mfma_f32_16x16x32_bf16 v[228:231], a[188:191], a[92:95], v[228:231]
s_xor_b32 s65, s70, 768
s_add_u32 s71, s68, s65
s_add_u32 s72, s69, s65
v_mfma_f32_16x16x32_bf16 v[168:171], a[180:183], a[92:95], v[168:171]
ds_read_b128 a[64:67], v4 offset:40960
v_lshlrev_b32 v27, 3, v1
v_mfma_f32_16x16x32_bf16 v[168:171], a[176:179], a[88:91], v[168:171]
v_add_u32 v27, s83, v27
v_lshrrev_b32 v22, 3, v1
v_mfma_f32_16x16x32_bf16 v[176:179], a[168:171], a[88:91], v[176:179]
s_add_u32 m0, s73, 0
s_add_u32 s64, s71, 0
ds_read_b128 a[80:83], v9 offset:0
v_mfma_f32_16x16x32_bf16 v[176:179], a[172:175], a[92:95], v[176:179]
L_PAD6:
s_cbranch_execz L_PAD10
v_mul_u32_u24 v22, 1152, v22
v_and_b32 v23, 7, v1
v_mfma_f32_16x16x32_bf16 v[80:83], a[164:167], a[92:95], v[80:83]
buffer_load_dwordx4 v5, s[12:15], s64 offen lds
v_mfma_f32_16x16x32_bf16 v[80:83], a[160:163], a[88:91], v[80:83]
ds_read_b128 a[68:71], v4 offset:43008
v_lshl_add_u32 v22, v23, 4, v22
v_mfma_f32_16x16x32_bf16 v[184:187], a[160:163], a[96:99], v[184:187]
ds_read_b128 a[84:87], v10 offset:0
v_lshrrev_b32 v23, 2, v1
v_mfma_f32_16x16x32_bf16 v[184:187], a[164:167], a[100:103], v[184:187]
v_mul_u32_u24 v23, 96, v23
v_add_u32 v23, v23, v27
v_mfma_f32_16x16x32_bf16 v[248:251], a[172:175], a[100:103], v[248:251]
v_and_b32 v16, 3, v1
v_cmp_eq_u32 s[96:97], 0, v16
v_mfma_f32_16x16x32_bf16 v[248:251], a[168:171], a[96:99], v[248:251]
ds_read_b128 a[72:75], v4 offset:41984
v_mov_b32 v16, 0x3f803f80
v_mfma_f32_16x16x32_bf16 v[240:243], a[176:179], a[96:99], v[240:243]
buffer_load_dwordx4 v6, s[12:15], s64 offen offset:1024 lds
v_mfma_f32_16x16x32_bf16 v[240:243], a[180:183], a[100:103], v[240:243]
ds_read_b128 a[88:91], v9 offset:2048
v_cndmask_b32 v16, 0, v16, s[96:97]
v_mfma_f32_16x16x32_bf16 v[232:235], a[188:191], a[100:103], v[232:235]
v_accvgpr_write_b32 a240, v16
v_accvgpr_write_b32 a241, v16
v_mfma_f32_16x16x32_bf16 v[232:235], a[184:187], a[96:99], v[232:235]
ds_read_b128 a[76:79], v4 offset:44032
v_accvgpr_write_b32 a242, v16
v_mfma_f32_16x16x32_bf16 v[236:239], a[112:115], a[96:99], v[236:239]
s_add_u32 m0, s73, 2048
s_add_u32 s64, s71, 18432
v_accvgpr_write_b32 a243, v16
v_mfma_f32_16x16x32_bf16 v[236:239], a[116:119], a[100:103], v[236:239]
ds_read_b128 a[92:95], v10 offset:2048
v_accvgpr_write_b32 a232, 0
v_mfma_f32_16x16x32_bf16 v[224:227], a[124:127], a[100:103], v[224:227]
buffer_load_dwordx4 v5, s[12:15], s64 offen lds
v_mfma_f32_16x16x32_bf16 v[224:227], a[120:123], a[96:99], v[224:227]
v_accvgpr_write_b32 a233, 0
v_accvgpr_write_b32 a234, 0
v_mfma_f32_16x16x32_bf16 v[208:211], a[120:123], a[104:107], v[208:211]
v_accvgpr_write_b32 a235, 0
v_accvgpr_write_b32 a236, 0
v_mfma_f32_16x16x32_bf16 v[208:211], a[124:127], a[108:111], v[208:211]
s_add_u32 s53, s88, 786432
v_accvgpr_write_b32 a237, 0
v_accvgpr_write_b32 a238, 0
v_mfma_f32_16x16x32_bf16 v[216:219], a[116:119], a[108:111], v[216:219]
buffer_store_dwordx4 v[136:139], v15, s[24:27], s53 offen offset:1024 sc1
v_mfma_f32_16x16x32_bf16 v[216:219], a[112:115], a[104:107], v[216:219]
v_accvgpr_write_b32 a239, 0
v_lshlrev_b32 v16, 2, v3
v_mfma_f32_16x16x32_bf16 v[244:247], a[184:187], a[104:107], v[244:247]
buffer_load_dwordx4 v6, s[12:15], s64 offen offset:1024 lds
v_mfma_f32_16x16x32_bf16 v[244:247], a[188:191], a[108:111], v[244:247]
v_sub_u32 v16, v2, v16
v_cmp_gt_i32 s[56:57], 0, v16
v_mfma_f32_16x16x32_bf16 v[192:195], a[180:183], a[108:111], v[192:195]
v_cmp_gt_i32 s[58:59], 1, v16
v_cmp_gt_i32 s[60:61], 2, v16
v_mfma_f32_16x16x32_bf16 v[192:195], a[176:179], a[104:107], v[192:195]
v_cmp_gt_i32 s[62:63], 3, v16
v_cmp_eq_u32 s[96:97], 3, v3
v_mfma_f32_16x16x32_bf16 v[200:203], a[168:171], a[104:107], v[200:203]
v_add_u32 v17, 48, v2
v_lshlrev_b32 v17, 2, v17
v_mfma_f32_16x16x32_bf16 v[200:203], a[172:175], a[108:111], v[200:203]
v_lshlrev_b32 v18, 16, v3
v_lshl_add_u32 v18, v2, 4, v18
v_mfma_f32_16x16x32_bf16 v[88:91], a[164:167], a[108:111], v[88:91]
v_add_u32 v19, 0x8000, v18
v_cndmask_b32 v19, v19, v20, s[96:97]
v_mfma_f32_16x16x32_bf16 v[88:91], a[160:163], a[104:107], v[88:91]
s_waitcnt lgkmcnt(0)
v_cmp_eq_u32 s[96:97], 0, v3
v_mfma_f32_16x16x32_bf16 v[36:39], a[128:131], a[80:83], v[36:39]
s_waitcnt vmcnt(24)
v_mfma_f32_16x16x32_bf16 v[36:39], a[132:135], a[84:87], v[36:39]
s_barrier
v_mfma_f32_16x16x32_bf16 v[44:47], a[140:143], a[84:87], v[44:47]
ds_read_b128 a[96:99], v9 offset:4096
v_cndmask_b32 v18, v18, v20, s[96:97]
v_mfma_f32_16x16x32_bf16 v[44:47], a[136:139], a[80:83], v[44:47]
s_xor_b32 s75, s93, 6
s_lshl_b32 s76, s75, 19
s_add_u32 s76, s76, s74
v_mfma_f32_16x16x32_bf16 v[32:35], a[144:147], a[80:83], v[32:35]
s_lshl_b32 s79, s75, 13
s_add_u32 s79, s79, s78
ds_read_b128 a[100:103], v10 offset:4096
v_mfma_f32_16x16x32_bf16 v[32:35], a[148:151], a[84:87], v[32:35]
s_add_u32 m0, s77, 32768
s_add_u32 s64, s76, 0
ds_read_b128 a[104:107], v9 offset:6144
v_mfma_f32_16x16x32_bf16 v[52:55], a[156:159], a[84:87], v[52:55]
buffer_load_dwordx4 v7, s[20:23], s64 offen lds
v_mfma_f32_16x16x32_bf16 v[52:55], a[152:155], a[80:83], v[52:55]
ds_read_b64_tr_b16 a[160:161], v11 offset:49152
ds_read_b64_tr_b16 a[162:163], v11 offset:49664
v_mfma_f32_16x16x32_bf16 v[60:63], a[64:67], a[80:83], v[60:63]
v_cndmask_b32 v19, v19, v20, s[96:97]
v_mfma_f32_16x16x32_bf16 v[60:63], a[68:71], a[84:87], v[60:63]
ds_read_b128 a[108:111], v10 offset:6144
v_mfma_f32_16x16x32_bf16 v[68:71], a[76:79], a[84:87], v[68:71]
buffer_load_dwordx4 v8, s[20:23], s64 offen offset:1024 lds
v_mfma_f32_16x16x32_bf16 v[68:71], a[72:75], a[80:83], v[68:71]
ds_read_b64_tr_b16 a[164:165], v11 offset:53248
ds_read_b64_tr_b16 a[166:167], v11 offset:53760
v_mfma_f32_16x16x32_bf16 v[76:79], a[72:75], a[88:91], v[76:79]
v_add_u32 v9, 32768, v9
v_add_u32 v10, 32768, v10
v_mfma_f32_16x16x32_bf16 v[76:79], a[76:79], a[92:95], v[76:79]
ds_read_b64_tr_b16 a[168:169], v12 offset:49152
ds_read_b64_tr_b16 a[170:171], v12 offset:49664
v_mfma_f32_16x16x32_bf16 v[84:87], a[68:71], a[92:95], v[84:87]
s_add_u32 m0, s80, 32768
s_add_u32 s64, s79, 0
v_mfma_f32_16x16x32_bf16 v[84:87], a[64:67], a[88:91], v[84:87]
ds_read_b64_tr_b16 a[172:173], v12 offset:53248
ds_read_b64_tr_b16 a[174:175], v12 offset:53760
v_mfma_f32_16x16x32_bf16 v[92:95], a[152:155], a[88:91], v[92:95]
buffer_load_dwordx4 v15, s[24:27], s64 offen sc1 lds
v_mfma_f32_16x16x32_bf16 v[92:95], a[156:159], a[92:95], v[92:95]
s_add_u32 s53, s88, 786432
v_mfma_f32_16x16x32_bf16 v[40:43], a[148:151], a[92:95], v[40:43]
ds_read_b64_tr_b16 a[176:177], v13 offset:49152
ds_read_b64_tr_b16 a[178:179], v13 offset:49664
v_mfma_f32_16x16x32_bf16 v[40:43], a[144:147], a[88:91], v[40:43]
buffer_store_dwordx4 v[144:147], v15, s[24:27], s53 offen offset:2048 sc1
v_mfma_f32_16x16x32_bf16 v[100:103], a[136:139], a[88:91], v[100:103]
s_add_u32 m0, s73, 4096
s_add_u32 s64, s72, 0
v_mfma_f32_16x16x32_bf16 v[100:103], a[140:143], a[92:95], v[100:103]
ds_read_b64_tr_b16 a[180:181], v13 offset:53248
ds_read_b64_tr_b16 a[182:183], v13 offset:53760
v_mfma_f32_16x16x32_bf16 v[108:111], a[132:135], a[92:95], v[108:111]
buffer_load_dwordx4 v5, s[12:15], s64 offen lds
v_mfma_f32_16x16x32_bf16 v[108:111], a[128:131], a[88:91], v[108:111]
s_waitcnt lgkmcnt(14)
ds_read_b64_tr_b16 a[184:185], v14 offset:49152
ds_read_b64_tr_b16 a[186:187], v14 offset:49664
v_mfma_f32_16x16x32_bf16 v[116:119], a[128:131], a[96:99], v[116:119]
ds_read_b64_tr_b16 a[188:189], v14 offset:53248
ds_read_b64_tr_b16 a[190:191], v14 offset:53760
v_mfma_f32_16x16x32_bf16 v[116:119], a[132:135], a[100:103], v[116:119]
v_mfma_f32_16x16x32_bf16 v[124:127], a[140:143], a[100:103], v[124:127]
v_mfma_f32_16x16x32_bf16 v[124:127], a[136:139], a[96:99], v[124:127]
ds_read_b128 a[112:115], v4 offset:57344
v_mfma_f32_16x16x32_bf16 v[132:135], a[144:147], a[96:99], v[132:135]
buffer_load_dwordx4 v6, s[12:15], s64 offen offset:1024 lds
v_mfma_f32_16x16x32_bf16 v[132:135], a[148:151], a[100:103], v[132:135]
ds_read_b128 a[116:119], v4 offset:59392
v_mfma_f32_16x16x32_bf16 v[140:143], a[156:159], a[100:103], v[140:143]
v_mfma_f32_16x16x32_bf16 v[140:143], a[152:155], a[96:99], v[140:143]
ds_read_b128 a[120:123], v4 offset:58368
v_mfma_f32_16x16x32_bf16 v[148:151], a[64:67], a[96:99], v[148:151]
s_add_u32 m0, s73, 6144
s_add_u32 s64, s72, 18432
v_mfma_f32_16x16x32_bf16 v[148:151], a[68:71], a[100:103], v[148:151]
ds_read_b128 a[124:127], v4 offset:60416
v_mfma_f32_16x16x32_bf16 v[48:51], a[76:79], a[100:103], v[48:51]
buffer_load_dwordx4 v5, s[12:15], s64 offen lds
v_mfma_f32_16x16x32_bf16 v[48:51], a[72:75], a[96:99], v[48:51]
s_waitcnt lgkmcnt(15)
v_mfma_f32_16x16x32_bf16 v[156:159], a[72:75], a[104:107], v[156:159]
v_mfma_f32_16x16x32_bf16 v[156:159], a[76:79], a[108:111], v[156:159]
v_mfma_f32_16x16x32_bf16 v[164:167], a[68:71], a[108:111], v[164:167]
v_mfma_f32_16x16x32_bf16 v[164:167], a[64:67], a[104:107], v[164:167]
v_mfma_f32_16x16x32_bf16 v[172:175], a[152:155], a[104:107], v[172:175]
buffer_load_dwordx4 v6, s[12:15], s64 offen offset:1024 lds
v_mfma_f32_16x16x32_bf16 v[172:175], a[156:159], a[108:111], v[172:175]
v_mfma_f32_16x16x32_bf16 v[56:59], a[148:151], a[108:111], v[56:59]
v_mfma_f32_16x16x32_bf16 v[56:59], a[144:147], a[104:107], v[56:59]
s_add_u32 s53, s88, 786432
v_mfma_f32_16x16x32_bf16 v[180:183], a[136:139], a[104:107], v[180:183]
buffer_store_dwordx4 v[152:155], v15, s[24:27], s53 offen offset:3072 sc1
v_mfma_f32_16x16x32_bf16 v[180:183], a[140:143], a[108:111], v[180:183]
v_mfma_f32_16x16x32_bf16 v[188:191], a[132:135], a[108:111], v[188:191]
v_mfma_f32_16x16x32_bf16 v[188:191], a[128:131], a[104:107], v[188:191]
s_waitcnt lgkmcnt(0)
v_mov_b32 v96, 0
v_mov_b32 v97, 0
v_mfma_f32_16x16x32_bf16 v[196:199], a[160:163], a[80:83], v[196:199]
s_waitcnt vmcnt(19)
v_mov_b32 v98, 0
v_mov_b32 v99, 0
v_mfma_f32_16x16x32_bf16 v[196:199], a[164:167], a[84:87], v[196:199]
s_barrier
v_mfma_f32_16x16x32_bf16 v[64:67], a[172:175], a[84:87], v[64:67]
ds_read_b64_tr_b16 a[128:129], v11 offset:0
ds_read_b64_tr_b16 a[130:131], v11 offset:512
v_mfma_f32_16x16x32_bf16 v[64:67], a[168:171], a[80:83], v[64:67]
s_add_u32 m0, s77, 49152
s_add_u32 s64, s76, 128
v_mov_b32 v104, 0
v_mfma_f32_16x16x32_bf16 v[204:207], a[176:179], a[80:83], v[204:207]
buffer_load_dwordx4 v7, s[20:23], s64 offen lds
v_mfma_f32_16x16x32_bf16 v[204:207], a[180:183], a[84:87], v[204:207]
ds_read_b64_tr_b16 a[132:133], v11 offset:4096
ds_read_b64_tr_b16 a[134:135], v11 offset:4608
v_mfma_f32_16x16x32_bf16 v[212:215], a[188:191], a[84:87], v[212:215]
ds_read_b64_tr_b16 a[136:137], v12 offset:0
ds_read_b64_tr_b16 a[138:139], v12 offset:512
v_mfma_f32_16x16x32_bf16 v[212:215], a[184:187], a[80:83], v[212:215]
ds_read_b64_tr_b16 a[140:141], v12 offset:4096
ds_read_b64_tr_b16 a[142:143], v12 offset:4608
v_mfma_f32_16x16x32_bf16 v[72:75], a[112:115], a[80:83], v[72:75]
buffer_load_dword v30, v29, s[24:27], s89 offen offset:4 sc1
v_mfma_f32_16x16x32_bf16 v[72:75], a[116:119], a[84:87], v[72:75]
ds_read_b64_tr_b16 a[144:145], v13 offset:0
ds_read_b64_tr_b16 a[146:147], v13 offset:512
v_mfma_f32_16x16x32_bf16 v[220:223], a[124:127], a[84:87], v[220:223]
buffer_load_dwordx4 v8, s[20:23], s64 offen offset:1024 lds
v_mfma_f32_16x16x32_bf16 v[220:223], a[120:123], a[80:83], v[220:223]
ds_read_b64_tr_b16 a[148:149], v13 offset:4096
ds_read_b64_tr_b16 a[150:151], v13 offset:4608
v_mfma_f32_16x16x32_bf16 v[252:255], a[120:123], a[88:91], v[252:255]
v_mov_b32 v105, 0
v_mov_b32 v106, 0
v_mfma_f32_16x16x32_bf16 v[252:255], a[124:127], a[92:95], v[252:255]
ds_read_b64_tr_b16 a[152:153], v14 offset:0
ds_read_b64_tr_b16 a[154:155], v14 offset:512
v_mfma_f32_16x16x32_bf16 v[160:163], a[116:119], a[92:95], v[160:163]
s_add_u32 m0, s80, 49152
s_add_u32 s64, s79, 2048
v_mov_b32 v107, 0
v_mfma_f32_16x16x32_bf16 v[160:163], a[112:115], a[88:91], v[160:163]
ds_read_b64_tr_b16 a[156:157], v14 offset:4096
ds_read_b64_tr_b16 a[158:159], v14 offset:4608
v_mfma_f32_16x16x32_bf16 v[228:231], a[184:187], a[88:91], v[228:231]
buffer_load_dwordx4 v15, s[24:27], s64 offen sc1 lds
v_mfma_f32_16x16x32_bf16 v[228:231], a[188:191], a[92:95], v[228:231]
s_xor_b32 s65, s70, 896
s_add_u32 s71, s68, s65
s_add_u32 s72, s69, s65
v_mfma_f32_16x16x32_bf16 v[168:171], a[180:183], a[92:95], v[168:171]
ds_read_b128 a[64:67], v4 offset:8192
v_mov_b32 v112, 0
v_mfma_f32_16x16x32_bf16 v[168:171], a[176:179], a[88:91], v[168:171]
v_mov_b32 v113, 0
v_mov_b32 v114, 0
v_mfma_f32_16x16x32_bf16 v[176:179], a[168:171], a[88:91], v[176:179]
s_add_u32 m0, s73, 32768
s_add_u32 s64, s71, 0
ds_read_b128 a[80:83], v9 offset:0
v_mfma_f32_16x16x32_bf16 v[176:179], a[172:175], a[92:95], v[176:179]
v_mov_b32 v115, 0
v_mov_b32 v120, 0
v_mfma_f32_16x16x32_bf16 v[80:83], a[164:167], a[92:95], v[80:83]
buffer_load_dwordx4 v5, s[12:15], s64 offen lds
v_mfma_f32_16x16x32_bf16 v[80:83], a[160:163], a[88:91], v[80:83]
s_add_u32 s53, s87, 524288
ds_read_b128 a[68:71], v4 offset:10240
v_mov_b32 v121, 0
v_mfma_f32_16x16x32_bf16 v[184:187], a[160:163], a[96:99], v[184:187]
ds_read_b128 a[84:87], v10 offset:0
v_mov_b32 v122, 0
v_mfma_f32_16x16x32_bf16 v[184:187], a[164:167], a[100:103], v[184:187]
buffer_store_dwordx4 a[28:31], v15, s[24:27], s53 offen offset:0 sc1
v_mfma_f32_16x16x32_bf16 v[248:251], a[172:175], a[100:103], v[248:251]
v_mov_b32 v123, 0
v_mov_b32 v128, 0
v_mfma_f32_16x16x32_bf16 v[248:251], a[168:171], a[96:99], v[248:251]
ds_read_b128 a[72:75], v4 offset:9216
v_mov_b32 v129, 0
v_mfma_f32_16x16x32_bf16 v[240:243], a[176:179], a[96:99], v[240:243]
buffer_load_dwordx4 v6, s[12:15], s64 offen offset:1024 lds
v_mfma_f32_16x16x32_bf16 v[240:243], a[180:183], a[100:103], v[240:243]
ds_read_b128 a[88:91], v9 offset:2048
v_mov_b32 v130, 0
v_mfma_f32_16x16x32_bf16 v[232:235], a[188:191], a[100:103], v[232:235]
v_mov_b32 v131, 0
v_mov_b32 v136, 0
v_mfma_f32_16x16x32_bf16 v[232:235], a[184:187], a[96:99], v[232:235]
ds_read_b128 a[76:79], v4 offset:11264
v_mov_b32 v137, 0
v_mfma_f32_16x16x32_bf16 v[236:239], a[112:115], a[96:99], v[236:239]
s_add_u32 m0, s73, 34816
s_add_u32 s64, s71, 18432
v_mov_b32 v138, 0
v_mfma_f32_16x16x32_bf16 v[236:239], a[116:119], a[100:103], v[236:239]
ds_read_b128 a[92:95], v10 offset:2048
v_mov_b32 v139, 0
v_mfma_f32_16x16x32_bf16 v[224:227], a[124:127], a[100:103], v[224:227]
buffer_load_dwordx4 v5, s[12:15], s64 offen lds
v_mfma_f32_16x16x32_bf16 v[224:227], a[120:123], a[96:99], v[224:227]
v_mov_b32 v144, 0
v_mov_b32 v145, 0
v_mfma_f32_16x16x32_bf16 v[208:211], a[120:123], a[104:107], v[208:211]
v_mov_b32 v146, 0
v_mov_b32 v147, 0
v_mfma_f32_16x16x32_bf16 v[208:211], a[124:127], a[108:111], v[208:211]
v_mov_b32 v152, 0
v_mov_b32 v153, 0
v_mfma_f32_16x16x32_bf16 v[216:219], a[116:119], a[108:111], v[216:219]
v_mov_b32 v154, 0
v_mov_b32 v155, 0
v_mfma_f32_16x16x32_bf16 v[216:219], a[112:115], a[104:107], v[216:219]
v_mfma_f32_16x16x32_bf16 v[244:247], a[184:187], a[104:107], v[244:247]
buffer_load_dwordx4 v6, s[12:15], s64 offen offset:1024 lds
v_mfma_f32_16x16x32_bf16 v[244:247], a[188:191], a[108:111], v[244:247]
v_mfma_f32_16x16x32_bf16 v[192:195], a[180:183], a[108:111], v[192:195]
v_mfma_f32_16x16x32_bf16 v[192:195], a[176:179], a[104:107], v[192:195]
v_mfma_f32_16x16x32_bf16 v[200:203], a[168:171], a[104:107], v[200:203]
v_mfma_f32_16x16x32_bf16 v[200:203], a[172:175], a[108:111], v[200:203]
v_mfma_f32_16x16x32_bf16 v[88:91], a[164:167], a[108:111], v[88:91]
v_mfma_f32_16x16x32_bf16 v[88:91], a[160:163], a[104:107], v[88:91]
s_waitcnt lgkmcnt(0)
v_mfma_f32_16x16x32_bf16 v[36:39], a[128:131], a[80:83], v[36:39]
s_waitcnt vmcnt(23)
v_mfma_f32_16x16x32_bf16 v[36:39], a[132:135], a[84:87], v[36:39]
s_barrier
v_mfma_f32_16x16x32_bf16 v[44:47], a[140:143], a[84:87], v[44:47]
s_add_u32 s53, s87, 524288
ds_read_b128 a[96:99], v9 offset:4096
v_mfma_f32_16x16x32_bf16 v[44:47], a[136:139], a[80:83], v[44:47]
s_xor_b32 s75, s93, 7
s_lshl_b32 s76, s75, 19
s_add_u32 s76, s76, s74
v_mfma_f32_16x16x32_bf16 v[32:35], a[144:147], a[80:83], v[32:35]
s_lshl_b32 s79, s75, 13
s_add_u32 s79, s79, s78
ds_read_b128 a[100:103], v10 offset:4096
v_mfma_f32_16x16x32_bf16 v[32:35], a[148:151], a[84:87], v[32:35]
s_add_u32 m0, s77, 0
s_add_u32 s64, s76, 0
ds_read_b128 a[104:107], v9 offset:6144
v_mfma_f32_16x16x32_bf16 v[52:55], a[156:159], a[84:87], v[52:55]
buffer_load_dwordx4 v7, s[20:23], s64 offen lds
v_mfma_f32_16x16x32_bf16 v[52:55], a[152:155], a[80:83], v[52:55]
ds_read_b64_tr_b16 a[160:161], v11 offset:16384
ds_read_b64_tr_b16 a[162:163], v11 offset:16896
v_mfma_f32_16x16x32_bf16 v[60:63], a[64:67], a[80:83], v[60:63]
buffer_store_dwordx4 a[20:23], v15, s[24:27], s53 offen offset:1024 sc1
v_mfma_f32_16x16x32_bf16 v[60:63], a[68:71], a[84:87], v[60:63]
ds_read_b128 a[108:111], v10 offset:6144
v_mfma_f32_16x16x32_bf16 v[68:71], a[76:79], a[84:87], v[68:71]
buffer_load_dwordx4 v8, s[20:23], s64 offen offset:1024 lds
v_mfma_f32_16x16x32_bf16 v[68:71], a[72:75], a[80:83], v[68:71]
ds_read_b64_tr_b16 a[164:165], v11 offset:20480
ds_read_b64_tr_b16 a[166:167], v11 offset:20992
v_mfma_f32_16x16x32_bf16 v[76:79], a[72:75], a[88:91], v[76:79]
v_add_u32 v9, -65536, v9
v_add_u32 v10, -65536, v10
v_mfma_f32_16x16x32_bf16 v[76:79], a[76:79], a[92:95], v[76:79]
ds_read_b64_tr_b16 a[168:169], v12 offset:16384
ds_read_b64_tr_b16 a[170:171], v12 offset:16896
v_mfma_f32_16x16x32_bf16 v[84:87], a[68:71], a[92:95], v[84:87]
s_add_u32 m0, s80, 0
s_add_u32 s64, s79, 0
v_mfma_f32_16x16x32_bf16 v[84:87], a[64:67], a[88:91], v[84:87]
ds_read_b64_tr_b16 a[172:173], v12 offset:20480
ds_read_b64_tr_b16 a[174:175], v12 offset:20992
v_mfma_f32_16x16x32_bf16 v[92:95], a[152:155], a[88:91], v[92:95]
buffer_load_dwordx4 v15, s[24:27], s64 offen sc1 lds
v_mfma_f32_16x16x32_bf16 v[92:95], a[156:159], a[92:95], v[92:95]
v_mfma_f32_16x16x32_bf16 v[40:43], a[148:151], a[92:95], v[40:43]
ds_read_b64_tr_b16 a[176:177], v13 offset:16384
ds_read_b64_tr_b16 a[178:179], v13 offset:16896
v_mfma_f32_16x16x32_bf16 v[40:43], a[144:147], a[88:91], v[40:43]
v_mfma_f32_16x16x32_bf16 v[100:103], a[136:139], a[88:91], v[100:103]
s_add_u32 m0, s73, 36864
s_add_u32 s64, s72, 0
v_mfma_f32_16x16x32_bf16 v[100:103], a[140:143], a[92:95], v[100:103]
ds_read_b64_tr_b16 a[180:181], v13 offset:20480
ds_read_b64_tr_b16 a[182:183], v13 offset:20992
v_mfma_f32_16x16x32_bf16 v[108:111], a[132:135], a[92:95], v[108:111]
buffer_load_dwordx4 v5, s[12:15], s64 offen lds
v_mfma_f32_16x16x32_bf16 v[108:111], a[128:131], a[88:91], v[108:111]
s_waitcnt lgkmcnt(14)
ds_read_b64_tr_b16 a[184:185], v14 offset:16384
ds_read_b64_tr_b16 a[186:187], v14 offset:16896
v_mfma_f32_16x16x32_bf16 v[116:119], a[128:131], a[96:99], v[116:119]
ds_read_b64_tr_b16 a[188:189], v14 offset:20480
ds_read_b64_tr_b16 a[190:191], v14 offset:20992
v_mfma_f32_16x16x32_bf16 v[116:119], a[132:135], a[100:103], v[116:119]
v_mfma_f32_16x16x32_bf16 v[124:127], a[140:143], a[100:103], v[124:127]
v_mfma_f32_16x16x32_bf16 v[124:127], a[136:139], a[96:99], v[124:127]
ds_read_b128 a[112:115], v4 offset:24576
v_mfma_f32_16x16x32_bf16 v[132:135], a[144:147], a[96:99], v[132:135]
buffer_load_dwordx4 v6, s[12:15], s64 offen offset:1024 lds
v_mfma_f32_16x16x32_bf16 v[132:135], a[148:151], a[100:103], v[132:135]
s_add_u32 s53, s87, 528384
ds_read_b128 a[116:119], v4 offset:26624
v_mfma_f32_16x16x32_bf16 v[140:143], a[156:159], a[100:103], v[140:143]
buffer_store_dwordx4 a[12:15], v15, s[24:27], s53 offen offset:0 sc1
v_mfma_f32_16x16x32_bf16 v[140:143], a[152:155], a[96:99], v[140:143]
ds_read_b128 a[120:123], v4 offset:25600
v_mfma_f32_16x16x32_bf16 v[148:151], a[64:67], a[96:99], v[148:151]
s_add_u32 m0, s73, 38912
s_add_u32 s64, s72, 18432
v_mfma_f32_16x16x32_bf16 v[148:151], a[68:71], a[100:103], v[148:151]
ds_read_b128 a[124:127], v4 offset:27648
v_mfma_f32_16x16x32_bf16 v[48:51], a[76:79], a[100:103], v[48:51]
buffer_load_dwordx4 v5, s[12:15], s64 offen lds
v_mfma_f32_16x16x32_bf16 v[48:51], a[72:75], a[96:99], v[48:51]
s_waitcnt lgkmcnt(15)
v_mfma_f32_16x16x32_bf16 v[156:159], a[72:75], a[104:107], v[156:159]
v_mfma_f32_16x16x32_bf16 v[156:159], a[76:79], a[108:111], v[156:159]
v_mfma_f32_16x16x32_bf16 v[164:167], a[68:71], a[108:111], v[164:167]
v_mfma_f32_16x16x32_bf16 v[164:167], a[64:67], a[104:107], v[164:167]
v_mfma_f32_16x16x32_bf16 v[172:175], a[152:155], a[104:107], v[172:175]
buffer_load_dwordx4 v6, s[12:15], s64 offen offset:1024 lds
v_mfma_f32_16x16x32_bf16 v[172:175], a[156:159], a[108:111], v[172:175]
v_mfma_f32_16x16x32_bf16 v[56:59], a[148:151], a[108:111], v[56:59]
v_mfma_f32_16x16x32_bf16 v[56:59], a[144:147], a[104:107], v[56:59]
v_mfma_f32_16x16x32_bf16 v[180:183], a[136:139], a[104:107], v[180:183]
v_mfma_f32_16x16x32_bf16 v[180:183], a[140:143], a[108:111], v[180:183]
v_mfma_f32_16x16x32_bf16 v[188:191], a[132:135], a[108:111], v[188:191]
v_mfma_f32_16x16x32_bf16 v[188:191], a[128:131], a[104:107], v[188:191]
s_waitcnt lgkmcnt(0)
v_mfma_f32_16x16x32_bf16 v[196:199], a[160:163], a[80:83], v[196:199]
s_waitcnt vmcnt(19)
v_mfma_f32_16x16x32_bf16 v[196:199], a[164:167], a[84:87], v[196:199]
s_barrier
v_mfma_f32_16x16x32_bf16 v[64:67], a[172:175], a[84:87], v[64:67]
ds_read_b64_tr_b16 a[128:129], v11 offset:32768
ds_read_b64_tr_b16 a[130:131], v11 offset:33280
v_mfma_f32_16x16x32_bf16 v[64:67], a[168:171], a[80:83], v[64:67]
s_add_u32 m0, s77, 16384
s_add_u32 s64, s76, 128
v_mfma_f32_16x16x32_bf16 v[204:207], a[176:179], a[80:83], v[204:207]
buffer_load_dwordx4 v7, s[20:23], s64 offen lds
v_mfma_f32_16x16x32_bf16 v[204:207], a[180:183], a[84:87], v[204:207]
ds_read_b64_tr_b16 a[132:133], v11 offset:36864
ds_read_b64_tr_b16 a[134:135], v11 offset:37376
v_mfma_f32_16x16x32_bf16 v[212:215], a[188:191], a[84:87], v[212:215]
ds_read_b64_tr_b16 a[136:137], v12 offset:32768
ds_read_b64_tr_b16 a[138:139], v12 offset:33280
v_mfma_f32_16x16x32_bf16 v[212:215], a[184:187], a[80:83], v[212:215]
s_add_u32 s53, s87, 528384
ds_read_b64_tr_b16 a[140:141], v12 offset:36864
ds_read_b64_tr_b16 a[142:143], v12 offset:37376
v_mfma_f32_16x16x32_bf16 v[72:75], a[112:115], a[80:83], v[72:75]
buffer_load_dwordx4 v8, s[20:23], s64 offen offset:1024 lds
v_mfma_f32_16x16x32_bf16 v[72:75], a[116:119], a[84:87], v[72:75]
ds_read_b64_tr_b16 a[144:145], v13 offset:32768
ds_read_b64_tr_b16 a[146:147], v13 offset:33280
v_mfma_f32_16x16x32_bf16 v[220:223], a[124:127], a[84:87], v[220:223]
buffer_store_dwordx4 a[4:7], v15, s[24:27], s53 offen offset:1024 sc1
v_mfma_f32_16x16x32_bf16 v[220:223], a[120:123], a[80:83], v[220:223]
s_add_u32 m0, s80, 16384
s_add_u32 s64, s79, 2048
v_mfma_f32_16x16x32_bf16 v[252:255], a[120:123], a[88:91], v[252:255]
ds_read_b64_tr_b16 a[148:149], v13 offset:36864
ds_read_b64_tr_b16 a[150:151], v13 offset:37376
v_mfma_f32_16x16x32_bf16 v[252:255], a[124:127], a[92:95], v[252:255]
buffer_load_dwordx4 v15, s[24:27], s64 offen sc1 lds
v_mfma_f32_16x16x32_bf16 v[160:163], a[116:119], a[92:95], v[160:163]
ds_read_b64_tr_b16 a[152:153], v14 offset:32768
ds_read_b64_tr_b16 a[154:155], v14 offset:33280
v_mfma_f32_16x16x32_bf16 v[160:163], a[112:115], a[88:91], v[160:163]
ds_read_b64_tr_b16 a[156:157], v14 offset:36864
ds_read_b64_tr_b16 a[158:159], v14 offset:37376
v_mfma_f32_16x16x32_bf16 v[228:231], a[184:187], a[88:91], v[228:231]
s_add_u32 m0, s83, 0
s_add_u32 s64, s81, 0
v_mfma_f32_16x16x32_bf16 v[228:231], a[188:191], a[92:95], v[228:231]
v_mfma_f32_16x16x32_bf16 v[168:171], a[180:183], a[92:95], v[168:171]
buffer_load_dwordx4 v22, s[32:35], s64 offen lds
v_mfma_f32_16x16x32_bf16 v[168:171], a[176:179], a[88:91], v[168:171]
ds_read_b128 a[64:67], v4 offset:40960
v_mfma_f32_16x16x32_bf16 v[176:179], a[168:171], a[88:91], v[176:179]
s_add_u32 m0, s83, 1024
s_add_u32 s64, s81, 9216
ds_read_b128 a[80:83], v9 offset:0
v_mfma_f32_16x16x32_bf16 v[176:179], a[172:175], a[92:95], v[176:179]
v_mfma_f32_16x16x32_bf16 v[80:83], a[164:167], a[92:95], v[80:83]
buffer_load_dwordx4 v22, s[32:35], s64 offen lds
v_mfma_f32_16x16x32_bf16 v[80:83], a[160:163], a[88:91], v[80:83]
ds_read_b128 a[68:71], v4 offset:43008
v_mfma_f32_16x16x32_bf16 v[184:187], a[160:163], a[96:99], v[184:187]
ds_read_b128 a[84:87], v10 offset:0
v_mfma_f32_16x16x32_bf16 v[184:187], a[164:167], a[100:103], v[184:187]
s_add_u32 m0, s83, 2048
s_add_u32 s64, s81, 18432
v_mfma_f32_16x16x32_bf16 v[248:251], a[172:175], a[100:103], v[248:251]
v_mfma_f32_16x16x32_bf16 v[248:251], a[168:171], a[96:99], v[248:251]
buffer_load_dwordx4 v22, s[32:35], s64 offen lds
v_mfma_f32_16x16x32_bf16 v[240:243], a[176:179], a[96:99], v[240:243]
ds_read_b128 a[72:75], v4 offset:41984
v_mfma_f32_16x16x32_bf16 v[240:243], a[180:183], a[100:103], v[240:243]
ds_read_b128 a[88:91], v9 offset:2048
v_mfma_f32_16x16x32_bf16 v[232:235], a[188:191], a[100:103], v[232:235]
s_add_u32 m0, s83, 3072
s_add_u32 s64, s81, 27648
v_mfma_f32_16x16x32_bf16 v[232:235], a[184:187], a[96:99], v[232:235]
ds_read_b128 a[76:79], v4 offset:44032
v_mfma_f32_16x16x32_bf16 v[236:239], a[112:115], a[96:99], v[236:239]
buffer_load_dwordx4 v22, s[32:35], s64 offen lds
v_mfma_f32_16x16x32_bf16 v[236:239], a[116:119], a[100:103], v[236:239]
ds_read_b128 a[92:95], v10 offset:2048
v_mfma_f32_16x16x32_bf16 v[224:227], a[124:127], a[100:103], v[224:227]
s_add_u32 m0, s83, 4096
s_add_u32 s64, s81, 128
s_add_u32 s53, s87, 786432
v_mfma_f32_16x16x32_bf16 v[224:227], a[120:123], a[96:99], v[224:227]
buffer_store_dwordx4 a[0:3], v15, s[24:27], s53 offen offset:0 sc1
v_mfma_f32_16x16x32_bf16 v[208:211], a[120:123], a[104:107], v[208:211]
buffer_load_dwordx4 v24, s[32:35], s64 offen lds
v_mfma_f32_16x16x32_bf16 v[208:211], a[124:127], a[108:111], v[208:211]
s_waitcnt vmcnt(26)
v_mfma_f32_16x16x32_bf16 v[216:219], a[116:119], a[108:111], v[216:219]
v_cmp_gt_u32 vcc, 8, v30
v_mfma_f32_16x16x32_bf16 v[216:219], a[112:115], a[104:107], v[216:219]
s_add_u32 m0, s83, 5120
s_add_u32 s64, s82, 0
v_mfma_f32_16x16x32_bf16 v[244:247], a[184:187], a[104:107], v[244:247]
v_mfma_f32_16x16x32_bf16 v[244:247], a[188:191], a[108:111], v[244:247]
buffer_load_dwordx4 v25, s[48:51], s64 offen lds
v_mfma_f32_16x16x32_bf16 v[192:195], a[180:183], a[108:111], v[192:195]
v_mfma_f32_16x16x32_bf16 v[192:195], a[176:179], a[104:107], v[192:195]
s_cbranch_vccnz CK_KV
CK_KV_R:
v_mfma_f32_16x16x32_bf16 v[200:203], a[168:171], a[104:107], v[200:203]
v_mfma_f32_16x16x32_bf16 v[200:203], a[172:175], a[108:111], v[200:203]
v_mfma_f32_16x16x32_bf16 v[88:91], a[164:167], a[108:111], v[88:91]
v_mfma_f32_16x16x32_bf16 v[88:91], a[160:163], a[104:107], v[88:91]
s_waitcnt lgkmcnt(0)
v_mfma_f32_16x16x32_bf16 v[36:39], a[128:131], a[80:83], v[36:39]
s_waitcnt vmcnt(25)
v_mov_b32 v6, 0xf149f2ca
v_mfma_f32_16x16x32_bf16 v[36:39], a[132:135], a[84:87], v[36:39]
s_barrier
v_mfma_f32_16x16x32_bf16 v[44:47], a[140:143], a[84:87], v[44:47]
ds_read_b128 a[96:99], v9 offset:4096
v_mfma_f32_16x16x32_bf16 v[44:47], a[136:139], a[80:83], v[44:47]
s_lshl_b32 s70, s3, 12
s_add_u32 s68, s70, s94
ds_read_b128 a[100:103], v10 offset:4096
v_mfma_f32_16x16x32_bf16 v[32:35], a[144:147], a[80:83], v[32:35]
s_add_u32 m0, s70, 32768
s_cmp_lt_u32 s3, 2
s_cselect_b32 s64, s68, 2147418112
v_mfma_f32_16x16x32_bf16 v[32:35], a[148:151], a[84:87], v[32:35]
buffer_load_dwordx4 v15, s[24:27], s64 offen offset:0 sc1 lds
v_mfma_f32_16x16x32_bf16 v[52:55], a[156:159], a[84:87], v[52:55]
ds_read_b128 a[104:107], v9 offset:6144
v_mfma_f32_16x16x32_bf16 v[52:55], a[152:155], a[80:83], v[52:55]
ds_read_b64_tr_b16 a[160:161], v11 offset:49152
ds_read_b64_tr_b16 a[162:163], v11 offset:49664
v_mfma_f32_16x16x32_bf16 v[60:63], a[64:67], a[80:83], v[60:63]
s_cmp_eq_u32 s66, 0
s_cbranch_scc1 D0
D0_R:
v_mfma_f32_16x16x32_bf16 v[60:63], a[68:71], a[84:87], v[60:63]
s_lshl_b32 s52, s4, 18
s_add_u32 s52, s52, 45088768
ds_read_b128 a[108:111], v10 offset:6144
v_mfma_f32_16x16x32_bf16 v[68:71], a[76:79], a[84:87], v[68:71]
s_lshl_b32 s54, s66, 9
v_add_u32 v9, 32768, v9
v_add_u32 v10, 32768, v10
v_mfma_f32_16x16x32_bf16 v[68:71], a[72:75], a[80:83], v[68:71]
s_add_u32 s54, s54, s52
ds_read_b64_tr_b16 a[164:165], v11 offset:53248
ds_read_b64_tr_b16 a[166:167], v11 offset:53760
v_mfma_f32_16x16x32_bf16 v[76:79], a[72:75], a[88:91], v[76:79]
s_lshl_b32 s55, s67, 9
s_add_u32 s55, s55, s52
v_mfma_f32_16x16x32_bf16 v[76:79], a[76:79], a[92:95], v[76:79]
s_add_u32 s53, s87, 786432
ds_read_b64_tr_b16 a[168:169], v12 offset:49152
L_PAD7:
s_cbranch_execz L_PAD11
ds_read_b64_tr_b16 a[170:171], v12 offset:49664
v_mfma_f32_16x16x32_bf16 v[84:87], a[68:71], a[92:95], v[84:87]
buffer_load_dwordx4 v15, s[24:27], s64 offen offset:1024 sc1 lds
v_mfma_f32_16x16x32_bf16 v[84:87], a[64:67], a[88:91], v[84:87]
s_max_u32 s65, s66, 1
ds_read_b64_tr_b16 a[172:173], v12 offset:53248
ds_read_b64_tr_b16 a[174:175], v12 offset:53760
v_mfma_f32_16x16x32_bf16 v[92:95], a[152:155], a[88:91], v[92:95]
buffer_store_dwordx4 a[8:11], v15, s[24:27], s53 offen offset:1024 sc1
v_mfma_f32_16x16x32_bf16 v[92:95], a[156:159], a[92:95], v[92:95]
s_lshl_b32 s65, s65, 9
s_add_u32 s52, s52, s65
s_sub_u32 s65, s55, s52
v_mfma_f32_16x16x32_bf16 v[40:43], a[148:151], a[92:95], v[40:43]
s_sub_u32 s65, s65, 163840
ds_read_b64_tr_b16 a[176:177], v13 offset:49152
ds_read_b64_tr_b16 a[178:179], v13 offset:49664
v_mfma_f32_16x16x32_bf16 v[40:43], a[144:147], a[88:91], v[40:43]
s_add_u32 s52, s52, 65280
v_mfma_f32_16x16x32_bf16 v[100:103], a[136:139], a[88:91], v[100:103]
ds_read_b64_tr_b16 a[180:181], v13 offset:53248
ds_read_b64_tr_b16 a[182:183], v13 offset:53760
v_mfma_f32_16x16x32_bf16 v[100:103], a[140:143], a[92:95], v[100:103]
v_cmp_lt_u32 s[96:97], 0, v3
v_lshlrev_b32 v16, 15, v3
v_mfma_f32_16x16x32_bf16 v[108:111], a[132:135], a[92:95], v[108:111]
ds_read_b64_tr_b16 a[184:185], v14 offset:49152
ds_read_b64_tr_b16 a[186:187], v14 offset:49664
v_mfma_f32_16x16x32_bf16 v[108:111], a[128:131], a[88:91], v[108:111]
s_waitcnt lgkmcnt(15)
v_lshl_add_u32 v16, v2, 4, v16
v_add_u32 v16, s52, v16
v_mfma_f32_16x16x32_bf16 v[116:119], a[128:131], a[96:99], v[116:119]
ds_read_b64_tr_b16 a[188:189], v14 offset:53248
ds_read_b64_tr_b16 a[190:191], v14 offset:53760
v_mfma_f32_16x16x32_bf16 v[116:119], a[132:135], a[100:103], v[116:119]
buffer_load_dwordx4 v15, s[24:27], s64 offen offset:2048 sc1 lds
v_mfma_f32_16x16x32_bf16 v[124:127], a[140:143], a[100:103], v[124:127]
v_accvgpr_write_b32 a244, v16
v_add_u32 v16, 131072, v16
v_mfma_f32_16x16x32_bf16 v[124:127], a[136:139], a[96:99], v[124:127]
ds_read_b128 a[112:115], v4 offset:57344
v_add_u32 v21, s65, v16
v_mfma_f32_16x16x32_bf16 v[132:135], a[144:147], a[96:99], v[132:135]
v_cndmask_b32 v16, v16, v21, s[96:97]
v_accvgpr_write_b32 a248, v16
v_mfma_f32_16x16x32_bf16 v[132:135], a[148:151], a[100:103], v[132:135]
ds_read_b128 a[116:119], v4 offset:59392
v_cmp_lt_u32 s[96:97], 1, v3
v_mfma_f32_16x16x32_bf16 v[140:143], a[156:159], a[100:103], v[140:143]
v_add_u32 v21, 131072, v21
v_mfma_f32_16x16x32_bf16 v[140:143], a[152:155], a[96:99], v[140:143]
ds_read_b128 a[120:123], v4 offset:58368
v_cndmask_b32 v21, v21, v20, s[96:97]
v_mfma_f32_16x16x32_bf16 v[148:151], a[64:67], a[96:99], v[148:151]
v_accvgpr_write_b32 a252, v21
v_mfma_f32_16x16x32_bf16 v[148:151], a[68:71], a[100:103], v[148:151]
s_lshr_b32 s52, s4, 3
s_mul_i32 s52, s52, 75776
ds_read_b128 a[124:127], v4 offset:60416
v_mfma_f32_16x16x32_bf16 v[48:51], a[76:79], a[100:103], v[48:51]
s_waitcnt lgkmcnt(15)
s_add_u32 s52, s52, 54525952
s_and_b32 s65, s4, 7
v_mfma_f32_16x16x32_bf16 v[48:51], a[72:75], a[96:99], v[48:51]
buffer_load_dwordx4 v15, s[24:27], s64 offen offset:3072 sc1 lds
v_mfma_f32_16x16x32_bf16 v[156:159], a[72:75], a[104:107], v[156:159]
s_mul_i32 s65, s65, 8192
s_add_u32 s52, s52, s65
s_mul_i32 s78, s66, 303104
v_mfma_f32_16x16x32_bf16 v[156:159], a[76:79], a[108:111], v[156:159]
s_add_u32 s78, s78, s52
s_mul_i32 s79, s67, 303104
s_add_u32 s79, s79, s52
v_mfma_f32_16x16x32_bf16 v[164:167], a[68:71], a[108:111], v[164:167]
s_cmp_lt_u32 s4, 16
s_cselect_b32 s90, s66, s67
s_and_b32 s52, s4, 15
v_mfma_f32_16x16x32_bf16 v[164:167], a[64:67], a[104:107], v[164:167]
s_lshl4_add_u32 s90, s90, s52
s_mul_i32 s90, s90, 2304
s_mov_b32 s76, 0
v_mfma_f32_16x16x32_bf16 v[172:175], a[152:155], a[104:107], v[172:175]
s_add_u32 s53, s87, 790528
v_mov_b32 v7, 0x5d800000
v_and_b32 v28, 31, v1
v_mfma_f32_16x16x32_bf16 v[172:175], a[156:159], a[108:111], v[172:175]
buffer_store_dwordx4 a[16:19], v15, s[24:27], s53 offen offset:0 sc1
v_mfma_f32_16x16x32_bf16 v[56:59], a[148:151], a[108:111], v[56:59]
v_lshlrev_b32 v28, 10, v28
v_add_u32 v28, 75497992, v28
v_mfma_f32_16x16x32_bf16 v[56:59], a[144:147], a[104:107], v[56:59]
v_lshlrev_b32 v31, 2, v1
v_mfma_f32_16x16x32_bf16 v[180:183], a[136:139], a[104:107], v[180:183]
v_mfma_f32_16x16x32_bf16 v[180:183], a[140:143], a[108:111], v[180:183]
v_mfma_f32_16x16x32_bf16 v[188:191], a[132:135], a[108:111], v[188:191]
v_mfma_f32_16x16x32_bf16 v[188:191], a[128:131], a[104:107], v[188:191]
s_waitcnt lgkmcnt(0)
v_mfma_f32_16x16x32_bf16 v[196:199], a[160:163], a[80:83], v[196:199]
s_waitcnt vmcnt(17)
v_mfma_f32_16x16x32_bf16 v[196:199], a[164:167], a[84:87], v[196:199]
s_barrier
v_mfma_f32_16x16x32_bf16 v[64:67], a[172:175], a[84:87], v[64:67]
ds_read_b64_tr_b16 a[128:129], v11 offset:0
ds_read_b64_tr_b16 a[130:131], v11 offset:512
v_mfma_f32_16x16x32_bf16 v[64:67], a[168:171], a[80:83], v[64:67]
s_add_u32 m0, s70, 49152
s_add_u32 s64, s68, 16384
s_waitcnt vmcnt(6)
v_mfma_f32_16x16x32_bf16 v[204:207], a[176:179], a[80:83], v[204:207]
buffer_load_dwordx4 v15, s[24:27], s64 offen offset:0 sc1 lds
v_mfma_f32_16x16x32_bf16 v[204:207], a[180:183], a[84:87], v[204:207]
ds_read_b64_tr_b16 a[132:133], v11 offset:4096
ds_read_b64_tr_b16 a[134:135], v11 offset:4608
v_mfma_f32_16x16x32_bf16 v[212:215], a[188:191], a[84:87], v[212:215]
ds_read_b64_tr_b16 a[136:137], v12 offset:0
ds_read_b64_tr_b16 a[138:139], v12 offset:512
v_mfma_f32_16x16x32_bf16 v[212:215], a[184:187], a[80:83], v[212:215]
ds_read_b64_tr_b16 a[140:141], v12 offset:4096
ds_read_b64_tr_b16 a[142:143], v12 offset:4608
v_mfma_f32_16x16x32_bf16 v[72:75], a[112:115], a[80:83], v[72:75]
ds_read_b64_tr_b16 a[192:193], v23 offset:0
ds_read_b64_tr_b16 a[194:195], v23 offset:2048
v_mfma_f32_16x16x32_bf16 v[72:75], a[116:119], a[84:87], v[72:75]
ds_read_b64_tr_b16 a[144:145], v13 offset:0
ds_read_b64_tr_b16 a[146:147], v13 offset:512
v_mfma_f32_16x16x32_bf16 v[220:223], a[124:127], a[84:87], v[220:223]
ds_read_b64_tr_b16 a[196:197], v23 offset:32
ds_read_b64_tr_b16 a[198:199], v23 offset:2080
v_mfma_f32_16x16x32_bf16 v[220:223], a[120:123], a[80:83], v[220:223]
ds_read_b64_tr_b16 a[148:149], v13 offset:4096
ds_read_b64_tr_b16 a[150:151], v13 offset:4608
v_mfma_f32_16x16x32_bf16 v[252:255], a[120:123], a[88:91], v[252:255]
ds_read_b64_tr_b16 a[200:201], v23 offset:64
ds_read_b64_tr_b16 a[202:203], v23 offset:2112
v_mfma_f32_16x16x32_bf16 v[252:255], a[124:127], a[92:95], v[252:255]
ds_read_b64_tr_b16 a[152:153], v14 offset:0
ds_read_b64_tr_b16 a[154:155], v14 offset:512
v_mfma_f32_16x16x32_bf16 v[160:163], a[116:119], a[92:95], v[160:163]
buffer_load_dwordx4 v15, s[24:27], s64 offen offset:1024 sc1 lds
v_mfma_f32_16x16x32_bf16 v[160:163], a[112:115], a[88:91], v[160:163]
ds_read_b64_tr_b16 a[156:157], v14 offset:4096
ds_read_b64_tr_b16 a[158:159], v14 offset:4608
v_mfma_f32_16x16x32_bf16 v[228:231], a[184:187], a[88:91], v[228:231]
ds_read_b64_tr_b16 a[204:205], v23 offset:96
ds_read_b64_tr_b16 a[206:207], v23 offset:2144
v_mfma_f32_16x16x32_bf16 v[228:231], a[188:191], a[92:95], v[228:231]
ds_read_b64_tr_b16 a[208:209], v27 offset:4096
ds_read_b64_tr_b16 a[210:211], v27 offset:4608
v_mfma_f32_16x16x32_bf16 v[168:171], a[180:183], a[92:95], v[168:171]
ds_read_b128 a[64:67], v4 offset:8192
v_mfma_f32_16x16x32_bf16 v[168:171], a[176:179], a[88:91], v[168:171]
s_add_u32 s53, s87, 790528
ds_read_b64_tr_b16 a[212:213], v27 offset:5120
ds_read_b64_tr_b16 a[214:215], v27 offset:5632
v_mfma_f32_16x16x32_bf16 v[176:179], a[168:171], a[88:91], v[176:179]
ds_read_b128 a[80:83], v9 offset:0
v_readlane_b32 s81, v26, 0
v_mfma_f32_16x16x32_bf16 v[176:179], a[172:175], a[92:95], v[176:179]
buffer_store_dwordx4 a[24:27], v15, s[24:27], s53 offen offset:1024 sc1
v_mfma_f32_16x16x32_bf16 v[80:83], a[164:167], a[92:95], v[80:83]
ds_read_b128 a[68:71], v4 offset:10240
v_readlane_b32 s82, v26, 1
v_mfma_f32_16x16x32_bf16 v[80:83], a[160:163], a[88:91], v[80:83]
v_readlane_b32 s71, v26, 2
v_readlane_b32 s72, v26, 3
v_mfma_f32_16x16x32_bf16 v[184:187], a[160:163], a[96:99], v[184:187]
ds_read_b128 a[84:87], v10 offset:0
v_readlane_b32 s74, v26, 4
v_mfma_f32_16x16x32_bf16 v[184:187], a[164:167], a[100:103], v[184:187]
buffer_load_dwordx4 v15, s[24:27], s64 offen offset:2048 sc1 lds
v_mfma_f32_16x16x32_bf16 v[248:251], a[172:175], a[100:103], v[248:251]
v_readlane_b32 s75, v26, 5
v_mfma_f32_16x16x32_bf16 v[248:251], a[168:171], a[96:99], v[248:251]
ds_read_b128 a[72:75], v4 offset:9216
v_mfma_f32_16x16x32_bf16 v[240:243], a[176:179], a[96:99], v[240:243]
v_mfma_f32_16x16x32_bf16 v[240:243], a[180:183], a[100:103], v[240:243]
ds_read_b128 a[88:91], v9 offset:2048
v_mfma_f32_16x16x32_bf16 v[232:235], a[188:191], a[100:103], v[232:235]
v_mfma_f32_16x16x32_bf16 v[232:235], a[184:187], a[96:99], v[232:235]
ds_read_b128 a[76:79], v4 offset:11264
v_mfma_f32_16x16x32_bf16 v[236:239], a[112:115], a[96:99], v[236:239]
v_mfma_f32_16x16x32_bf16 v[236:239], a[116:119], a[100:103], v[236:239]
ds_read_b128 a[92:95], v10 offset:2048
v_mfma_f32_16x16x32_bf16 v[224:227], a[124:127], a[100:103], v[224:227]
v_mfma_f32_16x16x32_bf16 v[224:227], a[120:123], a[96:99], v[224:227]
buffer_load_dwordx4 v15, s[24:27], s64 offen offset:3072 sc1 lds
v_mfma_f32_16x16x32_bf16 v[208:211], a[120:123], a[104:107], v[208:211]
v_mfma_f32_16x16x32_bf16 v[208:211], a[124:127], a[108:111], v[208:211]
v_mfma_f32_16x16x32_bf16 v[216:219], a[116:119], a[108:111], v[216:219]
v_mfma_f32_16x16x32_bf16 v[216:219], a[112:115], a[104:107], v[216:219]
v_mfma_f32_16x16x32_bf16 v[244:247], a[184:187], a[104:107], v[244:247]
v_mfma_f32_16x16x32_bf16 v[244:247], a[188:191], a[108:111], v[244:247]
v_mfma_f32_16x16x32_bf16 v[192:195], a[180:183], a[108:111], v[192:195]
v_mfma_f32_16x16x32_bf16 v[192:195], a[176:179], a[104:107], v[192:195]
v_mfma_f32_16x16x32_bf16 v[200:203], a[168:171], a[104:107], v[200:203]
v_mfma_f32_16x16x32_bf16 v[200:203], a[172:175], a[108:111], v[200:203]
v_mfma_f32_16x16x32_bf16 v[88:91], a[164:167], a[108:111], v[88:91]
v_mfma_f32_16x16x32_bf16 v[88:91], a[160:163], a[104:107], v[88:91]
s_waitcnt lgkmcnt(0)
v_mfma_f32_16x16x32_bf16 v[36:39], a[128:131], a[80:83], v[36:39]
s_waitcnt vmcnt(18)
v_mfma_f32_16x16x32_bf16 v[36:39], a[132:135], a[84:87], v[36:39]
s_barrier
v_mfma_f32_16x16x32_bf16 v[44:47], a[140:143], a[84:87], v[44:47]
ds_read_b128 a[96:99], v9 offset:4096
v_mfma_f32_16x16x32_bf16 v[44:47], a[136:139], a[80:83], v[44:47]
s_add_u32 m0, s70, 65536
s_add_u32 s64, s68, 32768
ds_read_b128 a[100:103], v10 offset:4096
v_mfma_f32_16x16x32_bf16 v[32:35], a[144:147], a[80:83], v[32:35]
buffer_load_dwordx4 v15, s[24:27], s64 offen offset:0 sc1 lds
v_mfma_f32_16x16x32_bf16 v[32:35], a[148:151], a[84:87], v[32:35]
ds_read_b128 a[104:107], v9 offset:6144
v_mfma_f32_16x16x32_bf16 v[52:55], a[156:159], a[84:87], v[52:55]
ds_read_b64_tr_b16 a[160:161], v11 offset:16384
ds_read_b64_tr_b16 a[162:163], v11 offset:16896
v_mfma_f32_16x16x32_bf16 v[52:55], a[152:155], a[80:83], v[52:55]
buffer_store_dwordx4 a[192:195], v15, s[24:27], s81 offen sc1
v_mfma_f32_16x16x32_bf16 v[60:63], a[64:67], a[80:83], v[60:63]
v_mfma_f32_16x16x32_bf16 v[60:63], a[68:71], a[84:87], v[60:63]
ds_read_b128 a[108:111], v10 offset:6144
v_mfma_f32_16x16x32_bf16 v[68:71], a[76:79], a[84:87], v[68:71]
v_cvt_pk_bf16_f32 v36, v36, v37
v_cvt_pk_bf16_f32 v37, v38, v39
v_mfma_f32_16x16x32_bf16 v[68:71], a[72:75], a[80:83], v[68:71]
ds_read_b64_tr_b16 a[164:165], v11 offset:20480
ds_read_b64_tr_b16 a[166:167], v11 offset:20992
v_mfma_f32_16x16x32_bf16 v[76:79], a[72:75], a[88:91], v[76:79]
buffer_store_dwordx4 a[196:199], v15, s[24:27], s82 offen sc1
v_mfma_f32_16x16x32_bf16 v[76:79], a[76:79], a[92:95], v[76:79]
ds_read_b64_tr_b16 a[168:169], v12 offset:16384
ds_read_b64_tr_b16 a[170:171], v12 offset:16896
v_mfma_f32_16x16x32_bf16 v[84:87], a[68:71], a[92:95], v[84:87]
buffer_load_dwordx4 v15, s[24:27], s64 offen offset:1024 sc1 lds
v_mfma_f32_16x16x32_bf16 v[84:87], a[64:67], a[88:91], v[84:87]
ds_read_b64_tr_b16 a[172:173], v12 offset:20480
ds_read_b64_tr_b16 a[174:175], v12 offset:20992
v_mfma_f32_16x16x32_bf16 v[92:95], a[152:155], a[88:91], v[92:95]
v_cvt_pk_bf16_f32 v38, v44, v45
v_cvt_pk_bf16_f32 v39, v46, v47
v_mfma_f32_16x16x32_bf16 v[92:95], a[156:159], a[92:95], v[92:95]
buffer_store_dwordx4 a[200:203], v15, s[24:27], s71 offen sc1
v_mfma_f32_16x16x32_bf16 v[40:43], a[148:151], a[92:95], v[40:43]
ds_read_b64_tr_b16 a[176:177], v13 offset:16384
ds_read_b64_tr_b16 a[178:179], v13 offset:16896
v_mfma_f32_16x16x32_bf16 v[40:43], a[144:147], a[88:91], v[40:43]
v_cvt_pk_bf16_f32 v32, v32, v33
v_cvt_pk_bf16_f32 v33, v34, v35
v_mfma_f32_16x16x32_bf16 v[100:103], a[136:139], a[88:91], v[100:103]
ds_read_b64_tr_b16 a[180:181], v13 offset:20480
ds_read_b64_tr_b16 a[182:183], v13 offset:20992
v_mfma_f32_16x16x32_bf16 v[100:103], a[140:143], a[92:95], v[100:103]
v_cvt_pk_bf16_f32 v34, v52, v53
v_cvt_pk_bf16_f32 v35, v54, v55
v_mfma_f32_16x16x32_bf16 v[108:111], a[132:135], a[92:95], v[108:111]
ds_read_b64_tr_b16 a[184:185], v14 offset:16384
ds_read_b64_tr_b16 a[186:187], v14 offset:16896
v_mfma_f32_16x16x32_bf16 v[108:111], a[128:131], a[88:91], v[108:111]
s_waitcnt lgkmcnt(15)
v_mfma_f32_16x16x32_bf16 v[116:119], a[128:131], a[96:99], v[116:119]
ds_read_b64_tr_b16 a[188:189], v14 offset:20480
ds_read_b64_tr_b16 a[190:191], v14 offset:20992
v_mfma_f32_16x16x32_bf16 v[116:119], a[132:135], a[100:103], v[116:119]
buffer_load_dwordx4 v15, s[24:27], s64 offen offset:2048 sc1 lds
v_mfma_f32_16x16x32_bf16 v[124:127], a[140:143], a[100:103], v[124:127]
buffer_store_dwordx4 a[204:207], v15, s[24:27], s72 offen sc1
v_mfma_f32_16x16x32_bf16 v[124:127], a[136:139], a[96:99], v[124:127]
ds_read_b128 a[112:115], v4 offset:24576
v_cvt_pk_bf16_f32 v40, v40, v41
v_mfma_f32_16x16x32_bf16 v[132:135], a[144:147], a[96:99], v[132:135]
v_cvt_pk_bf16_f32 v41, v42, v43
v_cvt_pk_bf16_f32 v42, v92, v93
v_mfma_f32_16x16x32_bf16 v[132:135], a[148:151], a[100:103], v[132:135]
ds_read_b128 a[116:119], v4 offset:26624
v_cvt_pk_bf16_f32 v43, v94, v95
v_mfma_f32_16x16x32_bf16 v[140:143], a[156:159], a[100:103], v[140:143]
v_cvt_pk_bf16_f32 v108, v108, v109
v_cvt_pk_bf16_f32 v109, v110, v111
v_mfma_f32_16x16x32_bf16 v[140:143], a[152:155], a[96:99], v[140:143]
ds_read_b128 a[120:123], v4 offset:25600
v_cvt_pk_bf16_f32 v110, v100, v101
v_mfma_f32_16x16x32_bf16 v[148:151], a[64:67], a[96:99], v[148:151]
buffer_store_dwordx4 a[208:211], v15, s[24:27], s74 offen sc1
v_mfma_f32_16x16x32_bf16 v[148:151], a[68:71], a[100:103], v[148:151]
ds_read_b128 a[124:127], v4 offset:27648
v_cvt_pk_bf16_f32 v111, v102, v103
v_mfma_f32_16x16x32_bf16 v[48:51], a[76:79], a[100:103], v[48:51]
s_waitcnt lgkmcnt(15)
v_cvt_pk_bf16_f32 v116, v116, v117
v_cvt_pk_bf16_f32 v117, v118, v119
v_mfma_f32_16x16x32_bf16 v[48:51], a[72:75], a[96:99], v[48:51]
buffer_load_dwordx4 v15, s[24:27], s64 offen offset:3072 sc1 lds
v_mfma_f32_16x16x32_bf16 v[156:159], a[72:75], a[104:107], v[156:159]
v_cvt_pk_bf16_f32 v118, v124, v125
v_cvt_pk_bf16_f32 v119, v126, v127
v_mfma_f32_16x16x32_bf16 v[156:159], a[76:79], a[108:111], v[156:159]
buffer_store_dwordx4 a[212:215], v15, s[24:27], s75 offen sc1
v_mfma_f32_16x16x32_bf16 v[164:167], a[68:71], a[108:111], v[164:167]
v_cvt_pk_bf16_f32 v132, v132, v133
v_cvt_pk_bf16_f32 v133, v134, v135
v_mfma_f32_16x16x32_bf16 v[164:167], a[64:67], a[104:107], v[164:167]
v_cvt_pk_bf16_f32 v134, v140, v141
v_cvt_pk_bf16_f32 v135, v142, v143
v_mfma_f32_16x16x32_bf16 v[172:175], a[152:155], a[104:107], v[172:175]
v_mfma_f32_16x16x32_bf16 v[172:175], a[156:159], a[108:111], v[172:175]
v_mfma_f32_16x16x32_bf16 v[56:59], a[148:151], a[108:111], v[56:59]
v_mfma_f32_16x16x32_bf16 v[56:59], a[144:147], a[104:107], v[56:59]
v_mfma_f32_16x16x32_bf16 v[180:183], a[136:139], a[104:107], v[180:183]
v_mfma_f32_16x16x32_bf16 v[180:183], a[140:143], a[108:111], v[180:183]
v_mfma_f32_16x16x32_bf16 v[188:191], a[132:135], a[108:111], v[188:191]
v_mfma_f32_16x16x32_bf16 v[188:191], a[128:131], a[104:107], v[188:191]
s_waitcnt lgkmcnt(0)
v_mfma_f32_16x16x32_bf16 v[196:199], a[160:163], a[80:83], v[196:199]
s_waitcnt vmcnt(16)
v_mfma_f32_16x16x32_bf16 v[196:199], a[164:167], a[84:87], v[196:199]
s_barrier
v_mfma_f32_16x16x32_bf16 v[64:67], a[172:175], a[84:87], v[64:67]
ds_read_b128 a[192:195], v4 offset:32768
v_cvt_pk_bf16_f32 v56, v56, v57
v_mfma_f32_16x16x32_bf16 v[64:67], a[168:171], a[80:83], v[64:67]
s_add_u32 m0, s70, 81920
s_add_u32 s64, s68, 49152
v_cvt_pk_bf16_f32 v57, v58, v59
v_mfma_f32_16x16x32_bf16 v[204:207], a[176:179], a[80:83], v[204:207]
buffer_load_dwordx4 v15, s[24:27], s64 offen offset:0 sc1 lds
v_mfma_f32_16x16x32_bf16 v[204:207], a[180:183], a[84:87], v[204:207]
ds_read_b128 a[196:199], v4 offset:33792
v_cvt_pk_bf16_f32 v58, v172, v173
v_mfma_f32_16x16x32_bf16 v[212:215], a[188:191], a[84:87], v[212:215]
v_cvt_pk_bf16_f32 v59, v174, v175
v_cvt_pk_bf16_f32 v188, v188, v189
v_mfma_f32_16x16x32_bf16 v[212:215], a[184:187], a[80:83], v[212:215]
ds_read_b128 a[200:203], v4 offset:34816
v_cvt_pk_bf16_f32 v189, v190, v191
v_mfma_f32_16x16x32_bf16 v[80:83], a[160:163], a[88:91], v[80:83]
v_cvt_pk_bf16_f32 v190, v180, v181
v_cvt_pk_bf16_f32 v191, v182, v183
v_mfma_f32_16x16x32_bf16 v[80:83], a[164:167], a[92:95], v[80:83]
ds_read_b128 a[204:207], v4 offset:35840
ds_bpermute_b32 v8, v17, v63
v_mfma_f32_16x16x32_bf16 v[176:179], a[172:175], a[92:95], v[176:179]
v_cvt_pk_bf16_f32 v196, v196, v197
v_cvt_pk_bf16_f32 v197, v198, v199
v_mfma_f32_16x16x32_bf16 v[176:179], a[168:171], a[88:91], v[176:179]
ds_read_b128 a[208:211], v4 offset:36864
v_cvt_pk_bf16_f32 v198, v64, v65
v_mfma_f32_16x16x32_bf16 v[168:171], a[176:179], a[88:91], v[168:171]
v_cvt_pk_bf16_f32 v199, v66, v67
v_cvt_pk_bf16_f32 v60, v60, v61
v_mfma_f32_16x16x32_bf16 v[168:171], a[180:183], a[92:95], v[168:171]
ds_read_b128 a[212:215], v4 offset:37888
v_cvt_pk_bf16_f32 v61, v62, v63
v_mfma_f32_16x16x32_bf16 v[228:231], a[188:191], a[92:95], v[228:231]
buffer_load_dwordx4 v15, s[24:27], s64 offen offset:1024 sc1 lds
v_mfma_f32_16x16x32_bf16 v[228:231], a[184:187], a[88:91], v[228:231]
ds_read_b128 a[216:219], v4 offset:38912
v_cvt_pk_bf16_f32 v204, v204, v205
v_mfma_f32_16x16x32_bf16 v[184:187], a[160:163], a[96:99], v[184:187]
v_cvt_pk_bf16_f32 v205, v206, v207
v_cvt_pk_bf16_f32 v206, v212, v213
v_mfma_f32_16x16x32_bf16 v[184:187], a[164:167], a[100:103], v[184:187]
ds_read_b128 a[220:223], v4 offset:39936
v_cvt_pk_bf16_f32 v207, v214, v215
v_mfma_f32_16x16x32_bf16 v[248:251], a[172:175], a[100:103], v[248:251]
v_cvt_pk_bf16_f32 v80, v80, v81
v_cvt_pk_bf16_f32 v81, v82, v83
v_mfma_f32_16x16x32_bf16 v[248:251], a[168:171], a[96:99], v[248:251]
v_cvt_pk_bf16_f32 v82, v176, v177
v_cvt_pk_bf16_f32 v83, v178, v179
v_mfma_f32_16x16x32_bf16 v[240:243], a[176:179], a[96:99], v[240:243]
v_cvt_pk_bf16_f32 v62, v68, v69
v_cvt_pk_bf16_f32 v63, v70, v71
v_mfma_f32_16x16x32_bf16 v[240:243], a[180:183], a[100:103], v[240:243]
v_accvgpr_write_b32 a128, v60
v_accvgpr_write_b32 a129, v61
v_mfma_f32_16x16x32_bf16 v[232:235], a[188:191], a[100:103], v[232:235]
v_cvt_pk_bf16_f32 v168, v168, v169
v_cvt_pk_bf16_f32 v169, v170, v171
v_mfma_f32_16x16x32_bf16 v[232:235], a[184:187], a[96:99], v[232:235]
v_cvt_pk_bf16_f32 v170, v228, v229
v_cvt_pk_bf16_f32 v171, v230, v231
v_mfma_f32_16x16x32_bf16 v[88:91], a[160:163], a[104:107], v[88:91]
v_accvgpr_write_b32 a130, v62
v_accvgpr_write_b32 a131, v63
v_mfma_f32_16x16x32_bf16 v[88:91], a[164:167], a[108:111], v[88:91]
buffer_load_dwordx4 v15, s[24:27], s64 offen offset:2048 sc1 lds
v_mfma_f32_16x16x32_bf16 v[200:203], a[172:175], a[108:111], v[200:203]
v_cvt_pk_bf16_f32 v184, v184, v185
v_cvt_pk_bf16_f32 v185, v186, v187
v_mfma_f32_16x16x32_bf16 v[200:203], a[168:171], a[104:107], v[200:203]
v_cvt_pk_bf16_f32 v186, v248, v249
v_cvt_pk_bf16_f32 v187, v250, v251
v_mfma_f32_16x16x32_bf16 v[192:195], a[176:179], a[104:107], v[192:195]
ds_bpermute_b32 v9, v17, v87
v_cvt_pk_bf16_f32 v84, v84, v85
v_mfma_f32_16x16x32_bf16 v[192:195], a[180:183], a[108:111], v[192:195]
v_cvt_pk_bf16_f32 v85, v86, v87
v_cvt_pk_bf16_f32 v86, v76, v77
v_mfma_f32_16x16x32_bf16 v[244:247], a[188:191], a[108:111], v[244:247]
v_cvt_pk_bf16_f32 v240, v240, v241
v_cvt_pk_bf16_f32 v241, v242, v243
v_mfma_f32_16x16x32_bf16 v[244:247], a[184:187], a[104:107], v[244:247]
v_cvt_pk_bf16_f32 v242, v232, v233
v_cvt_pk_bf16_f32 v243, v234, v235
v_mfma_f32_16x16x32_bf16 v[72:75], a[112:115], a[80:83], v[72:75]
v_cvt_pk_bf16_f32 v87, v78, v79
v_mov_b32 v68, 0
v_mfma_f32_16x16x32_bf16 v[72:75], a[116:119], a[84:87], v[72:75]
buffer_store_dwordx4 v[84:87], v18, s[24:27], s54 offen offset:256 sc1
v_mfma_f32_16x16x32_bf16 v[220:223], a[124:127], a[84:87], v[220:223]
v_cvt_pk_bf16_f32 v88, v88, v89
v_cvt_pk_bf16_f32 v89, v90, v91
v_mfma_f32_16x16x32_bf16 v[220:223], a[120:123], a[80:83], v[220:223]
buffer_load_dwordx4 v15, s[24:27], s64 offen offset:3072 sc1 lds
v_mfma_f32_16x16x32_bf16 v[160:163], a[112:115], a[88:91], v[160:163]
v_cvt_pk_bf16_f32 v90, v200, v201
v_cvt_pk_bf16_f32 v91, v202, v203
v_mfma_f32_16x16x32_bf16 v[160:163], a[116:119], a[92:95], v[160:163]
v_accvgpr_write_b32 a136, v84
v_accvgpr_write_b32 a137, v85
v_mfma_f32_16x16x32_bf16 v[252:255], a[124:127], a[92:95], v[252:255]
v_cvt_pk_bf16_f32 v192, v192, v193
v_cvt_pk_bf16_f32 v193, v194, v195
v_mfma_f32_16x16x32_bf16 v[252:255], a[120:123], a[88:91], v[252:255]
v_cvt_pk_bf16_f32 v194, v244, v245
v_cvt_pk_bf16_f32 v195, v246, v247
v_mfma_f32_16x16x32_bf16 v[236:239], a[112:115], a[96:99], v[236:239]
v_accvgpr_write_b32 a138, v86
v_accvgpr_write_b32 a139, v87
v_mfma_f32_16x16x32_bf16 v[236:239], a[116:119], a[100:103], v[236:239]
ds_bpermute_b32 v10, v17, v151
v_cvt_pk_bf16_f32 v148, v148, v149
v_mfma_f32_16x16x32_bf16 v[224:227], a[124:127], a[100:103], v[224:227]
v_cvt_pk_bf16_f32 v149, v150, v151
v_cvt_pk_bf16_f32 v150, v48, v49
v_mfma_f32_16x16x32_bf16 v[224:227], a[120:123], a[96:99], v[224:227]
v_cvt_pk_bf16_f32 v151, v50, v51
v_accvgpr_write_b32 a144, v148
v_mfma_f32_16x16x32_bf16 v[216:219], a[112:115], a[104:107], v[216:219]
v_accvgpr_write_b32 a145, v149
v_accvgpr_write_b32 a146, v150
v_mfma_f32_16x16x32_bf16 v[216:219], a[116:119], a[108:111], v[216:219]
ds_bpermute_b32 v11, v17, v167
v_accvgpr_write_b32 a147, v151
v_mfma_f32_16x16x32_bf16 v[208:211], a[124:127], a[108:111], v[208:211]
v_cvt_pk_bf16_f32 v164, v164, v165
v_cvt_pk_bf16_f32 v165, v166, v167
v_mfma_f32_16x16x32_bf16 v[208:211], a[120:123], a[104:107], v[208:211]
s_waitcnt lgkmcnt(0)
v_cvt_pk_bf16_f32 v166, v156, v157
v_cvt_pk_bf16_f32 v167, v158, v159
v_mfma_f32_16x16x32_bf16 v[44:47], a[192:195], v[36:39], v[96:99]
buffer_store_dwordx4 v[164:167], v18, s[24:27], s55 offen offset:256 sc1
v_mfma_f32_16x16x32_bf16 v[44:47], a[196:199], v[32:35], v[44:47]
v_accvgpr_write_b32 a152, v164
v_accvgpr_write_b32 a153, v165
v_mfma_f32_16x16x32_bf16 v[44:47], a[200:203], v[196:199], v[44:47]
v_accvgpr_write_b32 a154, v166
v_accvgpr_write_b32 a155, v167
v_mfma_f32_16x16x32_bf16 v[44:47], a[204:207], v[204:207], v[44:47]
v_cvt_pk_bf16_f32 v72, v72, v73
v_cvt_pk_bf16_f32 v73, v74, v75
v_mfma_f32_16x16x32_bf16 v[52:55], a[192:195], v[108:111], v[104:107]
v_cvt_pk_bf16_f32 v74, v220, v221
v_cvt_pk_bf16_f32 v75, v222, v223
v_mfma_f32_16x16x32_bf16 v[52:55], a[196:199], v[40:43], v[52:55]
v_accvgpr_write_b32 a132, v72
v_accvgpr_write_b32 a133, v73
v_mfma_f32_16x16x32_bf16 v[52:55], a[200:203], v[80:83], v[52:55]
v_accvgpr_write_b32 a134, v74
v_accvgpr_write_b32 a135, v75
v_mfma_f32_16x16x32_bf16 v[52:55], a[204:207], v[168:171], v[52:55]
v_cvt_pk_bf16_f32 v160, v160, v161
v_cvt_pk_bf16_f32 v161, v162, v163
v_mfma_f32_16x16x32_bf16 v[64:67], a[208:211], v[36:39], v[112:115]
v_cvt_pk_bf16_f32 v162, v252, v253
v_cvt_pk_bf16_f32 v163, v254, v255
v_mfma_f32_16x16x32_bf16 v[64:67], a[212:215], v[32:35], v[64:67]
buffer_store_dwordx4 v[160:163], v19, s[24:27], s54 offen offset:256 sc1
v_mfma_f32_16x16x32_bf16 v[64:67], a[216:219], v[196:199], v[64:67]
v_accvgpr_write_b32 a140, v160
v_accvgpr_write_b32 a141, v161
v_mfma_f32_16x16x32_bf16 v[64:67], a[220:223], v[204:207], v[64:67]
v_accvgpr_write_b32 a142, v162
v_accvgpr_write_b32 a143, v163
v_mfma_f32_16x16x32_bf16 v[212:215], a[208:211], v[108:111], v[120:123]
v_cvt_pk_bf16_f32 v236, v236, v237
v_cvt_pk_bf16_f32 v237, v238, v239
v_mfma_f32_16x16x32_bf16 v[212:215], a[212:215], v[40:43], v[212:215]
v_cvt_pk_bf16_f32 v238, v224, v225
v_cvt_pk_bf16_f32 v239, v226, v227
v_mfma_f32_16x16x32_bf16 v[212:215], a[216:219], v[80:83], v[212:215]
v_accvgpr_write_b32 a148, v236
v_accvgpr_write_b32 a149, v237
v_mfma_f32_16x16x32_bf16 v[212:215], a[220:223], v[168:171], v[212:215]
s_waitcnt vmcnt(17)
v_accvgpr_write_b32 a150, v238
v_accvgpr_write_b32 a151, v239
v_mfma_f32_16x16x32_bf16 v[100:103], a[192:195], v[116:119], v[128:131]
s_barrier
v_cvt_pk_bf16_f32 v216, v216, v217
v_cvt_pk_bf16_f32 v217, v218, v219
v_mfma_f32_16x16x32_bf16 v[100:103], a[196:199], v[132:135], v[100:103]
v_cvt_pk_bf16_f32 v218, v208, v209
v_cvt_pk_bf16_f32 v219, v210, v211
v_mfma_f32_16x16x32_bf16 v[100:103], a[200:203], v[184:187], v[100:103]
buffer_store_dwordx4 v[216:219], v19, s[24:27], s55 offen offset:256 sc1
v_mfma_f32_16x16x32_bf16 v[100:103], a[204:207], v[240:243], v[100:103]
v_accvgpr_write_b32 a156, v216
v_accvgpr_write_b32 a157, v217
v_mfma_f32_16x16x32_bf16 v[92:95], a[192:195], v[188:191], v[136:139]
v_accvgpr_write_b32 a158, v218
v_accvgpr_write_b32 a159, v219
v_mfma_f32_16x16x32_bf16 v[92:95], a[196:199], v[56:59], v[92:95]
v_max3_f32 v24, v44, v45, v46
v_max3_f32 v25, v47, v64, v65
v_mfma_f32_16x16x32_bf16 v[92:95], a[200:203], v[88:91], v[92:95]
v_max3_f32 v26, v52, v53, v54
v_max3_f32 v27, v55, v212, v213
v_mfma_f32_16x16x32_bf16 v[92:95], a[204:207], v[192:195], v[92:95]
v_max3_f32 v24, v24, v66, v67
v_max_f32 v24, v24, v25
v_mfma_f32_16x16x32_bf16 v[176:179], a[208:211], v[116:119], v[144:147]
v_max3_f32 v26, v26, v214, v215
v_max_f32 v26, v26, v27
v_mfma_f32_16x16x32_bf16 v[176:179], a[212:215], v[132:135], v[176:179]
L_PAD8:
s_cbranch_execz L_PAD12
v_mov_b32 v25, v24
v_mov_b32 v27, v26
v_mfma_f32_16x16x32_bf16 v[176:179], a[216:219], v[184:187], v[176:179]
v_mov_b32 v69, 0
v_mov_b32 v70, 0
v_mfma_f32_16x16x32_bf16 v[176:179], a[220:223], v[240:243], v[176:179]
v_permlane32_swap_b32 v25, v24
v_permlane32_swap_b32 v27, v26
v_mfma_f32_16x16x32_bf16 v[228:231], a[208:211], v[188:191], v[152:155]
v_max_f32 v24, v24, v25
v_max_f32 v26, v26, v27
v_mfma_f32_16x16x32_bf16 v[228:231], a[212:215], v[56:59], v[228:231]
v_mov_b32 v25, v24
v_mov_b32 v27, v26
v_mfma_f32_16x16x32_bf16 v[228:231], a[216:219], v[88:91], v[228:231]
v_mov_b32 v71, 0
v_mfma_f32_16x16x32_bf16 v[228:231], a[220:223], v[192:195], v[228:231]
v_permlane16_swap_b32 v25, v24
v_permlane16_swap_b32 v27, v26
ds_read_b128 a[64:67], v4 offset:57344
ds_read_b128 a[68:71], v4 offset:58368
ds_read_b128 a[72:75], v4 offset:59392
ds_read_b128 a[76:79], v4 offset:60416
ds_read_b128 a[80:83], v4 offset:61440
ds_read_b128 a[84:87], v4 offset:62464
ds_read_b128 a[88:91], v4 offset:63488
ds_read_b128 a[92:95], v4 offset:64512
s_add_u32 m0, s70, 98304
s_add_u32 s64, s68, 65536
buffer_load_dwordx4 v15, s[24:27], s64 offen offset:0 sc1 lds
s_nop 1
v_max_f32 v24, v24, v25
v_max_f32 v26, v26, v27
v_pk_add_f32 v[44:45], v[44:45], v[24:25] op_sel_hi:[1,0] neg_lo:[0,1] neg_hi:[0,1]
v_pk_add_f32 v[46:47], v[46:47], v[24:25] op_sel_hi:[1,0] neg_lo:[0,1] neg_hi:[0,1]
v_pk_add_f32 v[52:53], v[52:53], v[26:27] op_sel_hi:[1,0] neg_lo:[0,1] neg_hi:[0,1]
v_pk_add_f32 v[54:55], v[54:55], v[26:27] op_sel_hi:[1,0] neg_lo:[0,1] neg_hi:[0,1]
buffer_load_dwordx4 v15, s[24:27], s64 offen offset:1024 sc1 lds
v_pk_add_f32 v[64:65], v[64:65], v[24:25] op_sel_hi:[1,0] neg_lo:[0,1] neg_hi:[0,1]
v_pk_add_f32 v[66:67], v[66:67], v[24:25] op_sel_hi:[1,0] neg_lo:[0,1] neg_hi:[0,1]
v_pk_add_f32 v[212:213], v[212:213], v[26:27] op_sel_hi:[1,0] neg_lo:[0,1] neg_hi:[0,1]
v_pk_add_f32 v[214:215], v[214:215], v[26:27] op_sel_hi:[1,0] neg_lo:[0,1] neg_hi:[0,1]
v_pk_add_f32 v[96:97], v[96:97], v[24:25] op_sel_hi:[1,0] neg_lo:[0,1] neg_hi:[0,1]
v_pk_add_f32 v[98:99], v[98:99], v[24:25] op_sel_hi:[1,0] neg_lo:[0,1] neg_hi:[0,1]
v_pk_add_f32 v[104:105], v[104:105], v[26:27] op_sel_hi:[1,0] neg_lo:[0,1] neg_hi:[0,1]
buffer_load_dwordx4 v15, s[24:27], s64 offen offset:2048 sc1 lds
v_pk_add_f32 v[106:107], v[106:107], v[26:27] op_sel_hi:[1,0] neg_lo:[0,1] neg_hi:[0,1]
v_pk_add_f32 v[112:113], v[112:113], v[24:25] op_sel_hi:[1,0] neg_lo:[0,1] neg_hi:[0,1]
v_pk_add_f32 v[114:115], v[114:115], v[24:25] op_sel_hi:[1,0] neg_lo:[0,1] neg_hi:[0,1]
v_pk_add_f32 v[120:121], v[120:121], v[26:27] op_sel_hi:[1,0] neg_lo:[0,1] neg_hi:[0,1]
v_pk_add_f32 v[122:123], v[122:123], v[26:27] op_sel_hi:[1,0] neg_lo:[0,1] neg_hi:[0,1]
v_exp_f32 v44, v44
v_exp_f32 v45, v45
buffer_load_dwordx4 v15, s[24:27], s64 offen offset:3072 sc1 lds
v_exp_f32 v46, v46
v_exp_f32 v47, v47
v_cvt_pk_bf16_f32 v124, v44, v45
v_exp_f32 v52, v52
v_exp_f32 v53, v53
v_cvt_pk_bf16_f32 v125, v46, v47
v_exp_f32 v54, v54
s_add_u32 m0, s70, 114688
s_add_u32 s64, s68, 81920
buffer_load_dwordx4 v15, s[24:27], s64 offen offset:0 sc1 lds
v_exp_f32 v55, v55
v_cvt_pk_bf16_f32 v140, v52, v53
v_exp_f32 v64, v64
v_exp_f32 v65, v65
v_cvt_pk_bf16_f32 v141, v54, v55
v_exp_f32 v66, v66
v_exp_f32 v67, v67
buffer_load_dwordx4 v15, s[24:27], s64 offen offset:1024 sc1 lds
v_cvt_pk_bf16_f32 v126, v64, v65
v_exp_f32 v212, v212
v_exp_f32 v213, v213
v_cvt_pk_bf16_f32 v127, v66, v67
v_exp_f32 v214, v214
v_exp_f32 v215, v215
v_cvt_pk_bf16_f32 v142, v212, v213
buffer_load_dwordx4 v15, s[24:27], s64 offen offset:2048 sc1 lds
v_max3_f32 v24, v100, v101, v102
v_cvt_pk_bf16_f32 v143, v214, v215
v_max3_f32 v25, v103, v176, v177
v_max3_f32 v26, v92, v93, v94
v_max3_f32 v27, v95, v228, v229
v_max3_f32 v24, v24, v178, v179
v_max_f32 v24, v24, v25
buffer_load_dwordx4 v15, s[24:27], s64 offen offset:3072 sc1 lds
v_max3_f32 v26, v26, v230, v231
v_max_f32 v26, v26, v27
v_mov_b32 v25, v24
v_mov_b32 v27, v26
s_nop 1
v_permlane32_swap_b32 v25, v24
v_permlane32_swap_b32 v27, v26
s_cmp_lt_u32 s3, 1
s_cbranch_scc1 L_SK5
s_add_u32 m0, s70, 131072
s_add_u32 s64, s68, 98304
buffer_load_dwordx4 v15, s[24:27], s64 offen offset:0 sc1 lds
buffer_load_dwordx4 v15, s[24:27], s64 offen offset:1024 sc1 lds
buffer_load_dwordx4 v15, s[24:27], s64 offen offset:2048 sc1 lds
buffer_load_dwordx4 v15, s[24:27], s64 offen offset:3072 sc1 lds
L_SK5:
s_nop 0
v_max_f32 v24, v24, v25
v_max_f32 v26, v26, v27
v_mov_b32 v25, v24
v_mov_b32 v27, v26
s_nop 1
v_permlane16_swap_b32 v25, v24
v_permlane16_swap_b32 v27, v26
s_nop 0
v_max_f32 v24, v24, v25
v_max_f32 v26, v26, v27
v_pk_add_f32 v[100:101], v[100:101], v[24:25] op_sel_hi:[1,0] neg_lo:[0,1] neg_hi:[0,1]
v_pk_add_f32 v[102:103], v[102:103], v[24:25] op_sel_hi:[1,0] neg_lo:[0,1] neg_hi:[0,1]
v_pk_add_f32 v[92:93], v[92:93], v[26:27] op_sel_hi:[1,0] neg_lo:[0,1] neg_hi:[0,1]
v_pk_add_f32 v[94:95], v[94:95], v[26:27] op_sel_hi:[1,0] neg_lo:[0,1] neg_hi:[0,1]
v_pk_add_f32 v[176:177], v[176:177], v[24:25] op_sel_hi:[1,0] neg_lo:[0,1] neg_hi:[0,1]
v_pk_add_f32 v[178:179], v[178:179], v[24:25] op_sel_hi:[1,0] neg_lo:[0,1] neg_hi:[0,1]
v_pk_add_f32 v[228:229], v[228:229], v[26:27] op_sel_hi:[1,0] neg_lo:[0,1] neg_hi:[0,1]
v_pk_add_f32 v[230:231], v[230:231], v[26:27] op_sel_hi:[1,0] neg_lo:[0,1] neg_hi:[0,1]
s_cmp_lt_u32 s3, 2
s_cbranch_scc1 L_SK6
s_add_u32 m0, s70, 147456
s_add_u32 s64, s68, 114688
buffer_load_dwordx4 v15, s[24:27], s64 offen offset:0 sc1 lds
buffer_load_dwordx4 v15, s[24:27], s64 offen offset:1024 sc1 lds
buffer_load_dwordx4 v15, s[24:27], s64 offen offset:2048 sc1 lds
buffer_load_dwordx4 v15, s[24:27], s64 offen offset:3072 sc1 lds
L_SK6:
v_pk_add_f32 v[128:129], v[128:129], v[24:25] op_sel_hi:[1,0] neg_lo:[0,1] neg_hi:[0,1]
v_pk_add_f32 v[130:131], v[130:131], v[24:25] op_sel_hi:[1,0] neg_lo:[0,1] neg_hi:[0,1]
v_pk_add_f32 v[136:137], v[136:137], v[26:27] op_sel_hi:[1,0] neg_lo:[0,1] neg_hi:[0,1]
v_pk_add_f32 v[138:139], v[138:139], v[26:27] op_sel_hi:[1,0] neg_lo:[0,1] neg_hi:[0,1]
v_pk_add_f32 v[144:145], v[144:145], v[24:25] op_sel_hi:[1,0] neg_lo:[0,1] neg_hi:[0,1]
v_pk_add_f32 v[146:147], v[146:147], v[24:25] op_sel_hi:[1,0] neg_lo:[0,1] neg_hi:[0,1]
v_pk_add_f32 v[152:153], v[152:153], v[26:27] op_sel_hi:[1,0] neg_lo:[0,1] neg_hi:[0,1]
v_pk_add_f32 v[154:155], v[154:155], v[26:27] op_sel_hi:[1,0] neg_lo:[0,1] neg_hi:[0,1]
v_mov_b64 v[60:61], 0
v_mov_b64 v[62:63], 0
v_mov_b64 v[72:73], 0
v_mov_b64 v[74:75], 0
v_mov_b64 v[220:221], 0
v_mov_b64 v[222:223], 0
v_mov_b64 v[84:85], 0
v_mov_b64 v[86:87], 0
v_mov_b64 v[76:77], 0
v_mov_b64 v[78:79], 0
v_mov_b64 v[160:161], 0
s_cmp_lt_u32 s3, 3
s_cbranch_scc1 L_SK7
s_add_u32 m0, s70, 0
s_add_u32 s64, s68, 131072
buffer_load_dwordx4 v15, s[24:27], s64 offen offset:0 sc1 lds
buffer_load_dwordx4 v15, s[24:27], s64 offen offset:1024 sc1 lds
buffer_load_dwordx4 v15, s[24:27], s64 offen offset:2048 sc1 lds
buffer_load_dwordx4 v15, s[24:27], s64 offen offset:3072 sc1 lds
L_SK7:
v_mov_b64 v[162:163], 0
v_mov_b64 v[252:253], 0
v_mov_b64 v[254:255], 0
v_mov_b64 v[148:149], 0
v_mov_b64 v[150:151], 0
v_mov_b64 v[48:49], 0
v_mov_b64 v[50:51], 0
v_mov_b64 v[236:237], 0
v_mov_b64 v[238:239], 0
v_mov_b64 v[224:225], 0
v_mov_b64 v[226:227], 0
v_mov_b64 v[164:165], 0
v_mov_b64 v[166:167], 0
v_mov_b64 v[156:157], 0
v_mov_b64 v[158:159], 0
v_mov_b64 v[216:217], 0
v_mov_b64 v[218:219], 0
v_mov_b64 v[208:209], 0
v_mov_b64 v[210:211], 0
ds_read_b128 a[192:195], v4 offset:49152
ds_read_b128 a[196:199], v4 offset:50176
ds_read_b128 a[200:203], v4 offset:51200
ds_read_b128 a[204:207], v4 offset:52224
ds_read_b128 a[208:211], v4 offset:53248
ds_read_b128 a[212:215], v4 offset:54272
ds_read_b128 a[216:219], v4 offset:55296
ds_read_b128 a[220:223], v4 offset:56320
s_waitcnt lgkmcnt(8)
s_lshl2_add_u32 s77, s86, s84
s_mul_i32 s77, s77, 344064
s_mov_b32 s80, s70
s_cmp_lt_u32 s3, 2
s_cselect_b32 s53, 8, -2
s_add_u32 s53, s53, s3
v_mfma_f32_16x16x32_bf16 a[0:3], a[64:67], v[124:127], 0
s_mul_i32 s52, s5, 65536
v_exp_f32 v100, v100
v_mfma_f32_16x16x32_bf16 a[32:35], a[64:67], v[140:143], 0
s_sub_u32 s52, 1064960, s52
v_exp_f32 v101, v101
v_mfma_f32_16x16x32_bf16 a[36:39], a[68:71], v[140:143], 0
s_add_u32 s71, s68, s52
v_exp_f32 v102, v102
v_mfma_f32_16x16x32_bf16 a[4:7], a[68:71], v[124:127], 0
s_add_u32 s77, s77, s80
v_exp_f32 v103, v103
v_mfma_f32_16x16x32_bf16 a[8:11], a[72:75], v[124:127], 0
s_add_u32 s77, s77, 38797312
v_cvt_pk_bf16_f32 v248, v100, v101
v_cvt_pk_bf16_f32 v249, v102, v103
v_mfma_f32_16x16x32_bf16 a[40:43], a[72:75], v[140:143], 0
s_add_u32 s52, s3, 6
v_exp_f32 v92, v92
v_mfma_f32_16x16x32_bf16 a[44:47], a[76:79], v[140:143], 0
s_mul_i32 s52, s52, 16384
v_exp_f32 v93, v93
v_mfma_f32_16x16x32_bf16 a[12:15], a[76:79], v[124:127], 0
s_add_u32 s68, s68, s52
v_exp_f32 v94, v94
v_mfma_f32_16x16x32_bf16 a[16:19], a[80:83], v[124:127], 0
s_lshl_b32 s53, s53, 14
v_exp_f32 v95, v95
v_mfma_f32_16x16x32_bf16 a[48:51], a[80:83], v[140:143], 0
s_add_u32 s70, s70, s53
v_cvt_pk_bf16_f32 v232, v92, v93
v_cvt_pk_bf16_f32 v233, v94, v95
v_mfma_f32_16x16x32_bf16 a[52:55], a[84:87], v[140:143], 0
s_mov_b32 s75, 65536
v_exp_f32 v176, v176
v_mfma_f32_16x16x32_bf16 a[20:23], a[84:87], v[124:127], 0
s_mov_b32 s72, 1
v_exp_f32 v177, v177
v_mfma_f32_16x16x32_bf16 a[24:27], a[88:91], v[124:127], 0
s_mov_b32 s73, 9
v_exp_f32 v178, v178
v_mfma_f32_16x16x32_bf16 a[56:59], a[88:91], v[140:143], 0
s_lshl2_add_u32 s69, s5, 4
v_exp_f32 v179, v179
v_mfma_f32_16x16x32_bf16 a[60:63], a[92:95], v[140:143], 0
s_max_u32 s69, s69, 12
v_cvt_pk_bf16_f32 v250, v176, v177
v_cvt_pk_bf16_f32 v251, v178, v179
v_mfma_f32_16x16x32_bf16 a[28:31], a[92:95], v[124:127], 0
s_min_u32 s74, s73, s66
v_exp_f32 v228, v228
v_mfma_f32_16x16x32_bf16 a[224:227], a[240:243], v[124:127], 0
s_mov_b32 s93, 9
s_waitcnt vmcnt(8) lgkmcnt(0)
v_mfma_f32_16x16x32_bf16 a[228:231], a[240:243], v[140:143], 0
s_cmp_lt_u32 s66, 2
buffer_atomic_add v1, v0, s[24:27], s89 offen offset:8 sc1
s_cbranch_scc1 L_NE
L_DUAL:
v_mfma_f32_16x16x32_bf16 v[44:47], a[192:195], v[36:39], v[96:99]
s_barrier
v_mfma_f32_16x16x32_bf16 v[44:47], a[196:199], v[32:35], v[44:47]
s_cmp_eq_u32 s68, s71
v_exp_f32 v229, v229
v_mfma_f32_16x16x32_bf16 v[44:47], a[200:203], v[196:199], v[44:47]
s_cselect_b32 s64, s77, s68
v_add_u32 v5, s75, v4
v_cvt_pk_bf16_f32 v234, v228, v229
v_mfma_f32_16x16x32_bf16 v[44:47], a[204:207], v[204:207], v[44:47]
s_mov_b32 m0, s70
v_exp_f32 v230, v230
v_mfma_f32_16x16x32_bf16 v[52:55], a[192:195], v[108:111], v[104:107]
buffer_load_dwordx4 v15, s[24:27], s64 offen offset:0 sc1 lds
v_mfma_f32_16x16x32_bf16 v[52:55], a[196:199], v[40:43], v[52:55]
s_add_u32 s75, s75, 16384
v_exp_f32 v231, v231
v_mfma_f32_16x16x32_bf16 v[52:55], a[200:203], v[80:83], v[52:55]
v_cvt_pk_bf16_f32 v235, v230, v231
v_mfma_f32_16x16x32_bf16 v[52:55], a[204:207], v[168:171], v[52:55]
s_cmp_ge_u32 s75, 163840
v_exp_f32 v44, v44
v_mfma_f32_16x16x32_bf16 v[64:67], a[208:211], v[36:39], v[112:115]
v_mfma_f32_16x16x32_bf16 v[64:67], a[212:215], v[32:35], v[64:67]
s_cselect_b32 s75, 0, s75
v_exp_f32 v45, v45
v_mfma_f32_16x16x32_bf16 v[64:67], a[216:219], v[196:199], v[64:67]
v_cvt_pk_bf16_f32 v124, v44, v45
v_mfma_f32_16x16x32_bf16 v[64:67], a[220:223], v[204:207], v[64:67]
s_add_u32 s68, s64, 16384
v_exp_f32 v46, v46
v_mfma_f32_16x16x32_bf16 v[212:215], a[208:211], v[108:111], v[120:123]
buffer_load_dwordx4 v15, s[24:27], s64 offen offset:1024 sc1 lds
v_mfma_f32_16x16x32_bf16 v[212:215], a[212:215], v[40:43], v[212:215]
s_add_u32 s70, s70, 16384
v_exp_f32 v47, v47
v_mfma_f32_16x16x32_bf16 v[212:215], a[216:219], v[80:83], v[212:215]
v_cvt_pk_bf16_f32 v125, v46, v47
v_mfma_f32_16x16x32_bf16 v[212:215], a[220:223], v[168:171], v[212:215]
v_exp_f32 v52, v52
v_mfma_f32_16x16x32_bf16 v[60:63], a[64:67], v[248:251], v[60:63]
v_mfma_f32_16x16x32_bf16 v[148:151], a[64:67], v[232:235], v[148:151]
s_cmp_ge_u32 s70, 163840
v_exp_f32 v53, v53
v_mfma_f32_16x16x32_bf16 v[48:51], a[68:71], v[232:235], v[48:51]
ds_read_b128 a[64:67], v5 offset:8192
v_cvt_pk_bf16_f32 v140, v52, v53
v_mfma_f32_16x16x32_bf16 v[68:71], a[68:71], v[248:251], v[68:71]
s_cselect_b32 s70, s80, s70
v_exp_f32 v54, v54
v_mfma_f32_16x16x32_bf16 v[72:75], a[72:75], v[248:251], v[72:75]
buffer_load_dwordx4 v15, s[24:27], s64 offen offset:2048 sc1 lds
v_mfma_f32_16x16x32_bf16 v[236:239], a[72:75], v[232:235], v[236:239]
v_exp_f32 v55, v55
v_mfma_f32_16x16x32_bf16 v[224:227], a[76:79], v[232:235], v[224:227]
ds_read_b128 a[68:71], v5 offset:9216
v_cvt_pk_bf16_f32 v141, v54, v55
v_mfma_f32_16x16x32_bf16 v[220:223], a[76:79], v[248:251], v[220:223]
v_exp_f32 v64, v64
v_mfma_f32_16x16x32_bf16 v[84:87], a[80:83], v[248:251], v[84:87]
ds_read_b128 a[72:75], v5 offset:10240
v_mfma_f32_16x16x32_bf16 v[164:167], a[80:83], v[232:235], v[164:167]
v_exp_f32 v65, v65
v_mfma_f32_16x16x32_bf16 v[156:159], a[84:87], v[232:235], v[156:159]
ds_read_b128 a[76:79], v5 offset:11264
v_cvt_pk_bf16_f32 v126, v64, v65
v_mfma_f32_16x16x32_bf16 v[76:79], a[84:87], v[248:251], v[76:79]
v_exp_f32 v66, v66
v_mfma_f32_16x16x32_bf16 v[160:163], a[88:91], v[248:251], v[160:163]
buffer_load_dwordx4 v15, s[24:27], s64 offen offset:3072 sc1 lds
v_mfma_f32_16x16x32_bf16 v[216:219], a[88:91], v[232:235], v[216:219]
v_exp_f32 v67, v67
v_mfma_f32_16x16x32_bf16 v[208:211], a[92:95], v[232:235], v[208:211]
ds_read_b128 a[80:83], v5 offset:12288
v_cvt_pk_bf16_f32 v127, v66, v67
v_mfma_f32_16x16x32_bf16 v[252:255], a[92:95], v[248:251], v[252:255]
v_exp_f32 v212, v212
v_mfma_f32_16x16x32_bf16 a[232:235], a[240:243], v[248:251], a[232:235]
ds_read_b128 a[84:87], v5 offset:13312
v_mfma_f32_16x16x32_bf16 a[236:239], a[240:243], v[232:235], a[236:239]
ds_read_b128 a[88:91], v5 offset:14336
v_mfma_f32_16x16x32_bf16 v[100:103], a[192:195], v[116:119], v[128:131]
ds_read_b128 a[92:95], v5 offset:15360
v_mfma_f32_16x16x32_bf16 v[100:103], a[196:199], v[132:135], v[100:103]
v_exp_f32 v213, v213
v_mfma_f32_16x16x32_bf16 v[100:103], a[200:203], v[184:187], v[100:103]
v_cvt_pk_bf16_f32 v142, v212, v213
v_mfma_f32_16x16x32_bf16 v[100:103], a[204:207], v[240:243], v[100:103]
v_exp_f32 v214, v214
v_mfma_f32_16x16x32_bf16 v[92:95], a[192:195], v[188:191], v[136:139]
s_nop 0
v_mfma_f32_16x16x32_bf16 v[92:95], a[196:199], v[56:59], v[92:95]
v_exp_f32 v215, v215
v_mfma_f32_16x16x32_bf16 v[92:95], a[200:203], v[88:91], v[92:95]
ds_read_b128 a[192:195], v5 offset:0
v_cvt_pk_bf16_f32 v143, v214, v215
v_mfma_f32_16x16x32_bf16 v[92:95], a[204:207], v[192:195], v[92:95]
v_exp_f32 v100, v100
v_mfma_f32_16x16x32_bf16 v[176:179], a[208:211], v[116:119], v[144:147]
ds_read_b128 a[196:199], v5 offset:1024
v_mfma_f32_16x16x32_bf16 v[176:179], a[212:215], v[132:135], v[176:179]
v_exp_f32 v101, v101
v_mfma_f32_16x16x32_bf16 v[176:179], a[216:219], v[184:187], v[176:179]
ds_read_b128 a[200:203], v5 offset:2048
v_cvt_pk_bf16_f32 v248, v100, v101
v_mfma_f32_16x16x32_bf16 v[176:179], a[220:223], v[240:243], v[176:179]
v_exp_f32 v102, v102
v_mfma_f32_16x16x32_bf16 v[228:231], a[208:211], v[188:191], v[152:155]
ds_read_b128 a[204:207], v5 offset:3072
v_mfma_f32_16x16x32_bf16 v[228:231], a[212:215], v[56:59], v[228:231]
v_exp_f32 v103, v103
v_mfma_f32_16x16x32_bf16 v[228:231], a[216:219], v[88:91], v[228:231]
ds_read_b128 a[208:211], v5 offset:4096
v_cvt_pk_bf16_f32 v249, v102, v103
v_mfma_f32_16x16x32_bf16 v[228:231], a[220:223], v[192:195], v[228:231]
s_waitcnt lgkmcnt(5)
v_exp_f32 v92, v92
v_mfma_f32_16x16x32_bf16 a[0:3], a[64:67], v[124:127], a[0:3]
ds_read_b128 a[212:215], v5 offset:5120
v_mfma_f32_16x16x32_bf16 a[32:35], a[64:67], v[140:143], a[32:35]
v_exp_f32 v93, v93
v_mfma_f32_16x16x32_bf16 a[36:39], a[68:71], v[140:143], a[36:39]
ds_read_b128 a[216:219], v5 offset:6144
v_cvt_pk_bf16_f32 v232, v92, v93
v_mfma_f32_16x16x32_bf16 a[4:7], a[68:71], v[124:127], a[4:7]
v_exp_f32 v94, v94
v_mfma_f32_16x16x32_bf16 a[8:11], a[72:75], v[124:127], a[8:11]
ds_read_b128 a[220:223], v5 offset:7168
v_mfma_f32_16x16x32_bf16 a[40:43], a[72:75], v[140:143], a[40:43]
s_add_u32 s72, s72, 1
v_exp_f32 v95, v95
v_mfma_f32_16x16x32_bf16 a[44:47], a[76:79], v[140:143], a[44:47]
v_cvt_pk_bf16_f32 v233, v94, v95
v_mfma_f32_16x16x32_bf16 a[12:15], a[76:79], v[124:127], a[12:15]
v_exp_f32 v176, v176
v_mfma_f32_16x16x32_bf16 a[16:19], a[80:83], v[124:127], a[16:19]
v_mfma_f32_16x16x32_bf16 a[48:51], a[80:83], v[140:143], a[48:51]
v_exp_f32 v177, v177
v_mfma_f32_16x16x32_bf16 a[52:55], a[84:87], v[140:143], a[52:55]
v_cvt_pk_bf16_f32 v250, v176, v177
v_mfma_f32_16x16x32_bf16 a[20:23], a[84:87], v[124:127], a[20:23]
v_exp_f32 v178, v178
v_mfma_f32_16x16x32_bf16 a[24:27], a[88:91], v[124:127], a[24:27]
v_mfma_f32_16x16x32_bf16 a[56:59], a[88:91], v[140:143], a[56:59]
s_cmp_lt_u32 s72, s74
v_exp_f32 v179, v179
v_mfma_f32_16x16x32_bf16 a[60:63], a[92:95], v[140:143], a[60:63]
v_cvt_pk_bf16_f32 v251, v178, v179
v_mfma_f32_16x16x32_bf16 a[28:31], a[92:95], v[124:127], a[28:31]
s_waitcnt vmcnt(8) lgkmcnt(0)
v_exp_f32 v228, v228
v_mfma_f32_16x16x32_bf16 a[224:227], a[240:243], v[124:127], a[224:227]
v_mfma_f32_16x16x32_bf16 a[228:231], a[240:243], v[140:143], a[228:231]
s_cbranch_scc1 L_DUAL
L_DISP:
s_cmp_eq_u32 s72, s93
s_cbranch_scc1 L_STOP
L_NE:
s_mov_b32 s74, s93
s_cmp_gt_u32 s72, s66
s_cbranch_scc1 L_SINGLE
v_cndmask_b32 v96, v96, v6, s[56:57]
v_cndmask_b32 v120, v120, v6, s[56:57]
v_mov_b32 v112, v6
v_cndmask_b32 v97, v97, v6, s[58:59]
v_cndmask_b32 v121, v121, v6, s[58:59]
v_mov_b32 v113, v6
v_cndmask_b32 v98, v98, v6, s[60:61]
v_cndmask_b32 v122, v122, v6, s[60:61]
v_mov_b32 v114, v6
v_cndmask_b32 v99, v99, v6, s[62:63]
v_cndmask_b32 v123, v123, v6, s[62:63]
v_mov_b32 v115, v6
s_mov_b32 s74, 0
s_branch L_DUAL
L_STOP:
s_cmp_eq_u32 s72, 9
s_cbranch_scc1 L_E1
s_cmp_lg_u32 s72, 11
s_cbranch_scc1 L_SE
v_cmp_gt_u32 vcc, 32, v172
s_mov_b32 s73, 32
s_min_u32 s93, s73, s69
s_min_u32 s74, s93, s66
v_accvgpr_read_b32 v16, a244
v_accvgpr_read_b32 v17, a248
v_accvgpr_read_b32 v18, a252
s_cbranch_vccnz CK_Q
CK_Q_R:
buffer_load_dwordx4 a[244:247], v16, s[24:27], 0 offen sc1
buffer_load_dwordx4 a[248:251], v17, s[24:27], 0 offen sc1
buffer_load_dwordx4 a[252:255], v18, s[24:27], 0 offen sc1
s_cmp_lt_u32 s72, s66
s_cbranch_scc1 L_DUAL
s_mov_b32 s74, s93
s_cmp_gt_u32 s72, s66
s_cbranch_scc1 L_SINGLE
s_branch L_NE
L_E1:
buffer_load_dword v172, v28, s[24:27], 0 offen sc1
s_mov_b32 s73, 11
buffer_store_dwordx4 v[0:3], v4, s[44:47], s90 offen sc1
buffer_store_dwordx4 v[0:3], v4, s[44:47], s90 offen offset:1024 sc1
buffer_store_dword v0, v31, s[44:47], s90 offen offset:2048 sc1
s_min_u32 s93, s73, s69
s_min_u32 s74, s93, s66
s_cmp_lt_u32 s72, s66
s_cbranch_scc1 L_DUAL
s_mov_b32 s74, s93
s_cmp_gt_u32 s72, s66
s_cbranch_scc1 L_SINGLE
s_branch L_NE
L_SE:
s_mov_b32 s69, 64
s_nop 1
v_accvgpr_read_b32 v180, a224
v_accvgpr_read_b32 v182, a228
v_cmp_nle_f32 vcc, v180, v7
v_cmp_nle_f32 s[96:97], v182, v7
s_nop 3
s_or_b64 vcc, vcc, s[96:97]
s_cbranch_vccnz L_NS
s_add_u32 s53, s77, 163840
buffer_load_dwordx4 a[96:99], v15, s[24:27], s53 offen offset:0 sc1
v_mul_f32 v8, 0x3fb8aa3b, v8
v_mul_f32 v9, 0x3fb8aa3b, v9
v_exp_f32 v8, v8
v_exp_f32 v9, v9
s_nop 0
v_fma_f32 v180, v180, v8, v180
v_fma_f32 v182, v182, v9, v182
v_rcp_f32 v180, v180
v_rcp_f32 v182, v182
s_add_u32 s52, s78, 4096
v_mov_b32 v181, v180
v_mov_b32 v183, v182
v_accvgpr_read_b32 v16, a0
v_accvgpr_read_b32 v17, a1
v_accvgpr_read_b32 v18, a2
v_accvgpr_read_b32 v19, a3
v_accvgpr_read_b32 v20, a4
v_accvgpr_read_b32 v21, a5
buffer_load_dwordx4 a[100:103], v15, s[24:27], s53 offen offset:1024 sc1
v_accvgpr_read_b32 v22, a6
v_accvgpr_read_b32 v23, a7
v_pk_mul_f32 v[16:17], v[16:17], v[180:181]
v_pk_mul_f32 v[18:19], v[18:19], v[180:181]
v_pk_mul_f32 v[20:21], v[20:21], v[180:181]
v_pk_mul_f32 v[22:23], v[22:23], v[180:181]
v_cvt_pk_bf16_f32 v16, v16, v17
v_cvt_pk_bf16_f32 v17, v18, v19
v_cvt_pk_bf16_f32 v18, v20, v21
v_cvt_pk_bf16_f32 v19, v22, v23
buffer_store_dwordx4 v[16:19], v15, s[24:27], s78 offen offset:0 sc1
v_accvgpr_read_b32 v24, a32
v_accvgpr_read_b32 v25, a33
v_accvgpr_read_b32 v26, a34
v_accvgpr_read_b32 v27, a35
v_accvgpr_read_b32 v28, a36
v_accvgpr_read_b32 v29, a37
v_accvgpr_read_b32 v30, a38
buffer_load_dwordx4 a[104:107], v15, s[24:27], s53 offen offset:2048 sc1
v_accvgpr_read_b32 v31, a39
v_pk_mul_f32 v[24:25], v[24:25], v[182:183]
v_pk_mul_f32 v[26:27], v[26:27], v[182:183]
v_pk_mul_f32 v[28:29], v[28:29], v[182:183]
v_pk_mul_f32 v[30:31], v[30:31], v[182:183]
v_cvt_pk_bf16_f32 v24, v24, v25
v_cvt_pk_bf16_f32 v25, v26, v27
v_cvt_pk_bf16_f32 v26, v28, v29
v_cvt_pk_bf16_f32 v27, v30, v31
buffer_store_dwordx4 v[24:27], v15, s[24:27], s78 offen offset:1024 sc1
v_accvgpr_read_b32 v16, a8
v_accvgpr_read_b32 v17, a9
v_accvgpr_read_b32 v18, a10
v_accvgpr_read_b32 v19, a11
v_accvgpr_read_b32 v20, a12
v_accvgpr_read_b32 v21, a13
v_accvgpr_read_b32 v22, a14
v_accvgpr_read_b32 v23, a15
buffer_load_dwordx4 a[108:111], v15, s[24:27], s53 offen offset:3072 sc1
v_pk_mul_f32 v[16:17], v[16:17], v[180:181]
v_pk_mul_f32 v[18:19], v[18:19], v[180:181]
v_pk_mul_f32 v[20:21], v[20:21], v[180:181]
v_pk_mul_f32 v[22:23], v[22:23], v[180:181]
v_cvt_pk_bf16_f32 v16, v16, v17
v_cvt_pk_bf16_f32 v17, v18, v19
v_cvt_pk_bf16_f32 v18, v20, v21
v_cvt_pk_bf16_f32 v19, v22, v23
buffer_store_dwordx4 v[16:19], v15, s[24:27], s78 offen offset:2048 sc1
v_accvgpr_read_b32 v24, a40
v_accvgpr_read_b32 v25, a41
v_accvgpr_read_b32 v26, a42
v_accvgpr_read_b32 v27, a43
v_accvgpr_read_b32 v28, a44
v_accvgpr_read_b32 v29, a45
v_accvgpr_read_b32 v30, a46
v_accvgpr_read_b32 v31, a47
v_pk_mul_f32 v[24:25], v[24:25], v[182:183]
s_add_u32 s53, s77, 180224
buffer_load_dwordx4 a[112:115], v15, s[24:27], s53 offen offset:0 sc1
v_pk_mul_f32 v[26:27], v[26:27], v[182:183]
v_pk_mul_f32 v[28:29], v[28:29], v[182:183]
v_pk_mul_f32 v[30:31], v[30:31], v[182:183]
v_cvt_pk_bf16_f32 v24, v24, v25
v_cvt_pk_bf16_f32 v25, v26, v27
v_cvt_pk_bf16_f32 v26, v28, v29
v_cvt_pk_bf16_f32 v27, v30, v31
buffer_store_dwordx4 v[24:27], v15, s[24:27], s78 offen offset:3072 sc1
v_accvgpr_read_b32 v16, a16
v_accvgpr_read_b32 v17, a17
v_accvgpr_read_b32 v18, a18
v_accvgpr_read_b32 v19, a19
v_accvgpr_read_b32 v20, a20
v_accvgpr_read_b32 v21, a21
v_accvgpr_read_b32 v22, a22
v_accvgpr_read_b32 v23, a23
v_pk_mul_f32 v[16:17], v[16:17], v[180:181]
v_pk_mul_f32 v[18:19], v[18:19], v[180:181]
buffer_load_dwordx4 a[116:119], v15, s[24:27], s53 offen offset:1024 sc1
v_pk_mul_f32 v[20:21], v[20:21], v[180:181]
v_pk_mul_f32 v[22:23], v[22:23], v[180:181]
v_cvt_pk_bf16_f32 v16, v16, v17
v_cvt_pk_bf16_f32 v17, v18, v19
v_cvt_pk_bf16_f32 v18, v20, v21
v_cvt_pk_bf16_f32 v19, v22, v23
buffer_store_dwordx4 v[16:19], v15, s[24:27], s52 offen offset:0 sc1
v_accvgpr_read_b32 v24, a48
v_accvgpr_read_b32 v25, a49
v_accvgpr_read_b32 v26, a50
v_accvgpr_read_b32 v27, a51
v_accvgpr_read_b32 v28, a52
v_accvgpr_read_b32 v29, a53
v_accvgpr_read_b32 v30, a54
v_accvgpr_read_b32 v31, a55
v_pk_mul_f32 v[24:25], v[24:25], v[182:183]
v_pk_mul_f32 v[26:27], v[26:27], v[182:183]
v_pk_mul_f32 v[28:29], v[28:29], v[182:183]
buffer_load_dwordx4 a[120:123], v15, s[24:27], s53 offen offset:2048 sc1
v_pk_mul_f32 v[30:31], v[30:31], v[182:183]
v_cvt_pk_bf16_f32 v24, v24, v25
v_cvt_pk_bf16_f32 v25, v26, v27
v_cvt_pk_bf16_f32 v26, v28, v29
v_cvt_pk_bf16_f32 v27, v30, v31
buffer_store_dwordx4 v[24:27], v15, s[24:27], s52 offen offset:1024 sc1
v_accvgpr_read_b32 v16, a24
v_accvgpr_read_b32 v17, a25
v_accvgpr_read_b32 v18, a26
v_accvgpr_read_b32 v19, a27
v_accvgpr_read_b32 v20, a28
v_accvgpr_read_b32 v21, a29
v_accvgpr_read_b32 v22, a30
v_accvgpr_read_b32 v23, a31
v_pk_mul_f32 v[16:17], v[16:17], v[180:181]
v_pk_mul_f32 v[18:19], v[18:19], v[180:181]
v_pk_mul_f32 v[20:21], v[20:21], v[180:181]
v_pk_mul_f32 v[22:23], v[22:23], v[180:181]
buffer_load_dwordx4 a[124:127], v15, s[24:27], s53 offen offset:3072 sc1
v_cvt_pk_bf16_f32 v16, v16, v17
v_cvt_pk_bf16_f32 v17, v18, v19
v_cvt_pk_bf16_f32 v18, v20, v21
v_cvt_pk_bf16_f32 v19, v22, v23
buffer_store_dwordx4 v[16:19], v15, s[24:27], s52 offen offset:2048 sc1
v_accvgpr_read_b32 v24, a56
v_accvgpr_read_b32 v25, a57
v_accvgpr_read_b32 v26, a58
v_accvgpr_read_b32 v27, a59
v_accvgpr_read_b32 v28, a60
v_accvgpr_read_b32 v29, a61
v_accvgpr_read_b32 v30, a62
v_accvgpr_read_b32 v31, a63
v_pk_mul_f32 v[24:25], v[24:25], v[182:183]
v_pk_mul_f32 v[26:27], v[26:27], v[182:183]
v_pk_mul_f32 v[28:29], v[28:29], v[182:183]
v_pk_mul_f32 v[30:31], v[30:31], v[182:183]
v_cvt_pk_bf16_f32 v24, v24, v25
v_cvt_pk_bf16_f32 v25, v26, v27
v_cvt_pk_bf16_f32 v26, v28, v29
v_cvt_pk_bf16_f32 v27, v30, v31
buffer_store_dwordx4 v[24:27], v15, s[24:27], s52 offen offset:3072 sc1
L_PAD9:
s_cbranch_execz L_PAD13
s_mov_b32 s76, 1
L_NS:
s_mov_b32 s74, s73
s_mov_b32 s93, s73
s_cmp_eq_u32 s72, 32
s_cbranch_scc1 L_FIN
L_SINGLE:
v_mfma_f32_16x16x32_bf16 v[44:47], a[192:195], v[116:119], v[128:131]
s_barrier
v_mfma_f32_16x16x32_bf16 v[44:47], a[196:199], v[132:135], v[44:47]
s_cmp_eq_u32 s68, s71
v_exp_f32 v229, v229
v_mfma_f32_16x16x32_bf16 v[44:47], a[200:203], v[184:187], v[44:47]
s_cselect_b32 s64, s77, s68
v_add_u32 v5, s75, v4
v_cvt_pk_bf16_f32 v234, v228, v229
v_mfma_f32_16x16x32_bf16 v[44:47], a[204:207], v[240:243], v[44:47]
s_mov_b32 m0, s70
v_exp_f32 v230, v230
v_mfma_f32_16x16x32_bf16 v[52:55], a[192:195], v[188:191], v[136:139]
buffer_load_dwordx4 v15, s[24:27], s64 offen offset:0 sc1 lds
v_mfma_f32_16x16x32_bf16 v[52:55], a[196:199], v[56:59], v[52:55]
s_add_u32 s75, s75, 16384
v_exp_f32 v231, v231
v_mfma_f32_16x16x32_bf16 v[52:55], a[200:203], v[88:91], v[52:55]
ds_read_b128 a[192:195], v5 offset:0
v_cvt_pk_bf16_f32 v235, v230, v231
v_mfma_f32_16x16x32_bf16 v[52:55], a[204:207], v[192:195], v[52:55]
s_cmp_ge_u32 s75, 163840
v_exp_f32 v44, v44
v_mfma_f32_16x16x32_bf16 v[64:67], a[208:211], v[116:119], v[144:147]
ds_read_b128 a[196:199], v5 offset:1024
ds_read_b128 a[200:203], v5 offset:2048
v_mfma_f32_16x16x32_bf16 v[64:67], a[212:215], v[132:135], v[64:67]
s_cselect_b32 s75, 0, s75
v_exp_f32 v45, v45
v_mfma_f32_16x16x32_bf16 v[64:67], a[216:219], v[184:187], v[64:67]
ds_read_b128 a[204:207], v5 offset:3072
v_cvt_pk_bf16_f32 v124, v44, v45
v_mfma_f32_16x16x32_bf16 v[64:67], a[220:223], v[240:243], v[64:67]
s_add_u32 s68, s64, 16384
v_exp_f32 v46, v46
v_mfma_f32_16x16x32_bf16 v[212:215], a[208:211], v[188:191], v[152:155]
buffer_load_dwordx4 v15, s[24:27], s64 offen offset:1024 sc1 lds
v_mfma_f32_16x16x32_bf16 v[212:215], a[212:215], v[56:59], v[212:215]
s_add_u32 s70, s70, 16384
v_exp_f32 v47, v47
v_mfma_f32_16x16x32_bf16 v[212:215], a[216:219], v[88:91], v[212:215]
ds_read_b128 a[208:211], v5 offset:4096
v_cvt_pk_bf16_f32 v125, v46, v47
v_mfma_f32_16x16x32_bf16 v[212:215], a[220:223], v[192:195], v[212:215]
s_waitcnt lgkmcnt(5)
v_exp_f32 v52, v52
v_mfma_f32_16x16x32_bf16 v[60:63], a[64:67], v[248:251], v[60:63]
ds_read_b128 a[212:215], v5 offset:5120
ds_read_b128 a[216:219], v5 offset:6144
v_mfma_f32_16x16x32_bf16 v[148:151], a[64:67], v[232:235], v[148:151]
s_cmp_ge_u32 s70, 163840
v_exp_f32 v53, v53
v_mfma_f32_16x16x32_bf16 v[48:51], a[68:71], v[232:235], v[48:51]
ds_read_b128 a[220:223], v5 offset:7168
v_cvt_pk_bf16_f32 v140, v52, v53
v_mfma_f32_16x16x32_bf16 v[68:71], a[68:71], v[248:251], v[68:71]
s_cselect_b32 s70, s80, s70
v_exp_f32 v54, v54
v_mfma_f32_16x16x32_bf16 v[72:75], a[72:75], v[248:251], v[72:75]
buffer_load_dwordx4 v15, s[24:27], s64 offen offset:2048 sc1 lds
v_mfma_f32_16x16x32_bf16 v[236:239], a[72:75], v[232:235], v[236:239]
v_exp_f32 v55, v55
v_mfma_f32_16x16x32_bf16 v[224:227], a[76:79], v[232:235], v[224:227]
ds_read_b128 a[64:67], v5 offset:8192
v_cvt_pk_bf16_f32 v141, v54, v55
v_mfma_f32_16x16x32_bf16 v[220:223], a[76:79], v[248:251], v[220:223]
v_exp_f32 v64, v64
v_mfma_f32_16x16x32_bf16 v[84:87], a[80:83], v[248:251], v[84:87]
ds_read_b128 a[68:71], v5 offset:9216
ds_read_b128 a[72:75], v5 offset:10240
v_mfma_f32_16x16x32_bf16 v[164:167], a[80:83], v[232:235], v[164:167]
v_exp_f32 v65, v65
v_mfma_f32_16x16x32_bf16 v[156:159], a[84:87], v[232:235], v[156:159]
ds_read_b128 a[76:79], v5 offset:11264
v_cvt_pk_bf16_f32 v126, v64, v65
v_mfma_f32_16x16x32_bf16 v[76:79], a[84:87], v[248:251], v[76:79]
s_cmp_eq_u32 s68, s71
v_exp_f32 v66, v66
v_mfma_f32_16x16x32_bf16 v[160:163], a[88:91], v[248:251], v[160:163]
buffer_load_dwordx4 v15, s[24:27], s64 offen offset:3072 sc1 lds
v_mfma_f32_16x16x32_bf16 v[216:219], a[88:91], v[232:235], v[216:219]
s_cselect_b32 s64, s77, s68
v_exp_f32 v67, v67
v_mfma_f32_16x16x32_bf16 v[208:211], a[92:95], v[232:235], v[208:211]
ds_read_b128 a[80:83], v5 offset:12288
v_cvt_pk_bf16_f32 v127, v66, v67
v_mfma_f32_16x16x32_bf16 v[252:255], a[92:95], v[248:251], v[252:255]
s_waitcnt lgkmcnt(5)
v_exp_f32 v212, v212
v_mfma_f32_16x16x32_bf16 a[232:235], a[240:243], v[248:251], a[232:235]
ds_read_b128 a[84:87], v5 offset:13312
ds_read_b128 a[88:91], v5 offset:14336
v_mfma_f32_16x16x32_bf16 a[236:239], a[240:243], v[232:235], a[236:239]
s_mov_b32 m0, s70
ds_read_b128 a[92:95], v5 offset:15360
v_mfma_f32_16x16x32_bf16 v[100:103], a[192:195], v[116:119], v[128:131]
buffer_load_dwordx4 v15, s[24:27], s64 offen offset:0 sc1 lds
v_mfma_f32_16x16x32_bf16 v[100:103], a[196:199], v[132:135], v[100:103]
v_exp_f32 v213, v213
v_mfma_f32_16x16x32_bf16 v[100:103], a[200:203], v[184:187], v[100:103]
v_add_u32 v5, s75, v4
v_cvt_pk_bf16_f32 v142, v212, v213
v_mfma_f32_16x16x32_bf16 v[100:103], a[204:207], v[240:243], v[100:103]
v_exp_f32 v214, v214
v_mfma_f32_16x16x32_bf16 v[92:95], a[192:195], v[188:191], v[136:139]
buffer_load_dwordx4 v15, s[24:27], s64 offen offset:1024 sc1 lds
v_mfma_f32_16x16x32_bf16 v[92:95], a[196:199], v[56:59], v[92:95]
s_add_u32 s75, s75, 16384
v_exp_f32 v215, v215
v_mfma_f32_16x16x32_bf16 v[92:95], a[200:203], v[88:91], v[92:95]
ds_read_b128 a[192:195], v5 offset:0
v_cvt_pk_bf16_f32 v143, v214, v215
v_mfma_f32_16x16x32_bf16 v[92:95], a[204:207], v[192:195], v[92:95]
s_cmp_ge_u32 s75, 163840
v_exp_f32 v100, v100
v_mfma_f32_16x16x32_bf16 v[176:179], a[208:211], v[116:119], v[144:147]
ds_read_b128 a[196:199], v5 offset:1024
ds_read_b128 a[200:203], v5 offset:2048
v_mfma_f32_16x16x32_bf16 v[176:179], a[212:215], v[132:135], v[176:179]
s_cselect_b32 s75, 0, s75
v_exp_f32 v101, v101
v_mfma_f32_16x16x32_bf16 v[176:179], a[216:219], v[184:187], v[176:179]
ds_read_b128 a[204:207], v5 offset:3072
v_cvt_pk_bf16_f32 v248, v100, v101
v_mfma_f32_16x16x32_bf16 v[176:179], a[220:223], v[240:243], v[176:179]
s_add_u32 s68, s64, 16384
v_exp_f32 v102, v102
v_mfma_f32_16x16x32_bf16 v[228:231], a[208:211], v[188:191], v[152:155]
buffer_load_dwordx4 v15, s[24:27], s64 offen offset:2048 sc1 lds
v_mfma_f32_16x16x32_bf16 v[228:231], a[212:215], v[56:59], v[228:231]
s_add_u32 s70, s70, 16384
v_exp_f32 v103, v103
v_mfma_f32_16x16x32_bf16 v[228:231], a[216:219], v[88:91], v[228:231]
ds_read_b128 a[208:211], v5 offset:4096
v_cvt_pk_bf16_f32 v249, v102, v103
v_mfma_f32_16x16x32_bf16 v[228:231], a[220:223], v[192:195], v[228:231]
s_waitcnt lgkmcnt(5)
v_exp_f32 v92, v92
v_mfma_f32_16x16x32_bf16 v[60:63], a[64:67], v[124:127], v[60:63]
ds_read_b128 a[212:215], v5 offset:5120
ds_read_b128 a[216:219], v5 offset:6144
v_mfma_f32_16x16x32_bf16 v[148:151], a[64:67], v[140:143], v[148:151]
s_cmp_ge_u32 s70, 163840
v_exp_f32 v93, v93
v_mfma_f32_16x16x32_bf16 v[48:51], a[68:71], v[140:143], v[48:51]
ds_read_b128 a[220:223], v5 offset:7168
v_cvt_pk_bf16_f32 v232, v92, v93
v_mfma_f32_16x16x32_bf16 v[68:71], a[68:71], v[124:127], v[68:71]
s_cselect_b32 s70, s80, s70
v_exp_f32 v94, v94
v_mfma_f32_16x16x32_bf16 v[72:75], a[72:75], v[124:127], v[72:75]
buffer_load_dwordx4 v15, s[24:27], s64 offen offset:3072 sc1 lds
v_mfma_f32_16x16x32_bf16 v[236:239], a[72:75], v[140:143], v[236:239]
s_add_u32 s72, s72, 1
v_exp_f32 v95, v95
v_mfma_f32_16x16x32_bf16 v[224:227], a[76:79], v[140:143], v[224:227]
ds_read_b128 a[64:67], v5 offset:8192
v_cvt_pk_bf16_f32 v233, v94, v95
v_mfma_f32_16x16x32_bf16 v[220:223], a[76:79], v[124:127], v[220:223]
v_exp_f32 v176, v176
v_mfma_f32_16x16x32_bf16 v[84:87], a[80:83], v[124:127], v[84:87]
ds_read_b128 a[68:71], v5 offset:9216
ds_read_b128 a[72:75], v5 offset:10240
v_mfma_f32_16x16x32_bf16 v[164:167], a[80:83], v[140:143], v[164:167]
v_exp_f32 v177, v177
v_mfma_f32_16x16x32_bf16 v[156:159], a[84:87], v[140:143], v[156:159]
ds_read_b128 a[76:79], v5 offset:11264
v_cvt_pk_bf16_f32 v250, v176, v177
v_mfma_f32_16x16x32_bf16 v[76:79], a[84:87], v[124:127], v[76:79]
v_exp_f32 v178, v178
v_mfma_f32_16x16x32_bf16 v[160:163], a[88:91], v[124:127], v[160:163]
ds_read_b128 a[80:83], v5 offset:12288
ds_read_b128 a[84:87], v5 offset:13312
v_mfma_f32_16x16x32_bf16 v[216:219], a[88:91], v[140:143], v[216:219]
s_cmp_lt_u32 s72, s74
v_exp_f32 v179, v179
v_mfma_f32_16x16x32_bf16 v[208:211], a[92:95], v[140:143], v[208:211]
ds_read_b128 a[88:91], v5 offset:14336
v_cvt_pk_bf16_f32 v251, v178, v179
v_mfma_f32_16x16x32_bf16 v[252:255], a[92:95], v[124:127], v[252:255]
s_waitcnt vmcnt(8) lgkmcnt(7)
v_exp_f32 v228, v228
v_mfma_f32_16x16x32_bf16 a[232:235], a[240:243], v[124:127], a[232:235]
ds_read_b128 a[92:95], v5 offset:15360
v_mfma_f32_16x16x32_bf16 a[236:239], a[240:243], v[140:143], a[236:239]
s_cbranch_scc1 L_SINGLE
s_cmp_eq_u32 s72, s69
s_cbranch_scc1 L_SE
s_cmp_lt_u32 s72, 32
s_cbranch_scc1 L_STOP
L_FIN:
s_add_u32 s53, s77, 196608
buffer_load_dwordx4 a[160:163], v15, s[24:27], s53 offen offset:0 sc1
v_cndmask_b32 v128, v128, v6, s[56:57]
v_cndmask_b32 v152, v152, v6, s[56:57]
v_mov_b32 v144, v6
buffer_load_dwordx4 a[164:167], v15, s[24:27], s53 offen offset:1024 sc1
v_cndmask_b32 v129, v129, v6, s[58:59]
v_cndmask_b32 v153, v153, v6, s[58:59]
v_mov_b32 v145, v6
buffer_load_dwordx4 a[168:171], v15, s[24:27], s53 offen offset:2048 sc1
v_cndmask_b32 v130, v130, v6, s[60:61]
v_cndmask_b32 v154, v154, v6, s[60:61]
v_mov_b32 v146, v6
buffer_load_dwordx4 a[172:175], v15, s[24:27], s53 offen offset:3072 sc1
v_cndmask_b32 v131, v131, v6, s[62:63]
v_cndmask_b32 v155, v155, v6, s[62:63]
v_mov_b32 v147, v6
s_mov_b32 s83, s75
s_sub_u32 s91, s70, s80
v_mfma_f32_16x16x32_bf16 v[44:47], a[192:195], v[116:119], v[128:131]
s_barrier
v_mfma_f32_16x16x32_bf16 v[44:47], a[196:199], v[132:135], v[44:47]
s_mov_b32 m0, s70
v_exp_f32 v229, v229
v_mfma_f32_16x16x32_bf16 v[44:47], a[200:203], v[184:187], v[44:47]
s_mov_b32 s64, s68
v_add_u32 v5, s75, v4
v_cvt_pk_bf16_f32 v234, v228, v229
v_mfma_f32_16x16x32_bf16 v[44:47], a[204:207], v[240:243], v[44:47]
s_add_u32 s68, s68, 16384
v_exp_f32 v230, v230
v_mfma_f32_16x16x32_bf16 v[52:55], a[192:195], v[188:191], v[136:139]
buffer_load_dwordx4 v15, s[24:27], s64 offen offset:0 sc1 lds
v_mfma_f32_16x16x32_bf16 v[52:55], a[196:199], v[56:59], v[52:55]
s_add_u32 s70, s70, 16384
v_exp_f32 v231, v231
v_mfma_f32_16x16x32_bf16 v[52:55], a[200:203], v[88:91], v[52:55]
v_cvt_pk_bf16_f32 v235, v230, v231
v_mul_f32 v10, 0x3fb8aa3b, v10
v_mfma_f32_16x16x32_bf16 v[52:55], a[204:207], v[192:195], v[52:55]
s_cmp_ge_u32 s70, 163840
v_exp_f32 v44, v44
v_mfma_f32_16x16x32_bf16 v[64:67], a[208:211], v[116:119], v[144:147]
buffer_load_dwordx4 v15, s[24:27], s64 offen offset:1024 sc1 lds
v_mfma_f32_16x16x32_bf16 v[64:67], a[212:215], v[132:135], v[64:67]
s_cselect_b32 s70, s80, s70
v_exp_f32 v45, v45
v_mfma_f32_16x16x32_bf16 v[64:67], a[216:219], v[184:187], v[64:67]
v_cvt_pk_bf16_f32 v124, v44, v45
v_mul_f32 v11, 0x3fb8aa3b, v11
v_mfma_f32_16x16x32_bf16 v[64:67], a[220:223], v[240:243], v[64:67]
v_exp_f32 v46, v46
v_mfma_f32_16x16x32_bf16 v[212:215], a[208:211], v[188:191], v[152:155]
buffer_load_dwordx4 v15, s[24:27], s64 offen offset:2048 sc1 lds
v_mfma_f32_16x16x32_bf16 v[212:215], a[212:215], v[56:59], v[212:215]
v_exp_f32 v47, v47
v_mfma_f32_16x16x32_bf16 v[212:215], a[216:219], v[88:91], v[212:215]
v_cvt_pk_bf16_f32 v125, v46, v47
v_mfma_f32_16x16x32_bf16 v[212:215], a[220:223], v[192:195], v[212:215]
s_waitcnt lgkmcnt(0)
v_exp_f32 v52, v52
v_mfma_f32_16x16x32_bf16 v[60:63], a[64:67], v[248:251], v[60:63]
buffer_load_dwordx4 v15, s[24:27], s64 offen offset:3072 sc1 lds
v_mfma_f32_16x16x32_bf16 v[148:151], a[64:67], v[232:235], v[148:151]
s_mov_b32 m0, s70
v_exp_f32 v53, v53
v_mfma_f32_16x16x32_bf16 v[48:51], a[68:71], v[232:235], v[48:51]
s_mov_b32 s64, s68
ds_read_b128 a[64:67], v5 offset:8192
v_cvt_pk_bf16_f32 v140, v52, v53
v_mfma_f32_16x16x32_bf16 v[68:71], a[68:71], v[248:251], v[68:71]
s_add_u32 s68, s68, 16384
v_exp_f32 v54, v54
v_mfma_f32_16x16x32_bf16 v[72:75], a[72:75], v[248:251], v[72:75]
buffer_load_dwordx4 v15, s[24:27], s64 offen offset:0 sc1 lds
v_mfma_f32_16x16x32_bf16 v[236:239], a[72:75], v[232:235], v[236:239]
s_add_u32 s70, s70, 16384
v_exp_f32 v55, v55
v_mfma_f32_16x16x32_bf16 v[224:227], a[76:79], v[232:235], v[224:227]
ds_read_b128 a[68:71], v5 offset:9216
v_cvt_pk_bf16_f32 v141, v54, v55
v_mfma_f32_16x16x32_bf16 v[220:223], a[76:79], v[248:251], v[220:223]
s_cmp_ge_u32 s70, 163840
v_exp_f32 v64, v64
v_mfma_f32_16x16x32_bf16 v[84:87], a[80:83], v[248:251], v[84:87]
ds_read_b128 a[72:75], v5 offset:10240
v_mfma_f32_16x16x32_bf16 v[164:167], a[80:83], v[232:235], v[164:167]
s_cselect_b32 s70, s80, s70
v_exp_f32 v65, v65
v_mfma_f32_16x16x32_bf16 v[156:159], a[84:87], v[232:235], v[156:159]
ds_read_b128 a[76:79], v5 offset:11264
v_cvt_pk_bf16_f32 v126, v64, v65
v_mfma_f32_16x16x32_bf16 v[76:79], a[84:87], v[248:251], v[76:79]
v_exp_f32 v66, v66
v_mfma_f32_16x16x32_bf16 v[160:163], a[88:91], v[248:251], v[160:163]
buffer_load_dwordx4 v15, s[24:27], s64 offen offset:1024 sc1 lds
v_mfma_f32_16x16x32_bf16 v[216:219], a[88:91], v[232:235], v[216:219]
s_add_u32 s52, s79, 4096
v_exp_f32 v67, v67
v_mfma_f32_16x16x32_bf16 v[208:211], a[92:95], v[232:235], v[208:211]
ds_read_b128 a[80:83], v5 offset:12288
v_cvt_pk_bf16_f32 v127, v66, v67
v_mfma_f32_16x16x32_bf16 v[252:255], a[92:95], v[248:251], v[252:255]
v_exp_f32 v212, v212
v_mfma_f32_16x16x32_bf16 a[232:235], a[240:243], v[248:251], a[232:235]
ds_read_b128 a[84:87], v5 offset:13312
ds_read_b128 a[88:91], v5 offset:14336
v_mfma_f32_16x16x32_bf16 a[236:239], a[240:243], v[232:235], a[236:239]
ds_read_b128 a[92:95], v5 offset:15360
v_exp_f32 v213, v213
v_exp_f32 v214, v214
v_exp_f32 v215, v215
v_exp_f32 v10, v10
v_cvt_pk_bf16_f32 v142, v212, v213
v_cvt_pk_bf16_f32 v143, v214, v215
v_exp_f32 v11, v11
s_waitcnt lgkmcnt(0)
v_mfma_f32_16x16x32_bf16 a[232:235], a[240:243], v[124:127], a[232:235]
buffer_load_dwordx4 v15, s[24:27], s64 offen offset:2048 sc1 lds
v_mfma_f32_16x16x32_bf16 a[236:239], a[240:243], v[140:143], a[236:239]
s_barrier
v_mfma_f32_16x16x32_bf16 v[60:63], a[64:67], v[124:127], v[60:63]
v_cmp_eq_u32 vcc, 0, v3
v_mul_u32_u24 v244, 1536, v3
v_mfma_f32_16x16x32_bf16 v[148:151], a[64:67], v[140:143], v[148:151]
v_mov_b32 v246, 9728
v_cndmask_b32 v244, v244, v246, vcc
v_mfma_f32_16x16x32_bf16 v[48:51], a[68:71], v[140:143], v[48:51]
buffer_load_dwordx4 v15, s[24:27], s64 offen offset:3072 sc1 lds
v_mfma_f32_16x16x32_bf16 v[68:71], a[68:71], v[124:127], v[68:71]
v_lshl_add_u32 v247, v2, 4, s83
v_mov_b32 v246, 10496
v_mfma_f32_16x16x32_bf16 v[72:75], a[72:75], v[124:127], v[72:75]
v_accvgpr_read_b32 v180, a232
v_accvgpr_read_b32 v182, a236
v_mfma_f32_16x16x32_bf16 v[236:239], a[72:75], v[140:143], v[236:239]
v_cmp_nle_f32 vcc, v180, v7
v_cmp_nle_f32 s[96:97], v182, v7
v_mfma_f32_16x16x32_bf16 v[224:227], a[76:79], v[140:143], v[224:227]
v_fma_f32 v180, v180, v10, v180
v_fma_f32 v182, v182, v11, v182
v_mfma_f32_16x16x32_bf16 v[220:223], a[76:79], v[124:127], v[220:223]
v_rcp_f32 v180, v180
v_mfma_f32_16x16x32_bf16 v[84:87], a[80:83], v[124:127], v[84:87]
s_or_b64 vcc, vcc, s[96:97]
v_rcp_f32 v182, v182
v_mfma_f32_16x16x32_bf16 v[164:167], a[80:83], v[140:143], v[164:167]
v_mul_f32 v60, v180, v60
v_mul_f32 v61, v180, v61
v_mfma_f32_16x16x32_bf16 v[156:159], a[84:87], v[140:143], v[156:159]
v_mul_f32 v62, v180, v62
v_mul_f32 v63, v180, v63
v_mfma_f32_16x16x32_bf16 v[76:79], a[84:87], v[124:127], v[76:79]
v_mul_f32 v68, v180, v68
v_mul_f32 v69, v180, v69
v_mfma_f32_16x16x32_bf16 v[160:163], a[88:91], v[124:127], v[160:163]
v_mul_f32 v70, v180, v70
v_mul_f32 v71, v180, v71
v_mfma_f32_16x16x32_bf16 v[216:219], a[88:91], v[140:143], v[216:219]
v_cvt_pk_bf16_f32 v60, v60, v61
v_cvt_pk_bf16_f32 v61, v62, v63
v_mfma_f32_16x16x32_bf16 v[208:211], a[92:95], v[140:143], v[208:211]
v_cvt_pk_bf16_f32 v62, v68, v69
v_cvt_pk_bf16_f32 v63, v70, v71
v_mfma_f32_16x16x32_bf16 v[252:255], a[92:95], v[124:127], v[252:255]
s_cbranch_vccnz SLOW1
L_EP:
buffer_store_dwordx4 v[60:63], v15, s[24:27], s79 offen offset:0 sc1
v_pk_mul_f32 v[148:149], v[148:149], v[182:183] op_sel_hi:[1,0]
v_pk_mul_f32 v[150:151], v[150:151], v[182:183] op_sel_hi:[1,0]
v_pk_mul_f32 v[48:49], v[48:49], v[182:183] op_sel_hi:[1,0]
v_pk_mul_f32 v[50:51], v[50:51], v[182:183] op_sel_hi:[1,0]
v_cvt_pk_bf16_f32 v148, v148, v149
v_cvt_pk_bf16_f32 v149, v150, v151
v_cvt_pk_bf16_f32 v150, v48, v49
v_cvt_pk_bf16_f32 v151, v50, v51
buffer_store_dwordx4 v[148:151], v15, s[24:27], s79 offen offset:1024 sc1
v_pk_mul_f32 v[72:73], v[72:73], v[180:181] op_sel_hi:[1,0]
v_pk_mul_f32 v[74:75], v[74:75], v[180:181] op_sel_hi:[1,0]
v_pk_mul_f32 v[220:221], v[220:221], v[180:181] op_sel_hi:[1,0]
v_pk_mul_f32 v[222:223], v[222:223], v[180:181] op_sel_hi:[1,0]
v_cvt_pk_bf16_f32 v72, v72, v73
v_cvt_pk_bf16_f32 v73, v74, v75
v_cvt_pk_bf16_f32 v74, v220, v221
v_cvt_pk_bf16_f32 v75, v222, v223
buffer_store_dwordx4 v[72:75], v15, s[24:27], s79 offen offset:2048 sc1
v_pk_mul_f32 v[236:237], v[236:237], v[182:183] op_sel_hi:[1,0]
v_pk_mul_f32 v[238:239], v[238:239], v[182:183] op_sel_hi:[1,0]
v_pk_mul_f32 v[224:225], v[224:225], v[182:183] op_sel_hi:[1,0]
v_pk_mul_f32 v[226:227], v[226:227], v[182:183] op_sel_hi:[1,0]
v_cvt_pk_bf16_f32 v236, v236, v237
v_cvt_pk_bf16_f32 v237, v238, v239
v_cvt_pk_bf16_f32 v238, v224, v225
v_cvt_pk_bf16_f32 v239, v226, v227
buffer_store_dwordx4 v[236:239], v15, s[24:27], s79 offen offset:3072 sc1
v_pk_mul_f32 v[84:85], v[84:85], v[180:181] op_sel_hi:[1,0]
v_pk_mul_f32 v[86:87], v[86:87], v[180:181] op_sel_hi:[1,0]
v_pk_mul_f32 v[76:77], v[76:77], v[180:181] op_sel_hi:[1,0]
v_pk_mul_f32 v[78:79], v[78:79], v[180:181] op_sel_hi:[1,0]
v_cvt_pk_bf16_f32 v84, v84, v85
v_cvt_pk_bf16_f32 v85, v86, v87
v_cvt_pk_bf16_f32 v86, v76, v77
v_cvt_pk_bf16_f32 v87, v78, v79
buffer_store_dwordx4 v[84:87], v15, s[24:27], s52 offen offset:0 sc1
v_pk_mul_f32 v[164:165], v[164:165], v[182:183] op_sel_hi:[1,0]
v_pk_mul_f32 v[166:167], v[166:167], v[182:183] op_sel_hi:[1,0]
v_pk_mul_f32 v[156:157], v[156:157], v[182:183] op_sel_hi:[1,0]
v_pk_mul_f32 v[158:159], v[158:159], v[182:183] op_sel_hi:[1,0]
v_cvt_pk_bf16_f32 v164, v164, v165
v_cvt_pk_bf16_f32 v165, v166, v167
v_cvt_pk_bf16_f32 v166, v156, v157
v_cvt_pk_bf16_f32 v167, v158, v159
buffer_store_dwordx4 v[164:167], v15, s[24:27], s52 offen offset:1024 sc1
v_pk_mul_f32 v[160:161], v[160:161], v[180:181] op_sel_hi:[1,0]
v_pk_mul_f32 v[162:163], v[162:163], v[180:181] op_sel_hi:[1,0]
v_pk_mul_f32 v[252:253], v[252:253], v[180:181] op_sel_hi:[1,0]
v_pk_mul_f32 v[254:255], v[254:255], v[180:181] op_sel_hi:[1,0]
v_cvt_pk_bf16_f32 v160, v160, v161
v_cvt_pk_bf16_f32 v161, v162, v163
v_cvt_pk_bf16_f32 v162, v252, v253
v_cvt_pk_bf16_f32 v163, v254, v255
buffer_store_dwordx4 v[160:163], v15, s[24:27], s52 offen offset:2048 sc1
v_pk_mul_f32 v[216:217], v[216:217], v[182:183] op_sel_hi:[1,0]
v_pk_mul_f32 v[218:219], v[218:219], v[182:183] op_sel_hi:[1,0]
v_pk_mul_f32 v[208:209], v[208:209], v[182:183] op_sel_hi:[1,0]
v_pk_mul_f32 v[210:211], v[210:211], v[182:183] op_sel_hi:[1,0]
v_cvt_pk_bf16_f32 v216, v216, v217
v_cvt_pk_bf16_f32 v217, v218, v219
v_cvt_pk_bf16_f32 v218, v208, v209
v_cvt_pk_bf16_f32 v219, v210, v211
buffer_store_dwordx4 v[216:219], v15, s[24:27], s52 offen offset:3072 sc1
v_cmp_eq_u32 vcc, 3, v3
v_mul_u32_u24 v200, 768, v3
v_add_u32 v200, v200, v247
ds_write_b128 v200, a[244:247] offset:0
v_cndmask_b32 v245, v244, v246, vcc
ds_write_b128 v200, a[248:251] offset:3072
v_add_u32 v247, -1280, v247
ds_write_b128 v200, a[252:255] offset:6144
v_add_u32 v244, v244, v247
v_add_u32 v245, v245, v247
ds_write_b128 v244, a[128:131] offset:0
v_cmp_lt_u32 vcc, 31, v1
ds_write_b128 v245, a[132:135] offset:768
v_and_b32 v202, 31, v1
ds_write_b128 v244, a[136:139] offset:256
v_mov_b32 v200, s66
ds_write_b128 v245, a[140:143] offset:1024
v_mov_b32 v203, s67
ds_write_b128 v244, a[144:147] offset:3840
v_cndmask_b32 v200, v200, v203, vcc
ds_write_b128 v245, a[148:151] offset:4608
v_lshl_add_u32 v200, v200, 5, v202
ds_write_b128 v244, a[152:155] offset:4096
v_lshrrev_b32 v201, 5, v1
ds_write_b128 v245, a[156:159] offset:4864
v_mul_u32_u24 v201, 3840, v201
v_lshl_add_u32 v201, v202, 4, v201
v_add_u32 v201, s83, v201
s_cmp_eq_u32 s76, 0
s_cbranch_scc1 L_SE2
L_LA:
v_mov_b32 v5, v200
v_mov_b32 v6, v201
v_mov_b32 v13, 0
s_lshl_b32 s74, s66, 10
s_lshr_b32 s52, s4, 3
s_lshl_b32 s52, s52, 8
s_add_u32 s74, s74, s52
s_add_u32 s74, s74, 75530240
ds_read_b128 v[16:19], v6 offset:8448
ds_read_b128 v[20:23], v6 offset:9216
ds_read_b128 v[96:99], v6 offset:3328
ds_read_b128 v[32:35], v6 offset:256
ds_read_b128 v[36:39], v6 offset:1024
ds_read_b128 v[100:103], v6 offset:3296
ds_read_b128 v[40:43], v6 offset:224
ds_read_b128 v[44:47], v6 offset:992
ds_read_b128 v[104:107], v6 offset:3264
ds_read_b128 v[48:51], v6 offset:192
ds_read_b128 v[52:55], v6 offset:960
ds_read_b128 v[108:111], v6 offset:3232
ds_read_b128 v[56:59], v6 offset:160
ds_read_b128 v[60:63], v6 offset:928
ds_read_b128 v[112:115], v6 offset:3200
ds_read_b128 v[64:67], v6 offset:128
ds_read_b128 v[68:71], v6 offset:896
ds_read_b128 v[116:119], v6 offset:3168
ds_read_b128 v[72:75], v6 offset:96
ds_read_b128 v[76:79], v6 offset:864
ds_read_b128 v[120:123], v6 offset:3136
ds_read_b128 v[80:83], v6 offset:64
ds_read_b128 v[84:87], v6 offset:832
ds_read_b128 v[124:127], v6 offset:3104
ds_read_b128 v[88:91], v6 offset:32
ds_read_b128 v[92:95], v6 offset:800
ds_read_b128 v[128:131], v6 offset:1792
ds_read_b128 v[132:135], v6 offset:2560
s_waitcnt vmcnt(0)
buffer_atomic_add v1, v0, s[24:27], s74 offen offset:0 sc1
ds_read_b128 v[136:139], v6 offset:1760
ds_read_b128 v[140:143], v6 offset:2528
ds_read_b128 v[144:147], v6 offset:1728
ds_read_b128 v[148:151], v6 offset:2496
ds_read_b128 v[152:155], v6 offset:1696
ds_read_b128 v[156:159], v6 offset:2464
ds_read_b128 v[160:163], v6 offset:1664
ds_read_b128 v[164:167], v6 offset:2432
ds_read_b128 v[168:171], v6 offset:1632
ds_read_b128 v[172:175], v6 offset:2400
ds_read_b128 v[176:179], v6 offset:1600
ds_read_b128 v[180:183], v6 offset:2368
ds_read_b128 v[184:187], v6 offset:1568
ds_read_b128 v[188:191], v6 offset:2336
s_lshr_b32 s52, s3, 1
s_lshl1_add_u32 s72, s85, s52
s_lshl2_add_u32 s75, s72, s84
s_lshl_b32 s75, s75, 8
s_add_u32 s75, s75, 75530240
s_and_b32 s82, s86, 1
s_lshl_b32 s82, s82, 13
s_lshr_b32 s53, s4, 3
s_mul_i32 s53, s53, 75776
s_add_u32 s53, s53, 54525952
s_and_b32 s52, s3, 1
s_lshl_b32 s52, s52, 10
s_add_u32 s52, s52, s53
s_sub_u32 s54, 63, s72
s_mul_i32 s77, s72, 303104
s_add_u32 s77, s77, s52
s_mul_i32 s81, s54, 303104
s_add_u32 s81, s81, s52
s_add_u32 s91, s91, 114688
s_sub_u32 s52, s91, 163840
s_cmp_ge_u32 s91, 163840
s_cselect_b32 s91, s52, s91
v_add_u32 v14, 4096, v15
v_add_u32 v7, s91, v4
s_waitcnt lgkmcnt(0)
s_barrier
s_mov_b32 m0, s70
s_mov_b32 s64, s68
s_add_u32 s68, s68, 16384
s_add_u32 s70, s70, 16384
s_cmp_ge_u32 s70, 163840
s_cselect_b32 s70, s80, s70
buffer_load_dwordx4 v15, s[24:27], s64 offen offset:0 sc1 lds
v_and_b32 v9, 0xffff, v97
v_and_b32 v11, 0xffff0000, v97
v_dot2_f32_bf16 v24, v98, v99, 0
v_dot2_f32_bf16 v25, v102, v99, 0
v_dot2_f32_bf16 v26, v106, v99, 0
v_dot2_f32_bf16 v27, v110, v99, 0
v_dot2_f32_bf16 v28, v114, v99, 0
v_dot2_f32_bf16 v29, v118, v99, 0
v_dot2_f32_bf16 v30, v122, v99, 0
v_dot2_f32_bf16 v31, v126, v99, 0
v_dot2c_f32_bf16 v24, v96, v9
buffer_load_dwordx4 v15, s[24:27], s64 offen offset:1024 sc1 lds
v_dot2c_f32_bf16 v25, v100, v9
v_dot2c_f32_bf16 v26, v104, v9
v_dot2c_f32_bf16 v27, v108, v9
v_dot2c_f32_bf16 v28, v112, v9
v_dot2c_f32_bf16 v29, v116, v9
v_dot2c_f32_bf16 v30, v120, v9
v_dot2c_f32_bf16 v31, v124, v9
v_dot2c_f32_bf16 v24, v16, v32
v_dot2c_f32_bf16 v25, v16, v40
v_dot2c_f32_bf16 v26, v16, v48
v_dot2c_f32_bf16 v27, v16, v56
buffer_load_dwordx4 v15, s[24:27], s64 offen offset:2048 sc1 lds
v_dot2c_f32_bf16 v28, v16, v64
v_dot2c_f32_bf16 v29, v16, v72
v_dot2c_f32_bf16 v30, v16, v80
v_dot2c_f32_bf16 v31, v16, v88
v_dot2c_f32_bf16 v24, v17, v33
v_dot2c_f32_bf16 v25, v17, v41
v_dot2c_f32_bf16 v26, v17, v49
v_dot2c_f32_bf16 v27, v17, v57
v_dot2c_f32_bf16 v28, v17, v65
v_dot2c_f32_bf16 v29, v17, v73
v_dot2c_f32_bf16 v30, v17, v81
buffer_load_dwordx4 v15, s[24:27], s64 offen offset:3072 sc1 lds
v_dot2c_f32_bf16 v31, v17, v89
v_dot2c_f32_bf16 v24, v18, v34
v_dot2c_f32_bf16 v25, v18, v42
v_dot2c_f32_bf16 v26, v18, v50
v_dot2c_f32_bf16 v27, v18, v58
v_dot2c_f32_bf16 v28, v18, v66
v_dot2c_f32_bf16 v29, v18, v74
v_dot2c_f32_bf16 v30, v18, v82
v_dot2c_f32_bf16 v31, v18, v90
v_dot2c_f32_bf16 v24, v19, v35
v_dot2c_f32_bf16 v25, v19, v43
s_mov_b32 m0, s70
s_mov_b32 s64, s68
s_add_u32 s68, s68, 16384
s_add_u32 s70, s70, 16384
s_cmp_ge_u32 s70, 163840
s_cselect_b32 s70, s80, s70
buffer_load_dwordx4 v15, s[24:27], s64 offen offset:0 sc1 lds
v_dot2c_f32_bf16 v26, v19, v51
v_dot2c_f32_bf16 v27, v19, v59
v_dot2c_f32_bf16 v28, v19, v67
v_dot2c_f32_bf16 v29, v19, v75
v_dot2c_f32_bf16 v30, v19, v83
v_dot2c_f32_bf16 v31, v19, v91
v_dot2c_f32_bf16 v24, v20, v36
v_dot2c_f32_bf16 v25, v20, v44
v_dot2c_f32_bf16 v26, v20, v52
v_dot2c_f32_bf16 v27, v20, v60
v_dot2c_f32_bf16 v28, v20, v68
buffer_load_dwordx4 v15, s[24:27], s64 offen offset:1024 sc1 lds
v_dot2c_f32_bf16 v29, v20, v76
v_dot2c_f32_bf16 v30, v20, v84
v_dot2c_f32_bf16 v31, v20, v92
v_dot2c_f32_bf16 v24, v21, v37
v_dot2c_f32_bf16 v25, v21, v45
v_dot2c_f32_bf16 v26, v21, v53
v_dot2c_f32_bf16 v27, v21, v61
v_dot2c_f32_bf16 v28, v21, v69
v_dot2c_f32_bf16 v29, v21, v77
v_dot2c_f32_bf16 v30, v21, v85
v_dot2c_f32_bf16 v31, v21, v93
buffer_load_dwordx4 v15, s[24:27], s64 offen offset:2048 sc1 lds
v_dot2c_f32_bf16 v24, v22, v38
v_dot2c_f32_bf16 v25, v22, v46
L_PAD10:
s_cbranch_execz L_MAIN
v_dot2c_f32_bf16 v26, v22, v54
v_dot2c_f32_bf16 v27, v22, v62
v_dot2c_f32_bf16 v28, v22, v70
v_dot2c_f32_bf16 v29, v22, v78
v_dot2c_f32_bf16 v30, v22, v86
v_dot2c_f32_bf16 v31, v22, v94
v_dot2c_f32_bf16 v24, v23, v39
v_dot2c_f32_bf16 v25, v23, v47
v_dot2c_f32_bf16 v26, v23, v55
buffer_load_dwordx4 v15, s[24:27], s64 offen offset:3072 sc1 lds
v_dot2c_f32_bf16 v27, v23, v63
v_dot2c_f32_bf16 v28, v23, v71
v_dot2c_f32_bf16 v29, v23, v79
v_dot2c_f32_bf16 v30, v23, v87
v_dot2c_f32_bf16 v31, v23, v95
v_mov_b32 v9, 0xf149f2ca
v_mul_f32 v11, 0xbfb8aa3b, v11
v_exp_f32 v11, v11
v_cmp_gt_u32 vcc, 2, v5
v_cmp_gt_u32 s[56:57], 4, v5
s_nop 0
s_mov_b32 m0, s70
s_mov_b32 s64, s68
s_add_u32 s68, s68, 16384
s_add_u32 s70, s70, 16384
s_cmp_ge_u32 s70, 163840
s_cselect_b32 s70, s80, s70
buffer_load_dwordx4 v15, s[24:27], s64 offen offset:0 sc1 lds
v_cndmask_b32 v25, v25, v9, vcc
v_cndmask_b32 v26, v26, v9, s[56:57]
v_cmp_gt_u32 vcc, 6, v5
v_cmp_gt_u32 s[56:57], 8, v5
s_nop 0
v_cndmask_b32 v27, v27, v9, vcc
v_cndmask_b32 v28, v28, v9, s[56:57]
v_cmp_gt_u32 vcc, 10, v5
v_cmp_gt_u32 s[56:57], 12, v5
s_nop 0
v_cndmask_b32 v29, v29, v9, vcc
buffer_load_dwordx4 v15, s[24:27], s64 offen offset:1024 sc1 lds
v_cndmask_b32 v30, v30, v9, s[56:57]
v_cmp_gt_u32 vcc, 14, v5
s_nop 0
s_nop 0
v_cndmask_b32 v31, v31, v9, vcc
v_max3_f32 v10, v24, v25, v26
v_max3_f32 v10, v10, v27, v28
v_max3_f32 v10, v10, v29, v30
v_max_f32 v10, v10, v31
s_mov_b32 s52, 0x3eae1a93
v_sub_f32 v24, v24, v10
buffer_load_dwordx4 v15, s[24:27], s64 offen offset:2048 sc1 lds
v_sub_f32 v25, v25, v10
v_sub_f32 v26, v26, v10
v_sub_f32 v27, v27, v10
v_sub_f32 v28, v28, v10
v_sub_f32 v29, v29, v10
v_sub_f32 v30, v30, v10
v_sub_f32 v31, v31, v10
v_mul_f32 v24, s52, v24
v_mul_f32 v25, s52, v25
v_mul_f32 v26, s52, v26
v_mul_f32 v27, s52, v27
buffer_load_dwordx4 v15, s[24:27], s64 offen offset:3072 sc1 lds
v_mul_f32 v28, s52, v28
v_mul_f32 v29, s52, v29
v_mul_f32 v30, s52, v30
v_mul_f32 v31, s52, v31
v_exp_f32 v24, v24
v_exp_f32 v25, v25
v_exp_f32 v26, v26
v_exp_f32 v27, v27
v_exp_f32 v28, v28
v_exp_f32 v29, v29
v_exp_f32 v30, v30
s_mov_b32 m0, s70
s_mov_b32 s64, s68
s_add_u32 s68, s68, 16384
s_add_u32 s70, s70, 16384
s_cmp_ge_u32 s70, 163840
s_cselect_b32 s70, s80, s70
buffer_load_dwordx4 v15, s[24:27], s64 offen offset:0 sc1 lds
v_exp_f32 v31, v31
v_cvt_pk_bf16_f32 v32, v24, 0
v_cvt_pk_bf16_f32 v40, v25, 0
v_cvt_pk_bf16_f32 v48, v26, 0
v_cvt_pk_bf16_f32 v56, v27, 0
v_cvt_pk_bf16_f32 v64, v28, 0
v_cvt_pk_bf16_f32 v72, v29, 0
v_cvt_pk_bf16_f32 v80, v30, 0
v_cvt_pk_bf16_f32 v88, v31, 0
v_lshlrev_b32 v33, 16, v32
v_lshlrev_b32 v41, 16, v40
buffer_load_dwordx4 v15, s[24:27], s64 offen offset:1024 sc1 lds
v_lshlrev_b32 v49, 16, v48
v_lshlrev_b32 v57, 16, v56
v_lshlrev_b32 v65, 16, v64
v_lshlrev_b32 v73, 16, v72
v_lshlrev_b32 v81, 16, v80
v_lshlrev_b32 v89, 16, v88
v_add_f32 v10, v33, v41
v_add_f32 v10, v10, v49
v_add_f32 v10, v10, v57
v_add_f32 v10, v10, v65
v_add_f32 v10, v10, v73
buffer_load_dwordx4 v15, s[24:27], s64 offen offset:2048 sc1 lds
v_add_f32 v10, v10, v81
v_add_f32 v10, v10, v89
v_fmac_f32 v10, v10, v11
v_rcp_f32 v10, v10
v_dot2_f32_bf16 v192, v128, v32, 0
v_dot2_f32_bf16 v193, v128, v33, 0
v_dot2_f32_bf16 v194, v129, v32, 0
v_dot2_f32_bf16 v195, v129, v33, 0
v_dot2_f32_bf16 v196, v130, v32, 0
v_dot2_f32_bf16 v197, v130, v33, 0
v_dot2_f32_bf16 v198, v131, v32, 0
buffer_load_dwordx4 v15, s[24:27], s64 offen offset:3072 sc1 lds
v_dot2_f32_bf16 v199, v131, v33, 0
v_dot2_f32_bf16 v200, v132, v32, 0
v_dot2_f32_bf16 v201, v132, v33, 0
v_dot2_f32_bf16 v202, v133, v32, 0
v_dot2_f32_bf16 v203, v133, v33, 0
v_dot2_f32_bf16 v204, v134, v32, 0
v_dot2_f32_bf16 v205, v134, v33, 0
v_dot2_f32_bf16 v206, v135, v32, 0
v_dot2_f32_bf16 v207, v135, v33, 0
v_dot2_f32_bf16 v208, v96, v33, 0
v_dot2_f32_bf16 v209, v98, v33, 0
buffer_load_dword v12, v13, s[24:27], s75 offen sc1
v_dot2c_f32_bf16 v192, v136, v40
v_dot2c_f32_bf16 v193, v136, v41
v_dot2c_f32_bf16 v194, v137, v40
v_dot2c_f32_bf16 v195, v137, v41
v_dot2c_f32_bf16 v196, v138, v40
v_dot2c_f32_bf16 v197, v138, v41
v_dot2c_f32_bf16 v198, v139, v40
v_dot2c_f32_bf16 v199, v139, v41
v_dot2c_f32_bf16 v200, v140, v40
v_dot2c_f32_bf16 v201, v140, v41
v_dot2c_f32_bf16 v202, v141, v40
s_mov_b32 m0, s70
s_mov_b32 s64, s68
s_add_u32 s68, s68, 16384
s_add_u32 s70, s70, 16384
s_cmp_ge_u32 s70, 163840
s_cselect_b32 s70, s80, s70
buffer_load_dwordx4 v15, s[24:27], s64 offen offset:0 sc1 lds
v_dot2c_f32_bf16 v203, v141, v41
v_dot2c_f32_bf16 v204, v142, v40
v_dot2c_f32_bf16 v205, v142, v41
v_dot2c_f32_bf16 v206, v143, v40
v_dot2c_f32_bf16 v207, v143, v41
v_dot2c_f32_bf16 v208, v100, v41
v_dot2c_f32_bf16 v209, v102, v41
v_dot2c_f32_bf16 v192, v144, v48
v_dot2c_f32_bf16 v193, v144, v49
v_dot2c_f32_bf16 v194, v145, v48
v_dot2c_f32_bf16 v195, v145, v49
buffer_load_dwordx4 v15, s[24:27], s64 offen offset:1024 sc1 lds
v_dot2c_f32_bf16 v196, v146, v48
v_dot2c_f32_bf16 v197, v146, v49
v_dot2c_f32_bf16 v198, v147, v48
v_dot2c_f32_bf16 v199, v147, v49
v_dot2c_f32_bf16 v200, v148, v48
v_dot2c_f32_bf16 v201, v148, v49
v_dot2c_f32_bf16 v202, v149, v48
v_dot2c_f32_bf16 v203, v149, v49
v_dot2c_f32_bf16 v204, v150, v48
v_dot2c_f32_bf16 v205, v150, v49
v_dot2c_f32_bf16 v206, v151, v48
buffer_load_dwordx4 v15, s[24:27], s64 offen offset:2048 sc1 lds
v_dot2c_f32_bf16 v207, v151, v49
v_dot2c_f32_bf16 v208, v104, v49
v_dot2c_f32_bf16 v209, v106, v49
v_dot2c_f32_bf16 v192, v152, v56
v_dot2c_f32_bf16 v193, v152, v57
v_dot2c_f32_bf16 v194, v153, v56
v_dot2c_f32_bf16 v195, v153, v57
v_dot2c_f32_bf16 v196, v154, v56
v_dot2c_f32_bf16 v197, v154, v57
v_dot2c_f32_bf16 v198, v155, v56
v_dot2c_f32_bf16 v199, v155, v57
buffer_load_dwordx4 v15, s[24:27], s64 offen offset:3072 sc1 lds
v_dot2c_f32_bf16 v200, v156, v56
v_dot2c_f32_bf16 v201, v156, v57
v_dot2c_f32_bf16 v202, v157, v56
v_dot2c_f32_bf16 v203, v157, v57
v_dot2c_f32_bf16 v204, v158, v56
v_dot2c_f32_bf16 v205, v158, v57
v_dot2c_f32_bf16 v206, v159, v56
v_dot2c_f32_bf16 v207, v159, v57
v_dot2c_f32_bf16 v208, v108, v57
v_dot2c_f32_bf16 v209, v110, v57
v_dot2c_f32_bf16 v192, v160, v64
s_waitcnt vmcnt(4)
v_cmp_gt_u32 s[96:97], 8, v12
s_nop 3
s_cmp_eq_u64 s[96:97], 0
s_cselect_b32 s78, s77, 2147418112
s_cselect_b32 s79, s81, 2147418112
s_xor_b32 s65, s82, 0
s_add_u32 s65, s65, s78
buffer_load_dwordx4 a[0:3], v15, s[24:27], s65 offen offset:0 sc1
v_dot2c_f32_bf16 v193, v160, v65
v_dot2c_f32_bf16 v194, v161, v64
v_dot2c_f32_bf16 v195, v161, v65
v_dot2c_f32_bf16 v196, v162, v64
v_dot2c_f32_bf16 v197, v162, v65
v_dot2c_f32_bf16 v198, v163, v64
v_dot2c_f32_bf16 v199, v163, v65
v_dot2c_f32_bf16 v200, v164, v64
v_dot2c_f32_bf16 v201, v164, v65
v_dot2c_f32_bf16 v202, v165, v64
v_dot2c_f32_bf16 v203, v165, v65
buffer_load_dwordx4 a[8:11], v15, s[24:27], s65 offen offset:2048 sc1
v_dot2c_f32_bf16 v204, v166, v64
v_dot2c_f32_bf16 v205, v166, v65
v_dot2c_f32_bf16 v206, v167, v64
v_dot2c_f32_bf16 v207, v167, v65
v_dot2c_f32_bf16 v208, v112, v65
v_dot2c_f32_bf16 v209, v114, v65
v_dot2c_f32_bf16 v192, v168, v72
v_dot2c_f32_bf16 v193, v168, v73
v_dot2c_f32_bf16 v194, v169, v72
v_dot2c_f32_bf16 v195, v169, v73
v_dot2c_f32_bf16 v196, v170, v72
s_xor_b32 s93, s82, 0
s_add_u32 s93, s93, s79
buffer_load_dwordx4 a[4:7], v15, s[24:27], s93 offen offset:0 sc1
v_dot2c_f32_bf16 v197, v170, v73
v_dot2c_f32_bf16 v198, v171, v72
v_dot2c_f32_bf16 v199, v171, v73
v_dot2c_f32_bf16 v200, v172, v72
v_dot2c_f32_bf16 v201, v172, v73
v_dot2c_f32_bf16 v202, v173, v72
v_dot2c_f32_bf16 v203, v173, v73
v_dot2c_f32_bf16 v204, v174, v72
v_dot2c_f32_bf16 v205, v174, v73
v_dot2c_f32_bf16 v206, v175, v72
v_dot2c_f32_bf16 v207, v175, v73
buffer_load_dwordx4 a[12:15], v15, s[24:27], s93 offen offset:2048 sc1
v_dot2c_f32_bf16 v208, v116, v73
v_dot2c_f32_bf16 v209, v118, v73
v_dot2c_f32_bf16 v192, v176, v80
v_dot2c_f32_bf16 v193, v176, v81
v_dot2c_f32_bf16 v194, v177, v80
v_dot2c_f32_bf16 v195, v177, v81
v_dot2c_f32_bf16 v196, v178, v80
v_dot2c_f32_bf16 v197, v178, v81
v_dot2c_f32_bf16 v198, v179, v80
v_dot2c_f32_bf16 v199, v179, v81
v_dot2c_f32_bf16 v200, v180, v80
buffer_load_dwordx4 a[16:19], v14, s[24:27], s65 offen offset:0 sc1
v_dot2c_f32_bf16 v201, v180, v81
v_dot2c_f32_bf16 v202, v181, v80
v_dot2c_f32_bf16 v203, v181, v81
v_dot2c_f32_bf16 v204, v182, v80
v_dot2c_f32_bf16 v205, v182, v81
v_dot2c_f32_bf16 v206, v183, v80
v_dot2c_f32_bf16 v207, v183, v81
v_dot2c_f32_bf16 v208, v120, v81
v_dot2c_f32_bf16 v209, v122, v81
v_dot2c_f32_bf16 v192, v184, v88
v_dot2c_f32_bf16 v193, v184, v89
buffer_load_dwordx4 a[24:27], v14, s[24:27], s65 offen offset:2048 sc1
v_dot2c_f32_bf16 v194, v185, v88
v_dot2c_f32_bf16 v195, v185, v89
v_dot2c_f32_bf16 v196, v186, v88
v_dot2c_f32_bf16 v197, v186, v89
v_dot2c_f32_bf16 v198, v187, v88
v_dot2c_f32_bf16 v199, v187, v89
v_dot2c_f32_bf16 v200, v188, v88
v_dot2c_f32_bf16 v201, v188, v89
v_dot2c_f32_bf16 v202, v189, v88
v_dot2c_f32_bf16 v203, v189, v89
v_dot2c_f32_bf16 v204, v190, v88
buffer_load_dwordx4 a[20:23], v14, s[24:27], s93 offen offset:0 sc1
v_dot2c_f32_bf16 v205, v190, v89
v_dot2c_f32_bf16 v206, v191, v88
v_dot2c_f32_bf16 v207, v191, v89
v_dot2c_f32_bf16 v208, v124, v89
v_dot2c_f32_bf16 v209, v126, v89
v_lshrrev_b32 v9, 5, v5
v_mul_u32_u24 v9, 303104, v9
v_and_b32 v11, 1, v3
v_lshl_add_u32 v9, v11, 10, v9
v_lshl_add_u32 v9, v2, 4, v9
v_lshrrev_b32 v11, 3, v2
buffer_load_dwordx4 a[28:31], v14, s[24:27], s93 offen offset:2048 sc1
s_bitcmp0_b32 s4, 0
s_cselect_b32 s52, 100663168, 0
v_mul_lo_u32 v6, v11, s52
v_add_u32 v6, v6, v9
s_bitcmp1_b32 s4, 2
s_cselect_b32 s52, 100663168, 0
v_mul_lo_u32 v11, v11, s52
v_add_u32 v11, v11, v9
v_mul_f32 v192, v10, v192
v_mul_f32 v193, v10, v193
v_mul_f32 v194, v10, v194
v_mul_f32 v195, v10, v195
v_mul_f32 v196, v10, v196
buffer_load_dword v12, v13, s[24:27], s75 offen sc1
v_mul_f32 v197, v10, v197
v_mul_f32 v198, v10, v198
v_mul_f32 v199, v10, v199
v_mul_f32 v200, v10, v200
v_mul_f32 v201, v10, v201
v_mul_f32 v202, v10, v202
v_mul_f32 v203, v10, v203
v_mul_f32 v204, v10, v204
v_mul_f32 v205, v10, v205
v_mul_f32 v206, v10, v206
v_mul_f32 v207, v10, v207
v_mul_f32 v208, v10, v208
v_mul_f32 v209, v10, v209
v_cvt_pk_bf16_f32 v192, v192, v193
v_cvt_pk_bf16_f32 v193, v194, v195
v_cvt_pk_bf16_f32 v194, v196, v197
v_cvt_pk_bf16_f32 v195, v198, v199
v_cvt_pk_bf16_f32 v196, v200, v201
v_cvt_pk_bf16_f32 v197, v202, v203
v_cvt_pk_bf16_f32 v198, v204, v205
v_cvt_pk_bf16_f32 v199, v206, v207
v_cvt_pk_bf16_f32 v200, v208, v209
s_add_u32 s53, s53, 65536
s_bfe_u32 s54, s4, 131073
s_lshl_b32 s54, s54, 11
s_add_u32 s54, s54, s53
s_and_b32 s55, s4, 1
s_lshl_b32 s55, s55, 9
s_add_u32 s54, s54, s55
s_lshl2_add_u32 s52, s85, s86
s_lshl2_add_u32 s52, s52, s3
s_mul_i32 s69, s52, 28672
s_add_u32 s69, s69, 76546048
s_mul_i32 s73, s52, 640
s_add_u32 s73, s73, 75563008
ds_read_b128 v[144:147], v7 offset:0
ds_read_b128 v[148:151], v7 offset:1024
ds_read_b128 v[152:155], v7 offset:2048
ds_read_b128 v[156:159], v7 offset:3072
ds_read_b128 v[160:163], v7 offset:4096
ds_read_b128 v[164:167], v7 offset:5120
ds_read_b128 v[168:171], v7 offset:6144
ds_read_b128 v[172:175], v7 offset:7168
v_mov_b32 v10, 0
s_mov_b32 s92, 0
s_cmp_eq_u32 s78, s77
s_cbranch_scc1 L_ZBX
s_branch L_ZB1
L_ZB:
s_sleep 2
buffer_load_dword v12, v13, s[24:27], s75 offen sc1
L_ZB1:
s_add_u32 s92, s92, 1
s_waitcnt vmcnt(0)
v_cmp_gt_u32 vcc, 8, v12
s_cmp_gt_u32 s92, 1048576
s_cbranch_scc1 L_ZBY
s_nop 2
s_cbranch_vccnz L_ZB
L_ZBY:
s_xor_b32 s65, s82, 0
s_add_u32 s65, s65, s77
buffer_load_dwordx4 a[0:3], v15, s[24:27], s65 offen offset:0 sc1
buffer_load_dwordx4 a[8:11], v15, s[24:27], s65 offen offset:2048 sc1
s_xor_b32 s93, s82, 0
s_add_u32 s93, s93, s81
buffer_load_dwordx4 a[4:7], v15, s[24:27], s93 offen offset:0 sc1
buffer_load_dwordx4 a[12:15], v15, s[24:27], s93 offen offset:2048 sc1
buffer_load_dwordx4 a[16:19], v14, s[24:27], s65 offen offset:0 sc1
buffer_load_dwordx4 a[24:27], v14, s[24:27], s65 offen offset:2048 sc1
buffer_load_dwordx4 a[20:23], v14, s[24:27], s93 offen offset:0 sc1
buffer_load_dwordx4 a[28:31], v14, s[24:27], s93 offen offset:2048 sc1
L_ZBX:
buffer_store_dwordx4 v[192:195], v9, s[24:27], s54 offen sc1
buffer_store_dwordx4 v[196:199], v6, s[24:27], s54 offen offset:256 sc1
s_bfe_u32 s55, s4, 65538
s_lshl_b32 s55, s55, 8
s_add_u32 s54, s53, s55
s_and_b32 s55, s4, 3
s_lshl2_add_u32 s54, s55, s54
s_add_u32 s54, s54, 8192
buffer_store_dword v200, v11, s[24:27], s54 offen sc1
s_waitcnt vmcnt(9) lgkmcnt(6)
v_mfma_f32_16x16x32_bf16 v[120:123], v[144:147], a[0:3], 0
s_waitcnt vmcnt(7)
s_add_u32 s91, s91, 16384
ds_read_b128 v[176:179], v7 offset:8192
v_mfma_f32_16x16x32_bf16 v[120:123], v[148:151], a[8:11], v[120:123]
s_xor_b32 s65, s82, 8192
s_add_u32 s65, s65, s77
ds_read_b128 v[180:183], v7 offset:9216
v_mfma_f32_16x16x32_bf16 v[124:127], v[148:151], a[12:15], 0
s_waitcnt lgkmcnt(6)
ds_read_b128 v[184:187], v7 offset:10240
v_mfma_f32_16x16x32_bf16 v[124:127], v[144:147], a[4:7], v[124:127]
buffer_load_dwordx4 a[32:35], v15, s[24:27], s65 offen offset:0 sc1
v_mfma_f32_16x16x32_bf16 v[72:75], v[152:155], a[0:3], 0
s_cmp_ge_u32 s91, 163840
s_cselect_b32 s91, 0, s91
ds_read_b128 v[188:191], v7 offset:11264
v_mfma_f32_16x16x32_bf16 v[72:75], v[156:159], a[8:11], v[72:75]
s_waitcnt lgkmcnt(6)
v_add_u32 v8, s91, v4
v_mfma_f32_16x16x32_bf16 v[76:79], v[156:159], a[12:15], 0
buffer_load_dwordx4 a[40:43], v15, s[24:27], s65 offen offset:2048 sc1
v_mfma_f32_16x16x32_bf16 v[76:79], v[152:155], a[4:7], v[76:79]
s_xor_b32 s93, s82, 8192
s_add_u32 s93, s93, s81
ds_read_b128 v[144:147], v7 offset:12288
v_mfma_f32_16x16x32_bf16 v[80:83], v[160:163], a[0:3], 0
ds_read_b128 v[148:151], v7 offset:13312
v_mfma_f32_16x16x32_bf16 v[80:83], v[164:167], a[8:11], v[80:83]
buffer_load_dwordx4 a[36:39], v15, s[24:27], s93 offen offset:0 sc1
v_mfma_f32_16x16x32_bf16 v[84:87], v[164:167], a[12:15], 0
ds_read_b128 v[152:155], v7 offset:14336
v_mfma_f32_16x16x32_bf16 v[84:87], v[160:163], a[4:7], v[84:87]
s_waitcnt lgkmcnt(7)
v_mfma_f32_16x16x32_bf16 v[88:91], v[168:171], a[0:3], 0
buffer_load_dwordx4 a[44:47], v15, s[24:27], s93 offen offset:2048 sc1
v_mfma_f32_16x16x32_bf16 v[88:91], v[172:175], a[8:11], v[88:91]
ds_read_b128 v[156:159], v7 offset:15360
v_mfma_f32_16x16x32_bf16 v[92:95], v[172:175], a[12:15], 0
s_waitcnt lgkmcnt(6)
s_add_u32 s91, s91, 16384
ds_read_b128 v[160:163], v8 offset:0
v_mfma_f32_16x16x32_bf16 v[92:95], v[168:171], a[4:7], v[92:95]
buffer_load_dwordx4 a[48:51], v14, s[24:27], s65 offen offset:0 sc1
v_mfma_f32_16x16x32_bf16 v[96:99], v[176:179], a[0:3], 0
s_cmp_ge_u32 s91, 163840
s_cselect_b32 s91, 0, s91
ds_read_b128 v[164:167], v8 offset:1024
v_mfma_f32_16x16x32_bf16 v[96:99], v[180:183], a[8:11], v[96:99]
v_add_u32 v7, s91, v4
v_mfma_f32_16x16x32_bf16 v[100:103], v[180:183], a[12:15], 0
buffer_load_dwordx4 a[56:59], v14, s[24:27], s65 offen offset:2048 sc1
v_mfma_f32_16x16x32_bf16 v[100:103], v[176:179], a[4:7], v[100:103]
s_waitcnt lgkmcnt(6)
ds_read_b128 v[168:171], v8 offset:2048
v_mfma_f32_16x16x32_bf16 v[104:107], v[184:187], a[0:3], 0
ds_read_b128 v[172:175], v8 offset:3072
v_mfma_f32_16x16x32_bf16 v[104:107], v[188:191], a[8:11], v[104:107]
v_mfma_f32_16x16x32_bf16 v[108:111], v[188:191], a[12:15], 0
buffer_load_dwordx4 a[52:55], v14, s[24:27], s93 offen offset:0 sc1
v_mfma_f32_16x16x32_bf16 v[108:111], v[184:187], a[4:7], v[108:111]
s_waitcnt lgkmcnt(6)
ds_read_b128 v[176:179], v8 offset:4096
v_mfma_f32_16x16x32_bf16 v[112:115], v[144:147], a[0:3], 0
ds_read_b128 v[180:183], v8 offset:5120
v_mfma_f32_16x16x32_bf16 v[112:115], v[148:151], a[8:11], v[112:115]
v_mfma_f32_16x16x32_bf16 v[116:119], v[148:151], a[12:15], 0
buffer_load_dwordx4 a[60:63], v14, s[24:27], s93 offen offset:2048 sc1
v_mfma_f32_16x16x32_bf16 v[116:119], v[144:147], a[4:7], v[116:119]
s_waitcnt lgkmcnt(6) vmcnt(13)
ds_read_b128 v[184:187], v8 offset:6144
v_mfma_f32_16x16x32_bf16 v[120:123], v[152:155], a[16:19], v[120:123]
ds_read_b128 v[188:191], v8 offset:7168
v_mfma_f32_16x16x32_bf16 v[120:123], v[156:159], a[24:27], v[120:123]
s_waitcnt vmcnt(11)
v_mfma_f32_16x16x32_bf16 v[124:127], v[156:159], a[28:31], v[124:127]
ds_read_b128 v[144:147], v8 offset:8192
v_mfma_f32_16x16x32_bf16 v[124:127], v[152:155], a[20:23], v[124:127]
s_waitcnt lgkmcnt(7)
v_mfma_f32_16x16x32_bf16 v[72:75], v[160:163], a[16:19], v[72:75]
ds_read_b128 v[148:151], v8 offset:9216
v_mfma_f32_16x16x32_bf16 v[72:75], v[164:167], a[24:27], v[72:75]
v_mfma_f32_16x16x32_bf16 v[76:79], v[164:167], a[28:31], v[76:79]
ds_read_b128 v[152:155], v8 offset:10240
v_mfma_f32_16x16x32_bf16 v[76:79], v[160:163], a[20:23], v[76:79]
s_waitcnt lgkmcnt(7)
v_mfma_f32_16x16x32_bf16 v[80:83], v[168:171], a[16:19], v[80:83]
ds_read_b128 v[156:159], v8 offset:11264
v_mfma_f32_16x16x32_bf16 v[80:83], v[172:175], a[24:27], v[80:83]
v_mfma_f32_16x16x32_bf16 v[84:87], v[172:175], a[28:31], v[84:87]
ds_read_b128 v[160:163], v8 offset:12288
v_mfma_f32_16x16x32_bf16 v[84:87], v[168:171], a[20:23], v[84:87]
s_waitcnt lgkmcnt(7)
v_mfma_f32_16x16x32_bf16 v[88:91], v[176:179], a[16:19], v[88:91]
s_xor_b32 s65, s82, 16384
s_add_u32 s65, s65, s77
ds_read_b128 v[164:167], v8 offset:13312
v_mfma_f32_16x16x32_bf16 v[88:91], v[180:183], a[24:27], v[88:91]
v_mfma_f32_16x16x32_bf16 v[92:95], v[180:183], a[28:31], v[92:95]
s_waitcnt lgkmcnt(6)
ds_read_b128 v[168:171], v8 offset:14336
v_add_u32 v11, s70, v4
v_mfma_f32_16x16x32_bf16 v[92:95], v[176:179], a[20:23], v[92:95]
s_add_u32 s70, s70, 16384
s_cmp_ge_u32 s70, 163840
s_cselect_b32 s70, s80, s70
v_mfma_f32_16x16x32_bf16 v[96:99], v[184:187], a[16:19], v[96:99]
buffer_load_dwordx4 a[64:67], v15, s[24:27], s65 offen offset:0 sc1
v_mfma_f32_16x16x32_bf16 v[96:99], v[188:191], a[24:27], v[96:99]
s_barrier
v_mfma_f32_16x16x32_bf16 v[100:103], v[188:191], a[28:31], v[100:103]
s_waitcnt lgkmcnt(5)
ds_read_b128 v[172:175], v8 offset:15360
v_mfma_f32_16x16x32_bf16 v[100:103], v[184:187], a[20:23], v[100:103]
buffer_load_dwordx4 a[72:75], v15, s[24:27], s65 offen offset:2048 sc1
v_mfma_f32_16x16x32_bf16 v[104:107], v[144:147], a[16:19], v[104:107]
ds_write_b64 v11, a[96:97] offset:0
v_mfma_f32_16x16x32_bf16 v[104:107], v[148:151], a[24:27], v[104:107]
s_xor_b32 s93, s82, 16384
s_add_u32 s93, s93, s81
ds_read_b128 v[176:179], v7 offset:0
v_mfma_f32_16x16x32_bf16 v[108:111], v[148:151], a[28:31], v[108:111]
buffer_load_dwordx4 a[68:71], v15, s[24:27], s93 offen offset:0 sc1
v_mfma_f32_16x16x32_bf16 v[108:111], v[144:147], a[20:23], v[108:111]
s_waitcnt lgkmcnt(6)
s_add_u32 s91, s91, 16384
ds_read_b128 v[180:183], v7 offset:1024
v_mfma_f32_16x16x32_bf16 v[112:115], v[152:155], a[16:19], v[112:115]
ds_write_b64 v11, a[98:99] offset:8
v_mfma_f32_16x16x32_bf16 v[112:115], v[156:159], a[24:27], v[112:115]
s_cmp_ge_u32 s91, 163840
s_cselect_b32 s91, 0, s91
ds_read_b128 v[184:187], v7 offset:2048
v_mfma_f32_16x16x32_bf16 v[116:119], v[156:159], a[28:31], v[116:119]
buffer_load_dwordx4 a[76:79], v15, s[24:27], s93 offen offset:2048 sc1
v_mfma_f32_16x16x32_bf16 v[116:119], v[152:155], a[20:23], v[116:119]
s_waitcnt lgkmcnt(7) vmcnt(10)
ds_read_b128 v[188:191], v7 offset:3072
v_add_u32 v8, s91, v4
v_mfma_f32_16x16x32_bf16 v[120:123], v[160:163], a[32:35], v[120:123]
s_waitcnt vmcnt(12)
s_waitcnt vmcnt(8)
ds_read_b128 v[144:147], v7 offset:4096
v_mfma_f32_16x16x32_bf16 v[120:123], v[164:167], a[40:43], v[120:123]
buffer_atomic_add v1, v0, s[24:27], s74 offen offset:128 sc1
v_mfma_f32_16x16x32_bf16 v[124:127], v[164:167], a[44:47], v[124:127]
ds_write_b64 v11, a[100:101] offset:1024
v_mfma_f32_16x16x32_bf16 v[124:127], v[160:163], a[36:39], v[124:127]
s_waitcnt lgkmcnt(8)
ds_read_b128 v[148:151], v7 offset:5120
v_mfma_f32_16x16x32_bf16 v[72:75], v[168:171], a[32:35], v[72:75]
ds_read_b128 v[152:155], v7 offset:6144
v_mfma_f32_16x16x32_bf16 v[72:75], v[172:175], a[40:43], v[72:75]
s_waitcnt lgkmcnt(7)
ds_read_b128 v[156:159], v7 offset:7168
v_mfma_f32_16x16x32_bf16 v[76:79], v[172:175], a[44:47], v[76:79]
ds_write_b64 v11, a[102:103] offset:1032
v_mfma_f32_16x16x32_bf16 v[76:79], v[168:171], a[36:39], v[76:79]
buffer_load_dwordx4 a[80:83], v14, s[24:27], s65 offen offset:0 sc1
v_mfma_f32_16x16x32_bf16 v[80:83], v[176:179], a[32:35], v[80:83]
ds_read_b128 v[160:163], v7 offset:8192
v_mfma_f32_16x16x32_bf16 v[80:83], v[180:183], a[40:43], v[80:83]
s_waitcnt lgkmcnt(7)
ds_read_b128 v[164:167], v7 offset:9216
v_mfma_f32_16x16x32_bf16 v[84:87], v[180:183], a[44:47], v[84:87]
ds_write_b64 v11, a[104:105] offset:2048
v_mfma_f32_16x16x32_bf16 v[84:87], v[176:179], a[36:39], v[84:87]
buffer_load_dwordx4 a[88:91], v14, s[24:27], s65 offen offset:2048 sc1
v_mfma_f32_16x16x32_bf16 v[88:91], v[184:187], a[32:35], v[88:91]
ds_read_b128 v[168:171], v7 offset:10240
v_mfma_f32_16x16x32_bf16 v[88:91], v[188:191], a[40:43], v[88:91]
s_waitcnt lgkmcnt(7)
ds_read_b128 v[172:175], v7 offset:11264
v_mfma_f32_16x16x32_bf16 v[92:95], v[188:191], a[44:47], v[92:95]
ds_write_b64 v11, a[106:107] offset:2056
v_mfma_f32_16x16x32_bf16 v[92:95], v[184:187], a[36:39], v[92:95]
buffer_load_dwordx4 a[84:87], v14, s[24:27], s93 offen offset:0 sc1
v_mfma_f32_16x16x32_bf16 v[96:99], v[144:147], a[32:35], v[96:99]
ds_read_b128 v[176:179], v7 offset:12288
v_mfma_f32_16x16x32_bf16 v[96:99], v[148:151], a[40:43], v[96:99]
s_waitcnt lgkmcnt(8)
ds_read_b128 v[180:183], v7 offset:13312
v_mfma_f32_16x16x32_bf16 v[100:103], v[148:151], a[44:47], v[100:103]
ds_write_b64 v11, a[108:109] offset:3072
v_mfma_f32_16x16x32_bf16 v[100:103], v[144:147], a[36:39], v[100:103]
buffer_load_dwordx4 a[92:95], v14, s[24:27], s93 offen offset:2048 sc1
v_mfma_f32_16x16x32_bf16 v[104:107], v[152:155], a[32:35], v[104:107]
ds_read_b128 v[184:187], v7 offset:14336
v_mfma_f32_16x16x32_bf16 v[104:107], v[156:159], a[40:43], v[104:107]
ds_read_b128 v[188:191], v7 offset:15360
v_mfma_f32_16x16x32_bf16 v[108:111], v[156:159], a[44:47], v[108:111]
ds_write_b64 v11, a[110:111] offset:3080
v_mfma_f32_16x16x32_bf16 v[108:111], v[152:155], a[36:39], v[108:111]
s_waitcnt lgkmcnt(10)
s_add_u32 s91, s91, 16384
ds_read_b128 v[144:147], v8 offset:0
v_mfma_f32_16x16x32_bf16 v[112:115], v[160:163], a[32:35], v[112:115]
s_xor_b32 s65, s82, 24576
s_add_u32 s65, s65, s77
ds_read_b128 v[148:151], v8 offset:1024
v_mfma_f32_16x16x32_bf16 v[112:115], v[164:167], a[40:43], v[112:115]
s_cmp_ge_u32 s91, 163840
s_cselect_b32 s91, 0, s91
v_add_u32 v7, s91, v4
v_mfma_f32_16x16x32_bf16 v[116:119], v[164:167], a[44:47], v[116:119]
buffer_load_dwordx4 a[192:195], v15, s[24:27], s65 offen offset:0 sc1
v_mfma_f32_16x16x32_bf16 v[116:119], v[160:163], a[36:39], v[116:119]
s_waitcnt lgkmcnt(9) vmcnt(12)
ds_read_b128 v[152:155], v8 offset:2048
v_mfma_f32_16x16x32_bf16 v[120:123], v[168:171], a[48:51], v[120:123]
ds_read_b128 v[156:159], v8 offset:3072
v_mfma_f32_16x16x32_bf16 v[120:123], v[172:175], a[56:59], v[120:123]
s_waitcnt vmcnt(10)
v_mfma_f32_16x16x32_bf16 v[124:127], v[172:175], a[60:63], v[124:127]
buffer_load_dwordx4 a[200:203], v15, s[24:27], s65 offen offset:2048 sc1
v_mfma_f32_16x16x32_bf16 v[124:127], v[168:171], a[52:55], v[124:127]
s_waitcnt lgkmcnt(8)
ds_read_b128 v[160:163], v8 offset:4096
v_mfma_f32_16x16x32_bf16 v[72:75], v[176:179], a[48:51], v[72:75]
s_xor_b32 s93, s82, 24576
s_add_u32 s93, s93, s81
ds_read_b128 v[164:167], v8 offset:5120
v_mfma_f32_16x16x32_bf16 v[72:75], v[180:183], a[56:59], v[72:75]
v_mfma_f32_16x16x32_bf16 v[76:79], v[180:183], a[60:63], v[76:79]
buffer_load_dwordx4 a[196:199], v15, s[24:27], s93 offen offset:0 sc1
v_mfma_f32_16x16x32_bf16 v[76:79], v[176:179], a[52:55], v[76:79]
s_waitcnt lgkmcnt(7)
ds_read_b128 v[168:171], v8 offset:6144
v_mfma_f32_16x16x32_bf16 v[80:83], v[184:187], a[48:51], v[80:83]
ds_read_b128 v[172:175], v8 offset:7168
v_mfma_f32_16x16x32_bf16 v[80:83], v[188:191], a[56:59], v[80:83]
v_mfma_f32_16x16x32_bf16 v[84:87], v[188:191], a[60:63], v[84:87]
buffer_load_dwordx4 a[204:207], v15, s[24:27], s93 offen offset:2048 sc1
v_mfma_f32_16x16x32_bf16 v[84:87], v[184:187], a[52:55], v[84:87]
s_waitcnt lgkmcnt(6)
ds_read_b128 v[176:179], v8 offset:8192
v_mfma_f32_16x16x32_bf16 v[88:91], v[144:147], a[48:51], v[88:91]
ds_read_b128 v[180:183], v8 offset:9216
v_mfma_f32_16x16x32_bf16 v[88:91], v[148:151], a[56:59], v[88:91]
v_mfma_f32_16x16x32_bf16 v[92:95], v[148:151], a[60:63], v[92:95]
ds_read_b128 v[184:187], v8 offset:10240
v_mfma_f32_16x16x32_bf16 v[92:95], v[144:147], a[52:55], v[92:95]
s_waitcnt lgkmcnt(7)
v_mfma_f32_16x16x32_bf16 v[96:99], v[152:155], a[48:51], v[96:99]
s_add_u32 s52, s84, 1
ds_read_b128 v[188:191], v8 offset:11264
v_mfma_f32_16x16x32_bf16 v[96:99], v[156:159], a[56:59], v[96:99]
v_mfma_f32_16x16x32_bf16 v[100:103], v[156:159], a[60:63], v[100:103]
buffer_load_dwordx4 a[208:211], v14, s[24:27], s65 offen offset:0 sc1
v_mfma_f32_16x16x32_bf16 v[100:103], v[152:155], a[52:55], v[100:103]
s_and_b32 s52, s52, 3
s_waitcnt lgkmcnt(6)
ds_read_b128 v[144:147], v8 offset:12288
v_mfma_f32_16x16x32_bf16 v[104:107], v[160:163], a[48:51], v[104:107]
ds_read_b128 v[148:151], v8 offset:13312
v_mfma_f32_16x16x32_bf16 v[104:107], v[164:167], a[56:59], v[104:107]
s_waitcnt lgkmcnt(6)
v_mfma_f32_16x16x32_bf16 v[108:111], v[164:167], a[60:63], v[108:111]
s_mul_i32 s52, s52, 6144
ds_read_b128 v[152:155], v8 offset:14336
v_add_u32 v11, s70, v4
v_mfma_f32_16x16x32_bf16 v[108:111], v[160:163], a[52:55], v[108:111]
s_add_u32 s70, s70, 16384
s_cmp_ge_u32 s70, 163840
s_cselect_b32 s70, s80, s70
v_mfma_f32_16x16x32_bf16 v[112:115], v[168:171], a[48:51], v[112:115]
s_waitcnt vmcnt(51)
ds_read_b128 v[156:159], v8 offset:15360
v_mfma_f32_16x16x32_bf16 v[112:115], v[172:175], a[56:59], v[112:115]
s_barrier
v_mfma_f32_16x16x32_bf16 v[116:119], v[172:175], a[60:63], v[116:119]
s_add_u32 s52, s52, s69
s_waitcnt lgkmcnt(6) vmcnt(12)
ds_read_b128 v[160:163], v7 offset:0
v_mfma_f32_16x16x32_bf16 v[116:119], v[168:171], a[52:55], v[116:119]
buffer_load_dwordx4 a[216:219], v14, s[24:27], s65 offen offset:2048 sc1
v_mfma_f32_16x16x32_bf16 v[120:123], v[176:179], a[64:67], v[120:123]
ds_write_b64 v11, a[112:113] offset:0
v_mfma_f32_16x16x32_bf16 v[120:123], v[180:183], a[72:75], v[120:123]
s_add_u32 s52, s52, 0
s_waitcnt vmcnt(11)
ds_read_b128 v[164:167], v7 offset:1024
v_mfma_f32_16x16x32_bf16 v[124:127], v[180:183], a[76:79], v[124:127]
buffer_load_dwordx4 a[212:215], v14, s[24:27], s93 offen offset:0 sc1
v_mfma_f32_16x16x32_bf16 v[124:127], v[176:179], a[68:71], v[124:127]
s_waitcnt lgkmcnt(7)
s_add_u32 s91, s91, 16384
ds_read_b128 v[168:171], v7 offset:2048
v_mfma_f32_16x16x32_bf16 v[72:75], v[184:187], a[64:67], v[72:75]
s_add_u32 s53, s84, 2
ds_read_b128 v[172:175], v7 offset:3072
v_mfma_f32_16x16x32_bf16 v[72:75], v[188:191], a[72:75], v[72:75]
L_PAD11:
s_cbranch_execz L_MAIN
ds_write_b64 v11, a[114:115] offset:8
v_mfma_f32_16x16x32_bf16 v[76:79], v[188:191], a[76:79], v[76:79]
buffer_load_dwordx4 a[220:223], v14, s[24:27], s93 offen offset:2048 sc1
v_mfma_f32_16x16x32_bf16 v[76:79], v[184:187], a[68:71], v[76:79]
s_and_b32 s53, s53, 3
s_waitcnt lgkmcnt(8)
ds_read_b128 v[176:179], v7 offset:4096
v_mfma_f32_16x16x32_bf16 v[80:83], v[144:147], a[64:67], v[80:83]
s_xor_b32 s65, s82, 32768
s_add_u32 s65, s65, s77
ds_read_b128 v[180:183], v7 offset:5120
v_mfma_f32_16x16x32_bf16 v[80:83], v[148:151], a[72:75], v[80:83]
ds_write_b64 v11, a[116:117] offset:1024
v_mfma_f32_16x16x32_bf16 v[84:87], v[148:151], a[76:79], v[84:87]
s_mul_i32 s53, s53, 6144
s_waitcnt lgkmcnt(9)
ds_read_b128 v[184:187], v7 offset:6144
v_mfma_f32_16x16x32_bf16 v[84:87], v[144:147], a[68:71], v[84:87]
buffer_load_dwordx4 a[224:227], v15, s[24:27], s65 offen offset:0 sc1
v_mfma_f32_16x16x32_bf16 v[88:91], v[152:155], a[64:67], v[88:91]
s_cmp_ge_u32 s91, 163840
s_cselect_b32 s91, 0, s91
ds_read_b128 v[188:191], v7 offset:7168
v_mfma_f32_16x16x32_bf16 v[88:91], v[156:159], a[72:75], v[88:91]
s_add_u32 s53, s53, s69
s_waitcnt lgkmcnt(8)
v_add_u32 v8, s91, v4
v_mfma_f32_16x16x32_bf16 v[92:95], v[156:159], a[76:79], v[92:95]
ds_write_b64 v11, a[118:119] offset:1032
v_mfma_f32_16x16x32_bf16 v[92:95], v[152:155], a[68:71], v[92:95]
buffer_load_dwordx4 a[232:235], v15, s[24:27], s65 offen offset:2048 sc1
v_mfma_f32_16x16x32_bf16 v[96:99], v[160:163], a[64:67], v[96:99]
s_add_u32 s53, s53, 2048
s_xor_b32 s93, s82, 32768
s_add_u32 s93, s93, s81
v_mfma_f32_16x16x32_bf16 v[96:99], v[164:167], a[72:75], v[96:99]
ds_read_b128 v[144:147], v7 offset:8192
v_mfma_f32_16x16x32_bf16 v[100:103], v[164:167], a[76:79], v[100:103]
ds_write_b64 v11, a[120:121] offset:2048
v_mfma_f32_16x16x32_bf16 v[100:103], v[160:163], a[68:71], v[100:103]
s_add_u32 s54, s84, 3
s_waitcnt lgkmcnt(9) vmcnt(12)
ds_read_b128 v[148:151], v7 offset:9216
v_mfma_f32_16x16x32_bf16 v[120:123], v[168:171], a[80:83], v[120:123]
buffer_load_dwordx4 a[228:231], v15, s[24:27], s93 offen offset:0 sc1
v_mfma_f32_16x16x32_bf16 v[120:123], v[172:175], a[88:91], v[120:123]
s_waitcnt vmcnt(11)
ds_read_b128 v[152:155], v7 offset:10240
v_mfma_f32_16x16x32_bf16 v[124:127], v[172:175], a[92:95], v[124:127]
s_and_b32 s54, s54, 3
s_waitcnt lgkmcnt(8)
ds_read_b128 v[156:159], v7 offset:11264
v_mfma_f32_16x16x32_bf16 v[124:127], v[168:171], a[84:87], v[124:127]
ds_write_b64 v11, a[122:123] offset:2056
v_mfma_f32_16x16x32_bf16 v[72:75], v[176:179], a[80:83], v[72:75]
buffer_load_dwordx4 a[236:239], v15, s[24:27], s93 offen offset:2048 sc1
v_mfma_f32_16x16x32_bf16 v[72:75], v[180:183], a[88:91], v[72:75]
s_mul_i32 s54, s54, 6144
ds_read_b128 v[160:163], v7 offset:12288
v_mfma_f32_16x16x32_bf16 v[76:79], v[180:183], a[92:95], v[76:79]
s_waitcnt lgkmcnt(8)
ds_read_b128 v[164:167], v7 offset:13312
v_mfma_f32_16x16x32_bf16 v[76:79], v[176:179], a[84:87], v[76:79]
ds_write_b64 v11, a[124:125] offset:3072
v_mfma_f32_16x16x32_bf16 v[80:83], v[184:187], a[80:83], v[80:83]
s_add_u32 s54, s54, s69
ds_read_b128 v[168:171], v7 offset:14336
v_mfma_f32_16x16x32_bf16 v[80:83], v[188:191], a[88:91], v[80:83]
ds_read_b128 v[172:175], v7 offset:15360
v_mfma_f32_16x16x32_bf16 v[84:87], v[188:191], a[92:95], v[84:87]
buffer_load_dwordx4 a[240:243], v14, s[24:27], s65 offen offset:0 sc1
v_mfma_f32_16x16x32_bf16 v[84:87], v[184:187], a[84:87], v[84:87]
s_add_u32 s54, s54, 4096
s_waitcnt lgkmcnt(8)
ds_read_b128 v[176:179], v8 offset:0
v_mfma_f32_16x16x32_bf16 v[88:91], v[144:147], a[80:83], v[88:91]
ds_write_b64 v11, a[126:127] offset:3080
v_mfma_f32_16x16x32_bf16 v[88:91], v[148:151], a[88:91], v[88:91]
s_add_u32 s91, s91, 16384
ds_read_b128 v[180:183], v8 offset:1024
v_add_u32 v11, s70, v4
v_mfma_f32_16x16x32_bf16 v[92:95], v[148:151], a[92:95], v[92:95]
s_sub_u32 s55, s3, s84
s_add_u32 s70, s70, 16384
ds_read_b128 v[184:187], v8 offset:2048
v_mfma_f32_16x16x32_bf16 v[92:95], v[144:147], a[84:87], v[92:95]
s_cmp_ge_u32 s70, 163840
s_cselect_b32 s70, s80, s70
s_waitcnt lgkmcnt(10)
v_mfma_f32_16x16x32_bf16 v[96:99], v[152:155], a[80:83], v[96:99]
buffer_load_dwordx4 a[248:251], v14, s[24:27], s65 offen offset:2048 sc1
v_mfma_f32_16x16x32_bf16 v[96:99], v[156:159], a[88:91], v[96:99]
s_and_b32 s55, s55, 3
s_waitcnt lgkmcnt(7) vmcnt(12)
ds_read_b128 v[188:191], v8 offset:3072
v_mfma_f32_16x16x32_bf16 v[100:103], v[156:159], a[92:95], v[100:103]
ds_write_b64 v11, a[160:161] offset:0
v_mfma_f32_16x16x32_bf16 v[100:103], v[152:155], a[84:87], v[100:103]
buffer_load_dwordx4 a[244:247], v14, s[24:27], s93 offen offset:0 sc1
v_mfma_f32_16x16x32_bf16 v[120:123], v[160:163], a[192:195], v[120:123]
s_lshl_b32 s55, s55, 10
ds_read_b128 v[144:147], v8 offset:4096
v_mfma_f32_16x16x32_bf16 v[120:123], v[164:167], a[200:203], v[120:123]
s_waitcnt vmcnt(11)
ds_read_b128 v[148:151], v8 offset:5120
v_mfma_f32_16x16x32_bf16 v[124:127], v[164:167], a[204:207], v[124:127]
ds_write_b64 v11, a[162:163] offset:8
v_mfma_f32_16x16x32_bf16 v[124:127], v[160:163], a[196:199], v[124:127]
s_add_u32 s55, s55, s69
s_waitcnt lgkmcnt(9)
ds_read_b128 v[152:155], v8 offset:6144
v_mfma_f32_16x16x32_bf16 v[72:75], v[168:171], a[192:195], v[72:75]
buffer_load_dwordx4 a[252:255], v14, s[24:27], s93 offen offset:2048 sc1
v_mfma_f32_16x16x32_bf16 v[72:75], v[172:175], a[200:203], v[72:75]
s_cmp_ge_u32 s91, 163840
s_cselect_b32 s91, 0, s91
ds_read_b128 v[156:159], v8 offset:7168
v_mfma_f32_16x16x32_bf16 v[76:79], v[172:175], a[204:207], v[76:79]
s_add_u32 s55, s55, 23552
s_waitcnt lgkmcnt(8)
ds_read_b128 v[160:163], v8 offset:8192
v_mfma_f32_16x16x32_bf16 v[76:79], v[168:171], a[196:199], v[76:79]
ds_write_b64 v11, a[164:165] offset:1024
v_mfma_f32_16x16x32_bf16 v[80:83], v[176:179], a[192:195], v[80:83]
s_xor_b32 s65, s82, 40960
s_add_u32 s65, s65, s77
ds_read_b128 v[164:167], v8 offset:9216
v_mfma_f32_16x16x32_bf16 v[80:83], v[180:183], a[200:203], v[80:83]
s_add_u32 s71, s69, 24576
s_waitcnt lgkmcnt(9)
v_add_u32 v7, s91, v4
v_mfma_f32_16x16x32_bf16 v[84:87], v[180:183], a[204:207], v[84:87]
buffer_load_dwordx4 a[96:99], v15, s[24:27], s65 offen offset:0 sc1
v_mfma_f32_16x16x32_bf16 v[84:87], v[176:179], a[196:199], v[84:87]
ds_write_b64 v11, a[166:167] offset:1032
v_mfma_f32_16x16x32_bf16 v[88:91], v[184:187], a[192:195], v[88:91]
s_cmp_eq_u32 s3, s84
s_cselect_b32 s55, 2147418112, s55
s_cselect_b32 s71, s71, 2147418112
v_mfma_f32_16x16x32_bf16 v[88:91], v[188:191], a[200:203], v[88:91]
ds_read_b128 v[168:171], v8 offset:10240
v_mfma_f32_16x16x32_bf16 v[92:95], v[188:191], a[204:207], v[92:95]
buffer_load_dwordx4 a[104:107], v15, s[24:27], s65 offen offset:2048 sc1
v_mfma_f32_16x16x32_bf16 v[92:95], v[184:187], a[196:199], v[92:95]
s_mul_i32 s83, s84, 6144
s_waitcnt lgkmcnt(8)
ds_read_b128 v[172:175], v8 offset:11264
v_mfma_f32_16x16x32_bf16 v[96:99], v[144:147], a[192:195], v[96:99]
ds_write_b64 v11, a[168:169] offset:2048
v_mfma_f32_16x16x32_bf16 v[96:99], v[148:151], a[200:203], v[96:99]
s_xor_b32 s93, s82, 40960
s_add_u32 s93, s93, s81
ds_read_b128 v[176:179], v8 offset:12288
v_mfma_f32_16x16x32_bf16 v[100:103], v[148:151], a[204:207], v[100:103]
s_add_u32 s69, s69, s83
s_waitcnt lgkmcnt(8) vmcnt(12)
ds_read_b128 v[180:183], v8 offset:13312
v_mfma_f32_16x16x32_bf16 v[100:103], v[144:147], a[196:199], v[100:103]
buffer_load_dwordx4 a[100:103], v15, s[24:27], s93 offen offset:0 sc1
v_mfma_f32_16x16x32_bf16 v[120:123], v[152:155], a[208:211], v[120:123]
s_waitcnt vmcnt(57)
s_waitcnt vmcnt(11)
ds_read_b128 v[184:187], v8 offset:14336
v_mfma_f32_16x16x32_bf16 v[120:123], v[156:159], a[216:219], v[120:123]
s_barrier
v_mfma_f32_16x16x32_bf16 v[124:127], v[156:159], a[220:223], v[124:127]
s_add_u32 s83, s69, 4096
s_waitcnt lgkmcnt(7)
ds_read_b128 v[188:191], v8 offset:15360
v_mfma_f32_16x16x32_bf16 v[124:127], v[152:155], a[212:215], v[124:127]
ds_write_b64 v11, a[170:171] offset:2056
v_mfma_f32_16x16x32_bf16 v[72:75], v[160:163], a[208:211], v[72:75]
buffer_load_dwordx4 a[108:111], v15, s[24:27], s93 offen offset:2048 sc1
v_mfma_f32_16x16x32_bf16 v[72:75], v[164:167], a[216:219], v[72:75]
s_add_u32 s91, s91, 16384
ds_read_b128 v[144:147], v7 offset:0
v_mfma_f32_16x16x32_bf16 v[76:79], v[164:167], a[220:223], v[76:79]
s_waitcnt lgkmcnt(7)
ds_read_b128 v[148:151], v7 offset:1024
v_mfma_f32_16x16x32_bf16 v[76:79], v[160:163], a[212:215], v[76:79]
ds_write_b64 v11, a[172:173] offset:3072
v_mfma_f32_16x16x32_bf16 v[80:83], v[168:171], a[208:211], v[80:83]
s_cmp_ge_u32 s91, 163840
s_cselect_b32 s91, 0, s91
ds_read_b128 v[152:155], v7 offset:2048
v_mfma_f32_16x16x32_bf16 v[80:83], v[172:175], a[216:219], v[80:83]
s_waitcnt lgkmcnt(7)
ds_read_b128 v[156:159], v7 offset:3072
v_add_u32 v8, s91, v4
v_mfma_f32_16x16x32_bf16 v[84:87], v[172:175], a[220:223], v[84:87]
buffer_load_dwordx4 a[112:115], v14, s[24:27], s65 offen offset:0 sc1
v_mfma_f32_16x16x32_bf16 v[84:87], v[168:171], a[212:215], v[84:87]
ds_write_b64 v11, a[174:175] offset:3080
v_mfma_f32_16x16x32_bf16 v[88:91], v[176:179], a[208:211], v[88:91]
s_add_u32 s68, s68, 49152
ds_read_b128 v[160:163], v7 offset:4096
v_mfma_f32_16x16x32_bf16 v[88:91], v[180:183], a[216:219], v[88:91]
ds_read_b128 v[164:167], v7 offset:5120
v_mfma_f32_16x16x32_bf16 v[92:95], v[180:183], a[220:223], v[92:95]
buffer_load_dwordx4 a[120:123], v14, s[24:27], s65 offen offset:2048 sc1
v_mfma_f32_16x16x32_bf16 v[92:95], v[176:179], a[212:215], v[92:95]
s_waitcnt lgkmcnt(9)
ds_read_b128 v[168:171], v7 offset:6144
v_mfma_f32_16x16x32_bf16 v[96:99], v[184:187], a[208:211], v[96:99]
ds_read_b128 v[172:175], v7 offset:7168
v_mfma_f32_16x16x32_bf16 v[96:99], v[188:191], a[216:219], v[96:99]
v_mfma_f32_16x16x32_bf16 v[100:103], v[188:191], a[220:223], v[100:103]
buffer_load_dwordx4 a[116:119], v14, s[24:27], s93 offen offset:0 sc1
v_mfma_f32_16x16x32_bf16 v[100:103], v[184:187], a[212:215], v[100:103]
s_waitcnt lgkmcnt(8) vmcnt(13)
ds_read_b128 v[176:179], v7 offset:8192
v_mfma_f32_16x16x32_bf16 v[120:123], v[144:147], a[224:227], v[120:123]
ds_read_b128 v[180:183], v7 offset:9216
v_mfma_f32_16x16x32_bf16 v[120:123], v[148:151], a[232:235], v[120:123]
s_waitcnt vmcnt(11)
v_mfma_f32_16x16x32_bf16 v[124:127], v[148:151], a[236:239], v[124:127]
buffer_load_dwordx4 a[124:127], v14, s[24:27], s93 offen offset:2048 sc1
v_mfma_f32_16x16x32_bf16 v[124:127], v[144:147], a[228:231], v[124:127]
s_waitcnt lgkmcnt(7)
ds_read_b128 v[184:187], v7 offset:10240
v_mfma_f32_16x16x32_bf16 v[72:75], v[152:155], a[224:227], v[72:75]
ds_read_b128 v[188:191], v7 offset:11264
v_mfma_f32_16x16x32_bf16 v[72:75], v[156:159], a[232:235], v[72:75]
v_mfma_f32_16x16x32_bf16 v[76:79], v[156:159], a[236:239], v[76:79]
ds_read_b128 v[144:147], v7 offset:12288
v_mfma_f32_16x16x32_bf16 v[76:79], v[152:155], a[228:231], v[76:79]
s_waitcnt lgkmcnt(7)
v_mfma_f32_16x16x32_bf16 v[80:83], v[160:163], a[224:227], v[80:83]
s_xor_b32 s65, s82, 49152
s_add_u32 s65, s65, s77
ds_read_b128 v[148:151], v7 offset:13312
v_mfma_f32_16x16x32_bf16 v[80:83], v[164:167], a[232:235], v[80:83]
v_mov_b32 v13, 0xffff0000
v_mul_u32_u24 v5, 1152, v2
v_mfma_f32_16x16x32_bf16 v[84:87], v[164:167], a[236:239], v[84:87]
buffer_load_dwordx4 a[128:131], v15, s[24:27], s65 offen offset:0 sc1
v_mfma_f32_16x16x32_bf16 v[84:87], v[160:163], a[228:231], v[84:87]
s_waitcnt lgkmcnt(6)
ds_read_b128 v[152:155], v7 offset:14336
v_lshl_add_u32 v6, v3, 3, v5
v_mfma_f32_16x16x32_bf16 v[88:91], v[168:171], a[224:227], v[88:91]
ds_read_b128 v[156:159], v7 offset:15360
v_and_b32 v9, 1, v3
v_mfma_f32_16x16x32_bf16 v[88:91], v[172:175], a[232:235], v[88:91]
s_add_u32 s91, s91, 16384
s_cmp_ge_u32 s91, 163840
s_cselect_b32 s91, 0, s91
v_mfma_f32_16x16x32_bf16 v[92:95], v[172:175], a[236:239], v[92:95]
buffer_load_dwordx4 a[136:139], v15, s[24:27], s65 offen offset:2048 sc1
v_mfma_f32_16x16x32_bf16 v[92:95], v[168:171], a[228:231], v[92:95]
s_waitcnt lgkmcnt(6)
ds_read_b128 v[160:163], v8 offset:0
v_add_u32 v7, s91, v4
v_mfma_f32_16x16x32_bf16 v[96:99], v[176:179], a[224:227], v[96:99]
s_xor_b32 s93, s82, 49152
s_add_u32 s93, s93, s81
ds_read_b128 v[164:167], v8 offset:1024
v_mfma_f32_16x16x32_bf16 v[96:99], v[180:183], a[232:235], v[96:99]
v_lshl_add_u32 v5, v9, 5, v5
v_lshrrev_b32 v9, 1, v3
v_mfma_f32_16x16x32_bf16 v[100:103], v[180:183], a[236:239], v[100:103]
buffer_load_dwordx4 a[132:135], v15, s[24:27], s93 offen offset:0 sc1
v_mfma_f32_16x16x32_bf16 v[100:103], v[176:179], a[228:231], v[100:103]
s_waitcnt lgkmcnt(6) vmcnt(13)
ds_read_b128 v[168:171], v8 offset:2048
v_lshl_add_u32 v5, v9, 4, v5
v_mfma_f32_16x16x32_bf16 v[120:123], v[184:187], a[240:243], v[120:123]
ds_read_b128 v[172:175], v8 offset:3072
v_mfma_f32_16x16x32_bf16 v[120:123], v[188:191], a[248:251], v[120:123]
s_waitcnt vmcnt(11)
v_mfma_f32_16x16x32_bf16 v[124:127], v[188:191], a[252:255], v[124:127]
buffer_load_dwordx4 a[140:143], v15, s[24:27], s93 offen offset:2048 sc1
v_mfma_f32_16x16x32_bf16 v[124:127], v[184:187], a[244:247], v[124:127]
s_waitcnt lgkmcnt(6)
ds_read_b128 v[176:179], v8 offset:4096
v_mfma_f32_16x16x32_bf16 v[72:75], v[144:147], a[240:243], v[72:75]
ds_read_b128 v[180:183], v8 offset:5120
v_mfma_f32_16x16x32_bf16 v[72:75], v[148:151], a[248:251], v[72:75]
v_mfma_f32_16x16x32_bf16 v[76:79], v[148:151], a[252:255], v[76:79]
ds_read_b128 v[184:187], v8 offset:6144
v_mfma_f32_16x16x32_bf16 v[76:79], v[144:147], a[244:247], v[76:79]
s_waitcnt lgkmcnt(7)
v_mfma_f32_16x16x32_bf16 v[80:83], v[152:155], a[240:243], v[80:83]
ds_read_b128 v[188:191], v8 offset:7168
v_mfma_f32_16x16x32_bf16 v[80:83], v[156:159], a[248:251], v[80:83]
s_waitcnt lgkmcnt(6)
v_mfma_f32_16x16x32_bf16 v[84:87], v[156:159], a[252:255], v[84:87]
buffer_load_dword v12, v10, s[24:27], s75 offen offset:128 sc1
v_mfma_f32_16x16x32_bf16 v[84:87], v[152:155], a[244:247], v[84:87]
buffer_load_dwordx4 a[144:147], v14, s[24:27], s65 offen offset:0 sc1
v_mfma_f32_16x16x32_bf16 v[88:91], v[160:163], a[240:243], v[88:91]
ds_read_b128 v[144:147], v8 offset:8192
v_mfma_f32_16x16x32_bf16 v[88:91], v[164:167], a[248:251], v[88:91]
ds_read_b128 v[148:151], v8 offset:9216
v_mfma_f32_16x16x32_bf16 v[92:95], v[164:167], a[252:255], v[92:95]
buffer_load_dwordx4 a[152:155], v14, s[24:27], s65 offen offset:2048 sc1
v_mfma_f32_16x16x32_bf16 v[92:95], v[160:163], a[244:247], v[92:95]
s_waitcnt lgkmcnt(6)
ds_read_b128 v[152:155], v8 offset:10240
v_mfma_f32_16x16x32_bf16 v[96:99], v[168:171], a[240:243], v[96:99]
ds_read_b128 v[156:159], v8 offset:11264
v_mfma_f32_16x16x32_bf16 v[96:99], v[172:175], a[248:251], v[96:99]
v_mfma_f32_16x16x32_bf16 v[100:103], v[172:175], a[252:255], v[100:103]
buffer_load_dwordx4 a[148:151], v14, s[24:27], s93 offen offset:0 sc1
v_mfma_f32_16x16x32_bf16 v[100:103], v[168:171], a[244:247], v[100:103]
s_waitcnt lgkmcnt(6) vmcnt(14)
ds_read_b128 v[160:163], v8 offset:12288
v_mfma_f32_16x16x32_bf16 v[120:123], v[176:179], a[96:99], v[120:123]
ds_read_b128 v[164:167], v8 offset:13312
v_mfma_f32_16x16x32_bf16 v[120:123], v[180:183], a[104:107], v[120:123]
s_waitcnt vmcnt(12)
v_mfma_f32_16x16x32_bf16 v[124:127], v[180:183], a[108:111], v[124:127]
buffer_load_dwordx4 a[156:159], v14, s[24:27], s93 offen offset:2048 sc1
v_mfma_f32_16x16x32_bf16 v[124:127], v[176:179], a[100:103], v[124:127]
s_waitcnt lgkmcnt(6)
ds_read_b128 v[168:171], v8 offset:14336
v_mfma_f32_16x16x32_bf16 v[72:75], v[184:187], a[96:99], v[72:75]
s_waitcnt vmcnt(62)
ds_read_b128 v[172:175], v8 offset:15360
v_mfma_f32_16x16x32_bf16 v[72:75], v[188:191], a[104:107], v[72:75]
s_barrier
v_mfma_f32_16x16x32_bf16 v[76:79], v[188:191], a[108:111], v[76:79]
s_add_u32 s91, s91, 16384
ds_read_b128 v[176:179], v7 offset:0
v_mfma_f32_16x16x32_bf16 v[76:79], v[184:187], a[100:103], v[76:79]
s_waitcnt lgkmcnt(7)
s_cmp_ge_u32 s91, 163840
s_cselect_b32 s91, 0, s91
v_mfma_f32_16x16x32_bf16 v[80:83], v[144:147], a[96:99], v[80:83]
s_xor_b32 s65, s82, 57344
s_add_u32 s65, s65, s77
ds_read_b128 v[180:183], v7 offset:1024
v_mfma_f32_16x16x32_bf16 v[80:83], v[148:151], a[104:107], v[80:83]
v_add_u32 v8, s91, v4
v_mfma_f32_16x16x32_bf16 v[84:87], v[148:151], a[108:111], v[84:87]
buffer_load_dwordx4 a[160:163], v15, s[24:27], s65 offen offset:0 sc1
v_mfma_f32_16x16x32_bf16 v[84:87], v[144:147], a[100:103], v[84:87]
s_waitcnt lgkmcnt(6)
ds_read_b128 v[184:187], v7 offset:2048
v_mfma_f32_16x16x32_bf16 v[88:91], v[152:155], a[96:99], v[88:91]
ds_read_b128 v[188:191], v7 offset:3072
v_mfma_f32_16x16x32_bf16 v[88:91], v[156:159], a[104:107], v[88:91]
v_mfma_f32_16x16x32_bf16 v[92:95], v[156:159], a[108:111], v[92:95]
buffer_load_dwordx4 a[168:171], v15, s[24:27], s65 offen offset:2048 sc1
v_mfma_f32_16x16x32_bf16 v[92:95], v[152:155], a[100:103], v[92:95]
s_waitcnt lgkmcnt(6)
ds_read_b128 v[144:147], v7 offset:4096
v_mfma_f32_16x16x32_bf16 v[96:99], v[160:163], a[96:99], v[96:99]
s_xor_b32 s93, s82, 57344
s_add_u32 s93, s93, s81
ds_read_b128 v[148:151], v7 offset:5120
v_mfma_f32_16x16x32_bf16 v[96:99], v[164:167], a[104:107], v[96:99]
v_mfma_f32_16x16x32_bf16 v[100:103], v[164:167], a[108:111], v[100:103]
buffer_load_dwordx4 a[164:167], v15, s[24:27], s93 offen offset:0 sc1
v_mfma_f32_16x16x32_bf16 v[100:103], v[160:163], a[100:103], v[100:103]
s_waitcnt lgkmcnt(6) vmcnt(14)
ds_read_b128 v[152:155], v7 offset:6144
v_mfma_f32_16x16x32_bf16 v[120:123], v[168:171], a[112:115], v[120:123]
ds_read_b128 v[156:159], v7 offset:7168
v_mfma_f32_16x16x32_bf16 v[120:123], v[172:175], a[120:123], v[120:123]
s_waitcnt vmcnt(12)
v_mfma_f32_16x16x32_bf16 v[124:127], v[172:175], a[124:127], v[124:127]
buffer_load_dwordx4 a[172:175], v15, s[24:27], s93 offen offset:2048 sc1
v_mfma_f32_16x16x32_bf16 v[124:127], v[168:171], a[116:119], v[124:127]
s_waitcnt lgkmcnt(6)
ds_read_b128 v[160:163], v7 offset:8192
v_mfma_f32_16x16x32_bf16 v[72:75], v[176:179], a[112:115], v[72:75]
ds_read_b128 v[164:167], v7 offset:9216
v_mfma_f32_16x16x32_bf16 v[72:75], v[180:183], a[120:123], v[72:75]
v_mfma_f32_16x16x32_bf16 v[76:79], v[180:183], a[124:127], v[76:79]
ds_read_b128 v[168:171], v7 offset:10240
v_mfma_f32_16x16x32_bf16 v[76:79], v[176:179], a[116:119], v[76:79]
s_waitcnt lgkmcnt(7)
v_mfma_f32_16x16x32_bf16 v[80:83], v[184:187], a[112:115], v[80:83]
ds_read_b128 v[172:175], v7 offset:11264
v_mfma_f32_16x16x32_bf16 v[80:83], v[188:191], a[120:123], v[80:83]
v_mfma_f32_16x16x32_bf16 v[84:87], v[188:191], a[124:127], v[84:87]
buffer_load_dwordx4 a[176:179], v14, s[24:27], s65 offen offset:0 sc1
v_mfma_f32_16x16x32_bf16 v[84:87], v[184:187], a[116:119], v[84:87]
s_waitcnt lgkmcnt(6)
ds_read_b128 v[176:179], v7 offset:12288
v_mfma_f32_16x16x32_bf16 v[88:91], v[144:147], a[112:115], v[88:91]
ds_read_b128 v[180:183], v7 offset:13312
v_mfma_f32_16x16x32_bf16 v[88:91], v[148:151], a[120:123], v[88:91]
v_mfma_f32_16x16x32_bf16 v[92:95], v[148:151], a[124:127], v[92:95]
buffer_load_dwordx4 a[184:187], v14, s[24:27], s65 offen offset:2048 sc1
v_mfma_f32_16x16x32_bf16 v[92:95], v[144:147], a[116:119], v[92:95]
s_waitcnt lgkmcnt(6)
ds_read_b128 v[184:187], v7 offset:14336
v_mfma_f32_16x16x32_bf16 v[96:99], v[152:155], a[112:115], v[96:99]
s_waitcnt vmcnt(10)
ds_read_b128 v[188:191], v7 offset:15360
v_mfma_f32_16x16x32_bf16 v[96:99], v[156:159], a[120:123], v[96:99]
s_add_u32 s91, s91, 16384
v_cmp_gt_u32 vcc, 8, v12
v_mfma_f32_16x16x32_bf16 v[100:103], v[156:159], a[124:127], v[100:103]
buffer_load_dwordx4 a[180:183], v14, s[24:27], s93 offen offset:0 sc1
v_mfma_f32_16x16x32_bf16 v[100:103], v[152:155], a[116:119], v[100:103]
s_waitcnt lgkmcnt(6) vmcnt(14)
ds_read_b128 v[144:147], v8 offset:0
v_mfma_f32_16x16x32_bf16 v[120:123], v[160:163], a[128:131], v[120:123]
s_cmp_ge_u32 s91, 163840
s_cselect_b32 s91, 0, s91
ds_read_b128 v[148:151], v8 offset:1024
v_mfma_f32_16x16x32_bf16 v[120:123], v[164:167], a[136:139], v[120:123]
s_waitcnt lgkmcnt(6) vmcnt(12)
v_add_u32 v7, s91, v4
v_mfma_f32_16x16x32_bf16 v[124:127], v[164:167], a[140:143], v[124:127]
s_cbranch_vccnz CK_ZAA
CK_ZAA_R:
v_mfma_f32_16x16x32_bf16 v[124:127], v[160:163], a[132:135], v[124:127]
buffer_load_dwordx4 a[188:191], v14, s[24:27], s93 offen offset:2048 sc1
v_mfma_f32_16x16x32_bf16 v[72:75], v[168:171], a[128:131], v[72:75]
ds_read_b128 v[152:155], v8 offset:2048
v_mfma_f32_16x16x32_bf16 v[72:75], v[172:175], a[136:139], v[72:75]
ds_read_b128 v[156:159], v8 offset:3072
v_mfma_f32_16x16x32_bf16 v[76:79], v[172:175], a[140:143], v[76:79]
ds_read_b128 v[160:163], v8 offset:4096
v_mfma_f32_16x16x32_bf16 v[76:79], v[168:171], a[132:135], v[76:79]
s_waitcnt lgkmcnt(7)
v_mfma_f32_16x16x32_bf16 v[80:83], v[176:179], a[128:131], v[80:83]
s_add_u32 s65, s77, 65536
ds_read_b128 v[164:167], v8 offset:5120
v_mfma_f32_16x16x32_bf16 v[80:83], v[180:183], a[136:139], v[80:83]
v_mfma_f32_16x16x32_bf16 v[84:87], v[180:183], a[140:143], v[84:87]
buffer_load_dwordx4 v[32:35], v15, s[24:27], s65 offen offset:0 sc1
v_mfma_f32_16x16x32_bf16 v[84:87], v[176:179], a[132:135], v[84:87]
s_waitcnt lgkmcnt(6)
ds_read_b128 v[168:171], v8 offset:6144
v_mfma_f32_16x16x32_bf16 v[88:91], v[184:187], a[128:131], v[88:91]
ds_read_b128 v[172:175], v8 offset:7168
v_mfma_f32_16x16x32_bf16 v[88:91], v[188:191], a[136:139], v[88:91]
v_mfma_f32_16x16x32_bf16 v[92:95], v[188:191], a[140:143], v[92:95]
buffer_load_dwordx4 v[40:43], v15, s[24:27], s65 offen offset:2048 sc1
v_mfma_f32_16x16x32_bf16 v[92:95], v[184:187], a[132:135], v[92:95]
s_waitcnt lgkmcnt(6)
ds_read_b128 v[176:179], v8 offset:8192
v_mfma_f32_16x16x32_bf16 v[96:99], v[144:147], a[128:131], v[96:99]
s_add_u32 s93, s81, 65536
ds_read_b128 v[180:183], v8 offset:9216
v_mfma_f32_16x16x32_bf16 v[96:99], v[148:151], a[136:139], v[96:99]
s_waitcnt lgkmcnt(6) vmcnt(12)
v_mfma_f32_16x16x32_bf16 v[100:103], v[148:151], a[140:143], v[100:103]
buffer_load_dwordx4 v[36:39], v15, s[24:27], s93 offen offset:0 sc1
v_mfma_f32_16x16x32_bf16 v[100:103], v[144:147], a[132:135], v[100:103]
s_mov_b32 m0, s70
s_mov_b32 s64, s68
s_add_u32 s68, s68, 16384
v_mfma_f32_16x16x32_bf16 v[120:123], v[152:155], a[144:147], v[120:123]
s_waitcnt vmcnt(11)
ds_read_b128 v[184:187], v8 offset:10240
v_mfma_f32_16x16x32_bf16 v[120:123], v[156:159], a[152:155], v[120:123]
s_add_u32 s70, s70, 16384
s_cmp_ge_u32 s70, 163840
s_cselect_b32 s70, s80, s70
v_mfma_f32_16x16x32_bf16 v[124:127], v[156:159], a[156:159], v[124:127]
buffer_load_dwordx4 v15, s[24:27], s64 offen offset:0 sc1 lds
v_mfma_f32_16x16x32_bf16 v[124:127], v[152:155], a[148:151], v[124:127]
s_waitcnt lgkmcnt(5)
ds_read_b128 v[188:191], v8 offset:11264
v_mfma_f32_16x16x32_bf16 v[72:75], v[160:163], a[144:147], v[72:75]
ds_read_b128 v[144:147], v8 offset:12288
v_mfma_f32_16x16x32_bf16 v[72:75], v[164:167], a[152:155], v[72:75]
buffer_load_dwordx4 v15, s[24:27], s64 offen offset:1024 sc1 lds
v_mfma_f32_16x16x32_bf16 v[76:79], v[164:167], a[156:159], v[76:79]
ds_read_b128 v[148:151], v8 offset:13312
v_mfma_f32_16x16x32_bf16 v[76:79], v[160:163], a[148:151], v[76:79]
s_waitcnt lgkmcnt(6)
ds_read_b128 v[152:155], v8 offset:14336
v_mfma_f32_16x16x32_bf16 v[80:83], v[168:171], a[144:147], v[80:83]
buffer_load_dwordx4 v[44:47], v15, s[24:27], s93 offen offset:2048 sc1
v_mfma_f32_16x16x32_bf16 v[80:83], v[172:175], a[152:155], v[80:83]
s_barrier
v_mfma_f32_16x16x32_bf16 v[84:87], v[172:175], a[156:159], v[84:87]
s_waitcnt lgkmcnt(5)
ds_read_b128 v[156:159], v8 offset:15360
v_mfma_f32_16x16x32_bf16 v[84:87], v[168:171], a[148:151], v[84:87]
buffer_load_dwordx4 v15, s[24:27], s64 offen offset:2048 sc1 lds
v_mfma_f32_16x16x32_bf16 v[88:91], v[176:179], a[144:147], v[88:91]
s_add_u32 s91, s91, 16384
ds_read_b128 v[160:163], v7 offset:0
v_mfma_f32_16x16x32_bf16 v[88:91], v[180:183], a[152:155], v[88:91]
s_cmp_ge_u32 s91, 163840
s_cselect_b32 s91, 0, s91
ds_read_b128 v[164:167], v7 offset:1024
v_mfma_f32_16x16x32_bf16 v[92:95], v[180:183], a[156:159], v[92:95]
buffer_load_dwordx4 v15, s[24:27], s64 offen offset:3072 sc1 lds
v_mfma_f32_16x16x32_bf16 v[92:95], v[176:179], a[148:151], v[92:95]
s_waitcnt lgkmcnt(6)
ds_read_b128 v[168:171], v7 offset:2048
v_add_u32 v8, s91, v4
v_mfma_f32_16x16x32_bf16 v[96:99], v[184:187], a[144:147], v[96:99]
ds_read_b128 v[172:175], v7 offset:3072
v_mfma_f32_16x16x32_bf16 v[96:99], v[188:191], a[152:155], v[96:99]
buffer_load_dwordx4 v[48:51], v14, s[24:27], s65 offen offset:0 sc1
v_mfma_f32_16x16x32_bf16 v[100:103], v[188:191], a[156:159], v[100:103]
ds_read_b128 v[176:179], v7 offset:4096
v_mfma_f32_16x16x32_bf16 v[100:103], v[184:187], a[148:151], v[100:103]
s_waitcnt lgkmcnt(7) vmcnt(15)
v_mfma_f32_16x16x32_bf16 v[120:123], v[144:147], a[160:163], v[120:123]
buffer_load_dwordx4 v[56:59], v14, s[24:27], s65 offen offset:2048 sc1
v_mfma_f32_16x16x32_bf16 v[120:123], v[148:151], a[168:171], v[120:123]
s_waitcnt vmcnt(14)
ds_read_b128 v[180:183], v7 offset:5120
v_mfma_f32_16x16x32_bf16 v[124:127], v[148:151], a[172:175], v[124:127]
s_waitcnt lgkmcnt(6)
ds_read_b128 v[184:187], v7 offset:6144
v_mfma_f32_16x16x32_bf16 v[124:127], v[144:147], a[164:167], v[124:127]
buffer_load_dwordx4 v[52:55], v14, s[24:27], s93 offen offset:0 sc1
v_mfma_f32_16x16x32_bf16 v[72:75], v[152:155], a[160:163], v[72:75]
ds_read_b128 v[188:191], v7 offset:7168
v_mfma_f32_16x16x32_bf16 v[72:75], v[156:159], a[168:171], v[72:75]
v_mfma_f32_16x16x32_bf16 v[76:79], v[156:159], a[172:175], v[76:79]
buffer_load_dwordx4 v[60:63], v14, s[24:27], s93 offen offset:2048 sc1
v_mfma_f32_16x16x32_bf16 v[76:79], v[152:155], a[164:167], v[76:79]
s_waitcnt lgkmcnt(6)
ds_read_b128 v[144:147], v7 offset:8192
v_mfma_f32_16x16x32_bf16 v[80:83], v[160:163], a[160:163], v[80:83]
ds_read_b128 v[148:151], v7 offset:9216
v_mfma_f32_16x16x32_bf16 v[80:83], v[164:167], a[168:171], v[80:83]
v_mfma_f32_16x16x32_bf16 v[84:87], v[164:167], a[172:175], v[84:87]
ds_read_b128 v[152:155], v7 offset:10240
v_mfma_f32_16x16x32_bf16 v[84:87], v[160:163], a[164:167], v[84:87]
s_waitcnt lgkmcnt(7)
v_mfma_f32_16x16x32_bf16 v[88:91], v[168:171], a[160:163], v[88:91]
s_add_u32 s65, s77, 73728
ds_read_b128 v[156:159], v7 offset:11264
v_mfma_f32_16x16x32_bf16 v[88:91], v[172:175], a[168:171], v[88:91]
v_mfma_f32_16x16x32_bf16 v[92:95], v[172:175], a[172:175], v[92:95]
buffer_load_dwordx4 v[64:67], v15, s[24:27], s65 offen offset:0 sc1
v_mfma_f32_16x16x32_bf16 v[92:95], v[168:171], a[164:167], v[92:95]
s_waitcnt lgkmcnt(6)
ds_read_b128 v[160:163], v7 offset:12288
v_mfma_f32_16x16x32_bf16 v[96:99], v[176:179], a[160:163], v[96:99]
ds_read_b128 v[164:167], v7 offset:13312
v_mfma_f32_16x16x32_bf16 v[96:99], v[180:183], a[168:171], v[96:99]
v_mfma_f32_16x16x32_bf16 v[100:103], v[180:183], a[172:175], v[100:103]
ds_read_b128 v[168:171], v7 offset:14336
v_mfma_f32_16x16x32_bf16 v[100:103], v[176:179], a[164:167], v[100:103]
s_add_u32 s93, s81, 73728
s_waitcnt lgkmcnt(7) vmcnt(15)
v_mfma_f32_16x16x32_bf16 v[120:123], v[184:187], a[176:179], v[120:123]
s_waitcnt vmcnt(13)
ds_read_b128 v[172:175], v7 offset:15360
v_mfma_f32_16x16x32_bf16 v[120:123], v[188:191], a[184:187], v[120:123]
buffer_load_dwordx4 v[68:71], v15, s[24:27], s93 offen offset:0 sc1
v_mfma_f32_16x16x32_bf16 v[124:127], v[188:191], a[188:191], v[124:127]
s_add_u32 s91, s91, 16384
ds_read_b128 v[176:179], v8 offset:0
v_mfma_f32_16x16x32_bf16 v[124:127], v[184:187], a[180:183], v[124:127]
s_waitcnt lgkmcnt(7)
s_cmp_ge_u32 s91, 163840
s_cselect_b32 s91, 0, s91
v_mfma_f32_16x16x32_bf16 v[72:75], v[144:147], a[176:179], v[72:75]
ds_read_b128 v[180:183], v8 offset:1024
v_add_u32 v7, s91, v4
v_mfma_f32_16x16x32_bf16 v[72:75], v[148:151], a[184:187], v[72:75]
v_mfma_f32_16x16x32_bf16 v[76:79], v[148:151], a[188:191], v[76:79]
s_mov_b32 m0, s70
s_mov_b32 s64, s68
s_add_u32 s68, s68, 16384
v_mfma_f32_16x16x32_bf16 v[76:79], v[144:147], a[180:183], v[76:79]
s_waitcnt lgkmcnt(6)
ds_read_b128 v[184:187], v8 offset:2048
v_mfma_f32_16x16x32_bf16 v[80:83], v[152:155], a[176:179], v[80:83]
s_add_u32 s70, s70, 16384
s_cmp_ge_u32 s70, 163840
s_cselect_b32 s70, s80, s70
v_mfma_f32_16x16x32_bf16 v[80:83], v[156:159], a[184:187], v[80:83]
buffer_load_dwordx4 v15, s[24:27], s64 offen offset:0 sc1 lds
v_mfma_f32_16x16x32_bf16 v[84:87], v[156:159], a[188:191], v[84:87]
L_PAD12:
s_cbranch_execz L_MAIN
ds_read_b128 v[188:191], v8 offset:3072
v_mfma_f32_16x16x32_bf16 v[84:87], v[152:155], a[180:183], v[84:87]
s_waitcnt lgkmcnt(6)
ds_read_b128 v[144:147], v8 offset:4096
v_mfma_f32_16x16x32_bf16 v[88:91], v[160:163], a[176:179], v[88:91]
buffer_load_dwordx4 v15, s[24:27], s64 offen offset:1024 sc1 lds
v_mfma_f32_16x16x32_bf16 v[88:91], v[164:167], a[184:187], v[88:91]
ds_read_b128 v[148:151], v8 offset:5120
v_mfma_f32_16x16x32_bf16 v[92:95], v[164:167], a[188:191], v[92:95]
s_waitcnt lgkmcnt(6)
ds_read_b128 v[152:155], v8 offset:6144
v_mfma_f32_16x16x32_bf16 v[92:95], v[160:163], a[180:183], v[92:95]
buffer_load_dwordx4 v15, s[24:27], s64 offen offset:2048 sc1 lds
v_mfma_f32_16x16x32_bf16 v[96:99], v[168:171], a[176:179], v[96:99]
ds_read_b128 v[156:159], v8 offset:7168
v_mfma_f32_16x16x32_bf16 v[96:99], v[172:175], a[184:187], v[96:99]
v_mfma_f32_16x16x32_bf16 v[100:103], v[172:175], a[188:191], v[100:103]
buffer_load_dwordx4 v15, s[24:27], s64 offen offset:3072 sc1 lds
v_mfma_f32_16x16x32_bf16 v[100:103], v[168:171], a[180:183], v[100:103]
s_waitcnt lgkmcnt(6) vmcnt(16)
ds_read_b128 v[160:163], v8 offset:8192
v_mfma_f32_16x16x32_bf16 v[120:123], v[176:179], v[32:35], v[120:123]
s_mov_b32 m0, s70
s_mov_b32 s64, s68
s_add_u32 s68, s68, 16384
v_mfma_f32_16x16x32_bf16 v[120:123], v[180:183], v[40:43], v[120:123]
s_waitcnt lgkmcnt(5) vmcnt(12)
ds_read_b128 v[164:167], v8 offset:9216
v_mfma_f32_16x16x32_bf16 v[124:127], v[180:183], v[44:47], v[124:127]
s_add_u32 s70, s70, 16384
s_cmp_ge_u32 s70, 163840
s_cselect_b32 s70, s80, s70
v_mfma_f32_16x16x32_bf16 v[124:127], v[176:179], v[36:39], v[124:127]
buffer_load_dwordx4 v15, s[24:27], s64 offen offset:0 sc1 lds
v_mfma_f32_16x16x32_bf16 v[72:75], v[184:187], v[32:35], v[72:75]
ds_read_b128 v[168:171], v8 offset:10240
v_mfma_f32_16x16x32_bf16 v[72:75], v[188:191], v[40:43], v[72:75]
ds_read_b128 v[172:175], v8 offset:11264
v_mfma_f32_16x16x32_bf16 v[76:79], v[188:191], v[44:47], v[76:79]
buffer_load_dwordx4 v15, s[24:27], s64 offen offset:1024 sc1 lds
v_mfma_f32_16x16x32_bf16 v[76:79], v[184:187], v[36:39], v[76:79]
s_waitcnt lgkmcnt(6)
ds_read_b128 v[176:179], v8 offset:12288
v_mfma_f32_16x16x32_bf16 v[80:83], v[144:147], v[32:35], v[80:83]
ds_read_b128 v[180:183], v8 offset:13312
v_mfma_f32_16x16x32_bf16 v[80:83], v[148:151], v[40:43], v[80:83]
buffer_load_dwordx4 v15, s[24:27], s64 offen offset:2048 sc1 lds
v_mfma_f32_16x16x32_bf16 v[84:87], v[148:151], v[44:47], v[84:87]
ds_read_b128 v[184:187], v8 offset:14336
v_mfma_f32_16x16x32_bf16 v[84:87], v[144:147], v[36:39], v[84:87]
s_waitcnt lgkmcnt(7)
v_mfma_f32_16x16x32_bf16 v[88:91], v[152:155], v[32:35], v[88:91]
s_waitcnt vmcnt(13)
ds_read_b128 v[188:191], v8 offset:15360
v_mfma_f32_16x16x32_bf16 v[88:91], v[156:159], v[40:43], v[88:91]
s_barrier
v_mfma_f32_16x16x32_bf16 v[92:95], v[156:159], v[44:47], v[92:95]
buffer_load_dwordx4 v15, s[24:27], s64 offen offset:3072 sc1 lds
v_mfma_f32_16x16x32_bf16 v[92:95], v[152:155], v[36:39], v[92:95]
s_waitcnt lgkmcnt(6)
s_add_u32 s91, s91, 16384
ds_read_b128 v[144:147], v7 offset:0
v_mfma_f32_16x16x32_bf16 v[96:99], v[160:163], v[32:35], v[96:99]
s_cmp_ge_u32 s91, 163840
s_cselect_b32 s91, 0, s91
ds_read_b128 v[148:151], v7 offset:1024
v_mfma_f32_16x16x32_bf16 v[96:99], v[164:167], v[40:43], v[96:99]
v_add_u32 v8, s91, v4
v_mfma_f32_16x16x32_bf16 v[100:103], v[164:167], v[44:47], v[100:103]
ds_read_b128 v[152:155], v7 offset:2048
v_mfma_f32_16x16x32_bf16 v[100:103], v[160:163], v[36:39], v[100:103]
s_waitcnt lgkmcnt(7) vmcnt(12)
v_mfma_f32_16x16x32_bf16 v[120:123], v[168:171], v[48:51], v[120:123]
ds_read_b128 v[156:159], v7 offset:3072
v_mfma_f32_16x16x32_bf16 v[120:123], v[172:175], v[56:59], v[120:123]
s_waitcnt vmcnt(10)
v_mfma_f32_16x16x32_bf16 v[124:127], v[172:175], v[60:63], v[124:127]
ds_read_b128 v[160:163], v7 offset:4096
v_mfma_f32_16x16x32_bf16 v[124:127], v[168:171], v[52:55], v[124:127]
s_waitcnt lgkmcnt(7)
v_mfma_f32_16x16x32_bf16 v[72:75], v[176:179], v[48:51], v[72:75]
ds_read_b128 v[164:167], v7 offset:5120
v_mfma_f32_16x16x32_bf16 v[72:75], v[180:183], v[56:59], v[72:75]
v_mfma_f32_16x16x32_bf16 v[76:79], v[180:183], v[60:63], v[76:79]
ds_read_b128 v[168:171], v7 offset:6144
v_mfma_f32_16x16x32_bf16 v[76:79], v[176:179], v[52:55], v[76:79]
s_waitcnt lgkmcnt(7)
v_mfma_f32_16x16x32_bf16 v[80:83], v[184:187], v[48:51], v[80:83]
ds_read_b128 v[172:175], v7 offset:7168
v_mfma_f32_16x16x32_bf16 v[80:83], v[188:191], v[56:59], v[80:83]
v_mfma_f32_16x16x32_bf16 v[84:87], v[188:191], v[60:63], v[84:87]
ds_read_b128 v[176:179], v7 offset:8192
v_mfma_f32_16x16x32_bf16 v[84:87], v[184:187], v[52:55], v[84:87]
s_waitcnt lgkmcnt(7)
v_mfma_f32_16x16x32_bf16 v[88:91], v[144:147], v[48:51], v[88:91]
ds_read_b128 v[180:183], v7 offset:9216
v_mfma_f32_16x16x32_bf16 v[88:91], v[148:151], v[56:59], v[88:91]
v_mfma_f32_16x16x32_bf16 v[92:95], v[148:151], v[60:63], v[92:95]
ds_read_b128 v[184:187], v7 offset:10240
v_mfma_f32_16x16x32_bf16 v[92:95], v[144:147], v[52:55], v[92:95]
s_waitcnt lgkmcnt(7)
v_mfma_f32_16x16x32_bf16 v[96:99], v[152:155], v[48:51], v[96:99]
ds_read_b128 v[188:191], v7 offset:11264
v_mfma_f32_16x16x32_bf16 v[96:99], v[156:159], v[56:59], v[96:99]
v_mfma_f32_16x16x32_bf16 v[100:103], v[156:159], v[60:63], v[100:103]
ds_read_b128 v[144:147], v7 offset:12288
v_mfma_f32_16x16x32_bf16 v[100:103], v[152:155], v[52:55], v[100:103]
s_waitcnt lgkmcnt(7) vmcnt(9)
v_mfma_f32_16x16x32_bf16 v[120:123], v[160:163], v[64:67], v[120:123]
s_waitcnt vmcnt(8)
ds_read_b128 v[148:151], v7 offset:13312
v_mfma_f32_16x16x32_bf16 v[124:127], v[160:163], v[68:71], v[124:127]
v_mfma_f32_16x16x32_bf16 v[72:75], v[164:167], v[64:67], v[72:75]
ds_read_b128 v[152:155], v7 offset:14336
v_mfma_f32_16x16x32_bf16 v[76:79], v[164:167], v[68:71], v[76:79]
s_waitcnt lgkmcnt(7)
v_mfma_f32_16x16x32_bf16 v[80:83], v[168:171], v[64:67], v[80:83]
ds_read_b128 v[156:159], v7 offset:15360
v_mfma_f32_16x16x32_bf16 v[84:87], v[168:171], v[68:71], v[84:87]
s_add_u32 s91, s91, 16384
s_cmp_ge_u32 s91, 163840
s_cselect_b32 s91, 0, s91
v_mfma_f32_16x16x32_bf16 v[88:91], v[172:175], v[64:67], v[88:91]
ds_read_b128 v[160:163], v8 offset:0
v_add_u32 v7, s91, v4
v_mfma_f32_16x16x32_bf16 v[92:95], v[172:175], v[68:71], v[92:95]
s_waitcnt lgkmcnt(7)
v_mfma_f32_16x16x32_bf16 v[96:99], v[176:179], v[64:67], v[96:99]
ds_read_b128 v[164:167], v8 offset:1024
v_cvt_pk_bf16_f32 v228, v120, v121
v_mfma_f32_16x16x32_bf16 v[100:103], v[176:179], v[68:71], v[100:103]
v_cvt_pk_bf16_f32 v229, v122, v123
v_mfma_f32_16x16x32_bf16 v[104:107], v[180:183], a[64:67], v[104:107]
s_waitcnt lgkmcnt(6)
ds_read_b128 v[168:171], v8 offset:2048
v_cvt_pk_bf16_f32 v230, v124, v125
v_mfma_f32_16x16x32_bf16 v[104:107], v[184:187], a[72:75], v[104:107]
v_cvt_pk_bf16_f32 v231, v126, v127
v_mfma_f32_16x16x32_bf16 v[108:111], v[184:187], a[76:79], v[108:111]
buffer_store_dwordx4 v[228:231], v15, s[24:27], s55 offen offset:0 sc1
v_mfma_f32_16x16x32_bf16 v[108:111], v[180:183], a[68:71], v[108:111]
ds_read_b128 v[172:175], v8 offset:3072
v_cvt_pk_bf16_f32 v72, v72, v73
v_mfma_f32_16x16x32_bf16 v[112:115], v[188:191], a[64:67], v[112:115]
s_waitcnt lgkmcnt(6)
ds_read_b128 v[176:179], v8 offset:4096
v_cvt_pk_bf16_f32 v73, v74, v75
v_mfma_f32_16x16x32_bf16 v[112:115], v[144:147], a[72:75], v[112:115]
v_cvt_pk_bf16_f32 v74, v80, v81
v_mfma_f32_16x16x32_bf16 v[116:119], v[144:147], a[76:79], v[116:119]
ds_read_b128 v[180:183], v8 offset:5120
v_cvt_pk_bf16_f32 v75, v82, v83
v_mfma_f32_16x16x32_bf16 v[116:119], v[188:191], a[68:71], v[116:119]
buffer_store_dwordx4 v[72:75], v15, s[24:27], s52 offen offset:0 sc1
v_mfma_f32_16x16x32_bf16 v[104:107], v[148:151], a[80:83], v[104:107]
s_waitcnt lgkmcnt(6)
ds_read_b128 v[184:187], v8 offset:6144
v_cvt_pk_bf16_f32 v76, v76, v77
v_mfma_f32_16x16x32_bf16 v[104:107], v[152:155], a[88:91], v[104:107]
v_cvt_pk_bf16_f32 v77, v78, v79
v_mfma_f32_16x16x32_bf16 v[108:111], v[152:155], a[92:95], v[108:111]
ds_read_b128 v[188:191], v8 offset:7168
v_cvt_pk_bf16_f32 v78, v84, v85
v_mfma_f32_16x16x32_bf16 v[108:111], v[148:151], a[84:87], v[108:111]
s_waitcnt lgkmcnt(6)
v_cvt_pk_bf16_f32 v79, v86, v87
v_mfma_f32_16x16x32_bf16 v[112:115], v[156:159], a[80:83], v[112:115]
buffer_store_dwordx4 v[76:79], v15, s[24:27], s52 offen offset:1024 sc1
v_mfma_f32_16x16x32_bf16 v[112:115], v[160:163], a[88:91], v[112:115]
ds_read_b128 v[144:147], v8 offset:8192
v_cvt_pk_bf16_f32 v88, v88, v89
v_mfma_f32_16x16x32_bf16 v[116:119], v[160:163], a[92:95], v[116:119]
ds_read_b128 v[148:151], v8 offset:9216
v_cvt_pk_bf16_f32 v89, v90, v91
v_mfma_f32_16x16x32_bf16 v[116:119], v[156:159], a[84:87], v[116:119]
v_cvt_pk_bf16_f32 v90, v96, v97
v_mfma_f32_16x16x32_bf16 v[104:107], v[164:167], a[192:195], v[104:107]
s_waitcnt lgkmcnt(6)
ds_read_b128 v[152:155], v8 offset:10240
v_cvt_pk_bf16_f32 v91, v98, v99
v_mfma_f32_16x16x32_bf16 v[104:107], v[168:171], a[200:203], v[104:107]
buffer_store_dwordx4 v[88:91], v15, s[24:27], s53 offen offset:0 sc1
v_mfma_f32_16x16x32_bf16 v[108:111], v[168:171], a[204:207], v[108:111]
ds_read_b128 v[156:159], v8 offset:11264
v_cvt_pk_bf16_f32 v92, v92, v93
v_mfma_f32_16x16x32_bf16 v[108:111], v[164:167], a[196:199], v[108:111]
v_cvt_pk_bf16_f32 v93, v94, v95
v_mfma_f32_16x16x32_bf16 v[112:115], v[172:175], a[192:195], v[112:115]
s_waitcnt lgkmcnt(6)
ds_read_b128 v[160:163], v8 offset:12288
v_cvt_pk_bf16_f32 v94, v100, v101
v_mfma_f32_16x16x32_bf16 v[112:115], v[176:179], a[200:203], v[112:115]
s_waitcnt lgkmcnt(5)
v_cvt_pk_bf16_f32 v95, v102, v103
v_mfma_f32_16x16x32_bf16 v[116:119], v[176:179], a[204:207], v[116:119]
buffer_store_dwordx4 v[92:95], v15, s[24:27], s53 offen offset:1024 sc1
v_mfma_f32_16x16x32_bf16 v[116:119], v[172:175], a[196:199], v[116:119]
s_mov_b32 m0, s70
s_mov_b32 s64, s68
s_add_u32 s68, s68, 16384
v_mfma_f32_16x16x32_bf16 v[104:107], v[180:183], a[208:211], v[104:107]
s_add_u32 s70, s70, 16384
s_cmp_ge_u32 s70, 163840
s_cselect_b32 s70, s80, s70
v_mfma_f32_16x16x32_bf16 v[104:107], v[184:187], a[216:219], v[104:107]
buffer_load_dwordx4 v15, s[24:27], s64 offen offset:0 sc1 lds
v_mfma_f32_16x16x32_bf16 v[108:111], v[184:187], a[220:223], v[108:111]
s_waitcnt vmcnt(6) lgkmcnt(3)
ds_read_b128 v[164:167], v8 offset:13312
v_mfma_f32_16x16x32_bf16 v[108:111], v[180:183], a[212:215], v[108:111]
s_barrier
v_mfma_f32_16x16x32_bf16 v[112:115], v[188:191], a[208:211], v[112:115]
buffer_load_dwordx4 v15, s[24:27], s64 offen offset:1024 sc1 lds
v_mfma_f32_16x16x32_bf16 v[112:115], v[144:147], a[216:219], v[112:115]
ds_read_b128 v[168:171], v8 offset:14336
v_mfma_f32_16x16x32_bf16 v[116:119], v[144:147], a[220:223], v[116:119]
ds_read_b128 v[172:175], v8 offset:15360
v_mfma_f32_16x16x32_bf16 v[116:119], v[188:191], a[212:215], v[116:119]
buffer_load_dwordx4 v15, s[24:27], s64 offen offset:2048 sc1 lds
v_mfma_f32_16x16x32_bf16 v[104:107], v[148:151], a[224:227], v[104:107]
s_waitcnt lgkmcnt(4)
s_add_u32 s91, s91, 16384
ds_read_b128 v[176:179], v7 offset:0
v_mfma_f32_16x16x32_bf16 v[104:107], v[152:155], a[232:235], v[104:107]
s_cmp_ge_u32 s91, 163840
s_cselect_b32 s91, 0, s91
ds_read_b128 v[180:183], v7 offset:1024
v_mfma_f32_16x16x32_bf16 v[108:111], v[152:155], a[236:239], v[108:111]
buffer_load_dwordx4 v15, s[24:27], s64 offen offset:3072 sc1 lds
v_mfma_f32_16x16x32_bf16 v[108:111], v[148:151], a[228:231], v[108:111]
s_mov_b32 m0, s70
s_mov_b32 s64, s68
s_add_u32 s68, s68, 16384
v_mfma_f32_16x16x32_bf16 v[112:115], v[156:159], a[224:227], v[112:115]
s_waitcnt lgkmcnt(4)
ds_read_b128 v[184:187], v7 offset:2048
v_add_u32 v8, s91, v4
v_mfma_f32_16x16x32_bf16 v[112:115], v[160:163], a[232:235], v[112:115]
s_add_u32 s70, s70, 16384
s_cmp_ge_u32 s70, 163840
s_cselect_b32 s70, s80, s70
v_mfma_f32_16x16x32_bf16 v[116:119], v[160:163], a[236:239], v[116:119]
buffer_load_dwordx4 v15, s[24:27], s64 offen offset:0 sc1 lds
v_mfma_f32_16x16x32_bf16 v[116:119], v[156:159], a[228:231], v[116:119]
ds_read_b128 v[188:191], v7 offset:3072
v_mfma_f32_16x16x32_bf16 v[104:107], v[164:167], a[240:243], v[104:107]
s_waitcnt lgkmcnt(4)
ds_read_b128 v[144:147], v7 offset:4096
v_mfma_f32_16x16x32_bf16 v[104:107], v[168:171], a[248:251], v[104:107]
buffer_load_dwordx4 v15, s[24:27], s64 offen offset:1024 sc1 lds
v_mfma_f32_16x16x32_bf16 v[108:111], v[168:171], a[252:255], v[108:111]
ds_read_b128 v[148:151], v7 offset:5120
v_mfma_f32_16x16x32_bf16 v[108:111], v[164:167], a[244:247], v[108:111]
s_waitcnt lgkmcnt(4)
ds_read_b128 v[152:155], v7 offset:6144
v_mfma_f32_16x16x32_bf16 v[112:115], v[172:175], a[240:243], v[112:115]
buffer_load_dwordx4 v15, s[24:27], s64 offen offset:2048 sc1 lds
v_mfma_f32_16x16x32_bf16 v[112:115], v[176:179], a[248:251], v[112:115]
ds_read_b128 v[156:159], v7 offset:7168
v_mfma_f32_16x16x32_bf16 v[116:119], v[176:179], a[252:255], v[116:119]
ds_read_b128 v[160:163], v7 offset:8192
v_mfma_f32_16x16x32_bf16 v[116:119], v[172:175], a[244:247], v[116:119]
buffer_load_dwordx4 v15, s[24:27], s64 offen offset:3072 sc1 lds
v_mfma_f32_16x16x32_bf16 v[104:107], v[180:183], a[96:99], v[104:107]
s_waitcnt lgkmcnt(5)
ds_read_b128 v[164:167], v7 offset:9216
v_mfma_f32_16x16x32_bf16 v[104:107], v[184:187], a[104:107], v[104:107]
ds_read_b128 v[168:171], v7 offset:10240
v_mfma_f32_16x16x32_bf16 v[108:111], v[184:187], a[108:111], v[108:111]
ds_read_b128 v[172:175], v7 offset:11264
v_mfma_f32_16x16x32_bf16 v[108:111], v[180:183], a[100:103], v[108:111]
v_mfma_f32_16x16x32_bf16 v[112:115], v[188:191], a[96:99], v[112:115]
s_waitcnt lgkmcnt(6)
ds_read_b128 v[176:179], v7 offset:12288
v_mfma_f32_16x16x32_bf16 v[112:115], v[144:147], a[104:107], v[112:115]
v_mfma_f32_16x16x32_bf16 v[116:119], v[144:147], a[108:111], v[116:119]
ds_read_b128 v[180:183], v7 offset:13312
v_mfma_f32_16x16x32_bf16 v[116:119], v[188:191], a[100:103], v[116:119]
v_mfma_f32_16x16x32_bf16 v[104:107], v[148:151], a[112:115], v[104:107]
s_waitcnt lgkmcnt(6)
ds_read_b128 v[184:187], v7 offset:14336
v_mfma_f32_16x16x32_bf16 v[104:107], v[152:155], a[120:123], v[104:107]
v_mfma_f32_16x16x32_bf16 v[108:111], v[152:155], a[124:127], v[108:111]
ds_read_b128 v[188:191], v7 offset:15360
v_mfma_f32_16x16x32_bf16 v[108:111], v[148:151], a[116:119], v[108:111]
s_add_u32 s91, s91, 16384
s_cmp_ge_u32 s91, 163840
s_cselect_b32 s91, 0, s91
v_mfma_f32_16x16x32_bf16 v[112:115], v[156:159], a[112:115], v[112:115]
s_waitcnt lgkmcnt(6)
ds_read_b128 v[144:147], v8 offset:0
v_add_u32 v7, s91, v4
v_mfma_f32_16x16x32_bf16 v[112:115], v[160:163], a[120:123], v[112:115]
v_mfma_f32_16x16x32_bf16 v[116:119], v[160:163], a[124:127], v[116:119]
ds_read_b128 v[148:151], v8 offset:1024
v_mfma_f32_16x16x32_bf16 v[116:119], v[156:159], a[116:119], v[116:119]
s_waitcnt lgkmcnt(6)
v_mfma_f32_16x16x32_bf16 v[104:107], v[164:167], a[128:131], v[104:107]
s_mov_b32 m0, s70
s_mov_b32 s64, s68
s_add_u32 s68, s68, 16384
v_mfma_f32_16x16x32_bf16 v[104:107], v[168:171], a[136:139], v[104:107]
ds_read_b128 v[152:155], v8 offset:2048
v_mfma_f32_16x16x32_bf16 v[108:111], v[168:171], a[140:143], v[108:111]
s_add_u32 s70, s70, 16384
s_cmp_ge_u32 s70, 163840
s_cselect_b32 s70, s80, s70
v_mfma_f32_16x16x32_bf16 v[108:111], v[164:167], a[132:135], v[108:111]
buffer_load_dwordx4 v15, s[24:27], s64 offen offset:0 sc1 lds
v_mfma_f32_16x16x32_bf16 v[112:115], v[172:175], a[128:131], v[112:115]
s_waitcnt lgkmcnt(5)
ds_read_b128 v[156:159], v8 offset:3072
v_mfma_f32_16x16x32_bf16 v[112:115], v[176:179], a[136:139], v[112:115]
ds_read_b128 v[160:163], v8 offset:4096
v_mfma_f32_16x16x32_bf16 v[116:119], v[176:179], a[140:143], v[116:119]
buffer_load_dwordx4 v15, s[24:27], s64 offen offset:1024 sc1 lds
v_mfma_f32_16x16x32_bf16 v[116:119], v[172:175], a[132:135], v[116:119]
ds_read_b128 v[164:167], v8 offset:5120
v_mfma_f32_16x16x32_bf16 v[104:107], v[180:183], a[144:147], v[104:107]
s_waitcnt vmcnt(10) lgkmcnt(6)
ds_read_b128 v[168:171], v8 offset:6144
v_mfma_f32_16x16x32_bf16 v[104:107], v[184:187], a[152:155], v[104:107]
buffer_atomic_add v1, v0, s[24:27], s73 offen offset:0 sc1
v_mfma_f32_16x16x32_bf16 v[108:111], v[184:187], a[156:159], v[108:111]
buffer_load_dwordx4 v15, s[24:27], s64 offen offset:2048 sc1 lds
v_mfma_f32_16x16x32_bf16 v[108:111], v[180:183], a[148:151], v[108:111]
ds_read_b128 v[172:175], v8 offset:7168
v_mfma_f32_16x16x32_bf16 v[112:115], v[188:191], a[144:147], v[112:115]
s_waitcnt lgkmcnt(6)
ds_read_b128 v[176:179], v8 offset:8192
v_mfma_f32_16x16x32_bf16 v[112:115], v[144:147], a[152:155], v[112:115]
buffer_load_dwordx4 v15, s[24:27], s64 offen offset:3072 sc1 lds
v_mfma_f32_16x16x32_bf16 v[116:119], v[144:147], a[156:159], v[116:119]
s_mov_b32 m0, s70
s_mov_b32 s64, s68
s_add_u32 s68, s68, 16384
v_mfma_f32_16x16x32_bf16 v[116:119], v[188:191], a[148:151], v[116:119]
s_waitcnt lgkmcnt(5)
ds_read_b128 v[180:183], v8 offset:9216
v_mfma_f32_16x16x32_bf16 v[104:107], v[148:151], a[160:163], v[104:107]
s_add_u32 s70, s70, 16384
s_cmp_ge_u32 s70, 163840
s_cselect_b32 s70, s80, s70
v_mfma_f32_16x16x32_bf16 v[104:107], v[152:155], a[168:171], v[104:107]
buffer_load_dwordx4 v15, s[24:27], s64 offen offset:0 sc1 lds
v_mfma_f32_16x16x32_bf16 v[108:111], v[152:155], a[172:175], v[108:111]
ds_read_b128 v[184:187], v8 offset:10240
v_mfma_f32_16x16x32_bf16 v[108:111], v[148:151], a[164:167], v[108:111]
s_waitcnt lgkmcnt(5)
ds_read_b128 v[188:191], v8 offset:11264
v_mfma_f32_16x16x32_bf16 v[112:115], v[156:159], a[160:163], v[112:115]
buffer_load_dwordx4 v15, s[24:27], s64 offen offset:1024 sc1 lds
v_mfma_f32_16x16x32_bf16 v[112:115], v[160:163], a[168:171], v[112:115]
ds_read_b128 v[144:147], v8 offset:12288
v_mfma_f32_16x16x32_bf16 v[116:119], v[160:163], a[172:175], v[116:119]
s_add_u32 s82, s84, 3
ds_read_b128 v[148:151], v8 offset:13312
v_mfma_f32_16x16x32_bf16 v[116:119], v[156:159], a[164:167], v[116:119]
buffer_load_dwordx4 v15, s[24:27], s64 offen offset:2048 sc1 lds
v_mfma_f32_16x16x32_bf16 v[104:107], v[164:167], a[176:179], v[104:107]
s_and_b32 s82, s82, 3
s_waitcnt lgkmcnt(6)
ds_read_b128 v[152:155], v8 offset:14336
v_mfma_f32_16x16x32_bf16 v[104:107], v[168:171], a[184:187], v[104:107]
v_mfma_f32_16x16x32_bf16 v[108:111], v[168:171], a[188:191], v[108:111]
s_waitcnt vmcnt(8)
s_lshl_b32 s82, s82, 7
ds_read_b128 v[156:159], v8 offset:15360
v_mfma_f32_16x16x32_bf16 v[108:111], v[164:167], a[180:183], v[108:111]
s_barrier
v_mfma_f32_16x16x32_bf16 v[112:115], v[172:175], a[176:179], v[112:115]
s_add_u32 s82, s82, s73
s_waitcnt lgkmcnt(6)
ds_read_b128 v[160:163], v7 offset:0
v_mfma_f32_16x16x32_bf16 v[112:115], v[176:179], a[184:187], v[112:115]
buffer_load_dwordx4 v15, s[24:27], s64 offen offset:3072 sc1 lds
v_mfma_f32_16x16x32_bf16 v[116:119], v[176:179], a[188:191], v[116:119]
s_lshl_b32 s75, s84, 7
s_add_u32 s91, s91, 16384
ds_read_b128 v[164:167], v7 offset:1024
v_mfma_f32_16x16x32_bf16 v[116:119], v[172:175], a[180:183], v[116:119]
s_cmp_ge_u32 s91, 163840
s_cselect_b32 s91, 0, s91
v_add_u32 v8, s91, v4
v_mfma_f32_16x16x32_bf16 v[104:107], v[180:183], v[32:35], v[104:107]
s_add_u32 s75, s75, s73
s_waitcnt lgkmcnt(6)
ds_read_b128 v[168:171], v7 offset:2048
v_mfma_f32_16x16x32_bf16 v[104:107], v[184:187], v[40:43], v[104:107]
v_mfma_f32_16x16x32_bf16 v[108:111], v[184:187], v[44:47], v[108:111]
ds_read_b128 v[172:175], v7 offset:3072
v_mfma_f32_16x16x32_bf16 v[108:111], v[180:183], v[36:39], v[108:111]
v_mfma_f32_16x16x32_bf16 v[112:115], v[188:191], v[32:35], v[112:115]
s_waitcnt lgkmcnt(6)
ds_read_b128 v[176:179], v7 offset:4096
v_mfma_f32_16x16x32_bf16 v[112:115], v[144:147], v[40:43], v[112:115]
v_mfma_f32_16x16x32_bf16 v[116:119], v[144:147], v[44:47], v[116:119]
ds_read_b128 v[180:183], v7 offset:5120
v_mfma_f32_16x16x32_bf16 v[116:119], v[188:191], v[36:39], v[116:119]
v_mfma_f32_16x16x32_bf16 v[104:107], v[148:151], v[48:51], v[104:107]
s_waitcnt lgkmcnt(6)
ds_read_b128 v[184:187], v7 offset:6144
v_mfma_f32_16x16x32_bf16 v[104:107], v[152:155], v[56:59], v[104:107]
v_mfma_f32_16x16x32_bf16 v[108:111], v[152:155], v[60:63], v[108:111]
ds_read_b128 v[188:191], v7 offset:7168
v_mfma_f32_16x16x32_bf16 v[108:111], v[148:151], v[52:55], v[108:111]
v_mfma_f32_16x16x32_bf16 v[112:115], v[156:159], v[48:51], v[112:115]
s_waitcnt lgkmcnt(6)
ds_read_b128 v[144:147], v7 offset:8192
v_mfma_f32_16x16x32_bf16 v[112:115], v[160:163], v[56:59], v[112:115]
v_mfma_f32_16x16x32_bf16 v[116:119], v[160:163], v[60:63], v[116:119]
ds_read_b128 v[148:151], v7 offset:9216
v_mfma_f32_16x16x32_bf16 v[116:119], v[156:159], v[52:55], v[116:119]
v_mfma_f32_16x16x32_bf16 v[104:107], v[164:167], v[64:67], v[104:107]
ds_read_b128 v[152:155], v7 offset:10240
v_mfma_f32_16x16x32_bf16 v[108:111], v[164:167], v[68:71], v[108:111]
s_waitcnt lgkmcnt(7)
v_mfma_f32_16x16x32_bf16 v[112:115], v[168:171], v[64:67], v[112:115]
ds_read_b128 v[156:159], v7 offset:11264
v_mfma_f32_16x16x32_bf16 v[116:119], v[168:171], v[68:71], v[116:119]
v_mfma_f32_16x16x32_bf16 v[128:131], v[172:175], a[0:3], 0
s_waitcnt lgkmcnt(6)
ds_read_b128 v[160:163], v7 offset:12288
v_mfma_f32_16x16x32_bf16 v[128:131], v[176:179], a[8:11], v[128:131]
v_mfma_f32_16x16x32_bf16 v[132:135], v[176:179], a[12:15], 0
ds_read_b128 v[164:167], v7 offset:13312
v_mfma_f32_16x16x32_bf16 v[132:135], v[172:175], a[4:7], v[132:135]
v_mfma_f32_16x16x32_bf16 v[136:139], v[180:183], a[0:3], 0
s_waitcnt lgkmcnt(6)
ds_read_b128 v[168:171], v7 offset:14336
v_mfma_f32_16x16x32_bf16 v[136:139], v[184:187], a[8:11], v[136:139]
v_cvt_pk_bf16_f32 v104, v104, v105
v_mfma_f32_16x16x32_bf16 v[140:143], v[184:187], a[12:15], 0
ds_read_b128 v[172:175], v7 offset:15360
v_cvt_pk_bf16_f32 v105, v106, v107
v_mfma_f32_16x16x32_bf16 v[140:143], v[180:183], a[4:7], v[140:143]
s_add_u32 s91, s91, 16384
v_cvt_pk_bf16_f32 v106, v112, v113
v_mfma_f32_16x16x32_bf16 v[128:131], v[188:191], a[16:19], v[128:131]
s_waitcnt lgkmcnt(6)
ds_read_b128 v[176:179], v8 offset:0
v_cvt_pk_bf16_f32 v107, v114, v115
v_mfma_f32_16x16x32_bf16 v[128:131], v[144:147], a[24:27], v[128:131]
buffer_store_dwordx4 v[104:107], v15, s[24:27], s54 offen offset:0 sc1
v_mfma_f32_16x16x32_bf16 v[132:135], v[144:147], a[28:31], v[132:135]
ds_read_b128 v[180:183], v8 offset:1024
v_cvt_pk_bf16_f32 v108, v108, v109
v_mfma_f32_16x16x32_bf16 v[132:135], v[188:191], a[20:23], v[132:135]
s_cmp_ge_u32 s91, 163840
s_cselect_b32 s91, 0, s91
v_cvt_pk_bf16_f32 v109, v110, v111
v_mfma_f32_16x16x32_bf16 v[136:139], v[148:151], a[16:19], v[136:139]
s_waitcnt lgkmcnt(6)
ds_read_b128 v[184:187], v8 offset:2048
v_cvt_pk_bf16_f32 v110, v116, v117
v_mfma_f32_16x16x32_bf16 v[136:139], v[152:155], a[24:27], v[136:139]
s_waitcnt lgkmcnt(5)
v_cvt_pk_bf16_f32 v111, v118, v119
v_add_u32 v7, s91, v4
v_mfma_f32_16x16x32_bf16 v[140:143], v[152:155], a[28:31], v[140:143]
buffer_store_dwordx4 v[108:111], v15, s[24:27], s54 offen offset:1024 sc1
v_mfma_f32_16x16x32_bf16 v[140:143], v[148:151], a[20:23], v[140:143]
s_mov_b32 m0, s70
s_mov_b32 s64, s68
s_add_u32 s68, s68, 16384
v_mfma_f32_16x16x32_bf16 v[128:131], v[156:159], a[32:35], v[128:131]
s_cmp_lt_u32 s3, 3
s_cselect_b32 s68, s64, 2147418112
ds_read_b128 v[188:191], v8 offset:3072
v_mfma_f32_16x16x32_bf16 v[128:131], v[160:163], a[40:43], v[128:131]
buffer_load_dwordx4 v15, s[24:27], s64 offen offset:0 sc1 lds
v_mfma_f32_16x16x32_bf16 v[132:135], v[160:163], a[44:47], v[132:135]
ds_read_b128 v[144:147], v8 offset:4096
v_mfma_f32_16x16x32_bf16 v[132:135], v[156:159], a[36:39], v[132:135]
s_waitcnt lgkmcnt(5)
ds_read_b128 v[148:151], v8 offset:5120
v_mfma_f32_16x16x32_bf16 v[136:139], v[164:167], a[32:35], v[136:139]
buffer_load_dwordx4 v15, s[24:27], s68 offen offset:1024 sc1 lds
v_mfma_f32_16x16x32_bf16 v[136:139], v[168:171], a[40:43], v[136:139]
ds_read_b128 v[152:155], v8 offset:6144
v_mfma_f32_16x16x32_bf16 v[140:143], v[168:171], a[44:47], v[140:143]
ds_read_b128 v[156:159], v8 offset:7168
v_mfma_f32_16x16x32_bf16 v[140:143], v[164:167], a[36:39], v[140:143]
buffer_load_dwordx4 v15, s[24:27], s68 offen offset:2048 sc1 lds
v_mfma_f32_16x16x32_bf16 v[128:131], v[172:175], a[48:51], v[128:131]
s_waitcnt lgkmcnt(6)
ds_read_b128 v[160:163], v8 offset:8192
v_mfma_f32_16x16x32_bf16 v[128:131], v[176:179], a[56:59], v[128:131]
v_mfma_f32_16x16x32_bf16 v[132:135], v[176:179], a[60:63], v[132:135]
buffer_load_dwordx4 v15, s[24:27], s68 offen offset:3072 sc1 lds
v_mfma_f32_16x16x32_bf16 v[132:135], v[172:175], a[52:55], v[132:135]
buffer_load_dword v12, v10, s[24:27], s73 offen sc1
v_mfma_f32_16x16x32_bf16 v[136:139], v[180:183], a[48:51], v[136:139]
s_waitcnt lgkmcnt(5)
ds_read_b128 v[164:167], v8 offset:9216
v_mfma_f32_16x16x32_bf16 v[136:139], v[184:187], a[56:59], v[136:139]
ds_read_b128 v[168:171], v8 offset:10240
v_mfma_f32_16x16x32_bf16 v[140:143], v[184:187], a[60:63], v[140:143]
ds_read_b128 v[172:175], v8 offset:11264
v_mfma_f32_16x16x32_bf16 v[140:143], v[180:183], a[52:55], v[140:143]
v_mfma_f32_16x16x32_bf16 v[128:131], v[188:191], a[64:67], v[128:131]
s_waitcnt lgkmcnt(6)
ds_read_b128 v[176:179], v8 offset:12288
v_mfma_f32_16x16x32_bf16 v[128:131], v[144:147], a[72:75], v[128:131]
v_mfma_f32_16x16x32_bf16 v[132:135], v[144:147], a[76:79], v[132:135]
ds_read_b128 v[180:183], v8 offset:13312
v_mfma_f32_16x16x32_bf16 v[132:135], v[188:191], a[68:71], v[132:135]
v_mfma_f32_16x16x32_bf16 v[136:139], v[148:151], a[64:67], v[136:139]
s_waitcnt lgkmcnt(6)
ds_read_b128 v[184:187], v8 offset:14336
v_mfma_f32_16x16x32_bf16 v[136:139], v[152:155], a[72:75], v[136:139]
v_mfma_f32_16x16x32_bf16 v[140:143], v[152:155], a[76:79], v[140:143]
s_waitcnt vmcnt(7)
ds_read_b128 v[188:191], v8 offset:15360
v_mfma_f32_16x16x32_bf16 v[140:143], v[148:151], a[68:71], v[140:143]
s_barrier
v_mfma_f32_16x16x32_bf16 v[128:131], v[156:159], a[80:83], v[128:131]
s_waitcnt lgkmcnt(6)
s_add_u32 s91, s91, 16384
ds_read_b128 v[144:147], v7 offset:0
v_mfma_f32_16x16x32_bf16 v[128:131], v[160:163], a[88:91], v[128:131]
s_cmp_ge_u32 s91, 163840
s_cselect_b32 s91, 0, s91
v_add_u32 v8, s91, v4
v_mfma_f32_16x16x32_bf16 v[132:135], v[160:163], a[92:95], v[132:135]
ds_read_b128 v[148:151], v7 offset:1024
v_mfma_f32_16x16x32_bf16 v[132:135], v[156:159], a[84:87], v[132:135]
v_mfma_f32_16x16x32_bf16 v[136:139], v[164:167], a[80:83], v[136:139]
s_waitcnt vmcnt(5) lgkmcnt(6)
ds_read_b128 v[152:155], v7 offset:2048
v_mfma_f32_16x16x32_bf16 v[136:139], v[168:171], a[88:91], v[136:139]
buffer_atomic_add v1, v0, s[24:27], s82 offen offset:128 sc1
v_mfma_f32_16x16x32_bf16 v[140:143], v[168:171], a[92:95], v[140:143]
s_and_b32 s54, s3, 1
ds_read_b128 v[156:159], v7 offset:3072
v_mfma_f32_16x16x32_bf16 v[140:143], v[164:167], a[84:87], v[140:143]
s_mul_i32 s54, s54, 18432
v_mfma_f32_16x16x32_bf16 v[128:131], v[172:175], a[192:195], v[128:131]
s_waitcnt lgkmcnt(6)
s_mul_i32 s55, s86, 288
ds_read_b128 v[160:163], v7 offset:4096
v_mfma_f32_16x16x32_bf16 v[128:131], v[176:179], a[200:203], v[128:131]
s_add_u32 s54, s54, s55
v_mfma_f32_16x16x32_bf16 v[132:135], v[176:179], a[204:207], v[132:135]
s_add_u32 s54, s54, 256
ds_read_b128 v[164:167], v7 offset:5120
v_mfma_f32_16x16x32_bf16 v[132:135], v[172:175], a[196:199], v[132:135]
s_sub_u32 s55, 63, s72
v_mfma_f32_16x16x32_bf16 v[136:139], v[180:183], a[192:195], v[136:139]
s_waitcnt lgkmcnt(6)
s_mul_i32 s55, s55, 36864
ds_read_b128 v[168:171], v7 offset:6144
v_mfma_f32_16x16x32_bf16 v[136:139], v[184:187], a[200:203], v[136:139]
s_waitcnt vmcnt(1)
s_add_u32 s55, s55, s54
v_cmp_gt_u32 vcc, 4, v12
v_mfma_f32_16x16x32_bf16 v[140:143], v[184:187], a[204:207], v[140:143]
s_mul_i32 s52, s72, 36864
ds_read_b128 v[172:175], v7 offset:7168
v_mfma_f32_16x16x32_bf16 v[140:143], v[180:183], a[196:199], v[140:143]
s_waitcnt lgkmcnt(6)
s_add_u32 s54, s54, s52
v_mfma_f32_16x16x32_bf16 v[128:131], v[188:191], a[208:211], v[128:131]
s_cmp_eq_u64 vcc, 0
s_cselect_b32 s81, s69, 2147418112
s_cselect_b32 s93, s71, 2147418112
v_mfma_f32_16x16x32_bf16 v[128:131], v[144:147], a[216:219], v[128:131]
s_lshl_b32 s53, s84, 6
ds_read_b128 v[176:179], v7 offset:8192
v_mfma_f32_16x16x32_bf16 v[132:135], v[144:147], a[220:223], v[132:135]
L_PAD13:
s_cbranch_execz L_MAIN
s_sub_u32 s53, s53, 256
ds_read_b128 v[180:183], v7 offset:9216
v_mfma_f32_16x16x32_bf16 v[132:135], v[188:191], a[212:215], v[132:135]
buffer_load_dwordx4 v[192:195], v15, s[24:27], s81 offen offset:0 sc1
v_mfma_f32_16x16x32_bf16 v[136:139], v[148:151], a[208:211], v[136:139]
s_waitcnt lgkmcnt(6)
s_add_u32 s52, s54, s53
ds_read_b128 v[184:187], v7 offset:10240
v_mfma_f32_16x16x32_bf16 v[136:139], v[152:155], a[216:219], v[136:139]
s_add_u32 s53, s55, s53
v_mfma_f32_16x16x32_bf16 v[140:143], v[152:155], a[220:223], v[140:143]
buffer_load_dwordx4 v[196:199], v15, s[24:27], s81 offen offset:1024 sc1
v_mfma_f32_16x16x32_bf16 v[140:143], v[148:151], a[212:215], v[140:143]
ds_read_b128 v[188:191], v7 offset:11264
v_mfma_f32_16x16x32_bf16 v[128:131], v[156:159], a[224:227], v[128:131]
s_waitcnt lgkmcnt(6)
ds_read_b128 v[144:147], v7 offset:12288
v_mfma_f32_16x16x32_bf16 v[128:131], v[160:163], a[232:235], v[128:131]
buffer_load_dwordx4 v[200:203], v15, s[24:27], s81 offen offset:2048 sc1
v_mfma_f32_16x16x32_bf16 v[132:135], v[160:163], a[236:239], v[132:135]
ds_read_b128 v[148:151], v7 offset:13312
v_mfma_f32_16x16x32_bf16 v[132:135], v[156:159], a[228:231], v[132:135]
s_waitcnt lgkmcnt(6)
v_mfma_f32_16x16x32_bf16 v[136:139], v[164:167], a[224:227], v[136:139]
buffer_load_dwordx4 v[204:207], v15, s[24:27], s81 offen offset:3072 sc1
v_mfma_f32_16x16x32_bf16 v[136:139], v[168:171], a[232:235], v[136:139]
ds_read_b128 v[152:155], v7 offset:14336
v_mfma_f32_16x16x32_bf16 v[140:143], v[168:171], a[236:239], v[140:143]
ds_read_b128 v[156:159], v7 offset:15360
v_mfma_f32_16x16x32_bf16 v[140:143], v[164:167], a[228:231], v[140:143]
buffer_load_dwordx4 v[208:211], v15, s[24:27], s93 offen offset:0 sc1
v_mfma_f32_16x16x32_bf16 v[128:131], v[172:175], a[240:243], v[128:131]
s_waitcnt lgkmcnt(6)
s_add_u32 s91, s91, 16384
ds_read_b128 v[160:163], v8 offset:0
v_mfma_f32_16x16x32_bf16 v[128:131], v[176:179], a[248:251], v[128:131]
s_cmp_ge_u32 s91, 163840
s_cselect_b32 s91, 0, s91
v_add_u32 v7, s91, v4
v_mfma_f32_16x16x32_bf16 v[132:135], v[176:179], a[252:255], v[132:135]
buffer_load_dwordx4 v[212:215], v15, s[24:27], s93 offen offset:1024 sc1
v_mfma_f32_16x16x32_bf16 v[132:135], v[172:175], a[244:247], v[132:135]
ds_read_b128 v[164:167], v8 offset:1024
v_mfma_f32_16x16x32_bf16 v[136:139], v[180:183], a[240:243], v[136:139]
s_waitcnt lgkmcnt(6)
ds_read_b128 v[168:171], v8 offset:2048
v_mfma_f32_16x16x32_bf16 v[136:139], v[184:187], a[248:251], v[136:139]
buffer_load_dwordx4 v[216:219], v15, s[24:27], s93 offen offset:2048 sc1
v_mfma_f32_16x16x32_bf16 v[140:143], v[184:187], a[252:255], v[140:143]
ds_read_b128 v[172:175], v8 offset:3072
v_mfma_f32_16x16x32_bf16 v[140:143], v[180:183], a[244:247], v[140:143]
v_mfma_f32_16x16x32_bf16 v[128:131], v[188:191], a[96:99], v[128:131]
s_waitcnt lgkmcnt(6)
ds_read_b128 v[176:179], v8 offset:4096
v_mfma_f32_16x16x32_bf16 v[128:131], v[144:147], a[104:107], v[128:131]
v_mfma_f32_16x16x32_bf16 v[132:135], v[144:147], a[108:111], v[132:135]
ds_read_b128 v[180:183], v8 offset:5120
v_mfma_f32_16x16x32_bf16 v[132:135], v[188:191], a[100:103], v[132:135]
v_mfma_f32_16x16x32_bf16 v[136:139], v[148:151], a[96:99], v[136:139]
s_waitcnt lgkmcnt(6)
ds_read_b128 v[184:187], v8 offset:6144
v_mfma_f32_16x16x32_bf16 v[136:139], v[152:155], a[104:107], v[136:139]
v_mfma_f32_16x16x32_bf16 v[140:143], v[152:155], a[108:111], v[140:143]
ds_read_b128 v[188:191], v8 offset:7168
v_mfma_f32_16x16x32_bf16 v[140:143], v[148:151], a[100:103], v[140:143]
v_mfma_f32_16x16x32_bf16 v[128:131], v[156:159], a[112:115], v[128:131]
s_waitcnt lgkmcnt(6)
ds_read_b128 v[144:147], v8 offset:8192
v_mfma_f32_16x16x32_bf16 v[128:131], v[160:163], a[120:123], v[128:131]
v_mfma_f32_16x16x32_bf16 v[132:135], v[160:163], a[124:127], v[132:135]
ds_read_b128 v[148:151], v8 offset:9216
v_mfma_f32_16x16x32_bf16 v[132:135], v[156:159], a[116:119], v[132:135]
s_waitcnt lgkmcnt(6)
v_mfma_f32_16x16x32_bf16 v[136:139], v[164:167], a[112:115], v[136:139]
buffer_load_dword v12, v10, s[24:27], s75 offen offset:128 sc1
v_mfma_f32_16x16x32_bf16 v[136:139], v[168:171], a[120:123], v[136:139]
ds_read_b128 v[152:155], v8 offset:10240
v_mfma_f32_16x16x32_bf16 v[140:143], v[168:171], a[124:127], v[140:143]
ds_read_b128 v[156:159], v8 offset:11264
v_mfma_f32_16x16x32_bf16 v[140:143], v[164:167], a[116:119], v[140:143]
v_mfma_f32_16x16x32_bf16 v[128:131], v[172:175], a[128:131], v[128:131]
s_waitcnt lgkmcnt(6)
ds_read_b128 v[160:163], v8 offset:12288
v_mfma_f32_16x16x32_bf16 v[128:131], v[176:179], a[136:139], v[128:131]
v_mfma_f32_16x16x32_bf16 v[132:135], v[176:179], a[140:143], v[132:135]
ds_read_b128 v[164:167], v8 offset:13312
v_mfma_f32_16x16x32_bf16 v[132:135], v[172:175], a[132:135], v[132:135]
v_mfma_f32_16x16x32_bf16 v[136:139], v[180:183], a[128:131], v[136:139]
s_waitcnt lgkmcnt(6)
ds_read_b128 v[168:171], v8 offset:14336
v_mfma_f32_16x16x32_bf16 v[136:139], v[184:187], a[136:139], v[136:139]
v_mfma_f32_16x16x32_bf16 v[140:143], v[184:187], a[140:143], v[140:143]
s_waitcnt vmcnt(10)
ds_read_b128 v[172:175], v8 offset:15360
v_mfma_f32_16x16x32_bf16 v[140:143], v[180:183], a[132:135], v[140:143]
s_barrier
v_mfma_f32_16x16x32_bf16 v[128:131], v[188:191], a[144:147], v[128:131]
s_waitcnt lgkmcnt(6)
ds_read_b128 v[176:179], v7 offset:0
v_mfma_f32_16x16x32_bf16 v[128:131], v[144:147], a[152:155], v[128:131]
v_mfma_f32_16x16x32_bf16 v[132:135], v[144:147], a[156:159], v[132:135]
ds_read_b128 v[180:183], v7 offset:1024
v_mfma_f32_16x16x32_bf16 v[132:135], v[188:191], a[148:151], v[132:135]
v_mfma_f32_16x16x32_bf16 v[136:139], v[148:151], a[144:147], v[136:139]
s_waitcnt lgkmcnt(6)
ds_read_b128 v[184:187], v7 offset:2048
v_mfma_f32_16x16x32_bf16 v[136:139], v[152:155], a[152:155], v[136:139]
v_mfma_f32_16x16x32_bf16 v[140:143], v[152:155], a[156:159], v[140:143]
ds_read_b128 v[188:191], v7 offset:3072
v_mfma_f32_16x16x32_bf16 v[140:143], v[148:151], a[148:151], v[140:143]
v_mfma_f32_16x16x32_bf16 v[128:131], v[156:159], a[160:163], v[128:131]
s_waitcnt lgkmcnt(6)
ds_read_b128 v[144:147], v7 offset:4096
v_mfma_f32_16x16x32_bf16 v[128:131], v[160:163], a[168:171], v[128:131]
v_mfma_f32_16x16x32_bf16 v[132:135], v[160:163], a[172:175], v[132:135]
ds_read_b128 v[148:151], v7 offset:5120
v_mfma_f32_16x16x32_bf16 v[132:135], v[156:159], a[164:167], v[132:135]
v_mfma_f32_16x16x32_bf16 v[136:139], v[164:167], a[160:163], v[136:139]
s_waitcnt lgkmcnt(6)
ds_read_b128 v[152:155], v7 offset:6144
v_mfma_f32_16x16x32_bf16 v[136:139], v[168:171], a[168:171], v[136:139]
v_mfma_f32_16x16x32_bf16 v[140:143], v[168:171], a[172:175], v[140:143]
s_waitcnt vmcnt(0)
ds_read_b128 v[156:159], v7 offset:7168
v_cmp_gt_u32 vcc, 1, v12
v_mfma_f32_16x16x32_bf16 v[140:143], v[164:167], a[164:167], v[140:143]
v_lshlrev_b32 v72, 16, v192
v_and_b32 v73, v13, v192
v_mfma_f32_16x16x32_bf16 v[128:131], v[172:175], a[176:179], v[128:131]
s_waitcnt lgkmcnt(6)
ds_read_b128 v[160:163], v7 offset:8192
v_lshlrev_b32 v74, 16, v193
v_mfma_f32_16x16x32_bf16 v[128:131], v[176:179], a[184:187], v[128:131]
s_cmp_eq_u64 vcc, 0
s_cselect_b32 s77, s83, 2147418112
v_and_b32 v75, v13, v193
v_mfma_f32_16x16x32_bf16 v[132:135], v[176:179], a[188:191], v[132:135]
buffer_load_dwordx4 v[220:223], v15, s[24:27], s77 offen offset:0 sc1
v_mfma_f32_16x16x32_bf16 v[132:135], v[172:175], a[180:183], v[132:135]
s_waitcnt lgkmcnt(5)
ds_read_b128 v[164:167], v7 offset:9216
v_lshlrev_b32 v80, 16, v194
v_mfma_f32_16x16x32_bf16 v[136:139], v[180:183], a[176:179], v[136:139]
buffer_load_dwordx4 v[224:227], v15, s[24:27], s77 offen offset:1024 sc1
v_mfma_f32_16x16x32_bf16 v[136:139], v[184:187], a[184:187], v[136:139]
ds_read_b128 v[168:171], v7 offset:10240
v_and_b32 v81, v13, v194
v_mfma_f32_16x16x32_bf16 v[140:143], v[184:187], a[188:191], v[140:143]
ds_read_b128 v[172:175], v7 offset:11264
v_lshlrev_b32 v82, 16, v195
v_mfma_f32_16x16x32_bf16 v[140:143], v[180:183], a[180:183], v[140:143]
s_waitcnt lgkmcnt(6)
v_and_b32 v83, v13, v195
v_lshlrev_b32 v76, 16, v196
v_mfma_f32_16x16x32_bf16 v[128:131], v[188:191], v[32:35], v[128:131]
buffer_load_dword v11, v10, s[24:27], s73 offen sc1
v_mfma_f32_16x16x32_bf16 v[128:131], v[144:147], v[40:43], v[128:131]
ds_read_b128 v[176:179], v7 offset:12288
v_and_b32 v77, v13, v196
v_mfma_f32_16x16x32_bf16 v[132:135], v[144:147], v[44:47], v[132:135]
buffer_load_dword v12, v10, s[24:27], s75 offen offset:128 sc1
v_mfma_f32_16x16x32_bf16 v[132:135], v[188:191], v[36:39], v[132:135]
v_lshlrev_b32 v78, 16, v197
v_and_b32 v79, v13, v197
v_mfma_f32_16x16x32_bf16 v[136:139], v[148:151], v[32:35], v[136:139]
s_waitcnt lgkmcnt(5)
v_lshlrev_b32 v84, 16, v198
v_and_b32 v85, v13, v198
v_mfma_f32_16x16x32_bf16 v[136:139], v[152:155], v[40:43], v[136:139]
v_lshlrev_b32 v86, 16, v199
v_and_b32 v87, v13, v199
v_mfma_f32_16x16x32_bf16 v[140:143], v[152:155], v[44:47], v[140:143]
v_lshlrev_b32 v88, 16, v200
v_and_b32 v89, v13, v200
v_mfma_f32_16x16x32_bf16 v[140:143], v[148:151], v[36:39], v[140:143]
v_lshlrev_b32 v90, 16, v201
v_and_b32 v91, v13, v201
v_mfma_f32_16x16x32_bf16 v[128:131], v[156:159], v[48:51], v[128:131]
s_waitcnt lgkmcnt(3)
v_lshlrev_b32 v96, 16, v202
v_and_b32 v97, v13, v202
v_mfma_f32_16x16x32_bf16 v[128:131], v[160:163], v[56:59], v[128:131]
v_lshlrev_b32 v98, 16, v203
v_and_b32 v99, v13, v203
v_mfma_f32_16x16x32_bf16 v[132:135], v[160:163], v[60:63], v[132:135]
v_lshlrev_b32 v92, 16, v204
v_and_b32 v93, v13, v204
v_mfma_f32_16x16x32_bf16 v[132:135], v[156:159], v[52:55], v[132:135]
v_lshlrev_b32 v94, 16, v205
v_and_b32 v95, v13, v205
v_mfma_f32_16x16x32_bf16 v[136:139], v[164:167], v[48:51], v[136:139]
s_waitcnt lgkmcnt(1)
v_lshlrev_b32 v100, 16, v206
v_and_b32 v101, v13, v206
v_mfma_f32_16x16x32_bf16 v[136:139], v[168:171], v[56:59], v[136:139]
v_lshlrev_b32 v102, 16, v207
v_and_b32 v103, v13, v207
v_mfma_f32_16x16x32_bf16 v[140:143], v[168:171], v[60:63], v[140:143]
v_mfma_f32_16x16x32_bf16 v[140:143], v[164:167], v[52:55], v[140:143]
v_mfma_f32_16x16x32_bf16 v[128:131], v[172:175], v[64:67], v[128:131]
v_mfma_f32_16x16x32_bf16 v[132:135], v[172:175], v[68:71], v[132:135]
s_waitcnt lgkmcnt(0)
v_mfma_f32_16x16x32_bf16 v[136:139], v[176:179], v[64:67], v[136:139]
v_mfma_f32_16x16x32_bf16 v[140:143], v[176:179], v[68:71], v[140:143]
s_max_u32 s92, s81, s77
s_cmp_lt_u32 s92, 2147418112
s_cbranch_scc1 L_P1
s_mov_b32 s92, 0
s_branch L_S1
L_S0:
s_sleep 8
buffer_load_dword v11, v10, s[24:27], s73 offen sc1
buffer_load_dword v12, v10, s[24:27], s75 offen offset:128 sc1
L_S1:
s_waitcnt vmcnt(0)
v_cmp_gt_u32 vcc, 4, v11
s_add_u32 s92, s92, 1
s_cmp_gt_u32 s92, 1048576
s_cbranch_scc1 L_S2
s_nop 1
s_cbranch_vccnz L_S0
L_S2:
s_cmp_eq_u32 s81, s69
s_cbranch_scc1 L_S4
buffer_load_dwordx4 v[192:195], v15, s[24:27], s69 offen offset:0 sc1
buffer_load_dwordx4 v[196:199], v15, s[24:27], s69 offen offset:1024 sc1
buffer_load_dwordx4 v[200:203], v15, s[24:27], s69 offen offset:2048 sc1
buffer_load_dwordx4 v[204:207], v15, s[24:27], s69 offen offset:3072 sc1
buffer_load_dwordx4 v[208:211], v15, s[24:27], s71 offen offset:0 sc1
buffer_load_dwordx4 v[212:215], v15, s[24:27], s71 offen offset:1024 sc1
buffer_load_dwordx4 v[216:219], v15, s[24:27], s71 offen offset:2048 sc1
s_branch L_S4
L_S3:
s_sleep 2
buffer_load_dword v12, v10, s[24:27], s75 offen offset:128 sc1
s_waitcnt vmcnt(0)
L_S4:
v_cmp_gt_u32 vcc, 1, v12
s_add_u32 s92, s92, 1
s_cmp_gt_u32 s92, 1048576
s_cbranch_scc1 L_S5
s_nop 1
s_cbranch_vccnz L_S3
L_S5:
buffer_load_dwordx4 v[220:223], v15, s[24:27], s83 offen offset:0 sc1
buffer_load_dwordx4 v[224:227], v15, s[24:27], s83 offen offset:1024 sc1
s_cmp_eq_u32 s81, s69
s_cbranch_scc1 L_P1
s_waitcnt vmcnt(2)
v_lshlrev_b32 v72, 16, v192
v_and_b32 v73, v13, v192
v_lshlrev_b32 v74, 16, v193
v_and_b32 v75, v13, v193
v_lshlrev_b32 v80, 16, v194
v_and_b32 v81, v13, v194
v_lshlrev_b32 v82, 16, v195
v_and_b32 v83, v13, v195
v_lshlrev_b32 v76, 16, v196
v_and_b32 v77, v13, v196
v_lshlrev_b32 v78, 16, v197
v_and_b32 v79, v13, v197
v_lshlrev_b32 v84, 16, v198
v_and_b32 v85, v13, v198
v_lshlrev_b32 v86, 16, v199
v_and_b32 v87, v13, v199
v_lshlrev_b32 v88, 16, v200
v_and_b32 v89, v13, v200
v_lshlrev_b32 v90, 16, v201
v_and_b32 v91, v13, v201
v_lshlrev_b32 v96, 16, v202
v_and_b32 v97, v13, v202
v_lshlrev_b32 v98, 16, v203
v_and_b32 v99, v13, v203
v_lshlrev_b32 v92, 16, v204
v_and_b32 v93, v13, v204
v_lshlrev_b32 v94, 16, v205
v_and_b32 v95, v13, v205
v_lshlrev_b32 v100, 16, v206
v_and_b32 v101, v13, v206
v_lshlrev_b32 v102, 16, v207
v_and_b32 v103, v13, v207
L_P1:
s_nop 1
v_pk_add_f32 v[72:73], v[72:73], v[88:89]
v_pk_add_f32 v[74:75], v[74:75], v[90:91]
v_pk_add_f32 v[76:77], v[76:77], v[92:93]
v_pk_add_f32 v[78:79], v[78:79], v[94:95]
v_pk_add_f32 v[80:81], v[80:81], v[96:97]
v_pk_add_f32 v[82:83], v[82:83], v[98:99]
v_pk_add_f32 v[84:85], v[84:85], v[100:101]
v_pk_add_f32 v[86:87], v[86:87], v[102:103]
v_pk_add_f32 v[128:129], v[128:129], v[72:73]
v_pk_add_f32 v[130:131], v[130:131], v[74:75]
v_pk_add_f32 v[132:133], v[132:133], v[76:77]
v_pk_add_f32 v[134:135], v[134:135], v[78:79]
v_pk_add_f32 v[136:137], v[136:137], v[80:81]
v_pk_add_f32 v[138:139], v[138:139], v[82:83]
v_pk_add_f32 v[140:141], v[140:141], v[84:85]
v_pk_add_f32 v[142:143], v[142:143], v[86:87]
s_cmp_lg_u32 s3, s84
s_cbranch_scc1 L_NO9
v_lshlrev_b32 v16, 16, v208
v_and_b32 v17, v13, v208
v_lshlrev_b32 v18, 16, v209
v_and_b32 v19, v13, v209
v_lshlrev_b32 v20, 16, v210
v_and_b32 v21, v13, v210
v_lshlrev_b32 v22, 16, v211
v_and_b32 v23, v13, v211
v_pk_add_f32 v[120:121], v[120:121], v[16:17]
v_pk_add_f32 v[122:123], v[122:123], v[18:19]
v_pk_add_f32 v[124:125], v[124:125], v[20:21]
v_pk_add_f32 v[126:127], v[126:127], v[22:23]
v_lshlrev_b32 v16, 16, v212
v_and_b32 v17, v13, v212
v_lshlrev_b32 v18, 16, v213
v_and_b32 v19, v13, v213
v_lshlrev_b32 v20, 16, v214
v_and_b32 v21, v13, v214
v_lshlrev_b32 v22, 16, v215
v_and_b32 v23, v13, v215
v_pk_add_f32 v[120:121], v[120:121], v[16:17]
v_pk_add_f32 v[122:123], v[122:123], v[18:19]
v_pk_add_f32 v[124:125], v[124:125], v[20:21]
v_pk_add_f32 v[126:127], v[126:127], v[22:23]
v_lshlrev_b32 v16, 16, v216
v_and_b32 v17, v13, v216
v_lshlrev_b32 v18, 16, v217
v_and_b32 v19, v13, v217
v_lshlrev_b32 v20, 16, v218
v_and_b32 v21, v13, v218
v_lshlrev_b32 v22, 16, v219
v_and_b32 v23, v13, v219
v_pk_add_f32 v[120:121], v[120:121], v[16:17]
v_pk_add_f32 v[122:123], v[122:123], v[18:19]
v_pk_add_f32 v[124:125], v[124:125], v[20:21]
v_pk_add_f32 v[126:127], v[126:127], v[22:23]
v_cvt_pk_bf16_f32 v228, v120, v121
v_cvt_pk_bf16_f32 v229, v122, v123
v_cvt_pk_bf16_f32 v230, v124, v125
v_cvt_pk_bf16_f32 v231, v126, v127
s_waitcnt vmcnt(0)
buffer_store_dwordx2 v[228:229], v6, s[44:47], s54 offen sc1
buffer_store_dwordx2 v[230:231], v6, s[44:47], s55 offen sc1
s_branch L_9D
L_NO9:
s_waitcnt vmcnt(0)
L_9D:
v_lshlrev_b32 v16, 16, v220
v_and_b32 v17, v13, v220
v_lshlrev_b32 v18, 16, v221
v_and_b32 v19, v13, v221
v_lshlrev_b32 v20, 16, v222
v_and_b32 v21, v13, v222
v_lshlrev_b32 v22, 16, v223
v_and_b32 v23, v13, v223
v_pk_add_f32 v[128:129], v[128:129], v[16:17]
v_pk_add_f32 v[130:131], v[130:131], v[18:19]
v_pk_add_f32 v[136:137], v[136:137], v[20:21]
v_pk_add_f32 v[138:139], v[138:139], v[22:23]
v_cvt_pk_bf16_f32 v128, v128, v129
v_cvt_pk_bf16_f32 v129, v130, v131
v_cvt_pk_bf16_f32 v130, v136, v137
v_cvt_pk_bf16_f32 v131, v138, v139
s_nop 1
v_permlane16_swap_b32 v128, v130
v_permlane16_swap_b32 v129, v131
buffer_store_dwordx4 v[128:131], v5, s[44:47], s52 offen sc1
v_lshlrev_b32 v16, 16, v224
v_and_b32 v17, v13, v224
v_lshlrev_b32 v18, 16, v225
v_and_b32 v19, v13, v225
v_lshlrev_b32 v20, 16, v226
v_and_b32 v21, v13, v226
v_lshlrev_b32 v22, 16, v227
v_and_b32 v23, v13, v227
v_pk_add_f32 v[132:133], v[132:133], v[16:17]
v_pk_add_f32 v[134:135], v[134:135], v[18:19]
v_pk_add_f32 v[140:141], v[140:141], v[20:21]
v_pk_add_f32 v[142:143], v[142:143], v[22:23]
v_cvt_pk_bf16_f32 v132, v132, v133
v_cvt_pk_bf16_f32 v133, v134, v135
v_cvt_pk_bf16_f32 v134, v140, v141
v_cvt_pk_bf16_f32 v135, v142, v143
s_nop 1
v_permlane16_swap_b32 v132, v134
v_permlane16_swap_b32 v133, v135
buffer_store_dwordx4 v[132:135], v5, s[44:47], s53 offen sc1
L_END:
s_endpgm
L_SE2:
v_accvgpr_read_b32 v180, a224
v_accvgpr_read_b32 v182, a228
v_cmp_nle_f32 vcc, v180, v7
v_cmp_nle_f32 s[96:97], v182, v7
s_nop 3
s_or_b64 vcc, vcc, s[96:97]
s_cbranch_vccnz SLOW0
SLOW0_R:
s_add_u32 s53, s77, 163840
buffer_load_dwordx4 a[96:99], v15, s[24:27], s53 offen offset:0 sc1
v_mul_f32 v8, 0x3fb8aa3b, v8
v_mul_f32 v9, 0x3fb8aa3b, v9
v_exp_f32 v8, v8
v_exp_f32 v9, v9
s_nop 0
v_fma_f32 v180, v180, v8, v180
v_fma_f32 v182, v182, v9, v182
v_rcp_f32 v180, v180
v_rcp_f32 v182, v182
s_add_u32 s52, s78, 4096
v_mov_b32 v181, v180
v_mov_b32 v183, v182
v_accvgpr_read_b32 v16, a0
v_accvgpr_read_b32 v17, a1
v_accvgpr_read_b32 v18, a2
v_accvgpr_read_b32 v19, a3
v_accvgpr_read_b32 v20, a4
v_accvgpr_read_b32 v21, a5
buffer_load_dwordx4 a[100:103], v15, s[24:27], s53 offen offset:1024 sc1
v_accvgpr_read_b32 v22, a6
v_accvgpr_read_b32 v23, a7
v_pk_mul_f32 v[16:17], v[16:17], v[180:181]
v_pk_mul_f32 v[18:19], v[18:19], v[180:181]
v_pk_mul_f32 v[20:21], v[20:21], v[180:181]
v_pk_mul_f32 v[22:23], v[22:23], v[180:181]
v_cvt_pk_bf16_f32 v16, v16, v17
v_cvt_pk_bf16_f32 v17, v18, v19
v_cvt_pk_bf16_f32 v18, v20, v21
v_cvt_pk_bf16_f32 v19, v22, v23
buffer_store_dwordx4 v[16:19], v15, s[24:27], s78 offen offset:0 sc1
v_accvgpr_read_b32 v24, a32
v_accvgpr_read_b32 v25, a33
v_accvgpr_read_b32 v26, a34
v_accvgpr_read_b32 v27, a35
v_accvgpr_read_b32 v28, a36
v_accvgpr_read_b32 v29, a37
v_accvgpr_read_b32 v30, a38
buffer_load_dwordx4 a[104:107], v15, s[24:27], s53 offen offset:2048 sc1
v_accvgpr_read_b32 v31, a39
v_pk_mul_f32 v[24:25], v[24:25], v[182:183]
v_pk_mul_f32 v[26:27], v[26:27], v[182:183]
v_pk_mul_f32 v[28:29], v[28:29], v[182:183]
v_pk_mul_f32 v[30:31], v[30:31], v[182:183]
v_cvt_pk_bf16_f32 v24, v24, v25
v_cvt_pk_bf16_f32 v25, v26, v27
v_cvt_pk_bf16_f32 v26, v28, v29
v_cvt_pk_bf16_f32 v27, v30, v31
buffer_store_dwordx4 v[24:27], v15, s[24:27], s78 offen offset:1024 sc1
v_accvgpr_read_b32 v16, a8
v_accvgpr_read_b32 v17, a9
v_accvgpr_read_b32 v18, a10
v_accvgpr_read_b32 v19, a11
v_accvgpr_read_b32 v20, a12
v_accvgpr_read_b32 v21, a13
v_accvgpr_read_b32 v22, a14
v_accvgpr_read_b32 v23, a15
buffer_load_dwordx4 a[108:111], v15, s[24:27], s53 offen offset:3072 sc1
v_pk_mul_f32 v[16:17], v[16:17], v[180:181]
v_pk_mul_f32 v[18:19], v[18:19], v[180:181]
v_pk_mul_f32 v[20:21], v[20:21], v[180:181]
v_pk_mul_f32 v[22:23], v[22:23], v[180:181]
v_cvt_pk_bf16_f32 v16, v16, v17
v_cvt_pk_bf16_f32 v17, v18, v19
v_cvt_pk_bf16_f32 v18, v20, v21
v_cvt_pk_bf16_f32 v19, v22, v23
buffer_store_dwordx4 v[16:19], v15, s[24:27], s78 offen offset:2048 sc1
v_accvgpr_read_b32 v24, a40
v_accvgpr_read_b32 v25, a41
v_accvgpr_read_b32 v26, a42
v_accvgpr_read_b32 v27, a43
v_accvgpr_read_b32 v28, a44
v_accvgpr_read_b32 v29, a45
v_accvgpr_read_b32 v30, a46
v_accvgpr_read_b32 v31, a47
v_pk_mul_f32 v[24:25], v[24:25], v[182:183]
s_add_u32 s53, s77, 180224
buffer_load_dwordx4 a[112:115], v15, s[24:27], s53 offen offset:0 sc1
v_pk_mul_f32 v[26:27], v[26:27], v[182:183]
v_pk_mul_f32 v[28:29], v[28:29], v[182:183]
v_pk_mul_f32 v[30:31], v[30:31], v[182:183]
v_cvt_pk_bf16_f32 v24, v24, v25
v_cvt_pk_bf16_f32 v25, v26, v27
v_cvt_pk_bf16_f32 v26, v28, v29
v_cvt_pk_bf16_f32 v27, v30, v31
buffer_store_dwordx4 v[24:27], v15, s[24:27], s78 offen offset:3072 sc1
v_accvgpr_read_b32 v16, a16
v_accvgpr_read_b32 v17, a17
v_accvgpr_read_b32 v18, a18
v_accvgpr_read_b32 v19, a19
v_accvgpr_read_b32 v20, a20
v_accvgpr_read_b32 v21, a21
v_accvgpr_read_b32 v22, a22
v_accvgpr_read_b32 v23, a23
v_pk_mul_f32 v[16:17], v[16:17], v[180:181]
v_pk_mul_f32 v[18:19], v[18:19], v[180:181]
buffer_load_dwordx4 a[116:119], v15, s[24:27], s53 offen offset:1024 sc1
v_pk_mul_f32 v[20:21], v[20:21], v[180:181]
v_pk_mul_f32 v[22:23], v[22:23], v[180:181]
v_cvt_pk_bf16_f32 v16, v16, v17
v_cvt_pk_bf16_f32 v17, v18, v19
v_cvt_pk_bf16_f32 v18, v20, v21
v_cvt_pk_bf16_f32 v19, v22, v23
buffer_store_dwordx4 v[16:19], v15, s[24:27], s52 offen offset:0 sc1
v_accvgpr_read_b32 v24, a48
v_accvgpr_read_b32 v25, a49
v_accvgpr_read_b32 v26, a50
v_accvgpr_read_b32 v27, a51
v_accvgpr_read_b32 v28, a52
v_accvgpr_read_b32 v29, a53
v_accvgpr_read_b32 v30, a54
v_accvgpr_read_b32 v31, a55
v_pk_mul_f32 v[24:25], v[24:25], v[182:183]
v_pk_mul_f32 v[26:27], v[26:27], v[182:183]
v_pk_mul_f32 v[28:29], v[28:29], v[182:183]
buffer_load_dwordx4 a[120:123], v15, s[24:27], s53 offen offset:2048 sc1
v_pk_mul_f32 v[30:31], v[30:31], v[182:183]
v_cvt_pk_bf16_f32 v24, v24, v25
v_cvt_pk_bf16_f32 v25, v26, v27
v_cvt_pk_bf16_f32 v26, v28, v29
v_cvt_pk_bf16_f32 v27, v30, v31
buffer_store_dwordx4 v[24:27], v15, s[24:27], s52 offen offset:1024 sc1
v_accvgpr_read_b32 v16, a24
v_accvgpr_read_b32 v17, a25
v_accvgpr_read_b32 v18, a26
v_accvgpr_read_b32 v19, a27
v_accvgpr_read_b32 v20, a28
v_accvgpr_read_b32 v21, a29
v_accvgpr_read_b32 v22, a30
v_accvgpr_read_b32 v23, a31
v_pk_mul_f32 v[16:17], v[16:17], v[180:181]
v_pk_mul_f32 v[18:19], v[18:19], v[180:181]
v_pk_mul_f32 v[20:21], v[20:21], v[180:181]
v_pk_mul_f32 v[22:23], v[22:23], v[180:181]
buffer_load_dwordx4 a[124:127], v15, s[24:27], s53 offen offset:3072 sc1
v_cvt_pk_bf16_f32 v16, v16, v17
v_cvt_pk_bf16_f32 v17, v18, v19
v_cvt_pk_bf16_f32 v18, v20, v21
v_cvt_pk_bf16_f32 v19, v22, v23
buffer_store_dwordx4 v[16:19], v15, s[24:27], s52 offen offset:2048 sc1
v_accvgpr_read_b32 v24, a56
v_accvgpr_read_b32 v25, a57
v_accvgpr_read_b32 v26, a58
v_accvgpr_read_b32 v27, a59
v_accvgpr_read_b32 v28, a60
v_accvgpr_read_b32 v29, a61
v_accvgpr_read_b32 v30, a62
v_accvgpr_read_b32 v31, a63
v_pk_mul_f32 v[24:25], v[24:25], v[182:183]
v_pk_mul_f32 v[26:27], v[26:27], v[182:183]
v_pk_mul_f32 v[28:29], v[28:29], v[182:183]
v_pk_mul_f32 v[30:31], v[30:31], v[182:183]
v_cvt_pk_bf16_f32 v24, v24, v25
v_cvt_pk_bf16_f32 v25, v26, v27
v_cvt_pk_bf16_f32 v26, v28, v29
v_cvt_pk_bf16_f32 v27, v30, v31
buffer_store_dwordx4 v[24:27], v15, s[24:27], s52 offen offset:3072 sc1
s_branch L_LA
CK_Z:
s_mov_b32 s92, 0
CK_Z_L:
s_sleep 1
buffer_load_dword v23, v22, s[40:43], 0 offen sc1
s_add_u32 s92, s92, 1
s_waitcnt vmcnt(0)
v_cmp_gt_u32 vcc, 1, v23
s_cmp_gt_u32 s92, 1048576
s_cbranch_scc1 CK_Z_R
s_nop 3
s_cbranch_vccnz CK_Z_L
s_branch CK_Z_R
CK_WA:
s_mov_b32 s92, 0
CK_WA_L:
s_sleep 1
buffer_load_dword v30, v29, s[24:27], s89 offen sc1
s_add_u32 s92, s92, 1
s_waitcnt vmcnt(0)
v_cmp_gt_u32 vcc, 18, v30
s_cmp_gt_u32 s92, 1048576
s_cbranch_scc1 CK_WA_R
s_nop 3
s_cbranch_vccnz CK_WA_L
s_branch CK_WA_R
CK_ZA:
s_mov_b32 s92, 0
CK_ZA_L:
s_sleep 1
buffer_load_dword v30, v28, s[40:43], 0 offen sc1
s_add_u32 s92, s92, 1
s_waitcnt vmcnt(0)
v_cmp_gt_u32 vcc, 1, v30
s_cmp_gt_u32 s92, 1048576
s_cbranch_scc1 CK_ZA_R
s_nop 3
s_cbranch_vccnz CK_ZA_L
s_branch CK_ZA_R
CK_KV:
s_mov_b32 s92, 0
CK_KV_L:
s_sleep 1
buffer_load_dword v30, v29, s[24:27], s89 offen offset:4 sc1
s_add_u32 s92, s92, 1
s_waitcnt vmcnt(0)
v_cmp_gt_u32 vcc, 8, v30
s_cmp_gt_u32 s92, 1048576
s_cbranch_scc1 CK_KV_R
s_nop 3
s_cbranch_vccnz CK_KV_L
s_branch CK_KV_R
D0:
v_cndmask_b32 v96, v96, v6, s[56:57]
v_cndmask_b32 v120, v120, v6, s[56:57]
v_mov_b32 v112, v6
v_cndmask_b32 v97, v97, v6, s[58:59]
v_cndmask_b32 v121, v121, v6, s[58:59]
v_mov_b32 v113, v6
v_cndmask_b32 v98, v98, v6, s[60:61]
v_cndmask_b32 v122, v122, v6, s[60:61]
v_mov_b32 v114, v6
v_cndmask_b32 v99, v99, v6, s[62:63]
v_cndmask_b32 v123, v123, v6, s[62:63]
v_mov_b32 v115, v6
s_branch D0_R
CK_Q:
s_mov_b32 s92, 0
CK_Q_L:
s_sleep 1
buffer_load_dword v172, v28, s[24:27], 0 offen sc1
s_add_u32 s92, s92, 1
s_waitcnt vmcnt(0)
v_cmp_gt_u32 vcc, 32, v172
s_cmp_gt_u32 s92, 1048576
s_cbranch_scc1 CK_Q_R
s_nop 3
s_cbranch_vccnz CK_Q_L
s_branch CK_Q_R
CK_ZAA:
s_mov_b32 s92, 0
CK_ZAA_L:
s_sleep 1
buffer_load_dword v12, v10, s[24:27], s75 offen offset:128 sc1
s_add_u32 s92, s92, 1
s_waitcnt vmcnt(0)
v_cmp_gt_u32 vcc, 8, v12
s_cmp_gt_u32 s92, 1048576
s_cbranch_scc1 CK_ZAA_R
s_nop 3
s_cbranch_vccnz CK_ZAA_L
s_branch CK_ZAA_R
SLOW0:
v_add_u32 v20, 4096, v15
s_mov_b32 s54, 0
v_mov_b32 v16, v6
v_mov_b32 v18, v6
SLOW0_P:
s_mov_b32 s53, 0
s_mov_b32 s52, s94
SLOW0_T:
s_add_u32 s55, s52, 24576
buffer_load_dwordx4 a[192:195], v15, s[24:27], s52 offen offset:0 sc1
buffer_load_dwordx4 a[196:199], v15, s[24:27], s52 offen offset:1024 sc1
buffer_load_dwordx4 a[200:203], v15, s[24:27], s52 offen offset:2048 sc1
buffer_load_dwordx4 a[204:207], v15, s[24:27], s52 offen offset:3072 sc1
buffer_load_dwordx4 a[208:211], v20, s[24:27], s52 offen offset:0 sc1
buffer_load_dwordx4 a[212:215], v20, s[24:27], s52 offen offset:1024 sc1
buffer_load_dwordx4 a[216:219], v20, s[24:27], s52 offen offset:2048 sc1
buffer_load_dwordx4 a[220:223], v20, s[24:27], s52 offen offset:3072 sc1
buffer_load_dwordx4 a[64:67], v15, s[24:27], s55 offen offset:0 sc1
buffer_load_dwordx4 a[68:71], v15, s[24:27], s55 offen offset:1024 sc1
buffer_load_dwordx4 a[72:75], v15, s[24:27], s55 offen offset:2048 sc1
buffer_load_dwordx4 a[76:79], v15, s[24:27], s55 offen offset:3072 sc1
buffer_load_dwordx4 a[80:83], v20, s[24:27], s55 offen offset:0 sc1
buffer_load_dwordx4 a[84:87], v20, s[24:27], s55 offen offset:1024 sc1
buffer_load_dwordx4 a[88:91], v20, s[24:27], s55 offen offset:2048 sc1
buffer_load_dwordx4 a[92:95], v20, s[24:27], s55 offen offset:3072 sc1
s_waitcnt vmcnt(0)
v_mfma_f32_16x16x32_bf16 v[44:47], a[192:195], v[36:39], 0
v_mfma_f32_16x16x32_bf16 v[44:47], a[196:199], v[32:35], v[44:47]
v_mfma_f32_16x16x32_bf16 v[44:47], a[200:203], v[196:199], v[44:47]
v_mfma_f32_16x16x32_bf16 v[44:47], a[204:207], v[204:207], v[44:47]
v_mfma_f32_16x16x32_bf16 v[52:55], a[192:195], v[108:111], 0
v_mfma_f32_16x16x32_bf16 v[52:55], a[196:199], v[40:43], v[52:55]
v_mfma_f32_16x16x32_bf16 v[52:55], a[200:203], v[80:83], v[52:55]
v_mfma_f32_16x16x32_bf16 v[52:55], a[204:207], v[168:171], v[52:55]
v_mfma_f32_16x16x32_bf16 v[64:67], a[208:211], v[36:39], 0
v_mfma_f32_16x16x32_bf16 v[64:67], a[212:215], v[32:35], v[64:67]
v_mfma_f32_16x16x32_bf16 v[64:67], a[216:219], v[196:199], v[64:67]
v_mfma_f32_16x16x32_bf16 v[64:67], a[220:223], v[204:207], v[64:67]
v_mfma_f32_16x16x32_bf16 v[212:215], a[208:211], v[108:111], 0
v_mfma_f32_16x16x32_bf16 v[212:215], a[212:215], v[40:43], v[212:215]
v_mfma_f32_16x16x32_bf16 v[212:215], a[216:219], v[80:83], v[212:215]
v_mfma_f32_16x16x32_bf16 v[212:215], a[220:223], v[168:171], v[212:215]
s_nop 7
s_cmp_lg_u32 s53, s66
s_cbranch_scc1 SLOW0_U
v_cndmask_b32 v44, v44, v6, s[56:57]
v_cndmask_b32 v212, v212, v6, s[56:57]
v_mov_b32 v64, v6
v_cndmask_b32 v45, v45, v6, s[58:59]
v_cndmask_b32 v213, v213, v6, s[58:59]
v_mov_b32 v65, v6
v_cndmask_b32 v46, v46, v6, s[60:61]
v_cndmask_b32 v214, v214, v6, s[60:61]
v_mov_b32 v66, v6
v_cndmask_b32 v47, v47, v6, s[62:63]
v_cndmask_b32 v215, v215, v6, s[62:63]
v_mov_b32 v67, v6
SLOW0_U:
s_cmp_lg_u32 s54, 0
s_cbranch_scc1 SLOW0_A
v_max3_f32 v16, v16, v44, v45
v_max3_f32 v16, v16, v46, v47
v_max3_f32 v18, v18, v52, v53
v_max3_f32 v18, v18, v54, v55
v_max3_f32 v16, v16, v64, v65
v_max3_f32 v16, v16, v66, v67
v_max3_f32 v18, v18, v212, v213
v_max3_f32 v18, v18, v214, v215
s_branch SLOW0_N
SLOW0_A:
v_sub_f32 v44, v44, v16
v_sub_f32 v45, v45, v16
v_sub_f32 v46, v46, v16
v_sub_f32 v47, v47, v16
v_sub_f32 v52, v52, v18
v_sub_f32 v53, v53, v18
v_sub_f32 v54, v54, v18
v_sub_f32 v55, v55, v18
v_sub_f32 v64, v64, v16
v_sub_f32 v65, v65, v16
v_sub_f32 v66, v66, v16
v_sub_f32 v67, v67, v16
v_sub_f32 v212, v212, v18
v_sub_f32 v213, v213, v18
v_sub_f32 v214, v214, v18
v_sub_f32 v215, v215, v18
v_exp_f32 v44, v44
v_exp_f32 v45, v45
v_exp_f32 v46, v46
v_exp_f32 v47, v47
v_exp_f32 v52, v52
v_exp_f32 v53, v53
v_exp_f32 v54, v54
v_exp_f32 v55, v55
v_exp_f32 v64, v64
v_exp_f32 v65, v65
v_exp_f32 v66, v66
v_exp_f32 v67, v67
v_exp_f32 v212, v212
v_exp_f32 v213, v213
v_exp_f32 v214, v214
v_exp_f32 v215, v215
s_nop 0
v_cvt_pk_bf16_f32 v124, v44, v45
v_cvt_pk_bf16_f32 v125, v46, v47
v_cvt_pk_bf16_f32 v140, v52, v53
v_cvt_pk_bf16_f32 v141, v54, v55
v_cvt_pk_bf16_f32 v126, v64, v65
v_cvt_pk_bf16_f32 v127, v66, v67
v_cvt_pk_bf16_f32 v142, v212, v213
v_cvt_pk_bf16_f32 v143, v214, v215
s_nop 1
v_mfma_f32_16x16x32_bf16 a[0:3], a[64:67], v[124:127], a[0:3]
v_mfma_f32_16x16x32_bf16 a[32:35], a[64:67], v[140:143], a[32:35]
v_mfma_f32_16x16x32_bf16 a[36:39], a[68:71], v[140:143], a[36:39]
v_mfma_f32_16x16x32_bf16 a[4:7], a[68:71], v[124:127], a[4:7]
v_mfma_f32_16x16x32_bf16 a[8:11], a[72:75], v[124:127], a[8:11]
v_mfma_f32_16x16x32_bf16 a[40:43], a[72:75], v[140:143], a[40:43]
v_mfma_f32_16x16x32_bf16 a[44:47], a[76:79], v[140:143], a[44:47]
v_mfma_f32_16x16x32_bf16 a[12:15], a[76:79], v[124:127], a[12:15]
v_mfma_f32_16x16x32_bf16 a[16:19], a[80:83], v[124:127], a[16:19]
v_mfma_f32_16x16x32_bf16 a[48:51], a[80:83], v[140:143], a[48:51]
v_mfma_f32_16x16x32_bf16 a[52:55], a[84:87], v[140:143], a[52:55]
v_mfma_f32_16x16x32_bf16 a[20:23], a[84:87], v[124:127], a[20:23]
v_mfma_f32_16x16x32_bf16 a[24:27], a[88:91], v[124:127], a[24:27]
v_mfma_f32_16x16x32_bf16 a[56:59], a[88:91], v[140:143], a[56:59]
v_mfma_f32_16x16x32_bf16 a[60:63], a[92:95], v[140:143], a[60:63]
v_mfma_f32_16x16x32_bf16 a[28:31], a[92:95], v[124:127], a[28:31]
v_mfma_f32_16x16x32_bf16 a[224:227], a[240:243], v[124:127], a[224:227]
v_mfma_f32_16x16x32_bf16 a[228:231], a[240:243], v[140:143], a[228:231]
SLOW0_N:
s_add_u32 s52, s52, 16384
s_add_u32 s53, s53, 1
s_cmp_le_u32 s53, s66
s_cbranch_scc1 SLOW0_T
s_cmp_lg_u32 s54, 0
s_cbranch_scc1 SLOW0_E
v_mov_b32 v17, v16
v_mov_b32 v19, v18
s_nop 1
v_permlane32_swap_b32 v17, v16
v_permlane32_swap_b32 v19, v18
s_nop 1
v_max_f32 v16, v16, v17
v_max_f32 v18, v18, v19
v_mov_b32 v17, v16
v_mov_b32 v19, v18
s_nop 1
v_permlane16_swap_b32 v17, v16
v_permlane16_swap_b32 v19, v18
s_nop 1
v_max_f32 v16, v16, v17
v_max_f32 v18, v18, v19
v_accvgpr_write_b32 a0, 0
v_accvgpr_write_b32 a1, 0
v_accvgpr_write_b32 a2, 0
v_accvgpr_write_b32 a3, 0
v_accvgpr_write_b32 a4, 0
v_accvgpr_write_b32 a5, 0
v_accvgpr_write_b32 a6, 0
v_accvgpr_write_b32 a7, 0
v_accvgpr_write_b32 a8, 0
v_accvgpr_write_b32 a9, 0
v_accvgpr_write_b32 a10, 0
v_accvgpr_write_b32 a11, 0
v_accvgpr_write_b32 a12, 0
v_accvgpr_write_b32 a13, 0
v_accvgpr_write_b32 a14, 0
v_accvgpr_write_b32 a15, 0
v_accvgpr_write_b32 a16, 0
v_accvgpr_write_b32 a17, 0
v_accvgpr_write_b32 a18, 0
v_accvgpr_write_b32 a19, 0
v_accvgpr_write_b32 a20, 0
v_accvgpr_write_b32 a21, 0
v_accvgpr_write_b32 a22, 0
v_accvgpr_write_b32 a23, 0
v_accvgpr_write_b32 a24, 0
v_accvgpr_write_b32 a25, 0
v_accvgpr_write_b32 a26, 0
v_accvgpr_write_b32 a27, 0
v_accvgpr_write_b32 a28, 0
v_accvgpr_write_b32 a29, 0
v_accvgpr_write_b32 a30, 0
v_accvgpr_write_b32 a31, 0
v_accvgpr_write_b32 a32, 0
v_accvgpr_write_b32 a33, 0
v_accvgpr_write_b32 a34, 0
v_accvgpr_write_b32 a35, 0
v_accvgpr_write_b32 a36, 0
v_accvgpr_write_b32 a37, 0
v_accvgpr_write_b32 a38, 0
v_accvgpr_write_b32 a39, 0
v_accvgpr_write_b32 a40, 0
v_accvgpr_write_b32 a41, 0
v_accvgpr_write_b32 a42, 0
v_accvgpr_write_b32 a43, 0
v_accvgpr_write_b32 a44, 0
v_accvgpr_write_b32 a45, 0
v_accvgpr_write_b32 a46, 0
v_accvgpr_write_b32 a47, 0
v_accvgpr_write_b32 a48, 0
v_accvgpr_write_b32 a49, 0
v_accvgpr_write_b32 a50, 0
v_accvgpr_write_b32 a51, 0
v_accvgpr_write_b32 a52, 0
v_accvgpr_write_b32 a53, 0
v_accvgpr_write_b32 a54, 0
v_accvgpr_write_b32 a55, 0
v_accvgpr_write_b32 a56, 0
v_accvgpr_write_b32 a57, 0
v_accvgpr_write_b32 a58, 0
v_accvgpr_write_b32 a59, 0
v_accvgpr_write_b32 a60, 0
v_accvgpr_write_b32 a61, 0
v_accvgpr_write_b32 a62, 0
v_accvgpr_write_b32 a63, 0
v_accvgpr_write_b32 a224, 0
v_accvgpr_write_b32 a225, 0
v_accvgpr_write_b32 a226, 0
v_accvgpr_write_b32 a227, 0
v_accvgpr_write_b32 a228, 0
v_accvgpr_write_b32 a229, 0
v_accvgpr_write_b32 a230, 0
v_accvgpr_write_b32 a231, 0
s_mov_b32 s54, 1
s_branch SLOW0_P
SLOW0_E:
s_nop 7
v_accvgpr_read_b32 v180, a224
v_accvgpr_read_b32 v182, a228
s_branch SLOW0_R
SLOW1:
v_add_u32 v20, 4096, v15
s_mov_b32 s54, 0
v_mov_b32 v16, v6
v_mov_b32 v18, v6
SLOW1_P:
s_mov_b32 s53, 0
s_mov_b32 s52, s94
SLOW1_T:
s_add_u32 s55, s52, 24576
buffer_load_dwordx4 a[192:195], v15, s[24:27], s52 offen offset:0 sc1
buffer_load_dwordx4 a[196:199], v15, s[24:27], s52 offen offset:1024 sc1
buffer_load_dwordx4 a[200:203], v15, s[24:27], s52 offen offset:2048 sc1
buffer_load_dwordx4 a[204:207], v15, s[24:27], s52 offen offset:3072 sc1
buffer_load_dwordx4 a[208:211], v20, s[24:27], s52 offen offset:0 sc1
buffer_load_dwordx4 a[212:215], v20, s[24:27], s52 offen offset:1024 sc1
buffer_load_dwordx4 a[216:219], v20, s[24:27], s52 offen offset:2048 sc1
buffer_load_dwordx4 a[220:223], v20, s[24:27], s52 offen offset:3072 sc1
buffer_load_dwordx4 a[64:67], v15, s[24:27], s55 offen offset:0 sc1
buffer_load_dwordx4 a[68:71], v15, s[24:27], s55 offen offset:1024 sc1
buffer_load_dwordx4 a[72:75], v15, s[24:27], s55 offen offset:2048 sc1
buffer_load_dwordx4 a[76:79], v15, s[24:27], s55 offen offset:3072 sc1
buffer_load_dwordx4 a[80:83], v20, s[24:27], s55 offen offset:0 sc1
buffer_load_dwordx4 a[84:87], v20, s[24:27], s55 offen offset:1024 sc1
buffer_load_dwordx4 a[88:91], v20, s[24:27], s55 offen offset:2048 sc1
buffer_load_dwordx4 a[92:95], v20, s[24:27], s55 offen offset:3072 sc1
s_waitcnt vmcnt(0)
v_mfma_f32_16x16x32_bf16 v[44:47], a[192:195], v[116:119], 0
v_mfma_f32_16x16x32_bf16 v[44:47], a[196:199], v[132:135], v[44:47]
v_mfma_f32_16x16x32_bf16 v[44:47], a[200:203], v[184:187], v[44:47]
v_mfma_f32_16x16x32_bf16 v[44:47], a[204:207], v[240:243], v[44:47]
v_mfma_f32_16x16x32_bf16 v[52:55], a[192:195], v[188:191], 0
v_mfma_f32_16x16x32_bf16 v[52:55], a[196:199], v[56:59], v[52:55]
v_mfma_f32_16x16x32_bf16 v[52:55], a[200:203], v[88:91], v[52:55]
v_mfma_f32_16x16x32_bf16 v[52:55], a[204:207], v[192:195], v[52:55]
v_mfma_f32_16x16x32_bf16 v[64:67], a[208:211], v[116:119], 0
v_mfma_f32_16x16x32_bf16 v[64:67], a[212:215], v[132:135], v[64:67]
v_mfma_f32_16x16x32_bf16 v[64:67], a[216:219], v[184:187], v[64:67]
v_mfma_f32_16x16x32_bf16 v[64:67], a[220:223], v[240:243], v[64:67]
v_mfma_f32_16x16x32_bf16 v[212:215], a[208:211], v[188:191], 0
v_mfma_f32_16x16x32_bf16 v[212:215], a[212:215], v[56:59], v[212:215]
v_mfma_f32_16x16x32_bf16 v[212:215], a[216:219], v[88:91], v[212:215]
v_mfma_f32_16x16x32_bf16 v[212:215], a[220:223], v[192:195], v[212:215]
s_nop 7
s_cmp_lg_u32 s53, s67
s_cbranch_scc1 SLOW1_U
v_cndmask_b32 v44, v44, v6, s[56:57]
v_cndmask_b32 v212, v212, v6, s[56:57]
v_mov_b32 v64, v6
v_cndmask_b32 v45, v45, v6, s[58:59]
v_cndmask_b32 v213, v213, v6, s[58:59]
v_mov_b32 v65, v6
v_cndmask_b32 v46, v46, v6, s[60:61]
v_cndmask_b32 v214, v214, v6, s[60:61]
v_mov_b32 v66, v6
v_cndmask_b32 v47, v47, v6, s[62:63]
v_cndmask_b32 v215, v215, v6, s[62:63]
v_mov_b32 v67, v6
SLOW1_U:
s_cmp_lg_u32 s54, 0
s_cbranch_scc1 SLOW1_A
v_max3_f32 v16, v16, v44, v45
v_max3_f32 v16, v16, v46, v47
v_max3_f32 v18, v18, v52, v53
v_max3_f32 v18, v18, v54, v55
v_max3_f32 v16, v16, v64, v65
v_max3_f32 v16, v16, v66, v67
v_max3_f32 v18, v18, v212, v213
v_max3_f32 v18, v18, v214, v215
s_branch SLOW1_N
SLOW1_A:
v_sub_f32 v44, v44, v16
v_sub_f32 v45, v45, v16
v_sub_f32 v46, v46, v16
v_sub_f32 v47, v47, v16
v_sub_f32 v52, v52, v18
v_sub_f32 v53, v53, v18
v_sub_f32 v54, v54, v18
v_sub_f32 v55, v55, v18
v_sub_f32 v64, v64, v16
v_sub_f32 v65, v65, v16
v_sub_f32 v66, v66, v16
v_sub_f32 v67, v67, v16
v_sub_f32 v212, v212, v18
v_sub_f32 v213, v213, v18
v_sub_f32 v214, v214, v18
v_sub_f32 v215, v215, v18
v_exp_f32 v44, v44
v_exp_f32 v45, v45
v_exp_f32 v46, v46
v_exp_f32 v47, v47
v_exp_f32 v52, v52
v_exp_f32 v53, v53
v_exp_f32 v54, v54
v_exp_f32 v55, v55
v_exp_f32 v64, v64
v_exp_f32 v65, v65
v_exp_f32 v66, v66
v_exp_f32 v67, v67
v_exp_f32 v212, v212
v_exp_f32 v213, v213
v_exp_f32 v214, v214
v_exp_f32 v215, v215
s_nop 0
v_cvt_pk_bf16_f32 v124, v44, v45
v_cvt_pk_bf16_f32 v125, v46, v47
v_cvt_pk_bf16_f32 v140, v52, v53
v_cvt_pk_bf16_f32 v141, v54, v55
v_cvt_pk_bf16_f32 v126, v64, v65
v_cvt_pk_bf16_f32 v127, v66, v67
v_cvt_pk_bf16_f32 v142, v212, v213
v_cvt_pk_bf16_f32 v143, v214, v215
s_nop 1
v_mfma_f32_16x16x32_bf16 v[60:63], a[64:67], v[124:127], v[60:63]
v_mfma_f32_16x16x32_bf16 v[148:151], a[64:67], v[140:143], v[148:151]
v_mfma_f32_16x16x32_bf16 v[48:51], a[68:71], v[140:143], v[48:51]
v_mfma_f32_16x16x32_bf16 v[68:71], a[68:71], v[124:127], v[68:71]
v_mfma_f32_16x16x32_bf16 v[72:75], a[72:75], v[124:127], v[72:75]
v_mfma_f32_16x16x32_bf16 v[236:239], a[72:75], v[140:143], v[236:239]
v_mfma_f32_16x16x32_bf16 v[224:227], a[76:79], v[140:143], v[224:227]
v_mfma_f32_16x16x32_bf16 v[220:223], a[76:79], v[124:127], v[220:223]
v_mfma_f32_16x16x32_bf16 v[84:87], a[80:83], v[124:127], v[84:87]
v_mfma_f32_16x16x32_bf16 v[164:167], a[80:83], v[140:143], v[164:167]
v_mfma_f32_16x16x32_bf16 v[156:159], a[84:87], v[140:143], v[156:159]
v_mfma_f32_16x16x32_bf16 v[76:79], a[84:87], v[124:127], v[76:79]
v_mfma_f32_16x16x32_bf16 v[160:163], a[88:91], v[124:127], v[160:163]
v_mfma_f32_16x16x32_bf16 v[216:219], a[88:91], v[140:143], v[216:219]
v_mfma_f32_16x16x32_bf16 v[208:211], a[92:95], v[140:143], v[208:211]
v_mfma_f32_16x16x32_bf16 v[252:255], a[92:95], v[124:127], v[252:255]
v_mfma_f32_16x16x32_bf16 a[232:235], a[240:243], v[124:127], a[232:235]
v_mfma_f32_16x16x32_bf16 a[236:239], a[240:243], v[140:143], a[236:239]
SLOW1_N:
s_add_u32 s52, s52, 16384
s_add_u32 s53, s53, 1
s_cmp_le_u32 s53, s67
s_cbranch_scc1 SLOW1_T
s_cmp_lg_u32 s54, 0
s_cbranch_scc1 SLOW1_E
v_mov_b32 v17, v16
v_mov_b32 v19, v18
s_nop 1
v_permlane32_swap_b32 v17, v16
v_permlane32_swap_b32 v19, v18
s_nop 1
v_max_f32 v16, v16, v17
v_max_f32 v18, v18, v19
v_mov_b32 v17, v16
v_mov_b32 v19, v18
s_nop 1
v_permlane16_swap_b32 v17, v16
v_permlane16_swap_b32 v19, v18
s_nop 1
v_max_f32 v16, v16, v17
v_max_f32 v18, v18, v19
v_mov_b32 v60, 0
v_mov_b32 v61, 0
v_mov_b32 v62, 0
v_mov_b32 v63, 0
v_mov_b32 v68, 0
v_mov_b32 v69, 0
v_mov_b32 v70, 0
v_mov_b32 v71, 0
v_mov_b32 v72, 0
v_mov_b32 v73, 0
v_mov_b32 v74, 0
v_mov_b32 v75, 0
v_mov_b32 v220, 0
v_mov_b32 v221, 0
v_mov_b32 v222, 0
v_mov_b32 v223, 0
v_mov_b32 v84, 0
v_mov_b32 v85, 0
v_mov_b32 v86, 0
v_mov_b32 v87, 0
v_mov_b32 v76, 0
v_mov_b32 v77, 0
v_mov_b32 v78, 0
v_mov_b32 v79, 0
v_mov_b32 v160, 0
v_mov_b32 v161, 0
v_mov_b32 v162, 0
v_mov_b32 v163, 0
v_mov_b32 v252, 0
v_mov_b32 v253, 0
v_mov_b32 v254, 0
v_mov_b32 v255, 0
v_mov_b32 v148, 0
v_mov_b32 v149, 0
v_mov_b32 v150, 0
v_mov_b32 v151, 0
v_mov_b32 v48, 0
v_mov_b32 v49, 0
v_mov_b32 v50, 0
v_mov_b32 v51, 0
v_mov_b32 v236, 0
v_mov_b32 v237, 0
v_mov_b32 v238, 0
v_mov_b32 v239, 0
v_mov_b32 v224, 0
v_mov_b32 v225, 0
v_mov_b32 v226, 0
v_mov_b32 v227, 0
v_mov_b32 v164, 0
v_mov_b32 v165, 0
v_mov_b32 v166, 0
v_mov_b32 v167, 0
v_mov_b32 v156, 0
v_mov_b32 v157, 0
v_mov_b32 v158, 0
v_mov_b32 v159, 0
v_mov_b32 v216, 0
v_mov_b32 v217, 0
v_mov_b32 v218, 0
v_mov_b32 v219, 0
v_mov_b32 v208, 0
v_mov_b32 v209, 0
v_mov_b32 v210, 0
v_mov_b32 v211, 0
v_accvgpr_write_b32 a232, 0
v_accvgpr_write_b32 a233, 0
v_accvgpr_write_b32 a234, 0
v_accvgpr_write_b32 a235, 0
v_accvgpr_write_b32 a236, 0
v_accvgpr_write_b32 a237, 0
v_accvgpr_write_b32 a238, 0
v_accvgpr_write_b32 a239, 0
s_mov_b32 s54, 1
s_branch SLOW1_P
SLOW1_E:
s_nop 7
v_accvgpr_read_b32 v180, a232
v_accvgpr_read_b32 v182, a236
s_add_u32 s52, s79, 4096
v_fma_f32 v180, v180, v10, v180
v_fma_f32 v182, v182, v11, v182
v_rcp_f32 v180, v180
v_rcp_f32 v182, v182
s_nop 0
v_pk_mul_f32 v[60:61], v[60:61], v[180:181] op_sel_hi:[1,0]
v_pk_mul_f32 v[62:63], v[62:63], v[180:181] op_sel_hi:[1,0]
v_pk_mul_f32 v[68:69], v[68:69], v[180:181] op_sel_hi:[1,0]
v_pk_mul_f32 v[70:71], v[70:71], v[180:181] op_sel_hi:[1,0]
v_cvt_pk_bf16_f32 v60, v60, v61
v_cvt_pk_bf16_f32 v61, v62, v63
v_cvt_pk_bf16_f32 v62, v68, v69
v_cvt_pk_bf16_f32 v63, v70, v71
s_branch L_EP
.section .rodata,"a"
.p2align 6
.amdhsa_kernel gated_mix__sliding_local_dilated__compressed_kv_cla__prompt_kernel
  .amdhsa_next_free_vgpr 512
  .amdhsa_next_free_sgpr 102
  .amdhsa_accum_offset 256
  .amdhsa_group_segment_fixed_size 0
  .amdhsa_kernarg_size 104
  .amdhsa_user_sgpr_count 2
  .amdhsa_user_sgpr_kernarg_segment_ptr 1
  .amdhsa_system_sgpr_workgroup_id_x 1
.end_amdhsa_kernel
```
